```python
import torch

def _softmax(x, axis=-1):
    return torch.softmax(x, dim=axis)
def _gelu(x):
    return torch.nn.functional.gelu(x, approximate="tanh")
def _silu(x):
    return torch.nn.functional.silu(x)
def _sigmoid(x):
    return torch.sigmoid(x)
def _layernorm(x, axis=-1, eps=1e-5):
    m = x.mean(dim=axis, keepdim=True)
    v = x.var(dim=axis, keepdim=True, unbiased=False)
    return (x - m) / torch.sqrt(v + eps)
def _scatter_add(tgt, idx, src, axis=0):
    return tgt.clone().index_add_(axis, idx, src)
def _segment_sum(src, seg, n):
    out = torch.zeros((n,) + src.shape[1:], dtype=src.dtype)
    return out.index_add_(0, seg, src)
def _pad(x, pw):
    flat = tuple(v for pair in reversed(pw) for v in pair)
    return torch.nn.functional.pad(x, flat)

kernel_name = 'standalone__seq2seq_rnn_t_joint__speech'

def setup_inputs():

    _w = (lambda a: (lambda t: t.to(torch.bfloat16) if t.is_floating_point() else t)(torch.as_tensor(a)))
    B, T, D, K = 2, 16000, 256, 31
    U = 8
    sc = (1.0 / (K * D)) ** 0.5
    sd = (1.0 / D) ** 0.5
    return {
        "x": _w((lambda *s: torch.randn(*s, dtype=torch.bfloat16) * 0.2)(B, T, D) * 0.5),
        "w1": _w((lambda *s: torch.randn(*s, dtype=torch.bfloat16) * 3.2)(K, D, D) * sc),
        "w2": _w((lambda *s: torch.randn(*s, dtype=torch.bfloat16) * 3.2)(K, D, D) * sc),
        "g": _w((lambda *s: torch.randn(*s, dtype=torch.bfloat16) * 3.2)(B, U, D) * 0.5),
        "w_f": _w((lambda *s: torch.randn(*s, dtype=torch.bfloat16) * 3.2)(D, D) * sd),
        "w_g": _w((lambda *s: torch.randn(*s, dtype=torch.bfloat16) * 3.2)(D, D) * sd),
        "w_o": _w((lambda *s: torch.randn(*s, dtype=torch.bfloat16) * 3.2)(D, D) * sd),
    }

def reference(x, w1, w2, g, w_f, w_g, w_o):
    B, T, D = x.shape
    K = w1.shape[0]
    pad = K // 2
    xp = _pad(x, ((0,0),(pad,pad),(0,0)))
    h = torch.zeros_like(x)
    for i in range(K):
        h = h + torch.einsum("btc,cd->btd", xp[:, i:i+T, :], w1[i])
    h = _gelu(h)[:, ::2, :]
    T1 = h.shape[1]
    hp = _pad(h, ((0,0),(pad,pad),(0,0)))
    f = torch.zeros_like(h)
    for i in range(K):
        f = f + torch.einsum("btc,cd->btd", hp[:, i:i+T1, :], w2[i])
    f = _gelu(f)[:, ::2, :]
    fe = torch.einsum("btd,de->bte", f, w_f)
    ge = torch.einsum("bud,de->bue", g, w_g)
    j = torch.tanh(fe[:, :, None, :] + ge[:, None, :, :])
    return torch.einsum("btud,dv->btuv", j, w_o)
```

```asm
; @launch kernel=prep_kernel grid=(268,1,1) block=(256,1,1) lds=32768
; @launch kernel=conv1_kernel grid=(256,1,1) block=(512,1,1) lds=163840
; @launch kernel=conv2_kernel grid=(256,1,1) block=(512,1,1) lds=163840
; @launch kernel=joint_kernel grid=(250,1,1) block=(512,1,1) lds=58368
.amdgcn_target "amdgcn-amd-amdhsa--gfx950"
.text
.globl prep_kernel
.p2align 8
.type prep_kernel,@function
prep_kernel:
    s_cmp_ge_u32 s2, 268
    s_cbranch_scc1 L_prep_kernel_done
    s_cmp_lt_u32 s2, 12
    s_cbranch_scc1 L_prep_kernel_small
    s_sub_u32 s2, s2, 12
    s_load_dwordx4 s[4:7], s[0:1], 8
    s_load_dwordx2 s[30:31], s[0:1], 72
    v_readfirstlane_b32 s20, v0
    s_lshr_b32 s20, s20, 6
    s_lshr_b32 s21, s2, 7
    s_bfe_u32 s22, s2, 0x20005
    s_bfe_u32 s23, s2, 0x40001
    s_and_b32 s24, s2, 1
    s_lshl_b32 s24, s24, 2
    s_add_u32 s24, s24, s20
    s_waitcnt lgkmcnt(0)
    s_cmp_eq_u32 s21, 0
    s_cselect_b32 s8, s4, s6
    s_cselect_b32 s9, s5, s7
    s_mov_b32 s10, 4063232
    s_mov_b32 s11, 0x00020000
    s_mul_i32 s25, s21, 9437184
    s_add_u32 s12, s30, s25
    s_addc_u32 s13, s31, 0
    s_mov_b32 s14, 9437184
    s_mov_b32 s15, 0x00020000
    v_and_b32 v1, 63, v0
    v_lshrrev_b32 v2, 4, v1
    v_lshlrev_b32 v2, 10, v2
    v_and_b32 v3, 15, v1
    v_lshl_add_u32 v2, v3, 2, v2
    s_lshl_b32 s26, s22, 3
    s_lshr_b32 s27, s23, 3
    s_add_u32 s26, s26, s27
    s_lshl_b32 s26, s26, 17
    s_and_b32 s27, s23, 7
    s_lshl_b32 s27, s27, 14
    s_add_u32 s26, s26, s27
    s_lshl_b32 s27, s24, 6
    s_add_u32 s26, s26, s27
    v_add_u32 v5, 0, v2
    v_add_u32 v6, 4096, v2
    v_add_u32 v7, 8192, v2
    v_add_u32 v8, 12288, v2
    buffer_load_dword v16, v5, s[8:11], s26 offen offset:0
    buffer_load_dword v17, v5, s[8:11], s26 offen offset:512
    buffer_load_dword v18, v6, s[8:11], s26 offen offset:0
    buffer_load_dword v19, v6, s[8:11], s26 offen offset:512
    buffer_load_dword v20, v7, s[8:11], s26 offen offset:0
    buffer_load_dword v21, v7, s[8:11], s26 offen offset:512
    buffer_load_dword v22, v8, s[8:11], s26 offen offset:0
    buffer_load_dword v23, v8, s[8:11], s26 offen offset:512
    s_add_u32 s26, s26, 262144
    buffer_load_dword v24, v5, s[8:11], s26 offen offset:0
    buffer_load_dword v25, v5, s[8:11], s26 offen offset:512
    buffer_load_dword v26, v6, s[8:11], s26 offen offset:0
    buffer_load_dword v27, v6, s[8:11], s26 offen offset:512
    buffer_load_dword v28, v7, s[8:11], s26 offen offset:0
    buffer_load_dword v29, v7, s[8:11], s26 offen offset:512
    buffer_load_dword v30, v8, s[8:11], s26 offen offset:0
    buffer_load_dword v31, v8, s[8:11], s26 offen offset:512
    s_add_u32 s26, s26, 262144
    buffer_load_dword v32, v5, s[8:11], s26 offen offset:0
    buffer_load_dword v33, v5, s[8:11], s26 offen offset:512
    buffer_load_dword v34, v6, s[8:11], s26 offen offset:0
    buffer_load_dword v35, v6, s[8:11], s26 offen offset:512
    buffer_load_dword v36, v7, s[8:11], s26 offen offset:0
    buffer_load_dword v37, v7, s[8:11], s26 offen offset:512
    buffer_load_dword v38, v8, s[8:11], s26 offen offset:0
    buffer_load_dword v39, v8, s[8:11], s26 offen offset:512
    s_add_u32 s26, s26, 262144
    buffer_load_dword v40, v5, s[8:11], s26 offen offset:0
    buffer_load_dword v41, v5, s[8:11], s26 offen offset:512
    buffer_load_dword v42, v6, s[8:11], s26 offen offset:0
    buffer_load_dword v43, v6, s[8:11], s26 offen offset:512
    buffer_load_dword v44, v7, s[8:11], s26 offen offset:0
    buffer_load_dword v45, v7, s[8:11], s26 offen offset:512
    buffer_load_dword v46, v8, s[8:11], s26 offen offset:0
    buffer_load_dword v47, v8, s[8:11], s26 offen offset:512
    v_lshlrev_b32 v4, 4, v1
    s_lshl_b32 s27, s24, 4
    s_add_u32 s27, s27, s23
    s_mul_i32 s27, s27, 73728
    s_lshl_b32 s28, s22, 11
    s_add_u32 s27, s27, s28
    s_mov_b32 s32, 0x05040100
    s_mov_b32 s33, 0x07060302
    s_mov_b32 s34, 0xffff0000
    s_waitcnt vmcnt(24)
    v_perm_b32 v72, v17, v16, s32
    v_perm_b32 v73, v19, v18, s32
    v_perm_b32 v74, v21, v20, s32
    v_perm_b32 v75, v23, v22, s32
    v_perm_b32 v76, v17, v16, s33
    v_perm_b32 v77, v19, v18, s33
    v_perm_b32 v78, v21, v20, s33
    v_perm_b32 v79, v23, v22, s33
    s_add_u32 s28, s27, 24576
    buffer_store_dwordx4 v[72:75], v4, s[12:15], s28 offen offset:0
    buffer_store_dwordx4 v[76:79], v4, s[12:15], s28 offen offset:1024
    s_waitcnt vmcnt(18)
    v_perm_b32 v64, v25, v24, s32
    v_perm_b32 v65, v27, v26, s32
    v_perm_b32 v66, v29, v28, s32
    v_perm_b32 v67, v31, v30, s32
    v_perm_b32 v68, v25, v24, s33
    v_perm_b32 v69, v27, v26, s33
    v_perm_b32 v70, v29, v28, s33
    v_perm_b32 v71, v31, v30, s33
    s_add_u32 s28, s27, 16384
    buffer_store_dwordx4 v[64:67], v4, s[12:15], s28 offen offset:0
    buffer_store_dwordx4 v[68:71], v4, s[12:15], s28 offen offset:1024
    s_waitcnt vmcnt(12)
    v_perm_b32 v56, v33, v32, s32
    v_perm_b32 v57, v35, v34, s32
    v_perm_b32 v58, v37, v36, s32
    v_perm_b32 v59, v39, v38, s32
    v_perm_b32 v60, v33, v32, s33
    v_perm_b32 v61, v35, v34, s33
    v_perm_b32 v62, v37, v36, s33
    v_perm_b32 v63, v39, v38, s33
    s_add_u32 s28, s27, 8192
    buffer_store_dwordx4 v[56:59], v4, s[12:15], s28 offen offset:0
    buffer_store_dwordx4 v[60:63], v4, s[12:15], s28 offen offset:1024
    s_waitcnt vmcnt(6)
    v_perm_b32 v48, v41, v40, s32
    v_perm_b32 v49, v43, v42, s32
    v_perm_b32 v50, v45, v44, s32
    v_perm_b32 v51, v47, v46, s32
    v_perm_b32 v52, v41, v40, s33
    v_perm_b32 v53, v43, v42, s33
    v_perm_b32 v54, v45, v44, s33
    v_perm_b32 v55, v47, v46, s33
    s_add_u32 s28, s27, 0
    buffer_store_dwordx4 v[48:51], v4, s[12:15], s28 offen offset:0
    buffer_store_dwordx4 v[52:55], v4, s[12:15], s28 offen offset:1024
    v_lshlrev_b32 v120, 16, v16
    v_lshlrev_b32 v121, 16, v24
    v_lshlrev_b32 v122, 16, v32
    v_lshlrev_b32 v123, 16, v40
    v_add_f32 v124, v123, v122
    v_add_f32 v125, v121, v120
    v_add_f32 v126, v123, v121
    v_add_f32 v127, v122, v120
    v_add_f32 v128, v124, v125
    v_lshlrev_b32 v120, 16, v17
    v_lshlrev_b32 v121, 16, v25
    v_lshlrev_b32 v122, 16, v33
    v_lshlrev_b32 v123, 16, v41
    v_add_f32 v129, v123, v122
    v_add_f32 v130, v121, v120
    v_add_f32 v131, v123, v121
    v_add_f32 v132, v122, v120
    v_add_f32 v133, v129, v130
    v_cvt_pk_bf16_f32 v80, v124, v129
    v_cvt_pk_bf16_f32 v88, v125, v130
    v_cvt_pk_bf16_f32 v96, v126, v131
    v_cvt_pk_bf16_f32 v104, v127, v132
    v_cvt_pk_bf16_f32 v112, v128, v133
    v_lshlrev_b32 v120, 16, v18
    v_lshlrev_b32 v121, 16, v26
    v_lshlrev_b32 v122, 16, v34
    v_lshlrev_b32 v123, 16, v42
    v_add_f32 v124, v123, v122
    v_add_f32 v125, v121, v120
    v_add_f32 v126, v123, v121
    v_add_f32 v127, v122, v120
    v_add_f32 v128, v124, v125
    v_lshlrev_b32 v120, 16, v19
    v_lshlrev_b32 v121, 16, v27
    v_lshlrev_b32 v122, 16, v35
    v_lshlrev_b32 v123, 16, v43
    v_add_f32 v129, v123, v122
    v_add_f32 v130, v121, v120
    v_add_f32 v131, v123, v121
    v_add_f32 v132, v122, v120
    v_add_f32 v133, v129, v130
    v_cvt_pk_bf16_f32 v81, v124, v129
    v_cvt_pk_bf16_f32 v89, v125, v130
    v_cvt_pk_bf16_f32 v97, v126, v131
    v_cvt_pk_bf16_f32 v105, v127, v132
    v_cvt_pk_bf16_f32 v113, v128, v133
    v_lshlrev_b32 v120, 16, v20
    v_lshlrev_b32 v121, 16, v28
    v_lshlrev_b32 v122, 16, v36
    v_lshlrev_b32 v123, 16, v44
    v_add_f32 v124, v123, v122
    v_add_f32 v125, v121, v120
    v_add_f32 v126, v123, v121
    v_add_f32 v127, v122, v120
    v_add_f32 v128, v124, v125
    v_lshlrev_b32 v120, 16, v21
    v_lshlrev_b32 v121, 16, v29
    v_lshlrev_b32 v122, 16, v37
    v_lshlrev_b32 v123, 16, v45
    v_add_f32 v129, v123, v122
    v_add_f32 v130, v121, v120
    v_add_f32 v131, v123, v121
    v_add_f32 v132, v122, v120
    v_add_f32 v133, v129, v130
    v_cvt_pk_bf16_f32 v82, v124, v129
    v_cvt_pk_bf16_f32 v90, v125, v130
    v_cvt_pk_bf16_f32 v98, v126, v131
    v_cvt_pk_bf16_f32 v106, v127, v132
    v_cvt_pk_bf16_f32 v114, v128, v133
    v_lshlrev_b32 v120, 16, v22
    v_lshlrev_b32 v121, 16, v30
    v_lshlrev_b32 v122, 16, v38
    v_lshlrev_b32 v123, 16, v46
    v_add_f32 v124, v123, v122
    v_add_f32 v125, v121, v120
    v_add_f32 v126, v123, v121
    v_add_f32 v127, v122, v120
    v_add_f32 v128, v124, v125
    v_lshlrev_b32 v120, 16, v23
    v_lshlrev_b32 v121, 16, v31
    v_lshlrev_b32 v122, 16, v39
    v_lshlrev_b32 v123, 16, v47
    v_add_f32 v129, v123, v122
    v_add_f32 v130, v121, v120
    v_add_f32 v131, v123, v121
    v_add_f32 v132, v122, v120
    v_add_f32 v133, v129, v130
    v_cvt_pk_bf16_f32 v83, v124, v129
    v_cvt_pk_bf16_f32 v91, v125, v130
    v_cvt_pk_bf16_f32 v99, v126, v131
    v_cvt_pk_bf16_f32 v107, v127, v132
    v_cvt_pk_bf16_f32 v115, v128, v133
    v_and_b32 v120, s34, v16
    v_and_b32 v121, s34, v24
    v_and_b32 v122, s34, v32
    v_and_b32 v123, s34, v40
    v_add_f32 v124, v123, v122
    v_add_f32 v125, v121, v120
    v_add_f32 v126, v123, v121
    v_add_f32 v127, v122, v120
    v_add_f32 v128, v124, v125
    v_and_b32 v120, s34, v17
    v_and_b32 v121, s34, v25
    v_and_b32 v122, s34, v33
    v_and_b32 v123, s34, v41
    v_add_f32 v129, v123, v122
    v_add_f32 v130, v121, v120
    v_add_f32 v131, v123, v121
    v_add_f32 v132, v122, v120
    v_add_f32 v133, v129, v130
    v_cvt_pk_bf16_f32 v84, v124, v129
    v_cvt_pk_bf16_f32 v92, v125, v130
    v_cvt_pk_bf16_f32 v100, v126, v131
    v_cvt_pk_bf16_f32 v108, v127, v132
    v_cvt_pk_bf16_f32 v116, v128, v133
    v_and_b32 v120, s34, v18
    v_and_b32 v121, s34, v26
    v_and_b32 v122, s34, v34
    v_and_b32 v123, s34, v42
    v_add_f32 v124, v123, v122
    v_add_f32 v125, v121, v120
    v_add_f32 v126, v123, v121
    v_add_f32 v127, v122, v120
    v_add_f32 v128, v124, v125
    v_and_b32 v120, s34, v19
    v_and_b32 v121, s34, v27
    v_and_b32 v122, s34, v35
    v_and_b32 v123, s34, v43
    v_add_f32 v129, v123, v122
    v_add_f32 v130, v121, v120
    v_add_f32 v131, v123, v121
    v_add_f32 v132, v122, v120
    v_add_f32 v133, v129, v130
    v_cvt_pk_bf16_f32 v85, v124, v129
    v_cvt_pk_bf16_f32 v93, v125, v130
    v_cvt_pk_bf16_f32 v101, v126, v131
    v_cvt_pk_bf16_f32 v109, v127, v132
    v_cvt_pk_bf16_f32 v117, v128, v133
    v_and_b32 v120, s34, v20
    v_and_b32 v121, s34, v28
    v_and_b32 v122, s34, v36
    v_and_b32 v123, s34, v44
    v_add_f32 v124, v123, v122
    v_add_f32 v125, v121, v120
    v_add_f32 v126, v123, v121
    v_add_f32 v127, v122, v120
    v_add_f32 v128, v124, v125
    v_and_b32 v120, s34, v21
    v_and_b32 v121, s34, v29
    v_and_b32 v122, s34, v37
    v_and_b32 v123, s34, v45
    v_add_f32 v129, v123, v122
    v_add_f32 v130, v121, v120
    v_add_f32 v131, v123, v121
    v_add_f32 v132, v122, v120
    v_add_f32 v133, v129, v130
    v_cvt_pk_bf16_f32 v86, v124, v129
    v_cvt_pk_bf16_f32 v94, v125, v130
    v_cvt_pk_bf16_f32 v102, v126, v131
    v_cvt_pk_bf16_f32 v110, v127, v132
    v_cvt_pk_bf16_f32 v118, v128, v133
    v_and_b32 v120, s34, v22
    v_and_b32 v121, s34, v30
    v_and_b32 v122, s34, v38
    v_and_b32 v123, s34, v46
    v_add_f32 v124, v123, v122
    v_add_f32 v125, v121, v120
    v_add_f32 v126, v123, v121
    v_add_f32 v127, v122, v120
    v_add_f32 v128, v124, v125
    v_and_b32 v120, s34, v23
    v_and_b32 v121, s34, v31
    v_and_b32 v122, s34, v39
    v_and_b32 v123, s34, v47
    v_add_f32 v129, v123, v122
    v_add_f32 v130, v121, v120
    v_add_f32 v131, v123, v121
    v_add_f32 v132, v122, v120
    v_add_f32 v133, v129, v130
    v_cvt_pk_bf16_f32 v87, v124, v129
    v_cvt_pk_bf16_f32 v95, v125, v130
    v_cvt_pk_bf16_f32 v103, v126, v131
    v_cvt_pk_bf16_f32 v111, v127, v132
    v_cvt_pk_bf16_f32 v119, v128, v133
    s_add_u32 s28, s27, 32768
    buffer_store_dwordx4 v[80:83], v4, s[12:15], s28 offen offset:0
    buffer_store_dwordx4 v[84:87], v4, s[12:15], s28 offen offset:1024
    s_add_u32 s28, s27, 40960
    buffer_store_dwordx4 v[88:91], v4, s[12:15], s28 offen offset:0
    buffer_store_dwordx4 v[92:95], v4, s[12:15], s28 offen offset:1024
    s_add_u32 s28, s27, 49152
    buffer_store_dwordx4 v[96:99], v4, s[12:15], s28 offen offset:0
    buffer_store_dwordx4 v[100:103], v4, s[12:15], s28 offen offset:1024
    s_add_u32 s28, s27, 57344
    buffer_store_dwordx4 v[104:107], v4, s[12:15], s28 offen offset:0
    buffer_store_dwordx4 v[108:111], v4, s[12:15], s28 offen offset:1024
    s_add_u32 s28, s27, 65536
    buffer_store_dwordx4 v[112:115], v4, s[12:15], s28 offen offset:0
    buffer_store_dwordx4 v[116:119], v4, s[12:15], s28 offen offset:1024
L_prep_kernel_done:
    s_endpgm
L_prep_kernel_small:
    s_load_dwordx4 s[4:7], s[0:1], 24
    s_load_dwordx4 s[36:39], s[0:1], 40
    s_load_dwordx2 s[30:31], s[0:1], 72
    v_readfirstlane_b32 s20, v0
    s_lshr_b32 s20, s20, 6
    s_lshr_b32 s21, s2, 2
    s_and_b32 s22, s2, 3
    v_and_b32 v1, 63, v0
    v_lshrrev_b32 v2, 5, v1
    v_and_b32 v3, 31, v1
    v_lshlrev_b32 v5, 12, v2
    v_lshl_add_u32 v5, v3, 2, v5
    s_lshl_b32 s23, s20, 15
    s_lshl_b32 s24, s22, 7
    s_add_u32 s23, s23, s24
    s_mov_b32 s32, 0x05040100
    s_mov_b32 s33, 0x07060302
    s_waitcnt lgkmcnt(0)
    s_cmp_eq_u32 s21, 1
    s_cselect_b32 s8, s38, s6
    s_cselect_b32 s9, s39, s7
    s_cmp_eq_u32 s21, 2
    s_cselect_b32 s8, s36, s8
    s_cselect_b32 s9, s37, s9
    s_mov_b32 s10, 131072
    s_mov_b32 s11, 0x00020000
    buffer_load_dword v16, v5, s[8:11], s23 offen offset:0
    buffer_load_dword v17, v5, s[8:11], s23 offen offset:512
    buffer_load_dword v18, v5, s[8:11], s23 offen offset:1024
    buffer_load_dword v19, v5, s[8:11], s23 offen offset:1536
    buffer_load_dword v20, v5, s[8:11], s23 offen offset:2048
    buffer_load_dword v21, v5, s[8:11], s23 offen offset:2560
    buffer_load_dword v22, v5, s[8:11], s23 offen offset:3072
    buffer_load_dword v23, v5, s[8:11], s23 offen offset:3584
    s_add_u32 s23, s23, 8192
    buffer_load_dword v24, v5, s[8:11], s23 offen offset:0
    buffer_load_dword v25, v5, s[8:11], s23 offen offset:512
    buffer_load_dword v26, v5, s[8:11], s23 offen offset:1024
    buffer_load_dword v27, v5, s[8:11], s23 offen offset:1536
    buffer_load_dword v28, v5, s[8:11], s23 offen offset:2048
    buffer_load_dword v29, v5, s[8:11], s23 offen offset:2560
    buffer_load_dword v30, v5, s[8:11], s23 offen offset:3072
    buffer_load_dword v31, v5, s[8:11], s23 offen offset:3584
    s_add_u32 s23, s23, 8192
    buffer_load_dword v32, v5, s[8:11], s23 offen offset:0
    buffer_load_dword v33, v5, s[8:11], s23 offen offset:512
    buffer_load_dword v34, v5, s[8:11], s23 offen offset:1024
    buffer_load_dword v35, v5, s[8:11], s23 offen offset:1536
    buffer_load_dword v36, v5, s[8:11], s23 offen offset:2048
    buffer_load_dword v37, v5, s[8:11], s23 offen offset:2560
    buffer_load_dword v38, v5, s[8:11], s23 offen offset:3072
    buffer_load_dword v39, v5, s[8:11], s23 offen offset:3584
    s_add_u32 s23, s23, 8192
    buffer_load_dword v40, v5, s[8:11], s23 offen offset:0
    buffer_load_dword v41, v5, s[8:11], s23 offen offset:512
    buffer_load_dword v42, v5, s[8:11], s23 offen offset:1024
    buffer_load_dword v43, v5, s[8:11], s23 offen offset:1536
    buffer_load_dword v44, v5, s[8:11], s23 offen offset:2048
    buffer_load_dword v45, v5, s[8:11], s23 offen offset:2560
    buffer_load_dword v46, v5, s[8:11], s23 offen offset:3072
    buffer_load_dword v47, v5, s[8:11], s23 offen offset:3584
    s_mov_b32 s16, s4
    s_mov_b32 s17, s5
    s_mov_b32 s18, 8192
    s_mov_b32 s19, 0x00020000
    v_lshlrev_b32 v6, 9, v3
    v_lshl_add_u32 v6, v2, 4, v6
    s_lshl_b32 s24, s20, 7
    buffer_load_dwordx4 v[80:83], v6, s[16:19], s24 offen offset:0
    buffer_load_dwordx4 v[84:87], v6, s[16:19], s24 offen offset:32
    buffer_load_dwordx4 v[88:91], v6, s[16:19], s24 offen offset:64
    buffer_load_dwordx4 v[92:95], v6, s[16:19], s24 offen offset:96
    s_lshl_b32 s24, s21, 17
    s_add_u32 s24, s24, 44040192
    s_add_u32 s12, s30, s24
    s_addc_u32 s13, s31, 0
    s_mov_b32 s14, 131072
    s_mov_b32 s15, 0x00020000
    s_waitcnt vmcnt(0)
    v_perm_b32 v48, v17, v16, s32
    v_perm_b32 v49, v19, v18, s32
    v_perm_b32 v50, v21, v20, s32
    v_perm_b32 v51, v23, v22, s32
    v_perm_b32 v52, v17, v16, s33
    v_perm_b32 v53, v19, v18, s33
    v_perm_b32 v54, v21, v20, s33
    v_perm_b32 v55, v23, v22, s33
    v_perm_b32 v56, v25, v24, s32
    v_perm_b32 v57, v27, v26, s32
    v_perm_b32 v58, v29, v28, s32
    v_perm_b32 v59, v31, v30, s32
    v_perm_b32 v60, v25, v24, s33
    v_perm_b32 v61, v27, v26, s33
    v_perm_b32 v62, v29, v28, s33
    v_perm_b32 v63, v31, v30, s33
    v_perm_b32 v64, v33, v32, s32
    v_perm_b32 v65, v35, v34, s32
    v_perm_b32 v66, v37, v36, s32
    v_perm_b32 v67, v39, v38, s32
    v_perm_b32 v68, v33, v32, s33
    v_perm_b32 v69, v35, v34, s33
    v_perm_b32 v70, v37, v36, s33
    v_perm_b32 v71, v39, v38, s33
    v_perm_b32 v72, v41, v40, s32
    v_perm_b32 v73, v43, v42, s32
    v_perm_b32 v74, v45, v44, s32
    v_perm_b32 v75, v47, v46, s32
    v_perm_b32 v76, v41, v40, s33
    v_perm_b32 v77, v43, v42, s33
    v_perm_b32 v78, v45, v44, s33
    v_perm_b32 v79, v47, v46, s33
    s_cmp_eq_u32 s21, 2
    s_cbranch_scc1 L_prep_kernel_ge
    v_lshlrev_b32 v4, 4, v1
    s_lshl_b32 s24, s22, 15
    s_lshl_b32 s25, s20, 13
    s_add_u32 s24, s24, s25
    s_add_u32 s25, s24, 4096
    buffer_store_dwordx4 v[48:51], v4, s[12:15], s24 offen offset:0
    buffer_store_dwordx4 v[52:55], v4, s[12:15], s24 offen offset:1024
    buffer_store_dwordx4 v[56:59], v4, s[12:15], s24 offen offset:2048
    buffer_store_dwordx4 v[60:63], v4, s[12:15], s24 offen offset:3072
    buffer_store_dwordx4 v[64:67], v4, s[12:15], s25 offen offset:0
    buffer_store_dwordx4 v[68:71], v4, s[12:15], s25 offen offset:1024
    buffer_store_dwordx4 v[72:75], v4, s[12:15], s25 offen offset:2048
    buffer_store_dwordx4 v[76:79], v4, s[12:15], s25 offen offset:3072
    s_endpgm
L_prep_kernel_ge:
    v_mfma_f32_32x32x16_bf16 v[96:111], v[48:51], v[80:83], 0
    v_mfma_f32_32x32x16_bf16 v[112:127], v[52:55], v[80:83], 0
    v_mfma_f32_32x32x16_bf16 v[96:111], v[56:59], v[84:87], v[96:111]
    v_mfma_f32_32x32x16_bf16 v[112:127], v[60:63], v[84:87], v[112:127]
    v_mfma_f32_32x32x16_bf16 v[96:111], v[64:67], v[88:91], v[96:111]
    v_mfma_f32_32x32x16_bf16 v[112:127], v[68:71], v[88:91], v[112:127]
    v_mfma_f32_32x32x16_bf16 v[96:111], v[72:75], v[92:95], v[96:111]
    v_mfma_f32_32x32x16_bf16 v[112:127], v[76:79], v[92:95], v[112:127]
    v_lshlrev_b32 v4, 4, v1
    s_lshl_b32 s24, s20, 13
    v_add_u32 v7, s24, v4
    s_nop 15
    ds_write_b128 v7, v[96:99] offset:0
    ds_write_b128 v7, v[100:103] offset:1024
    ds_write_b128 v7, v[104:107] offset:2048
    ds_write_b128 v7, v[108:111] offset:3072
    ds_write_b128 v7, v[112:115] offset:4096
    ds_write_b128 v7, v[116:119] offset:5120
    ds_write_b128 v7, v[120:123] offset:6144
    ds_write_b128 v7, v[124:127] offset:7168
    s_waitcnt lgkmcnt(0)
    s_barrier
    s_lshl_b32 s24, s20, 10
    v_add_u32 v7, s24, v4
    ds_read_b128 v[16:19], v7 offset:0
    ds_read_b128 v[20:23], v7 offset:4096
    ds_read_b128 v[24:27], v7 offset:8192
    ds_read_b128 v[28:31], v7 offset:12288
    ds_read_b128 v[32:35], v7 offset:16384
    ds_read_b128 v[36:39], v7 offset:20480
    ds_read_b128 v[40:43], v7 offset:24576
    ds_read_b128 v[44:47], v7 offset:28672
    s_mov_b32 s14, 16384
    v_lshlrev_b32 v8, 10, v3
    v_lshl_add_u32 v8, v2, 5, v8
    s_lshl_b32 s24, s22, 8
    s_lshl_b32 s25, s20, 6
    s_add_u32 s24, s24, s25
    s_mov_b32 s34, 0xffff0000
    s_mov_b32 s35, 0x4038aa3b
    s_waitcnt lgkmcnt(0)
    v_add_f32 v16, v16, v24
    v_add_f32 v16, v16, v32
    v_add_f32 v16, v16, v40
    v_add_f32 v17, v17, v25
    v_add_f32 v17, v17, v33
    v_add_f32 v17, v17, v41
    v_add_f32 v18, v18, v26
    v_add_f32 v18, v18, v34
    v_add_f32 v18, v18, v42
    v_add_f32 v19, v19, v27
    v_add_f32 v19, v19, v35
    v_add_f32 v19, v19, v43
    v_add_f32 v20, v20, v28
    v_add_f32 v20, v20, v36
    v_add_f32 v20, v20, v44
    v_add_f32 v21, v21, v29
    v_add_f32 v21, v21, v37
    v_add_f32 v21, v21, v45
    v_add_f32 v22, v22, v30
    v_add_f32 v22, v22, v38
    v_add_f32 v22, v22, v46
    v_add_f32 v23, v23, v31
    v_add_f32 v23, v23, v39
    v_add_f32 v23, v23, v47
    v_cvt_pk_bf16_f32 v48, v16, v20
    v_cvt_pk_bf16_f32 v49, v17, v21
    v_cvt_pk_bf16_f32 v50, v18, v22
    v_cvt_pk_bf16_f32 v51, v19, v23
    v_lshlrev_b32 v56, 16, v48
    v_and_b32 v57, s34, v48
    v_lshlrev_b32 v58, 16, v49
    v_and_b32 v59, s34, v49
    v_lshlrev_b32 v60, 16, v50
    v_and_b32 v61, s34, v50
    v_lshlrev_b32 v62, 16, v51
    v_and_b32 v63, s34, v51
    v_mul_f32 v56, s35, v56
    v_mul_f32 v57, s35, v57
    v_mul_f32 v58, s35, v58
    v_mul_f32 v59, s35, v59
    v_mul_f32 v60, s35, v60
    v_mul_f32 v61, s35, v61
    v_mul_f32 v62, s35, v62
    v_mul_f32 v63, s35, v63
    buffer_store_dwordx4 v[56:59], v8, s[12:15], s24 offen
    buffer_store_dwordx4 v[60:63], v8, s[12:15], s24 offen offset:16
    s_endpgm
.globl conv1_kernel
.p2align 8
.type conv1_kernel,@function
conv1_kernel:
    s_cmp_ge_u32 s2, 256
    s_cbranch_scc1 L_conv1_kernel_done
    s_load_dwordx2 s[4:5], s[0:1], 0
    s_load_dwordx2 s[30:31], s[0:1], 72
    v_readfirstlane_b32 s20, v0
    s_lshr_b32 s20, s20, 6
    s_and_b32 s36, s2, 1
    s_lshl_b32 s36, s36, 2
    s_bfe_u32 s37, s2, 131075
    s_or_b32 s29, s36, s37
    s_bfe_u32 s36, s2, 131073
    s_lshl_b32 s36, s36, 3
    s_lshr_b32 s37, s2, 5
    s_or_b32 s36, s36, s37
    s_mov_b32 s33, 0
    s_and_b32 s34, s36, 15
    s_lshr_b32 s35, s36, 4
    s_mul_i32 s21, s34, 500
    s_and_b32 s32, s20, 3
    v_and_b32 v255, 63, v0
    v_and_b32 v3, 15, v255
    v_lshrrev_b32 v4, 4, v255
    v_lshlrev_b32 v1, 11, v4
    v_lshl_add_u32 v1, v3, 4, v1
    v_lshrrev_b32 v5, 2, v255
    v_and_b32 v6, 3, v255
    v_lshlrev_b32 v7, 15, v5
    v_lshl_add_u32 v7, v6, 4, v7
    s_mov_b32 s25, 0xffff0000
    s_lshl_b32 s26, s32, 9
    s_add_u32 s27, s26, 63996
    s_mov_b32 m0, s26
    s_add_u32 s36, s26, 131072
    v_lshl_add_u32 v249, v255, 2, s36
    s_waitcnt lgkmcnt(0)
    s_mul_i32 s36, s35, 8192000
    s_add_u32 s8, s4, s36
    s_addc_u32 s9, s5, 0
    s_mov_b32 s10, 8192000
    s_mov_b32 s11, 0x00020000
    s_lshl_b32 s36, s29, 4
    s_lshl_b32 s37, s33, 3
    s_add_u32 s36, s36, s37
    s_mul_i32 s36, s36, 73728
    s_add_u32 s36, s36, 0
    s_add_u32 s12, s30, s36
    s_addc_u32 s13, s31, 0
    s_mov_b32 s14, 1179648
    s_mov_b32 s15, 0x00020000
    s_mul_i32 s36, s35, 4096000
    s_add_u32 s36, s36, 18874368
    s_add_u32 s16, s30, s36
    s_addc_u32 s17, s31, 0
    s_mov_b32 s18, 4096000
    s_mov_b32 s19, 0x00020000
    s_lshl_b32 s36, s21, 10
    s_lshl_b32 s37, s33, 9
    s_add_u32 s36, s36, s37
    s_sub_u32 s36, s36, 7680
    s_lshl_b32 s37, s32, 13
    s_add_u32 s37, s37, s36
    v_add_u32 v7, s37, v7
    s_cmp_ge_u32 s20, 4
    s_cbranch_scc1 L_conv1_kernel_helper
    v_add_u32 v16, 4096, v7
    buffer_load_dwordx4 v[192:195], v16, s[8:11], 0 offen
    v_add_u32 v17, 5120, v7
    buffer_load_dwordx4 v[196:199], v17, s[8:11], 0 offen
    v_add_u32 v18, 6144, v7
    buffer_load_dwordx4 v[200:203], v18, s[8:11], 0 offen
    v_add_u32 v19, 7168, v7
    buffer_load_dwordx4 v[204:207], v19, s[8:11], 0 offen
    s_add_u32 s37, s36, 524288
    v_lshl_add_u32 v8, v255, 4, s37
    s_cmp_eq_u32 s20, 1
    s_cselect_b32 s38, 2048, 0
    s_lshl_b32 s39, s20, 10
    s_sub_u32 s39, s39, 1024
    s_cmp_lt_u32 s20, 2
    s_cselect_b32 s39, 2130706432, s39
    buffer_load_dwordx4 v[208:211], v8, s[8:11], s38 offen
    buffer_load_dwordx4 v[212:215], v8, s[8:11], s39 offen
    s_lshl_b32 s37, s20, 14
    v_lshl_add_u32 v240, v255, 4, s37
    v_add_u32 v241, 4096, v240
    v_add_u32 v242, 8192, v240
    v_add_u32 v243, 12288, v240
    s_mov_b32 s23, 0
    v_add_u32 v236, s37, v1
    v_add_u32 v237, 65536, v236
    s_lshl_b32 s37, s20, 15
    v_lshl_add_u32 v244, v255, 4, s37
    s_lshl_b32 s37, s20, 10
    s_add_u32 s37, s37, 147456
    v_lshl_add_u32 v22, v4, 8, s37
    v_lshlrev_b32 v23, 8, v4
    v_add_u32 v23, 151552, v23
    v_add_u32 v24, 16, v236
    v_add_u32 v28, 8208, v236
    v_cmp_eq_u32 vcc, 15, v3
    v_mov_b32 v25, 0x10000
    v_mov_b32 v26, 0xffff0000
    v_mov_b32 v27, 16
    v_cndmask_b32 v245, v24, v22, vcc
    v_cndmask_b32 v246, v28, v23, vcc
    v_cndmask_b32 v247, v25, v27, vcc
    v_cndmask_b32 v248, v26, v27, vcc
    v_lshl_add_u32 v238, v255, 2, s37
    v_lshlrev_b32 v239, 2, v255
    v_add_u32 v239, 151552, v239
    v_mov_b32 v0, 0
    v_mov_b32 v1, 0
    v_mov_b32 v2, 0
    v_mov_b32 v3, 0
    v_mov_b32 v4, 0
    v_mov_b32 v5, 0
    v_mov_b32 v6, 0
    v_mov_b32 v7, 0
    v_mov_b32 v8, 0
    v_mov_b32 v9, 0
    v_mov_b32 v10, 0
    v_mov_b32 v11, 0
    v_mov_b32 v12, 0
    v_mov_b32 v13, 0
    v_mov_b32 v14, 0
    v_mov_b32 v15, 0
    v_mov_b32 v16, 0
    v_mov_b32 v17, 0
    v_mov_b32 v18, 0
    v_mov_b32 v19, 0
    v_mov_b32 v20, 0
    v_mov_b32 v21, 0
    v_mov_b32 v22, 0
    v_mov_b32 v23, 0
    v_mov_b32 v24, 0
    v_mov_b32 v25, 0
    v_mov_b32 v26, 0
    v_mov_b32 v27, 0
    v_mov_b32 v28, 0
    v_mov_b32 v29, 0
    v_mov_b32 v30, 0
    v_mov_b32 v31, 0
    v_mov_b32 v32, 0
    v_mov_b32 v33, 0
    v_mov_b32 v34, 0
    v_mov_b32 v35, 0
    v_mov_b32 v36, 0
    v_mov_b32 v37, 0
    v_mov_b32 v38, 0
    v_mov_b32 v39, 0
    v_mov_b32 v40, 0
    v_mov_b32 v41, 0
    v_mov_b32 v42, 0
    v_mov_b32 v43, 0
    v_mov_b32 v44, 0
    v_mov_b32 v45, 0
    v_mov_b32 v46, 0
    v_mov_b32 v47, 0
    v_mov_b32 v48, 0
    v_mov_b32 v49, 0
    v_mov_b32 v50, 0
    v_mov_b32 v51, 0
    v_mov_b32 v52, 0
    v_mov_b32 v53, 0
    v_mov_b32 v54, 0
    v_mov_b32 v55, 0
    v_mov_b32 v56, 0
    v_mov_b32 v57, 0
    v_mov_b32 v58, 0
    v_mov_b32 v59, 0
    v_mov_b32 v60, 0
    v_mov_b32 v61, 0
    v_mov_b32 v62, 0
    v_mov_b32 v63, 0
    buffer_load_dwordx4 v[128:131], v240, s[12:15], s23 offen offset:0
    buffer_load_dwordx4 v[132:135], v240, s[12:15], s23 offen offset:1024
    buffer_load_dwordx4 v[136:139], v240, s[12:15], s23 offen offset:2048
    buffer_load_dwordx4 v[140:143], v240, s[12:15], s23 offen offset:3072
    buffer_load_dwordx4 v[144:147], v241, s[12:15], s23 offen offset:0
    buffer_load_dwordx4 v[148:151], v241, s[12:15], s23 offen offset:1024
    buffer_load_dwordx4 v[152:155], v241, s[12:15], s23 offen offset:2048
    buffer_load_dwordx4 v[156:159], v241, s[12:15], s23 offen offset:3072
    v_mov_b32 v64, 0
    v_mov_b32 v65, 0
    v_mov_b32 v66, 0
    v_mov_b32 v67, 0
    v_mov_b32 v68, 0
    v_mov_b32 v69, 0
    v_mov_b32 v70, 0
    v_mov_b32 v71, 0
    v_mov_b32 v72, 0
    v_mov_b32 v73, 0
    v_mov_b32 v74, 0
    v_mov_b32 v75, 0
    v_mov_b32 v76, 0
    v_mov_b32 v77, 0
    v_mov_b32 v78, 0
    v_mov_b32 v79, 0
    v_mov_b32 v80, 0
    v_mov_b32 v81, 0
    v_mov_b32 v82, 0
    v_mov_b32 v83, 0
    v_mov_b32 v84, 0
    v_mov_b32 v85, 0
    v_mov_b32 v86, 0
    v_mov_b32 v87, 0
    v_mov_b32 v88, 0
    v_mov_b32 v89, 0
    v_mov_b32 v90, 0
    v_mov_b32 v91, 0
    v_mov_b32 v92, 0
    v_mov_b32 v93, 0
    v_mov_b32 v94, 0
    v_mov_b32 v95, 0
    v_mov_b32 v96, 0
    v_mov_b32 v97, 0
    v_mov_b32 v98, 0
    v_mov_b32 v99, 0
    v_mov_b32 v100, 0
    v_mov_b32 v101, 0
    v_mov_b32 v102, 0
    v_mov_b32 v103, 0
    v_mov_b32 v104, 0
    v_mov_b32 v105, 0
    v_mov_b32 v106, 0
    v_mov_b32 v107, 0
    v_mov_b32 v108, 0
    v_mov_b32 v109, 0
    v_mov_b32 v110, 0
    v_mov_b32 v111, 0
    v_mov_b32 v112, 0
    v_mov_b32 v113, 0
    v_mov_b32 v114, 0
    v_mov_b32 v115, 0
    v_mov_b32 v116, 0
    v_mov_b32 v117, 0
    v_mov_b32 v118, 0
    v_mov_b32 v119, 0
    v_mov_b32 v120, 0
    v_mov_b32 v121, 0
    v_mov_b32 v122, 0
    v_mov_b32 v123, 0
    v_mov_b32 v124, 0
    v_mov_b32 v125, 0
    v_mov_b32 v126, 0
    v_mov_b32 v127, 0
    s_waitcnt vmcnt(10)
    v_lshlrev_b32 v160, 16, v192
    v_and_b32 v164, s25, v192
    ds_write_addtid_b32 v192 offset:256
    v_lshlrev_b32 v161, 16, v196
    v_and_b32 v165, s25, v196
    ds_write_addtid_b32 v196 offset:8448
    v_lshlrev_b32 v162, 16, v200
    v_and_b32 v166, s25, v200
    ds_write_addtid_b32 v200 offset:16640
    v_lshlrev_b32 v163, 16, v204
    v_and_b32 v167, s25, v204
    ds_write_addtid_b32 v204 offset:24832
    v_add_f32 v168, v160, v161
    v_add_f32 v172, v164, v165
    v_cvt_pk_bf16_f32 v176, v168, v172
    v_add_f32 v169, v162, v163
    v_add_f32 v173, v166, v167
    ds_write_addtid_b32 v176 offset:33024
    v_cvt_pk_bf16_f32 v177, v169, v173
    v_add_f32 v170, v160, v162
    v_add_f32 v174, v164, v166
    ds_write_addtid_b32 v177 offset:41216
    v_cvt_pk_bf16_f32 v178, v170, v174
    v_add_f32 v171, v161, v163
    v_add_f32 v175, v165, v167
    ds_write_addtid_b32 v178 offset:49408
    v_cvt_pk_bf16_f32 v179, v171, v175
    v_add_f32 v160, v168, v169
    v_add_f32 v164, v172, v173
    ds_write_addtid_b32 v179 offset:57600
    v_cvt_pk_bf16_f32 v180, v160, v164
    ds_write_b32 v249, v180 offset:256
    v_lshlrev_b32 v160, 16, v193
    v_and_b32 v164, s25, v193
    ds_write_addtid_b32 v193 offset:2304
    v_lshlrev_b32 v161, 16, v197
    v_and_b32 v165, s25, v197
    ds_write_addtid_b32 v197 offset:10496
    v_lshlrev_b32 v162, 16, v201
    v_and_b32 v166, s25, v201
    ds_write_addtid_b32 v201 offset:18688
    v_lshlrev_b32 v163, 16, v205
    v_and_b32 v167, s25, v205
    ds_write_addtid_b32 v205 offset:26880
    v_add_f32 v168, v160, v161
    v_add_f32 v172, v164, v165
    v_cvt_pk_bf16_f32 v181, v168, v172
    v_add_f32 v169, v162, v163
    v_add_f32 v173, v166, v167
    ds_write_addtid_b32 v181 offset:35072
    v_cvt_pk_bf16_f32 v182, v169, v173
    v_add_f32 v170, v160, v162
    v_add_f32 v174, v164, v166
    ds_write_addtid_b32 v182 offset:43264
    v_cvt_pk_bf16_f32 v183, v170, v174
    v_add_f32 v171, v161, v163
    v_add_f32 v175, v165, v167
    s_waitcnt lgkmcnt(8)
    ds_write_addtid_b32 v183 offset:51456
    v_cvt_pk_bf16_f32 v184, v171, v175
    v_add_f32 v160, v168, v169
    v_add_f32 v164, v172, v173
    ds_write_addtid_b32 v184 offset:59648
    v_cvt_pk_bf16_f32 v185, v160, v164
    ds_write_b32 v249, v185 offset:2304
    v_lshlrev_b32 v160, 16, v194
    v_and_b32 v164, s25, v194
    ds_write_addtid_b32 v194 offset:4352
    v_lshlrev_b32 v161, 16, v198
    v_and_b32 v165, s25, v198
    ds_write_addtid_b32 v198 offset:12544
    v_lshlrev_b32 v162, 16, v202
    v_and_b32 v166, s25, v202
    ds_write_addtid_b32 v202 offset:20736
    v_lshlrev_b32 v163, 16, v206
    v_and_b32 v167, s25, v206
    ds_write_addtid_b32 v206 offset:28928
    v_add_f32 v168, v160, v161
    v_add_f32 v172, v164, v165
    v_cvt_pk_bf16_f32 v176, v168, v172
    v_add_f32 v169, v162, v163
    v_add_f32 v173, v166, v167
    s_waitcnt lgkmcnt(8)
    ds_write_addtid_b32 v176 offset:37120
    v_cvt_pk_bf16_f32 v177, v169, v173
    v_add_f32 v170, v160, v162
    v_add_f32 v174, v164, v166
    ds_write_addtid_b32 v177 offset:45312
    v_cvt_pk_bf16_f32 v178, v170, v174
    v_add_f32 v171, v161, v163
    v_add_f32 v175, v165, v167
    ds_write_addtid_b32 v178 offset:53504
    v_cvt_pk_bf16_f32 v179, v171, v175
    v_add_f32 v160, v168, v169
    v_add_f32 v164, v172, v173
    ds_write_addtid_b32 v179 offset:61696
    v_cvt_pk_bf16_f32 v180, v160, v164
    ds_write_b32 v249, v180 offset:4352
    v_lshlrev_b32 v160, 16, v195
    v_and_b32 v164, s25, v195
    ds_write_addtid_b32 v195 offset:6400
    v_lshlrev_b32 v161, 16, v199
    v_and_b32 v165, s25, v199
    ds_write_addtid_b32 v199 offset:14592
    v_lshlrev_b32 v162, 16, v203
    v_and_b32 v166, s25, v203
    s_waitcnt lgkmcnt(8)
    ds_write_addtid_b32 v203 offset:22784
    v_lshlrev_b32 v163, 16, v207
    v_and_b32 v167, s25, v207
    ds_write_addtid_b32 v207 offset:30976
    v_add_f32 v168, v160, v161
    v_add_f32 v172, v164, v165
    v_cvt_pk_bf16_f32 v181, v168, v172
    v_add_f32 v169, v162, v163
    v_add_f32 v173, v166, v167
    ds_write_addtid_b32 v181 offset:39168
    v_cvt_pk_bf16_f32 v182, v169, v173
    v_add_f32 v170, v160, v162
    v_add_f32 v174, v164, v166
    ds_write_addtid_b32 v182 offset:47360
    v_cvt_pk_bf16_f32 v183, v170, v174
    v_add_f32 v171, v161, v163
    v_add_f32 v175, v165, v167
    ds_write_addtid_b32 v183 offset:55552
    v_cvt_pk_bf16_f32 v184, v171, v175
    v_add_f32 v160, v168, v169
    v_add_f32 v164, v172, v173
    ds_write_addtid_b32 v184 offset:63744
    v_cvt_pk_bf16_f32 v185, v160, v164
    ds_write_b32 v249, v185 offset:6400
    s_waitcnt vmcnt(8) lgkmcnt(0)
    v_lshlrev_b32 v216, 16, v208
    v_and_b32 v217, s25, v208
    v_lshlrev_b32 v218, 16, v212
    v_and_b32 v219, s25, v212
    v_add_f32 v216, v216, v218
    v_add_f32 v217, v217, v219
    v_cvt_pk_bf16_f32 v220, v216, v217
    ds_write_b32 v238, v220 offset:0
    v_lshlrev_b32 v216, 16, v209
    v_and_b32 v217, s25, v209
    v_lshlrev_b32 v218, 16, v213
    v_and_b32 v219, s25, v213
    v_add_f32 v216, v216, v218
    v_add_f32 v217, v217, v219
    v_cvt_pk_bf16_f32 v221, v216, v217
    ds_write_b32 v238, v221 offset:256
    v_lshlrev_b32 v216, 16, v210
    v_and_b32 v217, s25, v210
    v_lshlrev_b32 v218, 16, v214
    v_and_b32 v219, s25, v214
    v_add_f32 v216, v216, v218
    v_add_f32 v217, v217, v219
    v_cvt_pk_bf16_f32 v222, v216, v217
    ds_write_b32 v238, v222 offset:512
    v_lshlrev_b32 v216, 16, v211
    v_and_b32 v217, s25, v211
    v_lshlrev_b32 v218, 16, v215
    v_and_b32 v219, s25, v215
    v_add_f32 v216, v216, v218
    v_add_f32 v217, v217, v219
    v_cvt_pk_bf16_f32 v223, v216, v217
    ds_write_b32 v238, v223 offset:768
    s_cmp_lg_u32 s20, 2
    s_cbranch_scc1 L_conv1_kernel_nsp
    ds_write_b32 v239, v212 offset:0
    ds_write_b32 v239, v213 offset:256
    ds_write_b32 v239, v214 offset:512
    ds_write_b32 v239, v215 offset:768
L_conv1_kernel_nsp:
    s_waitcnt lgkmcnt(0)
    s_barrier
    ds_read_b128 v[192:195], v236 offset:0
    ds_read_b128 v[196:199], v236 offset:256
    ds_read_b128 v[200:203], v236 offset:512
    ds_read_b128 v[204:207], v236 offset:768
    ds_read_b128 v[208:211], v236 offset:1024
    ds_read_b128 v[212:215], v236 offset:1280
    ds_read_b128 v[216:219], v236 offset:1536
    ds_read_b128 v[220:223], v236 offset:1792
    ds_read_b128 v[224:227], v245 offset:0
    v_add_u32 v245, v247, v245
    ds_read_b128 v[228:231], v236 offset:272
    buffer_load_dwordx4 v[160:163], v242, s[12:15], s23 offen offset:0
    buffer_load_dwordx4 v[164:167], v242, s[12:15], s23 offen offset:1024
    buffer_load_dwordx4 v[168:171], v242, s[12:15], s23 offen offset:2048
    buffer_load_dwordx4 v[172:175], v242, s[12:15], s23 offen offset:3072
    buffer_load_dwordx4 v[176:179], v243, s[12:15], s23 offen offset:0
    buffer_load_dwordx4 v[180:183], v243, s[12:15], s23 offen offset:1024
    buffer_load_dwordx4 v[184:187], v243, s[12:15], s23 offen offset:2048
    buffer_load_dwordx4 v[188:191], v243, s[12:15], s23 offen offset:3072
    s_mov_b32 s23, 73728
    s_mov_b32 s22, 8
    s_setprio 0
L_conv1_kernel_mloop:
    s_waitcnt vmcnt(14) lgkmcnt(9)
    s_nop 0
    v_mfma_f32_16x16x32_bf16 v[0:3], v[128:131], v[192:195], v[0:3]
    ds_read_b128 v[232:235], v236 offset:528
    v_mfma_f32_16x16x32_bf16 v[32:35], v[132:135], v[192:195], v[32:35]
    s_waitcnt lgkmcnt(9)
    s_nop 0
    v_mfma_f32_16x16x32_bf16 v[4:7], v[128:131], v[196:199], v[4:7]
    v_mfma_f32_16x16x32_bf16 v[36:39], v[132:135], v[196:199], v[36:39]
    s_waitcnt lgkmcnt(8)
    s_nop 0
    v_mfma_f32_16x16x32_bf16 v[8:11], v[128:131], v[200:203], v[8:11]
    v_mfma_f32_16x16x32_bf16 v[40:43], v[132:135], v[200:203], v[40:43]
    s_waitcnt lgkmcnt(7)
    s_nop 0
    v_mfma_f32_16x16x32_bf16 v[12:15], v[128:131], v[204:207], v[12:15]
    v_mfma_f32_16x16x32_bf16 v[44:47], v[132:135], v[204:207], v[44:47]
    s_waitcnt lgkmcnt(6)
    s_nop 0
    v_mfma_f32_16x16x32_bf16 v[16:19], v[128:131], v[208:211], v[16:19]
    v_mfma_f32_16x16x32_bf16 v[48:51], v[132:135], v[208:211], v[48:51]
    s_waitcnt lgkmcnt(5)
    s_nop 0
    v_mfma_f32_16x16x32_bf16 v[20:23], v[128:131], v[212:215], v[20:23]
    v_mfma_f32_16x16x32_bf16 v[52:55], v[132:135], v[212:215], v[52:55]
    s_waitcnt lgkmcnt(4)
    s_nop 0
    v_mfma_f32_16x16x32_bf16 v[24:27], v[128:131], v[216:219], v[24:27]
    v_mfma_f32_16x16x32_bf16 v[56:59], v[132:135], v[216:219], v[56:59]
    s_waitcnt lgkmcnt(3)
    s_nop 0
    v_mfma_f32_16x16x32_bf16 v[28:31], v[128:131], v[220:223], v[28:31]
    v_mfma_f32_16x16x32_bf16 v[60:63], v[132:135], v[220:223], v[60:63]
    buffer_load_dwordx4 v[128:131], v240, s[12:15], s23 offen offset:0
    buffer_load_dwordx4 v[132:135], v240, s[12:15], s23 offen offset:1024
    s_waitcnt vmcnt(14)
    s_nop 0
    v_mfma_f32_16x16x32_bf16 v[0:3], v[136:139], v[196:199], v[0:3]
    v_mfma_f32_16x16x32_bf16 v[32:35], v[140:143], v[196:199], v[32:35]
    v_mfma_f32_16x16x32_bf16 v[4:7], v[136:139], v[200:203], v[4:7]
    v_mfma_f32_16x16x32_bf16 v[36:39], v[140:143], v[200:203], v[36:39]
    v_mfma_f32_16x16x32_bf16 v[8:11], v[136:139], v[204:207], v[8:11]
    v_mfma_f32_16x16x32_bf16 v[40:43], v[140:143], v[204:207], v[40:43]
    v_mfma_f32_16x16x32_bf16 v[12:15], v[136:139], v[208:211], v[12:15]
    v_mfma_f32_16x16x32_bf16 v[44:47], v[140:143], v[208:211], v[44:47]
    v_mfma_f32_16x16x32_bf16 v[16:19], v[136:139], v[212:215], v[16:19]
    v_mfma_f32_16x16x32_bf16 v[48:51], v[140:143], v[212:215], v[48:51]
    v_mfma_f32_16x16x32_bf16 v[20:23], v[136:139], v[216:219], v[20:23]
    v_mfma_f32_16x16x32_bf16 v[52:55], v[140:143], v[216:219], v[52:55]
    v_mfma_f32_16x16x32_bf16 v[24:27], v[136:139], v[220:223], v[24:27]
    v_mfma_f32_16x16x32_bf16 v[56:59], v[140:143], v[220:223], v[56:59]
    s_waitcnt lgkmcnt(2)
    s_nop 0
    v_mfma_f32_16x16x32_bf16 v[28:31], v[136:139], v[224:227], v[28:31]
    v_mfma_f32_16x16x32_bf16 v[60:63], v[140:143], v[224:227], v[60:63]
    buffer_load_dwordx4 v[136:139], v240, s[12:15], s23 offen offset:2048
    buffer_load_dwordx4 v[140:143], v240, s[12:15], s23 offen offset:3072
    s_waitcnt vmcnt(14)
    s_nop 0
    v_mfma_f32_16x16x32_bf16 v[0:3], v[144:147], v[200:203], v[0:3]
    v_mfma_f32_16x16x32_bf16 v[32:35], v[148:151], v[200:203], v[32:35]
    v_mfma_f32_16x16x32_bf16 v[4:7], v[144:147], v[204:207], v[4:7]
    v_mfma_f32_16x16x32_bf16 v[36:39], v[148:151], v[204:207], v[36:39]
    v_mfma_f32_16x16x32_bf16 v[8:11], v[144:147], v[208:211], v[8:11]
    v_mfma_f32_16x16x32_bf16 v[40:43], v[148:151], v[208:211], v[40:43]
    v_mfma_f32_16x16x32_bf16 v[12:15], v[144:147], v[212:215], v[12:15]
    v_mfma_f32_16x16x32_bf16 v[44:47], v[148:151], v[212:215], v[44:47]
    v_mfma_f32_16x16x32_bf16 v[16:19], v[144:147], v[216:219], v[16:19]
    v_mfma_f32_16x16x32_bf16 v[48:51], v[148:151], v[216:219], v[48:51]
    v_mfma_f32_16x16x32_bf16 v[20:23], v[144:147], v[220:223], v[20:23]
    v_mfma_f32_16x16x32_bf16 v[52:55], v[148:151], v[220:223], v[52:55]
    v_mfma_f32_16x16x32_bf16 v[24:27], v[144:147], v[224:227], v[24:27]
    ds_read_b128 v[192:195], v236 offset:8192
    v_mfma_f32_16x16x32_bf16 v[56:59], v[148:151], v[224:227], v[56:59]
    s_waitcnt lgkmcnt(2)
    s_nop 0
    v_mfma_f32_16x16x32_bf16 v[28:31], v[144:147], v[228:231], v[28:31]
    ds_read_b128 v[196:199], v236 offset:8448
    v_mfma_f32_16x16x32_bf16 v[60:63], v[148:151], v[228:231], v[60:63]
    buffer_load_dwordx4 v[144:147], v241, s[12:15], s23 offen offset:0
    buffer_load_dwordx4 v[148:151], v241, s[12:15], s23 offen offset:1024
    s_waitcnt vmcnt(14)
    s_nop 0
    v_mfma_f32_16x16x32_bf16 v[0:3], v[152:155], v[204:207], v[0:3]
    ds_read_b128 v[200:203], v236 offset:8704
    v_mfma_f32_16x16x32_bf16 v[32:35], v[156:159], v[204:207], v[32:35]
    v_mfma_f32_16x16x32_bf16 v[4:7], v[152:155], v[208:211], v[4:7]
    ds_read_b128 v[204:207], v236 offset:8960
    v_mfma_f32_16x16x32_bf16 v[36:39], v[156:159], v[208:211], v[36:39]
    v_mfma_f32_16x16x32_bf16 v[8:11], v[152:155], v[212:215], v[8:11]
    ds_read_b128 v[208:211], v236 offset:9216
    v_mfma_f32_16x16x32_bf16 v[40:43], v[156:159], v[212:215], v[40:43]
    v_mfma_f32_16x16x32_bf16 v[12:15], v[152:155], v[216:219], v[12:15]
    ds_read_b128 v[212:215], v236 offset:9472
    v_mfma_f32_16x16x32_bf16 v[44:47], v[156:159], v[216:219], v[44:47]
    v_mfma_f32_16x16x32_bf16 v[16:19], v[152:155], v[220:223], v[16:19]
    ds_read_b128 v[216:219], v236 offset:9728
    v_mfma_f32_16x16x32_bf16 v[48:51], v[156:159], v[220:223], v[48:51]
    v_mfma_f32_16x16x32_bf16 v[20:23], v[152:155], v[224:227], v[20:23]
    ds_read_b128 v[220:223], v236 offset:9984
    v_mfma_f32_16x16x32_bf16 v[52:55], v[156:159], v[224:227], v[52:55]
    v_mfma_f32_16x16x32_bf16 v[24:27], v[152:155], v[228:231], v[24:27]
    ds_read_b128 v[224:227], v246 offset:0
    v_add_u32 v246, v247, v246
    s_nop 0
    v_mfma_f32_16x16x32_bf16 v[56:59], v[156:159], v[228:231], v[56:59]
    s_waitcnt lgkmcnt(9)
    s_nop 0
    v_mfma_f32_16x16x32_bf16 v[28:31], v[152:155], v[232:235], v[28:31]
    ds_read_b128 v[228:231], v236 offset:8464
    v_mfma_f32_16x16x32_bf16 v[60:63], v[156:159], v[232:235], v[60:63]
    buffer_load_dwordx4 v[152:155], v241, s[12:15], s23 offen offset:2048
    buffer_load_dwordx4 v[156:159], v241, s[12:15], s23 offen offset:3072
    s_waitcnt vmcnt(14) lgkmcnt(9)
    s_nop 0
    v_mfma_f32_16x16x32_bf16 v[64:67], v[160:163], v[192:195], v[64:67]
    ds_read_b128 v[232:235], v236 offset:8720
    v_mfma_f32_16x16x32_bf16 v[96:99], v[164:167], v[192:195], v[96:99]
    s_waitcnt lgkmcnt(9)
    s_nop 0
    v_mfma_f32_16x16x32_bf16 v[68:71], v[160:163], v[196:199], v[68:71]
    v_mfma_f32_16x16x32_bf16 v[100:103], v[164:167], v[196:199], v[100:103]
    s_waitcnt lgkmcnt(8)
    s_nop 0
    v_mfma_f32_16x16x32_bf16 v[72:75], v[160:163], v[200:203], v[72:75]
    v_mfma_f32_16x16x32_bf16 v[104:107], v[164:167], v[200:203], v[104:107]
    s_waitcnt lgkmcnt(7)
    s_nop 0
    v_mfma_f32_16x16x32_bf16 v[76:79], v[160:163], v[204:207], v[76:79]
    v_mfma_f32_16x16x32_bf16 v[108:111], v[164:167], v[204:207], v[108:111]
    s_waitcnt lgkmcnt(6)
    s_nop 0
    v_mfma_f32_16x16x32_bf16 v[80:83], v[160:163], v[208:211], v[80:83]
    v_mfma_f32_16x16x32_bf16 v[112:115], v[164:167], v[208:211], v[112:115]
    s_waitcnt lgkmcnt(5)
    s_nop 0
    v_mfma_f32_16x16x32_bf16 v[84:87], v[160:163], v[212:215], v[84:87]
    v_mfma_f32_16x16x32_bf16 v[116:119], v[164:167], v[212:215], v[116:119]
    s_waitcnt lgkmcnt(4)
    s_nop 0
    v_mfma_f32_16x16x32_bf16 v[88:91], v[160:163], v[216:219], v[88:91]
    v_mfma_f32_16x16x32_bf16 v[120:123], v[164:167], v[216:219], v[120:123]
    s_waitcnt lgkmcnt(3)
    s_nop 0
    v_mfma_f32_16x16x32_bf16 v[92:95], v[160:163], v[220:223], v[92:95]
    v_mfma_f32_16x16x32_bf16 v[124:127], v[164:167], v[220:223], v[124:127]
    buffer_load_dwordx4 v[160:163], v242, s[12:15], s23 offen offset:0
    buffer_load_dwordx4 v[164:167], v242, s[12:15], s23 offen offset:1024
    s_waitcnt vmcnt(14)
    s_nop 0
    v_mfma_f32_16x16x32_bf16 v[64:67], v[168:171], v[196:199], v[64:67]
    v_mfma_f32_16x16x32_bf16 v[96:99], v[172:175], v[196:199], v[96:99]
    v_mfma_f32_16x16x32_bf16 v[68:71], v[168:171], v[200:203], v[68:71]
    v_mfma_f32_16x16x32_bf16 v[100:103], v[172:175], v[200:203], v[100:103]
    v_mfma_f32_16x16x32_bf16 v[72:75], v[168:171], v[204:207], v[72:75]
    v_mfma_f32_16x16x32_bf16 v[104:107], v[172:175], v[204:207], v[104:107]
    v_mfma_f32_16x16x32_bf16 v[76:79], v[168:171], v[208:211], v[76:79]
    v_mfma_f32_16x16x32_bf16 v[108:111], v[172:175], v[208:211], v[108:111]
    v_mfma_f32_16x16x32_bf16 v[80:83], v[168:171], v[212:215], v[80:83]
    v_mfma_f32_16x16x32_bf16 v[112:115], v[172:175], v[212:215], v[112:115]
    v_mfma_f32_16x16x32_bf16 v[84:87], v[168:171], v[216:219], v[84:87]
    v_mfma_f32_16x16x32_bf16 v[116:119], v[172:175], v[216:219], v[116:119]
    v_mfma_f32_16x16x32_bf16 v[88:91], v[168:171], v[220:223], v[88:91]
    v_mfma_f32_16x16x32_bf16 v[120:123], v[172:175], v[220:223], v[120:123]
    s_waitcnt lgkmcnt(2)
    s_nop 0
    v_mfma_f32_16x16x32_bf16 v[92:95], v[168:171], v[224:227], v[92:95]
    v_mfma_f32_16x16x32_bf16 v[124:127], v[172:175], v[224:227], v[124:127]
    buffer_load_dwordx4 v[168:171], v242, s[12:15], s23 offen offset:2048
    buffer_load_dwordx4 v[172:175], v242, s[12:15], s23 offen offset:3072
    s_waitcnt vmcnt(14)
    s_nop 0
    v_mfma_f32_16x16x32_bf16 v[64:67], v[176:179], v[200:203], v[64:67]
    v_mfma_f32_16x16x32_bf16 v[96:99], v[180:183], v[200:203], v[96:99]
    v_mfma_f32_16x16x32_bf16 v[68:71], v[176:179], v[204:207], v[68:71]
    v_mfma_f32_16x16x32_bf16 v[100:103], v[180:183], v[204:207], v[100:103]
    v_mfma_f32_16x16x32_bf16 v[72:75], v[176:179], v[208:211], v[72:75]
    v_mfma_f32_16x16x32_bf16 v[104:107], v[180:183], v[208:211], v[104:107]
    v_mfma_f32_16x16x32_bf16 v[76:79], v[176:179], v[212:215], v[76:79]
    v_mfma_f32_16x16x32_bf16 v[108:111], v[180:183], v[212:215], v[108:111]
    s_waitcnt lgkmcnt(0)
    s_barrier
    v_mfma_f32_16x16x32_bf16 v[80:83], v[176:179], v[216:219], v[80:83]
    v_mfma_f32_16x16x32_bf16 v[112:115], v[180:183], v[216:219], v[112:115]
    v_mfma_f32_16x16x32_bf16 v[84:87], v[176:179], v[220:223], v[84:87]
    v_mfma_f32_16x16x32_bf16 v[116:119], v[180:183], v[220:223], v[116:119]
    v_mfma_f32_16x16x32_bf16 v[88:91], v[176:179], v[224:227], v[88:91]
    ds_read_b128 v[192:195], v237 offset:0
    v_mfma_f32_16x16x32_bf16 v[120:123], v[180:183], v[224:227], v[120:123]
    v_mfma_f32_16x16x32_bf16 v[92:95], v[176:179], v[228:231], v[92:95]
    ds_read_b128 v[196:199], v237 offset:256
    v_mfma_f32_16x16x32_bf16 v[124:127], v[180:183], v[228:231], v[124:127]
    buffer_load_dwordx4 v[176:179], v243, s[12:15], s23 offen offset:0
    buffer_load_dwordx4 v[180:183], v243, s[12:15], s23 offen offset:1024
    s_waitcnt vmcnt(14)
    s_nop 0
    v_mfma_f32_16x16x32_bf16 v[64:67], v[184:187], v[204:207], v[64:67]
    ds_read_b128 v[200:203], v237 offset:512
    v_mfma_f32_16x16x32_bf16 v[96:99], v[188:191], v[204:207], v[96:99]
    v_mfma_f32_16x16x32_bf16 v[68:71], v[184:187], v[208:211], v[68:71]
    ds_read_b128 v[204:207], v237 offset:768
    v_mfma_f32_16x16x32_bf16 v[100:103], v[188:191], v[208:211], v[100:103]
    v_mfma_f32_16x16x32_bf16 v[72:75], v[184:187], v[212:215], v[72:75]
    ds_read_b128 v[208:211], v237 offset:1024
    v_mfma_f32_16x16x32_bf16 v[104:107], v[188:191], v[212:215], v[104:107]
    v_mfma_f32_16x16x32_bf16 v[76:79], v[184:187], v[216:219], v[76:79]
    ds_read_b128 v[212:215], v237 offset:1280
    v_mfma_f32_16x16x32_bf16 v[108:111], v[188:191], v[216:219], v[108:111]
    v_mfma_f32_16x16x32_bf16 v[80:83], v[184:187], v[220:223], v[80:83]
    ds_read_b128 v[216:219], v237 offset:1536
    v_mfma_f32_16x16x32_bf16 v[112:115], v[188:191], v[220:223], v[112:115]
    v_mfma_f32_16x16x32_bf16 v[84:87], v[184:187], v[224:227], v[84:87]
    ds_read_b128 v[220:223], v237 offset:1792
    v_mfma_f32_16x16x32_bf16 v[116:119], v[188:191], v[224:227], v[116:119]
    v_mfma_f32_16x16x32_bf16 v[88:91], v[184:187], v[228:231], v[88:91]
    ds_read_b128 v[224:227], v245 offset:0
    v_add_u32 v245, v248, v245
    s_nop 0
    v_mfma_f32_16x16x32_bf16 v[120:123], v[188:191], v[228:231], v[120:123]
    v_mfma_f32_16x16x32_bf16 v[92:95], v[184:187], v[232:235], v[92:95]
    ds_read_b128 v[228:231], v237 offset:272
    v_mfma_f32_16x16x32_bf16 v[124:127], v[188:191], v[232:235], v[124:127]
    buffer_load_dwordx4 v[184:187], v243, s[12:15], s23 offen offset:2048
    buffer_load_dwordx4 v[188:191], v243, s[12:15], s23 offen offset:3072
    s_add_u32 s23, s23, 73728
    s_waitcnt vmcnt(14) lgkmcnt(9)
    s_nop 0
    v_mfma_f32_16x16x32_bf16 v[0:3], v[128:131], v[192:195], v[0:3]
    ds_read_b128 v[232:235], v237 offset:528
    v_mfma_f32_16x16x32_bf16 v[32:35], v[132:135], v[192:195], v[32:35]
    s_waitcnt lgkmcnt(9)
    s_nop 0
    v_mfma_f32_16x16x32_bf16 v[4:7], v[128:131], v[196:199], v[4:7]
    v_mfma_f32_16x16x32_bf16 v[36:39], v[132:135], v[196:199], v[36:39]
    s_waitcnt lgkmcnt(8)
    s_nop 0
    v_mfma_f32_16x16x32_bf16 v[8:11], v[128:131], v[200:203], v[8:11]
    v_mfma_f32_16x16x32_bf16 v[40:43], v[132:135], v[200:203], v[40:43]
    s_waitcnt lgkmcnt(7)
    s_nop 0
    v_mfma_f32_16x16x32_bf16 v[12:15], v[128:131], v[204:207], v[12:15]
    v_mfma_f32_16x16x32_bf16 v[44:47], v[132:135], v[204:207], v[44:47]
    s_waitcnt lgkmcnt(6)
    s_nop 0
    v_mfma_f32_16x16x32_bf16 v[16:19], v[128:131], v[208:211], v[16:19]
    v_mfma_f32_16x16x32_bf16 v[48:51], v[132:135], v[208:211], v[48:51]
    s_waitcnt lgkmcnt(5)
    s_nop 0
    v_mfma_f32_16x16x32_bf16 v[20:23], v[128:131], v[212:215], v[20:23]
    v_mfma_f32_16x16x32_bf16 v[52:55], v[132:135], v[212:215], v[52:55]
    s_waitcnt lgkmcnt(4)
    s_nop 0
    v_mfma_f32_16x16x32_bf16 v[24:27], v[128:131], v[216:219], v[24:27]
    v_mfma_f32_16x16x32_bf16 v[56:59], v[132:135], v[216:219], v[56:59]
    s_waitcnt lgkmcnt(3)
    s_nop 0
    v_mfma_f32_16x16x32_bf16 v[28:31], v[128:131], v[220:223], v[28:31]
    v_mfma_f32_16x16x32_bf16 v[60:63], v[132:135], v[220:223], v[60:63]
    buffer_load_dwordx4 v[128:131], v240, s[12:15], s23 offen offset:0
    buffer_load_dwordx4 v[132:135], v240, s[12:15], s23 offen offset:1024
    s_waitcnt vmcnt(14)
    s_nop 0
    v_mfma_f32_16x16x32_bf16 v[0:3], v[136:139], v[196:199], v[0:3]
    v_mfma_f32_16x16x32_bf16 v[32:35], v[140:143], v[196:199], v[32:35]
    v_mfma_f32_16x16x32_bf16 v[4:7], v[136:139], v[200:203], v[4:7]
    v_mfma_f32_16x16x32_bf16 v[36:39], v[140:143], v[200:203], v[36:39]
    v_mfma_f32_16x16x32_bf16 v[8:11], v[136:139], v[204:207], v[8:11]
    v_mfma_f32_16x16x32_bf16 v[40:43], v[140:143], v[204:207], v[40:43]
    v_mfma_f32_16x16x32_bf16 v[12:15], v[136:139], v[208:211], v[12:15]
    v_mfma_f32_16x16x32_bf16 v[44:47], v[140:143], v[208:211], v[44:47]
    v_mfma_f32_16x16x32_bf16 v[16:19], v[136:139], v[212:215], v[16:19]
    v_mfma_f32_16x16x32_bf16 v[48:51], v[140:143], v[212:215], v[48:51]
    v_mfma_f32_16x16x32_bf16 v[20:23], v[136:139], v[216:219], v[20:23]
    v_mfma_f32_16x16x32_bf16 v[52:55], v[140:143], v[216:219], v[52:55]
    v_mfma_f32_16x16x32_bf16 v[24:27], v[136:139], v[220:223], v[24:27]
    v_mfma_f32_16x16x32_bf16 v[56:59], v[140:143], v[220:223], v[56:59]
    s_waitcnt lgkmcnt(2)
    s_nop 0
    v_mfma_f32_16x16x32_bf16 v[28:31], v[136:139], v[224:227], v[28:31]
    v_mfma_f32_16x16x32_bf16 v[60:63], v[140:143], v[224:227], v[60:63]
    buffer_load_dwordx4 v[136:139], v240, s[12:15], s23 offen offset:2048
    buffer_load_dwordx4 v[140:143], v240, s[12:15], s23 offen offset:3072
    s_waitcnt vmcnt(14)
    s_nop 0
    v_mfma_f32_16x16x32_bf16 v[0:3], v[144:147], v[200:203], v[0:3]
    v_mfma_f32_16x16x32_bf16 v[32:35], v[148:151], v[200:203], v[32:35]
    v_mfma_f32_16x16x32_bf16 v[4:7], v[144:147], v[204:207], v[4:7]
    v_mfma_f32_16x16x32_bf16 v[36:39], v[148:151], v[204:207], v[36:39]
    v_mfma_f32_16x16x32_bf16 v[8:11], v[144:147], v[208:211], v[8:11]
    v_mfma_f32_16x16x32_bf16 v[40:43], v[148:151], v[208:211], v[40:43]
    v_mfma_f32_16x16x32_bf16 v[12:15], v[144:147], v[212:215], v[12:15]
    v_mfma_f32_16x16x32_bf16 v[44:47], v[148:151], v[212:215], v[44:47]
    v_mfma_f32_16x16x32_bf16 v[16:19], v[144:147], v[216:219], v[16:19]
    v_mfma_f32_16x16x32_bf16 v[48:51], v[148:151], v[216:219], v[48:51]
    v_mfma_f32_16x16x32_bf16 v[20:23], v[144:147], v[220:223], v[20:23]
    v_mfma_f32_16x16x32_bf16 v[52:55], v[148:151], v[220:223], v[52:55]
    v_mfma_f32_16x16x32_bf16 v[24:27], v[144:147], v[224:227], v[24:27]
    ds_read_b128 v[192:195], v237 offset:8192
    v_mfma_f32_16x16x32_bf16 v[56:59], v[148:151], v[224:227], v[56:59]
    s_waitcnt lgkmcnt(2)
    s_nop 0
    v_mfma_f32_16x16x32_bf16 v[28:31], v[144:147], v[228:231], v[28:31]
    ds_read_b128 v[196:199], v237 offset:8448
    v_mfma_f32_16x16x32_bf16 v[60:63], v[148:151], v[228:231], v[60:63]
    buffer_load_dwordx4 v[144:147], v241, s[12:15], s23 offen offset:0
    buffer_load_dwordx4 v[148:151], v241, s[12:15], s23 offen offset:1024
    s_waitcnt vmcnt(14)
    s_nop 0
    v_mfma_f32_16x16x32_bf16 v[0:3], v[152:155], v[204:207], v[0:3]
    ds_read_b128 v[200:203], v237 offset:8704
    v_mfma_f32_16x16x32_bf16 v[32:35], v[156:159], v[204:207], v[32:35]
    v_mfma_f32_16x16x32_bf16 v[4:7], v[152:155], v[208:211], v[4:7]
    ds_read_b128 v[204:207], v237 offset:8960
    v_mfma_f32_16x16x32_bf16 v[36:39], v[156:159], v[208:211], v[36:39]
    v_mfma_f32_16x16x32_bf16 v[8:11], v[152:155], v[212:215], v[8:11]
    ds_read_b128 v[208:211], v237 offset:9216
    v_mfma_f32_16x16x32_bf16 v[40:43], v[156:159], v[212:215], v[40:43]
    v_mfma_f32_16x16x32_bf16 v[12:15], v[152:155], v[216:219], v[12:15]
    ds_read_b128 v[212:215], v237 offset:9472
    v_mfma_f32_16x16x32_bf16 v[44:47], v[156:159], v[216:219], v[44:47]
    v_mfma_f32_16x16x32_bf16 v[16:19], v[152:155], v[220:223], v[16:19]
    ds_read_b128 v[216:219], v237 offset:9728
    v_mfma_f32_16x16x32_bf16 v[48:51], v[156:159], v[220:223], v[48:51]
    v_mfma_f32_16x16x32_bf16 v[20:23], v[152:155], v[224:227], v[20:23]
    ds_read_b128 v[220:223], v237 offset:9984
    v_mfma_f32_16x16x32_bf16 v[52:55], v[156:159], v[224:227], v[52:55]
    v_mfma_f32_16x16x32_bf16 v[24:27], v[152:155], v[228:231], v[24:27]
    ds_read_b128 v[224:227], v246 offset:0
    v_add_u32 v246, v248, v246
    s_nop 0
    v_mfma_f32_16x16x32_bf16 v[56:59], v[156:159], v[228:231], v[56:59]
    s_waitcnt lgkmcnt(9)
    s_nop 0
    v_mfma_f32_16x16x32_bf16 v[28:31], v[152:155], v[232:235], v[28:31]
    ds_read_b128 v[228:231], v237 offset:8464
    v_mfma_f32_16x16x32_bf16 v[60:63], v[156:159], v[232:235], v[60:63]
    buffer_load_dwordx4 v[152:155], v241, s[12:15], s23 offen offset:2048
    buffer_load_dwordx4 v[156:159], v241, s[12:15], s23 offen offset:3072
    s_waitcnt vmcnt(14) lgkmcnt(9)
    s_nop 0
    v_mfma_f32_16x16x32_bf16 v[64:67], v[160:163], v[192:195], v[64:67]
    ds_read_b128 v[232:235], v237 offset:8720
    v_mfma_f32_16x16x32_bf16 v[96:99], v[164:167], v[192:195], v[96:99]
    s_waitcnt lgkmcnt(9)
    s_nop 0
    v_mfma_f32_16x16x32_bf16 v[68:71], v[160:163], v[196:199], v[68:71]
    v_mfma_f32_16x16x32_bf16 v[100:103], v[164:167], v[196:199], v[100:103]
    s_waitcnt lgkmcnt(8)
    s_nop 0
    v_mfma_f32_16x16x32_bf16 v[72:75], v[160:163], v[200:203], v[72:75]
    v_mfma_f32_16x16x32_bf16 v[104:107], v[164:167], v[200:203], v[104:107]
    s_waitcnt lgkmcnt(7)
    s_nop 0
    v_mfma_f32_16x16x32_bf16 v[76:79], v[160:163], v[204:207], v[76:79]
    v_mfma_f32_16x16x32_bf16 v[108:111], v[164:167], v[204:207], v[108:111]
    s_waitcnt lgkmcnt(6)
    s_nop 0
    v_mfma_f32_16x16x32_bf16 v[80:83], v[160:163], v[208:211], v[80:83]
    v_mfma_f32_16x16x32_bf16 v[112:115], v[164:167], v[208:211], v[112:115]
    s_waitcnt lgkmcnt(5)
    s_nop 0
    v_mfma_f32_16x16x32_bf16 v[84:87], v[160:163], v[212:215], v[84:87]
    v_mfma_f32_16x16x32_bf16 v[116:119], v[164:167], v[212:215], v[116:119]
    s_waitcnt lgkmcnt(4)
    s_nop 0
    v_mfma_f32_16x16x32_bf16 v[88:91], v[160:163], v[216:219], v[88:91]
    v_mfma_f32_16x16x32_bf16 v[120:123], v[164:167], v[216:219], v[120:123]
    s_waitcnt lgkmcnt(3)
    s_nop 0
    v_mfma_f32_16x16x32_bf16 v[92:95], v[160:163], v[220:223], v[92:95]
    v_mfma_f32_16x16x32_bf16 v[124:127], v[164:167], v[220:223], v[124:127]
    buffer_load_dwordx4 v[160:163], v242, s[12:15], s23 offen offset:0
    buffer_load_dwordx4 v[164:167], v242, s[12:15], s23 offen offset:1024
    s_waitcnt vmcnt(14)
    s_nop 0
    v_mfma_f32_16x16x32_bf16 v[64:67], v[168:171], v[196:199], v[64:67]
    v_mfma_f32_16x16x32_bf16 v[96:99], v[172:175], v[196:199], v[96:99]
    v_mfma_f32_16x16x32_bf16 v[68:71], v[168:171], v[200:203], v[68:71]
    v_mfma_f32_16x16x32_bf16 v[100:103], v[172:175], v[200:203], v[100:103]
    v_mfma_f32_16x16x32_bf16 v[72:75], v[168:171], v[204:207], v[72:75]
    v_mfma_f32_16x16x32_bf16 v[104:107], v[172:175], v[204:207], v[104:107]
    v_mfma_f32_16x16x32_bf16 v[76:79], v[168:171], v[208:211], v[76:79]
    v_mfma_f32_16x16x32_bf16 v[108:111], v[172:175], v[208:211], v[108:111]
    v_mfma_f32_16x16x32_bf16 v[80:83], v[168:171], v[212:215], v[80:83]
    v_mfma_f32_16x16x32_bf16 v[112:115], v[172:175], v[212:215], v[112:115]
    v_mfma_f32_16x16x32_bf16 v[84:87], v[168:171], v[216:219], v[84:87]
    v_mfma_f32_16x16x32_bf16 v[116:119], v[172:175], v[216:219], v[116:119]
    v_mfma_f32_16x16x32_bf16 v[88:91], v[168:171], v[220:223], v[88:91]
    v_mfma_f32_16x16x32_bf16 v[120:123], v[172:175], v[220:223], v[120:123]
    s_waitcnt lgkmcnt(2)
    s_nop 0
    v_mfma_f32_16x16x32_bf16 v[92:95], v[168:171], v[224:227], v[92:95]
    v_mfma_f32_16x16x32_bf16 v[124:127], v[172:175], v[224:227], v[124:127]
    buffer_load_dwordx4 v[168:171], v242, s[12:15], s23 offen offset:2048
    buffer_load_dwordx4 v[172:175], v242, s[12:15], s23 offen offset:3072
    s_waitcnt vmcnt(14)
    s_nop 0
    v_mfma_f32_16x16x32_bf16 v[64:67], v[176:179], v[200:203], v[64:67]
    v_mfma_f32_16x16x32_bf16 v[96:99], v[180:183], v[200:203], v[96:99]
    v_mfma_f32_16x16x32_bf16 v[68:71], v[176:179], v[204:207], v[68:71]
    v_mfma_f32_16x16x32_bf16 v[100:103], v[180:183], v[204:207], v[100:103]
    v_mfma_f32_16x16x32_bf16 v[72:75], v[176:179], v[208:211], v[72:75]
    v_mfma_f32_16x16x32_bf16 v[104:107], v[180:183], v[208:211], v[104:107]
    v_mfma_f32_16x16x32_bf16 v[76:79], v[176:179], v[212:215], v[76:79]
    v_mfma_f32_16x16x32_bf16 v[108:111], v[180:183], v[212:215], v[108:111]
    s_waitcnt lgkmcnt(0)
    s_barrier
    v_mfma_f32_16x16x32_bf16 v[80:83], v[176:179], v[216:219], v[80:83]
    v_mfma_f32_16x16x32_bf16 v[112:115], v[180:183], v[216:219], v[112:115]
    v_mfma_f32_16x16x32_bf16 v[84:87], v[176:179], v[220:223], v[84:87]
    v_mfma_f32_16x16x32_bf16 v[116:119], v[180:183], v[220:223], v[116:119]
    v_mfma_f32_16x16x32_bf16 v[88:91], v[176:179], v[224:227], v[88:91]
    ds_read_b128 v[192:195], v236 offset:0
    v_mfma_f32_16x16x32_bf16 v[120:123], v[180:183], v[224:227], v[120:123]
    v_mfma_f32_16x16x32_bf16 v[92:95], v[176:179], v[228:231], v[92:95]
    ds_read_b128 v[196:199], v236 offset:256
    v_mfma_f32_16x16x32_bf16 v[124:127], v[180:183], v[228:231], v[124:127]
    buffer_load_dwordx4 v[176:179], v243, s[12:15], s23 offen offset:0
    buffer_load_dwordx4 v[180:183], v243, s[12:15], s23 offen offset:1024
    s_waitcnt vmcnt(14)
    s_nop 0
    v_mfma_f32_16x16x32_bf16 v[64:67], v[184:187], v[204:207], v[64:67]
    ds_read_b128 v[200:203], v236 offset:512
    v_mfma_f32_16x16x32_bf16 v[96:99], v[188:191], v[204:207], v[96:99]
    v_mfma_f32_16x16x32_bf16 v[68:71], v[184:187], v[208:211], v[68:71]
    ds_read_b128 v[204:207], v236 offset:768
    v_mfma_f32_16x16x32_bf16 v[100:103], v[188:191], v[208:211], v[100:103]
    v_mfma_f32_16x16x32_bf16 v[72:75], v[184:187], v[212:215], v[72:75]
    ds_read_b128 v[208:211], v236 offset:1024
    v_mfma_f32_16x16x32_bf16 v[104:107], v[188:191], v[212:215], v[104:107]
    v_mfma_f32_16x16x32_bf16 v[76:79], v[184:187], v[216:219], v[76:79]
    ds_read_b128 v[212:215], v236 offset:1280
    v_mfma_f32_16x16x32_bf16 v[108:111], v[188:191], v[216:219], v[108:111]
    v_mfma_f32_16x16x32_bf16 v[80:83], v[184:187], v[220:223], v[80:83]
    ds_read_b128 v[216:219], v236 offset:1536
    v_mfma_f32_16x16x32_bf16 v[112:115], v[188:191], v[220:223], v[112:115]
    v_mfma_f32_16x16x32_bf16 v[84:87], v[184:187], v[224:227], v[84:87]
    ds_read_b128 v[220:223], v236 offset:1792
    v_mfma_f32_16x16x32_bf16 v[116:119], v[188:191], v[224:227], v[116:119]
    v_mfma_f32_16x16x32_bf16 v[88:91], v[184:187], v[228:231], v[88:91]
    ds_read_b128 v[224:227], v245 offset:0
    v_add_u32 v245, v247, v245
    s_nop 0
    v_mfma_f32_16x16x32_bf16 v[120:123], v[188:191], v[228:231], v[120:123]
    v_mfma_f32_16x16x32_bf16 v[92:95], v[184:187], v[232:235], v[92:95]
    ds_read_b128 v[228:231], v236 offset:272
    v_mfma_f32_16x16x32_bf16 v[124:127], v[188:191], v[232:235], v[124:127]
    buffer_load_dwordx4 v[184:187], v243, s[12:15], s23 offen offset:2048
    buffer_load_dwordx4 v[188:191], v243, s[12:15], s23 offen offset:3072
    s_add_u32 s23, s23, 73728
    s_sub_u32 s22, s22, 1
    s_cmp_lg_u32 s22, 0
    s_cbranch_scc1 L_conv1_kernel_mloop
    s_setprio 0
    s_nop 7
    s_waitcnt vmcnt(0) lgkmcnt(0)
    ds_write_b128 v244, v[0:3] offset:0
    ds_write_b128 v244, v[4:7] offset:1024
    ds_write_b128 v244, v[8:11] offset:2048
    ds_write_b128 v244, v[12:15] offset:3072
    ds_write_b128 v244, v[16:19] offset:4096
    ds_write_b128 v244, v[20:23] offset:5120
    ds_write_b128 v244, v[24:27] offset:6144
    ds_write_b128 v244, v[28:31] offset:7168
    ds_write_b128 v244, v[32:35] offset:8192
    ds_write_b128 v244, v[36:39] offset:9216
    ds_write_b128 v244, v[40:43] offset:10240
    ds_write_b128 v244, v[44:47] offset:11264
    ds_write_b128 v244, v[48:51] offset:12288
    ds_write_b128 v244, v[52:55] offset:13312
    ds_write_b128 v244, v[56:59] offset:14336
    ds_write_b128 v244, v[60:63] offset:15360
    ds_write_b128 v244, v[64:67] offset:16384
    ds_write_b128 v244, v[68:71] offset:17408
    ds_write_b128 v244, v[72:75] offset:18432
    ds_write_b128 v244, v[76:79] offset:19456
    ds_write_b128 v244, v[80:83] offset:20480
    ds_write_b128 v244, v[84:87] offset:21504
    ds_write_b128 v244, v[88:91] offset:22528
    ds_write_b128 v244, v[92:95] offset:23552
    ds_write_b128 v244, v[96:99] offset:24576
    ds_write_b128 v244, v[100:103] offset:25600
    ds_write_b128 v244, v[104:107] offset:26624
    ds_write_b128 v244, v[108:111] offset:27648
    ds_write_b128 v244, v[112:115] offset:28672
    ds_write_b128 v244, v[116:119] offset:29696
    ds_write_b128 v244, v[120:123] offset:30720
    ds_write_b128 v244, v[124:127] offset:31744
    s_branch L_conv1_kernel_epi
L_conv1_kernel_helper:
    v_add_u32 v232, 0, v7
    v_add_u32 v233, 1024, v7
    v_add_u32 v234, 2048, v7
    v_add_u32 v235, 3072, v7
    v_add_u32 v236, 4096, v7
    v_add_u32 v237, 5120, v7
    v_add_u32 v238, 6144, v7
    v_add_u32 v239, 7168, v7
    s_lshr_b32 s37, s32, 1
    s_lshl_b32 s38, s37, 9
    s_add_u32 s38, s38, 131072
    v_add_u32 v240, s38, v1
    s_cmp_eq_u32 s37, 0
    s_mov_b32 s38, 131088
    s_cselect_b32 s38, 132608, s38
    v_add_u32 v241, s38, v1
    s_mov_b32 s24, 0
    buffer_load_dwordx4 v[0:3], v232, s[8:11], s24 offen offset:0
    buffer_load_dwordx4 v[32:35], v232, s[8:11], s24 offen offset:64
    v_add_u32 v232, 128, v232
    buffer_load_dwordx4 v[4:7], v233, s[8:11], s24 offen offset:0
    buffer_load_dwordx4 v[36:39], v233, s[8:11], s24 offen offset:64
    v_add_u32 v233, 128, v233
    buffer_load_dwordx4 v[8:11], v234, s[8:11], s24 offen offset:0
    buffer_load_dwordx4 v[40:43], v234, s[8:11], s24 offen offset:64
    v_add_u32 v234, 128, v234
    buffer_load_dwordx4 v[12:15], v235, s[8:11], s24 offen offset:0
    buffer_load_dwordx4 v[44:47], v235, s[8:11], s24 offen offset:64
    v_add_u32 v235, 128, v235
    buffer_load_dwordx4 v[48:51], v236, s[8:11], s24 offen offset:64
    v_add_u32 v236, 128, v236
    buffer_load_dwordx4 v[52:55], v237, s[8:11], s24 offen offset:64
    v_add_u32 v237, 128, v237
    buffer_load_dwordx4 v[56:59], v238, s[8:11], s24 offen offset:64
    v_add_u32 v238, 128, v238
    buffer_load_dwordx4 v[60:63], v239, s[8:11], s24 offen offset:64
    v_add_u32 v239, 128, v239
    s_lshl_b32 s38, s37, 12
    s_and_b32 s39, s32, 1
    s_lshl_b32 s40, s39, 10
    s_add_u32 s38, s38, s40
    s_add_u32 s38, s38, 65536
    v_lshl_add_u32 v245, v255, 4, s38
    s_add_u32 s38, s37, 8
    s_lshl_b32 s38, s38, 14
    s_lshl_b32 s40, s39, 13
    s_add_u32 s38, s38, s40
    v_lshl_add_u32 v244, v255, 4, s38
    v_mov_b32 v128, 0
    v_mov_b32 v129, 0
    v_mov_b32 v130, 0
    v_mov_b32 v131, 0
    v_mov_b32 v132, 0
    v_mov_b32 v133, 0
    v_mov_b32 v134, 0
    v_mov_b32 v135, 0
    v_mov_b32 v136, 0
    v_mov_b32 v137, 0
    v_mov_b32 v138, 0
    v_mov_b32 v139, 0
    v_mov_b32 v140, 0
    v_mov_b32 v141, 0
    v_mov_b32 v142, 0
    v_mov_b32 v143, 0
    v_mov_b32 v144, 0
    v_mov_b32 v145, 0
    v_mov_b32 v146, 0
    v_mov_b32 v147, 0
    v_mov_b32 v148, 0
    v_mov_b32 v149, 0
    v_mov_b32 v150, 0
    v_mov_b32 v151, 0
    v_mov_b32 v152, 0
    v_mov_b32 v153, 0
    v_mov_b32 v154, 0
    v_mov_b32 v155, 0
    v_mov_b32 v156, 0
    v_mov_b32 v157, 0
    v_mov_b32 v158, 0
    v_mov_b32 v159, 0
    s_waitcnt vmcnt(4)
    v_lshlrev_b32 v204, 16, v0
    v_and_b32 v208, s25, v0
    ds_write_addtid_b32 v0 offset:0
    v_lshlrev_b32 v205, 16, v4
    v_and_b32 v209, s25, v4
    ds_write_addtid_b32 v4 offset:8192
    v_lshlrev_b32 v206, 16, v8
    v_and_b32 v210, s25, v8
    ds_write_addtid_b32 v8 offset:16384
    v_lshlrev_b32 v207, 16, v12
    v_and_b32 v211, s25, v12
    ds_write_addtid_b32 v12 offset:24576
    v_add_f32 v212, v204, v205
    v_add_f32 v216, v208, v209
    v_cvt_pk_bf16_f32 v220, v212, v216
    v_add_f32 v213, v206, v207
    v_add_f32 v217, v210, v211
    ds_write_addtid_b32 v220 offset:32768
    v_cvt_pk_bf16_f32 v221, v213, v217
    v_add_f32 v214, v204, v206
    v_add_f32 v218, v208, v210
    ds_write_addtid_b32 v221 offset:40960
    v_cvt_pk_bf16_f32 v222, v214, v218
    v_add_f32 v215, v205, v207
    v_add_f32 v219, v209, v211
    ds_write_addtid_b32 v222 offset:49152
    v_cvt_pk_bf16_f32 v223, v215, v219
    v_add_f32 v204, v212, v213
    v_add_f32 v208, v216, v217
    ds_write_addtid_b32 v223 offset:57344
    v_cvt_pk_bf16_f32 v224, v204, v208
    ds_write_b32 v249, v224 offset:0
    v_lshlrev_b32 v204, 16, v1
    v_and_b32 v208, s25, v1
    ds_write_addtid_b32 v1 offset:2048
    v_lshlrev_b32 v205, 16, v5
    v_and_b32 v209, s25, v5
    ds_write_addtid_b32 v5 offset:10240
    v_lshlrev_b32 v206, 16, v9
    v_and_b32 v210, s25, v9
    ds_write_addtid_b32 v9 offset:18432
    v_lshlrev_b32 v207, 16, v13
    v_and_b32 v211, s25, v13
    ds_write_addtid_b32 v13 offset:26624
    v_add_f32 v212, v204, v205
    v_add_f32 v216, v208, v209
    v_cvt_pk_bf16_f32 v225, v212, v216
    v_add_f32 v213, v206, v207
    v_add_f32 v217, v210, v211
    ds_write_addtid_b32 v225 offset:34816
    v_cvt_pk_bf16_f32 v226, v213, v217
    v_add_f32 v214, v204, v206
    v_add_f32 v218, v208, v210
    ds_write_addtid_b32 v226 offset:43008
    v_cvt_pk_bf16_f32 v227, v214, v218
    v_add_f32 v215, v205, v207
    v_add_f32 v219, v209, v211
    s_waitcnt lgkmcnt(8)
    ds_write_addtid_b32 v227 offset:51200
    v_cvt_pk_bf16_f32 v228, v215, v219
    v_add_f32 v204, v212, v213
    v_add_f32 v208, v216, v217
    ds_write_addtid_b32 v228 offset:59392
    v_cvt_pk_bf16_f32 v229, v204, v208
    ds_write_b32 v249, v229 offset:2048
    v_lshlrev_b32 v204, 16, v2
    v_and_b32 v208, s25, v2
    ds_write_addtid_b32 v2 offset:4096
    v_lshlrev_b32 v205, 16, v6
    v_and_b32 v209, s25, v6
    ds_write_addtid_b32 v6 offset:12288
    v_lshlrev_b32 v206, 16, v10
    v_and_b32 v210, s25, v10
    ds_write_addtid_b32 v10 offset:20480
    v_lshlrev_b32 v207, 16, v14
    v_and_b32 v211, s25, v14
    ds_write_addtid_b32 v14 offset:28672
    v_add_f32 v212, v204, v205
    v_add_f32 v216, v208, v209
    v_cvt_pk_bf16_f32 v220, v212, v216
    v_add_f32 v213, v206, v207
    v_add_f32 v217, v210, v211
    s_waitcnt lgkmcnt(8)
    ds_write_addtid_b32 v220 offset:36864
    v_cvt_pk_bf16_f32 v221, v213, v217
    v_add_f32 v214, v204, v206
    v_add_f32 v218, v208, v210
    ds_write_addtid_b32 v221 offset:45056
    v_cvt_pk_bf16_f32 v222, v214, v218
    v_add_f32 v215, v205, v207
    v_add_f32 v219, v209, v211
    ds_write_addtid_b32 v222 offset:53248
    v_cvt_pk_bf16_f32 v223, v215, v219
    v_add_f32 v204, v212, v213
    v_add_f32 v208, v216, v217
    ds_write_addtid_b32 v223 offset:61440
    v_cvt_pk_bf16_f32 v224, v204, v208
    ds_write_b32 v249, v224 offset:4096
    v_lshlrev_b32 v204, 16, v3
    v_and_b32 v208, s25, v3
    ds_write_addtid_b32 v3 offset:6144
    v_lshlrev_b32 v205, 16, v7
    v_and_b32 v209, s25, v7
    ds_write_addtid_b32 v7 offset:14336
    v_lshlrev_b32 v206, 16, v11
    v_and_b32 v210, s25, v11
    s_waitcnt lgkmcnt(8)
    ds_write_addtid_b32 v11 offset:22528
    v_lshlrev_b32 v207, 16, v15
    v_and_b32 v211, s25, v15
    ds_write_addtid_b32 v15 offset:30720
    v_add_f32 v212, v204, v205
    v_add_f32 v216, v208, v209
    v_cvt_pk_bf16_f32 v225, v212, v216
    v_add_f32 v213, v206, v207
    v_add_f32 v217, v210, v211
    ds_write_addtid_b32 v225 offset:38912
    v_cvt_pk_bf16_f32 v226, v213, v217
    v_add_f32 v214, v204, v206
    v_add_f32 v218, v208, v210
    ds_write_addtid_b32 v226 offset:47104
    v_cvt_pk_bf16_f32 v227, v214, v218
    v_add_f32 v215, v205, v207
    v_add_f32 v219, v209, v211
    ds_write_addtid_b32 v227 offset:55296
    v_cvt_pk_bf16_f32 v228, v215, v219
    v_add_f32 v204, v212, v213
    v_add_f32 v208, v216, v217
    ds_write_addtid_b32 v228 offset:63488
    v_cvt_pk_bf16_f32 v229, v204, v208
    ds_write_b32 v249, v229 offset:6144
    buffer_load_dwordx4 v[64:67], v232, s[8:11], s24 offen offset:0
    buffer_load_dwordx4 v[96:99], v232, s[8:11], s24 offen offset:64
    v_add_u32 v232, 128, v232
    buffer_load_dwordx4 v[68:71], v233, s[8:11], s24 offen offset:0
    buffer_load_dwordx4 v[100:103], v233, s[8:11], s24 offen offset:64
    v_add_u32 v233, 128, v233
    buffer_load_dwordx4 v[72:75], v234, s[8:11], s24 offen offset:0
    buffer_load_dwordx4 v[104:107], v234, s[8:11], s24 offen offset:64
    v_add_u32 v234, 128, v234
    buffer_load_dwordx4 v[76:79], v235, s[8:11], s24 offen offset:0
    buffer_load_dwordx4 v[108:111], v235, s[8:11], s24 offen offset:64
    v_add_u32 v235, 128, v235
    buffer_load_dwordx4 v[80:83], v236, s[8:11], s24 offen offset:0
    buffer_load_dwordx4 v[112:115], v236, s[8:11], s24 offen offset:64
    v_add_u32 v236, 128, v236
    buffer_load_dwordx4 v[84:87], v237, s[8:11], s24 offen offset:0
    buffer_load_dwordx4 v[116:119], v237, s[8:11], s24 offen offset:64
    v_add_u32 v237, 128, v237
    s_mov_b32 s23, 0
    buffer_load_dwordx4 v[160:163], v245, s[12:15], s23 offen offset:0
    buffer_load_dwordx4 v[164:167], v245, s[12:15], s23 offen offset:2048
    s_mov_b32 s23, 73728
    s_mov_b32 s28, 0
    s_mov_b32 s22, 4
    s_waitcnt vmcnt(14) lgkmcnt(0)
    s_barrier
    s_setprio 1
L_conv1_kernel_hloop:
    s_mov_b32 m0, s27
    ds_read_b128 v[168:171], v240 offset:0
    ds_read_b128 v[172:175], v240 offset:256
    ds_read_b128 v[176:179], v240 offset:512
    ds_read_b128 v[180:183], v240 offset:768
    ds_read_b128 v[184:187], v240 offset:1024
    ds_read_b128 v[188:191], v240 offset:1280
    ds_read_b128 v[192:195], v241 offset:0
    ds_read_b128 v[196:199], v241 offset:256
    ds_read_b128 v[200:203], v240 offset:16
    v_lshlrev_b32 v204, 16, v32
    v_and_b32 v208, s25, v32
    ds_write_addtid_b32 v32 offset:1540
    v_lshlrev_b32 v205, 16, v36
    v_and_b32 v209, s25, v36
    ds_write_addtid_b32 v36 offset:9732
    v_lshlrev_b32 v206, 16, v40
    v_and_b32 v210, s25, v40
    ds_write_addtid_b32 v40 offset:17924
    v_lshlrev_b32 v207, 16, v44
    v_and_b32 v211, s25, v44
    ds_write_addtid_b32 v44 offset:26116
    v_add_f32 v212, v204, v205
    v_add_f32 v216, v208, v209
    v_cvt_pk_bf16_f32 v220, v212, v216
    v_add_f32 v213, v206, v207
    v_add_f32 v217, v210, v211
    ds_write_addtid_b32 v220 offset:34308
    v_cvt_pk_bf16_f32 v221, v213, v217
    v_add_f32 v214, v204, v206
    v_add_f32 v218, v208, v210
    ds_write_addtid_b32 v221 offset:42500
    v_cvt_pk_bf16_f32 v222, v214, v218
    v_add_f32 v215, v205, v207
    v_add_f32 v219, v209, v211
    s_waitcnt lgkmcnt(8)
    ds_write_addtid_b32 v222 offset:50692
    v_cvt_pk_bf16_f32 v223, v215, v219
    v_add_f32 v204, v212, v213
    v_add_f32 v208, v216, v217
    ds_write_addtid_b32 v223 offset:58884
    v_cvt_pk_bf16_f32 v224, v204, v208
    ds_write_b32 v249, v224 offset:8192
    v_lshlrev_b32 v204, 16, v33
    v_and_b32 v208, s25, v33
    ds_write_addtid_b32 v33 offset:3588
    v_lshlrev_b32 v205, 16, v37
    v_and_b32 v209, s25, v37
    ds_write_addtid_b32 v37 offset:11780
    s_cmp_lt_i32 s28, 13
    s_cselect_b32 s24, 0, 2130706432
    buffer_load_dwordx4 v[88:91], v238, s[8:11], s24 offen offset:0
    buffer_load_dwordx4 v[120:123], v238, s[8:11], s24 offen offset:64
    v_add_u32 v238, 128, v238
    v_lshlrev_b32 v206, 16, v41
    v_and_b32 v210, s25, v41
    ds_write_addtid_b32 v41 offset:19972
    v_lshlrev_b32 v207, 16, v45
    v_and_b32 v211, s25, v45
    ds_write_addtid_b32 v45 offset:28164
    v_add_f32 v212, v204, v205
    v_add_f32 v216, v208, v209
    v_cvt_pk_bf16_f32 v225, v212, v216
    v_add_f32 v213, v206, v207
    v_add_f32 v217, v210, v211
    s_waitcnt lgkmcnt(8)
    ds_write_addtid_b32 v225 offset:36356
    v_cvt_pk_bf16_f32 v226, v213, v217
    s_waitcnt vmcnt(2)
    v_mfma_f32_16x16x32_bf16 v[128:131], v[160:163], v[168:171], v[128:131]
    v_add_f32 v214, v204, v206
    v_add_f32 v218, v208, v210
    ds_write_addtid_b32 v226 offset:44548
    v_cvt_pk_bf16_f32 v227, v214, v218
    v_add_f32 v215, v205, v207
    v_add_f32 v219, v209, v211
    ds_write_addtid_b32 v227 offset:52740
    v_cvt_pk_bf16_f32 v228, v215, v219
    v_add_f32 v204, v212, v213
    v_add_f32 v208, v216, v217
    ds_write_addtid_b32 v228 offset:60932
    v_cvt_pk_bf16_f32 v229, v204, v208
    ds_write_b32 v249, v229 offset:10240
    v_lshlrev_b32 v204, 16, v34
    v_and_b32 v208, s25, v34
    ds_write_addtid_b32 v34 offset:5636
    v_lshlrev_b32 v205, 16, v38
    v_and_b32 v209, s25, v38
    ds_write_addtid_b32 v38 offset:13828
    v_lshlrev_b32 v206, 16, v42
    v_and_b32 v210, s25, v42
    s_waitcnt lgkmcnt(8)
    ds_write_addtid_b32 v42 offset:22020
    v_mfma_f32_16x16x32_bf16 v[132:135], v[160:163], v[172:175], v[132:135]
    v_mfma_f32_16x16x32_bf16 v[128:131], v[164:167], v[172:175], v[128:131]
    v_lshlrev_b32 v207, 16, v46
    v_and_b32 v211, s25, v46
    ds_write_addtid_b32 v46 offset:30212
    v_add_f32 v212, v204, v205
    v_add_f32 v216, v208, v209
    v_cvt_pk_bf16_f32 v220, v212, v216
    v_add_f32 v213, v206, v207
    v_add_f32 v217, v210, v211
    ds_write_addtid_b32 v220 offset:38404
    v_cvt_pk_bf16_f32 v221, v213, v217
    v_add_f32 v214, v204, v206
    v_add_f32 v218, v208, v210
    ds_write_addtid_b32 v221 offset:46596
    v_cvt_pk_bf16_f32 v222, v214, v218
    v_add_f32 v215, v205, v207
    v_add_f32 v219, v209, v211
    buffer_load_dwordx4 v[92:95], v239, s[8:11], s24 offen offset:0
    buffer_load_dwordx4 v[124:127], v239, s[8:11], s24 offen offset:64
    v_add_u32 v239, 128, v239
    ds_write_addtid_b32 v222 offset:54788
    v_cvt_pk_bf16_f32 v223, v215, v219
    v_add_f32 v204, v212, v213
    v_add_f32 v208, v216, v217
    ds_write_addtid_b32 v223 offset:62980
    v_cvt_pk_bf16_f32 v224, v204, v208
    ds_write_b32 v249, v224 offset:12288
    v_mfma_f32_16x16x32_bf16 v[136:139], v[160:163], v[176:179], v[136:139]
    v_mfma_f32_16x16x32_bf16 v[132:135], v[164:167], v[176:179], v[132:135]
    v_lshlrev_b32 v204, 16, v35
    v_and_b32 v208, s25, v35
    s_waitcnt lgkmcnt(8)
    ds_write_addtid_b32 v35 offset:7684
    v_lshlrev_b32 v205, 16, v39
    v_and_b32 v209, s25, v39
    ds_write_addtid_b32 v39 offset:15876
    v_lshlrev_b32 v206, 16, v43
    v_and_b32 v210, s25, v43
    ds_write_addtid_b32 v43 offset:24068
    v_lshlrev_b32 v207, 16, v47
    v_and_b32 v211, s25, v47
    ds_write_addtid_b32 v47 offset:32260
    v_add_f32 v212, v204, v205
    v_add_f32 v216, v208, v209
    v_cvt_pk_bf16_f32 v225, v212, v216
    v_add_f32 v213, v206, v207
    v_add_f32 v217, v210, v211
    ds_write_addtid_b32 v225 offset:40452
    v_cvt_pk_bf16_f32 v226, v213, v217
    v_add_f32 v214, v204, v206
    v_add_f32 v218, v208, v210
    ds_write_addtid_b32 v226 offset:48644
    v_mfma_f32_16x16x32_bf16 v[140:143], v[160:163], v[180:183], v[140:143]
    v_mfma_f32_16x16x32_bf16 v[136:139], v[164:167], v[180:183], v[136:139]
    v_cvt_pk_bf16_f32 v227, v214, v218
    v_add_f32 v215, v205, v207
    v_add_f32 v219, v209, v211
    ds_write_addtid_b32 v227 offset:56836
    v_cvt_pk_bf16_f32 v228, v215, v219
    v_add_f32 v204, v212, v213
    v_add_f32 v208, v216, v217
    s_waitcnt lgkmcnt(8)
    ds_write_addtid_b32 v228 offset:65028
    v_cvt_pk_bf16_f32 v229, v204, v208
    ds_write_b32 v249, v229 offset:14336
    v_lshlrev_b32 v204, 16, v48
    v_and_b32 v208, s25, v48
    ds_write_addtid_b32 v48 offset:1796
    v_lshlrev_b32 v205, 16, v52
    v_and_b32 v209, s25, v52
    ds_write_addtid_b32 v52 offset:9988
    v_lshlrev_b32 v206, 16, v56
    v_and_b32 v210, s25, v56
    ds_write_addtid_b32 v56 offset:18180
    v_lshlrev_b32 v207, 16, v60
    v_and_b32 v211, s25, v60
    ds_write_addtid_b32 v60 offset:26372
    v_mfma_f32_16x16x32_bf16 v[144:147], v[160:163], v[184:187], v[144:147]
    v_mfma_f32_16x16x32_bf16 v[140:143], v[164:167], v[184:187], v[140:143]
    v_add_f32 v212, v204, v205
    v_add_f32 v216, v208, v209
    v_cvt_pk_bf16_f32 v220, v212, v216
    v_add_f32 v213, v206, v207
    v_add_f32 v217, v210, v211
    ds_write_addtid_b32 v220 offset:34564
    v_cvt_pk_bf16_f32 v221, v213, v217
    v_add_f32 v214, v204, v206
    v_add_f32 v218, v208, v210
    s_waitcnt lgkmcnt(8)
    ds_write_addtid_b32 v221 offset:42756
    v_cvt_pk_bf16_f32 v222, v214, v218
    v_add_f32 v215, v205, v207
    v_add_f32 v219, v209, v211
    s_cmp_lt_i32 s28, 12
    s_cselect_b32 s24, 0, 2130706432
    buffer_load_dwordx4 v[0:3], v232, s[8:11], s24 offen offset:0
    buffer_load_dwordx4 v[32:35], v232, s[8:11], s24 offen offset:64
    v_add_u32 v232, 128, v232
    ds_write_addtid_b32 v222 offset:50948
    v_cvt_pk_bf16_f32 v223, v215, v219
    v_add_f32 v204, v212, v213
    v_add_f32 v208, v216, v217
    ds_write_addtid_b32 v223 offset:59140
    v_cvt_pk_bf16_f32 v224, v204, v208
    ds_write_b32 v249, v224 offset:8448
    v_lshlrev_b32 v204, 16, v49
    v_and_b32 v208, s25, v49
    ds_write_addtid_b32 v49 offset:3844
    v_mfma_f32_16x16x32_bf16 v[148:151], v[160:163], v[188:191], v[148:151]
    v_mfma_f32_16x16x32_bf16 v[144:147], v[164:167], v[188:191], v[144:147]
    v_lshlrev_b32 v205, 16, v53
    v_and_b32 v209, s25, v53
    ds_write_addtid_b32 v53 offset:12036
    v_lshlrev_b32 v206, 16, v57
    v_and_b32 v210, s25, v57
    ds_write_addtid_b32 v57 offset:20228
    v_lshlrev_b32 v207, 16, v61
    v_and_b32 v211, s25, v61
    s_waitcnt lgkmcnt(8)
    ds_write_addtid_b32 v61 offset:28420
    v_add_f32 v212, v204, v205
    v_add_f32 v216, v208, v209
    v_cvt_pk_bf16_f32 v225, v212, v216
    v_add_f32 v213, v206, v207
    v_add_f32 v217, v210, v211
    ds_write_addtid_b32 v225 offset:36612
    v_cvt_pk_bf16_f32 v226, v213, v217
    v_add_f32 v214, v204, v206
    v_add_f32 v218, v208, v210
    ds_write_addtid_b32 v226 offset:44804
    v_cvt_pk_bf16_f32 v227, v214, v218
    v_add_f32 v215, v205, v207
    v_add_f32 v219, v209, v211
    v_mfma_f32_16x16x32_bf16 v[152:155], v[160:163], v[192:195], v[152:155]
    v_mfma_f32_16x16x32_bf16 v[148:151], v[164:167], v[192:195], v[148:151]
    ds_write_addtid_b32 v227 offset:52996
    v_cvt_pk_bf16_f32 v228, v215, v219
    v_add_f32 v204, v212, v213
    v_add_f32 v208, v216, v217
    ds_write_addtid_b32 v228 offset:61188
    v_cvt_pk_bf16_f32 v229, v204, v208
    ds_write_b32 v249, v229 offset:10496
    v_lshlrev_b32 v204, 16, v50
    v_and_b32 v208, s25, v50
    ds_write_addtid_b32 v50 offset:5892
    v_lshlrev_b32 v205, 16, v54
    v_and_b32 v209, s25, v54
    s_waitcnt lgkmcnt(8)
    ds_write_addtid_b32 v54 offset:14084
    v_lshlrev_b32 v206, 16, v58
    v_and_b32 v210, s25, v58
    ds_write_addtid_b32 v58 offset:22276
    v_lshlrev_b32 v207, 16, v62
    v_and_b32 v211, s25, v62
    ds_write_addtid_b32 v62 offset:30468
    buffer_load_dwordx4 v[4:7], v233, s[8:11], s24 offen offset:0
    buffer_load_dwordx4 v[36:39], v233, s[8:11], s24 offen offset:64
    v_add_u32 v233, 128, v233
    v_add_f32 v212, v204, v205
    v_add_f32 v216, v208, v209
    v_cvt_pk_bf16_f32 v220, v212, v216
    v_add_f32 v213, v206, v207
    v_mfma_f32_16x16x32_bf16 v[156:159], v[160:163], v[196:199], v[156:159]
    v_mfma_f32_16x16x32_bf16 v[152:155], v[164:167], v[196:199], v[152:155]
    v_add_f32 v217, v210, v211
    ds_write_addtid_b32 v220 offset:38660
    v_cvt_pk_bf16_f32 v221, v213, v217
    v_add_f32 v214, v204, v206
    v_add_f32 v218, v208, v210
    ds_write_addtid_b32 v221 offset:46852
    v_cvt_pk_bf16_f32 v222, v214, v218
    v_add_f32 v215, v205, v207
    v_add_f32 v219, v209, v211
    ds_write_addtid_b32 v222 offset:55044
    v_cvt_pk_bf16_f32 v223, v215, v219
    v_add_f32 v204, v212, v213
    v_add_f32 v208, v216, v217
    ds_write_addtid_b32 v223 offset:63236
    v_cvt_pk_bf16_f32 v224, v204, v208
    s_waitcnt lgkmcnt(8)
    ds_write_b32 v249, v224 offset:12544
    v_lshlrev_b32 v204, 16, v51
    v_and_b32 v208, s25, v51
    ds_write_addtid_b32 v51 offset:7940
    v_lshlrev_b32 v205, 16, v55
    v_and_b32 v209, s25, v55
    ds_write_addtid_b32 v55 offset:16132
    v_mfma_f32_16x16x32_bf16 v[156:159], v[164:167], v[200:203], v[156:159]
    buffer_load_dwordx4 v[160:163], v245, s[12:15], s23 offen offset:0
    buffer_load_dwordx4 v[164:167], v245, s[12:15], s23 offen offset:2048
    v_lshlrev_b32 v206, 16, v59
    v_and_b32 v210, s25, v59
    ds_write_addtid_b32 v59 offset:24324
    v_lshlrev_b32 v207, 16, v63
    v_and_b32 v211, s25, v63
    ds_write_addtid_b32 v63 offset:32516
    v_add_f32 v212, v204, v205
    v_add_f32 v216, v208, v209
    v_cvt_pk_bf16_f32 v225, v212, v216
    v_add_f32 v213, v206, v207
    v_add_f32 v217, v210, v211
    ds_write_addtid_b32 v225 offset:40708
    v_cvt_pk_bf16_f32 v226, v213, v217
    v_add_f32 v214, v204, v206
    v_add_f32 v218, v208, v210
    ds_write_addtid_b32 v226 offset:48900
    v_cvt_pk_bf16_f32 v227, v214, v218
    v_add_f32 v215, v205, v207
    v_add_f32 v219, v209, v211
    s_waitcnt lgkmcnt(8)
    ds_write_addtid_b32 v227 offset:57092
    v_cvt_pk_bf16_f32 v228, v215, v219
    v_add_f32 v204, v212, v213
    v_add_f32 v208, v216, v217
    ds_write_addtid_b32 v228 offset:65284
    v_cvt_pk_bf16_f32 v229, v204, v208
    ds_write_b32 v249, v229 offset:14592
    s_add_u32 s23, s23, 73728
    s_add_u32 s28, s28, 1
    s_waitcnt lgkmcnt(0)
    s_barrier
    s_mov_b32 m0, s26
    ds_read_b128 v[168:171], v240 offset:8192
    ds_read_b128 v[172:175], v240 offset:8448
    ds_read_b128 v[176:179], v240 offset:8704
    ds_read_b128 v[180:183], v240 offset:8960
    ds_read_b128 v[184:187], v240 offset:9216
    ds_read_b128 v[188:191], v240 offset:9472
    ds_read_b128 v[192:195], v241 offset:8192
    ds_read_b128 v[196:199], v241 offset:8448
    ds_read_b128 v[200:203], v240 offset:8208
    v_lshlrev_b32 v204, 16, v64
    v_and_b32 v208, s25, v64
    ds_write_addtid_b32 v64 offset:0
    v_lshlrev_b32 v205, 16, v68
    v_and_b32 v209, s25, v68
    ds_write_addtid_b32 v68 offset:8192
    v_lshlrev_b32 v206, 16, v72
    v_and_b32 v210, s25, v72
    ds_write_addtid_b32 v72 offset:16384
    v_lshlrev_b32 v207, 16, v76
    v_and_b32 v211, s25, v76
    ds_write_addtid_b32 v76 offset:24576
    v_add_f32 v212, v204, v205
    v_add_f32 v216, v208, v209
    v_cvt_pk_bf16_f32 v220, v212, v216
    v_add_f32 v213, v206, v207
    v_add_f32 v217, v210, v211
    ds_write_addtid_b32 v220 offset:32768
    v_cvt_pk_bf16_f32 v221, v213, v217
    v_add_f32 v214, v204, v206
    v_add_f32 v218, v208, v210
    ds_write_addtid_b32 v221 offset:40960
    v_cvt_pk_bf16_f32 v222, v214, v218
    v_add_f32 v215, v205, v207
    v_add_f32 v219, v209, v211
    s_waitcnt lgkmcnt(8)
    ds_write_addtid_b32 v222 offset:49152
    v_cvt_pk_bf16_f32 v223, v215, v219
    v_add_f32 v204, v212, v213
    v_add_f32 v208, v216, v217
    ds_write_addtid_b32 v223 offset:57344
    v_cvt_pk_bf16_f32 v224, v204, v208
    ds_write_b32 v249, v224 offset:0
    v_lshlrev_b32 v204, 16, v65
    v_and_b32 v208, s25, v65
    ds_write_addtid_b32 v65 offset:2048
    v_lshlrev_b32 v205, 16, v69
    v_and_b32 v209, s25, v69
    ds_write_addtid_b32 v69 offset:10240
    s_cmp_lt_i32 s28, 13
    s_cselect_b32 s24, 0, 2130706432
    buffer_load_dwordx4 v[8:11], v234, s[8:11], s24 offen offset:0
    buffer_load_dwordx4 v[40:43], v234, s[8:11], s24 offen offset:64
    v_add_u32 v234, 128, v234
    v_lshlrev_b32 v206, 16, v73
    v_and_b32 v210, s25, v73
    ds_write_addtid_b32 v73 offset:18432
    v_lshlrev_b32 v207, 16, v77
    v_and_b32 v211, s25, v77
    ds_write_addtid_b32 v77 offset:26624
    v_add_f32 v212, v204, v205
    v_add_f32 v216, v208, v209
    v_cvt_pk_bf16_f32 v225, v212, v216
    v_add_f32 v213, v206, v207
    v_add_f32 v217, v210, v211
    s_waitcnt lgkmcnt(8)
    ds_write_addtid_b32 v225 offset:34816
    v_cvt_pk_bf16_f32 v226, v213, v217
    s_waitcnt vmcnt(2)
    v_mfma_f32_16x16x32_bf16 v[128:131], v[160:163], v[168:171], v[128:131]
    v_add_f32 v214, v204, v206
    v_add_f32 v218, v208, v210
    ds_write_addtid_b32 v226 offset:43008
    v_cvt_pk_bf16_f32 v227, v214, v218
    v_add_f32 v215, v205, v207
    v_add_f32 v219, v209, v211
    ds_write_addtid_b32 v227 offset:51200
    v_cvt_pk_bf16_f32 v228, v215, v219
    v_add_f32 v204, v212, v213
    v_add_f32 v208, v216, v217
    ds_write_addtid_b32 v228 offset:59392
    v_cvt_pk_bf16_f32 v229, v204, v208
    ds_write_b32 v249, v229 offset:2048
    v_lshlrev_b32 v204, 16, v66
    v_and_b32 v208, s25, v66
    ds_write_addtid_b32 v66 offset:4096
    v_lshlrev_b32 v205, 16, v70
    v_and_b32 v209, s25, v70
    ds_write_addtid_b32 v70 offset:12288
    v_lshlrev_b32 v206, 16, v74
    v_and_b32 v210, s25, v74
    s_waitcnt lgkmcnt(8)
    ds_write_addtid_b32 v74 offset:20480
    v_mfma_f32_16x16x32_bf16 v[132:135], v[160:163], v[172:175], v[132:135]
    v_mfma_f32_16x16x32_bf16 v[128:131], v[164:167], v[172:175], v[128:131]
    v_lshlrev_b32 v207, 16, v78
    v_and_b32 v211, s25, v78
    ds_write_addtid_b32 v78 offset:28672
    v_add_f32 v212, v204, v205
    v_add_f32 v216, v208, v209
    v_cvt_pk_bf16_f32 v220, v212, v216
    v_add_f32 v213, v206, v207
    v_add_f32 v217, v210, v211
    ds_write_addtid_b32 v220 offset:36864
    v_cvt_pk_bf16_f32 v221, v213, v217
    v_add_f32 v214, v204, v206
    v_add_f32 v218, v208, v210
    ds_write_addtid_b32 v221 offset:45056
    v_cvt_pk_bf16_f32 v222, v214, v218
    v_add_f32 v215, v205, v207
    v_add_f32 v219, v209, v211
    buffer_load_dwordx4 v[12:15], v235, s[8:11], s24 offen offset:0
    buffer_load_dwordx4 v[44:47], v235, s[8:11], s24 offen offset:64
    v_add_u32 v235, 128, v235
    ds_write_addtid_b32 v222 offset:53248
    v_cvt_pk_bf16_f32 v223, v215, v219
    v_add_f32 v204, v212, v213
    v_add_f32 v208, v216, v217
    ds_write_addtid_b32 v223 offset:61440
    v_cvt_pk_bf16_f32 v224, v204, v208
    ds_write_b32 v249, v224 offset:4096
    v_mfma_f32_16x16x32_bf16 v[136:139], v[160:163], v[176:179], v[136:139]
    v_mfma_f32_16x16x32_bf16 v[132:135], v[164:167], v[176:179], v[132:135]
    v_lshlrev_b32 v204, 16, v67
    v_and_b32 v208, s25, v67
    s_waitcnt lgkmcnt(8)
    ds_write_addtid_b32 v67 offset:6144
    v_lshlrev_b32 v205, 16, v71
    v_and_b32 v209, s25, v71
    ds_write_addtid_b32 v71 offset:14336
    v_lshlrev_b32 v206, 16, v75
    v_and_b32 v210, s25, v75
    ds_write_addtid_b32 v75 offset:22528
    v_lshlrev_b32 v207, 16, v79
    v_and_b32 v211, s25, v79
    ds_write_addtid_b32 v79 offset:30720
    v_add_f32 v212, v204, v205
    v_add_f32 v216, v208, v209
    v_cvt_pk_bf16_f32 v225, v212, v216
    v_add_f32 v213, v206, v207
    v_add_f32 v217, v210, v211
    ds_write_addtid_b32 v225 offset:38912
    v_cvt_pk_bf16_f32 v226, v213, v217
    v_add_f32 v214, v204, v206
    v_add_f32 v218, v208, v210
    ds_write_addtid_b32 v226 offset:47104
    v_mfma_f32_16x16x32_bf16 v[140:143], v[160:163], v[180:183], v[140:143]
    v_mfma_f32_16x16x32_bf16 v[136:139], v[164:167], v[180:183], v[136:139]
    v_cvt_pk_bf16_f32 v227, v214, v218
    v_add_f32 v215, v205, v207
    v_add_f32 v219, v209, v211
    ds_write_addtid_b32 v227 offset:55296
    v_cvt_pk_bf16_f32 v228, v215, v219
    v_add_f32 v204, v212, v213
    v_add_f32 v208, v216, v217
    s_waitcnt lgkmcnt(8)
    ds_write_addtid_b32 v228 offset:63488
    v_cvt_pk_bf16_f32 v229, v204, v208
    ds_write_b32 v249, v229 offset:6144
    v_lshlrev_b32 v204, 16, v80
    v_and_b32 v208, s25, v80
    ds_write_addtid_b32 v80 offset:256
    v_lshlrev_b32 v205, 16, v84
    v_and_b32 v209, s25, v84
    ds_write_addtid_b32 v84 offset:8448
    v_lshlrev_b32 v206, 16, v88
    v_and_b32 v210, s25, v88
    ds_write_addtid_b32 v88 offset:16640
    v_lshlrev_b32 v207, 16, v92
    v_and_b32 v211, s25, v92
    ds_write_addtid_b32 v92 offset:24832
    v_mfma_f32_16x16x32_bf16 v[144:147], v[160:163], v[184:187], v[144:147]
    v_mfma_f32_16x16x32_bf16 v[140:143], v[164:167], v[184:187], v[140:143]
    v_add_f32 v212, v204, v205
    v_add_f32 v216, v208, v209
    v_cvt_pk_bf16_f32 v220, v212, v216
    v_add_f32 v213, v206, v207
    v_add_f32 v217, v210, v211
    ds_write_addtid_b32 v220 offset:33024
    v_cvt_pk_bf16_f32 v221, v213, v217
    v_add_f32 v214, v204, v206
    v_add_f32 v218, v208, v210
    s_waitcnt lgkmcnt(8)
    ds_write_addtid_b32 v221 offset:41216
    v_cvt_pk_bf16_f32 v222, v214, v218
    v_add_f32 v215, v205, v207
    v_add_f32 v219, v209, v211
    s_cmp_lt_i32 s28, 12
    s_cselect_b32 s24, 0, 2130706432
    buffer_load_dwordx4 v[16:19], v236, s[8:11], s24 offen offset:0
    buffer_load_dwordx4 v[48:51], v236, s[8:11], s24 offen offset:64
    v_add_u32 v236, 128, v236
    ds_write_addtid_b32 v222 offset:49408
    v_cvt_pk_bf16_f32 v223, v215, v219
    v_add_f32 v204, v212, v213
    v_add_f32 v208, v216, v217
    ds_write_addtid_b32 v223 offset:57600
    v_cvt_pk_bf16_f32 v224, v204, v208
    ds_write_b32 v249, v224 offset:256
    v_lshlrev_b32 v204, 16, v81
    v_and_b32 v208, s25, v81
    ds_write_addtid_b32 v81 offset:2304
    v_mfma_f32_16x16x32_bf16 v[148:151], v[160:163], v[188:191], v[148:151]
    v_mfma_f32_16x16x32_bf16 v[144:147], v[164:167], v[188:191], v[144:147]
    v_lshlrev_b32 v205, 16, v85
    v_and_b32 v209, s25, v85
    ds_write_addtid_b32 v85 offset:10496
    v_lshlrev_b32 v206, 16, v89
    v_and_b32 v210, s25, v89
    ds_write_addtid_b32 v89 offset:18688
    v_lshlrev_b32 v207, 16, v93
    v_and_b32 v211, s25, v93
    s_waitcnt lgkmcnt(8)
    ds_write_addtid_b32 v93 offset:26880
    v_add_f32 v212, v204, v205
    v_add_f32 v216, v208, v209
    v_cvt_pk_bf16_f32 v225, v212, v216
    v_add_f32 v213, v206, v207
    v_add_f32 v217, v210, v211
    ds_write_addtid_b32 v225 offset:35072
    v_cvt_pk_bf16_f32 v226, v213, v217
    v_add_f32 v214, v204, v206
    v_add_f32 v218, v208, v210
    ds_write_addtid_b32 v226 offset:43264
    v_cvt_pk_bf16_f32 v227, v214, v218
    v_add_f32 v215, v205, v207
    v_add_f32 v219, v209, v211
    v_mfma_f32_16x16x32_bf16 v[152:155], v[160:163], v[192:195], v[152:155]
    v_mfma_f32_16x16x32_bf16 v[148:151], v[164:167], v[192:195], v[148:151]
    ds_write_addtid_b32 v227 offset:51456
    v_cvt_pk_bf16_f32 v228, v215, v219
    v_add_f32 v204, v212, v213
    v_add_f32 v208, v216, v217
    ds_write_addtid_b32 v228 offset:59648
    v_cvt_pk_bf16_f32 v229, v204, v208
    ds_write_b32 v249, v229 offset:2304
    v_lshlrev_b32 v204, 16, v82
    v_and_b32 v208, s25, v82
    ds_write_addtid_b32 v82 offset:4352
    v_lshlrev_b32 v205, 16, v86
    v_and_b32 v209, s25, v86
    s_waitcnt lgkmcnt(8)
    ds_write_addtid_b32 v86 offset:12544
    v_lshlrev_b32 v206, 16, v90
    v_and_b32 v210, s25, v90
    ds_write_addtid_b32 v90 offset:20736
    v_lshlrev_b32 v207, 16, v94
    v_and_b32 v211, s25, v94
    ds_write_addtid_b32 v94 offset:28928
    buffer_load_dwordx4 v[20:23], v237, s[8:11], s24 offen offset:0
    buffer_load_dwordx4 v[52:55], v237, s[8:11], s24 offen offset:64
    v_add_u32 v237, 128, v237
    v_add_f32 v212, v204, v205
    v_add_f32 v216, v208, v209
    v_cvt_pk_bf16_f32 v220, v212, v216
    v_add_f32 v213, v206, v207
    v_mfma_f32_16x16x32_bf16 v[156:159], v[160:163], v[196:199], v[156:159]
    v_mfma_f32_16x16x32_bf16 v[152:155], v[164:167], v[196:199], v[152:155]
    v_add_f32 v217, v210, v211
    ds_write_addtid_b32 v220 offset:37120
    v_cvt_pk_bf16_f32 v221, v213, v217
    v_add_f32 v214, v204, v206
    v_add_f32 v218, v208, v210
    ds_write_addtid_b32 v221 offset:45312
    v_cvt_pk_bf16_f32 v222, v214, v218
    v_add_f32 v215, v205, v207
    v_add_f32 v219, v209, v211
    ds_write_addtid_b32 v222 offset:53504
    v_cvt_pk_bf16_f32 v223, v215, v219
    v_add_f32 v204, v212, v213
    v_add_f32 v208, v216, v217
    ds_write_addtid_b32 v223 offset:61696
    v_cvt_pk_bf16_f32 v224, v204, v208
    s_waitcnt lgkmcnt(8)
    ds_write_b32 v249, v224 offset:4352
    v_lshlrev_b32 v204, 16, v83
    v_and_b32 v208, s25, v83
    ds_write_addtid_b32 v83 offset:6400
    v_lshlrev_b32 v205, 16, v87
    v_and_b32 v209, s25, v87
    ds_write_addtid_b32 v87 offset:14592
    v_mfma_f32_16x16x32_bf16 v[156:159], v[164:167], v[200:203], v[156:159]
    buffer_load_dwordx4 v[160:163], v245, s[12:15], s23 offen offset:0
    buffer_load_dwordx4 v[164:167], v245, s[12:15], s23 offen offset:2048
    v_lshlrev_b32 v206, 16, v91
    v_and_b32 v210, s25, v91
    ds_write_addtid_b32 v91 offset:22784
    v_lshlrev_b32 v207, 16, v95
    v_and_b32 v211, s25, v95
    ds_write_addtid_b32 v95 offset:30976
    v_add_f32 v212, v204, v205
    v_add_f32 v216, v208, v209
    v_cvt_pk_bf16_f32 v225, v212, v216
    v_add_f32 v213, v206, v207
    v_add_f32 v217, v210, v211
    ds_write_addtid_b32 v225 offset:39168
    v_cvt_pk_bf16_f32 v226, v213, v217
    v_add_f32 v214, v204, v206
    v_add_f32 v218, v208, v210
    ds_write_addtid_b32 v226 offset:47360
    v_cvt_pk_bf16_f32 v227, v214, v218
    v_add_f32 v215, v205, v207
    v_add_f32 v219, v209, v211
    s_waitcnt lgkmcnt(8)
    ds_write_addtid_b32 v227 offset:55552
    v_cvt_pk_bf16_f32 v228, v215, v219
    v_add_f32 v204, v212, v213
    v_add_f32 v208, v216, v217
    ds_write_addtid_b32 v228 offset:63744
    v_cvt_pk_bf16_f32 v229, v204, v208
    ds_write_b32 v249, v229 offset:6400
    s_add_u32 s23, s23, 73728
    s_add_u32 s28, s28, 1
    s_waitcnt lgkmcnt(0)
    s_barrier
    s_mov_b32 m0, s27
    ds_read_b128 v[168:171], v240 offset:0
    ds_read_b128 v[172:175], v240 offset:256
    ds_read_b128 v[176:179], v240 offset:512
    ds_read_b128 v[180:183], v240 offset:768
    ds_read_b128 v[184:187], v240 offset:1024
    ds_read_b128 v[188:191], v240 offset:1280
    ds_read_b128 v[192:195], v241 offset:0
    ds_read_b128 v[196:199], v241 offset:256
    ds_read_b128 v[200:203], v240 offset:16
    v_lshlrev_b32 v204, 16, v96
    v_and_b32 v208, s25, v96
    ds_write_addtid_b32 v96 offset:1540
    v_lshlrev_b32 v205, 16, v100
    v_and_b32 v209, s25, v100
    ds_write_addtid_b32 v100 offset:9732
    v_lshlrev_b32 v206, 16, v104
    v_and_b32 v210, s25, v104
    ds_write_addtid_b32 v104 offset:17924
    v_lshlrev_b32 v207, 16, v108
    v_and_b32 v211, s25, v108
    ds_write_addtid_b32 v108 offset:26116
    v_add_f32 v212, v204, v205
    v_add_f32 v216, v208, v209
    v_cvt_pk_bf16_f32 v220, v212, v216
    v_add_f32 v213, v206, v207
    v_add_f32 v217, v210, v211
    ds_write_addtid_b32 v220 offset:34308
    v_cvt_pk_bf16_f32 v221, v213, v217
    v_add_f32 v214, v204, v206
    v_add_f32 v218, v208, v210
    ds_write_addtid_b32 v221 offset:42500
    v_cvt_pk_bf16_f32 v222, v214, v218
    v_add_f32 v215, v205, v207
    v_add_f32 v219, v209, v211
    s_waitcnt lgkmcnt(8)
    ds_write_addtid_b32 v222 offset:50692
    v_cvt_pk_bf16_f32 v223, v215, v219
    v_add_f32 v204, v212, v213
    v_add_f32 v208, v216, v217
    ds_write_addtid_b32 v223 offset:58884
    v_cvt_pk_bf16_f32 v224, v204, v208
    ds_write_b32 v249, v224 offset:8192
    v_lshlrev_b32 v204, 16, v97
    v_and_b32 v208, s25, v97
    ds_write_addtid_b32 v97 offset:3588
    v_lshlrev_b32 v205, 16, v101
    v_and_b32 v209, s25, v101
    ds_write_addtid_b32 v101 offset:11780
    s_cmp_lt_i32 s28, 13
    s_cselect_b32 s24, 0, 2130706432
    buffer_load_dwordx4 v[24:27], v238, s[8:11], s24 offen offset:0
    buffer_load_dwordx4 v[56:59], v238, s[8:11], s24 offen offset:64
    v_add_u32 v238, 128, v238
    v_lshlrev_b32 v206, 16, v105
    v_and_b32 v210, s25, v105
    ds_write_addtid_b32 v105 offset:19972
    v_lshlrev_b32 v207, 16, v109
    v_and_b32 v211, s25, v109
    ds_write_addtid_b32 v109 offset:28164
    v_add_f32 v212, v204, v205
    v_add_f32 v216, v208, v209
    v_cvt_pk_bf16_f32 v225, v212, v216
    v_add_f32 v213, v206, v207
    v_add_f32 v217, v210, v211
    s_waitcnt lgkmcnt(8)
    ds_write_addtid_b32 v225 offset:36356
    v_cvt_pk_bf16_f32 v226, v213, v217
    s_waitcnt vmcnt(2)
    v_mfma_f32_16x16x32_bf16 v[128:131], v[160:163], v[168:171], v[128:131]
    v_add_f32 v214, v204, v206
    v_add_f32 v218, v208, v210
    ds_write_addtid_b32 v226 offset:44548
    v_cvt_pk_bf16_f32 v227, v214, v218
    v_add_f32 v215, v205, v207
    v_add_f32 v219, v209, v211
    ds_write_addtid_b32 v227 offset:52740
    v_cvt_pk_bf16_f32 v228, v215, v219
    v_add_f32 v204, v212, v213
    v_add_f32 v208, v216, v217
    ds_write_addtid_b32 v228 offset:60932
    v_cvt_pk_bf16_f32 v229, v204, v208
    ds_write_b32 v249, v229 offset:10240
    v_lshlrev_b32 v204, 16, v98
    v_and_b32 v208, s25, v98
    ds_write_addtid_b32 v98 offset:5636
    v_lshlrev_b32 v205, 16, v102
    v_and_b32 v209, s25, v102
    ds_write_addtid_b32 v102 offset:13828
    v_lshlrev_b32 v206, 16, v106
    v_and_b32 v210, s25, v106
    s_waitcnt lgkmcnt(8)
    ds_write_addtid_b32 v106 offset:22020
    v_mfma_f32_16x16x32_bf16 v[132:135], v[160:163], v[172:175], v[132:135]
    v_mfma_f32_16x16x32_bf16 v[128:131], v[164:167], v[172:175], v[128:131]
    v_lshlrev_b32 v207, 16, v110
    v_and_b32 v211, s25, v110
    ds_write_addtid_b32 v110 offset:30212
    v_add_f32 v212, v204, v205
    v_add_f32 v216, v208, v209
    v_cvt_pk_bf16_f32 v220, v212, v216
    v_add_f32 v213, v206, v207
    v_add_f32 v217, v210, v211
    ds_write_addtid_b32 v220 offset:38404
    v_cvt_pk_bf16_f32 v221, v213, v217
    v_add_f32 v214, v204, v206
    v_add_f32 v218, v208, v210
    ds_write_addtid_b32 v221 offset:46596
    v_cvt_pk_bf16_f32 v222, v214, v218
    v_add_f32 v215, v205, v207
    v_add_f32 v219, v209, v211
    buffer_load_dwordx4 v[28:31], v239, s[8:11], s24 offen offset:0
    buffer_load_dwordx4 v[60:63], v239, s[8:11], s24 offen offset:64
    v_add_u32 v239, 128, v239
    ds_write_addtid_b32 v222 offset:54788
    v_cvt_pk_bf16_f32 v223, v215, v219
    v_add_f32 v204, v212, v213
    v_add_f32 v208, v216, v217
    ds_write_addtid_b32 v223 offset:62980
    v_cvt_pk_bf16_f32 v224, v204, v208
    ds_write_b32 v249, v224 offset:12288
    v_mfma_f32_16x16x32_bf16 v[136:139], v[160:163], v[176:179], v[136:139]
    v_mfma_f32_16x16x32_bf16 v[132:135], v[164:167], v[176:179], v[132:135]
    v_lshlrev_b32 v204, 16, v99
    v_and_b32 v208, s25, v99
    s_waitcnt lgkmcnt(8)
    ds_write_addtid_b32 v99 offset:7684
    v_lshlrev_b32 v205, 16, v103
    v_and_b32 v209, s25, v103
    ds_write_addtid_b32 v103 offset:15876
    v_lshlrev_b32 v206, 16, v107
    v_and_b32 v210, s25, v107
    ds_write_addtid_b32 v107 offset:24068
    v_lshlrev_b32 v207, 16, v111
    v_and_b32 v211, s25, v111
    ds_write_addtid_b32 v111 offset:32260
    v_add_f32 v212, v204, v205
    v_add_f32 v216, v208, v209
    v_cvt_pk_bf16_f32 v225, v212, v216
    v_add_f32 v213, v206, v207
    v_add_f32 v217, v210, v211
    ds_write_addtid_b32 v225 offset:40452
    v_cvt_pk_bf16_f32 v226, v213, v217
    v_add_f32 v214, v204, v206
    v_add_f32 v218, v208, v210
    ds_write_addtid_b32 v226 offset:48644
    v_mfma_f32_16x16x32_bf16 v[140:143], v[160:163], v[180:183], v[140:143]
    v_mfma_f32_16x16x32_bf16 v[136:139], v[164:167], v[180:183], v[136:139]
    v_cvt_pk_bf16_f32 v227, v214, v218
    v_add_f32 v215, v205, v207
    v_add_f32 v219, v209, v211
    ds_write_addtid_b32 v227 offset:56836
    v_cvt_pk_bf16_f32 v228, v215, v219
    v_add_f32 v204, v212, v213
    v_add_f32 v208, v216, v217
    s_waitcnt lgkmcnt(8)
    ds_write_addtid_b32 v228 offset:65028
    v_cvt_pk_bf16_f32 v229, v204, v208
    ds_write_b32 v249, v229 offset:14336
    v_lshlrev_b32 v204, 16, v112
    v_and_b32 v208, s25, v112
    ds_write_addtid_b32 v112 offset:1796
    v_lshlrev_b32 v205, 16, v116
    v_and_b32 v209, s25, v116
    ds_write_addtid_b32 v116 offset:9988
    v_lshlrev_b32 v206, 16, v120
    v_and_b32 v210, s25, v120
    ds_write_addtid_b32 v120 offset:18180
    v_lshlrev_b32 v207, 16, v124
    v_and_b32 v211, s25, v124
    ds_write_addtid_b32 v124 offset:26372
    v_mfma_f32_16x16x32_bf16 v[144:147], v[160:163], v[184:187], v[144:147]
    v_mfma_f32_16x16x32_bf16 v[140:143], v[164:167], v[184:187], v[140:143]
    v_add_f32 v212, v204, v205
    v_add_f32 v216, v208, v209
    v_cvt_pk_bf16_f32 v220, v212, v216
    v_add_f32 v213, v206, v207
    v_add_f32 v217, v210, v211
    ds_write_addtid_b32 v220 offset:34564
    v_cvt_pk_bf16_f32 v221, v213, v217
    v_add_f32 v214, v204, v206
    v_add_f32 v218, v208, v210
    s_waitcnt lgkmcnt(8)
    ds_write_addtid_b32 v221 offset:42756
    v_cvt_pk_bf16_f32 v222, v214, v218
    v_add_f32 v215, v205, v207
    v_add_f32 v219, v209, v211
    s_cmp_lt_i32 s28, 12
    s_cselect_b32 s24, 0, 2130706432
    buffer_load_dwordx4 v[64:67], v232, s[8:11], s24 offen offset:0
    buffer_load_dwordx4 v[96:99], v232, s[8:11], s24 offen offset:64
    v_add_u32 v232, 128, v232
    ds_write_addtid_b32 v222 offset:50948
    v_cvt_pk_bf16_f32 v223, v215, v219
    v_add_f32 v204, v212, v213
    v_add_f32 v208, v216, v217
    ds_write_addtid_b32 v223 offset:59140
    v_cvt_pk_bf16_f32 v224, v204, v208
    ds_write_b32 v249, v224 offset:8448
    v_lshlrev_b32 v204, 16, v113
    v_and_b32 v208, s25, v113
    ds_write_addtid_b32 v113 offset:3844
    v_mfma_f32_16x16x32_bf16 v[148:151], v[160:163], v[188:191], v[148:151]
    v_mfma_f32_16x16x32_bf16 v[144:147], v[164:167], v[188:191], v[144:147]
    v_lshlrev_b32 v205, 16, v117
    v_and_b32 v209, s25, v117
    ds_write_addtid_b32 v117 offset:12036
    v_lshlrev_b32 v206, 16, v121
    v_and_b32 v210, s25, v121
    ds_write_addtid_b32 v121 offset:20228
    v_lshlrev_b32 v207, 16, v125
    v_and_b32 v211, s25, v125
    s_waitcnt lgkmcnt(8)
    ds_write_addtid_b32 v125 offset:28420
    v_add_f32 v212, v204, v205
    v_add_f32 v216, v208, v209
    v_cvt_pk_bf16_f32 v225, v212, v216
    v_add_f32 v213, v206, v207
    v_add_f32 v217, v210, v211
    ds_write_addtid_b32 v225 offset:36612
    v_cvt_pk_bf16_f32 v226, v213, v217
    v_add_f32 v214, v204, v206
    v_add_f32 v218, v208, v210
    ds_write_addtid_b32 v226 offset:44804
    v_cvt_pk_bf16_f32 v227, v214, v218
    v_add_f32 v215, v205, v207
    v_add_f32 v219, v209, v211
    v_mfma_f32_16x16x32_bf16 v[152:155], v[160:163], v[192:195], v[152:155]
    v_mfma_f32_16x16x32_bf16 v[148:151], v[164:167], v[192:195], v[148:151]
    ds_write_addtid_b32 v227 offset:52996
    v_cvt_pk_bf16_f32 v228, v215, v219
    v_add_f32 v204, v212, v213
    v_add_f32 v208, v216, v217
    ds_write_addtid_b32 v228 offset:61188
    v_cvt_pk_bf16_f32 v229, v204, v208
    ds_write_b32 v249, v229 offset:10496
    v_lshlrev_b32 v204, 16, v114
    v_and_b32 v208, s25, v114
    ds_write_addtid_b32 v114 offset:5892
    v_lshlrev_b32 v205, 16, v118
    v_and_b32 v209, s25, v118
    s_waitcnt lgkmcnt(8)
    ds_write_addtid_b32 v118 offset:14084
    v_lshlrev_b32 v206, 16, v122
    v_and_b32 v210, s25, v122
    ds_write_addtid_b32 v122 offset:22276
    v_lshlrev_b32 v207, 16, v126
    v_and_b32 v211, s25, v126
    ds_write_addtid_b32 v126 offset:30468
    buffer_load_dwordx4 v[68:71], v233, s[8:11], s24 offen offset:0
    buffer_load_dwordx4 v[100:103], v233, s[8:11], s24 offen offset:64
    v_add_u32 v233, 128, v233
    v_add_f32 v212, v204, v205
    v_add_f32 v216, v208, v209
    v_cvt_pk_bf16_f32 v220, v212, v216
    v_add_f32 v213, v206, v207
    v_mfma_f32_16x16x32_bf16 v[156:159], v[160:163], v[196:199], v[156:159]
    v_mfma_f32_16x16x32_bf16 v[152:155], v[164:167], v[196:199], v[152:155]
    v_add_f32 v217, v210, v211
    ds_write_addtid_b32 v220 offset:38660
    v_cvt_pk_bf16_f32 v221, v213, v217
    v_add_f32 v214, v204, v206
    v_add_f32 v218, v208, v210
    ds_write_addtid_b32 v221 offset:46852
    v_cvt_pk_bf16_f32 v222, v214, v218
    v_add_f32 v215, v205, v207
    v_add_f32 v219, v209, v211
    ds_write_addtid_b32 v222 offset:55044
    v_cvt_pk_bf16_f32 v223, v215, v219
    v_add_f32 v204, v212, v213
    v_add_f32 v208, v216, v217
    ds_write_addtid_b32 v223 offset:63236
    v_cvt_pk_bf16_f32 v224, v204, v208
    s_waitcnt lgkmcnt(8)
    ds_write_b32 v249, v224 offset:12544
    v_lshlrev_b32 v204, 16, v115
    v_and_b32 v208, s25, v115
    ds_write_addtid_b32 v115 offset:7940
    v_lshlrev_b32 v205, 16, v119
    v_and_b32 v209, s25, v119
    ds_write_addtid_b32 v119 offset:16132
    v_mfma_f32_16x16x32_bf16 v[156:159], v[164:167], v[200:203], v[156:159]
    buffer_load_dwordx4 v[160:163], v245, s[12:15], s23 offen offset:0
    buffer_load_dwordx4 v[164:167], v245, s[12:15], s23 offen offset:2048
    v_lshlrev_b32 v206, 16, v123
    v_and_b32 v210, s25, v123
    ds_write_addtid_b32 v123 offset:24324
    v_lshlrev_b32 v207, 16, v127
    v_and_b32 v211, s25, v127
    ds_write_addtid_b32 v127 offset:32516
    v_add_f32 v212, v204, v205
    v_add_f32 v216, v208, v209
    v_cvt_pk_bf16_f32 v225, v212, v216
    v_add_f32 v213, v206, v207
    v_add_f32 v217, v210, v211
    ds_write_addtid_b32 v225 offset:40708
    v_cvt_pk_bf16_f32 v226, v213, v217
    v_add_f32 v214, v204, v206
    v_add_f32 v218, v208, v210
    ds_write_addtid_b32 v226 offset:48900
    v_cvt_pk_bf16_f32 v227, v214, v218
    v_add_f32 v215, v205, v207
    v_add_f32 v219, v209, v211
    s_waitcnt lgkmcnt(8)
    ds_write_addtid_b32 v227 offset:57092
    v_cvt_pk_bf16_f32 v228, v215, v219
    v_add_f32 v204, v212, v213
    v_add_f32 v208, v216, v217
    ds_write_addtid_b32 v228 offset:65284
    v_cvt_pk_bf16_f32 v229, v204, v208
    ds_write_b32 v249, v229 offset:14592
    s_add_u32 s23, s23, 73728
    s_add_u32 s28, s28, 1
    s_waitcnt lgkmcnt(0)
    s_barrier
    s_mov_b32 m0, s26
    ds_read_b128 v[168:171], v240 offset:8192
    ds_read_b128 v[172:175], v240 offset:8448
    ds_read_b128 v[176:179], v240 offset:8704
    ds_read_b128 v[180:183], v240 offset:8960
    ds_read_b128 v[184:187], v240 offset:9216
    ds_read_b128 v[188:191], v240 offset:9472
    ds_read_b128 v[192:195], v241 offset:8192
    ds_read_b128 v[196:199], v241 offset:8448
    ds_read_b128 v[200:203], v240 offset:8208
    v_lshlrev_b32 v204, 16, v0
    v_and_b32 v208, s25, v0
    ds_write_addtid_b32 v0 offset:0
    v_lshlrev_b32 v205, 16, v4
    v_and_b32 v209, s25, v4
    ds_write_addtid_b32 v4 offset:8192
    v_lshlrev_b32 v206, 16, v8
    v_and_b32 v210, s25, v8
    ds_write_addtid_b32 v8 offset:16384
    v_lshlrev_b32 v207, 16, v12
    v_and_b32 v211, s25, v12
    ds_write_addtid_b32 v12 offset:24576
    v_add_f32 v212, v204, v205
    v_add_f32 v216, v208, v209
    v_cvt_pk_bf16_f32 v220, v212, v216
    v_add_f32 v213, v206, v207
    v_add_f32 v217, v210, v211
    ds_write_addtid_b32 v220 offset:32768
    v_cvt_pk_bf16_f32 v221, v213, v217
    v_add_f32 v214, v204, v206
    v_add_f32 v218, v208, v210
    ds_write_addtid_b32 v221 offset:40960
    v_cvt_pk_bf16_f32 v222, v214, v218
    v_add_f32 v215, v205, v207
    v_add_f32 v219, v209, v211
    s_waitcnt lgkmcnt(8)
    ds_write_addtid_b32 v222 offset:49152
    v_cvt_pk_bf16_f32 v223, v215, v219
    v_add_f32 v204, v212, v213
    v_add_f32 v208, v216, v217
    ds_write_addtid_b32 v223 offset:57344
    v_cvt_pk_bf16_f32 v224, v204, v208
    ds_write_b32 v249, v224 offset:0
    v_lshlrev_b32 v204, 16, v1
    v_and_b32 v208, s25, v1
    ds_write_addtid_b32 v1 offset:2048
    v_lshlrev_b32 v205, 16, v5
    v_and_b32 v209, s25, v5
    ds_write_addtid_b32 v5 offset:10240
    s_cmp_lt_i32 s28, 13
    s_cselect_b32 s24, 0, 2130706432
    buffer_load_dwordx4 v[72:75], v234, s[8:11], s24 offen offset:0
    buffer_load_dwordx4 v[104:107], v234, s[8:11], s24 offen offset:64
    v_add_u32 v234, 128, v234
    v_lshlrev_b32 v206, 16, v9
    v_and_b32 v210, s25, v9
    ds_write_addtid_b32 v9 offset:18432
    v_lshlrev_b32 v207, 16, v13
    v_and_b32 v211, s25, v13
    ds_write_addtid_b32 v13 offset:26624
    v_add_f32 v212, v204, v205
    v_add_f32 v216, v208, v209
    v_cvt_pk_bf16_f32 v225, v212, v216
    v_add_f32 v213, v206, v207
    v_add_f32 v217, v210, v211
    s_waitcnt lgkmcnt(8)
    ds_write_addtid_b32 v225 offset:34816
    v_cvt_pk_bf16_f32 v226, v213, v217
    s_waitcnt vmcnt(2)
    v_mfma_f32_16x16x32_bf16 v[128:131], v[160:163], v[168:171], v[128:131]
    v_add_f32 v214, v204, v206
    v_add_f32 v218, v208, v210
    ds_write_addtid_b32 v226 offset:43008
    v_cvt_pk_bf16_f32 v227, v214, v218
    v_add_f32 v215, v205, v207
    v_add_f32 v219, v209, v211
    ds_write_addtid_b32 v227 offset:51200
    v_cvt_pk_bf16_f32 v228, v215, v219
    v_add_f32 v204, v212, v213
    v_add_f32 v208, v216, v217
    ds_write_addtid_b32 v228 offset:59392
    v_cvt_pk_bf16_f32 v229, v204, v208
    ds_write_b32 v249, v229 offset:2048
    v_lshlrev_b32 v204, 16, v2
    v_and_b32 v208, s25, v2
    ds_write_addtid_b32 v2 offset:4096
    v_lshlrev_b32 v205, 16, v6
    v_and_b32 v209, s25, v6
    ds_write_addtid_b32 v6 offset:12288
    v_lshlrev_b32 v206, 16, v10
    v_and_b32 v210, s25, v10
    s_waitcnt lgkmcnt(8)
    ds_write_addtid_b32 v10 offset:20480
    v_mfma_f32_16x16x32_bf16 v[132:135], v[160:163], v[172:175], v[132:135]
    v_mfma_f32_16x16x32_bf16 v[128:131], v[164:167], v[172:175], v[128:131]
    v_lshlrev_b32 v207, 16, v14
    v_and_b32 v211, s25, v14
    ds_write_addtid_b32 v14 offset:28672
    v_add_f32 v212, v204, v205
    v_add_f32 v216, v208, v209
    v_cvt_pk_bf16_f32 v220, v212, v216
    v_add_f32 v213, v206, v207
    v_add_f32 v217, v210, v211
    ds_write_addtid_b32 v220 offset:36864
    v_cvt_pk_bf16_f32 v221, v213, v217
    v_add_f32 v214, v204, v206
    v_add_f32 v218, v208, v210
    ds_write_addtid_b32 v221 offset:45056
    v_cvt_pk_bf16_f32 v222, v214, v218
    v_add_f32 v215, v205, v207
    v_add_f32 v219, v209, v211
    buffer_load_dwordx4 v[76:79], v235, s[8:11], s24 offen offset:0
    buffer_load_dwordx4 v[108:111], v235, s[8:11], s24 offen offset:64
    v_add_u32 v235, 128, v235
    ds_write_addtid_b32 v222 offset:53248
    v_cvt_pk_bf16_f32 v223, v215, v219
    v_add_f32 v204, v212, v213
    v_add_f32 v208, v216, v217
    ds_write_addtid_b32 v223 offset:61440
    v_cvt_pk_bf16_f32 v224, v204, v208
    ds_write_b32 v249, v224 offset:4096
    v_mfma_f32_16x16x32_bf16 v[136:139], v[160:163], v[176:179], v[136:139]
    v_mfma_f32_16x16x32_bf16 v[132:135], v[164:167], v[176:179], v[132:135]
    v_lshlrev_b32 v204, 16, v3
    v_and_b32 v208, s25, v3
    s_waitcnt lgkmcnt(8)
    ds_write_addtid_b32 v3 offset:6144
    v_lshlrev_b32 v205, 16, v7
    v_and_b32 v209, s25, v7
    ds_write_addtid_b32 v7 offset:14336
    v_lshlrev_b32 v206, 16, v11
    v_and_b32 v210, s25, v11
    ds_write_addtid_b32 v11 offset:22528
    v_lshlrev_b32 v207, 16, v15
    v_and_b32 v211, s25, v15
    ds_write_addtid_b32 v15 offset:30720
    v_add_f32 v212, v204, v205
    v_add_f32 v216, v208, v209
    v_cvt_pk_bf16_f32 v225, v212, v216
    v_add_f32 v213, v206, v207
    v_add_f32 v217, v210, v211
    ds_write_addtid_b32 v225 offset:38912
    v_cvt_pk_bf16_f32 v226, v213, v217
    v_add_f32 v214, v204, v206
    v_add_f32 v218, v208, v210
    ds_write_addtid_b32 v226 offset:47104
    v_mfma_f32_16x16x32_bf16 v[140:143], v[160:163], v[180:183], v[140:143]
    v_mfma_f32_16x16x32_bf16 v[136:139], v[164:167], v[180:183], v[136:139]
    v_cvt_pk_bf16_f32 v227, v214, v218
    v_add_f32 v215, v205, v207
    v_add_f32 v219, v209, v211
    ds_write_addtid_b32 v227 offset:55296
    v_cvt_pk_bf16_f32 v228, v215, v219
    v_add_f32 v204, v212, v213
    v_add_f32 v208, v216, v217
    s_waitcnt lgkmcnt(8)
    ds_write_addtid_b32 v228 offset:63488
    v_cvt_pk_bf16_f32 v229, v204, v208
    ds_write_b32 v249, v229 offset:6144
    v_lshlrev_b32 v204, 16, v16
    v_and_b32 v208, s25, v16
    ds_write_addtid_b32 v16 offset:256
    v_lshlrev_b32 v205, 16, v20
    v_and_b32 v209, s25, v20
    ds_write_addtid_b32 v20 offset:8448
    v_lshlrev_b32 v206, 16, v24
    v_and_b32 v210, s25, v24
    ds_write_addtid_b32 v24 offset:16640
    v_lshlrev_b32 v207, 16, v28
    v_and_b32 v211, s25, v28
    ds_write_addtid_b32 v28 offset:24832
    v_mfma_f32_16x16x32_bf16 v[144:147], v[160:163], v[184:187], v[144:147]
    v_mfma_f32_16x16x32_bf16 v[140:143], v[164:167], v[184:187], v[140:143]
    v_add_f32 v212, v204, v205
    v_add_f32 v216, v208, v209
    v_cvt_pk_bf16_f32 v220, v212, v216
    v_add_f32 v213, v206, v207
    v_add_f32 v217, v210, v211
    ds_write_addtid_b32 v220 offset:33024
    v_cvt_pk_bf16_f32 v221, v213, v217
    v_add_f32 v214, v204, v206
    v_add_f32 v218, v208, v210
    s_waitcnt lgkmcnt(8)
    ds_write_addtid_b32 v221 offset:41216
    v_cvt_pk_bf16_f32 v222, v214, v218
    v_add_f32 v215, v205, v207
    v_add_f32 v219, v209, v211
    s_cmp_lt_i32 s28, 12
    s_cselect_b32 s24, 0, 2130706432
    buffer_load_dwordx4 v[80:83], v236, s[8:11], s24 offen offset:0
    buffer_load_dwordx4 v[112:115], v236, s[8:11], s24 offen offset:64
    v_add_u32 v236, 128, v236
    ds_write_addtid_b32 v222 offset:49408
    v_cvt_pk_bf16_f32 v223, v215, v219
    v_add_f32 v204, v212, v213
    v_add_f32 v208, v216, v217
    ds_write_addtid_b32 v223 offset:57600
    v_cvt_pk_bf16_f32 v224, v204, v208
    ds_write_b32 v249, v224 offset:256
    v_lshlrev_b32 v204, 16, v17
    v_and_b32 v208, s25, v17
    ds_write_addtid_b32 v17 offset:2304
    v_mfma_f32_16x16x32_bf16 v[148:151], v[160:163], v[188:191], v[148:151]
    v_mfma_f32_16x16x32_bf16 v[144:147], v[164:167], v[188:191], v[144:147]
    v_lshlrev_b32 v205, 16, v21
    v_and_b32 v209, s25, v21
    ds_write_addtid_b32 v21 offset:10496
    v_lshlrev_b32 v206, 16, v25
    v_and_b32 v210, s25, v25
    ds_write_addtid_b32 v25 offset:18688
    v_lshlrev_b32 v207, 16, v29
    v_and_b32 v211, s25, v29
    s_waitcnt lgkmcnt(8)
    ds_write_addtid_b32 v29 offset:26880
    v_add_f32 v212, v204, v205
    v_add_f32 v216, v208, v209
    v_cvt_pk_bf16_f32 v225, v212, v216
    v_add_f32 v213, v206, v207
    v_add_f32 v217, v210, v211
    ds_write_addtid_b32 v225 offset:35072
    v_cvt_pk_bf16_f32 v226, v213, v217
    v_add_f32 v214, v204, v206
    v_add_f32 v218, v208, v210
    ds_write_addtid_b32 v226 offset:43264
    v_cvt_pk_bf16_f32 v227, v214, v218
    v_add_f32 v215, v205, v207
    v_add_f32 v219, v209, v211
    v_mfma_f32_16x16x32_bf16 v[152:155], v[160:163], v[192:195], v[152:155]
    v_mfma_f32_16x16x32_bf16 v[148:151], v[164:167], v[192:195], v[148:151]
    ds_write_addtid_b32 v227 offset:51456
    v_cvt_pk_bf16_f32 v228, v215, v219
    v_add_f32 v204, v212, v213
    v_add_f32 v208, v216, v217
    ds_write_addtid_b32 v228 offset:59648
    v_cvt_pk_bf16_f32 v229, v204, v208
    ds_write_b32 v249, v229 offset:2304
    v_lshlrev_b32 v204, 16, v18
    v_and_b32 v208, s25, v18
    ds_write_addtid_b32 v18 offset:4352
    v_lshlrev_b32 v205, 16, v22
    v_and_b32 v209, s25, v22
    s_waitcnt lgkmcnt(8)
    ds_write_addtid_b32 v22 offset:12544
    v_lshlrev_b32 v206, 16, v26
    v_and_b32 v210, s25, v26
    ds_write_addtid_b32 v26 offset:20736
    v_lshlrev_b32 v207, 16, v30
    v_and_b32 v211, s25, v30
    ds_write_addtid_b32 v30 offset:28928
    buffer_load_dwordx4 v[84:87], v237, s[8:11], s24 offen offset:0
    buffer_load_dwordx4 v[116:119], v237, s[8:11], s24 offen offset:64
    v_add_u32 v237, 128, v237
    v_add_f32 v212, v204, v205
    v_add_f32 v216, v208, v209
    v_cvt_pk_bf16_f32 v220, v212, v216
    v_add_f32 v213, v206, v207
    v_mfma_f32_16x16x32_bf16 v[156:159], v[160:163], v[196:199], v[156:159]
    v_mfma_f32_16x16x32_bf16 v[152:155], v[164:167], v[196:199], v[152:155]
    v_add_f32 v217, v210, v211
    ds_write_addtid_b32 v220 offset:37120
    v_cvt_pk_bf16_f32 v221, v213, v217
    v_add_f32 v214, v204, v206
    v_add_f32 v218, v208, v210
    ds_write_addtid_b32 v221 offset:45312
    v_cvt_pk_bf16_f32 v222, v214, v218
    v_add_f32 v215, v205, v207
    v_add_f32 v219, v209, v211
    ds_write_addtid_b32 v222 offset:53504
    v_cvt_pk_bf16_f32 v223, v215, v219
    v_add_f32 v204, v212, v213
    v_add_f32 v208, v216, v217
    ds_write_addtid_b32 v223 offset:61696
    v_cvt_pk_bf16_f32 v224, v204, v208
    s_waitcnt lgkmcnt(8)
    ds_write_b32 v249, v224 offset:4352
    v_lshlrev_b32 v204, 16, v19
    v_and_b32 v208, s25, v19
    ds_write_addtid_b32 v19 offset:6400
    v_lshlrev_b32 v205, 16, v23
    v_and_b32 v209, s25, v23
    ds_write_addtid_b32 v23 offset:14592
    v_mfma_f32_16x16x32_bf16 v[156:159], v[164:167], v[200:203], v[156:159]
    buffer_load_dwordx4 v[160:163], v245, s[12:15], s23 offen offset:0
    buffer_load_dwordx4 v[164:167], v245, s[12:15], s23 offen offset:2048
    v_lshlrev_b32 v206, 16, v27
    v_and_b32 v210, s25, v27
    ds_write_addtid_b32 v27 offset:22784
    v_lshlrev_b32 v207, 16, v31
    v_and_b32 v211, s25, v31
    ds_write_addtid_b32 v31 offset:30976
    v_add_f32 v212, v204, v205
    v_add_f32 v216, v208, v209
    v_cvt_pk_bf16_f32 v225, v212, v216
    v_add_f32 v213, v206, v207
    v_add_f32 v217, v210, v211
    ds_write_addtid_b32 v225 offset:39168
    v_cvt_pk_bf16_f32 v226, v213, v217
    v_add_f32 v214, v204, v206
    v_add_f32 v218, v208, v210
    ds_write_addtid_b32 v226 offset:47360
    v_cvt_pk_bf16_f32 v227, v214, v218
    v_add_f32 v215, v205, v207
    v_add_f32 v219, v209, v211
    s_waitcnt lgkmcnt(8)
    ds_write_addtid_b32 v227 offset:55552
    v_cvt_pk_bf16_f32 v228, v215, v219
    v_add_f32 v204, v212, v213
    v_add_f32 v208, v216, v217
    ds_write_addtid_b32 v228 offset:63744
    v_cvt_pk_bf16_f32 v229, v204, v208
    ds_write_b32 v249, v229 offset:6400
    s_add_u32 s23, s23, 73728
    s_add_u32 s28, s28, 1
    s_waitcnt lgkmcnt(0)
    s_barrier
    s_sub_u32 s22, s22, 1
    s_cmp_lg_u32 s22, 0
    s_cbranch_scc1 L_conv1_kernel_hloop
    s_setprio 0
    s_nop 7
    s_waitcnt vmcnt(0)
    ds_write_b128 v244, v[128:131] offset:0
    ds_write_b128 v244, v[132:135] offset:1024
    ds_write_b128 v244, v[136:139] offset:2048
    ds_write_b128 v244, v[140:143] offset:3072
    ds_write_b128 v244, v[144:147] offset:4096
    ds_write_b128 v244, v[148:151] offset:5120
    ds_write_b128 v244, v[152:155] offset:6144
    ds_write_b128 v244, v[156:159] offset:7168
L_conv1_kernel_epi:
    s_lshl_b32 s36, s20, 10
    v_lshl_add_u32 v236, v255, 4, s36
    v_add_u32 v237, 65536, v236
    v_add_u32 v238, 131072, v236
    s_add_u32 s36, s36, 1024
    s_cmp_eq_u32 s20, 7
    s_cselect_b32 s36, 16, s36
    v_lshl_add_u32 v239, v255, 4, s36
    v_add_u32 v240, 65536, v239
    v_and_b32 v242, 15, v255
    v_lshlrev_b32 v242, 3, v242
    v_add_u32 v242, s20, v242
    v_lshl_add_u32 v243, v242, 2, s21
    v_lshlrev_b32 v243, 9, v243
    v_lshrrev_b32 v245, 4, v255
    v_lshl_add_u32 v243, v245, 4, v243
    s_lshl_b32 s36, s29, 6
    v_add_u32 v243, s36, v243
    v_mov_b32 v245, 2130706432
    v_cmp_gt_u32 vcc, 125, v242
    s_waitcnt lgkmcnt(0)
    s_barrier
    v_cndmask_b32 v241, v245, v243, vcc
    ds_read_b128 v[0:3], v236 offset:0
    ds_read_b128 v[4:7], v236 offset:16384
    ds_read_b128 v[8:11], v236 offset:32768
    ds_read_b128 v[12:15], v236 offset:49152
    ds_read_b128 v[16:19], v237 offset:0
    ds_read_b128 v[20:23], v237 offset:16384
    ds_read_b128 v[24:27], v237 offset:32768
    ds_read_b128 v[28:31], v237 offset:49152
    ds_read_b128 v[32:35], v238 offset:0
    ds_read_b128 v[36:39], v238 offset:16384
    ds_read_b128 v[40:43], v239 offset:0
    ds_read_b128 v[44:47], v239 offset:16384
    ds_read_b128 v[48:51], v239 offset:32768
    ds_read_b128 v[52:55], v240 offset:0
    ds_read_b128 v[56:59], v240 offset:32768
    s_waitcnt lgkmcnt(0)
    ds_read_b128 v[60:63], v236 offset:8192
    ds_read_b128 v[64:67], v236 offset:24576
    ds_read_b128 v[68:71], v236 offset:40960
    ds_read_b128 v[72:75], v236 offset:57344
    ds_read_b128 v[76:79], v237 offset:8192
    ds_read_b128 v[80:83], v237 offset:24576
    ds_read_b128 v[84:87], v237 offset:40960
    ds_read_b128 v[88:91], v237 offset:57344
    ds_read_b128 v[92:95], v238 offset:8192
    ds_read_b128 v[96:99], v238 offset:24576
    ds_read_b128 v[100:103], v239 offset:8192
    ds_read_b128 v[104:107], v239 offset:24576
    ds_read_b128 v[108:111], v239 offset:40960
    ds_read_b128 v[112:115], v240 offset:8192
    ds_read_b128 v[116:119], v240 offset:40960
    v_add_f32 v32, v32, v36
    v_sub_f32 v20, v20, v8
    v_sub_f32 v16, v16, v0
    v_sub_f32 v32, v32, v24
    v_sub_f32 v20, v20, v12
    v_sub_f32 v16, v16, v4
    v_sub_f32 v32, v32, v28
    v_sub_f32 v28, v28, v4
    v_sub_f32 v52, v52, v40
    v_sub_f32 v56, v56, v40
    v_sub_f32 v32, v32, v16
    v_sub_f32 v28, v28, v12
    v_sub_f32 v52, v52, v44
    v_sub_f32 v56, v56, v48
    v_sub_f32 v120, v32, v20
    v_add_f32 v28, v28, v8
    v_add_f32 v136, v20, v52
    v_add_f32 v56, v56, v44
    v_add_f32 v128, v28, v40
    v_add_f32 v144, v12, v56
    v_add_f32 v33, v33, v37
    v_sub_f32 v21, v21, v9
    v_sub_f32 v17, v17, v1
    v_sub_f32 v33, v33, v25
    v_sub_f32 v21, v21, v13
    v_sub_f32 v17, v17, v5
    v_sub_f32 v33, v33, v29
    v_sub_f32 v29, v29, v5
    v_sub_f32 v53, v53, v41
    v_sub_f32 v57, v57, v41
    v_sub_f32 v33, v33, v17
    v_sub_f32 v29, v29, v13
    v_sub_f32 v53, v53, v45
    v_sub_f32 v57, v57, v49
    v_sub_f32 v122, v33, v21
    v_add_f32 v29, v29, v9
    v_add_f32 v138, v21, v53
    v_add_f32 v57, v57, v45
    v_add_f32 v130, v29, v41
    v_add_f32 v146, v13, v57
    v_add_f32 v34, v34, v38
    v_sub_f32 v22, v22, v10
    v_sub_f32 v18, v18, v2
    v_sub_f32 v34, v34, v26
    v_sub_f32 v22, v22, v14
    v_sub_f32 v18, v18, v6
    v_sub_f32 v34, v34, v30
    v_sub_f32 v30, v30, v6
    v_sub_f32 v54, v54, v42
    v_sub_f32 v58, v58, v42
    v_sub_f32 v34, v34, v18
    v_sub_f32 v30, v30, v14
    v_sub_f32 v54, v54, v46
    v_sub_f32 v58, v58, v50
    v_sub_f32 v124, v34, v22
    v_add_f32 v30, v30, v10
    v_add_f32 v140, v22, v54
    v_add_f32 v58, v58, v46
    v_add_f32 v132, v30, v42
    v_add_f32 v148, v14, v58
    v_add_f32 v35, v35, v39
    v_sub_f32 v23, v23, v11
    v_sub_f32 v19, v19, v3
    v_sub_f32 v35, v35, v27
    v_sub_f32 v23, v23, v15
    v_sub_f32 v19, v19, v7
    v_sub_f32 v35, v35, v31
    v_sub_f32 v31, v31, v7
    v_sub_f32 v55, v55, v43
    v_sub_f32 v59, v59, v43
    v_sub_f32 v35, v35, v19
    v_sub_f32 v31, v31, v15
    v_sub_f32 v55, v55, v47
    v_sub_f32 v59, v59, v51
    v_sub_f32 v126, v35, v23
    v_add_f32 v31, v31, v11
    v_add_f32 v142, v23, v55
    v_add_f32 v59, v59, v47
    v_add_f32 v134, v31, v43
    v_add_f32 v150, v15, v59
    s_waitcnt lgkmcnt(0)
    v_add_f32 v92, v92, v96
    v_sub_f32 v80, v80, v68
    v_sub_f32 v76, v76, v60
    v_sub_f32 v92, v92, v84
    v_sub_f32 v80, v80, v72
    v_sub_f32 v76, v76, v64
    v_sub_f32 v92, v92, v88
    v_sub_f32 v88, v88, v64
    v_sub_f32 v112, v112, v100
    v_sub_f32 v116, v116, v100
    v_sub_f32 v92, v92, v76
    v_sub_f32 v88, v88, v72
    v_sub_f32 v112, v112, v104
    v_sub_f32 v116, v116, v108
    v_sub_f32 v121, v92, v80
    v_add_f32 v88, v88, v68
    v_add_f32 v137, v80, v112
    v_add_f32 v116, v116, v104
    v_add_f32 v129, v88, v100
    v_add_f32 v145, v72, v116
    v_add_f32 v93, v93, v97
    v_sub_f32 v81, v81, v69
    v_sub_f32 v77, v77, v61
    v_sub_f32 v93, v93, v85
    v_sub_f32 v81, v81, v73
    v_sub_f32 v77, v77, v65
    v_sub_f32 v93, v93, v89
    v_sub_f32 v89, v89, v65
    v_sub_f32 v113, v113, v101
    v_sub_f32 v117, v117, v101
    v_sub_f32 v93, v93, v77
    v_sub_f32 v89, v89, v73
    v_sub_f32 v113, v113, v105
    v_sub_f32 v117, v117, v109
    v_sub_f32 v123, v93, v81
    v_add_f32 v89, v89, v69
    v_add_f32 v139, v81, v113
    v_add_f32 v117, v117, v105
    v_add_f32 v131, v89, v101
    v_add_f32 v147, v73, v117
    v_add_f32 v94, v94, v98
    v_sub_f32 v82, v82, v70
    v_sub_f32 v78, v78, v62
    v_sub_f32 v94, v94, v86
    v_sub_f32 v82, v82, v74
    v_sub_f32 v78, v78, v66
    v_sub_f32 v94, v94, v90
    v_sub_f32 v90, v90, v66
    v_sub_f32 v114, v114, v102
    v_sub_f32 v118, v118, v102
    v_sub_f32 v94, v94, v78
    v_sub_f32 v90, v90, v74
    v_sub_f32 v114, v114, v106
    v_sub_f32 v118, v118, v110
    v_sub_f32 v125, v94, v82
    v_add_f32 v90, v90, v70
    v_add_f32 v141, v82, v114
    v_add_f32 v118, v118, v106
    v_add_f32 v133, v90, v102
    v_add_f32 v149, v74, v118
    v_add_f32 v95, v95, v99
    v_sub_f32 v83, v83, v71
    v_sub_f32 v79, v79, v63
    v_sub_f32 v95, v95, v87
    v_sub_f32 v83, v83, v75
    v_sub_f32 v79, v79, v67
    v_sub_f32 v95, v95, v91
    v_sub_f32 v91, v91, v67
    v_sub_f32 v115, v115, v103
    v_sub_f32 v119, v119, v103
    v_sub_f32 v95, v95, v79
    v_sub_f32 v91, v91, v75
    v_sub_f32 v115, v115, v107
    v_sub_f32 v119, v119, v111
    v_sub_f32 v127, v95, v83
    v_add_f32 v91, v91, v71
    v_add_f32 v143, v83, v115
    v_add_f32 v119, v119, v107
    v_add_f32 v135, v91, v103
    v_add_f32 v151, v75, v119
    s_mov_b32 s40, 0xbdd2d3e8
    v_mov_b32 v160, 0xc0135761
    v_mul_f32 v0, v120, v120
    v_mul_f32 v1, v121, v121
    v_mul_f32 v2, v122, v122
    v_mul_f32 v3, v123, v123
    v_mul_f32 v4, v124, v124
    v_mul_f32 v5, v125, v125
    v_mul_f32 v6, v126, v126
    v_mul_f32 v7, v127, v127
    v_fma_f32 v0, v0, s40, v160
    v_fma_f32 v1, v1, s40, v160
    v_fma_f32 v2, v2, s40, v160
    v_fma_f32 v3, v3, s40, v160
    v_fma_f32 v4, v4, s40, v160
    v_fma_f32 v5, v5, s40, v160
    v_fma_f32 v6, v6, s40, v160
    v_fma_f32 v7, v7, s40, v160
    v_mul_f32 v0, v0, v120
    v_mul_f32 v1, v1, v121
    v_mul_f32 v2, v2, v122
    v_mul_f32 v3, v3, v123
    v_mul_f32 v4, v4, v124
    v_mul_f32 v5, v5, v125
    v_mul_f32 v6, v6, v126
    v_mul_f32 v7, v7, v127
    v_exp_f32 v0, v0
    v_exp_f32 v1, v1
    v_exp_f32 v2, v2
    v_exp_f32 v3, v3
    v_exp_f32 v4, v4
    v_exp_f32 v5, v5
    v_exp_f32 v6, v6
    v_exp_f32 v7, v7
    v_add_f32 v0, 1.0, v0
    v_add_f32 v1, 1.0, v1
    v_add_f32 v2, 1.0, v2
    v_add_f32 v3, 1.0, v3
    v_add_f32 v4, 1.0, v4
    v_add_f32 v5, 1.0, v5
    v_add_f32 v6, 1.0, v6
    v_add_f32 v7, 1.0, v7
    v_rcp_f32 v0, v0
    v_rcp_f32 v1, v1
    v_rcp_f32 v2, v2
    v_rcp_f32 v3, v3
    v_rcp_f32 v4, v4
    v_rcp_f32 v5, v5
    v_rcp_f32 v6, v6
    v_rcp_f32 v7, v7
    v_mul_f32 v120, v120, v0
    v_mul_f32 v121, v121, v1
    v_mul_f32 v122, v122, v2
    v_mul_f32 v123, v123, v3
    v_mul_f32 v124, v124, v4
    v_mul_f32 v125, v125, v5
    v_mul_f32 v126, v126, v6
    v_mul_f32 v127, v127, v7
    v_cvt_pk_bf16_f32 v16, v120, v121
    v_cvt_pk_bf16_f32 v17, v122, v123
    v_cvt_pk_bf16_f32 v18, v124, v125
    v_cvt_pk_bf16_f32 v19, v126, v127
    buffer_store_dwordx4 v[16:19], v241, s[16:19], 0 offen offset:0
    v_mul_f32 v8, v128, v128
    v_mul_f32 v9, v129, v129
    v_mul_f32 v10, v130, v130
    v_mul_f32 v11, v131, v131
    v_mul_f32 v12, v132, v132
    v_mul_f32 v13, v133, v133
    v_mul_f32 v14, v134, v134
    v_mul_f32 v15, v135, v135
    v_fma_f32 v8, v8, s40, v160
    v_fma_f32 v9, v9, s40, v160
    v_fma_f32 v10, v10, s40, v160
    v_fma_f32 v11, v11, s40, v160
    v_fma_f32 v12, v12, s40, v160
    v_fma_f32 v13, v13, s40, v160
    v_fma_f32 v14, v14, s40, v160
    v_fma_f32 v15, v15, s40, v160
    v_mul_f32 v8, v8, v128
    v_mul_f32 v9, v9, v129
    v_mul_f32 v10, v10, v130
    v_mul_f32 v11, v11, v131
    v_mul_f32 v12, v12, v132
    v_mul_f32 v13, v13, v133
    v_mul_f32 v14, v14, v134
    v_mul_f32 v15, v15, v135
    v_exp_f32 v8, v8
    v_exp_f32 v9, v9
    v_exp_f32 v10, v10
    v_exp_f32 v11, v11
    v_exp_f32 v12, v12
    v_exp_f32 v13, v13
    v_exp_f32 v14, v14
    v_exp_f32 v15, v15
    v_add_f32 v8, 1.0, v8
    v_add_f32 v9, 1.0, v9
    v_add_f32 v10, 1.0, v10
    v_add_f32 v11, 1.0, v11
    v_add_f32 v12, 1.0, v12
    v_add_f32 v13, 1.0, v13
    v_add_f32 v14, 1.0, v14
    v_add_f32 v15, 1.0, v15
    v_rcp_f32 v8, v8
    v_rcp_f32 v9, v9
    v_rcp_f32 v10, v10
    v_rcp_f32 v11, v11
    v_rcp_f32 v12, v12
    v_rcp_f32 v13, v13
    v_rcp_f32 v14, v14
    v_rcp_f32 v15, v15
    v_mul_f32 v128, v128, v8
    v_mul_f32 v129, v129, v9
    v_mul_f32 v130, v130, v10
    v_mul_f32 v131, v131, v11
    v_mul_f32 v132, v132, v12
    v_mul_f32 v133, v133, v13
    v_mul_f32 v134, v134, v14
    v_mul_f32 v135, v135, v15
    v_cvt_pk_bf16_f32 v20, v128, v129
    v_cvt_pk_bf16_f32 v21, v130, v131
    v_cvt_pk_bf16_f32 v22, v132, v133
    v_cvt_pk_bf16_f32 v23, v134, v135
    buffer_store_dwordx4 v[20:23], v241, s[16:19], 0 offen offset:512
    v_mul_f32 v0, v136, v136
    v_mul_f32 v1, v137, v137
    v_mul_f32 v2, v138, v138
    v_mul_f32 v3, v139, v139
    v_mul_f32 v4, v140, v140
    v_mul_f32 v5, v141, v141
    v_mul_f32 v6, v142, v142
    v_mul_f32 v7, v143, v143
    v_fma_f32 v0, v0, s40, v160
    v_fma_f32 v1, v1, s40, v160
    v_fma_f32 v2, v2, s40, v160
    v_fma_f32 v3, v3, s40, v160
    v_fma_f32 v4, v4, s40, v160
    v_fma_f32 v5, v5, s40, v160
    v_fma_f32 v6, v6, s40, v160
    v_fma_f32 v7, v7, s40, v160
    v_mul_f32 v0, v0, v136
    v_mul_f32 v1, v1, v137
    v_mul_f32 v2, v2, v138
    v_mul_f32 v3, v3, v139
    v_mul_f32 v4, v4, v140
    v_mul_f32 v5, v5, v141
    v_mul_f32 v6, v6, v142
    v_mul_f32 v7, v7, v143
    v_exp_f32 v0, v0
    v_exp_f32 v1, v1
    v_exp_f32 v2, v2
    v_exp_f32 v3, v3
    v_exp_f32 v4, v4
    v_exp_f32 v5, v5
    v_exp_f32 v6, v6
    v_exp_f32 v7, v7
    v_add_f32 v0, 1.0, v0
    v_add_f32 v1, 1.0, v1
    v_add_f32 v2, 1.0, v2
    v_add_f32 v3, 1.0, v3
    v_add_f32 v4, 1.0, v4
    v_add_f32 v5, 1.0, v5
    v_add_f32 v6, 1.0, v6
    v_add_f32 v7, 1.0, v7
    v_rcp_f32 v0, v0
    v_rcp_f32 v1, v1
    v_rcp_f32 v2, v2
    v_rcp_f32 v3, v3
    v_rcp_f32 v4, v4
    v_rcp_f32 v5, v5
    v_rcp_f32 v6, v6
    v_rcp_f32 v7, v7
    v_mul_f32 v136, v136, v0
    v_mul_f32 v137, v137, v1
    v_mul_f32 v138, v138, v2
    v_mul_f32 v139, v139, v3
    v_mul_f32 v140, v140, v4
    v_mul_f32 v141, v141, v5
    v_mul_f32 v142, v142, v6
    v_mul_f32 v143, v143, v7
    v_cvt_pk_bf16_f32 v24, v136, v137
    v_cvt_pk_bf16_f32 v25, v138, v139
    v_cvt_pk_bf16_f32 v26, v140, v141
    v_cvt_pk_bf16_f32 v27, v142, v143
    buffer_store_dwordx4 v[24:27], v241, s[16:19], 0 offen offset:1024
    v_mul_f32 v8, v144, v144
    v_mul_f32 v9, v145, v145
    v_mul_f32 v10, v146, v146
    v_mul_f32 v11, v147, v147
    v_mul_f32 v12, v148, v148
    v_mul_f32 v13, v149, v149
    v_mul_f32 v14, v150, v150
    v_mul_f32 v15, v151, v151
    v_fma_f32 v8, v8, s40, v160
    v_fma_f32 v9, v9, s40, v160
    v_fma_f32 v10, v10, s40, v160
    v_fma_f32 v11, v11, s40, v160
    v_fma_f32 v12, v12, s40, v160
    v_fma_f32 v13, v13, s40, v160
    v_fma_f32 v14, v14, s40, v160
    v_fma_f32 v15, v15, s40, v160
    v_mul_f32 v8, v8, v144
    v_mul_f32 v9, v9, v145
    v_mul_f32 v10, v10, v146
    v_mul_f32 v11, v11, v147
    v_mul_f32 v12, v12, v148
    v_mul_f32 v13, v13, v149
    v_mul_f32 v14, v14, v150
    v_mul_f32 v15, v15, v151
    v_exp_f32 v8, v8
    v_exp_f32 v9, v9
    v_exp_f32 v10, v10
    v_exp_f32 v11, v11
    v_exp_f32 v12, v12
    v_exp_f32 v13, v13
    v_exp_f32 v14, v14
    v_exp_f32 v15, v15
    v_add_f32 v8, 1.0, v8
    v_add_f32 v9, 1.0, v9
    v_add_f32 v10, 1.0, v10
    v_add_f32 v11, 1.0, v11
    v_add_f32 v12, 1.0, v12
    v_add_f32 v13, 1.0, v13
    v_add_f32 v14, 1.0, v14
    v_add_f32 v15, 1.0, v15
    v_rcp_f32 v8, v8
    v_rcp_f32 v9, v9
    v_rcp_f32 v10, v10
    v_rcp_f32 v11, v11
    v_rcp_f32 v12, v12
    v_rcp_f32 v13, v13
    v_rcp_f32 v14, v14
    v_rcp_f32 v15, v15
    v_mul_f32 v144, v144, v8
    v_mul_f32 v145, v145, v9
    v_mul_f32 v146, v146, v10
    v_mul_f32 v147, v147, v11
    v_mul_f32 v148, v148, v12
    v_mul_f32 v149, v149, v13
    v_mul_f32 v150, v150, v14
    v_mul_f32 v151, v151, v15
    v_cvt_pk_bf16_f32 v28, v144, v145
    v_cvt_pk_bf16_f32 v29, v146, v147
    v_cvt_pk_bf16_f32 v30, v148, v149
    v_cvt_pk_bf16_f32 v31, v150, v151
    buffer_store_dwordx4 v[28:31], v241, s[16:19], 0 offen offset:1536
L_conv1_kernel_done:
    s_endpgm
.globl conv2_kernel
.p2align 8
.type conv2_kernel,@function
conv2_kernel:
    s_cmp_ge_u32 s2, 256
    s_cbranch_scc1 L_conv2_kernel_done
    s_load_dwordx2 s[4:5], s[0:1], 72
    s_load_dwordx2 s[30:31], s[0:1], 72
    v_readfirstlane_b32 s20, v0
    s_lshr_b32 s20, s20, 6
    s_and_b32 s36, s2, 1
    s_lshl_b32 s36, s36, 2
    s_bfe_u32 s37, s2, 131075
    s_or_b32 s29, s36, s37
    s_bfe_u32 s36, s2, 131073
    s_lshl_b32 s36, s36, 3
    s_lshr_b32 s37, s2, 5
    s_or_b32 s36, s36, s37
    s_lshr_b32 s33, s36, 4
    s_and_b32 s34, s36, 7
    s_bfe_u32 s35, s36, 0x10003
    s_mul_i32 s21, s34, 500
    s_and_b32 s32, s20, 3
    v_and_b32 v255, 63, v0
    v_and_b32 v3, 15, v255
    v_lshrrev_b32 v4, 4, v255
    v_lshlrev_b32 v1, 11, v4
    v_lshl_add_u32 v1, v3, 4, v1
    v_lshrrev_b32 v5, 2, v255
    v_and_b32 v6, 3, v255
    v_lshlrev_b32 v7, 15, v5
    v_lshl_add_u32 v7, v6, 4, v7
    s_mov_b32 s25, 0xffff0000
    s_lshl_b32 s26, s32, 9
    s_add_u32 s27, s26, 63996
    s_mov_b32 m0, s26
    s_add_u32 s36, s26, 131072
    v_lshl_add_u32 v249, v255, 2, s36
    s_waitcnt lgkmcnt(0)
    s_mul_i32 s36, s35, 4096000
    s_add_u32 s36, s36, 18874368
    s_add_u32 s8, s4, s36
    s_addc_u32 s9, s5, 0
    s_mov_b32 s10, 4096000
    s_mov_b32 s11, 0x00020000
    s_lshl_b32 s36, s29, 4
    s_lshl_b32 s37, s33, 3
    s_add_u32 s36, s36, s37
    s_mul_i32 s36, s36, 73728
    s_add_u32 s36, s36, 9437184
    s_add_u32 s12, s30, s36
    s_addc_u32 s13, s31, 0
    s_mov_b32 s14, 589824
    s_mov_b32 s15, 0x00020000
    s_mul_i32 s36, s35, 4096000
    s_add_u32 s36, s36, 27262976
    s_mul_i32 s37, s33, 8388608
    s_add_u32 s36, s36, s37
    s_add_u32 s16, s30, s36
    s_addc_u32 s17, s31, 0
    s_mov_b32 s18, 4096000
    s_mov_b32 s19, 0x00020000
    s_lshl_b32 s36, s21, 10
    s_lshl_b32 s37, s33, 9
    s_add_u32 s36, s36, s37
    s_sub_u32 s36, s36, 7680
    s_lshl_b32 s37, s32, 13
    s_add_u32 s37, s37, s36
    v_add_u32 v7, s37, v7
    s_cmp_ge_u32 s20, 4
    s_cbranch_scc1 L_conv2_kernel_helper
    v_add_u32 v16, 4096, v7
    buffer_load_dwordx4 v[192:195], v16, s[8:11], 0 offen
    v_add_u32 v17, 5120, v7
    buffer_load_dwordx4 v[196:199], v17, s[8:11], 0 offen
    v_add_u32 v18, 6144, v7
    buffer_load_dwordx4 v[200:203], v18, s[8:11], 0 offen
    v_add_u32 v19, 7168, v7
    buffer_load_dwordx4 v[204:207], v19, s[8:11], 0 offen
    s_add_u32 s37, s36, 524288
    v_lshl_add_u32 v8, v255, 4, s37
    s_cmp_eq_u32 s20, 1
    s_cselect_b32 s38, 2048, 0
    s_lshl_b32 s39, s20, 10
    s_sub_u32 s39, s39, 1024
    s_cmp_lt_u32 s20, 2
    s_cselect_b32 s39, 2130706432, s39
    buffer_load_dwordx4 v[208:211], v8, s[8:11], s38 offen
    buffer_load_dwordx4 v[212:215], v8, s[8:11], s39 offen
    s_lshl_b32 s37, s20, 14
    v_lshl_add_u32 v240, v255, 4, s37
    v_add_u32 v241, 4096, v240
    v_add_u32 v242, 8192, v240
    v_add_u32 v243, 12288, v240
    s_mov_b32 s23, 0
    v_add_u32 v236, s37, v1
    v_add_u32 v237, 65536, v236
    s_lshl_b32 s37, s20, 15
    v_lshl_add_u32 v244, v255, 4, s37
    s_lshl_b32 s37, s20, 10
    s_add_u32 s37, s37, 147456
    v_lshl_add_u32 v22, v4, 8, s37
    v_lshlrev_b32 v23, 8, v4
    v_add_u32 v23, 151552, v23
    v_add_u32 v24, 16, v236
    v_add_u32 v28, 8208, v236
    v_cmp_eq_u32 vcc, 15, v3
    v_mov_b32 v25, 0x10000
    v_mov_b32 v26, 0xffff0000
    v_mov_b32 v27, 16
    v_cndmask_b32 v245, v24, v22, vcc
    v_cndmask_b32 v246, v28, v23, vcc
    v_cndmask_b32 v247, v25, v27, vcc
    v_cndmask_b32 v248, v26, v27, vcc
    v_lshl_add_u32 v238, v255, 2, s37
    v_lshlrev_b32 v239, 2, v255
    v_add_u32 v239, 151552, v239
    v_mov_b32 v0, 0
    v_mov_b32 v1, 0
    v_mov_b32 v2, 0
    v_mov_b32 v3, 0
    v_mov_b32 v4, 0
    v_mov_b32 v5, 0
    v_mov_b32 v6, 0
    v_mov_b32 v7, 0
    v_mov_b32 v8, 0
    v_mov_b32 v9, 0
    v_mov_b32 v10, 0
    v_mov_b32 v11, 0
    v_mov_b32 v12, 0
    v_mov_b32 v13, 0
    v_mov_b32 v14, 0
    v_mov_b32 v15, 0
    v_mov_b32 v16, 0
    v_mov_b32 v17, 0
    v_mov_b32 v18, 0
    v_mov_b32 v19, 0
    v_mov_b32 v20, 0
    v_mov_b32 v21, 0
    v_mov_b32 v22, 0
    v_mov_b32 v23, 0
    v_mov_b32 v24, 0
    v_mov_b32 v25, 0
    v_mov_b32 v26, 0
    v_mov_b32 v27, 0
    v_mov_b32 v28, 0
    v_mov_b32 v29, 0
    v_mov_b32 v30, 0
    v_mov_b32 v31, 0
    v_mov_b32 v32, 0
    v_mov_b32 v33, 0
    v_mov_b32 v34, 0
    v_mov_b32 v35, 0
    v_mov_b32 v36, 0
    v_mov_b32 v37, 0
    v_mov_b32 v38, 0
    v_mov_b32 v39, 0
    v_mov_b32 v40, 0
    v_mov_b32 v41, 0
    v_mov_b32 v42, 0
    v_mov_b32 v43, 0
    v_mov_b32 v44, 0
    v_mov_b32 v45, 0
    v_mov_b32 v46, 0
    v_mov_b32 v47, 0
    v_mov_b32 v48, 0
    v_mov_b32 v49, 0
    v_mov_b32 v50, 0
    v_mov_b32 v51, 0
    v_mov_b32 v52, 0
    v_mov_b32 v53, 0
    v_mov_b32 v54, 0
    v_mov_b32 v55, 0
    v_mov_b32 v56, 0
    v_mov_b32 v57, 0
    v_mov_b32 v58, 0
    v_mov_b32 v59, 0
    v_mov_b32 v60, 0
    v_mov_b32 v61, 0
    v_mov_b32 v62, 0
    v_mov_b32 v63, 0
    buffer_load_dwordx4 v[128:131], v240, s[12:15], s23 offen offset:0
    buffer_load_dwordx4 v[132:135], v240, s[12:15], s23 offen offset:1024
    buffer_load_dwordx4 v[136:139], v240, s[12:15], s23 offen offset:2048
    buffer_load_dwordx4 v[140:143], v240, s[12:15], s23 offen offset:3072
    buffer_load_dwordx4 v[144:147], v241, s[12:15], s23 offen offset:0
    buffer_load_dwordx4 v[148:151], v241, s[12:15], s23 offen offset:1024
    buffer_load_dwordx4 v[152:155], v241, s[12:15], s23 offen offset:2048
    buffer_load_dwordx4 v[156:159], v241, s[12:15], s23 offen offset:3072
    v_mov_b32 v64, 0
    v_mov_b32 v65, 0
    v_mov_b32 v66, 0
    v_mov_b32 v67, 0
    v_mov_b32 v68, 0
    v_mov_b32 v69, 0
    v_mov_b32 v70, 0
    v_mov_b32 v71, 0
    v_mov_b32 v72, 0
    v_mov_b32 v73, 0
    v_mov_b32 v74, 0
    v_mov_b32 v75, 0
    v_mov_b32 v76, 0
    v_mov_b32 v77, 0
    v_mov_b32 v78, 0
    v_mov_b32 v79, 0
    v_mov_b32 v80, 0
    v_mov_b32 v81, 0
    v_mov_b32 v82, 0
    v_mov_b32 v83, 0
    v_mov_b32 v84, 0
    v_mov_b32 v85, 0
    v_mov_b32 v86, 0
    v_mov_b32 v87, 0
    v_mov_b32 v88, 0
    v_mov_b32 v89, 0
    v_mov_b32 v90, 0
    v_mov_b32 v91, 0
    v_mov_b32 v92, 0
    v_mov_b32 v93, 0
    v_mov_b32 v94, 0
    v_mov_b32 v95, 0
    v_mov_b32 v96, 0
    v_mov_b32 v97, 0
    v_mov_b32 v98, 0
    v_mov_b32 v99, 0
    v_mov_b32 v100, 0
    v_mov_b32 v101, 0
    v_mov_b32 v102, 0
    v_mov_b32 v103, 0
    v_mov_b32 v104, 0
    v_mov_b32 v105, 0
    v_mov_b32 v106, 0
    v_mov_b32 v107, 0
    v_mov_b32 v108, 0
    v_mov_b32 v109, 0
    v_mov_b32 v110, 0
    v_mov_b32 v111, 0
    v_mov_b32 v112, 0
    v_mov_b32 v113, 0
    v_mov_b32 v114, 0
    v_mov_b32 v115, 0
    v_mov_b32 v116, 0
    v_mov_b32 v117, 0
    v_mov_b32 v118, 0
    v_mov_b32 v119, 0
    v_mov_b32 v120, 0
    v_mov_b32 v121, 0
    v_mov_b32 v122, 0
    v_mov_b32 v123, 0
    v_mov_b32 v124, 0
    v_mov_b32 v125, 0
    v_mov_b32 v126, 0
    v_mov_b32 v127, 0
    s_waitcnt vmcnt(10)
    v_lshlrev_b32 v160, 16, v192
    v_and_b32 v164, s25, v192
    ds_write_addtid_b32 v192 offset:256
    v_lshlrev_b32 v161, 16, v196
    v_and_b32 v165, s25, v196
    ds_write_addtid_b32 v196 offset:8448
    v_lshlrev_b32 v162, 16, v200
    v_and_b32 v166, s25, v200
    ds_write_addtid_b32 v200 offset:16640
    v_lshlrev_b32 v163, 16, v204
    v_and_b32 v167, s25, v204
    ds_write_addtid_b32 v204 offset:24832
    v_add_f32 v168, v160, v161
    v_add_f32 v172, v164, v165
    v_cvt_pk_bf16_f32 v176, v168, v172
    v_add_f32 v169, v162, v163
    v_add_f32 v173, v166, v167
    ds_write_addtid_b32 v176 offset:33024
    v_cvt_pk_bf16_f32 v177, v169, v173
    v_add_f32 v170, v160, v162
    v_add_f32 v174, v164, v166
    ds_write_addtid_b32 v177 offset:41216
    v_cvt_pk_bf16_f32 v178, v170, v174
    v_add_f32 v171, v161, v163
    v_add_f32 v175, v165, v167
    ds_write_addtid_b32 v178 offset:49408
    v_cvt_pk_bf16_f32 v179, v171, v175
    v_add_f32 v160, v168, v169
    v_add_f32 v164, v172, v173
    ds_write_addtid_b32 v179 offset:57600
    v_cvt_pk_bf16_f32 v180, v160, v164
    ds_write_b32 v249, v180 offset:256
    v_lshlrev_b32 v160, 16, v193
    v_and_b32 v164, s25, v193
    ds_write_addtid_b32 v193 offset:2304
    v_lshlrev_b32 v161, 16, v197
    v_and_b32 v165, s25, v197
    ds_write_addtid_b32 v197 offset:10496
    v_lshlrev_b32 v162, 16, v201
    v_and_b32 v166, s25, v201
    ds_write_addtid_b32 v201 offset:18688
    v_lshlrev_b32 v163, 16, v205
    v_and_b32 v167, s25, v205
    ds_write_addtid_b32 v205 offset:26880
    v_add_f32 v168, v160, v161
    v_add_f32 v172, v164, v165
    v_cvt_pk_bf16_f32 v181, v168, v172
    v_add_f32 v169, v162, v163
    v_add_f32 v173, v166, v167
    ds_write_addtid_b32 v181 offset:35072
    v_cvt_pk_bf16_f32 v182, v169, v173
    v_add_f32 v170, v160, v162
    v_add_f32 v174, v164, v166
    ds_write_addtid_b32 v182 offset:43264
    v_cvt_pk_bf16_f32 v183, v170, v174
    v_add_f32 v171, v161, v163
    v_add_f32 v175, v165, v167
    s_waitcnt lgkmcnt(8)
    ds_write_addtid_b32 v183 offset:51456
    v_cvt_pk_bf16_f32 v184, v171, v175
    v_add_f32 v160, v168, v169
    v_add_f32 v164, v172, v173
    ds_write_addtid_b32 v184 offset:59648
    v_cvt_pk_bf16_f32 v185, v160, v164
    ds_write_b32 v249, v185 offset:2304
    v_lshlrev_b32 v160, 16, v194
    v_and_b32 v164, s25, v194
    ds_write_addtid_b32 v194 offset:4352
    v_lshlrev_b32 v161, 16, v198
    v_and_b32 v165, s25, v198
    ds_write_addtid_b32 v198 offset:12544
    v_lshlrev_b32 v162, 16, v202
    v_and_b32 v166, s25, v202
    ds_write_addtid_b32 v202 offset:20736
    v_lshlrev_b32 v163, 16, v206
    v_and_b32 v167, s25, v206
    ds_write_addtid_b32 v206 offset:28928
    v_add_f32 v168, v160, v161
    v_add_f32 v172, v164, v165
    v_cvt_pk_bf16_f32 v176, v168, v172
    v_add_f32 v169, v162, v163
    v_add_f32 v173, v166, v167
    s_waitcnt lgkmcnt(8)
    ds_write_addtid_b32 v176 offset:37120
    v_cvt_pk_bf16_f32 v177, v169, v173
    v_add_f32 v170, v160, v162
    v_add_f32 v174, v164, v166
    ds_write_addtid_b32 v177 offset:45312
    v_cvt_pk_bf16_f32 v178, v170, v174
    v_add_f32 v171, v161, v163
    v_add_f32 v175, v165, v167
    ds_write_addtid_b32 v178 offset:53504
    v_cvt_pk_bf16_f32 v179, v171, v175
    v_add_f32 v160, v168, v169
    v_add_f32 v164, v172, v173
    ds_write_addtid_b32 v179 offset:61696
    v_cvt_pk_bf16_f32 v180, v160, v164
    ds_write_b32 v249, v180 offset:4352
    v_lshlrev_b32 v160, 16, v195
    v_and_b32 v164, s25, v195
    ds_write_addtid_b32 v195 offset:6400
    v_lshlrev_b32 v161, 16, v199
    v_and_b32 v165, s25, v199
    ds_write_addtid_b32 v199 offset:14592
    v_lshlrev_b32 v162, 16, v203
    v_and_b32 v166, s25, v203
    s_waitcnt lgkmcnt(8)
    ds_write_addtid_b32 v203 offset:22784
    v_lshlrev_b32 v163, 16, v207
    v_and_b32 v167, s25, v207
    ds_write_addtid_b32 v207 offset:30976
    v_add_f32 v168, v160, v161
    v_add_f32 v172, v164, v165
    v_cvt_pk_bf16_f32 v181, v168, v172
    v_add_f32 v169, v162, v163
    v_add_f32 v173, v166, v167
    ds_write_addtid_b32 v181 offset:39168
    v_cvt_pk_bf16_f32 v182, v169, v173
    v_add_f32 v170, v160, v162
    v_add_f32 v174, v164, v166
    ds_write_addtid_b32 v182 offset:47360
    v_cvt_pk_bf16_f32 v183, v170, v174
    v_add_f32 v171, v161, v163
    v_add_f32 v175, v165, v167
    ds_write_addtid_b32 v183 offset:55552
    v_cvt_pk_bf16_f32 v184, v171, v175
    v_add_f32 v160, v168, v169
    v_add_f32 v164, v172, v173
    ds_write_addtid_b32 v184 offset:63744
    v_cvt_pk_bf16_f32 v185, v160, v164
    ds_write_b32 v249, v185 offset:6400
    s_waitcnt vmcnt(8) lgkmcnt(0)
    v_lshlrev_b32 v216, 16, v208
    v_and_b32 v217, s25, v208
    v_lshlrev_b32 v218, 16, v212
    v_and_b32 v219, s25, v212
    v_add_f32 v216, v216, v218
    v_add_f32 v217, v217, v219
    v_cvt_pk_bf16_f32 v220, v216, v217
    ds_write_b32 v238, v220 offset:0
    v_lshlrev_b32 v216, 16, v209
    v_and_b32 v217, s25, v209
    v_lshlrev_b32 v218, 16, v213
    v_and_b32 v219, s25, v213
    v_add_f32 v216, v216, v218
    v_add_f32 v217, v217, v219
    v_cvt_pk_bf16_f32 v221, v216, v217
    ds_write_b32 v238, v221 offset:256
    v_lshlrev_b32 v216, 16, v210
    v_and_b32 v217, s25, v210
    v_lshlrev_b32 v218, 16, v214
    v_and_b32 v219, s25, v214
    v_add_f32 v216, v216, v218
    v_add_f32 v217, v217, v219
    v_cvt_pk_bf16_f32 v222, v216, v217
    ds_write_b32 v238, v222 offset:512
    v_lshlrev_b32 v216, 16, v211
    v_and_b32 v217, s25, v211
    v_lshlrev_b32 v218, 16, v215
    v_and_b32 v219, s25, v215
    v_add_f32 v216, v216, v218
    v_add_f32 v217, v217, v219
    v_cvt_pk_bf16_f32 v223, v216, v217
    ds_write_b32 v238, v223 offset:768
    s_cmp_lg_u32 s20, 2
    s_cbranch_scc1 L_conv2_kernel_nsp
    ds_write_b32 v239, v212 offset:0
    ds_write_b32 v239, v213 offset:256
    ds_write_b32 v239, v214 offset:512
    ds_write_b32 v239, v215 offset:768
L_conv2_kernel_nsp:
    s_waitcnt lgkmcnt(0)
    s_barrier
    ds_read_b128 v[192:195], v236 offset:0
    ds_read_b128 v[196:199], v236 offset:256
    ds_read_b128 v[200:203], v236 offset:512
    ds_read_b128 v[204:207], v236 offset:768
    ds_read_b128 v[208:211], v236 offset:1024
    ds_read_b128 v[212:215], v236 offset:1280
    ds_read_b128 v[216:219], v236 offset:1536
    ds_read_b128 v[220:223], v236 offset:1792
    ds_read_b128 v[224:227], v245 offset:0
    v_add_u32 v245, v247, v245
    ds_read_b128 v[228:231], v236 offset:272
    buffer_load_dwordx4 v[160:163], v242, s[12:15], s23 offen offset:0
    buffer_load_dwordx4 v[164:167], v242, s[12:15], s23 offen offset:1024
    buffer_load_dwordx4 v[168:171], v242, s[12:15], s23 offen offset:2048
    buffer_load_dwordx4 v[172:175], v242, s[12:15], s23 offen offset:3072
    buffer_load_dwordx4 v[176:179], v243, s[12:15], s23 offen offset:0
    buffer_load_dwordx4 v[180:183], v243, s[12:15], s23 offen offset:1024
    buffer_load_dwordx4 v[184:187], v243, s[12:15], s23 offen offset:2048
    buffer_load_dwordx4 v[188:191], v243, s[12:15], s23 offen offset:3072
    s_mov_b32 s23, 73728
    s_mov_b32 s22, 4
    s_setprio 0
    s_nop 0
L_conv2_kernel_mloop:
    s_waitcnt vmcnt(14) lgkmcnt(9)
    s_nop 0
    v_mfma_f32_16x16x32_bf16 v[0:3], v[128:131], v[192:195], v[0:3]
    ds_read_b128 v[232:235], v236 offset:528
    v_mfma_f32_16x16x32_bf16 v[32:35], v[132:135], v[192:195], v[32:35]
    s_waitcnt lgkmcnt(9)
    s_nop 0
    v_mfma_f32_16x16x32_bf16 v[4:7], v[128:131], v[196:199], v[4:7]
    v_mfma_f32_16x16x32_bf16 v[36:39], v[132:135], v[196:199], v[36:39]
    s_waitcnt lgkmcnt(8)
    s_nop 0
    v_mfma_f32_16x16x32_bf16 v[8:11], v[128:131], v[200:203], v[8:11]
    v_mfma_f32_16x16x32_bf16 v[40:43], v[132:135], v[200:203], v[40:43]
    s_waitcnt lgkmcnt(7)
    s_nop 0
    v_mfma_f32_16x16x32_bf16 v[12:15], v[128:131], v[204:207], v[12:15]
    v_mfma_f32_16x16x32_bf16 v[44:47], v[132:135], v[204:207], v[44:47]
    s_waitcnt lgkmcnt(6)
    s_nop 0
    v_mfma_f32_16x16x32_bf16 v[16:19], v[128:131], v[208:211], v[16:19]
    v_mfma_f32_16x16x32_bf16 v[48:51], v[132:135], v[208:211], v[48:51]
    s_waitcnt lgkmcnt(5)
    s_nop 0
    v_mfma_f32_16x16x32_bf16 v[20:23], v[128:131], v[212:215], v[20:23]
    v_mfma_f32_16x16x32_bf16 v[52:55], v[132:135], v[212:215], v[52:55]
    s_waitcnt lgkmcnt(4)
    s_nop 0
    v_mfma_f32_16x16x32_bf16 v[24:27], v[128:131], v[216:219], v[24:27]
    v_mfma_f32_16x16x32_bf16 v[56:59], v[132:135], v[216:219], v[56:59]
    s_waitcnt lgkmcnt(3)
    s_nop 0
    v_mfma_f32_16x16x32_bf16 v[28:31], v[128:131], v[220:223], v[28:31]
    v_mfma_f32_16x16x32_bf16 v[60:63], v[132:135], v[220:223], v[60:63]
    buffer_load_dwordx4 v[128:131], v240, s[12:15], s23 offen offset:0
    buffer_load_dwordx4 v[132:135], v240, s[12:15], s23 offen offset:1024
    s_waitcnt vmcnt(14)
    s_nop 0
    v_mfma_f32_16x16x32_bf16 v[0:3], v[136:139], v[196:199], v[0:3]
    v_mfma_f32_16x16x32_bf16 v[32:35], v[140:143], v[196:199], v[32:35]
    v_mfma_f32_16x16x32_bf16 v[4:7], v[136:139], v[200:203], v[4:7]
    v_mfma_f32_16x16x32_bf16 v[36:39], v[140:143], v[200:203], v[36:39]
    v_mfma_f32_16x16x32_bf16 v[8:11], v[136:139], v[204:207], v[8:11]
    v_mfma_f32_16x16x32_bf16 v[40:43], v[140:143], v[204:207], v[40:43]
    v_mfma_f32_16x16x32_bf16 v[12:15], v[136:139], v[208:211], v[12:15]
    v_mfma_f32_16x16x32_bf16 v[44:47], v[140:143], v[208:211], v[44:47]
    v_mfma_f32_16x16x32_bf16 v[16:19], v[136:139], v[212:215], v[16:19]
    v_mfma_f32_16x16x32_bf16 v[48:51], v[140:143], v[212:215], v[48:51]
    v_mfma_f32_16x16x32_bf16 v[20:23], v[136:139], v[216:219], v[20:23]
    v_mfma_f32_16x16x32_bf16 v[52:55], v[140:143], v[216:219], v[52:55]
    v_mfma_f32_16x16x32_bf16 v[24:27], v[136:139], v[220:223], v[24:27]
    v_mfma_f32_16x16x32_bf16 v[56:59], v[140:143], v[220:223], v[56:59]
    s_waitcnt lgkmcnt(2)
    s_nop 0
    v_mfma_f32_16x16x32_bf16 v[28:31], v[136:139], v[224:227], v[28:31]
    v_mfma_f32_16x16x32_bf16 v[60:63], v[140:143], v[224:227], v[60:63]
    buffer_load_dwordx4 v[136:139], v240, s[12:15], s23 offen offset:2048
    buffer_load_dwordx4 v[140:143], v240, s[12:15], s23 offen offset:3072
    s_waitcnt vmcnt(14)
    s_nop 0
    v_mfma_f32_16x16x32_bf16 v[0:3], v[144:147], v[200:203], v[0:3]
    v_mfma_f32_16x16x32_bf16 v[32:35], v[148:151], v[200:203], v[32:35]
    v_mfma_f32_16x16x32_bf16 v[4:7], v[144:147], v[204:207], v[4:7]
    v_mfma_f32_16x16x32_bf16 v[36:39], v[148:151], v[204:207], v[36:39]
    v_mfma_f32_16x16x32_bf16 v[8:11], v[144:147], v[208:211], v[8:11]
    v_mfma_f32_16x16x32_bf16 v[40:43], v[148:151], v[208:211], v[40:43]
    v_mfma_f32_16x16x32_bf16 v[12:15], v[144:147], v[212:215], v[12:15]
    v_mfma_f32_16x16x32_bf16 v[44:47], v[148:151], v[212:215], v[44:47]
    v_mfma_f32_16x16x32_bf16 v[16:19], v[144:147], v[216:219], v[16:19]
    v_mfma_f32_16x16x32_bf16 v[48:51], v[148:151], v[216:219], v[48:51]
    v_mfma_f32_16x16x32_bf16 v[20:23], v[144:147], v[220:223], v[20:23]
    v_mfma_f32_16x16x32_bf16 v[52:55], v[148:151], v[220:223], v[52:55]
    v_mfma_f32_16x16x32_bf16 v[24:27], v[144:147], v[224:227], v[24:27]
    ds_read_b128 v[192:195], v236 offset:8192
    v_mfma_f32_16x16x32_bf16 v[56:59], v[148:151], v[224:227], v[56:59]
    s_waitcnt lgkmcnt(2)
    s_nop 0
    v_mfma_f32_16x16x32_bf16 v[28:31], v[144:147], v[228:231], v[28:31]
    ds_read_b128 v[196:199], v236 offset:8448
    v_mfma_f32_16x16x32_bf16 v[60:63], v[148:151], v[228:231], v[60:63]
    buffer_load_dwordx4 v[144:147], v241, s[12:15], s23 offen offset:0
    buffer_load_dwordx4 v[148:151], v241, s[12:15], s23 offen offset:1024
    s_waitcnt vmcnt(14)
    s_nop 0
    v_mfma_f32_16x16x32_bf16 v[0:3], v[152:155], v[204:207], v[0:3]
    ds_read_b128 v[200:203], v236 offset:8704
    v_mfma_f32_16x16x32_bf16 v[32:35], v[156:159], v[204:207], v[32:35]
    v_mfma_f32_16x16x32_bf16 v[4:7], v[152:155], v[208:211], v[4:7]
    ds_read_b128 v[204:207], v236 offset:8960
    v_mfma_f32_16x16x32_bf16 v[36:39], v[156:159], v[208:211], v[36:39]
    v_mfma_f32_16x16x32_bf16 v[8:11], v[152:155], v[212:215], v[8:11]
    ds_read_b128 v[208:211], v236 offset:9216
    v_mfma_f32_16x16x32_bf16 v[40:43], v[156:159], v[212:215], v[40:43]
    v_mfma_f32_16x16x32_bf16 v[12:15], v[152:155], v[216:219], v[12:15]
    ds_read_b128 v[212:215], v236 offset:9472
    v_mfma_f32_16x16x32_bf16 v[44:47], v[156:159], v[216:219], v[44:47]
    v_mfma_f32_16x16x32_bf16 v[16:19], v[152:155], v[220:223], v[16:19]
    ds_read_b128 v[216:219], v236 offset:9728
    v_mfma_f32_16x16x32_bf16 v[48:51], v[156:159], v[220:223], v[48:51]
    v_mfma_f32_16x16x32_bf16 v[20:23], v[152:155], v[224:227], v[20:23]
    ds_read_b128 v[220:223], v236 offset:9984
    v_mfma_f32_16x16x32_bf16 v[52:55], v[156:159], v[224:227], v[52:55]
    v_mfma_f32_16x16x32_bf16 v[24:27], v[152:155], v[228:231], v[24:27]
    ds_read_b128 v[224:227], v246 offset:0
    v_add_u32 v246, v247, v246
    s_nop 0
    v_mfma_f32_16x16x32_bf16 v[56:59], v[156:159], v[228:231], v[56:59]
    s_waitcnt lgkmcnt(9)
    s_nop 0
    v_mfma_f32_16x16x32_bf16 v[28:31], v[152:155], v[232:235], v[28:31]
    ds_read_b128 v[228:231], v236 offset:8464
    v_mfma_f32_16x16x32_bf16 v[60:63], v[156:159], v[232:235], v[60:63]
    buffer_load_dwordx4 v[152:155], v241, s[12:15], s23 offen offset:2048
    buffer_load_dwordx4 v[156:159], v241, s[12:15], s23 offen offset:3072
    s_waitcnt vmcnt(14) lgkmcnt(9)
    s_nop 0
    v_mfma_f32_16x16x32_bf16 v[64:67], v[160:163], v[192:195], v[64:67]
    ds_read_b128 v[232:235], v236 offset:8720
    v_mfma_f32_16x16x32_bf16 v[96:99], v[164:167], v[192:195], v[96:99]
    s_waitcnt lgkmcnt(9)
    s_nop 0
    v_mfma_f32_16x16x32_bf16 v[68:71], v[160:163], v[196:199], v[68:71]
    v_mfma_f32_16x16x32_bf16 v[100:103], v[164:167], v[196:199], v[100:103]
    s_waitcnt lgkmcnt(8)
    s_nop 0
    v_mfma_f32_16x16x32_bf16 v[72:75], v[160:163], v[200:203], v[72:75]
    v_mfma_f32_16x16x32_bf16 v[104:107], v[164:167], v[200:203], v[104:107]
    s_waitcnt lgkmcnt(7)
    s_nop 0
    v_mfma_f32_16x16x32_bf16 v[76:79], v[160:163], v[204:207], v[76:79]
    v_mfma_f32_16x16x32_bf16 v[108:111], v[164:167], v[204:207], v[108:111]
    s_waitcnt lgkmcnt(6)
    s_nop 0
    v_mfma_f32_16x16x32_bf16 v[80:83], v[160:163], v[208:211], v[80:83]
    v_mfma_f32_16x16x32_bf16 v[112:115], v[164:167], v[208:211], v[112:115]
    s_waitcnt lgkmcnt(5)
    s_nop 0
    v_mfma_f32_16x16x32_bf16 v[84:87], v[160:163], v[212:215], v[84:87]
    v_mfma_f32_16x16x32_bf16 v[116:119], v[164:167], v[212:215], v[116:119]
    s_waitcnt lgkmcnt(4)
    s_nop 0
    v_mfma_f32_16x16x32_bf16 v[88:91], v[160:163], v[216:219], v[88:91]
    v_mfma_f32_16x16x32_bf16 v[120:123], v[164:167], v[216:219], v[120:123]
    s_waitcnt lgkmcnt(3)
    s_nop 0
    v_mfma_f32_16x16x32_bf16 v[92:95], v[160:163], v[220:223], v[92:95]
    v_mfma_f32_16x16x32_bf16 v[124:127], v[164:167], v[220:223], v[124:127]
    buffer_load_dwordx4 v[160:163], v242, s[12:15], s23 offen offset:0
    buffer_load_dwordx4 v[164:167], v242, s[12:15], s23 offen offset:1024
    s_waitcnt vmcnt(14)
    s_nop 0
    v_mfma_f32_16x16x32_bf16 v[64:67], v[168:171], v[196:199], v[64:67]
    v_mfma_f32_16x16x32_bf16 v[96:99], v[172:175], v[196:199], v[96:99]
    v_mfma_f32_16x16x32_bf16 v[68:71], v[168:171], v[200:203], v[68:71]
    v_mfma_f32_16x16x32_bf16 v[100:103], v[172:175], v[200:203], v[100:103]
    v_mfma_f32_16x16x32_bf16 v[72:75], v[168:171], v[204:207], v[72:75]
    v_mfma_f32_16x16x32_bf16 v[104:107], v[172:175], v[204:207], v[104:107]
    v_mfma_f32_16x16x32_bf16 v[76:79], v[168:171], v[208:211], v[76:79]
    v_mfma_f32_16x16x32_bf16 v[108:111], v[172:175], v[208:211], v[108:111]
    v_mfma_f32_16x16x32_bf16 v[80:83], v[168:171], v[212:215], v[80:83]
    v_mfma_f32_16x16x32_bf16 v[112:115], v[172:175], v[212:215], v[112:115]
    v_mfma_f32_16x16x32_bf16 v[84:87], v[168:171], v[216:219], v[84:87]
    v_mfma_f32_16x16x32_bf16 v[116:119], v[172:175], v[216:219], v[116:119]
    v_mfma_f32_16x16x32_bf16 v[88:91], v[168:171], v[220:223], v[88:91]
    v_mfma_f32_16x16x32_bf16 v[120:123], v[172:175], v[220:223], v[120:123]
    s_waitcnt lgkmcnt(2)
    s_nop 0
    v_mfma_f32_16x16x32_bf16 v[92:95], v[168:171], v[224:227], v[92:95]
    v_mfma_f32_16x16x32_bf16 v[124:127], v[172:175], v[224:227], v[124:127]
    buffer_load_dwordx4 v[168:171], v242, s[12:15], s23 offen offset:2048
    buffer_load_dwordx4 v[172:175], v242, s[12:15], s23 offen offset:3072
    s_waitcnt vmcnt(14)
    s_nop 0
    v_mfma_f32_16x16x32_bf16 v[64:67], v[176:179], v[200:203], v[64:67]
    v_mfma_f32_16x16x32_bf16 v[96:99], v[180:183], v[200:203], v[96:99]
    v_mfma_f32_16x16x32_bf16 v[68:71], v[176:179], v[204:207], v[68:71]
    v_mfma_f32_16x16x32_bf16 v[100:103], v[180:183], v[204:207], v[100:103]
    v_mfma_f32_16x16x32_bf16 v[72:75], v[176:179], v[208:211], v[72:75]
    v_mfma_f32_16x16x32_bf16 v[104:107], v[180:183], v[208:211], v[104:107]
    v_mfma_f32_16x16x32_bf16 v[76:79], v[176:179], v[212:215], v[76:79]
    v_mfma_f32_16x16x32_bf16 v[108:111], v[180:183], v[212:215], v[108:111]
    s_waitcnt lgkmcnt(0)
    s_barrier
    v_mfma_f32_16x16x32_bf16 v[80:83], v[176:179], v[216:219], v[80:83]
    v_mfma_f32_16x16x32_bf16 v[112:115], v[180:183], v[216:219], v[112:115]
    v_mfma_f32_16x16x32_bf16 v[84:87], v[176:179], v[220:223], v[84:87]
    v_mfma_f32_16x16x32_bf16 v[116:119], v[180:183], v[220:223], v[116:119]
    v_mfma_f32_16x16x32_bf16 v[88:91], v[176:179], v[224:227], v[88:91]
    ds_read_b128 v[192:195], v237 offset:0
    v_mfma_f32_16x16x32_bf16 v[120:123], v[180:183], v[224:227], v[120:123]
    v_mfma_f32_16x16x32_bf16 v[92:95], v[176:179], v[228:231], v[92:95]
    ds_read_b128 v[196:199], v237 offset:256
    v_mfma_f32_16x16x32_bf16 v[124:127], v[180:183], v[228:231], v[124:127]
    buffer_load_dwordx4 v[176:179], v243, s[12:15], s23 offen offset:0
    buffer_load_dwordx4 v[180:183], v243, s[12:15], s23 offen offset:1024
    s_waitcnt vmcnt(14)
    s_nop 0
    v_mfma_f32_16x16x32_bf16 v[64:67], v[184:187], v[204:207], v[64:67]
    ds_read_b128 v[200:203], v237 offset:512
    v_mfma_f32_16x16x32_bf16 v[96:99], v[188:191], v[204:207], v[96:99]
    v_mfma_f32_16x16x32_bf16 v[68:71], v[184:187], v[208:211], v[68:71]
    ds_read_b128 v[204:207], v237 offset:768
    v_mfma_f32_16x16x32_bf16 v[100:103], v[188:191], v[208:211], v[100:103]
    v_mfma_f32_16x16x32_bf16 v[72:75], v[184:187], v[212:215], v[72:75]
    ds_read_b128 v[208:211], v237 offset:1024
    v_mfma_f32_16x16x32_bf16 v[104:107], v[188:191], v[212:215], v[104:107]
    v_mfma_f32_16x16x32_bf16 v[76:79], v[184:187], v[216:219], v[76:79]
    ds_read_b128 v[212:215], v237 offset:1280
    v_mfma_f32_16x16x32_bf16 v[108:111], v[188:191], v[216:219], v[108:111]
    v_mfma_f32_16x16x32_bf16 v[80:83], v[184:187], v[220:223], v[80:83]
    ds_read_b128 v[216:219], v237 offset:1536
    v_mfma_f32_16x16x32_bf16 v[112:115], v[188:191], v[220:223], v[112:115]
    v_mfma_f32_16x16x32_bf16 v[84:87], v[184:187], v[224:227], v[84:87]
    ds_read_b128 v[220:223], v237 offset:1792
    v_mfma_f32_16x16x32_bf16 v[116:119], v[188:191], v[224:227], v[116:119]
    v_mfma_f32_16x16x32_bf16 v[88:91], v[184:187], v[228:231], v[88:91]
    ds_read_b128 v[224:227], v245 offset:0
    v_add_u32 v245, v248, v245
    s_nop 0
    v_mfma_f32_16x16x32_bf16 v[120:123], v[188:191], v[228:231], v[120:123]
    v_mfma_f32_16x16x32_bf16 v[92:95], v[184:187], v[232:235], v[92:95]
    ds_read_b128 v[228:231], v237 offset:272
    v_mfma_f32_16x16x32_bf16 v[124:127], v[188:191], v[232:235], v[124:127]
    buffer_load_dwordx4 v[184:187], v243, s[12:15], s23 offen offset:2048
    buffer_load_dwordx4 v[188:191], v243, s[12:15], s23 offen offset:3072
    s_add_u32 s23, s23, 73728
    s_waitcnt vmcnt(14) lgkmcnt(9)
    s_nop 0
    v_mfma_f32_16x16x32_bf16 v[0:3], v[128:131], v[192:195], v[0:3]
    ds_read_b128 v[232:235], v237 offset:528
    v_mfma_f32_16x16x32_bf16 v[32:35], v[132:135], v[192:195], v[32:35]
    s_waitcnt lgkmcnt(9)
    s_nop 0
    v_mfma_f32_16x16x32_bf16 v[4:7], v[128:131], v[196:199], v[4:7]
    v_mfma_f32_16x16x32_bf16 v[36:39], v[132:135], v[196:199], v[36:39]
    s_waitcnt lgkmcnt(8)
    s_nop 0
    v_mfma_f32_16x16x32_bf16 v[8:11], v[128:131], v[200:203], v[8:11]
    v_mfma_f32_16x16x32_bf16 v[40:43], v[132:135], v[200:203], v[40:43]
    s_waitcnt lgkmcnt(7)
    s_nop 0
    v_mfma_f32_16x16x32_bf16 v[12:15], v[128:131], v[204:207], v[12:15]
    v_mfma_f32_16x16x32_bf16 v[44:47], v[132:135], v[204:207], v[44:47]
    s_waitcnt lgkmcnt(6)
    s_nop 0
    v_mfma_f32_16x16x32_bf16 v[16:19], v[128:131], v[208:211], v[16:19]
    v_mfma_f32_16x16x32_bf16 v[48:51], v[132:135], v[208:211], v[48:51]
    s_waitcnt lgkmcnt(5)
    s_nop 0
    v_mfma_f32_16x16x32_bf16 v[20:23], v[128:131], v[212:215], v[20:23]
    v_mfma_f32_16x16x32_bf16 v[52:55], v[132:135], v[212:215], v[52:55]
    s_waitcnt lgkmcnt(4)
    s_nop 0
    v_mfma_f32_16x16x32_bf16 v[24:27], v[128:131], v[216:219], v[24:27]
    v_mfma_f32_16x16x32_bf16 v[56:59], v[132:135], v[216:219], v[56:59]
    s_waitcnt lgkmcnt(3)
    s_nop 0
    v_mfma_f32_16x16x32_bf16 v[28:31], v[128:131], v[220:223], v[28:31]
    v_mfma_f32_16x16x32_bf16 v[60:63], v[132:135], v[220:223], v[60:63]
    buffer_load_dwordx4 v[128:131], v240, s[12:15], s23 offen offset:0
    buffer_load_dwordx4 v[132:135], v240, s[12:15], s23 offen offset:1024
    s_waitcnt vmcnt(14)
    s_nop 0
    v_mfma_f32_16x16x32_bf16 v[0:3], v[136:139], v[196:199], v[0:3]
    v_mfma_f32_16x16x32_bf16 v[32:35], v[140:143], v[196:199], v[32:35]
    v_mfma_f32_16x16x32_bf16 v[4:7], v[136:139], v[200:203], v[4:7]
    v_mfma_f32_16x16x32_bf16 v[36:39], v[140:143], v[200:203], v[36:39]
    v_mfma_f32_16x16x32_bf16 v[8:11], v[136:139], v[204:207], v[8:11]
    v_mfma_f32_16x16x32_bf16 v[40:43], v[140:143], v[204:207], v[40:43]
    v_mfma_f32_16x16x32_bf16 v[12:15], v[136:139], v[208:211], v[12:15]
    v_mfma_f32_16x16x32_bf16 v[44:47], v[140:143], v[208:211], v[44:47]
    v_mfma_f32_16x16x32_bf16 v[16:19], v[136:139], v[212:215], v[16:19]
    v_mfma_f32_16x16x32_bf16 v[48:51], v[140:143], v[212:215], v[48:51]
    v_mfma_f32_16x16x32_bf16 v[20:23], v[136:139], v[216:219], v[20:23]
    v_mfma_f32_16x16x32_bf16 v[52:55], v[140:143], v[216:219], v[52:55]
    v_mfma_f32_16x16x32_bf16 v[24:27], v[136:139], v[220:223], v[24:27]
    v_mfma_f32_16x16x32_bf16 v[56:59], v[140:143], v[220:223], v[56:59]
    s_waitcnt lgkmcnt(2)
    s_nop 0
    v_mfma_f32_16x16x32_bf16 v[28:31], v[136:139], v[224:227], v[28:31]
    v_mfma_f32_16x16x32_bf16 v[60:63], v[140:143], v[224:227], v[60:63]
    buffer_load_dwordx4 v[136:139], v240, s[12:15], s23 offen offset:2048
    buffer_load_dwordx4 v[140:143], v240, s[12:15], s23 offen offset:3072
    s_waitcnt vmcnt(14)
    s_nop 0
    v_mfma_f32_16x16x32_bf16 v[0:3], v[144:147], v[200:203], v[0:3]
    v_mfma_f32_16x16x32_bf16 v[32:35], v[148:151], v[200:203], v[32:35]
    v_mfma_f32_16x16x32_bf16 v[4:7], v[144:147], v[204:207], v[4:7]
    v_mfma_f32_16x16x32_bf16 v[36:39], v[148:151], v[204:207], v[36:39]
    v_mfma_f32_16x16x32_bf16 v[8:11], v[144:147], v[208:211], v[8:11]
    v_mfma_f32_16x16x32_bf16 v[40:43], v[148:151], v[208:211], v[40:43]
    v_mfma_f32_16x16x32_bf16 v[12:15], v[144:147], v[212:215], v[12:15]
    v_mfma_f32_16x16x32_bf16 v[44:47], v[148:151], v[212:215], v[44:47]
    v_mfma_f32_16x16x32_bf16 v[16:19], v[144:147], v[216:219], v[16:19]
    v_mfma_f32_16x16x32_bf16 v[48:51], v[148:151], v[216:219], v[48:51]
    v_mfma_f32_16x16x32_bf16 v[20:23], v[144:147], v[220:223], v[20:23]
    v_mfma_f32_16x16x32_bf16 v[52:55], v[148:151], v[220:223], v[52:55]
    v_mfma_f32_16x16x32_bf16 v[24:27], v[144:147], v[224:227], v[24:27]
    ds_read_b128 v[192:195], v237 offset:8192
    v_mfma_f32_16x16x32_bf16 v[56:59], v[148:151], v[224:227], v[56:59]
    s_waitcnt lgkmcnt(2)
    s_nop 0
    v_mfma_f32_16x16x32_bf16 v[28:31], v[144:147], v[228:231], v[28:31]
    ds_read_b128 v[196:199], v237 offset:8448
    v_mfma_f32_16x16x32_bf16 v[60:63], v[148:151], v[228:231], v[60:63]
    buffer_load_dwordx4 v[144:147], v241, s[12:15], s23 offen offset:0
    buffer_load_dwordx4 v[148:151], v241, s[12:15], s23 offen offset:1024
    s_waitcnt vmcnt(14)
    s_nop 0
    v_mfma_f32_16x16x32_bf16 v[0:3], v[152:155], v[204:207], v[0:3]
    ds_read_b128 v[200:203], v237 offset:8704
    v_mfma_f32_16x16x32_bf16 v[32:35], v[156:159], v[204:207], v[32:35]
    v_mfma_f32_16x16x32_bf16 v[4:7], v[152:155], v[208:211], v[4:7]
    ds_read_b128 v[204:207], v237 offset:8960
    v_mfma_f32_16x16x32_bf16 v[36:39], v[156:159], v[208:211], v[36:39]
    v_mfma_f32_16x16x32_bf16 v[8:11], v[152:155], v[212:215], v[8:11]
    ds_read_b128 v[208:211], v237 offset:9216
    v_mfma_f32_16x16x32_bf16 v[40:43], v[156:159], v[212:215], v[40:43]
    v_mfma_f32_16x16x32_bf16 v[12:15], v[152:155], v[216:219], v[12:15]
    ds_read_b128 v[212:215], v237 offset:9472
    v_mfma_f32_16x16x32_bf16 v[44:47], v[156:159], v[216:219], v[44:47]
    v_mfma_f32_16x16x32_bf16 v[16:19], v[152:155], v[220:223], v[16:19]
    ds_read_b128 v[216:219], v237 offset:9728
    v_mfma_f32_16x16x32_bf16 v[48:51], v[156:159], v[220:223], v[48:51]
    v_mfma_f32_16x16x32_bf16 v[20:23], v[152:155], v[224:227], v[20:23]
    ds_read_b128 v[220:223], v237 offset:9984
    v_mfma_f32_16x16x32_bf16 v[52:55], v[156:159], v[224:227], v[52:55]
    v_mfma_f32_16x16x32_bf16 v[24:27], v[152:155], v[228:231], v[24:27]
    ds_read_b128 v[224:227], v246 offset:0
    v_add_u32 v246, v248, v246
    s_nop 0
    v_mfma_f32_16x16x32_bf16 v[56:59], v[156:159], v[228:231], v[56:59]
    s_waitcnt lgkmcnt(9)
    s_nop 0
    v_mfma_f32_16x16x32_bf16 v[28:31], v[152:155], v[232:235], v[28:31]
    ds_read_b128 v[228:231], v237 offset:8464
    v_mfma_f32_16x16x32_bf16 v[60:63], v[156:159], v[232:235], v[60:63]
    buffer_load_dwordx4 v[152:155], v241, s[12:15], s23 offen offset:2048
    buffer_load_dwordx4 v[156:159], v241, s[12:15], s23 offen offset:3072
    s_waitcnt vmcnt(14) lgkmcnt(9)
    s_nop 0
    v_mfma_f32_16x16x32_bf16 v[64:67], v[160:163], v[192:195], v[64:67]
    ds_read_b128 v[232:235], v237 offset:8720
    v_mfma_f32_16x16x32_bf16 v[96:99], v[164:167], v[192:195], v[96:99]
    s_waitcnt lgkmcnt(9)
    s_nop 0
    v_mfma_f32_16x16x32_bf16 v[68:71], v[160:163], v[196:199], v[68:71]
    v_mfma_f32_16x16x32_bf16 v[100:103], v[164:167], v[196:199], v[100:103]
    s_waitcnt lgkmcnt(8)
    s_nop 0
    v_mfma_f32_16x16x32_bf16 v[72:75], v[160:163], v[200:203], v[72:75]
    v_mfma_f32_16x16x32_bf16 v[104:107], v[164:167], v[200:203], v[104:107]
    s_waitcnt lgkmcnt(7)
    s_nop 0
    v_mfma_f32_16x16x32_bf16 v[76:79], v[160:163], v[204:207], v[76:79]
    v_mfma_f32_16x16x32_bf16 v[108:111], v[164:167], v[204:207], v[108:111]
    s_waitcnt lgkmcnt(6)
    s_nop 0
    v_mfma_f32_16x16x32_bf16 v[80:83], v[160:163], v[208:211], v[80:83]
    v_mfma_f32_16x16x32_bf16 v[112:115], v[164:167], v[208:211], v[112:115]
    s_waitcnt lgkmcnt(5)
    s_nop 0
    v_mfma_f32_16x16x32_bf16 v[84:87], v[160:163], v[212:215], v[84:87]
    v_mfma_f32_16x16x32_bf16 v[116:119], v[164:167], v[212:215], v[116:119]
    s_waitcnt lgkmcnt(4)
    s_nop 0
    v_mfma_f32_16x16x32_bf16 v[88:91], v[160:163], v[216:219], v[88:91]
    v_mfma_f32_16x16x32_bf16 v[120:123], v[164:167], v[216:219], v[120:123]
    s_waitcnt lgkmcnt(3)
    s_nop 0
    v_mfma_f32_16x16x32_bf16 v[92:95], v[160:163], v[220:223], v[92:95]
    v_mfma_f32_16x16x32_bf16 v[124:127], v[164:167], v[220:223], v[124:127]
    buffer_load_dwordx4 v[160:163], v242, s[12:15], s23 offen offset:0
    buffer_load_dwordx4 v[164:167], v242, s[12:15], s23 offen offset:1024
    s_waitcnt vmcnt(14)
    s_nop 0
    v_mfma_f32_16x16x32_bf16 v[64:67], v[168:171], v[196:199], v[64:67]
    v_mfma_f32_16x16x32_bf16 v[96:99], v[172:175], v[196:199], v[96:99]
    v_mfma_f32_16x16x32_bf16 v[68:71], v[168:171], v[200:203], v[68:71]
    v_mfma_f32_16x16x32_bf16 v[100:103], v[172:175], v[200:203], v[100:103]
    v_mfma_f32_16x16x32_bf16 v[72:75], v[168:171], v[204:207], v[72:75]
    v_mfma_f32_16x16x32_bf16 v[104:107], v[172:175], v[204:207], v[104:107]
    v_mfma_f32_16x16x32_bf16 v[76:79], v[168:171], v[208:211], v[76:79]
    v_mfma_f32_16x16x32_bf16 v[108:111], v[172:175], v[208:211], v[108:111]
    v_mfma_f32_16x16x32_bf16 v[80:83], v[168:171], v[212:215], v[80:83]
    v_mfma_f32_16x16x32_bf16 v[112:115], v[172:175], v[212:215], v[112:115]
    v_mfma_f32_16x16x32_bf16 v[84:87], v[168:171], v[216:219], v[84:87]
    v_mfma_f32_16x16x32_bf16 v[116:119], v[172:175], v[216:219], v[116:119]
    v_mfma_f32_16x16x32_bf16 v[88:91], v[168:171], v[220:223], v[88:91]
    v_mfma_f32_16x16x32_bf16 v[120:123], v[172:175], v[220:223], v[120:123]
    s_waitcnt lgkmcnt(2)
    s_nop 0
    v_mfma_f32_16x16x32_bf16 v[92:95], v[168:171], v[224:227], v[92:95]
    v_mfma_f32_16x16x32_bf16 v[124:127], v[172:175], v[224:227], v[124:127]
    buffer_load_dwordx4 v[168:171], v242, s[12:15], s23 offen offset:2048
    buffer_load_dwordx4 v[172:175], v242, s[12:15], s23 offen offset:3072
    s_waitcnt vmcnt(14)
    s_nop 0
    v_mfma_f32_16x16x32_bf16 v[64:67], v[176:179], v[200:203], v[64:67]
    v_mfma_f32_16x16x32_bf16 v[96:99], v[180:183], v[200:203], v[96:99]
    v_mfma_f32_16x16x32_bf16 v[68:71], v[176:179], v[204:207], v[68:71]
    v_mfma_f32_16x16x32_bf16 v[100:103], v[180:183], v[204:207], v[100:103]
    v_mfma_f32_16x16x32_bf16 v[72:75], v[176:179], v[208:211], v[72:75]
    v_mfma_f32_16x16x32_bf16 v[104:107], v[180:183], v[208:211], v[104:107]
    v_mfma_f32_16x16x32_bf16 v[76:79], v[176:179], v[212:215], v[76:79]
    v_mfma_f32_16x16x32_bf16 v[108:111], v[180:183], v[212:215], v[108:111]
    s_waitcnt lgkmcnt(0)
    s_barrier
    v_mfma_f32_16x16x32_bf16 v[80:83], v[176:179], v[216:219], v[80:83]
    v_mfma_f32_16x16x32_bf16 v[112:115], v[180:183], v[216:219], v[112:115]
    v_mfma_f32_16x16x32_bf16 v[84:87], v[176:179], v[220:223], v[84:87]
    v_mfma_f32_16x16x32_bf16 v[116:119], v[180:183], v[220:223], v[116:119]
    v_mfma_f32_16x16x32_bf16 v[88:91], v[176:179], v[224:227], v[88:91]
    ds_read_b128 v[192:195], v236 offset:0
    v_mfma_f32_16x16x32_bf16 v[120:123], v[180:183], v[224:227], v[120:123]
    v_mfma_f32_16x16x32_bf16 v[92:95], v[176:179], v[228:231], v[92:95]
    ds_read_b128 v[196:199], v236 offset:256
    v_mfma_f32_16x16x32_bf16 v[124:127], v[180:183], v[228:231], v[124:127]
    buffer_load_dwordx4 v[176:179], v243, s[12:15], s23 offen offset:0
    buffer_load_dwordx4 v[180:183], v243, s[12:15], s23 offen offset:1024
    s_waitcnt vmcnt(14)
    s_nop 0
    v_mfma_f32_16x16x32_bf16 v[64:67], v[184:187], v[204:207], v[64:67]
    ds_read_b128 v[200:203], v236 offset:512
    v_mfma_f32_16x16x32_bf16 v[96:99], v[188:191], v[204:207], v[96:99]
    v_mfma_f32_16x16x32_bf16 v[68:71], v[184:187], v[208:211], v[68:71]
    ds_read_b128 v[204:207], v236 offset:768
    v_mfma_f32_16x16x32_bf16 v[100:103], v[188:191], v[208:211], v[100:103]
    v_mfma_f32_16x16x32_bf16 v[72:75], v[184:187], v[212:215], v[72:75]
    ds_read_b128 v[208:211], v236 offset:1024
    v_mfma_f32_16x16x32_bf16 v[104:107], v[188:191], v[212:215], v[104:107]
    v_mfma_f32_16x16x32_bf16 v[76:79], v[184:187], v[216:219], v[76:79]
    ds_read_b128 v[212:215], v236 offset:1280
    v_mfma_f32_16x16x32_bf16 v[108:111], v[188:191], v[216:219], v[108:111]
    v_mfma_f32_16x16x32_bf16 v[80:83], v[184:187], v[220:223], v[80:83]
    ds_read_b128 v[216:219], v236 offset:1536
    v_mfma_f32_16x16x32_bf16 v[112:115], v[188:191], v[220:223], v[112:115]
    v_mfma_f32_16x16x32_bf16 v[84:87], v[184:187], v[224:227], v[84:87]
    ds_read_b128 v[220:223], v236 offset:1792
    v_mfma_f32_16x16x32_bf16 v[116:119], v[188:191], v[224:227], v[116:119]
    v_mfma_f32_16x16x32_bf16 v[88:91], v[184:187], v[228:231], v[88:91]
    ds_read_b128 v[224:227], v245 offset:0
    v_add_u32 v245, v247, v245
    s_nop 0
    v_mfma_f32_16x16x32_bf16 v[120:123], v[188:191], v[228:231], v[120:123]
    v_mfma_f32_16x16x32_bf16 v[92:95], v[184:187], v[232:235], v[92:95]
    ds_read_b128 v[228:231], v236 offset:272
    v_mfma_f32_16x16x32_bf16 v[124:127], v[188:191], v[232:235], v[124:127]
    buffer_load_dwordx4 v[184:187], v243, s[12:15], s23 offen offset:2048
    buffer_load_dwordx4 v[188:191], v243, s[12:15], s23 offen offset:3072
    s_add_u32 s23, s23, 73728
    s_sub_u32 s22, s22, 1
    s_cmp_lg_u32 s22, 0
    s_cbranch_scc1 L_conv2_kernel_mloop
    s_setprio 0
    s_nop 7
    s_waitcnt vmcnt(0) lgkmcnt(0)
    ds_write_b128 v244, v[0:3] offset:0
    ds_write_b128 v244, v[4:7] offset:1024
    ds_write_b128 v244, v[8:11] offset:2048
    ds_write_b128 v244, v[12:15] offset:3072
    ds_write_b128 v244, v[16:19] offset:4096
    ds_write_b128 v244, v[20:23] offset:5120
    ds_write_b128 v244, v[24:27] offset:6144
    ds_write_b128 v244, v[28:31] offset:7168
    ds_write_b128 v244, v[32:35] offset:8192
    ds_write_b128 v244, v[36:39] offset:9216
    ds_write_b128 v244, v[40:43] offset:10240
    ds_write_b128 v244, v[44:47] offset:11264
    ds_write_b128 v244, v[48:51] offset:12288
    ds_write_b128 v244, v[52:55] offset:13312
    ds_write_b128 v244, v[56:59] offset:14336
    ds_write_b128 v244, v[60:63] offset:15360
    ds_write_b128 v244, v[64:67] offset:16384
    ds_write_b128 v244, v[68:71] offset:17408
    ds_write_b128 v244, v[72:75] offset:18432
    ds_write_b128 v244, v[76:79] offset:19456
    ds_write_b128 v244, v[80:83] offset:20480
    ds_write_b128 v244, v[84:87] offset:21504
    ds_write_b128 v244, v[88:91] offset:22528
    ds_write_b128 v244, v[92:95] offset:23552
    ds_write_b128 v244, v[96:99] offset:24576
    ds_write_b128 v244, v[100:103] offset:25600
    ds_write_b128 v244, v[104:107] offset:26624
    ds_write_b128 v244, v[108:111] offset:27648
    ds_write_b128 v244, v[112:115] offset:28672
    ds_write_b128 v244, v[116:119] offset:29696
    ds_write_b128 v244, v[120:123] offset:30720
    ds_write_b128 v244, v[124:127] offset:31744
    s_branch L_conv2_kernel_epi
L_conv2_kernel_helper:
    v_add_u32 v232, 0, v7
    v_add_u32 v233, 1024, v7
    v_add_u32 v234, 2048, v7
    v_add_u32 v235, 3072, v7
    v_add_u32 v236, 4096, v7
    v_add_u32 v237, 5120, v7
    v_add_u32 v238, 6144, v7
    v_add_u32 v239, 7168, v7
    s_lshr_b32 s37, s32, 1
    s_lshl_b32 s38, s37, 9
    s_add_u32 s38, s38, 131072
    v_add_u32 v240, s38, v1
    s_cmp_eq_u32 s37, 0
    s_mov_b32 s38, 131088
    s_cselect_b32 s38, 132608, s38
    v_add_u32 v241, s38, v1
    s_mov_b32 s24, 0
    buffer_load_dwordx4 v[0:3], v232, s[8:11], s24 offen offset:0
    buffer_load_dwordx4 v[32:35], v232, s[8:11], s24 offen offset:64
    v_add_u32 v232, 128, v232
    buffer_load_dwordx4 v[4:7], v233, s[8:11], s24 offen offset:0
    buffer_load_dwordx4 v[36:39], v233, s[8:11], s24 offen offset:64
    v_add_u32 v233, 128, v233
    buffer_load_dwordx4 v[8:11], v234, s[8:11], s24 offen offset:0
    buffer_load_dwordx4 v[40:43], v234, s[8:11], s24 offen offset:64
    v_add_u32 v234, 128, v234
    buffer_load_dwordx4 v[12:15], v235, s[8:11], s24 offen offset:0
    buffer_load_dwordx4 v[44:47], v235, s[8:11], s24 offen offset:64
    v_add_u32 v235, 128, v235
    buffer_load_dwordx4 v[48:51], v236, s[8:11], s24 offen offset:64
    v_add_u32 v236, 128, v236
    buffer_load_dwordx4 v[52:55], v237, s[8:11], s24 offen offset:64
    v_add_u32 v237, 128, v237
    buffer_load_dwordx4 v[56:59], v238, s[8:11], s24 offen offset:64
    v_add_u32 v238, 128, v238
    buffer_load_dwordx4 v[60:63], v239, s[8:11], s24 offen offset:64
    v_add_u32 v239, 128, v239
    s_lshl_b32 s38, s37, 12
    s_and_b32 s39, s32, 1
    s_lshl_b32 s40, s39, 10
    s_add_u32 s38, s38, s40
    s_add_u32 s38, s38, 65536
    v_lshl_add_u32 v245, v255, 4, s38
    s_add_u32 s38, s37, 8
    s_lshl_b32 s38, s38, 14
    s_lshl_b32 s40, s39, 13
    s_add_u32 s38, s38, s40
    v_lshl_add_u32 v244, v255, 4, s38
    v_mov_b32 v128, 0
    v_mov_b32 v129, 0
    v_mov_b32 v130, 0
    v_mov_b32 v131, 0
    v_mov_b32 v132, 0
    v_mov_b32 v133, 0
    v_mov_b32 v134, 0
    v_mov_b32 v135, 0
    v_mov_b32 v136, 0
    v_mov_b32 v137, 0
    v_mov_b32 v138, 0
    v_mov_b32 v139, 0
    v_mov_b32 v140, 0
    v_mov_b32 v141, 0
    v_mov_b32 v142, 0
    v_mov_b32 v143, 0
    v_mov_b32 v144, 0
    v_mov_b32 v145, 0
    v_mov_b32 v146, 0
    v_mov_b32 v147, 0
    v_mov_b32 v148, 0
    v_mov_b32 v149, 0
    v_mov_b32 v150, 0
    v_mov_b32 v151, 0
    v_mov_b32 v152, 0
    v_mov_b32 v153, 0
    v_mov_b32 v154, 0
    v_mov_b32 v155, 0
    v_mov_b32 v156, 0
    v_mov_b32 v157, 0
    v_mov_b32 v158, 0
    v_mov_b32 v159, 0
    s_waitcnt vmcnt(4)
    v_lshlrev_b32 v204, 16, v0
    v_and_b32 v208, s25, v0
    ds_write_addtid_b32 v0 offset:0
    v_lshlrev_b32 v205, 16, v4
    v_and_b32 v209, s25, v4
    ds_write_addtid_b32 v4 offset:8192
    v_lshlrev_b32 v206, 16, v8
    v_and_b32 v210, s25, v8
    ds_write_addtid_b32 v8 offset:16384
    v_lshlrev_b32 v207, 16, v12
    v_and_b32 v211, s25, v12
    ds_write_addtid_b32 v12 offset:24576
    v_add_f32 v212, v204, v205
    v_add_f32 v216, v208, v209
    v_cvt_pk_bf16_f32 v220, v212, v216
    v_add_f32 v213, v206, v207
    v_add_f32 v217, v210, v211
    ds_write_addtid_b32 v220 offset:32768
    v_cvt_pk_bf16_f32 v221, v213, v217
    v_add_f32 v214, v204, v206
    v_add_f32 v218, v208, v210
    ds_write_addtid_b32 v221 offset:40960
    v_cvt_pk_bf16_f32 v222, v214, v218
    v_add_f32 v215, v205, v207
    v_add_f32 v219, v209, v211
    ds_write_addtid_b32 v222 offset:49152
    v_cvt_pk_bf16_f32 v223, v215, v219
    v_add_f32 v204, v212, v213
    v_add_f32 v208, v216, v217
    ds_write_addtid_b32 v223 offset:57344
    v_cvt_pk_bf16_f32 v224, v204, v208
    ds_write_b32 v249, v224 offset:0
    v_lshlrev_b32 v204, 16, v1
    v_and_b32 v208, s25, v1
    ds_write_addtid_b32 v1 offset:2048
    v_lshlrev_b32 v205, 16, v5
    v_and_b32 v209, s25, v5
    ds_write_addtid_b32 v5 offset:10240
    v_lshlrev_b32 v206, 16, v9
    v_and_b32 v210, s25, v9
    ds_write_addtid_b32 v9 offset:18432
    v_lshlrev_b32 v207, 16, v13
    v_and_b32 v211, s25, v13
    ds_write_addtid_b32 v13 offset:26624
    v_add_f32 v212, v204, v205
    v_add_f32 v216, v208, v209
    v_cvt_pk_bf16_f32 v225, v212, v216
    v_add_f32 v213, v206, v207
    v_add_f32 v217, v210, v211
    ds_write_addtid_b32 v225 offset:34816
    v_cvt_pk_bf16_f32 v226, v213, v217
    v_add_f32 v214, v204, v206
    v_add_f32 v218, v208, v210
    ds_write_addtid_b32 v226 offset:43008
    v_cvt_pk_bf16_f32 v227, v214, v218
    v_add_f32 v215, v205, v207
    v_add_f32 v219, v209, v211
    s_waitcnt lgkmcnt(8)
    ds_write_addtid_b32 v227 offset:51200
    v_cvt_pk_bf16_f32 v228, v215, v219
    v_add_f32 v204, v212, v213
    v_add_f32 v208, v216, v217
    ds_write_addtid_b32 v228 offset:59392
    v_cvt_pk_bf16_f32 v229, v204, v208
    ds_write_b32 v249, v229 offset:2048
    v_lshlrev_b32 v204, 16, v2
    v_and_b32 v208, s25, v2
    ds_write_addtid_b32 v2 offset:4096
    v_lshlrev_b32 v205, 16, v6
    v_and_b32 v209, s25, v6
    ds_write_addtid_b32 v6 offset:12288
    v_lshlrev_b32 v206, 16, v10
    v_and_b32 v210, s25, v10
    ds_write_addtid_b32 v10 offset:20480
    v_lshlrev_b32 v207, 16, v14
    v_and_b32 v211, s25, v14
    ds_write_addtid_b32 v14 offset:28672
    v_add_f32 v212, v204, v205
    v_add_f32 v216, v208, v209
    v_cvt_pk_bf16_f32 v220, v212, v216
    v_add_f32 v213, v206, v207
    v_add_f32 v217, v210, v211
    s_waitcnt lgkmcnt(8)
    ds_write_addtid_b32 v220 offset:36864
    v_cvt_pk_bf16_f32 v221, v213, v217
    v_add_f32 v214, v204, v206
    v_add_f32 v218, v208, v210
    ds_write_addtid_b32 v221 offset:45056
    v_cvt_pk_bf16_f32 v222, v214, v218
    v_add_f32 v215, v205, v207
    v_add_f32 v219, v209, v211
    ds_write_addtid_b32 v222 offset:53248
    v_cvt_pk_bf16_f32 v223, v215, v219
    v_add_f32 v204, v212, v213
    v_add_f32 v208, v216, v217
    ds_write_addtid_b32 v223 offset:61440
    v_cvt_pk_bf16_f32 v224, v204, v208
    ds_write_b32 v249, v224 offset:4096
    v_lshlrev_b32 v204, 16, v3
    v_and_b32 v208, s25, v3
    ds_write_addtid_b32 v3 offset:6144
    v_lshlrev_b32 v205, 16, v7
    v_and_b32 v209, s25, v7
    ds_write_addtid_b32 v7 offset:14336
    v_lshlrev_b32 v206, 16, v11
    v_and_b32 v210, s25, v11
    s_waitcnt lgkmcnt(8)
    ds_write_addtid_b32 v11 offset:22528
    v_lshlrev_b32 v207, 16, v15
    v_and_b32 v211, s25, v15
    ds_write_addtid_b32 v15 offset:30720
    v_add_f32 v212, v204, v205
    v_add_f32 v216, v208, v209
    v_cvt_pk_bf16_f32 v225, v212, v216
    v_add_f32 v213, v206, v207
    v_add_f32 v217, v210, v211
    ds_write_addtid_b32 v225 offset:38912
    v_cvt_pk_bf16_f32 v226, v213, v217
    v_add_f32 v214, v204, v206
    v_add_f32 v218, v208, v210
    ds_write_addtid_b32 v226 offset:47104
    v_cvt_pk_bf16_f32 v227, v214, v218
    v_add_f32 v215, v205, v207
    v_add_f32 v219, v209, v211
    ds_write_addtid_b32 v227 offset:55296
    v_cvt_pk_bf16_f32 v228, v215, v219
    v_add_f32 v204, v212, v213
    v_add_f32 v208, v216, v217
    ds_write_addtid_b32 v228 offset:63488
    v_cvt_pk_bf16_f32 v229, v204, v208
    ds_write_b32 v249, v229 offset:6144
    buffer_load_dwordx4 v[64:67], v232, s[8:11], s24 offen offset:0
    buffer_load_dwordx4 v[96:99], v232, s[8:11], s24 offen offset:64
    v_add_u32 v232, 128, v232
    buffer_load_dwordx4 v[68:71], v233, s[8:11], s24 offen offset:0
    buffer_load_dwordx4 v[100:103], v233, s[8:11], s24 offen offset:64
    v_add_u32 v233, 128, v233
    buffer_load_dwordx4 v[72:75], v234, s[8:11], s24 offen offset:0
    buffer_load_dwordx4 v[104:107], v234, s[8:11], s24 offen offset:64
    v_add_u32 v234, 128, v234
    buffer_load_dwordx4 v[76:79], v235, s[8:11], s24 offen offset:0
    buffer_load_dwordx4 v[108:111], v235, s[8:11], s24 offen offset:64
    v_add_u32 v235, 128, v235
    buffer_load_dwordx4 v[80:83], v236, s[8:11], s24 offen offset:0
    buffer_load_dwordx4 v[112:115], v236, s[8:11], s24 offen offset:64
    v_add_u32 v236, 128, v236
    buffer_load_dwordx4 v[84:87], v237, s[8:11], s24 offen offset:0
    buffer_load_dwordx4 v[116:119], v237, s[8:11], s24 offen offset:64
    v_add_u32 v237, 128, v237
    s_mov_b32 s23, 0
    buffer_load_dwordx4 v[160:163], v245, s[12:15], s23 offen offset:0
    buffer_load_dwordx4 v[164:167], v245, s[12:15], s23 offen offset:2048
    s_mov_b32 s23, 73728
    s_mov_b32 s28, 0
    s_mov_b32 s22, 2
    s_waitcnt vmcnt(14) lgkmcnt(0)
    s_barrier
    s_setprio 1
L_conv2_kernel_hloop:
    s_mov_b32 m0, s27
    ds_read_b128 v[168:171], v240 offset:0
    ds_read_b128 v[172:175], v240 offset:256
    ds_read_b128 v[176:179], v240 offset:512
    ds_read_b128 v[180:183], v240 offset:768
    ds_read_b128 v[184:187], v240 offset:1024
    ds_read_b128 v[188:191], v240 offset:1280
    ds_read_b128 v[192:195], v241 offset:0
    ds_read_b128 v[196:199], v241 offset:256
    ds_read_b128 v[200:203], v240 offset:16
    v_lshlrev_b32 v204, 16, v32
    v_and_b32 v208, s25, v32
    ds_write_addtid_b32 v32 offset:1540
    v_lshlrev_b32 v205, 16, v36
    v_and_b32 v209, s25, v36
    ds_write_addtid_b32 v36 offset:9732
    v_lshlrev_b32 v206, 16, v40
    v_and_b32 v210, s25, v40
    ds_write_addtid_b32 v40 offset:17924
    v_lshlrev_b32 v207, 16, v44
    v_and_b32 v211, s25, v44
    ds_write_addtid_b32 v44 offset:26116
    v_add_f32 v212, v204, v205
    v_add_f32 v216, v208, v209
    v_cvt_pk_bf16_f32 v220, v212, v216
    v_add_f32 v213, v206, v207
    v_add_f32 v217, v210, v211
    ds_write_addtid_b32 v220 offset:34308
    v_cvt_pk_bf16_f32 v221, v213, v217
    v_add_f32 v214, v204, v206
    v_add_f32 v218, v208, v210
    ds_write_addtid_b32 v221 offset:42500
    v_cvt_pk_bf16_f32 v222, v214, v218
    v_add_f32 v215, v205, v207
    v_add_f32 v219, v209, v211
    s_waitcnt lgkmcnt(8)
    ds_write_addtid_b32 v222 offset:50692
    v_cvt_pk_bf16_f32 v223, v215, v219
    v_add_f32 v204, v212, v213
    v_add_f32 v208, v216, v217
    ds_write_addtid_b32 v223 offset:58884
    v_cvt_pk_bf16_f32 v224, v204, v208
    ds_write_b32 v249, v224 offset:8192
    v_lshlrev_b32 v204, 16, v33
    v_and_b32 v208, s25, v33
    ds_write_addtid_b32 v33 offset:3588
    v_lshlrev_b32 v205, 16, v37
    v_and_b32 v209, s25, v37
    ds_write_addtid_b32 v37 offset:11780
    s_cmp_lt_i32 s28, 5
    s_cselect_b32 s24, 0, 2130706432
    buffer_load_dwordx4 v[88:91], v238, s[8:11], s24 offen offset:0
    buffer_load_dwordx4 v[120:123], v238, s[8:11], s24 offen offset:64
    v_add_u32 v238, 128, v238
    v_lshlrev_b32 v206, 16, v41
    v_and_b32 v210, s25, v41
    ds_write_addtid_b32 v41 offset:19972
    v_lshlrev_b32 v207, 16, v45
    v_and_b32 v211, s25, v45
    ds_write_addtid_b32 v45 offset:28164
    v_add_f32 v212, v204, v205
    v_add_f32 v216, v208, v209
    v_cvt_pk_bf16_f32 v225, v212, v216
    v_add_f32 v213, v206, v207
    v_add_f32 v217, v210, v211
    s_waitcnt lgkmcnt(8)
    ds_write_addtid_b32 v225 offset:36356
    v_cvt_pk_bf16_f32 v226, v213, v217
    s_waitcnt vmcnt(2)
    v_mfma_f32_16x16x32_bf16 v[128:131], v[160:163], v[168:171], v[128:131]
    v_add_f32 v214, v204, v206
    v_add_f32 v218, v208, v210
    ds_write_addtid_b32 v226 offset:44548
    v_cvt_pk_bf16_f32 v227, v214, v218
    v_add_f32 v215, v205, v207
    v_add_f32 v219, v209, v211
    ds_write_addtid_b32 v227 offset:52740
    v_cvt_pk_bf16_f32 v228, v215, v219
    v_add_f32 v204, v212, v213
    v_add_f32 v208, v216, v217
    ds_write_addtid_b32 v228 offset:60932
    v_cvt_pk_bf16_f32 v229, v204, v208
    ds_write_b32 v249, v229 offset:10240
    v_lshlrev_b32 v204, 16, v34
    v_and_b32 v208, s25, v34
    ds_write_addtid_b32 v34 offset:5636
    v_lshlrev_b32 v205, 16, v38
    v_and_b32 v209, s25, v38
    ds_write_addtid_b32 v38 offset:13828
    v_lshlrev_b32 v206, 16, v42
    v_and_b32 v210, s25, v42
    s_waitcnt lgkmcnt(8)
    ds_write_addtid_b32 v42 offset:22020
    v_mfma_f32_16x16x32_bf16 v[132:135], v[160:163], v[172:175], v[132:135]
    v_mfma_f32_16x16x32_bf16 v[128:131], v[164:167], v[172:175], v[128:131]
    v_lshlrev_b32 v207, 16, v46
    v_and_b32 v211, s25, v46
    ds_write_addtid_b32 v46 offset:30212
    v_add_f32 v212, v204, v205
    v_add_f32 v216, v208, v209
    v_cvt_pk_bf16_f32 v220, v212, v216
    v_add_f32 v213, v206, v207
    v_add_f32 v217, v210, v211
    ds_write_addtid_b32 v220 offset:38404
    v_cvt_pk_bf16_f32 v221, v213, v217
    v_add_f32 v214, v204, v206
    v_add_f32 v218, v208, v210
    ds_write_addtid_b32 v221 offset:46596
    v_cvt_pk_bf16_f32 v222, v214, v218
    v_add_f32 v215, v205, v207
    v_add_f32 v219, v209, v211
    buffer_load_dwordx4 v[92:95], v239, s[8:11], s24 offen offset:0
    buffer_load_dwordx4 v[124:127], v239, s[8:11], s24 offen offset:64
    v_add_u32 v239, 128, v239
    ds_write_addtid_b32 v222 offset:54788
    v_cvt_pk_bf16_f32 v223, v215, v219
    v_add_f32 v204, v212, v213
    v_add_f32 v208, v216, v217
    ds_write_addtid_b32 v223 offset:62980
    v_cvt_pk_bf16_f32 v224, v204, v208
    ds_write_b32 v249, v224 offset:12288
    v_mfma_f32_16x16x32_bf16 v[136:139], v[160:163], v[176:179], v[136:139]
    v_mfma_f32_16x16x32_bf16 v[132:135], v[164:167], v[176:179], v[132:135]
    v_lshlrev_b32 v204, 16, v35
    v_and_b32 v208, s25, v35
    s_waitcnt lgkmcnt(8)
    ds_write_addtid_b32 v35 offset:7684
    v_lshlrev_b32 v205, 16, v39
    v_and_b32 v209, s25, v39
    ds_write_addtid_b32 v39 offset:15876
    v_lshlrev_b32 v206, 16, v43
    v_and_b32 v210, s25, v43
    ds_write_addtid_b32 v43 offset:24068
    v_lshlrev_b32 v207, 16, v47
    v_and_b32 v211, s25, v47
    ds_write_addtid_b32 v47 offset:32260
    v_add_f32 v212, v204, v205
    v_add_f32 v216, v208, v209
    v_cvt_pk_bf16_f32 v225, v212, v216
    v_add_f32 v213, v206, v207
    v_add_f32 v217, v210, v211
    ds_write_addtid_b32 v225 offset:40452
    v_cvt_pk_bf16_f32 v226, v213, v217
    v_add_f32 v214, v204, v206
    v_add_f32 v218, v208, v210
    ds_write_addtid_b32 v226 offset:48644
    v_mfma_f32_16x16x32_bf16 v[140:143], v[160:163], v[180:183], v[140:143]
    v_mfma_f32_16x16x32_bf16 v[136:139], v[164:167], v[180:183], v[136:139]
    v_cvt_pk_bf16_f32 v227, v214, v218
    v_add_f32 v215, v205, v207
    v_add_f32 v219, v209, v211
    ds_write_addtid_b32 v227 offset:56836
    v_cvt_pk_bf16_f32 v228, v215, v219
    v_add_f32 v204, v212, v213
    v_add_f32 v208, v216, v217
    s_waitcnt lgkmcnt(8)
    ds_write_addtid_b32 v228 offset:65028
    v_cvt_pk_bf16_f32 v229, v204, v208
    ds_write_b32 v249, v229 offset:14336
    v_lshlrev_b32 v204, 16, v48
    v_and_b32 v208, s25, v48
    ds_write_addtid_b32 v48 offset:1796
    v_lshlrev_b32 v205, 16, v52
    v_and_b32 v209, s25, v52
    ds_write_addtid_b32 v52 offset:9988
    v_lshlrev_b32 v206, 16, v56
    v_and_b32 v210, s25, v56
    ds_write_addtid_b32 v56 offset:18180
    v_lshlrev_b32 v207, 16, v60
    v_and_b32 v211, s25, v60
    ds_write_addtid_b32 v60 offset:26372
    v_mfma_f32_16x16x32_bf16 v[144:147], v[160:163], v[184:187], v[144:147]
    v_mfma_f32_16x16x32_bf16 v[140:143], v[164:167], v[184:187], v[140:143]
    v_add_f32 v212, v204, v205
    v_add_f32 v216, v208, v209
    v_cvt_pk_bf16_f32 v220, v212, v216
    v_add_f32 v213, v206, v207
    v_add_f32 v217, v210, v211
    ds_write_addtid_b32 v220 offset:34564
    v_cvt_pk_bf16_f32 v221, v213, v217
    v_add_f32 v214, v204, v206
    v_add_f32 v218, v208, v210
    s_waitcnt lgkmcnt(8)
    ds_write_addtid_b32 v221 offset:42756
    v_cvt_pk_bf16_f32 v222, v214, v218
    v_add_f32 v215, v205, v207
    v_add_f32 v219, v209, v211
    s_cmp_lt_i32 s28, 4
    s_cselect_b32 s24, 0, 2130706432
    buffer_load_dwordx4 v[0:3], v232, s[8:11], s24 offen offset:0
    buffer_load_dwordx4 v[32:35], v232, s[8:11], s24 offen offset:64
    v_add_u32 v232, 128, v232
    ds_write_addtid_b32 v222 offset:50948
    v_cvt_pk_bf16_f32 v223, v215, v219
    v_add_f32 v204, v212, v213
    v_add_f32 v208, v216, v217
    ds_write_addtid_b32 v223 offset:59140
    v_cvt_pk_bf16_f32 v224, v204, v208
    ds_write_b32 v249, v224 offset:8448
    v_lshlrev_b32 v204, 16, v49
    v_and_b32 v208, s25, v49
    ds_write_addtid_b32 v49 offset:3844
    v_mfma_f32_16x16x32_bf16 v[148:151], v[160:163], v[188:191], v[148:151]
    v_mfma_f32_16x16x32_bf16 v[144:147], v[164:167], v[188:191], v[144:147]
    v_lshlrev_b32 v205, 16, v53
    v_and_b32 v209, s25, v53
    ds_write_addtid_b32 v53 offset:12036
    v_lshlrev_b32 v206, 16, v57
    v_and_b32 v210, s25, v57
    ds_write_addtid_b32 v57 offset:20228
    v_lshlrev_b32 v207, 16, v61
    v_and_b32 v211, s25, v61
    s_waitcnt lgkmcnt(8)
    ds_write_addtid_b32 v61 offset:28420
    v_add_f32 v212, v204, v205
    v_add_f32 v216, v208, v209
    v_cvt_pk_bf16_f32 v225, v212, v216
    v_add_f32 v213, v206, v207
    v_add_f32 v217, v210, v211
    ds_write_addtid_b32 v225 offset:36612
    v_cvt_pk_bf16_f32 v226, v213, v217
    v_add_f32 v214, v204, v206
    v_add_f32 v218, v208, v210
    ds_write_addtid_b32 v226 offset:44804
    v_cvt_pk_bf16_f32 v227, v214, v218
    v_add_f32 v215, v205, v207
    v_add_f32 v219, v209, v211
    v_mfma_f32_16x16x32_bf16 v[152:155], v[160:163], v[192:195], v[152:155]
    v_mfma_f32_16x16x32_bf16 v[148:151], v[164:167], v[192:195], v[148:151]
    ds_write_addtid_b32 v227 offset:52996
    v_cvt_pk_bf16_f32 v228, v215, v219
    v_add_f32 v204, v212, v213
    v_add_f32 v208, v216, v217
    ds_write_addtid_b32 v228 offset:61188
    v_cvt_pk_bf16_f32 v229, v204, v208
    ds_write_b32 v249, v229 offset:10496
    v_lshlrev_b32 v204, 16, v50
    v_and_b32 v208, s25, v50
    ds_write_addtid_b32 v50 offset:5892
    v_lshlrev_b32 v205, 16, v54
    v_and_b32 v209, s25, v54
    s_waitcnt lgkmcnt(8)
    ds_write_addtid_b32 v54 offset:14084
    v_lshlrev_b32 v206, 16, v58
    v_and_b32 v210, s25, v58
    ds_write_addtid_b32 v58 offset:22276
    v_lshlrev_b32 v207, 16, v62
    v_and_b32 v211, s25, v62
    ds_write_addtid_b32 v62 offset:30468
    buffer_load_dwordx4 v[4:7], v233, s[8:11], s24 offen offset:0
    buffer_load_dwordx4 v[36:39], v233, s[8:11], s24 offen offset:64
    v_add_u32 v233, 128, v233
    v_add_f32 v212, v204, v205
    v_add_f32 v216, v208, v209
    v_cvt_pk_bf16_f32 v220, v212, v216
    v_add_f32 v213, v206, v207
    v_mfma_f32_16x16x32_bf16 v[156:159], v[160:163], v[196:199], v[156:159]
    v_mfma_f32_16x16x32_bf16 v[152:155], v[164:167], v[196:199], v[152:155]
    v_add_f32 v217, v210, v211
    ds_write_addtid_b32 v220 offset:38660
    v_cvt_pk_bf16_f32 v221, v213, v217
    v_add_f32 v214, v204, v206
    v_add_f32 v218, v208, v210
    ds_write_addtid_b32 v221 offset:46852
    v_cvt_pk_bf16_f32 v222, v214, v218
    v_add_f32 v215, v205, v207
    v_add_f32 v219, v209, v211
    ds_write_addtid_b32 v222 offset:55044
    v_cvt_pk_bf16_f32 v223, v215, v219
    v_add_f32 v204, v212, v213
    v_add_f32 v208, v216, v217
    ds_write_addtid_b32 v223 offset:63236
    v_cvt_pk_bf16_f32 v224, v204, v208
    s_waitcnt lgkmcnt(8)
    ds_write_b32 v249, v224 offset:12544
    v_lshlrev_b32 v204, 16, v51
    v_and_b32 v208, s25, v51
    ds_write_addtid_b32 v51 offset:7940
    v_lshlrev_b32 v205, 16, v55
    v_and_b32 v209, s25, v55
    ds_write_addtid_b32 v55 offset:16132
    v_mfma_f32_16x16x32_bf16 v[156:159], v[164:167], v[200:203], v[156:159]
    buffer_load_dwordx4 v[160:163], v245, s[12:15], s23 offen offset:0
    buffer_load_dwordx4 v[164:167], v245, s[12:15], s23 offen offset:2048
    v_lshlrev_b32 v206, 16, v59
    v_and_b32 v210, s25, v59
    ds_write_addtid_b32 v59 offset:24324
    v_lshlrev_b32 v207, 16, v63
    v_and_b32 v211, s25, v63
    ds_write_addtid_b32 v63 offset:32516
    v_add_f32 v212, v204, v205
    v_add_f32 v216, v208, v209
    v_cvt_pk_bf16_f32 v225, v212, v216
    v_add_f32 v213, v206, v207
    v_add_f32 v217, v210, v211
    ds_write_addtid_b32 v225 offset:40708
    v_cvt_pk_bf16_f32 v226, v213, v217
    v_add_f32 v214, v204, v206
    v_add_f32 v218, v208, v210
    ds_write_addtid_b32 v226 offset:48900
    v_cvt_pk_bf16_f32 v227, v214, v218
    v_add_f32 v215, v205, v207
    v_add_f32 v219, v209, v211
    s_waitcnt lgkmcnt(8)
    ds_write_addtid_b32 v227 offset:57092
    v_cvt_pk_bf16_f32 v228, v215, v219
    v_add_f32 v204, v212, v213
    v_add_f32 v208, v216, v217
    ds_write_addtid_b32 v228 offset:65284
    v_cvt_pk_bf16_f32 v229, v204, v208
    ds_write_b32 v249, v229 offset:14592
    s_add_u32 s23, s23, 73728
    s_add_u32 s28, s28, 1
    s_waitcnt lgkmcnt(0)
    s_barrier
    s_mov_b32 m0, s26
    ds_read_b128 v[168:171], v240 offset:8192
    ds_read_b128 v[172:175], v240 offset:8448
    ds_read_b128 v[176:179], v240 offset:8704
    ds_read_b128 v[180:183], v240 offset:8960
    ds_read_b128 v[184:187], v240 offset:9216
    ds_read_b128 v[188:191], v240 offset:9472
    ds_read_b128 v[192:195], v241 offset:8192
    ds_read_b128 v[196:199], v241 offset:8448
    ds_read_b128 v[200:203], v240 offset:8208
    v_lshlrev_b32 v204, 16, v64
    v_and_b32 v208, s25, v64
    ds_write_addtid_b32 v64 offset:0
    v_lshlrev_b32 v205, 16, v68
    v_and_b32 v209, s25, v68
    ds_write_addtid_b32 v68 offset:8192
    v_lshlrev_b32 v206, 16, v72
    v_and_b32 v210, s25, v72
    ds_write_addtid_b32 v72 offset:16384
    v_lshlrev_b32 v207, 16, v76
    v_and_b32 v211, s25, v76
    ds_write_addtid_b32 v76 offset:24576
    v_add_f32 v212, v204, v205
    v_add_f32 v216, v208, v209
    v_cvt_pk_bf16_f32 v220, v212, v216
    v_add_f32 v213, v206, v207
    v_add_f32 v217, v210, v211
    ds_write_addtid_b32 v220 offset:32768
    v_cvt_pk_bf16_f32 v221, v213, v217
    v_add_f32 v214, v204, v206
    v_add_f32 v218, v208, v210
    ds_write_addtid_b32 v221 offset:40960
    v_cvt_pk_bf16_f32 v222, v214, v218
    v_add_f32 v215, v205, v207
    v_add_f32 v219, v209, v211
    s_waitcnt lgkmcnt(8)
    ds_write_addtid_b32 v222 offset:49152
    v_cvt_pk_bf16_f32 v223, v215, v219
    v_add_f32 v204, v212, v213
    v_add_f32 v208, v216, v217
    ds_write_addtid_b32 v223 offset:57344
    v_cvt_pk_bf16_f32 v224, v204, v208
    ds_write_b32 v249, v224 offset:0
    v_lshlrev_b32 v204, 16, v65
    v_and_b32 v208, s25, v65
    ds_write_addtid_b32 v65 offset:2048
    v_lshlrev_b32 v205, 16, v69
    v_and_b32 v209, s25, v69
    ds_write_addtid_b32 v69 offset:10240
    s_cmp_lt_i32 s28, 5
    s_cselect_b32 s24, 0, 2130706432
    buffer_load_dwordx4 v[8:11], v234, s[8:11], s24 offen offset:0
    buffer_load_dwordx4 v[40:43], v234, s[8:11], s24 offen offset:64
    v_add_u32 v234, 128, v234
    v_lshlrev_b32 v206, 16, v73
    v_and_b32 v210, s25, v73
    ds_write_addtid_b32 v73 offset:18432
    v_lshlrev_b32 v207, 16, v77
    v_and_b32 v211, s25, v77
    ds_write_addtid_b32 v77 offset:26624
    v_add_f32 v212, v204, v205
    v_add_f32 v216, v208, v209
    v_cvt_pk_bf16_f32 v225, v212, v216
    v_add_f32 v213, v206, v207
    v_add_f32 v217, v210, v211
    s_waitcnt lgkmcnt(8)
    ds_write_addtid_b32 v225 offset:34816
    v_cvt_pk_bf16_f32 v226, v213, v217
    s_waitcnt vmcnt(2)
    v_mfma_f32_16x16x32_bf16 v[128:131], v[160:163], v[168:171], v[128:131]
    v_add_f32 v214, v204, v206
    v_add_f32 v218, v208, v210
    ds_write_addtid_b32 v226 offset:43008
    v_cvt_pk_bf16_f32 v227, v214, v218
    v_add_f32 v215, v205, v207
    v_add_f32 v219, v209, v211
    ds_write_addtid_b32 v227 offset:51200
    v_cvt_pk_bf16_f32 v228, v215, v219
    v_add_f32 v204, v212, v213
    v_add_f32 v208, v216, v217
    ds_write_addtid_b32 v228 offset:59392
    v_cvt_pk_bf16_f32 v229, v204, v208
    ds_write_b32 v249, v229 offset:2048
    v_lshlrev_b32 v204, 16, v66
    v_and_b32 v208, s25, v66
    ds_write_addtid_b32 v66 offset:4096
    v_lshlrev_b32 v205, 16, v70
    v_and_b32 v209, s25, v70
    ds_write_addtid_b32 v70 offset:12288
    v_lshlrev_b32 v206, 16, v74
    v_and_b32 v210, s25, v74
    s_waitcnt lgkmcnt(8)
    ds_write_addtid_b32 v74 offset:20480
    v_mfma_f32_16x16x32_bf16 v[132:135], v[160:163], v[172:175], v[132:135]
    v_mfma_f32_16x16x32_bf16 v[128:131], v[164:167], v[172:175], v[128:131]
    v_lshlrev_b32 v207, 16, v78
    v_and_b32 v211, s25, v78
    ds_write_addtid_b32 v78 offset:28672
    v_add_f32 v212, v204, v205
    v_add_f32 v216, v208, v209
    v_cvt_pk_bf16_f32 v220, v212, v216
    v_add_f32 v213, v206, v207
    v_add_f32 v217, v210, v211
    ds_write_addtid_b32 v220 offset:36864
    v_cvt_pk_bf16_f32 v221, v213, v217
    v_add_f32 v214, v204, v206
    v_add_f32 v218, v208, v210
    ds_write_addtid_b32 v221 offset:45056
    v_cvt_pk_bf16_f32 v222, v214, v218
    v_add_f32 v215, v205, v207
    v_add_f32 v219, v209, v211
    buffer_load_dwordx4 v[12:15], v235, s[8:11], s24 offen offset:0
    buffer_load_dwordx4 v[44:47], v235, s[8:11], s24 offen offset:64
    v_add_u32 v235, 128, v235
    ds_write_addtid_b32 v222 offset:53248
    v_cvt_pk_bf16_f32 v223, v215, v219
    v_add_f32 v204, v212, v213
    v_add_f32 v208, v216, v217
    ds_write_addtid_b32 v223 offset:61440
    v_cvt_pk_bf16_f32 v224, v204, v208
    ds_write_b32 v249, v224 offset:4096
    v_mfma_f32_16x16x32_bf16 v[136:139], v[160:163], v[176:179], v[136:139]
    v_mfma_f32_16x16x32_bf16 v[132:135], v[164:167], v[176:179], v[132:135]
    v_lshlrev_b32 v204, 16, v67
    v_and_b32 v208, s25, v67
    s_waitcnt lgkmcnt(8)
    ds_write_addtid_b32 v67 offset:6144
    v_lshlrev_b32 v205, 16, v71
    v_and_b32 v209, s25, v71
    ds_write_addtid_b32 v71 offset:14336
    v_lshlrev_b32 v206, 16, v75
    v_and_b32 v210, s25, v75
    ds_write_addtid_b32 v75 offset:22528
    v_lshlrev_b32 v207, 16, v79
    v_and_b32 v211, s25, v79
    ds_write_addtid_b32 v79 offset:30720
    v_add_f32 v212, v204, v205
    v_add_f32 v216, v208, v209
    v_cvt_pk_bf16_f32 v225, v212, v216
    v_add_f32 v213, v206, v207
    v_add_f32 v217, v210, v211
    ds_write_addtid_b32 v225 offset:38912
    v_cvt_pk_bf16_f32 v226, v213, v217
    v_add_f32 v214, v204, v206
    v_add_f32 v218, v208, v210
    ds_write_addtid_b32 v226 offset:47104
    v_mfma_f32_16x16x32_bf16 v[140:143], v[160:163], v[180:183], v[140:143]
    v_mfma_f32_16x16x32_bf16 v[136:139], v[164:167], v[180:183], v[136:139]
    v_cvt_pk_bf16_f32 v227, v214, v218
    v_add_f32 v215, v205, v207
    v_add_f32 v219, v209, v211
    ds_write_addtid_b32 v227 offset:55296
    v_cvt_pk_bf16_f32 v228, v215, v219
    v_add_f32 v204, v212, v213
    v_add_f32 v208, v216, v217
    s_waitcnt lgkmcnt(8)
    ds_write_addtid_b32 v228 offset:63488
    v_cvt_pk_bf16_f32 v229, v204, v208
    ds_write_b32 v249, v229 offset:6144
    v_lshlrev_b32 v204, 16, v80
    v_and_b32 v208, s25, v80
    ds_write_addtid_b32 v80 offset:256
    v_lshlrev_b32 v205, 16, v84
    v_and_b32 v209, s25, v84
    ds_write_addtid_b32 v84 offset:8448
    v_lshlrev_b32 v206, 16, v88
    v_and_b32 v210, s25, v88
    ds_write_addtid_b32 v88 offset:16640
    v_lshlrev_b32 v207, 16, v92
    v_and_b32 v211, s25, v92
    ds_write_addtid_b32 v92 offset:24832
    v_mfma_f32_16x16x32_bf16 v[144:147], v[160:163], v[184:187], v[144:147]
    v_mfma_f32_16x16x32_bf16 v[140:143], v[164:167], v[184:187], v[140:143]
    v_add_f32 v212, v204, v205
    v_add_f32 v216, v208, v209
    v_cvt_pk_bf16_f32 v220, v212, v216
    v_add_f32 v213, v206, v207
    v_add_f32 v217, v210, v211
    ds_write_addtid_b32 v220 offset:33024
    v_cvt_pk_bf16_f32 v221, v213, v217
    v_add_f32 v214, v204, v206
    v_add_f32 v218, v208, v210
    s_waitcnt lgkmcnt(8)
    ds_write_addtid_b32 v221 offset:41216
    v_cvt_pk_bf16_f32 v222, v214, v218
    v_add_f32 v215, v205, v207
    v_add_f32 v219, v209, v211
    s_cmp_lt_i32 s28, 4
    s_cselect_b32 s24, 0, 2130706432
    buffer_load_dwordx4 v[16:19], v236, s[8:11], s24 offen offset:0
    buffer_load_dwordx4 v[48:51], v236, s[8:11], s24 offen offset:64
    v_add_u32 v236, 128, v236
    ds_write_addtid_b32 v222 offset:49408
    v_cvt_pk_bf16_f32 v223, v215, v219
    v_add_f32 v204, v212, v213
    v_add_f32 v208, v216, v217
    ds_write_addtid_b32 v223 offset:57600
    v_cvt_pk_bf16_f32 v224, v204, v208
    ds_write_b32 v249, v224 offset:256
    v_lshlrev_b32 v204, 16, v81
    v_and_b32 v208, s25, v81
    ds_write_addtid_b32 v81 offset:2304
    v_mfma_f32_16x16x32_bf16 v[148:151], v[160:163], v[188:191], v[148:151]
    v_mfma_f32_16x16x32_bf16 v[144:147], v[164:167], v[188:191], v[144:147]
    v_lshlrev_b32 v205, 16, v85
    v_and_b32 v209, s25, v85
    ds_write_addtid_b32 v85 offset:10496
    v_lshlrev_b32 v206, 16, v89
    v_and_b32 v210, s25, v89
    ds_write_addtid_b32 v89 offset:18688
    v_lshlrev_b32 v207, 16, v93
    v_and_b32 v211, s25, v93
    s_waitcnt lgkmcnt(8)
    ds_write_addtid_b32 v93 offset:26880
    v_add_f32 v212, v204, v205
    v_add_f32 v216, v208, v209
    v_cvt_pk_bf16_f32 v225, v212, v216
    v_add_f32 v213, v206, v207
    v_add_f32 v217, v210, v211
    ds_write_addtid_b32 v225 offset:35072
    v_cvt_pk_bf16_f32 v226, v213, v217
    v_add_f32 v214, v204, v206
    v_add_f32 v218, v208, v210
    ds_write_addtid_b32 v226 offset:43264
    v_cvt_pk_bf16_f32 v227, v214, v218
    v_add_f32 v215, v205, v207
    v_add_f32 v219, v209, v211
    v_mfma_f32_16x16x32_bf16 v[152:155], v[160:163], v[192:195], v[152:155]
    v_mfma_f32_16x16x32_bf16 v[148:151], v[164:167], v[192:195], v[148:151]
    ds_write_addtid_b32 v227 offset:51456
    v_cvt_pk_bf16_f32 v228, v215, v219
    v_add_f32 v204, v212, v213
    v_add_f32 v208, v216, v217
    ds_write_addtid_b32 v228 offset:59648
    v_cvt_pk_bf16_f32 v229, v204, v208
    ds_write_b32 v249, v229 offset:2304
    v_lshlrev_b32 v204, 16, v82
    v_and_b32 v208, s25, v82
    ds_write_addtid_b32 v82 offset:4352
    v_lshlrev_b32 v205, 16, v86
    v_and_b32 v209, s25, v86
    s_waitcnt lgkmcnt(8)
    ds_write_addtid_b32 v86 offset:12544
    v_lshlrev_b32 v206, 16, v90
    v_and_b32 v210, s25, v90
    ds_write_addtid_b32 v90 offset:20736
    v_lshlrev_b32 v207, 16, v94
    v_and_b32 v211, s25, v94
    ds_write_addtid_b32 v94 offset:28928
    buffer_load_dwordx4 v[20:23], v237, s[8:11], s24 offen offset:0
    buffer_load_dwordx4 v[52:55], v237, s[8:11], s24 offen offset:64
    v_add_u32 v237, 128, v237
    v_add_f32 v212, v204, v205
    v_add_f32 v216, v208, v209
    v_cvt_pk_bf16_f32 v220, v212, v216
    v_add_f32 v213, v206, v207
    v_mfma_f32_16x16x32_bf16 v[156:159], v[160:163], v[196:199], v[156:159]
    v_mfma_f32_16x16x32_bf16 v[152:155], v[164:167], v[196:199], v[152:155]
    v_add_f32 v217, v210, v211
    ds_write_addtid_b32 v220 offset:37120
    v_cvt_pk_bf16_f32 v221, v213, v217
    v_add_f32 v214, v204, v206
    v_add_f32 v218, v208, v210
    ds_write_addtid_b32 v221 offset:45312
    v_cvt_pk_bf16_f32 v222, v214, v218
    v_add_f32 v215, v205, v207
    v_add_f32 v219, v209, v211
    ds_write_addtid_b32 v222 offset:53504
    v_cvt_pk_bf16_f32 v223, v215, v219
    v_add_f32 v204, v212, v213
    v_add_f32 v208, v216, v217
    ds_write_addtid_b32 v223 offset:61696
    v_cvt_pk_bf16_f32 v224, v204, v208
    s_waitcnt lgkmcnt(8)
    ds_write_b32 v249, v224 offset:4352
    v_lshlrev_b32 v204, 16, v83
    v_and_b32 v208, s25, v83
    ds_write_addtid_b32 v83 offset:6400
    v_lshlrev_b32 v205, 16, v87
    v_and_b32 v209, s25, v87
    ds_write_addtid_b32 v87 offset:14592
    v_mfma_f32_16x16x32_bf16 v[156:159], v[164:167], v[200:203], v[156:159]
    buffer_load_dwordx4 v[160:163], v245, s[12:15], s23 offen offset:0
    buffer_load_dwordx4 v[164:167], v245, s[12:15], s23 offen offset:2048
    v_lshlrev_b32 v206, 16, v91
    v_and_b32 v210, s25, v91
    ds_write_addtid_b32 v91 offset:22784
    v_lshlrev_b32 v207, 16, v95
    v_and_b32 v211, s25, v95
    ds_write_addtid_b32 v95 offset:30976
    v_add_f32 v212, v204, v205
    v_add_f32 v216, v208, v209
    v_cvt_pk_bf16_f32 v225, v212, v216
    v_add_f32 v213, v206, v207
    v_add_f32 v217, v210, v211
    ds_write_addtid_b32 v225 offset:39168
    v_cvt_pk_bf16_f32 v226, v213, v217
    v_add_f32 v214, v204, v206
    v_add_f32 v218, v208, v210
    ds_write_addtid_b32 v226 offset:47360
    v_cvt_pk_bf16_f32 v227, v214, v218
    v_add_f32 v215, v205, v207
    v_add_f32 v219, v209, v211
    s_waitcnt lgkmcnt(8)
    ds_write_addtid_b32 v227 offset:55552
    v_cvt_pk_bf16_f32 v228, v215, v219
    v_add_f32 v204, v212, v213
    v_add_f32 v208, v216, v217
    ds_write_addtid_b32 v228 offset:63744
    v_cvt_pk_bf16_f32 v229, v204, v208
    ds_write_b32 v249, v229 offset:6400
    s_add_u32 s23, s23, 73728
    s_add_u32 s28, s28, 1
    s_waitcnt lgkmcnt(0)
    s_barrier
    s_mov_b32 m0, s27
    ds_read_b128 v[168:171], v240 offset:0
    ds_read_b128 v[172:175], v240 offset:256
    ds_read_b128 v[176:179], v240 offset:512
    ds_read_b128 v[180:183], v240 offset:768
    ds_read_b128 v[184:187], v240 offset:1024
    ds_read_b128 v[188:191], v240 offset:1280
    ds_read_b128 v[192:195], v241 offset:0
    ds_read_b128 v[196:199], v241 offset:256
    ds_read_b128 v[200:203], v240 offset:16
    v_lshlrev_b32 v204, 16, v96
    v_and_b32 v208, s25, v96
    ds_write_addtid_b32 v96 offset:1540
    v_lshlrev_b32 v205, 16, v100
    v_and_b32 v209, s25, v100
    ds_write_addtid_b32 v100 offset:9732
    v_lshlrev_b32 v206, 16, v104
    v_and_b32 v210, s25, v104
    ds_write_addtid_b32 v104 offset:17924
    v_lshlrev_b32 v207, 16, v108
    v_and_b32 v211, s25, v108
    ds_write_addtid_b32 v108 offset:26116
    v_add_f32 v212, v204, v205
    v_add_f32 v216, v208, v209
    v_cvt_pk_bf16_f32 v220, v212, v216
    v_add_f32 v213, v206, v207
    v_add_f32 v217, v210, v211
    ds_write_addtid_b32 v220 offset:34308
    v_cvt_pk_bf16_f32 v221, v213, v217
    v_add_f32 v214, v204, v206
    v_add_f32 v218, v208, v210
    ds_write_addtid_b32 v221 offset:42500
    v_cvt_pk_bf16_f32 v222, v214, v218
    v_add_f32 v215, v205, v207
    v_add_f32 v219, v209, v211
    s_waitcnt lgkmcnt(8)
    ds_write_addtid_b32 v222 offset:50692
    v_cvt_pk_bf16_f32 v223, v215, v219
    v_add_f32 v204, v212, v213
    v_add_f32 v208, v216, v217
    ds_write_addtid_b32 v223 offset:58884
    v_cvt_pk_bf16_f32 v224, v204, v208
    ds_write_b32 v249, v224 offset:8192
    v_lshlrev_b32 v204, 16, v97
    v_and_b32 v208, s25, v97
    ds_write_addtid_b32 v97 offset:3588
    v_lshlrev_b32 v205, 16, v101
    v_and_b32 v209, s25, v101
    ds_write_addtid_b32 v101 offset:11780
    s_cmp_lt_i32 s28, 5
    s_cselect_b32 s24, 0, 2130706432
    buffer_load_dwordx4 v[24:27], v238, s[8:11], s24 offen offset:0
    buffer_load_dwordx4 v[56:59], v238, s[8:11], s24 offen offset:64
    v_add_u32 v238, 128, v238
    v_lshlrev_b32 v206, 16, v105
    v_and_b32 v210, s25, v105
    ds_write_addtid_b32 v105 offset:19972
    v_lshlrev_b32 v207, 16, v109
    v_and_b32 v211, s25, v109
    ds_write_addtid_b32 v109 offset:28164
    v_add_f32 v212, v204, v205
    v_add_f32 v216, v208, v209
    v_cvt_pk_bf16_f32 v225, v212, v216
    v_add_f32 v213, v206, v207
    v_add_f32 v217, v210, v211
    s_waitcnt lgkmcnt(8)
    ds_write_addtid_b32 v225 offset:36356
    v_cvt_pk_bf16_f32 v226, v213, v217
    s_waitcnt vmcnt(2)
    v_mfma_f32_16x16x32_bf16 v[128:131], v[160:163], v[168:171], v[128:131]
    v_add_f32 v214, v204, v206
    v_add_f32 v218, v208, v210
    ds_write_addtid_b32 v226 offset:44548
    v_cvt_pk_bf16_f32 v227, v214, v218
    v_add_f32 v215, v205, v207
    v_add_f32 v219, v209, v211
    ds_write_addtid_b32 v227 offset:52740
    v_cvt_pk_bf16_f32 v228, v215, v219
    v_add_f32 v204, v212, v213
    v_add_f32 v208, v216, v217
    ds_write_addtid_b32 v228 offset:60932
    v_cvt_pk_bf16_f32 v229, v204, v208
    ds_write_b32 v249, v229 offset:10240
    v_lshlrev_b32 v204, 16, v98
    v_and_b32 v208, s25, v98
    ds_write_addtid_b32 v98 offset:5636
    v_lshlrev_b32 v205, 16, v102
    v_and_b32 v209, s25, v102
    ds_write_addtid_b32 v102 offset:13828
    v_lshlrev_b32 v206, 16, v106
    v_and_b32 v210, s25, v106
    s_waitcnt lgkmcnt(8)
    ds_write_addtid_b32 v106 offset:22020
    v_mfma_f32_16x16x32_bf16 v[132:135], v[160:163], v[172:175], v[132:135]
    v_mfma_f32_16x16x32_bf16 v[128:131], v[164:167], v[172:175], v[128:131]
    v_lshlrev_b32 v207, 16, v110
    v_and_b32 v211, s25, v110
    ds_write_addtid_b32 v110 offset:30212
    v_add_f32 v212, v204, v205
    v_add_f32 v216, v208, v209
    v_cvt_pk_bf16_f32 v220, v212, v216
    v_add_f32 v213, v206, v207
    v_add_f32 v217, v210, v211
    ds_write_addtid_b32 v220 offset:38404
    v_cvt_pk_bf16_f32 v221, v213, v217
    v_add_f32 v214, v204, v206
    v_add_f32 v218, v208, v210
    ds_write_addtid_b32 v221 offset:46596
    v_cvt_pk_bf16_f32 v222, v214, v218
    v_add_f32 v215, v205, v207
    v_add_f32 v219, v209, v211
    buffer_load_dwordx4 v[28:31], v239, s[8:11], s24 offen offset:0
    buffer_load_dwordx4 v[60:63], v239, s[8:11], s24 offen offset:64
    v_add_u32 v239, 128, v239
    ds_write_addtid_b32 v222 offset:54788
    v_cvt_pk_bf16_f32 v223, v215, v219
    v_add_f32 v204, v212, v213
    v_add_f32 v208, v216, v217
    ds_write_addtid_b32 v223 offset:62980
    v_cvt_pk_bf16_f32 v224, v204, v208
    ds_write_b32 v249, v224 offset:12288
    v_mfma_f32_16x16x32_bf16 v[136:139], v[160:163], v[176:179], v[136:139]
    v_mfma_f32_16x16x32_bf16 v[132:135], v[164:167], v[176:179], v[132:135]
    v_lshlrev_b32 v204, 16, v99
    v_and_b32 v208, s25, v99
    s_waitcnt lgkmcnt(8)
    ds_write_addtid_b32 v99 offset:7684
    v_lshlrev_b32 v205, 16, v103
    v_and_b32 v209, s25, v103
    ds_write_addtid_b32 v103 offset:15876
    v_lshlrev_b32 v206, 16, v107
    v_and_b32 v210, s25, v107
    ds_write_addtid_b32 v107 offset:24068
    v_lshlrev_b32 v207, 16, v111
    v_and_b32 v211, s25, v111
    ds_write_addtid_b32 v111 offset:32260
    v_add_f32 v212, v204, v205
    v_add_f32 v216, v208, v209
    v_cvt_pk_bf16_f32 v225, v212, v216
    v_add_f32 v213, v206, v207
    v_add_f32 v217, v210, v211
    ds_write_addtid_b32 v225 offset:40452
    v_cvt_pk_bf16_f32 v226, v213, v217
    v_add_f32 v214, v204, v206
    v_add_f32 v218, v208, v210
    ds_write_addtid_b32 v226 offset:48644
    v_mfma_f32_16x16x32_bf16 v[140:143], v[160:163], v[180:183], v[140:143]
    v_mfma_f32_16x16x32_bf16 v[136:139], v[164:167], v[180:183], v[136:139]
    v_cvt_pk_bf16_f32 v227, v214, v218
    v_add_f32 v215, v205, v207
    v_add_f32 v219, v209, v211
    ds_write_addtid_b32 v227 offset:56836
    v_cvt_pk_bf16_f32 v228, v215, v219
    v_add_f32 v204, v212, v213
    v_add_f32 v208, v216, v217
    s_waitcnt lgkmcnt(8)
    ds_write_addtid_b32 v228 offset:65028
    v_cvt_pk_bf16_f32 v229, v204, v208
    ds_write_b32 v249, v229 offset:14336
    v_lshlrev_b32 v204, 16, v112
    v_and_b32 v208, s25, v112
    ds_write_addtid_b32 v112 offset:1796
    v_lshlrev_b32 v205, 16, v116
    v_and_b32 v209, s25, v116
    ds_write_addtid_b32 v116 offset:9988
    v_lshlrev_b32 v206, 16, v120
    v_and_b32 v210, s25, v120
    ds_write_addtid_b32 v120 offset:18180
    v_lshlrev_b32 v207, 16, v124
    v_and_b32 v211, s25, v124
    ds_write_addtid_b32 v124 offset:26372
    v_mfma_f32_16x16x32_bf16 v[144:147], v[160:163], v[184:187], v[144:147]
    v_mfma_f32_16x16x32_bf16 v[140:143], v[164:167], v[184:187], v[140:143]
    v_add_f32 v212, v204, v205
    v_add_f32 v216, v208, v209
    v_cvt_pk_bf16_f32 v220, v212, v216
    v_add_f32 v213, v206, v207
    v_add_f32 v217, v210, v211
    ds_write_addtid_b32 v220 offset:34564
    v_cvt_pk_bf16_f32 v221, v213, v217
    v_add_f32 v214, v204, v206
    v_add_f32 v218, v208, v210
    s_waitcnt lgkmcnt(8)
    ds_write_addtid_b32 v221 offset:42756
    v_cvt_pk_bf16_f32 v222, v214, v218
    v_add_f32 v215, v205, v207
    v_add_f32 v219, v209, v211
    s_cmp_lt_i32 s28, 4
    s_cselect_b32 s24, 0, 2130706432
    buffer_load_dwordx4 v[64:67], v232, s[8:11], s24 offen offset:0
    buffer_load_dwordx4 v[96:99], v232, s[8:11], s24 offen offset:64
    v_add_u32 v232, 128, v232
    ds_write_addtid_b32 v222 offset:50948
    v_cvt_pk_bf16_f32 v223, v215, v219
    v_add_f32 v204, v212, v213
    v_add_f32 v208, v216, v217
    ds_write_addtid_b32 v223 offset:59140
    v_cvt_pk_bf16_f32 v224, v204, v208
    ds_write_b32 v249, v224 offset:8448
    v_lshlrev_b32 v204, 16, v113
    v_and_b32 v208, s25, v113
    ds_write_addtid_b32 v113 offset:3844
    v_mfma_f32_16x16x32_bf16 v[148:151], v[160:163], v[188:191], v[148:151]
    v_mfma_f32_16x16x32_bf16 v[144:147], v[164:167], v[188:191], v[144:147]
    v_lshlrev_b32 v205, 16, v117
    v_and_b32 v209, s25, v117
    ds_write_addtid_b32 v117 offset:12036
    v_lshlrev_b32 v206, 16, v121
    v_and_b32 v210, s25, v121
    ds_write_addtid_b32 v121 offset:20228
    v_lshlrev_b32 v207, 16, v125
    v_and_b32 v211, s25, v125
    s_waitcnt lgkmcnt(8)
    ds_write_addtid_b32 v125 offset:28420
    v_add_f32 v212, v204, v205
    v_add_f32 v216, v208, v209
    v_cvt_pk_bf16_f32 v225, v212, v216
    v_add_f32 v213, v206, v207
    v_add_f32 v217, v210, v211
    ds_write_addtid_b32 v225 offset:36612
    v_cvt_pk_bf16_f32 v226, v213, v217
    v_add_f32 v214, v204, v206
    v_add_f32 v218, v208, v210
    ds_write_addtid_b32 v226 offset:44804
    v_cvt_pk_bf16_f32 v227, v214, v218
    v_add_f32 v215, v205, v207
    v_add_f32 v219, v209, v211
    v_mfma_f32_16x16x32_bf16 v[152:155], v[160:163], v[192:195], v[152:155]
    v_mfma_f32_16x16x32_bf16 v[148:151], v[164:167], v[192:195], v[148:151]
    ds_write_addtid_b32 v227 offset:52996
    v_cvt_pk_bf16_f32 v228, v215, v219
    v_add_f32 v204, v212, v213
    v_add_f32 v208, v216, v217
    ds_write_addtid_b32 v228 offset:61188
    v_cvt_pk_bf16_f32 v229, v204, v208
    ds_write_b32 v249, v229 offset:10496
    v_lshlrev_b32 v204, 16, v114
    v_and_b32 v208, s25, v114
    ds_write_addtid_b32 v114 offset:5892
    v_lshlrev_b32 v205, 16, v118
    v_and_b32 v209, s25, v118
    s_waitcnt lgkmcnt(8)
    ds_write_addtid_b32 v118 offset:14084
    v_lshlrev_b32 v206, 16, v122
    v_and_b32 v210, s25, v122
    ds_write_addtid_b32 v122 offset:22276
    v_lshlrev_b32 v207, 16, v126
    v_and_b32 v211, s25, v126
    ds_write_addtid_b32 v126 offset:30468
    buffer_load_dwordx4 v[68:71], v233, s[8:11], s24 offen offset:0
    buffer_load_dwordx4 v[100:103], v233, s[8:11], s24 offen offset:64
    v_add_u32 v233, 128, v233
    v_add_f32 v212, v204, v205
    v_add_f32 v216, v208, v209
    v_cvt_pk_bf16_f32 v220, v212, v216
    v_add_f32 v213, v206, v207
    v_mfma_f32_16x16x32_bf16 v[156:159], v[160:163], v[196:199], v[156:159]
    v_mfma_f32_16x16x32_bf16 v[152:155], v[164:167], v[196:199], v[152:155]
    v_add_f32 v217, v210, v211
    ds_write_addtid_b32 v220 offset:38660
    v_cvt_pk_bf16_f32 v221, v213, v217
    v_add_f32 v214, v204, v206
    v_add_f32 v218, v208, v210
    ds_write_addtid_b32 v221 offset:46852
    v_cvt_pk_bf16_f32 v222, v214, v218
    v_add_f32 v215, v205, v207
    v_add_f32 v219, v209, v211
    ds_write_addtid_b32 v222 offset:55044
    v_cvt_pk_bf16_f32 v223, v215, v219
    v_add_f32 v204, v212, v213
    v_add_f32 v208, v216, v217
    ds_write_addtid_b32 v223 offset:63236
    v_cvt_pk_bf16_f32 v224, v204, v208
    s_waitcnt lgkmcnt(8)
    ds_write_b32 v249, v224 offset:12544
    v_lshlrev_b32 v204, 16, v115
    v_and_b32 v208, s25, v115
    ds_write_addtid_b32 v115 offset:7940
    v_lshlrev_b32 v205, 16, v119
    v_and_b32 v209, s25, v119
    ds_write_addtid_b32 v119 offset:16132
    v_mfma_f32_16x16x32_bf16 v[156:159], v[164:167], v[200:203], v[156:159]
    buffer_load_dwordx4 v[160:163], v245, s[12:15], s23 offen offset:0
    buffer_load_dwordx4 v[164:167], v245, s[12:15], s23 offen offset:2048
    v_lshlrev_b32 v206, 16, v123
    v_and_b32 v210, s25, v123
    ds_write_addtid_b32 v123 offset:24324
    v_lshlrev_b32 v207, 16, v127
    v_and_b32 v211, s25, v127
    ds_write_addtid_b32 v127 offset:32516
    v_add_f32 v212, v204, v205
    v_add_f32 v216, v208, v209
    v_cvt_pk_bf16_f32 v225, v212, v216
    v_add_f32 v213, v206, v207
    v_add_f32 v217, v210, v211
    ds_write_addtid_b32 v225 offset:40708
    v_cvt_pk_bf16_f32 v226, v213, v217
    v_add_f32 v214, v204, v206
    v_add_f32 v218, v208, v210
    ds_write_addtid_b32 v226 offset:48900
    v_cvt_pk_bf16_f32 v227, v214, v218
    v_add_f32 v215, v205, v207
    v_add_f32 v219, v209, v211
    s_waitcnt lgkmcnt(8)
    ds_write_addtid_b32 v227 offset:57092
    v_cvt_pk_bf16_f32 v228, v215, v219
    v_add_f32 v204, v212, v213
    v_add_f32 v208, v216, v217
    ds_write_addtid_b32 v228 offset:65284
    v_cvt_pk_bf16_f32 v229, v204, v208
    ds_write_b32 v249, v229 offset:14592
    s_add_u32 s23, s23, 73728
    s_add_u32 s28, s28, 1
    s_waitcnt lgkmcnt(0)
    s_barrier
    s_mov_b32 m0, s26
    ds_read_b128 v[168:171], v240 offset:8192
    ds_read_b128 v[172:175], v240 offset:8448
    ds_read_b128 v[176:179], v240 offset:8704
    ds_read_b128 v[180:183], v240 offset:8960
    ds_read_b128 v[184:187], v240 offset:9216
    ds_read_b128 v[188:191], v240 offset:9472
    ds_read_b128 v[192:195], v241 offset:8192
    ds_read_b128 v[196:199], v241 offset:8448
    ds_read_b128 v[200:203], v240 offset:8208
    v_lshlrev_b32 v204, 16, v0
    v_and_b32 v208, s25, v0
    ds_write_addtid_b32 v0 offset:0
    v_lshlrev_b32 v205, 16, v4
    v_and_b32 v209, s25, v4
    ds_write_addtid_b32 v4 offset:8192
    v_lshlrev_b32 v206, 16, v8
    v_and_b32 v210, s25, v8
    ds_write_addtid_b32 v8 offset:16384
    v_lshlrev_b32 v207, 16, v12
    v_and_b32 v211, s25, v12
    ds_write_addtid_b32 v12 offset:24576
    v_add_f32 v212, v204, v205
    v_add_f32 v216, v208, v209
    v_cvt_pk_bf16_f32 v220, v212, v216
    v_add_f32 v213, v206, v207
    v_add_f32 v217, v210, v211
    ds_write_addtid_b32 v220 offset:32768
    v_cvt_pk_bf16_f32 v221, v213, v217
    v_add_f32 v214, v204, v206
    v_add_f32 v218, v208, v210
    ds_write_addtid_b32 v221 offset:40960
    v_cvt_pk_bf16_f32 v222, v214, v218
    v_add_f32 v215, v205, v207
    v_add_f32 v219, v209, v211
    s_waitcnt lgkmcnt(8)
    ds_write_addtid_b32 v222 offset:49152
    v_cvt_pk_bf16_f32 v223, v215, v219
    v_add_f32 v204, v212, v213
    v_add_f32 v208, v216, v217
    ds_write_addtid_b32 v223 offset:57344
    v_cvt_pk_bf16_f32 v224, v204, v208
    ds_write_b32 v249, v224 offset:0
    v_lshlrev_b32 v204, 16, v1
    v_and_b32 v208, s25, v1
    ds_write_addtid_b32 v1 offset:2048
    v_lshlrev_b32 v205, 16, v5
    v_and_b32 v209, s25, v5
    ds_write_addtid_b32 v5 offset:10240
    s_cmp_lt_i32 s28, 5
    s_cselect_b32 s24, 0, 2130706432
    buffer_load_dwordx4 v[72:75], v234, s[8:11], s24 offen offset:0
    buffer_load_dwordx4 v[104:107], v234, s[8:11], s24 offen offset:64
    v_add_u32 v234, 128, v234
    v_lshlrev_b32 v206, 16, v9
    v_and_b32 v210, s25, v9
    ds_write_addtid_b32 v9 offset:18432
    v_lshlrev_b32 v207, 16, v13
    v_and_b32 v211, s25, v13
    ds_write_addtid_b32 v13 offset:26624
    v_add_f32 v212, v204, v205
    v_add_f32 v216, v208, v209
    v_cvt_pk_bf16_f32 v225, v212, v216
    v_add_f32 v213, v206, v207
    v_add_f32 v217, v210, v211
    s_waitcnt lgkmcnt(8)
    ds_write_addtid_b32 v225 offset:34816
    v_cvt_pk_bf16_f32 v226, v213, v217
    s_waitcnt vmcnt(2)
    v_mfma_f32_16x16x32_bf16 v[128:131], v[160:163], v[168:171], v[128:131]
    v_add_f32 v214, v204, v206
    v_add_f32 v218, v208, v210
    ds_write_addtid_b32 v226 offset:43008
    v_cvt_pk_bf16_f32 v227, v214, v218
    v_add_f32 v215, v205, v207
    v_add_f32 v219, v209, v211
    ds_write_addtid_b32 v227 offset:51200
    v_cvt_pk_bf16_f32 v228, v215, v219
    v_add_f32 v204, v212, v213
    v_add_f32 v208, v216, v217
    ds_write_addtid_b32 v228 offset:59392
    v_cvt_pk_bf16_f32 v229, v204, v208
    ds_write_b32 v249, v229 offset:2048
    v_lshlrev_b32 v204, 16, v2
    v_and_b32 v208, s25, v2
    ds_write_addtid_b32 v2 offset:4096
    v_lshlrev_b32 v205, 16, v6
    v_and_b32 v209, s25, v6
    ds_write_addtid_b32 v6 offset:12288
    v_lshlrev_b32 v206, 16, v10
    v_and_b32 v210, s25, v10
    s_waitcnt lgkmcnt(8)
    ds_write_addtid_b32 v10 offset:20480
    v_mfma_f32_16x16x32_bf16 v[132:135], v[160:163], v[172:175], v[132:135]
    v_mfma_f32_16x16x32_bf16 v[128:131], v[164:167], v[172:175], v[128:131]
    v_lshlrev_b32 v207, 16, v14
    v_and_b32 v211, s25, v14
    ds_write_addtid_b32 v14 offset:28672
    v_add_f32 v212, v204, v205
    v_add_f32 v216, v208, v209
    v_cvt_pk_bf16_f32 v220, v212, v216
    v_add_f32 v213, v206, v207
    v_add_f32 v217, v210, v211
    ds_write_addtid_b32 v220 offset:36864
    v_cvt_pk_bf16_f32 v221, v213, v217
    v_add_f32 v214, v204, v206
    v_add_f32 v218, v208, v210
    ds_write_addtid_b32 v221 offset:45056
    v_cvt_pk_bf16_f32 v222, v214, v218
    v_add_f32 v215, v205, v207
    v_add_f32 v219, v209, v211
    buffer_load_dwordx4 v[76:79], v235, s[8:11], s24 offen offset:0
    buffer_load_dwordx4 v[108:111], v235, s[8:11], s24 offen offset:64
    v_add_u32 v235, 128, v235
    ds_write_addtid_b32 v222 offset:53248
    v_cvt_pk_bf16_f32 v223, v215, v219
    v_add_f32 v204, v212, v213
    v_add_f32 v208, v216, v217
    ds_write_addtid_b32 v223 offset:61440
    v_cvt_pk_bf16_f32 v224, v204, v208
    ds_write_b32 v249, v224 offset:4096
    v_mfma_f32_16x16x32_bf16 v[136:139], v[160:163], v[176:179], v[136:139]
    v_mfma_f32_16x16x32_bf16 v[132:135], v[164:167], v[176:179], v[132:135]
    v_lshlrev_b32 v204, 16, v3
    v_and_b32 v208, s25, v3
    s_waitcnt lgkmcnt(8)
    ds_write_addtid_b32 v3 offset:6144
    v_lshlrev_b32 v205, 16, v7
    v_and_b32 v209, s25, v7
    ds_write_addtid_b32 v7 offset:14336
    v_lshlrev_b32 v206, 16, v11
    v_and_b32 v210, s25, v11
    ds_write_addtid_b32 v11 offset:22528
    v_lshlrev_b32 v207, 16, v15
    v_and_b32 v211, s25, v15
    ds_write_addtid_b32 v15 offset:30720
    v_add_f32 v212, v204, v205
    v_add_f32 v216, v208, v209
    v_cvt_pk_bf16_f32 v225, v212, v216
    v_add_f32 v213, v206, v207
    v_add_f32 v217, v210, v211
    ds_write_addtid_b32 v225 offset:38912
    v_cvt_pk_bf16_f32 v226, v213, v217
    v_add_f32 v214, v204, v206
    v_add_f32 v218, v208, v210
    ds_write_addtid_b32 v226 offset:47104
    v_mfma_f32_16x16x32_bf16 v[140:143], v[160:163], v[180:183], v[140:143]
    v_mfma_f32_16x16x32_bf16 v[136:139], v[164:167], v[180:183], v[136:139]
    v_cvt_pk_bf16_f32 v227, v214, v218
    v_add_f32 v215, v205, v207
    v_add_f32 v219, v209, v211
    ds_write_addtid_b32 v227 offset:55296
    v_cvt_pk_bf16_f32 v228, v215, v219
    v_add_f32 v204, v212, v213
    v_add_f32 v208, v216, v217
    s_waitcnt lgkmcnt(8)
    ds_write_addtid_b32 v228 offset:63488
    v_cvt_pk_bf16_f32 v229, v204, v208
    ds_write_b32 v249, v229 offset:6144
    v_lshlrev_b32 v204, 16, v16
    v_and_b32 v208, s25, v16
    ds_write_addtid_b32 v16 offset:256
    v_lshlrev_b32 v205, 16, v20
    v_and_b32 v209, s25, v20
    ds_write_addtid_b32 v20 offset:8448
    v_lshlrev_b32 v206, 16, v24
    v_and_b32 v210, s25, v24
    ds_write_addtid_b32 v24 offset:16640
    v_lshlrev_b32 v207, 16, v28
    v_and_b32 v211, s25, v28
    ds_write_addtid_b32 v28 offset:24832
    v_mfma_f32_16x16x32_bf16 v[144:147], v[160:163], v[184:187], v[144:147]
    v_mfma_f32_16x16x32_bf16 v[140:143], v[164:167], v[184:187], v[140:143]
    v_add_f32 v212, v204, v205
    v_add_f32 v216, v208, v209
    v_cvt_pk_bf16_f32 v220, v212, v216
    v_add_f32 v213, v206, v207
    v_add_f32 v217, v210, v211
    ds_write_addtid_b32 v220 offset:33024
    v_cvt_pk_bf16_f32 v221, v213, v217
    v_add_f32 v214, v204, v206
    v_add_f32 v218, v208, v210
    s_waitcnt lgkmcnt(8)
    ds_write_addtid_b32 v221 offset:41216
    v_cvt_pk_bf16_f32 v222, v214, v218
    v_add_f32 v215, v205, v207
    v_add_f32 v219, v209, v211
    s_cmp_lt_i32 s28, 4
    s_cselect_b32 s24, 0, 2130706432
    buffer_load_dwordx4 v[80:83], v236, s[8:11], s24 offen offset:0
    buffer_load_dwordx4 v[112:115], v236, s[8:11], s24 offen offset:64
    v_add_u32 v236, 128, v236
    ds_write_addtid_b32 v222 offset:49408
    v_cvt_pk_bf16_f32 v223, v215, v219
    v_add_f32 v204, v212, v213
    v_add_f32 v208, v216, v217
    ds_write_addtid_b32 v223 offset:57600
    v_cvt_pk_bf16_f32 v224, v204, v208
    ds_write_b32 v249, v224 offset:256
    v_lshlrev_b32 v204, 16, v17
    v_and_b32 v208, s25, v17
    ds_write_addtid_b32 v17 offset:2304
    v_mfma_f32_16x16x32_bf16 v[148:151], v[160:163], v[188:191], v[148:151]
    v_mfma_f32_16x16x32_bf16 v[144:147], v[164:167], v[188:191], v[144:147]
    v_lshlrev_b32 v205, 16, v21
    v_and_b32 v209, s25, v21
    ds_write_addtid_b32 v21 offset:10496
    v_lshlrev_b32 v206, 16, v25
    v_and_b32 v210, s25, v25
    ds_write_addtid_b32 v25 offset:18688
    v_lshlrev_b32 v207, 16, v29
    v_and_b32 v211, s25, v29
    s_waitcnt lgkmcnt(8)
    ds_write_addtid_b32 v29 offset:26880
    v_add_f32 v212, v204, v205
    v_add_f32 v216, v208, v209
    v_cvt_pk_bf16_f32 v225, v212, v216
    v_add_f32 v213, v206, v207
    v_add_f32 v217, v210, v211
    ds_write_addtid_b32 v225 offset:35072
    v_cvt_pk_bf16_f32 v226, v213, v217
    v_add_f32 v214, v204, v206
    v_add_f32 v218, v208, v210
    ds_write_addtid_b32 v226 offset:43264
    v_cvt_pk_bf16_f32 v227, v214, v218
    v_add_f32 v215, v205, v207
    v_add_f32 v219, v209, v211
    v_mfma_f32_16x16x32_bf16 v[152:155], v[160:163], v[192:195], v[152:155]
    v_mfma_f32_16x16x32_bf16 v[148:151], v[164:167], v[192:195], v[148:151]
    ds_write_addtid_b32 v227 offset:51456
    v_cvt_pk_bf16_f32 v228, v215, v219
    v_add_f32 v204, v212, v213
    v_add_f32 v208, v216, v217
    ds_write_addtid_b32 v228 offset:59648
    v_cvt_pk_bf16_f32 v229, v204, v208
    ds_write_b32 v249, v229 offset:2304
    v_lshlrev_b32 v204, 16, v18
    v_and_b32 v208, s25, v18
    ds_write_addtid_b32 v18 offset:4352
    v_lshlrev_b32 v205, 16, v22
    v_and_b32 v209, s25, v22
    s_waitcnt lgkmcnt(8)
    ds_write_addtid_b32 v22 offset:12544
    v_lshlrev_b32 v206, 16, v26
    v_and_b32 v210, s25, v26
    ds_write_addtid_b32 v26 offset:20736
    v_lshlrev_b32 v207, 16, v30
    v_and_b32 v211, s25, v30
    ds_write_addtid_b32 v30 offset:28928
    buffer_load_dwordx4 v[84:87], v237, s[8:11], s24 offen offset:0
    buffer_load_dwordx4 v[116:119], v237, s[8:11], s24 offen offset:64
    v_add_u32 v237, 128, v237
    v_add_f32 v212, v204, v205
    v_add_f32 v216, v208, v209
    v_cvt_pk_bf16_f32 v220, v212, v216
    v_add_f32 v213, v206, v207
    v_mfma_f32_16x16x32_bf16 v[156:159], v[160:163], v[196:199], v[156:159]
    v_mfma_f32_16x16x32_bf16 v[152:155], v[164:167], v[196:199], v[152:155]
    v_add_f32 v217, v210, v211
    ds_write_addtid_b32 v220 offset:37120
    v_cvt_pk_bf16_f32 v221, v213, v217
    v_add_f32 v214, v204, v206
    v_add_f32 v218, v208, v210
    ds_write_addtid_b32 v221 offset:45312
    v_cvt_pk_bf16_f32 v222, v214, v218
    v_add_f32 v215, v205, v207
    v_add_f32 v219, v209, v211
    ds_write_addtid_b32 v222 offset:53504
    v_cvt_pk_bf16_f32 v223, v215, v219
    v_add_f32 v204, v212, v213
    v_add_f32 v208, v216, v217
    ds_write_addtid_b32 v223 offset:61696
    v_cvt_pk_bf16_f32 v224, v204, v208
    s_waitcnt lgkmcnt(8)
    ds_write_b32 v249, v224 offset:4352
    v_lshlrev_b32 v204, 16, v19
    v_and_b32 v208, s25, v19
    ds_write_addtid_b32 v19 offset:6400
    v_lshlrev_b32 v205, 16, v23
    v_and_b32 v209, s25, v23
    ds_write_addtid_b32 v23 offset:14592
    v_mfma_f32_16x16x32_bf16 v[156:159], v[164:167], v[200:203], v[156:159]
    buffer_load_dwordx4 v[160:163], v245, s[12:15], s23 offen offset:0
    buffer_load_dwordx4 v[164:167], v245, s[12:15], s23 offen offset:2048
    v_lshlrev_b32 v206, 16, v27
    v_and_b32 v210, s25, v27
    ds_write_addtid_b32 v27 offset:22784
    v_lshlrev_b32 v207, 16, v31
    v_and_b32 v211, s25, v31
    ds_write_addtid_b32 v31 offset:30976
    v_add_f32 v212, v204, v205
    v_add_f32 v216, v208, v209
    v_cvt_pk_bf16_f32 v225, v212, v216
    v_add_f32 v213, v206, v207
    v_add_f32 v217, v210, v211
    ds_write_addtid_b32 v225 offset:39168
    v_cvt_pk_bf16_f32 v226, v213, v217
    v_add_f32 v214, v204, v206
    v_add_f32 v218, v208, v210
    ds_write_addtid_b32 v226 offset:47360
    v_cvt_pk_bf16_f32 v227, v214, v218
    v_add_f32 v215, v205, v207
    v_add_f32 v219, v209, v211
    s_waitcnt lgkmcnt(8)
    ds_write_addtid_b32 v227 offset:55552
    v_cvt_pk_bf16_f32 v228, v215, v219
    v_add_f32 v204, v212, v213
    v_add_f32 v208, v216, v217
    ds_write_addtid_b32 v228 offset:63744
    v_cvt_pk_bf16_f32 v229, v204, v208
    ds_write_b32 v249, v229 offset:6400
    s_add_u32 s23, s23, 73728
    s_add_u32 s28, s28, 1
    s_waitcnt lgkmcnt(0)
    s_barrier
    s_sub_u32 s22, s22, 1
    s_cmp_lg_u32 s22, 0
    s_cbranch_scc1 L_conv2_kernel_hloop
    s_setprio 0
    s_nop 7
    s_waitcnt vmcnt(0)
    ds_write_b128 v244, v[128:131] offset:0
    ds_write_b128 v244, v[132:135] offset:1024
    ds_write_b128 v244, v[136:139] offset:2048
    ds_write_b128 v244, v[140:143] offset:3072
    ds_write_b128 v244, v[144:147] offset:4096
    ds_write_b128 v244, v[148:151] offset:5120
    ds_write_b128 v244, v[152:155] offset:6144
    ds_write_b128 v244, v[156:159] offset:7168
L_conv2_kernel_epi:
    s_lshl_b32 s36, s20, 10
    v_lshl_add_u32 v236, v255, 4, s36
    v_add_u32 v237, 65536, v236
    v_add_u32 v238, 131072, v236
    s_add_u32 s36, s36, 1024
    s_cmp_eq_u32 s20, 7
    s_cselect_b32 s36, 16, s36
    v_lshl_add_u32 v239, v255, 4, s36
    v_add_u32 v240, 65536, v239
    v_and_b32 v242, 15, v255
    v_lshlrev_b32 v242, 3, v242
    v_add_u32 v242, s20, v242
    v_lshl_add_u32 v243, v242, 2, s21
    v_lshlrev_b32 v243, 10, v243
    v_lshrrev_b32 v245, 4, v255
    v_lshl_add_u32 v243, v245, 5, v243
    s_lshl_b32 s36, s29, 7
    v_add_u32 v243, s36, v243
    v_mov_b32 v245, 2130706432
    v_cmp_gt_u32 vcc, 125, v242
    s_waitcnt lgkmcnt(0)
    s_barrier
    v_cndmask_b32 v241, v245, v243, vcc
    ds_read_b128 v[0:3], v236 offset:0
    ds_read_b128 v[4:7], v236 offset:16384
    ds_read_b128 v[8:11], v236 offset:32768
    ds_read_b128 v[12:15], v236 offset:49152
    ds_read_b128 v[16:19], v237 offset:0
    ds_read_b128 v[20:23], v237 offset:16384
    ds_read_b128 v[24:27], v237 offset:32768
    ds_read_b128 v[28:31], v237 offset:49152
    ds_read_b128 v[32:35], v238 offset:0
    ds_read_b128 v[36:39], v238 offset:16384
    ds_read_b128 v[40:43], v239 offset:0
    ds_read_b128 v[44:47], v239 offset:16384
    ds_read_b128 v[48:51], v239 offset:32768
    ds_read_b128 v[52:55], v240 offset:0
    ds_read_b128 v[56:59], v240 offset:32768
    s_waitcnt lgkmcnt(0)
    ds_read_b128 v[60:63], v236 offset:8192
    ds_read_b128 v[64:67], v236 offset:24576
    ds_read_b128 v[68:71], v236 offset:40960
    ds_read_b128 v[72:75], v236 offset:57344
    ds_read_b128 v[76:79], v237 offset:8192
    ds_read_b128 v[80:83], v237 offset:24576
    ds_read_b128 v[84:87], v237 offset:40960
    ds_read_b128 v[88:91], v237 offset:57344
    ds_read_b128 v[92:95], v238 offset:8192
    ds_read_b128 v[96:99], v238 offset:24576
    ds_read_b128 v[100:103], v239 offset:8192
    ds_read_b128 v[104:107], v239 offset:24576
    ds_read_b128 v[108:111], v239 offset:40960
    ds_read_b128 v[112:115], v240 offset:8192
    ds_read_b128 v[116:119], v240 offset:40960
    v_add_f32 v32, v32, v36
    v_sub_f32 v20, v20, v8
    v_sub_f32 v16, v16, v0
    v_sub_f32 v32, v32, v24
    v_sub_f32 v20, v20, v12
    v_sub_f32 v16, v16, v4
    v_sub_f32 v32, v32, v28
    v_sub_f32 v28, v28, v4
    v_sub_f32 v52, v52, v40
    v_sub_f32 v56, v56, v40
    v_sub_f32 v32, v32, v16
    v_sub_f32 v28, v28, v12
    v_sub_f32 v52, v52, v44
    v_sub_f32 v56, v56, v48
    v_sub_f32 v120, v32, v20
    v_add_f32 v28, v28, v8
    v_add_f32 v136, v20, v52
    v_add_f32 v56, v56, v44
    v_add_f32 v128, v28, v40
    v_add_f32 v144, v12, v56
    v_add_f32 v33, v33, v37
    v_sub_f32 v21, v21, v9
    v_sub_f32 v17, v17, v1
    v_sub_f32 v33, v33, v25
    v_sub_f32 v21, v21, v13
    v_sub_f32 v17, v17, v5
    v_sub_f32 v33, v33, v29
    v_sub_f32 v29, v29, v5
    v_sub_f32 v53, v53, v41
    v_sub_f32 v57, v57, v41
    v_sub_f32 v33, v33, v17
    v_sub_f32 v29, v29, v13
    v_sub_f32 v53, v53, v45
    v_sub_f32 v57, v57, v49
    v_sub_f32 v122, v33, v21
    v_add_f32 v29, v29, v9
    v_add_f32 v138, v21, v53
    v_add_f32 v57, v57, v45
    v_add_f32 v130, v29, v41
    v_add_f32 v146, v13, v57
    v_add_f32 v34, v34, v38
    v_sub_f32 v22, v22, v10
    v_sub_f32 v18, v18, v2
    v_sub_f32 v34, v34, v26
    v_sub_f32 v22, v22, v14
    v_sub_f32 v18, v18, v6
    v_sub_f32 v34, v34, v30
    v_sub_f32 v30, v30, v6
    v_sub_f32 v54, v54, v42
    v_sub_f32 v58, v58, v42
    v_sub_f32 v34, v34, v18
    v_sub_f32 v30, v30, v14
    v_sub_f32 v54, v54, v46
    v_sub_f32 v58, v58, v50
    v_sub_f32 v124, v34, v22
    v_add_f32 v30, v30, v10
    v_add_f32 v140, v22, v54
    v_add_f32 v58, v58, v46
    v_add_f32 v132, v30, v42
    v_add_f32 v148, v14, v58
    v_add_f32 v35, v35, v39
    v_sub_f32 v23, v23, v11
    v_sub_f32 v19, v19, v3
    v_sub_f32 v35, v35, v27
    v_sub_f32 v23, v23, v15
    v_sub_f32 v19, v19, v7
    v_sub_f32 v35, v35, v31
    v_sub_f32 v31, v31, v7
    v_sub_f32 v55, v55, v43
    v_sub_f32 v59, v59, v43
    v_sub_f32 v35, v35, v19
    v_sub_f32 v31, v31, v15
    v_sub_f32 v55, v55, v47
    v_sub_f32 v59, v59, v51
    v_sub_f32 v126, v35, v23
    v_add_f32 v31, v31, v11
    v_add_f32 v142, v23, v55
    v_add_f32 v59, v59, v47
    v_add_f32 v134, v31, v43
    v_add_f32 v150, v15, v59
    s_waitcnt lgkmcnt(0)
    v_add_f32 v92, v92, v96
    v_sub_f32 v80, v80, v68
    v_sub_f32 v76, v76, v60
    v_sub_f32 v92, v92, v84
    v_sub_f32 v80, v80, v72
    v_sub_f32 v76, v76, v64
    v_sub_f32 v92, v92, v88
    v_sub_f32 v88, v88, v64
    v_sub_f32 v112, v112, v100
    v_sub_f32 v116, v116, v100
    v_sub_f32 v92, v92, v76
    v_sub_f32 v88, v88, v72
    v_sub_f32 v112, v112, v104
    v_sub_f32 v116, v116, v108
    v_sub_f32 v121, v92, v80
    v_add_f32 v88, v88, v68
    v_add_f32 v137, v80, v112
    v_add_f32 v116, v116, v104
    v_add_f32 v129, v88, v100
    v_add_f32 v145, v72, v116
    v_add_f32 v93, v93, v97
    v_sub_f32 v81, v81, v69
    v_sub_f32 v77, v77, v61
    v_sub_f32 v93, v93, v85
    v_sub_f32 v81, v81, v73
    v_sub_f32 v77, v77, v65
    v_sub_f32 v93, v93, v89
    v_sub_f32 v89, v89, v65
    v_sub_f32 v113, v113, v101
    v_sub_f32 v117, v117, v101
    v_sub_f32 v93, v93, v77
    v_sub_f32 v89, v89, v73
    v_sub_f32 v113, v113, v105
    v_sub_f32 v117, v117, v109
    v_sub_f32 v123, v93, v81
    v_add_f32 v89, v89, v69
    v_add_f32 v139, v81, v113
    v_add_f32 v117, v117, v105
    v_add_f32 v131, v89, v101
    v_add_f32 v147, v73, v117
    v_add_f32 v94, v94, v98
    v_sub_f32 v82, v82, v70
    v_sub_f32 v78, v78, v62
    v_sub_f32 v94, v94, v86
    v_sub_f32 v82, v82, v74
    v_sub_f32 v78, v78, v66
    v_sub_f32 v94, v94, v90
    v_sub_f32 v90, v90, v66
    v_sub_f32 v114, v114, v102
    v_sub_f32 v118, v118, v102
    v_sub_f32 v94, v94, v78
    v_sub_f32 v90, v90, v74
    v_sub_f32 v114, v114, v106
    v_sub_f32 v118, v118, v110
    v_sub_f32 v125, v94, v82
    v_add_f32 v90, v90, v70
    v_add_f32 v141, v82, v114
    v_add_f32 v118, v118, v106
    v_add_f32 v133, v90, v102
    v_add_f32 v149, v74, v118
    v_add_f32 v95, v95, v99
    v_sub_f32 v83, v83, v71
    v_sub_f32 v79, v79, v63
    v_sub_f32 v95, v95, v87
    v_sub_f32 v83, v83, v75
    v_sub_f32 v79, v79, v67
    v_sub_f32 v95, v95, v91
    v_sub_f32 v91, v91, v67
    v_sub_f32 v115, v115, v103
    v_sub_f32 v119, v119, v103
    v_sub_f32 v95, v95, v79
    v_sub_f32 v91, v91, v75
    v_sub_f32 v115, v115, v107
    v_sub_f32 v119, v119, v111
    v_sub_f32 v127, v95, v83
    v_add_f32 v91, v91, v71
    v_add_f32 v143, v83, v115
    v_add_f32 v119, v119, v107
    v_add_f32 v135, v91, v103
    v_add_f32 v151, v75, v119
    buffer_store_dwordx4 v[120:123], v241, s[16:19], 0 offen offset:0
    buffer_store_dwordx4 v[124:127], v241, s[16:19], 0 offen offset:16
    buffer_store_dwordx4 v[128:131], v241, s[16:19], 0 offen offset:1024
    buffer_store_dwordx4 v[132:135], v241, s[16:19], 0 offen offset:1040
    buffer_store_dwordx4 v[136:139], v241, s[16:19], 0 offen offset:2048
    buffer_store_dwordx4 v[140:143], v241, s[16:19], 0 offen offset:2064
    buffer_store_dwordx4 v[144:147], v241, s[16:19], 0 offen offset:3072
    buffer_store_dwordx4 v[148:151], v241, s[16:19], 0 offen offset:3088
L_conv2_kernel_done:
    s_endpgm
.globl joint_kernel
.p2align 8
.type joint_kernel,@function
joint_kernel:
    s_cmp_ge_u32 s2, 250
    s_cbranch_scc1 L_joint_kernel_done
    s_load_dwordx2 s[28:29], s[0:1], 56
    s_load_dwordx2 s[30:31], s[0:1], 72
    v_readfirstlane_b32 s20, v0
    s_lshr_b32 s20, s20, 6
    s_and_b32 s21, s20, 3
    v_and_b32 v255, 63, v0
    v_lshlrev_b32 v254, 4, v255
    s_cmp_ge_u32 s2, 125
    s_cselect_b32 s34, 8192, 0
    s_lshl_b32 s35, s2, 15
    s_add_u32 s35, s35, 27262976
    s_lshl_b32 s36, s20, 12
    s_add_u32 s37, s36, 8388608
    s_waitcnt lgkmcnt(0)
    s_add_u32 s8, s30, s35
    s_addc_u32 s9, s31, 0
    s_mov_b32 s10, 8421376
    s_mov_b32 s11, 0x00020000
    buffer_load_dwordx4 v[192:195], v254, s[8:11], s36 offen offset:0
    buffer_load_dwordx4 v[208:211], v254, s[8:11], s37 offen offset:0
    buffer_load_dwordx4 v[196:199], v254, s[8:11], s36 offen offset:1024
    buffer_load_dwordx4 v[212:215], v254, s[8:11], s37 offen offset:1024
    buffer_load_dwordx4 v[200:203], v254, s[8:11], s36 offen offset:2048
    buffer_load_dwordx4 v[216:219], v254, s[8:11], s37 offen offset:2048
    buffer_load_dwordx4 v[204:207], v254, s[8:11], s36 offen offset:3072
    buffer_load_dwordx4 v[220:223], v254, s[8:11], s37 offen offset:3072
    s_add_u32 s34, s34, 44302336
    s_add_u32 s40, s30, s34
    s_addc_u32 s41, s31, 0
    s_mov_b32 s42, 8192
    s_mov_b32 s43, 0x00020000
    s_lshl_b32 s38, s20, 10
    buffer_load_dwordx4 v[224:227], v254, s[40:43], s38 offen
    s_cmp_ge_u32 s20, 4
    s_mov_b32 s35, 44171264
    s_cselect_b32 s35, 44040192, s35
    s_lshl_b32 s36, s21, 15
    s_add_u32 s35, s35, s36
    s_add_u32 s12, s30, s35
    s_addc_u32 s13, s31, 0
    s_mov_b32 s14, 32768
    s_mov_b32 s15, 0x00020000
    s_lshl_b32 s35, s2, 17
    s_add_u32 s16, s28, s35
    s_addc_u32 s17, s29, 0
    s_mov_b32 s18, 131072
    s_mov_b32 s19, 0x00020000
    s_cmp_ge_u32 s20, 4
    s_cbranch_scc1 L_joint_kernel_T
    s_mov_b32 s44, 0xbdd2d3e8
    v_mov_b32 v253, 0xc0135761
    s_mul_i32 s36, s20, 2112
    v_lshl_add_u32 v252, v255, 3, s36
    v_add_u32 v251, s38, v254
    s_waitcnt vmcnt(7)
    v_add_f32 v192, v192, v208
    v_add_f32 v193, v193, v209
    v_add_f32 v194, v194, v210
    v_add_f32 v195, v195, v211
    v_mul_f32 v232, v192, v192
    v_mul_f32 v233, v193, v193
    v_mul_f32 v234, v194, v194
    v_mul_f32 v235, v195, v195
    v_fma_f32 v232, v232, s44, v253
    v_fma_f32 v233, v233, s44, v253
    v_fma_f32 v234, v234, s44, v253
    v_fma_f32 v235, v235, s44, v253
    v_mul_f32 v232, v232, v192
    v_mul_f32 v233, v233, v193
    v_mul_f32 v234, v234, v194
    v_mul_f32 v235, v235, v195
    v_exp_f32 v232, v232
    v_exp_f32 v233, v233
    v_exp_f32 v234, v234
    v_exp_f32 v235, v235
    v_add_f32 v232, 1.0, v232
    v_add_f32 v233, 1.0, v233
    v_add_f32 v234, 1.0, v234
    v_add_f32 v235, 1.0, v235
    v_rcp_f32 v232, v232
    v_rcp_f32 v233, v233
    v_rcp_f32 v234, v234
    v_rcp_f32 v235, v235
    v_mul_f32 v192, v192, v232
    v_mul_f32 v193, v193, v233
    v_mul_f32 v194, v194, v234
    v_mul_f32 v195, v195, v235
    v_cvt_pk_bf16_f32 v236, v192, v193
    v_cvt_pk_bf16_f32 v237, v194, v195
    ds_write_b64 v252, v[236:237] offset:0
    s_waitcnt vmcnt(5)
    v_add_f32 v196, v196, v212
    v_add_f32 v197, v197, v213
    v_add_f32 v198, v198, v214
    v_add_f32 v199, v199, v215
    v_mul_f32 v232, v196, v196
    v_mul_f32 v233, v197, v197
    v_mul_f32 v234, v198, v198
    v_mul_f32 v235, v199, v199
    v_fma_f32 v232, v232, s44, v253
    v_fma_f32 v233, v233, s44, v253
    v_fma_f32 v234, v234, s44, v253
    v_fma_f32 v235, v235, s44, v253
    v_mul_f32 v232, v232, v196
    v_mul_f32 v233, v233, v197
    v_mul_f32 v234, v234, v198
    v_mul_f32 v235, v235, v199
    v_exp_f32 v232, v232
    v_exp_f32 v233, v233
    v_exp_f32 v234, v234
    v_exp_f32 v235, v235
    v_add_f32 v232, 1.0, v232
    v_add_f32 v233, 1.0, v233
    v_add_f32 v234, 1.0, v234
    v_add_f32 v235, 1.0, v235
    v_rcp_f32 v232, v232
    v_rcp_f32 v233, v233
    v_rcp_f32 v234, v234
    v_rcp_f32 v235, v235
    v_mul_f32 v196, v196, v232
    v_mul_f32 v197, v197, v233
    v_mul_f32 v198, v198, v234
    v_mul_f32 v199, v199, v235
    v_cvt_pk_bf16_f32 v238, v196, v197
    v_cvt_pk_bf16_f32 v239, v198, v199
    ds_write_b64 v252, v[238:239] offset:528
    s_waitcnt vmcnt(3)
    v_add_f32 v200, v200, v216
    v_add_f32 v201, v201, v217
    v_add_f32 v202, v202, v218
    v_add_f32 v203, v203, v219
    v_mul_f32 v232, v200, v200
    v_mul_f32 v233, v201, v201
    v_mul_f32 v234, v202, v202
    v_mul_f32 v235, v203, v203
    v_fma_f32 v232, v232, s44, v253
    v_fma_f32 v233, v233, s44, v253
    v_fma_f32 v234, v234, s44, v253
    v_fma_f32 v235, v235, s44, v253
    v_mul_f32 v232, v232, v200
    v_mul_f32 v233, v233, v201
    v_mul_f32 v234, v234, v202
    v_mul_f32 v235, v235, v203
    v_exp_f32 v232, v232
    v_exp_f32 v233, v233
    v_exp_f32 v234, v234
    v_exp_f32 v235, v235
    v_add_f32 v232, 1.0, v232
    v_add_f32 v233, 1.0, v233
    v_add_f32 v234, 1.0, v234
    v_add_f32 v235, 1.0, v235
    v_rcp_f32 v232, v232
    v_rcp_f32 v233, v233
    v_rcp_f32 v234, v234
    v_rcp_f32 v235, v235
    v_mul_f32 v200, v200, v232
    v_mul_f32 v201, v201, v233
    v_mul_f32 v202, v202, v234
    v_mul_f32 v203, v203, v235
    v_cvt_pk_bf16_f32 v240, v200, v201
    v_cvt_pk_bf16_f32 v241, v202, v203
    ds_write_b64 v252, v[240:241] offset:1056
    s_waitcnt vmcnt(1)
    v_add_f32 v204, v204, v220
    v_add_f32 v205, v205, v221
    v_add_f32 v206, v206, v222
    v_add_f32 v207, v207, v223
    v_mul_f32 v232, v204, v204
    v_mul_f32 v233, v205, v205
    v_mul_f32 v234, v206, v206
    v_mul_f32 v235, v207, v207
    v_fma_f32 v232, v232, s44, v253
    v_fma_f32 v233, v233, s44, v253
    v_fma_f32 v234, v234, s44, v253
    v_fma_f32 v235, v235, s44, v253
    v_mul_f32 v232, v232, v204
    v_mul_f32 v233, v233, v205
    v_mul_f32 v234, v234, v206
    v_mul_f32 v235, v235, v207
    v_exp_f32 v232, v232
    v_exp_f32 v233, v233
    v_exp_f32 v234, v234
    v_exp_f32 v235, v235
    v_add_f32 v232, 1.0, v232
    v_add_f32 v233, 1.0, v233
    v_add_f32 v234, 1.0, v234
    v_add_f32 v235, 1.0, v235
    v_rcp_f32 v232, v232
    v_rcp_f32 v233, v233
    v_rcp_f32 v234, v234
    v_rcp_f32 v235, v235
    v_mul_f32 v204, v204, v232
    v_mul_f32 v205, v205, v233
    v_mul_f32 v206, v206, v234
    v_mul_f32 v207, v207, v235
    v_cvt_pk_bf16_f32 v242, v204, v205
    v_cvt_pk_bf16_f32 v243, v206, v207
    ds_write_b64 v252, v[242:243] offset:1584
    s_waitcnt vmcnt(0)
    ds_write_b128 v251, v[224:227] offset:17408
    s_waitcnt lgkmcnt(0)
    s_barrier
    s_mov_b32 s36, 0
    buffer_load_dwordx4 v[0:3], v254, s[12:15], s36 offen offset:0
    buffer_load_dwordx4 v[4:7], v254, s[12:15], s36 offen offset:1024
    buffer_load_dwordx4 v[8:11], v254, s[12:15], s36 offen offset:2048
    buffer_load_dwordx4 v[12:15], v254, s[12:15], s36 offen offset:3072
    s_mov_b32 s36, 4096
    buffer_load_dwordx4 v[16:19], v254, s[12:15], s36 offen offset:0
    buffer_load_dwordx4 v[20:23], v254, s[12:15], s36 offen offset:1024
    buffer_load_dwordx4 v[24:27], v254, s[12:15], s36 offen offset:2048
    buffer_load_dwordx4 v[28:31], v254, s[12:15], s36 offen offset:3072
    s_mov_b32 s36, 8192
    buffer_load_dwordx4 v[32:35], v254, s[12:15], s36 offen offset:0
    buffer_load_dwordx4 v[36:39], v254, s[12:15], s36 offen offset:1024
    buffer_load_dwordx4 v[40:43], v254, s[12:15], s36 offen offset:2048
    buffer_load_dwordx4 v[44:47], v254, s[12:15], s36 offen offset:3072
    s_mov_b32 s36, 12288
    buffer_load_dwordx4 v[48:51], v254, s[12:15], s36 offen offset:0
    buffer_load_dwordx4 v[52:55], v254, s[12:15], s36 offen offset:1024
    buffer_load_dwordx4 v[56:59], v254, s[12:15], s36 offen offset:2048
    buffer_load_dwordx4 v[60:63], v254, s[12:15], s36 offen offset:3072
    s_mov_b32 s36, 16384
    buffer_load_dwordx4 v[64:67], v254, s[12:15], s36 offen offset:0
    buffer_load_dwordx4 v[68:71], v254, s[12:15], s36 offen offset:1024
    buffer_load_dwordx4 v[72:75], v254, s[12:15], s36 offen offset:2048
    buffer_load_dwordx4 v[76:79], v254, s[12:15], s36 offen offset:3072
    s_mov_b32 s36, 20480
    buffer_load_dwordx4 v[80:83], v254, s[12:15], s36 offen offset:0
    buffer_load_dwordx4 v[84:87], v254, s[12:15], s36 offen offset:1024
    buffer_load_dwordx4 v[88:91], v254, s[12:15], s36 offen offset:2048
    buffer_load_dwordx4 v[92:95], v254, s[12:15], s36 offen offset:3072
    s_mov_b32 s36, 24576
    buffer_load_dwordx4 v[96:99], v254, s[12:15], s36 offen offset:0
    buffer_load_dwordx4 v[100:103], v254, s[12:15], s36 offen offset:1024
    buffer_load_dwordx4 v[104:107], v254, s[12:15], s36 offen offset:2048
    buffer_load_dwordx4 v[108:111], v254, s[12:15], s36 offen offset:3072
    s_mov_b32 s36, 28672
    buffer_load_dwordx4 v[112:115], v254, s[12:15], s36 offen offset:0
    buffer_load_dwordx4 v[116:119], v254, s[12:15], s36 offen offset:1024
    buffer_load_dwordx4 v[120:123], v254, s[12:15], s36 offen offset:2048
    buffer_load_dwordx4 v[124:127], v254, s[12:15], s36 offen offset:3072
    v_lshrrev_b32 v250, 5, v255
    v_lshlrev_b32 v250, 14, v250
    v_and_b32 v249, 31, v255
    v_lshl_add_u32 v250, v249, 2, v250
    s_lshl_b32 s36, s21, 7
    v_add_u32 v250, s36, v250
    s_mov_b32 s44, 0
    s_mov_b32 s45, 4096
    s_mov_b32 s46, 8192
    s_mov_b32 s47, 12288
    s_mov_b32 s48, 32768
    s_mov_b32 s49, 36864
    s_mov_b32 s50, 40960
    s_mov_b32 s51, 45056
    s_mov_b32 s52, 65536
    s_mov_b32 s53, 69632
    s_mov_b32 s54, 73728
    s_mov_b32 s55, 77824
    s_mov_b32 s56, 98304
    s_mov_b32 s57, 102400
    s_mov_b32 s58, 106496
    s_mov_b32 s59, 110592
    s_barrier
    ds_read_b128 v[192:195], v254 offset:25600
    ds_read_b128 v[196:199], v254 offset:26624
    ds_read_b128 v[200:203], v254 offset:27648
    ds_read_b128 v[204:207], v254 offset:28672
    ds_read_b128 v[208:211], v254 offset:29696
    ds_read_b128 v[212:215], v254 offset:30720
    s_waitcnt vmcnt(30) lgkmcnt(5)
    v_mfma_f32_32x32x16_bf16 v[128:143], v[192:195], v[0:3], 0
    ds_read_b128 v[216:219], v254 offset:31744
    v_mfma_f32_32x32x16_bf16 v[144:159], v[192:195], v[4:7], 0
    s_waitcnt vmcnt(28) lgkmcnt(5)
    v_mfma_f32_32x32x16_bf16 v[128:143], v[196:199], v[8:11], v[128:143]
    ds_read_b128 v[220:223], v254 offset:32768
    v_mfma_f32_32x32x16_bf16 v[144:159], v[196:199], v[12:15], v[144:159]
    s_waitcnt vmcnt(26) lgkmcnt(5)
    v_mfma_f32_32x32x16_bf16 v[128:143], v[200:203], v[16:19], v[128:143]
    ds_read_b128 v[192:195], v254 offset:33792
    v_mfma_f32_32x32x16_bf16 v[144:159], v[200:203], v[20:23], v[144:159]
    s_waitcnt vmcnt(24) lgkmcnt(5)
    v_mfma_f32_32x32x16_bf16 v[128:143], v[204:207], v[24:27], v[128:143]
    ds_read_b128 v[196:199], v254 offset:34816
    v_mfma_f32_32x32x16_bf16 v[144:159], v[204:207], v[28:31], v[144:159]
    s_waitcnt vmcnt(22) lgkmcnt(5)
    v_mfma_f32_32x32x16_bf16 v[128:143], v[208:211], v[32:35], v[128:143]
    ds_read_b128 v[200:203], v254 offset:35840
    v_mfma_f32_32x32x16_bf16 v[144:159], v[208:211], v[36:39], v[144:159]
    s_waitcnt vmcnt(20) lgkmcnt(5)
    v_mfma_f32_32x32x16_bf16 v[128:143], v[212:215], v[40:43], v[128:143]
    ds_read_b128 v[204:207], v254 offset:36864
    v_mfma_f32_32x32x16_bf16 v[144:159], v[212:215], v[44:47], v[144:159]
    s_waitcnt vmcnt(18) lgkmcnt(5)
    v_mfma_f32_32x32x16_bf16 v[128:143], v[216:219], v[48:51], v[128:143]
    ds_read_b128 v[208:211], v254 offset:37888
    v_mfma_f32_32x32x16_bf16 v[144:159], v[216:219], v[52:55], v[144:159]
    s_waitcnt vmcnt(16) lgkmcnt(5)
    v_mfma_f32_32x32x16_bf16 v[128:143], v[220:223], v[56:59], v[128:143]
    ds_read_b128 v[212:215], v254 offset:38912
    v_mfma_f32_32x32x16_bf16 v[144:159], v[220:223], v[60:63], v[144:159]
    s_waitcnt vmcnt(14) lgkmcnt(5)
    v_mfma_f32_32x32x16_bf16 v[128:143], v[192:195], v[64:67], v[128:143]
    ds_read_b128 v[216:219], v254 offset:39936
    v_mfma_f32_32x32x16_bf16 v[144:159], v[192:195], v[68:71], v[144:159]
    s_waitcnt vmcnt(12) lgkmcnt(5)
    v_mfma_f32_32x32x16_bf16 v[128:143], v[196:199], v[72:75], v[128:143]
    ds_read_b128 v[220:223], v254 offset:40960
    v_mfma_f32_32x32x16_bf16 v[144:159], v[196:199], v[76:79], v[144:159]
    s_waitcnt vmcnt(10) lgkmcnt(5)
    v_mfma_f32_32x32x16_bf16 v[128:143], v[200:203], v[80:83], v[128:143]
    v_mfma_f32_32x32x16_bf16 v[144:159], v[200:203], v[84:87], v[144:159]
    s_waitcnt vmcnt(8) lgkmcnt(4)
    v_mfma_f32_32x32x16_bf16 v[128:143], v[204:207], v[88:91], v[128:143]
    v_mfma_f32_32x32x16_bf16 v[144:159], v[204:207], v[92:95], v[144:159]
    s_waitcnt vmcnt(6) lgkmcnt(3)
    v_mfma_f32_32x32x16_bf16 v[128:143], v[208:211], v[96:99], v[128:143]
    v_mfma_f32_32x32x16_bf16 v[144:159], v[208:211], v[100:103], v[144:159]
    s_waitcnt vmcnt(4) lgkmcnt(2)
    v_mfma_f32_32x32x16_bf16 v[128:143], v[212:215], v[104:107], v[128:143]
    v_mfma_f32_32x32x16_bf16 v[144:159], v[212:215], v[108:111], v[144:159]
    s_waitcnt vmcnt(2) lgkmcnt(1)
    v_mfma_f32_32x32x16_bf16 v[128:143], v[216:219], v[112:115], v[128:143]
    v_mfma_f32_32x32x16_bf16 v[144:159], v[216:219], v[116:119], v[144:159]
    s_waitcnt vmcnt(0) lgkmcnt(0)
    v_mfma_f32_32x32x16_bf16 v[128:143], v[220:223], v[120:123], v[128:143]
    v_mfma_f32_32x32x16_bf16 v[144:159], v[220:223], v[124:127], v[144:159]
    s_barrier
    ds_read_b128 v[192:195], v254 offset:41984
    ds_read_b128 v[196:199], v254 offset:43008
    ds_read_b128 v[200:203], v254 offset:44032
    ds_read_b128 v[204:207], v254 offset:45056
    ds_read_b128 v[208:211], v254 offset:46080
    ds_read_b128 v[212:215], v254 offset:47104
    s_waitcnt lgkmcnt(5)
    v_mfma_f32_32x32x16_bf16 v[160:175], v[192:195], v[0:3], 0
    ds_read_b128 v[216:219], v254 offset:48128
    v_mfma_f32_32x32x16_bf16 v[176:191], v[192:195], v[4:7], 0
    s_waitcnt lgkmcnt(5)
    v_mfma_f32_32x32x16_bf16 v[160:175], v[196:199], v[8:11], v[160:175]
    ds_read_b128 v[220:223], v254 offset:49152
    v_mfma_f32_32x32x16_bf16 v[176:191], v[196:199], v[12:15], v[176:191]
    s_waitcnt lgkmcnt(5)
    v_mfma_f32_32x32x16_bf16 v[160:175], v[200:203], v[16:19], v[160:175]
    ds_read_b128 v[192:195], v254 offset:50176
    v_cvt_pk_bf16_f32 v224, v128, v144
    buffer_store_dword v224, v250, s[16:19], s44 offen offset:0
    v_mfma_f32_32x32x16_bf16 v[176:191], v[200:203], v[20:23], v[176:191]
    v_cvt_pk_bf16_f32 v225, v129, v145
    buffer_store_dword v225, v250, s[16:19], s45 offen offset:0
    s_waitcnt lgkmcnt(5)
    v_mfma_f32_32x32x16_bf16 v[160:175], v[204:207], v[24:27], v[160:175]
    ds_read_b128 v[196:199], v254 offset:51200
    v_cvt_pk_bf16_f32 v226, v130, v146
    buffer_store_dword v226, v250, s[16:19], s46 offen offset:0
    v_mfma_f32_32x32x16_bf16 v[176:191], v[204:207], v[28:31], v[176:191]
    v_cvt_pk_bf16_f32 v227, v131, v147
    buffer_store_dword v227, v250, s[16:19], s47 offen offset:0
    s_waitcnt lgkmcnt(5)
    v_mfma_f32_32x32x16_bf16 v[160:175], v[208:211], v[32:35], v[160:175]
    ds_read_b128 v[200:203], v254 offset:52224
    v_cvt_pk_bf16_f32 v228, v132, v148
    v_mfma_f32_32x32x16_bf16 v[176:191], v[208:211], v[36:39], v[176:191]
    buffer_store_dword v228, v250, s[16:19], s48 offen offset:0
    s_waitcnt lgkmcnt(5)
    v_mfma_f32_32x32x16_bf16 v[160:175], v[212:215], v[40:43], v[160:175]
    ds_read_b128 v[204:207], v254 offset:53248
    v_cvt_pk_bf16_f32 v229, v133, v149
    v_mfma_f32_32x32x16_bf16 v[176:191], v[212:215], v[44:47], v[176:191]
    buffer_store_dword v229, v250, s[16:19], s49 offen offset:0
    s_waitcnt lgkmcnt(5)
    v_mfma_f32_32x32x16_bf16 v[160:175], v[216:219], v[48:51], v[160:175]
    ds_read_b128 v[208:211], v254 offset:54272
    v_cvt_pk_bf16_f32 v230, v134, v150
    v_mfma_f32_32x32x16_bf16 v[176:191], v[216:219], v[52:55], v[176:191]
    buffer_store_dword v230, v250, s[16:19], s50 offen offset:0
    s_waitcnt lgkmcnt(5)
    v_mfma_f32_32x32x16_bf16 v[160:175], v[220:223], v[56:59], v[160:175]
    ds_read_b128 v[212:215], v254 offset:55296
    v_cvt_pk_bf16_f32 v231, v135, v151
    v_mfma_f32_32x32x16_bf16 v[176:191], v[220:223], v[60:63], v[176:191]
    buffer_store_dword v231, v250, s[16:19], s51 offen offset:0
    s_waitcnt lgkmcnt(5)
    v_mfma_f32_32x32x16_bf16 v[160:175], v[192:195], v[64:67], v[160:175]
    ds_read_b128 v[216:219], v254 offset:56320
    v_cvt_pk_bf16_f32 v232, v136, v152
    v_mfma_f32_32x32x16_bf16 v[176:191], v[192:195], v[68:71], v[176:191]
    buffer_store_dword v232, v250, s[16:19], s52 offen offset:0
    s_waitcnt lgkmcnt(5)
    v_mfma_f32_32x32x16_bf16 v[160:175], v[196:199], v[72:75], v[160:175]
    ds_read_b128 v[220:223], v254 offset:57344
    v_cvt_pk_bf16_f32 v233, v137, v153
    v_mfma_f32_32x32x16_bf16 v[176:191], v[196:199], v[76:79], v[176:191]
    buffer_store_dword v233, v250, s[16:19], s53 offen offset:0
    s_waitcnt lgkmcnt(5)
    v_mfma_f32_32x32x16_bf16 v[160:175], v[200:203], v[80:83], v[160:175]
    v_cvt_pk_bf16_f32 v234, v138, v154
    v_mfma_f32_32x32x16_bf16 v[176:191], v[200:203], v[84:87], v[176:191]
    buffer_store_dword v234, v250, s[16:19], s54 offen offset:0
    s_waitcnt lgkmcnt(4)
    v_mfma_f32_32x32x16_bf16 v[160:175], v[204:207], v[88:91], v[160:175]
    v_cvt_pk_bf16_f32 v235, v139, v155
    v_mfma_f32_32x32x16_bf16 v[176:191], v[204:207], v[92:95], v[176:191]
    buffer_store_dword v235, v250, s[16:19], s55 offen offset:0
    s_waitcnt lgkmcnt(3)
    v_mfma_f32_32x32x16_bf16 v[160:175], v[208:211], v[96:99], v[160:175]
    v_cvt_pk_bf16_f32 v236, v140, v156
    v_mfma_f32_32x32x16_bf16 v[176:191], v[208:211], v[100:103], v[176:191]
    buffer_store_dword v236, v250, s[16:19], s56 offen offset:0
    s_waitcnt lgkmcnt(2)
    v_mfma_f32_32x32x16_bf16 v[160:175], v[212:215], v[104:107], v[160:175]
    v_cvt_pk_bf16_f32 v237, v141, v157
    v_mfma_f32_32x32x16_bf16 v[176:191], v[212:215], v[108:111], v[176:191]
    buffer_store_dword v237, v250, s[16:19], s57 offen offset:0
    s_waitcnt lgkmcnt(1)
    v_mfma_f32_32x32x16_bf16 v[160:175], v[216:219], v[112:115], v[160:175]
    v_cvt_pk_bf16_f32 v238, v142, v158
    v_mfma_f32_32x32x16_bf16 v[176:191], v[216:219], v[116:119], v[176:191]
    buffer_store_dword v238, v250, s[16:19], s58 offen offset:0
    s_waitcnt lgkmcnt(0)
    v_mfma_f32_32x32x16_bf16 v[160:175], v[220:223], v[120:123], v[160:175]
    v_cvt_pk_bf16_f32 v239, v143, v159
    v_mfma_f32_32x32x16_bf16 v[176:191], v[220:223], v[124:127], v[176:191]
    buffer_store_dword v239, v250, s[16:19], s59 offen offset:0
    s_barrier
    ds_read_b128 v[192:195], v254 offset:25600
    ds_read_b128 v[196:199], v254 offset:26624
    ds_read_b128 v[200:203], v254 offset:27648
    ds_read_b128 v[204:207], v254 offset:28672
    ds_read_b128 v[208:211], v254 offset:29696
    ds_read_b128 v[212:215], v254 offset:30720
    s_waitcnt lgkmcnt(5)
    v_mfma_f32_32x32x16_bf16 v[128:143], v[192:195], v[0:3], 0
    ds_read_b128 v[216:219], v254 offset:31744
    v_mfma_f32_32x32x16_bf16 v[144:159], v[192:195], v[4:7], 0
    s_waitcnt lgkmcnt(5)
    v_mfma_f32_32x32x16_bf16 v[128:143], v[196:199], v[8:11], v[128:143]
    ds_read_b128 v[220:223], v254 offset:32768
    v_mfma_f32_32x32x16_bf16 v[144:159], v[196:199], v[12:15], v[144:159]
    s_waitcnt lgkmcnt(5)
    v_mfma_f32_32x32x16_bf16 v[128:143], v[200:203], v[16:19], v[128:143]
    ds_read_b128 v[192:195], v254 offset:33792
    v_cvt_pk_bf16_f32 v224, v160, v176
    buffer_store_dword v224, v250, s[16:19], s44 offen offset:512
    v_mfma_f32_32x32x16_bf16 v[144:159], v[200:203], v[20:23], v[144:159]
    v_cvt_pk_bf16_f32 v225, v161, v177
    buffer_store_dword v225, v250, s[16:19], s45 offen offset:512
    s_waitcnt lgkmcnt(5)
    v_mfma_f32_32x32x16_bf16 v[128:143], v[204:207], v[24:27], v[128:143]
    ds_read_b128 v[196:199], v254 offset:34816
    v_cvt_pk_bf16_f32 v226, v162, v178
    buffer_store_dword v226, v250, s[16:19], s46 offen offset:512
    v_mfma_f32_32x32x16_bf16 v[144:159], v[204:207], v[28:31], v[144:159]
    v_cvt_pk_bf16_f32 v227, v163, v179
    buffer_store_dword v227, v250, s[16:19], s47 offen offset:512
    s_waitcnt lgkmcnt(5)
    v_mfma_f32_32x32x16_bf16 v[128:143], v[208:211], v[32:35], v[128:143]
    ds_read_b128 v[200:203], v254 offset:35840
    v_cvt_pk_bf16_f32 v228, v164, v180
    v_mfma_f32_32x32x16_bf16 v[144:159], v[208:211], v[36:39], v[144:159]
    buffer_store_dword v228, v250, s[16:19], s48 offen offset:512
    s_waitcnt lgkmcnt(5)
    v_mfma_f32_32x32x16_bf16 v[128:143], v[212:215], v[40:43], v[128:143]
    ds_read_b128 v[204:207], v254 offset:36864
    v_cvt_pk_bf16_f32 v229, v165, v181
    v_mfma_f32_32x32x16_bf16 v[144:159], v[212:215], v[44:47], v[144:159]
    buffer_store_dword v229, v250, s[16:19], s49 offen offset:512
    s_waitcnt lgkmcnt(5)
    v_mfma_f32_32x32x16_bf16 v[128:143], v[216:219], v[48:51], v[128:143]
    ds_read_b128 v[208:211], v254 offset:37888
    v_cvt_pk_bf16_f32 v230, v166, v182
    v_mfma_f32_32x32x16_bf16 v[144:159], v[216:219], v[52:55], v[144:159]
    buffer_store_dword v230, v250, s[16:19], s50 offen offset:512
    s_waitcnt lgkmcnt(5)
    v_mfma_f32_32x32x16_bf16 v[128:143], v[220:223], v[56:59], v[128:143]
    ds_read_b128 v[212:215], v254 offset:38912
    v_cvt_pk_bf16_f32 v231, v167, v183
    v_mfma_f32_32x32x16_bf16 v[144:159], v[220:223], v[60:63], v[144:159]
    buffer_store_dword v231, v250, s[16:19], s51 offen offset:512
    s_waitcnt lgkmcnt(5)
    v_mfma_f32_32x32x16_bf16 v[128:143], v[192:195], v[64:67], v[128:143]
    ds_read_b128 v[216:219], v254 offset:39936
    v_cvt_pk_bf16_f32 v232, v168, v184
    v_mfma_f32_32x32x16_bf16 v[144:159], v[192:195], v[68:71], v[144:159]
    buffer_store_dword v232, v250, s[16:19], s52 offen offset:512
    s_waitcnt lgkmcnt(5)
    v_mfma_f32_32x32x16_bf16 v[128:143], v[196:199], v[72:75], v[128:143]
    ds_read_b128 v[220:223], v254 offset:40960
    v_cvt_pk_bf16_f32 v233, v169, v185
    v_mfma_f32_32x32x16_bf16 v[144:159], v[196:199], v[76:79], v[144:159]
    buffer_store_dword v233, v250, s[16:19], s53 offen offset:512
    s_waitcnt lgkmcnt(5)
    v_mfma_f32_32x32x16_bf16 v[128:143], v[200:203], v[80:83], v[128:143]
    v_cvt_pk_bf16_f32 v234, v170, v186
    v_mfma_f32_32x32x16_bf16 v[144:159], v[200:203], v[84:87], v[144:159]
    buffer_store_dword v234, v250, s[16:19], s54 offen offset:512
    s_waitcnt lgkmcnt(4)
    v_mfma_f32_32x32x16_bf16 v[128:143], v[204:207], v[88:91], v[128:143]
    v_cvt_pk_bf16_f32 v235, v171, v187
    v_mfma_f32_32x32x16_bf16 v[144:159], v[204:207], v[92:95], v[144:159]
    buffer_store_dword v235, v250, s[16:19], s55 offen offset:512
    s_waitcnt lgkmcnt(3)
    v_mfma_f32_32x32x16_bf16 v[128:143], v[208:211], v[96:99], v[128:143]
    v_cvt_pk_bf16_f32 v236, v172, v188
    v_mfma_f32_32x32x16_bf16 v[144:159], v[208:211], v[100:103], v[144:159]
    buffer_store_dword v236, v250, s[16:19], s56 offen offset:512
    s_waitcnt lgkmcnt(2)
    v_mfma_f32_32x32x16_bf16 v[128:143], v[212:215], v[104:107], v[128:143]
    v_cvt_pk_bf16_f32 v237, v173, v189
    v_mfma_f32_32x32x16_bf16 v[144:159], v[212:215], v[108:111], v[144:159]
    buffer_store_dword v237, v250, s[16:19], s57 offen offset:512
    s_waitcnt lgkmcnt(1)
    v_mfma_f32_32x32x16_bf16 v[128:143], v[216:219], v[112:115], v[128:143]
    v_cvt_pk_bf16_f32 v238, v174, v190
    v_mfma_f32_32x32x16_bf16 v[144:159], v[216:219], v[116:119], v[144:159]
    buffer_store_dword v238, v250, s[16:19], s58 offen offset:512
    s_waitcnt lgkmcnt(0)
    v_mfma_f32_32x32x16_bf16 v[128:143], v[220:223], v[120:123], v[128:143]
    v_cvt_pk_bf16_f32 v239, v175, v191
    v_mfma_f32_32x32x16_bf16 v[144:159], v[220:223], v[124:127], v[144:159]
    buffer_store_dword v239, v250, s[16:19], s59 offen offset:512
    s_barrier
    ds_read_b128 v[192:195], v254 offset:41984
    ds_read_b128 v[196:199], v254 offset:43008
    ds_read_b128 v[200:203], v254 offset:44032
    ds_read_b128 v[204:207], v254 offset:45056
    ds_read_b128 v[208:211], v254 offset:46080
    ds_read_b128 v[212:215], v254 offset:47104
    s_waitcnt lgkmcnt(5)
    v_mfma_f32_32x32x16_bf16 v[160:175], v[192:195], v[0:3], 0
    ds_read_b128 v[216:219], v254 offset:48128
    v_mfma_f32_32x32x16_bf16 v[176:191], v[192:195], v[4:7], 0
    s_waitcnt lgkmcnt(5)
    v_mfma_f32_32x32x16_bf16 v[160:175], v[196:199], v[8:11], v[160:175]
    ds_read_b128 v[220:223], v254 offset:49152
    v_mfma_f32_32x32x16_bf16 v[176:191], v[196:199], v[12:15], v[176:191]
    s_waitcnt lgkmcnt(5)
    v_mfma_f32_32x32x16_bf16 v[160:175], v[200:203], v[16:19], v[160:175]
    ds_read_b128 v[192:195], v254 offset:50176
    v_cvt_pk_bf16_f32 v224, v128, v144
    buffer_store_dword v224, v250, s[16:19], s44 offen offset:1024
    v_mfma_f32_32x32x16_bf16 v[176:191], v[200:203], v[20:23], v[176:191]
    v_cvt_pk_bf16_f32 v225, v129, v145
    buffer_store_dword v225, v250, s[16:19], s45 offen offset:1024
    s_waitcnt lgkmcnt(5)
    v_mfma_f32_32x32x16_bf16 v[160:175], v[204:207], v[24:27], v[160:175]
    ds_read_b128 v[196:199], v254 offset:51200
    v_cvt_pk_bf16_f32 v226, v130, v146
    buffer_store_dword v226, v250, s[16:19], s46 offen offset:1024
    v_mfma_f32_32x32x16_bf16 v[176:191], v[204:207], v[28:31], v[176:191]
    v_cvt_pk_bf16_f32 v227, v131, v147
    buffer_store_dword v227, v250, s[16:19], s47 offen offset:1024
    s_waitcnt lgkmcnt(5)
    v_mfma_f32_32x32x16_bf16 v[160:175], v[208:211], v[32:35], v[160:175]
    ds_read_b128 v[200:203], v254 offset:52224
    v_cvt_pk_bf16_f32 v228, v132, v148
    v_mfma_f32_32x32x16_bf16 v[176:191], v[208:211], v[36:39], v[176:191]
    buffer_store_dword v228, v250, s[16:19], s48 offen offset:1024
    s_waitcnt lgkmcnt(5)
    v_mfma_f32_32x32x16_bf16 v[160:175], v[212:215], v[40:43], v[160:175]
    ds_read_b128 v[204:207], v254 offset:53248
    v_cvt_pk_bf16_f32 v229, v133, v149
    v_mfma_f32_32x32x16_bf16 v[176:191], v[212:215], v[44:47], v[176:191]
    buffer_store_dword v229, v250, s[16:19], s49 offen offset:1024
    s_waitcnt lgkmcnt(5)
    v_mfma_f32_32x32x16_bf16 v[160:175], v[216:219], v[48:51], v[160:175]
    ds_read_b128 v[208:211], v254 offset:54272
    v_cvt_pk_bf16_f32 v230, v134, v150
    v_mfma_f32_32x32x16_bf16 v[176:191], v[216:219], v[52:55], v[176:191]
    buffer_store_dword v230, v250, s[16:19], s50 offen offset:1024
    s_waitcnt lgkmcnt(5)
    v_mfma_f32_32x32x16_bf16 v[160:175], v[220:223], v[56:59], v[160:175]
    ds_read_b128 v[212:215], v254 offset:55296
    v_cvt_pk_bf16_f32 v231, v135, v151
    v_mfma_f32_32x32x16_bf16 v[176:191], v[220:223], v[60:63], v[176:191]
    buffer_store_dword v231, v250, s[16:19], s51 offen offset:1024
    s_waitcnt lgkmcnt(5)
    v_mfma_f32_32x32x16_bf16 v[160:175], v[192:195], v[64:67], v[160:175]
    ds_read_b128 v[216:219], v254 offset:56320
    v_cvt_pk_bf16_f32 v232, v136, v152
    v_mfma_f32_32x32x16_bf16 v[176:191], v[192:195], v[68:71], v[176:191]
    buffer_store_dword v232, v250, s[16:19], s52 offen offset:1024
    s_waitcnt lgkmcnt(5)
    v_mfma_f32_32x32x16_bf16 v[160:175], v[196:199], v[72:75], v[160:175]
    ds_read_b128 v[220:223], v254 offset:57344
    v_cvt_pk_bf16_f32 v233, v137, v153
    v_mfma_f32_32x32x16_bf16 v[176:191], v[196:199], v[76:79], v[176:191]
    s_waitcnt vmcnt(24)
    buffer_store_dword v233, v250, s[16:19], s53 offen offset:1024
    s_waitcnt lgkmcnt(5)
    v_mfma_f32_32x32x16_bf16 v[160:175], v[200:203], v[80:83], v[160:175]
    v_cvt_pk_bf16_f32 v234, v138, v154
    v_mfma_f32_32x32x16_bf16 v[176:191], v[200:203], v[84:87], v[176:191]
    buffer_store_dword v234, v250, s[16:19], s54 offen offset:1024
    s_waitcnt lgkmcnt(4)
    v_mfma_f32_32x32x16_bf16 v[160:175], v[204:207], v[88:91], v[160:175]
    v_cvt_pk_bf16_f32 v235, v139, v155
    v_mfma_f32_32x32x16_bf16 v[176:191], v[204:207], v[92:95], v[176:191]
    buffer_store_dword v235, v250, s[16:19], s55 offen offset:1024
    s_waitcnt lgkmcnt(3)
    v_mfma_f32_32x32x16_bf16 v[160:175], v[208:211], v[96:99], v[160:175]
    v_cvt_pk_bf16_f32 v236, v140, v156
    v_mfma_f32_32x32x16_bf16 v[176:191], v[208:211], v[100:103], v[176:191]
    buffer_store_dword v236, v250, s[16:19], s56 offen offset:1024
    s_waitcnt lgkmcnt(2)
    v_mfma_f32_32x32x16_bf16 v[160:175], v[212:215], v[104:107], v[160:175]
    v_cvt_pk_bf16_f32 v237, v141, v157
    v_mfma_f32_32x32x16_bf16 v[176:191], v[212:215], v[108:111], v[176:191]
    buffer_store_dword v237, v250, s[16:19], s57 offen offset:1024
    s_waitcnt lgkmcnt(1)
    v_mfma_f32_32x32x16_bf16 v[160:175], v[216:219], v[112:115], v[160:175]
    v_cvt_pk_bf16_f32 v238, v142, v158
    v_mfma_f32_32x32x16_bf16 v[176:191], v[216:219], v[116:119], v[176:191]
    buffer_store_dword v238, v250, s[16:19], s58 offen offset:1024
    s_waitcnt lgkmcnt(0)
    v_mfma_f32_32x32x16_bf16 v[160:175], v[220:223], v[120:123], v[160:175]
    v_cvt_pk_bf16_f32 v239, v143, v159
    v_mfma_f32_32x32x16_bf16 v[176:191], v[220:223], v[124:127], v[176:191]
    buffer_store_dword v239, v250, s[16:19], s59 offen offset:1024
    s_barrier
    ds_read_b128 v[192:195], v254 offset:25600
    ds_read_b128 v[196:199], v254 offset:26624
    ds_read_b128 v[200:203], v254 offset:27648
    ds_read_b128 v[204:207], v254 offset:28672
    ds_read_b128 v[208:211], v254 offset:29696
    ds_read_b128 v[212:215], v254 offset:30720
    s_waitcnt lgkmcnt(5)
    v_mfma_f32_32x32x16_bf16 v[128:143], v[192:195], v[0:3], 0
    ds_read_b128 v[216:219], v254 offset:31744
    v_mfma_f32_32x32x16_bf16 v[144:159], v[192:195], v[4:7], 0
    s_waitcnt lgkmcnt(5)
    v_mfma_f32_32x32x16_bf16 v[128:143], v[196:199], v[8:11], v[128:143]
    ds_read_b128 v[220:223], v254 offset:32768
    v_mfma_f32_32x32x16_bf16 v[144:159], v[196:199], v[12:15], v[144:159]
    s_waitcnt lgkmcnt(5)
    v_mfma_f32_32x32x16_bf16 v[128:143], v[200:203], v[16:19], v[128:143]
    ds_read_b128 v[192:195], v254 offset:33792
    v_cvt_pk_bf16_f32 v224, v160, v176
    buffer_store_dword v224, v250, s[16:19], s44 offen offset:1536
    v_mfma_f32_32x32x16_bf16 v[144:159], v[200:203], v[20:23], v[144:159]
    v_cvt_pk_bf16_f32 v225, v161, v177
    buffer_store_dword v225, v250, s[16:19], s45 offen offset:1536
    s_waitcnt lgkmcnt(5)
    v_mfma_f32_32x32x16_bf16 v[128:143], v[204:207], v[24:27], v[128:143]
    ds_read_b128 v[196:199], v254 offset:34816
    v_cvt_pk_bf16_f32 v226, v162, v178
    buffer_store_dword v226, v250, s[16:19], s46 offen offset:1536
    v_mfma_f32_32x32x16_bf16 v[144:159], v[204:207], v[28:31], v[144:159]
    v_cvt_pk_bf16_f32 v227, v163, v179
    buffer_store_dword v227, v250, s[16:19], s47 offen offset:1536
    s_waitcnt lgkmcnt(5)
    v_mfma_f32_32x32x16_bf16 v[128:143], v[208:211], v[32:35], v[128:143]
    ds_read_b128 v[200:203], v254 offset:35840
    v_cvt_pk_bf16_f32 v228, v164, v180
    v_mfma_f32_32x32x16_bf16 v[144:159], v[208:211], v[36:39], v[144:159]
    buffer_store_dword v228, v250, s[16:19], s48 offen offset:1536
    s_waitcnt lgkmcnt(5)
    v_mfma_f32_32x32x16_bf16 v[128:143], v[212:215], v[40:43], v[128:143]
    ds_read_b128 v[204:207], v254 offset:36864
    v_cvt_pk_bf16_f32 v229, v165, v181
    v_mfma_f32_32x32x16_bf16 v[144:159], v[212:215], v[44:47], v[144:159]
    buffer_store_dword v229, v250, s[16:19], s49 offen offset:1536
    s_waitcnt lgkmcnt(5)
    v_mfma_f32_32x32x16_bf16 v[128:143], v[216:219], v[48:51], v[128:143]
    ds_read_b128 v[208:211], v254 offset:37888
    v_cvt_pk_bf16_f32 v230, v166, v182
    v_mfma_f32_32x32x16_bf16 v[144:159], v[216:219], v[52:55], v[144:159]
    buffer_store_dword v230, v250, s[16:19], s50 offen offset:1536
    s_waitcnt lgkmcnt(5)
    v_mfma_f32_32x32x16_bf16 v[128:143], v[220:223], v[56:59], v[128:143]
    ds_read_b128 v[212:215], v254 offset:38912
    v_cvt_pk_bf16_f32 v231, v167, v183
    v_mfma_f32_32x32x16_bf16 v[144:159], v[220:223], v[60:63], v[144:159]
    buffer_store_dword v231, v250, s[16:19], s51 offen offset:1536
    s_waitcnt lgkmcnt(5)
    v_mfma_f32_32x32x16_bf16 v[128:143], v[192:195], v[64:67], v[128:143]
    ds_read_b128 v[216:219], v254 offset:39936
    v_cvt_pk_bf16_f32 v232, v168, v184
    v_mfma_f32_32x32x16_bf16 v[144:159], v[192:195], v[68:71], v[144:159]
    buffer_store_dword v232, v250, s[16:19], s52 offen offset:1536
    s_waitcnt lgkmcnt(5)
    v_mfma_f32_32x32x16_bf16 v[128:143], v[196:199], v[72:75], v[128:143]
    ds_read_b128 v[220:223], v254 offset:40960
    v_cvt_pk_bf16_f32 v233, v169, v185
    v_mfma_f32_32x32x16_bf16 v[144:159], v[196:199], v[76:79], v[144:159]
    buffer_store_dword v233, v250, s[16:19], s53 offen offset:1536
    s_waitcnt lgkmcnt(5)
    v_mfma_f32_32x32x16_bf16 v[128:143], v[200:203], v[80:83], v[128:143]
    v_cvt_pk_bf16_f32 v234, v170, v186
    v_mfma_f32_32x32x16_bf16 v[144:159], v[200:203], v[84:87], v[144:159]
    s_waitcnt vmcnt(24)
    buffer_store_dword v234, v250, s[16:19], s54 offen offset:1536
    s_waitcnt lgkmcnt(4)
    v_mfma_f32_32x32x16_bf16 v[128:143], v[204:207], v[88:91], v[128:143]
    v_cvt_pk_bf16_f32 v235, v171, v187
    v_mfma_f32_32x32x16_bf16 v[144:159], v[204:207], v[92:95], v[144:159]
    buffer_store_dword v235, v250, s[16:19], s55 offen offset:1536
    s_waitcnt lgkmcnt(3)
    v_mfma_f32_32x32x16_bf16 v[128:143], v[208:211], v[96:99], v[128:143]
    v_cvt_pk_bf16_f32 v236, v172, v188
    v_mfma_f32_32x32x16_bf16 v[144:159], v[208:211], v[100:103], v[144:159]
    buffer_store_dword v236, v250, s[16:19], s56 offen offset:1536
    s_waitcnt lgkmcnt(2)
    v_mfma_f32_32x32x16_bf16 v[128:143], v[212:215], v[104:107], v[128:143]
    v_cvt_pk_bf16_f32 v237, v173, v189
    v_mfma_f32_32x32x16_bf16 v[144:159], v[212:215], v[108:111], v[144:159]
    buffer_store_dword v237, v250, s[16:19], s57 offen offset:1536
    s_waitcnt lgkmcnt(1)
    v_mfma_f32_32x32x16_bf16 v[128:143], v[216:219], v[112:115], v[128:143]
    v_cvt_pk_bf16_f32 v238, v174, v190
    v_mfma_f32_32x32x16_bf16 v[144:159], v[216:219], v[116:119], v[144:159]
    buffer_store_dword v238, v250, s[16:19], s58 offen offset:1536
    s_waitcnt lgkmcnt(0)
    v_mfma_f32_32x32x16_bf16 v[128:143], v[220:223], v[120:123], v[128:143]
    v_cvt_pk_bf16_f32 v239, v175, v191
    v_mfma_f32_32x32x16_bf16 v[144:159], v[220:223], v[124:127], v[144:159]
    buffer_store_dword v239, v250, s[16:19], s59 offen offset:1536
    s_barrier
    ds_read_b128 v[192:195], v254 offset:41984
    ds_read_b128 v[196:199], v254 offset:43008
    ds_read_b128 v[200:203], v254 offset:44032
    ds_read_b128 v[204:207], v254 offset:45056
    ds_read_b128 v[208:211], v254 offset:46080
    ds_read_b128 v[212:215], v254 offset:47104
    s_waitcnt lgkmcnt(5)
    v_mfma_f32_32x32x16_bf16 v[160:175], v[192:195], v[0:3], 0
    ds_read_b128 v[216:219], v254 offset:48128
    v_mfma_f32_32x32x16_bf16 v[176:191], v[192:195], v[4:7], 0
    s_waitcnt lgkmcnt(5)
    v_mfma_f32_32x32x16_bf16 v[160:175], v[196:199], v[8:11], v[160:175]
    ds_read_b128 v[220:223], v254 offset:49152
    v_mfma_f32_32x32x16_bf16 v[176:191], v[196:199], v[12:15], v[176:191]
    s_waitcnt lgkmcnt(5)
    v_mfma_f32_32x32x16_bf16 v[160:175], v[200:203], v[16:19], v[160:175]
    ds_read_b128 v[192:195], v254 offset:50176
    v_cvt_pk_bf16_f32 v224, v128, v144
    buffer_store_dword v224, v250, s[16:19], s44 offen offset:2048
    v_mfma_f32_32x32x16_bf16 v[176:191], v[200:203], v[20:23], v[176:191]
    v_cvt_pk_bf16_f32 v225, v129, v145
    buffer_store_dword v225, v250, s[16:19], s45 offen offset:2048
    s_waitcnt lgkmcnt(5)
    v_mfma_f32_32x32x16_bf16 v[160:175], v[204:207], v[24:27], v[160:175]
    ds_read_b128 v[196:199], v254 offset:51200
    v_cvt_pk_bf16_f32 v226, v130, v146
    buffer_store_dword v226, v250, s[16:19], s46 offen offset:2048
    v_mfma_f32_32x32x16_bf16 v[176:191], v[204:207], v[28:31], v[176:191]
    v_cvt_pk_bf16_f32 v227, v131, v147
    buffer_store_dword v227, v250, s[16:19], s47 offen offset:2048
    s_waitcnt lgkmcnt(5)
    v_mfma_f32_32x32x16_bf16 v[160:175], v[208:211], v[32:35], v[160:175]
    ds_read_b128 v[200:203], v254 offset:52224
    v_cvt_pk_bf16_f32 v228, v132, v148
    v_mfma_f32_32x32x16_bf16 v[176:191], v[208:211], v[36:39], v[176:191]
    buffer_store_dword v228, v250, s[16:19], s48 offen offset:2048
    s_waitcnt lgkmcnt(5)
    v_mfma_f32_32x32x16_bf16 v[160:175], v[212:215], v[40:43], v[160:175]
    ds_read_b128 v[204:207], v254 offset:53248
    v_cvt_pk_bf16_f32 v229, v133, v149
    v_mfma_f32_32x32x16_bf16 v[176:191], v[212:215], v[44:47], v[176:191]
    buffer_store_dword v229, v250, s[16:19], s49 offen offset:2048
    s_waitcnt lgkmcnt(5)
    v_mfma_f32_32x32x16_bf16 v[160:175], v[216:219], v[48:51], v[160:175]
    ds_read_b128 v[208:211], v254 offset:54272
    v_cvt_pk_bf16_f32 v230, v134, v150
    v_mfma_f32_32x32x16_bf16 v[176:191], v[216:219], v[52:55], v[176:191]
    buffer_store_dword v230, v250, s[16:19], s50 offen offset:2048
    s_waitcnt lgkmcnt(5)
    v_mfma_f32_32x32x16_bf16 v[160:175], v[220:223], v[56:59], v[160:175]
    ds_read_b128 v[212:215], v254 offset:55296
    v_cvt_pk_bf16_f32 v231, v135, v151
    v_mfma_f32_32x32x16_bf16 v[176:191], v[220:223], v[60:63], v[176:191]
    buffer_store_dword v231, v250, s[16:19], s51 offen offset:2048
    s_waitcnt lgkmcnt(5)
    v_mfma_f32_32x32x16_bf16 v[160:175], v[192:195], v[64:67], v[160:175]
    ds_read_b128 v[216:219], v254 offset:56320
    v_cvt_pk_bf16_f32 v232, v136, v152
    v_mfma_f32_32x32x16_bf16 v[176:191], v[192:195], v[68:71], v[176:191]
    buffer_store_dword v232, v250, s[16:19], s52 offen offset:2048
    s_waitcnt lgkmcnt(5)
    v_mfma_f32_32x32x16_bf16 v[160:175], v[196:199], v[72:75], v[160:175]
    ds_read_b128 v[220:223], v254 offset:57344
    v_cvt_pk_bf16_f32 v233, v137, v153
    v_mfma_f32_32x32x16_bf16 v[176:191], v[196:199], v[76:79], v[176:191]
    buffer_store_dword v233, v250, s[16:19], s53 offen offset:2048
    s_waitcnt lgkmcnt(5)
    v_mfma_f32_32x32x16_bf16 v[160:175], v[200:203], v[80:83], v[160:175]
    v_cvt_pk_bf16_f32 v234, v138, v154
    v_mfma_f32_32x32x16_bf16 v[176:191], v[200:203], v[84:87], v[176:191]
    buffer_store_dword v234, v250, s[16:19], s54 offen offset:2048
    s_waitcnt lgkmcnt(4)
    v_mfma_f32_32x32x16_bf16 v[160:175], v[204:207], v[88:91], v[160:175]
    v_cvt_pk_bf16_f32 v235, v139, v155
    v_mfma_f32_32x32x16_bf16 v[176:191], v[204:207], v[92:95], v[176:191]
    s_waitcnt vmcnt(24)
    buffer_store_dword v235, v250, s[16:19], s55 offen offset:2048
    s_waitcnt lgkmcnt(3)
    v_mfma_f32_32x32x16_bf16 v[160:175], v[208:211], v[96:99], v[160:175]
    v_cvt_pk_bf16_f32 v236, v140, v156
    v_mfma_f32_32x32x16_bf16 v[176:191], v[208:211], v[100:103], v[176:191]
    buffer_store_dword v236, v250, s[16:19], s56 offen offset:2048
    s_waitcnt lgkmcnt(2)
    v_mfma_f32_32x32x16_bf16 v[160:175], v[212:215], v[104:107], v[160:175]
    v_cvt_pk_bf16_f32 v237, v141, v157
    v_mfma_f32_32x32x16_bf16 v[176:191], v[212:215], v[108:111], v[176:191]
    buffer_store_dword v237, v250, s[16:19], s57 offen offset:2048
    s_waitcnt lgkmcnt(1)
    v_mfma_f32_32x32x16_bf16 v[160:175], v[216:219], v[112:115], v[160:175]
    v_cvt_pk_bf16_f32 v238, v142, v158
    v_mfma_f32_32x32x16_bf16 v[176:191], v[216:219], v[116:119], v[176:191]
    buffer_store_dword v238, v250, s[16:19], s58 offen offset:2048
    s_waitcnt lgkmcnt(0)
    v_mfma_f32_32x32x16_bf16 v[160:175], v[220:223], v[120:123], v[160:175]
    v_cvt_pk_bf16_f32 v239, v143, v159
    v_mfma_f32_32x32x16_bf16 v[176:191], v[220:223], v[124:127], v[176:191]
    buffer_store_dword v239, v250, s[16:19], s59 offen offset:2048
    s_barrier
    ds_read_b128 v[192:195], v254 offset:25600
    ds_read_b128 v[196:199], v254 offset:26624
    ds_read_b128 v[200:203], v254 offset:27648
    ds_read_b128 v[204:207], v254 offset:28672
    ds_read_b128 v[208:211], v254 offset:29696
    ds_read_b128 v[212:215], v254 offset:30720
    s_waitcnt lgkmcnt(5)
    v_mfma_f32_32x32x16_bf16 v[128:143], v[192:195], v[0:3], 0
    ds_read_b128 v[216:219], v254 offset:31744
    v_mfma_f32_32x32x16_bf16 v[144:159], v[192:195], v[4:7], 0
    s_waitcnt lgkmcnt(5)
    v_mfma_f32_32x32x16_bf16 v[128:143], v[196:199], v[8:11], v[128:143]
    ds_read_b128 v[220:223], v254 offset:32768
    v_mfma_f32_32x32x16_bf16 v[144:159], v[196:199], v[12:15], v[144:159]
    s_waitcnt lgkmcnt(5)
    v_mfma_f32_32x32x16_bf16 v[128:143], v[200:203], v[16:19], v[128:143]
    ds_read_b128 v[192:195], v254 offset:33792
    v_cvt_pk_bf16_f32 v224, v160, v176
    buffer_store_dword v224, v250, s[16:19], s44 offen offset:2560
    v_mfma_f32_32x32x16_bf16 v[144:159], v[200:203], v[20:23], v[144:159]
    v_cvt_pk_bf16_f32 v225, v161, v177
    buffer_store_dword v225, v250, s[16:19], s45 offen offset:2560
    s_waitcnt lgkmcnt(5)
    v_mfma_f32_32x32x16_bf16 v[128:143], v[204:207], v[24:27], v[128:143]
    ds_read_b128 v[196:199], v254 offset:34816
    v_cvt_pk_bf16_f32 v226, v162, v178
    buffer_store_dword v226, v250, s[16:19], s46 offen offset:2560
    v_mfma_f32_32x32x16_bf16 v[144:159], v[204:207], v[28:31], v[144:159]
    v_cvt_pk_bf16_f32 v227, v163, v179
    buffer_store_dword v227, v250, s[16:19], s47 offen offset:2560
    s_waitcnt lgkmcnt(5)
    v_mfma_f32_32x32x16_bf16 v[128:143], v[208:211], v[32:35], v[128:143]
    ds_read_b128 v[200:203], v254 offset:35840
    v_cvt_pk_bf16_f32 v228, v164, v180
    v_mfma_f32_32x32x16_bf16 v[144:159], v[208:211], v[36:39], v[144:159]
    buffer_store_dword v228, v250, s[16:19], s48 offen offset:2560
    s_waitcnt lgkmcnt(5)
    v_mfma_f32_32x32x16_bf16 v[128:143], v[212:215], v[40:43], v[128:143]
    ds_read_b128 v[204:207], v254 offset:36864
    v_cvt_pk_bf16_f32 v229, v165, v181
    v_mfma_f32_32x32x16_bf16 v[144:159], v[212:215], v[44:47], v[144:159]
    buffer_store_dword v229, v250, s[16:19], s49 offen offset:2560
    s_waitcnt lgkmcnt(5)
    v_mfma_f32_32x32x16_bf16 v[128:143], v[216:219], v[48:51], v[128:143]
    ds_read_b128 v[208:211], v254 offset:37888
    v_cvt_pk_bf16_f32 v230, v166, v182
    v_mfma_f32_32x32x16_bf16 v[144:159], v[216:219], v[52:55], v[144:159]
    buffer_store_dword v230, v250, s[16:19], s50 offen offset:2560
    s_waitcnt lgkmcnt(5)
    v_mfma_f32_32x32x16_bf16 v[128:143], v[220:223], v[56:59], v[128:143]
    ds_read_b128 v[212:215], v254 offset:38912
    v_cvt_pk_bf16_f32 v231, v167, v183
    v_mfma_f32_32x32x16_bf16 v[144:159], v[220:223], v[60:63], v[144:159]
    buffer_store_dword v231, v250, s[16:19], s51 offen offset:2560
    s_waitcnt lgkmcnt(5)
    v_mfma_f32_32x32x16_bf16 v[128:143], v[192:195], v[64:67], v[128:143]
    ds_read_b128 v[216:219], v254 offset:39936
    v_cvt_pk_bf16_f32 v232, v168, v184
    v_mfma_f32_32x32x16_bf16 v[144:159], v[192:195], v[68:71], v[144:159]
    buffer_store_dword v232, v250, s[16:19], s52 offen offset:2560
    s_waitcnt lgkmcnt(5)
    v_mfma_f32_32x32x16_bf16 v[128:143], v[196:199], v[72:75], v[128:143]
    ds_read_b128 v[220:223], v254 offset:40960
    v_cvt_pk_bf16_f32 v233, v169, v185
    v_mfma_f32_32x32x16_bf16 v[144:159], v[196:199], v[76:79], v[144:159]
    buffer_store_dword v233, v250, s[16:19], s53 offen offset:2560
    s_waitcnt lgkmcnt(5)
    v_mfma_f32_32x32x16_bf16 v[128:143], v[200:203], v[80:83], v[128:143]
    v_cvt_pk_bf16_f32 v234, v170, v186
    v_mfma_f32_32x32x16_bf16 v[144:159], v[200:203], v[84:87], v[144:159]
    buffer_store_dword v234, v250, s[16:19], s54 offen offset:2560
    s_waitcnt lgkmcnt(4)
    v_mfma_f32_32x32x16_bf16 v[128:143], v[204:207], v[88:91], v[128:143]
    v_cvt_pk_bf16_f32 v235, v171, v187
    v_mfma_f32_32x32x16_bf16 v[144:159], v[204:207], v[92:95], v[144:159]
    buffer_store_dword v235, v250, s[16:19], s55 offen offset:2560
    s_waitcnt lgkmcnt(3)
    v_mfma_f32_32x32x16_bf16 v[128:143], v[208:211], v[96:99], v[128:143]
    v_cvt_pk_bf16_f32 v236, v172, v188
    v_mfma_f32_32x32x16_bf16 v[144:159], v[208:211], v[100:103], v[144:159]
    s_waitcnt vmcnt(24)
    buffer_store_dword v236, v250, s[16:19], s56 offen offset:2560
    s_waitcnt lgkmcnt(2)
    v_mfma_f32_32x32x16_bf16 v[128:143], v[212:215], v[104:107], v[128:143]
    v_cvt_pk_bf16_f32 v237, v173, v189
    v_mfma_f32_32x32x16_bf16 v[144:159], v[212:215], v[108:111], v[144:159]
    buffer_store_dword v237, v250, s[16:19], s57 offen offset:2560
    s_waitcnt lgkmcnt(1)
    v_mfma_f32_32x32x16_bf16 v[128:143], v[216:219], v[112:115], v[128:143]
    v_cvt_pk_bf16_f32 v238, v174, v190
    v_mfma_f32_32x32x16_bf16 v[144:159], v[216:219], v[116:119], v[144:159]
    buffer_store_dword v238, v250, s[16:19], s58 offen offset:2560
    s_waitcnt lgkmcnt(0)
    v_mfma_f32_32x32x16_bf16 v[128:143], v[220:223], v[120:123], v[128:143]
    v_cvt_pk_bf16_f32 v239, v175, v191
    v_mfma_f32_32x32x16_bf16 v[144:159], v[220:223], v[124:127], v[144:159]
    buffer_store_dword v239, v250, s[16:19], s59 offen offset:2560
    s_barrier
    ds_read_b128 v[192:195], v254 offset:41984
    ds_read_b128 v[196:199], v254 offset:43008
    ds_read_b128 v[200:203], v254 offset:44032
    ds_read_b128 v[204:207], v254 offset:45056
    ds_read_b128 v[208:211], v254 offset:46080
    ds_read_b128 v[212:215], v254 offset:47104
    s_waitcnt lgkmcnt(5)
    v_mfma_f32_32x32x16_bf16 v[160:175], v[192:195], v[0:3], 0
    ds_read_b128 v[216:219], v254 offset:48128
    v_mfma_f32_32x32x16_bf16 v[176:191], v[192:195], v[4:7], 0
    s_waitcnt lgkmcnt(5)
    v_mfma_f32_32x32x16_bf16 v[160:175], v[196:199], v[8:11], v[160:175]
    ds_read_b128 v[220:223], v254 offset:49152
    v_mfma_f32_32x32x16_bf16 v[176:191], v[196:199], v[12:15], v[176:191]
    s_waitcnt lgkmcnt(5)
    v_mfma_f32_32x32x16_bf16 v[160:175], v[200:203], v[16:19], v[160:175]
    ds_read_b128 v[192:195], v254 offset:50176
    v_cvt_pk_bf16_f32 v224, v128, v144
    buffer_store_dword v224, v250, s[16:19], s44 offen offset:3072
    v_mfma_f32_32x32x16_bf16 v[176:191], v[200:203], v[20:23], v[176:191]
    v_cvt_pk_bf16_f32 v225, v129, v145
    buffer_store_dword v225, v250, s[16:19], s45 offen offset:3072
    s_waitcnt lgkmcnt(5)
    v_mfma_f32_32x32x16_bf16 v[160:175], v[204:207], v[24:27], v[160:175]
    ds_read_b128 v[196:199], v254 offset:51200
    v_cvt_pk_bf16_f32 v226, v130, v146
    buffer_store_dword v226, v250, s[16:19], s46 offen offset:3072
    v_mfma_f32_32x32x16_bf16 v[176:191], v[204:207], v[28:31], v[176:191]
    v_cvt_pk_bf16_f32 v227, v131, v147
    buffer_store_dword v227, v250, s[16:19], s47 offen offset:3072
    s_waitcnt lgkmcnt(5)
    v_mfma_f32_32x32x16_bf16 v[160:175], v[208:211], v[32:35], v[160:175]
    ds_read_b128 v[200:203], v254 offset:52224
    v_cvt_pk_bf16_f32 v228, v132, v148
    v_mfma_f32_32x32x16_bf16 v[176:191], v[208:211], v[36:39], v[176:191]
    buffer_store_dword v228, v250, s[16:19], s48 offen offset:3072
    s_waitcnt lgkmcnt(5)
    v_mfma_f32_32x32x16_bf16 v[160:175], v[212:215], v[40:43], v[160:175]
    ds_read_b128 v[204:207], v254 offset:53248
    v_cvt_pk_bf16_f32 v229, v133, v149
    v_mfma_f32_32x32x16_bf16 v[176:191], v[212:215], v[44:47], v[176:191]
    buffer_store_dword v229, v250, s[16:19], s49 offen offset:3072
    s_waitcnt lgkmcnt(5)
    v_mfma_f32_32x32x16_bf16 v[160:175], v[216:219], v[48:51], v[160:175]
    ds_read_b128 v[208:211], v254 offset:54272
    v_cvt_pk_bf16_f32 v230, v134, v150
    v_mfma_f32_32x32x16_bf16 v[176:191], v[216:219], v[52:55], v[176:191]
    buffer_store_dword v230, v250, s[16:19], s50 offen offset:3072
    s_waitcnt lgkmcnt(5)
    v_mfma_f32_32x32x16_bf16 v[160:175], v[220:223], v[56:59], v[160:175]
    ds_read_b128 v[212:215], v254 offset:55296
    v_cvt_pk_bf16_f32 v231, v135, v151
    v_mfma_f32_32x32x16_bf16 v[176:191], v[220:223], v[60:63], v[176:191]
    buffer_store_dword v231, v250, s[16:19], s51 offen offset:3072
    s_waitcnt lgkmcnt(5)
    v_mfma_f32_32x32x16_bf16 v[160:175], v[192:195], v[64:67], v[160:175]
    ds_read_b128 v[216:219], v254 offset:56320
    v_cvt_pk_bf16_f32 v232, v136, v152
    v_mfma_f32_32x32x16_bf16 v[176:191], v[192:195], v[68:71], v[176:191]
    buffer_store_dword v232, v250, s[16:19], s52 offen offset:3072
    s_waitcnt lgkmcnt(5)
    v_mfma_f32_32x32x16_bf16 v[160:175], v[196:199], v[72:75], v[160:175]
    ds_read_b128 v[220:223], v254 offset:57344
    v_cvt_pk_bf16_f32 v233, v137, v153
    v_mfma_f32_32x32x16_bf16 v[176:191], v[196:199], v[76:79], v[176:191]
    buffer_store_dword v233, v250, s[16:19], s53 offen offset:3072
    s_waitcnt lgkmcnt(5)
    v_mfma_f32_32x32x16_bf16 v[160:175], v[200:203], v[80:83], v[160:175]
    v_cvt_pk_bf16_f32 v234, v138, v154
    v_mfma_f32_32x32x16_bf16 v[176:191], v[200:203], v[84:87], v[176:191]
    buffer_store_dword v234, v250, s[16:19], s54 offen offset:3072
    s_waitcnt lgkmcnt(4)
    v_mfma_f32_32x32x16_bf16 v[160:175], v[204:207], v[88:91], v[160:175]
    v_cvt_pk_bf16_f32 v235, v139, v155
    v_mfma_f32_32x32x16_bf16 v[176:191], v[204:207], v[92:95], v[176:191]
    buffer_store_dword v235, v250, s[16:19], s55 offen offset:3072
    s_waitcnt lgkmcnt(3)
    v_mfma_f32_32x32x16_bf16 v[160:175], v[208:211], v[96:99], v[160:175]
    v_cvt_pk_bf16_f32 v236, v140, v156
    v_mfma_f32_32x32x16_bf16 v[176:191], v[208:211], v[100:103], v[176:191]
    buffer_store_dword v236, v250, s[16:19], s56 offen offset:3072
    s_waitcnt lgkmcnt(2)
    v_mfma_f32_32x32x16_bf16 v[160:175], v[212:215], v[104:107], v[160:175]
    v_cvt_pk_bf16_f32 v237, v141, v157
    v_mfma_f32_32x32x16_bf16 v[176:191], v[212:215], v[108:111], v[176:191]
    s_waitcnt vmcnt(24)
    buffer_store_dword v237, v250, s[16:19], s57 offen offset:3072
    s_waitcnt lgkmcnt(1)
    v_mfma_f32_32x32x16_bf16 v[160:175], v[216:219], v[112:115], v[160:175]
    v_cvt_pk_bf16_f32 v238, v142, v158
    v_mfma_f32_32x32x16_bf16 v[176:191], v[216:219], v[116:119], v[176:191]
    buffer_store_dword v238, v250, s[16:19], s58 offen offset:3072
    s_waitcnt lgkmcnt(0)
    v_mfma_f32_32x32x16_bf16 v[160:175], v[220:223], v[120:123], v[160:175]
    v_cvt_pk_bf16_f32 v239, v143, v159
    v_mfma_f32_32x32x16_bf16 v[176:191], v[220:223], v[124:127], v[176:191]
    buffer_store_dword v239, v250, s[16:19], s59 offen offset:3072
    s_nop 15
    v_cvt_pk_bf16_f32 v224, v160, v176
    buffer_store_dword v224, v250, s[16:19], s44 offen offset:3584
    v_cvt_pk_bf16_f32 v225, v161, v177
    buffer_store_dword v225, v250, s[16:19], s45 offen offset:3584
    v_cvt_pk_bf16_f32 v226, v162, v178
    buffer_store_dword v226, v250, s[16:19], s46 offen offset:3584
    v_cvt_pk_bf16_f32 v227, v163, v179
    buffer_store_dword v227, v250, s[16:19], s47 offen offset:3584
    v_cvt_pk_bf16_f32 v228, v164, v180
    buffer_store_dword v228, v250, s[16:19], s48 offen offset:3584
    v_cvt_pk_bf16_f32 v229, v165, v181
    buffer_store_dword v229, v250, s[16:19], s49 offen offset:3584
    v_cvt_pk_bf16_f32 v230, v166, v182
    buffer_store_dword v230, v250, s[16:19], s50 offen offset:3584
    v_cvt_pk_bf16_f32 v231, v167, v183
    buffer_store_dword v231, v250, s[16:19], s51 offen offset:3584
    v_cvt_pk_bf16_f32 v232, v168, v184
    buffer_store_dword v232, v250, s[16:19], s52 offen offset:3584
    v_cvt_pk_bf16_f32 v233, v169, v185
    buffer_store_dword v233, v250, s[16:19], s53 offen offset:3584
    v_cvt_pk_bf16_f32 v234, v170, v186
    buffer_store_dword v234, v250, s[16:19], s54 offen offset:3584
    v_cvt_pk_bf16_f32 v235, v171, v187
    buffer_store_dword v235, v250, s[16:19], s55 offen offset:3584
    v_cvt_pk_bf16_f32 v236, v172, v188
    buffer_store_dword v236, v250, s[16:19], s56 offen offset:3584
    v_cvt_pk_bf16_f32 v237, v173, v189
    buffer_store_dword v237, v250, s[16:19], s57 offen offset:3584
    v_cvt_pk_bf16_f32 v238, v174, v190
    buffer_store_dword v238, v250, s[16:19], s58 offen offset:3584
    v_cvt_pk_bf16_f32 v239, v175, v191
    buffer_store_dword v239, v250, s[16:19], s59 offen offset:3584
    s_branch L_joint_kernel_fin
L_joint_kernel_T:
    s_mov_b32 s36, 0
    buffer_load_dwordx4 v[0:3], v254, s[12:15], s36 offen offset:0
    buffer_load_dwordx4 v[4:7], v254, s[12:15], s36 offen offset:1024
    buffer_load_dwordx4 v[8:11], v254, s[12:15], s36 offen offset:2048
    buffer_load_dwordx4 v[12:15], v254, s[12:15], s36 offen offset:3072
    s_mov_b32 s36, 4096
    buffer_load_dwordx4 v[16:19], v254, s[12:15], s36 offen offset:0
    buffer_load_dwordx4 v[20:23], v254, s[12:15], s36 offen offset:1024
    buffer_load_dwordx4 v[24:27], v254, s[12:15], s36 offen offset:2048
    buffer_load_dwordx4 v[28:31], v254, s[12:15], s36 offen offset:3072
    s_mov_b32 s36, 8192
    buffer_load_dwordx4 v[32:35], v254, s[12:15], s36 offen offset:0
    buffer_load_dwordx4 v[36:39], v254, s[12:15], s36 offen offset:1024
    buffer_load_dwordx4 v[40:43], v254, s[12:15], s36 offen offset:2048
    buffer_load_dwordx4 v[44:47], v254, s[12:15], s36 offen offset:3072
    s_mov_b32 s36, 12288
    buffer_load_dwordx4 v[48:51], v254, s[12:15], s36 offen offset:0
    buffer_load_dwordx4 v[52:55], v254, s[12:15], s36 offen offset:1024
    buffer_load_dwordx4 v[56:59], v254, s[12:15], s36 offen offset:2048
    buffer_load_dwordx4 v[60:63], v254, s[12:15], s36 offen offset:3072
    s_mov_b32 s36, 16384
    buffer_load_dwordx4 v[64:67], v254, s[12:15], s36 offen offset:0
    buffer_load_dwordx4 v[68:71], v254, s[12:15], s36 offen offset:1024
    buffer_load_dwordx4 v[72:75], v254, s[12:15], s36 offen offset:2048
    buffer_load_dwordx4 v[76:79], v254, s[12:15], s36 offen offset:3072
    s_mov_b32 s36, 20480
    buffer_load_dwordx4 v[80:83], v254, s[12:15], s36 offen offset:0
    buffer_load_dwordx4 v[84:87], v254, s[12:15], s36 offen offset:1024
    buffer_load_dwordx4 v[88:91], v254, s[12:15], s36 offen offset:2048
    buffer_load_dwordx4 v[92:95], v254, s[12:15], s36 offen offset:3072
    s_mov_b32 s36, 24576
    buffer_load_dwordx4 v[96:99], v254, s[12:15], s36 offen offset:0
    buffer_load_dwordx4 v[100:103], v254, s[12:15], s36 offen offset:1024
    buffer_load_dwordx4 v[104:107], v254, s[12:15], s36 offen offset:2048
    buffer_load_dwordx4 v[108:111], v254, s[12:15], s36 offen offset:3072
    s_mov_b32 s36, 28672
    buffer_load_dwordx4 v[112:115], v254, s[12:15], s36 offen offset:0
    buffer_load_dwordx4 v[116:119], v254, s[12:15], s36 offen offset:1024
    buffer_load_dwordx4 v[120:123], v254, s[12:15], s36 offen offset:2048
    buffer_load_dwordx4 v[124:127], v254, s[12:15], s36 offen offset:3072
    s_mov_b32 s44, 0xbdd2d3e8
    v_mov_b32 v253, 0xc0135761
    s_mul_i32 s36, s20, 2112
    v_lshl_add_u32 v252, v255, 3, s36
    v_add_u32 v251, s38, v254
    s_waitcnt vmcnt(39)
    v_add_f32 v192, v192, v208
    v_add_f32 v193, v193, v209
    v_add_f32 v194, v194, v210
    v_add_f32 v195, v195, v211
    v_mul_f32 v232, v192, v192
    v_mul_f32 v233, v193, v193
    v_mul_f32 v234, v194, v194
    v_mul_f32 v235, v195, v195
    v_fma_f32 v232, v232, s44, v253
    v_fma_f32 v233, v233, s44, v253
    v_fma_f32 v234, v234, s44, v253
    v_fma_f32 v235, v235, s44, v253
    v_mul_f32 v232, v232, v192
    v_mul_f32 v233, v233, v193
    v_mul_f32 v234, v234, v194
    v_mul_f32 v235, v235, v195
    v_exp_f32 v232, v232
    v_exp_f32 v233, v233
    v_exp_f32 v234, v234
    v_exp_f32 v235, v235
    v_add_f32 v232, 1.0, v232
    v_add_f32 v233, 1.0, v233
    v_add_f32 v234, 1.0, v234
    v_add_f32 v235, 1.0, v235
    v_rcp_f32 v232, v232
    v_rcp_f32 v233, v233
    v_rcp_f32 v234, v234
    v_rcp_f32 v235, v235
    v_mul_f32 v192, v192, v232
    v_mul_f32 v193, v193, v233
    v_mul_f32 v194, v194, v234
    v_mul_f32 v195, v195, v235
    v_cvt_pk_bf16_f32 v236, v192, v193
    v_cvt_pk_bf16_f32 v237, v194, v195
    ds_write_b64 v252, v[236:237] offset:0
    s_waitcnt vmcnt(37)
    v_add_f32 v196, v196, v212
    v_add_f32 v197, v197, v213
    v_add_f32 v198, v198, v214
    v_add_f32 v199, v199, v215
    v_mul_f32 v232, v196, v196
    v_mul_f32 v233, v197, v197
    v_mul_f32 v234, v198, v198
    v_mul_f32 v235, v199, v199
    v_fma_f32 v232, v232, s44, v253
    v_fma_f32 v233, v233, s44, v253
    v_fma_f32 v234, v234, s44, v253
    v_fma_f32 v235, v235, s44, v253
    v_mul_f32 v232, v232, v196
    v_mul_f32 v233, v233, v197
    v_mul_f32 v234, v234, v198
    v_mul_f32 v235, v235, v199
    v_exp_f32 v232, v232
    v_exp_f32 v233, v233
    v_exp_f32 v234, v234
    v_exp_f32 v235, v235
    v_add_f32 v232, 1.0, v232
    v_add_f32 v233, 1.0, v233
    v_add_f32 v234, 1.0, v234
    v_add_f32 v235, 1.0, v235
    v_rcp_f32 v232, v232
    v_rcp_f32 v233, v233
    v_rcp_f32 v234, v234
    v_rcp_f32 v235, v235
    v_mul_f32 v196, v196, v232
    v_mul_f32 v197, v197, v233
    v_mul_f32 v198, v198, v234
    v_mul_f32 v199, v199, v235
    v_cvt_pk_bf16_f32 v238, v196, v197
    v_cvt_pk_bf16_f32 v239, v198, v199
    ds_write_b64 v252, v[238:239] offset:528
    s_waitcnt vmcnt(35)
    v_add_f32 v200, v200, v216
    v_add_f32 v201, v201, v217
    v_add_f32 v202, v202, v218
    v_add_f32 v203, v203, v219
    v_mul_f32 v232, v200, v200
    v_mul_f32 v233, v201, v201
    v_mul_f32 v234, v202, v202
    v_mul_f32 v235, v203, v203
    v_fma_f32 v232, v232, s44, v253
    v_fma_f32 v233, v233, s44, v253
    v_fma_f32 v234, v234, s44, v253
    v_fma_f32 v235, v235, s44, v253
    v_mul_f32 v232, v232, v200
    v_mul_f32 v233, v233, v201
    v_mul_f32 v234, v234, v202
    v_mul_f32 v235, v235, v203
    v_exp_f32 v232, v232
    v_exp_f32 v233, v233
    v_exp_f32 v234, v234
    v_exp_f32 v235, v235
    v_add_f32 v232, 1.0, v232
    v_add_f32 v233, 1.0, v233
    v_add_f32 v234, 1.0, v234
    v_add_f32 v235, 1.0, v235
    v_rcp_f32 v232, v232
    v_rcp_f32 v233, v233
    v_rcp_f32 v234, v234
    v_rcp_f32 v235, v235
    v_mul_f32 v200, v200, v232
    v_mul_f32 v201, v201, v233
    v_mul_f32 v202, v202, v234
    v_mul_f32 v203, v203, v235
    v_cvt_pk_bf16_f32 v240, v200, v201
    v_cvt_pk_bf16_f32 v241, v202, v203
    ds_write_b64 v252, v[240:241] offset:1056
    s_waitcnt vmcnt(33)
    v_add_f32 v204, v204, v220
    v_add_f32 v205, v205, v221
    v_add_f32 v206, v206, v222
    v_add_f32 v207, v207, v223
    v_mul_f32 v232, v204, v204
    v_mul_f32 v233, v205, v205
    v_mul_f32 v234, v206, v206
    v_mul_f32 v235, v207, v207
    v_fma_f32 v232, v232, s44, v253
    v_fma_f32 v233, v233, s44, v253
    v_fma_f32 v234, v234, s44, v253
    v_fma_f32 v235, v235, s44, v253
    v_mul_f32 v232, v232, v204
    v_mul_f32 v233, v233, v205
    v_mul_f32 v234, v234, v206
    v_mul_f32 v235, v235, v207
    v_exp_f32 v232, v232
    v_exp_f32 v233, v233
    v_exp_f32 v234, v234
    v_exp_f32 v235, v235
    v_add_f32 v232, 1.0, v232
    v_add_f32 v233, 1.0, v233
    v_add_f32 v234, 1.0, v234
    v_add_f32 v235, 1.0, v235
    v_rcp_f32 v232, v232
    v_rcp_f32 v233, v233
    v_rcp_f32 v234, v234
    v_rcp_f32 v235, v235
    v_mul_f32 v204, v204, v232
    v_mul_f32 v205, v205, v233
    v_mul_f32 v206, v206, v234
    v_mul_f32 v207, v207, v235
    v_cvt_pk_bf16_f32 v242, v204, v205
    v_cvt_pk_bf16_f32 v243, v206, v207
    ds_write_b64 v252, v[242:243] offset:1584
    s_waitcnt vmcnt(32)
    ds_write_b128 v251, v[224:227] offset:17408
    s_waitcnt lgkmcnt(0)
    s_barrier
    v_and_b32 v250, 31, v255
    v_mul_u32_u24 v250, 528, v250
    v_lshrrev_b32 v249, 5, v255
    v_lshl_add_u32 v250, v249, 4, v250
    ds_read_b128 v[160:163], v250 offset:0
    ds_read_b128 v[164:167], v250 offset:32
    ds_read_b128 v[168:171], v250 offset:64
    ds_read_b128 v[172:175], v250 offset:96
    ds_read_b128 v[176:179], v250 offset:128
    ds_read_b128 v[180:183], v250 offset:160
    ds_read_b128 v[184:187], v250 offset:192
    ds_read_b128 v[188:191], v250 offset:224
    v_lshlrev_b32 v249, 5, v249
    s_lshl_b32 s36, s21, 8
    v_add_u32 v249, s36, v249
    s_lshl_b32 s36, s21, 12
    v_add_u32 v248, s36, v254
    s_waitcnt vmcnt(30) lgkmcnt(7)
    v_mfma_f32_32x32x16_bf16 v[128:143], v[0:3], v[160:163], 0
    v_mfma_f32_32x32x16_bf16 v[144:159], v[4:7], v[160:163], 0
    ds_read_b128 v[160:163], v250 offset:256
    s_waitcnt vmcnt(28) lgkmcnt(7)
    v_mfma_f32_32x32x16_bf16 v[128:143], v[8:11], v[164:167], v[128:143]
    v_mfma_f32_32x32x16_bf16 v[144:159], v[12:15], v[164:167], v[144:159]
    ds_read_b128 v[164:167], v250 offset:288
    s_waitcnt vmcnt(26) lgkmcnt(7)
    v_mfma_f32_32x32x16_bf16 v[128:143], v[16:19], v[168:171], v[128:143]
    v_mfma_f32_32x32x16_bf16 v[144:159], v[20:23], v[168:171], v[144:159]
    ds_read_b128 v[168:171], v250 offset:320
    s_waitcnt vmcnt(24) lgkmcnt(7)
    v_mfma_f32_32x32x16_bf16 v[128:143], v[24:27], v[172:175], v[128:143]
    v_mfma_f32_32x32x16_bf16 v[144:159], v[28:31], v[172:175], v[144:159]
    ds_read_b128 v[172:175], v250 offset:352
    s_waitcnt vmcnt(22) lgkmcnt(7)
    v_mfma_f32_32x32x16_bf16 v[128:143], v[32:35], v[176:179], v[128:143]
    v_mfma_f32_32x32x16_bf16 v[144:159], v[36:39], v[176:179], v[144:159]
    ds_read_b128 v[176:179], v250 offset:384
    s_waitcnt vmcnt(20) lgkmcnt(7)
    v_mfma_f32_32x32x16_bf16 v[128:143], v[40:43], v[180:183], v[128:143]
    v_mfma_f32_32x32x16_bf16 v[144:159], v[44:47], v[180:183], v[144:159]
    ds_read_b128 v[180:183], v250 offset:416
    s_waitcnt vmcnt(18) lgkmcnt(7)
    v_mfma_f32_32x32x16_bf16 v[128:143], v[48:51], v[184:187], v[128:143]
    v_mfma_f32_32x32x16_bf16 v[144:159], v[52:55], v[184:187], v[144:159]
    ds_read_b128 v[184:187], v250 offset:448
    s_waitcnt vmcnt(16) lgkmcnt(7)
    v_mfma_f32_32x32x16_bf16 v[128:143], v[56:59], v[188:191], v[128:143]
    v_mfma_f32_32x32x16_bf16 v[144:159], v[60:63], v[188:191], v[144:159]
    ds_read_b128 v[188:191], v250 offset:480
    s_waitcnt vmcnt(14) lgkmcnt(7)
    v_mfma_f32_32x32x16_bf16 v[128:143], v[64:67], v[160:163], v[128:143]
    v_mfma_f32_32x32x16_bf16 v[144:159], v[68:71], v[160:163], v[144:159]
    s_waitcnt vmcnt(12) lgkmcnt(6)
    v_mfma_f32_32x32x16_bf16 v[128:143], v[72:75], v[164:167], v[128:143]
    v_mfma_f32_32x32x16_bf16 v[144:159], v[76:79], v[164:167], v[144:159]
    s_waitcnt vmcnt(10) lgkmcnt(5)
    v_mfma_f32_32x32x16_bf16 v[128:143], v[80:83], v[168:171], v[128:143]
    v_mfma_f32_32x32x16_bf16 v[144:159], v[84:87], v[168:171], v[144:159]
    s_waitcnt vmcnt(8) lgkmcnt(4)
    v_mfma_f32_32x32x16_bf16 v[128:143], v[88:91], v[172:175], v[128:143]
    v_mfma_f32_32x32x16_bf16 v[144:159], v[92:95], v[172:175], v[144:159]
    s_waitcnt vmcnt(6) lgkmcnt(3)
    v_mfma_f32_32x32x16_bf16 v[128:143], v[96:99], v[176:179], v[128:143]
    v_mfma_f32_32x32x16_bf16 v[144:159], v[100:103], v[176:179], v[144:159]
    s_waitcnt vmcnt(4) lgkmcnt(2)
    v_mfma_f32_32x32x16_bf16 v[128:143], v[104:107], v[180:183], v[128:143]
    v_mfma_f32_32x32x16_bf16 v[144:159], v[108:111], v[180:183], v[144:159]
    s_waitcnt vmcnt(2) lgkmcnt(1)
    v_mfma_f32_32x32x16_bf16 v[128:143], v[112:115], v[184:187], v[128:143]
    v_mfma_f32_32x32x16_bf16 v[144:159], v[116:119], v[184:187], v[144:159]
    s_waitcnt vmcnt(0) lgkmcnt(0)
    v_mfma_f32_32x32x16_bf16 v[128:143], v[120:123], v[188:191], v[128:143]
    v_mfma_f32_32x32x16_bf16 v[144:159], v[124:127], v[188:191], v[144:159]
    ds_read_b128 v[192:195], v249 offset:17408
    ds_read_b128 v[196:199], v249 offset:17424
    ds_read_b128 v[200:203], v249 offset:17472
    ds_read_b128 v[204:207], v249 offset:17488
    ds_read_b128 v[208:211], v249 offset:17536
    ds_read_b128 v[212:215], v249 offset:17552
    ds_read_b128 v[216:219], v249 offset:17600
    ds_read_b128 v[220:223], v249 offset:17616
    s_mov_b32 s44, 0xffff0000
    s_mov_b32 s45, 0x4038aa3b
    s_nop 7
    v_cvt_pk_bf16_f32 v224, v128, v144
    v_cvt_pk_bf16_f32 v225, v129, v145
    v_cvt_pk_bf16_f32 v226, v130, v146
    v_cvt_pk_bf16_f32 v227, v131, v147
    v_cvt_pk_bf16_f32 v228, v132, v148
    v_cvt_pk_bf16_f32 v229, v133, v149
    v_cvt_pk_bf16_f32 v230, v134, v150
    v_cvt_pk_bf16_f32 v231, v135, v151
    v_cvt_pk_bf16_f32 v232, v136, v152
    v_cvt_pk_bf16_f32 v233, v137, v153
    v_cvt_pk_bf16_f32 v234, v138, v154
    v_cvt_pk_bf16_f32 v235, v139, v155
    v_cvt_pk_bf16_f32 v236, v140, v156
    v_cvt_pk_bf16_f32 v237, v141, v157
    v_cvt_pk_bf16_f32 v238, v142, v158
    v_cvt_pk_bf16_f32 v239, v143, v159
    v_lshlrev_b32 v0, 16, v224
    v_and_b32 v1, s44, v224
    v_lshlrev_b32 v2, 16, v225
    v_and_b32 v3, s44, v225
    v_lshlrev_b32 v4, 16, v226
    v_and_b32 v5, s44, v226
    v_lshlrev_b32 v6, 16, v227
    v_and_b32 v7, s44, v227
    v_lshlrev_b32 v8, 16, v228
    v_and_b32 v9, s44, v228
    v_lshlrev_b32 v10, 16, v229
    v_and_b32 v11, s44, v229
    v_lshlrev_b32 v12, 16, v230
    v_and_b32 v13, s44, v230
    v_lshlrev_b32 v14, 16, v231
    v_and_b32 v15, s44, v231
    v_lshlrev_b32 v16, 16, v232
    v_and_b32 v17, s44, v232
    v_lshlrev_b32 v18, 16, v233
    v_and_b32 v19, s44, v233
    v_lshlrev_b32 v20, 16, v234
    v_and_b32 v21, s44, v234
    v_lshlrev_b32 v22, 16, v235
    v_and_b32 v23, s44, v235
    v_lshlrev_b32 v24, 16, v236
    v_and_b32 v25, s44, v236
    v_lshlrev_b32 v26, 16, v237
    v_and_b32 v27, s44, v237
    v_lshlrev_b32 v28, 16, v238
    v_and_b32 v29, s44, v238
    v_lshlrev_b32 v30, 16, v239
    v_and_b32 v31, s44, v239
    v_mul_f32 v0, s45, v0
    v_mul_f32 v1, s45, v1
    v_mul_f32 v2, s45, v2
    v_mul_f32 v3, s45, v3
    v_mul_f32 v4, s45, v4
    v_mul_f32 v5, s45, v5
    v_mul_f32 v6, s45, v6
    v_mul_f32 v7, s45, v7
    v_mul_f32 v8, s45, v8
    v_mul_f32 v9, s45, v9
    v_mul_f32 v10, s45, v10
    v_mul_f32 v11, s45, v11
    v_mul_f32 v12, s45, v12
    v_mul_f32 v13, s45, v13
    v_mul_f32 v14, s45, v14
    v_mul_f32 v15, s45, v15
    v_mul_f32 v16, s45, v16
    v_mul_f32 v17, s45, v17
    v_mul_f32 v18, s45, v18
    v_mul_f32 v19, s45, v19
    v_mul_f32 v20, s45, v20
    v_mul_f32 v21, s45, v21
    v_mul_f32 v22, s45, v22
    v_mul_f32 v23, s45, v23
    v_mul_f32 v24, s45, v24
    v_mul_f32 v25, s45, v25
    v_mul_f32 v26, s45, v26
    v_mul_f32 v27, s45, v27
    v_mul_f32 v28, s45, v28
    v_mul_f32 v29, s45, v29
    v_mul_f32 v30, s45, v30
    v_mul_f32 v31, s45, v31
    s_waitcnt lgkmcnt(6)
    v_add_f32 v32, v192, v0
    v_add_f32 v33, v193, v1
    v_add_f32 v34, v194, v2
    v_add_f32 v35, v195, v3
    v_add_f32 v36, v196, v4
    v_add_f32 v37, v197, v5
    v_add_f32 v38, v198, v6
    v_add_f32 v39, v199, v7
    v_exp_f32 v32, v32
    v_exp_f32 v33, v33
    v_exp_f32 v34, v34
    v_exp_f32 v35, v35
    v_exp_f32 v36, v36
    v_exp_f32 v37, v37
    v_exp_f32 v38, v38
    v_exp_f32 v39, v39
    v_add_f32 v32, 1.0, v32
    v_add_f32 v33, 1.0, v33
    v_add_f32 v34, 1.0, v34
    v_add_f32 v35, 1.0, v35
    v_add_f32 v36, 1.0, v36
    v_add_f32 v37, 1.0, v37
    v_add_f32 v38, 1.0, v38
    v_add_f32 v39, 1.0, v39
    v_rcp_f32 v32, v32
    v_rcp_f32 v33, v33
    v_rcp_f32 v34, v34
    v_rcp_f32 v35, v35
    v_rcp_f32 v36, v36
    v_rcp_f32 v37, v37
    v_rcp_f32 v38, v38
    v_rcp_f32 v39, v39
    v_fma_f32 v32, v32, -2.0, 1.0
    v_fma_f32 v33, v33, -2.0, 1.0
    v_fma_f32 v34, v34, -2.0, 1.0
    v_fma_f32 v35, v35, -2.0, 1.0
    v_fma_f32 v36, v36, -2.0, 1.0
    v_fma_f32 v37, v37, -2.0, 1.0
    v_fma_f32 v38, v38, -2.0, 1.0
    v_fma_f32 v39, v39, -2.0, 1.0
    v_cvt_pk_bf16_f32 v224, v32, v33
    v_cvt_pk_bf16_f32 v225, v34, v35
    v_cvt_pk_bf16_f32 v226, v36, v37
    v_cvt_pk_bf16_f32 v227, v38, v39
    ds_write_b128 v248, v[224:227] offset:25600
    s_waitcnt lgkmcnt(5)
    v_add_f32 v40, v200, v8
    v_add_f32 v41, v201, v9
    v_add_f32 v42, v202, v10
    v_add_f32 v43, v203, v11
    v_add_f32 v44, v204, v12
    v_add_f32 v45, v205, v13
    v_add_f32 v46, v206, v14
    v_add_f32 v47, v207, v15
    v_exp_f32 v40, v40
    v_exp_f32 v41, v41
    v_exp_f32 v42, v42
    v_exp_f32 v43, v43
    v_exp_f32 v44, v44
    v_exp_f32 v45, v45
    v_exp_f32 v46, v46
    v_exp_f32 v47, v47
    v_add_f32 v40, 1.0, v40
    v_add_f32 v41, 1.0, v41
    v_add_f32 v42, 1.0, v42
    v_add_f32 v43, 1.0, v43
    v_add_f32 v44, 1.0, v44
    v_add_f32 v45, 1.0, v45
    v_add_f32 v46, 1.0, v46
    v_add_f32 v47, 1.0, v47
    v_rcp_f32 v40, v40
    v_rcp_f32 v41, v41
    v_rcp_f32 v42, v42
    v_rcp_f32 v43, v43
    v_rcp_f32 v44, v44
    v_rcp_f32 v45, v45
    v_rcp_f32 v46, v46
    v_rcp_f32 v47, v47
    v_fma_f32 v40, v40, -2.0, 1.0
    v_fma_f32 v41, v41, -2.0, 1.0
    v_fma_f32 v42, v42, -2.0, 1.0
    v_fma_f32 v43, v43, -2.0, 1.0
    v_fma_f32 v44, v44, -2.0, 1.0
    v_fma_f32 v45, v45, -2.0, 1.0
    v_fma_f32 v46, v46, -2.0, 1.0
    v_fma_f32 v47, v47, -2.0, 1.0
    v_cvt_pk_bf16_f32 v228, v40, v41
    v_cvt_pk_bf16_f32 v229, v42, v43
    v_cvt_pk_bf16_f32 v230, v44, v45
    v_cvt_pk_bf16_f32 v231, v46, v47
    ds_write_b128 v248, v[228:231] offset:26624
    s_waitcnt lgkmcnt(4)
    v_add_f32 v48, v208, v16
    v_add_f32 v49, v209, v17
    v_add_f32 v50, v210, v18
    v_add_f32 v51, v211, v19
    v_add_f32 v52, v212, v20
    v_add_f32 v53, v213, v21
    v_add_f32 v54, v214, v22
    v_add_f32 v55, v215, v23
    v_exp_f32 v48, v48
    v_exp_f32 v49, v49
    v_exp_f32 v50, v50
    v_exp_f32 v51, v51
    v_exp_f32 v52, v52
    v_exp_f32 v53, v53
    v_exp_f32 v54, v54
    v_exp_f32 v55, v55
    v_add_f32 v48, 1.0, v48
    v_add_f32 v49, 1.0, v49
    v_add_f32 v50, 1.0, v50
    v_add_f32 v51, 1.0, v51
    v_add_f32 v52, 1.0, v52
    v_add_f32 v53, 1.0, v53
    v_add_f32 v54, 1.0, v54
    v_add_f32 v55, 1.0, v55
    v_rcp_f32 v48, v48
    v_rcp_f32 v49, v49
    v_rcp_f32 v50, v50
    v_rcp_f32 v51, v51
    v_rcp_f32 v52, v52
    v_rcp_f32 v53, v53
    v_rcp_f32 v54, v54
    v_rcp_f32 v55, v55
    v_fma_f32 v48, v48, -2.0, 1.0
    v_fma_f32 v49, v49, -2.0, 1.0
    v_fma_f32 v50, v50, -2.0, 1.0
    v_fma_f32 v51, v51, -2.0, 1.0
    v_fma_f32 v52, v52, -2.0, 1.0
    v_fma_f32 v53, v53, -2.0, 1.0
    v_fma_f32 v54, v54, -2.0, 1.0
    v_fma_f32 v55, v55, -2.0, 1.0
    v_cvt_pk_bf16_f32 v232, v48, v49
    v_cvt_pk_bf16_f32 v233, v50, v51
    v_cvt_pk_bf16_f32 v234, v52, v53
    v_cvt_pk_bf16_f32 v235, v54, v55
    ds_write_b128 v248, v[232:235] offset:27648
    s_waitcnt lgkmcnt(3)
    v_add_f32 v56, v216, v24
    v_add_f32 v57, v217, v25
    v_add_f32 v58, v218, v26
    v_add_f32 v59, v219, v27
    v_add_f32 v60, v220, v28
    v_add_f32 v61, v221, v29
    v_add_f32 v62, v222, v30
    v_add_f32 v63, v223, v31
    ds_read_b128 v[192:195], v249 offset:18432
    ds_read_b128 v[196:199], v249 offset:18448
    ds_read_b128 v[200:203], v249 offset:18496
    ds_read_b128 v[204:207], v249 offset:18512
    ds_read_b128 v[208:211], v249 offset:18560
    ds_read_b128 v[212:215], v249 offset:18576
    ds_read_b128 v[216:219], v249 offset:18624
    ds_read_b128 v[220:223], v249 offset:18640
    v_exp_f32 v56, v56
    v_exp_f32 v57, v57
    v_exp_f32 v58, v58
    v_exp_f32 v59, v59
    v_exp_f32 v60, v60
    v_exp_f32 v61, v61
    v_exp_f32 v62, v62
    v_exp_f32 v63, v63
    v_add_f32 v56, 1.0, v56
    v_add_f32 v57, 1.0, v57
    v_add_f32 v58, 1.0, v58
    v_add_f32 v59, 1.0, v59
    v_add_f32 v60, 1.0, v60
    v_add_f32 v61, 1.0, v61
    v_add_f32 v62, 1.0, v62
    v_add_f32 v63, 1.0, v63
    v_rcp_f32 v56, v56
    v_rcp_f32 v57, v57
    v_rcp_f32 v58, v58
    v_rcp_f32 v59, v59
    v_rcp_f32 v60, v60
    v_rcp_f32 v61, v61
    v_rcp_f32 v62, v62
    v_rcp_f32 v63, v63
    v_fma_f32 v56, v56, -2.0, 1.0
    v_fma_f32 v57, v57, -2.0, 1.0
    v_fma_f32 v58, v58, -2.0, 1.0
    v_fma_f32 v59, v59, -2.0, 1.0
    v_fma_f32 v60, v60, -2.0, 1.0
    v_fma_f32 v61, v61, -2.0, 1.0
    v_fma_f32 v62, v62, -2.0, 1.0
    v_fma_f32 v63, v63, -2.0, 1.0
    v_cvt_pk_bf16_f32 v236, v56, v57
    v_cvt_pk_bf16_f32 v237, v58, v59
    v_cvt_pk_bf16_f32 v238, v60, v61
    v_cvt_pk_bf16_f32 v239, v62, v63
    ds_write_b128 v248, v[236:239] offset:28672
    s_waitcnt lgkmcnt(0)
    s_barrier
    v_add_f32 v32, v192, v0
    v_add_f32 v33, v193, v1
    v_add_f32 v34, v194, v2
    v_add_f32 v35, v195, v3
    v_add_f32 v36, v196, v4
    v_add_f32 v37, v197, v5
    v_add_f32 v38, v198, v6
    v_add_f32 v39, v199, v7
    v_exp_f32 v32, v32
    v_exp_f32 v33, v33
    v_exp_f32 v34, v34
    v_exp_f32 v35, v35
    v_exp_f32 v36, v36
    v_exp_f32 v37, v37
    v_exp_f32 v38, v38
    v_exp_f32 v39, v39
    v_add_f32 v32, 1.0, v32
    v_add_f32 v33, 1.0, v33
    v_add_f32 v34, 1.0, v34
    v_add_f32 v35, 1.0, v35
    v_add_f32 v36, 1.0, v36
    v_add_f32 v37, 1.0, v37
    v_add_f32 v38, 1.0, v38
    v_add_f32 v39, 1.0, v39
    v_rcp_f32 v32, v32
    v_rcp_f32 v33, v33
    v_rcp_f32 v34, v34
    v_rcp_f32 v35, v35
    v_rcp_f32 v36, v36
    v_rcp_f32 v37, v37
    v_rcp_f32 v38, v38
    v_rcp_f32 v39, v39
    v_fma_f32 v32, v32, -2.0, 1.0
    v_fma_f32 v33, v33, -2.0, 1.0
    v_fma_f32 v34, v34, -2.0, 1.0
    v_fma_f32 v35, v35, -2.0, 1.0
    v_fma_f32 v36, v36, -2.0, 1.0
    v_fma_f32 v37, v37, -2.0, 1.0
    v_fma_f32 v38, v38, -2.0, 1.0
    v_fma_f32 v39, v39, -2.0, 1.0
    v_cvt_pk_bf16_f32 v224, v32, v33
    v_cvt_pk_bf16_f32 v225, v34, v35
    v_cvt_pk_bf16_f32 v226, v36, v37
    v_cvt_pk_bf16_f32 v227, v38, v39
    ds_write_b128 v248, v[224:227] offset:41984
    v_add_f32 v40, v200, v8
    v_add_f32 v41, v201, v9
    v_add_f32 v42, v202, v10
    v_add_f32 v43, v203, v11
    v_add_f32 v44, v204, v12
    v_add_f32 v45, v205, v13
    v_add_f32 v46, v206, v14
    v_add_f32 v47, v207, v15
    v_exp_f32 v40, v40
    v_exp_f32 v41, v41
    v_exp_f32 v42, v42
    v_exp_f32 v43, v43
    v_exp_f32 v44, v44
    v_exp_f32 v45, v45
    v_exp_f32 v46, v46
    v_exp_f32 v47, v47
    v_add_f32 v40, 1.0, v40
    v_add_f32 v41, 1.0, v41
    v_add_f32 v42, 1.0, v42
    v_add_f32 v43, 1.0, v43
    v_add_f32 v44, 1.0, v44
    v_add_f32 v45, 1.0, v45
    v_add_f32 v46, 1.0, v46
    v_add_f32 v47, 1.0, v47
    v_rcp_f32 v40, v40
    v_rcp_f32 v41, v41
    v_rcp_f32 v42, v42
    v_rcp_f32 v43, v43
    v_rcp_f32 v44, v44
    v_rcp_f32 v45, v45
    v_rcp_f32 v46, v46
    v_rcp_f32 v47, v47
    v_fma_f32 v40, v40, -2.0, 1.0
    v_fma_f32 v41, v41, -2.0, 1.0
    v_fma_f32 v42, v42, -2.0, 1.0
    v_fma_f32 v43, v43, -2.0, 1.0
    v_fma_f32 v44, v44, -2.0, 1.0
    v_fma_f32 v45, v45, -2.0, 1.0
    v_fma_f32 v46, v46, -2.0, 1.0
    v_fma_f32 v47, v47, -2.0, 1.0
    v_cvt_pk_bf16_f32 v228, v40, v41
    v_cvt_pk_bf16_f32 v229, v42, v43
    v_cvt_pk_bf16_f32 v230, v44, v45
    v_cvt_pk_bf16_f32 v231, v46, v47
    ds_write_b128 v248, v[228:231] offset:43008
    v_add_f32 v48, v208, v16
    v_add_f32 v49, v209, v17
    v_add_f32 v50, v210, v18
    v_add_f32 v51, v211, v19
    v_add_f32 v52, v212, v20
    v_add_f32 v53, v213, v21
    v_add_f32 v54, v214, v22
    v_add_f32 v55, v215, v23
    v_exp_f32 v48, v48
    v_exp_f32 v49, v49
    v_exp_f32 v50, v50
    v_exp_f32 v51, v51
    v_exp_f32 v52, v52
    v_exp_f32 v53, v53
    v_exp_f32 v54, v54
    v_exp_f32 v55, v55
    v_add_f32 v48, 1.0, v48
    v_add_f32 v49, 1.0, v49
    v_add_f32 v50, 1.0, v50
    v_add_f32 v51, 1.0, v51
    v_add_f32 v52, 1.0, v52
    v_add_f32 v53, 1.0, v53
    v_add_f32 v54, 1.0, v54
    v_add_f32 v55, 1.0, v55
    v_rcp_f32 v48, v48
    v_rcp_f32 v49, v49
    v_rcp_f32 v50, v50
    v_rcp_f32 v51, v51
    v_rcp_f32 v52, v52
    v_rcp_f32 v53, v53
    v_rcp_f32 v54, v54
    v_rcp_f32 v55, v55
    v_fma_f32 v48, v48, -2.0, 1.0
    v_fma_f32 v49, v49, -2.0, 1.0
    v_fma_f32 v50, v50, -2.0, 1.0
    v_fma_f32 v51, v51, -2.0, 1.0
    v_fma_f32 v52, v52, -2.0, 1.0
    v_fma_f32 v53, v53, -2.0, 1.0
    v_fma_f32 v54, v54, -2.0, 1.0
    v_fma_f32 v55, v55, -2.0, 1.0
    v_cvt_pk_bf16_f32 v232, v48, v49
    v_cvt_pk_bf16_f32 v233, v50, v51
    v_cvt_pk_bf16_f32 v234, v52, v53
    v_cvt_pk_bf16_f32 v235, v54, v55
    ds_write_b128 v248, v[232:235] offset:44032
    v_add_f32 v56, v216, v24
    v_add_f32 v57, v217, v25
    v_add_f32 v58, v218, v26
    v_add_f32 v59, v219, v27
    v_add_f32 v60, v220, v28
    v_add_f32 v61, v221, v29
    v_add_f32 v62, v222, v30
    v_add_f32 v63, v223, v31
    ds_read_b128 v[192:195], v249 offset:19456
    ds_read_b128 v[196:199], v249 offset:19472
    ds_read_b128 v[200:203], v249 offset:19520
    ds_read_b128 v[204:207], v249 offset:19536
    ds_read_b128 v[208:211], v249 offset:19584
    ds_read_b128 v[212:215], v249 offset:19600
    ds_read_b128 v[216:219], v249 offset:19648
    ds_read_b128 v[220:223], v249 offset:19664
    v_exp_f32 v56, v56
    v_exp_f32 v57, v57
    v_exp_f32 v58, v58
    v_exp_f32 v59, v59
    v_exp_f32 v60, v60
    v_exp_f32 v61, v61
    v_exp_f32 v62, v62
    v_exp_f32 v63, v63
    v_add_f32 v56, 1.0, v56
    v_add_f32 v57, 1.0, v57
    v_add_f32 v58, 1.0, v58
    v_add_f32 v59, 1.0, v59
    v_add_f32 v60, 1.0, v60
    v_add_f32 v61, 1.0, v61
    v_add_f32 v62, 1.0, v62
    v_add_f32 v63, 1.0, v63
    v_rcp_f32 v56, v56
    v_rcp_f32 v57, v57
    v_rcp_f32 v58, v58
    v_rcp_f32 v59, v59
    v_rcp_f32 v60, v60
    v_rcp_f32 v61, v61
    v_rcp_f32 v62, v62
    v_rcp_f32 v63, v63
    v_fma_f32 v56, v56, -2.0, 1.0
    v_fma_f32 v57, v57, -2.0, 1.0
    v_fma_f32 v58, v58, -2.0, 1.0
    v_fma_f32 v59, v59, -2.0, 1.0
    v_fma_f32 v60, v60, -2.0, 1.0
    v_fma_f32 v61, v61, -2.0, 1.0
    v_fma_f32 v62, v62, -2.0, 1.0
    v_fma_f32 v63, v63, -2.0, 1.0
    v_cvt_pk_bf16_f32 v236, v56, v57
    v_cvt_pk_bf16_f32 v237, v58, v59
    v_cvt_pk_bf16_f32 v238, v60, v61
    v_cvt_pk_bf16_f32 v239, v62, v63
    ds_write_b128 v248, v[236:239] offset:45056
    s_waitcnt lgkmcnt(0)
    s_barrier
    v_add_f32 v32, v192, v0
    v_add_f32 v33, v193, v1
    v_add_f32 v34, v194, v2
    v_add_f32 v35, v195, v3
    v_add_f32 v36, v196, v4
    v_add_f32 v37, v197, v5
    v_add_f32 v38, v198, v6
    v_add_f32 v39, v199, v7
    v_exp_f32 v32, v32
    v_exp_f32 v33, v33
    v_exp_f32 v34, v34
    v_exp_f32 v35, v35
    v_exp_f32 v36, v36
    v_exp_f32 v37, v37
    v_exp_f32 v38, v38
    v_exp_f32 v39, v39
    v_add_f32 v32, 1.0, v32
    v_add_f32 v33, 1.0, v33
    v_add_f32 v34, 1.0, v34
    v_add_f32 v35, 1.0, v35
    v_add_f32 v36, 1.0, v36
    v_add_f32 v37, 1.0, v37
    v_add_f32 v38, 1.0, v38
    v_add_f32 v39, 1.0, v39
    v_rcp_f32 v32, v32
    v_rcp_f32 v33, v33
    v_rcp_f32 v34, v34
    v_rcp_f32 v35, v35
    v_rcp_f32 v36, v36
    v_rcp_f32 v37, v37
    v_rcp_f32 v38, v38
    v_rcp_f32 v39, v39
    v_fma_f32 v32, v32, -2.0, 1.0
    v_fma_f32 v33, v33, -2.0, 1.0
    v_fma_f32 v34, v34, -2.0, 1.0
    v_fma_f32 v35, v35, -2.0, 1.0
    v_fma_f32 v36, v36, -2.0, 1.0
    v_fma_f32 v37, v37, -2.0, 1.0
    v_fma_f32 v38, v38, -2.0, 1.0
    v_fma_f32 v39, v39, -2.0, 1.0
    v_cvt_pk_bf16_f32 v224, v32, v33
    v_cvt_pk_bf16_f32 v225, v34, v35
    v_cvt_pk_bf16_f32 v226, v36, v37
    v_cvt_pk_bf16_f32 v227, v38, v39
    ds_write_b128 v248, v[224:227] offset:25600
    v_add_f32 v40, v200, v8
    v_add_f32 v41, v201, v9
    v_add_f32 v42, v202, v10
    v_add_f32 v43, v203, v11
    v_add_f32 v44, v204, v12
    v_add_f32 v45, v205, v13
    v_add_f32 v46, v206, v14
    v_add_f32 v47, v207, v15
    v_exp_f32 v40, v40
    v_exp_f32 v41, v41
    v_exp_f32 v42, v42
    v_exp_f32 v43, v43
    v_exp_f32 v44, v44
    v_exp_f32 v45, v45
    v_exp_f32 v46, v46
    v_exp_f32 v47, v47
    v_add_f32 v40, 1.0, v40
    v_add_f32 v41, 1.0, v41
    v_add_f32 v42, 1.0, v42
    v_add_f32 v43, 1.0, v43
    v_add_f32 v44, 1.0, v44
    v_add_f32 v45, 1.0, v45
    v_add_f32 v46, 1.0, v46
    v_add_f32 v47, 1.0, v47
    v_rcp_f32 v40, v40
    v_rcp_f32 v41, v41
    v_rcp_f32 v42, v42
    v_rcp_f32 v43, v43
    v_rcp_f32 v44, v44
    v_rcp_f32 v45, v45
    v_rcp_f32 v46, v46
    v_rcp_f32 v47, v47
    v_fma_f32 v40, v40, -2.0, 1.0
    v_fma_f32 v41, v41, -2.0, 1.0
    v_fma_f32 v42, v42, -2.0, 1.0
    v_fma_f32 v43, v43, -2.0, 1.0
    v_fma_f32 v44, v44, -2.0, 1.0
    v_fma_f32 v45, v45, -2.0, 1.0
    v_fma_f32 v46, v46, -2.0, 1.0
    v_fma_f32 v47, v47, -2.0, 1.0
    v_cvt_pk_bf16_f32 v228, v40, v41
    v_cvt_pk_bf16_f32 v229, v42, v43
    v_cvt_pk_bf16_f32 v230, v44, v45
    v_cvt_pk_bf16_f32 v231, v46, v47
    ds_write_b128 v248, v[228:231] offset:26624
    v_add_f32 v48, v208, v16
    v_add_f32 v49, v209, v17
    v_add_f32 v50, v210, v18
    v_add_f32 v51, v211, v19
    v_add_f32 v52, v212, v20
    v_add_f32 v53, v213, v21
    v_add_f32 v54, v214, v22
    v_add_f32 v55, v215, v23
    v_exp_f32 v48, v48
    v_exp_f32 v49, v49
    v_exp_f32 v50, v50
    v_exp_f32 v51, v51
    v_exp_f32 v52, v52
    v_exp_f32 v53, v53
    v_exp_f32 v54, v54
    v_exp_f32 v55, v55
    v_add_f32 v48, 1.0, v48
    v_add_f32 v49, 1.0, v49
    v_add_f32 v50, 1.0, v50
    v_add_f32 v51, 1.0, v51
    v_add_f32 v52, 1.0, v52
    v_add_f32 v53, 1.0, v53
    v_add_f32 v54, 1.0, v54
    v_add_f32 v55, 1.0, v55
    v_rcp_f32 v48, v48
    v_rcp_f32 v49, v49
    v_rcp_f32 v50, v50
    v_rcp_f32 v51, v51
    v_rcp_f32 v52, v52
    v_rcp_f32 v53, v53
    v_rcp_f32 v54, v54
    v_rcp_f32 v55, v55
    v_fma_f32 v48, v48, -2.0, 1.0
    v_fma_f32 v49, v49, -2.0, 1.0
    v_fma_f32 v50, v50, -2.0, 1.0
    v_fma_f32 v51, v51, -2.0, 1.0
    v_fma_f32 v52, v52, -2.0, 1.0
    v_fma_f32 v53, v53, -2.0, 1.0
    v_fma_f32 v54, v54, -2.0, 1.0
    v_fma_f32 v55, v55, -2.0, 1.0
    v_cvt_pk_bf16_f32 v232, v48, v49
    v_cvt_pk_bf16_f32 v233, v50, v51
    v_cvt_pk_bf16_f32 v234, v52, v53
    v_cvt_pk_bf16_f32 v235, v54, v55
    ds_write_b128 v248, v[232:235] offset:27648
    v_add_f32 v56, v216, v24
    v_add_f32 v57, v217, v25
    v_add_f32 v58, v218, v26
    v_add_f32 v59, v219, v27
    v_add_f32 v60, v220, v28
    v_add_f32 v61, v221, v29
    v_add_f32 v62, v222, v30
    v_add_f32 v63, v223, v31
    ds_read_b128 v[192:195], v249 offset:20480
    ds_read_b128 v[196:199], v249 offset:20496
    ds_read_b128 v[200:203], v249 offset:20544
    ds_read_b128 v[204:207], v249 offset:20560
    ds_read_b128 v[208:211], v249 offset:20608
    ds_read_b128 v[212:215], v249 offset:20624
    ds_read_b128 v[216:219], v249 offset:20672
    ds_read_b128 v[220:223], v249 offset:20688
    v_exp_f32 v56, v56
    v_exp_f32 v57, v57
    v_exp_f32 v58, v58
    v_exp_f32 v59, v59
    v_exp_f32 v60, v60
    v_exp_f32 v61, v61
    v_exp_f32 v62, v62
    v_exp_f32 v63, v63
    v_add_f32 v56, 1.0, v56
    v_add_f32 v57, 1.0, v57
    v_add_f32 v58, 1.0, v58
    v_add_f32 v59, 1.0, v59
    v_add_f32 v60, 1.0, v60
    v_add_f32 v61, 1.0, v61
    v_add_f32 v62, 1.0, v62
    v_add_f32 v63, 1.0, v63
    v_rcp_f32 v56, v56
    v_rcp_f32 v57, v57
    v_rcp_f32 v58, v58
    v_rcp_f32 v59, v59
    v_rcp_f32 v60, v60
    v_rcp_f32 v61, v61
    v_rcp_f32 v62, v62
    v_rcp_f32 v63, v63
    v_fma_f32 v56, v56, -2.0, 1.0
    v_fma_f32 v57, v57, -2.0, 1.0
    v_fma_f32 v58, v58, -2.0, 1.0
    v_fma_f32 v59, v59, -2.0, 1.0
    v_fma_f32 v60, v60, -2.0, 1.0
    v_fma_f32 v61, v61, -2.0, 1.0
    v_fma_f32 v62, v62, -2.0, 1.0
    v_fma_f32 v63, v63, -2.0, 1.0
    v_cvt_pk_bf16_f32 v236, v56, v57
    v_cvt_pk_bf16_f32 v237, v58, v59
    v_cvt_pk_bf16_f32 v238, v60, v61
    v_cvt_pk_bf16_f32 v239, v62, v63
    ds_write_b128 v248, v[236:239] offset:28672
    s_waitcnt lgkmcnt(0)
    s_barrier
    v_add_f32 v32, v192, v0
    v_add_f32 v33, v193, v1
    v_add_f32 v34, v194, v2
    v_add_f32 v35, v195, v3
    v_add_f32 v36, v196, v4
    v_add_f32 v37, v197, v5
    v_add_f32 v38, v198, v6
    v_add_f32 v39, v199, v7
    v_exp_f32 v32, v32
    v_exp_f32 v33, v33
    v_exp_f32 v34, v34
    v_exp_f32 v35, v35
    v_exp_f32 v36, v36
    v_exp_f32 v37, v37
    v_exp_f32 v38, v38
    v_exp_f32 v39, v39
    v_add_f32 v32, 1.0, v32
    v_add_f32 v33, 1.0, v33
    v_add_f32 v34, 1.0, v34
    v_add_f32 v35, 1.0, v35
    v_add_f32 v36, 1.0, v36
    v_add_f32 v37, 1.0, v37
    v_add_f32 v38, 1.0, v38
    v_add_f32 v39, 1.0, v39
    v_rcp_f32 v32, v32
    v_rcp_f32 v33, v33
    v_rcp_f32 v34, v34
    v_rcp_f32 v35, v35
    v_rcp_f32 v36, v36
    v_rcp_f32 v37, v37
    v_rcp_f32 v38, v38
    v_rcp_f32 v39, v39
    v_fma_f32 v32, v32, -2.0, 1.0
    v_fma_f32 v33, v33, -2.0, 1.0
    v_fma_f32 v34, v34, -2.0, 1.0
    v_fma_f32 v35, v35, -2.0, 1.0
    v_fma_f32 v36, v36, -2.0, 1.0
    v_fma_f32 v37, v37, -2.0, 1.0
    v_fma_f32 v38, v38, -2.0, 1.0
    v_fma_f32 v39, v39, -2.0, 1.0
    v_cvt_pk_bf16_f32 v224, v32, v33
    v_cvt_pk_bf16_f32 v225, v34, v35
    v_cvt_pk_bf16_f32 v226, v36, v37
    v_cvt_pk_bf16_f32 v227, v38, v39
    ds_write_b128 v248, v[224:227] offset:41984
    v_add_f32 v40, v200, v8
    v_add_f32 v41, v201, v9
    v_add_f32 v42, v202, v10
    v_add_f32 v43, v203, v11
    v_add_f32 v44, v204, v12
    v_add_f32 v45, v205, v13
    v_add_f32 v46, v206, v14
    v_add_f32 v47, v207, v15
    v_exp_f32 v40, v40
    v_exp_f32 v41, v41
    v_exp_f32 v42, v42
    v_exp_f32 v43, v43
    v_exp_f32 v44, v44
    v_exp_f32 v45, v45
    v_exp_f32 v46, v46
    v_exp_f32 v47, v47
    v_add_f32 v40, 1.0, v40
    v_add_f32 v41, 1.0, v41
    v_add_f32 v42, 1.0, v42
    v_add_f32 v43, 1.0, v43
    v_add_f32 v44, 1.0, v44
    v_add_f32 v45, 1.0, v45
    v_add_f32 v46, 1.0, v46
    v_add_f32 v47, 1.0, v47
    v_rcp_f32 v40, v40
    v_rcp_f32 v41, v41
    v_rcp_f32 v42, v42
    v_rcp_f32 v43, v43
    v_rcp_f32 v44, v44
    v_rcp_f32 v45, v45
    v_rcp_f32 v46, v46
    v_rcp_f32 v47, v47
    v_fma_f32 v40, v40, -2.0, 1.0
    v_fma_f32 v41, v41, -2.0, 1.0
    v_fma_f32 v42, v42, -2.0, 1.0
    v_fma_f32 v43, v43, -2.0, 1.0
    v_fma_f32 v44, v44, -2.0, 1.0
    v_fma_f32 v45, v45, -2.0, 1.0
    v_fma_f32 v46, v46, -2.0, 1.0
    v_fma_f32 v47, v47, -2.0, 1.0
    v_cvt_pk_bf16_f32 v228, v40, v41
    v_cvt_pk_bf16_f32 v229, v42, v43
    v_cvt_pk_bf16_f32 v230, v44, v45
    v_cvt_pk_bf16_f32 v231, v46, v47
    ds_write_b128 v248, v[228:231] offset:43008
    v_add_f32 v48, v208, v16
    v_add_f32 v49, v209, v17
    v_add_f32 v50, v210, v18
    v_add_f32 v51, v211, v19
    v_add_f32 v52, v212, v20
    v_add_f32 v53, v213, v21
    v_add_f32 v54, v214, v22
    v_add_f32 v55, v215, v23
    v_exp_f32 v48, v48
    v_exp_f32 v49, v49
    v_exp_f32 v50, v50
    v_exp_f32 v51, v51
    v_exp_f32 v52, v52
    v_exp_f32 v53, v53
    v_exp_f32 v54, v54
    v_exp_f32 v55, v55
    v_add_f32 v48, 1.0, v48
    v_add_f32 v49, 1.0, v49
    v_add_f32 v50, 1.0, v50
    v_add_f32 v51, 1.0, v51
    v_add_f32 v52, 1.0, v52
    v_add_f32 v53, 1.0, v53
    v_add_f32 v54, 1.0, v54
    v_add_f32 v55, 1.0, v55
    v_rcp_f32 v48, v48
    v_rcp_f32 v49, v49
    v_rcp_f32 v50, v50
    v_rcp_f32 v51, v51
    v_rcp_f32 v52, v52
    v_rcp_f32 v53, v53
    v_rcp_f32 v54, v54
    v_rcp_f32 v55, v55
    v_fma_f32 v48, v48, -2.0, 1.0
    v_fma_f32 v49, v49, -2.0, 1.0
    v_fma_f32 v50, v50, -2.0, 1.0
    v_fma_f32 v51, v51, -2.0, 1.0
    v_fma_f32 v52, v52, -2.0, 1.0
    v_fma_f32 v53, v53, -2.0, 1.0
    v_fma_f32 v54, v54, -2.0, 1.0
    v_fma_f32 v55, v55, -2.0, 1.0
    v_cvt_pk_bf16_f32 v232, v48, v49
    v_cvt_pk_bf16_f32 v233, v50, v51
    v_cvt_pk_bf16_f32 v234, v52, v53
    v_cvt_pk_bf16_f32 v235, v54, v55
    ds_write_b128 v248, v[232:235] offset:44032
    v_add_f32 v56, v216, v24
    v_add_f32 v57, v217, v25
    v_add_f32 v58, v218, v26
    v_add_f32 v59, v219, v27
    v_add_f32 v60, v220, v28
    v_add_f32 v61, v221, v29
    v_add_f32 v62, v222, v30
    v_add_f32 v63, v223, v31
    ds_read_b128 v[192:195], v249 offset:21504
    ds_read_b128 v[196:199], v249 offset:21520
    ds_read_b128 v[200:203], v249 offset:21568
    ds_read_b128 v[204:207], v249 offset:21584
    ds_read_b128 v[208:211], v249 offset:21632
    ds_read_b128 v[212:215], v249 offset:21648
    ds_read_b128 v[216:219], v249 offset:21696
    ds_read_b128 v[220:223], v249 offset:21712
    v_exp_f32 v56, v56
    v_exp_f32 v57, v57
    v_exp_f32 v58, v58
    v_exp_f32 v59, v59
    v_exp_f32 v60, v60
    v_exp_f32 v61, v61
    v_exp_f32 v62, v62
    v_exp_f32 v63, v63
    v_add_f32 v56, 1.0, v56
    v_add_f32 v57, 1.0, v57
    v_add_f32 v58, 1.0, v58
    v_add_f32 v59, 1.0, v59
    v_add_f32 v60, 1.0, v60
    v_add_f32 v61, 1.0, v61
    v_add_f32 v62, 1.0, v62
    v_add_f32 v63, 1.0, v63
    v_rcp_f32 v56, v56
    v_rcp_f32 v57, v57
    v_rcp_f32 v58, v58
    v_rcp_f32 v59, v59
    v_rcp_f32 v60, v60
    v_rcp_f32 v61, v61
    v_rcp_f32 v62, v62
    v_rcp_f32 v63, v63
    v_fma_f32 v56, v56, -2.0, 1.0
    v_fma_f32 v57, v57, -2.0, 1.0
    v_fma_f32 v58, v58, -2.0, 1.0
    v_fma_f32 v59, v59, -2.0, 1.0
    v_fma_f32 v60, v60, -2.0, 1.0
    v_fma_f32 v61, v61, -2.0, 1.0
    v_fma_f32 v62, v62, -2.0, 1.0
    v_fma_f32 v63, v63, -2.0, 1.0
    v_cvt_pk_bf16_f32 v236, v56, v57
    v_cvt_pk_bf16_f32 v237, v58, v59
    v_cvt_pk_bf16_f32 v238, v60, v61
    v_cvt_pk_bf16_f32 v239, v62, v63
    ds_write_b128 v248, v[236:239] offset:45056
    s_waitcnt lgkmcnt(0)
    s_barrier
    v_add_f32 v32, v192, v0
    v_add_f32 v33, v193, v1
    v_add_f32 v34, v194, v2
    v_add_f32 v35, v195, v3
    v_add_f32 v36, v196, v4
    v_add_f32 v37, v197, v5
    v_add_f32 v38, v198, v6
    v_add_f32 v39, v199, v7
    v_exp_f32 v32, v32
    v_exp_f32 v33, v33
    v_exp_f32 v34, v34
    v_exp_f32 v35, v35
    v_exp_f32 v36, v36
    v_exp_f32 v37, v37
    v_exp_f32 v38, v38
    v_exp_f32 v39, v39
    v_add_f32 v32, 1.0, v32
    v_add_f32 v33, 1.0, v33
    v_add_f32 v34, 1.0, v34
    v_add_f32 v35, 1.0, v35
    v_add_f32 v36, 1.0, v36
    v_add_f32 v37, 1.0, v37
    v_add_f32 v38, 1.0, v38
    v_add_f32 v39, 1.0, v39
    v_rcp_f32 v32, v32
    v_rcp_f32 v33, v33
    v_rcp_f32 v34, v34
    v_rcp_f32 v35, v35
    v_rcp_f32 v36, v36
    v_rcp_f32 v37, v37
    v_rcp_f32 v38, v38
    v_rcp_f32 v39, v39
    v_fma_f32 v32, v32, -2.0, 1.0
    v_fma_f32 v33, v33, -2.0, 1.0
    v_fma_f32 v34, v34, -2.0, 1.0
    v_fma_f32 v35, v35, -2.0, 1.0
    v_fma_f32 v36, v36, -2.0, 1.0
    v_fma_f32 v37, v37, -2.0, 1.0
    v_fma_f32 v38, v38, -2.0, 1.0
    v_fma_f32 v39, v39, -2.0, 1.0
    v_cvt_pk_bf16_f32 v224, v32, v33
    v_cvt_pk_bf16_f32 v225, v34, v35
    v_cvt_pk_bf16_f32 v226, v36, v37
    v_cvt_pk_bf16_f32 v227, v38, v39
    ds_write_b128 v248, v[224:227] offset:25600
    v_add_f32 v40, v200, v8
    v_add_f32 v41, v201, v9
    v_add_f32 v42, v202, v10
    v_add_f32 v43, v203, v11
    v_add_f32 v44, v204, v12
    v_add_f32 v45, v205, v13
    v_add_f32 v46, v206, v14
    v_add_f32 v47, v207, v15
    v_exp_f32 v40, v40
    v_exp_f32 v41, v41
    v_exp_f32 v42, v42
    v_exp_f32 v43, v43
    v_exp_f32 v44, v44
    v_exp_f32 v45, v45
    v_exp_f32 v46, v46
    v_exp_f32 v47, v47
    v_add_f32 v40, 1.0, v40
    v_add_f32 v41, 1.0, v41
    v_add_f32 v42, 1.0, v42
    v_add_f32 v43, 1.0, v43
    v_add_f32 v44, 1.0, v44
    v_add_f32 v45, 1.0, v45
    v_add_f32 v46, 1.0, v46
    v_add_f32 v47, 1.0, v47
    v_rcp_f32 v40, v40
    v_rcp_f32 v41, v41
    v_rcp_f32 v42, v42
    v_rcp_f32 v43, v43
    v_rcp_f32 v44, v44
    v_rcp_f32 v45, v45
    v_rcp_f32 v46, v46
    v_rcp_f32 v47, v47
    v_fma_f32 v40, v40, -2.0, 1.0
    v_fma_f32 v41, v41, -2.0, 1.0
    v_fma_f32 v42, v42, -2.0, 1.0
    v_fma_f32 v43, v43, -2.0, 1.0
    v_fma_f32 v44, v44, -2.0, 1.0
    v_fma_f32 v45, v45, -2.0, 1.0
    v_fma_f32 v46, v46, -2.0, 1.0
    v_fma_f32 v47, v47, -2.0, 1.0
    v_cvt_pk_bf16_f32 v228, v40, v41
    v_cvt_pk_bf16_f32 v229, v42, v43
    v_cvt_pk_bf16_f32 v230, v44, v45
    v_cvt_pk_bf16_f32 v231, v46, v47
    ds_write_b128 v248, v[228:231] offset:26624
    v_add_f32 v48, v208, v16
    v_add_f32 v49, v209, v17
    v_add_f32 v50, v210, v18
    v_add_f32 v51, v211, v19
    v_add_f32 v52, v212, v20
    v_add_f32 v53, v213, v21
    v_add_f32 v54, v214, v22
    v_add_f32 v55, v215, v23
    v_exp_f32 v48, v48
    v_exp_f32 v49, v49
    v_exp_f32 v50, v50
    v_exp_f32 v51, v51
    v_exp_f32 v52, v52
    v_exp_f32 v53, v53
    v_exp_f32 v54, v54
    v_exp_f32 v55, v55
    v_add_f32 v48, 1.0, v48
    v_add_f32 v49, 1.0, v49
    v_add_f32 v50, 1.0, v50
    v_add_f32 v51, 1.0, v51
    v_add_f32 v52, 1.0, v52
    v_add_f32 v53, 1.0, v53
    v_add_f32 v54, 1.0, v54
    v_add_f32 v55, 1.0, v55
    v_rcp_f32 v48, v48
    v_rcp_f32 v49, v49
    v_rcp_f32 v50, v50
    v_rcp_f32 v51, v51
    v_rcp_f32 v52, v52
    v_rcp_f32 v53, v53
    v_rcp_f32 v54, v54
    v_rcp_f32 v55, v55
    v_fma_f32 v48, v48, -2.0, 1.0
    v_fma_f32 v49, v49, -2.0, 1.0
    v_fma_f32 v50, v50, -2.0, 1.0
    v_fma_f32 v51, v51, -2.0, 1.0
    v_fma_f32 v52, v52, -2.0, 1.0
    v_fma_f32 v53, v53, -2.0, 1.0
    v_fma_f32 v54, v54, -2.0, 1.0
    v_fma_f32 v55, v55, -2.0, 1.0
    v_cvt_pk_bf16_f32 v232, v48, v49
    v_cvt_pk_bf16_f32 v233, v50, v51
    v_cvt_pk_bf16_f32 v234, v52, v53
    v_cvt_pk_bf16_f32 v235, v54, v55
    ds_write_b128 v248, v[232:235] offset:27648
    v_add_f32 v56, v216, v24
    v_add_f32 v57, v217, v25
    v_add_f32 v58, v218, v26
    v_add_f32 v59, v219, v27
    v_add_f32 v60, v220, v28
    v_add_f32 v61, v221, v29
    v_add_f32 v62, v222, v30
    v_add_f32 v63, v223, v31
    ds_read_b128 v[192:195], v249 offset:22528
    ds_read_b128 v[196:199], v249 offset:22544
    ds_read_b128 v[200:203], v249 offset:22592
    ds_read_b128 v[204:207], v249 offset:22608
    ds_read_b128 v[208:211], v249 offset:22656
    ds_read_b128 v[212:215], v249 offset:22672
    ds_read_b128 v[216:219], v249 offset:22720
    ds_read_b128 v[220:223], v249 offset:22736
    v_exp_f32 v56, v56
    v_exp_f32 v57, v57
    v_exp_f32 v58, v58
    v_exp_f32 v59, v59
    v_exp_f32 v60, v60
    v_exp_f32 v61, v61
    v_exp_f32 v62, v62
    v_exp_f32 v63, v63
    v_add_f32 v56, 1.0, v56
    v_add_f32 v57, 1.0, v57
    v_add_f32 v58, 1.0, v58
    v_add_f32 v59, 1.0, v59
    v_add_f32 v60, 1.0, v60
    v_add_f32 v61, 1.0, v61
    v_add_f32 v62, 1.0, v62
    v_add_f32 v63, 1.0, v63
    v_rcp_f32 v56, v56
    v_rcp_f32 v57, v57
    v_rcp_f32 v58, v58
    v_rcp_f32 v59, v59
    v_rcp_f32 v60, v60
    v_rcp_f32 v61, v61
    v_rcp_f32 v62, v62
    v_rcp_f32 v63, v63
    v_fma_f32 v56, v56, -2.0, 1.0
    v_fma_f32 v57, v57, -2.0, 1.0
    v_fma_f32 v58, v58, -2.0, 1.0
    v_fma_f32 v59, v59, -2.0, 1.0
    v_fma_f32 v60, v60, -2.0, 1.0
    v_fma_f32 v61, v61, -2.0, 1.0
    v_fma_f32 v62, v62, -2.0, 1.0
    v_fma_f32 v63, v63, -2.0, 1.0
    v_cvt_pk_bf16_f32 v236, v56, v57
    v_cvt_pk_bf16_f32 v237, v58, v59
    v_cvt_pk_bf16_f32 v238, v60, v61
    v_cvt_pk_bf16_f32 v239, v62, v63
    ds_write_b128 v248, v[236:239] offset:28672
    s_waitcnt lgkmcnt(0)
    s_barrier
    v_add_f32 v32, v192, v0
    v_add_f32 v33, v193, v1
    v_add_f32 v34, v194, v2
    v_add_f32 v35, v195, v3
    v_add_f32 v36, v196, v4
    v_add_f32 v37, v197, v5
    v_add_f32 v38, v198, v6
    v_add_f32 v39, v199, v7
    v_exp_f32 v32, v32
    v_exp_f32 v33, v33
    v_exp_f32 v34, v34
    v_exp_f32 v35, v35
    v_exp_f32 v36, v36
    v_exp_f32 v37, v37
    v_exp_f32 v38, v38
    v_exp_f32 v39, v39
    v_add_f32 v32, 1.0, v32
    v_add_f32 v33, 1.0, v33
    v_add_f32 v34, 1.0, v34
    v_add_f32 v35, 1.0, v35
    v_add_f32 v36, 1.0, v36
    v_add_f32 v37, 1.0, v37
    v_add_f32 v38, 1.0, v38
    v_add_f32 v39, 1.0, v39
    v_rcp_f32 v32, v32
    v_rcp_f32 v33, v33
    v_rcp_f32 v34, v34
    v_rcp_f32 v35, v35
    v_rcp_f32 v36, v36
    v_rcp_f32 v37, v37
    v_rcp_f32 v38, v38
    v_rcp_f32 v39, v39
    v_fma_f32 v32, v32, -2.0, 1.0
    v_fma_f32 v33, v33, -2.0, 1.0
    v_fma_f32 v34, v34, -2.0, 1.0
    v_fma_f32 v35, v35, -2.0, 1.0
    v_fma_f32 v36, v36, -2.0, 1.0
    v_fma_f32 v37, v37, -2.0, 1.0
    v_fma_f32 v38, v38, -2.0, 1.0
    v_fma_f32 v39, v39, -2.0, 1.0
    v_cvt_pk_bf16_f32 v224, v32, v33
    v_cvt_pk_bf16_f32 v225, v34, v35
    v_cvt_pk_bf16_f32 v226, v36, v37
    v_cvt_pk_bf16_f32 v227, v38, v39
    ds_write_b128 v248, v[224:227] offset:41984
    v_add_f32 v40, v200, v8
    v_add_f32 v41, v201, v9
    v_add_f32 v42, v202, v10
    v_add_f32 v43, v203, v11
    v_add_f32 v44, v204, v12
    v_add_f32 v45, v205, v13
    v_add_f32 v46, v206, v14
    v_add_f32 v47, v207, v15
    v_exp_f32 v40, v40
    v_exp_f32 v41, v41
    v_exp_f32 v42, v42
    v_exp_f32 v43, v43
    v_exp_f32 v44, v44
    v_exp_f32 v45, v45
    v_exp_f32 v46, v46
    v_exp_f32 v47, v47
    v_add_f32 v40, 1.0, v40
    v_add_f32 v41, 1.0, v41
    v_add_f32 v42, 1.0, v42
    v_add_f32 v43, 1.0, v43
    v_add_f32 v44, 1.0, v44
    v_add_f32 v45, 1.0, v45
    v_add_f32 v46, 1.0, v46
    v_add_f32 v47, 1.0, v47
    v_rcp_f32 v40, v40
    v_rcp_f32 v41, v41
    v_rcp_f32 v42, v42
    v_rcp_f32 v43, v43
    v_rcp_f32 v44, v44
    v_rcp_f32 v45, v45
    v_rcp_f32 v46, v46
    v_rcp_f32 v47, v47
    v_fma_f32 v40, v40, -2.0, 1.0
    v_fma_f32 v41, v41, -2.0, 1.0
    v_fma_f32 v42, v42, -2.0, 1.0
    v_fma_f32 v43, v43, -2.0, 1.0
    v_fma_f32 v44, v44, -2.0, 1.0
    v_fma_f32 v45, v45, -2.0, 1.0
    v_fma_f32 v46, v46, -2.0, 1.0
    v_fma_f32 v47, v47, -2.0, 1.0
    v_cvt_pk_bf16_f32 v228, v40, v41
    v_cvt_pk_bf16_f32 v229, v42, v43
    v_cvt_pk_bf16_f32 v230, v44, v45
    v_cvt_pk_bf16_f32 v231, v46, v47
    ds_write_b128 v248, v[228:231] offset:43008
    v_add_f32 v48, v208, v16
    v_add_f32 v49, v209, v17
    v_add_f32 v50, v210, v18
    v_add_f32 v51, v211, v19
    v_add_f32 v52, v212, v20
    v_add_f32 v53, v213, v21
    v_add_f32 v54, v214, v22
    v_add_f32 v55, v215, v23
    v_exp_f32 v48, v48
    v_exp_f32 v49, v49
    v_exp_f32 v50, v50
    v_exp_f32 v51, v51
    v_exp_f32 v52, v52
    v_exp_f32 v53, v53
    v_exp_f32 v54, v54
    v_exp_f32 v55, v55
    v_add_f32 v48, 1.0, v48
    v_add_f32 v49, 1.0, v49
    v_add_f32 v50, 1.0, v50
    v_add_f32 v51, 1.0, v51
    v_add_f32 v52, 1.0, v52
    v_add_f32 v53, 1.0, v53
    v_add_f32 v54, 1.0, v54
    v_add_f32 v55, 1.0, v55
    v_rcp_f32 v48, v48
    v_rcp_f32 v49, v49
    v_rcp_f32 v50, v50
    v_rcp_f32 v51, v51
    v_rcp_f32 v52, v52
    v_rcp_f32 v53, v53
    v_rcp_f32 v54, v54
    v_rcp_f32 v55, v55
    v_fma_f32 v48, v48, -2.0, 1.0
    v_fma_f32 v49, v49, -2.0, 1.0
    v_fma_f32 v50, v50, -2.0, 1.0
    v_fma_f32 v51, v51, -2.0, 1.0
    v_fma_f32 v52, v52, -2.0, 1.0
    v_fma_f32 v53, v53, -2.0, 1.0
    v_fma_f32 v54, v54, -2.0, 1.0
    v_fma_f32 v55, v55, -2.0, 1.0
    v_cvt_pk_bf16_f32 v232, v48, v49
    v_cvt_pk_bf16_f32 v233, v50, v51
    v_cvt_pk_bf16_f32 v234, v52, v53
    v_cvt_pk_bf16_f32 v235, v54, v55
    ds_write_b128 v248, v[232:235] offset:44032
    v_add_f32 v56, v216, v24
    v_add_f32 v57, v217, v25
    v_add_f32 v58, v218, v26
    v_add_f32 v59, v219, v27
    v_add_f32 v60, v220, v28
    v_add_f32 v61, v221, v29
    v_add_f32 v62, v222, v30
    v_add_f32 v63, v223, v31
    ds_read_b128 v[192:195], v249 offset:23552
    ds_read_b128 v[196:199], v249 offset:23568
    ds_read_b128 v[200:203], v249 offset:23616
    ds_read_b128 v[204:207], v249 offset:23632
    ds_read_b128 v[208:211], v249 offset:23680
    ds_read_b128 v[212:215], v249 offset:23696
    ds_read_b128 v[216:219], v249 offset:23744
    ds_read_b128 v[220:223], v249 offset:23760
    v_exp_f32 v56, v56
    v_exp_f32 v57, v57
    v_exp_f32 v58, v58
    v_exp_f32 v59, v59
    v_exp_f32 v60, v60
    v_exp_f32 v61, v61
    v_exp_f32 v62, v62
    v_exp_f32 v63, v63
    v_add_f32 v56, 1.0, v56
    v_add_f32 v57, 1.0, v57
    v_add_f32 v58, 1.0, v58
    v_add_f32 v59, 1.0, v59
    v_add_f32 v60, 1.0, v60
    v_add_f32 v61, 1.0, v61
    v_add_f32 v62, 1.0, v62
    v_add_f32 v63, 1.0, v63
    v_rcp_f32 v56, v56
    v_rcp_f32 v57, v57
    v_rcp_f32 v58, v58
    v_rcp_f32 v59, v59
    v_rcp_f32 v60, v60
    v_rcp_f32 v61, v61
    v_rcp_f32 v62, v62
    v_rcp_f32 v63, v63
    v_fma_f32 v56, v56, -2.0, 1.0
    v_fma_f32 v57, v57, -2.0, 1.0
    v_fma_f32 v58, v58, -2.0, 1.0
    v_fma_f32 v59, v59, -2.0, 1.0
    v_fma_f32 v60, v60, -2.0, 1.0
    v_fma_f32 v61, v61, -2.0, 1.0
    v_fma_f32 v62, v62, -2.0, 1.0
    v_fma_f32 v63, v63, -2.0, 1.0
    v_cvt_pk_bf16_f32 v236, v56, v57
    v_cvt_pk_bf16_f32 v237, v58, v59
    v_cvt_pk_bf16_f32 v238, v60, v61
    v_cvt_pk_bf16_f32 v239, v62, v63
    ds_write_b128 v248, v[236:239] offset:45056
    s_waitcnt lgkmcnt(0)
    s_barrier
    v_add_f32 v32, v192, v0
    v_add_f32 v33, v193, v1
    v_add_f32 v34, v194, v2
    v_add_f32 v35, v195, v3
    v_add_f32 v36, v196, v4
    v_add_f32 v37, v197, v5
    v_add_f32 v38, v198, v6
    v_add_f32 v39, v199, v7
    v_exp_f32 v32, v32
    v_exp_f32 v33, v33
    v_exp_f32 v34, v34
    v_exp_f32 v35, v35
    v_exp_f32 v36, v36
    v_exp_f32 v37, v37
    v_exp_f32 v38, v38
    v_exp_f32 v39, v39
    v_add_f32 v32, 1.0, v32
    v_add_f32 v33, 1.0, v33
    v_add_f32 v34, 1.0, v34
    v_add_f32 v35, 1.0, v35
    v_add_f32 v36, 1.0, v36
    v_add_f32 v37, 1.0, v37
    v_add_f32 v38, 1.0, v38
    v_add_f32 v39, 1.0, v39
    v_rcp_f32 v32, v32
    v_rcp_f32 v33, v33
    v_rcp_f32 v34, v34
    v_rcp_f32 v35, v35
    v_rcp_f32 v36, v36
    v_rcp_f32 v37, v37
    v_rcp_f32 v38, v38
    v_rcp_f32 v39, v39
    v_fma_f32 v32, v32, -2.0, 1.0
    v_fma_f32 v33, v33, -2.0, 1.0
    v_fma_f32 v34, v34, -2.0, 1.0
    v_fma_f32 v35, v35, -2.0, 1.0
    v_fma_f32 v36, v36, -2.0, 1.0
    v_fma_f32 v37, v37, -2.0, 1.0
    v_fma_f32 v38, v38, -2.0, 1.0
    v_fma_f32 v39, v39, -2.0, 1.0
    v_cvt_pk_bf16_f32 v224, v32, v33
    v_cvt_pk_bf16_f32 v225, v34, v35
    v_cvt_pk_bf16_f32 v226, v36, v37
    v_cvt_pk_bf16_f32 v227, v38, v39
    ds_write_b128 v248, v[224:227] offset:25600
    v_add_f32 v40, v200, v8
    v_add_f32 v41, v201, v9
    v_add_f32 v42, v202, v10
    v_add_f32 v43, v203, v11
    v_add_f32 v44, v204, v12
    v_add_f32 v45, v205, v13
    v_add_f32 v46, v206, v14
    v_add_f32 v47, v207, v15
    v_exp_f32 v40, v40
    v_exp_f32 v41, v41
    v_exp_f32 v42, v42
    v_exp_f32 v43, v43
    v_exp_f32 v44, v44
    v_exp_f32 v45, v45
    v_exp_f32 v46, v46
    v_exp_f32 v47, v47
    v_add_f32 v40, 1.0, v40
    v_add_f32 v41, 1.0, v41
    v_add_f32 v42, 1.0, v42
    v_add_f32 v43, 1.0, v43
    v_add_f32 v44, 1.0, v44
    v_add_f32 v45, 1.0, v45
    v_add_f32 v46, 1.0, v46
    v_add_f32 v47, 1.0, v47
    v_rcp_f32 v40, v40
    v_rcp_f32 v41, v41
    v_rcp_f32 v42, v42
    v_rcp_f32 v43, v43
    v_rcp_f32 v44, v44
    v_rcp_f32 v45, v45
    v_rcp_f32 v46, v46
    v_rcp_f32 v47, v47
    v_fma_f32 v40, v40, -2.0, 1.0
    v_fma_f32 v41, v41, -2.0, 1.0
    v_fma_f32 v42, v42, -2.0, 1.0
    v_fma_f32 v43, v43, -2.0, 1.0
    v_fma_f32 v44, v44, -2.0, 1.0
    v_fma_f32 v45, v45, -2.0, 1.0
    v_fma_f32 v46, v46, -2.0, 1.0
    v_fma_f32 v47, v47, -2.0, 1.0
    v_cvt_pk_bf16_f32 v228, v40, v41
    v_cvt_pk_bf16_f32 v229, v42, v43
    v_cvt_pk_bf16_f32 v230, v44, v45
    v_cvt_pk_bf16_f32 v231, v46, v47
    ds_write_b128 v248, v[228:231] offset:26624
    v_add_f32 v48, v208, v16
    v_add_f32 v49, v209, v17
    v_add_f32 v50, v210, v18
    v_add_f32 v51, v211, v19
    v_add_f32 v52, v212, v20
    v_add_f32 v53, v213, v21
    v_add_f32 v54, v214, v22
    v_add_f32 v55, v215, v23
    v_exp_f32 v48, v48
    v_exp_f32 v49, v49
    v_exp_f32 v50, v50
    v_exp_f32 v51, v51
    v_exp_f32 v52, v52
    v_exp_f32 v53, v53
    v_exp_f32 v54, v54
    v_exp_f32 v55, v55
    v_add_f32 v48, 1.0, v48
    v_add_f32 v49, 1.0, v49
    v_add_f32 v50, 1.0, v50
    v_add_f32 v51, 1.0, v51
    v_add_f32 v52, 1.0, v52
    v_add_f32 v53, 1.0, v53
    v_add_f32 v54, 1.0, v54
    v_add_f32 v55, 1.0, v55
    v_rcp_f32 v48, v48
    v_rcp_f32 v49, v49
    v_rcp_f32 v50, v50
    v_rcp_f32 v51, v51
    v_rcp_f32 v52, v52
    v_rcp_f32 v53, v53
    v_rcp_f32 v54, v54
    v_rcp_f32 v55, v55
    v_fma_f32 v48, v48, -2.0, 1.0
    v_fma_f32 v49, v49, -2.0, 1.0
    v_fma_f32 v50, v50, -2.0, 1.0
    v_fma_f32 v51, v51, -2.0, 1.0
    v_fma_f32 v52, v52, -2.0, 1.0
    v_fma_f32 v53, v53, -2.0, 1.0
    v_fma_f32 v54, v54, -2.0, 1.0
    v_fma_f32 v55, v55, -2.0, 1.0
    v_cvt_pk_bf16_f32 v232, v48, v49
    v_cvt_pk_bf16_f32 v233, v50, v51
    v_cvt_pk_bf16_f32 v234, v52, v53
    v_cvt_pk_bf16_f32 v235, v54, v55
    ds_write_b128 v248, v[232:235] offset:27648
    v_add_f32 v56, v216, v24
    v_add_f32 v57, v217, v25
    v_add_f32 v58, v218, v26
    v_add_f32 v59, v219, v27
    v_add_f32 v60, v220, v28
    v_add_f32 v61, v221, v29
    v_add_f32 v62, v222, v30
    v_add_f32 v63, v223, v31
    ds_read_b128 v[192:195], v249 offset:24576
    ds_read_b128 v[196:199], v249 offset:24592
    ds_read_b128 v[200:203], v249 offset:24640
    ds_read_b128 v[204:207], v249 offset:24656
    ds_read_b128 v[208:211], v249 offset:24704
    ds_read_b128 v[212:215], v249 offset:24720
    ds_read_b128 v[216:219], v249 offset:24768
    ds_read_b128 v[220:223], v249 offset:24784
    v_exp_f32 v56, v56
    v_exp_f32 v57, v57
    v_exp_f32 v58, v58
    v_exp_f32 v59, v59
    v_exp_f32 v60, v60
    v_exp_f32 v61, v61
    v_exp_f32 v62, v62
    v_exp_f32 v63, v63
    v_add_f32 v56, 1.0, v56
    v_add_f32 v57, 1.0, v57
    v_add_f32 v58, 1.0, v58
    v_add_f32 v59, 1.0, v59
    v_add_f32 v60, 1.0, v60
    v_add_f32 v61, 1.0, v61
    v_add_f32 v62, 1.0, v62
    v_add_f32 v63, 1.0, v63
    v_rcp_f32 v56, v56
    v_rcp_f32 v57, v57
    v_rcp_f32 v58, v58
    v_rcp_f32 v59, v59
    v_rcp_f32 v60, v60
    v_rcp_f32 v61, v61
    v_rcp_f32 v62, v62
    v_rcp_f32 v63, v63
    v_fma_f32 v56, v56, -2.0, 1.0
    v_fma_f32 v57, v57, -2.0, 1.0
    v_fma_f32 v58, v58, -2.0, 1.0
    v_fma_f32 v59, v59, -2.0, 1.0
    v_fma_f32 v60, v60, -2.0, 1.0
    v_fma_f32 v61, v61, -2.0, 1.0
    v_fma_f32 v62, v62, -2.0, 1.0
    v_fma_f32 v63, v63, -2.0, 1.0
    v_cvt_pk_bf16_f32 v236, v56, v57
    v_cvt_pk_bf16_f32 v237, v58, v59
    v_cvt_pk_bf16_f32 v238, v60, v61
    v_cvt_pk_bf16_f32 v239, v62, v63
    ds_write_b128 v248, v[236:239] offset:28672
    s_waitcnt lgkmcnt(0)
    s_barrier
    v_add_f32 v32, v192, v0
    v_add_f32 v33, v193, v1
    v_add_f32 v34, v194, v2
    v_add_f32 v35, v195, v3
    v_add_f32 v36, v196, v4
    v_add_f32 v37, v197, v5
    v_add_f32 v38, v198, v6
    v_add_f32 v39, v199, v7
    v_exp_f32 v32, v32
    v_exp_f32 v33, v33
    v_exp_f32 v34, v34
    v_exp_f32 v35, v35
    v_exp_f32 v36, v36
    v_exp_f32 v37, v37
    v_exp_f32 v38, v38
    v_exp_f32 v39, v39
    v_add_f32 v32, 1.0, v32
    v_add_f32 v33, 1.0, v33
    v_add_f32 v34, 1.0, v34
    v_add_f32 v35, 1.0, v35
    v_add_f32 v36, 1.0, v36
    v_add_f32 v37, 1.0, v37
    v_add_f32 v38, 1.0, v38
    v_add_f32 v39, 1.0, v39
    v_rcp_f32 v32, v32
    v_rcp_f32 v33, v33
    v_rcp_f32 v34, v34
    v_rcp_f32 v35, v35
    v_rcp_f32 v36, v36
    v_rcp_f32 v37, v37
    v_rcp_f32 v38, v38
    v_rcp_f32 v39, v39
    v_fma_f32 v32, v32, -2.0, 1.0
    v_fma_f32 v33, v33, -2.0, 1.0
    v_fma_f32 v34, v34, -2.0, 1.0
    v_fma_f32 v35, v35, -2.0, 1.0
    v_fma_f32 v36, v36, -2.0, 1.0
    v_fma_f32 v37, v37, -2.0, 1.0
    v_fma_f32 v38, v38, -2.0, 1.0
    v_fma_f32 v39, v39, -2.0, 1.0
    v_cvt_pk_bf16_f32 v224, v32, v33
    v_cvt_pk_bf16_f32 v225, v34, v35
    v_cvt_pk_bf16_f32 v226, v36, v37
    v_cvt_pk_bf16_f32 v227, v38, v39
    ds_write_b128 v248, v[224:227] offset:41984
    v_add_f32 v40, v200, v8
    v_add_f32 v41, v201, v9
    v_add_f32 v42, v202, v10
    v_add_f32 v43, v203, v11
    v_add_f32 v44, v204, v12
    v_add_f32 v45, v205, v13
    v_add_f32 v46, v206, v14
    v_add_f32 v47, v207, v15
    v_exp_f32 v40, v40
    v_exp_f32 v41, v41
    v_exp_f32 v42, v42
    v_exp_f32 v43, v43
    v_exp_f32 v44, v44
    v_exp_f32 v45, v45
    v_exp_f32 v46, v46
    v_exp_f32 v47, v47
    v_add_f32 v40, 1.0, v40
    v_add_f32 v41, 1.0, v41
    v_add_f32 v42, 1.0, v42
    v_add_f32 v43, 1.0, v43
    v_add_f32 v44, 1.0, v44
    v_add_f32 v45, 1.0, v45
    v_add_f32 v46, 1.0, v46
    v_add_f32 v47, 1.0, v47
    v_rcp_f32 v40, v40
    v_rcp_f32 v41, v41
    v_rcp_f32 v42, v42
    v_rcp_f32 v43, v43
    v_rcp_f32 v44, v44
    v_rcp_f32 v45, v45
    v_rcp_f32 v46, v46
    v_rcp_f32 v47, v47
    v_fma_f32 v40, v40, -2.0, 1.0
    v_fma_f32 v41, v41, -2.0, 1.0
    v_fma_f32 v42, v42, -2.0, 1.0
    v_fma_f32 v43, v43, -2.0, 1.0
    v_fma_f32 v44, v44, -2.0, 1.0
    v_fma_f32 v45, v45, -2.0, 1.0
    v_fma_f32 v46, v46, -2.0, 1.0
    v_fma_f32 v47, v47, -2.0, 1.0
    v_cvt_pk_bf16_f32 v228, v40, v41
    v_cvt_pk_bf16_f32 v229, v42, v43
    v_cvt_pk_bf16_f32 v230, v44, v45
    v_cvt_pk_bf16_f32 v231, v46, v47
    ds_write_b128 v248, v[228:231] offset:43008
    v_add_f32 v48, v208, v16
    v_add_f32 v49, v209, v17
    v_add_f32 v50, v210, v18
    v_add_f32 v51, v211, v19
    v_add_f32 v52, v212, v20
    v_add_f32 v53, v213, v21
    v_add_f32 v54, v214, v22
    v_add_f32 v55, v215, v23
    v_exp_f32 v48, v48
    v_exp_f32 v49, v49
    v_exp_f32 v50, v50
    v_exp_f32 v51, v51
    v_exp_f32 v52, v52
    v_exp_f32 v53, v53
    v_exp_f32 v54, v54
    v_exp_f32 v55, v55
    v_add_f32 v48, 1.0, v48
    v_add_f32 v49, 1.0, v49
    v_add_f32 v50, 1.0, v50
    v_add_f32 v51, 1.0, v51
    v_add_f32 v52, 1.0, v52
    v_add_f32 v53, 1.0, v53
    v_add_f32 v54, 1.0, v54
    v_add_f32 v55, 1.0, v55
    v_rcp_f32 v48, v48
    v_rcp_f32 v49, v49
    v_rcp_f32 v50, v50
    v_rcp_f32 v51, v51
    v_rcp_f32 v52, v52
    v_rcp_f32 v53, v53
    v_rcp_f32 v54, v54
    v_rcp_f32 v55, v55
    v_fma_f32 v48, v48, -2.0, 1.0
    v_fma_f32 v49, v49, -2.0, 1.0
    v_fma_f32 v50, v50, -2.0, 1.0
    v_fma_f32 v51, v51, -2.0, 1.0
    v_fma_f32 v52, v52, -2.0, 1.0
    v_fma_f32 v53, v53, -2.0, 1.0
    v_fma_f32 v54, v54, -2.0, 1.0
    v_fma_f32 v55, v55, -2.0, 1.0
    v_cvt_pk_bf16_f32 v232, v48, v49
    v_cvt_pk_bf16_f32 v233, v50, v51
    v_cvt_pk_bf16_f32 v234, v52, v53
    v_cvt_pk_bf16_f32 v235, v54, v55
    ds_write_b128 v248, v[232:235] offset:44032
    v_add_f32 v56, v216, v24
    v_add_f32 v57, v217, v25
    v_add_f32 v58, v218, v26
    v_add_f32 v59, v219, v27
    v_add_f32 v60, v220, v28
    v_add_f32 v61, v221, v29
    v_add_f32 v62, v222, v30
    v_add_f32 v63, v223, v31
    v_exp_f32 v56, v56
    v_exp_f32 v57, v57
    v_exp_f32 v58, v58
    v_exp_f32 v59, v59
    v_exp_f32 v60, v60
    v_exp_f32 v61, v61
    v_exp_f32 v62, v62
    v_exp_f32 v63, v63
    v_add_f32 v56, 1.0, v56
    v_add_f32 v57, 1.0, v57
    v_add_f32 v58, 1.0, v58
    v_add_f32 v59, 1.0, v59
    v_add_f32 v60, 1.0, v60
    v_add_f32 v61, 1.0, v61
    v_add_f32 v62, 1.0, v62
    v_add_f32 v63, 1.0, v63
    v_rcp_f32 v56, v56
    v_rcp_f32 v57, v57
    v_rcp_f32 v58, v58
    v_rcp_f32 v59, v59
    v_rcp_f32 v60, v60
    v_rcp_f32 v61, v61
    v_rcp_f32 v62, v62
    v_rcp_f32 v63, v63
    v_fma_f32 v56, v56, -2.0, 1.0
    v_fma_f32 v57, v57, -2.0, 1.0
    v_fma_f32 v58, v58, -2.0, 1.0
    v_fma_f32 v59, v59, -2.0, 1.0
    v_fma_f32 v60, v60, -2.0, 1.0
    v_fma_f32 v61, v61, -2.0, 1.0
    v_fma_f32 v62, v62, -2.0, 1.0
    v_fma_f32 v63, v63, -2.0, 1.0
    v_cvt_pk_bf16_f32 v236, v56, v57
    v_cvt_pk_bf16_f32 v237, v58, v59
    v_cvt_pk_bf16_f32 v238, v60, v61
    v_cvt_pk_bf16_f32 v239, v62, v63
    ds_write_b128 v248, v[236:239] offset:45056
    s_waitcnt lgkmcnt(0)
    s_barrier
L_joint_kernel_fin:
L_joint_kernel_done:
    s_endpgm
.section .rodata,"a"
.p2align 6
.amdhsa_kernel prep_kernel
  .amdhsa_next_free_vgpr 136
  .amdhsa_next_free_sgpr 102
  .amdhsa_accum_offset 136
  .amdhsa_group_segment_fixed_size 0
  .amdhsa_kernarg_size 80
  .amdhsa_user_sgpr_count 2
  .amdhsa_user_sgpr_kernarg_segment_ptr 1
  .amdhsa_system_sgpr_workgroup_id_x 1
.end_amdhsa_kernel
.p2align 6
.amdhsa_kernel conv1_kernel
  .amdhsa_next_free_vgpr 256
  .amdhsa_next_free_sgpr 102
  .amdhsa_accum_offset 256
  .amdhsa_group_segment_fixed_size 0
  .amdhsa_kernarg_size 80
  .amdhsa_user_sgpr_count 2
  .amdhsa_user_sgpr_kernarg_segment_ptr 1
  .amdhsa_system_sgpr_workgroup_id_x 1
.end_amdhsa_kernel
.p2align 6
.amdhsa_kernel conv2_kernel
  .amdhsa_next_free_vgpr 256
  .amdhsa_next_free_sgpr 102
  .amdhsa_accum_offset 256
  .amdhsa_group_segment_fixed_size 0
  .amdhsa_kernarg_size 80
  .amdhsa_user_sgpr_count 2
  .amdhsa_user_sgpr_kernarg_segment_ptr 1
  .amdhsa_system_sgpr_workgroup_id_x 1
.end_amdhsa_kernel
.p2align 6
.amdhsa_kernel joint_kernel
  .amdhsa_next_free_vgpr 256
  .amdhsa_next_free_sgpr 102
  .amdhsa_accum_offset 256
  .amdhsa_group_segment_fixed_size 0
  .amdhsa_kernarg_size 80
  .amdhsa_user_sgpr_count 2
  .amdhsa_user_sgpr_kernarg_segment_ptr 1
  .amdhsa_system_sgpr_workgroup_id_x 1
.end_amdhsa_kernel
```

```asm
; @launch kernel=prep_kernel grid=(268,1,1) block=(256,1,1) lds=32768
; @launch kernel=conv1_kernel grid=(256,1,1) block=(1024,1,1) lds=162816
; @launch kernel=conv2_kernel grid=(256,1,1) block=(1024,1,1) lds=162816
; @launch kernel=joint_kernel grid=(250,1,1) block=(512,1,1) lds=66048
.amdgcn_target "amdgcn-amd-amdhsa--gfx950"
.text
.globl prep_kernel
.p2align 8
.type prep_kernel,@function
prep_kernel:
    s_cmp_ge_u32 s2, 268
    s_cbranch_scc1 L_prep_kernel_done
    s_cmp_lt_u32 s2, 12
    s_cbranch_scc1 L_prep_kernel_small
    s_sub_u32 s2, s2, 12
    v_readfirstlane_b32 s20, v0
    s_lshr_b32 s20, s20, 6
    s_lshl_b32 s21, s2, 2
    s_add_u32 s20, s20, s21
    v_and_b32 v1, 63, v0
    s_load_dwordx2 s[8:9], s[0:1], 8
    s_load_dwordx2 s[30:31], s[0:1], 72
    s_lshr_b32 s22, s20, 8
    s_bfe_u32 s23, s20, 0x40004
    s_bfe_u32 s24, s20, 0x30001
    s_and_b32 s21, s20, 1
    v_lshrrev_b32 v2, 4, v1
    v_lshlrev_b32 v2, 12, v2
    v_and_b32 v3, 15, v1
    v_lshl_add_u32 v2, v3, 2, v2
    s_lshl_b32 s26, s22, 3
    s_lshr_b32 s27, s23, 3
    s_add_u32 s26, s26, s27
    s_lshl_b32 s26, s26, 17
    s_and_b32 s27, s23, 7
    s_lshl_b32 s27, s27, 14
    s_add_u32 s26, s26, s27
    s_lshl_b32 s27, s24, 6
    s_add_u32 s26, s26, s27
    s_mov_b32 s10, 4063232
    s_mov_b32 s11, 0x00020000
    s_add_u32 s37, s26, 262144
    s_add_u32 s38, s26, 524288
    s_add_u32 s39, s26, 786432
    s_waitcnt lgkmcnt(0)
    buffer_load_dword v16, v2, s[8:11], s26 offen offset:0
    buffer_load_dword v17, v2, s[8:11], s26 offen offset:512
    buffer_load_dword v24, v2, s[8:11], s37 offen offset:0
    buffer_load_dword v25, v2, s[8:11], s37 offen offset:512
    buffer_load_dword v32, v2, s[8:11], s38 offen offset:0
    buffer_load_dword v33, v2, s[8:11], s38 offen offset:512
    buffer_load_dword v40, v2, s[8:11], s39 offen offset:0
    buffer_load_dword v41, v2, s[8:11], s39 offen offset:512
    buffer_load_dword v18, v2, s[8:11], s26 offen offset:1024
    buffer_load_dword v19, v2, s[8:11], s26 offen offset:1536
    buffer_load_dword v26, v2, s[8:11], s37 offen offset:1024
    buffer_load_dword v27, v2, s[8:11], s37 offen offset:1536
    buffer_load_dword v34, v2, s[8:11], s38 offen offset:1024
    buffer_load_dword v35, v2, s[8:11], s38 offen offset:1536
    buffer_load_dword v42, v2, s[8:11], s39 offen offset:1024
    buffer_load_dword v43, v2, s[8:11], s39 offen offset:1536
    buffer_load_dword v20, v2, s[8:11], s26 offen offset:2048
    buffer_load_dword v21, v2, s[8:11], s26 offen offset:2560
    buffer_load_dword v28, v2, s[8:11], s37 offen offset:2048
    buffer_load_dword v29, v2, s[8:11], s37 offen offset:2560
    buffer_load_dword v36, v2, s[8:11], s38 offen offset:2048
    buffer_load_dword v37, v2, s[8:11], s38 offen offset:2560
    buffer_load_dword v44, v2, s[8:11], s39 offen offset:2048
    buffer_load_dword v45, v2, s[8:11], s39 offen offset:2560
    buffer_load_dword v22, v2, s[8:11], s26 offen offset:3072
    buffer_load_dword v23, v2, s[8:11], s26 offen offset:3584
    buffer_load_dword v30, v2, s[8:11], s37 offen offset:3072
    buffer_load_dword v31, v2, s[8:11], s37 offen offset:3584
    buffer_load_dword v38, v2, s[8:11], s38 offen offset:3072
    buffer_load_dword v39, v2, s[8:11], s38 offen offset:3584
    buffer_load_dword v46, v2, s[8:11], s39 offen offset:3072
    buffer_load_dword v47, v2, s[8:11], s39 offen offset:3584
    s_add_u32 s12, s30, 0
    s_addc_u32 s13, s31, 0
    s_mov_b32 s14, 7340032
    s_mov_b32 s15, 0x00020000
    v_lshlrev_b32 v4, 4, v1
    s_lshl_b32 s27, s24, 4
    s_add_u32 s27, s27, s23
    s_mul_i32 s27, s27, 57344
    s_lshl_b32 s28, s22, 11
    s_add_u32 s27, s27, s28
    s_lshl_b32 s28, s21, 10
    s_add_u32 s27, s27, s28
    s_cmp_eq_u32 s21, 0
    s_mov_b32 s32, 0x07060302
    s_cselect_b32 s32, 0x05040100, s32
    s_mov_b32 s33, 0x03020c0c
    s_cselect_b32 s33, 0x01000c0c, s33
    s_mov_b32 s35, 0x3d2aaaab
    s_mov_b32 s36, 0x3c638e39
    s_waitcnt vmcnt(24)
    v_perm_b32 v72, v17, v16, s32
    v_perm_b32 v48, v41, v40, s32
    v_perm_b32 v76, v76, v40, s33
    v_perm_b32 v84, v84, v41, s33
    v_perm_b32 v77, v77, v32, s33
    v_perm_b32 v85, v85, v33, s33
    v_perm_b32 v78, v78, v24, s33
    v_perm_b32 v86, v86, v25, s33
    v_perm_b32 v79, v79, v16, s33
    v_perm_b32 v87, v87, v17, s33
    v_add_f32 v80, v76, v78
    v_add_f32 v88, v84, v86
    v_add_f32 v81, v77, v79
    v_add_f32 v89, v85, v87
    v_fma_f32 v82, v78, 4.0, v76
    v_fma_f32 v90, v86, 4.0, v84
    v_fma_f32 v83, v79, 4.0, v77
    v_fma_f32 v91, v87, 4.0, v85
    v_add_f32 v77, v80, v81
    v_add_f32 v85, v88, v89
    v_sub_f32 v78, v80, v81
    v_sub_f32 v86, v88, v89
    v_fma_f32 v79, v83, 2.0, v82
    v_fma_f32 v87, v91, 2.0, v90
    v_fma_f32 v82, v83, -2.0, v82
    v_fma_f32 v90, v91, -2.0, v90
    v_fmamk_f32 v80, v76, 0x41700000, v82
    v_fmamk_f32 v88, v84, 0x41700000, v90
    v_fmamk_f32 v80, v81, 0x41200000, v80
    v_fmamk_f32 v88, v89, 0x41200000, v88
    v_mul_f32 v77, 0.5, v77
    v_mul_f32 v85, 0.5, v85
    v_mul_f32 v78, 0.5, v78
    v_mul_f32 v86, 0.5, v86
    v_mul_f32 v79, s35, v79
    v_mul_f32 v87, s35, v87
    v_mul_f32 v82, s35, v82
    v_mul_f32 v90, s35, v90
    v_mul_f32 v80, s36, v80
    v_mul_f32 v88, s36, v88
    v_cvt_pk_bf16_f32 v52, v77, v85
    v_cvt_pk_bf16_f32 v56, v78, v86
    v_cvt_pk_bf16_f32 v60, v79, v87
    v_cvt_pk_bf16_f32 v64, v82, v90
    v_cvt_pk_bf16_f32 v68, v80, v88
    s_waitcnt vmcnt(16)
    v_perm_b32 v73, v19, v18, s32
    v_perm_b32 v49, v43, v42, s32
    v_perm_b32 v76, v76, v42, s33
    v_perm_b32 v84, v84, v43, s33
    v_perm_b32 v77, v77, v34, s33
    v_perm_b32 v85, v85, v35, s33
    v_perm_b32 v78, v78, v26, s33
    v_perm_b32 v86, v86, v27, s33
    v_perm_b32 v79, v79, v18, s33
    v_perm_b32 v87, v87, v19, s33
    v_add_f32 v80, v76, v78
    v_add_f32 v88, v84, v86
    v_add_f32 v81, v77, v79
    v_add_f32 v89, v85, v87
    v_fma_f32 v82, v78, 4.0, v76
    v_fma_f32 v90, v86, 4.0, v84
    v_fma_f32 v83, v79, 4.0, v77
    v_fma_f32 v91, v87, 4.0, v85
    v_add_f32 v77, v80, v81
    v_add_f32 v85, v88, v89
    v_sub_f32 v78, v80, v81
    v_sub_f32 v86, v88, v89
    v_fma_f32 v79, v83, 2.0, v82
    v_fma_f32 v87, v91, 2.0, v90
    v_fma_f32 v82, v83, -2.0, v82
    v_fma_f32 v90, v91, -2.0, v90
    v_fmamk_f32 v80, v76, 0x41700000, v82
    v_fmamk_f32 v88, v84, 0x41700000, v90
    v_fmamk_f32 v80, v81, 0x41200000, v80
    v_fmamk_f32 v88, v89, 0x41200000, v88
    v_mul_f32 v77, 0.5, v77
    v_mul_f32 v85, 0.5, v85
    v_mul_f32 v78, 0.5, v78
    v_mul_f32 v86, 0.5, v86
    v_mul_f32 v79, s35, v79
    v_mul_f32 v87, s35, v87
    v_mul_f32 v82, s35, v82
    v_mul_f32 v90, s35, v90
    v_mul_f32 v80, s36, v80
    v_mul_f32 v88, s36, v88
    v_cvt_pk_bf16_f32 v53, v77, v85
    v_cvt_pk_bf16_f32 v57, v78, v86
    v_cvt_pk_bf16_f32 v61, v79, v87
    v_cvt_pk_bf16_f32 v65, v82, v90
    v_cvt_pk_bf16_f32 v69, v80, v88
    s_waitcnt vmcnt(8)
    v_perm_b32 v74, v21, v20, s32
    v_perm_b32 v50, v45, v44, s32
    v_perm_b32 v76, v76, v44, s33
    v_perm_b32 v84, v84, v45, s33
    v_perm_b32 v77, v77, v36, s33
    v_perm_b32 v85, v85, v37, s33
    v_perm_b32 v78, v78, v28, s33
    v_perm_b32 v86, v86, v29, s33
    v_perm_b32 v79, v79, v20, s33
    v_perm_b32 v87, v87, v21, s33
    v_add_f32 v80, v76, v78
    v_add_f32 v88, v84, v86
    v_add_f32 v81, v77, v79
    v_add_f32 v89, v85, v87
    v_fma_f32 v82, v78, 4.0, v76
    v_fma_f32 v90, v86, 4.0, v84
    v_fma_f32 v83, v79, 4.0, v77
    v_fma_f32 v91, v87, 4.0, v85
    v_add_f32 v77, v80, v81
    v_add_f32 v85, v88, v89
    v_sub_f32 v78, v80, v81
    v_sub_f32 v86, v88, v89
    v_fma_f32 v79, v83, 2.0, v82
    v_fma_f32 v87, v91, 2.0, v90
    v_fma_f32 v82, v83, -2.0, v82
    v_fma_f32 v90, v91, -2.0, v90
    v_fmamk_f32 v80, v76, 0x41700000, v82
    v_fmamk_f32 v88, v84, 0x41700000, v90
    v_fmamk_f32 v80, v81, 0x41200000, v80
    v_fmamk_f32 v88, v89, 0x41200000, v88
    v_mul_f32 v77, 0.5, v77
    v_mul_f32 v85, 0.5, v85
    v_mul_f32 v78, 0.5, v78
    v_mul_f32 v86, 0.5, v86
    v_mul_f32 v79, s35, v79
    v_mul_f32 v87, s35, v87
    v_mul_f32 v82, s35, v82
    v_mul_f32 v90, s35, v90
    v_mul_f32 v80, s36, v80
    v_mul_f32 v88, s36, v88
    v_cvt_pk_bf16_f32 v54, v77, v85
    v_cvt_pk_bf16_f32 v58, v78, v86
    v_cvt_pk_bf16_f32 v62, v79, v87
    v_cvt_pk_bf16_f32 v66, v82, v90
    v_cvt_pk_bf16_f32 v70, v80, v88
    s_waitcnt vmcnt(0)
    v_perm_b32 v75, v23, v22, s32
    v_perm_b32 v51, v47, v46, s32
    v_perm_b32 v76, v76, v46, s33
    v_perm_b32 v84, v84, v47, s33
    v_perm_b32 v77, v77, v38, s33
    v_perm_b32 v85, v85, v39, s33
    v_perm_b32 v78, v78, v30, s33
    v_perm_b32 v86, v86, v31, s33
    v_perm_b32 v79, v79, v22, s33
    v_perm_b32 v87, v87, v23, s33
    v_add_f32 v80, v76, v78
    v_add_f32 v88, v84, v86
    v_add_f32 v81, v77, v79
    v_add_f32 v89, v85, v87
    v_fma_f32 v82, v78, 4.0, v76
    v_fma_f32 v90, v86, 4.0, v84
    v_fma_f32 v83, v79, 4.0, v77
    v_fma_f32 v91, v87, 4.0, v85
    v_add_f32 v77, v80, v81
    v_add_f32 v85, v88, v89
    v_sub_f32 v78, v80, v81
    v_sub_f32 v86, v88, v89
    v_fma_f32 v79, v83, 2.0, v82
    v_fma_f32 v87, v91, 2.0, v90
    v_fma_f32 v82, v83, -2.0, v82
    v_fma_f32 v90, v91, -2.0, v90
    v_fmamk_f32 v80, v76, 0x41700000, v82
    v_fmamk_f32 v88, v84, 0x41700000, v90
    v_fmamk_f32 v80, v81, 0x41200000, v80
    v_fmamk_f32 v88, v89, 0x41200000, v88
    v_mul_f32 v77, 0.5, v77
    v_mul_f32 v85, 0.5, v85
    v_mul_f32 v78, 0.5, v78
    v_mul_f32 v86, 0.5, v86
    v_mul_f32 v79, s35, v79
    v_mul_f32 v87, s35, v87
    v_mul_f32 v82, s35, v82
    v_mul_f32 v90, s35, v90
    v_mul_f32 v80, s36, v80
    v_mul_f32 v88, s36, v88
    v_cvt_pk_bf16_f32 v55, v77, v85
    v_cvt_pk_bf16_f32 v59, v78, v86
    v_cvt_pk_bf16_f32 v63, v79, v87
    v_cvt_pk_bf16_f32 v67, v82, v90
    v_cvt_pk_bf16_f32 v71, v80, v88
    s_add_u32 s28, s27, 49152
    buffer_store_dwordx4 v[72:75], v4, s[12:15], s28 offen sc1
    s_add_u32 s28, s27, 0
    buffer_store_dwordx4 v[48:51], v4, s[12:15], s28 offen sc1
    s_add_u32 s28, s27, 8192
    buffer_store_dwordx4 v[52:55], v4, s[12:15], s28 offen sc1
    s_add_u32 s28, s27, 16384
    buffer_store_dwordx4 v[56:59], v4, s[12:15], s28 offen sc1
    s_add_u32 s28, s27, 24576
    buffer_store_dwordx4 v[60:63], v4, s[12:15], s28 offen sc1
    s_add_u32 s28, s27, 32768
    buffer_store_dwordx4 v[64:67], v4, s[12:15], s28 offen sc1
    s_add_u32 s28, s27, 40960
    buffer_store_dwordx4 v[68:71], v4, s[12:15], s28 offen sc1
L_prep_kernel_done:
    s_endpgm
L_prep_kernel_small:
    s_load_dwordx4 s[4:7], s[0:1], 24
    s_load_dwordx4 s[36:39], s[0:1], 40
    s_load_dwordx2 s[30:31], s[0:1], 72
    v_readfirstlane_b32 s20, v0
    s_lshr_b32 s20, s20, 6
    s_lshr_b32 s21, s2, 2
    s_and_b32 s22, s2, 3
    v_and_b32 v1, 63, v0
    v_lshrrev_b32 v2, 5, v1
    v_and_b32 v3, 31, v1
    v_lshlrev_b32 v5, 12, v2
    v_lshl_add_u32 v5, v3, 2, v5
    s_lshl_b32 s23, s20, 15
    s_lshl_b32 s24, s22, 7
    s_add_u32 s23, s23, s24
    s_mov_b32 s32, 0x05040100
    s_mov_b32 s33, 0x07060302
    s_waitcnt lgkmcnt(0)
    s_cmp_eq_u32 s21, 1
    s_cselect_b32 s8, s38, s6
    s_cselect_b32 s9, s39, s7
    s_cmp_eq_u32 s21, 2
    s_cselect_b32 s8, s36, s8
    s_cselect_b32 s9, s37, s9
    s_mov_b32 s10, 131072
    s_mov_b32 s11, 0x00020000
    buffer_load_dword v16, v5, s[8:11], s23 offen offset:0
    buffer_load_dword v17, v5, s[8:11], s23 offen offset:512
    buffer_load_dword v18, v5, s[8:11], s23 offen offset:1024
    buffer_load_dword v19, v5, s[8:11], s23 offen offset:1536
    buffer_load_dword v20, v5, s[8:11], s23 offen offset:2048
    buffer_load_dword v21, v5, s[8:11], s23 offen offset:2560
    buffer_load_dword v22, v5, s[8:11], s23 offen offset:3072
    buffer_load_dword v23, v5, s[8:11], s23 offen offset:3584
    s_add_u32 s23, s23, 8192
    buffer_load_dword v24, v5, s[8:11], s23 offen offset:0
    buffer_load_dword v25, v5, s[8:11], s23 offen offset:512
    buffer_load_dword v26, v5, s[8:11], s23 offen offset:1024
    buffer_load_dword v27, v5, s[8:11], s23 offen offset:1536
    buffer_load_dword v28, v5, s[8:11], s23 offen offset:2048
    buffer_load_dword v29, v5, s[8:11], s23 offen offset:2560
    buffer_load_dword v30, v5, s[8:11], s23 offen offset:3072
    buffer_load_dword v31, v5, s[8:11], s23 offen offset:3584
    s_add_u32 s23, s23, 8192
    buffer_load_dword v32, v5, s[8:11], s23 offen offset:0
    buffer_load_dword v33, v5, s[8:11], s23 offen offset:512
    buffer_load_dword v34, v5, s[8:11], s23 offen offset:1024
    buffer_load_dword v35, v5, s[8:11], s23 offen offset:1536
    buffer_load_dword v36, v5, s[8:11], s23 offen offset:2048
    buffer_load_dword v37, v5, s[8:11], s23 offen offset:2560
    buffer_load_dword v38, v5, s[8:11], s23 offen offset:3072
    buffer_load_dword v39, v5, s[8:11], s23 offen offset:3584
    s_add_u32 s23, s23, 8192
    buffer_load_dword v40, v5, s[8:11], s23 offen offset:0
    buffer_load_dword v41, v5, s[8:11], s23 offen offset:512
    buffer_load_dword v42, v5, s[8:11], s23 offen offset:1024
    buffer_load_dword v43, v5, s[8:11], s23 offen offset:1536
    buffer_load_dword v44, v5, s[8:11], s23 offen offset:2048
    buffer_load_dword v45, v5, s[8:11], s23 offen offset:2560
    buffer_load_dword v46, v5, s[8:11], s23 offen offset:3072
    buffer_load_dword v47, v5, s[8:11], s23 offen offset:3584
    s_mov_b32 s16, s4
    s_mov_b32 s17, s5
    s_mov_b32 s18, 8192
    s_mov_b32 s19, 0x00020000
    v_lshlrev_b32 v6, 9, v3
    v_lshl_add_u32 v6, v2, 4, v6
    s_lshl_b32 s24, s20, 7
    buffer_load_dwordx4 v[80:83], v6, s[16:19], s24 offen offset:0
    buffer_load_dwordx4 v[84:87], v6, s[16:19], s24 offen offset:32
    buffer_load_dwordx4 v[88:91], v6, s[16:19], s24 offen offset:64
    buffer_load_dwordx4 v[92:95], v6, s[16:19], s24 offen offset:96
    s_lshl_b32 s24, s21, 17
    s_add_u32 s24, s24, 44040192
    s_add_u32 s12, s30, s24
    s_addc_u32 s13, s31, 0
    s_mov_b32 s14, 131072
    s_mov_b32 s15, 0x00020000
    s_waitcnt vmcnt(0)
    v_perm_b32 v48, v17, v16, s32
    v_perm_b32 v49, v19, v18, s32
    v_perm_b32 v50, v21, v20, s32
    v_perm_b32 v51, v23, v22, s32
    v_perm_b32 v52, v17, v16, s33
    v_perm_b32 v53, v19, v18, s33
    v_perm_b32 v54, v21, v20, s33
    v_perm_b32 v55, v23, v22, s33
    v_perm_b32 v56, v25, v24, s32
    v_perm_b32 v57, v27, v26, s32
    v_perm_b32 v58, v29, v28, s32
    v_perm_b32 v59, v31, v30, s32
    v_perm_b32 v60, v25, v24, s33
    v_perm_b32 v61, v27, v26, s33
    v_perm_b32 v62, v29, v28, s33
    v_perm_b32 v63, v31, v30, s33
    v_perm_b32 v64, v33, v32, s32
    v_perm_b32 v65, v35, v34, s32
    v_perm_b32 v66, v37, v36, s32
    v_perm_b32 v67, v39, v38, s32
    v_perm_b32 v68, v33, v32, s33
    v_perm_b32 v69, v35, v34, s33
    v_perm_b32 v70, v37, v36, s33
    v_perm_b32 v71, v39, v38, s33
    v_perm_b32 v72, v41, v40, s32
    v_perm_b32 v73, v43, v42, s32
    v_perm_b32 v74, v45, v44, s32
    v_perm_b32 v75, v47, v46, s32
    v_perm_b32 v76, v41, v40, s33
    v_perm_b32 v77, v43, v42, s33
    v_perm_b32 v78, v45, v44, s33
    v_perm_b32 v79, v47, v46, s33
    s_cmp_eq_u32 s21, 2
    s_cbranch_scc1 L_prep_kernel_ge
    v_lshlrev_b32 v4, 4, v1
    s_lshl_b32 s24, s22, 15
    s_lshl_b32 s25, s20, 13
    s_add_u32 s24, s24, s25
    s_add_u32 s25, s24, 4096
    buffer_store_dwordx4 v[48:51], v4, s[12:15], s24 offen offset:0
    buffer_store_dwordx4 v[52:55], v4, s[12:15], s24 offen offset:1024
    buffer_store_dwordx4 v[56:59], v4, s[12:15], s24 offen offset:2048
    buffer_store_dwordx4 v[60:63], v4, s[12:15], s24 offen offset:3072
    buffer_store_dwordx4 v[64:67], v4, s[12:15], s25 offen offset:0
    buffer_store_dwordx4 v[68:71], v4, s[12:15], s25 offen offset:1024
    buffer_store_dwordx4 v[72:75], v4, s[12:15], s25 offen offset:2048
    buffer_store_dwordx4 v[76:79], v4, s[12:15], s25 offen offset:3072
    s_endpgm
L_prep_kernel_ge:
    v_mfma_f32_32x32x16_bf16 v[96:111], v[48:51], v[80:83], 0
    v_mfma_f32_32x32x16_bf16 v[112:127], v[52:55], v[80:83], 0
    v_mfma_f32_32x32x16_bf16 v[96:111], v[56:59], v[84:87], v[96:111]
    v_mfma_f32_32x32x16_bf16 v[112:127], v[60:63], v[84:87], v[112:127]
    v_mfma_f32_32x32x16_bf16 v[96:111], v[64:67], v[88:91], v[96:111]
    v_mfma_f32_32x32x16_bf16 v[112:127], v[68:71], v[88:91], v[112:127]
    v_mfma_f32_32x32x16_bf16 v[96:111], v[72:75], v[92:95], v[96:111]
    v_mfma_f32_32x32x16_bf16 v[112:127], v[76:79], v[92:95], v[112:127]
    v_lshlrev_b32 v4, 4, v1
    s_lshl_b32 s24, s20, 13
    v_add_u32 v7, s24, v4
    s_nop 15
    ds_write_b128 v7, v[96:99] offset:0
    ds_write_b128 v7, v[100:103] offset:1024
    ds_write_b128 v7, v[104:107] offset:2048
    ds_write_b128 v7, v[108:111] offset:3072
    ds_write_b128 v7, v[112:115] offset:4096
    ds_write_b128 v7, v[116:119] offset:5120
    ds_write_b128 v7, v[120:123] offset:6144
    ds_write_b128 v7, v[124:127] offset:7168
    s_waitcnt lgkmcnt(0)
    s_barrier
    s_lshl_b32 s24, s20, 10
    v_add_u32 v7, s24, v4
    ds_read_b128 v[16:19], v7 offset:0
    ds_read_b128 v[20:23], v7 offset:4096
    ds_read_b128 v[24:27], v7 offset:8192
    ds_read_b128 v[28:31], v7 offset:12288
    ds_read_b128 v[32:35], v7 offset:16384
    ds_read_b128 v[36:39], v7 offset:20480
    ds_read_b128 v[40:43], v7 offset:24576
    ds_read_b128 v[44:47], v7 offset:28672
    s_mov_b32 s14, 16384
    v_lshlrev_b32 v8, 10, v3
    v_lshl_add_u32 v8, v2, 5, v8
    s_lshl_b32 s24, s22, 8
    s_lshl_b32 s25, s20, 6
    s_add_u32 s24, s24, s25
    s_mov_b32 s34, 0xffff0000
    s_mov_b32 s35, 0x4038aa3b
    s_waitcnt lgkmcnt(0)
    v_add_f32 v16, v16, v24
    v_add_f32 v16, v16, v32
    v_add_f32 v16, v16, v40
    v_add_f32 v17, v17, v25
    v_add_f32 v17, v17, v33
    v_add_f32 v17, v17, v41
    v_add_f32 v18, v18, v26
    v_add_f32 v18, v18, v34
    v_add_f32 v18, v18, v42
    v_add_f32 v19, v19, v27
    v_add_f32 v19, v19, v35
    v_add_f32 v19, v19, v43
    v_add_f32 v20, v20, v28
    v_add_f32 v20, v20, v36
    v_add_f32 v20, v20, v44
    v_add_f32 v21, v21, v29
    v_add_f32 v21, v21, v37
    v_add_f32 v21, v21, v45
    v_add_f32 v22, v22, v30
    v_add_f32 v22, v22, v38
    v_add_f32 v22, v22, v46
    v_add_f32 v23, v23, v31
    v_add_f32 v23, v23, v39
    v_add_f32 v23, v23, v47
    v_cvt_pk_bf16_f32 v48, v16, v20
    v_cvt_pk_bf16_f32 v49, v17, v21
    v_cvt_pk_bf16_f32 v50, v18, v22
    v_cvt_pk_bf16_f32 v51, v19, v23
    v_lshlrev_b32 v56, 16, v48
    v_and_b32 v57, s34, v48
    v_lshlrev_b32 v58, 16, v49
    v_and_b32 v59, s34, v49
    v_lshlrev_b32 v60, 16, v50
    v_and_b32 v61, s34, v50
    v_lshlrev_b32 v62, 16, v51
    v_and_b32 v63, s34, v51
    v_mul_f32 v56, s35, v56
    v_mul_f32 v57, s35, v57
    v_mul_f32 v58, s35, v58
    v_mul_f32 v59, s35, v59
    v_mul_f32 v60, s35, v60
    v_mul_f32 v61, s35, v61
    v_mul_f32 v62, s35, v62
    v_mul_f32 v63, s35, v63
    buffer_store_dwordx4 v[56:59], v8, s[12:15], s24 offen
    buffer_store_dwordx4 v[60:63], v8, s[12:15], s24 offen offset:16
    v_exp_f32 v64, v56
    v_exp_f32 v65, v57
    v_exp_f32 v66, v58
    v_exp_f32 v67, v59
    v_exp_f32 v68, v60
    v_exp_f32 v69, v61
    v_exp_f32 v70, v62
    v_exp_f32 v71, v63
    v_max3_f32 v72, |v56|, |v57|, |v58|
    v_max3_f32 v72, |v59|, |v60|, v72
    v_max3_f32 v72, |v61|, |v62|, v72
    v_max_f32 v72, |v63|, v72
    s_add_u32 s12, s12, 16384
    s_addc_u32 s13, s13, 0
    v_cmp_lt_f32 vcc, 0x42f00000, v72
    buffer_store_dwordx4 v[64:67], v8, s[12:15], s24 offen
    buffer_store_dwordx4 v[68:71], v8, s[12:15], s24 offen offset:16
    s_add_u32 s12, s12, 16384
    s_addc_u32 s13, s13, 0
    s_or_b32 s26, vcc_lo, vcc_hi
    s_lshr_b32 s24, s24, 4
    v_mov_b32 v73, s26
    v_mov_b32 v74, 0
    buffer_store_dword v73, v74, s[12:15], s24 offen
    s_endpgm
.globl conv1_kernel
.p2align 8
.type conv1_kernel,@function
conv1_kernel:
    s_cmp_ge_u32 s2, 256
    s_cbranch_scc1 L_conv1_kernel_done
    s_load_dwordx2 s[4:5], s[0:1], 0
    s_load_dwordx2 s[30:31], s[0:1], 72
    v_readfirstlane_b32 s20, v0
    s_lshr_b32 s20, s20, 6
    s_and_b32 s36, s2, 1
    s_lshl_b32 s36, s36, 2
    s_bfe_u32 s37, s2, 131075
    s_or_b32 s29, s36, s37
    s_bfe_u32 s36, s2, 131073
    s_lshl_b32 s36, s36, 3
    s_lshr_b32 s37, s2, 5
    s_or_b32 s36, s36, s37
    s_mov_b32 s33, 0
    s_and_b32 s34, s36, 15
    s_lshr_b32 s35, s36, 4
    s_mul_i32 s21, s34, 500
    s_and_b32 s32, s20, 3
    v_and_b32 v127, 63, v0
    v_lshrrev_b32 v5, 2, v127
    v_and_b32 v6, 3, v127
    v_lshlrev_b32 v7, 15, v5
    v_lshl_add_u32 v7, v6, 4, v7
    s_lshl_b32 s41, s21, 10
    s_lshl_b32 s37, s33, 9
    s_add_u32 s41, s41, s37
    s_sub_u32 s41, s41, 7680
    s_and_b32 s42, s20, 7
    s_lshl_b32 s37, s42, 12
    s_add_u32 s37, s37, s41
    v_add_u32 v7, s37, v7
    s_mul_i32 s36, s35, 8192000
    s_mov_b32 s10, 8192000
    s_mov_b32 s11, 0x00020000
    s_mov_b32 s25, 0xffff0000
    s_waitcnt lgkmcnt(0)
    s_add_u32 s8, s4, s36
    s_addc_u32 s9, s5, 0
    s_cmp_ge_u32 s20, 8
    s_cbranch_scc1 L_conv1_kernel_helper
    s_add_u32 s37, s41, 524288
    v_lshl_add_u32 v108, v127, 4, s37
    s_lshl_b32 s36, s29, 4
    s_lshl_b32 s37, s33, 3
    s_add_u32 s36, s36, s37
    s_mul_i32 s36, s36, 57344
    s_add_u32 s36, s36, 0
    s_add_u32 s12, s30, s36
    s_addc_u32 s13, s31, 0
    s_mov_b32 s14, 917504
    s_mov_b32 s15, 0x00020000
    s_mul_i32 s36, s35, 4096000
    s_add_u32 s36, s36, 18874368
    s_add_u32 s16, s30, s36
    s_addc_u32 s17, s31, 0
    s_mov_b32 s18, 4096000
    s_mov_b32 s19, 0x00020000
    v_and_b32 v10, 15, v127
    v_lshrrev_b32 v11, 4, v127
    v_add_u32 v8, 0, v10
    v_and_b32 v16, 4, v8
    v_lshrrev_b32 v16, 1, v16
    v_xor_b32 v16, v11, v16
    v_lshlrev_b32 v16, 4, v16
    v_lshl_add_u32 v8, v8, 6, v16
    v_add_u32 v9, 1, v10
    v_and_b32 v16, 4, v9
    v_lshrrev_b32 v16, 1, v16
    v_xor_b32 v16, v11, v16
    v_lshlrev_b32 v16, 4, v16
    v_lshl_add_u32 v9, v9, 6, v16
    s_lshr_b32 s38, s32, 1
    s_and_b32 s39, s32, 1
    s_add_u32 s40, s38, 4
    s_lshl_b32 s43, s39, 10
    s_cmp_lt_u32 s20, 4
    s_cselect_b32 s40, s20, s40
    s_cselect_b32 s36, 0, s43
    s_lshl_b32 s37, s40, 13
    s_add_u32 s37, s37, s36
    v_lshl_add_u32 v125, v127, 4, s37
    s_mul_i32 s37, s40, 16384
    v_add_u32 v120, s37, v8
    v_add_u32 v121, s37, v9
    s_lshl_b32 s37, s40, 10
    s_add_u32 s37, s37, 115712
    v_lshl_add_u32 v16, v11, 4, s37
    v_cmp_eq_u32 vcc, 15, v10
    v_mov_b32 v17, 8192
    v_mov_b32 v18, 4294959104
    v_mov_b32 v19, 64
    v_cndmask_b32 v122, v121, v16, vcc
    v_cndmask_b32 v123, v17, v19, vcc
    v_cndmask_b32 v124, v18, v19, vcc
    v_lshl_add_u32 v126, v127, 4, s37
    s_mov_b32 s44, 0x3f800000
    s_mov_b32 s45, 0x00000000
    s_mov_b32 s46, 0x00000000
    s_cmp_eq_u32 s40, 1
    s_cselect_b32 s45, 0x3f800000, s45
    s_cselect_b32 s46, 0x3f800000, s46
    s_cmp_eq_u32 s40, 2
    s_cselect_b32 s45, 0xbf800000, s45
    s_cselect_b32 s46, 0x3f800000, s46
    s_cmp_eq_u32 s40, 3
    s_cselect_b32 s45, 0x40000000, s45
    s_cselect_b32 s46, 0x40800000, s46
    s_cmp_eq_u32 s40, 4
    s_cselect_b32 s45, 0xc0000000, s45
    s_cselect_b32 s46, 0x40800000, s46
    s_cmp_eq_u32 s40, 5
    s_cselect_b32 s44, 0x41800000, s44
    s_cselect_b32 s45, 0x41000000, s45
    s_cselect_b32 s46, 0x40800000, s46
    s_cmp_ge_u32 s20, 4
    s_cbranch_scc1 L_conv1_kernel_m2
    v_mov_b32 v0, 0
    v_mov_b32 v1, 0
    v_mov_b32 v2, 0
    v_mov_b32 v3, 0
    v_mov_b32 v4, 0
    v_mov_b32 v5, 0
    v_mov_b32 v6, 0
    v_mov_b32 v7, 0
    v_mov_b32 v8, 0
    v_mov_b32 v9, 0
    v_mov_b32 v10, 0
    v_mov_b32 v11, 0
    v_mov_b32 v12, 0
    v_mov_b32 v13, 0
    v_mov_b32 v14, 0
    v_mov_b32 v15, 0
    v_mov_b32 v16, 0
    v_mov_b32 v17, 0
    v_mov_b32 v18, 0
    v_mov_b32 v19, 0
    v_mov_b32 v20, 0
    v_mov_b32 v21, 0
    v_mov_b32 v22, 0
    v_mov_b32 v23, 0
    v_mov_b32 v24, 0
    v_mov_b32 v25, 0
    v_mov_b32 v26, 0
    v_mov_b32 v27, 0
    v_mov_b32 v28, 0
    v_mov_b32 v29, 0
    v_mov_b32 v30, 0
    v_mov_b32 v31, 0
    v_mov_b32 v32, 0
    v_mov_b32 v33, 0
    v_mov_b32 v34, 0
    v_mov_b32 v35, 0
    v_mov_b32 v36, 0
    v_mov_b32 v37, 0
    v_mov_b32 v38, 0
    v_mov_b32 v39, 0
    v_mov_b32 v40, 0
    v_mov_b32 v41, 0
    v_mov_b32 v42, 0
    v_mov_b32 v43, 0
    v_mov_b32 v44, 0
    v_mov_b32 v45, 0
    v_mov_b32 v46, 0
    v_mov_b32 v47, 0
    v_mov_b32 v48, 0
    v_mov_b32 v49, 0
    v_mov_b32 v50, 0
    v_mov_b32 v51, 0
    v_mov_b32 v52, 0
    v_mov_b32 v53, 0
    v_mov_b32 v54, 0
    v_mov_b32 v55, 0
    v_mov_b32 v56, 0
    v_mov_b32 v57, 0
    v_mov_b32 v58, 0
    v_mov_b32 v59, 0
    v_mov_b32 v60, 0
    v_mov_b32 v61, 0
    v_mov_b32 v62, 0
    v_mov_b32 v63, 0
    s_barrier
    buffer_load_dwordx4 v[96:99], v108, s[8:11], 0 offen offset:0
    buffer_load_dwordx4 v[100:103], v108, s[8:11], 0 offen offset:1024
    buffer_load_dwordx4 v[104:107], v108, s[8:11], 0 offen offset:2048
    s_mov_b32 s23, 0
    s_mov_b32 s26, 4096
    buffer_load_dwordx4 v[64:67], v125, s[12:15], s23 offen offset:0
    buffer_load_dwordx4 v[68:71], v125, s[12:15], s23 offen offset:1024
    buffer_load_dwordx4 v[72:75], v125, s[12:15], s23 offen offset:2048
    buffer_load_dwordx4 v[76:79], v125, s[12:15], s23 offen offset:3072
    buffer_load_dwordx4 v[80:83], v125, s[12:15], s26 offen offset:0
    buffer_load_dwordx4 v[84:87], v125, s[12:15], s26 offen offset:1024
    buffer_load_dwordx4 v[88:91], v125, s[12:15], s26 offen offset:2048
    buffer_load_dwordx4 v[92:95], v125, s[12:15], s26 offen offset:3072
    s_mov_b32 s23, 57344
    s_mov_b32 s26, 61440
    s_waitcnt vmcnt(8)
    v_lshlrev_b32 v108, 16, v96
    v_and_b32 v111, s25, v96
    v_lshlrev_b32 v109, 16, v100
    v_and_b32 v112, s25, v100
    v_lshlrev_b32 v110, 16, v104
    v_and_b32 v113, s25, v104
    v_mul_f32 v114, s44, v108
    v_mul_f32 v115, s44, v111
    v_fmac_f32 v114, s45, v109
    v_fmac_f32 v115, s45, v112
    v_fmac_f32 v114, s46, v110
    v_fmac_f32 v115, s46, v113
    v_cvt_pk_bf16_f32 v96, v114, v115
    v_lshlrev_b32 v108, 16, v97
    v_and_b32 v111, s25, v97
    v_lshlrev_b32 v109, 16, v101
    v_and_b32 v112, s25, v101
    v_lshlrev_b32 v110, 16, v105
    v_and_b32 v113, s25, v105
    v_mul_f32 v114, s44, v108
    v_mul_f32 v115, s44, v111
    v_fmac_f32 v114, s45, v109
    v_fmac_f32 v115, s45, v112
    v_fmac_f32 v114, s46, v110
    v_fmac_f32 v115, s46, v113
    v_cvt_pk_bf16_f32 v97, v114, v115
    v_lshlrev_b32 v108, 16, v98
    v_and_b32 v111, s25, v98
    v_lshlrev_b32 v109, 16, v102
    v_and_b32 v112, s25, v102
    v_lshlrev_b32 v110, 16, v106
    v_and_b32 v113, s25, v106
    v_mul_f32 v114, s44, v108
    v_mul_f32 v115, s44, v111
    v_fmac_f32 v114, s45, v109
    v_fmac_f32 v115, s45, v112
    v_fmac_f32 v114, s46, v110
    v_fmac_f32 v115, s46, v113
    v_cvt_pk_bf16_f32 v98, v114, v115
    v_lshlrev_b32 v108, 16, v99
    v_and_b32 v111, s25, v99
    v_lshlrev_b32 v109, 16, v103
    v_and_b32 v112, s25, v103
    v_lshlrev_b32 v110, 16, v107
    v_and_b32 v113, s25, v107
    v_mul_f32 v114, s44, v108
    v_mul_f32 v115, s44, v111
    v_fmac_f32 v114, s45, v109
    v_fmac_f32 v115, s45, v112
    v_fmac_f32 v114, s46, v110
    v_fmac_f32 v115, s46, v113
    v_cvt_pk_bf16_f32 v99, v114, v115
    ds_write_b128 v126, v[96:99]
    s_waitcnt lgkmcnt(0)
    s_barrier
    s_mov_b32 s22, 8
    s_setprio 2
L_conv1_kernel_mloop1:
    ds_read_b128 v[96:99], v120 offset:0
    ds_read_b128 v[100:103], v120 offset:1024
    ds_read_b128 v[104:107], v120 offset:2048
    ds_read_b128 v[108:111], v120 offset:3072
    ds_read_b128 v[112:115], v120 offset:4096
    ds_read_b128 v[116:119], v120 offset:5120
    s_waitcnt vmcnt(6) lgkmcnt(5)
    v_mfma_f32_16x16x32_bf16 v[0:3], v[64:67], v[96:99], v[0:3]
    v_mfma_f32_16x16x32_bf16 v[32:35], v[68:71], v[96:99], v[32:35]
    ds_read_b128 v[96:99], v120 offset:6144
    s_waitcnt vmcnt(4) lgkmcnt(5)
    v_mfma_f32_16x16x32_bf16 v[4:7], v[64:67], v[100:103], v[4:7]
    v_mfma_f32_16x16x32_bf16 v[36:39], v[68:71], v[100:103], v[36:39]
    v_mfma_f32_16x16x32_bf16 v[0:3], v[72:75], v[100:103], v[0:3]
    v_mfma_f32_16x16x32_bf16 v[32:35], v[76:79], v[100:103], v[32:35]
    ds_read_b128 v[100:103], v120 offset:7168
    s_waitcnt vmcnt(2) lgkmcnt(5)
    v_mfma_f32_16x16x32_bf16 v[8:11], v[64:67], v[104:107], v[8:11]
    v_mfma_f32_16x16x32_bf16 v[40:43], v[68:71], v[104:107], v[40:43]
    v_mfma_f32_16x16x32_bf16 v[4:7], v[72:75], v[104:107], v[4:7]
    v_mfma_f32_16x16x32_bf16 v[36:39], v[76:79], v[104:107], v[36:39]
    v_mfma_f32_16x16x32_bf16 v[0:3], v[80:83], v[104:107], v[0:3]
    v_mfma_f32_16x16x32_bf16 v[32:35], v[84:87], v[104:107], v[32:35]
    ds_read_b128 v[104:107], v122 offset:0
    v_add_u32 v122, v123, v122
    s_waitcnt vmcnt(0) lgkmcnt(5)
    v_mfma_f32_16x16x32_bf16 v[12:15], v[64:67], v[108:111], v[12:15]
    v_mfma_f32_16x16x32_bf16 v[44:47], v[68:71], v[108:111], v[44:47]
    v_mfma_f32_16x16x32_bf16 v[8:11], v[72:75], v[108:111], v[8:11]
    v_mfma_f32_16x16x32_bf16 v[40:43], v[76:79], v[108:111], v[40:43]
    v_mfma_f32_16x16x32_bf16 v[4:7], v[80:83], v[108:111], v[4:7]
    v_mfma_f32_16x16x32_bf16 v[36:39], v[84:87], v[108:111], v[36:39]
    v_mfma_f32_16x16x32_bf16 v[0:3], v[88:91], v[108:111], v[0:3]
    v_mfma_f32_16x16x32_bf16 v[32:35], v[92:95], v[108:111], v[32:35]
    ds_read_b128 v[108:111], v121 offset:1024
    s_waitcnt lgkmcnt(5)
    v_mfma_f32_16x16x32_bf16 v[16:19], v[64:67], v[112:115], v[16:19]
    v_mfma_f32_16x16x32_bf16 v[48:51], v[68:71], v[112:115], v[48:51]
    v_mfma_f32_16x16x32_bf16 v[12:15], v[72:75], v[112:115], v[12:15]
    v_mfma_f32_16x16x32_bf16 v[44:47], v[76:79], v[112:115], v[44:47]
    v_mfma_f32_16x16x32_bf16 v[8:11], v[80:83], v[112:115], v[8:11]
    v_mfma_f32_16x16x32_bf16 v[40:43], v[84:87], v[112:115], v[40:43]
    v_mfma_f32_16x16x32_bf16 v[4:7], v[88:91], v[112:115], v[4:7]
    v_mfma_f32_16x16x32_bf16 v[36:39], v[92:95], v[112:115], v[36:39]
    ds_read_b128 v[112:115], v121 offset:2048
    s_waitcnt lgkmcnt(5)
    v_mfma_f32_16x16x32_bf16 v[20:23], v[64:67], v[116:119], v[20:23]
    v_mfma_f32_16x16x32_bf16 v[52:55], v[68:71], v[116:119], v[52:55]
    v_mfma_f32_16x16x32_bf16 v[16:19], v[72:75], v[116:119], v[16:19]
    v_mfma_f32_16x16x32_bf16 v[48:51], v[76:79], v[116:119], v[48:51]
    v_mfma_f32_16x16x32_bf16 v[12:15], v[80:83], v[116:119], v[12:15]
    v_mfma_f32_16x16x32_bf16 v[44:47], v[84:87], v[116:119], v[44:47]
    v_mfma_f32_16x16x32_bf16 v[8:11], v[88:91], v[116:119], v[8:11]
    v_mfma_f32_16x16x32_bf16 v[40:43], v[92:95], v[116:119], v[40:43]
    s_waitcnt lgkmcnt(4)
    v_mfma_f32_16x16x32_bf16 v[24:27], v[64:67], v[96:99], v[24:27]
    v_mfma_f32_16x16x32_bf16 v[56:59], v[68:71], v[96:99], v[56:59]
    v_mfma_f32_16x16x32_bf16 v[20:23], v[72:75], v[96:99], v[20:23]
    v_mfma_f32_16x16x32_bf16 v[52:55], v[76:79], v[96:99], v[52:55]
    v_mfma_f32_16x16x32_bf16 v[16:19], v[80:83], v[96:99], v[16:19]
    v_mfma_f32_16x16x32_bf16 v[48:51], v[84:87], v[96:99], v[48:51]
    v_mfma_f32_16x16x32_bf16 v[12:15], v[88:91], v[96:99], v[12:15]
    v_mfma_f32_16x16x32_bf16 v[44:47], v[92:95], v[96:99], v[44:47]
    s_waitcnt lgkmcnt(3)
    v_mfma_f32_16x16x32_bf16 v[28:31], v[64:67], v[100:103], v[28:31]
    v_mfma_f32_16x16x32_bf16 v[60:63], v[68:71], v[100:103], v[60:63]
    v_mfma_f32_16x16x32_bf16 v[24:27], v[72:75], v[100:103], v[24:27]
    v_mfma_f32_16x16x32_bf16 v[56:59], v[76:79], v[100:103], v[56:59]
    v_mfma_f32_16x16x32_bf16 v[20:23], v[80:83], v[100:103], v[20:23]
    v_mfma_f32_16x16x32_bf16 v[52:55], v[84:87], v[100:103], v[52:55]
    v_mfma_f32_16x16x32_bf16 v[16:19], v[88:91], v[100:103], v[16:19]
    v_mfma_f32_16x16x32_bf16 v[48:51], v[92:95], v[100:103], v[48:51]
    buffer_load_dwordx4 v[64:67], v125, s[12:15], s23 offen offset:0
    buffer_load_dwordx4 v[68:71], v125, s[12:15], s23 offen offset:1024
    s_waitcnt lgkmcnt(2)
    v_mfma_f32_16x16x32_bf16 v[28:31], v[72:75], v[104:107], v[28:31]
    v_mfma_f32_16x16x32_bf16 v[60:63], v[76:79], v[104:107], v[60:63]
    v_mfma_f32_16x16x32_bf16 v[24:27], v[80:83], v[104:107], v[24:27]
    v_mfma_f32_16x16x32_bf16 v[56:59], v[84:87], v[104:107], v[56:59]
    v_mfma_f32_16x16x32_bf16 v[20:23], v[88:91], v[104:107], v[20:23]
    v_mfma_f32_16x16x32_bf16 v[52:55], v[92:95], v[104:107], v[52:55]
    buffer_load_dwordx4 v[72:75], v125, s[12:15], s23 offen offset:2048
    buffer_load_dwordx4 v[76:79], v125, s[12:15], s23 offen offset:3072
    s_waitcnt lgkmcnt(1)
    v_mfma_f32_16x16x32_bf16 v[28:31], v[80:83], v[108:111], v[28:31]
    v_mfma_f32_16x16x32_bf16 v[60:63], v[84:87], v[108:111], v[60:63]
    v_mfma_f32_16x16x32_bf16 v[24:27], v[88:91], v[108:111], v[24:27]
    v_mfma_f32_16x16x32_bf16 v[56:59], v[92:95], v[108:111], v[56:59]
    buffer_load_dwordx4 v[80:83], v125, s[12:15], s26 offen offset:0
    buffer_load_dwordx4 v[84:87], v125, s[12:15], s26 offen offset:1024
    s_waitcnt lgkmcnt(0)
    v_mfma_f32_16x16x32_bf16 v[28:31], v[88:91], v[112:115], v[28:31]
    v_mfma_f32_16x16x32_bf16 v[60:63], v[92:95], v[112:115], v[60:63]
    buffer_load_dwordx4 v[88:91], v125, s[12:15], s26 offen offset:2048
    buffer_load_dwordx4 v[92:95], v125, s[12:15], s26 offen offset:3072
    s_add_u32 s23, s23, 57344
    s_add_u32 s26, s26, 57344
    s_barrier
    s_sub_u32 s22, s22, 1
    s_cmp_eq_u32 s22, 0
    s_cbranch_scc1 L_conv1_kernel_mlast1
    ds_read_b128 v[96:99], v120 offset:8192
    ds_read_b128 v[100:103], v120 offset:9216
    ds_read_b128 v[104:107], v120 offset:10240
    ds_read_b128 v[108:111], v120 offset:11264
    ds_read_b128 v[112:115], v120 offset:12288
    ds_read_b128 v[116:119], v120 offset:13312
    s_waitcnt vmcnt(6) lgkmcnt(5)
    v_mfma_f32_16x16x32_bf16 v[0:3], v[64:67], v[96:99], v[0:3]
    v_mfma_f32_16x16x32_bf16 v[32:35], v[68:71], v[96:99], v[32:35]
    ds_read_b128 v[96:99], v120 offset:14336
    s_waitcnt vmcnt(4) lgkmcnt(5)
    v_mfma_f32_16x16x32_bf16 v[4:7], v[64:67], v[100:103], v[4:7]
    v_mfma_f32_16x16x32_bf16 v[36:39], v[68:71], v[100:103], v[36:39]
    v_mfma_f32_16x16x32_bf16 v[0:3], v[72:75], v[100:103], v[0:3]
    v_mfma_f32_16x16x32_bf16 v[32:35], v[76:79], v[100:103], v[32:35]
    ds_read_b128 v[100:103], v120 offset:15360
    s_waitcnt vmcnt(2) lgkmcnt(5)
    v_mfma_f32_16x16x32_bf16 v[8:11], v[64:67], v[104:107], v[8:11]
    v_mfma_f32_16x16x32_bf16 v[40:43], v[68:71], v[104:107], v[40:43]
    v_mfma_f32_16x16x32_bf16 v[4:7], v[72:75], v[104:107], v[4:7]
    v_mfma_f32_16x16x32_bf16 v[36:39], v[76:79], v[104:107], v[36:39]
    v_mfma_f32_16x16x32_bf16 v[0:3], v[80:83], v[104:107], v[0:3]
    v_mfma_f32_16x16x32_bf16 v[32:35], v[84:87], v[104:107], v[32:35]
    ds_read_b128 v[104:107], v122 offset:0
    v_add_u32 v122, v124, v122
    s_waitcnt vmcnt(0) lgkmcnt(5)
    v_mfma_f32_16x16x32_bf16 v[12:15], v[64:67], v[108:111], v[12:15]
    v_mfma_f32_16x16x32_bf16 v[44:47], v[68:71], v[108:111], v[44:47]
    v_mfma_f32_16x16x32_bf16 v[8:11], v[72:75], v[108:111], v[8:11]
    v_mfma_f32_16x16x32_bf16 v[40:43], v[76:79], v[108:111], v[40:43]
    v_mfma_f32_16x16x32_bf16 v[4:7], v[80:83], v[108:111], v[4:7]
    v_mfma_f32_16x16x32_bf16 v[36:39], v[84:87], v[108:111], v[36:39]
    v_mfma_f32_16x16x32_bf16 v[0:3], v[88:91], v[108:111], v[0:3]
    v_mfma_f32_16x16x32_bf16 v[32:35], v[92:95], v[108:111], v[32:35]
    ds_read_b128 v[108:111], v121 offset:9216
    s_waitcnt lgkmcnt(5)
    v_mfma_f32_16x16x32_bf16 v[16:19], v[64:67], v[112:115], v[16:19]
    v_mfma_f32_16x16x32_bf16 v[48:51], v[68:71], v[112:115], v[48:51]
    v_mfma_f32_16x16x32_bf16 v[12:15], v[72:75], v[112:115], v[12:15]
    v_mfma_f32_16x16x32_bf16 v[44:47], v[76:79], v[112:115], v[44:47]
    v_mfma_f32_16x16x32_bf16 v[8:11], v[80:83], v[112:115], v[8:11]
    v_mfma_f32_16x16x32_bf16 v[40:43], v[84:87], v[112:115], v[40:43]
    v_mfma_f32_16x16x32_bf16 v[4:7], v[88:91], v[112:115], v[4:7]
    v_mfma_f32_16x16x32_bf16 v[36:39], v[92:95], v[112:115], v[36:39]
    ds_read_b128 v[112:115], v121 offset:10240
    s_waitcnt lgkmcnt(5)
    v_mfma_f32_16x16x32_bf16 v[20:23], v[64:67], v[116:119], v[20:23]
    v_mfma_f32_16x16x32_bf16 v[52:55], v[68:71], v[116:119], v[52:55]
    v_mfma_f32_16x16x32_bf16 v[16:19], v[72:75], v[116:119], v[16:19]
    v_mfma_f32_16x16x32_bf16 v[48:51], v[76:79], v[116:119], v[48:51]
    v_mfma_f32_16x16x32_bf16 v[12:15], v[80:83], v[116:119], v[12:15]
    v_mfma_f32_16x16x32_bf16 v[44:47], v[84:87], v[116:119], v[44:47]
    v_mfma_f32_16x16x32_bf16 v[8:11], v[88:91], v[116:119], v[8:11]
    v_mfma_f32_16x16x32_bf16 v[40:43], v[92:95], v[116:119], v[40:43]
    s_waitcnt lgkmcnt(4)
    v_mfma_f32_16x16x32_bf16 v[24:27], v[64:67], v[96:99], v[24:27]
    v_mfma_f32_16x16x32_bf16 v[56:59], v[68:71], v[96:99], v[56:59]
    v_mfma_f32_16x16x32_bf16 v[20:23], v[72:75], v[96:99], v[20:23]
    v_mfma_f32_16x16x32_bf16 v[52:55], v[76:79], v[96:99], v[52:55]
    v_mfma_f32_16x16x32_bf16 v[16:19], v[80:83], v[96:99], v[16:19]
    v_mfma_f32_16x16x32_bf16 v[48:51], v[84:87], v[96:99], v[48:51]
    v_mfma_f32_16x16x32_bf16 v[12:15], v[88:91], v[96:99], v[12:15]
    v_mfma_f32_16x16x32_bf16 v[44:47], v[92:95], v[96:99], v[44:47]
    s_waitcnt lgkmcnt(3)
    v_mfma_f32_16x16x32_bf16 v[28:31], v[64:67], v[100:103], v[28:31]
    v_mfma_f32_16x16x32_bf16 v[60:63], v[68:71], v[100:103], v[60:63]
    v_mfma_f32_16x16x32_bf16 v[24:27], v[72:75], v[100:103], v[24:27]
    v_mfma_f32_16x16x32_bf16 v[56:59], v[76:79], v[100:103], v[56:59]
    v_mfma_f32_16x16x32_bf16 v[20:23], v[80:83], v[100:103], v[20:23]
    v_mfma_f32_16x16x32_bf16 v[52:55], v[84:87], v[100:103], v[52:55]
    v_mfma_f32_16x16x32_bf16 v[16:19], v[88:91], v[100:103], v[16:19]
    v_mfma_f32_16x16x32_bf16 v[48:51], v[92:95], v[100:103], v[48:51]
    buffer_load_dwordx4 v[64:67], v125, s[12:15], s23 offen offset:0
    buffer_load_dwordx4 v[68:71], v125, s[12:15], s23 offen offset:1024
    s_waitcnt lgkmcnt(2)
    v_mfma_f32_16x16x32_bf16 v[28:31], v[72:75], v[104:107], v[28:31]
    v_mfma_f32_16x16x32_bf16 v[60:63], v[76:79], v[104:107], v[60:63]
    v_mfma_f32_16x16x32_bf16 v[24:27], v[80:83], v[104:107], v[24:27]
    v_mfma_f32_16x16x32_bf16 v[56:59], v[84:87], v[104:107], v[56:59]
    v_mfma_f32_16x16x32_bf16 v[20:23], v[88:91], v[104:107], v[20:23]
    v_mfma_f32_16x16x32_bf16 v[52:55], v[92:95], v[104:107], v[52:55]
    buffer_load_dwordx4 v[72:75], v125, s[12:15], s23 offen offset:2048
    buffer_load_dwordx4 v[76:79], v125, s[12:15], s23 offen offset:3072
    s_waitcnt lgkmcnt(1)
    v_mfma_f32_16x16x32_bf16 v[28:31], v[80:83], v[108:111], v[28:31]
    v_mfma_f32_16x16x32_bf16 v[60:63], v[84:87], v[108:111], v[60:63]
    v_mfma_f32_16x16x32_bf16 v[24:27], v[88:91], v[108:111], v[24:27]
    v_mfma_f32_16x16x32_bf16 v[56:59], v[92:95], v[108:111], v[56:59]
    buffer_load_dwordx4 v[80:83], v125, s[12:15], s26 offen offset:0
    buffer_load_dwordx4 v[84:87], v125, s[12:15], s26 offen offset:1024
    s_waitcnt lgkmcnt(0)
    v_mfma_f32_16x16x32_bf16 v[28:31], v[88:91], v[112:115], v[28:31]
    v_mfma_f32_16x16x32_bf16 v[60:63], v[92:95], v[112:115], v[60:63]
    buffer_load_dwordx4 v[88:91], v125, s[12:15], s26 offen offset:2048
    buffer_load_dwordx4 v[92:95], v125, s[12:15], s26 offen offset:3072
    s_add_u32 s23, s23, 57344
    s_add_u32 s26, s26, 57344
    s_barrier
    s_branch L_conv1_kernel_mloop1
L_conv1_kernel_mlast1:
    v_and_b32 v125, 15, v127
    v_and_b32 v126, 7, v127
    v_lshlrev_b32 v126, 4, v126
    v_lshl_add_u32 v125, v125, 7, v126
    v_lshrrev_b32 v126, 4, v127
    v_lshl_add_u32 v125, v126, 11, v125
    s_lshl_b32 s36, s20, 14
    s_add_u32 s37, s36, 8192
    v_add_u32 v126, s37, v125
    v_add_u32 v125, s36, v125
    ds_read_b128 v[96:99], v120 offset:8192
    ds_read_b128 v[100:103], v120 offset:9216
    ds_read_b128 v[104:107], v120 offset:10240
    ds_read_b128 v[108:111], v120 offset:11264
    ds_read_b128 v[112:115], v120 offset:12288
    ds_read_b128 v[116:119], v120 offset:13312
    s_waitcnt vmcnt(6) lgkmcnt(5)
    v_mfma_f32_16x16x32_bf16 v[0:3], v[64:67], v[96:99], v[0:3]
    v_mfma_f32_16x16x32_bf16 v[32:35], v[68:71], v[96:99], v[32:35]
    ds_read_b128 v[96:99], v120 offset:14336
    s_waitcnt vmcnt(4) lgkmcnt(5)
    v_mfma_f32_16x16x32_bf16 v[4:7], v[64:67], v[100:103], v[4:7]
    v_mfma_f32_16x16x32_bf16 v[36:39], v[68:71], v[100:103], v[36:39]
    v_mfma_f32_16x16x32_bf16 v[0:3], v[72:75], v[100:103], v[0:3]
    v_mfma_f32_16x16x32_bf16 v[32:35], v[76:79], v[100:103], v[32:35]
    ds_read_b128 v[100:103], v120 offset:15360
    s_waitcnt vmcnt(2) lgkmcnt(5)
    v_mfma_f32_16x16x32_bf16 v[8:11], v[64:67], v[104:107], v[8:11]
    v_mfma_f32_16x16x32_bf16 v[40:43], v[68:71], v[104:107], v[40:43]
    v_mfma_f32_16x16x32_bf16 v[4:7], v[72:75], v[104:107], v[4:7]
    v_mfma_f32_16x16x32_bf16 v[36:39], v[76:79], v[104:107], v[36:39]
    v_mfma_f32_16x16x32_bf16 v[0:3], v[80:83], v[104:107], v[0:3]
    v_mfma_f32_16x16x32_bf16 v[32:35], v[84:87], v[104:107], v[32:35]
    ds_read_b128 v[104:107], v122 offset:0
    s_waitcnt vmcnt(0) lgkmcnt(5)
    v_mfma_f32_16x16x32_bf16 v[12:15], v[64:67], v[108:111], v[12:15]
    v_mfma_f32_16x16x32_bf16 v[44:47], v[68:71], v[108:111], v[44:47]
    v_mfma_f32_16x16x32_bf16 v[8:11], v[72:75], v[108:111], v[8:11]
    v_mfma_f32_16x16x32_bf16 v[40:43], v[76:79], v[108:111], v[40:43]
    v_mfma_f32_16x16x32_bf16 v[4:7], v[80:83], v[108:111], v[4:7]
    v_mfma_f32_16x16x32_bf16 v[36:39], v[84:87], v[108:111], v[36:39]
    v_mfma_f32_16x16x32_bf16 v[0:3], v[88:91], v[108:111], v[0:3]
    v_mfma_f32_16x16x32_bf16 v[32:35], v[92:95], v[108:111], v[32:35]
    ds_read_b128 v[108:111], v121 offset:9216
    s_waitcnt lgkmcnt(5)
    v_mfma_f32_16x16x32_bf16 v[16:19], v[64:67], v[112:115], v[16:19]
    v_mfma_f32_16x16x32_bf16 v[48:51], v[68:71], v[112:115], v[48:51]
    v_mfma_f32_16x16x32_bf16 v[12:15], v[72:75], v[112:115], v[12:15]
    v_mfma_f32_16x16x32_bf16 v[44:47], v[76:79], v[112:115], v[44:47]
    v_mfma_f32_16x16x32_bf16 v[8:11], v[80:83], v[112:115], v[8:11]
    v_mfma_f32_16x16x32_bf16 v[40:43], v[84:87], v[112:115], v[40:43]
    v_mfma_f32_16x16x32_bf16 v[4:7], v[88:91], v[112:115], v[4:7]
    v_mfma_f32_16x16x32_bf16 v[36:39], v[92:95], v[112:115], v[36:39]
    ds_read_b128 v[112:115], v121 offset:10240
    v_xor_b32 v123, 0, v125
    ds_write_b128 v123, v[0:3]
    s_waitcnt lgkmcnt(6)
    v_mfma_f32_16x16x32_bf16 v[20:23], v[64:67], v[116:119], v[20:23]
    v_mfma_f32_16x16x32_bf16 v[52:55], v[68:71], v[116:119], v[52:55]
    v_mfma_f32_16x16x32_bf16 v[16:19], v[72:75], v[116:119], v[16:19]
    v_mfma_f32_16x16x32_bf16 v[48:51], v[76:79], v[116:119], v[48:51]
    v_mfma_f32_16x16x32_bf16 v[12:15], v[80:83], v[116:119], v[12:15]
    v_mfma_f32_16x16x32_bf16 v[44:47], v[84:87], v[116:119], v[44:47]
    v_mfma_f32_16x16x32_bf16 v[8:11], v[88:91], v[116:119], v[8:11]
    v_mfma_f32_16x16x32_bf16 v[40:43], v[92:95], v[116:119], v[40:43]
    v_xor_b32 v124, 16, v125
    ds_write_b128 v124, v[4:7]
    s_waitcnt lgkmcnt(2)
    v_mfma_f32_16x16x32_bf16 v[24:27], v[64:67], v[96:99], v[24:27]
    v_mfma_f32_16x16x32_bf16 v[56:59], v[68:71], v[96:99], v[56:59]
    v_mfma_f32_16x16x32_bf16 v[20:23], v[72:75], v[96:99], v[20:23]
    v_mfma_f32_16x16x32_bf16 v[52:55], v[76:79], v[96:99], v[52:55]
    v_mfma_f32_16x16x32_bf16 v[16:19], v[80:83], v[96:99], v[16:19]
    v_mfma_f32_16x16x32_bf16 v[48:51], v[84:87], v[96:99], v[48:51]
    v_mfma_f32_16x16x32_bf16 v[12:15], v[88:91], v[96:99], v[12:15]
    v_mfma_f32_16x16x32_bf16 v[44:47], v[92:95], v[96:99], v[44:47]
    v_xor_b32 v123, 32, v125
    ds_write_b128 v123, v[8:11]
    v_xor_b32 v124, 0, v126
    ds_write_b128 v124, v[32:35]
    v_mfma_f32_16x16x32_bf16 v[28:31], v[64:67], v[100:103], v[28:31]
    v_mfma_f32_16x16x32_bf16 v[60:63], v[68:71], v[100:103], v[60:63]
    v_mfma_f32_16x16x32_bf16 v[24:27], v[72:75], v[100:103], v[24:27]
    v_mfma_f32_16x16x32_bf16 v[56:59], v[76:79], v[100:103], v[56:59]
    v_mfma_f32_16x16x32_bf16 v[20:23], v[80:83], v[100:103], v[20:23]
    v_mfma_f32_16x16x32_bf16 v[52:55], v[84:87], v[100:103], v[52:55]
    v_mfma_f32_16x16x32_bf16 v[16:19], v[88:91], v[100:103], v[16:19]
    v_mfma_f32_16x16x32_bf16 v[48:51], v[92:95], v[100:103], v[48:51]
    v_xor_b32 v123, 16, v126
    ds_write_b128 v123, v[36:39]
    v_xor_b32 v124, 32, v126
    ds_write_b128 v124, v[40:43]
    v_mfma_f32_16x16x32_bf16 v[28:31], v[72:75], v[104:107], v[28:31]
    v_mfma_f32_16x16x32_bf16 v[60:63], v[76:79], v[104:107], v[60:63]
    v_mfma_f32_16x16x32_bf16 v[24:27], v[80:83], v[104:107], v[24:27]
    v_mfma_f32_16x16x32_bf16 v[56:59], v[84:87], v[104:107], v[56:59]
    v_mfma_f32_16x16x32_bf16 v[20:23], v[88:91], v[104:107], v[20:23]
    v_mfma_f32_16x16x32_bf16 v[52:55], v[92:95], v[104:107], v[52:55]
    v_xor_b32 v124, 48, v125
    ds_write_b128 v124, v[12:15]
    v_xor_b32 v123, 48, v126
    ds_write_b128 v123, v[44:47]
    v_mfma_f32_16x16x32_bf16 v[28:31], v[80:83], v[108:111], v[28:31]
    v_mfma_f32_16x16x32_bf16 v[60:63], v[84:87], v[108:111], v[60:63]
    v_mfma_f32_16x16x32_bf16 v[24:27], v[88:91], v[108:111], v[24:27]
    v_mfma_f32_16x16x32_bf16 v[56:59], v[92:95], v[108:111], v[56:59]
    v_xor_b32 v123, 64, v125
    ds_write_b128 v123, v[16:19]
    v_xor_b32 v124, 64, v126
    ds_write_b128 v124, v[48:51]
    v_mfma_f32_16x16x32_bf16 v[28:31], v[88:91], v[112:115], v[28:31]
    v_mfma_f32_16x16x32_bf16 v[60:63], v[92:95], v[112:115], v[60:63]
    v_xor_b32 v124, 80, v125
    ds_write_b128 v124, v[20:23]
    v_xor_b32 v123, 80, v126
    ds_write_b128 v123, v[52:55]
    s_nop 7
    v_xor_b32 v123, 96, v125
    ds_write_b128 v123, v[24:27]
    v_xor_b32 v124, 96, v126
    ds_write_b128 v124, v[56:59]
    v_xor_b32 v124, 112, v125
    ds_write_b128 v124, v[28:31]
    v_xor_b32 v123, 112, v126
    s_waitcnt lgkmcnt(8)
    ds_write_b128 v123, v[60:63]
    s_setprio 0
    s_branch L_conv1_kernel_epi
L_conv1_kernel_m2:
    s_mul_i32 s37, s38, 2176
    s_add_u32 s37, s37, 98304
    v_add_u32 v116, s37, v8
    v_add_u32 v118, s37, v9
    v_add_u32 v117, 104832, v8
    s_cmp_eq_u32 s38, 0
    s_cbranch_scc1 L_conv1_kernel_hh0
    v_add_u32 v117, 98304, v9
L_conv1_kernel_hh0:
    s_lshl_b32 s37, s38, 12
    s_add_u32 s37, s37, s43
    s_add_u32 s37, s37, 49152
    v_lshl_add_u32 v119, v127, 4, s37
    v_mov_b32 v0, 0
    v_mov_b32 v1, 0
    v_mov_b32 v2, 0
    v_mov_b32 v3, 0
    v_mov_b32 v4, 0
    v_mov_b32 v5, 0
    v_mov_b32 v6, 0
    v_mov_b32 v7, 0
    v_mov_b32 v8, 0
    v_mov_b32 v9, 0
    v_mov_b32 v10, 0
    v_mov_b32 v11, 0
    v_mov_b32 v12, 0
    v_mov_b32 v13, 0
    v_mov_b32 v14, 0
    v_mov_b32 v15, 0
    v_mov_b32 v16, 0
    v_mov_b32 v17, 0
    v_mov_b32 v18, 0
    v_mov_b32 v19, 0
    v_mov_b32 v20, 0
    v_mov_b32 v21, 0
    v_mov_b32 v22, 0
    v_mov_b32 v23, 0
    v_mov_b32 v24, 0
    v_mov_b32 v25, 0
    v_mov_b32 v26, 0
    v_mov_b32 v27, 0
    v_mov_b32 v28, 0
    v_mov_b32 v29, 0
    v_mov_b32 v30, 0
    v_mov_b32 v31, 0
    v_mov_b32 v32, 0
    v_mov_b32 v33, 0
    v_mov_b32 v34, 0
    v_mov_b32 v35, 0
    v_mov_b32 v36, 0
    v_mov_b32 v37, 0
    v_mov_b32 v38, 0
    v_mov_b32 v39, 0
    v_mov_b32 v40, 0
    v_mov_b32 v41, 0
    v_mov_b32 v42, 0
    v_mov_b32 v43, 0
    v_mov_b32 v44, 0
    v_mov_b32 v45, 0
    v_mov_b32 v46, 0
    v_mov_b32 v47, 0
    v_mov_b32 v48, 0
    v_mov_b32 v49, 0
    v_mov_b32 v50, 0
    v_mov_b32 v51, 0
    v_mov_b32 v52, 0
    v_mov_b32 v53, 0
    v_mov_b32 v54, 0
    v_mov_b32 v55, 0
    v_mov_b32 v56, 0
    v_mov_b32 v57, 0
    v_mov_b32 v58, 0
    v_mov_b32 v59, 0
    v_mov_b32 v60, 0
    v_mov_b32 v61, 0
    v_mov_b32 v62, 0
    v_mov_b32 v63, 0
    s_barrier
    buffer_load_dwordx4 v[96:99], v108, s[8:11], 0 offen offset:0
    buffer_load_dwordx4 v[100:103], v108, s[8:11], 0 offen offset:1024
    buffer_load_dwordx4 v[104:107], v108, s[8:11], 0 offen offset:2048
    s_mov_b32 s23, 0
    s_mov_b32 s26, 4096
    buffer_load_dwordx4 v[64:67], v125, s[12:15], s23 offen offset:0
    buffer_load_dwordx4 v[68:71], v125, s[12:15], s23 offen offset:2048
    buffer_load_dwordx4 v[80:83], v119, s[12:15], s23 offen offset:0
    buffer_load_dwordx4 v[72:75], v125, s[12:15], s26 offen offset:0
    buffer_load_dwordx4 v[84:87], v119, s[12:15], s23 offen offset:2048
    buffer_load_dwordx4 v[76:79], v125, s[12:15], s26 offen offset:2048
    s_mov_b32 s23, 57344
    s_mov_b32 s26, 61440
    s_waitcnt vmcnt(6)
    v_lshlrev_b32 v108, 16, v96
    v_and_b32 v111, s25, v96
    v_lshlrev_b32 v109, 16, v100
    v_and_b32 v112, s25, v100
    v_lshlrev_b32 v110, 16, v104
    v_and_b32 v113, s25, v104
    v_mul_f32 v114, s44, v108
    v_mul_f32 v115, s44, v111
    v_fmac_f32 v114, s45, v109
    v_fmac_f32 v115, s45, v112
    v_fmac_f32 v114, s46, v110
    v_fmac_f32 v115, s46, v113
    v_cvt_pk_bf16_f32 v96, v114, v115
    v_lshlrev_b32 v108, 16, v97
    v_and_b32 v111, s25, v97
    v_lshlrev_b32 v109, 16, v101
    v_and_b32 v112, s25, v101
    v_lshlrev_b32 v110, 16, v105
    v_and_b32 v113, s25, v105
    v_mul_f32 v114, s44, v108
    v_mul_f32 v115, s44, v111
    v_fmac_f32 v114, s45, v109
    v_fmac_f32 v115, s45, v112
    v_fmac_f32 v114, s46, v110
    v_fmac_f32 v115, s46, v113
    v_cvt_pk_bf16_f32 v97, v114, v115
    v_lshlrev_b32 v108, 16, v98
    v_and_b32 v111, s25, v98
    v_lshlrev_b32 v109, 16, v102
    v_and_b32 v112, s25, v102
    v_lshlrev_b32 v110, 16, v106
    v_and_b32 v113, s25, v106
    v_mul_f32 v114, s44, v108
    v_mul_f32 v115, s44, v111
    v_fmac_f32 v114, s45, v109
    v_fmac_f32 v115, s45, v112
    v_fmac_f32 v114, s46, v110
    v_fmac_f32 v115, s46, v113
    v_cvt_pk_bf16_f32 v98, v114, v115
    v_lshlrev_b32 v108, 16, v99
    v_and_b32 v111, s25, v99
    v_lshlrev_b32 v109, 16, v103
    v_and_b32 v112, s25, v103
    v_lshlrev_b32 v110, 16, v107
    v_and_b32 v113, s25, v107
    v_mul_f32 v114, s44, v108
    v_mul_f32 v115, s44, v111
    v_fmac_f32 v114, s45, v109
    v_fmac_f32 v115, s45, v112
    v_fmac_f32 v114, s46, v110
    v_fmac_f32 v115, s46, v113
    v_cvt_pk_bf16_f32 v99, v114, v115
    ds_write_b128 v126, v[96:99]
    v_and_b32 v126, 15, v127
    v_lshlrev_b32 v126, 2, v126
    v_add_u32 v126, 99328, v126
    ds_write_b32 v126, v0
    ds_write_b32 v126, v0 offset:8704
    s_waitcnt lgkmcnt(0)
    s_barrier
    s_mov_b32 s22, 8
    s_setprio 2
L_conv1_kernel_mloop2:
    ds_read_b128 v[88:91], v120 offset:0
    ds_read_b128 v[92:95], v120 offset:1024
    ds_read_b128 v[96:99], v116 offset:0
    ds_read_b128 v[100:103], v120 offset:2048
    ds_read_b128 v[104:107], v116 offset:1088
    ds_read_b128 v[108:111], v120 offset:3072
    ds_read_b128 v[112:115], v116 offset:2176
    s_waitcnt vmcnt(5) lgkmcnt(6)
    v_mfma_f32_16x16x32_bf16 v[0:3], v[64:67], v[88:91], v[0:3]
    ds_read_b128 v[88:91], v120 offset:4096
    s_waitcnt vmcnt(4) lgkmcnt(6)
    v_mfma_f32_16x16x32_bf16 v[4:7], v[64:67], v[92:95], v[4:7]
    v_mfma_f32_16x16x32_bf16 v[0:3], v[68:71], v[92:95], v[0:3]
    ds_read_b128 v[92:95], v116 offset:3264
    s_waitcnt vmcnt(3) lgkmcnt(6)
    v_mfma_f32_16x16x32_bf16 v[32:35], v[80:83], v[96:99], v[32:35]
    ds_read_b128 v[96:99], v120 offset:5120
    s_waitcnt vmcnt(2) lgkmcnt(6)
    v_mfma_f32_16x16x32_bf16 v[8:11], v[64:67], v[100:103], v[8:11]
    v_mfma_f32_16x16x32_bf16 v[4:7], v[68:71], v[100:103], v[4:7]
    v_mfma_f32_16x16x32_bf16 v[0:3], v[72:75], v[100:103], v[0:3]
    ds_read_b128 v[100:103], v116 offset:4352
    s_waitcnt vmcnt(1) lgkmcnt(6)
    v_mfma_f32_16x16x32_bf16 v[36:39], v[80:83], v[104:107], v[36:39]
    v_mfma_f32_16x16x32_bf16 v[32:35], v[84:87], v[104:107], v[32:35]
    ds_read_b128 v[104:107], v120 offset:6144
    s_waitcnt vmcnt(0) lgkmcnt(6)
    v_mfma_f32_16x16x32_bf16 v[12:15], v[64:67], v[108:111], v[12:15]
    v_mfma_f32_16x16x32_bf16 v[8:11], v[68:71], v[108:111], v[8:11]
    v_mfma_f32_16x16x32_bf16 v[4:7], v[72:75], v[108:111], v[4:7]
    v_mfma_f32_16x16x32_bf16 v[0:3], v[76:79], v[108:111], v[0:3]
    ds_read_b128 v[108:111], v116 offset:5440
    s_waitcnt lgkmcnt(6)
    v_mfma_f32_16x16x32_bf16 v[40:43], v[80:83], v[112:115], v[40:43]
    v_mfma_f32_16x16x32_bf16 v[36:39], v[84:87], v[112:115], v[36:39]
    ds_read_b128 v[112:115], v120 offset:7168
    s_waitcnt lgkmcnt(6)
    v_mfma_f32_16x16x32_bf16 v[16:19], v[64:67], v[88:91], v[16:19]
    v_mfma_f32_16x16x32_bf16 v[12:15], v[68:71], v[88:91], v[12:15]
    v_mfma_f32_16x16x32_bf16 v[8:11], v[72:75], v[88:91], v[8:11]
    v_mfma_f32_16x16x32_bf16 v[4:7], v[76:79], v[88:91], v[4:7]
    ds_read_b128 v[88:91], v117 offset:0
    s_waitcnt lgkmcnt(6)
    v_mfma_f32_16x16x32_bf16 v[44:47], v[80:83], v[92:95], v[44:47]
    v_mfma_f32_16x16x32_bf16 v[40:43], v[84:87], v[92:95], v[40:43]
    ds_read_b128 v[92:95], v122 offset:0
    v_add_u32 v122, v123, v122
    s_waitcnt lgkmcnt(6)
    v_mfma_f32_16x16x32_bf16 v[20:23], v[64:67], v[96:99], v[20:23]
    v_mfma_f32_16x16x32_bf16 v[16:19], v[68:71], v[96:99], v[16:19]
    v_mfma_f32_16x16x32_bf16 v[12:15], v[72:75], v[96:99], v[12:15]
    v_mfma_f32_16x16x32_bf16 v[8:11], v[76:79], v[96:99], v[8:11]
    ds_read_b128 v[96:99], v117 offset:1088
    s_waitcnt lgkmcnt(6)
    v_mfma_f32_16x16x32_bf16 v[48:51], v[80:83], v[100:103], v[48:51]
    v_mfma_f32_16x16x32_bf16 v[44:47], v[84:87], v[100:103], v[44:47]
    ds_read_b128 v[100:103], v121 offset:1024
    s_waitcnt lgkmcnt(6)
    v_mfma_f32_16x16x32_bf16 v[24:27], v[64:67], v[104:107], v[24:27]
    v_mfma_f32_16x16x32_bf16 v[20:23], v[68:71], v[104:107], v[20:23]
    v_mfma_f32_16x16x32_bf16 v[16:19], v[72:75], v[104:107], v[16:19]
    v_mfma_f32_16x16x32_bf16 v[12:15], v[76:79], v[104:107], v[12:15]
    ds_read_b128 v[104:107], v118 offset:0
    s_waitcnt lgkmcnt(6)
    v_mfma_f32_16x16x32_bf16 v[52:55], v[80:83], v[108:111], v[52:55]
    v_mfma_f32_16x16x32_bf16 v[48:51], v[84:87], v[108:111], v[48:51]
    ds_read_b128 v[108:111], v121 offset:2048
    s_waitcnt lgkmcnt(6)
    v_mfma_f32_16x16x32_bf16 v[28:31], v[64:67], v[112:115], v[28:31]
    v_mfma_f32_16x16x32_bf16 v[24:27], v[68:71], v[112:115], v[24:27]
    v_mfma_f32_16x16x32_bf16 v[20:23], v[72:75], v[112:115], v[20:23]
    v_mfma_f32_16x16x32_bf16 v[16:19], v[76:79], v[112:115], v[16:19]
    buffer_load_dwordx4 v[64:67], v125, s[12:15], s23 offen offset:0
    s_waitcnt lgkmcnt(5)
    v_mfma_f32_16x16x32_bf16 v[56:59], v[80:83], v[88:91], v[56:59]
    v_mfma_f32_16x16x32_bf16 v[52:55], v[84:87], v[88:91], v[52:55]
    s_waitcnt lgkmcnt(0)
    s_barrier
    v_mfma_f32_16x16x32_bf16 v[28:31], v[68:71], v[92:95], v[28:31]
    v_mfma_f32_16x16x32_bf16 v[24:27], v[72:75], v[92:95], v[24:27]
    v_mfma_f32_16x16x32_bf16 v[20:23], v[76:79], v[92:95], v[20:23]
    buffer_load_dwordx4 v[68:71], v125, s[12:15], s23 offen offset:2048
    v_mfma_f32_16x16x32_bf16 v[60:63], v[80:83], v[96:99], v[60:63]
    v_mfma_f32_16x16x32_bf16 v[56:59], v[84:87], v[96:99], v[56:59]
    buffer_load_dwordx4 v[80:83], v119, s[12:15], s23 offen offset:0
    v_mfma_f32_16x16x32_bf16 v[28:31], v[72:75], v[100:103], v[28:31]
    v_mfma_f32_16x16x32_bf16 v[24:27], v[76:79], v[100:103], v[24:27]
    buffer_load_dwordx4 v[72:75], v125, s[12:15], s26 offen offset:0
    v_mfma_f32_16x16x32_bf16 v[60:63], v[84:87], v[104:107], v[60:63]
    buffer_load_dwordx4 v[84:87], v119, s[12:15], s23 offen offset:2048
    v_mfma_f32_16x16x32_bf16 v[28:31], v[76:79], v[108:111], v[28:31]
    buffer_load_dwordx4 v[76:79], v125, s[12:15], s26 offen offset:2048
    s_add_u32 s23, s23, 57344
    s_add_u32 s26, s26, 57344
    s_sub_u32 s22, s22, 1
    s_cmp_eq_u32 s22, 0
    s_cbranch_scc1 L_conv1_kernel_mlast2
    ds_read_b128 v[88:91], v120 offset:8192
    ds_read_b128 v[92:95], v120 offset:9216
    ds_read_b128 v[96:99], v116 offset:8704
    ds_read_b128 v[100:103], v120 offset:10240
    ds_read_b128 v[104:107], v116 offset:9792
    ds_read_b128 v[108:111], v120 offset:11264
    ds_read_b128 v[112:115], v116 offset:10880
    s_waitcnt vmcnt(5) lgkmcnt(6)
    v_mfma_f32_16x16x32_bf16 v[0:3], v[64:67], v[88:91], v[0:3]
    ds_read_b128 v[88:91], v120 offset:12288
    s_waitcnt vmcnt(4) lgkmcnt(6)
    v_mfma_f32_16x16x32_bf16 v[4:7], v[64:67], v[92:95], v[4:7]
    v_mfma_f32_16x16x32_bf16 v[0:3], v[68:71], v[92:95], v[0:3]
    ds_read_b128 v[92:95], v116 offset:11968
    s_waitcnt vmcnt(3) lgkmcnt(6)
    v_mfma_f32_16x16x32_bf16 v[32:35], v[80:83], v[96:99], v[32:35]
    ds_read_b128 v[96:99], v120 offset:13312
    s_waitcnt vmcnt(2) lgkmcnt(6)
    v_mfma_f32_16x16x32_bf16 v[8:11], v[64:67], v[100:103], v[8:11]
    v_mfma_f32_16x16x32_bf16 v[4:7], v[68:71], v[100:103], v[4:7]
    v_mfma_f32_16x16x32_bf16 v[0:3], v[72:75], v[100:103], v[0:3]
    ds_read_b128 v[100:103], v116 offset:13056
    s_waitcnt vmcnt(1) lgkmcnt(6)
    v_mfma_f32_16x16x32_bf16 v[36:39], v[80:83], v[104:107], v[36:39]
    v_mfma_f32_16x16x32_bf16 v[32:35], v[84:87], v[104:107], v[32:35]
    ds_read_b128 v[104:107], v120 offset:14336
    s_waitcnt vmcnt(0) lgkmcnt(6)
    v_mfma_f32_16x16x32_bf16 v[12:15], v[64:67], v[108:111], v[12:15]
    v_mfma_f32_16x16x32_bf16 v[8:11], v[68:71], v[108:111], v[8:11]
    v_mfma_f32_16x16x32_bf16 v[4:7], v[72:75], v[108:111], v[4:7]
    v_mfma_f32_16x16x32_bf16 v[0:3], v[76:79], v[108:111], v[0:3]
    ds_read_b128 v[108:111], v116 offset:14144
    s_waitcnt lgkmcnt(6)
    v_mfma_f32_16x16x32_bf16 v[40:43], v[80:83], v[112:115], v[40:43]
    v_mfma_f32_16x16x32_bf16 v[36:39], v[84:87], v[112:115], v[36:39]
    ds_read_b128 v[112:115], v120 offset:15360
    s_waitcnt lgkmcnt(6)
    v_mfma_f32_16x16x32_bf16 v[16:19], v[64:67], v[88:91], v[16:19]
    v_mfma_f32_16x16x32_bf16 v[12:15], v[68:71], v[88:91], v[12:15]
    v_mfma_f32_16x16x32_bf16 v[8:11], v[72:75], v[88:91], v[8:11]
    v_mfma_f32_16x16x32_bf16 v[4:7], v[76:79], v[88:91], v[4:7]
    ds_read_b128 v[88:91], v117 offset:8704
    s_waitcnt lgkmcnt(6)
    v_mfma_f32_16x16x32_bf16 v[44:47], v[80:83], v[92:95], v[44:47]
    v_mfma_f32_16x16x32_bf16 v[40:43], v[84:87], v[92:95], v[40:43]
    ds_read_b128 v[92:95], v122 offset:0
    v_add_u32 v122, v124, v122
    s_waitcnt lgkmcnt(6)
    v_mfma_f32_16x16x32_bf16 v[20:23], v[64:67], v[96:99], v[20:23]
    v_mfma_f32_16x16x32_bf16 v[16:19], v[68:71], v[96:99], v[16:19]
    v_mfma_f32_16x16x32_bf16 v[12:15], v[72:75], v[96:99], v[12:15]
    v_mfma_f32_16x16x32_bf16 v[8:11], v[76:79], v[96:99], v[8:11]
    ds_read_b128 v[96:99], v117 offset:9792
    s_waitcnt lgkmcnt(6)
    v_mfma_f32_16x16x32_bf16 v[48:51], v[80:83], v[100:103], v[48:51]
    v_mfma_f32_16x16x32_bf16 v[44:47], v[84:87], v[100:103], v[44:47]
    ds_read_b128 v[100:103], v121 offset:9216
    s_waitcnt lgkmcnt(6)
    v_mfma_f32_16x16x32_bf16 v[24:27], v[64:67], v[104:107], v[24:27]
    v_mfma_f32_16x16x32_bf16 v[20:23], v[68:71], v[104:107], v[20:23]
    v_mfma_f32_16x16x32_bf16 v[16:19], v[72:75], v[104:107], v[16:19]
    v_mfma_f32_16x16x32_bf16 v[12:15], v[76:79], v[104:107], v[12:15]
    ds_read_b128 v[104:107], v118 offset:8704
    s_waitcnt lgkmcnt(6)
    v_mfma_f32_16x16x32_bf16 v[52:55], v[80:83], v[108:111], v[52:55]
    v_mfma_f32_16x16x32_bf16 v[48:51], v[84:87], v[108:111], v[48:51]
    ds_read_b128 v[108:111], v121 offset:10240
    s_waitcnt lgkmcnt(6)
    v_mfma_f32_16x16x32_bf16 v[28:31], v[64:67], v[112:115], v[28:31]
    v_mfma_f32_16x16x32_bf16 v[24:27], v[68:71], v[112:115], v[24:27]
    v_mfma_f32_16x16x32_bf16 v[20:23], v[72:75], v[112:115], v[20:23]
    v_mfma_f32_16x16x32_bf16 v[16:19], v[76:79], v[112:115], v[16:19]
    buffer_load_dwordx4 v[64:67], v125, s[12:15], s23 offen offset:0
    s_waitcnt lgkmcnt(5)
    v_mfma_f32_16x16x32_bf16 v[56:59], v[80:83], v[88:91], v[56:59]
    v_mfma_f32_16x16x32_bf16 v[52:55], v[84:87], v[88:91], v[52:55]
    s_waitcnt lgkmcnt(0)
    s_barrier
    v_mfma_f32_16x16x32_bf16 v[28:31], v[68:71], v[92:95], v[28:31]
    v_mfma_f32_16x16x32_bf16 v[24:27], v[72:75], v[92:95], v[24:27]
    v_mfma_f32_16x16x32_bf16 v[20:23], v[76:79], v[92:95], v[20:23]
    buffer_load_dwordx4 v[68:71], v125, s[12:15], s23 offen offset:2048
    v_mfma_f32_16x16x32_bf16 v[60:63], v[80:83], v[96:99], v[60:63]
    v_mfma_f32_16x16x32_bf16 v[56:59], v[84:87], v[96:99], v[56:59]
    buffer_load_dwordx4 v[80:83], v119, s[12:15], s23 offen offset:0
    v_mfma_f32_16x16x32_bf16 v[28:31], v[72:75], v[100:103], v[28:31]
    v_mfma_f32_16x16x32_bf16 v[24:27], v[76:79], v[100:103], v[24:27]
    buffer_load_dwordx4 v[72:75], v125, s[12:15], s26 offen offset:0
    v_mfma_f32_16x16x32_bf16 v[60:63], v[84:87], v[104:107], v[60:63]
    buffer_load_dwordx4 v[84:87], v119, s[12:15], s23 offen offset:2048
    v_mfma_f32_16x16x32_bf16 v[28:31], v[76:79], v[108:111], v[28:31]
    buffer_load_dwordx4 v[76:79], v125, s[12:15], s26 offen offset:2048
    s_add_u32 s23, s23, 57344
    s_add_u32 s26, s26, 57344
    s_branch L_conv1_kernel_mloop2
L_conv1_kernel_mlast2:
    v_and_b32 v125, 15, v127
    v_and_b32 v126, 7, v127
    v_lshlrev_b32 v126, 4, v126
    v_lshl_add_u32 v125, v125, 7, v126
    v_lshrrev_b32 v126, 4, v127
    v_lshl_add_u32 v125, v126, 11, v125
    s_mov_b32 s36, 65536
    s_cmp_eq_u32 s32, 1
    s_cselect_b32 s36, 121856, s36
    s_cmp_eq_u32 s32, 2
    s_cselect_b32 s36, 81920, s36
    s_cmp_eq_u32 s32, 3
    s_cselect_b32 s36, 130048, s36
    s_mov_b32 s37, 98304
    s_cmp_eq_u32 s32, 1
    s_cselect_b32 s37, 138240, s37
    s_cmp_eq_u32 s32, 2
    s_cselect_b32 s37, 146432, s37
    s_cmp_eq_u32 s32, 3
    s_cselect_b32 s37, 154624, s37
    v_add_u32 v126, s37, v125
    v_add_u32 v125, s36, v125
    ds_read_b128 v[88:91], v120 offset:8192
    ds_read_b128 v[92:95], v120 offset:9216
    ds_read_b128 v[96:99], v116 offset:8704
    ds_read_b128 v[100:103], v120 offset:10240
    ds_read_b128 v[104:107], v116 offset:9792
    ds_read_b128 v[108:111], v120 offset:11264
    ds_read_b128 v[112:115], v116 offset:10880
    s_waitcnt vmcnt(5) lgkmcnt(6)
    v_mfma_f32_16x16x32_bf16 v[0:3], v[64:67], v[88:91], v[0:3]
    ds_read_b128 v[88:91], v120 offset:12288
    s_waitcnt vmcnt(4) lgkmcnt(6)
    v_mfma_f32_16x16x32_bf16 v[4:7], v[64:67], v[92:95], v[4:7]
    v_mfma_f32_16x16x32_bf16 v[0:3], v[68:71], v[92:95], v[0:3]
    ds_read_b128 v[92:95], v116 offset:11968
    s_waitcnt vmcnt(3) lgkmcnt(6)
    v_mfma_f32_16x16x32_bf16 v[32:35], v[80:83], v[96:99], v[32:35]
    ds_read_b128 v[96:99], v120 offset:13312
    s_waitcnt vmcnt(2) lgkmcnt(6)
    v_mfma_f32_16x16x32_bf16 v[8:11], v[64:67], v[100:103], v[8:11]
    v_mfma_f32_16x16x32_bf16 v[4:7], v[68:71], v[100:103], v[4:7]
    v_mfma_f32_16x16x32_bf16 v[0:3], v[72:75], v[100:103], v[0:3]
    ds_read_b128 v[100:103], v116 offset:13056
    s_waitcnt vmcnt(1) lgkmcnt(6)
    v_mfma_f32_16x16x32_bf16 v[36:39], v[80:83], v[104:107], v[36:39]
    v_mfma_f32_16x16x32_bf16 v[32:35], v[84:87], v[104:107], v[32:35]
    ds_read_b128 v[104:107], v120 offset:14336
    s_waitcnt vmcnt(0) lgkmcnt(6)
    v_mfma_f32_16x16x32_bf16 v[12:15], v[64:67], v[108:111], v[12:15]
    v_mfma_f32_16x16x32_bf16 v[8:11], v[68:71], v[108:111], v[8:11]
    v_mfma_f32_16x16x32_bf16 v[4:7], v[72:75], v[108:111], v[4:7]
    v_mfma_f32_16x16x32_bf16 v[0:3], v[76:79], v[108:111], v[0:3]
    ds_read_b128 v[108:111], v116 offset:14144
    s_waitcnt lgkmcnt(6)
    v_mfma_f32_16x16x32_bf16 v[40:43], v[80:83], v[112:115], v[40:43]
    v_mfma_f32_16x16x32_bf16 v[36:39], v[84:87], v[112:115], v[36:39]
    ds_read_b128 v[112:115], v120 offset:15360
    s_waitcnt lgkmcnt(6)
    v_mfma_f32_16x16x32_bf16 v[16:19], v[64:67], v[88:91], v[16:19]
    v_mfma_f32_16x16x32_bf16 v[12:15], v[68:71], v[88:91], v[12:15]
    v_mfma_f32_16x16x32_bf16 v[8:11], v[72:75], v[88:91], v[8:11]
    v_mfma_f32_16x16x32_bf16 v[4:7], v[76:79], v[88:91], v[4:7]
    ds_read_b128 v[88:91], v117 offset:8704
    v_xor_b32 v124, 0, v126
    ds_write_b128 v124, v[32:35]
    s_waitcnt lgkmcnt(7)
    v_mfma_f32_16x16x32_bf16 v[44:47], v[80:83], v[92:95], v[44:47]
    v_mfma_f32_16x16x32_bf16 v[40:43], v[84:87], v[92:95], v[40:43]
    ds_read_b128 v[92:95], v122 offset:0
    v_xor_b32 v123, 0, v125
    ds_write_b128 v123, v[0:3]
    s_waitcnt lgkmcnt(8)
    v_mfma_f32_16x16x32_bf16 v[20:23], v[64:67], v[96:99], v[20:23]
    v_mfma_f32_16x16x32_bf16 v[16:19], v[68:71], v[96:99], v[16:19]
    v_mfma_f32_16x16x32_bf16 v[12:15], v[72:75], v[96:99], v[12:15]
    v_mfma_f32_16x16x32_bf16 v[8:11], v[76:79], v[96:99], v[8:11]
    ds_read_b128 v[96:99], v117 offset:9792
    v_xor_b32 v123, 16, v126
    ds_write_b128 v123, v[36:39]
    s_waitcnt lgkmcnt(9)
    v_mfma_f32_16x16x32_bf16 v[48:51], v[80:83], v[100:103], v[48:51]
    v_mfma_f32_16x16x32_bf16 v[44:47], v[84:87], v[100:103], v[44:47]
    ds_read_b128 v[100:103], v121 offset:9216
    v_xor_b32 v124, 16, v125
    ds_write_b128 v124, v[4:7]
    s_waitcnt lgkmcnt(10)
    v_mfma_f32_16x16x32_bf16 v[24:27], v[64:67], v[104:107], v[24:27]
    v_mfma_f32_16x16x32_bf16 v[20:23], v[68:71], v[104:107], v[20:23]
    v_mfma_f32_16x16x32_bf16 v[16:19], v[72:75], v[104:107], v[16:19]
    v_mfma_f32_16x16x32_bf16 v[12:15], v[76:79], v[104:107], v[12:15]
    ds_read_b128 v[104:107], v118 offset:8704
    v_xor_b32 v124, 32, v126
    ds_write_b128 v124, v[40:43]
    s_waitcnt lgkmcnt(11)
    v_mfma_f32_16x16x32_bf16 v[52:55], v[80:83], v[108:111], v[52:55]
    v_mfma_f32_16x16x32_bf16 v[48:51], v[84:87], v[108:111], v[48:51]
    ds_read_b128 v[108:111], v121 offset:10240
    v_xor_b32 v123, 32, v125
    ds_write_b128 v123, v[8:11]
    s_waitcnt lgkmcnt(12)
    v_mfma_f32_16x16x32_bf16 v[28:31], v[64:67], v[112:115], v[28:31]
    v_mfma_f32_16x16x32_bf16 v[24:27], v[68:71], v[112:115], v[24:27]
    v_mfma_f32_16x16x32_bf16 v[20:23], v[72:75], v[112:115], v[20:23]
    v_mfma_f32_16x16x32_bf16 v[16:19], v[76:79], v[112:115], v[16:19]
    v_xor_b32 v123, 48, v126
    ds_write_b128 v123, v[44:47]
    s_waitcnt lgkmcnt(12)
    v_mfma_f32_16x16x32_bf16 v[56:59], v[80:83], v[88:91], v[56:59]
    v_mfma_f32_16x16x32_bf16 v[52:55], v[84:87], v[88:91], v[52:55]
    v_xor_b32 v124, 48, v125
    ds_write_b128 v124, v[12:15]
    s_waitcnt lgkmcnt(11)
    v_mfma_f32_16x16x32_bf16 v[28:31], v[68:71], v[92:95], v[28:31]
    v_mfma_f32_16x16x32_bf16 v[24:27], v[72:75], v[92:95], v[24:27]
    v_mfma_f32_16x16x32_bf16 v[20:23], v[76:79], v[92:95], v[20:23]
    v_xor_b32 v124, 64, v126
    ds_write_b128 v124, v[48:51]
    s_waitcnt lgkmcnt(10)
    v_mfma_f32_16x16x32_bf16 v[60:63], v[80:83], v[96:99], v[60:63]
    v_mfma_f32_16x16x32_bf16 v[56:59], v[84:87], v[96:99], v[56:59]
    v_xor_b32 v123, 64, v125
    ds_write_b128 v123, v[16:19]
    s_waitcnt lgkmcnt(9)
    v_mfma_f32_16x16x32_bf16 v[28:31], v[72:75], v[100:103], v[28:31]
    v_mfma_f32_16x16x32_bf16 v[24:27], v[76:79], v[100:103], v[24:27]
    v_xor_b32 v123, 80, v126
    ds_write_b128 v123, v[52:55]
    s_waitcnt lgkmcnt(8)
    v_mfma_f32_16x16x32_bf16 v[60:63], v[84:87], v[104:107], v[60:63]
    v_xor_b32 v124, 80, v125
    ds_write_b128 v124, v[20:23]
    s_waitcnt lgkmcnt(7)
    v_mfma_f32_16x16x32_bf16 v[28:31], v[76:79], v[108:111], v[28:31]
    v_xor_b32 v124, 96, v126
    ds_write_b128 v124, v[56:59]
    s_nop 7
    v_xor_b32 v123, 96, v125
    ds_write_b128 v123, v[24:27]
    v_xor_b32 v123, 112, v126
    ds_write_b128 v123, v[60:63]
    v_xor_b32 v124, 112, v125
    ds_write_b128 v124, v[28:31]
    s_setprio 0
    s_branch L_conv1_kernel_epi
L_conv1_kernel_helper:
    s_setprio 3
    v_add_u32 v92, 0, v7
    v_add_u32 v93, 1024, v7
    v_add_u32 v94, 2048, v7
    v_add_u32 v95, 3072, v7
    v_and_b32 v76, 4, v5
    v_lshrrev_b32 v76, 1, v76
    v_xor_b32 v76, v6, v76
    v_lshlrev_b32 v76, 4, v76
    v_lshl_add_u32 v76, v5, 6, v76
    s_mov_b32 s24, 0
    buffer_load_dwordx4 v[0:3], v92, s[8:11], s24 offen offset:0
    buffer_load_dwordx4 v[16:19], v92, s[8:11], s24 offen offset:64
    v_add_u32 v92, 128, v92
    buffer_load_dwordx4 v[4:7], v93, s[8:11], s24 offen offset:0
    buffer_load_dwordx4 v[20:23], v93, s[8:11], s24 offen offset:64
    v_add_u32 v93, 128, v93
    buffer_load_dwordx4 v[8:11], v94, s[8:11], s24 offen offset:0
    buffer_load_dwordx4 v[24:27], v94, s[8:11], s24 offen offset:64
    v_add_u32 v94, 128, v94
    buffer_load_dwordx4 v[12:15], v95, s[8:11], s24 offen offset:0
    buffer_load_dwordx4 v[28:31], v95, s[8:11], s24 offen offset:64
    v_add_u32 v95, 128, v95
    s_barrier
    s_mul_i32 s36, s42, 1024
    v_add_u32 v96, s36, v76
    v_add_u32 v97, 65536, v96
    s_mul_i32 s36, s42, 1088
    s_add_u32 s36, s36, 98304
    v_add_u32 v98, s36, v76
    s_lshl_b32 s36, s29, 4
    s_lshl_b32 s37, s33, 3
    s_add_u32 s36, s36, s37
    s_mul_i32 s36, s36, 57344
    s_add_u32 s36, s36, 0
    s_add_u32 s12, s30, s36
    s_addc_u32 s13, s31, 0
    s_mov_b32 s14, 917504
    s_mov_b32 s15, 0x00020000
    s_bfe_u32 s36, s2, 131075
    s_lshl_b32 s36, s36, 3
    s_add_u32 s36, s36, s42
    s_lshl_b32 s36, s36, 14
    s_add_u32 s44, s36, s41
    s_add_u32 s44, s44, 256
    s_lshr_b32 s36, s2, 5
    s_lshl_b32 s36, s36, 3
    s_add_u32 s36, s36, s42
    s_mul_i32 s45, s36, 896
    s_add_u32 s45, s45, 57344
    s_waitcnt vmcnt(0)
    s_waitcnt lgkmcnt(0)
    s_mov_b32 s28, 0
    s_mov_b32 s22, 4
    s_cmp_ge_u32 s20, 12
    s_cbranch_scc1 L_conv1_kernel_h2
    s_waitcnt lgkmcnt(0)
    ds_write_b128 v96, v[0:3] offset:0
    ds_write_b128 v98, v[12:15] offset:0
    v_lshlrev_b32 v76, 16, v0
    v_and_b32 v84, s25, v0
    v_lshlrev_b32 v77, 16, v4
    v_and_b32 v85, s25, v4
    v_lshlrev_b32 v78, 16, v8
    v_and_b32 v86, s25, v8
    v_lshlrev_b32 v79, 16, v12
    v_and_b32 v87, s25, v12
    v_add_f32 v80, v76, v78
    v_add_f32 v88, v84, v86
    v_add_f32 v81, v77, v79
    v_add_f32 v89, v85, v87
    v_fma_f32 v82, v78, 4.0, v76
    v_fma_f32 v90, v86, 4.0, v84
    v_fma_f32 v83, v79, 4.0, v77
    v_fma_f32 v91, v87, 4.0, v85
    v_add_f32 v77, v80, v81
    v_add_f32 v85, v88, v89
    v_sub_f32 v78, v80, v81
    v_sub_f32 v86, v88, v89
    v_fma_f32 v79, v83, 2.0, v82
    v_fma_f32 v87, v91, 2.0, v90
    v_fma_f32 v82, v83, -2.0, v82
    v_fma_f32 v90, v91, -2.0, v90
    v_fmamk_f32 v80, v76, 0x41700000, v82
    v_fmamk_f32 v88, v84, 0x41700000, v90
    v_fmamk_f32 v80, v81, 0x41200000, v80
    v_fmamk_f32 v88, v89, 0x41200000, v88
    v_cvt_pk_bf16_f32 v4, v77, v85
    v_cvt_pk_bf16_f32 v8, v78, v86
    v_cvt_pk_bf16_f32 v64, v79, v87
    v_cvt_pk_bf16_f32 v68, v82, v90
    v_cvt_pk_bf16_f32 v72, v80, v88
    v_lshlrev_b32 v76, 16, v1
    v_and_b32 v84, s25, v1
    v_lshlrev_b32 v77, 16, v5
    v_and_b32 v85, s25, v5
    v_lshlrev_b32 v78, 16, v9
    v_and_b32 v86, s25, v9
    v_lshlrev_b32 v79, 16, v13
    v_and_b32 v87, s25, v13
    v_add_f32 v80, v76, v78
    v_add_f32 v88, v84, v86
    v_add_f32 v81, v77, v79
    v_add_f32 v89, v85, v87
    v_fma_f32 v82, v78, 4.0, v76
    v_fma_f32 v90, v86, 4.0, v84
    v_fma_f32 v83, v79, 4.0, v77
    v_fma_f32 v91, v87, 4.0, v85
    v_add_f32 v77, v80, v81
    v_add_f32 v85, v88, v89
    v_sub_f32 v78, v80, v81
    v_sub_f32 v86, v88, v89
    v_fma_f32 v79, v83, 2.0, v82
    v_fma_f32 v87, v91, 2.0, v90
    v_fma_f32 v82, v83, -2.0, v82
    v_fma_f32 v90, v91, -2.0, v90
    v_fmamk_f32 v80, v76, 0x41700000, v82
    v_fmamk_f32 v88, v84, 0x41700000, v90
    v_fmamk_f32 v80, v81, 0x41200000, v80
    v_fmamk_f32 v88, v89, 0x41200000, v88
    v_cvt_pk_bf16_f32 v5, v77, v85
    v_cvt_pk_bf16_f32 v9, v78, v86
    v_cvt_pk_bf16_f32 v65, v79, v87
    v_cvt_pk_bf16_f32 v69, v82, v90
    v_cvt_pk_bf16_f32 v73, v80, v88
    v_lshlrev_b32 v76, 16, v2
    v_and_b32 v84, s25, v2
    v_lshlrev_b32 v77, 16, v6
    v_and_b32 v85, s25, v6
    v_lshlrev_b32 v78, 16, v10
    v_and_b32 v86, s25, v10
    v_lshlrev_b32 v79, 16, v14
    v_and_b32 v87, s25, v14
    v_add_f32 v80, v76, v78
    v_add_f32 v88, v84, v86
    v_add_f32 v81, v77, v79
    v_add_f32 v89, v85, v87
    v_fma_f32 v82, v78, 4.0, v76
    v_fma_f32 v90, v86, 4.0, v84
    v_fma_f32 v83, v79, 4.0, v77
    v_fma_f32 v91, v87, 4.0, v85
    v_add_f32 v77, v80, v81
    v_add_f32 v85, v88, v89
    v_sub_f32 v78, v80, v81
    v_sub_f32 v86, v88, v89
    v_fma_f32 v79, v83, 2.0, v82
    v_fma_f32 v87, v91, 2.0, v90
    v_fma_f32 v82, v83, -2.0, v82
    v_fma_f32 v90, v91, -2.0, v90
    v_fmamk_f32 v80, v76, 0x41700000, v82
    v_fmamk_f32 v88, v84, 0x41700000, v90
    v_fmamk_f32 v80, v81, 0x41200000, v80
    v_fmamk_f32 v88, v89, 0x41200000, v88
    v_cvt_pk_bf16_f32 v6, v77, v85
    v_cvt_pk_bf16_f32 v10, v78, v86
    v_cvt_pk_bf16_f32 v66, v79, v87
    v_cvt_pk_bf16_f32 v70, v82, v90
    v_cvt_pk_bf16_f32 v74, v80, v88
    v_lshlrev_b32 v76, 16, v3
    v_and_b32 v84, s25, v3
    v_lshlrev_b32 v77, 16, v7
    v_and_b32 v85, s25, v7
    v_lshlrev_b32 v78, 16, v11
    v_and_b32 v86, s25, v11
    v_lshlrev_b32 v79, 16, v15
    v_and_b32 v87, s25, v15
    v_add_f32 v80, v76, v78
    v_add_f32 v88, v84, v86
    v_add_f32 v81, v77, v79
    v_add_f32 v89, v85, v87
    v_fma_f32 v82, v78, 4.0, v76
    v_fma_f32 v90, v86, 4.0, v84
    v_fma_f32 v83, v79, 4.0, v77
    v_fma_f32 v91, v87, 4.0, v85
    v_add_f32 v77, v80, v81
    v_add_f32 v85, v88, v89
    v_sub_f32 v78, v80, v81
    v_sub_f32 v86, v88, v89
    v_fma_f32 v79, v83, 2.0, v82
    v_fma_f32 v87, v91, 2.0, v90
    v_fma_f32 v82, v83, -2.0, v82
    v_fma_f32 v90, v91, -2.0, v90
    v_fmamk_f32 v80, v76, 0x41700000, v82
    v_fmamk_f32 v88, v84, 0x41700000, v90
    v_fmamk_f32 v80, v81, 0x41200000, v80
    v_fmamk_f32 v88, v89, 0x41200000, v88
    v_cvt_pk_bf16_f32 v7, v77, v85
    v_cvt_pk_bf16_f32 v11, v78, v86
    v_cvt_pk_bf16_f32 v67, v79, v87
    v_cvt_pk_bf16_f32 v71, v82, v90
    v_cvt_pk_bf16_f32 v75, v80, v88
    ds_write_b128 v96, v[4:7] offset:16384
    ds_write_b128 v96, v[8:11] offset:32768
    ds_write_b128 v96, v[64:67] offset:49152
    ds_write_b128 v97, v[68:71] offset:0
    ds_write_b128 v97, v[72:75] offset:16384
    buffer_load_dwordx4 v[32:35], v92, s[8:11], s24 offen offset:0
    buffer_load_dwordx4 v[48:51], v92, s[8:11], s24 offen offset:64
    v_add_u32 v92, 128, v92
    buffer_load_dwordx4 v[36:39], v93, s[8:11], s24 offen offset:0
    buffer_load_dwordx4 v[52:55], v93, s[8:11], s24 offen offset:64
    v_add_u32 v93, 128, v93
    s_waitcnt lgkmcnt(0)
    s_barrier
    s_setprio 1
L_conv1_kernel_hloop1:
    s_cmp_lt_u32 s28, 13
    s_cselect_b32 s24, 0, 2130706432
    v_lshlrev_b32 v76, 16, v16
    v_and_b32 v84, s25, v16
    v_lshlrev_b32 v77, 16, v20
    v_and_b32 v85, s25, v20
    v_lshlrev_b32 v78, 16, v24
    v_and_b32 v86, s25, v24
    v_lshlrev_b32 v79, 16, v28
    v_and_b32 v87, s25, v28
    v_add_f32 v80, v76, v78
    v_add_f32 v88, v84, v86
    v_add_f32 v81, v77, v79
    v_add_f32 v89, v85, v87
    v_fma_f32 v82, v78, 4.0, v76
    buffer_load_dwordx4 v[40:43], v94, s[8:11], s24 offen offset:0
    buffer_load_dwordx4 v[56:59], v94, s[8:11], s24 offen offset:64
    v_add_u32 v94, 128, v94
    v_fma_f32 v90, v86, 4.0, v84
    v_fma_f32 v83, v79, 4.0, v77
    v_fma_f32 v91, v87, 4.0, v85
    v_add_f32 v77, v80, v81
    v_add_f32 v85, v88, v89
    v_sub_f32 v78, v80, v81
    v_sub_f32 v86, v88, v89
    v_fma_f32 v79, v83, 2.0, v82
    v_fma_f32 v87, v91, 2.0, v90
    v_fma_f32 v82, v83, -2.0, v82
    v_fma_f32 v90, v91, -2.0, v90
    v_fmamk_f32 v80, v76, 0x41700000, v82
    v_fmamk_f32 v88, v84, 0x41700000, v90
    v_fmamk_f32 v80, v81, 0x41200000, v80
    v_fmamk_f32 v88, v89, 0x41200000, v88
    v_cvt_pk_bf16_f32 v20, v77, v85
    v_cvt_pk_bf16_f32 v24, v78, v86
    v_cvt_pk_bf16_f32 v64, v79, v87
    v_cvt_pk_bf16_f32 v68, v82, v90
    v_cvt_pk_bf16_f32 v72, v80, v88
    v_lshlrev_b32 v76, 16, v17
    v_and_b32 v84, s25, v17
    v_lshlrev_b32 v77, 16, v21
    v_and_b32 v85, s25, v21
    v_lshlrev_b32 v78, 16, v25
    v_and_b32 v86, s25, v25
    v_lshlrev_b32 v79, 16, v29
    v_and_b32 v87, s25, v29
    v_add_f32 v80, v76, v78
    v_add_f32 v88, v84, v86
    v_add_f32 v81, v77, v79
    v_add_f32 v89, v85, v87
    v_fma_f32 v82, v78, 4.0, v76
    v_fma_f32 v90, v86, 4.0, v84
    v_fma_f32 v83, v79, 4.0, v77
    v_fma_f32 v91, v87, 4.0, v85
    v_add_f32 v77, v80, v81
    v_add_f32 v85, v88, v89
    v_sub_f32 v78, v80, v81
    v_sub_f32 v86, v88, v89
    v_fma_f32 v79, v83, 2.0, v82
    v_fma_f32 v87, v91, 2.0, v90
    v_fma_f32 v82, v83, -2.0, v82
    v_fma_f32 v90, v91, -2.0, v90
    v_fmamk_f32 v80, v76, 0x41700000, v82
    v_fmamk_f32 v88, v84, 0x41700000, v90
    v_fmamk_f32 v80, v81, 0x41200000, v80
    v_fmamk_f32 v88, v89, 0x41200000, v88
    v_cvt_pk_bf16_f32 v21, v77, v85
    v_cvt_pk_bf16_f32 v25, v78, v86
    v_cvt_pk_bf16_f32 v65, v79, v87
    v_cvt_pk_bf16_f32 v69, v82, v90
    v_cvt_pk_bf16_f32 v73, v80, v88
    buffer_load_dwordx4 v[44:47], v95, s[8:11], s24 offen offset:0
    buffer_load_dwordx4 v[60:63], v95, s[8:11], s24 offen offset:64
    v_add_u32 v95, 128, v95
    v_lshlrev_b32 v76, 16, v18
    v_and_b32 v84, s25, v18
    v_lshlrev_b32 v77, 16, v22
    v_and_b32 v85, s25, v22
    v_lshlrev_b32 v78, 16, v26
    v_and_b32 v86, s25, v26
    v_lshlrev_b32 v79, 16, v30
    v_and_b32 v87, s25, v30
    v_add_f32 v80, v76, v78
    v_add_f32 v88, v84, v86
    v_add_f32 v81, v77, v79
    v_add_f32 v89, v85, v87
    v_fma_f32 v82, v78, 4.0, v76
    v_fma_f32 v90, v86, 4.0, v84
    v_fma_f32 v83, v79, 4.0, v77
    v_fma_f32 v91, v87, 4.0, v85
    v_add_f32 v77, v80, v81
    v_add_f32 v85, v88, v89
    v_sub_f32 v78, v80, v81
    v_sub_f32 v86, v88, v89
    v_fma_f32 v79, v83, 2.0, v82
    v_fma_f32 v87, v91, 2.0, v90
    v_fma_f32 v82, v83, -2.0, v82
    v_fma_f32 v90, v91, -2.0, v90
    v_fmamk_f32 v80, v76, 0x41700000, v82
    v_fmamk_f32 v88, v84, 0x41700000, v90
    v_fmamk_f32 v80, v81, 0x41200000, v80
    v_fmamk_f32 v88, v89, 0x41200000, v88
    v_cvt_pk_bf16_f32 v22, v77, v85
    v_cvt_pk_bf16_f32 v26, v78, v86
    v_cvt_pk_bf16_f32 v66, v79, v87
    v_cvt_pk_bf16_f32 v70, v82, v90
    v_cvt_pk_bf16_f32 v74, v80, v88
    v_lshlrev_b32 v76, 16, v19
    v_and_b32 v84, s25, v19
    v_lshlrev_b32 v77, 16, v23
    v_and_b32 v85, s25, v23
    v_lshlrev_b32 v78, 16, v27
    v_and_b32 v86, s25, v27
    v_lshlrev_b32 v79, 16, v31
    v_and_b32 v87, s25, v31
    v_add_f32 v80, v76, v78
    v_add_f32 v88, v84, v86
    v_add_f32 v81, v77, v79
    v_add_f32 v89, v85, v87
    v_fma_f32 v82, v78, 4.0, v76
    v_fma_f32 v90, v86, 4.0, v84
    v_fma_f32 v83, v79, 4.0, v77
    v_fma_f32 v91, v87, 4.0, v85
    v_add_f32 v77, v80, v81
    v_add_f32 v85, v88, v89
    v_sub_f32 v78, v80, v81
    v_sub_f32 v86, v88, v89
    v_fma_f32 v79, v83, 2.0, v82
    v_fma_f32 v87, v91, 2.0, v90
    v_fma_f32 v82, v83, -2.0, v82
    v_fma_f32 v90, v91, -2.0, v90
    v_fmamk_f32 v80, v76, 0x41700000, v82
    v_fmamk_f32 v88, v84, 0x41700000, v90
    v_fmamk_f32 v80, v81, 0x41200000, v80
    v_fmamk_f32 v88, v89, 0x41200000, v88
    v_cvt_pk_bf16_f32 v23, v77, v85
    v_cvt_pk_bf16_f32 v27, v78, v86
    v_cvt_pk_bf16_f32 v67, v79, v87
    v_cvt_pk_bf16_f32 v71, v82, v90
    v_cvt_pk_bf16_f32 v75, v80, v88
    s_waitcnt lgkmcnt(0)
    ds_write_b128 v96, v[64:67] offset:57344
    ds_write_b128 v97, v[68:71] offset:8192
    ds_write_b128 v97, v[72:75] offset:24576
    ds_write_b128 v96, v[16:19] offset:8192
    ds_write_b128 v96, v[20:23] offset:24576
    ds_write_b128 v96, v[24:27] offset:40960
    ds_write_b128 v98, v[28:31] offset:8704
    s_add_u32 s28, s28, 1
    s_waitcnt lgkmcnt(0)
    s_barrier
    s_cmp_lt_u32 s28, 13
    s_cselect_b32 s24, 0, 2130706432
    s_waitcnt vmcnt(0)
    v_lshlrev_b32 v76, 16, v32
    v_and_b32 v84, s25, v32
    v_lshlrev_b32 v77, 16, v36
    v_and_b32 v85, s25, v36
    v_lshlrev_b32 v78, 16, v40
    v_and_b32 v86, s25, v40
    v_lshlrev_b32 v79, 16, v44
    v_and_b32 v87, s25, v44
    v_add_f32 v80, v76, v78
    v_add_f32 v88, v84, v86
    v_add_f32 v81, v77, v79
    v_add_f32 v89, v85, v87
    v_fma_f32 v82, v78, 4.0, v76
    v_fma_f32 v90, v86, 4.0, v84
    v_fma_f32 v83, v79, 4.0, v77
    v_fma_f32 v91, v87, 4.0, v85
    v_add_f32 v77, v80, v81
    v_add_f32 v85, v88, v89
    v_sub_f32 v78, v80, v81
    v_sub_f32 v86, v88, v89
    v_fma_f32 v79, v83, 2.0, v82
    v_fma_f32 v87, v91, 2.0, v90
    v_fma_f32 v82, v83, -2.0, v82
    v_fma_f32 v90, v91, -2.0, v90
    v_fmamk_f32 v80, v76, 0x41700000, v82
    v_fmamk_f32 v88, v84, 0x41700000, v90
    v_fmamk_f32 v80, v81, 0x41200000, v80
    v_fmamk_f32 v88, v89, 0x41200000, v88
    v_cvt_pk_bf16_f32 v36, v77, v85
    v_cvt_pk_bf16_f32 v40, v78, v86
    v_cvt_pk_bf16_f32 v64, v79, v87
    v_cvt_pk_bf16_f32 v68, v82, v90
    v_cvt_pk_bf16_f32 v72, v80, v88
    v_lshlrev_b32 v76, 16, v33
    v_and_b32 v84, s25, v33
    v_lshlrev_b32 v77, 16, v37
    v_and_b32 v85, s25, v37
    v_lshlrev_b32 v78, 16, v41
    v_and_b32 v86, s25, v41
    buffer_load_dwordx4 v[0:3], v92, s[8:11], s24 offen offset:0
    buffer_load_dwordx4 v[16:19], v92, s[8:11], s24 offen offset:64
    v_add_u32 v92, 128, v92
    v_lshlrev_b32 v79, 16, v45
    v_and_b32 v87, s25, v45
    v_add_f32 v80, v76, v78
    v_add_f32 v88, v84, v86
    v_add_f32 v81, v77, v79
    v_add_f32 v89, v85, v87
    v_fma_f32 v82, v78, 4.0, v76
    v_fma_f32 v90, v86, 4.0, v84
    v_fma_f32 v83, v79, 4.0, v77
    v_fma_f32 v91, v87, 4.0, v85
    v_add_f32 v77, v80, v81
    v_add_f32 v85, v88, v89
    v_sub_f32 v78, v80, v81
    v_sub_f32 v86, v88, v89
    v_fma_f32 v79, v83, 2.0, v82
    v_fma_f32 v87, v91, 2.0, v90
    v_fma_f32 v82, v83, -2.0, v82
    v_fma_f32 v90, v91, -2.0, v90
    v_fmamk_f32 v80, v76, 0x41700000, v82
    v_fmamk_f32 v88, v84, 0x41700000, v90
    v_fmamk_f32 v80, v81, 0x41200000, v80
    v_fmamk_f32 v88, v89, 0x41200000, v88
    v_cvt_pk_bf16_f32 v37, v77, v85
    v_cvt_pk_bf16_f32 v41, v78, v86
    v_cvt_pk_bf16_f32 v65, v79, v87
    v_cvt_pk_bf16_f32 v69, v82, v90
    v_cvt_pk_bf16_f32 v73, v80, v88
    v_lshlrev_b32 v76, 16, v34
    v_and_b32 v84, s25, v34
    v_lshlrev_b32 v77, 16, v38
    v_and_b32 v85, s25, v38
    v_lshlrev_b32 v78, 16, v42
    v_and_b32 v86, s25, v42
    v_lshlrev_b32 v79, 16, v46
    v_and_b32 v87, s25, v46
    v_add_f32 v80, v76, v78
    v_add_f32 v88, v84, v86
    v_add_f32 v81, v77, v79
    v_add_f32 v89, v85, v87
    v_fma_f32 v82, v78, 4.0, v76
    v_fma_f32 v90, v86, 4.0, v84
    v_fma_f32 v83, v79, 4.0, v77
    v_fma_f32 v91, v87, 4.0, v85
    v_add_f32 v77, v80, v81
    v_add_f32 v85, v88, v89
    v_sub_f32 v78, v80, v81
    v_sub_f32 v86, v88, v89
    v_fma_f32 v79, v83, 2.0, v82
    v_fma_f32 v87, v91, 2.0, v90
    v_fma_f32 v82, v83, -2.0, v82
    v_fma_f32 v90, v91, -2.0, v90
    v_fmamk_f32 v80, v76, 0x41700000, v82
    v_fmamk_f32 v88, v84, 0x41700000, v90
    buffer_load_dwordx4 v[4:7], v93, s[8:11], s24 offen offset:0
    buffer_load_dwordx4 v[20:23], v93, s[8:11], s24 offen offset:64
    v_add_u32 v93, 128, v93
    v_fmamk_f32 v80, v81, 0x41200000, v80
    v_fmamk_f32 v88, v89, 0x41200000, v88
    v_cvt_pk_bf16_f32 v38, v77, v85
    v_cvt_pk_bf16_f32 v42, v78, v86
    v_cvt_pk_bf16_f32 v66, v79, v87
    v_cvt_pk_bf16_f32 v70, v82, v90
    v_cvt_pk_bf16_f32 v74, v80, v88
    v_lshlrev_b32 v76, 16, v35
    v_and_b32 v84, s25, v35
    v_lshlrev_b32 v77, 16, v39
    v_and_b32 v85, s25, v39
    v_lshlrev_b32 v78, 16, v43
    v_and_b32 v86, s25, v43
    v_lshlrev_b32 v79, 16, v47
    v_and_b32 v87, s25, v47
    v_add_f32 v80, v76, v78
    v_add_f32 v88, v84, v86
    v_add_f32 v81, v77, v79
    v_add_f32 v89, v85, v87
    v_fma_f32 v82, v78, 4.0, v76
    v_fma_f32 v90, v86, 4.0, v84
    v_fma_f32 v83, v79, 4.0, v77
    v_fma_f32 v91, v87, 4.0, v85
    v_add_f32 v77, v80, v81
    v_add_f32 v85, v88, v89
    v_sub_f32 v78, v80, v81
    v_sub_f32 v86, v88, v89
    v_fma_f32 v79, v83, 2.0, v82
    v_fma_f32 v87, v91, 2.0, v90
    v_fma_f32 v82, v83, -2.0, v82
    v_fma_f32 v90, v91, -2.0, v90
    v_fmamk_f32 v80, v76, 0x41700000, v82
    v_fmamk_f32 v88, v84, 0x41700000, v90
    v_fmamk_f32 v80, v81, 0x41200000, v80
    v_fmamk_f32 v88, v89, 0x41200000, v88
    v_cvt_pk_bf16_f32 v39, v77, v85
    v_cvt_pk_bf16_f32 v43, v78, v86
    v_cvt_pk_bf16_f32 v67, v79, v87
    v_cvt_pk_bf16_f32 v71, v82, v90
    v_cvt_pk_bf16_f32 v75, v80, v88
    s_waitcnt lgkmcnt(0)
    ds_write_b128 v96, v[64:67] offset:49152
    ds_write_b128 v97, v[68:71] offset:0
    ds_write_b128 v97, v[72:75] offset:16384
    ds_write_b128 v96, v[32:35] offset:0
    ds_write_b128 v96, v[36:39] offset:16384
    ds_write_b128 v96, v[40:43] offset:32768
    ds_write_b128 v98, v[44:47] offset:0
    s_add_u32 s28, s28, 1
    s_waitcnt lgkmcnt(0)
    s_barrier
    s_cmp_lt_u32 s28, 13
    s_cselect_b32 s24, 0, 2130706432
    v_lshlrev_b32 v76, 16, v48
    v_and_b32 v84, s25, v48
    v_lshlrev_b32 v77, 16, v52
    v_and_b32 v85, s25, v52
    v_lshlrev_b32 v78, 16, v56
    v_and_b32 v86, s25, v56
    v_lshlrev_b32 v79, 16, v60
    v_and_b32 v87, s25, v60
    v_add_f32 v80, v76, v78
    v_add_f32 v88, v84, v86
    v_add_f32 v81, v77, v79
    v_add_f32 v89, v85, v87
    v_fma_f32 v82, v78, 4.0, v76
    buffer_load_dwordx4 v[8:11], v94, s[8:11], s24 offen offset:0
    buffer_load_dwordx4 v[24:27], v94, s[8:11], s24 offen offset:64
    v_add_u32 v94, 128, v94
    v_fma_f32 v90, v86, 4.0, v84
    v_fma_f32 v83, v79, 4.0, v77
    v_fma_f32 v91, v87, 4.0, v85
    v_add_f32 v77, v80, v81
    v_add_f32 v85, v88, v89
    v_sub_f32 v78, v80, v81
    v_sub_f32 v86, v88, v89
    v_fma_f32 v79, v83, 2.0, v82
    v_fma_f32 v87, v91, 2.0, v90
    v_fma_f32 v82, v83, -2.0, v82
    v_fma_f32 v90, v91, -2.0, v90
    v_fmamk_f32 v80, v76, 0x41700000, v82
    v_fmamk_f32 v88, v84, 0x41700000, v90
    v_fmamk_f32 v80, v81, 0x41200000, v80
    v_fmamk_f32 v88, v89, 0x41200000, v88
    v_cvt_pk_bf16_f32 v52, v77, v85
    v_cvt_pk_bf16_f32 v56, v78, v86
    v_cvt_pk_bf16_f32 v64, v79, v87
    v_cvt_pk_bf16_f32 v68, v82, v90
    v_cvt_pk_bf16_f32 v72, v80, v88
    v_lshlrev_b32 v76, 16, v49
    v_and_b32 v84, s25, v49
    v_lshlrev_b32 v77, 16, v53
    v_and_b32 v85, s25, v53
    v_lshlrev_b32 v78, 16, v57
    v_and_b32 v86, s25, v57
    v_lshlrev_b32 v79, 16, v61
    v_and_b32 v87, s25, v61
    v_add_f32 v80, v76, v78
    v_add_f32 v88, v84, v86
    v_add_f32 v81, v77, v79
    v_add_f32 v89, v85, v87
    v_fma_f32 v82, v78, 4.0, v76
    v_fma_f32 v90, v86, 4.0, v84
    v_fma_f32 v83, v79, 4.0, v77
    v_fma_f32 v91, v87, 4.0, v85
    v_add_f32 v77, v80, v81
    v_add_f32 v85, v88, v89
    v_sub_f32 v78, v80, v81
    v_sub_f32 v86, v88, v89
    v_fma_f32 v79, v83, 2.0, v82
    v_fma_f32 v87, v91, 2.0, v90
    v_fma_f32 v82, v83, -2.0, v82
    v_fma_f32 v90, v91, -2.0, v90
    v_fmamk_f32 v80, v76, 0x41700000, v82
    v_fmamk_f32 v88, v84, 0x41700000, v90
    v_fmamk_f32 v80, v81, 0x41200000, v80
    v_fmamk_f32 v88, v89, 0x41200000, v88
    v_cvt_pk_bf16_f32 v53, v77, v85
    v_cvt_pk_bf16_f32 v57, v78, v86
    v_cvt_pk_bf16_f32 v65, v79, v87
    v_cvt_pk_bf16_f32 v69, v82, v90
    v_cvt_pk_bf16_f32 v73, v80, v88
    buffer_load_dwordx4 v[12:15], v95, s[8:11], s24 offen offset:0
    buffer_load_dwordx4 v[28:31], v95, s[8:11], s24 offen offset:64
    v_add_u32 v95, 128, v95
    v_lshlrev_b32 v76, 16, v50
    v_and_b32 v84, s25, v50
    v_lshlrev_b32 v77, 16, v54
    v_and_b32 v85, s25, v54
    v_lshlrev_b32 v78, 16, v58
    v_and_b32 v86, s25, v58
    v_lshlrev_b32 v79, 16, v62
    v_and_b32 v87, s25, v62
    v_add_f32 v80, v76, v78
    v_add_f32 v88, v84, v86
    v_add_f32 v81, v77, v79
    v_add_f32 v89, v85, v87
    v_fma_f32 v82, v78, 4.0, v76
    v_fma_f32 v90, v86, 4.0, v84
    v_fma_f32 v83, v79, 4.0, v77
    v_fma_f32 v91, v87, 4.0, v85
    v_add_f32 v77, v80, v81
    v_add_f32 v85, v88, v89
    v_sub_f32 v78, v80, v81
    v_sub_f32 v86, v88, v89
    v_fma_f32 v79, v83, 2.0, v82
    v_fma_f32 v87, v91, 2.0, v90
    v_fma_f32 v82, v83, -2.0, v82
    v_fma_f32 v90, v91, -2.0, v90
    v_fmamk_f32 v80, v76, 0x41700000, v82
    v_fmamk_f32 v88, v84, 0x41700000, v90
    v_fmamk_f32 v80, v81, 0x41200000, v80
    v_fmamk_f32 v88, v89, 0x41200000, v88
    v_cvt_pk_bf16_f32 v54, v77, v85
    v_cvt_pk_bf16_f32 v58, v78, v86
    v_cvt_pk_bf16_f32 v66, v79, v87
    v_cvt_pk_bf16_f32 v70, v82, v90
    v_cvt_pk_bf16_f32 v74, v80, v88
    v_lshlrev_b32 v76, 16, v51
    v_and_b32 v84, s25, v51
    v_lshlrev_b32 v77, 16, v55
    v_and_b32 v85, s25, v55
    v_lshlrev_b32 v78, 16, v59
    v_and_b32 v86, s25, v59
    v_lshlrev_b32 v79, 16, v63
    v_and_b32 v87, s25, v63
    v_add_f32 v80, v76, v78
    v_add_f32 v88, v84, v86
    v_add_f32 v81, v77, v79
    v_add_f32 v89, v85, v87
    v_fma_f32 v82, v78, 4.0, v76
    v_fma_f32 v90, v86, 4.0, v84
    v_fma_f32 v83, v79, 4.0, v77
    v_fma_f32 v91, v87, 4.0, v85
    v_add_f32 v77, v80, v81
    v_add_f32 v85, v88, v89
    v_sub_f32 v78, v80, v81
    v_sub_f32 v86, v88, v89
    v_fma_f32 v79, v83, 2.0, v82
    v_fma_f32 v87, v91, 2.0, v90
    v_fma_f32 v82, v83, -2.0, v82
    v_fma_f32 v90, v91, -2.0, v90
    v_fmamk_f32 v80, v76, 0x41700000, v82
    v_fmamk_f32 v88, v84, 0x41700000, v90
    v_fmamk_f32 v80, v81, 0x41200000, v80
    v_fmamk_f32 v88, v89, 0x41200000, v88
    v_cvt_pk_bf16_f32 v55, v77, v85
    v_cvt_pk_bf16_f32 v59, v78, v86
    v_cvt_pk_bf16_f32 v67, v79, v87
    v_cvt_pk_bf16_f32 v71, v82, v90
    v_cvt_pk_bf16_f32 v75, v80, v88
    s_waitcnt lgkmcnt(0)
    ds_write_b128 v96, v[64:67] offset:57344
    ds_write_b128 v97, v[68:71] offset:8192
    ds_write_b128 v97, v[72:75] offset:24576
    ds_write_b128 v96, v[48:51] offset:8192
    ds_write_b128 v96, v[52:55] offset:24576
    ds_write_b128 v96, v[56:59] offset:40960
    ds_write_b128 v98, v[60:63] offset:8704
    s_add_u32 s28, s28, 1
    s_waitcnt lgkmcnt(0)
    s_barrier
    s_cmp_eq_u32 s22, 1
    s_cbranch_scc1 L_conv1_kernel_hlast1
    s_cmp_lt_u32 s28, 13
    s_cselect_b32 s24, 0, 2130706432
    s_waitcnt vmcnt(0)
    v_lshlrev_b32 v76, 16, v0
    v_and_b32 v84, s25, v0
    v_lshlrev_b32 v77, 16, v4
    v_and_b32 v85, s25, v4
    v_lshlrev_b32 v78, 16, v8
    v_and_b32 v86, s25, v8
    v_lshlrev_b32 v79, 16, v12
    v_and_b32 v87, s25, v12
    v_add_f32 v80, v76, v78
    v_add_f32 v88, v84, v86
    v_add_f32 v81, v77, v79
    v_add_f32 v89, v85, v87
    v_fma_f32 v82, v78, 4.0, v76
    v_fma_f32 v90, v86, 4.0, v84
    v_fma_f32 v83, v79, 4.0, v77
    v_fma_f32 v91, v87, 4.0, v85
    v_add_f32 v77, v80, v81
    v_add_f32 v85, v88, v89
    v_sub_f32 v78, v80, v81
    v_sub_f32 v86, v88, v89
    v_fma_f32 v79, v83, 2.0, v82
    v_fma_f32 v87, v91, 2.0, v90
    v_fma_f32 v82, v83, -2.0, v82
    v_fma_f32 v90, v91, -2.0, v90
    v_fmamk_f32 v80, v76, 0x41700000, v82
    v_fmamk_f32 v88, v84, 0x41700000, v90
    v_fmamk_f32 v80, v81, 0x41200000, v80
    v_fmamk_f32 v88, v89, 0x41200000, v88
    v_cvt_pk_bf16_f32 v4, v77, v85
    v_cvt_pk_bf16_f32 v8, v78, v86
    v_cvt_pk_bf16_f32 v64, v79, v87
    v_cvt_pk_bf16_f32 v68, v82, v90
    v_cvt_pk_bf16_f32 v72, v80, v88
    v_lshlrev_b32 v76, 16, v1
    v_and_b32 v84, s25, v1
    v_lshlrev_b32 v77, 16, v5
    v_and_b32 v85, s25, v5
    v_lshlrev_b32 v78, 16, v9
    v_and_b32 v86, s25, v9
    buffer_load_dwordx4 v[32:35], v92, s[8:11], s24 offen offset:0
    buffer_load_dwordx4 v[48:51], v92, s[8:11], s24 offen offset:64
    v_add_u32 v92, 128, v92
    v_lshlrev_b32 v79, 16, v13
    v_and_b32 v87, s25, v13
    v_add_f32 v80, v76, v78
    v_add_f32 v88, v84, v86
    v_add_f32 v81, v77, v79
    v_add_f32 v89, v85, v87
    v_fma_f32 v82, v78, 4.0, v76
    v_fma_f32 v90, v86, 4.0, v84
    v_fma_f32 v83, v79, 4.0, v77
    v_fma_f32 v91, v87, 4.0, v85
    v_add_f32 v77, v80, v81
    v_add_f32 v85, v88, v89
    v_sub_f32 v78, v80, v81
    v_sub_f32 v86, v88, v89
    v_fma_f32 v79, v83, 2.0, v82
    v_fma_f32 v87, v91, 2.0, v90
    v_fma_f32 v82, v83, -2.0, v82
    v_fma_f32 v90, v91, -2.0, v90
    v_fmamk_f32 v80, v76, 0x41700000, v82
    v_fmamk_f32 v88, v84, 0x41700000, v90
    v_fmamk_f32 v80, v81, 0x41200000, v80
    v_fmamk_f32 v88, v89, 0x41200000, v88
    v_cvt_pk_bf16_f32 v5, v77, v85
    v_cvt_pk_bf16_f32 v9, v78, v86
    v_cvt_pk_bf16_f32 v65, v79, v87
    v_cvt_pk_bf16_f32 v69, v82, v90
    v_cvt_pk_bf16_f32 v73, v80, v88
    v_lshlrev_b32 v76, 16, v2
    v_and_b32 v84, s25, v2
    v_lshlrev_b32 v77, 16, v6
    v_and_b32 v85, s25, v6
    v_lshlrev_b32 v78, 16, v10
    v_and_b32 v86, s25, v10
    v_lshlrev_b32 v79, 16, v14
    v_and_b32 v87, s25, v14
    v_add_f32 v80, v76, v78
    v_add_f32 v88, v84, v86
    v_add_f32 v81, v77, v79
    v_add_f32 v89, v85, v87
    v_fma_f32 v82, v78, 4.0, v76
    v_fma_f32 v90, v86, 4.0, v84
    v_fma_f32 v83, v79, 4.0, v77
    v_fma_f32 v91, v87, 4.0, v85
    v_add_f32 v77, v80, v81
    v_add_f32 v85, v88, v89
    v_sub_f32 v78, v80, v81
    v_sub_f32 v86, v88, v89
    v_fma_f32 v79, v83, 2.0, v82
    v_fma_f32 v87, v91, 2.0, v90
    v_fma_f32 v82, v83, -2.0, v82
    v_fma_f32 v90, v91, -2.0, v90
    v_fmamk_f32 v80, v76, 0x41700000, v82
    v_fmamk_f32 v88, v84, 0x41700000, v90
    buffer_load_dwordx4 v[36:39], v93, s[8:11], s24 offen offset:0
    buffer_load_dwordx4 v[52:55], v93, s[8:11], s24 offen offset:64
    v_add_u32 v93, 128, v93
    v_fmamk_f32 v80, v81, 0x41200000, v80
    v_fmamk_f32 v88, v89, 0x41200000, v88
    v_cvt_pk_bf16_f32 v6, v77, v85
    v_cvt_pk_bf16_f32 v10, v78, v86
    v_cvt_pk_bf16_f32 v66, v79, v87
    v_cvt_pk_bf16_f32 v70, v82, v90
    v_cvt_pk_bf16_f32 v74, v80, v88
    v_lshlrev_b32 v76, 16, v3
    v_and_b32 v84, s25, v3
    v_lshlrev_b32 v77, 16, v7
    v_and_b32 v85, s25, v7
    v_lshlrev_b32 v78, 16, v11
    v_and_b32 v86, s25, v11
    v_lshlrev_b32 v79, 16, v15
    v_and_b32 v87, s25, v15
    v_add_f32 v80, v76, v78
    v_add_f32 v88, v84, v86
    v_add_f32 v81, v77, v79
    v_add_f32 v89, v85, v87
    v_fma_f32 v82, v78, 4.0, v76
    v_fma_f32 v90, v86, 4.0, v84
    v_fma_f32 v83, v79, 4.0, v77
    v_fma_f32 v91, v87, 4.0, v85
    v_add_f32 v77, v80, v81
    v_add_f32 v85, v88, v89
    v_sub_f32 v78, v80, v81
    v_sub_f32 v86, v88, v89
    v_fma_f32 v79, v83, 2.0, v82
    v_fma_f32 v87, v91, 2.0, v90
    v_fma_f32 v82, v83, -2.0, v82
    v_fma_f32 v90, v91, -2.0, v90
    v_fmamk_f32 v80, v76, 0x41700000, v82
    v_fmamk_f32 v88, v84, 0x41700000, v90
    v_fmamk_f32 v80, v81, 0x41200000, v80
    v_fmamk_f32 v88, v89, 0x41200000, v88
    v_cvt_pk_bf16_f32 v7, v77, v85
    v_cvt_pk_bf16_f32 v11, v78, v86
    v_cvt_pk_bf16_f32 v67, v79, v87
    v_cvt_pk_bf16_f32 v71, v82, v90
    v_cvt_pk_bf16_f32 v75, v80, v88
    s_waitcnt lgkmcnt(0)
    ds_write_b128 v96, v[64:67] offset:49152
    ds_write_b128 v97, v[68:71] offset:0
    ds_write_b128 v97, v[72:75] offset:16384
    ds_write_b128 v96, v[0:3] offset:0
    ds_write_b128 v96, v[4:7] offset:16384
    ds_write_b128 v96, v[8:11] offset:32768
    ds_write_b128 v98, v[12:15] offset:0
    s_add_u32 s28, s28, 1
    s_waitcnt lgkmcnt(0)
    s_barrier
    s_sub_u32 s22, s22, 1
    s_branch L_conv1_kernel_hloop1
L_conv1_kernel_hlast1:
    s_branch L_conv1_kernel_end
L_conv1_kernel_h2:
    s_waitcnt lgkmcnt(0)
    ds_write_b128 v96, v[0:3] offset:0
    ds_write_b128 v98, v[12:15] offset:0
    v_lshlrev_b32 v76, 16, v0
    v_and_b32 v84, s25, v0
    v_lshlrev_b32 v77, 16, v4
    v_and_b32 v85, s25, v4
    v_lshlrev_b32 v78, 16, v8
    v_and_b32 v86, s25, v8
    v_lshlrev_b32 v79, 16, v12
    v_and_b32 v87, s25, v12
    v_add_f32 v80, v76, v78
    v_add_f32 v88, v84, v86
    v_add_f32 v81, v77, v79
    v_add_f32 v89, v85, v87
    v_fma_f32 v82, v78, 4.0, v76
    v_fma_f32 v90, v86, 4.0, v84
    v_fma_f32 v83, v79, 4.0, v77
    v_fma_f32 v91, v87, 4.0, v85
    v_add_f32 v77, v80, v81
    v_add_f32 v85, v88, v89
    v_sub_f32 v78, v80, v81
    v_sub_f32 v86, v88, v89
    v_fma_f32 v79, v83, 2.0, v82
    v_fma_f32 v87, v91, 2.0, v90
    v_fma_f32 v82, v83, -2.0, v82
    v_fma_f32 v90, v91, -2.0, v90
    v_fmamk_f32 v80, v76, 0x41700000, v82
    v_fmamk_f32 v88, v84, 0x41700000, v90
    v_fmamk_f32 v80, v81, 0x41200000, v80
    v_fmamk_f32 v88, v89, 0x41200000, v88
    v_cvt_pk_bf16_f32 v4, v77, v85
    v_cvt_pk_bf16_f32 v8, v78, v86
    v_cvt_pk_bf16_f32 v64, v79, v87
    v_cvt_pk_bf16_f32 v68, v82, v90
    v_cvt_pk_bf16_f32 v72, v80, v88
    v_lshlrev_b32 v76, 16, v1
    v_and_b32 v84, s25, v1
    v_lshlrev_b32 v77, 16, v5
    v_and_b32 v85, s25, v5
    v_lshlrev_b32 v78, 16, v9
    v_and_b32 v86, s25, v9
    v_lshlrev_b32 v79, 16, v13
    v_and_b32 v87, s25, v13
    v_add_f32 v80, v76, v78
    v_add_f32 v88, v84, v86
    v_add_f32 v81, v77, v79
    v_add_f32 v89, v85, v87
    v_fma_f32 v82, v78, 4.0, v76
    v_fma_f32 v90, v86, 4.0, v84
    v_fma_f32 v83, v79, 4.0, v77
    v_fma_f32 v91, v87, 4.0, v85
    v_add_f32 v77, v80, v81
    v_add_f32 v85, v88, v89
    v_sub_f32 v78, v80, v81
    v_sub_f32 v86, v88, v89
    v_fma_f32 v79, v83, 2.0, v82
    v_fma_f32 v87, v91, 2.0, v90
    v_fma_f32 v82, v83, -2.0, v82
    v_fma_f32 v90, v91, -2.0, v90
    v_fmamk_f32 v80, v76, 0x41700000, v82
    v_fmamk_f32 v88, v84, 0x41700000, v90
    v_fmamk_f32 v80, v81, 0x41200000, v80
    v_fmamk_f32 v88, v89, 0x41200000, v88
    v_cvt_pk_bf16_f32 v5, v77, v85
    v_cvt_pk_bf16_f32 v9, v78, v86
    v_cvt_pk_bf16_f32 v65, v79, v87
    v_cvt_pk_bf16_f32 v69, v82, v90
    v_cvt_pk_bf16_f32 v73, v80, v88
    v_lshlrev_b32 v76, 16, v2
    v_and_b32 v84, s25, v2
    v_lshlrev_b32 v77, 16, v6
    v_and_b32 v85, s25, v6
    v_lshlrev_b32 v78, 16, v10
    v_and_b32 v86, s25, v10
    v_lshlrev_b32 v79, 16, v14
    v_and_b32 v87, s25, v14
    v_add_f32 v80, v76, v78
    v_add_f32 v88, v84, v86
    v_add_f32 v81, v77, v79
    v_add_f32 v89, v85, v87
    v_fma_f32 v82, v78, 4.0, v76
    v_fma_f32 v90, v86, 4.0, v84
    v_fma_f32 v83, v79, 4.0, v77
    v_fma_f32 v91, v87, 4.0, v85
    v_add_f32 v77, v80, v81
    v_add_f32 v85, v88, v89
    v_sub_f32 v78, v80, v81
    v_sub_f32 v86, v88, v89
    v_fma_f32 v79, v83, 2.0, v82
    v_fma_f32 v87, v91, 2.0, v90
    v_fma_f32 v82, v83, -2.0, v82
    v_fma_f32 v90, v91, -2.0, v90
    v_fmamk_f32 v80, v76, 0x41700000, v82
    v_fmamk_f32 v88, v84, 0x41700000, v90
    v_fmamk_f32 v80, v81, 0x41200000, v80
    v_fmamk_f32 v88, v89, 0x41200000, v88
    v_cvt_pk_bf16_f32 v6, v77, v85
    v_cvt_pk_bf16_f32 v10, v78, v86
    v_cvt_pk_bf16_f32 v66, v79, v87
    v_cvt_pk_bf16_f32 v70, v82, v90
    v_cvt_pk_bf16_f32 v74, v80, v88
    v_lshlrev_b32 v76, 16, v3
    v_and_b32 v84, s25, v3
    v_lshlrev_b32 v77, 16, v7
    v_and_b32 v85, s25, v7
    v_lshlrev_b32 v78, 16, v11
    v_and_b32 v86, s25, v11
    v_lshlrev_b32 v79, 16, v15
    v_and_b32 v87, s25, v15
    v_add_f32 v80, v76, v78
    v_add_f32 v88, v84, v86
    v_add_f32 v81, v77, v79
    v_add_f32 v89, v85, v87
    v_fma_f32 v82, v78, 4.0, v76
    v_fma_f32 v90, v86, 4.0, v84
    v_fma_f32 v83, v79, 4.0, v77
    v_fma_f32 v91, v87, 4.0, v85
    v_add_f32 v77, v80, v81
    v_add_f32 v85, v88, v89
    v_sub_f32 v78, v80, v81
    v_sub_f32 v86, v88, v89
    v_fma_f32 v79, v83, 2.0, v82
    v_fma_f32 v87, v91, 2.0, v90
    v_fma_f32 v82, v83, -2.0, v82
    v_fma_f32 v90, v91, -2.0, v90
    v_fmamk_f32 v80, v76, 0x41700000, v82
    v_fmamk_f32 v88, v84, 0x41700000, v90
    v_fmamk_f32 v80, v81, 0x41200000, v80
    v_fmamk_f32 v88, v89, 0x41200000, v88
    v_cvt_pk_bf16_f32 v7, v77, v85
    v_cvt_pk_bf16_f32 v11, v78, v86
    v_cvt_pk_bf16_f32 v67, v79, v87
    v_cvt_pk_bf16_f32 v71, v82, v90
    v_cvt_pk_bf16_f32 v75, v80, v88
    ds_write_b128 v96, v[4:7] offset:16384
    ds_write_b128 v96, v[8:11] offset:32768
    ds_write_b128 v96, v[64:67] offset:49152
    ds_write_b128 v97, v[68:71] offset:0
    ds_write_b128 v97, v[72:75] offset:16384
    buffer_load_dwordx4 v[32:35], v92, s[8:11], s24 offen offset:0
    buffer_load_dwordx4 v[48:51], v92, s[8:11], s24 offen offset:64
    v_add_u32 v92, 128, v92
    buffer_load_dwordx4 v[36:39], v93, s[8:11], s24 offen offset:0
    buffer_load_dwordx4 v[52:55], v93, s[8:11], s24 offen offset:64
    v_add_u32 v93, 128, v93
    buffer_load_dwordx4 v[40:43], v94, s[8:11], s24 offen offset:0
    buffer_load_dwordx4 v[56:59], v94, s[8:11], s24 offen offset:64
    v_add_u32 v94, 128, v94
    buffer_load_dwordx4 v[44:47], v95, s[8:11], s24 offen offset:0
    buffer_load_dwordx4 v[60:63], v95, s[8:11], s24 offen offset:64
    v_add_u32 v95, 128, v95
    s_waitcnt lgkmcnt(0)
    s_barrier
    s_setprio 0
    v_lshlrev_b32 v76, 16, v16
    v_and_b32 v84, s25, v16
    v_lshlrev_b32 v77, 16, v20
    v_and_b32 v85, s25, v20
    v_lshlrev_b32 v78, 16, v24
    v_and_b32 v86, s25, v24
    v_lshlrev_b32 v79, 16, v28
    v_and_b32 v87, s25, v28
    v_add_f32 v80, v76, v78
    v_add_f32 v88, v84, v86
    v_add_f32 v81, v77, v79
    v_add_f32 v89, v85, v87
    v_fma_f32 v82, v78, 4.0, v76
    v_fma_f32 v90, v86, 4.0, v84
    v_fma_f32 v83, v79, 4.0, v77
    v_fma_f32 v91, v87, 4.0, v85
    v_add_f32 v77, v80, v81
    v_add_f32 v85, v88, v89
    v_sub_f32 v78, v80, v81
    v_sub_f32 v86, v88, v89
    v_fma_f32 v79, v83, 2.0, v82
    v_fma_f32 v87, v91, 2.0, v90
    v_fma_f32 v82, v83, -2.0, v82
    v_fma_f32 v90, v91, -2.0, v90
    v_fmamk_f32 v80, v76, 0x41700000, v82
    v_fmamk_f32 v88, v84, 0x41700000, v90
    v_fmamk_f32 v80, v81, 0x41200000, v80
    v_fmamk_f32 v88, v89, 0x41200000, v88
    v_cvt_pk_bf16_f32 v20, v77, v85
    v_cvt_pk_bf16_f32 v24, v78, v86
    v_cvt_pk_bf16_f32 v64, v79, v87
    v_cvt_pk_bf16_f32 v68, v82, v90
    v_cvt_pk_bf16_f32 v72, v80, v88
    v_lshlrev_b32 v76, 16, v17
    v_and_b32 v84, s25, v17
    v_lshlrev_b32 v77, 16, v21
    v_and_b32 v85, s25, v21
    v_lshlrev_b32 v78, 16, v25
    v_and_b32 v86, s25, v25
    v_lshlrev_b32 v79, 16, v29
    v_and_b32 v87, s25, v29
    v_add_f32 v80, v76, v78
    v_add_f32 v88, v84, v86
    v_add_f32 v81, v77, v79
    v_add_f32 v89, v85, v87
    v_fma_f32 v82, v78, 4.0, v76
    v_fma_f32 v90, v86, 4.0, v84
    v_fma_f32 v83, v79, 4.0, v77
    v_fma_f32 v91, v87, 4.0, v85
    v_add_f32 v77, v80, v81
    v_add_f32 v85, v88, v89
    v_sub_f32 v78, v80, v81
    v_sub_f32 v86, v88, v89
    v_fma_f32 v79, v83, 2.0, v82
    v_fma_f32 v87, v91, 2.0, v90
    v_fma_f32 v82, v83, -2.0, v82
    v_fma_f32 v90, v91, -2.0, v90
    v_fmamk_f32 v80, v76, 0x41700000, v82
    v_fmamk_f32 v88, v84, 0x41700000, v90
    v_fmamk_f32 v80, v81, 0x41200000, v80
    v_fmamk_f32 v88, v89, 0x41200000, v88
    v_cvt_pk_bf16_f32 v21, v77, v85
    v_cvt_pk_bf16_f32 v25, v78, v86
    v_cvt_pk_bf16_f32 v65, v79, v87
    v_cvt_pk_bf16_f32 v69, v82, v90
    v_cvt_pk_bf16_f32 v73, v80, v88
    v_lshlrev_b32 v76, 16, v18
    v_and_b32 v84, s25, v18
    v_lshlrev_b32 v77, 16, v22
    v_and_b32 v85, s25, v22
    v_lshlrev_b32 v78, 16, v26
    v_and_b32 v86, s25, v26
    v_lshlrev_b32 v79, 16, v30
    v_and_b32 v87, s25, v30
    v_add_f32 v80, v76, v78
    v_add_f32 v88, v84, v86
    v_add_f32 v81, v77, v79
    v_add_f32 v89, v85, v87
    v_fma_f32 v82, v78, 4.0, v76
    v_fma_f32 v90, v86, 4.0, v84
    v_fma_f32 v83, v79, 4.0, v77
    v_fma_f32 v91, v87, 4.0, v85
    v_add_f32 v77, v80, v81
    v_add_f32 v85, v88, v89
    v_sub_f32 v78, v80, v81
    v_sub_f32 v86, v88, v89
    v_fma_f32 v79, v83, 2.0, v82
    v_fma_f32 v87, v91, 2.0, v90
    v_fma_f32 v82, v83, -2.0, v82
    v_fma_f32 v90, v91, -2.0, v90
    v_fmamk_f32 v80, v76, 0x41700000, v82
    v_fmamk_f32 v88, v84, 0x41700000, v90
    v_fmamk_f32 v80, v81, 0x41200000, v80
    v_fmamk_f32 v88, v89, 0x41200000, v88
    v_cvt_pk_bf16_f32 v22, v77, v85
    v_cvt_pk_bf16_f32 v26, v78, v86
    v_cvt_pk_bf16_f32 v66, v79, v87
    v_cvt_pk_bf16_f32 v70, v82, v90
    v_cvt_pk_bf16_f32 v74, v80, v88
    v_lshlrev_b32 v76, 16, v19
    v_and_b32 v84, s25, v19
    v_lshlrev_b32 v77, 16, v23
    v_and_b32 v85, s25, v23
    v_lshlrev_b32 v78, 16, v27
    v_and_b32 v86, s25, v27
    v_lshlrev_b32 v79, 16, v31
    v_and_b32 v87, s25, v31
    v_add_f32 v80, v76, v78
    v_add_f32 v88, v84, v86
    v_add_f32 v81, v77, v79
    v_add_f32 v89, v85, v87
    v_fma_f32 v82, v78, 4.0, v76
    v_fma_f32 v90, v86, 4.0, v84
    v_fma_f32 v83, v79, 4.0, v77
    v_fma_f32 v91, v87, 4.0, v85
    v_add_f32 v77, v80, v81
    v_add_f32 v85, v88, v89
    v_sub_f32 v78, v80, v81
    v_sub_f32 v86, v88, v89
    v_fma_f32 v79, v83, 2.0, v82
    v_fma_f32 v87, v91, 2.0, v90
    v_fma_f32 v82, v83, -2.0, v82
    v_fma_f32 v90, v91, -2.0, v90
    v_fmamk_f32 v80, v76, 0x41700000, v82
    v_fmamk_f32 v88, v84, 0x41700000, v90
    v_fmamk_f32 v80, v81, 0x41200000, v80
    v_fmamk_f32 v88, v89, 0x41200000, v88
    v_cvt_pk_bf16_f32 v23, v77, v85
    v_cvt_pk_bf16_f32 v27, v78, v86
    v_cvt_pk_bf16_f32 v67, v79, v87
    v_cvt_pk_bf16_f32 v71, v82, v90
    v_cvt_pk_bf16_f32 v75, v80, v88
L_conv1_kernel_hloop2:
    s_cmp_lt_u32 s28, 12
    s_cselect_b32 s24, 0, 2130706432
    ds_write_b128 v96, v[64:67] offset:57344
    ds_write_b128 v97, v[68:71] offset:8192
    ds_write_b128 v97, v[72:75] offset:24576
    ds_write_b128 v96, v[16:19] offset:8192
    ds_write_b128 v96, v[20:23] offset:24576
    ds_write_b128 v96, v[24:27] offset:40960
    ds_write_b128 v98, v[28:31] offset:8704
    s_waitcnt lgkmcnt(0)
    s_waitcnt vmcnt(0)
    v_lshlrev_b32 v76, 16, v32
    v_and_b32 v84, s25, v32
    v_lshlrev_b32 v77, 16, v36
    v_and_b32 v85, s25, v36
    v_lshlrev_b32 v78, 16, v40
    v_and_b32 v86, s25, v40
    v_lshlrev_b32 v79, 16, v44
    v_and_b32 v87, s25, v44
    v_add_f32 v80, v76, v78
    v_add_f32 v88, v84, v86
    v_add_f32 v81, v77, v79
    v_add_f32 v89, v85, v87
    v_fma_f32 v82, v78, 4.0, v76
    v_fma_f32 v90, v86, 4.0, v84
    v_fma_f32 v83, v79, 4.0, v77
    v_fma_f32 v91, v87, 4.0, v85
    v_add_f32 v77, v80, v81
    v_add_f32 v85, v88, v89
    v_sub_f32 v78, v80, v81
    v_sub_f32 v86, v88, v89
    v_fma_f32 v79, v83, 2.0, v82
    v_fma_f32 v87, v91, 2.0, v90
    v_fma_f32 v82, v83, -2.0, v82
    v_fma_f32 v90, v91, -2.0, v90
    v_fmamk_f32 v80, v76, 0x41700000, v82
    v_fmamk_f32 v88, v84, 0x41700000, v90
    v_fmamk_f32 v80, v81, 0x41200000, v80
    v_fmamk_f32 v88, v89, 0x41200000, v88
    v_cvt_pk_bf16_f32 v36, v77, v85
    v_cvt_pk_bf16_f32 v40, v78, v86
    v_cvt_pk_bf16_f32 v64, v79, v87
    v_cvt_pk_bf16_f32 v68, v82, v90
    v_cvt_pk_bf16_f32 v72, v80, v88
    v_lshlrev_b32 v76, 16, v33
    v_and_b32 v84, s25, v33
    v_lshlrev_b32 v77, 16, v37
    v_and_b32 v85, s25, v37
    v_lshlrev_b32 v78, 16, v41
    v_and_b32 v86, s25, v41
    buffer_load_dwordx4 v[0:3], v92, s[8:11], s24 offen offset:0
    buffer_load_dwordx4 v[16:19], v92, s[8:11], s24 offen offset:64
    v_add_u32 v92, 128, v92
    v_lshlrev_b32 v79, 16, v45
    v_and_b32 v87, s25, v45
    v_add_f32 v80, v76, v78
    v_add_f32 v88, v84, v86
    v_add_f32 v81, v77, v79
    v_add_f32 v89, v85, v87
    v_fma_f32 v82, v78, 4.0, v76
    v_fma_f32 v90, v86, 4.0, v84
    v_fma_f32 v83, v79, 4.0, v77
    v_fma_f32 v91, v87, 4.0, v85
    v_add_f32 v77, v80, v81
    v_add_f32 v85, v88, v89
    v_sub_f32 v78, v80, v81
    v_sub_f32 v86, v88, v89
    v_fma_f32 v79, v83, 2.0, v82
    v_fma_f32 v87, v91, 2.0, v90
    v_fma_f32 v82, v83, -2.0, v82
    v_fma_f32 v90, v91, -2.0, v90
    v_fmamk_f32 v80, v76, 0x41700000, v82
    v_fmamk_f32 v88, v84, 0x41700000, v90
    v_fmamk_f32 v80, v81, 0x41200000, v80
    v_fmamk_f32 v88, v89, 0x41200000, v88
    v_cvt_pk_bf16_f32 v37, v77, v85
    v_cvt_pk_bf16_f32 v41, v78, v86
    v_cvt_pk_bf16_f32 v65, v79, v87
    v_cvt_pk_bf16_f32 v69, v82, v90
    v_cvt_pk_bf16_f32 v73, v80, v88
    v_lshlrev_b32 v76, 16, v34
    v_and_b32 v84, s25, v34
    v_lshlrev_b32 v77, 16, v38
    v_and_b32 v85, s25, v38
    v_lshlrev_b32 v78, 16, v42
    v_and_b32 v86, s25, v42
    v_lshlrev_b32 v79, 16, v46
    v_and_b32 v87, s25, v46
    v_add_f32 v80, v76, v78
    v_add_f32 v88, v84, v86
    v_add_f32 v81, v77, v79
    v_add_f32 v89, v85, v87
    v_fma_f32 v82, v78, 4.0, v76
    v_fma_f32 v90, v86, 4.0, v84
    v_fma_f32 v83, v79, 4.0, v77
    v_fma_f32 v91, v87, 4.0, v85
    v_add_f32 v77, v80, v81
    v_add_f32 v85, v88, v89
    v_sub_f32 v78, v80, v81
    v_sub_f32 v86, v88, v89
    v_fma_f32 v79, v83, 2.0, v82
    v_fma_f32 v87, v91, 2.0, v90
    v_fma_f32 v82, v83, -2.0, v82
    v_fma_f32 v90, v91, -2.0, v90
    v_fmamk_f32 v80, v76, 0x41700000, v82
    v_fmamk_f32 v88, v84, 0x41700000, v90
    buffer_load_dwordx4 v[4:7], v93, s[8:11], s24 offen offset:0
    buffer_load_dwordx4 v[20:23], v93, s[8:11], s24 offen offset:64
    v_add_u32 v93, 128, v93
    v_fmamk_f32 v80, v81, 0x41200000, v80
    v_fmamk_f32 v88, v89, 0x41200000, v88
    v_cvt_pk_bf16_f32 v38, v77, v85
    v_cvt_pk_bf16_f32 v42, v78, v86
    v_cvt_pk_bf16_f32 v66, v79, v87
    v_cvt_pk_bf16_f32 v70, v82, v90
    v_cvt_pk_bf16_f32 v74, v80, v88
    v_lshlrev_b32 v76, 16, v35
    v_and_b32 v84, s25, v35
    v_lshlrev_b32 v77, 16, v39
    v_and_b32 v85, s25, v39
    v_lshlrev_b32 v78, 16, v43
    v_and_b32 v86, s25, v43
    v_lshlrev_b32 v79, 16, v47
    v_and_b32 v87, s25, v47
    v_add_f32 v80, v76, v78
    v_add_f32 v88, v84, v86
    v_add_f32 v81, v77, v79
    v_add_f32 v89, v85, v87
    v_fma_f32 v82, v78, 4.0, v76
    v_fma_f32 v90, v86, 4.0, v84
    v_fma_f32 v83, v79, 4.0, v77
    v_fma_f32 v91, v87, 4.0, v85
    v_add_f32 v77, v80, v81
    v_add_f32 v85, v88, v89
    v_sub_f32 v78, v80, v81
    v_sub_f32 v86, v88, v89
    v_fma_f32 v79, v83, 2.0, v82
    v_fma_f32 v87, v91, 2.0, v90
    v_fma_f32 v82, v83, -2.0, v82
    v_fma_f32 v90, v91, -2.0, v90
    v_fmamk_f32 v80, v76, 0x41700000, v82
    v_fmamk_f32 v88, v84, 0x41700000, v90
    v_fmamk_f32 v80, v81, 0x41200000, v80
    v_fmamk_f32 v88, v89, 0x41200000, v88
    v_cvt_pk_bf16_f32 v39, v77, v85
    v_cvt_pk_bf16_f32 v43, v78, v86
    v_cvt_pk_bf16_f32 v67, v79, v87
    v_cvt_pk_bf16_f32 v71, v82, v90
    v_cvt_pk_bf16_f32 v75, v80, v88
    s_add_u32 s28, s28, 1
    s_waitcnt lgkmcnt(0)
    s_barrier
    s_cmp_lt_u32 s28, 12
    s_cselect_b32 s24, 0, 2130706432
    ds_write_b128 v96, v[64:67] offset:49152
    ds_write_b128 v97, v[68:71] offset:0
    ds_write_b128 v97, v[72:75] offset:16384
    ds_write_b128 v96, v[32:35] offset:0
    ds_write_b128 v96, v[36:39] offset:16384
    ds_write_b128 v96, v[40:43] offset:32768
    ds_write_b128 v98, v[44:47] offset:0
    s_waitcnt lgkmcnt(0)
    v_lshlrev_b32 v76, 16, v48
    v_and_b32 v84, s25, v48
    buffer_load_dwordx4 v[8:11], v94, s[8:11], s24 offen offset:0
    buffer_load_dwordx4 v[24:27], v94, s[8:11], s24 offen offset:64
    v_add_u32 v94, 128, v94
    v_lshlrev_b32 v77, 16, v52
    v_and_b32 v85, s25, v52
    v_lshlrev_b32 v78, 16, v56
    v_and_b32 v86, s25, v56
    v_lshlrev_b32 v79, 16, v60
    v_and_b32 v87, s25, v60
    v_add_f32 v80, v76, v78
    v_add_f32 v88, v84, v86
    v_add_f32 v81, v77, v79
    v_add_f32 v89, v85, v87
    v_fma_f32 v82, v78, 4.0, v76
    v_fma_f32 v90, v86, 4.0, v84
    v_fma_f32 v83, v79, 4.0, v77
    v_fma_f32 v91, v87, 4.0, v85
    v_add_f32 v77, v80, v81
    v_add_f32 v85, v88, v89
    v_sub_f32 v78, v80, v81
    buffer_load_dwordx4 v[12:15], v95, s[8:11], s24 offen offset:0
    buffer_load_dwordx4 v[28:31], v95, s[8:11], s24 offen offset:64
    v_add_u32 v95, 128, v95
    v_sub_f32 v86, v88, v89
    v_fma_f32 v79, v83, 2.0, v82
    v_fma_f32 v87, v91, 2.0, v90
    v_fma_f32 v82, v83, -2.0, v82
    v_fma_f32 v90, v91, -2.0, v90
    v_fmamk_f32 v80, v76, 0x41700000, v82
    v_fmamk_f32 v88, v84, 0x41700000, v90
    v_fmamk_f32 v80, v81, 0x41200000, v80
    v_fmamk_f32 v88, v89, 0x41200000, v88
    v_cvt_pk_bf16_f32 v52, v77, v85
    v_cvt_pk_bf16_f32 v56, v78, v86
    v_cvt_pk_bf16_f32 v64, v79, v87
    v_cvt_pk_bf16_f32 v68, v82, v90
    v_cvt_pk_bf16_f32 v72, v80, v88
    v_lshlrev_b32 v76, 16, v49
    v_and_b32 v84, s25, v49
    v_lshlrev_b32 v77, 16, v53
    v_and_b32 v85, s25, v53
    v_lshlrev_b32 v78, 16, v57
    v_and_b32 v86, s25, v57
    v_lshlrev_b32 v79, 16, v61
    v_and_b32 v87, s25, v61
    v_add_f32 v80, v76, v78
    v_add_f32 v88, v84, v86
    v_add_f32 v81, v77, v79
    v_add_f32 v89, v85, v87
    v_fma_f32 v82, v78, 4.0, v76
    v_fma_f32 v90, v86, 4.0, v84
    v_fma_f32 v83, v79, 4.0, v77
    v_fma_f32 v91, v87, 4.0, v85
    v_add_f32 v77, v80, v81
    v_add_f32 v85, v88, v89
    v_sub_f32 v78, v80, v81
    v_sub_f32 v86, v88, v89
    v_fma_f32 v79, v83, 2.0, v82
    v_fma_f32 v87, v91, 2.0, v90
    v_fma_f32 v82, v83, -2.0, v82
    v_fma_f32 v90, v91, -2.0, v90
    v_fmamk_f32 v80, v76, 0x41700000, v82
    v_fmamk_f32 v88, v84, 0x41700000, v90
    v_fmamk_f32 v80, v81, 0x41200000, v80
    v_fmamk_f32 v88, v89, 0x41200000, v88
    v_cvt_pk_bf16_f32 v53, v77, v85
    v_cvt_pk_bf16_f32 v57, v78, v86
    v_cvt_pk_bf16_f32 v65, v79, v87
    v_cvt_pk_bf16_f32 v69, v82, v90
    v_cvt_pk_bf16_f32 v73, v80, v88
    v_lshlrev_b32 v76, 16, v50
    v_and_b32 v84, s25, v50
    v_lshlrev_b32 v77, 16, v54
    v_and_b32 v85, s25, v54
    v_lshlrev_b32 v78, 16, v58
    v_and_b32 v86, s25, v58
    v_lshlrev_b32 v79, 16, v62
    v_and_b32 v87, s25, v62
    v_add_f32 v80, v76, v78
    v_add_f32 v88, v84, v86
    v_add_f32 v81, v77, v79
    v_add_f32 v89, v85, v87
    v_fma_f32 v82, v78, 4.0, v76
    v_fma_f32 v90, v86, 4.0, v84
    v_fma_f32 v83, v79, 4.0, v77
    v_fma_f32 v91, v87, 4.0, v85
    v_add_f32 v77, v80, v81
    v_add_f32 v85, v88, v89
    v_sub_f32 v78, v80, v81
    v_sub_f32 v86, v88, v89
    v_fma_f32 v79, v83, 2.0, v82
    v_fma_f32 v87, v91, 2.0, v90
    v_fma_f32 v82, v83, -2.0, v82
    v_fma_f32 v90, v91, -2.0, v90
    v_fmamk_f32 v80, v76, 0x41700000, v82
    v_fmamk_f32 v88, v84, 0x41700000, v90
    v_fmamk_f32 v80, v81, 0x41200000, v80
    v_fmamk_f32 v88, v89, 0x41200000, v88
    v_cvt_pk_bf16_f32 v54, v77, v85
    v_cvt_pk_bf16_f32 v58, v78, v86
    v_cvt_pk_bf16_f32 v66, v79, v87
    v_cvt_pk_bf16_f32 v70, v82, v90
    v_cvt_pk_bf16_f32 v74, v80, v88
    v_lshlrev_b32 v76, 16, v51
    v_and_b32 v84, s25, v51
    v_lshlrev_b32 v77, 16, v55
    v_and_b32 v85, s25, v55
    v_lshlrev_b32 v78, 16, v59
    v_and_b32 v86, s25, v59
    v_lshlrev_b32 v79, 16, v63
    v_and_b32 v87, s25, v63
    v_add_f32 v80, v76, v78
    v_add_f32 v88, v84, v86
    v_add_f32 v81, v77, v79
    v_add_f32 v89, v85, v87
    v_fma_f32 v82, v78, 4.0, v76
    v_fma_f32 v90, v86, 4.0, v84
    v_fma_f32 v83, v79, 4.0, v77
    v_fma_f32 v91, v87, 4.0, v85
    v_add_f32 v77, v80, v81
    v_add_f32 v85, v88, v89
    v_sub_f32 v78, v80, v81
    v_sub_f32 v86, v88, v89
    v_fma_f32 v79, v83, 2.0, v82
    v_fma_f32 v87, v91, 2.0, v90
    v_fma_f32 v82, v83, -2.0, v82
    v_fma_f32 v90, v91, -2.0, v90
    v_fmamk_f32 v80, v76, 0x41700000, v82
    v_fmamk_f32 v88, v84, 0x41700000, v90
    v_fmamk_f32 v80, v81, 0x41200000, v80
    v_fmamk_f32 v88, v89, 0x41200000, v88
    v_cvt_pk_bf16_f32 v55, v77, v85
    v_cvt_pk_bf16_f32 v59, v78, v86
    v_cvt_pk_bf16_f32 v67, v79, v87
    v_cvt_pk_bf16_f32 v71, v82, v90
    v_cvt_pk_bf16_f32 v75, v80, v88
    s_add_u32 s28, s28, 1
    s_waitcnt lgkmcnt(0)
    s_barrier
    s_cmp_eq_u32 s22, 1
    s_cbranch_scc1 L_conv1_kernel_hlast2
    s_cmp_lt_u32 s28, 12
    s_cselect_b32 s24, 0, 2130706432
    ds_write_b128 v96, v[64:67] offset:57344
    ds_write_b128 v97, v[68:71] offset:8192
    ds_write_b128 v97, v[72:75] offset:24576
    ds_write_b128 v96, v[48:51] offset:8192
    ds_write_b128 v96, v[52:55] offset:24576
    ds_write_b128 v96, v[56:59] offset:40960
    ds_write_b128 v98, v[60:63] offset:8704
    s_waitcnt lgkmcnt(0)
    s_waitcnt vmcnt(0)
    v_lshlrev_b32 v76, 16, v0
    v_and_b32 v84, s25, v0
    v_lshlrev_b32 v77, 16, v4
    v_and_b32 v85, s25, v4
    v_lshlrev_b32 v78, 16, v8
    v_and_b32 v86, s25, v8
    v_lshlrev_b32 v79, 16, v12
    v_and_b32 v87, s25, v12
    v_add_f32 v80, v76, v78
    v_add_f32 v88, v84, v86
    v_add_f32 v81, v77, v79
    v_add_f32 v89, v85, v87
    v_fma_f32 v82, v78, 4.0, v76
    v_fma_f32 v90, v86, 4.0, v84
    v_fma_f32 v83, v79, 4.0, v77
    v_fma_f32 v91, v87, 4.0, v85
    v_add_f32 v77, v80, v81
    v_add_f32 v85, v88, v89
    v_sub_f32 v78, v80, v81
    v_sub_f32 v86, v88, v89
    v_fma_f32 v79, v83, 2.0, v82
    v_fma_f32 v87, v91, 2.0, v90
    v_fma_f32 v82, v83, -2.0, v82
    v_fma_f32 v90, v91, -2.0, v90
    v_fmamk_f32 v80, v76, 0x41700000, v82
    v_fmamk_f32 v88, v84, 0x41700000, v90
    v_fmamk_f32 v80, v81, 0x41200000, v80
    v_fmamk_f32 v88, v89, 0x41200000, v88
    v_cvt_pk_bf16_f32 v4, v77, v85
    v_cvt_pk_bf16_f32 v8, v78, v86
    v_cvt_pk_bf16_f32 v64, v79, v87
    v_cvt_pk_bf16_f32 v68, v82, v90
    v_cvt_pk_bf16_f32 v72, v80, v88
    v_lshlrev_b32 v76, 16, v1
    v_and_b32 v84, s25, v1
    v_lshlrev_b32 v77, 16, v5
    v_and_b32 v85, s25, v5
    v_lshlrev_b32 v78, 16, v9
    v_and_b32 v86, s25, v9
    buffer_load_dwordx4 v[32:35], v92, s[8:11], s24 offen offset:0
    buffer_load_dwordx4 v[48:51], v92, s[8:11], s24 offen offset:64
    v_add_u32 v92, 128, v92
    v_lshlrev_b32 v79, 16, v13
    v_and_b32 v87, s25, v13
    v_add_f32 v80, v76, v78
    v_add_f32 v88, v84, v86
    v_add_f32 v81, v77, v79
    v_add_f32 v89, v85, v87
    v_fma_f32 v82, v78, 4.0, v76
    v_fma_f32 v90, v86, 4.0, v84
    v_fma_f32 v83, v79, 4.0, v77
    v_fma_f32 v91, v87, 4.0, v85
    v_add_f32 v77, v80, v81
    v_add_f32 v85, v88, v89
    v_sub_f32 v78, v80, v81
    v_sub_f32 v86, v88, v89
    v_fma_f32 v79, v83, 2.0, v82
    v_fma_f32 v87, v91, 2.0, v90
    v_fma_f32 v82, v83, -2.0, v82
    v_fma_f32 v90, v91, -2.0, v90
    v_fmamk_f32 v80, v76, 0x41700000, v82
    v_fmamk_f32 v88, v84, 0x41700000, v90
    v_fmamk_f32 v80, v81, 0x41200000, v80
    v_fmamk_f32 v88, v89, 0x41200000, v88
    v_cvt_pk_bf16_f32 v5, v77, v85
    v_cvt_pk_bf16_f32 v9, v78, v86
    v_cvt_pk_bf16_f32 v65, v79, v87
    v_cvt_pk_bf16_f32 v69, v82, v90
    v_cvt_pk_bf16_f32 v73, v80, v88
    v_lshlrev_b32 v76, 16, v2
    v_and_b32 v84, s25, v2
    v_lshlrev_b32 v77, 16, v6
    v_and_b32 v85, s25, v6
    v_lshlrev_b32 v78, 16, v10
    v_and_b32 v86, s25, v10
    v_lshlrev_b32 v79, 16, v14
    v_and_b32 v87, s25, v14
    v_add_f32 v80, v76, v78
    v_add_f32 v88, v84, v86
    v_add_f32 v81, v77, v79
    v_add_f32 v89, v85, v87
    v_fma_f32 v82, v78, 4.0, v76
    v_fma_f32 v90, v86, 4.0, v84
    v_fma_f32 v83, v79, 4.0, v77
    v_fma_f32 v91, v87, 4.0, v85
    v_add_f32 v77, v80, v81
    v_add_f32 v85, v88, v89
    v_sub_f32 v78, v80, v81
    v_sub_f32 v86, v88, v89
    v_fma_f32 v79, v83, 2.0, v82
    v_fma_f32 v87, v91, 2.0, v90
    v_fma_f32 v82, v83, -2.0, v82
    v_fma_f32 v90, v91, -2.0, v90
    v_fmamk_f32 v80, v76, 0x41700000, v82
    v_fmamk_f32 v88, v84, 0x41700000, v90
    buffer_load_dwordx4 v[36:39], v93, s[8:11], s24 offen offset:0
    buffer_load_dwordx4 v[52:55], v93, s[8:11], s24 offen offset:64
    v_add_u32 v93, 128, v93
    v_fmamk_f32 v80, v81, 0x41200000, v80
    v_fmamk_f32 v88, v89, 0x41200000, v88
    v_cvt_pk_bf16_f32 v6, v77, v85
    v_cvt_pk_bf16_f32 v10, v78, v86
    v_cvt_pk_bf16_f32 v66, v79, v87
    v_cvt_pk_bf16_f32 v70, v82, v90
    v_cvt_pk_bf16_f32 v74, v80, v88
    v_lshlrev_b32 v76, 16, v3
    v_and_b32 v84, s25, v3
    v_lshlrev_b32 v77, 16, v7
    v_and_b32 v85, s25, v7
    v_lshlrev_b32 v78, 16, v11
    v_and_b32 v86, s25, v11
    v_lshlrev_b32 v79, 16, v15
    v_and_b32 v87, s25, v15
    v_add_f32 v80, v76, v78
    v_add_f32 v88, v84, v86
    v_add_f32 v81, v77, v79
    v_add_f32 v89, v85, v87
    v_fma_f32 v82, v78, 4.0, v76
    v_fma_f32 v90, v86, 4.0, v84
    v_fma_f32 v83, v79, 4.0, v77
    v_fma_f32 v91, v87, 4.0, v85
    v_add_f32 v77, v80, v81
    v_add_f32 v85, v88, v89
    v_sub_f32 v78, v80, v81
    v_sub_f32 v86, v88, v89
    v_fma_f32 v79, v83, 2.0, v82
    v_fma_f32 v87, v91, 2.0, v90
    v_fma_f32 v82, v83, -2.0, v82
    v_fma_f32 v90, v91, -2.0, v90
    v_fmamk_f32 v80, v76, 0x41700000, v82
    v_fmamk_f32 v88, v84, 0x41700000, v90
    v_fmamk_f32 v80, v81, 0x41200000, v80
    v_fmamk_f32 v88, v89, 0x41200000, v88
    v_cvt_pk_bf16_f32 v7, v77, v85
    v_cvt_pk_bf16_f32 v11, v78, v86
    v_cvt_pk_bf16_f32 v67, v79, v87
    v_cvt_pk_bf16_f32 v71, v82, v90
    v_cvt_pk_bf16_f32 v75, v80, v88
    s_add_u32 s28, s28, 1
    s_waitcnt lgkmcnt(0)
    s_barrier
    s_cmp_lt_u32 s28, 12
    s_cselect_b32 s24, 0, 2130706432
    ds_write_b128 v96, v[64:67] offset:49152
    ds_write_b128 v97, v[68:71] offset:0
    ds_write_b128 v97, v[72:75] offset:16384
    ds_write_b128 v96, v[0:3] offset:0
    ds_write_b128 v96, v[4:7] offset:16384
    ds_write_b128 v96, v[8:11] offset:32768
    ds_write_b128 v98, v[12:15] offset:0
    s_waitcnt lgkmcnt(0)
    v_lshlrev_b32 v76, 16, v16
    v_and_b32 v84, s25, v16
    buffer_load_dwordx4 v[40:43], v94, s[8:11], s24 offen offset:0
    buffer_load_dwordx4 v[56:59], v94, s[8:11], s24 offen offset:64
    v_add_u32 v94, 128, v94
    v_lshlrev_b32 v77, 16, v20
    v_and_b32 v85, s25, v20
    v_lshlrev_b32 v78, 16, v24
    v_and_b32 v86, s25, v24
    v_lshlrev_b32 v79, 16, v28
    v_and_b32 v87, s25, v28
    v_add_f32 v80, v76, v78
    v_add_f32 v88, v84, v86
    v_add_f32 v81, v77, v79
    v_add_f32 v89, v85, v87
    v_fma_f32 v82, v78, 4.0, v76
    v_fma_f32 v90, v86, 4.0, v84
    v_fma_f32 v83, v79, 4.0, v77
    v_fma_f32 v91, v87, 4.0, v85
    v_add_f32 v77, v80, v81
    v_add_f32 v85, v88, v89
    v_sub_f32 v78, v80, v81
    buffer_load_dwordx4 v[44:47], v95, s[8:11], s24 offen offset:0
    buffer_load_dwordx4 v[60:63], v95, s[8:11], s24 offen offset:64
    v_add_u32 v95, 128, v95
    v_sub_f32 v86, v88, v89
    v_fma_f32 v79, v83, 2.0, v82
    v_fma_f32 v87, v91, 2.0, v90
    v_fma_f32 v82, v83, -2.0, v82
    v_fma_f32 v90, v91, -2.0, v90
    v_fmamk_f32 v80, v76, 0x41700000, v82
    v_fmamk_f32 v88, v84, 0x41700000, v90
    v_fmamk_f32 v80, v81, 0x41200000, v80
    v_fmamk_f32 v88, v89, 0x41200000, v88
    v_cvt_pk_bf16_f32 v20, v77, v85
    v_cvt_pk_bf16_f32 v24, v78, v86
    v_cvt_pk_bf16_f32 v64, v79, v87
    v_cvt_pk_bf16_f32 v68, v82, v90
    v_cvt_pk_bf16_f32 v72, v80, v88
    v_lshlrev_b32 v76, 16, v17
    v_and_b32 v84, s25, v17
    v_lshlrev_b32 v77, 16, v21
    v_and_b32 v85, s25, v21
    v_lshlrev_b32 v78, 16, v25
    v_and_b32 v86, s25, v25
    v_lshlrev_b32 v79, 16, v29
    v_and_b32 v87, s25, v29
    v_add_f32 v80, v76, v78
    v_add_f32 v88, v84, v86
    v_add_f32 v81, v77, v79
    v_add_f32 v89, v85, v87
    v_fma_f32 v82, v78, 4.0, v76
    v_fma_f32 v90, v86, 4.0, v84
    v_fma_f32 v83, v79, 4.0, v77
    v_fma_f32 v91, v87, 4.0, v85
    v_add_f32 v77, v80, v81
    v_add_f32 v85, v88, v89
    v_sub_f32 v78, v80, v81
    v_sub_f32 v86, v88, v89
    v_fma_f32 v79, v83, 2.0, v82
    v_fma_f32 v87, v91, 2.0, v90
    v_fma_f32 v82, v83, -2.0, v82
    v_fma_f32 v90, v91, -2.0, v90
    v_fmamk_f32 v80, v76, 0x41700000, v82
    v_fmamk_f32 v88, v84, 0x41700000, v90
    v_fmamk_f32 v80, v81, 0x41200000, v80
    v_fmamk_f32 v88, v89, 0x41200000, v88
    v_cvt_pk_bf16_f32 v21, v77, v85
    v_cvt_pk_bf16_f32 v25, v78, v86
    v_cvt_pk_bf16_f32 v65, v79, v87
    v_cvt_pk_bf16_f32 v69, v82, v90
    v_cvt_pk_bf16_f32 v73, v80, v88
    v_lshlrev_b32 v76, 16, v18
    v_and_b32 v84, s25, v18
    v_lshlrev_b32 v77, 16, v22
    v_and_b32 v85, s25, v22
    v_lshlrev_b32 v78, 16, v26
    v_and_b32 v86, s25, v26
    v_lshlrev_b32 v79, 16, v30
    v_and_b32 v87, s25, v30
    v_add_f32 v80, v76, v78
    v_add_f32 v88, v84, v86
    v_add_f32 v81, v77, v79
    v_add_f32 v89, v85, v87
    v_fma_f32 v82, v78, 4.0, v76
    v_fma_f32 v90, v86, 4.0, v84
    v_fma_f32 v83, v79, 4.0, v77
    v_fma_f32 v91, v87, 4.0, v85
    v_add_f32 v77, v80, v81
    v_add_f32 v85, v88, v89
    v_sub_f32 v78, v80, v81
    v_sub_f32 v86, v88, v89
    v_fma_f32 v79, v83, 2.0, v82
    v_fma_f32 v87, v91, 2.0, v90
    v_fma_f32 v82, v83, -2.0, v82
    v_fma_f32 v90, v91, -2.0, v90
    v_fmamk_f32 v80, v76, 0x41700000, v82
    v_fmamk_f32 v88, v84, 0x41700000, v90
    v_fmamk_f32 v80, v81, 0x41200000, v80
    v_fmamk_f32 v88, v89, 0x41200000, v88
    v_cvt_pk_bf16_f32 v22, v77, v85
    v_cvt_pk_bf16_f32 v26, v78, v86
    v_cvt_pk_bf16_f32 v66, v79, v87
    v_cvt_pk_bf16_f32 v70, v82, v90
    v_cvt_pk_bf16_f32 v74, v80, v88
    v_lshlrev_b32 v76, 16, v19
    v_and_b32 v84, s25, v19
    v_lshlrev_b32 v77, 16, v23
    v_and_b32 v85, s25, v23
    v_lshlrev_b32 v78, 16, v27
    v_and_b32 v86, s25, v27
    v_lshlrev_b32 v79, 16, v31
    v_and_b32 v87, s25, v31
    v_add_f32 v80, v76, v78
    v_add_f32 v88, v84, v86
    v_add_f32 v81, v77, v79
    v_add_f32 v89, v85, v87
    v_fma_f32 v82, v78, 4.0, v76
    v_fma_f32 v90, v86, 4.0, v84
    v_fma_f32 v83, v79, 4.0, v77
    v_fma_f32 v91, v87, 4.0, v85
    v_add_f32 v77, v80, v81
    v_add_f32 v85, v88, v89
    v_sub_f32 v78, v80, v81
    v_sub_f32 v86, v88, v89
    v_fma_f32 v79, v83, 2.0, v82
    v_fma_f32 v87, v91, 2.0, v90
    v_fma_f32 v82, v83, -2.0, v82
    v_fma_f32 v90, v91, -2.0, v90
    v_fmamk_f32 v80, v76, 0x41700000, v82
    v_fmamk_f32 v88, v84, 0x41700000, v90
    v_fmamk_f32 v80, v81, 0x41200000, v80
    v_fmamk_f32 v88, v89, 0x41200000, v88
    v_cvt_pk_bf16_f32 v23, v77, v85
    v_cvt_pk_bf16_f32 v27, v78, v86
    v_cvt_pk_bf16_f32 v67, v79, v87
    v_cvt_pk_bf16_f32 v71, v82, v90
    v_cvt_pk_bf16_f32 v75, v80, v88
    s_add_u32 s28, s28, 1
    s_waitcnt lgkmcnt(0)
    s_barrier
    s_sub_u32 s22, s22, 1
    s_branch L_conv1_kernel_hloop2
L_conv1_kernel_hlast2:
    ds_write_b128 v96, v[64:67] offset:57344
    ds_write_b128 v97, v[68:71] offset:8192
    ds_write_b128 v97, v[72:75] offset:24576
    ds_write_b128 v96, v[48:51] offset:8192
    ds_write_b128 v96, v[52:55] offset:24576
    ds_write_b128 v96, v[56:59] offset:40960
    ds_write_b128 v98, v[60:63] offset:8704
    s_waitcnt vmcnt(0) lgkmcnt(0)
    s_mov_b32 s58, s20
    s_lshl_b32 s20, s2, 2
    s_add_u32 s20, s20, s32
    v_mov_b32 v1, v127
    s_load_dwordx2 s[8:9], s[0:1], 16
    s_lshr_b32 s22, s20, 8
    s_bfe_u32 s23, s20, 0x40004
    s_bfe_u32 s24, s20, 0x30001
    s_and_b32 s21, s20, 1
    v_lshrrev_b32 v2, 4, v1
    v_lshlrev_b32 v2, 12, v2
    v_and_b32 v3, 15, v1
    v_lshl_add_u32 v2, v3, 2, v2
    s_lshl_b32 s26, s22, 3
    s_lshr_b32 s27, s23, 3
    s_add_u32 s26, s26, s27
    s_lshl_b32 s26, s26, 17
    s_and_b32 s27, s23, 7
    s_lshl_b32 s27, s27, 14
    s_add_u32 s26, s26, s27
    s_lshl_b32 s27, s24, 6
    s_add_u32 s26, s26, s27
    s_mov_b32 s10, 4063232
    s_mov_b32 s11, 0x00020000
    s_add_u32 s37, s26, 262144
    s_add_u32 s38, s26, 524288
    s_add_u32 s39, s26, 786432
    s_waitcnt lgkmcnt(0)
    buffer_load_dword v16, v2, s[8:11], s26 offen offset:0
    buffer_load_dword v17, v2, s[8:11], s26 offen offset:512
    buffer_load_dword v24, v2, s[8:11], s37 offen offset:0
    buffer_load_dword v25, v2, s[8:11], s37 offen offset:512
    buffer_load_dword v32, v2, s[8:11], s38 offen offset:0
    buffer_load_dword v33, v2, s[8:11], s38 offen offset:512
    buffer_load_dword v40, v2, s[8:11], s39 offen offset:0
    buffer_load_dword v41, v2, s[8:11], s39 offen offset:512
    buffer_load_dword v18, v2, s[8:11], s26 offen offset:1024
    buffer_load_dword v19, v2, s[8:11], s26 offen offset:1536
    buffer_load_dword v26, v2, s[8:11], s37 offen offset:1024
    buffer_load_dword v27, v2, s[8:11], s37 offen offset:1536
    buffer_load_dword v34, v2, s[8:11], s38 offen offset:1024
    buffer_load_dword v35, v2, s[8:11], s38 offen offset:1536
    buffer_load_dword v42, v2, s[8:11], s39 offen offset:1024
    buffer_load_dword v43, v2, s[8:11], s39 offen offset:1536
    buffer_load_dword v20, v2, s[8:11], s26 offen offset:2048
    buffer_load_dword v21, v2, s[8:11], s26 offen offset:2560
    buffer_load_dword v28, v2, s[8:11], s37 offen offset:2048
    buffer_load_dword v29, v2, s[8:11], s37 offen offset:2560
    buffer_load_dword v36, v2, s[8:11], s38 offen offset:2048
    buffer_load_dword v37, v2, s[8:11], s38 offen offset:2560
    buffer_load_dword v44, v2, s[8:11], s39 offen offset:2048
    buffer_load_dword v45, v2, s[8:11], s39 offen offset:2560
    buffer_load_dword v22, v2, s[8:11], s26 offen offset:3072
    buffer_load_dword v23, v2, s[8:11], s26 offen offset:3584
    buffer_load_dword v30, v2, s[8:11], s37 offen offset:3072
    buffer_load_dword v31, v2, s[8:11], s37 offen offset:3584
    buffer_load_dword v38, v2, s[8:11], s38 offen offset:3072
    buffer_load_dword v39, v2, s[8:11], s38 offen offset:3584
    buffer_load_dword v46, v2, s[8:11], s39 offen offset:3072
    buffer_load_dword v47, v2, s[8:11], s39 offen offset:3584
    s_add_u32 s12, s30, 9437184
    s_addc_u32 s13, s31, 0
    s_mov_b32 s14, 7340032
    s_mov_b32 s15, 0x00020000
    v_lshlrev_b32 v4, 4, v1
    s_lshl_b32 s27, s24, 4
    s_add_u32 s27, s27, s23
    s_mul_i32 s27, s27, 57344
    s_lshl_b32 s28, s22, 11
    s_add_u32 s27, s27, s28
    s_lshl_b32 s28, s21, 10
    s_add_u32 s27, s27, s28
    s_cmp_eq_u32 s21, 0
    s_mov_b32 s32, 0x07060302
    s_cselect_b32 s32, 0x05040100, s32
    s_mov_b32 s33, 0x03020c0c
    s_cselect_b32 s33, 0x01000c0c, s33
    s_mov_b32 s35, 0x3d2aaaab
    s_mov_b32 s36, 0x3c638e39
    s_barrier
    s_waitcnt vmcnt(24)
    v_perm_b32 v72, v17, v16, s32
    v_perm_b32 v48, v41, v40, s32
    v_perm_b32 v76, v76, v40, s33
    v_perm_b32 v84, v84, v41, s33
    v_perm_b32 v77, v77, v32, s33
    v_perm_b32 v85, v85, v33, s33
    v_perm_b32 v78, v78, v24, s33
    v_perm_b32 v86, v86, v25, s33
    v_perm_b32 v79, v79, v16, s33
    v_perm_b32 v87, v87, v17, s33
    v_add_f32 v80, v76, v78
    v_add_f32 v88, v84, v86
    v_add_f32 v81, v77, v79
    v_add_f32 v89, v85, v87
    v_fma_f32 v82, v78, 4.0, v76
    v_fma_f32 v90, v86, 4.0, v84
    v_fma_f32 v83, v79, 4.0, v77
    v_fma_f32 v91, v87, 4.0, v85
    v_add_f32 v77, v80, v81
    v_add_f32 v85, v88, v89
    v_sub_f32 v78, v80, v81
    v_sub_f32 v86, v88, v89
    v_fma_f32 v79, v83, 2.0, v82
    v_fma_f32 v87, v91, 2.0, v90
    v_fma_f32 v82, v83, -2.0, v82
    v_fma_f32 v90, v91, -2.0, v90
    v_fmamk_f32 v80, v76, 0x41700000, v82
    v_fmamk_f32 v88, v84, 0x41700000, v90
    v_fmamk_f32 v80, v81, 0x41200000, v80
    v_fmamk_f32 v88, v89, 0x41200000, v88
    v_mul_f32 v77, 0.5, v77
    v_mul_f32 v85, 0.5, v85
    v_mul_f32 v78, 0.5, v78
    v_mul_f32 v86, 0.5, v86
    v_mul_f32 v79, s35, v79
    v_mul_f32 v87, s35, v87
    v_mul_f32 v82, s35, v82
    v_mul_f32 v90, s35, v90
    v_mul_f32 v80, s36, v80
    v_mul_f32 v88, s36, v88
    v_cvt_pk_bf16_f32 v52, v77, v85
    v_cvt_pk_bf16_f32 v56, v78, v86
    v_cvt_pk_bf16_f32 v60, v79, v87
    v_cvt_pk_bf16_f32 v64, v82, v90
    v_cvt_pk_bf16_f32 v68, v80, v88
    s_waitcnt vmcnt(16)
    v_perm_b32 v73, v19, v18, s32
    v_perm_b32 v49, v43, v42, s32
    v_perm_b32 v76, v76, v42, s33
    v_perm_b32 v84, v84, v43, s33
    v_perm_b32 v77, v77, v34, s33
    v_perm_b32 v85, v85, v35, s33
    v_perm_b32 v78, v78, v26, s33
    v_perm_b32 v86, v86, v27, s33
    v_perm_b32 v79, v79, v18, s33
    v_perm_b32 v87, v87, v19, s33
    v_add_f32 v80, v76, v78
    v_add_f32 v88, v84, v86
    v_add_f32 v81, v77, v79
    v_add_f32 v89, v85, v87
    v_fma_f32 v82, v78, 4.0, v76
    v_fma_f32 v90, v86, 4.0, v84
    v_fma_f32 v83, v79, 4.0, v77
    v_fma_f32 v91, v87, 4.0, v85
    v_add_f32 v77, v80, v81
    v_add_f32 v85, v88, v89
    v_sub_f32 v78, v80, v81
    v_sub_f32 v86, v88, v89
    v_fma_f32 v79, v83, 2.0, v82
    v_fma_f32 v87, v91, 2.0, v90
    v_fma_f32 v82, v83, -2.0, v82
    v_fma_f32 v90, v91, -2.0, v90
    v_fmamk_f32 v80, v76, 0x41700000, v82
    v_fmamk_f32 v88, v84, 0x41700000, v90
    v_fmamk_f32 v80, v81, 0x41200000, v80
    v_fmamk_f32 v88, v89, 0x41200000, v88
    v_mul_f32 v77, 0.5, v77
    v_mul_f32 v85, 0.5, v85
    v_mul_f32 v78, 0.5, v78
    v_mul_f32 v86, 0.5, v86
    v_mul_f32 v79, s35, v79
    v_mul_f32 v87, s35, v87
    v_mul_f32 v82, s35, v82
    v_mul_f32 v90, s35, v90
    v_mul_f32 v80, s36, v80
    v_mul_f32 v88, s36, v88
    v_cvt_pk_bf16_f32 v53, v77, v85
    v_cvt_pk_bf16_f32 v57, v78, v86
    v_cvt_pk_bf16_f32 v61, v79, v87
    v_cvt_pk_bf16_f32 v65, v82, v90
    v_cvt_pk_bf16_f32 v69, v80, v88
    s_waitcnt vmcnt(8)
    v_perm_b32 v74, v21, v20, s32
    v_perm_b32 v50, v45, v44, s32
    v_perm_b32 v76, v76, v44, s33
    v_perm_b32 v84, v84, v45, s33
    v_perm_b32 v77, v77, v36, s33
    v_perm_b32 v85, v85, v37, s33
    v_perm_b32 v78, v78, v28, s33
    v_perm_b32 v86, v86, v29, s33
    v_perm_b32 v79, v79, v20, s33
    v_perm_b32 v87, v87, v21, s33
    v_add_f32 v80, v76, v78
    v_add_f32 v88, v84, v86
    v_add_f32 v81, v77, v79
    v_add_f32 v89, v85, v87
    v_fma_f32 v82, v78, 4.0, v76
    v_fma_f32 v90, v86, 4.0, v84
    v_fma_f32 v83, v79, 4.0, v77
    v_fma_f32 v91, v87, 4.0, v85
    v_add_f32 v77, v80, v81
    v_add_f32 v85, v88, v89
    v_sub_f32 v78, v80, v81
    v_sub_f32 v86, v88, v89
    v_fma_f32 v79, v83, 2.0, v82
    v_fma_f32 v87, v91, 2.0, v90
    v_fma_f32 v82, v83, -2.0, v82
    v_fma_f32 v90, v91, -2.0, v90
    v_fmamk_f32 v80, v76, 0x41700000, v82
    v_fmamk_f32 v88, v84, 0x41700000, v90
    v_fmamk_f32 v80, v81, 0x41200000, v80
    v_fmamk_f32 v88, v89, 0x41200000, v88
    v_mul_f32 v77, 0.5, v77
    v_mul_f32 v85, 0.5, v85
    v_mul_f32 v78, 0.5, v78
    v_mul_f32 v86, 0.5, v86
    v_mul_f32 v79, s35, v79
    v_mul_f32 v87, s35, v87
    v_mul_f32 v82, s35, v82
    v_mul_f32 v90, s35, v90
    v_mul_f32 v80, s36, v80
    v_mul_f32 v88, s36, v88
    v_cvt_pk_bf16_f32 v54, v77, v85
    v_cvt_pk_bf16_f32 v58, v78, v86
    v_cvt_pk_bf16_f32 v62, v79, v87
    v_cvt_pk_bf16_f32 v66, v82, v90
    v_cvt_pk_bf16_f32 v70, v80, v88
    s_waitcnt vmcnt(0)
    v_perm_b32 v75, v23, v22, s32
    v_perm_b32 v51, v47, v46, s32
    v_perm_b32 v76, v76, v46, s33
    v_perm_b32 v84, v84, v47, s33
    v_perm_b32 v77, v77, v38, s33
    v_perm_b32 v85, v85, v39, s33
    v_perm_b32 v78, v78, v30, s33
    v_perm_b32 v86, v86, v31, s33
    v_perm_b32 v79, v79, v22, s33
    v_perm_b32 v87, v87, v23, s33
    v_add_f32 v80, v76, v78
    v_add_f32 v88, v84, v86
    v_add_f32 v81, v77, v79
    v_add_f32 v89, v85, v87
    v_fma_f32 v82, v78, 4.0, v76
    v_fma_f32 v90, v86, 4.0, v84
    v_fma_f32 v83, v79, 4.0, v77
    v_fma_f32 v91, v87, 4.0, v85
    v_add_f32 v77, v80, v81
    v_add_f32 v85, v88, v89
    v_sub_f32 v78, v80, v81
    v_sub_f32 v86, v88, v89
    v_fma_f32 v79, v83, 2.0, v82
    v_fma_f32 v87, v91, 2.0, v90
    v_fma_f32 v82, v83, -2.0, v82
    v_fma_f32 v90, v91, -2.0, v90
    v_fmamk_f32 v80, v76, 0x41700000, v82
    v_fmamk_f32 v88, v84, 0x41700000, v90
    v_fmamk_f32 v80, v81, 0x41200000, v80
    v_fmamk_f32 v88, v89, 0x41200000, v88
    v_mul_f32 v77, 0.5, v77
    v_mul_f32 v85, 0.5, v85
    v_mul_f32 v78, 0.5, v78
    v_mul_f32 v86, 0.5, v86
    v_mul_f32 v79, s35, v79
    v_mul_f32 v87, s35, v87
    v_mul_f32 v82, s35, v82
    v_mul_f32 v90, s35, v90
    v_mul_f32 v80, s36, v80
    v_mul_f32 v88, s36, v88
    v_cvt_pk_bf16_f32 v55, v77, v85
    v_cvt_pk_bf16_f32 v59, v78, v86
    v_cvt_pk_bf16_f32 v63, v79, v87
    v_cvt_pk_bf16_f32 v67, v82, v90
    v_cvt_pk_bf16_f32 v71, v80, v88
    s_add_u32 s28, s27, 49152
    buffer_store_dwordx4 v[72:75], v4, s[12:15], s28 offen sc1
    s_add_u32 s28, s27, 0
    buffer_store_dwordx4 v[48:51], v4, s[12:15], s28 offen sc1
    s_add_u32 s28, s27, 8192
    buffer_store_dwordx4 v[52:55], v4, s[12:15], s28 offen sc1
    s_add_u32 s28, s27, 16384
    buffer_store_dwordx4 v[56:59], v4, s[12:15], s28 offen sc1
    s_add_u32 s28, s27, 24576
    buffer_store_dwordx4 v[60:63], v4, s[12:15], s28 offen sc1
    s_add_u32 s28, s27, 32768
    buffer_store_dwordx4 v[64:67], v4, s[12:15], s28 offen sc1
    s_add_u32 s28, s27, 40960
    buffer_store_dwordx4 v[68:71], v4, s[12:15], s28 offen sc1
    s_mov_b32 s20, s58
    s_branch L_conv1_kernel_end
L_conv1_kernel_epi:
    v_and_b32 v108, 15, v127
    v_lshrrev_b32 v109, 4, v127
    v_lshrrev_b32 v110, 3, v108
    s_lshl_b32 s36, s20, 1
    v_add_u32 v110, s36, v110
    v_xor_b32 v111, v110, v108
    v_and_b32 v111, 7, v111
    v_lshlrev_b32 v111, 4, v111
    v_lshl_add_u32 v111, v110, 7, v111
    v_lshl_add_u32 v120, v109, 11, v111
    v_add_u32 v121, 65536, v120
    v_add_u32 v125, 131072, v120
    s_lshl_b32 s36, s20, 9
    s_add_u32 s36, s36, 115712
    v_lshl_add_u32 v123, v109, 7, s36
    s_lshl_b32 s36, s20, 4
    v_add_u32 v108, s36, v108
    v_lshl_add_u32 v110, v108, 2, s21
    v_lshlrev_b32 v110, 9, v110
    v_lshl_add_u32 v110, v109, 4, v110
    s_lshl_b32 s36, s29, 6
    v_add_u32 v110, s36, v110
    v_mov_b32 v111, 2130706432
    v_cmp_gt_u32 vcc, 125, v108
    s_mov_b32 s4, 0xbeaaaaab
    s_mov_b32 s5, s4
    s_mov_b32 s6, 0x3e800000
    s_mov_b32 s7, s6
    s_mov_b32 s8, 0xc0a00000
    s_mov_b32 s9, s8
    s_mov_b32 s10, 0xc0638e39
    s_mov_b32 s11, s10
    s_mov_b32 s12, 0xbf638e39
    s_mov_b32 s13, s12
    s_mov_b32 s14, 0xbe638e39
    s_mov_b32 s15, s14
    s_mov_b32 s22, 0xbd638e39
    s_mov_b32 s23, s22
    s_mov_b32 s24, 0x3ff1c71c
    s_mov_b32 s25, s24
    s_mov_b32 s26, 0xbf2aaaab
    s_mov_b32 s27, s26
    s_mov_b32 s32, 0x3ecccccd
    s_mov_b32 s33, s32
    s_mov_b32 s34, 0xbd888889
    s_mov_b32 s35, s34
    s_mov_b32 s38, 0xbe4ccccd
    s_mov_b32 s39, s38
    s_mov_b32 s40, 0xbdd2d3e8
    s_mov_b32 s41, s40
    s_mov_b32 s42, 0x3f800000
    s_mov_b32 s43, s42
    s_waitcnt lgkmcnt(0)
    s_barrier
    v_cndmask_b32 v122, v111, v110, vcc
    ds_read_b128 v[0:3], v120 offset:0
    ds_read_b128 v[4:7], v120 offset:16384
    ds_read_b128 v[8:11], v120 offset:32768
    ds_read_b128 v[12:15], v120 offset:49152
    ds_read_b128 v[16:19], v121 offset:0
    ds_read_b128 v[20:23], v121 offset:16384
    ds_read_b128 v[24:27], v121 offset:32768
    ds_read_b128 v[28:31], v125 offset:15360
    ds_read_b128 v[32:35], v120 offset:8192
    ds_read_b128 v[36:39], v120 offset:24576
    ds_read_b128 v[40:43], v120 offset:40960
    ds_read_b128 v[44:47], v120 offset:57344
    ds_read_b128 v[48:51], v121 offset:56320
    ds_read_b128 v[52:55], v121 offset:64512
    ds_read_b128 v[56:59], v125 offset:7168
    s_waitcnt lgkmcnt(7)
    ds_read_b128 v[60:63], v125 offset:23552
    s_waitcnt lgkmcnt(8)
    v_pk_add_f32 v[88:89], v[24:25], v[28:29]
    v_pk_add_f32 v[90:91], v[26:27], v[30:31]
    v_pk_add_f32 v[24:25], v[4:5], v[8:9]
    v_pk_add_f32 v[26:27], v[6:7], v[10:11]
    v_pk_add_f32 v[4:5], v[4:5], v[8:9] neg_lo:[0,1] neg_hi:[0,1]
    v_pk_add_f32 v[6:7], v[6:7], v[10:11] neg_lo:[0,1] neg_hi:[0,1]
    v_pk_add_f32 v[72:73], v[12:13], v[16:17]
    v_pk_add_f32 v[74:75], v[14:15], v[18:19]
    v_pk_add_f32 v[12:13], v[12:13], v[16:17] neg_lo:[0,1] neg_hi:[0,1]
    v_pk_add_f32 v[14:15], v[14:15], v[18:19] neg_lo:[0,1] neg_hi:[0,1]
    v_pk_fma_f32 v[72:73], v[24:25], s[4:5], v[72:73]
    v_pk_fma_f32 v[74:75], v[26:27], s[4:5], v[74:75]
    v_pk_fma_f32 v[20:21], v[0:1], s[10:11], v[20:21]
    v_pk_fma_f32 v[22:23], v[2:3], s[10:11], v[22:23]
    v_pk_fma_f32 v[72:73], v[0:1], s[6:7], v[72:73]
    v_pk_fma_f32 v[74:75], v[2:3], s[6:7], v[74:75]
    v_pk_add_f32 v[24:25], v[24:25], v[0:1] neg_lo:[0,1] neg_hi:[0,1]
    v_pk_add_f32 v[26:27], v[26:27], v[2:3] neg_lo:[0,1] neg_hi:[0,1]
    v_pk_fma_f32 v[72:73], v[88:89], s[8:9], v[72:73]
    v_pk_fma_f32 v[74:75], v[90:91], s[8:9], v[74:75]
    v_pk_add_f32 v[24:25], v[24:25], v[88:89] neg_lo:[0,1] neg_hi:[0,1]
    v_pk_add_f32 v[26:27], v[26:27], v[90:91] neg_lo:[0,1] neg_hi:[0,1]
    v_pk_fma_f32 v[20:21], v[88:89], s[22:23], v[20:21]
    v_pk_fma_f32 v[22:23], v[90:91], s[22:23], v[22:23]
    v_pk_add_f32 v[8:9], v[24:25], v[72:73] neg_lo:[0,1] neg_hi:[0,1]
    v_pk_add_f32 v[10:11], v[26:27], v[74:75] neg_lo:[0,1] neg_hi:[0,1]
    v_pk_fma_f32 v[20:21], v[72:73], s[14:15], v[20:21]
    v_pk_fma_f32 v[22:23], v[74:75], s[14:15], v[22:23]
    v_pk_mul_f32 v[80:81], v[12:13], s[32:33]
    v_pk_mul_f32 v[82:83], v[14:15], s[32:33]
    v_pk_fma_f32 v[20:21], v[8:9], s[12:13], v[20:21]
    v_pk_fma_f32 v[22:23], v[10:11], s[12:13], v[22:23]
    v_pk_fma_f32 v[80:81], v[4:5], s[34:35], v[80:81]
    v_pk_fma_f32 v[82:83], v[6:7], s[34:35], v[82:83]
    v_pk_fma_f32 v[64:65], v[4:5], s[24:25], v[20:21] neg_lo:[0,0,1] neg_hi:[0,0,1]
    v_pk_fma_f32 v[66:67], v[6:7], s[24:25], v[22:23] neg_lo:[0,0,1] neg_hi:[0,0,1]
    v_pk_fma_f32 v[64:65], v[12:13], s[26:27], v[64:65]
    v_pk_fma_f32 v[66:67], v[14:15], s[26:27], v[66:67]
    v_pk_fma_f32 v[80:81], v[64:65], s[38:39], v[80:81]
    v_pk_fma_f32 v[82:83], v[66:67], s[38:39], v[82:83]
    v_pk_add_f32 v[4:5], v[4:5], v[64:65] neg_lo:[0,1] neg_hi:[0,1]
    v_pk_add_f32 v[6:7], v[6:7], v[66:67] neg_lo:[0,1] neg_hi:[0,1]
    v_pk_add_f32 v[4:5], v[4:5], v[80:81] neg_lo:[0,1] neg_hi:[0,1]
    v_pk_add_f32 v[6:7], v[6:7], v[82:83] neg_lo:[0,1] neg_hi:[0,1]
    s_waitcnt lgkmcnt(0)
    v_pk_add_f32 v[92:93], v[56:57], v[60:61]
    v_pk_add_f32 v[94:95], v[58:59], v[62:63]
    v_pk_add_f32 v[56:57], v[36:37], v[40:41]
    v_pk_add_f32 v[58:59], v[38:39], v[42:43]
    v_pk_add_f32 v[36:37], v[36:37], v[40:41] neg_lo:[0,1] neg_hi:[0,1]
    v_pk_add_f32 v[38:39], v[38:39], v[42:43] neg_lo:[0,1] neg_hi:[0,1]
    v_pk_add_f32 v[76:77], v[44:45], v[48:49]
    v_pk_add_f32 v[78:79], v[46:47], v[50:51]
    v_pk_add_f32 v[44:45], v[44:45], v[48:49] neg_lo:[0,1] neg_hi:[0,1]
    v_pk_add_f32 v[46:47], v[46:47], v[50:51] neg_lo:[0,1] neg_hi:[0,1]
    v_pk_fma_f32 v[76:77], v[56:57], s[4:5], v[76:77]
    v_pk_fma_f32 v[78:79], v[58:59], s[4:5], v[78:79]
    v_pk_fma_f32 v[52:53], v[32:33], s[10:11], v[52:53]
    v_pk_fma_f32 v[54:55], v[34:35], s[10:11], v[54:55]
    v_pk_fma_f32 v[76:77], v[32:33], s[6:7], v[76:77]
    v_pk_fma_f32 v[78:79], v[34:35], s[6:7], v[78:79]
    v_pk_add_f32 v[56:57], v[56:57], v[32:33] neg_lo:[0,1] neg_hi:[0,1]
    v_pk_add_f32 v[58:59], v[58:59], v[34:35] neg_lo:[0,1] neg_hi:[0,1]
    v_pk_fma_f32 v[76:77], v[92:93], s[8:9], v[76:77]
    v_pk_fma_f32 v[78:79], v[94:95], s[8:9], v[78:79]
    v_pk_add_f32 v[56:57], v[56:57], v[92:93] neg_lo:[0,1] neg_hi:[0,1]
    v_pk_add_f32 v[58:59], v[58:59], v[94:95] neg_lo:[0,1] neg_hi:[0,1]
    v_pk_fma_f32 v[52:53], v[92:93], s[22:23], v[52:53]
    v_pk_fma_f32 v[54:55], v[94:95], s[22:23], v[54:55]
    v_pk_add_f32 v[40:41], v[56:57], v[76:77] neg_lo:[0,1] neg_hi:[0,1]
    v_pk_add_f32 v[42:43], v[58:59], v[78:79] neg_lo:[0,1] neg_hi:[0,1]
    v_pk_fma_f32 v[52:53], v[76:77], s[14:15], v[52:53]
    v_pk_fma_f32 v[54:55], v[78:79], s[14:15], v[54:55]
    v_pk_mul_f32 v[84:85], v[44:45], s[32:33]
    v_pk_mul_f32 v[86:87], v[46:47], s[32:33]
    v_pk_fma_f32 v[52:53], v[40:41], s[12:13], v[52:53]
    v_pk_fma_f32 v[54:55], v[42:43], s[12:13], v[54:55]
    v_pk_fma_f32 v[84:85], v[36:37], s[34:35], v[84:85]
    v_pk_fma_f32 v[86:87], v[38:39], s[34:35], v[86:87]
    v_pk_fma_f32 v[68:69], v[36:37], s[24:25], v[52:53] neg_lo:[0,0,1] neg_hi:[0,0,1]
    v_pk_fma_f32 v[70:71], v[38:39], s[24:25], v[54:55] neg_lo:[0,0,1] neg_hi:[0,0,1]
    v_pk_fma_f32 v[68:69], v[44:45], s[26:27], v[68:69]
    v_pk_fma_f32 v[70:71], v[46:47], s[26:27], v[70:71]
    v_pk_fma_f32 v[84:85], v[68:69], s[38:39], v[84:85]
    v_pk_fma_f32 v[86:87], v[70:71], s[38:39], v[86:87]
    v_pk_add_f32 v[36:37], v[36:37], v[68:69] neg_lo:[0,1] neg_hi:[0,1]
    v_pk_add_f32 v[38:39], v[38:39], v[70:71] neg_lo:[0,1] neg_hi:[0,1]
    v_pk_add_f32 v[36:37], v[36:37], v[84:85] neg_lo:[0,1] neg_hi:[0,1]
    v_pk_add_f32 v[38:39], v[38:39], v[86:87] neg_lo:[0,1] neg_hi:[0,1]
    s_mov_b32 s36, 0x00010001
    s_mov_b32 s37, 0x00010001
    s_mov_b64 exec, s[36:37]
    ds_write_b128 v123, v[0:3] offset:0
    ds_write_b128 v123, v[32:35] offset:16
    ds_write_b128 v123, v[4:7] offset:32
    ds_write_b128 v123, v[36:39] offset:48
    ds_write_b128 v123, v[8:11] offset:64
    ds_write_b128 v123, v[40:43] offset:80
    s_mov_b64 exec, -1
    v_mov_b32 v44, 0xc0135761
    v_mov_b32 v45, v44
    v_pk_mul_f32 v[16:17], v[64:65], v[64:65]
    v_pk_mul_f32 v[18:19], v[66:67], v[66:67]
    v_pk_mul_f32 v[20:21], v[68:69], v[68:69]
    v_pk_mul_f32 v[22:23], v[70:71], v[70:71]
    v_pk_fma_f32 v[16:17], v[16:17], s[40:41], v[44:45]
    v_pk_fma_f32 v[18:19], v[18:19], s[40:41], v[44:45]
    v_pk_fma_f32 v[20:21], v[20:21], s[40:41], v[44:45]
    v_pk_fma_f32 v[22:23], v[22:23], s[40:41], v[44:45]
    v_pk_mul_f32 v[16:17], v[16:17], v[64:65]
    v_pk_mul_f32 v[18:19], v[18:19], v[66:67]
    v_pk_mul_f32 v[20:21], v[20:21], v[68:69]
    v_pk_mul_f32 v[22:23], v[22:23], v[70:71]
    v_exp_f32 v16, v16
    v_exp_f32 v17, v17
    v_exp_f32 v18, v18
    v_exp_f32 v19, v19
    v_exp_f32 v20, v20
    v_exp_f32 v21, v21
    v_exp_f32 v22, v22
    v_exp_f32 v23, v23
    v_pk_add_f32 v[16:17], v[16:17], s[42:43]
    v_pk_add_f32 v[18:19], v[18:19], s[42:43]
    v_pk_add_f32 v[20:21], v[20:21], s[42:43]
    v_pk_add_f32 v[22:23], v[22:23], s[42:43]
    v_rcp_f32 v16, v16
    v_rcp_f32 v17, v17
    v_rcp_f32 v18, v18
    v_rcp_f32 v19, v19
    v_rcp_f32 v20, v20
    v_rcp_f32 v21, v21
    v_rcp_f32 v22, v22
    v_rcp_f32 v23, v23
    v_pk_mul_f32 v[64:65], v[64:65], v[16:17]
    v_pk_mul_f32 v[66:67], v[66:67], v[18:19]
    v_pk_mul_f32 v[68:69], v[68:69], v[20:21]
    v_pk_mul_f32 v[70:71], v[70:71], v[22:23]
    v_cvt_pk_bf16_f32 v48, v64, v68
    v_cvt_pk_bf16_f32 v49, v65, v69
    v_cvt_pk_bf16_f32 v50, v66, v70
    v_cvt_pk_bf16_f32 v51, v67, v71
    buffer_store_dwordx4 v[48:51], v122, s[16:19], 0 offen offset:0 sc1
    s_waitcnt lgkmcnt(0)
    s_barrier
    ds_read_b128 v[96:99], v123 offset:512
    ds_read_b128 v[100:103], v123 offset:528
    ds_read_b128 v[104:107], v123 offset:544
    ds_read_b128 v[108:111], v123 offset:560
    ds_read_b128 v[112:115], v123 offset:576
    ds_read_b128 v[116:119], v123 offset:592
    s_waitcnt lgkmcnt(4)
    v_mov_b32_dpp v96, v0 row_shl:1 row_mask:0xf bank_mask:0xf
    v_mov_b32_dpp v97, v1 row_shl:1 row_mask:0xf bank_mask:0xf
    v_mov_b32_dpp v98, v2 row_shl:1 row_mask:0xf bank_mask:0xf
    v_mov_b32_dpp v99, v3 row_shl:1 row_mask:0xf bank_mask:0xf
    v_mov_b32_dpp v100, v32 row_shl:1 row_mask:0xf bank_mask:0xf
    v_mov_b32_dpp v101, v33 row_shl:1 row_mask:0xf bank_mask:0xf
    v_mov_b32_dpp v102, v34 row_shl:1 row_mask:0xf bank_mask:0xf
    v_mov_b32_dpp v103, v35 row_shl:1 row_mask:0xf bank_mask:0xf
    v_pk_add_f32 v[72:73], v[72:73], v[96:97]
    v_pk_add_f32 v[74:75], v[74:75], v[98:99]
    v_pk_add_f32 v[76:77], v[76:77], v[100:101]
    v_pk_add_f32 v[78:79], v[78:79], v[102:103]
    v_pk_mul_f32 v[24:25], v[72:73], v[72:73]
    v_pk_mul_f32 v[26:27], v[74:75], v[74:75]
    v_pk_mul_f32 v[28:29], v[76:77], v[76:77]
    v_pk_mul_f32 v[30:31], v[78:79], v[78:79]
    v_pk_fma_f32 v[24:25], v[24:25], s[40:41], v[44:45]
    v_pk_fma_f32 v[26:27], v[26:27], s[40:41], v[44:45]
    v_pk_fma_f32 v[28:29], v[28:29], s[40:41], v[44:45]
    v_pk_fma_f32 v[30:31], v[30:31], s[40:41], v[44:45]
    v_pk_mul_f32 v[24:25], v[24:25], v[72:73]
    v_pk_mul_f32 v[26:27], v[26:27], v[74:75]
    v_pk_mul_f32 v[28:29], v[28:29], v[76:77]
    v_pk_mul_f32 v[30:31], v[30:31], v[78:79]
    v_exp_f32 v24, v24
    v_exp_f32 v25, v25
    v_exp_f32 v26, v26
    v_exp_f32 v27, v27
    v_exp_f32 v28, v28
    v_exp_f32 v29, v29
    v_exp_f32 v30, v30
    v_exp_f32 v31, v31
    v_pk_add_f32 v[24:25], v[24:25], s[42:43]
    v_pk_add_f32 v[26:27], v[26:27], s[42:43]
    v_pk_add_f32 v[28:29], v[28:29], s[42:43]
    v_pk_add_f32 v[30:31], v[30:31], s[42:43]
    v_rcp_f32 v24, v24
    v_rcp_f32 v25, v25
    v_rcp_f32 v26, v26
    v_rcp_f32 v27, v27
    v_rcp_f32 v28, v28
    v_rcp_f32 v29, v29
    v_rcp_f32 v30, v30
    v_rcp_f32 v31, v31
    v_pk_mul_f32 v[72:73], v[72:73], v[24:25]
    v_pk_mul_f32 v[74:75], v[74:75], v[26:27]
    v_pk_mul_f32 v[76:77], v[76:77], v[28:29]
    v_pk_mul_f32 v[78:79], v[78:79], v[30:31]
    v_cvt_pk_bf16_f32 v52, v72, v76
    v_cvt_pk_bf16_f32 v53, v73, v77
    v_cvt_pk_bf16_f32 v54, v74, v78
    v_cvt_pk_bf16_f32 v55, v75, v79
    buffer_store_dwordx4 v[52:55], v122, s[16:19], 0 offen offset:512 sc1
    s_waitcnt lgkmcnt(2)
    v_mov_b32_dpp v104, v4 row_shl:1 row_mask:0xf bank_mask:0xf
    v_mov_b32_dpp v105, v5 row_shl:1 row_mask:0xf bank_mask:0xf
    v_mov_b32_dpp v106, v6 row_shl:1 row_mask:0xf bank_mask:0xf
    v_mov_b32_dpp v107, v7 row_shl:1 row_mask:0xf bank_mask:0xf
    v_mov_b32_dpp v108, v36 row_shl:1 row_mask:0xf bank_mask:0xf
    v_mov_b32_dpp v109, v37 row_shl:1 row_mask:0xf bank_mask:0xf
    v_mov_b32_dpp v110, v38 row_shl:1 row_mask:0xf bank_mask:0xf
    v_mov_b32_dpp v111, v39 row_shl:1 row_mask:0xf bank_mask:0xf
    v_pk_add_f32 v[80:81], v[80:81], v[104:105]
    v_pk_add_f32 v[82:83], v[82:83], v[106:107]
    v_pk_add_f32 v[84:85], v[84:85], v[108:109]
    v_pk_add_f32 v[86:87], v[86:87], v[110:111]
    v_pk_mul_f32 v[16:17], v[80:81], v[80:81]
    v_pk_mul_f32 v[18:19], v[82:83], v[82:83]
    v_pk_mul_f32 v[20:21], v[84:85], v[84:85]
    v_pk_mul_f32 v[22:23], v[86:87], v[86:87]
    v_pk_fma_f32 v[16:17], v[16:17], s[40:41], v[44:45]
    v_pk_fma_f32 v[18:19], v[18:19], s[40:41], v[44:45]
    v_pk_fma_f32 v[20:21], v[20:21], s[40:41], v[44:45]
    v_pk_fma_f32 v[22:23], v[22:23], s[40:41], v[44:45]
    v_pk_mul_f32 v[16:17], v[16:17], v[80:81]
    v_pk_mul_f32 v[18:19], v[18:19], v[82:83]
    v_pk_mul_f32 v[20:21], v[20:21], v[84:85]
    v_pk_mul_f32 v[22:23], v[22:23], v[86:87]
    v_exp_f32 v16, v16
    v_exp_f32 v17, v17
    v_exp_f32 v18, v18
    v_exp_f32 v19, v19
    v_exp_f32 v20, v20
    v_exp_f32 v21, v21
    v_exp_f32 v22, v22
    v_exp_f32 v23, v23
    v_pk_add_f32 v[16:17], v[16:17], s[42:43]
    v_pk_add_f32 v[18:19], v[18:19], s[42:43]
    v_pk_add_f32 v[20:21], v[20:21], s[42:43]
    v_pk_add_f32 v[22:23], v[22:23], s[42:43]
    v_rcp_f32 v16, v16
    v_rcp_f32 v17, v17
    v_rcp_f32 v18, v18
    v_rcp_f32 v19, v19
    v_rcp_f32 v20, v20
    v_rcp_f32 v21, v21
    v_rcp_f32 v22, v22
    v_rcp_f32 v23, v23
    v_pk_mul_f32 v[80:81], v[80:81], v[16:17]
    v_pk_mul_f32 v[82:83], v[82:83], v[18:19]
    v_pk_mul_f32 v[84:85], v[84:85], v[20:21]
    v_pk_mul_f32 v[86:87], v[86:87], v[22:23]
    v_cvt_pk_bf16_f32 v56, v80, v84
    v_cvt_pk_bf16_f32 v57, v81, v85
    v_cvt_pk_bf16_f32 v58, v82, v86
    v_cvt_pk_bf16_f32 v59, v83, v87
    buffer_store_dwordx4 v[56:59], v122, s[16:19], 0 offen offset:1024 sc1
    s_waitcnt lgkmcnt(0)
    v_mov_b32_dpp v112, v8 row_shl:1 row_mask:0xf bank_mask:0xf
    v_mov_b32_dpp v113, v9 row_shl:1 row_mask:0xf bank_mask:0xf
    v_mov_b32_dpp v114, v10 row_shl:1 row_mask:0xf bank_mask:0xf
    v_mov_b32_dpp v115, v11 row_shl:1 row_mask:0xf bank_mask:0xf
    v_mov_b32_dpp v116, v40 row_shl:1 row_mask:0xf bank_mask:0xf
    v_mov_b32_dpp v117, v41 row_shl:1 row_mask:0xf bank_mask:0xf
    v_mov_b32_dpp v118, v42 row_shl:1 row_mask:0xf bank_mask:0xf
    v_mov_b32_dpp v119, v43 row_shl:1 row_mask:0xf bank_mask:0xf
    v_pk_add_f32 v[88:89], v[88:89], v[112:113]
    v_pk_add_f32 v[90:91], v[90:91], v[114:115]
    v_pk_add_f32 v[92:93], v[92:93], v[116:117]
    v_pk_add_f32 v[94:95], v[94:95], v[118:119]
    v_pk_mul_f32 v[24:25], v[88:89], v[88:89]
    v_pk_mul_f32 v[26:27], v[90:91], v[90:91]
    v_pk_mul_f32 v[28:29], v[92:93], v[92:93]
    v_pk_mul_f32 v[30:31], v[94:95], v[94:95]
    v_pk_fma_f32 v[24:25], v[24:25], s[40:41], v[44:45]
    v_pk_fma_f32 v[26:27], v[26:27], s[40:41], v[44:45]
    v_pk_fma_f32 v[28:29], v[28:29], s[40:41], v[44:45]
    v_pk_fma_f32 v[30:31], v[30:31], s[40:41], v[44:45]
    v_pk_mul_f32 v[24:25], v[24:25], v[88:89]
    v_pk_mul_f32 v[26:27], v[26:27], v[90:91]
    v_pk_mul_f32 v[28:29], v[28:29], v[92:93]
    v_pk_mul_f32 v[30:31], v[30:31], v[94:95]
    v_exp_f32 v24, v24
    v_exp_f32 v25, v25
    v_exp_f32 v26, v26
    v_exp_f32 v27, v27
    v_exp_f32 v28, v28
    v_exp_f32 v29, v29
    v_exp_f32 v30, v30
    v_exp_f32 v31, v31
    v_pk_add_f32 v[24:25], v[24:25], s[42:43]
    v_pk_add_f32 v[26:27], v[26:27], s[42:43]
    v_pk_add_f32 v[28:29], v[28:29], s[42:43]
    v_pk_add_f32 v[30:31], v[30:31], s[42:43]
    v_rcp_f32 v24, v24
    v_rcp_f32 v25, v25
    v_rcp_f32 v26, v26
    v_rcp_f32 v27, v27
    v_rcp_f32 v28, v28
    v_rcp_f32 v29, v29
    v_rcp_f32 v30, v30
    v_rcp_f32 v31, v31
    v_pk_mul_f32 v[88:89], v[88:89], v[24:25]
    v_pk_mul_f32 v[90:91], v[90:91], v[26:27]
    v_pk_mul_f32 v[92:93], v[92:93], v[28:29]
    v_pk_mul_f32 v[94:95], v[94:95], v[30:31]
    v_cvt_pk_bf16_f32 v60, v88, v92
    v_cvt_pk_bf16_f32 v61, v89, v93
    v_cvt_pk_bf16_f32 v62, v90, v94
    v_cvt_pk_bf16_f32 v63, v91, v95
    buffer_store_dwordx4 v[60:63], v122, s[16:19], 0 offen offset:1536 sc1
L_conv1_kernel_end:
L_conv1_kernel_done:
    s_endpgm
.globl conv2_kernel
.p2align 8
.type conv2_kernel,@function
conv2_kernel:
    s_cmp_ge_u32 s2, 256
    s_cbranch_scc1 L_conv2_kernel_done
    s_load_dwordx2 s[4:5], s[0:1], 72
    s_load_dwordx2 s[30:31], s[0:1], 72
    v_readfirstlane_b32 s20, v0
    s_lshr_b32 s20, s20, 6
    s_and_b32 s36, s2, 1
    s_lshl_b32 s36, s36, 2
    s_bfe_u32 s37, s2, 131075
    s_or_b32 s29, s36, s37
    s_bfe_u32 s36, s2, 131073
    s_lshl_b32 s36, s36, 3
    s_lshr_b32 s37, s2, 5
    s_or_b32 s36, s36, s37
    s_lshr_b32 s33, s36, 4
    s_and_b32 s34, s36, 7
    s_bfe_u32 s35, s36, 0x10003
    s_mul_i32 s21, s34, 500
    s_and_b32 s32, s20, 3
    v_and_b32 v127, 63, v0
    v_lshrrev_b32 v5, 2, v127
    v_and_b32 v6, 3, v127
    v_lshlrev_b32 v7, 15, v5
    v_lshl_add_u32 v7, v6, 4, v7
    s_lshl_b32 s41, s21, 10
    s_lshl_b32 s37, s33, 9
    s_add_u32 s41, s41, s37
    s_sub_u32 s41, s41, 7680
    s_and_b32 s42, s20, 7
    s_lshl_b32 s37, s42, 12
    s_add_u32 s37, s37, s41
    v_add_u32 v7, s37, v7
    s_mul_i32 s36, s35, 4096000
    s_add_u32 s36, s36, 18874368
    s_mov_b32 s10, 4096000
    s_mov_b32 s11, 0x00020000
    s_mov_b32 s25, 0xffff0000
    s_waitcnt lgkmcnt(0)
    s_add_u32 s8, s4, s36
    s_addc_u32 s9, s5, 0
    s_cmp_ge_u32 s20, 8
    s_cbranch_scc1 L_conv2_kernel_helper
    s_add_u32 s37, s41, 524288
    v_lshl_add_u32 v108, v127, 4, s37
    s_lshl_b32 s36, s29, 4
    s_lshl_b32 s37, s33, 3
    s_add_u32 s36, s36, s37
    s_mul_i32 s36, s36, 57344
    s_add_u32 s36, s36, 9437184
    s_add_u32 s12, s30, s36
    s_addc_u32 s13, s31, 0
    s_mov_b32 s14, 458752
    s_mov_b32 s15, 0x00020000
    s_mul_i32 s36, s35, 2048000
    s_add_u32 s36, s36, 27262976
    s_mul_i32 s37, s33, 8388608
    s_add_u32 s36, s36, s37
    s_add_u32 s16, s30, s36
    s_addc_u32 s17, s31, 0
    s_mov_b32 s18, 2048000
    s_mov_b32 s19, 0x00020000
    v_and_b32 v10, 15, v127
    v_lshrrev_b32 v11, 4, v127
    v_add_u32 v8, 0, v10
    v_and_b32 v16, 4, v8
    v_lshrrev_b32 v16, 1, v16
    v_xor_b32 v16, v11, v16
    v_lshlrev_b32 v16, 4, v16
    v_lshl_add_u32 v8, v8, 6, v16
    v_add_u32 v9, 1, v10
    v_and_b32 v16, 4, v9
    v_lshrrev_b32 v16, 1, v16
    v_xor_b32 v16, v11, v16
    v_lshlrev_b32 v16, 4, v16
    v_lshl_add_u32 v9, v9, 6, v16
    s_lshr_b32 s38, s32, 1
    s_and_b32 s39, s32, 1
    s_add_u32 s40, s38, 4
    s_lshl_b32 s43, s39, 10
    s_cmp_lt_u32 s20, 4
    s_cselect_b32 s40, s20, s40
    s_cselect_b32 s36, 0, s43
    s_lshl_b32 s37, s40, 13
    s_add_u32 s37, s37, s36
    v_lshl_add_u32 v125, v127, 4, s37
    s_mul_i32 s37, s40, 16384
    v_add_u32 v120, s37, v8
    v_add_u32 v121, s37, v9
    s_lshl_b32 s37, s40, 10
    s_add_u32 s37, s37, 115712
    v_lshl_add_u32 v16, v11, 4, s37
    v_cmp_eq_u32 vcc, 15, v10
    v_mov_b32 v17, 8192
    v_mov_b32 v18, 4294959104
    v_mov_b32 v19, 64
    v_cndmask_b32 v122, v121, v16, vcc
    v_cndmask_b32 v123, v17, v19, vcc
    v_cndmask_b32 v124, v18, v19, vcc
    v_lshl_add_u32 v126, v127, 4, s37
    s_mov_b32 s44, 0x3f800000
    s_mov_b32 s45, 0x00000000
    s_mov_b32 s46, 0x00000000
    s_cmp_eq_u32 s40, 1
    s_cselect_b32 s45, 0x3f800000, s45
    s_cselect_b32 s46, 0x3f800000, s46
    s_cmp_eq_u32 s40, 2
    s_cselect_b32 s45, 0xbf800000, s45
    s_cselect_b32 s46, 0x3f800000, s46
    s_cmp_eq_u32 s40, 3
    s_cselect_b32 s45, 0x40000000, s45
    s_cselect_b32 s46, 0x40800000, s46
    s_cmp_eq_u32 s40, 4
    s_cselect_b32 s45, 0xc0000000, s45
    s_cselect_b32 s46, 0x40800000, s46
    s_cmp_eq_u32 s40, 5
    s_cselect_b32 s44, 0x41800000, s44
    s_cselect_b32 s45, 0x41000000, s45
    s_cselect_b32 s46, 0x40800000, s46
    s_cmp_ge_u32 s20, 4
    s_cbranch_scc1 L_conv2_kernel_m2
    v_mov_b32 v0, 0
    v_mov_b32 v1, 0
    v_mov_b32 v2, 0
    v_mov_b32 v3, 0
    v_mov_b32 v4, 0
    v_mov_b32 v5, 0
    v_mov_b32 v6, 0
    v_mov_b32 v7, 0
    v_mov_b32 v8, 0
    v_mov_b32 v9, 0
    v_mov_b32 v10, 0
    v_mov_b32 v11, 0
    v_mov_b32 v12, 0
    v_mov_b32 v13, 0
    v_mov_b32 v14, 0
    v_mov_b32 v15, 0
    v_mov_b32 v16, 0
    v_mov_b32 v17, 0
    v_mov_b32 v18, 0
    v_mov_b32 v19, 0
    v_mov_b32 v20, 0
    v_mov_b32 v21, 0
    v_mov_b32 v22, 0
    v_mov_b32 v23, 0
    v_mov_b32 v24, 0
    v_mov_b32 v25, 0
    v_mov_b32 v26, 0
    v_mov_b32 v27, 0
    v_mov_b32 v28, 0
    v_mov_b32 v29, 0
    v_mov_b32 v30, 0
    v_mov_b32 v31, 0
    v_mov_b32 v32, 0
    v_mov_b32 v33, 0
    v_mov_b32 v34, 0
    v_mov_b32 v35, 0
    v_mov_b32 v36, 0
    v_mov_b32 v37, 0
    v_mov_b32 v38, 0
    v_mov_b32 v39, 0
    v_mov_b32 v40, 0
    v_mov_b32 v41, 0
    v_mov_b32 v42, 0
    v_mov_b32 v43, 0
    v_mov_b32 v44, 0
    v_mov_b32 v45, 0
    v_mov_b32 v46, 0
    v_mov_b32 v47, 0
    v_mov_b32 v48, 0
    v_mov_b32 v49, 0
    v_mov_b32 v50, 0
    v_mov_b32 v51, 0
    v_mov_b32 v52, 0
    v_mov_b32 v53, 0
    v_mov_b32 v54, 0
    v_mov_b32 v55, 0
    v_mov_b32 v56, 0
    v_mov_b32 v57, 0
    v_mov_b32 v58, 0
    v_mov_b32 v59, 0
    v_mov_b32 v60, 0
    v_mov_b32 v61, 0
    v_mov_b32 v62, 0
    v_mov_b32 v63, 0
    s_barrier
    buffer_load_dwordx4 v[96:99], v108, s[8:11], 0 offen offset:0
    buffer_load_dwordx4 v[100:103], v108, s[8:11], 0 offen offset:1024
    buffer_load_dwordx4 v[104:107], v108, s[8:11], 0 offen offset:2048
    s_mov_b32 s23, 0
    s_mov_b32 s26, 4096
    buffer_load_dwordx4 v[64:67], v125, s[12:15], s23 offen offset:0
    buffer_load_dwordx4 v[68:71], v125, s[12:15], s23 offen offset:1024
    buffer_load_dwordx4 v[72:75], v125, s[12:15], s23 offen offset:2048
    buffer_load_dwordx4 v[76:79], v125, s[12:15], s23 offen offset:3072
    buffer_load_dwordx4 v[80:83], v125, s[12:15], s26 offen offset:0
    buffer_load_dwordx4 v[84:87], v125, s[12:15], s26 offen offset:1024
    buffer_load_dwordx4 v[88:91], v125, s[12:15], s26 offen offset:2048
    buffer_load_dwordx4 v[92:95], v125, s[12:15], s26 offen offset:3072
    s_mov_b32 s23, 57344
    s_mov_b32 s26, 61440
    s_waitcnt vmcnt(8)
    v_lshlrev_b32 v108, 16, v96
    v_and_b32 v111, s25, v96
    v_lshlrev_b32 v109, 16, v100
    v_and_b32 v112, s25, v100
    v_lshlrev_b32 v110, 16, v104
    v_and_b32 v113, s25, v104
    v_mul_f32 v114, s44, v108
    v_mul_f32 v115, s44, v111
    v_fmac_f32 v114, s45, v109
    v_fmac_f32 v115, s45, v112
    v_fmac_f32 v114, s46, v110
    v_fmac_f32 v115, s46, v113
    v_cvt_pk_bf16_f32 v96, v114, v115
    v_lshlrev_b32 v108, 16, v97
    v_and_b32 v111, s25, v97
    v_lshlrev_b32 v109, 16, v101
    v_and_b32 v112, s25, v101
    v_lshlrev_b32 v110, 16, v105
    v_and_b32 v113, s25, v105
    v_mul_f32 v114, s44, v108
    v_mul_f32 v115, s44, v111
    v_fmac_f32 v114, s45, v109
    v_fmac_f32 v115, s45, v112
    v_fmac_f32 v114, s46, v110
    v_fmac_f32 v115, s46, v113
    v_cvt_pk_bf16_f32 v97, v114, v115
    v_lshlrev_b32 v108, 16, v98
    v_and_b32 v111, s25, v98
    v_lshlrev_b32 v109, 16, v102
    v_and_b32 v112, s25, v102
    v_lshlrev_b32 v110, 16, v106
    v_and_b32 v113, s25, v106
    v_mul_f32 v114, s44, v108
    v_mul_f32 v115, s44, v111
    v_fmac_f32 v114, s45, v109
    v_fmac_f32 v115, s45, v112
    v_fmac_f32 v114, s46, v110
    v_fmac_f32 v115, s46, v113
    v_cvt_pk_bf16_f32 v98, v114, v115
    v_lshlrev_b32 v108, 16, v99
    v_and_b32 v111, s25, v99
    v_lshlrev_b32 v109, 16, v103
    v_and_b32 v112, s25, v103
    v_lshlrev_b32 v110, 16, v107
    v_and_b32 v113, s25, v107
    v_mul_f32 v114, s44, v108
    v_mul_f32 v115, s44, v111
    v_fmac_f32 v114, s45, v109
    v_fmac_f32 v115, s45, v112
    v_fmac_f32 v114, s46, v110
    v_fmac_f32 v115, s46, v113
    v_cvt_pk_bf16_f32 v99, v114, v115
    ds_write_b128 v126, v[96:99]
    s_waitcnt lgkmcnt(0)
    s_barrier
    s_mov_b32 s22, 4
    s_setprio 2
L_conv2_kernel_mloop1:
    ds_read_b128 v[96:99], v120 offset:0
    ds_read_b128 v[100:103], v120 offset:1024
    ds_read_b128 v[104:107], v120 offset:2048
    ds_read_b128 v[108:111], v120 offset:3072
    ds_read_b128 v[112:115], v120 offset:4096
    ds_read_b128 v[116:119], v120 offset:5120
    s_waitcnt vmcnt(6) lgkmcnt(5)
    v_mfma_f32_16x16x32_bf16 v[0:3], v[64:67], v[96:99], v[0:3]
    v_mfma_f32_16x16x32_bf16 v[32:35], v[68:71], v[96:99], v[32:35]
    ds_read_b128 v[96:99], v120 offset:6144
    s_waitcnt vmcnt(4) lgkmcnt(5)
    v_mfma_f32_16x16x32_bf16 v[4:7], v[64:67], v[100:103], v[4:7]
    v_mfma_f32_16x16x32_bf16 v[36:39], v[68:71], v[100:103], v[36:39]
    v_mfma_f32_16x16x32_bf16 v[0:3], v[72:75], v[100:103], v[0:3]
    v_mfma_f32_16x16x32_bf16 v[32:35], v[76:79], v[100:103], v[32:35]
    ds_read_b128 v[100:103], v120 offset:7168
    s_waitcnt vmcnt(2) lgkmcnt(5)
    v_mfma_f32_16x16x32_bf16 v[8:11], v[64:67], v[104:107], v[8:11]
    v_mfma_f32_16x16x32_bf16 v[40:43], v[68:71], v[104:107], v[40:43]
    v_mfma_f32_16x16x32_bf16 v[4:7], v[72:75], v[104:107], v[4:7]
    v_mfma_f32_16x16x32_bf16 v[36:39], v[76:79], v[104:107], v[36:39]
    v_mfma_f32_16x16x32_bf16 v[0:3], v[80:83], v[104:107], v[0:3]
    v_mfma_f32_16x16x32_bf16 v[32:35], v[84:87], v[104:107], v[32:35]
    ds_read_b128 v[104:107], v122 offset:0
    v_add_u32 v122, v123, v122
    s_waitcnt vmcnt(0) lgkmcnt(5)
    v_mfma_f32_16x16x32_bf16 v[12:15], v[64:67], v[108:111], v[12:15]
    v_mfma_f32_16x16x32_bf16 v[44:47], v[68:71], v[108:111], v[44:47]
    v_mfma_f32_16x16x32_bf16 v[8:11], v[72:75], v[108:111], v[8:11]
    v_mfma_f32_16x16x32_bf16 v[40:43], v[76:79], v[108:111], v[40:43]
    v_mfma_f32_16x16x32_bf16 v[4:7], v[80:83], v[108:111], v[4:7]
    v_mfma_f32_16x16x32_bf16 v[36:39], v[84:87], v[108:111], v[36:39]
    v_mfma_f32_16x16x32_bf16 v[0:3], v[88:91], v[108:111], v[0:3]
    v_mfma_f32_16x16x32_bf16 v[32:35], v[92:95], v[108:111], v[32:35]
    ds_read_b128 v[108:111], v121 offset:1024
    s_waitcnt lgkmcnt(5)
    v_mfma_f32_16x16x32_bf16 v[16:19], v[64:67], v[112:115], v[16:19]
    v_mfma_f32_16x16x32_bf16 v[48:51], v[68:71], v[112:115], v[48:51]
    v_mfma_f32_16x16x32_bf16 v[12:15], v[72:75], v[112:115], v[12:15]
    v_mfma_f32_16x16x32_bf16 v[44:47], v[76:79], v[112:115], v[44:47]
    v_mfma_f32_16x16x32_bf16 v[8:11], v[80:83], v[112:115], v[8:11]
    v_mfma_f32_16x16x32_bf16 v[40:43], v[84:87], v[112:115], v[40:43]
    v_mfma_f32_16x16x32_bf16 v[4:7], v[88:91], v[112:115], v[4:7]
    v_mfma_f32_16x16x32_bf16 v[36:39], v[92:95], v[112:115], v[36:39]
    ds_read_b128 v[112:115], v121 offset:2048
    s_waitcnt lgkmcnt(5)
    v_mfma_f32_16x16x32_bf16 v[20:23], v[64:67], v[116:119], v[20:23]
    v_mfma_f32_16x16x32_bf16 v[52:55], v[68:71], v[116:119], v[52:55]
    v_mfma_f32_16x16x32_bf16 v[16:19], v[72:75], v[116:119], v[16:19]
    v_mfma_f32_16x16x32_bf16 v[48:51], v[76:79], v[116:119], v[48:51]
    v_mfma_f32_16x16x32_bf16 v[12:15], v[80:83], v[116:119], v[12:15]
    v_mfma_f32_16x16x32_bf16 v[44:47], v[84:87], v[116:119], v[44:47]
    v_mfma_f32_16x16x32_bf16 v[8:11], v[88:91], v[116:119], v[8:11]
    v_mfma_f32_16x16x32_bf16 v[40:43], v[92:95], v[116:119], v[40:43]
    s_waitcnt lgkmcnt(4)
    v_mfma_f32_16x16x32_bf16 v[24:27], v[64:67], v[96:99], v[24:27]
    v_mfma_f32_16x16x32_bf16 v[56:59], v[68:71], v[96:99], v[56:59]
    v_mfma_f32_16x16x32_bf16 v[20:23], v[72:75], v[96:99], v[20:23]
    v_mfma_f32_16x16x32_bf16 v[52:55], v[76:79], v[96:99], v[52:55]
    v_mfma_f32_16x16x32_bf16 v[16:19], v[80:83], v[96:99], v[16:19]
    v_mfma_f32_16x16x32_bf16 v[48:51], v[84:87], v[96:99], v[48:51]
    v_mfma_f32_16x16x32_bf16 v[12:15], v[88:91], v[96:99], v[12:15]
    v_mfma_f32_16x16x32_bf16 v[44:47], v[92:95], v[96:99], v[44:47]
    s_waitcnt lgkmcnt(3)
    v_mfma_f32_16x16x32_bf16 v[28:31], v[64:67], v[100:103], v[28:31]
    v_mfma_f32_16x16x32_bf16 v[60:63], v[68:71], v[100:103], v[60:63]
    v_mfma_f32_16x16x32_bf16 v[24:27], v[72:75], v[100:103], v[24:27]
    v_mfma_f32_16x16x32_bf16 v[56:59], v[76:79], v[100:103], v[56:59]
    v_mfma_f32_16x16x32_bf16 v[20:23], v[80:83], v[100:103], v[20:23]
    v_mfma_f32_16x16x32_bf16 v[52:55], v[84:87], v[100:103], v[52:55]
    v_mfma_f32_16x16x32_bf16 v[16:19], v[88:91], v[100:103], v[16:19]
    v_mfma_f32_16x16x32_bf16 v[48:51], v[92:95], v[100:103], v[48:51]
    buffer_load_dwordx4 v[64:67], v125, s[12:15], s23 offen offset:0
    buffer_load_dwordx4 v[68:71], v125, s[12:15], s23 offen offset:1024
    s_waitcnt lgkmcnt(2)
    v_mfma_f32_16x16x32_bf16 v[28:31], v[72:75], v[104:107], v[28:31]
    v_mfma_f32_16x16x32_bf16 v[60:63], v[76:79], v[104:107], v[60:63]
    v_mfma_f32_16x16x32_bf16 v[24:27], v[80:83], v[104:107], v[24:27]
    v_mfma_f32_16x16x32_bf16 v[56:59], v[84:87], v[104:107], v[56:59]
    v_mfma_f32_16x16x32_bf16 v[20:23], v[88:91], v[104:107], v[20:23]
    v_mfma_f32_16x16x32_bf16 v[52:55], v[92:95], v[104:107], v[52:55]
    buffer_load_dwordx4 v[72:75], v125, s[12:15], s23 offen offset:2048
    buffer_load_dwordx4 v[76:79], v125, s[12:15], s23 offen offset:3072
    s_waitcnt lgkmcnt(1)
    v_mfma_f32_16x16x32_bf16 v[28:31], v[80:83], v[108:111], v[28:31]
    v_mfma_f32_16x16x32_bf16 v[60:63], v[84:87], v[108:111], v[60:63]
    v_mfma_f32_16x16x32_bf16 v[24:27], v[88:91], v[108:111], v[24:27]
    v_mfma_f32_16x16x32_bf16 v[56:59], v[92:95], v[108:111], v[56:59]
    buffer_load_dwordx4 v[80:83], v125, s[12:15], s26 offen offset:0
    buffer_load_dwordx4 v[84:87], v125, s[12:15], s26 offen offset:1024
    s_waitcnt lgkmcnt(0)
    v_mfma_f32_16x16x32_bf16 v[28:31], v[88:91], v[112:115], v[28:31]
    v_mfma_f32_16x16x32_bf16 v[60:63], v[92:95], v[112:115], v[60:63]
    buffer_load_dwordx4 v[88:91], v125, s[12:15], s26 offen offset:2048
    buffer_load_dwordx4 v[92:95], v125, s[12:15], s26 offen offset:3072
    s_add_u32 s23, s23, 57344
    s_add_u32 s26, s26, 57344
    s_barrier
    s_sub_u32 s22, s22, 1
    s_cmp_eq_u32 s22, 0
    s_cbranch_scc1 L_conv2_kernel_mlast1
    ds_read_b128 v[96:99], v120 offset:8192
    ds_read_b128 v[100:103], v120 offset:9216
    ds_read_b128 v[104:107], v120 offset:10240
    ds_read_b128 v[108:111], v120 offset:11264
    ds_read_b128 v[112:115], v120 offset:12288
    ds_read_b128 v[116:119], v120 offset:13312
    s_waitcnt vmcnt(6) lgkmcnt(5)
    v_mfma_f32_16x16x32_bf16 v[0:3], v[64:67], v[96:99], v[0:3]
    v_mfma_f32_16x16x32_bf16 v[32:35], v[68:71], v[96:99], v[32:35]
    ds_read_b128 v[96:99], v120 offset:14336
    s_waitcnt vmcnt(4) lgkmcnt(5)
    v_mfma_f32_16x16x32_bf16 v[4:7], v[64:67], v[100:103], v[4:7]
    v_mfma_f32_16x16x32_bf16 v[36:39], v[68:71], v[100:103], v[36:39]
    v_mfma_f32_16x16x32_bf16 v[0:3], v[72:75], v[100:103], v[0:3]
    v_mfma_f32_16x16x32_bf16 v[32:35], v[76:79], v[100:103], v[32:35]
    ds_read_b128 v[100:103], v120 offset:15360
    s_waitcnt vmcnt(2) lgkmcnt(5)
    v_mfma_f32_16x16x32_bf16 v[8:11], v[64:67], v[104:107], v[8:11]
    v_mfma_f32_16x16x32_bf16 v[40:43], v[68:71], v[104:107], v[40:43]
    v_mfma_f32_16x16x32_bf16 v[4:7], v[72:75], v[104:107], v[4:7]
    v_mfma_f32_16x16x32_bf16 v[36:39], v[76:79], v[104:107], v[36:39]
    v_mfma_f32_16x16x32_bf16 v[0:3], v[80:83], v[104:107], v[0:3]
    v_mfma_f32_16x16x32_bf16 v[32:35], v[84:87], v[104:107], v[32:35]
    ds_read_b128 v[104:107], v122 offset:0
    v_add_u32 v122, v124, v122
    s_waitcnt vmcnt(0) lgkmcnt(5)
    v_mfma_f32_16x16x32_bf16 v[12:15], v[64:67], v[108:111], v[12:15]
    v_mfma_f32_16x16x32_bf16 v[44:47], v[68:71], v[108:111], v[44:47]
    v_mfma_f32_16x16x32_bf16 v[8:11], v[72:75], v[108:111], v[8:11]
    v_mfma_f32_16x16x32_bf16 v[40:43], v[76:79], v[108:111], v[40:43]
    v_mfma_f32_16x16x32_bf16 v[4:7], v[80:83], v[108:111], v[4:7]
    v_mfma_f32_16x16x32_bf16 v[36:39], v[84:87], v[108:111], v[36:39]
    v_mfma_f32_16x16x32_bf16 v[0:3], v[88:91], v[108:111], v[0:3]
    v_mfma_f32_16x16x32_bf16 v[32:35], v[92:95], v[108:111], v[32:35]
    ds_read_b128 v[108:111], v121 offset:9216
    s_waitcnt lgkmcnt(5)
    v_mfma_f32_16x16x32_bf16 v[16:19], v[64:67], v[112:115], v[16:19]
    v_mfma_f32_16x16x32_bf16 v[48:51], v[68:71], v[112:115], v[48:51]
    v_mfma_f32_16x16x32_bf16 v[12:15], v[72:75], v[112:115], v[12:15]
    v_mfma_f32_16x16x32_bf16 v[44:47], v[76:79], v[112:115], v[44:47]
    v_mfma_f32_16x16x32_bf16 v[8:11], v[80:83], v[112:115], v[8:11]
    v_mfma_f32_16x16x32_bf16 v[40:43], v[84:87], v[112:115], v[40:43]
    v_mfma_f32_16x16x32_bf16 v[4:7], v[88:91], v[112:115], v[4:7]
    v_mfma_f32_16x16x32_bf16 v[36:39], v[92:95], v[112:115], v[36:39]
    ds_read_b128 v[112:115], v121 offset:10240
    s_waitcnt lgkmcnt(5)
    v_mfma_f32_16x16x32_bf16 v[20:23], v[64:67], v[116:119], v[20:23]
    v_mfma_f32_16x16x32_bf16 v[52:55], v[68:71], v[116:119], v[52:55]
    v_mfma_f32_16x16x32_bf16 v[16:19], v[72:75], v[116:119], v[16:19]
    v_mfma_f32_16x16x32_bf16 v[48:51], v[76:79], v[116:119], v[48:51]
    v_mfma_f32_16x16x32_bf16 v[12:15], v[80:83], v[116:119], v[12:15]
    v_mfma_f32_16x16x32_bf16 v[44:47], v[84:87], v[116:119], v[44:47]
    v_mfma_f32_16x16x32_bf16 v[8:11], v[88:91], v[116:119], v[8:11]
    v_mfma_f32_16x16x32_bf16 v[40:43], v[92:95], v[116:119], v[40:43]
    s_waitcnt lgkmcnt(4)
    v_mfma_f32_16x16x32_bf16 v[24:27], v[64:67], v[96:99], v[24:27]
    v_mfma_f32_16x16x32_bf16 v[56:59], v[68:71], v[96:99], v[56:59]
    v_mfma_f32_16x16x32_bf16 v[20:23], v[72:75], v[96:99], v[20:23]
    v_mfma_f32_16x16x32_bf16 v[52:55], v[76:79], v[96:99], v[52:55]
    v_mfma_f32_16x16x32_bf16 v[16:19], v[80:83], v[96:99], v[16:19]
    v_mfma_f32_16x16x32_bf16 v[48:51], v[84:87], v[96:99], v[48:51]
    v_mfma_f32_16x16x32_bf16 v[12:15], v[88:91], v[96:99], v[12:15]
    v_mfma_f32_16x16x32_bf16 v[44:47], v[92:95], v[96:99], v[44:47]
    s_waitcnt lgkmcnt(3)
    v_mfma_f32_16x16x32_bf16 v[28:31], v[64:67], v[100:103], v[28:31]
    v_mfma_f32_16x16x32_bf16 v[60:63], v[68:71], v[100:103], v[60:63]
    v_mfma_f32_16x16x32_bf16 v[24:27], v[72:75], v[100:103], v[24:27]
    v_mfma_f32_16x16x32_bf16 v[56:59], v[76:79], v[100:103], v[56:59]
    v_mfma_f32_16x16x32_bf16 v[20:23], v[80:83], v[100:103], v[20:23]
    v_mfma_f32_16x16x32_bf16 v[52:55], v[84:87], v[100:103], v[52:55]
    v_mfma_f32_16x16x32_bf16 v[16:19], v[88:91], v[100:103], v[16:19]
    v_mfma_f32_16x16x32_bf16 v[48:51], v[92:95], v[100:103], v[48:51]
    buffer_load_dwordx4 v[64:67], v125, s[12:15], s23 offen offset:0
    buffer_load_dwordx4 v[68:71], v125, s[12:15], s23 offen offset:1024
    s_waitcnt lgkmcnt(2)
    v_mfma_f32_16x16x32_bf16 v[28:31], v[72:75], v[104:107], v[28:31]
    v_mfma_f32_16x16x32_bf16 v[60:63], v[76:79], v[104:107], v[60:63]
    v_mfma_f32_16x16x32_bf16 v[24:27], v[80:83], v[104:107], v[24:27]
    v_mfma_f32_16x16x32_bf16 v[56:59], v[84:87], v[104:107], v[56:59]
    v_mfma_f32_16x16x32_bf16 v[20:23], v[88:91], v[104:107], v[20:23]
    v_mfma_f32_16x16x32_bf16 v[52:55], v[92:95], v[104:107], v[52:55]
    buffer_load_dwordx4 v[72:75], v125, s[12:15], s23 offen offset:2048
    buffer_load_dwordx4 v[76:79], v125, s[12:15], s23 offen offset:3072
    s_waitcnt lgkmcnt(1)
    v_mfma_f32_16x16x32_bf16 v[28:31], v[80:83], v[108:111], v[28:31]
    v_mfma_f32_16x16x32_bf16 v[60:63], v[84:87], v[108:111], v[60:63]
    v_mfma_f32_16x16x32_bf16 v[24:27], v[88:91], v[108:111], v[24:27]
    v_mfma_f32_16x16x32_bf16 v[56:59], v[92:95], v[108:111], v[56:59]
    buffer_load_dwordx4 v[80:83], v125, s[12:15], s26 offen offset:0
    buffer_load_dwordx4 v[84:87], v125, s[12:15], s26 offen offset:1024
    s_waitcnt lgkmcnt(0)
    v_mfma_f32_16x16x32_bf16 v[28:31], v[88:91], v[112:115], v[28:31]
    v_mfma_f32_16x16x32_bf16 v[60:63], v[92:95], v[112:115], v[60:63]
    buffer_load_dwordx4 v[88:91], v125, s[12:15], s26 offen offset:2048
    buffer_load_dwordx4 v[92:95], v125, s[12:15], s26 offen offset:3072
    s_add_u32 s23, s23, 57344
    s_add_u32 s26, s26, 57344
    s_barrier
    s_branch L_conv2_kernel_mloop1
L_conv2_kernel_mlast1:
    v_and_b32 v125, 15, v127
    v_and_b32 v126, 7, v127
    v_lshlrev_b32 v126, 4, v126
    v_lshl_add_u32 v125, v125, 7, v126
    v_lshrrev_b32 v126, 4, v127
    v_lshl_add_u32 v125, v126, 11, v125
    s_lshl_b32 s36, s20, 14
    s_add_u32 s37, s36, 8192
    v_add_u32 v126, s37, v125
    v_add_u32 v125, s36, v125
    ds_read_b128 v[96:99], v120 offset:8192
    ds_read_b128 v[100:103], v120 offset:9216
    ds_read_b128 v[104:107], v120 offset:10240
    ds_read_b128 v[108:111], v120 offset:11264
    ds_read_b128 v[112:115], v120 offset:12288
    ds_read_b128 v[116:119], v120 offset:13312
    s_waitcnt vmcnt(6) lgkmcnt(5)
    v_mfma_f32_16x16x32_bf16 v[0:3], v[64:67], v[96:99], v[0:3]
    v_mfma_f32_16x16x32_bf16 v[32:35], v[68:71], v[96:99], v[32:35]
    ds_read_b128 v[96:99], v120 offset:14336
    s_waitcnt vmcnt(4) lgkmcnt(5)
    v_mfma_f32_16x16x32_bf16 v[4:7], v[64:67], v[100:103], v[4:7]
    v_mfma_f32_16x16x32_bf16 v[36:39], v[68:71], v[100:103], v[36:39]
    v_mfma_f32_16x16x32_bf16 v[0:3], v[72:75], v[100:103], v[0:3]
    v_mfma_f32_16x16x32_bf16 v[32:35], v[76:79], v[100:103], v[32:35]
    ds_read_b128 v[100:103], v120 offset:15360
    s_waitcnt vmcnt(2) lgkmcnt(5)
    v_mfma_f32_16x16x32_bf16 v[8:11], v[64:67], v[104:107], v[8:11]
    v_mfma_f32_16x16x32_bf16 v[40:43], v[68:71], v[104:107], v[40:43]
    v_mfma_f32_16x16x32_bf16 v[4:7], v[72:75], v[104:107], v[4:7]
    v_mfma_f32_16x16x32_bf16 v[36:39], v[76:79], v[104:107], v[36:39]
    v_mfma_f32_16x16x32_bf16 v[0:3], v[80:83], v[104:107], v[0:3]
    v_mfma_f32_16x16x32_bf16 v[32:35], v[84:87], v[104:107], v[32:35]
    ds_read_b128 v[104:107], v122 offset:0
    s_waitcnt vmcnt(0) lgkmcnt(5)
    v_mfma_f32_16x16x32_bf16 v[12:15], v[64:67], v[108:111], v[12:15]
    v_mfma_f32_16x16x32_bf16 v[44:47], v[68:71], v[108:111], v[44:47]
    v_mfma_f32_16x16x32_bf16 v[8:11], v[72:75], v[108:111], v[8:11]
    v_mfma_f32_16x16x32_bf16 v[40:43], v[76:79], v[108:111], v[40:43]
    v_mfma_f32_16x16x32_bf16 v[4:7], v[80:83], v[108:111], v[4:7]
    v_mfma_f32_16x16x32_bf16 v[36:39], v[84:87], v[108:111], v[36:39]
    v_mfma_f32_16x16x32_bf16 v[0:3], v[88:91], v[108:111], v[0:3]
    v_mfma_f32_16x16x32_bf16 v[32:35], v[92:95], v[108:111], v[32:35]
    ds_read_b128 v[108:111], v121 offset:9216
    s_waitcnt lgkmcnt(5)
    v_mfma_f32_16x16x32_bf16 v[16:19], v[64:67], v[112:115], v[16:19]
    v_mfma_f32_16x16x32_bf16 v[48:51], v[68:71], v[112:115], v[48:51]
    v_mfma_f32_16x16x32_bf16 v[12:15], v[72:75], v[112:115], v[12:15]
    v_mfma_f32_16x16x32_bf16 v[44:47], v[76:79], v[112:115], v[44:47]
    v_mfma_f32_16x16x32_bf16 v[8:11], v[80:83], v[112:115], v[8:11]
    v_mfma_f32_16x16x32_bf16 v[40:43], v[84:87], v[112:115], v[40:43]
    v_mfma_f32_16x16x32_bf16 v[4:7], v[88:91], v[112:115], v[4:7]
    v_mfma_f32_16x16x32_bf16 v[36:39], v[92:95], v[112:115], v[36:39]
    ds_read_b128 v[112:115], v121 offset:10240
    v_xor_b32 v123, 0, v125
    ds_write_b128 v123, v[0:3]
    s_waitcnt lgkmcnt(6)
    v_mfma_f32_16x16x32_bf16 v[20:23], v[64:67], v[116:119], v[20:23]
    v_mfma_f32_16x16x32_bf16 v[52:55], v[68:71], v[116:119], v[52:55]
    v_mfma_f32_16x16x32_bf16 v[16:19], v[72:75], v[116:119], v[16:19]
    v_mfma_f32_16x16x32_bf16 v[48:51], v[76:79], v[116:119], v[48:51]
    v_mfma_f32_16x16x32_bf16 v[12:15], v[80:83], v[116:119], v[12:15]
    v_mfma_f32_16x16x32_bf16 v[44:47], v[84:87], v[116:119], v[44:47]
    v_mfma_f32_16x16x32_bf16 v[8:11], v[88:91], v[116:119], v[8:11]
    v_mfma_f32_16x16x32_bf16 v[40:43], v[92:95], v[116:119], v[40:43]
    v_xor_b32 v124, 16, v125
    ds_write_b128 v124, v[4:7]
    s_waitcnt lgkmcnt(2)
    v_mfma_f32_16x16x32_bf16 v[24:27], v[64:67], v[96:99], v[24:27]
    v_mfma_f32_16x16x32_bf16 v[56:59], v[68:71], v[96:99], v[56:59]
    v_mfma_f32_16x16x32_bf16 v[20:23], v[72:75], v[96:99], v[20:23]
    v_mfma_f32_16x16x32_bf16 v[52:55], v[76:79], v[96:99], v[52:55]
    v_mfma_f32_16x16x32_bf16 v[16:19], v[80:83], v[96:99], v[16:19]
    v_mfma_f32_16x16x32_bf16 v[48:51], v[84:87], v[96:99], v[48:51]
    v_mfma_f32_16x16x32_bf16 v[12:15], v[88:91], v[96:99], v[12:15]
    v_mfma_f32_16x16x32_bf16 v[44:47], v[92:95], v[96:99], v[44:47]
    v_xor_b32 v123, 32, v125
    ds_write_b128 v123, v[8:11]
    v_xor_b32 v124, 0, v126
    ds_write_b128 v124, v[32:35]
    v_mfma_f32_16x16x32_bf16 v[28:31], v[64:67], v[100:103], v[28:31]
    v_mfma_f32_16x16x32_bf16 v[60:63], v[68:71], v[100:103], v[60:63]
    v_mfma_f32_16x16x32_bf16 v[24:27], v[72:75], v[100:103], v[24:27]
    v_mfma_f32_16x16x32_bf16 v[56:59], v[76:79], v[100:103], v[56:59]
    v_mfma_f32_16x16x32_bf16 v[20:23], v[80:83], v[100:103], v[20:23]
    v_mfma_f32_16x16x32_bf16 v[52:55], v[84:87], v[100:103], v[52:55]
    v_mfma_f32_16x16x32_bf16 v[16:19], v[88:91], v[100:103], v[16:19]
    v_mfma_f32_16x16x32_bf16 v[48:51], v[92:95], v[100:103], v[48:51]
    v_xor_b32 v123, 16, v126
    ds_write_b128 v123, v[36:39]
    v_xor_b32 v124, 32, v126
    ds_write_b128 v124, v[40:43]
    v_mfma_f32_16x16x32_bf16 v[28:31], v[72:75], v[104:107], v[28:31]
    v_mfma_f32_16x16x32_bf16 v[60:63], v[76:79], v[104:107], v[60:63]
    v_mfma_f32_16x16x32_bf16 v[24:27], v[80:83], v[104:107], v[24:27]
    v_mfma_f32_16x16x32_bf16 v[56:59], v[84:87], v[104:107], v[56:59]
    v_mfma_f32_16x16x32_bf16 v[20:23], v[88:91], v[104:107], v[20:23]
    v_mfma_f32_16x16x32_bf16 v[52:55], v[92:95], v[104:107], v[52:55]
    v_xor_b32 v124, 48, v125
    ds_write_b128 v124, v[12:15]
    v_xor_b32 v123, 48, v126
    ds_write_b128 v123, v[44:47]
    v_mfma_f32_16x16x32_bf16 v[28:31], v[80:83], v[108:111], v[28:31]
    v_mfma_f32_16x16x32_bf16 v[60:63], v[84:87], v[108:111], v[60:63]
    v_mfma_f32_16x16x32_bf16 v[24:27], v[88:91], v[108:111], v[24:27]
    v_mfma_f32_16x16x32_bf16 v[56:59], v[92:95], v[108:111], v[56:59]
    v_xor_b32 v123, 64, v125
    ds_write_b128 v123, v[16:19]
    v_xor_b32 v124, 64, v126
    ds_write_b128 v124, v[48:51]
    v_mfma_f32_16x16x32_bf16 v[28:31], v[88:91], v[112:115], v[28:31]
    v_mfma_f32_16x16x32_bf16 v[60:63], v[92:95], v[112:115], v[60:63]
    v_xor_b32 v124, 80, v125
    ds_write_b128 v124, v[20:23]
    v_xor_b32 v123, 80, v126
    ds_write_b128 v123, v[52:55]
    s_nop 7
    v_xor_b32 v123, 96, v125
    ds_write_b128 v123, v[24:27]
    v_xor_b32 v124, 96, v126
    ds_write_b128 v124, v[56:59]
    v_xor_b32 v124, 112, v125
    ds_write_b128 v124, v[28:31]
    v_xor_b32 v123, 112, v126
    s_waitcnt lgkmcnt(8)
    ds_write_b128 v123, v[60:63]
    s_setprio 0
    s_branch L_conv2_kernel_epi
L_conv2_kernel_m2:
    s_mul_i32 s37, s38, 2176
    s_add_u32 s37, s37, 98304
    v_add_u32 v116, s37, v8
    v_add_u32 v118, s37, v9
    v_add_u32 v117, 104832, v8
    s_cmp_eq_u32 s38, 0
    s_cbranch_scc1 L_conv2_kernel_hh0
    v_add_u32 v117, 98304, v9
L_conv2_kernel_hh0:
    s_lshl_b32 s37, s38, 12
    s_add_u32 s37, s37, s43
    s_add_u32 s37, s37, 49152
    v_lshl_add_u32 v119, v127, 4, s37
    v_mov_b32 v0, 0
    v_mov_b32 v1, 0
    v_mov_b32 v2, 0
    v_mov_b32 v3, 0
    v_mov_b32 v4, 0
    v_mov_b32 v5, 0
    v_mov_b32 v6, 0
    v_mov_b32 v7, 0
    v_mov_b32 v8, 0
    v_mov_b32 v9, 0
    v_mov_b32 v10, 0
    v_mov_b32 v11, 0
    v_mov_b32 v12, 0
    v_mov_b32 v13, 0
    v_mov_b32 v14, 0
    v_mov_b32 v15, 0
    v_mov_b32 v16, 0
    v_mov_b32 v17, 0
    v_mov_b32 v18, 0
    v_mov_b32 v19, 0
    v_mov_b32 v20, 0
    v_mov_b32 v21, 0
    v_mov_b32 v22, 0
    v_mov_b32 v23, 0
    v_mov_b32 v24, 0
    v_mov_b32 v25, 0
    v_mov_b32 v26, 0
    v_mov_b32 v27, 0
    v_mov_b32 v28, 0
    v_mov_b32 v29, 0
    v_mov_b32 v30, 0
    v_mov_b32 v31, 0
    v_mov_b32 v32, 0
    v_mov_b32 v33, 0
    v_mov_b32 v34, 0
    v_mov_b32 v35, 0
    v_mov_b32 v36, 0
    v_mov_b32 v37, 0
    v_mov_b32 v38, 0
    v_mov_b32 v39, 0
    v_mov_b32 v40, 0
    v_mov_b32 v41, 0
    v_mov_b32 v42, 0
    v_mov_b32 v43, 0
    v_mov_b32 v44, 0
    v_mov_b32 v45, 0
    v_mov_b32 v46, 0
    v_mov_b32 v47, 0
    v_mov_b32 v48, 0
    v_mov_b32 v49, 0
    v_mov_b32 v50, 0
    v_mov_b32 v51, 0
    v_mov_b32 v52, 0
    v_mov_b32 v53, 0
    v_mov_b32 v54, 0
    v_mov_b32 v55, 0
    v_mov_b32 v56, 0
    v_mov_b32 v57, 0
    v_mov_b32 v58, 0
    v_mov_b32 v59, 0
    v_mov_b32 v60, 0
    v_mov_b32 v61, 0
    v_mov_b32 v62, 0
    v_mov_b32 v63, 0
    s_barrier
    buffer_load_dwordx4 v[96:99], v108, s[8:11], 0 offen offset:0
    buffer_load_dwordx4 v[100:103], v108, s[8:11], 0 offen offset:1024
    buffer_load_dwordx4 v[104:107], v108, s[8:11], 0 offen offset:2048
    s_mov_b32 s23, 0
    s_mov_b32 s26, 4096
    buffer_load_dwordx4 v[64:67], v125, s[12:15], s23 offen offset:0
    buffer_load_dwordx4 v[68:71], v125, s[12:15], s23 offen offset:2048
    buffer_load_dwordx4 v[80:83], v119, s[12:15], s23 offen offset:0
    buffer_load_dwordx4 v[72:75], v125, s[12:15], s26 offen offset:0
    buffer_load_dwordx4 v[84:87], v119, s[12:15], s23 offen offset:2048
    buffer_load_dwordx4 v[76:79], v125, s[12:15], s26 offen offset:2048
    s_mov_b32 s23, 57344
    s_mov_b32 s26, 61440
    s_waitcnt vmcnt(6)
    v_lshlrev_b32 v108, 16, v96
    v_and_b32 v111, s25, v96
    v_lshlrev_b32 v109, 16, v100
    v_and_b32 v112, s25, v100
    v_lshlrev_b32 v110, 16, v104
    v_and_b32 v113, s25, v104
    v_mul_f32 v114, s44, v108
    v_mul_f32 v115, s44, v111
    v_fmac_f32 v114, s45, v109
    v_fmac_f32 v115, s45, v112
    v_fmac_f32 v114, s46, v110
    v_fmac_f32 v115, s46, v113
    v_cvt_pk_bf16_f32 v96, v114, v115
    v_lshlrev_b32 v108, 16, v97
    v_and_b32 v111, s25, v97
    v_lshlrev_b32 v109, 16, v101
    v_and_b32 v112, s25, v101
    v_lshlrev_b32 v110, 16, v105
    v_and_b32 v113, s25, v105
    v_mul_f32 v114, s44, v108
    v_mul_f32 v115, s44, v111
    v_fmac_f32 v114, s45, v109
    v_fmac_f32 v115, s45, v112
    v_fmac_f32 v114, s46, v110
    v_fmac_f32 v115, s46, v113
    v_cvt_pk_bf16_f32 v97, v114, v115
    v_lshlrev_b32 v108, 16, v98
    v_and_b32 v111, s25, v98
    v_lshlrev_b32 v109, 16, v102
    v_and_b32 v112, s25, v102
    v_lshlrev_b32 v110, 16, v106
    v_and_b32 v113, s25, v106
    v_mul_f32 v114, s44, v108
    v_mul_f32 v115, s44, v111
    v_fmac_f32 v114, s45, v109
    v_fmac_f32 v115, s45, v112
    v_fmac_f32 v114, s46, v110
    v_fmac_f32 v115, s46, v113
    v_cvt_pk_bf16_f32 v98, v114, v115
    v_lshlrev_b32 v108, 16, v99
    v_and_b32 v111, s25, v99
    v_lshlrev_b32 v109, 16, v103
    v_and_b32 v112, s25, v103
    v_lshlrev_b32 v110, 16, v107
    v_and_b32 v113, s25, v107
    v_mul_f32 v114, s44, v108
    v_mul_f32 v115, s44, v111
    v_fmac_f32 v114, s45, v109
    v_fmac_f32 v115, s45, v112
    v_fmac_f32 v114, s46, v110
    v_fmac_f32 v115, s46, v113
    v_cvt_pk_bf16_f32 v99, v114, v115
    ds_write_b128 v126, v[96:99]
    v_and_b32 v126, 15, v127
    v_lshlrev_b32 v126, 2, v126
    v_add_u32 v126, 99328, v126
    ds_write_b32 v126, v0
    ds_write_b32 v126, v0 offset:8704
    s_waitcnt lgkmcnt(0)
    s_barrier
    s_mov_b32 s22, 4
    s_setprio 2
L_conv2_kernel_mloop2:
    ds_read_b128 v[88:91], v120 offset:0
    ds_read_b128 v[92:95], v120 offset:1024
    ds_read_b128 v[96:99], v116 offset:0
    ds_read_b128 v[100:103], v120 offset:2048
    ds_read_b128 v[104:107], v116 offset:1088
    ds_read_b128 v[108:111], v120 offset:3072
    ds_read_b128 v[112:115], v116 offset:2176
    s_waitcnt vmcnt(5) lgkmcnt(6)
    v_mfma_f32_16x16x32_bf16 v[0:3], v[64:67], v[88:91], v[0:3]
    ds_read_b128 v[88:91], v120 offset:4096
    s_waitcnt vmcnt(4) lgkmcnt(6)
    v_mfma_f32_16x16x32_bf16 v[4:7], v[64:67], v[92:95], v[4:7]
    v_mfma_f32_16x16x32_bf16 v[0:3], v[68:71], v[92:95], v[0:3]
    ds_read_b128 v[92:95], v116 offset:3264
    s_waitcnt vmcnt(3) lgkmcnt(6)
    v_mfma_f32_16x16x32_bf16 v[32:35], v[80:83], v[96:99], v[32:35]
    ds_read_b128 v[96:99], v120 offset:5120
    s_waitcnt vmcnt(2) lgkmcnt(6)
    v_mfma_f32_16x16x32_bf16 v[8:11], v[64:67], v[100:103], v[8:11]
    v_mfma_f32_16x16x32_bf16 v[4:7], v[68:71], v[100:103], v[4:7]
    v_mfma_f32_16x16x32_bf16 v[0:3], v[72:75], v[100:103], v[0:3]
    ds_read_b128 v[100:103], v116 offset:4352
    s_waitcnt vmcnt(1) lgkmcnt(6)
    v_mfma_f32_16x16x32_bf16 v[36:39], v[80:83], v[104:107], v[36:39]
    v_mfma_f32_16x16x32_bf16 v[32:35], v[84:87], v[104:107], v[32:35]
    ds_read_b128 v[104:107], v120 offset:6144
    s_waitcnt vmcnt(0) lgkmcnt(6)
    v_mfma_f32_16x16x32_bf16 v[12:15], v[64:67], v[108:111], v[12:15]
    v_mfma_f32_16x16x32_bf16 v[8:11], v[68:71], v[108:111], v[8:11]
    v_mfma_f32_16x16x32_bf16 v[4:7], v[72:75], v[108:111], v[4:7]
    v_mfma_f32_16x16x32_bf16 v[0:3], v[76:79], v[108:111], v[0:3]
    ds_read_b128 v[108:111], v116 offset:5440
    s_waitcnt lgkmcnt(6)
    v_mfma_f32_16x16x32_bf16 v[40:43], v[80:83], v[112:115], v[40:43]
    v_mfma_f32_16x16x32_bf16 v[36:39], v[84:87], v[112:115], v[36:39]
    ds_read_b128 v[112:115], v120 offset:7168
    s_waitcnt lgkmcnt(6)
    v_mfma_f32_16x16x32_bf16 v[16:19], v[64:67], v[88:91], v[16:19]
    v_mfma_f32_16x16x32_bf16 v[12:15], v[68:71], v[88:91], v[12:15]
    v_mfma_f32_16x16x32_bf16 v[8:11], v[72:75], v[88:91], v[8:11]
    v_mfma_f32_16x16x32_bf16 v[4:7], v[76:79], v[88:91], v[4:7]
    ds_read_b128 v[88:91], v117 offset:0
    s_waitcnt lgkmcnt(6)
    v_mfma_f32_16x16x32_bf16 v[44:47], v[80:83], v[92:95], v[44:47]
    v_mfma_f32_16x16x32_bf16 v[40:43], v[84:87], v[92:95], v[40:43]
    ds_read_b128 v[92:95], v122 offset:0
    v_add_u32 v122, v123, v122
    s_waitcnt lgkmcnt(6)
    v_mfma_f32_16x16x32_bf16 v[20:23], v[64:67], v[96:99], v[20:23]
    v_mfma_f32_16x16x32_bf16 v[16:19], v[68:71], v[96:99], v[16:19]
    v_mfma_f32_16x16x32_bf16 v[12:15], v[72:75], v[96:99], v[12:15]
    v_mfma_f32_16x16x32_bf16 v[8:11], v[76:79], v[96:99], v[8:11]
    ds_read_b128 v[96:99], v117 offset:1088
    s_waitcnt lgkmcnt(6)
    v_mfma_f32_16x16x32_bf16 v[48:51], v[80:83], v[100:103], v[48:51]
    v_mfma_f32_16x16x32_bf16 v[44:47], v[84:87], v[100:103], v[44:47]
    ds_read_b128 v[100:103], v121 offset:1024
    s_waitcnt lgkmcnt(6)
    v_mfma_f32_16x16x32_bf16 v[24:27], v[64:67], v[104:107], v[24:27]
    v_mfma_f32_16x16x32_bf16 v[20:23], v[68:71], v[104:107], v[20:23]
    v_mfma_f32_16x16x32_bf16 v[16:19], v[72:75], v[104:107], v[16:19]
    v_mfma_f32_16x16x32_bf16 v[12:15], v[76:79], v[104:107], v[12:15]
    ds_read_b128 v[104:107], v118 offset:0
    s_waitcnt lgkmcnt(6)
    v_mfma_f32_16x16x32_bf16 v[52:55], v[80:83], v[108:111], v[52:55]
    v_mfma_f32_16x16x32_bf16 v[48:51], v[84:87], v[108:111], v[48:51]
    ds_read_b128 v[108:111], v121 offset:2048
    s_waitcnt lgkmcnt(6)
    v_mfma_f32_16x16x32_bf16 v[28:31], v[64:67], v[112:115], v[28:31]
    v_mfma_f32_16x16x32_bf16 v[24:27], v[68:71], v[112:115], v[24:27]
    v_mfma_f32_16x16x32_bf16 v[20:23], v[72:75], v[112:115], v[20:23]
    v_mfma_f32_16x16x32_bf16 v[16:19], v[76:79], v[112:115], v[16:19]
    buffer_load_dwordx4 v[64:67], v125, s[12:15], s23 offen offset:0
    s_waitcnt lgkmcnt(5)
    v_mfma_f32_16x16x32_bf16 v[56:59], v[80:83], v[88:91], v[56:59]
    v_mfma_f32_16x16x32_bf16 v[52:55], v[84:87], v[88:91], v[52:55]
    s_waitcnt lgkmcnt(0)
    s_barrier
    v_mfma_f32_16x16x32_bf16 v[28:31], v[68:71], v[92:95], v[28:31]
    v_mfma_f32_16x16x32_bf16 v[24:27], v[72:75], v[92:95], v[24:27]
    v_mfma_f32_16x16x32_bf16 v[20:23], v[76:79], v[92:95], v[20:23]
    buffer_load_dwordx4 v[68:71], v125, s[12:15], s23 offen offset:2048
    v_mfma_f32_16x16x32_bf16 v[60:63], v[80:83], v[96:99], v[60:63]
    v_mfma_f32_16x16x32_bf16 v[56:59], v[84:87], v[96:99], v[56:59]
    buffer_load_dwordx4 v[80:83], v119, s[12:15], s23 offen offset:0
    v_mfma_f32_16x16x32_bf16 v[28:31], v[72:75], v[100:103], v[28:31]
    v_mfma_f32_16x16x32_bf16 v[24:27], v[76:79], v[100:103], v[24:27]
    buffer_load_dwordx4 v[72:75], v125, s[12:15], s26 offen offset:0
    v_mfma_f32_16x16x32_bf16 v[60:63], v[84:87], v[104:107], v[60:63]
    buffer_load_dwordx4 v[84:87], v119, s[12:15], s23 offen offset:2048
    v_mfma_f32_16x16x32_bf16 v[28:31], v[76:79], v[108:111], v[28:31]
    buffer_load_dwordx4 v[76:79], v125, s[12:15], s26 offen offset:2048
    s_add_u32 s23, s23, 57344
    s_add_u32 s26, s26, 57344
    s_sub_u32 s22, s22, 1
    s_cmp_eq_u32 s22, 0
    s_cbranch_scc1 L_conv2_kernel_mlast2
    ds_read_b128 v[88:91], v120 offset:8192
    ds_read_b128 v[92:95], v120 offset:9216
    ds_read_b128 v[96:99], v116 offset:8704
    ds_read_b128 v[100:103], v120 offset:10240
    ds_read_b128 v[104:107], v116 offset:9792
    ds_read_b128 v[108:111], v120 offset:11264
    ds_read_b128 v[112:115], v116 offset:10880
    s_waitcnt vmcnt(5) lgkmcnt(6)
    v_mfma_f32_16x16x32_bf16 v[0:3], v[64:67], v[88:91], v[0:3]
    ds_read_b128 v[88:91], v120 offset:12288
    s_waitcnt vmcnt(4) lgkmcnt(6)
    v_mfma_f32_16x16x32_bf16 v[4:7], v[64:67], v[92:95], v[4:7]
    v_mfma_f32_16x16x32_bf16 v[0:3], v[68:71], v[92:95], v[0:3]
    ds_read_b128 v[92:95], v116 offset:11968
    s_waitcnt vmcnt(3) lgkmcnt(6)
    v_mfma_f32_16x16x32_bf16 v[32:35], v[80:83], v[96:99], v[32:35]
    ds_read_b128 v[96:99], v120 offset:13312
    s_waitcnt vmcnt(2) lgkmcnt(6)
    v_mfma_f32_16x16x32_bf16 v[8:11], v[64:67], v[100:103], v[8:11]
    v_mfma_f32_16x16x32_bf16 v[4:7], v[68:71], v[100:103], v[4:7]
    v_mfma_f32_16x16x32_bf16 v[0:3], v[72:75], v[100:103], v[0:3]
    ds_read_b128 v[100:103], v116 offset:13056
    s_waitcnt vmcnt(1) lgkmcnt(6)
    v_mfma_f32_16x16x32_bf16 v[36:39], v[80:83], v[104:107], v[36:39]
    v_mfma_f32_16x16x32_bf16 v[32:35], v[84:87], v[104:107], v[32:35]
    ds_read_b128 v[104:107], v120 offset:14336
    s_waitcnt vmcnt(0) lgkmcnt(6)
    v_mfma_f32_16x16x32_bf16 v[12:15], v[64:67], v[108:111], v[12:15]
    v_mfma_f32_16x16x32_bf16 v[8:11], v[68:71], v[108:111], v[8:11]
    v_mfma_f32_16x16x32_bf16 v[4:7], v[72:75], v[108:111], v[4:7]
    v_mfma_f32_16x16x32_bf16 v[0:3], v[76:79], v[108:111], v[0:3]
    ds_read_b128 v[108:111], v116 offset:14144
    s_waitcnt lgkmcnt(6)
    v_mfma_f32_16x16x32_bf16 v[40:43], v[80:83], v[112:115], v[40:43]
    v_mfma_f32_16x16x32_bf16 v[36:39], v[84:87], v[112:115], v[36:39]
    ds_read_b128 v[112:115], v120 offset:15360
    s_waitcnt lgkmcnt(6)
    v_mfma_f32_16x16x32_bf16 v[16:19], v[64:67], v[88:91], v[16:19]
    v_mfma_f32_16x16x32_bf16 v[12:15], v[68:71], v[88:91], v[12:15]
    v_mfma_f32_16x16x32_bf16 v[8:11], v[72:75], v[88:91], v[8:11]
    v_mfma_f32_16x16x32_bf16 v[4:7], v[76:79], v[88:91], v[4:7]
    ds_read_b128 v[88:91], v117 offset:8704
    s_waitcnt lgkmcnt(6)
    v_mfma_f32_16x16x32_bf16 v[44:47], v[80:83], v[92:95], v[44:47]
    v_mfma_f32_16x16x32_bf16 v[40:43], v[84:87], v[92:95], v[40:43]
    ds_read_b128 v[92:95], v122 offset:0
    v_add_u32 v122, v124, v122
    s_waitcnt lgkmcnt(6)
    v_mfma_f32_16x16x32_bf16 v[20:23], v[64:67], v[96:99], v[20:23]
    v_mfma_f32_16x16x32_bf16 v[16:19], v[68:71], v[96:99], v[16:19]
    v_mfma_f32_16x16x32_bf16 v[12:15], v[72:75], v[96:99], v[12:15]
    v_mfma_f32_16x16x32_bf16 v[8:11], v[76:79], v[96:99], v[8:11]
    ds_read_b128 v[96:99], v117 offset:9792
    s_waitcnt lgkmcnt(6)
    v_mfma_f32_16x16x32_bf16 v[48:51], v[80:83], v[100:103], v[48:51]
    v_mfma_f32_16x16x32_bf16 v[44:47], v[84:87], v[100:103], v[44:47]
    ds_read_b128 v[100:103], v121 offset:9216
    s_waitcnt lgkmcnt(6)
    v_mfma_f32_16x16x32_bf16 v[24:27], v[64:67], v[104:107], v[24:27]
    v_mfma_f32_16x16x32_bf16 v[20:23], v[68:71], v[104:107], v[20:23]
    v_mfma_f32_16x16x32_bf16 v[16:19], v[72:75], v[104:107], v[16:19]
    v_mfma_f32_16x16x32_bf16 v[12:15], v[76:79], v[104:107], v[12:15]
    ds_read_b128 v[104:107], v118 offset:8704
    s_waitcnt lgkmcnt(6)
    v_mfma_f32_16x16x32_bf16 v[52:55], v[80:83], v[108:111], v[52:55]
    v_mfma_f32_16x16x32_bf16 v[48:51], v[84:87], v[108:111], v[48:51]
    ds_read_b128 v[108:111], v121 offset:10240
    s_waitcnt lgkmcnt(6)
    v_mfma_f32_16x16x32_bf16 v[28:31], v[64:67], v[112:115], v[28:31]
    v_mfma_f32_16x16x32_bf16 v[24:27], v[68:71], v[112:115], v[24:27]
    v_mfma_f32_16x16x32_bf16 v[20:23], v[72:75], v[112:115], v[20:23]
    v_mfma_f32_16x16x32_bf16 v[16:19], v[76:79], v[112:115], v[16:19]
    buffer_load_dwordx4 v[64:67], v125, s[12:15], s23 offen offset:0
    s_waitcnt lgkmcnt(5)
    v_mfma_f32_16x16x32_bf16 v[56:59], v[80:83], v[88:91], v[56:59]
    v_mfma_f32_16x16x32_bf16 v[52:55], v[84:87], v[88:91], v[52:55]
    s_waitcnt lgkmcnt(0)
    s_barrier
    v_mfma_f32_16x16x32_bf16 v[28:31], v[68:71], v[92:95], v[28:31]
    v_mfma_f32_16x16x32_bf16 v[24:27], v[72:75], v[92:95], v[24:27]
    v_mfma_f32_16x16x32_bf16 v[20:23], v[76:79], v[92:95], v[20:23]
    buffer_load_dwordx4 v[68:71], v125, s[12:15], s23 offen offset:2048
    v_mfma_f32_16x16x32_bf16 v[60:63], v[80:83], v[96:99], v[60:63]
    v_mfma_f32_16x16x32_bf16 v[56:59], v[84:87], v[96:99], v[56:59]
    buffer_load_dwordx4 v[80:83], v119, s[12:15], s23 offen offset:0
    v_mfma_f32_16x16x32_bf16 v[28:31], v[72:75], v[100:103], v[28:31]
    v_mfma_f32_16x16x32_bf16 v[24:27], v[76:79], v[100:103], v[24:27]
    buffer_load_dwordx4 v[72:75], v125, s[12:15], s26 offen offset:0
    v_mfma_f32_16x16x32_bf16 v[60:63], v[84:87], v[104:107], v[60:63]
    buffer_load_dwordx4 v[84:87], v119, s[12:15], s23 offen offset:2048
    v_mfma_f32_16x16x32_bf16 v[28:31], v[76:79], v[108:111], v[28:31]
    buffer_load_dwordx4 v[76:79], v125, s[12:15], s26 offen offset:2048
    s_add_u32 s23, s23, 57344
    s_add_u32 s26, s26, 57344
    s_branch L_conv2_kernel_mloop2
L_conv2_kernel_mlast2:
    v_and_b32 v125, 15, v127
    v_and_b32 v126, 7, v127
    v_lshlrev_b32 v126, 4, v126
    v_lshl_add_u32 v125, v125, 7, v126
    v_lshrrev_b32 v126, 4, v127
    v_lshl_add_u32 v125, v126, 11, v125
    s_mov_b32 s36, 65536
    s_cmp_eq_u32 s32, 1
    s_cselect_b32 s36, 121856, s36
    s_cmp_eq_u32 s32, 2
    s_cselect_b32 s36, 81920, s36
    s_cmp_eq_u32 s32, 3
    s_cselect_b32 s36, 130048, s36
    s_mov_b32 s37, 98304
    s_cmp_eq_u32 s32, 1
    s_cselect_b32 s37, 138240, s37
    s_cmp_eq_u32 s32, 2
    s_cselect_b32 s37, 146432, s37
    s_cmp_eq_u32 s32, 3
    s_cselect_b32 s37, 154624, s37
    v_add_u32 v126, s37, v125
    v_add_u32 v125, s36, v125
    ds_read_b128 v[88:91], v120 offset:8192
    ds_read_b128 v[92:95], v120 offset:9216
    ds_read_b128 v[96:99], v116 offset:8704
    ds_read_b128 v[100:103], v120 offset:10240
    ds_read_b128 v[104:107], v116 offset:9792
    ds_read_b128 v[108:111], v120 offset:11264
    ds_read_b128 v[112:115], v116 offset:10880
    s_waitcnt vmcnt(5) lgkmcnt(6)
    v_mfma_f32_16x16x32_bf16 v[0:3], v[64:67], v[88:91], v[0:3]
    ds_read_b128 v[88:91], v120 offset:12288
    s_waitcnt vmcnt(4) lgkmcnt(6)
    v_mfma_f32_16x16x32_bf16 v[4:7], v[64:67], v[92:95], v[4:7]
    v_mfma_f32_16x16x32_bf16 v[0:3], v[68:71], v[92:95], v[0:3]
    ds_read_b128 v[92:95], v116 offset:11968
    s_waitcnt vmcnt(3) lgkmcnt(6)
    v_mfma_f32_16x16x32_bf16 v[32:35], v[80:83], v[96:99], v[32:35]
    ds_read_b128 v[96:99], v120 offset:13312
    s_waitcnt vmcnt(2) lgkmcnt(6)
    v_mfma_f32_16x16x32_bf16 v[8:11], v[64:67], v[100:103], v[8:11]
    v_mfma_f32_16x16x32_bf16 v[4:7], v[68:71], v[100:103], v[4:7]
    v_mfma_f32_16x16x32_bf16 v[0:3], v[72:75], v[100:103], v[0:3]
    ds_read_b128 v[100:103], v116 offset:13056
    s_waitcnt vmcnt(1) lgkmcnt(6)
    v_mfma_f32_16x16x32_bf16 v[36:39], v[80:83], v[104:107], v[36:39]
    v_mfma_f32_16x16x32_bf16 v[32:35], v[84:87], v[104:107], v[32:35]
    ds_read_b128 v[104:107], v120 offset:14336
    s_waitcnt vmcnt(0) lgkmcnt(6)
    v_mfma_f32_16x16x32_bf16 v[12:15], v[64:67], v[108:111], v[12:15]
    v_mfma_f32_16x16x32_bf16 v[8:11], v[68:71], v[108:111], v[8:11]
    v_mfma_f32_16x16x32_bf16 v[4:7], v[72:75], v[108:111], v[4:7]
    v_mfma_f32_16x16x32_bf16 v[0:3], v[76:79], v[108:111], v[0:3]
    ds_read_b128 v[108:111], v116 offset:14144
    s_waitcnt lgkmcnt(6)
    v_mfma_f32_16x16x32_bf16 v[40:43], v[80:83], v[112:115], v[40:43]
    v_mfma_f32_16x16x32_bf16 v[36:39], v[84:87], v[112:115], v[36:39]
    ds_read_b128 v[112:115], v120 offset:15360
    s_waitcnt lgkmcnt(6)
    v_mfma_f32_16x16x32_bf16 v[16:19], v[64:67], v[88:91], v[16:19]
    v_mfma_f32_16x16x32_bf16 v[12:15], v[68:71], v[88:91], v[12:15]
    v_mfma_f32_16x16x32_bf16 v[8:11], v[72:75], v[88:91], v[8:11]
    v_mfma_f32_16x16x32_bf16 v[4:7], v[76:79], v[88:91], v[4:7]
    ds_read_b128 v[88:91], v117 offset:8704
    v_xor_b32 v124, 0, v126
    ds_write_b128 v124, v[32:35]
    s_waitcnt lgkmcnt(7)
    v_mfma_f32_16x16x32_bf16 v[44:47], v[80:83], v[92:95], v[44:47]
    v_mfma_f32_16x16x32_bf16 v[40:43], v[84:87], v[92:95], v[40:43]
    ds_read_b128 v[92:95], v122 offset:0
    v_xor_b32 v123, 0, v125
    ds_write_b128 v123, v[0:3]
    s_waitcnt lgkmcnt(8)
    v_mfma_f32_16x16x32_bf16 v[20:23], v[64:67], v[96:99], v[20:23]
    v_mfma_f32_16x16x32_bf16 v[16:19], v[68:71], v[96:99], v[16:19]
    v_mfma_f32_16x16x32_bf16 v[12:15], v[72:75], v[96:99], v[12:15]
    v_mfma_f32_16x16x32_bf16 v[8:11], v[76:79], v[96:99], v[8:11]
    ds_read_b128 v[96:99], v117 offset:9792
    v_xor_b32 v123, 16, v126
    ds_write_b128 v123, v[36:39]
    s_waitcnt lgkmcnt(9)
    v_mfma_f32_16x16x32_bf16 v[48:51], v[80:83], v[100:103], v[48:51]
    v_mfma_f32_16x16x32_bf16 v[44:47], v[84:87], v[100:103], v[44:47]
    ds_read_b128 v[100:103], v121 offset:9216
    v_xor_b32 v124, 16, v125
    ds_write_b128 v124, v[4:7]
    s_waitcnt lgkmcnt(10)
    v_mfma_f32_16x16x32_bf16 v[24:27], v[64:67], v[104:107], v[24:27]
    v_mfma_f32_16x16x32_bf16 v[20:23], v[68:71], v[104:107], v[20:23]
    v_mfma_f32_16x16x32_bf16 v[16:19], v[72:75], v[104:107], v[16:19]
    v_mfma_f32_16x16x32_bf16 v[12:15], v[76:79], v[104:107], v[12:15]
    ds_read_b128 v[104:107], v118 offset:8704
    v_xor_b32 v124, 32, v126
    ds_write_b128 v124, v[40:43]
    s_waitcnt lgkmcnt(11)
    v_mfma_f32_16x16x32_bf16 v[52:55], v[80:83], v[108:111], v[52:55]
    v_mfma_f32_16x16x32_bf16 v[48:51], v[84:87], v[108:111], v[48:51]
    ds_read_b128 v[108:111], v121 offset:10240
    v_xor_b32 v123, 32, v125
    ds_write_b128 v123, v[8:11]
    s_waitcnt lgkmcnt(12)
    v_mfma_f32_16x16x32_bf16 v[28:31], v[64:67], v[112:115], v[28:31]
    v_mfma_f32_16x16x32_bf16 v[24:27], v[68:71], v[112:115], v[24:27]
    v_mfma_f32_16x16x32_bf16 v[20:23], v[72:75], v[112:115], v[20:23]
    v_mfma_f32_16x16x32_bf16 v[16:19], v[76:79], v[112:115], v[16:19]
    v_xor_b32 v123, 48, v126
    ds_write_b128 v123, v[44:47]
    s_waitcnt lgkmcnt(12)
    v_mfma_f32_16x16x32_bf16 v[56:59], v[80:83], v[88:91], v[56:59]
    v_mfma_f32_16x16x32_bf16 v[52:55], v[84:87], v[88:91], v[52:55]
    v_xor_b32 v124, 48, v125
    ds_write_b128 v124, v[12:15]
    s_waitcnt lgkmcnt(11)
    v_mfma_f32_16x16x32_bf16 v[28:31], v[68:71], v[92:95], v[28:31]
    v_mfma_f32_16x16x32_bf16 v[24:27], v[72:75], v[92:95], v[24:27]
    v_mfma_f32_16x16x32_bf16 v[20:23], v[76:79], v[92:95], v[20:23]
    v_xor_b32 v124, 64, v126
    ds_write_b128 v124, v[48:51]
    s_waitcnt lgkmcnt(10)
    v_mfma_f32_16x16x32_bf16 v[60:63], v[80:83], v[96:99], v[60:63]
    v_mfma_f32_16x16x32_bf16 v[56:59], v[84:87], v[96:99], v[56:59]
    v_xor_b32 v123, 64, v125
    ds_write_b128 v123, v[16:19]
    s_waitcnt lgkmcnt(9)
    v_mfma_f32_16x16x32_bf16 v[28:31], v[72:75], v[100:103], v[28:31]
    v_mfma_f32_16x16x32_bf16 v[24:27], v[76:79], v[100:103], v[24:27]
    v_xor_b32 v123, 80, v126
    ds_write_b128 v123, v[52:55]
    s_waitcnt lgkmcnt(8)
    v_mfma_f32_16x16x32_bf16 v[60:63], v[84:87], v[104:107], v[60:63]
    v_xor_b32 v124, 80, v125
    ds_write_b128 v124, v[20:23]
    s_waitcnt lgkmcnt(7)
    v_mfma_f32_16x16x32_bf16 v[28:31], v[76:79], v[108:111], v[28:31]
    v_xor_b32 v124, 96, v126
    ds_write_b128 v124, v[56:59]
    s_nop 7
    v_xor_b32 v123, 96, v125
    ds_write_b128 v123, v[24:27]
    v_xor_b32 v123, 112, v126
    ds_write_b128 v123, v[60:63]
    v_xor_b32 v124, 112, v125
    ds_write_b128 v124, v[28:31]
    s_setprio 0
    s_branch L_conv2_kernel_epi
L_conv2_kernel_helper:
    s_setprio 3
    v_add_u32 v92, 0, v7
    v_add_u32 v93, 1024, v7
    v_add_u32 v94, 2048, v7
    v_add_u32 v95, 3072, v7
    v_and_b32 v76, 4, v5
    v_lshrrev_b32 v76, 1, v76
    v_xor_b32 v76, v6, v76
    v_lshlrev_b32 v76, 4, v76
    v_lshl_add_u32 v76, v5, 6, v76
    s_mov_b32 s24, 0
    buffer_load_dwordx4 v[0:3], v92, s[8:11], s24 offen offset:0
    buffer_load_dwordx4 v[16:19], v92, s[8:11], s24 offen offset:64
    v_add_u32 v92, 128, v92
    buffer_load_dwordx4 v[4:7], v93, s[8:11], s24 offen offset:0
    buffer_load_dwordx4 v[20:23], v93, s[8:11], s24 offen offset:64
    v_add_u32 v93, 128, v93
    buffer_load_dwordx4 v[8:11], v94, s[8:11], s24 offen offset:0
    buffer_load_dwordx4 v[24:27], v94, s[8:11], s24 offen offset:64
    v_add_u32 v94, 128, v94
    buffer_load_dwordx4 v[12:15], v95, s[8:11], s24 offen offset:0
    buffer_load_dwordx4 v[28:31], v95, s[8:11], s24 offen offset:64
    v_add_u32 v95, 128, v95
    s_barrier
    s_mul_i32 s36, s42, 1024
    v_add_u32 v96, s36, v76
    v_add_u32 v97, 65536, v96
    s_mul_i32 s36, s42, 1088
    s_add_u32 s36, s36, 98304
    v_add_u32 v98, s36, v76
    s_lshl_b32 s36, s29, 4
    s_lshl_b32 s37, s33, 3
    s_add_u32 s36, s36, s37
    s_mul_i32 s36, s36, 57344
    s_add_u32 s36, s36, 9437184
    s_add_u32 s12, s30, s36
    s_addc_u32 s13, s31, 0
    s_mov_b32 s14, 458752
    s_mov_b32 s15, 0x00020000
    s_bfe_u32 s36, s2, 131075
    s_lshl_b32 s36, s36, 3
    s_add_u32 s36, s36, s42
    s_lshl_b32 s36, s36, 14
    s_add_u32 s44, s36, s41
    s_add_u32 s44, s44, 256
    s_lshr_b32 s36, s2, 5
    s_lshl_b32 s36, s36, 3
    s_add_u32 s36, s36, s42
    s_mul_i32 s45, s36, 896
    s_add_u32 s45, s45, 57344
    s_waitcnt vmcnt(0)
    s_waitcnt lgkmcnt(0)
    s_mov_b32 s28, 0
    s_mov_b32 s22, 2
    s_cmp_ge_u32 s20, 12
    s_cbranch_scc1 L_conv2_kernel_h2
    s_waitcnt lgkmcnt(0)
    ds_write_b128 v96, v[0:3] offset:0
    ds_write_b128 v98, v[12:15] offset:0
    v_lshlrev_b32 v76, 16, v0
    v_and_b32 v84, s25, v0
    v_lshlrev_b32 v77, 16, v4
    v_and_b32 v85, s25, v4
    v_lshlrev_b32 v78, 16, v8
    v_and_b32 v86, s25, v8
    v_lshlrev_b32 v79, 16, v12
    v_and_b32 v87, s25, v12
    v_add_f32 v80, v76, v78
    v_add_f32 v88, v84, v86
    v_add_f32 v81, v77, v79
    v_add_f32 v89, v85, v87
    v_fma_f32 v82, v78, 4.0, v76
    v_fma_f32 v90, v86, 4.0, v84
    v_fma_f32 v83, v79, 4.0, v77
    v_fma_f32 v91, v87, 4.0, v85
    v_add_f32 v77, v80, v81
    v_add_f32 v85, v88, v89
    v_sub_f32 v78, v80, v81
    v_sub_f32 v86, v88, v89
    v_fma_f32 v79, v83, 2.0, v82
    v_fma_f32 v87, v91, 2.0, v90
    v_fma_f32 v82, v83, -2.0, v82
    v_fma_f32 v90, v91, -2.0, v90
    v_fmamk_f32 v80, v76, 0x41700000, v82
    v_fmamk_f32 v88, v84, 0x41700000, v90
    v_fmamk_f32 v80, v81, 0x41200000, v80
    v_fmamk_f32 v88, v89, 0x41200000, v88
    v_cvt_pk_bf16_f32 v4, v77, v85
    v_cvt_pk_bf16_f32 v8, v78, v86
    v_cvt_pk_bf16_f32 v64, v79, v87
    v_cvt_pk_bf16_f32 v68, v82, v90
    v_cvt_pk_bf16_f32 v72, v80, v88
    v_lshlrev_b32 v76, 16, v1
    v_and_b32 v84, s25, v1
    v_lshlrev_b32 v77, 16, v5
    v_and_b32 v85, s25, v5
    v_lshlrev_b32 v78, 16, v9
    v_and_b32 v86, s25, v9
    v_lshlrev_b32 v79, 16, v13
    v_and_b32 v87, s25, v13
    v_add_f32 v80, v76, v78
    v_add_f32 v88, v84, v86
    v_add_f32 v81, v77, v79
    v_add_f32 v89, v85, v87
    v_fma_f32 v82, v78, 4.0, v76
    v_fma_f32 v90, v86, 4.0, v84
    v_fma_f32 v83, v79, 4.0, v77
    v_fma_f32 v91, v87, 4.0, v85
    v_add_f32 v77, v80, v81
    v_add_f32 v85, v88, v89
    v_sub_f32 v78, v80, v81
    v_sub_f32 v86, v88, v89
    v_fma_f32 v79, v83, 2.0, v82
    v_fma_f32 v87, v91, 2.0, v90
    v_fma_f32 v82, v83, -2.0, v82
    v_fma_f32 v90, v91, -2.0, v90
    v_fmamk_f32 v80, v76, 0x41700000, v82
    v_fmamk_f32 v88, v84, 0x41700000, v90
    v_fmamk_f32 v80, v81, 0x41200000, v80
    v_fmamk_f32 v88, v89, 0x41200000, v88
    v_cvt_pk_bf16_f32 v5, v77, v85
    v_cvt_pk_bf16_f32 v9, v78, v86
    v_cvt_pk_bf16_f32 v65, v79, v87
    v_cvt_pk_bf16_f32 v69, v82, v90
    v_cvt_pk_bf16_f32 v73, v80, v88
    v_lshlrev_b32 v76, 16, v2
    v_and_b32 v84, s25, v2
    v_lshlrev_b32 v77, 16, v6
    v_and_b32 v85, s25, v6
    v_lshlrev_b32 v78, 16, v10
    v_and_b32 v86, s25, v10
    v_lshlrev_b32 v79, 16, v14
    v_and_b32 v87, s25, v14
    v_add_f32 v80, v76, v78
    v_add_f32 v88, v84, v86
    v_add_f32 v81, v77, v79
    v_add_f32 v89, v85, v87
    v_fma_f32 v82, v78, 4.0, v76
    v_fma_f32 v90, v86, 4.0, v84
    v_fma_f32 v83, v79, 4.0, v77
    v_fma_f32 v91, v87, 4.0, v85
    v_add_f32 v77, v80, v81
    v_add_f32 v85, v88, v89
    v_sub_f32 v78, v80, v81
    v_sub_f32 v86, v88, v89
    v_fma_f32 v79, v83, 2.0, v82
    v_fma_f32 v87, v91, 2.0, v90
    v_fma_f32 v82, v83, -2.0, v82
    v_fma_f32 v90, v91, -2.0, v90
    v_fmamk_f32 v80, v76, 0x41700000, v82
    v_fmamk_f32 v88, v84, 0x41700000, v90
    v_fmamk_f32 v80, v81, 0x41200000, v80
    v_fmamk_f32 v88, v89, 0x41200000, v88
    v_cvt_pk_bf16_f32 v6, v77, v85
    v_cvt_pk_bf16_f32 v10, v78, v86
    v_cvt_pk_bf16_f32 v66, v79, v87
    v_cvt_pk_bf16_f32 v70, v82, v90
    v_cvt_pk_bf16_f32 v74, v80, v88
    v_lshlrev_b32 v76, 16, v3
    v_and_b32 v84, s25, v3
    v_lshlrev_b32 v77, 16, v7
    v_and_b32 v85, s25, v7
    v_lshlrev_b32 v78, 16, v11
    v_and_b32 v86, s25, v11
    v_lshlrev_b32 v79, 16, v15
    v_and_b32 v87, s25, v15
    v_add_f32 v80, v76, v78
    v_add_f32 v88, v84, v86
    v_add_f32 v81, v77, v79
    v_add_f32 v89, v85, v87
    v_fma_f32 v82, v78, 4.0, v76
    v_fma_f32 v90, v86, 4.0, v84
    v_fma_f32 v83, v79, 4.0, v77
    v_fma_f32 v91, v87, 4.0, v85
    v_add_f32 v77, v80, v81
    v_add_f32 v85, v88, v89
    v_sub_f32 v78, v80, v81
    v_sub_f32 v86, v88, v89
    v_fma_f32 v79, v83, 2.0, v82
    v_fma_f32 v87, v91, 2.0, v90
    v_fma_f32 v82, v83, -2.0, v82
    v_fma_f32 v90, v91, -2.0, v90
    v_fmamk_f32 v80, v76, 0x41700000, v82
    v_fmamk_f32 v88, v84, 0x41700000, v90
    v_fmamk_f32 v80, v81, 0x41200000, v80
    v_fmamk_f32 v88, v89, 0x41200000, v88
    v_cvt_pk_bf16_f32 v7, v77, v85
    v_cvt_pk_bf16_f32 v11, v78, v86
    v_cvt_pk_bf16_f32 v67, v79, v87
    v_cvt_pk_bf16_f32 v71, v82, v90
    v_cvt_pk_bf16_f32 v75, v80, v88
    ds_write_b128 v96, v[4:7] offset:16384
    ds_write_b128 v96, v[8:11] offset:32768
    ds_write_b128 v96, v[64:67] offset:49152
    ds_write_b128 v97, v[68:71] offset:0
    ds_write_b128 v97, v[72:75] offset:16384
    buffer_load_dwordx4 v[32:35], v92, s[8:11], s24 offen offset:0
    buffer_load_dwordx4 v[48:51], v92, s[8:11], s24 offen offset:64
    v_add_u32 v92, 128, v92
    buffer_load_dwordx4 v[36:39], v93, s[8:11], s24 offen offset:0
    buffer_load_dwordx4 v[52:55], v93, s[8:11], s24 offen offset:64
    v_add_u32 v93, 128, v93
    s_waitcnt lgkmcnt(0)
    s_barrier
    s_setprio 1
L_conv2_kernel_hloop1:
    s_cmp_lt_u32 s28, 5
    s_cselect_b32 s24, 0, 2130706432
    v_lshlrev_b32 v76, 16, v16
    v_and_b32 v84, s25, v16
    v_lshlrev_b32 v77, 16, v20
    v_and_b32 v85, s25, v20
    v_lshlrev_b32 v78, 16, v24
    v_and_b32 v86, s25, v24
    v_lshlrev_b32 v79, 16, v28
    v_and_b32 v87, s25, v28
    v_add_f32 v80, v76, v78
    v_add_f32 v88, v84, v86
    v_add_f32 v81, v77, v79
    v_add_f32 v89, v85, v87
    v_fma_f32 v82, v78, 4.0, v76
    buffer_load_dwordx4 v[40:43], v94, s[8:11], s24 offen offset:0
    buffer_load_dwordx4 v[56:59], v94, s[8:11], s24 offen offset:64
    v_add_u32 v94, 128, v94
    v_fma_f32 v90, v86, 4.0, v84
    v_fma_f32 v83, v79, 4.0, v77
    v_fma_f32 v91, v87, 4.0, v85
    v_add_f32 v77, v80, v81
    v_add_f32 v85, v88, v89
    v_sub_f32 v78, v80, v81
    v_sub_f32 v86, v88, v89
    v_fma_f32 v79, v83, 2.0, v82
    v_fma_f32 v87, v91, 2.0, v90
    v_fma_f32 v82, v83, -2.0, v82
    v_fma_f32 v90, v91, -2.0, v90
    v_fmamk_f32 v80, v76, 0x41700000, v82
    v_fmamk_f32 v88, v84, 0x41700000, v90
    v_fmamk_f32 v80, v81, 0x41200000, v80
    v_fmamk_f32 v88, v89, 0x41200000, v88
    v_cvt_pk_bf16_f32 v20, v77, v85
    v_cvt_pk_bf16_f32 v24, v78, v86
    v_cvt_pk_bf16_f32 v64, v79, v87
    v_cvt_pk_bf16_f32 v68, v82, v90
    v_cvt_pk_bf16_f32 v72, v80, v88
    v_lshlrev_b32 v76, 16, v17
    v_and_b32 v84, s25, v17
    v_lshlrev_b32 v77, 16, v21
    v_and_b32 v85, s25, v21
    v_lshlrev_b32 v78, 16, v25
    v_and_b32 v86, s25, v25
    v_lshlrev_b32 v79, 16, v29
    v_and_b32 v87, s25, v29
    v_add_f32 v80, v76, v78
    v_add_f32 v88, v84, v86
    v_add_f32 v81, v77, v79
    v_add_f32 v89, v85, v87
    v_fma_f32 v82, v78, 4.0, v76
    v_fma_f32 v90, v86, 4.0, v84
    v_fma_f32 v83, v79, 4.0, v77
    v_fma_f32 v91, v87, 4.0, v85
    v_add_f32 v77, v80, v81
    v_add_f32 v85, v88, v89
    v_sub_f32 v78, v80, v81
    v_sub_f32 v86, v88, v89
    v_fma_f32 v79, v83, 2.0, v82
    v_fma_f32 v87, v91, 2.0, v90
    v_fma_f32 v82, v83, -2.0, v82
    v_fma_f32 v90, v91, -2.0, v90
    v_fmamk_f32 v80, v76, 0x41700000, v82
    v_fmamk_f32 v88, v84, 0x41700000, v90
    v_fmamk_f32 v80, v81, 0x41200000, v80
    v_fmamk_f32 v88, v89, 0x41200000, v88
    v_cvt_pk_bf16_f32 v21, v77, v85
    v_cvt_pk_bf16_f32 v25, v78, v86
    v_cvt_pk_bf16_f32 v65, v79, v87
    v_cvt_pk_bf16_f32 v69, v82, v90
    v_cvt_pk_bf16_f32 v73, v80, v88
    buffer_load_dwordx4 v[44:47], v95, s[8:11], s24 offen offset:0
    buffer_load_dwordx4 v[60:63], v95, s[8:11], s24 offen offset:64
    v_add_u32 v95, 128, v95
    v_lshlrev_b32 v76, 16, v18
    v_and_b32 v84, s25, v18
    v_lshlrev_b32 v77, 16, v22
    v_and_b32 v85, s25, v22
    v_lshlrev_b32 v78, 16, v26
    v_and_b32 v86, s25, v26
    v_lshlrev_b32 v79, 16, v30
    v_and_b32 v87, s25, v30
    v_add_f32 v80, v76, v78
    v_add_f32 v88, v84, v86
    v_add_f32 v81, v77, v79
    v_add_f32 v89, v85, v87
    v_fma_f32 v82, v78, 4.0, v76
    v_fma_f32 v90, v86, 4.0, v84
    v_fma_f32 v83, v79, 4.0, v77
    v_fma_f32 v91, v87, 4.0, v85
    v_add_f32 v77, v80, v81
    v_add_f32 v85, v88, v89
    v_sub_f32 v78, v80, v81
    v_sub_f32 v86, v88, v89
    v_fma_f32 v79, v83, 2.0, v82
    v_fma_f32 v87, v91, 2.0, v90
    v_fma_f32 v82, v83, -2.0, v82
    v_fma_f32 v90, v91, -2.0, v90
    v_fmamk_f32 v80, v76, 0x41700000, v82
    v_fmamk_f32 v88, v84, 0x41700000, v90
    v_fmamk_f32 v80, v81, 0x41200000, v80
    v_fmamk_f32 v88, v89, 0x41200000, v88
    v_cvt_pk_bf16_f32 v22, v77, v85
    v_cvt_pk_bf16_f32 v26, v78, v86
    v_cvt_pk_bf16_f32 v66, v79, v87
    v_cvt_pk_bf16_f32 v70, v82, v90
    v_cvt_pk_bf16_f32 v74, v80, v88
    v_lshlrev_b32 v76, 16, v19
    v_and_b32 v84, s25, v19
    v_lshlrev_b32 v77, 16, v23
    v_and_b32 v85, s25, v23
    v_lshlrev_b32 v78, 16, v27
    v_and_b32 v86, s25, v27
    v_lshlrev_b32 v79, 16, v31
    v_and_b32 v87, s25, v31
    v_add_f32 v80, v76, v78
    v_add_f32 v88, v84, v86
    v_add_f32 v81, v77, v79
    v_add_f32 v89, v85, v87
    v_fma_f32 v82, v78, 4.0, v76
    v_fma_f32 v90, v86, 4.0, v84
    v_fma_f32 v83, v79, 4.0, v77
    v_fma_f32 v91, v87, 4.0, v85
    v_add_f32 v77, v80, v81
    v_add_f32 v85, v88, v89
    v_sub_f32 v78, v80, v81
    v_sub_f32 v86, v88, v89
    v_fma_f32 v79, v83, 2.0, v82
    v_fma_f32 v87, v91, 2.0, v90
    v_fma_f32 v82, v83, -2.0, v82
    v_fma_f32 v90, v91, -2.0, v90
    v_fmamk_f32 v80, v76, 0x41700000, v82
    v_fmamk_f32 v88, v84, 0x41700000, v90
    v_fmamk_f32 v80, v81, 0x41200000, v80
    v_fmamk_f32 v88, v89, 0x41200000, v88
    v_cvt_pk_bf16_f32 v23, v77, v85
    v_cvt_pk_bf16_f32 v27, v78, v86
    v_cvt_pk_bf16_f32 v67, v79, v87
    v_cvt_pk_bf16_f32 v71, v82, v90
    v_cvt_pk_bf16_f32 v75, v80, v88
    s_waitcnt lgkmcnt(0)
    ds_write_b128 v96, v[64:67] offset:57344
    ds_write_b128 v97, v[68:71] offset:8192
    ds_write_b128 v97, v[72:75] offset:24576
    ds_write_b128 v96, v[16:19] offset:8192
    ds_write_b128 v96, v[20:23] offset:24576
    ds_write_b128 v96, v[24:27] offset:40960
    ds_write_b128 v98, v[28:31] offset:8704
    s_add_u32 s28, s28, 1
    s_waitcnt lgkmcnt(0)
    s_barrier
    s_cmp_lt_u32 s28, 5
    s_cselect_b32 s24, 0, 2130706432
    s_waitcnt vmcnt(0)
    v_lshlrev_b32 v76, 16, v32
    v_and_b32 v84, s25, v32
    v_lshlrev_b32 v77, 16, v36
    v_and_b32 v85, s25, v36
    v_lshlrev_b32 v78, 16, v40
    v_and_b32 v86, s25, v40
    v_lshlrev_b32 v79, 16, v44
    v_and_b32 v87, s25, v44
    v_add_f32 v80, v76, v78
    v_add_f32 v88, v84, v86
    v_add_f32 v81, v77, v79
    v_add_f32 v89, v85, v87
    v_fma_f32 v82, v78, 4.0, v76
    v_fma_f32 v90, v86, 4.0, v84
    v_fma_f32 v83, v79, 4.0, v77
    v_fma_f32 v91, v87, 4.0, v85
    v_add_f32 v77, v80, v81
    v_add_f32 v85, v88, v89
    v_sub_f32 v78, v80, v81
    v_sub_f32 v86, v88, v89
    v_fma_f32 v79, v83, 2.0, v82
    v_fma_f32 v87, v91, 2.0, v90
    v_fma_f32 v82, v83, -2.0, v82
    v_fma_f32 v90, v91, -2.0, v90
    v_fmamk_f32 v80, v76, 0x41700000, v82
    v_fmamk_f32 v88, v84, 0x41700000, v90
    v_fmamk_f32 v80, v81, 0x41200000, v80
    v_fmamk_f32 v88, v89, 0x41200000, v88
    v_cvt_pk_bf16_f32 v36, v77, v85
    v_cvt_pk_bf16_f32 v40, v78, v86
    v_cvt_pk_bf16_f32 v64, v79, v87
    v_cvt_pk_bf16_f32 v68, v82, v90
    v_cvt_pk_bf16_f32 v72, v80, v88
    v_lshlrev_b32 v76, 16, v33
    v_and_b32 v84, s25, v33
    v_lshlrev_b32 v77, 16, v37
    v_and_b32 v85, s25, v37
    v_lshlrev_b32 v78, 16, v41
    v_and_b32 v86, s25, v41
    buffer_load_dwordx4 v[0:3], v92, s[8:11], s24 offen offset:0
    buffer_load_dwordx4 v[16:19], v92, s[8:11], s24 offen offset:64
    v_add_u32 v92, 128, v92
    v_lshlrev_b32 v79, 16, v45
    v_and_b32 v87, s25, v45
    v_add_f32 v80, v76, v78
    v_add_f32 v88, v84, v86
    v_add_f32 v81, v77, v79
    v_add_f32 v89, v85, v87
    v_fma_f32 v82, v78, 4.0, v76
    v_fma_f32 v90, v86, 4.0, v84
    v_fma_f32 v83, v79, 4.0, v77
    v_fma_f32 v91, v87, 4.0, v85
    v_add_f32 v77, v80, v81
    v_add_f32 v85, v88, v89
    v_sub_f32 v78, v80, v81
    v_sub_f32 v86, v88, v89
    v_fma_f32 v79, v83, 2.0, v82
    v_fma_f32 v87, v91, 2.0, v90
    v_fma_f32 v82, v83, -2.0, v82
    v_fma_f32 v90, v91, -2.0, v90
    v_fmamk_f32 v80, v76, 0x41700000, v82
    v_fmamk_f32 v88, v84, 0x41700000, v90
    v_fmamk_f32 v80, v81, 0x41200000, v80
    v_fmamk_f32 v88, v89, 0x41200000, v88
    v_cvt_pk_bf16_f32 v37, v77, v85
    v_cvt_pk_bf16_f32 v41, v78, v86
    v_cvt_pk_bf16_f32 v65, v79, v87
    v_cvt_pk_bf16_f32 v69, v82, v90
    v_cvt_pk_bf16_f32 v73, v80, v88
    v_lshlrev_b32 v76, 16, v34
    v_and_b32 v84, s25, v34
    v_lshlrev_b32 v77, 16, v38
    v_and_b32 v85, s25, v38
    v_lshlrev_b32 v78, 16, v42
    v_and_b32 v86, s25, v42
    v_lshlrev_b32 v79, 16, v46
    v_and_b32 v87, s25, v46
    v_add_f32 v80, v76, v78
    v_add_f32 v88, v84, v86
    v_add_f32 v81, v77, v79
    v_add_f32 v89, v85, v87
    v_fma_f32 v82, v78, 4.0, v76
    v_fma_f32 v90, v86, 4.0, v84
    v_fma_f32 v83, v79, 4.0, v77
    v_fma_f32 v91, v87, 4.0, v85
    v_add_f32 v77, v80, v81
    v_add_f32 v85, v88, v89
    v_sub_f32 v78, v80, v81
    v_sub_f32 v86, v88, v89
    v_fma_f32 v79, v83, 2.0, v82
    v_fma_f32 v87, v91, 2.0, v90
    v_fma_f32 v82, v83, -2.0, v82
    v_fma_f32 v90, v91, -2.0, v90
    v_fmamk_f32 v80, v76, 0x41700000, v82
    v_fmamk_f32 v88, v84, 0x41700000, v90
    buffer_load_dwordx4 v[4:7], v93, s[8:11], s24 offen offset:0
    buffer_load_dwordx4 v[20:23], v93, s[8:11], s24 offen offset:64
    v_add_u32 v93, 128, v93
    v_fmamk_f32 v80, v81, 0x41200000, v80
    v_fmamk_f32 v88, v89, 0x41200000, v88
    v_cvt_pk_bf16_f32 v38, v77, v85
    v_cvt_pk_bf16_f32 v42, v78, v86
    v_cvt_pk_bf16_f32 v66, v79, v87
    v_cvt_pk_bf16_f32 v70, v82, v90
    v_cvt_pk_bf16_f32 v74, v80, v88
    v_lshlrev_b32 v76, 16, v35
    v_and_b32 v84, s25, v35
    v_lshlrev_b32 v77, 16, v39
    v_and_b32 v85, s25, v39
    v_lshlrev_b32 v78, 16, v43
    v_and_b32 v86, s25, v43
    v_lshlrev_b32 v79, 16, v47
    v_and_b32 v87, s25, v47
    v_add_f32 v80, v76, v78
    v_add_f32 v88, v84, v86
    v_add_f32 v81, v77, v79
    v_add_f32 v89, v85, v87
    v_fma_f32 v82, v78, 4.0, v76
    v_fma_f32 v90, v86, 4.0, v84
    v_fma_f32 v83, v79, 4.0, v77
    v_fma_f32 v91, v87, 4.0, v85
    v_add_f32 v77, v80, v81
    v_add_f32 v85, v88, v89
    v_sub_f32 v78, v80, v81
    v_sub_f32 v86, v88, v89
    v_fma_f32 v79, v83, 2.0, v82
    v_fma_f32 v87, v91, 2.0, v90
    v_fma_f32 v82, v83, -2.0, v82
    v_fma_f32 v90, v91, -2.0, v90
    v_fmamk_f32 v80, v76, 0x41700000, v82
    v_fmamk_f32 v88, v84, 0x41700000, v90
    v_fmamk_f32 v80, v81, 0x41200000, v80
    v_fmamk_f32 v88, v89, 0x41200000, v88
    v_cvt_pk_bf16_f32 v39, v77, v85
    v_cvt_pk_bf16_f32 v43, v78, v86
    v_cvt_pk_bf16_f32 v67, v79, v87
    v_cvt_pk_bf16_f32 v71, v82, v90
    v_cvt_pk_bf16_f32 v75, v80, v88
    s_waitcnt lgkmcnt(0)
    ds_write_b128 v96, v[64:67] offset:49152
    ds_write_b128 v97, v[68:71] offset:0
    ds_write_b128 v97, v[72:75] offset:16384
    ds_write_b128 v96, v[32:35] offset:0
    ds_write_b128 v96, v[36:39] offset:16384
    ds_write_b128 v96, v[40:43] offset:32768
    ds_write_b128 v98, v[44:47] offset:0
    s_add_u32 s28, s28, 1
    s_waitcnt lgkmcnt(0)
    s_barrier
    s_cmp_lt_u32 s28, 5
    s_cselect_b32 s24, 0, 2130706432
    v_lshlrev_b32 v76, 16, v48
    v_and_b32 v84, s25, v48
    v_lshlrev_b32 v77, 16, v52
    v_and_b32 v85, s25, v52
    v_lshlrev_b32 v78, 16, v56
    v_and_b32 v86, s25, v56
    v_lshlrev_b32 v79, 16, v60
    v_and_b32 v87, s25, v60
    v_add_f32 v80, v76, v78
    v_add_f32 v88, v84, v86
    v_add_f32 v81, v77, v79
    v_add_f32 v89, v85, v87
    v_fma_f32 v82, v78, 4.0, v76
    buffer_load_dwordx4 v[8:11], v94, s[8:11], s24 offen offset:0
    buffer_load_dwordx4 v[24:27], v94, s[8:11], s24 offen offset:64
    v_add_u32 v94, 128, v94
    v_fma_f32 v90, v86, 4.0, v84
    v_fma_f32 v83, v79, 4.0, v77
    v_fma_f32 v91, v87, 4.0, v85
    v_add_f32 v77, v80, v81
    v_add_f32 v85, v88, v89
    v_sub_f32 v78, v80, v81
    v_sub_f32 v86, v88, v89
    v_fma_f32 v79, v83, 2.0, v82
    v_fma_f32 v87, v91, 2.0, v90
    v_fma_f32 v82, v83, -2.0, v82
    v_fma_f32 v90, v91, -2.0, v90
    v_fmamk_f32 v80, v76, 0x41700000, v82
    v_fmamk_f32 v88, v84, 0x41700000, v90
    v_fmamk_f32 v80, v81, 0x41200000, v80
    v_fmamk_f32 v88, v89, 0x41200000, v88
    v_cvt_pk_bf16_f32 v52, v77, v85
    v_cvt_pk_bf16_f32 v56, v78, v86
    v_cvt_pk_bf16_f32 v64, v79, v87
    v_cvt_pk_bf16_f32 v68, v82, v90
    v_cvt_pk_bf16_f32 v72, v80, v88
    v_lshlrev_b32 v76, 16, v49
    v_and_b32 v84, s25, v49
    v_lshlrev_b32 v77, 16, v53
    v_and_b32 v85, s25, v53
    v_lshlrev_b32 v78, 16, v57
    v_and_b32 v86, s25, v57
    v_lshlrev_b32 v79, 16, v61
    v_and_b32 v87, s25, v61
    v_add_f32 v80, v76, v78
    v_add_f32 v88, v84, v86
    v_add_f32 v81, v77, v79
    v_add_f32 v89, v85, v87
    v_fma_f32 v82, v78, 4.0, v76
    v_fma_f32 v90, v86, 4.0, v84
    v_fma_f32 v83, v79, 4.0, v77
    v_fma_f32 v91, v87, 4.0, v85
    v_add_f32 v77, v80, v81
    v_add_f32 v85, v88, v89
    v_sub_f32 v78, v80, v81
    v_sub_f32 v86, v88, v89
    v_fma_f32 v79, v83, 2.0, v82
    v_fma_f32 v87, v91, 2.0, v90
    v_fma_f32 v82, v83, -2.0, v82
    v_fma_f32 v90, v91, -2.0, v90
    v_fmamk_f32 v80, v76, 0x41700000, v82
    v_fmamk_f32 v88, v84, 0x41700000, v90
    v_fmamk_f32 v80, v81, 0x41200000, v80
    v_fmamk_f32 v88, v89, 0x41200000, v88
    v_cvt_pk_bf16_f32 v53, v77, v85
    v_cvt_pk_bf16_f32 v57, v78, v86
    v_cvt_pk_bf16_f32 v65, v79, v87
    v_cvt_pk_bf16_f32 v69, v82, v90
    v_cvt_pk_bf16_f32 v73, v80, v88
    buffer_load_dwordx4 v[12:15], v95, s[8:11], s24 offen offset:0
    buffer_load_dwordx4 v[28:31], v95, s[8:11], s24 offen offset:64
    v_add_u32 v95, 128, v95
    v_lshlrev_b32 v76, 16, v50
    v_and_b32 v84, s25, v50
    v_lshlrev_b32 v77, 16, v54
    v_and_b32 v85, s25, v54
    v_lshlrev_b32 v78, 16, v58
    v_and_b32 v86, s25, v58
    v_lshlrev_b32 v79, 16, v62
    v_and_b32 v87, s25, v62
    v_add_f32 v80, v76, v78
    v_add_f32 v88, v84, v86
    v_add_f32 v81, v77, v79
    v_add_f32 v89, v85, v87
    v_fma_f32 v82, v78, 4.0, v76
    v_fma_f32 v90, v86, 4.0, v84
    v_fma_f32 v83, v79, 4.0, v77
    v_fma_f32 v91, v87, 4.0, v85
    v_add_f32 v77, v80, v81
    v_add_f32 v85, v88, v89
    v_sub_f32 v78, v80, v81
    v_sub_f32 v86, v88, v89
    v_fma_f32 v79, v83, 2.0, v82
    v_fma_f32 v87, v91, 2.0, v90
    v_fma_f32 v82, v83, -2.0, v82
    v_fma_f32 v90, v91, -2.0, v90
    v_fmamk_f32 v80, v76, 0x41700000, v82
    v_fmamk_f32 v88, v84, 0x41700000, v90
    v_fmamk_f32 v80, v81, 0x41200000, v80
    v_fmamk_f32 v88, v89, 0x41200000, v88
    v_cvt_pk_bf16_f32 v54, v77, v85
    v_cvt_pk_bf16_f32 v58, v78, v86
    v_cvt_pk_bf16_f32 v66, v79, v87
    v_cvt_pk_bf16_f32 v70, v82, v90
    v_cvt_pk_bf16_f32 v74, v80, v88
    v_lshlrev_b32 v76, 16, v51
    v_and_b32 v84, s25, v51
    v_lshlrev_b32 v77, 16, v55
    v_and_b32 v85, s25, v55
    v_lshlrev_b32 v78, 16, v59
    v_and_b32 v86, s25, v59
    v_lshlrev_b32 v79, 16, v63
    v_and_b32 v87, s25, v63
    v_add_f32 v80, v76, v78
    v_add_f32 v88, v84, v86
    v_add_f32 v81, v77, v79
    v_add_f32 v89, v85, v87
    v_fma_f32 v82, v78, 4.0, v76
    v_fma_f32 v90, v86, 4.0, v84
    v_fma_f32 v83, v79, 4.0, v77
    v_fma_f32 v91, v87, 4.0, v85
    v_add_f32 v77, v80, v81
    v_add_f32 v85, v88, v89
    v_sub_f32 v78, v80, v81
    v_sub_f32 v86, v88, v89
    v_fma_f32 v79, v83, 2.0, v82
    v_fma_f32 v87, v91, 2.0, v90
    v_fma_f32 v82, v83, -2.0, v82
    v_fma_f32 v90, v91, -2.0, v90
    v_fmamk_f32 v80, v76, 0x41700000, v82
    v_fmamk_f32 v88, v84, 0x41700000, v90
    v_fmamk_f32 v80, v81, 0x41200000, v80
    v_fmamk_f32 v88, v89, 0x41200000, v88
    v_cvt_pk_bf16_f32 v55, v77, v85
    v_cvt_pk_bf16_f32 v59, v78, v86
    v_cvt_pk_bf16_f32 v67, v79, v87
    v_cvt_pk_bf16_f32 v71, v82, v90
    v_cvt_pk_bf16_f32 v75, v80, v88
    s_waitcnt lgkmcnt(0)
    ds_write_b128 v96, v[64:67] offset:57344
    ds_write_b128 v97, v[68:71] offset:8192
    ds_write_b128 v97, v[72:75] offset:24576
    ds_write_b128 v96, v[48:51] offset:8192
    ds_write_b128 v96, v[52:55] offset:24576
    ds_write_b128 v96, v[56:59] offset:40960
    ds_write_b128 v98, v[60:63] offset:8704
    s_add_u32 s28, s28, 1
    s_waitcnt lgkmcnt(0)
    s_barrier
    s_cmp_eq_u32 s22, 1
    s_cbranch_scc1 L_conv2_kernel_hlast1
    s_cmp_lt_u32 s28, 5
    s_cselect_b32 s24, 0, 2130706432
    s_waitcnt vmcnt(0)
    v_lshlrev_b32 v76, 16, v0
    v_and_b32 v84, s25, v0
    v_lshlrev_b32 v77, 16, v4
    v_and_b32 v85, s25, v4
    v_lshlrev_b32 v78, 16, v8
    v_and_b32 v86, s25, v8
    v_lshlrev_b32 v79, 16, v12
    v_and_b32 v87, s25, v12
    v_add_f32 v80, v76, v78
    v_add_f32 v88, v84, v86
    v_add_f32 v81, v77, v79
    v_add_f32 v89, v85, v87
    v_fma_f32 v82, v78, 4.0, v76
    v_fma_f32 v90, v86, 4.0, v84
    v_fma_f32 v83, v79, 4.0, v77
    v_fma_f32 v91, v87, 4.0, v85
    v_add_f32 v77, v80, v81
    v_add_f32 v85, v88, v89
    v_sub_f32 v78, v80, v81
    v_sub_f32 v86, v88, v89
    v_fma_f32 v79, v83, 2.0, v82
    v_fma_f32 v87, v91, 2.0, v90
    v_fma_f32 v82, v83, -2.0, v82
    v_fma_f32 v90, v91, -2.0, v90
    v_fmamk_f32 v80, v76, 0x41700000, v82
    v_fmamk_f32 v88, v84, 0x41700000, v90
    v_fmamk_f32 v80, v81, 0x41200000, v80
    v_fmamk_f32 v88, v89, 0x41200000, v88
    v_cvt_pk_bf16_f32 v4, v77, v85
    v_cvt_pk_bf16_f32 v8, v78, v86
    v_cvt_pk_bf16_f32 v64, v79, v87
    v_cvt_pk_bf16_f32 v68, v82, v90
    v_cvt_pk_bf16_f32 v72, v80, v88
    v_lshlrev_b32 v76, 16, v1
    v_and_b32 v84, s25, v1
    v_lshlrev_b32 v77, 16, v5
    v_and_b32 v85, s25, v5
    v_lshlrev_b32 v78, 16, v9
    v_and_b32 v86, s25, v9
    buffer_load_dwordx4 v[32:35], v92, s[8:11], s24 offen offset:0
    buffer_load_dwordx4 v[48:51], v92, s[8:11], s24 offen offset:64
    v_add_u32 v92, 128, v92
    v_lshlrev_b32 v79, 16, v13
    v_and_b32 v87, s25, v13
    v_add_f32 v80, v76, v78
    v_add_f32 v88, v84, v86
    v_add_f32 v81, v77, v79
    v_add_f32 v89, v85, v87
    v_fma_f32 v82, v78, 4.0, v76
    v_fma_f32 v90, v86, 4.0, v84
    v_fma_f32 v83, v79, 4.0, v77
    v_fma_f32 v91, v87, 4.0, v85
    v_add_f32 v77, v80, v81
    v_add_f32 v85, v88, v89
    v_sub_f32 v78, v80, v81
    v_sub_f32 v86, v88, v89
    v_fma_f32 v79, v83, 2.0, v82
    v_fma_f32 v87, v91, 2.0, v90
    v_fma_f32 v82, v83, -2.0, v82
    v_fma_f32 v90, v91, -2.0, v90
    v_fmamk_f32 v80, v76, 0x41700000, v82
    v_fmamk_f32 v88, v84, 0x41700000, v90
    v_fmamk_f32 v80, v81, 0x41200000, v80
    v_fmamk_f32 v88, v89, 0x41200000, v88
    v_cvt_pk_bf16_f32 v5, v77, v85
    v_cvt_pk_bf16_f32 v9, v78, v86
    v_cvt_pk_bf16_f32 v65, v79, v87
    v_cvt_pk_bf16_f32 v69, v82, v90
    v_cvt_pk_bf16_f32 v73, v80, v88
    v_lshlrev_b32 v76, 16, v2
    v_and_b32 v84, s25, v2
    v_lshlrev_b32 v77, 16, v6
    v_and_b32 v85, s25, v6
    v_lshlrev_b32 v78, 16, v10
    v_and_b32 v86, s25, v10
    v_lshlrev_b32 v79, 16, v14
    v_and_b32 v87, s25, v14
    v_add_f32 v80, v76, v78
    v_add_f32 v88, v84, v86
    v_add_f32 v81, v77, v79
    v_add_f32 v89, v85, v87
    v_fma_f32 v82, v78, 4.0, v76
    v_fma_f32 v90, v86, 4.0, v84
    v_fma_f32 v83, v79, 4.0, v77
    v_fma_f32 v91, v87, 4.0, v85
    v_add_f32 v77, v80, v81
    v_add_f32 v85, v88, v89
    v_sub_f32 v78, v80, v81
    v_sub_f32 v86, v88, v89
    v_fma_f32 v79, v83, 2.0, v82
    v_fma_f32 v87, v91, 2.0, v90
    v_fma_f32 v82, v83, -2.0, v82
    v_fma_f32 v90, v91, -2.0, v90
    v_fmamk_f32 v80, v76, 0x41700000, v82
    v_fmamk_f32 v88, v84, 0x41700000, v90
    buffer_load_dwordx4 v[36:39], v93, s[8:11], s24 offen offset:0
    buffer_load_dwordx4 v[52:55], v93, s[8:11], s24 offen offset:64
    v_add_u32 v93, 128, v93
    v_fmamk_f32 v80, v81, 0x41200000, v80
    v_fmamk_f32 v88, v89, 0x41200000, v88
    v_cvt_pk_bf16_f32 v6, v77, v85
    v_cvt_pk_bf16_f32 v10, v78, v86
    v_cvt_pk_bf16_f32 v66, v79, v87
    v_cvt_pk_bf16_f32 v70, v82, v90
    v_cvt_pk_bf16_f32 v74, v80, v88
    v_lshlrev_b32 v76, 16, v3
    v_and_b32 v84, s25, v3
    v_lshlrev_b32 v77, 16, v7
    v_and_b32 v85, s25, v7
    v_lshlrev_b32 v78, 16, v11
    v_and_b32 v86, s25, v11
    v_lshlrev_b32 v79, 16, v15
    v_and_b32 v87, s25, v15
    v_add_f32 v80, v76, v78
    v_add_f32 v88, v84, v86
    v_add_f32 v81, v77, v79
    v_add_f32 v89, v85, v87
    v_fma_f32 v82, v78, 4.0, v76
    v_fma_f32 v90, v86, 4.0, v84
    v_fma_f32 v83, v79, 4.0, v77
    v_fma_f32 v91, v87, 4.0, v85
    v_add_f32 v77, v80, v81
    v_add_f32 v85, v88, v89
    v_sub_f32 v78, v80, v81
    v_sub_f32 v86, v88, v89
    v_fma_f32 v79, v83, 2.0, v82
    v_fma_f32 v87, v91, 2.0, v90
    v_fma_f32 v82, v83, -2.0, v82
    v_fma_f32 v90, v91, -2.0, v90
    v_fmamk_f32 v80, v76, 0x41700000, v82
    v_fmamk_f32 v88, v84, 0x41700000, v90
    v_fmamk_f32 v80, v81, 0x41200000, v80
    v_fmamk_f32 v88, v89, 0x41200000, v88
    v_cvt_pk_bf16_f32 v7, v77, v85
    v_cvt_pk_bf16_f32 v11, v78, v86
    v_cvt_pk_bf16_f32 v67, v79, v87
    v_cvt_pk_bf16_f32 v71, v82, v90
    v_cvt_pk_bf16_f32 v75, v80, v88
    s_waitcnt lgkmcnt(0)
    ds_write_b128 v96, v[64:67] offset:49152
    ds_write_b128 v97, v[68:71] offset:0
    ds_write_b128 v97, v[72:75] offset:16384
    ds_write_b128 v96, v[0:3] offset:0
    ds_write_b128 v96, v[4:7] offset:16384
    ds_write_b128 v96, v[8:11] offset:32768
    ds_write_b128 v98, v[12:15] offset:0
    s_add_u32 s28, s28, 1
    s_waitcnt lgkmcnt(0)
    s_barrier
    s_sub_u32 s22, s22, 1
    s_branch L_conv2_kernel_hloop1
L_conv2_kernel_hlast1:
    s_branch L_conv2_kernel_end
L_conv2_kernel_h2:
    s_waitcnt lgkmcnt(0)
    ds_write_b128 v96, v[0:3] offset:0
    ds_write_b128 v98, v[12:15] offset:0
    v_lshlrev_b32 v76, 16, v0
    v_and_b32 v84, s25, v0
    v_lshlrev_b32 v77, 16, v4
    v_and_b32 v85, s25, v4
    v_lshlrev_b32 v78, 16, v8
    v_and_b32 v86, s25, v8
    v_lshlrev_b32 v79, 16, v12
    v_and_b32 v87, s25, v12
    v_add_f32 v80, v76, v78
    v_add_f32 v88, v84, v86
    v_add_f32 v81, v77, v79
    v_add_f32 v89, v85, v87
    v_fma_f32 v82, v78, 4.0, v76
    v_fma_f32 v90, v86, 4.0, v84
    v_fma_f32 v83, v79, 4.0, v77
    v_fma_f32 v91, v87, 4.0, v85
    v_add_f32 v77, v80, v81
    v_add_f32 v85, v88, v89
    v_sub_f32 v78, v80, v81
    v_sub_f32 v86, v88, v89
    v_fma_f32 v79, v83, 2.0, v82
    v_fma_f32 v87, v91, 2.0, v90
    v_fma_f32 v82, v83, -2.0, v82
    v_fma_f32 v90, v91, -2.0, v90
    v_fmamk_f32 v80, v76, 0x41700000, v82
    v_fmamk_f32 v88, v84, 0x41700000, v90
    v_fmamk_f32 v80, v81, 0x41200000, v80
    v_fmamk_f32 v88, v89, 0x41200000, v88
    v_cvt_pk_bf16_f32 v4, v77, v85
    v_cvt_pk_bf16_f32 v8, v78, v86
    v_cvt_pk_bf16_f32 v64, v79, v87
    v_cvt_pk_bf16_f32 v68, v82, v90
    v_cvt_pk_bf16_f32 v72, v80, v88
    v_lshlrev_b32 v76, 16, v1
    v_and_b32 v84, s25, v1
    v_lshlrev_b32 v77, 16, v5
    v_and_b32 v85, s25, v5
    v_lshlrev_b32 v78, 16, v9
    v_and_b32 v86, s25, v9
    v_lshlrev_b32 v79, 16, v13
    v_and_b32 v87, s25, v13
    v_add_f32 v80, v76, v78
    v_add_f32 v88, v84, v86
    v_add_f32 v81, v77, v79
    v_add_f32 v89, v85, v87
    v_fma_f32 v82, v78, 4.0, v76
    v_fma_f32 v90, v86, 4.0, v84
    v_fma_f32 v83, v79, 4.0, v77
    v_fma_f32 v91, v87, 4.0, v85
    v_add_f32 v77, v80, v81
    v_add_f32 v85, v88, v89
    v_sub_f32 v78, v80, v81
    v_sub_f32 v86, v88, v89
    v_fma_f32 v79, v83, 2.0, v82
    v_fma_f32 v87, v91, 2.0, v90
    v_fma_f32 v82, v83, -2.0, v82
    v_fma_f32 v90, v91, -2.0, v90
    v_fmamk_f32 v80, v76, 0x41700000, v82
    v_fmamk_f32 v88, v84, 0x41700000, v90
    v_fmamk_f32 v80, v81, 0x41200000, v80
    v_fmamk_f32 v88, v89, 0x41200000, v88
    v_cvt_pk_bf16_f32 v5, v77, v85
    v_cvt_pk_bf16_f32 v9, v78, v86
    v_cvt_pk_bf16_f32 v65, v79, v87
    v_cvt_pk_bf16_f32 v69, v82, v90
    v_cvt_pk_bf16_f32 v73, v80, v88
    v_lshlrev_b32 v76, 16, v2
    v_and_b32 v84, s25, v2
    v_lshlrev_b32 v77, 16, v6
    v_and_b32 v85, s25, v6
    v_lshlrev_b32 v78, 16, v10
    v_and_b32 v86, s25, v10
    v_lshlrev_b32 v79, 16, v14
    v_and_b32 v87, s25, v14
    v_add_f32 v80, v76, v78
    v_add_f32 v88, v84, v86
    v_add_f32 v81, v77, v79
    v_add_f32 v89, v85, v87
    v_fma_f32 v82, v78, 4.0, v76
    v_fma_f32 v90, v86, 4.0, v84
    v_fma_f32 v83, v79, 4.0, v77
    v_fma_f32 v91, v87, 4.0, v85
    v_add_f32 v77, v80, v81
    v_add_f32 v85, v88, v89
    v_sub_f32 v78, v80, v81
    v_sub_f32 v86, v88, v89
    v_fma_f32 v79, v83, 2.0, v82
    v_fma_f32 v87, v91, 2.0, v90
    v_fma_f32 v82, v83, -2.0, v82
    v_fma_f32 v90, v91, -2.0, v90
    v_fmamk_f32 v80, v76, 0x41700000, v82
    v_fmamk_f32 v88, v84, 0x41700000, v90
    v_fmamk_f32 v80, v81, 0x41200000, v80
    v_fmamk_f32 v88, v89, 0x41200000, v88
    v_cvt_pk_bf16_f32 v6, v77, v85
    v_cvt_pk_bf16_f32 v10, v78, v86
    v_cvt_pk_bf16_f32 v66, v79, v87
    v_cvt_pk_bf16_f32 v70, v82, v90
    v_cvt_pk_bf16_f32 v74, v80, v88
    v_lshlrev_b32 v76, 16, v3
    v_and_b32 v84, s25, v3
    v_lshlrev_b32 v77, 16, v7
    v_and_b32 v85, s25, v7
    v_lshlrev_b32 v78, 16, v11
    v_and_b32 v86, s25, v11
    v_lshlrev_b32 v79, 16, v15
    v_and_b32 v87, s25, v15
    v_add_f32 v80, v76, v78
    v_add_f32 v88, v84, v86
    v_add_f32 v81, v77, v79
    v_add_f32 v89, v85, v87
    v_fma_f32 v82, v78, 4.0, v76
    v_fma_f32 v90, v86, 4.0, v84
    v_fma_f32 v83, v79, 4.0, v77
    v_fma_f32 v91, v87, 4.0, v85
    v_add_f32 v77, v80, v81
    v_add_f32 v85, v88, v89
    v_sub_f32 v78, v80, v81
    v_sub_f32 v86, v88, v89
    v_fma_f32 v79, v83, 2.0, v82
    v_fma_f32 v87, v91, 2.0, v90
    v_fma_f32 v82, v83, -2.0, v82
    v_fma_f32 v90, v91, -2.0, v90
    v_fmamk_f32 v80, v76, 0x41700000, v82
    v_fmamk_f32 v88, v84, 0x41700000, v90
    v_fmamk_f32 v80, v81, 0x41200000, v80
    v_fmamk_f32 v88, v89, 0x41200000, v88
    v_cvt_pk_bf16_f32 v7, v77, v85
    v_cvt_pk_bf16_f32 v11, v78, v86
    v_cvt_pk_bf16_f32 v67, v79, v87
    v_cvt_pk_bf16_f32 v71, v82, v90
    v_cvt_pk_bf16_f32 v75, v80, v88
    ds_write_b128 v96, v[4:7] offset:16384
    ds_write_b128 v96, v[8:11] offset:32768
    ds_write_b128 v96, v[64:67] offset:49152
    ds_write_b128 v97, v[68:71] offset:0
    ds_write_b128 v97, v[72:75] offset:16384
    buffer_load_dwordx4 v[32:35], v92, s[8:11], s24 offen offset:0
    buffer_load_dwordx4 v[48:51], v92, s[8:11], s24 offen offset:64
    v_add_u32 v92, 128, v92
    buffer_load_dwordx4 v[36:39], v93, s[8:11], s24 offen offset:0
    buffer_load_dwordx4 v[52:55], v93, s[8:11], s24 offen offset:64
    v_add_u32 v93, 128, v93
    buffer_load_dwordx4 v[40:43], v94, s[8:11], s24 offen offset:0
    buffer_load_dwordx4 v[56:59], v94, s[8:11], s24 offen offset:64
    v_add_u32 v94, 128, v94
    buffer_load_dwordx4 v[44:47], v95, s[8:11], s24 offen offset:0
    buffer_load_dwordx4 v[60:63], v95, s[8:11], s24 offen offset:64
    v_add_u32 v95, 128, v95
    s_waitcnt lgkmcnt(0)
    s_barrier
    s_setprio 0
    v_lshlrev_b32 v76, 16, v16
    v_and_b32 v84, s25, v16
    v_lshlrev_b32 v77, 16, v20
    v_and_b32 v85, s25, v20
    v_lshlrev_b32 v78, 16, v24
    v_and_b32 v86, s25, v24
    v_lshlrev_b32 v79, 16, v28
    v_and_b32 v87, s25, v28
    v_add_f32 v80, v76, v78
    v_add_f32 v88, v84, v86
    v_add_f32 v81, v77, v79
    v_add_f32 v89, v85, v87
    v_fma_f32 v82, v78, 4.0, v76
    v_fma_f32 v90, v86, 4.0, v84
    v_fma_f32 v83, v79, 4.0, v77
    v_fma_f32 v91, v87, 4.0, v85
    v_add_f32 v77, v80, v81
    v_add_f32 v85, v88, v89
    v_sub_f32 v78, v80, v81
    v_sub_f32 v86, v88, v89
    v_fma_f32 v79, v83, 2.0, v82
    v_fma_f32 v87, v91, 2.0, v90
    v_fma_f32 v82, v83, -2.0, v82
    v_fma_f32 v90, v91, -2.0, v90
    v_fmamk_f32 v80, v76, 0x41700000, v82
    v_fmamk_f32 v88, v84, 0x41700000, v90
    v_fmamk_f32 v80, v81, 0x41200000, v80
    v_fmamk_f32 v88, v89, 0x41200000, v88
    v_cvt_pk_bf16_f32 v20, v77, v85
    v_cvt_pk_bf16_f32 v24, v78, v86
    v_cvt_pk_bf16_f32 v64, v79, v87
    v_cvt_pk_bf16_f32 v68, v82, v90
    v_cvt_pk_bf16_f32 v72, v80, v88
    v_lshlrev_b32 v76, 16, v17
    v_and_b32 v84, s25, v17
    v_lshlrev_b32 v77, 16, v21
    v_and_b32 v85, s25, v21
    v_lshlrev_b32 v78, 16, v25
    v_and_b32 v86, s25, v25
    v_lshlrev_b32 v79, 16, v29
    v_and_b32 v87, s25, v29
    v_add_f32 v80, v76, v78
    v_add_f32 v88, v84, v86
    v_add_f32 v81, v77, v79
    v_add_f32 v89, v85, v87
    v_fma_f32 v82, v78, 4.0, v76
    v_fma_f32 v90, v86, 4.0, v84
    v_fma_f32 v83, v79, 4.0, v77
    v_fma_f32 v91, v87, 4.0, v85
    v_add_f32 v77, v80, v81
    v_add_f32 v85, v88, v89
    v_sub_f32 v78, v80, v81
    v_sub_f32 v86, v88, v89
    v_fma_f32 v79, v83, 2.0, v82
    v_fma_f32 v87, v91, 2.0, v90
    v_fma_f32 v82, v83, -2.0, v82
    v_fma_f32 v90, v91, -2.0, v90
    v_fmamk_f32 v80, v76, 0x41700000, v82
    v_fmamk_f32 v88, v84, 0x41700000, v90
    v_fmamk_f32 v80, v81, 0x41200000, v80
    v_fmamk_f32 v88, v89, 0x41200000, v88
    v_cvt_pk_bf16_f32 v21, v77, v85
    v_cvt_pk_bf16_f32 v25, v78, v86
    v_cvt_pk_bf16_f32 v65, v79, v87
    v_cvt_pk_bf16_f32 v69, v82, v90
    v_cvt_pk_bf16_f32 v73, v80, v88
    v_lshlrev_b32 v76, 16, v18
    v_and_b32 v84, s25, v18
    v_lshlrev_b32 v77, 16, v22
    v_and_b32 v85, s25, v22
    v_lshlrev_b32 v78, 16, v26
    v_and_b32 v86, s25, v26
    v_lshlrev_b32 v79, 16, v30
    v_and_b32 v87, s25, v30
    v_add_f32 v80, v76, v78
    v_add_f32 v88, v84, v86
    v_add_f32 v81, v77, v79
    v_add_f32 v89, v85, v87
    v_fma_f32 v82, v78, 4.0, v76
    v_fma_f32 v90, v86, 4.0, v84
    v_fma_f32 v83, v79, 4.0, v77
    v_fma_f32 v91, v87, 4.0, v85
    v_add_f32 v77, v80, v81
    v_add_f32 v85, v88, v89
    v_sub_f32 v78, v80, v81
    v_sub_f32 v86, v88, v89
    v_fma_f32 v79, v83, 2.0, v82
    v_fma_f32 v87, v91, 2.0, v90
    v_fma_f32 v82, v83, -2.0, v82
    v_fma_f32 v90, v91, -2.0, v90
    v_fmamk_f32 v80, v76, 0x41700000, v82
    v_fmamk_f32 v88, v84, 0x41700000, v90
    v_fmamk_f32 v80, v81, 0x41200000, v80
    v_fmamk_f32 v88, v89, 0x41200000, v88
    v_cvt_pk_bf16_f32 v22, v77, v85
    v_cvt_pk_bf16_f32 v26, v78, v86
    v_cvt_pk_bf16_f32 v66, v79, v87
    v_cvt_pk_bf16_f32 v70, v82, v90
    v_cvt_pk_bf16_f32 v74, v80, v88
    v_lshlrev_b32 v76, 16, v19
    v_and_b32 v84, s25, v19
    v_lshlrev_b32 v77, 16, v23
    v_and_b32 v85, s25, v23
    v_lshlrev_b32 v78, 16, v27
    v_and_b32 v86, s25, v27
    v_lshlrev_b32 v79, 16, v31
    v_and_b32 v87, s25, v31
    v_add_f32 v80, v76, v78
    v_add_f32 v88, v84, v86
    v_add_f32 v81, v77, v79
    v_add_f32 v89, v85, v87
    v_fma_f32 v82, v78, 4.0, v76
    v_fma_f32 v90, v86, 4.0, v84
    v_fma_f32 v83, v79, 4.0, v77
    v_fma_f32 v91, v87, 4.0, v85
    v_add_f32 v77, v80, v81
    v_add_f32 v85, v88, v89
    v_sub_f32 v78, v80, v81
    v_sub_f32 v86, v88, v89
    v_fma_f32 v79, v83, 2.0, v82
    v_fma_f32 v87, v91, 2.0, v90
    v_fma_f32 v82, v83, -2.0, v82
    v_fma_f32 v90, v91, -2.0, v90
    v_fmamk_f32 v80, v76, 0x41700000, v82
    v_fmamk_f32 v88, v84, 0x41700000, v90
    v_fmamk_f32 v80, v81, 0x41200000, v80
    v_fmamk_f32 v88, v89, 0x41200000, v88
    v_cvt_pk_bf16_f32 v23, v77, v85
    v_cvt_pk_bf16_f32 v27, v78, v86
    v_cvt_pk_bf16_f32 v67, v79, v87
    v_cvt_pk_bf16_f32 v71, v82, v90
    v_cvt_pk_bf16_f32 v75, v80, v88
L_conv2_kernel_hloop2:
    s_cmp_lt_u32 s28, 4
    s_cselect_b32 s24, 0, 2130706432
    ds_write_b128 v96, v[64:67] offset:57344
    ds_write_b128 v97, v[68:71] offset:8192
    ds_write_b128 v97, v[72:75] offset:24576
    ds_write_b128 v96, v[16:19] offset:8192
    ds_write_b128 v96, v[20:23] offset:24576
    ds_write_b128 v96, v[24:27] offset:40960
    ds_write_b128 v98, v[28:31] offset:8704
    s_waitcnt lgkmcnt(0)
    s_waitcnt vmcnt(0)
    v_lshlrev_b32 v76, 16, v32
    v_and_b32 v84, s25, v32
    v_lshlrev_b32 v77, 16, v36
    v_and_b32 v85, s25, v36
    v_lshlrev_b32 v78, 16, v40
    v_and_b32 v86, s25, v40
    v_lshlrev_b32 v79, 16, v44
    v_and_b32 v87, s25, v44
    v_add_f32 v80, v76, v78
    v_add_f32 v88, v84, v86
    v_add_f32 v81, v77, v79
    v_add_f32 v89, v85, v87
    v_fma_f32 v82, v78, 4.0, v76
    v_fma_f32 v90, v86, 4.0, v84
    v_fma_f32 v83, v79, 4.0, v77
    v_fma_f32 v91, v87, 4.0, v85
    v_add_f32 v77, v80, v81
    v_add_f32 v85, v88, v89
    v_sub_f32 v78, v80, v81
    v_sub_f32 v86, v88, v89
    v_fma_f32 v79, v83, 2.0, v82
    v_fma_f32 v87, v91, 2.0, v90
    v_fma_f32 v82, v83, -2.0, v82
    v_fma_f32 v90, v91, -2.0, v90
    v_fmamk_f32 v80, v76, 0x41700000, v82
    v_fmamk_f32 v88, v84, 0x41700000, v90
    v_fmamk_f32 v80, v81, 0x41200000, v80
    v_fmamk_f32 v88, v89, 0x41200000, v88
    v_cvt_pk_bf16_f32 v36, v77, v85
    v_cvt_pk_bf16_f32 v40, v78, v86
    v_cvt_pk_bf16_f32 v64, v79, v87
    v_cvt_pk_bf16_f32 v68, v82, v90
    v_cvt_pk_bf16_f32 v72, v80, v88
    v_lshlrev_b32 v76, 16, v33
    v_and_b32 v84, s25, v33
    v_lshlrev_b32 v77, 16, v37
    v_and_b32 v85, s25, v37
    v_lshlrev_b32 v78, 16, v41
    v_and_b32 v86, s25, v41
    buffer_load_dwordx4 v[0:3], v92, s[8:11], s24 offen offset:0
    buffer_load_dwordx4 v[16:19], v92, s[8:11], s24 offen offset:64
    v_add_u32 v92, 128, v92
    v_lshlrev_b32 v79, 16, v45
    v_and_b32 v87, s25, v45
    v_add_f32 v80, v76, v78
    v_add_f32 v88, v84, v86
    v_add_f32 v81, v77, v79
    v_add_f32 v89, v85, v87
    v_fma_f32 v82, v78, 4.0, v76
    v_fma_f32 v90, v86, 4.0, v84
    v_fma_f32 v83, v79, 4.0, v77
    v_fma_f32 v91, v87, 4.0, v85
    v_add_f32 v77, v80, v81
    v_add_f32 v85, v88, v89
    v_sub_f32 v78, v80, v81
    v_sub_f32 v86, v88, v89
    v_fma_f32 v79, v83, 2.0, v82
    v_fma_f32 v87, v91, 2.0, v90
    v_fma_f32 v82, v83, -2.0, v82
    v_fma_f32 v90, v91, -2.0, v90
    v_fmamk_f32 v80, v76, 0x41700000, v82
    v_fmamk_f32 v88, v84, 0x41700000, v90
    v_fmamk_f32 v80, v81, 0x41200000, v80
    v_fmamk_f32 v88, v89, 0x41200000, v88
    v_cvt_pk_bf16_f32 v37, v77, v85
    v_cvt_pk_bf16_f32 v41, v78, v86
    v_cvt_pk_bf16_f32 v65, v79, v87
    v_cvt_pk_bf16_f32 v69, v82, v90
    v_cvt_pk_bf16_f32 v73, v80, v88
    v_lshlrev_b32 v76, 16, v34
    v_and_b32 v84, s25, v34
    v_lshlrev_b32 v77, 16, v38
    v_and_b32 v85, s25, v38
    v_lshlrev_b32 v78, 16, v42
    v_and_b32 v86, s25, v42
    v_lshlrev_b32 v79, 16, v46
    v_and_b32 v87, s25, v46
    v_add_f32 v80, v76, v78
    v_add_f32 v88, v84, v86
    v_add_f32 v81, v77, v79
    v_add_f32 v89, v85, v87
    v_fma_f32 v82, v78, 4.0, v76
    v_fma_f32 v90, v86, 4.0, v84
    v_fma_f32 v83, v79, 4.0, v77
    v_fma_f32 v91, v87, 4.0, v85
    v_add_f32 v77, v80, v81
    v_add_f32 v85, v88, v89
    v_sub_f32 v78, v80, v81
    v_sub_f32 v86, v88, v89
    v_fma_f32 v79, v83, 2.0, v82
    v_fma_f32 v87, v91, 2.0, v90
    v_fma_f32 v82, v83, -2.0, v82
    v_fma_f32 v90, v91, -2.0, v90
    v_fmamk_f32 v80, v76, 0x41700000, v82
    v_fmamk_f32 v88, v84, 0x41700000, v90
    buffer_load_dwordx4 v[4:7], v93, s[8:11], s24 offen offset:0
    buffer_load_dwordx4 v[20:23], v93, s[8:11], s24 offen offset:64
    v_add_u32 v93, 128, v93
    v_fmamk_f32 v80, v81, 0x41200000, v80
    v_fmamk_f32 v88, v89, 0x41200000, v88
    v_cvt_pk_bf16_f32 v38, v77, v85
    v_cvt_pk_bf16_f32 v42, v78, v86
    v_cvt_pk_bf16_f32 v66, v79, v87
    v_cvt_pk_bf16_f32 v70, v82, v90
    v_cvt_pk_bf16_f32 v74, v80, v88
    v_lshlrev_b32 v76, 16, v35
    v_and_b32 v84, s25, v35
    v_lshlrev_b32 v77, 16, v39
    v_and_b32 v85, s25, v39
    v_lshlrev_b32 v78, 16, v43
    v_and_b32 v86, s25, v43
    v_lshlrev_b32 v79, 16, v47
    v_and_b32 v87, s25, v47
    v_add_f32 v80, v76, v78
    v_add_f32 v88, v84, v86
    v_add_f32 v81, v77, v79
    v_add_f32 v89, v85, v87
    v_fma_f32 v82, v78, 4.0, v76
    v_fma_f32 v90, v86, 4.0, v84
    v_fma_f32 v83, v79, 4.0, v77
    v_fma_f32 v91, v87, 4.0, v85
    v_add_f32 v77, v80, v81
    v_add_f32 v85, v88, v89
    v_sub_f32 v78, v80, v81
    v_sub_f32 v86, v88, v89
    v_fma_f32 v79, v83, 2.0, v82
    v_fma_f32 v87, v91, 2.0, v90
    v_fma_f32 v82, v83, -2.0, v82
    v_fma_f32 v90, v91, -2.0, v90
    v_fmamk_f32 v80, v76, 0x41700000, v82
    v_fmamk_f32 v88, v84, 0x41700000, v90
    v_fmamk_f32 v80, v81, 0x41200000, v80
    v_fmamk_f32 v88, v89, 0x41200000, v88
    v_cvt_pk_bf16_f32 v39, v77, v85
    v_cvt_pk_bf16_f32 v43, v78, v86
    v_cvt_pk_bf16_f32 v67, v79, v87
    v_cvt_pk_bf16_f32 v71, v82, v90
    v_cvt_pk_bf16_f32 v75, v80, v88
    s_add_u32 s28, s28, 1
    s_waitcnt lgkmcnt(0)
    s_barrier
    s_cmp_lt_u32 s28, 4
    s_cselect_b32 s24, 0, 2130706432
    ds_write_b128 v96, v[64:67] offset:49152
    ds_write_b128 v97, v[68:71] offset:0
    ds_write_b128 v97, v[72:75] offset:16384
    ds_write_b128 v96, v[32:35] offset:0
    ds_write_b128 v96, v[36:39] offset:16384
    ds_write_b128 v96, v[40:43] offset:32768
    ds_write_b128 v98, v[44:47] offset:0
    s_waitcnt lgkmcnt(0)
    v_lshlrev_b32 v76, 16, v48
    v_and_b32 v84, s25, v48
    buffer_load_dwordx4 v[8:11], v94, s[8:11], s24 offen offset:0
    buffer_load_dwordx4 v[24:27], v94, s[8:11], s24 offen offset:64
    v_add_u32 v94, 128, v94
    v_lshlrev_b32 v77, 16, v52
    v_and_b32 v85, s25, v52
    v_lshlrev_b32 v78, 16, v56
    v_and_b32 v86, s25, v56
    v_lshlrev_b32 v79, 16, v60
    v_and_b32 v87, s25, v60
    v_add_f32 v80, v76, v78
    v_add_f32 v88, v84, v86
    v_add_f32 v81, v77, v79
    v_add_f32 v89, v85, v87
    v_fma_f32 v82, v78, 4.0, v76
    v_fma_f32 v90, v86, 4.0, v84
    v_fma_f32 v83, v79, 4.0, v77
    v_fma_f32 v91, v87, 4.0, v85
    v_add_f32 v77, v80, v81
    v_add_f32 v85, v88, v89
    v_sub_f32 v78, v80, v81
    buffer_load_dwordx4 v[12:15], v95, s[8:11], s24 offen offset:0
    buffer_load_dwordx4 v[28:31], v95, s[8:11], s24 offen offset:64
    v_add_u32 v95, 128, v95
    v_sub_f32 v86, v88, v89
    v_fma_f32 v79, v83, 2.0, v82
    v_fma_f32 v87, v91, 2.0, v90
    v_fma_f32 v82, v83, -2.0, v82
    v_fma_f32 v90, v91, -2.0, v90
    v_fmamk_f32 v80, v76, 0x41700000, v82
    v_fmamk_f32 v88, v84, 0x41700000, v90
    v_fmamk_f32 v80, v81, 0x41200000, v80
    v_fmamk_f32 v88, v89, 0x41200000, v88
    v_cvt_pk_bf16_f32 v52, v77, v85
    v_cvt_pk_bf16_f32 v56, v78, v86
    v_cvt_pk_bf16_f32 v64, v79, v87
    v_cvt_pk_bf16_f32 v68, v82, v90
    v_cvt_pk_bf16_f32 v72, v80, v88
    v_lshlrev_b32 v76, 16, v49
    v_and_b32 v84, s25, v49
    v_lshlrev_b32 v77, 16, v53
    v_and_b32 v85, s25, v53
    v_lshlrev_b32 v78, 16, v57
    v_and_b32 v86, s25, v57
    v_lshlrev_b32 v79, 16, v61
    v_and_b32 v87, s25, v61
    v_add_f32 v80, v76, v78
    v_add_f32 v88, v84, v86
    v_add_f32 v81, v77, v79
    v_add_f32 v89, v85, v87
    v_fma_f32 v82, v78, 4.0, v76
    v_fma_f32 v90, v86, 4.0, v84
    v_fma_f32 v83, v79, 4.0, v77
    v_fma_f32 v91, v87, 4.0, v85
    v_add_f32 v77, v80, v81
    v_add_f32 v85, v88, v89
    v_sub_f32 v78, v80, v81
    v_sub_f32 v86, v88, v89
    v_fma_f32 v79, v83, 2.0, v82
    v_fma_f32 v87, v91, 2.0, v90
    v_fma_f32 v82, v83, -2.0, v82
    v_fma_f32 v90, v91, -2.0, v90
    v_fmamk_f32 v80, v76, 0x41700000, v82
    v_fmamk_f32 v88, v84, 0x41700000, v90
    v_fmamk_f32 v80, v81, 0x41200000, v80
    v_fmamk_f32 v88, v89, 0x41200000, v88
    v_cvt_pk_bf16_f32 v53, v77, v85
    v_cvt_pk_bf16_f32 v57, v78, v86
    v_cvt_pk_bf16_f32 v65, v79, v87
    v_cvt_pk_bf16_f32 v69, v82, v90
    v_cvt_pk_bf16_f32 v73, v80, v88
    v_lshlrev_b32 v76, 16, v50
    v_and_b32 v84, s25, v50
    v_lshlrev_b32 v77, 16, v54
    v_and_b32 v85, s25, v54
    v_lshlrev_b32 v78, 16, v58
    v_and_b32 v86, s25, v58
    v_lshlrev_b32 v79, 16, v62
    v_and_b32 v87, s25, v62
    v_add_f32 v80, v76, v78
    v_add_f32 v88, v84, v86
    v_add_f32 v81, v77, v79
    v_add_f32 v89, v85, v87
    v_fma_f32 v82, v78, 4.0, v76
    v_fma_f32 v90, v86, 4.0, v84
    v_fma_f32 v83, v79, 4.0, v77
    v_fma_f32 v91, v87, 4.0, v85
    v_add_f32 v77, v80, v81
    v_add_f32 v85, v88, v89
    v_sub_f32 v78, v80, v81
    v_sub_f32 v86, v88, v89
    v_fma_f32 v79, v83, 2.0, v82
    v_fma_f32 v87, v91, 2.0, v90
    v_fma_f32 v82, v83, -2.0, v82
    v_fma_f32 v90, v91, -2.0, v90
    v_fmamk_f32 v80, v76, 0x41700000, v82
    v_fmamk_f32 v88, v84, 0x41700000, v90
    v_fmamk_f32 v80, v81, 0x41200000, v80
    v_fmamk_f32 v88, v89, 0x41200000, v88
    v_cvt_pk_bf16_f32 v54, v77, v85
    v_cvt_pk_bf16_f32 v58, v78, v86
    v_cvt_pk_bf16_f32 v66, v79, v87
    v_cvt_pk_bf16_f32 v70, v82, v90
    v_cvt_pk_bf16_f32 v74, v80, v88
    v_lshlrev_b32 v76, 16, v51
    v_and_b32 v84, s25, v51
    v_lshlrev_b32 v77, 16, v55
    v_and_b32 v85, s25, v55
    v_lshlrev_b32 v78, 16, v59
    v_and_b32 v86, s25, v59
    v_lshlrev_b32 v79, 16, v63
    v_and_b32 v87, s25, v63
    v_add_f32 v80, v76, v78
    v_add_f32 v88, v84, v86
    v_add_f32 v81, v77, v79
    v_add_f32 v89, v85, v87
    v_fma_f32 v82, v78, 4.0, v76
    v_fma_f32 v90, v86, 4.0, v84
    v_fma_f32 v83, v79, 4.0, v77
    v_fma_f32 v91, v87, 4.0, v85
    v_add_f32 v77, v80, v81
    v_add_f32 v85, v88, v89
    v_sub_f32 v78, v80, v81
    v_sub_f32 v86, v88, v89
    v_fma_f32 v79, v83, 2.0, v82
    v_fma_f32 v87, v91, 2.0, v90
    v_fma_f32 v82, v83, -2.0, v82
    v_fma_f32 v90, v91, -2.0, v90
    v_fmamk_f32 v80, v76, 0x41700000, v82
    v_fmamk_f32 v88, v84, 0x41700000, v90
    v_fmamk_f32 v80, v81, 0x41200000, v80
    v_fmamk_f32 v88, v89, 0x41200000, v88
    v_cvt_pk_bf16_f32 v55, v77, v85
    v_cvt_pk_bf16_f32 v59, v78, v86
    v_cvt_pk_bf16_f32 v67, v79, v87
    v_cvt_pk_bf16_f32 v71, v82, v90
    v_cvt_pk_bf16_f32 v75, v80, v88
    s_add_u32 s28, s28, 1
    s_waitcnt lgkmcnt(0)
    s_barrier
    s_cmp_eq_u32 s22, 1
    s_cbranch_scc1 L_conv2_kernel_hlast2
    s_cmp_lt_u32 s28, 4
    s_cselect_b32 s24, 0, 2130706432
    ds_write_b128 v96, v[64:67] offset:57344
    ds_write_b128 v97, v[68:71] offset:8192
    ds_write_b128 v97, v[72:75] offset:24576
    ds_write_b128 v96, v[48:51] offset:8192
    ds_write_b128 v96, v[52:55] offset:24576
    ds_write_b128 v96, v[56:59] offset:40960
    ds_write_b128 v98, v[60:63] offset:8704
    s_waitcnt lgkmcnt(0)
    s_waitcnt vmcnt(0)
    v_lshlrev_b32 v76, 16, v0
    v_and_b32 v84, s25, v0
    v_lshlrev_b32 v77, 16, v4
    v_and_b32 v85, s25, v4
    v_lshlrev_b32 v78, 16, v8
    v_and_b32 v86, s25, v8
    v_lshlrev_b32 v79, 16, v12
    v_and_b32 v87, s25, v12
    v_add_f32 v80, v76, v78
    v_add_f32 v88, v84, v86
    v_add_f32 v81, v77, v79
    v_add_f32 v89, v85, v87
    v_fma_f32 v82, v78, 4.0, v76
    v_fma_f32 v90, v86, 4.0, v84
    v_fma_f32 v83, v79, 4.0, v77
    v_fma_f32 v91, v87, 4.0, v85
    v_add_f32 v77, v80, v81
    v_add_f32 v85, v88, v89
    v_sub_f32 v78, v80, v81
    v_sub_f32 v86, v88, v89
    v_fma_f32 v79, v83, 2.0, v82
    v_fma_f32 v87, v91, 2.0, v90
    v_fma_f32 v82, v83, -2.0, v82
    v_fma_f32 v90, v91, -2.0, v90
    v_fmamk_f32 v80, v76, 0x41700000, v82
    v_fmamk_f32 v88, v84, 0x41700000, v90
    v_fmamk_f32 v80, v81, 0x41200000, v80
    v_fmamk_f32 v88, v89, 0x41200000, v88
    v_cvt_pk_bf16_f32 v4, v77, v85
    v_cvt_pk_bf16_f32 v8, v78, v86
    v_cvt_pk_bf16_f32 v64, v79, v87
    v_cvt_pk_bf16_f32 v68, v82, v90
    v_cvt_pk_bf16_f32 v72, v80, v88
    v_lshlrev_b32 v76, 16, v1
    v_and_b32 v84, s25, v1
    v_lshlrev_b32 v77, 16, v5
    v_and_b32 v85, s25, v5
    v_lshlrev_b32 v78, 16, v9
    v_and_b32 v86, s25, v9
    buffer_load_dwordx4 v[32:35], v92, s[8:11], s24 offen offset:0
    buffer_load_dwordx4 v[48:51], v92, s[8:11], s24 offen offset:64
    v_add_u32 v92, 128, v92
    v_lshlrev_b32 v79, 16, v13
    v_and_b32 v87, s25, v13
    v_add_f32 v80, v76, v78
    v_add_f32 v88, v84, v86
    v_add_f32 v81, v77, v79
    v_add_f32 v89, v85, v87
    v_fma_f32 v82, v78, 4.0, v76
    v_fma_f32 v90, v86, 4.0, v84
    v_fma_f32 v83, v79, 4.0, v77
    v_fma_f32 v91, v87, 4.0, v85
    v_add_f32 v77, v80, v81
    v_add_f32 v85, v88, v89
    v_sub_f32 v78, v80, v81
    v_sub_f32 v86, v88, v89
    v_fma_f32 v79, v83, 2.0, v82
    v_fma_f32 v87, v91, 2.0, v90
    v_fma_f32 v82, v83, -2.0, v82
    v_fma_f32 v90, v91, -2.0, v90
    v_fmamk_f32 v80, v76, 0x41700000, v82
    v_fmamk_f32 v88, v84, 0x41700000, v90
    v_fmamk_f32 v80, v81, 0x41200000, v80
    v_fmamk_f32 v88, v89, 0x41200000, v88
    v_cvt_pk_bf16_f32 v5, v77, v85
    v_cvt_pk_bf16_f32 v9, v78, v86
    v_cvt_pk_bf16_f32 v65, v79, v87
    v_cvt_pk_bf16_f32 v69, v82, v90
    v_cvt_pk_bf16_f32 v73, v80, v88
    v_lshlrev_b32 v76, 16, v2
    v_and_b32 v84, s25, v2
    v_lshlrev_b32 v77, 16, v6
    v_and_b32 v85, s25, v6
    v_lshlrev_b32 v78, 16, v10
    v_and_b32 v86, s25, v10
    v_lshlrev_b32 v79, 16, v14
    v_and_b32 v87, s25, v14
    v_add_f32 v80, v76, v78
    v_add_f32 v88, v84, v86
    v_add_f32 v81, v77, v79
    v_add_f32 v89, v85, v87
    v_fma_f32 v82, v78, 4.0, v76
    v_fma_f32 v90, v86, 4.0, v84
    v_fma_f32 v83, v79, 4.0, v77
    v_fma_f32 v91, v87, 4.0, v85
    v_add_f32 v77, v80, v81
    v_add_f32 v85, v88, v89
    v_sub_f32 v78, v80, v81
    v_sub_f32 v86, v88, v89
    v_fma_f32 v79, v83, 2.0, v82
    v_fma_f32 v87, v91, 2.0, v90
    v_fma_f32 v82, v83, -2.0, v82
    v_fma_f32 v90, v91, -2.0, v90
    v_fmamk_f32 v80, v76, 0x41700000, v82
    v_fmamk_f32 v88, v84, 0x41700000, v90
    buffer_load_dwordx4 v[36:39], v93, s[8:11], s24 offen offset:0
    buffer_load_dwordx4 v[52:55], v93, s[8:11], s24 offen offset:64
    v_add_u32 v93, 128, v93
    v_fmamk_f32 v80, v81, 0x41200000, v80
    v_fmamk_f32 v88, v89, 0x41200000, v88
    v_cvt_pk_bf16_f32 v6, v77, v85
    v_cvt_pk_bf16_f32 v10, v78, v86
    v_cvt_pk_bf16_f32 v66, v79, v87
    v_cvt_pk_bf16_f32 v70, v82, v90
    v_cvt_pk_bf16_f32 v74, v80, v88
    v_lshlrev_b32 v76, 16, v3
    v_and_b32 v84, s25, v3
    v_lshlrev_b32 v77, 16, v7
    v_and_b32 v85, s25, v7
    v_lshlrev_b32 v78, 16, v11
    v_and_b32 v86, s25, v11
    v_lshlrev_b32 v79, 16, v15
    v_and_b32 v87, s25, v15
    v_add_f32 v80, v76, v78
    v_add_f32 v88, v84, v86
    v_add_f32 v81, v77, v79
    v_add_f32 v89, v85, v87
    v_fma_f32 v82, v78, 4.0, v76
    v_fma_f32 v90, v86, 4.0, v84
    v_fma_f32 v83, v79, 4.0, v77
    v_fma_f32 v91, v87, 4.0, v85
    v_add_f32 v77, v80, v81
    v_add_f32 v85, v88, v89
    v_sub_f32 v78, v80, v81
    v_sub_f32 v86, v88, v89
    v_fma_f32 v79, v83, 2.0, v82
    v_fma_f32 v87, v91, 2.0, v90
    v_fma_f32 v82, v83, -2.0, v82
    v_fma_f32 v90, v91, -2.0, v90
    v_fmamk_f32 v80, v76, 0x41700000, v82
    v_fmamk_f32 v88, v84, 0x41700000, v90
    v_fmamk_f32 v80, v81, 0x41200000, v80
    v_fmamk_f32 v88, v89, 0x41200000, v88
    v_cvt_pk_bf16_f32 v7, v77, v85
    v_cvt_pk_bf16_f32 v11, v78, v86
    v_cvt_pk_bf16_f32 v67, v79, v87
    v_cvt_pk_bf16_f32 v71, v82, v90
    v_cvt_pk_bf16_f32 v75, v80, v88
    s_add_u32 s28, s28, 1
    s_waitcnt lgkmcnt(0)
    s_barrier
    s_cmp_lt_u32 s28, 4
    s_cselect_b32 s24, 0, 2130706432
    ds_write_b128 v96, v[64:67] offset:49152
    ds_write_b128 v97, v[68:71] offset:0
    ds_write_b128 v97, v[72:75] offset:16384
    ds_write_b128 v96, v[0:3] offset:0
    ds_write_b128 v96, v[4:7] offset:16384
    ds_write_b128 v96, v[8:11] offset:32768
    ds_write_b128 v98, v[12:15] offset:0
    s_waitcnt lgkmcnt(0)
    v_lshlrev_b32 v76, 16, v16
    v_and_b32 v84, s25, v16
    buffer_load_dwordx4 v[40:43], v94, s[8:11], s24 offen offset:0
    buffer_load_dwordx4 v[56:59], v94, s[8:11], s24 offen offset:64
    v_add_u32 v94, 128, v94
    v_lshlrev_b32 v77, 16, v20
    v_and_b32 v85, s25, v20
    v_lshlrev_b32 v78, 16, v24
    v_and_b32 v86, s25, v24
    v_lshlrev_b32 v79, 16, v28
    v_and_b32 v87, s25, v28
    v_add_f32 v80, v76, v78
    v_add_f32 v88, v84, v86
    v_add_f32 v81, v77, v79
    v_add_f32 v89, v85, v87
    v_fma_f32 v82, v78, 4.0, v76
    v_fma_f32 v90, v86, 4.0, v84
    v_fma_f32 v83, v79, 4.0, v77
    v_fma_f32 v91, v87, 4.0, v85
    v_add_f32 v77, v80, v81
    v_add_f32 v85, v88, v89
    v_sub_f32 v78, v80, v81
    buffer_load_dwordx4 v[44:47], v95, s[8:11], s24 offen offset:0
    buffer_load_dwordx4 v[60:63], v95, s[8:11], s24 offen offset:64
    v_add_u32 v95, 128, v95
    v_sub_f32 v86, v88, v89
    v_fma_f32 v79, v83, 2.0, v82
    v_fma_f32 v87, v91, 2.0, v90
    v_fma_f32 v82, v83, -2.0, v82
    v_fma_f32 v90, v91, -2.0, v90
    v_fmamk_f32 v80, v76, 0x41700000, v82
    v_fmamk_f32 v88, v84, 0x41700000, v90
    v_fmamk_f32 v80, v81, 0x41200000, v80
    v_fmamk_f32 v88, v89, 0x41200000, v88
    v_cvt_pk_bf16_f32 v20, v77, v85
    v_cvt_pk_bf16_f32 v24, v78, v86
    v_cvt_pk_bf16_f32 v64, v79, v87
    v_cvt_pk_bf16_f32 v68, v82, v90
    v_cvt_pk_bf16_f32 v72, v80, v88
    v_lshlrev_b32 v76, 16, v17
    v_and_b32 v84, s25, v17
    v_lshlrev_b32 v77, 16, v21
    v_and_b32 v85, s25, v21
    v_lshlrev_b32 v78, 16, v25
    v_and_b32 v86, s25, v25
    v_lshlrev_b32 v79, 16, v29
    v_and_b32 v87, s25, v29
    v_add_f32 v80, v76, v78
    v_add_f32 v88, v84, v86
    v_add_f32 v81, v77, v79
    v_add_f32 v89, v85, v87
    v_fma_f32 v82, v78, 4.0, v76
    v_fma_f32 v90, v86, 4.0, v84
    v_fma_f32 v83, v79, 4.0, v77
    v_fma_f32 v91, v87, 4.0, v85
    v_add_f32 v77, v80, v81
    v_add_f32 v85, v88, v89
    v_sub_f32 v78, v80, v81
    v_sub_f32 v86, v88, v89
    v_fma_f32 v79, v83, 2.0, v82
    v_fma_f32 v87, v91, 2.0, v90
    v_fma_f32 v82, v83, -2.0, v82
    v_fma_f32 v90, v91, -2.0, v90
    v_fmamk_f32 v80, v76, 0x41700000, v82
    v_fmamk_f32 v88, v84, 0x41700000, v90
    v_fmamk_f32 v80, v81, 0x41200000, v80
    v_fmamk_f32 v88, v89, 0x41200000, v88
    v_cvt_pk_bf16_f32 v21, v77, v85
    v_cvt_pk_bf16_f32 v25, v78, v86
    v_cvt_pk_bf16_f32 v65, v79, v87
    v_cvt_pk_bf16_f32 v69, v82, v90
    v_cvt_pk_bf16_f32 v73, v80, v88
    v_lshlrev_b32 v76, 16, v18
    v_and_b32 v84, s25, v18
    v_lshlrev_b32 v77, 16, v22
    v_and_b32 v85, s25, v22
    v_lshlrev_b32 v78, 16, v26
    v_and_b32 v86, s25, v26
    v_lshlrev_b32 v79, 16, v30
    v_and_b32 v87, s25, v30
    v_add_f32 v80, v76, v78
    v_add_f32 v88, v84, v86
    v_add_f32 v81, v77, v79
    v_add_f32 v89, v85, v87
    v_fma_f32 v82, v78, 4.0, v76
    v_fma_f32 v90, v86, 4.0, v84
    v_fma_f32 v83, v79, 4.0, v77
    v_fma_f32 v91, v87, 4.0, v85
    v_add_f32 v77, v80, v81
    v_add_f32 v85, v88, v89
    v_sub_f32 v78, v80, v81
    v_sub_f32 v86, v88, v89
    v_fma_f32 v79, v83, 2.0, v82
    v_fma_f32 v87, v91, 2.0, v90
    v_fma_f32 v82, v83, -2.0, v82
    v_fma_f32 v90, v91, -2.0, v90
    v_fmamk_f32 v80, v76, 0x41700000, v82
    v_fmamk_f32 v88, v84, 0x41700000, v90
    v_fmamk_f32 v80, v81, 0x41200000, v80
    v_fmamk_f32 v88, v89, 0x41200000, v88
    v_cvt_pk_bf16_f32 v22, v77, v85
    v_cvt_pk_bf16_f32 v26, v78, v86
    v_cvt_pk_bf16_f32 v66, v79, v87
    v_cvt_pk_bf16_f32 v70, v82, v90
    v_cvt_pk_bf16_f32 v74, v80, v88
    v_lshlrev_b32 v76, 16, v19
    v_and_b32 v84, s25, v19
    v_lshlrev_b32 v77, 16, v23
    v_and_b32 v85, s25, v23
    v_lshlrev_b32 v78, 16, v27
    v_and_b32 v86, s25, v27
    v_lshlrev_b32 v79, 16, v31
    v_and_b32 v87, s25, v31
    v_add_f32 v80, v76, v78
    v_add_f32 v88, v84, v86
    v_add_f32 v81, v77, v79
    v_add_f32 v89, v85, v87
    v_fma_f32 v82, v78, 4.0, v76
    v_fma_f32 v90, v86, 4.0, v84
    v_fma_f32 v83, v79, 4.0, v77
    v_fma_f32 v91, v87, 4.0, v85
    v_add_f32 v77, v80, v81
    v_add_f32 v85, v88, v89
    v_sub_f32 v78, v80, v81
    v_sub_f32 v86, v88, v89
    v_fma_f32 v79, v83, 2.0, v82
    v_fma_f32 v87, v91, 2.0, v90
    v_fma_f32 v82, v83, -2.0, v82
    v_fma_f32 v90, v91, -2.0, v90
    v_fmamk_f32 v80, v76, 0x41700000, v82
    v_fmamk_f32 v88, v84, 0x41700000, v90
    v_fmamk_f32 v80, v81, 0x41200000, v80
    v_fmamk_f32 v88, v89, 0x41200000, v88
    v_cvt_pk_bf16_f32 v23, v77, v85
    v_cvt_pk_bf16_f32 v27, v78, v86
    v_cvt_pk_bf16_f32 v67, v79, v87
    v_cvt_pk_bf16_f32 v71, v82, v90
    v_cvt_pk_bf16_f32 v75, v80, v88
    s_add_u32 s28, s28, 1
    s_waitcnt lgkmcnt(0)
    s_barrier
    s_sub_u32 s22, s22, 1
    s_branch L_conv2_kernel_hloop2
L_conv2_kernel_hlast2:
    ds_write_b128 v96, v[64:67] offset:57344
    ds_write_b128 v97, v[68:71] offset:8192
    ds_write_b128 v97, v[72:75] offset:24576
    ds_write_b128 v96, v[48:51] offset:8192
    ds_write_b128 v96, v[52:55] offset:24576
    ds_write_b128 v96, v[56:59] offset:40960
    ds_write_b128 v98, v[60:63] offset:8704
    s_waitcnt vmcnt(0) lgkmcnt(0)
    s_barrier
    s_branch L_conv2_kernel_end
L_conv2_kernel_epi:
    v_and_b32 v108, 15, v127
    v_lshrrev_b32 v109, 4, v127
    v_lshrrev_b32 v110, 3, v108
    s_lshl_b32 s36, s20, 1
    v_add_u32 v110, s36, v110
    v_xor_b32 v111, v110, v108
    v_and_b32 v111, 7, v111
    v_lshlrev_b32 v111, 4, v111
    v_lshl_add_u32 v111, v110, 7, v111
    v_lshl_add_u32 v120, v109, 11, v111
    v_add_u32 v121, 65536, v120
    v_add_u32 v125, 131072, v120
    s_lshl_b32 s36, s20, 9
    s_add_u32 s36, s36, 115712
    v_lshl_add_u32 v123, v109, 7, s36
    s_lshl_b32 s36, s20, 4
    v_add_u32 v108, s36, v108
    v_lshl_add_u32 v110, v108, 2, s21
    v_lshlrev_b32 v110, 9, v110
    v_lshl_add_u32 v110, v109, 4, v110
    s_lshl_b32 s36, s29, 6
    v_add_u32 v110, s36, v110
    v_mov_b32 v111, 2130706432
    v_cmp_gt_u32 vcc, 125, v108
    s_mov_b32 s4, 0xbeaaaaab
    s_mov_b32 s5, s4
    s_mov_b32 s6, 0x3e800000
    s_mov_b32 s7, s6
    s_mov_b32 s8, 0xc0a00000
    s_mov_b32 s9, s8
    s_mov_b32 s10, 0xc0638e39
    s_mov_b32 s11, s10
    s_mov_b32 s12, 0xbf638e39
    s_mov_b32 s13, s12
    s_mov_b32 s14, 0xbe638e39
    s_mov_b32 s15, s14
    s_mov_b32 s22, 0xbd638e39
    s_mov_b32 s23, s22
    s_mov_b32 s24, 0x3ff1c71c
    s_mov_b32 s25, s24
    s_mov_b32 s26, 0xbf2aaaab
    s_mov_b32 s27, s26
    s_mov_b32 s32, 0x3ecccccd
    s_mov_b32 s33, s32
    s_mov_b32 s34, 0xbd888889
    s_mov_b32 s35, s34
    s_mov_b32 s38, 0xbe4ccccd
    s_mov_b32 s39, s38
    s_mov_b32 s40, 0xbdd2d3e8
    s_mov_b32 s41, s40
    s_mov_b32 s42, 0x3f800000
    s_mov_b32 s43, s42
    s_waitcnt lgkmcnt(0)
    s_barrier
    v_cndmask_b32 v122, v111, v110, vcc
    ds_read_b128 v[0:3], v120 offset:0
    ds_read_b128 v[4:7], v120 offset:16384
    ds_read_b128 v[8:11], v120 offset:32768
    ds_read_b128 v[12:15], v120 offset:49152
    ds_read_b128 v[16:19], v121 offset:0
    ds_read_b128 v[20:23], v121 offset:16384
    ds_read_b128 v[24:27], v121 offset:32768
    ds_read_b128 v[28:31], v125 offset:15360
    ds_read_b128 v[32:35], v120 offset:8192
    ds_read_b128 v[36:39], v120 offset:24576
    ds_read_b128 v[40:43], v120 offset:40960
    ds_read_b128 v[44:47], v120 offset:57344
    ds_read_b128 v[48:51], v121 offset:56320
    ds_read_b128 v[52:55], v121 offset:64512
    ds_read_b128 v[56:59], v125 offset:7168
    s_waitcnt lgkmcnt(7)
    ds_read_b128 v[60:63], v125 offset:23552
    s_waitcnt lgkmcnt(8)
    v_pk_add_f32 v[88:89], v[24:25], v[28:29]
    v_pk_add_f32 v[90:91], v[26:27], v[30:31]
    v_pk_add_f32 v[24:25], v[4:5], v[8:9]
    v_pk_add_f32 v[26:27], v[6:7], v[10:11]
    v_pk_add_f32 v[4:5], v[4:5], v[8:9] neg_lo:[0,1] neg_hi:[0,1]
    v_pk_add_f32 v[6:7], v[6:7], v[10:11] neg_lo:[0,1] neg_hi:[0,1]
    v_pk_add_f32 v[72:73], v[12:13], v[16:17]
    v_pk_add_f32 v[74:75], v[14:15], v[18:19]
    v_pk_add_f32 v[12:13], v[12:13], v[16:17] neg_lo:[0,1] neg_hi:[0,1]
    v_pk_add_f32 v[14:15], v[14:15], v[18:19] neg_lo:[0,1] neg_hi:[0,1]
    v_pk_fma_f32 v[72:73], v[24:25], s[4:5], v[72:73]
    v_pk_fma_f32 v[74:75], v[26:27], s[4:5], v[74:75]
    v_pk_fma_f32 v[20:21], v[0:1], s[10:11], v[20:21]
    v_pk_fma_f32 v[22:23], v[2:3], s[10:11], v[22:23]
    v_pk_fma_f32 v[72:73], v[0:1], s[6:7], v[72:73]
    v_pk_fma_f32 v[74:75], v[2:3], s[6:7], v[74:75]
    v_pk_add_f32 v[24:25], v[24:25], v[0:1] neg_lo:[0,1] neg_hi:[0,1]
    v_pk_add_f32 v[26:27], v[26:27], v[2:3] neg_lo:[0,1] neg_hi:[0,1]
    v_pk_fma_f32 v[72:73], v[88:89], s[8:9], v[72:73]
    v_pk_fma_f32 v[74:75], v[90:91], s[8:9], v[74:75]
    v_pk_add_f32 v[24:25], v[24:25], v[88:89] neg_lo:[0,1] neg_hi:[0,1]
    v_pk_add_f32 v[26:27], v[26:27], v[90:91] neg_lo:[0,1] neg_hi:[0,1]
    v_pk_fma_f32 v[20:21], v[88:89], s[22:23], v[20:21]
    v_pk_fma_f32 v[22:23], v[90:91], s[22:23], v[22:23]
    v_pk_add_f32 v[8:9], v[24:25], v[72:73] neg_lo:[0,1] neg_hi:[0,1]
    v_pk_add_f32 v[10:11], v[26:27], v[74:75] neg_lo:[0,1] neg_hi:[0,1]
    v_pk_fma_f32 v[20:21], v[72:73], s[14:15], v[20:21]
    v_pk_fma_f32 v[22:23], v[74:75], s[14:15], v[22:23]
    v_pk_mul_f32 v[80:81], v[12:13], s[32:33]
    v_pk_mul_f32 v[82:83], v[14:15], s[32:33]
    v_pk_fma_f32 v[20:21], v[8:9], s[12:13], v[20:21]
    v_pk_fma_f32 v[22:23], v[10:11], s[12:13], v[22:23]
    v_pk_fma_f32 v[80:81], v[4:5], s[34:35], v[80:81]
    v_pk_fma_f32 v[82:83], v[6:7], s[34:35], v[82:83]
    v_pk_fma_f32 v[64:65], v[4:5], s[24:25], v[20:21] neg_lo:[0,0,1] neg_hi:[0,0,1]
    v_pk_fma_f32 v[66:67], v[6:7], s[24:25], v[22:23] neg_lo:[0,0,1] neg_hi:[0,0,1]
    v_pk_fma_f32 v[64:65], v[12:13], s[26:27], v[64:65]
    v_pk_fma_f32 v[66:67], v[14:15], s[26:27], v[66:67]
    v_pk_fma_f32 v[80:81], v[64:65], s[38:39], v[80:81]
    v_pk_fma_f32 v[82:83], v[66:67], s[38:39], v[82:83]
    v_pk_add_f32 v[4:5], v[4:5], v[64:65] neg_lo:[0,1] neg_hi:[0,1]
    v_pk_add_f32 v[6:7], v[6:7], v[66:67] neg_lo:[0,1] neg_hi:[0,1]
    v_pk_add_f32 v[4:5], v[4:5], v[80:81] neg_lo:[0,1] neg_hi:[0,1]
    v_pk_add_f32 v[6:7], v[6:7], v[82:83] neg_lo:[0,1] neg_hi:[0,1]
    s_waitcnt lgkmcnt(0)
    v_pk_add_f32 v[92:93], v[56:57], v[60:61]
    v_pk_add_f32 v[94:95], v[58:59], v[62:63]
    v_pk_add_f32 v[56:57], v[36:37], v[40:41]
    v_pk_add_f32 v[58:59], v[38:39], v[42:43]
    v_pk_add_f32 v[36:37], v[36:37], v[40:41] neg_lo:[0,1] neg_hi:[0,1]
    v_pk_add_f32 v[38:39], v[38:39], v[42:43] neg_lo:[0,1] neg_hi:[0,1]
    v_pk_add_f32 v[76:77], v[44:45], v[48:49]
    v_pk_add_f32 v[78:79], v[46:47], v[50:51]
    v_pk_add_f32 v[44:45], v[44:45], v[48:49] neg_lo:[0,1] neg_hi:[0,1]
    v_pk_add_f32 v[46:47], v[46:47], v[50:51] neg_lo:[0,1] neg_hi:[0,1]
    v_pk_fma_f32 v[76:77], v[56:57], s[4:5], v[76:77]
    v_pk_fma_f32 v[78:79], v[58:59], s[4:5], v[78:79]
    v_pk_fma_f32 v[52:53], v[32:33], s[10:11], v[52:53]
    v_pk_fma_f32 v[54:55], v[34:35], s[10:11], v[54:55]
    v_pk_fma_f32 v[76:77], v[32:33], s[6:7], v[76:77]
    v_pk_fma_f32 v[78:79], v[34:35], s[6:7], v[78:79]
    v_pk_add_f32 v[56:57], v[56:57], v[32:33] neg_lo:[0,1] neg_hi:[0,1]
    v_pk_add_f32 v[58:59], v[58:59], v[34:35] neg_lo:[0,1] neg_hi:[0,1]
    v_pk_fma_f32 v[76:77], v[92:93], s[8:9], v[76:77]
    v_pk_fma_f32 v[78:79], v[94:95], s[8:9], v[78:79]
    v_pk_add_f32 v[56:57], v[56:57], v[92:93] neg_lo:[0,1] neg_hi:[0,1]
    v_pk_add_f32 v[58:59], v[58:59], v[94:95] neg_lo:[0,1] neg_hi:[0,1]
    v_pk_fma_f32 v[52:53], v[92:93], s[22:23], v[52:53]
    v_pk_fma_f32 v[54:55], v[94:95], s[22:23], v[54:55]
    v_pk_add_f32 v[40:41], v[56:57], v[76:77] neg_lo:[0,1] neg_hi:[0,1]
    v_pk_add_f32 v[42:43], v[58:59], v[78:79] neg_lo:[0,1] neg_hi:[0,1]
    v_pk_fma_f32 v[52:53], v[76:77], s[14:15], v[52:53]
    v_pk_fma_f32 v[54:55], v[78:79], s[14:15], v[54:55]
    v_pk_mul_f32 v[84:85], v[44:45], s[32:33]
    v_pk_mul_f32 v[86:87], v[46:47], s[32:33]
    v_pk_fma_f32 v[52:53], v[40:41], s[12:13], v[52:53]
    v_pk_fma_f32 v[54:55], v[42:43], s[12:13], v[54:55]
    v_pk_fma_f32 v[84:85], v[36:37], s[34:35], v[84:85]
    v_pk_fma_f32 v[86:87], v[38:39], s[34:35], v[86:87]
    v_pk_fma_f32 v[68:69], v[36:37], s[24:25], v[52:53] neg_lo:[0,0,1] neg_hi:[0,0,1]
    v_pk_fma_f32 v[70:71], v[38:39], s[24:25], v[54:55] neg_lo:[0,0,1] neg_hi:[0,0,1]
    v_pk_fma_f32 v[68:69], v[44:45], s[26:27], v[68:69]
    v_pk_fma_f32 v[70:71], v[46:47], s[26:27], v[70:71]
    v_pk_fma_f32 v[84:85], v[68:69], s[38:39], v[84:85]
    v_pk_fma_f32 v[86:87], v[70:71], s[38:39], v[86:87]
    v_pk_add_f32 v[36:37], v[36:37], v[68:69] neg_lo:[0,1] neg_hi:[0,1]
    v_pk_add_f32 v[38:39], v[38:39], v[70:71] neg_lo:[0,1] neg_hi:[0,1]
    v_pk_add_f32 v[36:37], v[36:37], v[84:85] neg_lo:[0,1] neg_hi:[0,1]
    v_pk_add_f32 v[38:39], v[38:39], v[86:87] neg_lo:[0,1] neg_hi:[0,1]
    s_mov_b32 s36, 0x00010001
    s_mov_b32 s37, 0x00010001
    s_mov_b64 exec, s[36:37]
    ds_write_b128 v123, v[0:3] offset:0
    ds_write_b128 v123, v[32:35] offset:16
    ds_write_b128 v123, v[4:7] offset:32
    ds_write_b128 v123, v[36:39] offset:48
    ds_write_b128 v123, v[8:11] offset:64
    ds_write_b128 v123, v[40:43] offset:80
    s_mov_b64 exec, -1
    v_mov_b32 v44, 0xc0135761
    v_mov_b32 v45, v44
    v_cvt_pk_bf16_f32 v48, v64, v68
    v_cvt_pk_bf16_f32 v49, v65, v69
    v_cvt_pk_bf16_f32 v50, v66, v70
    v_cvt_pk_bf16_f32 v51, v67, v71
    buffer_store_dwordx4 v[48:51], v122, s[16:19], 0 offen offset:0 sc1
    s_waitcnt lgkmcnt(0)
    s_barrier
    ds_read_b128 v[96:99], v123 offset:512
    ds_read_b128 v[100:103], v123 offset:528
    ds_read_b128 v[104:107], v123 offset:544
    ds_read_b128 v[108:111], v123 offset:560
    ds_read_b128 v[112:115], v123 offset:576
    ds_read_b128 v[116:119], v123 offset:592
    s_waitcnt lgkmcnt(4)
    v_mov_b32_dpp v96, v0 row_shl:1 row_mask:0xf bank_mask:0xf
    v_mov_b32_dpp v97, v1 row_shl:1 row_mask:0xf bank_mask:0xf
    v_mov_b32_dpp v98, v2 row_shl:1 row_mask:0xf bank_mask:0xf
    v_mov_b32_dpp v99, v3 row_shl:1 row_mask:0xf bank_mask:0xf
    v_mov_b32_dpp v100, v32 row_shl:1 row_mask:0xf bank_mask:0xf
    v_mov_b32_dpp v101, v33 row_shl:1 row_mask:0xf bank_mask:0xf
    v_mov_b32_dpp v102, v34 row_shl:1 row_mask:0xf bank_mask:0xf
    v_mov_b32_dpp v103, v35 row_shl:1 row_mask:0xf bank_mask:0xf
    v_pk_add_f32 v[72:73], v[72:73], v[96:97]
    v_pk_add_f32 v[74:75], v[74:75], v[98:99]
    v_pk_add_f32 v[76:77], v[76:77], v[100:101]
    v_pk_add_f32 v[78:79], v[78:79], v[102:103]
    v_cvt_pk_bf16_f32 v52, v72, v76
    v_cvt_pk_bf16_f32 v53, v73, v77
    v_cvt_pk_bf16_f32 v54, v74, v78
    v_cvt_pk_bf16_f32 v55, v75, v79
    buffer_store_dwordx4 v[52:55], v122, s[16:19], 0 offen offset:512 sc1
    s_waitcnt lgkmcnt(2)
    v_mov_b32_dpp v104, v4 row_shl:1 row_mask:0xf bank_mask:0xf
    v_mov_b32_dpp v105, v5 row_shl:1 row_mask:0xf bank_mask:0xf
    v_mov_b32_dpp v106, v6 row_shl:1 row_mask:0xf bank_mask:0xf
    v_mov_b32_dpp v107, v7 row_shl:1 row_mask:0xf bank_mask:0xf
    v_mov_b32_dpp v108, v36 row_shl:1 row_mask:0xf bank_mask:0xf
    v_mov_b32_dpp v109, v37 row_shl:1 row_mask:0xf bank_mask:0xf
    v_mov_b32_dpp v110, v38 row_shl:1 row_mask:0xf bank_mask:0xf
    v_mov_b32_dpp v111, v39 row_shl:1 row_mask:0xf bank_mask:0xf
    v_pk_add_f32 v[80:81], v[80:81], v[104:105]
    v_pk_add_f32 v[82:83], v[82:83], v[106:107]
    v_pk_add_f32 v[84:85], v[84:85], v[108:109]
    v_pk_add_f32 v[86:87], v[86:87], v[110:111]
    v_cvt_pk_bf16_f32 v56, v80, v84
    v_cvt_pk_bf16_f32 v57, v81, v85
    v_cvt_pk_bf16_f32 v58, v82, v86
    v_cvt_pk_bf16_f32 v59, v83, v87
    buffer_store_dwordx4 v[56:59], v122, s[16:19], 0 offen offset:1024 sc1
    s_waitcnt lgkmcnt(0)
    v_mov_b32_dpp v112, v8 row_shl:1 row_mask:0xf bank_mask:0xf
    v_mov_b32_dpp v113, v9 row_shl:1 row_mask:0xf bank_mask:0xf
    v_mov_b32_dpp v114, v10 row_shl:1 row_mask:0xf bank_mask:0xf
    v_mov_b32_dpp v115, v11 row_shl:1 row_mask:0xf bank_mask:0xf
    v_mov_b32_dpp v116, v40 row_shl:1 row_mask:0xf bank_mask:0xf
    v_mov_b32_dpp v117, v41 row_shl:1 row_mask:0xf bank_mask:0xf
    v_mov_b32_dpp v118, v42 row_shl:1 row_mask:0xf bank_mask:0xf
    v_mov_b32_dpp v119, v43 row_shl:1 row_mask:0xf bank_mask:0xf
    v_pk_add_f32 v[88:89], v[88:89], v[112:113]
    v_pk_add_f32 v[90:91], v[90:91], v[114:115]
    v_pk_add_f32 v[92:93], v[92:93], v[116:117]
    v_pk_add_f32 v[94:95], v[94:95], v[118:119]
    v_cvt_pk_bf16_f32 v60, v88, v92
    v_cvt_pk_bf16_f32 v61, v89, v93
    v_cvt_pk_bf16_f32 v62, v90, v94
    v_cvt_pk_bf16_f32 v63, v91, v95
    buffer_store_dwordx4 v[60:63], v122, s[16:19], 0 offen offset:1536 sc1
L_conv2_kernel_end:
L_conv2_kernel_done:
    s_endpgm
.globl joint_kernel
.p2align 8
.type joint_kernel,@function
joint_kernel:
    s_cmp_ge_u32 s2, 250
    s_cbranch_scc1 L_joint_kernel_done
    s_load_dwordx2 s[28:29], s[0:1], 56
    s_load_dwordx2 s[30:31], s[0:1], 72
    v_readfirstlane_b32 s20, v0
    s_lshr_b32 s20, s20, 6
    s_and_b32 s21, s20, 3
    v_and_b32 v255, 63, v0
    v_lshlrev_b32 v254, 4, v255
    s_cmp_ge_u32 s20, 4
    s_mov_b32 s33, 44171264
    s_cselect_b32 s33, 44040192, s33
    s_lshl_b32 s36, s21, 15
    s_add_u32 s33, s33, s36
    s_mov_b32 s14, 32768
    s_mov_b32 s15, 0x00020000
    s_lshl_b32 s35, s2, 14
    s_add_u32 s35, s35, 27262976
    s_mov_b32 s10, 8404992
    s_mov_b32 s11, 0x00020000
    s_waitcnt lgkmcnt(0)
    s_add_u32 s12, s30, s33
    s_addc_u32 s13, s31, 0
    s_cmp_ge_u32 s20, 4
    s_cbranch_scc1 L_joint_kernel_T
    s_add_u32 s8, s30, s35
    s_addc_u32 s9, s31, 0
    s_lshl_b32 s36, s20, 12
    s_add_u32 s37, s36, 8388608
    buffer_load_dwordx4 v[128:131], v254, s[8:11], s36 offen offset:0
    buffer_load_dwordx4 v[144:147], v254, s[8:11], s37 offen offset:0
    buffer_load_dwordx4 v[132:135], v254, s[8:11], s36 offen offset:1024
    buffer_load_dwordx4 v[148:151], v254, s[8:11], s37 offen offset:1024
    buffer_load_dwordx4 v[136:139], v254, s[8:11], s36 offen offset:2048
    buffer_load_dwordx4 v[152:155], v254, s[8:11], s37 offen offset:2048
    buffer_load_dwordx4 v[140:143], v254, s[8:11], s36 offen offset:3072
    buffer_load_dwordx4 v[156:159], v254, s[8:11], s37 offen offset:3072
    s_cmp_ge_u32 s2, 125
    s_cselect_b32 s34, 8192, 0
    s_add_u32 s34, s34, 44302336
    s_add_u32 s40, s30, s34
    s_addc_u32 s41, s31, 0
    s_mov_b32 s42, 24576
    s_mov_b32 s43, 0x00020000
    s_lshl_b32 s38, s20, 11
    s_add_u32 s39, s38, 16384
    buffer_load_dwordx4 v[192:195], v254, s[40:43], s38 offen offset:0
    buffer_load_dwordx4 v[196:199], v254, s[40:43], s38 offen offset:1024
    buffer_load_dwordx4 v[200:203], v254, s[40:43], s39 offen offset:0
    buffer_load_dwordx4 v[204:207], v254, s[40:43], s39 offen offset:1024
    s_barrier
    s_lshl_b32 s35, s2, 17
    s_add_u32 s16, s28, s35
    s_addc_u32 s17, s29, 0
    s_mov_b32 s18, 131072
    s_mov_b32 s19, 0x00020000
    s_mov_b32 s44, 0xbdd2d3e8
    v_mov_b32 v253, 0xc0135761
    s_mul_i32 s36, s20, 4224
    v_lshrrev_b32 v252, 5, v255
    v_lshlrev_b32 v252, 4, v252
    v_add3_u32 v252, v252, v254, s36
    s_mov_b32 s45, 0xffff0000
    v_add_u32 v251, s38, v254
    s_waitcnt vmcnt(4)
    s_mov_b32 s22, 4
L_joint_kernel_floop:
    v_lshlrev_b32 v168, 16, v128
    v_and_b32 v169, s45, v128
    v_lshlrev_b32 v232, 16, v144
    v_and_b32 v233, s45, v144
    v_lshlrev_b32 v170, 16, v129
    v_and_b32 v171, s45, v129
    v_lshlrev_b32 v234, 16, v145
    v_and_b32 v235, s45, v145
    v_lshlrev_b32 v172, 16, v130
    v_and_b32 v173, s45, v130
    v_lshlrev_b32 v236, 16, v146
    v_and_b32 v237, s45, v146
    v_lshlrev_b32 v174, 16, v131
    v_and_b32 v175, s45, v131
    v_lshlrev_b32 v238, 16, v147
    v_and_b32 v239, s45, v147
    v_add_f32 v168, v168, v232
    v_add_f32 v169, v169, v233
    v_add_f32 v170, v170, v234
    v_add_f32 v171, v171, v235
    v_add_f32 v172, v172, v236
    v_add_f32 v173, v173, v237
    v_add_f32 v174, v174, v238
    v_add_f32 v175, v175, v239
    v_mul_f32 v232, v168, v168
    v_mul_f32 v233, v169, v169
    v_mul_f32 v234, v170, v170
    v_mul_f32 v235, v171, v171
    v_mul_f32 v236, v172, v172
    v_mul_f32 v237, v173, v173
    v_mul_f32 v238, v174, v174
    v_mul_f32 v239, v175, v175
    v_fma_f32 v232, v232, s44, v253
    v_fma_f32 v233, v233, s44, v253
    v_fma_f32 v234, v234, s44, v253
    v_fma_f32 v235, v235, s44, v253
    v_fma_f32 v236, v236, s44, v253
    v_fma_f32 v237, v237, s44, v253
    v_fma_f32 v238, v238, s44, v253
    v_fma_f32 v239, v239, s44, v253
    v_mul_f32 v232, v232, v168
    v_mul_f32 v233, v233, v169
    v_mul_f32 v234, v234, v170
    v_mul_f32 v235, v235, v171
    v_mul_f32 v236, v236, v172
    v_mul_f32 v237, v237, v173
    v_mul_f32 v238, v238, v174
    v_mul_f32 v239, v239, v175
    v_exp_f32 v232, v232
    v_exp_f32 v233, v233
    v_exp_f32 v234, v234
    v_exp_f32 v235, v235
    v_exp_f32 v236, v236
    v_exp_f32 v237, v237
    v_exp_f32 v238, v238
    v_exp_f32 v239, v239
    v_add_f32 v232, 1.0, v232
    v_add_f32 v233, 1.0, v233
    v_add_f32 v234, 1.0, v234
    v_add_f32 v235, 1.0, v235
    v_add_f32 v236, 1.0, v236
    v_add_f32 v237, 1.0, v237
    v_add_f32 v238, 1.0, v238
    v_add_f32 v239, 1.0, v239
    v_rcp_f32 v232, v232
    v_rcp_f32 v233, v233
    v_rcp_f32 v234, v234
    v_rcp_f32 v235, v235
    v_rcp_f32 v236, v236
    v_rcp_f32 v237, v237
    v_rcp_f32 v238, v238
    v_rcp_f32 v239, v239
    v_pk_mov_b32 v[128:129], v[132:133], v[132:133] op_sel:[0,1]
    v_pk_mov_b32 v[144:145], v[148:149], v[148:149] op_sel:[0,1]
    v_pk_mov_b32 v[130:131], v[134:135], v[134:135] op_sel:[0,1]
    v_pk_mov_b32 v[146:147], v[150:151], v[150:151] op_sel:[0,1]
    v_pk_mov_b32 v[132:133], v[136:137], v[136:137] op_sel:[0,1]
    v_pk_mov_b32 v[148:149], v[152:153], v[152:153] op_sel:[0,1]
    v_pk_mov_b32 v[134:135], v[138:139], v[138:139] op_sel:[0,1]
    v_pk_mov_b32 v[150:151], v[154:155], v[154:155] op_sel:[0,1]
    v_pk_mov_b32 v[136:137], v[140:141], v[140:141] op_sel:[0,1]
    v_pk_mov_b32 v[152:153], v[156:157], v[156:157] op_sel:[0,1]
    v_pk_mov_b32 v[138:139], v[142:143], v[142:143] op_sel:[0,1]
    v_pk_mov_b32 v[154:155], v[158:159], v[158:159] op_sel:[0,1]
    v_mul_f32 v168, v168, v232
    v_mul_f32 v169, v169, v233
    v_mul_f32 v170, v170, v234
    v_mul_f32 v171, v171, v235
    v_mul_f32 v172, v172, v236
    v_mul_f32 v173, v173, v237
    v_mul_f32 v174, v174, v238
    v_mul_f32 v175, v175, v239
    v_cvt_pk_bf16_f32 v240, v168, v169
    v_cvt_pk_bf16_f32 v241, v170, v171
    v_cvt_pk_bf16_f32 v242, v172, v173
    v_cvt_pk_bf16_f32 v243, v174, v175
    ds_write_b128 v252, v[240:243] offset:49152
    v_add_u32 v252, 1056, v252
    s_sub_u32 s22, s22, 1
    s_cmp_lg_u32 s22, 0
    s_cbranch_scc1 L_joint_kernel_floop
    s_waitcnt vmcnt(0)
    ds_write_b128 v251, v[192:195] offset:32768
    ds_write_b128 v251, v[196:199] offset:33792
    ds_write_b128 v251, v[200:203] offset:40960
    ds_write_b128 v251, v[204:207] offset:41984
    s_waitcnt lgkmcnt(0)
    s_barrier
    s_mov_b32 s36, 0
    buffer_load_dwordx4 v[0:3], v254, s[12:15], s36 offen offset:0
    buffer_load_dwordx4 v[4:7], v254, s[12:15], s36 offen offset:1024
    buffer_load_dwordx4 v[8:11], v254, s[12:15], s36 offen offset:2048
    buffer_load_dwordx4 v[12:15], v254, s[12:15], s36 offen offset:3072
    s_mov_b32 s36, 4096
    buffer_load_dwordx4 v[16:19], v254, s[12:15], s36 offen offset:0
    buffer_load_dwordx4 v[20:23], v254, s[12:15], s36 offen offset:1024
    buffer_load_dwordx4 v[24:27], v254, s[12:15], s36 offen offset:2048
    buffer_load_dwordx4 v[28:31], v254, s[12:15], s36 offen offset:3072
    s_mov_b32 s36, 8192
    buffer_load_dwordx4 v[32:35], v254, s[12:15], s36 offen offset:0
    buffer_load_dwordx4 v[36:39], v254, s[12:15], s36 offen offset:1024
    buffer_load_dwordx4 v[40:43], v254, s[12:15], s36 offen offset:2048
    buffer_load_dwordx4 v[44:47], v254, s[12:15], s36 offen offset:3072
    s_mov_b32 s36, 12288
    buffer_load_dwordx4 v[48:51], v254, s[12:15], s36 offen offset:0
    buffer_load_dwordx4 v[52:55], v254, s[12:15], s36 offen offset:1024
    buffer_load_dwordx4 v[56:59], v254, s[12:15], s36 offen offset:2048
    buffer_load_dwordx4 v[60:63], v254, s[12:15], s36 offen offset:3072
    s_mov_b32 s36, 16384
    buffer_load_dwordx4 v[64:67], v254, s[12:15], s36 offen offset:0
    buffer_load_dwordx4 v[68:71], v254, s[12:15], s36 offen offset:1024
    buffer_load_dwordx4 v[72:75], v254, s[12:15], s36 offen offset:2048
    buffer_load_dwordx4 v[76:79], v254, s[12:15], s36 offen offset:3072
    s_mov_b32 s36, 20480
    buffer_load_dwordx4 v[80:83], v254, s[12:15], s36 offen offset:0
    buffer_load_dwordx4 v[84:87], v254, s[12:15], s36 offen offset:1024
    buffer_load_dwordx4 v[88:91], v254, s[12:15], s36 offen offset:2048
    buffer_load_dwordx4 v[92:95], v254, s[12:15], s36 offen offset:3072
    s_mov_b32 s36, 24576
    buffer_load_dwordx4 v[96:99], v254, s[12:15], s36 offen offset:0
    buffer_load_dwordx4 v[100:103], v254, s[12:15], s36 offen offset:1024
    buffer_load_dwordx4 v[104:107], v254, s[12:15], s36 offen offset:2048
    buffer_load_dwordx4 v[108:111], v254, s[12:15], s36 offen offset:3072
    s_mov_b32 s36, 28672
    buffer_load_dwordx4 v[112:115], v254, s[12:15], s36 offen offset:0
    buffer_load_dwordx4 v[116:119], v254, s[12:15], s36 offen offset:1024
    buffer_load_dwordx4 v[120:123], v254, s[12:15], s36 offen offset:2048
    buffer_load_dwordx4 v[124:127], v254, s[12:15], s36 offen offset:3072
    v_lshrrev_b32 v250, 5, v255
    v_lshlrev_b32 v250, 14, v250
    v_and_b32 v249, 31, v255
    v_lshl_add_u32 v250, v249, 2, v250
    s_lshl_b32 s36, s21, 7
    v_add_u32 v250, s36, v250
    s_mov_b32 s44, 0
    s_mov_b32 s45, 4096
    s_mov_b32 s46, 8192
    s_mov_b32 s47, 12288
    s_mov_b32 s48, 32768
    s_mov_b32 s49, 36864
    s_mov_b32 s50, 40960
    s_mov_b32 s51, 45056
    s_mov_b32 s52, 65536
    s_mov_b32 s53, 69632
    s_mov_b32 s54, 73728
    s_mov_b32 s55, 77824
    s_mov_b32 s56, 98304
    s_mov_b32 s57, 102400
    s_mov_b32 s58, 106496
    s_mov_b32 s59, 110592
    s_barrier
    ds_read_b128 v[192:195], v254 offset:0
    ds_read_b128 v[196:199], v254 offset:1024
    ds_read_b128 v[200:203], v254 offset:2048
    ds_read_b128 v[204:207], v254 offset:3072
    s_waitcnt vmcnt(30) lgkmcnt(3)
    v_mfma_f32_32x32x16_bf16 v[128:143], v[192:195], v[0:3], 0
    ds_read_b128 v[208:211], v254 offset:4096
    v_mfma_f32_32x32x16_bf16 v[144:159], v[192:195], v[4:7], 0
    s_waitcnt vmcnt(28) lgkmcnt(3)
    v_mfma_f32_32x32x16_bf16 v[128:143], v[196:199], v[8:11], v[128:143]
    ds_read_b128 v[212:215], v254 offset:5120
    v_mfma_f32_32x32x16_bf16 v[144:159], v[196:199], v[12:15], v[144:159]
    s_waitcnt vmcnt(26) lgkmcnt(3)
    v_mfma_f32_32x32x16_bf16 v[128:143], v[200:203], v[16:19], v[128:143]
    ds_read_b128 v[216:219], v254 offset:6144
    v_mfma_f32_32x32x16_bf16 v[144:159], v[200:203], v[20:23], v[144:159]
    s_waitcnt vmcnt(24) lgkmcnt(3)
    v_mfma_f32_32x32x16_bf16 v[128:143], v[204:207], v[24:27], v[128:143]
    ds_read_b128 v[220:223], v254 offset:7168
    v_mfma_f32_32x32x16_bf16 v[144:159], v[204:207], v[28:31], v[144:159]
    s_waitcnt vmcnt(22) lgkmcnt(3)
    v_mfma_f32_32x32x16_bf16 v[128:143], v[208:211], v[32:35], v[128:143]
    ds_read_b128 v[192:195], v254 offset:8192
    v_mfma_f32_32x32x16_bf16 v[144:159], v[208:211], v[36:39], v[144:159]
    s_waitcnt vmcnt(20) lgkmcnt(3)
    v_mfma_f32_32x32x16_bf16 v[128:143], v[212:215], v[40:43], v[128:143]
    ds_read_b128 v[196:199], v254 offset:9216
    v_mfma_f32_32x32x16_bf16 v[144:159], v[212:215], v[44:47], v[144:159]
    s_waitcnt vmcnt(18) lgkmcnt(3)
    v_mfma_f32_32x32x16_bf16 v[128:143], v[216:219], v[48:51], v[128:143]
    ds_read_b128 v[200:203], v254 offset:10240
    v_mfma_f32_32x32x16_bf16 v[144:159], v[216:219], v[52:55], v[144:159]
    s_waitcnt vmcnt(16) lgkmcnt(3)
    v_mfma_f32_32x32x16_bf16 v[128:143], v[220:223], v[56:59], v[128:143]
    ds_read_b128 v[204:207], v254 offset:11264
    v_mfma_f32_32x32x16_bf16 v[144:159], v[220:223], v[60:63], v[144:159]
    s_waitcnt vmcnt(14) lgkmcnt(3)
    v_mfma_f32_32x32x16_bf16 v[128:143], v[192:195], v[64:67], v[128:143]
    ds_read_b128 v[208:211], v254 offset:12288
    v_mfma_f32_32x32x16_bf16 v[144:159], v[192:195], v[68:71], v[144:159]
    s_waitcnt vmcnt(12) lgkmcnt(3)
    v_mfma_f32_32x32x16_bf16 v[128:143], v[196:199], v[72:75], v[128:143]
    ds_read_b128 v[212:215], v254 offset:13312
    v_mfma_f32_32x32x16_bf16 v[144:159], v[196:199], v[76:79], v[144:159]
    s_waitcnt vmcnt(10) lgkmcnt(3)
    v_mfma_f32_32x32x16_bf16 v[128:143], v[200:203], v[80:83], v[128:143]
    ds_read_b128 v[216:219], v254 offset:14336
    v_mfma_f32_32x32x16_bf16 v[144:159], v[200:203], v[84:87], v[144:159]
    s_waitcnt vmcnt(8) lgkmcnt(3)
    v_mfma_f32_32x32x16_bf16 v[128:143], v[204:207], v[88:91], v[128:143]
    ds_read_b128 v[220:223], v254 offset:15360
    v_mfma_f32_32x32x16_bf16 v[144:159], v[204:207], v[92:95], v[144:159]
    s_waitcnt lgkmcnt(0)
    s_barrier
    s_waitcnt vmcnt(6)
    v_mfma_f32_32x32x16_bf16 v[128:143], v[208:211], v[96:99], v[128:143]
    ds_read_b128 v[192:195], v254 offset:16384
    v_mfma_f32_32x32x16_bf16 v[144:159], v[208:211], v[100:103], v[144:159]
    s_waitcnt vmcnt(4)
    v_mfma_f32_32x32x16_bf16 v[128:143], v[212:215], v[104:107], v[128:143]
    ds_read_b128 v[196:199], v254 offset:17408
    v_mfma_f32_32x32x16_bf16 v[144:159], v[212:215], v[108:111], v[144:159]
    s_waitcnt vmcnt(2)
    v_mfma_f32_32x32x16_bf16 v[128:143], v[216:219], v[112:115], v[128:143]
    ds_read_b128 v[200:203], v254 offset:18432
    v_mfma_f32_32x32x16_bf16 v[144:159], v[216:219], v[116:119], v[144:159]
    s_waitcnt vmcnt(0)
    v_mfma_f32_32x32x16_bf16 v[128:143], v[220:223], v[120:123], v[128:143]
    ds_read_b128 v[204:207], v254 offset:19456
    v_mfma_f32_32x32x16_bf16 v[144:159], v[220:223], v[124:127], v[144:159]
    s_mov_b32 s22, 4
    s_nop 0
L_joint_kernel_oloop:
    s_waitcnt lgkmcnt(3)
    s_nop 0
    v_mfma_f32_32x32x16_bf16 v[160:175], v[192:195], v[0:3], 0
    ds_read_b128 v[208:211], v254 offset:20480
    v_mfma_f32_32x32x16_bf16 v[176:191], v[192:195], v[4:7], 0
    s_waitcnt lgkmcnt(3)
    s_nop 0
    v_mfma_f32_32x32x16_bf16 v[160:175], v[196:199], v[8:11], v[160:175]
    ds_read_b128 v[212:215], v254 offset:21504
    v_mfma_f32_32x32x16_bf16 v[176:191], v[196:199], v[12:15], v[176:191]
    s_waitcnt lgkmcnt(3)
    s_nop 0
    v_mfma_f32_32x32x16_bf16 v[160:175], v[200:203], v[16:19], v[160:175]
    ds_read_b128 v[216:219], v254 offset:22528
    v_mfma_f32_32x32x16_bf16 v[176:191], v[200:203], v[20:23], v[176:191]
    s_waitcnt lgkmcnt(3)
    s_nop 0
    v_mfma_f32_32x32x16_bf16 v[160:175], v[204:207], v[24:27], v[160:175]
    ds_read_b128 v[220:223], v254 offset:23552
    v_mfma_f32_32x32x16_bf16 v[176:191], v[204:207], v[28:31], v[176:191]
    s_waitcnt lgkmcnt(3)
    s_nop 0
    v_mfma_f32_32x32x16_bf16 v[160:175], v[208:211], v[32:35], v[160:175]
    ds_read_b128 v[192:195], v254 offset:24576
    v_cvt_pk_bf16_f32 v224, v128, v144
    buffer_store_dword v224, v250, s[16:19], s44 offen nt
    v_mfma_f32_32x32x16_bf16 v[176:191], v[208:211], v[36:39], v[176:191]
    v_cvt_pk_bf16_f32 v225, v129, v145
    buffer_store_dword v225, v250, s[16:19], s45 offen nt
    s_waitcnt lgkmcnt(3)
    s_nop 0
    v_mfma_f32_32x32x16_bf16 v[160:175], v[212:215], v[40:43], v[160:175]
    ds_read_b128 v[196:199], v254 offset:25600
    v_cvt_pk_bf16_f32 v226, v130, v146
    buffer_store_dword v226, v250, s[16:19], s46 offen nt
    v_mfma_f32_32x32x16_bf16 v[176:191], v[212:215], v[44:47], v[176:191]
    v_cvt_pk_bf16_f32 v227, v131, v147
    buffer_store_dword v227, v250, s[16:19], s47 offen nt
    s_waitcnt lgkmcnt(3)
    s_nop 0
    v_mfma_f32_32x32x16_bf16 v[160:175], v[216:219], v[48:51], v[160:175]
    ds_read_b128 v[200:203], v254 offset:26624
    v_cvt_pk_bf16_f32 v228, v132, v148
    buffer_store_dword v228, v250, s[16:19], s48 offen nt
    v_mfma_f32_32x32x16_bf16 v[176:191], v[216:219], v[52:55], v[176:191]
    v_cvt_pk_bf16_f32 v229, v133, v149
    buffer_store_dword v229, v250, s[16:19], s49 offen nt
    s_waitcnt lgkmcnt(3)
    s_nop 0
    v_mfma_f32_32x32x16_bf16 v[160:175], v[220:223], v[56:59], v[160:175]
    ds_read_b128 v[204:207], v254 offset:27648
    v_cvt_pk_bf16_f32 v230, v134, v150
    buffer_store_dword v230, v250, s[16:19], s50 offen nt
    v_mfma_f32_32x32x16_bf16 v[176:191], v[220:223], v[60:63], v[176:191]
    v_cvt_pk_bf16_f32 v231, v135, v151
    buffer_store_dword v231, v250, s[16:19], s51 offen nt
    s_waitcnt lgkmcnt(3)
    s_nop 0
    v_mfma_f32_32x32x16_bf16 v[160:175], v[192:195], v[64:67], v[160:175]
    ds_read_b128 v[208:211], v254 offset:28672
    v_cvt_pk_bf16_f32 v232, v136, v152
    buffer_store_dword v232, v250, s[16:19], s52 offen nt
    v_mfma_f32_32x32x16_bf16 v[176:191], v[192:195], v[68:71], v[176:191]
    v_cvt_pk_bf16_f32 v233, v137, v153
    buffer_store_dword v233, v250, s[16:19], s53 offen nt
    s_waitcnt lgkmcnt(3)
    s_nop 0
    v_mfma_f32_32x32x16_bf16 v[160:175], v[196:199], v[72:75], v[160:175]
    ds_read_b128 v[212:215], v254 offset:29696
    v_cvt_pk_bf16_f32 v234, v138, v154
    v_mfma_f32_32x32x16_bf16 v[176:191], v[196:199], v[76:79], v[176:191]
    buffer_store_dword v234, v250, s[16:19], s54 offen nt
    s_waitcnt lgkmcnt(3)
    s_nop 0
    v_mfma_f32_32x32x16_bf16 v[160:175], v[200:203], v[80:83], v[160:175]
    ds_read_b128 v[216:219], v254 offset:30720
    v_cvt_pk_bf16_f32 v235, v139, v155
    v_mfma_f32_32x32x16_bf16 v[176:191], v[200:203], v[84:87], v[176:191]
    buffer_store_dword v235, v250, s[16:19], s55 offen nt
    s_waitcnt lgkmcnt(3)
    s_nop 0
    v_mfma_f32_32x32x16_bf16 v[160:175], v[204:207], v[88:91], v[160:175]
    ds_read_b128 v[220:223], v254 offset:31744
    v_cvt_pk_bf16_f32 v236, v140, v156
    v_mfma_f32_32x32x16_bf16 v[176:191], v[204:207], v[92:95], v[176:191]
    buffer_store_dword v236, v250, s[16:19], s56 offen nt
    s_waitcnt lgkmcnt(0)
    s_barrier
    v_mfma_f32_32x32x16_bf16 v[160:175], v[208:211], v[96:99], v[160:175]
    ds_read_b128 v[192:195], v254 offset:0
    v_cvt_pk_bf16_f32 v237, v141, v157
    v_mfma_f32_32x32x16_bf16 v[176:191], v[208:211], v[100:103], v[176:191]
    buffer_store_dword v237, v250, s[16:19], s57 offen nt
    v_mfma_f32_32x32x16_bf16 v[160:175], v[212:215], v[104:107], v[160:175]
    ds_read_b128 v[196:199], v254 offset:1024
    v_cvt_pk_bf16_f32 v238, v142, v158
    v_mfma_f32_32x32x16_bf16 v[176:191], v[212:215], v[108:111], v[176:191]
    buffer_store_dword v238, v250, s[16:19], s58 offen nt
    v_mfma_f32_32x32x16_bf16 v[160:175], v[216:219], v[112:115], v[160:175]
    ds_read_b128 v[200:203], v254 offset:2048
    v_cvt_pk_bf16_f32 v239, v143, v159
    v_mfma_f32_32x32x16_bf16 v[176:191], v[216:219], v[116:119], v[176:191]
    buffer_store_dword v239, v250, s[16:19], s59 offen nt
    v_mfma_f32_32x32x16_bf16 v[160:175], v[220:223], v[120:123], v[160:175]
    ds_read_b128 v[204:207], v254 offset:3072
    v_add_u32 v250, 512, v250
    v_mfma_f32_32x32x16_bf16 v[176:191], v[220:223], v[124:127], v[176:191]
    s_sub_u32 s22, s22, 1
    s_cmp_eq_u32 s22, 0
    s_cbranch_scc1 L_joint_kernel_oend
    s_waitcnt lgkmcnt(3)
    v_mfma_f32_32x32x16_bf16 v[128:143], v[192:195], v[0:3], 0
    ds_read_b128 v[208:211], v254 offset:4096
    v_mfma_f32_32x32x16_bf16 v[144:159], v[192:195], v[4:7], 0
    s_waitcnt lgkmcnt(3)
    s_nop 0
    v_mfma_f32_32x32x16_bf16 v[128:143], v[196:199], v[8:11], v[128:143]
    ds_read_b128 v[212:215], v254 offset:5120
    v_mfma_f32_32x32x16_bf16 v[144:159], v[196:199], v[12:15], v[144:159]
    s_waitcnt lgkmcnt(3)
    s_nop 0
    v_mfma_f32_32x32x16_bf16 v[128:143], v[200:203], v[16:19], v[128:143]
    ds_read_b128 v[216:219], v254 offset:6144
    v_mfma_f32_32x32x16_bf16 v[144:159], v[200:203], v[20:23], v[144:159]
    s_waitcnt lgkmcnt(3)
    s_nop 0
    v_mfma_f32_32x32x16_bf16 v[128:143], v[204:207], v[24:27], v[128:143]
    ds_read_b128 v[220:223], v254 offset:7168
    v_mfma_f32_32x32x16_bf16 v[144:159], v[204:207], v[28:31], v[144:159]
    s_waitcnt lgkmcnt(3)
    s_nop 0
    v_mfma_f32_32x32x16_bf16 v[128:143], v[208:211], v[32:35], v[128:143]
    ds_read_b128 v[192:195], v254 offset:8192
    v_cvt_pk_bf16_f32 v224, v160, v176
    buffer_store_dword v224, v250, s[16:19], s44 offen nt
    v_mfma_f32_32x32x16_bf16 v[144:159], v[208:211], v[36:39], v[144:159]
    v_cvt_pk_bf16_f32 v225, v161, v177
    buffer_store_dword v225, v250, s[16:19], s45 offen nt
    s_waitcnt lgkmcnt(3)
    s_nop 0
    v_mfma_f32_32x32x16_bf16 v[128:143], v[212:215], v[40:43], v[128:143]
    ds_read_b128 v[196:199], v254 offset:9216
    v_cvt_pk_bf16_f32 v226, v162, v178
    buffer_store_dword v226, v250, s[16:19], s46 offen nt
    v_mfma_f32_32x32x16_bf16 v[144:159], v[212:215], v[44:47], v[144:159]
    v_cvt_pk_bf16_f32 v227, v163, v179
    buffer_store_dword v227, v250, s[16:19], s47 offen nt
    s_waitcnt lgkmcnt(3)
    s_nop 0
    v_mfma_f32_32x32x16_bf16 v[128:143], v[216:219], v[48:51], v[128:143]
    ds_read_b128 v[200:203], v254 offset:10240
    v_cvt_pk_bf16_f32 v228, v164, v180
    buffer_store_dword v228, v250, s[16:19], s48 offen nt
    v_mfma_f32_32x32x16_bf16 v[144:159], v[216:219], v[52:55], v[144:159]
    v_cvt_pk_bf16_f32 v229, v165, v181
    buffer_store_dword v229, v250, s[16:19], s49 offen nt
    s_waitcnt lgkmcnt(3)
    s_nop 0
    v_mfma_f32_32x32x16_bf16 v[128:143], v[220:223], v[56:59], v[128:143]
    ds_read_b128 v[204:207], v254 offset:11264
    v_cvt_pk_bf16_f32 v230, v166, v182
    buffer_store_dword v230, v250, s[16:19], s50 offen nt
    v_mfma_f32_32x32x16_bf16 v[144:159], v[220:223], v[60:63], v[144:159]
    v_cvt_pk_bf16_f32 v231, v167, v183
    buffer_store_dword v231, v250, s[16:19], s51 offen nt
    s_waitcnt lgkmcnt(3)
    s_nop 0
    v_mfma_f32_32x32x16_bf16 v[128:143], v[192:195], v[64:67], v[128:143]
    ds_read_b128 v[208:211], v254 offset:12288
    v_cvt_pk_bf16_f32 v232, v168, v184
    buffer_store_dword v232, v250, s[16:19], s52 offen nt
    v_mfma_f32_32x32x16_bf16 v[144:159], v[192:195], v[68:71], v[144:159]
    v_cvt_pk_bf16_f32 v233, v169, v185
    buffer_store_dword v233, v250, s[16:19], s53 offen nt
    s_waitcnt lgkmcnt(3)
    s_nop 0
    v_mfma_f32_32x32x16_bf16 v[128:143], v[196:199], v[72:75], v[128:143]
    ds_read_b128 v[212:215], v254 offset:13312
    v_cvt_pk_bf16_f32 v234, v170, v186
    v_mfma_f32_32x32x16_bf16 v[144:159], v[196:199], v[76:79], v[144:159]
    buffer_store_dword v234, v250, s[16:19], s54 offen nt
    s_waitcnt lgkmcnt(3)
    s_nop 0
    v_mfma_f32_32x32x16_bf16 v[128:143], v[200:203], v[80:83], v[128:143]
    ds_read_b128 v[216:219], v254 offset:14336
    v_cvt_pk_bf16_f32 v235, v171, v187
    v_mfma_f32_32x32x16_bf16 v[144:159], v[200:203], v[84:87], v[144:159]
    buffer_store_dword v235, v250, s[16:19], s55 offen nt
    s_waitcnt lgkmcnt(3)
    s_nop 0
    v_mfma_f32_32x32x16_bf16 v[128:143], v[204:207], v[88:91], v[128:143]
    ds_read_b128 v[220:223], v254 offset:15360
    v_cvt_pk_bf16_f32 v236, v172, v188
    v_mfma_f32_32x32x16_bf16 v[144:159], v[204:207], v[92:95], v[144:159]
    buffer_store_dword v236, v250, s[16:19], s56 offen nt
    s_waitcnt lgkmcnt(0)
    s_barrier
    v_mfma_f32_32x32x16_bf16 v[128:143], v[208:211], v[96:99], v[128:143]
    ds_read_b128 v[192:195], v254 offset:16384
    v_cvt_pk_bf16_f32 v237, v173, v189
    v_mfma_f32_32x32x16_bf16 v[144:159], v[208:211], v[100:103], v[144:159]
    buffer_store_dword v237, v250, s[16:19], s57 offen nt
    v_mfma_f32_32x32x16_bf16 v[128:143], v[212:215], v[104:107], v[128:143]
    ds_read_b128 v[196:199], v254 offset:17408
    v_cvt_pk_bf16_f32 v238, v174, v190
    v_mfma_f32_32x32x16_bf16 v[144:159], v[212:215], v[108:111], v[144:159]
    buffer_store_dword v238, v250, s[16:19], s58 offen nt
    v_mfma_f32_32x32x16_bf16 v[128:143], v[216:219], v[112:115], v[128:143]
    ds_read_b128 v[200:203], v254 offset:18432
    v_cvt_pk_bf16_f32 v239, v175, v191
    v_mfma_f32_32x32x16_bf16 v[144:159], v[216:219], v[116:119], v[144:159]
    buffer_store_dword v239, v250, s[16:19], s59 offen nt
    v_mfma_f32_32x32x16_bf16 v[128:143], v[220:223], v[120:123], v[128:143]
    ds_read_b128 v[204:207], v254 offset:19456
    v_add_u32 v250, 512, v250
    v_mfma_f32_32x32x16_bf16 v[144:159], v[220:223], v[124:127], v[144:159]
    s_waitcnt vmcnt(24)
    s_branch L_joint_kernel_oloop
L_joint_kernel_oend:
    s_nop 15
    v_cvt_pk_bf16_f32 v224, v160, v176
    buffer_store_dword v224, v250, s[16:19], s44 offen nt
    v_cvt_pk_bf16_f32 v225, v161, v177
    buffer_store_dword v225, v250, s[16:19], s45 offen nt
    v_cvt_pk_bf16_f32 v226, v162, v178
    buffer_store_dword v226, v250, s[16:19], s46 offen nt
    v_cvt_pk_bf16_f32 v227, v163, v179
    buffer_store_dword v227, v250, s[16:19], s47 offen nt
    v_cvt_pk_bf16_f32 v228, v164, v180
    buffer_store_dword v228, v250, s[16:19], s48 offen nt
    v_cvt_pk_bf16_f32 v229, v165, v181
    buffer_store_dword v229, v250, s[16:19], s49 offen nt
    v_cvt_pk_bf16_f32 v230, v166, v182
    buffer_store_dword v230, v250, s[16:19], s50 offen nt
    v_cvt_pk_bf16_f32 v231, v167, v183
    buffer_store_dword v231, v250, s[16:19], s51 offen nt
    v_cvt_pk_bf16_f32 v232, v168, v184
    buffer_store_dword v232, v250, s[16:19], s52 offen nt
    v_cvt_pk_bf16_f32 v233, v169, v185
    buffer_store_dword v233, v250, s[16:19], s53 offen nt
    v_cvt_pk_bf16_f32 v234, v170, v186
    buffer_store_dword v234, v250, s[16:19], s54 offen nt
    v_cvt_pk_bf16_f32 v235, v171, v187
    buffer_store_dword v235, v250, s[16:19], s55 offen nt
    v_cvt_pk_bf16_f32 v236, v172, v188
    buffer_store_dword v236, v250, s[16:19], s56 offen nt
    v_cvt_pk_bf16_f32 v237, v173, v189
    buffer_store_dword v237, v250, s[16:19], s57 offen nt
    v_cvt_pk_bf16_f32 v238, v174, v190
    buffer_store_dword v238, v250, s[16:19], s58 offen nt
    v_cvt_pk_bf16_f32 v239, v175, v191
    buffer_store_dword v239, v250, s[16:19], s59 offen nt
    v_add_u32 v250, 512, v250
    s_branch L_joint_kernel_fin
L_joint_kernel_T:
    s_setprio 3
    s_add_u32 s36, s30, 44335104
    s_addc_u32 s37, s31, 0
    s_load_dwordx16 s[44:59], s[36:37], 0
    v_and_b32 v250, 31, v255
    v_mul_u32_u24 v250, 528, v250
    v_lshrrev_b32 v249, 5, v255
    v_lshl_add_u32 v250, v249, 4, v250
    v_lshlrev_b32 v249, 5, v249
    s_lshl_b32 s36, s21, 8
    v_add_u32 v249, s36, v249
    s_lshl_b32 s36, s21, 12
    v_add_u32 v248, s36, v254
    s_barrier
    s_mov_b32 s36, 0
    buffer_load_dwordx4 v[0:3], v254, s[12:15], s36 offen offset:0
    buffer_load_dwordx4 v[4:7], v254, s[12:15], s36 offen offset:1024
    buffer_load_dwordx4 v[8:11], v254, s[12:15], s36 offen offset:2048
    buffer_load_dwordx4 v[12:15], v254, s[12:15], s36 offen offset:3072
    s_mov_b32 s36, 4096
    buffer_load_dwordx4 v[16:19], v254, s[12:15], s36 offen offset:0
    buffer_load_dwordx4 v[20:23], v254, s[12:15], s36 offen offset:1024
    buffer_load_dwordx4 v[24:27], v254, s[12:15], s36 offen offset:2048
    buffer_load_dwordx4 v[28:31], v254, s[12:15], s36 offen offset:3072
    s_mov_b32 s36, 8192
    buffer_load_dwordx4 v[32:35], v254, s[12:15], s36 offen offset:0
    buffer_load_dwordx4 v[36:39], v254, s[12:15], s36 offen offset:1024
    buffer_load_dwordx4 v[40:43], v254, s[12:15], s36 offen offset:2048
    buffer_load_dwordx4 v[44:47], v254, s[12:15], s36 offen offset:3072
    s_mov_b32 s36, 12288
    buffer_load_dwordx4 v[48:51], v254, s[12:15], s36 offen offset:0
    buffer_load_dwordx4 v[52:55], v254, s[12:15], s36 offen offset:1024
    buffer_load_dwordx4 v[56:59], v254, s[12:15], s36 offen offset:2048
    buffer_load_dwordx4 v[60:63], v254, s[12:15], s36 offen offset:3072
    s_mov_b32 s36, 16384
    buffer_load_dwordx4 v[64:67], v254, s[12:15], s36 offen offset:0
    buffer_load_dwordx4 v[68:71], v254, s[12:15], s36 offen offset:1024
    buffer_load_dwordx4 v[72:75], v254, s[12:15], s36 offen offset:2048
    buffer_load_dwordx4 v[76:79], v254, s[12:15], s36 offen offset:3072
    s_mov_b32 s36, 20480
    buffer_load_dwordx4 v[80:83], v254, s[12:15], s36 offen offset:0
    buffer_load_dwordx4 v[84:87], v254, s[12:15], s36 offen offset:1024
    buffer_load_dwordx4 v[88:91], v254, s[12:15], s36 offen offset:2048
    buffer_load_dwordx4 v[92:95], v254, s[12:15], s36 offen offset:3072
    s_mov_b32 s36, 24576
    buffer_load_dwordx4 v[96:99], v254, s[12:15], s36 offen offset:0
    buffer_load_dwordx4 v[100:103], v254, s[12:15], s36 offen offset:1024
    buffer_load_dwordx4 v[104:107], v254, s[12:15], s36 offen offset:2048
    buffer_load_dwordx4 v[108:111], v254, s[12:15], s36 offen offset:3072
    s_mov_b32 s36, 28672
    buffer_load_dwordx4 v[112:115], v254, s[12:15], s36 offen offset:0
    buffer_load_dwordx4 v[116:119], v254, s[12:15], s36 offen offset:1024
    buffer_load_dwordx4 v[120:123], v254, s[12:15], s36 offen offset:2048
    buffer_load_dwordx4 v[124:127], v254, s[12:15], s36 offen offset:3072
    s_waitcnt lgkmcnt(0)
    s_setprio 0
    s_or_b32 s44, s44, s45
    s_or_b32 s44, s44, s46
    s_or_b32 s44, s44, s47
    s_or_b32 s44, s44, s48
    s_or_b32 s44, s44, s49
    s_or_b32 s44, s44, s50
    s_or_b32 s44, s44, s51
    s_or_b32 s44, s44, s52
    s_or_b32 s44, s44, s53
    s_or_b32 s44, s44, s54
    s_or_b32 s44, s44, s55
    s_or_b32 s44, s44, s56
    s_or_b32 s44, s44, s57
    s_or_b32 s44, s44, s58
    s_or_b32 s44, s44, s59
    s_barrier
    ds_read_b128 v[160:163], v250 offset:49152
    ds_read_b128 v[164:167], v250 offset:49184
    ds_read_b128 v[168:171], v250 offset:49216
    ds_read_b128 v[172:175], v250 offset:49248
    ds_read_b128 v[176:179], v250 offset:49280
    ds_read_b128 v[180:183], v250 offset:49312
    ds_read_b128 v[184:187], v250 offset:49344
    ds_read_b128 v[188:191], v250 offset:49376
    s_waitcnt vmcnt(30) lgkmcnt(7)
    v_mfma_f32_32x32x16_bf16 v[128:143], v[0:3], v[160:163], 0
    v_mfma_f32_32x32x16_bf16 v[144:159], v[4:7], v[160:163], 0
    ds_read_b128 v[160:163], v250 offset:49408
    s_waitcnt vmcnt(28) lgkmcnt(7)
    v_mfma_f32_32x32x16_bf16 v[128:143], v[8:11], v[164:167], v[128:143]
    v_mfma_f32_32x32x16_bf16 v[144:159], v[12:15], v[164:167], v[144:159]
    ds_read_b128 v[164:167], v250 offset:49440
    s_waitcnt vmcnt(26) lgkmcnt(7)
    v_mfma_f32_32x32x16_bf16 v[128:143], v[16:19], v[168:171], v[128:143]
    v_mfma_f32_32x32x16_bf16 v[144:159], v[20:23], v[168:171], v[144:159]
    ds_read_b128 v[168:171], v250 offset:49472
    s_waitcnt vmcnt(24) lgkmcnt(7)
    v_mfma_f32_32x32x16_bf16 v[128:143], v[24:27], v[172:175], v[128:143]
    v_mfma_f32_32x32x16_bf16 v[144:159], v[28:31], v[172:175], v[144:159]
    ds_read_b128 v[172:175], v250 offset:49504
    s_waitcnt vmcnt(22) lgkmcnt(7)
    v_mfma_f32_32x32x16_bf16 v[128:143], v[32:35], v[176:179], v[128:143]
    v_mfma_f32_32x32x16_bf16 v[144:159], v[36:39], v[176:179], v[144:159]
    ds_read_b128 v[176:179], v250 offset:49536
    s_waitcnt vmcnt(20) lgkmcnt(7)
    v_mfma_f32_32x32x16_bf16 v[128:143], v[40:43], v[180:183], v[128:143]
    v_mfma_f32_32x32x16_bf16 v[144:159], v[44:47], v[180:183], v[144:159]
    ds_read_b128 v[180:183], v250 offset:49568
    s_waitcnt vmcnt(18) lgkmcnt(7)
    v_mfma_f32_32x32x16_bf16 v[128:143], v[48:51], v[184:187], v[128:143]
    v_mfma_f32_32x32x16_bf16 v[144:159], v[52:55], v[184:187], v[144:159]
    ds_read_b128 v[184:187], v250 offset:49600
    s_waitcnt vmcnt(16) lgkmcnt(7)
    v_mfma_f32_32x32x16_bf16 v[128:143], v[56:59], v[188:191], v[128:143]
    v_mfma_f32_32x32x16_bf16 v[144:159], v[60:63], v[188:191], v[144:159]
    ds_read_b128 v[188:191], v250 offset:49632
    s_waitcnt vmcnt(14) lgkmcnt(7)
    v_mfma_f32_32x32x16_bf16 v[128:143], v[64:67], v[160:163], v[128:143]
    v_mfma_f32_32x32x16_bf16 v[144:159], v[68:71], v[160:163], v[144:159]
    s_waitcnt vmcnt(12) lgkmcnt(6)
    v_mfma_f32_32x32x16_bf16 v[128:143], v[72:75], v[164:167], v[128:143]
    v_mfma_f32_32x32x16_bf16 v[144:159], v[76:79], v[164:167], v[144:159]
    s_waitcnt vmcnt(10) lgkmcnt(5)
    v_mfma_f32_32x32x16_bf16 v[128:143], v[80:83], v[168:171], v[128:143]
    v_mfma_f32_32x32x16_bf16 v[144:159], v[84:87], v[168:171], v[144:159]
    s_waitcnt vmcnt(8) lgkmcnt(4)
    v_mfma_f32_32x32x16_bf16 v[128:143], v[88:91], v[172:175], v[128:143]
    v_mfma_f32_32x32x16_bf16 v[144:159], v[92:95], v[172:175], v[144:159]
    s_waitcnt vmcnt(6) lgkmcnt(3)
    v_mfma_f32_32x32x16_bf16 v[128:143], v[96:99], v[176:179], v[128:143]
    v_mfma_f32_32x32x16_bf16 v[144:159], v[100:103], v[176:179], v[144:159]
    s_waitcnt vmcnt(4) lgkmcnt(2)
    v_mfma_f32_32x32x16_bf16 v[128:143], v[104:107], v[180:183], v[128:143]
    v_mfma_f32_32x32x16_bf16 v[144:159], v[108:111], v[180:183], v[144:159]
    s_waitcnt vmcnt(2) lgkmcnt(1)
    v_mfma_f32_32x32x16_bf16 v[128:143], v[112:115], v[184:187], v[128:143]
    v_mfma_f32_32x32x16_bf16 v[144:159], v[116:119], v[184:187], v[144:159]
    s_waitcnt vmcnt(0) lgkmcnt(0)
    v_mfma_f32_32x32x16_bf16 v[128:143], v[120:123], v[188:191], v[128:143]
    v_mfma_f32_32x32x16_bf16 v[144:159], v[124:127], v[188:191], v[144:159]
    s_mov_b32 s46, 0xffff0000
    s_mov_b32 s45, 0x4038aa3b
    s_nop 10
    v_cvt_pk_bf16_f32 v224, v128, v144
    v_cvt_pk_bf16_f32 v225, v129, v145
    v_cvt_pk_bf16_f32 v226, v130, v146
    v_cvt_pk_bf16_f32 v227, v131, v147
    v_cvt_pk_bf16_f32 v228, v132, v148
    v_cvt_pk_bf16_f32 v229, v133, v149
    v_cvt_pk_bf16_f32 v230, v134, v150
    v_cvt_pk_bf16_f32 v231, v135, v151
    v_cvt_pk_bf16_f32 v232, v136, v152
    v_cvt_pk_bf16_f32 v233, v137, v153
    v_cvt_pk_bf16_f32 v234, v138, v154
    v_cvt_pk_bf16_f32 v235, v139, v155
    v_cvt_pk_bf16_f32 v236, v140, v156
    v_cvt_pk_bf16_f32 v237, v141, v157
    v_cvt_pk_bf16_f32 v238, v142, v158
    v_cvt_pk_bf16_f32 v239, v143, v159
    v_lshlrev_b32 v0, 16, v224
    v_and_b32 v1, s46, v224
    v_lshlrev_b32 v2, 16, v225
    v_and_b32 v3, s46, v225
    v_lshlrev_b32 v4, 16, v226
    v_and_b32 v5, s46, v226
    v_lshlrev_b32 v6, 16, v227
    v_and_b32 v7, s46, v227
    v_lshlrev_b32 v8, 16, v228
    v_and_b32 v9, s46, v228
    v_lshlrev_b32 v10, 16, v229
    v_and_b32 v11, s46, v229
    v_lshlrev_b32 v12, 16, v230
    v_and_b32 v13, s46, v230
    v_lshlrev_b32 v14, 16, v231
    v_and_b32 v15, s46, v231
    v_lshlrev_b32 v16, 16, v232
    v_and_b32 v17, s46, v232
    v_lshlrev_b32 v18, 16, v233
    v_and_b32 v19, s46, v233
    v_lshlrev_b32 v20, 16, v234
    v_and_b32 v21, s46, v234
    v_lshlrev_b32 v22, 16, v235
    v_and_b32 v23, s46, v235
    v_lshlrev_b32 v24, 16, v236
    v_and_b32 v25, s46, v236
    v_lshlrev_b32 v26, 16, v237
    v_and_b32 v27, s46, v237
    v_lshlrev_b32 v28, 16, v238
    v_and_b32 v29, s46, v238
    v_lshlrev_b32 v30, 16, v239
    v_and_b32 v31, s46, v239
    v_mul_f32 v0, s45, v0
    v_mul_f32 v1, s45, v1
    v_mul_f32 v2, s45, v2
    v_mul_f32 v3, s45, v3
    v_mul_f32 v4, s45, v4
    v_mul_f32 v5, s45, v5
    v_mul_f32 v6, s45, v6
    v_mul_f32 v7, s45, v7
    v_mul_f32 v8, s45, v8
    v_mul_f32 v9, s45, v9
    v_mul_f32 v10, s45, v10
    v_mul_f32 v11, s45, v11
    v_mul_f32 v12, s45, v12
    v_mul_f32 v13, s45, v13
    v_mul_f32 v14, s45, v14
    v_mul_f32 v15, s45, v15
    v_mul_f32 v16, s45, v16
    v_mul_f32 v17, s45, v17
    v_mul_f32 v18, s45, v18
    v_mul_f32 v19, s45, v19
    v_mul_f32 v20, s45, v20
    v_mul_f32 v21, s45, v21
    v_mul_f32 v22, s45, v22
    v_mul_f32 v23, s45, v23
    v_mul_f32 v24, s45, v24
    v_mul_f32 v25, s45, v25
    v_mul_f32 v26, s45, v26
    v_mul_f32 v27, s45, v27
    v_mul_f32 v28, s45, v28
    v_mul_f32 v29, s45, v29
    v_mul_f32 v30, s45, v30
    v_mul_f32 v31, s45, v31
    v_max_f32 v64, |v0|, |v1|
    v_max3_f32 v64, |v2|, |v3|, v64
    v_max3_f32 v64, |v4|, |v5|, v64
    v_max3_f32 v64, |v6|, |v7|, v64
    v_max3_f32 v64, |v8|, |v9|, v64
    v_max3_f32 v64, |v10|, |v11|, v64
    v_max3_f32 v64, |v12|, |v13|, v64
    v_max3_f32 v64, |v14|, |v15|, v64
    v_max3_f32 v64, |v16|, |v17|, v64
    v_max3_f32 v64, |v18|, |v19|, v64
    v_max3_f32 v64, |v20|, |v21|, v64
    v_max3_f32 v64, |v22|, |v23|, v64
    v_max3_f32 v64, |v24|, |v25|, v64
    v_max3_f32 v64, |v26|, |v27|, v64
    v_max3_f32 v64, |v28|, |v29|, v64
    v_max3_f32 v64, |v30|, |v31|, v64
    v_cmp_lt_f32 vcc, 0x42f00000, v64
    s_mov_b32 s22, 4
    s_or_b32 s44, s44, vcc_lo
    s_or_b32 s44, s44, vcc_hi
    s_cmp_lg_u32 s44, 0
    s_cbranch_scc1 L_joint_kernel_tslow
    ds_read_b128 v[192:195], v249 offset:40960
    ds_read_b128 v[196:199], v249 offset:40976
    ds_read_b128 v[200:203], v249 offset:41024
    ds_read_b128 v[204:207], v249 offset:41040
    ds_read_b128 v[208:211], v249 offset:41088
    ds_read_b128 v[212:215], v249 offset:41104
    ds_read_b128 v[216:219], v249 offset:41152
    ds_read_b128 v[220:223], v249 offset:41168
    v_add_u32 v249, 1024, v249
    v_exp_f32 v0, v0
    v_exp_f32 v1, v1
    v_exp_f32 v2, v2
    v_exp_f32 v3, v3
    v_exp_f32 v4, v4
    v_exp_f32 v5, v5
    v_exp_f32 v6, v6
    v_exp_f32 v7, v7
    v_exp_f32 v8, v8
    v_exp_f32 v9, v9
    v_exp_f32 v10, v10
    v_exp_f32 v11, v11
    v_exp_f32 v12, v12
    v_exp_f32 v13, v13
    v_exp_f32 v14, v14
    v_exp_f32 v15, v15
    v_exp_f32 v16, v16
    v_exp_f32 v17, v17
    v_exp_f32 v18, v18
    v_exp_f32 v19, v19
    v_exp_f32 v20, v20
    v_exp_f32 v21, v21
    v_exp_f32 v22, v22
    v_exp_f32 v23, v23
    v_exp_f32 v24, v24
    v_exp_f32 v25, v25
    v_exp_f32 v26, v26
    v_exp_f32 v27, v27
    v_exp_f32 v28, v28
    v_exp_f32 v29, v29
    v_exp_f32 v30, v30
    v_exp_f32 v31, v31
    s_waitcnt lgkmcnt(0)
L_joint_kernel_tloop1:
    v_fma_f32 v32, v192, v0, 1.0
    v_fma_f32 v33, v193, v1, 1.0
    v_fma_f32 v34, v194, v2, 1.0
    v_fma_f32 v35, v195, v3, 1.0
    v_fma_f32 v36, v196, v4, 1.0
    v_fma_f32 v37, v197, v5, 1.0
    v_fma_f32 v38, v198, v6, 1.0
    v_fma_f32 v39, v199, v7, 1.0
    v_rcp_f32 v32, v32
    v_rcp_f32 v33, v33
    v_rcp_f32 v34, v34
    v_rcp_f32 v35, v35
    v_rcp_f32 v36, v36
    v_rcp_f32 v37, v37
    v_rcp_f32 v38, v38
    v_rcp_f32 v39, v39
    v_fma_f32 v32, v32, -2.0, 1.0
    v_fma_f32 v33, v33, -2.0, 1.0
    v_fma_f32 v34, v34, -2.0, 1.0
    v_fma_f32 v35, v35, -2.0, 1.0
    v_fma_f32 v36, v36, -2.0, 1.0
    v_fma_f32 v37, v37, -2.0, 1.0
    v_fma_f32 v38, v38, -2.0, 1.0
    v_fma_f32 v39, v39, -2.0, 1.0
    v_cvt_pk_bf16_f32 v224, v32, v33
    v_cvt_pk_bf16_f32 v225, v34, v35
    v_cvt_pk_bf16_f32 v226, v36, v37
    v_cvt_pk_bf16_f32 v227, v38, v39
    ds_write_b128 v248, v[224:227] offset:0
    v_fma_f32 v40, v200, v8, 1.0
    v_fma_f32 v41, v201, v9, 1.0
    v_fma_f32 v42, v202, v10, 1.0
    v_fma_f32 v43, v203, v11, 1.0
    v_fma_f32 v44, v204, v12, 1.0
    v_fma_f32 v45, v205, v13, 1.0
    v_fma_f32 v46, v206, v14, 1.0
    v_fma_f32 v47, v207, v15, 1.0
    v_rcp_f32 v40, v40
    v_rcp_f32 v41, v41
    v_rcp_f32 v42, v42
    v_rcp_f32 v43, v43
    v_rcp_f32 v44, v44
    v_rcp_f32 v45, v45
    v_rcp_f32 v46, v46
    v_rcp_f32 v47, v47
    v_fma_f32 v40, v40, -2.0, 1.0
    v_fma_f32 v41, v41, -2.0, 1.0
    v_fma_f32 v42, v42, -2.0, 1.0
    v_fma_f32 v43, v43, -2.0, 1.0
    v_fma_f32 v44, v44, -2.0, 1.0
    v_fma_f32 v45, v45, -2.0, 1.0
    v_fma_f32 v46, v46, -2.0, 1.0
    v_fma_f32 v47, v47, -2.0, 1.0
    v_cvt_pk_bf16_f32 v228, v40, v41
    v_cvt_pk_bf16_f32 v229, v42, v43
    v_cvt_pk_bf16_f32 v230, v44, v45
    v_cvt_pk_bf16_f32 v231, v46, v47
    ds_write_b128 v248, v[228:231] offset:1024
    v_fma_f32 v48, v208, v16, 1.0
    v_fma_f32 v49, v209, v17, 1.0
    v_fma_f32 v50, v210, v18, 1.0
    v_fma_f32 v51, v211, v19, 1.0
    v_fma_f32 v52, v212, v20, 1.0
    v_fma_f32 v53, v213, v21, 1.0
    v_fma_f32 v54, v214, v22, 1.0
    v_fma_f32 v55, v215, v23, 1.0
    v_rcp_f32 v48, v48
    v_rcp_f32 v49, v49
    v_rcp_f32 v50, v50
    v_rcp_f32 v51, v51
    v_rcp_f32 v52, v52
    v_rcp_f32 v53, v53
    v_rcp_f32 v54, v54
    v_rcp_f32 v55, v55
    v_fma_f32 v48, v48, -2.0, 1.0
    v_fma_f32 v49, v49, -2.0, 1.0
    v_fma_f32 v50, v50, -2.0, 1.0
    v_fma_f32 v51, v51, -2.0, 1.0
    v_fma_f32 v52, v52, -2.0, 1.0
    v_fma_f32 v53, v53, -2.0, 1.0
    v_fma_f32 v54, v54, -2.0, 1.0
    v_fma_f32 v55, v55, -2.0, 1.0
    v_cvt_pk_bf16_f32 v232, v48, v49
    v_cvt_pk_bf16_f32 v233, v50, v51
    v_cvt_pk_bf16_f32 v234, v52, v53
    v_cvt_pk_bf16_f32 v235, v54, v55
    ds_write_b128 v248, v[232:235] offset:2048
    v_fma_f32 v56, v216, v24, 1.0
    v_fma_f32 v57, v217, v25, 1.0
    v_fma_f32 v58, v218, v26, 1.0
    v_fma_f32 v59, v219, v27, 1.0
    v_fma_f32 v60, v220, v28, 1.0
    v_fma_f32 v61, v221, v29, 1.0
    v_fma_f32 v62, v222, v30, 1.0
    v_fma_f32 v63, v223, v31, 1.0
    ds_read_b128 v[192:195], v249 offset:40960
    ds_read_b128 v[196:199], v249 offset:40976
    ds_read_b128 v[200:203], v249 offset:41024
    ds_read_b128 v[204:207], v249 offset:41040
    ds_read_b128 v[208:211], v249 offset:41088
    ds_read_b128 v[212:215], v249 offset:41104
    ds_read_b128 v[216:219], v249 offset:41152
    ds_read_b128 v[220:223], v249 offset:41168
    v_add_u32 v249, 1024, v249
    v_rcp_f32 v56, v56
    v_rcp_f32 v57, v57
    v_rcp_f32 v58, v58
    v_rcp_f32 v59, v59
    v_rcp_f32 v60, v60
    v_rcp_f32 v61, v61
    v_rcp_f32 v62, v62
    v_rcp_f32 v63, v63
    v_fma_f32 v56, v56, -2.0, 1.0
    v_fma_f32 v57, v57, -2.0, 1.0
    v_fma_f32 v58, v58, -2.0, 1.0
    v_fma_f32 v59, v59, -2.0, 1.0
    v_fma_f32 v60, v60, -2.0, 1.0
    v_fma_f32 v61, v61, -2.0, 1.0
    v_fma_f32 v62, v62, -2.0, 1.0
    v_fma_f32 v63, v63, -2.0, 1.0
    v_cvt_pk_bf16_f32 v236, v56, v57
    v_cvt_pk_bf16_f32 v237, v58, v59
    v_cvt_pk_bf16_f32 v238, v60, v61
    v_cvt_pk_bf16_f32 v239, v62, v63
    ds_write_b128 v248, v[236:239] offset:3072
    s_waitcnt lgkmcnt(0)
    s_barrier
    v_fma_f32 v32, v192, v0, 1.0
    v_fma_f32 v33, v193, v1, 1.0
    v_fma_f32 v34, v194, v2, 1.0
    v_fma_f32 v35, v195, v3, 1.0
    v_fma_f32 v36, v196, v4, 1.0
    v_fma_f32 v37, v197, v5, 1.0
    v_fma_f32 v38, v198, v6, 1.0
    v_fma_f32 v39, v199, v7, 1.0
    v_rcp_f32 v32, v32
    v_rcp_f32 v33, v33
    v_rcp_f32 v34, v34
    v_rcp_f32 v35, v35
    v_rcp_f32 v36, v36
    v_rcp_f32 v37, v37
    v_rcp_f32 v38, v38
    v_rcp_f32 v39, v39
    v_fma_f32 v32, v32, -2.0, 1.0
    v_fma_f32 v33, v33, -2.0, 1.0
    v_fma_f32 v34, v34, -2.0, 1.0
    v_fma_f32 v35, v35, -2.0, 1.0
    v_fma_f32 v36, v36, -2.0, 1.0
    v_fma_f32 v37, v37, -2.0, 1.0
    v_fma_f32 v38, v38, -2.0, 1.0
    v_fma_f32 v39, v39, -2.0, 1.0
    v_cvt_pk_bf16_f32 v224, v32, v33
    v_cvt_pk_bf16_f32 v225, v34, v35
    v_cvt_pk_bf16_f32 v226, v36, v37
    v_cvt_pk_bf16_f32 v227, v38, v39
    ds_write_b128 v248, v[224:227] offset:16384
    v_fma_f32 v40, v200, v8, 1.0
    v_fma_f32 v41, v201, v9, 1.0
    v_fma_f32 v42, v202, v10, 1.0
    v_fma_f32 v43, v203, v11, 1.0
    v_fma_f32 v44, v204, v12, 1.0
    v_fma_f32 v45, v205, v13, 1.0
    v_fma_f32 v46, v206, v14, 1.0
    v_fma_f32 v47, v207, v15, 1.0
    v_rcp_f32 v40, v40
    v_rcp_f32 v41, v41
    v_rcp_f32 v42, v42
    v_rcp_f32 v43, v43
    v_rcp_f32 v44, v44
    v_rcp_f32 v45, v45
    v_rcp_f32 v46, v46
    v_rcp_f32 v47, v47
    v_fma_f32 v40, v40, -2.0, 1.0
    v_fma_f32 v41, v41, -2.0, 1.0
    v_fma_f32 v42, v42, -2.0, 1.0
    v_fma_f32 v43, v43, -2.0, 1.0
    v_fma_f32 v44, v44, -2.0, 1.0
    v_fma_f32 v45, v45, -2.0, 1.0
    v_fma_f32 v46, v46, -2.0, 1.0
    v_fma_f32 v47, v47, -2.0, 1.0
    v_cvt_pk_bf16_f32 v228, v40, v41
    v_cvt_pk_bf16_f32 v229, v42, v43
    v_cvt_pk_bf16_f32 v230, v44, v45
    v_cvt_pk_bf16_f32 v231, v46, v47
    ds_write_b128 v248, v[228:231] offset:17408
    v_fma_f32 v48, v208, v16, 1.0
    v_fma_f32 v49, v209, v17, 1.0
    v_fma_f32 v50, v210, v18, 1.0
    v_fma_f32 v51, v211, v19, 1.0
    v_fma_f32 v52, v212, v20, 1.0
    v_fma_f32 v53, v213, v21, 1.0
    v_fma_f32 v54, v214, v22, 1.0
    v_fma_f32 v55, v215, v23, 1.0
    v_rcp_f32 v48, v48
    v_rcp_f32 v49, v49
    v_rcp_f32 v50, v50
    v_rcp_f32 v51, v51
    v_rcp_f32 v52, v52
    v_rcp_f32 v53, v53
    v_rcp_f32 v54, v54
    v_rcp_f32 v55, v55
    v_fma_f32 v48, v48, -2.0, 1.0
    v_fma_f32 v49, v49, -2.0, 1.0
    v_fma_f32 v50, v50, -2.0, 1.0
    v_fma_f32 v51, v51, -2.0, 1.0
    v_fma_f32 v52, v52, -2.0, 1.0
    v_fma_f32 v53, v53, -2.0, 1.0
    v_fma_f32 v54, v54, -2.0, 1.0
    v_fma_f32 v55, v55, -2.0, 1.0
    v_cvt_pk_bf16_f32 v232, v48, v49
    v_cvt_pk_bf16_f32 v233, v50, v51
    v_cvt_pk_bf16_f32 v234, v52, v53
    v_cvt_pk_bf16_f32 v235, v54, v55
    ds_write_b128 v248, v[232:235] offset:18432
    v_fma_f32 v56, v216, v24, 1.0
    v_fma_f32 v57, v217, v25, 1.0
    v_fma_f32 v58, v218, v26, 1.0
    v_fma_f32 v59, v219, v27, 1.0
    v_fma_f32 v60, v220, v28, 1.0
    v_fma_f32 v61, v221, v29, 1.0
    v_fma_f32 v62, v222, v30, 1.0
    v_fma_f32 v63, v223, v31, 1.0
    ds_read_b128 v[192:195], v249 offset:40960
    ds_read_b128 v[196:199], v249 offset:40976
    ds_read_b128 v[200:203], v249 offset:41024
    ds_read_b128 v[204:207], v249 offset:41040
    ds_read_b128 v[208:211], v249 offset:41088
    ds_read_b128 v[212:215], v249 offset:41104
    ds_read_b128 v[216:219], v249 offset:41152
    ds_read_b128 v[220:223], v249 offset:41168
    v_add_u32 v249, 1024, v249
    v_rcp_f32 v56, v56
    v_rcp_f32 v57, v57
    v_rcp_f32 v58, v58
    v_rcp_f32 v59, v59
    v_rcp_f32 v60, v60
    v_rcp_f32 v61, v61
    v_rcp_f32 v62, v62
    v_rcp_f32 v63, v63
    v_fma_f32 v56, v56, -2.0, 1.0
    v_fma_f32 v57, v57, -2.0, 1.0
    v_fma_f32 v58, v58, -2.0, 1.0
    v_fma_f32 v59, v59, -2.0, 1.0
    v_fma_f32 v60, v60, -2.0, 1.0
    v_fma_f32 v61, v61, -2.0, 1.0
    v_fma_f32 v62, v62, -2.0, 1.0
    v_fma_f32 v63, v63, -2.0, 1.0
    v_cvt_pk_bf16_f32 v236, v56, v57
    v_cvt_pk_bf16_f32 v237, v58, v59
    v_cvt_pk_bf16_f32 v238, v60, v61
    v_cvt_pk_bf16_f32 v239, v62, v63
    ds_write_b128 v248, v[236:239] offset:19456
    s_waitcnt lgkmcnt(0)
    s_barrier
    s_sub_u32 s22, s22, 1
    s_cmp_lg_u32 s22, 0
    s_cbranch_scc1 L_joint_kernel_tloop1
    s_branch L_joint_kernel_fin
L_joint_kernel_tslow:
    ds_read_b128 v[192:195], v249 offset:32768
    ds_read_b128 v[196:199], v249 offset:32784
    ds_read_b128 v[200:203], v249 offset:32832
    ds_read_b128 v[204:207], v249 offset:32848
    ds_read_b128 v[208:211], v249 offset:32896
    ds_read_b128 v[212:215], v249 offset:32912
    ds_read_b128 v[216:219], v249 offset:32960
    ds_read_b128 v[220:223], v249 offset:32976
    v_add_u32 v249, 1024, v249
    s_waitcnt lgkmcnt(0)
L_joint_kernel_tloop0:
    v_add_f32 v32, v192, v0
    v_add_f32 v33, v193, v1
    v_add_f32 v34, v194, v2
    v_add_f32 v35, v195, v3
    v_add_f32 v36, v196, v4
    v_add_f32 v37, v197, v5
    v_add_f32 v38, v198, v6
    v_add_f32 v39, v199, v7
    v_exp_f32 v32, v32
    v_exp_f32 v33, v33
    v_exp_f32 v34, v34
    v_exp_f32 v35, v35
    v_exp_f32 v36, v36
    v_exp_f32 v37, v37
    v_exp_f32 v38, v38
    v_exp_f32 v39, v39
    v_add_f32 v32, 1.0, v32
    v_add_f32 v33, 1.0, v33
    v_add_f32 v34, 1.0, v34
    v_add_f32 v35, 1.0, v35
    v_add_f32 v36, 1.0, v36
    v_add_f32 v37, 1.0, v37
    v_add_f32 v38, 1.0, v38
    v_add_f32 v39, 1.0, v39
    v_rcp_f32 v32, v32
    v_rcp_f32 v33, v33
    v_rcp_f32 v34, v34
    v_rcp_f32 v35, v35
    v_rcp_f32 v36, v36
    v_rcp_f32 v37, v37
    v_rcp_f32 v38, v38
    v_rcp_f32 v39, v39
    v_fma_f32 v32, v32, -2.0, 1.0
    v_fma_f32 v33, v33, -2.0, 1.0
    v_fma_f32 v34, v34, -2.0, 1.0
    v_fma_f32 v35, v35, -2.0, 1.0
    v_fma_f32 v36, v36, -2.0, 1.0
    v_fma_f32 v37, v37, -2.0, 1.0
    v_fma_f32 v38, v38, -2.0, 1.0
    v_fma_f32 v39, v39, -2.0, 1.0
    v_cvt_pk_bf16_f32 v224, v32, v33
    v_cvt_pk_bf16_f32 v225, v34, v35
    v_cvt_pk_bf16_f32 v226, v36, v37
    v_cvt_pk_bf16_f32 v227, v38, v39
    ds_write_b128 v248, v[224:227] offset:0
    v_add_f32 v40, v200, v8
    v_add_f32 v41, v201, v9
    v_add_f32 v42, v202, v10
    v_add_f32 v43, v203, v11
    v_add_f32 v44, v204, v12
    v_add_f32 v45, v205, v13
    v_add_f32 v46, v206, v14
    v_add_f32 v47, v207, v15
    v_exp_f32 v40, v40
    v_exp_f32 v41, v41
    v_exp_f32 v42, v42
    v_exp_f32 v43, v43
    v_exp_f32 v44, v44
    v_exp_f32 v45, v45
    v_exp_f32 v46, v46
    v_exp_f32 v47, v47
    v_add_f32 v40, 1.0, v40
    v_add_f32 v41, 1.0, v41
    v_add_f32 v42, 1.0, v42
    v_add_f32 v43, 1.0, v43
    v_add_f32 v44, 1.0, v44
    v_add_f32 v45, 1.0, v45
    v_add_f32 v46, 1.0, v46
    v_add_f32 v47, 1.0, v47
    v_rcp_f32 v40, v40
    v_rcp_f32 v41, v41
    v_rcp_f32 v42, v42
    v_rcp_f32 v43, v43
    v_rcp_f32 v44, v44
    v_rcp_f32 v45, v45
    v_rcp_f32 v46, v46
    v_rcp_f32 v47, v47
    v_fma_f32 v40, v40, -2.0, 1.0
    v_fma_f32 v41, v41, -2.0, 1.0
    v_fma_f32 v42, v42, -2.0, 1.0
    v_fma_f32 v43, v43, -2.0, 1.0
    v_fma_f32 v44, v44, -2.0, 1.0
    v_fma_f32 v45, v45, -2.0, 1.0
    v_fma_f32 v46, v46, -2.0, 1.0
    v_fma_f32 v47, v47, -2.0, 1.0
    v_cvt_pk_bf16_f32 v228, v40, v41
    v_cvt_pk_bf16_f32 v229, v42, v43
    v_cvt_pk_bf16_f32 v230, v44, v45
    v_cvt_pk_bf16_f32 v231, v46, v47
    ds_write_b128 v248, v[228:231] offset:1024
    v_add_f32 v48, v208, v16
    v_add_f32 v49, v209, v17
    v_add_f32 v50, v210, v18
    v_add_f32 v51, v211, v19
    v_add_f32 v52, v212, v20
    v_add_f32 v53, v213, v21
    v_add_f32 v54, v214, v22
    v_add_f32 v55, v215, v23
    v_exp_f32 v48, v48
    v_exp_f32 v49, v49
    v_exp_f32 v50, v50
    v_exp_f32 v51, v51
    v_exp_f32 v52, v52
    v_exp_f32 v53, v53
    v_exp_f32 v54, v54
    v_exp_f32 v55, v55
    v_add_f32 v48, 1.0, v48
    v_add_f32 v49, 1.0, v49
    v_add_f32 v50, 1.0, v50
    v_add_f32 v51, 1.0, v51
    v_add_f32 v52, 1.0, v52
    v_add_f32 v53, 1.0, v53
    v_add_f32 v54, 1.0, v54
    v_add_f32 v55, 1.0, v55
    v_rcp_f32 v48, v48
    v_rcp_f32 v49, v49
    v_rcp_f32 v50, v50
    v_rcp_f32 v51, v51
    v_rcp_f32 v52, v52
    v_rcp_f32 v53, v53
    v_rcp_f32 v54, v54
    v_rcp_f32 v55, v55
    v_fma_f32 v48, v48, -2.0, 1.0
    v_fma_f32 v49, v49, -2.0, 1.0
    v_fma_f32 v50, v50, -2.0, 1.0
    v_fma_f32 v51, v51, -2.0, 1.0
    v_fma_f32 v52, v52, -2.0, 1.0
    v_fma_f32 v53, v53, -2.0, 1.0
    v_fma_f32 v54, v54, -2.0, 1.0
    v_fma_f32 v55, v55, -2.0, 1.0
    v_cvt_pk_bf16_f32 v232, v48, v49
    v_cvt_pk_bf16_f32 v233, v50, v51
    v_cvt_pk_bf16_f32 v234, v52, v53
    v_cvt_pk_bf16_f32 v235, v54, v55
    ds_write_b128 v248, v[232:235] offset:2048
    v_add_f32 v56, v216, v24
    v_add_f32 v57, v217, v25
    v_add_f32 v58, v218, v26
    v_add_f32 v59, v219, v27
    v_add_f32 v60, v220, v28
    v_add_f32 v61, v221, v29
    v_add_f32 v62, v222, v30
    v_add_f32 v63, v223, v31
    ds_read_b128 v[192:195], v249 offset:32768
    ds_read_b128 v[196:199], v249 offset:32784
    ds_read_b128 v[200:203], v249 offset:32832
    ds_read_b128 v[204:207], v249 offset:32848
    ds_read_b128 v[208:211], v249 offset:32896
    ds_read_b128 v[212:215], v249 offset:32912
    ds_read_b128 v[216:219], v249 offset:32960
    ds_read_b128 v[220:223], v249 offset:32976
    v_add_u32 v249, 1024, v249
    v_exp_f32 v56, v56
    v_exp_f32 v57, v57
    v_exp_f32 v58, v58
    v_exp_f32 v59, v59
    v_exp_f32 v60, v60
    v_exp_f32 v61, v61
    v_exp_f32 v62, v62
    v_exp_f32 v63, v63
    v_add_f32 v56, 1.0, v56
    v_add_f32 v57, 1.0, v57
    v_add_f32 v58, 1.0, v58
    v_add_f32 v59, 1.0, v59
    v_add_f32 v60, 1.0, v60
    v_add_f32 v61, 1.0, v61
    v_add_f32 v62, 1.0, v62
    v_add_f32 v63, 1.0, v63
    v_rcp_f32 v56, v56
    v_rcp_f32 v57, v57
    v_rcp_f32 v58, v58
    v_rcp_f32 v59, v59
    v_rcp_f32 v60, v60
    v_rcp_f32 v61, v61
    v_rcp_f32 v62, v62
    v_rcp_f32 v63, v63
    v_fma_f32 v56, v56, -2.0, 1.0
    v_fma_f32 v57, v57, -2.0, 1.0
    v_fma_f32 v58, v58, -2.0, 1.0
    v_fma_f32 v59, v59, -2.0, 1.0
    v_fma_f32 v60, v60, -2.0, 1.0
    v_fma_f32 v61, v61, -2.0, 1.0
    v_fma_f32 v62, v62, -2.0, 1.0
    v_fma_f32 v63, v63, -2.0, 1.0
    v_cvt_pk_bf16_f32 v236, v56, v57
    v_cvt_pk_bf16_f32 v237, v58, v59
    v_cvt_pk_bf16_f32 v238, v60, v61
    v_cvt_pk_bf16_f32 v239, v62, v63
    ds_write_b128 v248, v[236:239] offset:3072
    s_waitcnt lgkmcnt(0)
    s_barrier
    v_add_f32 v32, v192, v0
    v_add_f32 v33, v193, v1
    v_add_f32 v34, v194, v2
    v_add_f32 v35, v195, v3
    v_add_f32 v36, v196, v4
    v_add_f32 v37, v197, v5
    v_add_f32 v38, v198, v6
    v_add_f32 v39, v199, v7
    v_exp_f32 v32, v32
    v_exp_f32 v33, v33
    v_exp_f32 v34, v34
    v_exp_f32 v35, v35
    v_exp_f32 v36, v36
    v_exp_f32 v37, v37
    v_exp_f32 v38, v38
    v_exp_f32 v39, v39
    v_add_f32 v32, 1.0, v32
    v_add_f32 v33, 1.0, v33
    v_add_f32 v34, 1.0, v34
    v_add_f32 v35, 1.0, v35
    v_add_f32 v36, 1.0, v36
    v_add_f32 v37, 1.0, v37
    v_add_f32 v38, 1.0, v38
    v_add_f32 v39, 1.0, v39
    v_rcp_f32 v32, v32
    v_rcp_f32 v33, v33
    v_rcp_f32 v34, v34
    v_rcp_f32 v35, v35
    v_rcp_f32 v36, v36
    v_rcp_f32 v37, v37
    v_rcp_f32 v38, v38
    v_rcp_f32 v39, v39
    v_fma_f32 v32, v32, -2.0, 1.0
    v_fma_f32 v33, v33, -2.0, 1.0
    v_fma_f32 v34, v34, -2.0, 1.0
    v_fma_f32 v35, v35, -2.0, 1.0
    v_fma_f32 v36, v36, -2.0, 1.0
    v_fma_f32 v37, v37, -2.0, 1.0
    v_fma_f32 v38, v38, -2.0, 1.0
    v_fma_f32 v39, v39, -2.0, 1.0
    v_cvt_pk_bf16_f32 v224, v32, v33
    v_cvt_pk_bf16_f32 v225, v34, v35
    v_cvt_pk_bf16_f32 v226, v36, v37
    v_cvt_pk_bf16_f32 v227, v38, v39
    ds_write_b128 v248, v[224:227] offset:16384
    v_add_f32 v40, v200, v8
    v_add_f32 v41, v201, v9
    v_add_f32 v42, v202, v10
    v_add_f32 v43, v203, v11
    v_add_f32 v44, v204, v12
    v_add_f32 v45, v205, v13
    v_add_f32 v46, v206, v14
    v_add_f32 v47, v207, v15
    v_exp_f32 v40, v40
    v_exp_f32 v41, v41
    v_exp_f32 v42, v42
    v_exp_f32 v43, v43
    v_exp_f32 v44, v44
    v_exp_f32 v45, v45
    v_exp_f32 v46, v46
    v_exp_f32 v47, v47
    v_add_f32 v40, 1.0, v40
    v_add_f32 v41, 1.0, v41
    v_add_f32 v42, 1.0, v42
    v_add_f32 v43, 1.0, v43
    v_add_f32 v44, 1.0, v44
    v_add_f32 v45, 1.0, v45
    v_add_f32 v46, 1.0, v46
    v_add_f32 v47, 1.0, v47
    v_rcp_f32 v40, v40
    v_rcp_f32 v41, v41
    v_rcp_f32 v42, v42
    v_rcp_f32 v43, v43
    v_rcp_f32 v44, v44
    v_rcp_f32 v45, v45
    v_rcp_f32 v46, v46
    v_rcp_f32 v47, v47
    v_fma_f32 v40, v40, -2.0, 1.0
    v_fma_f32 v41, v41, -2.0, 1.0
    v_fma_f32 v42, v42, -2.0, 1.0
    v_fma_f32 v43, v43, -2.0, 1.0
    v_fma_f32 v44, v44, -2.0, 1.0
    v_fma_f32 v45, v45, -2.0, 1.0
    v_fma_f32 v46, v46, -2.0, 1.0
    v_fma_f32 v47, v47, -2.0, 1.0
    v_cvt_pk_bf16_f32 v228, v40, v41
    v_cvt_pk_bf16_f32 v229, v42, v43
    v_cvt_pk_bf16_f32 v230, v44, v45
    v_cvt_pk_bf16_f32 v231, v46, v47
    ds_write_b128 v248, v[228:231] offset:17408
    v_add_f32 v48, v208, v16
    v_add_f32 v49, v209, v17
    v_add_f32 v50, v210, v18
    v_add_f32 v51, v211, v19
    v_add_f32 v52, v212, v20
    v_add_f32 v53, v213, v21
    v_add_f32 v54, v214, v22
    v_add_f32 v55, v215, v23
    v_exp_f32 v48, v48
    v_exp_f32 v49, v49
    v_exp_f32 v50, v50
    v_exp_f32 v51, v51
    v_exp_f32 v52, v52
    v_exp_f32 v53, v53
    v_exp_f32 v54, v54
    v_exp_f32 v55, v55
    v_add_f32 v48, 1.0, v48
    v_add_f32 v49, 1.0, v49
    v_add_f32 v50, 1.0, v50
    v_add_f32 v51, 1.0, v51
    v_add_f32 v52, 1.0, v52
    v_add_f32 v53, 1.0, v53
    v_add_f32 v54, 1.0, v54
    v_add_f32 v55, 1.0, v55
    v_rcp_f32 v48, v48
    v_rcp_f32 v49, v49
    v_rcp_f32 v50, v50
    v_rcp_f32 v51, v51
    v_rcp_f32 v52, v52
    v_rcp_f32 v53, v53
    v_rcp_f32 v54, v54
    v_rcp_f32 v55, v55
    v_fma_f32 v48, v48, -2.0, 1.0
    v_fma_f32 v49, v49, -2.0, 1.0
    v_fma_f32 v50, v50, -2.0, 1.0
    v_fma_f32 v51, v51, -2.0, 1.0
    v_fma_f32 v52, v52, -2.0, 1.0
    v_fma_f32 v53, v53, -2.0, 1.0
    v_fma_f32 v54, v54, -2.0, 1.0
    v_fma_f32 v55, v55, -2.0, 1.0
    v_cvt_pk_bf16_f32 v232, v48, v49
    v_cvt_pk_bf16_f32 v233, v50, v51
    v_cvt_pk_bf16_f32 v234, v52, v53
    v_cvt_pk_bf16_f32 v235, v54, v55
    ds_write_b128 v248, v[232:235] offset:18432
    v_add_f32 v56, v216, v24
    v_add_f32 v57, v217, v25
    v_add_f32 v58, v218, v26
    v_add_f32 v59, v219, v27
    v_add_f32 v60, v220, v28
    v_add_f32 v61, v221, v29
    v_add_f32 v62, v222, v30
    v_add_f32 v63, v223, v31
    ds_read_b128 v[192:195], v249 offset:32768
    ds_read_b128 v[196:199], v249 offset:32784
    ds_read_b128 v[200:203], v249 offset:32832
    ds_read_b128 v[204:207], v249 offset:32848
    ds_read_b128 v[208:211], v249 offset:32896
    ds_read_b128 v[212:215], v249 offset:32912
    ds_read_b128 v[216:219], v249 offset:32960
    ds_read_b128 v[220:223], v249 offset:32976
    v_add_u32 v249, 1024, v249
    v_exp_f32 v56, v56
    v_exp_f32 v57, v57
    v_exp_f32 v58, v58
    v_exp_f32 v59, v59
    v_exp_f32 v60, v60
    v_exp_f32 v61, v61
    v_exp_f32 v62, v62
    v_exp_f32 v63, v63
    v_add_f32 v56, 1.0, v56
    v_add_f32 v57, 1.0, v57
    v_add_f32 v58, 1.0, v58
    v_add_f32 v59, 1.0, v59
    v_add_f32 v60, 1.0, v60
    v_add_f32 v61, 1.0, v61
    v_add_f32 v62, 1.0, v62
    v_add_f32 v63, 1.0, v63
    v_rcp_f32 v56, v56
    v_rcp_f32 v57, v57
    v_rcp_f32 v58, v58
    v_rcp_f32 v59, v59
    v_rcp_f32 v60, v60
    v_rcp_f32 v61, v61
    v_rcp_f32 v62, v62
    v_rcp_f32 v63, v63
    v_fma_f32 v56, v56, -2.0, 1.0
    v_fma_f32 v57, v57, -2.0, 1.0
    v_fma_f32 v58, v58, -2.0, 1.0
    v_fma_f32 v59, v59, -2.0, 1.0
    v_fma_f32 v60, v60, -2.0, 1.0
    v_fma_f32 v61, v61, -2.0, 1.0
    v_fma_f32 v62, v62, -2.0, 1.0
    v_fma_f32 v63, v63, -2.0, 1.0
    v_cvt_pk_bf16_f32 v236, v56, v57
    v_cvt_pk_bf16_f32 v237, v58, v59
    v_cvt_pk_bf16_f32 v238, v60, v61
    v_cvt_pk_bf16_f32 v239, v62, v63
    ds_write_b128 v248, v[236:239] offset:19456
    s_waitcnt lgkmcnt(0)
    s_barrier
    s_sub_u32 s22, s22, 1
    s_cmp_lg_u32 s22, 0
    s_cbranch_scc1 L_joint_kernel_tloop0
L_joint_kernel_fin:
L_joint_kernel_done:
    s_endpgm
.section .rodata,"a"
.p2align 6
.amdhsa_kernel prep_kernel
  .amdhsa_next_free_vgpr 128
  .amdhsa_next_free_sgpr 102
  .amdhsa_accum_offset 128
  .amdhsa_group_segment_fixed_size 0
  .amdhsa_kernarg_size 80
  .amdhsa_user_sgpr_count 2
  .amdhsa_user_sgpr_kernarg_segment_ptr 1
  .amdhsa_system_sgpr_workgroup_id_x 1
.end_amdhsa_kernel
.p2align 6
.amdhsa_kernel conv1_kernel
  .amdhsa_next_free_vgpr 128
  .amdhsa_next_free_sgpr 102
  .amdhsa_accum_offset 128
  .amdhsa_group_segment_fixed_size 0
  .amdhsa_kernarg_size 80
  .amdhsa_user_sgpr_count 2
  .amdhsa_user_sgpr_kernarg_segment_ptr 1
  .amdhsa_system_sgpr_workgroup_id_x 1
.end_amdhsa_kernel
.p2align 6
.amdhsa_kernel conv2_kernel
  .amdhsa_next_free_vgpr 128
  .amdhsa_next_free_sgpr 102
  .amdhsa_accum_offset 128
  .amdhsa_group_segment_fixed_size 0
  .amdhsa_kernarg_size 80
  .amdhsa_user_sgpr_count 2
  .amdhsa_user_sgpr_kernarg_segment_ptr 1
  .amdhsa_system_sgpr_workgroup_id_x 1
.end_amdhsa_kernel
.p2align 6
.amdhsa_kernel joint_kernel
  .amdhsa_next_free_vgpr 256
  .amdhsa_next_free_sgpr 102
  .amdhsa_accum_offset 256
  .amdhsa_group_segment_fixed_size 0
  .amdhsa_kernarg_size 80
  .amdhsa_user_sgpr_count 2
  .amdhsa_user_sgpr_kernarg_segment_ptr 1
  .amdhsa_system_sgpr_workgroup_id_x 1
.end_amdhsa_kernel
```

```asm
; @launch kernel=prep_kernel grid=(268,1,1) block=(256,1,1) lds=32768
; @launch kernel=conv1_kernel grid=(256,1,1) block=(1024,1,1) lds=162816
; @launch kernel=conv2_kernel grid=(256,1,1) block=(1024,1,1) lds=162816
; @launch kernel=joint_kernel grid=(250,1,1) block=(512,1,1) lds=66048
.amdgcn_target "amdgcn-amd-amdhsa--gfx950"
.text
.globl prep_kernel
.p2align 8
.type prep_kernel,@function
prep_kernel:
    s_cmp_ge_u32 s2, 268
    s_cbranch_scc1 L_prep_kernel_done
    s_getpc_b64 s[62:63]
L_prep_kernel_pc:
    s_and_b32 s3, s2, 8
    s_lshl_b32 s3, s3, 12
    v_lshlrev_b32 v120, 7, v0
    v_add_u32 v120, s3, v120
    v_min_u32 v120, L_joint_kernel_done-L_prep_kernel_pc, v120
    v_mov_b32 v121, s63
    v_add_co_u32 v120, vcc, s62, v120
    v_addc_co_u32 v121, vcc, 0, v121, vcc
    global_load_dword v122, v[120:121], off
    s_cmp_lt_u32 s2, 12
    s_cbranch_scc1 L_prep_kernel_small
    s_sub_u32 s2, s2, 12
    v_readfirstlane_b32 s20, v0
    s_lshr_b32 s20, s20, 6
    s_lshl_b32 s21, s2, 2
    s_add_u32 s20, s20, s21
    v_and_b32 v1, 63, v0
    s_load_dwordx2 s[8:9], s[0:1], 8
    s_load_dwordx2 s[30:31], s[0:1], 72
    s_lshr_b32 s22, s20, 8
    s_bfe_u32 s23, s20, 0x40004
    s_bfe_u32 s24, s20, 0x30001
    s_and_b32 s21, s20, 1
    v_lshrrev_b32 v2, 4, v1
    v_lshlrev_b32 v2, 12, v2
    v_and_b32 v3, 15, v1
    v_lshl_add_u32 v2, v3, 2, v2
    s_lshl_b32 s26, s22, 3
    s_lshr_b32 s27, s23, 3
    s_add_u32 s26, s26, s27
    s_lshl_b32 s26, s26, 17
    s_and_b32 s27, s23, 7
    s_lshl_b32 s27, s27, 14
    s_add_u32 s26, s26, s27
    s_lshl_b32 s27, s24, 6
    s_add_u32 s26, s26, s27
    s_mov_b32 s10, 4063232
    s_mov_b32 s11, 0x00020000
    s_add_u32 s37, s26, 262144
    s_add_u32 s38, s26, 524288
    s_add_u32 s39, s26, 786432
    s_waitcnt lgkmcnt(0)
    buffer_load_dword v16, v2, s[8:11], s26 offen offset:0
    buffer_load_dword v17, v2, s[8:11], s26 offen offset:512
    buffer_load_dword v24, v2, s[8:11], s37 offen offset:0
    buffer_load_dword v25, v2, s[8:11], s37 offen offset:512
    buffer_load_dword v32, v2, s[8:11], s38 offen offset:0
    buffer_load_dword v33, v2, s[8:11], s38 offen offset:512
    buffer_load_dword v40, v2, s[8:11], s39 offen offset:0
    buffer_load_dword v41, v2, s[8:11], s39 offen offset:512
    buffer_load_dword v18, v2, s[8:11], s26 offen offset:1024
    buffer_load_dword v19, v2, s[8:11], s26 offen offset:1536
    buffer_load_dword v26, v2, s[8:11], s37 offen offset:1024
    buffer_load_dword v27, v2, s[8:11], s37 offen offset:1536
    buffer_load_dword v34, v2, s[8:11], s38 offen offset:1024
    buffer_load_dword v35, v2, s[8:11], s38 offen offset:1536
    buffer_load_dword v42, v2, s[8:11], s39 offen offset:1024
    buffer_load_dword v43, v2, s[8:11], s39 offen offset:1536
    buffer_load_dword v20, v2, s[8:11], s26 offen offset:2048
    buffer_load_dword v21, v2, s[8:11], s26 offen offset:2560
    buffer_load_dword v28, v2, s[8:11], s37 offen offset:2048
    buffer_load_dword v29, v2, s[8:11], s37 offen offset:2560
    buffer_load_dword v36, v2, s[8:11], s38 offen offset:2048
    buffer_load_dword v37, v2, s[8:11], s38 offen offset:2560
    buffer_load_dword v44, v2, s[8:11], s39 offen offset:2048
    buffer_load_dword v45, v2, s[8:11], s39 offen offset:2560
    buffer_load_dword v22, v2, s[8:11], s26 offen offset:3072
    buffer_load_dword v23, v2, s[8:11], s26 offen offset:3584
    buffer_load_dword v30, v2, s[8:11], s37 offen offset:3072
    buffer_load_dword v31, v2, s[8:11], s37 offen offset:3584
    buffer_load_dword v38, v2, s[8:11], s38 offen offset:3072
    buffer_load_dword v39, v2, s[8:11], s38 offen offset:3584
    buffer_load_dword v46, v2, s[8:11], s39 offen offset:3072
    buffer_load_dword v47, v2, s[8:11], s39 offen offset:3584
    s_add_u32 s12, s30, 0
    s_addc_u32 s13, s31, 0
    s_mov_b32 s14, 7340032
    s_mov_b32 s15, 0x00020000
    v_lshlrev_b32 v4, 4, v1
    s_lshl_b32 s27, s24, 4
    s_add_u32 s27, s27, s23
    s_mul_i32 s27, s27, 57344
    s_lshl_b32 s28, s22, 11
    s_add_u32 s27, s27, s28
    s_lshl_b32 s28, s21, 10
    s_add_u32 s27, s27, s28
    s_cmp_eq_u32 s21, 0
    s_mov_b32 s32, 0x07060302
    s_cselect_b32 s32, 0x05040100, s32
    s_mov_b32 s33, 0x03020c0c
    s_cselect_b32 s33, 0x01000c0c, s33
    s_mov_b32 s35, 0x3d2aaaab
    s_mov_b32 s36, 0x3c638e39
    s_waitcnt vmcnt(24)
    v_perm_b32 v72, v17, v16, s32
    v_perm_b32 v48, v41, v40, s32
    v_perm_b32 v76, v76, v40, s33
    v_perm_b32 v84, v84, v41, s33
    v_perm_b32 v77, v77, v32, s33
    v_perm_b32 v85, v85, v33, s33
    v_perm_b32 v78, v78, v24, s33
    v_perm_b32 v86, v86, v25, s33
    v_perm_b32 v79, v79, v16, s33
    v_perm_b32 v87, v87, v17, s33
    v_add_f32 v80, v76, v78
    v_add_f32 v88, v84, v86
    v_add_f32 v81, v77, v79
    v_add_f32 v89, v85, v87
    v_fma_f32 v82, v78, 4.0, v76
    v_fma_f32 v90, v86, 4.0, v84
    v_fma_f32 v83, v79, 4.0, v77
    v_fma_f32 v91, v87, 4.0, v85
    v_add_f32 v77, v80, v81
    v_add_f32 v85, v88, v89
    v_sub_f32 v78, v80, v81
    v_sub_f32 v86, v88, v89
    v_fma_f32 v79, v83, 2.0, v82
    v_fma_f32 v87, v91, 2.0, v90
    v_fma_f32 v82, v83, -2.0, v82
    v_fma_f32 v90, v91, -2.0, v90
    v_fmamk_f32 v80, v76, 0x41700000, v82
    v_fmamk_f32 v88, v84, 0x41700000, v90
    v_fmamk_f32 v80, v81, 0x41200000, v80
    v_fmamk_f32 v88, v89, 0x41200000, v88
    v_mul_f32 v77, 0.5, v77
    v_mul_f32 v85, 0.5, v85
    v_mul_f32 v78, 0.5, v78
    v_mul_f32 v86, 0.5, v86
    v_mul_f32 v79, s35, v79
    v_mul_f32 v87, s35, v87
    v_mul_f32 v82, s35, v82
    v_mul_f32 v90, s35, v90
    v_mul_f32 v80, s36, v80
    v_mul_f32 v88, s36, v88
    v_cvt_pk_bf16_f32 v52, v77, v85
    v_cvt_pk_bf16_f32 v56, v78, v86
    v_cvt_pk_bf16_f32 v60, v79, v87
    v_cvt_pk_bf16_f32 v64, v82, v90
    v_cvt_pk_bf16_f32 v68, v80, v88
    s_waitcnt vmcnt(16)
    v_perm_b32 v73, v19, v18, s32
    v_perm_b32 v49, v43, v42, s32
    v_perm_b32 v76, v76, v42, s33
    v_perm_b32 v84, v84, v43, s33
    v_perm_b32 v77, v77, v34, s33
    v_perm_b32 v85, v85, v35, s33
    v_perm_b32 v78, v78, v26, s33
    v_perm_b32 v86, v86, v27, s33
    v_perm_b32 v79, v79, v18, s33
    v_perm_b32 v87, v87, v19, s33
    v_add_f32 v80, v76, v78
    v_add_f32 v88, v84, v86
    v_add_f32 v81, v77, v79
    v_add_f32 v89, v85, v87
    v_fma_f32 v82, v78, 4.0, v76
    v_fma_f32 v90, v86, 4.0, v84
    v_fma_f32 v83, v79, 4.0, v77
    v_fma_f32 v91, v87, 4.0, v85
    v_add_f32 v77, v80, v81
    v_add_f32 v85, v88, v89
    v_sub_f32 v78, v80, v81
    v_sub_f32 v86, v88, v89
    v_fma_f32 v79, v83, 2.0, v82
    v_fma_f32 v87, v91, 2.0, v90
    v_fma_f32 v82, v83, -2.0, v82
    v_fma_f32 v90, v91, -2.0, v90
    v_fmamk_f32 v80, v76, 0x41700000, v82
    v_fmamk_f32 v88, v84, 0x41700000, v90
    v_fmamk_f32 v80, v81, 0x41200000, v80
    v_fmamk_f32 v88, v89, 0x41200000, v88
    v_mul_f32 v77, 0.5, v77
    v_mul_f32 v85, 0.5, v85
    v_mul_f32 v78, 0.5, v78
    v_mul_f32 v86, 0.5, v86
    v_mul_f32 v79, s35, v79
    v_mul_f32 v87, s35, v87
    v_mul_f32 v82, s35, v82
    v_mul_f32 v90, s35, v90
    v_mul_f32 v80, s36, v80
    v_mul_f32 v88, s36, v88
    v_cvt_pk_bf16_f32 v53, v77, v85
    v_cvt_pk_bf16_f32 v57, v78, v86
    v_cvt_pk_bf16_f32 v61, v79, v87
    v_cvt_pk_bf16_f32 v65, v82, v90
    v_cvt_pk_bf16_f32 v69, v80, v88
    s_waitcnt vmcnt(8)
    v_perm_b32 v74, v21, v20, s32
    v_perm_b32 v50, v45, v44, s32
    v_perm_b32 v76, v76, v44, s33
    v_perm_b32 v84, v84, v45, s33
    v_perm_b32 v77, v77, v36, s33
    v_perm_b32 v85, v85, v37, s33
    v_perm_b32 v78, v78, v28, s33
    v_perm_b32 v86, v86, v29, s33
    v_perm_b32 v79, v79, v20, s33
    v_perm_b32 v87, v87, v21, s33
    v_add_f32 v80, v76, v78
    v_add_f32 v88, v84, v86
    v_add_f32 v81, v77, v79
    v_add_f32 v89, v85, v87
    v_fma_f32 v82, v78, 4.0, v76
    v_fma_f32 v90, v86, 4.0, v84
    v_fma_f32 v83, v79, 4.0, v77
    v_fma_f32 v91, v87, 4.0, v85
    v_add_f32 v77, v80, v81
    v_add_f32 v85, v88, v89
    v_sub_f32 v78, v80, v81
    v_sub_f32 v86, v88, v89
    v_fma_f32 v79, v83, 2.0, v82
    v_fma_f32 v87, v91, 2.0, v90
    v_fma_f32 v82, v83, -2.0, v82
    v_fma_f32 v90, v91, -2.0, v90
    v_fmamk_f32 v80, v76, 0x41700000, v82
    v_fmamk_f32 v88, v84, 0x41700000, v90
    v_fmamk_f32 v80, v81, 0x41200000, v80
    v_fmamk_f32 v88, v89, 0x41200000, v88
    v_mul_f32 v77, 0.5, v77
    v_mul_f32 v85, 0.5, v85
    v_mul_f32 v78, 0.5, v78
    v_mul_f32 v86, 0.5, v86
    v_mul_f32 v79, s35, v79
    v_mul_f32 v87, s35, v87
    v_mul_f32 v82, s35, v82
    v_mul_f32 v90, s35, v90
    v_mul_f32 v80, s36, v80
    v_mul_f32 v88, s36, v88
    v_cvt_pk_bf16_f32 v54, v77, v85
    v_cvt_pk_bf16_f32 v58, v78, v86
    v_cvt_pk_bf16_f32 v62, v79, v87
    v_cvt_pk_bf16_f32 v66, v82, v90
    v_cvt_pk_bf16_f32 v70, v80, v88
    s_waitcnt vmcnt(0)
    v_perm_b32 v75, v23, v22, s32
    v_perm_b32 v51, v47, v46, s32
    v_perm_b32 v76, v76, v46, s33
    v_perm_b32 v84, v84, v47, s33
    v_perm_b32 v77, v77, v38, s33
    v_perm_b32 v85, v85, v39, s33
    v_perm_b32 v78, v78, v30, s33
    v_perm_b32 v86, v86, v31, s33
    v_perm_b32 v79, v79, v22, s33
    v_perm_b32 v87, v87, v23, s33
    v_add_f32 v80, v76, v78
    v_add_f32 v88, v84, v86
    v_add_f32 v81, v77, v79
    v_add_f32 v89, v85, v87
    v_fma_f32 v82, v78, 4.0, v76
    v_fma_f32 v90, v86, 4.0, v84
    v_fma_f32 v83, v79, 4.0, v77
    v_fma_f32 v91, v87, 4.0, v85
    v_add_f32 v77, v80, v81
    v_add_f32 v85, v88, v89
    v_sub_f32 v78, v80, v81
    v_sub_f32 v86, v88, v89
    v_fma_f32 v79, v83, 2.0, v82
    v_fma_f32 v87, v91, 2.0, v90
    v_fma_f32 v82, v83, -2.0, v82
    v_fma_f32 v90, v91, -2.0, v90
    v_fmamk_f32 v80, v76, 0x41700000, v82
    v_fmamk_f32 v88, v84, 0x41700000, v90
    v_fmamk_f32 v80, v81, 0x41200000, v80
    v_fmamk_f32 v88, v89, 0x41200000, v88
    v_mul_f32 v77, 0.5, v77
    v_mul_f32 v85, 0.5, v85
    v_mul_f32 v78, 0.5, v78
    v_mul_f32 v86, 0.5, v86
    v_mul_f32 v79, s35, v79
    v_mul_f32 v87, s35, v87
    v_mul_f32 v82, s35, v82
    v_mul_f32 v90, s35, v90
    v_mul_f32 v80, s36, v80
    v_mul_f32 v88, s36, v88
    v_cvt_pk_bf16_f32 v55, v77, v85
    v_cvt_pk_bf16_f32 v59, v78, v86
    v_cvt_pk_bf16_f32 v63, v79, v87
    v_cvt_pk_bf16_f32 v67, v82, v90
    v_cvt_pk_bf16_f32 v71, v80, v88
    s_add_u32 s28, s27, 49152
    buffer_store_dwordx4 v[72:75], v4, s[12:15], s28 offen sc1
    s_add_u32 s28, s27, 0
    buffer_store_dwordx4 v[48:51], v4, s[12:15], s28 offen sc1
    s_add_u32 s28, s27, 8192
    buffer_store_dwordx4 v[52:55], v4, s[12:15], s28 offen sc1
    s_add_u32 s28, s27, 16384
    buffer_store_dwordx4 v[56:59], v4, s[12:15], s28 offen sc1
    s_add_u32 s28, s27, 24576
    buffer_store_dwordx4 v[60:63], v4, s[12:15], s28 offen sc1
    s_add_u32 s28, s27, 32768
    buffer_store_dwordx4 v[64:67], v4, s[12:15], s28 offen sc1
    s_add_u32 s28, s27, 40960
    buffer_store_dwordx4 v[68:71], v4, s[12:15], s28 offen sc1
L_prep_kernel_done:
    s_endpgm
L_prep_kernel_small:
    s_load_dwordx4 s[4:7], s[0:1], 24
    s_load_dwordx4 s[36:39], s[0:1], 40
    s_load_dwordx2 s[30:31], s[0:1], 72
    v_readfirstlane_b32 s20, v0
    s_lshr_b32 s20, s20, 6
    s_lshr_b32 s21, s2, 2
    s_and_b32 s22, s2, 3
    v_and_b32 v1, 63, v0
    v_lshrrev_b32 v2, 5, v1
    v_and_b32 v3, 31, v1
    v_lshlrev_b32 v5, 12, v2
    v_lshl_add_u32 v5, v3, 2, v5
    s_lshl_b32 s23, s20, 15
    s_lshl_b32 s24, s22, 7
    s_add_u32 s23, s23, s24
    s_mov_b32 s32, 0x05040100
    s_mov_b32 s33, 0x07060302
    s_waitcnt lgkmcnt(0)
    s_cmp_eq_u32 s21, 1
    s_cselect_b32 s8, s38, s6
    s_cselect_b32 s9, s39, s7
    s_cmp_eq_u32 s21, 2
    s_cselect_b32 s8, s36, s8
    s_cselect_b32 s9, s37, s9
    s_mov_b32 s10, 131072
    s_mov_b32 s11, 0x00020000
    buffer_load_dword v16, v5, s[8:11], s23 offen offset:0
    buffer_load_dword v17, v5, s[8:11], s23 offen offset:512
    buffer_load_dword v18, v5, s[8:11], s23 offen offset:1024
    buffer_load_dword v19, v5, s[8:11], s23 offen offset:1536
    buffer_load_dword v20, v5, s[8:11], s23 offen offset:2048
    buffer_load_dword v21, v5, s[8:11], s23 offen offset:2560
    buffer_load_dword v22, v5, s[8:11], s23 offen offset:3072
    buffer_load_dword v23, v5, s[8:11], s23 offen offset:3584
    s_add_u32 s23, s23, 8192
    buffer_load_dword v24, v5, s[8:11], s23 offen offset:0
    buffer_load_dword v25, v5, s[8:11], s23 offen offset:512
    buffer_load_dword v26, v5, s[8:11], s23 offen offset:1024
    buffer_load_dword v27, v5, s[8:11], s23 offen offset:1536
    buffer_load_dword v28, v5, s[8:11], s23 offen offset:2048
    buffer_load_dword v29, v5, s[8:11], s23 offen offset:2560
    buffer_load_dword v30, v5, s[8:11], s23 offen offset:3072
    buffer_load_dword v31, v5, s[8:11], s23 offen offset:3584
    s_add_u32 s23, s23, 8192
    buffer_load_dword v32, v5, s[8:11], s23 offen offset:0
    buffer_load_dword v33, v5, s[8:11], s23 offen offset:512
    buffer_load_dword v34, v5, s[8:11], s23 offen offset:1024
    buffer_load_dword v35, v5, s[8:11], s23 offen offset:1536
    buffer_load_dword v36, v5, s[8:11], s23 offen offset:2048
    buffer_load_dword v37, v5, s[8:11], s23 offen offset:2560
    buffer_load_dword v38, v5, s[8:11], s23 offen offset:3072
    buffer_load_dword v39, v5, s[8:11], s23 offen offset:3584
    s_add_u32 s23, s23, 8192
    buffer_load_dword v40, v5, s[8:11], s23 offen offset:0
    buffer_load_dword v41, v5, s[8:11], s23 offen offset:512
    buffer_load_dword v42, v5, s[8:11], s23 offen offset:1024
    buffer_load_dword v43, v5, s[8:11], s23 offen offset:1536
    buffer_load_dword v44, v5, s[8:11], s23 offen offset:2048
    buffer_load_dword v45, v5, s[8:11], s23 offen offset:2560
    buffer_load_dword v46, v5, s[8:11], s23 offen offset:3072
    buffer_load_dword v47, v5, s[8:11], s23 offen offset:3584
    s_mov_b32 s16, s4
    s_mov_b32 s17, s5
    s_mov_b32 s18, 8192
    s_mov_b32 s19, 0x00020000
    v_lshlrev_b32 v6, 9, v3
    v_lshl_add_u32 v6, v2, 4, v6
    s_lshl_b32 s24, s20, 7
    buffer_load_dwordx4 v[80:83], v6, s[16:19], s24 offen offset:0
    buffer_load_dwordx4 v[84:87], v6, s[16:19], s24 offen offset:32
    buffer_load_dwordx4 v[88:91], v6, s[16:19], s24 offen offset:64
    buffer_load_dwordx4 v[92:95], v6, s[16:19], s24 offen offset:96
    s_lshl_b32 s24, s21, 17
    s_add_u32 s24, s24, 44040192
    s_add_u32 s12, s30, s24
    s_addc_u32 s13, s31, 0
    s_mov_b32 s14, 131072
    s_mov_b32 s15, 0x00020000
    s_waitcnt vmcnt(0)
    v_perm_b32 v48, v17, v16, s32
    v_perm_b32 v49, v19, v18, s32
    v_perm_b32 v50, v21, v20, s32
    v_perm_b32 v51, v23, v22, s32
    v_perm_b32 v52, v17, v16, s33
    v_perm_b32 v53, v19, v18, s33
    v_perm_b32 v54, v21, v20, s33
    v_perm_b32 v55, v23, v22, s33
    v_perm_b32 v56, v25, v24, s32
    v_perm_b32 v57, v27, v26, s32
    v_perm_b32 v58, v29, v28, s32
    v_perm_b32 v59, v31, v30, s32
    v_perm_b32 v60, v25, v24, s33
    v_perm_b32 v61, v27, v26, s33
    v_perm_b32 v62, v29, v28, s33
    v_perm_b32 v63, v31, v30, s33
    v_perm_b32 v64, v33, v32, s32
    v_perm_b32 v65, v35, v34, s32
    v_perm_b32 v66, v37, v36, s32
    v_perm_b32 v67, v39, v38, s32
    v_perm_b32 v68, v33, v32, s33
    v_perm_b32 v69, v35, v34, s33
    v_perm_b32 v70, v37, v36, s33
    v_perm_b32 v71, v39, v38, s33
    v_perm_b32 v72, v41, v40, s32
    v_perm_b32 v73, v43, v42, s32
    v_perm_b32 v74, v45, v44, s32
    v_perm_b32 v75, v47, v46, s32
    v_perm_b32 v76, v41, v40, s33
    v_perm_b32 v77, v43, v42, s33
    v_perm_b32 v78, v45, v44, s33
    v_perm_b32 v79, v47, v46, s33
    s_cmp_eq_u32 s21, 2
    s_cbranch_scc1 L_prep_kernel_ge
    v_lshlrev_b32 v4, 4, v1
    s_lshl_b32 s24, s22, 15
    s_lshl_b32 s25, s20, 13
    s_add_u32 s24, s24, s25
    s_add_u32 s25, s24, 4096
    buffer_store_dwordx4 v[48:51], v4, s[12:15], s24 offen offset:0
    buffer_store_dwordx4 v[52:55], v4, s[12:15], s24 offen offset:1024
    buffer_store_dwordx4 v[56:59], v4, s[12:15], s24 offen offset:2048
    buffer_store_dwordx4 v[60:63], v4, s[12:15], s24 offen offset:3072
    buffer_store_dwordx4 v[64:67], v4, s[12:15], s25 offen offset:0
    buffer_store_dwordx4 v[68:71], v4, s[12:15], s25 offen offset:1024
    buffer_store_dwordx4 v[72:75], v4, s[12:15], s25 offen offset:2048
    buffer_store_dwordx4 v[76:79], v4, s[12:15], s25 offen offset:3072
    s_endpgm
L_prep_kernel_ge:
    v_mfma_f32_32x32x16_bf16 v[96:111], v[48:51], v[80:83], 0
    v_mfma_f32_32x32x16_bf16 v[112:127], v[52:55], v[80:83], 0
    v_mfma_f32_32x32x16_bf16 v[96:111], v[56:59], v[84:87], v[96:111]
    v_mfma_f32_32x32x16_bf16 v[112:127], v[60:63], v[84:87], v[112:127]
    v_mfma_f32_32x32x16_bf16 v[96:111], v[64:67], v[88:91], v[96:111]
    v_mfma_f32_32x32x16_bf16 v[112:127], v[68:71], v[88:91], v[112:127]
    v_mfma_f32_32x32x16_bf16 v[96:111], v[72:75], v[92:95], v[96:111]
    v_mfma_f32_32x32x16_bf16 v[112:127], v[76:79], v[92:95], v[112:127]
    v_lshlrev_b32 v4, 4, v1
    s_lshl_b32 s24, s20, 13
    v_add_u32 v7, s24, v4
    s_nop 15
    ds_write_b128 v7, v[96:99] offset:0
    ds_write_b128 v7, v[100:103] offset:1024
    ds_write_b128 v7, v[104:107] offset:2048
    ds_write_b128 v7, v[108:111] offset:3072
    ds_write_b128 v7, v[112:115] offset:4096
    ds_write_b128 v7, v[116:119] offset:5120
    ds_write_b128 v7, v[120:123] offset:6144
    ds_write_b128 v7, v[124:127] offset:7168
    s_waitcnt lgkmcnt(0)
    s_barrier
    s_lshl_b32 s24, s20, 10
    v_add_u32 v7, s24, v4
    ds_read_b128 v[16:19], v7 offset:0
    ds_read_b128 v[20:23], v7 offset:4096
    ds_read_b128 v[24:27], v7 offset:8192
    ds_read_b128 v[28:31], v7 offset:12288
    ds_read_b128 v[32:35], v7 offset:16384
    ds_read_b128 v[36:39], v7 offset:20480
    ds_read_b128 v[40:43], v7 offset:24576
    ds_read_b128 v[44:47], v7 offset:28672
    s_mov_b32 s14, 16384
    v_lshlrev_b32 v8, 10, v3
    v_lshl_add_u32 v8, v2, 5, v8
    s_lshl_b32 s24, s22, 8
    s_lshl_b32 s25, s20, 6
    s_add_u32 s24, s24, s25
    s_mov_b32 s34, 0xffff0000
    s_mov_b32 s35, 0x4038aa3b
    s_waitcnt lgkmcnt(0)
    v_add_f32 v16, v16, v24
    v_add_f32 v16, v16, v32
    v_add_f32 v16, v16, v40
    v_add_f32 v17, v17, v25
    v_add_f32 v17, v17, v33
    v_add_f32 v17, v17, v41
    v_add_f32 v18, v18, v26
    v_add_f32 v18, v18, v34
    v_add_f32 v18, v18, v42
    v_add_f32 v19, v19, v27
    v_add_f32 v19, v19, v35
    v_add_f32 v19, v19, v43
    v_add_f32 v20, v20, v28
    v_add_f32 v20, v20, v36
    v_add_f32 v20, v20, v44
    v_add_f32 v21, v21, v29
    v_add_f32 v21, v21, v37
    v_add_f32 v21, v21, v45
    v_add_f32 v22, v22, v30
    v_add_f32 v22, v22, v38
    v_add_f32 v22, v22, v46
    v_add_f32 v23, v23, v31
    v_add_f32 v23, v23, v39
    v_add_f32 v23, v23, v47
    v_cvt_pk_bf16_f32 v48, v16, v20
    v_cvt_pk_bf16_f32 v49, v17, v21
    v_cvt_pk_bf16_f32 v50, v18, v22
    v_cvt_pk_bf16_f32 v51, v19, v23
    v_lshlrev_b32 v56, 16, v48
    v_and_b32 v57, s34, v48
    v_lshlrev_b32 v58, 16, v49
    v_and_b32 v59, s34, v49
    v_lshlrev_b32 v60, 16, v50
    v_and_b32 v61, s34, v50
    v_lshlrev_b32 v62, 16, v51
    v_and_b32 v63, s34, v51
    v_mul_f32 v56, s35, v56
    v_mul_f32 v57, s35, v57
    v_mul_f32 v58, s35, v58
    v_mul_f32 v59, s35, v59
    v_mul_f32 v60, s35, v60
    v_mul_f32 v61, s35, v61
    v_mul_f32 v62, s35, v62
    v_mul_f32 v63, s35, v63
    buffer_store_dwordx4 v[56:59], v8, s[12:15], s24 offen
    buffer_store_dwordx4 v[60:63], v8, s[12:15], s24 offen offset:16
    v_exp_f32 v64, v56
    v_exp_f32 v65, v57
    v_exp_f32 v66, v58
    v_exp_f32 v67, v59
    v_exp_f32 v68, v60
    v_exp_f32 v69, v61
    v_exp_f32 v70, v62
    v_exp_f32 v71, v63
    v_max3_f32 v72, |v56|, |v57|, |v58|
    v_max3_f32 v72, |v59|, |v60|, v72
    v_max3_f32 v72, |v61|, |v62|, v72
    v_max_f32 v72, |v63|, v72
    s_add_u32 s12, s12, 16384
    s_addc_u32 s13, s13, 0
    v_cmp_lt_f32 vcc, 0x42f00000, v72
    buffer_store_dwordx4 v[64:67], v8, s[12:15], s24 offen
    buffer_store_dwordx4 v[68:71], v8, s[12:15], s24 offen offset:16
    s_add_u32 s12, s12, 16384
    s_addc_u32 s13, s13, 0
    s_or_b32 s26, vcc_lo, vcc_hi
    s_lshr_b32 s24, s24, 4
    v_mov_b32 v73, s26
    v_mov_b32 v74, 0
    buffer_store_dword v73, v74, s[12:15], s24 offen
    s_endpgm
.globl conv1_kernel
.p2align 8
.type conv1_kernel,@function
conv1_kernel:
    s_cmp_ge_u32 s2, 256
    s_cbranch_scc1 L_conv1_kernel_done
    s_load_dwordx2 s[4:5], s[0:1], 0
    s_load_dwordx2 s[30:31], s[0:1], 72
    v_readfirstlane_b32 s20, v0
    s_lshr_b32 s20, s20, 6
    s_and_b32 s36, s2, 0
    s_lshl_b32 s36, s36, 3
    s_bfe_u32 s37, s2, 196611
    s_or_b32 s29, s36, s37
    s_bfe_u32 s36, s2, 196608
    s_lshl_b32 s36, s36, 2
    s_lshr_b32 s37, s2, 6
    s_or_b32 s36, s36, s37
    s_mov_b32 s33, 0
    s_and_b32 s34, s36, 15
    s_lshr_b32 s35, s36, 4
    s_mul_i32 s21, s34, 500
    s_and_b32 s32, s20, 3
    v_and_b32 v127, 63, v0
    v_lshrrev_b32 v5, 2, v127
    v_and_b32 v6, 3, v127
    v_lshlrev_b32 v7, 15, v5
    v_lshl_add_u32 v7, v6, 4, v7
    s_lshl_b32 s41, s21, 10
    s_lshl_b32 s37, s33, 9
    s_add_u32 s41, s41, s37
    s_sub_u32 s41, s41, 7680
    s_and_b32 s42, s20, 7
    s_lshl_b32 s37, s42, 12
    s_add_u32 s37, s37, s41
    v_add_u32 v7, s37, v7
    s_mul_i32 s36, s35, 8192000
    s_mov_b32 s10, 8192000
    s_mov_b32 s11, 0x00020000
    s_mov_b32 s25, 0xffff0000
    s_waitcnt lgkmcnt(0)
    s_add_u32 s8, s4, s36
    s_addc_u32 s9, s5, 0
    s_cmp_ge_u32 s20, 8
    s_cbranch_scc1 L_conv1_kernel_helper
    s_add_u32 s37, s41, 524288
    v_lshl_add_u32 v108, v127, 4, s37
    s_lshl_b32 s36, s29, 4
    s_lshl_b32 s37, s33, 3
    s_add_u32 s36, s36, s37
    s_mul_i32 s36, s36, 57344
    s_add_u32 s36, s36, 0
    s_add_u32 s12, s30, s36
    s_addc_u32 s13, s31, 0
    s_mov_b32 s14, 917504
    s_mov_b32 s15, 0x00020000
    s_mul_i32 s36, s35, 4096000
    s_add_u32 s36, s36, 18874368
    s_add_u32 s16, s30, s36
    s_addc_u32 s17, s31, 0
    s_mov_b32 s18, 4096000
    s_mov_b32 s19, 0x00020000
    v_and_b32 v10, 15, v127
    v_lshrrev_b32 v11, 4, v127
    v_add_u32 v8, 0, v10
    v_and_b32 v16, 4, v8
    v_lshrrev_b32 v16, 1, v16
    v_xor_b32 v16, v11, v16
    v_lshlrev_b32 v16, 4, v16
    v_lshl_add_u32 v8, v8, 6, v16
    v_add_u32 v9, 1, v10
    v_and_b32 v16, 4, v9
    v_lshrrev_b32 v16, 1, v16
    v_xor_b32 v16, v11, v16
    v_lshlrev_b32 v16, 4, v16
    v_lshl_add_u32 v9, v9, 6, v16
    s_lshr_b32 s38, s32, 1
    s_and_b32 s39, s32, 1
    s_add_u32 s40, s38, 4
    s_lshl_b32 s43, s39, 10
    s_cmp_lt_u32 s20, 4
    s_cselect_b32 s40, s20, s40
    s_cselect_b32 s36, 0, s43
    s_lshl_b32 s37, s40, 13
    s_add_u32 s37, s37, s36
    v_lshl_add_u32 v125, v127, 4, s37
    s_mul_i32 s37, s40, 16384
    v_add_u32 v120, s37, v8
    v_add_u32 v121, s37, v9
    s_lshl_b32 s37, s40, 10
    s_add_u32 s37, s37, 115712
    v_lshl_add_u32 v16, v11, 4, s37
    v_cmp_eq_u32 vcc, 15, v10
    v_mov_b32 v17, 8192
    v_mov_b32 v18, 4294959104
    v_mov_b32 v19, 64
    v_cndmask_b32 v122, v121, v16, vcc
    v_cndmask_b32 v123, v17, v19, vcc
    v_cndmask_b32 v124, v18, v19, vcc
    v_lshl_add_u32 v126, v127, 4, s37
    s_mov_b32 s44, 0x3f800000
    s_mov_b32 s45, 0x00000000
    s_mov_b32 s46, 0x00000000
    s_cmp_eq_u32 s40, 1
    s_cselect_b32 s45, 0x3f800000, s45
    s_cselect_b32 s46, 0x3f800000, s46
    s_cmp_eq_u32 s40, 2
    s_cselect_b32 s45, 0xbf800000, s45
    s_cselect_b32 s46, 0x3f800000, s46
    s_cmp_eq_u32 s40, 3
    s_cselect_b32 s45, 0x40000000, s45
    s_cselect_b32 s46, 0x40800000, s46
    s_cmp_eq_u32 s40, 4
    s_cselect_b32 s45, 0xc0000000, s45
    s_cselect_b32 s46, 0x40800000, s46
    s_cmp_eq_u32 s40, 5
    s_cselect_b32 s44, 0x41800000, s44
    s_cselect_b32 s45, 0x41000000, s45
    s_cselect_b32 s46, 0x40800000, s46
    s_cmp_ge_u32 s20, 4
    s_cbranch_scc1 L_conv1_kernel_m2
    v_mov_b32 v0, 0
    v_mov_b32 v1, 0
    v_mov_b32 v2, 0
    v_mov_b32 v3, 0
    v_mov_b32 v4, 0
    v_mov_b32 v5, 0
    v_mov_b32 v6, 0
    v_mov_b32 v7, 0
    v_mov_b32 v8, 0
    v_mov_b32 v9, 0
    v_mov_b32 v10, 0
    v_mov_b32 v11, 0
    v_mov_b32 v12, 0
    v_mov_b32 v13, 0
    v_mov_b32 v14, 0
    v_mov_b32 v15, 0
    v_mov_b32 v16, 0
    v_mov_b32 v17, 0
    v_mov_b32 v18, 0
    v_mov_b32 v19, 0
    v_mov_b32 v20, 0
    v_mov_b32 v21, 0
    v_mov_b32 v22, 0
    v_mov_b32 v23, 0
    v_mov_b32 v24, 0
    v_mov_b32 v25, 0
    v_mov_b32 v26, 0
    v_mov_b32 v27, 0
    v_mov_b32 v28, 0
    v_mov_b32 v29, 0
    v_mov_b32 v30, 0
    v_mov_b32 v31, 0
    v_mov_b32 v32, 0
    v_mov_b32 v33, 0
    v_mov_b32 v34, 0
    v_mov_b32 v35, 0
    v_mov_b32 v36, 0
    v_mov_b32 v37, 0
    v_mov_b32 v38, 0
    v_mov_b32 v39, 0
    v_mov_b32 v40, 0
    v_mov_b32 v41, 0
    v_mov_b32 v42, 0
    v_mov_b32 v43, 0
    v_mov_b32 v44, 0
    v_mov_b32 v45, 0
    v_mov_b32 v46, 0
    v_mov_b32 v47, 0
    v_mov_b32 v48, 0
    v_mov_b32 v49, 0
    v_mov_b32 v50, 0
    v_mov_b32 v51, 0
    v_mov_b32 v52, 0
    v_mov_b32 v53, 0
    v_mov_b32 v54, 0
    v_mov_b32 v55, 0
    v_mov_b32 v56, 0
    v_mov_b32 v57, 0
    v_mov_b32 v58, 0
    v_mov_b32 v59, 0
    v_mov_b32 v60, 0
    v_mov_b32 v61, 0
    v_mov_b32 v62, 0
    v_mov_b32 v63, 0
    s_barrier
    buffer_load_dwordx4 v[96:99], v108, s[8:11], 0 offen offset:0
    buffer_load_dwordx4 v[100:103], v108, s[8:11], 0 offen offset:1024
    buffer_load_dwordx4 v[104:107], v108, s[8:11], 0 offen offset:2048
    s_mov_b32 s23, 0
    s_mov_b32 s26, 4096
    buffer_load_dwordx4 v[64:67], v125, s[12:15], s23 offen offset:0
    buffer_load_dwordx4 v[68:71], v125, s[12:15], s23 offen offset:1024
    buffer_load_dwordx4 v[72:75], v125, s[12:15], s23 offen offset:2048
    buffer_load_dwordx4 v[76:79], v125, s[12:15], s23 offen offset:3072
    buffer_load_dwordx4 v[80:83], v125, s[12:15], s26 offen offset:0
    buffer_load_dwordx4 v[84:87], v125, s[12:15], s26 offen offset:1024
    buffer_load_dwordx4 v[88:91], v125, s[12:15], s26 offen offset:2048
    buffer_load_dwordx4 v[92:95], v125, s[12:15], s26 offen offset:3072
    s_mov_b32 s23, 57344
    s_mov_b32 s26, 61440
    s_waitcnt vmcnt(8)
    v_lshlrev_b32 v108, 16, v96
    v_and_b32 v111, s25, v96
    v_lshlrev_b32 v109, 16, v100
    v_and_b32 v112, s25, v100
    v_lshlrev_b32 v110, 16, v104
    v_and_b32 v113, s25, v104
    v_mul_f32 v114, s44, v108
    v_mul_f32 v115, s44, v111
    v_fmac_f32 v114, s45, v109
    v_fmac_f32 v115, s45, v112
    v_fmac_f32 v114, s46, v110
    v_fmac_f32 v115, s46, v113
    v_cvt_pk_bf16_f32 v96, v114, v115
    v_lshlrev_b32 v108, 16, v97
    v_and_b32 v111, s25, v97
    v_lshlrev_b32 v109, 16, v101
    v_and_b32 v112, s25, v101
    v_lshlrev_b32 v110, 16, v105
    v_and_b32 v113, s25, v105
    v_mul_f32 v114, s44, v108
    v_mul_f32 v115, s44, v111
    v_fmac_f32 v114, s45, v109
    v_fmac_f32 v115, s45, v112
    v_fmac_f32 v114, s46, v110
    v_fmac_f32 v115, s46, v113
    v_cvt_pk_bf16_f32 v97, v114, v115
    v_lshlrev_b32 v108, 16, v98
    v_and_b32 v111, s25, v98
    v_lshlrev_b32 v109, 16, v102
    v_and_b32 v112, s25, v102
    v_lshlrev_b32 v110, 16, v106
    v_and_b32 v113, s25, v106
    v_mul_f32 v114, s44, v108
    v_mul_f32 v115, s44, v111
    v_fmac_f32 v114, s45, v109
    v_fmac_f32 v115, s45, v112
    v_fmac_f32 v114, s46, v110
    v_fmac_f32 v115, s46, v113
    v_cvt_pk_bf16_f32 v98, v114, v115
    v_lshlrev_b32 v108, 16, v99
    v_and_b32 v111, s25, v99
    v_lshlrev_b32 v109, 16, v103
    v_and_b32 v112, s25, v103
    v_lshlrev_b32 v110, 16, v107
    v_and_b32 v113, s25, v107
    v_mul_f32 v114, s44, v108
    v_mul_f32 v115, s44, v111
    v_fmac_f32 v114, s45, v109
    v_fmac_f32 v115, s45, v112
    v_fmac_f32 v114, s46, v110
    v_fmac_f32 v115, s46, v113
    v_cvt_pk_bf16_f32 v99, v114, v115
    ds_write_b128 v126, v[96:99]
    s_waitcnt lgkmcnt(0)
    s_barrier
    s_mov_b32 s22, 8
    s_setprio 2
L_conv1_kernel_mloop1:
    ds_read_b128 v[96:99], v120 offset:0
    ds_read_b128 v[100:103], v120 offset:1024
    ds_read_b128 v[104:107], v120 offset:2048
    ds_read_b128 v[108:111], v120 offset:3072
    ds_read_b128 v[112:115], v120 offset:4096
    ds_read_b128 v[116:119], v120 offset:5120
    s_waitcnt vmcnt(6) lgkmcnt(5)
    v_mfma_f32_16x16x32_bf16 v[0:3], v[64:67], v[96:99], v[0:3]
    v_mfma_f32_16x16x32_bf16 v[32:35], v[68:71], v[96:99], v[32:35]
    ds_read_b128 v[96:99], v120 offset:6144
    s_waitcnt vmcnt(4) lgkmcnt(5)
    v_mfma_f32_16x16x32_bf16 v[4:7], v[64:67], v[100:103], v[4:7]
    v_mfma_f32_16x16x32_bf16 v[36:39], v[68:71], v[100:103], v[36:39]
    v_mfma_f32_16x16x32_bf16 v[0:3], v[72:75], v[100:103], v[0:3]
    v_mfma_f32_16x16x32_bf16 v[32:35], v[76:79], v[100:103], v[32:35]
    ds_read_b128 v[100:103], v120 offset:7168
    s_waitcnt vmcnt(2) lgkmcnt(5)
    v_mfma_f32_16x16x32_bf16 v[8:11], v[64:67], v[104:107], v[8:11]
    v_mfma_f32_16x16x32_bf16 v[40:43], v[68:71], v[104:107], v[40:43]
    v_mfma_f32_16x16x32_bf16 v[4:7], v[72:75], v[104:107], v[4:7]
    v_mfma_f32_16x16x32_bf16 v[36:39], v[76:79], v[104:107], v[36:39]
    v_mfma_f32_16x16x32_bf16 v[0:3], v[80:83], v[104:107], v[0:3]
    v_mfma_f32_16x16x32_bf16 v[32:35], v[84:87], v[104:107], v[32:35]
    ds_read_b128 v[104:107], v122 offset:0
    v_add_u32 v122, v123, v122
    s_waitcnt vmcnt(0) lgkmcnt(5)
    v_mfma_f32_16x16x32_bf16 v[12:15], v[64:67], v[108:111], v[12:15]
    v_mfma_f32_16x16x32_bf16 v[44:47], v[68:71], v[108:111], v[44:47]
    v_mfma_f32_16x16x32_bf16 v[8:11], v[72:75], v[108:111], v[8:11]
    v_mfma_f32_16x16x32_bf16 v[40:43], v[76:79], v[108:111], v[40:43]
    v_mfma_f32_16x16x32_bf16 v[4:7], v[80:83], v[108:111], v[4:7]
    v_mfma_f32_16x16x32_bf16 v[36:39], v[84:87], v[108:111], v[36:39]
    v_mfma_f32_16x16x32_bf16 v[0:3], v[88:91], v[108:111], v[0:3]
    v_mfma_f32_16x16x32_bf16 v[32:35], v[92:95], v[108:111], v[32:35]
    ds_read_b128 v[108:111], v121 offset:1024
    s_waitcnt lgkmcnt(5)
    v_mfma_f32_16x16x32_bf16 v[16:19], v[64:67], v[112:115], v[16:19]
    v_mfma_f32_16x16x32_bf16 v[48:51], v[68:71], v[112:115], v[48:51]
    v_mfma_f32_16x16x32_bf16 v[12:15], v[72:75], v[112:115], v[12:15]
    v_mfma_f32_16x16x32_bf16 v[44:47], v[76:79], v[112:115], v[44:47]
    v_mfma_f32_16x16x32_bf16 v[8:11], v[80:83], v[112:115], v[8:11]
    v_mfma_f32_16x16x32_bf16 v[40:43], v[84:87], v[112:115], v[40:43]
    v_mfma_f32_16x16x32_bf16 v[4:7], v[88:91], v[112:115], v[4:7]
    v_mfma_f32_16x16x32_bf16 v[36:39], v[92:95], v[112:115], v[36:39]
    ds_read_b128 v[112:115], v121 offset:2048
    s_waitcnt lgkmcnt(5)
    v_mfma_f32_16x16x32_bf16 v[20:23], v[64:67], v[116:119], v[20:23]
    v_mfma_f32_16x16x32_bf16 v[52:55], v[68:71], v[116:119], v[52:55]
    v_mfma_f32_16x16x32_bf16 v[16:19], v[72:75], v[116:119], v[16:19]
    v_mfma_f32_16x16x32_bf16 v[48:51], v[76:79], v[116:119], v[48:51]
    v_mfma_f32_16x16x32_bf16 v[12:15], v[80:83], v[116:119], v[12:15]
    v_mfma_f32_16x16x32_bf16 v[44:47], v[84:87], v[116:119], v[44:47]
    v_mfma_f32_16x16x32_bf16 v[8:11], v[88:91], v[116:119], v[8:11]
    v_mfma_f32_16x16x32_bf16 v[40:43], v[92:95], v[116:119], v[40:43]
    s_waitcnt lgkmcnt(4)
    v_mfma_f32_16x16x32_bf16 v[24:27], v[64:67], v[96:99], v[24:27]
    v_mfma_f32_16x16x32_bf16 v[56:59], v[68:71], v[96:99], v[56:59]
    v_mfma_f32_16x16x32_bf16 v[20:23], v[72:75], v[96:99], v[20:23]
    v_mfma_f32_16x16x32_bf16 v[52:55], v[76:79], v[96:99], v[52:55]
    v_mfma_f32_16x16x32_bf16 v[16:19], v[80:83], v[96:99], v[16:19]
    v_mfma_f32_16x16x32_bf16 v[48:51], v[84:87], v[96:99], v[48:51]
    v_mfma_f32_16x16x32_bf16 v[12:15], v[88:91], v[96:99], v[12:15]
    v_mfma_f32_16x16x32_bf16 v[44:47], v[92:95], v[96:99], v[44:47]
    s_waitcnt lgkmcnt(3)
    v_mfma_f32_16x16x32_bf16 v[28:31], v[64:67], v[100:103], v[28:31]
    v_mfma_f32_16x16x32_bf16 v[60:63], v[68:71], v[100:103], v[60:63]
    v_mfma_f32_16x16x32_bf16 v[24:27], v[72:75], v[100:103], v[24:27]
    v_mfma_f32_16x16x32_bf16 v[56:59], v[76:79], v[100:103], v[56:59]
    v_mfma_f32_16x16x32_bf16 v[20:23], v[80:83], v[100:103], v[20:23]
    v_mfma_f32_16x16x32_bf16 v[52:55], v[84:87], v[100:103], v[52:55]
    v_mfma_f32_16x16x32_bf16 v[16:19], v[88:91], v[100:103], v[16:19]
    v_mfma_f32_16x16x32_bf16 v[48:51], v[92:95], v[100:103], v[48:51]
    buffer_load_dwordx4 v[64:67], v125, s[12:15], s23 offen offset:0
    buffer_load_dwordx4 v[68:71], v125, s[12:15], s23 offen offset:1024
    s_waitcnt lgkmcnt(2)
    v_mfma_f32_16x16x32_bf16 v[28:31], v[72:75], v[104:107], v[28:31]
    v_mfma_f32_16x16x32_bf16 v[60:63], v[76:79], v[104:107], v[60:63]
    v_mfma_f32_16x16x32_bf16 v[24:27], v[80:83], v[104:107], v[24:27]
    v_mfma_f32_16x16x32_bf16 v[56:59], v[84:87], v[104:107], v[56:59]
    v_mfma_f32_16x16x32_bf16 v[20:23], v[88:91], v[104:107], v[20:23]
    v_mfma_f32_16x16x32_bf16 v[52:55], v[92:95], v[104:107], v[52:55]
    buffer_load_dwordx4 v[72:75], v125, s[12:15], s23 offen offset:2048
    buffer_load_dwordx4 v[76:79], v125, s[12:15], s23 offen offset:3072
    s_waitcnt lgkmcnt(1)
    v_mfma_f32_16x16x32_bf16 v[28:31], v[80:83], v[108:111], v[28:31]
    v_mfma_f32_16x16x32_bf16 v[60:63], v[84:87], v[108:111], v[60:63]
    v_mfma_f32_16x16x32_bf16 v[24:27], v[88:91], v[108:111], v[24:27]
    v_mfma_f32_16x16x32_bf16 v[56:59], v[92:95], v[108:111], v[56:59]
    buffer_load_dwordx4 v[80:83], v125, s[12:15], s26 offen offset:0
    buffer_load_dwordx4 v[84:87], v125, s[12:15], s26 offen offset:1024
    s_waitcnt lgkmcnt(0)
    v_mfma_f32_16x16x32_bf16 v[28:31], v[88:91], v[112:115], v[28:31]
    v_mfma_f32_16x16x32_bf16 v[60:63], v[92:95], v[112:115], v[60:63]
    buffer_load_dwordx4 v[88:91], v125, s[12:15], s26 offen offset:2048
    buffer_load_dwordx4 v[92:95], v125, s[12:15], s26 offen offset:3072
    s_add_u32 s23, s23, 57344
    s_add_u32 s26, s26, 57344
    s_barrier
    s_sub_u32 s22, s22, 1
    s_cmp_eq_u32 s22, 0
    s_cbranch_scc1 L_conv1_kernel_mlast1
    ds_read_b128 v[96:99], v120 offset:8192
    ds_read_b128 v[100:103], v120 offset:9216
    ds_read_b128 v[104:107], v120 offset:10240
    ds_read_b128 v[108:111], v120 offset:11264
    ds_read_b128 v[112:115], v120 offset:12288
    ds_read_b128 v[116:119], v120 offset:13312
    s_waitcnt vmcnt(6) lgkmcnt(5)
    v_mfma_f32_16x16x32_bf16 v[0:3], v[64:67], v[96:99], v[0:3]
    v_mfma_f32_16x16x32_bf16 v[32:35], v[68:71], v[96:99], v[32:35]
    ds_read_b128 v[96:99], v120 offset:14336
    s_waitcnt vmcnt(4) lgkmcnt(5)
    v_mfma_f32_16x16x32_bf16 v[4:7], v[64:67], v[100:103], v[4:7]
    v_mfma_f32_16x16x32_bf16 v[36:39], v[68:71], v[100:103], v[36:39]
    v_mfma_f32_16x16x32_bf16 v[0:3], v[72:75], v[100:103], v[0:3]
    v_mfma_f32_16x16x32_bf16 v[32:35], v[76:79], v[100:103], v[32:35]
    ds_read_b128 v[100:103], v120 offset:15360
    s_waitcnt vmcnt(2) lgkmcnt(5)
    v_mfma_f32_16x16x32_bf16 v[8:11], v[64:67], v[104:107], v[8:11]
    v_mfma_f32_16x16x32_bf16 v[40:43], v[68:71], v[104:107], v[40:43]
    v_mfma_f32_16x16x32_bf16 v[4:7], v[72:75], v[104:107], v[4:7]
    v_mfma_f32_16x16x32_bf16 v[36:39], v[76:79], v[104:107], v[36:39]
    v_mfma_f32_16x16x32_bf16 v[0:3], v[80:83], v[104:107], v[0:3]
    v_mfma_f32_16x16x32_bf16 v[32:35], v[84:87], v[104:107], v[32:35]
    ds_read_b128 v[104:107], v122 offset:0
    v_add_u32 v122, v124, v122
    s_waitcnt vmcnt(0) lgkmcnt(5)
    v_mfma_f32_16x16x32_bf16 v[12:15], v[64:67], v[108:111], v[12:15]
    v_mfma_f32_16x16x32_bf16 v[44:47], v[68:71], v[108:111], v[44:47]
    v_mfma_f32_16x16x32_bf16 v[8:11], v[72:75], v[108:111], v[8:11]
    v_mfma_f32_16x16x32_bf16 v[40:43], v[76:79], v[108:111], v[40:43]
    v_mfma_f32_16x16x32_bf16 v[4:7], v[80:83], v[108:111], v[4:7]
    v_mfma_f32_16x16x32_bf16 v[36:39], v[84:87], v[108:111], v[36:39]
    v_mfma_f32_16x16x32_bf16 v[0:3], v[88:91], v[108:111], v[0:3]
    v_mfma_f32_16x16x32_bf16 v[32:35], v[92:95], v[108:111], v[32:35]
    ds_read_b128 v[108:111], v121 offset:9216
    s_waitcnt lgkmcnt(5)
    v_mfma_f32_16x16x32_bf16 v[16:19], v[64:67], v[112:115], v[16:19]
    v_mfma_f32_16x16x32_bf16 v[48:51], v[68:71], v[112:115], v[48:51]
    v_mfma_f32_16x16x32_bf16 v[12:15], v[72:75], v[112:115], v[12:15]
    v_mfma_f32_16x16x32_bf16 v[44:47], v[76:79], v[112:115], v[44:47]
    v_mfma_f32_16x16x32_bf16 v[8:11], v[80:83], v[112:115], v[8:11]
    v_mfma_f32_16x16x32_bf16 v[40:43], v[84:87], v[112:115], v[40:43]
    v_mfma_f32_16x16x32_bf16 v[4:7], v[88:91], v[112:115], v[4:7]
    v_mfma_f32_16x16x32_bf16 v[36:39], v[92:95], v[112:115], v[36:39]
    ds_read_b128 v[112:115], v121 offset:10240
    s_waitcnt lgkmcnt(5)
    v_mfma_f32_16x16x32_bf16 v[20:23], v[64:67], v[116:119], v[20:23]
    v_mfma_f32_16x16x32_bf16 v[52:55], v[68:71], v[116:119], v[52:55]
    v_mfma_f32_16x16x32_bf16 v[16:19], v[72:75], v[116:119], v[16:19]
    v_mfma_f32_16x16x32_bf16 v[48:51], v[76:79], v[116:119], v[48:51]
    v_mfma_f32_16x16x32_bf16 v[12:15], v[80:83], v[116:119], v[12:15]
    v_mfma_f32_16x16x32_bf16 v[44:47], v[84:87], v[116:119], v[44:47]
    v_mfma_f32_16x16x32_bf16 v[8:11], v[88:91], v[116:119], v[8:11]
    v_mfma_f32_16x16x32_bf16 v[40:43], v[92:95], v[116:119], v[40:43]
    s_waitcnt lgkmcnt(4)
    v_mfma_f32_16x16x32_bf16 v[24:27], v[64:67], v[96:99], v[24:27]
    v_mfma_f32_16x16x32_bf16 v[56:59], v[68:71], v[96:99], v[56:59]
    v_mfma_f32_16x16x32_bf16 v[20:23], v[72:75], v[96:99], v[20:23]
    v_mfma_f32_16x16x32_bf16 v[52:55], v[76:79], v[96:99], v[52:55]
    v_mfma_f32_16x16x32_bf16 v[16:19], v[80:83], v[96:99], v[16:19]
    v_mfma_f32_16x16x32_bf16 v[48:51], v[84:87], v[96:99], v[48:51]
    v_mfma_f32_16x16x32_bf16 v[12:15], v[88:91], v[96:99], v[12:15]
    v_mfma_f32_16x16x32_bf16 v[44:47], v[92:95], v[96:99], v[44:47]
    s_waitcnt lgkmcnt(3)
    v_mfma_f32_16x16x32_bf16 v[28:31], v[64:67], v[100:103], v[28:31]
    v_mfma_f32_16x16x32_bf16 v[60:63], v[68:71], v[100:103], v[60:63]
    v_mfma_f32_16x16x32_bf16 v[24:27], v[72:75], v[100:103], v[24:27]
    v_mfma_f32_16x16x32_bf16 v[56:59], v[76:79], v[100:103], v[56:59]
    v_mfma_f32_16x16x32_bf16 v[20:23], v[80:83], v[100:103], v[20:23]
    v_mfma_f32_16x16x32_bf16 v[52:55], v[84:87], v[100:103], v[52:55]
    v_mfma_f32_16x16x32_bf16 v[16:19], v[88:91], v[100:103], v[16:19]
    v_mfma_f32_16x16x32_bf16 v[48:51], v[92:95], v[100:103], v[48:51]
    buffer_load_dwordx4 v[64:67], v125, s[12:15], s23 offen offset:0
    buffer_load_dwordx4 v[68:71], v125, s[12:15], s23 offen offset:1024
    s_waitcnt lgkmcnt(2)
    v_mfma_f32_16x16x32_bf16 v[28:31], v[72:75], v[104:107], v[28:31]
    v_mfma_f32_16x16x32_bf16 v[60:63], v[76:79], v[104:107], v[60:63]
    v_mfma_f32_16x16x32_bf16 v[24:27], v[80:83], v[104:107], v[24:27]
    v_mfma_f32_16x16x32_bf16 v[56:59], v[84:87], v[104:107], v[56:59]
    v_mfma_f32_16x16x32_bf16 v[20:23], v[88:91], v[104:107], v[20:23]
    v_mfma_f32_16x16x32_bf16 v[52:55], v[92:95], v[104:107], v[52:55]
    buffer_load_dwordx4 v[72:75], v125, s[12:15], s23 offen offset:2048
    buffer_load_dwordx4 v[76:79], v125, s[12:15], s23 offen offset:3072
    s_waitcnt lgkmcnt(1)
    v_mfma_f32_16x16x32_bf16 v[28:31], v[80:83], v[108:111], v[28:31]
    v_mfma_f32_16x16x32_bf16 v[60:63], v[84:87], v[108:111], v[60:63]
    v_mfma_f32_16x16x32_bf16 v[24:27], v[88:91], v[108:111], v[24:27]
    v_mfma_f32_16x16x32_bf16 v[56:59], v[92:95], v[108:111], v[56:59]
    buffer_load_dwordx4 v[80:83], v125, s[12:15], s26 offen offset:0
    buffer_load_dwordx4 v[84:87], v125, s[12:15], s26 offen offset:1024
    s_waitcnt lgkmcnt(0)
    v_mfma_f32_16x16x32_bf16 v[28:31], v[88:91], v[112:115], v[28:31]
    v_mfma_f32_16x16x32_bf16 v[60:63], v[92:95], v[112:115], v[60:63]
    buffer_load_dwordx4 v[88:91], v125, s[12:15], s26 offen offset:2048
    buffer_load_dwordx4 v[92:95], v125, s[12:15], s26 offen offset:3072
    s_add_u32 s23, s23, 57344
    s_add_u32 s26, s26, 57344
    s_barrier
    s_branch L_conv1_kernel_mloop1
L_conv1_kernel_mlast1:
    v_and_b32 v125, 15, v127
    v_and_b32 v126, 7, v127
    v_lshlrev_b32 v126, 4, v126
    v_lshl_add_u32 v125, v125, 7, v126
    v_lshrrev_b32 v126, 4, v127
    v_lshl_add_u32 v125, v126, 11, v125
    s_lshl_b32 s36, s20, 14
    s_add_u32 s37, s36, 8192
    v_add_u32 v126, s37, v125
    v_add_u32 v125, s36, v125
    ds_read_b128 v[96:99], v120 offset:8192
    ds_read_b128 v[100:103], v120 offset:9216
    ds_read_b128 v[104:107], v120 offset:10240
    ds_read_b128 v[108:111], v120 offset:11264
    ds_read_b128 v[112:115], v120 offset:12288
    ds_read_b128 v[116:119], v120 offset:13312
    s_waitcnt vmcnt(6) lgkmcnt(5)
    v_mfma_f32_16x16x32_bf16 v[0:3], v[64:67], v[96:99], v[0:3]
    v_mfma_f32_16x16x32_bf16 v[32:35], v[68:71], v[96:99], v[32:35]
    ds_read_b128 v[96:99], v120 offset:14336
    s_waitcnt vmcnt(4) lgkmcnt(5)
    v_mfma_f32_16x16x32_bf16 v[4:7], v[64:67], v[100:103], v[4:7]
    v_mfma_f32_16x16x32_bf16 v[36:39], v[68:71], v[100:103], v[36:39]
    v_mfma_f32_16x16x32_bf16 v[0:3], v[72:75], v[100:103], v[0:3]
    v_mfma_f32_16x16x32_bf16 v[32:35], v[76:79], v[100:103], v[32:35]
    ds_read_b128 v[100:103], v120 offset:15360
    s_waitcnt vmcnt(2) lgkmcnt(5)
    v_mfma_f32_16x16x32_bf16 v[8:11], v[64:67], v[104:107], v[8:11]
    v_mfma_f32_16x16x32_bf16 v[40:43], v[68:71], v[104:107], v[40:43]
    v_mfma_f32_16x16x32_bf16 v[4:7], v[72:75], v[104:107], v[4:7]
    v_mfma_f32_16x16x32_bf16 v[36:39], v[76:79], v[104:107], v[36:39]
    v_mfma_f32_16x16x32_bf16 v[0:3], v[80:83], v[104:107], v[0:3]
    v_mfma_f32_16x16x32_bf16 v[32:35], v[84:87], v[104:107], v[32:35]
    ds_read_b128 v[104:107], v122 offset:0
    s_waitcnt vmcnt(0) lgkmcnt(5)
    v_mfma_f32_16x16x32_bf16 v[12:15], v[64:67], v[108:111], v[12:15]
    v_mfma_f32_16x16x32_bf16 v[44:47], v[68:71], v[108:111], v[44:47]
    v_mfma_f32_16x16x32_bf16 v[8:11], v[72:75], v[108:111], v[8:11]
    v_mfma_f32_16x16x32_bf16 v[40:43], v[76:79], v[108:111], v[40:43]
    v_mfma_f32_16x16x32_bf16 v[4:7], v[80:83], v[108:111], v[4:7]
    v_mfma_f32_16x16x32_bf16 v[36:39], v[84:87], v[108:111], v[36:39]
    v_mfma_f32_16x16x32_bf16 v[0:3], v[88:91], v[108:111], v[0:3]
    v_mfma_f32_16x16x32_bf16 v[32:35], v[92:95], v[108:111], v[32:35]
    ds_read_b128 v[108:111], v121 offset:9216
    s_waitcnt lgkmcnt(5)
    v_mfma_f32_16x16x32_bf16 v[16:19], v[64:67], v[112:115], v[16:19]
    v_mfma_f32_16x16x32_bf16 v[48:51], v[68:71], v[112:115], v[48:51]
    v_mfma_f32_16x16x32_bf16 v[12:15], v[72:75], v[112:115], v[12:15]
    v_mfma_f32_16x16x32_bf16 v[44:47], v[76:79], v[112:115], v[44:47]
    v_mfma_f32_16x16x32_bf16 v[8:11], v[80:83], v[112:115], v[8:11]
    v_mfma_f32_16x16x32_bf16 v[40:43], v[84:87], v[112:115], v[40:43]
    v_mfma_f32_16x16x32_bf16 v[4:7], v[88:91], v[112:115], v[4:7]
    v_mfma_f32_16x16x32_bf16 v[36:39], v[92:95], v[112:115], v[36:39]
    ds_read_b128 v[112:115], v121 offset:10240
    v_xor_b32 v123, 0, v125
    ds_write_b128 v123, v[0:3]
    s_waitcnt lgkmcnt(6)
    v_mfma_f32_16x16x32_bf16 v[20:23], v[64:67], v[116:119], v[20:23]
    v_mfma_f32_16x16x32_bf16 v[52:55], v[68:71], v[116:119], v[52:55]
    v_mfma_f32_16x16x32_bf16 v[16:19], v[72:75], v[116:119], v[16:19]
    v_mfma_f32_16x16x32_bf16 v[48:51], v[76:79], v[116:119], v[48:51]
    v_mfma_f32_16x16x32_bf16 v[12:15], v[80:83], v[116:119], v[12:15]
    v_mfma_f32_16x16x32_bf16 v[44:47], v[84:87], v[116:119], v[44:47]
    v_mfma_f32_16x16x32_bf16 v[8:11], v[88:91], v[116:119], v[8:11]
    v_mfma_f32_16x16x32_bf16 v[40:43], v[92:95], v[116:119], v[40:43]
    v_xor_b32 v124, 16, v125
    ds_write_b128 v124, v[4:7]
    s_waitcnt lgkmcnt(2)
    v_mfma_f32_16x16x32_bf16 v[24:27], v[64:67], v[96:99], v[24:27]
    v_mfma_f32_16x16x32_bf16 v[56:59], v[68:71], v[96:99], v[56:59]
    v_mfma_f32_16x16x32_bf16 v[20:23], v[72:75], v[96:99], v[20:23]
    v_mfma_f32_16x16x32_bf16 v[52:55], v[76:79], v[96:99], v[52:55]
    v_mfma_f32_16x16x32_bf16 v[16:19], v[80:83], v[96:99], v[16:19]
    v_mfma_f32_16x16x32_bf16 v[48:51], v[84:87], v[96:99], v[48:51]
    v_mfma_f32_16x16x32_bf16 v[12:15], v[88:91], v[96:99], v[12:15]
    v_mfma_f32_16x16x32_bf16 v[44:47], v[92:95], v[96:99], v[44:47]
    v_xor_b32 v123, 32, v125
    ds_write_b128 v123, v[8:11]
    v_xor_b32 v124, 0, v126
    ds_write_b128 v124, v[32:35]
    v_mfma_f32_16x16x32_bf16 v[28:31], v[64:67], v[100:103], v[28:31]
    v_mfma_f32_16x16x32_bf16 v[60:63], v[68:71], v[100:103], v[60:63]
    v_mfma_f32_16x16x32_bf16 v[24:27], v[72:75], v[100:103], v[24:27]
    v_mfma_f32_16x16x32_bf16 v[56:59], v[76:79], v[100:103], v[56:59]
    v_mfma_f32_16x16x32_bf16 v[20:23], v[80:83], v[100:103], v[20:23]
    v_mfma_f32_16x16x32_bf16 v[52:55], v[84:87], v[100:103], v[52:55]
    v_mfma_f32_16x16x32_bf16 v[16:19], v[88:91], v[100:103], v[16:19]
    v_mfma_f32_16x16x32_bf16 v[48:51], v[92:95], v[100:103], v[48:51]
    v_xor_b32 v123, 16, v126
    ds_write_b128 v123, v[36:39]
    v_xor_b32 v124, 32, v126
    ds_write_b128 v124, v[40:43]
    v_mfma_f32_16x16x32_bf16 v[28:31], v[72:75], v[104:107], v[28:31]
    v_mfma_f32_16x16x32_bf16 v[60:63], v[76:79], v[104:107], v[60:63]
    v_mfma_f32_16x16x32_bf16 v[24:27], v[80:83], v[104:107], v[24:27]
    v_mfma_f32_16x16x32_bf16 v[56:59], v[84:87], v[104:107], v[56:59]
    v_mfma_f32_16x16x32_bf16 v[20:23], v[88:91], v[104:107], v[20:23]
    v_mfma_f32_16x16x32_bf16 v[52:55], v[92:95], v[104:107], v[52:55]
    v_xor_b32 v124, 48, v125
    ds_write_b128 v124, v[12:15]
    v_xor_b32 v123, 48, v126
    ds_write_b128 v123, v[44:47]
    v_mfma_f32_16x16x32_bf16 v[28:31], v[80:83], v[108:111], v[28:31]
    v_mfma_f32_16x16x32_bf16 v[60:63], v[84:87], v[108:111], v[60:63]
    v_mfma_f32_16x16x32_bf16 v[24:27], v[88:91], v[108:111], v[24:27]
    v_mfma_f32_16x16x32_bf16 v[56:59], v[92:95], v[108:111], v[56:59]
    v_xor_b32 v123, 64, v125
    ds_write_b128 v123, v[16:19]
    v_xor_b32 v124, 64, v126
    ds_write_b128 v124, v[48:51]
    v_mfma_f32_16x16x32_bf16 v[28:31], v[88:91], v[112:115], v[28:31]
    v_mfma_f32_16x16x32_bf16 v[60:63], v[92:95], v[112:115], v[60:63]
    v_xor_b32 v124, 80, v125
    ds_write_b128 v124, v[20:23]
    v_xor_b32 v123, 80, v126
    ds_write_b128 v123, v[52:55]
    s_nop 7
    v_xor_b32 v123, 96, v125
    ds_write_b128 v123, v[24:27]
    v_xor_b32 v124, 96, v126
    ds_write_b128 v124, v[56:59]
    v_xor_b32 v124, 112, v125
    ds_write_b128 v124, v[28:31]
    v_xor_b32 v123, 112, v126
    s_waitcnt lgkmcnt(8)
    ds_write_b128 v123, v[60:63]
    s_setprio 0
    s_branch L_conv1_kernel_epi
L_conv1_kernel_m2:
    s_mul_i32 s37, s38, 2176
    s_add_u32 s37, s37, 98304
    v_add_u32 v116, s37, v8
    v_add_u32 v118, s37, v9
    v_add_u32 v117, 104832, v8
    s_cmp_eq_u32 s38, 0
    s_cbranch_scc1 L_conv1_kernel_hh0
    v_add_u32 v117, 98304, v9
L_conv1_kernel_hh0:
    s_lshl_b32 s37, s38, 12
    s_add_u32 s37, s37, s43
    s_add_u32 s37, s37, 49152
    v_lshl_add_u32 v119, v127, 4, s37
    v_mov_b32 v0, 0
    v_mov_b32 v1, 0
    v_mov_b32 v2, 0
    v_mov_b32 v3, 0
    v_mov_b32 v4, 0
    v_mov_b32 v5, 0
    v_mov_b32 v6, 0
    v_mov_b32 v7, 0
    v_mov_b32 v8, 0
    v_mov_b32 v9, 0
    v_mov_b32 v10, 0
    v_mov_b32 v11, 0
    v_mov_b32 v12, 0
    v_mov_b32 v13, 0
    v_mov_b32 v14, 0
    v_mov_b32 v15, 0
    v_mov_b32 v16, 0
    v_mov_b32 v17, 0
    v_mov_b32 v18, 0
    v_mov_b32 v19, 0
    v_mov_b32 v20, 0
    v_mov_b32 v21, 0
    v_mov_b32 v22, 0
    v_mov_b32 v23, 0
    v_mov_b32 v24, 0
    v_mov_b32 v25, 0
    v_mov_b32 v26, 0
    v_mov_b32 v27, 0
    v_mov_b32 v28, 0
    v_mov_b32 v29, 0
    v_mov_b32 v30, 0
    v_mov_b32 v31, 0
    v_mov_b32 v32, 0
    v_mov_b32 v33, 0
    v_mov_b32 v34, 0
    v_mov_b32 v35, 0
    v_mov_b32 v36, 0
    v_mov_b32 v37, 0
    v_mov_b32 v38, 0
    v_mov_b32 v39, 0
    v_mov_b32 v40, 0
    v_mov_b32 v41, 0
    v_mov_b32 v42, 0
    v_mov_b32 v43, 0
    v_mov_b32 v44, 0
    v_mov_b32 v45, 0
    v_mov_b32 v46, 0
    v_mov_b32 v47, 0
    v_mov_b32 v48, 0
    v_mov_b32 v49, 0
    v_mov_b32 v50, 0
    v_mov_b32 v51, 0
    v_mov_b32 v52, 0
    v_mov_b32 v53, 0
    v_mov_b32 v54, 0
    v_mov_b32 v55, 0
    v_mov_b32 v56, 0
    v_mov_b32 v57, 0
    v_mov_b32 v58, 0
    v_mov_b32 v59, 0
    v_mov_b32 v60, 0
    v_mov_b32 v61, 0
    v_mov_b32 v62, 0
    v_mov_b32 v63, 0
    s_barrier
    buffer_load_dwordx4 v[96:99], v108, s[8:11], 0 offen offset:0
    buffer_load_dwordx4 v[100:103], v108, s[8:11], 0 offen offset:1024
    buffer_load_dwordx4 v[104:107], v108, s[8:11], 0 offen offset:2048
    s_mov_b32 s23, 0
    s_mov_b32 s26, 4096
    buffer_load_dwordx4 v[64:67], v125, s[12:15], s23 offen offset:0
    buffer_load_dwordx4 v[68:71], v125, s[12:15], s23 offen offset:2048
    buffer_load_dwordx4 v[80:83], v119, s[12:15], s23 offen offset:0
    buffer_load_dwordx4 v[72:75], v125, s[12:15], s26 offen offset:0
    buffer_load_dwordx4 v[84:87], v119, s[12:15], s23 offen offset:2048
    buffer_load_dwordx4 v[76:79], v125, s[12:15], s26 offen offset:2048
    s_mov_b32 s23, 57344
    s_mov_b32 s26, 61440
    s_waitcnt vmcnt(6)
    v_lshlrev_b32 v108, 16, v96
    v_and_b32 v111, s25, v96
    v_lshlrev_b32 v109, 16, v100
    v_and_b32 v112, s25, v100
    v_lshlrev_b32 v110, 16, v104
    v_and_b32 v113, s25, v104
    v_mul_f32 v114, s44, v108
    v_mul_f32 v115, s44, v111
    v_fmac_f32 v114, s45, v109
    v_fmac_f32 v115, s45, v112
    v_fmac_f32 v114, s46, v110
    v_fmac_f32 v115, s46, v113
    v_cvt_pk_bf16_f32 v96, v114, v115
    v_lshlrev_b32 v108, 16, v97
    v_and_b32 v111, s25, v97
    v_lshlrev_b32 v109, 16, v101
    v_and_b32 v112, s25, v101
    v_lshlrev_b32 v110, 16, v105
    v_and_b32 v113, s25, v105
    v_mul_f32 v114, s44, v108
    v_mul_f32 v115, s44, v111
    v_fmac_f32 v114, s45, v109
    v_fmac_f32 v115, s45, v112
    v_fmac_f32 v114, s46, v110
    v_fmac_f32 v115, s46, v113
    v_cvt_pk_bf16_f32 v97, v114, v115
    v_lshlrev_b32 v108, 16, v98
    v_and_b32 v111, s25, v98
    v_lshlrev_b32 v109, 16, v102
    v_and_b32 v112, s25, v102
    v_lshlrev_b32 v110, 16, v106
    v_and_b32 v113, s25, v106
    v_mul_f32 v114, s44, v108
    v_mul_f32 v115, s44, v111
    v_fmac_f32 v114, s45, v109
    v_fmac_f32 v115, s45, v112
    v_fmac_f32 v114, s46, v110
    v_fmac_f32 v115, s46, v113
    v_cvt_pk_bf16_f32 v98, v114, v115
    v_lshlrev_b32 v108, 16, v99
    v_and_b32 v111, s25, v99
    v_lshlrev_b32 v109, 16, v103
    v_and_b32 v112, s25, v103
    v_lshlrev_b32 v110, 16, v107
    v_and_b32 v113, s25, v107
    v_mul_f32 v114, s44, v108
    v_mul_f32 v115, s44, v111
    v_fmac_f32 v114, s45, v109
    v_fmac_f32 v115, s45, v112
    v_fmac_f32 v114, s46, v110
    v_fmac_f32 v115, s46, v113
    v_cvt_pk_bf16_f32 v99, v114, v115
    ds_write_b128 v126, v[96:99]
    v_and_b32 v126, 15, v127
    v_lshlrev_b32 v126, 2, v126
    v_add_u32 v126, 99328, v126
    ds_write_b32 v126, v0
    ds_write_b32 v126, v0 offset:8704
    s_waitcnt lgkmcnt(0)
    s_barrier
    s_mov_b32 s22, 8
    s_setprio 2
L_conv1_kernel_mloop2:
    ds_read_b128 v[88:91], v120 offset:0
    ds_read_b128 v[92:95], v120 offset:1024
    ds_read_b128 v[96:99], v116 offset:0
    ds_read_b128 v[100:103], v120 offset:2048
    ds_read_b128 v[104:107], v116 offset:1088
    ds_read_b128 v[108:111], v120 offset:3072
    ds_read_b128 v[112:115], v116 offset:2176
    s_waitcnt vmcnt(5) lgkmcnt(6)
    v_mfma_f32_16x16x32_bf16 v[0:3], v[64:67], v[88:91], v[0:3]
    ds_read_b128 v[88:91], v120 offset:4096
    s_waitcnt vmcnt(4) lgkmcnt(6)
    v_mfma_f32_16x16x32_bf16 v[4:7], v[64:67], v[92:95], v[4:7]
    v_mfma_f32_16x16x32_bf16 v[0:3], v[68:71], v[92:95], v[0:3]
    ds_read_b128 v[92:95], v116 offset:3264
    s_waitcnt vmcnt(3) lgkmcnt(6)
    v_mfma_f32_16x16x32_bf16 v[32:35], v[80:83], v[96:99], v[32:35]
    ds_read_b128 v[96:99], v120 offset:5120
    s_waitcnt vmcnt(2) lgkmcnt(6)
    v_mfma_f32_16x16x32_bf16 v[8:11], v[64:67], v[100:103], v[8:11]
    v_mfma_f32_16x16x32_bf16 v[4:7], v[68:71], v[100:103], v[4:7]
    v_mfma_f32_16x16x32_bf16 v[0:3], v[72:75], v[100:103], v[0:3]
    ds_read_b128 v[100:103], v116 offset:4352
    s_waitcnt vmcnt(1) lgkmcnt(6)
    v_mfma_f32_16x16x32_bf16 v[36:39], v[80:83], v[104:107], v[36:39]
    v_mfma_f32_16x16x32_bf16 v[32:35], v[84:87], v[104:107], v[32:35]
    ds_read_b128 v[104:107], v120 offset:6144
    s_waitcnt vmcnt(0) lgkmcnt(6)
    v_mfma_f32_16x16x32_bf16 v[12:15], v[64:67], v[108:111], v[12:15]
    v_mfma_f32_16x16x32_bf16 v[8:11], v[68:71], v[108:111], v[8:11]
    v_mfma_f32_16x16x32_bf16 v[4:7], v[72:75], v[108:111], v[4:7]
    v_mfma_f32_16x16x32_bf16 v[0:3], v[76:79], v[108:111], v[0:3]
    ds_read_b128 v[108:111], v116 offset:5440
    s_waitcnt lgkmcnt(6)
    v_mfma_f32_16x16x32_bf16 v[40:43], v[80:83], v[112:115], v[40:43]
    v_mfma_f32_16x16x32_bf16 v[36:39], v[84:87], v[112:115], v[36:39]
    ds_read_b128 v[112:115], v120 offset:7168
    s_waitcnt lgkmcnt(6)
    v_mfma_f32_16x16x32_bf16 v[16:19], v[64:67], v[88:91], v[16:19]
    v_mfma_f32_16x16x32_bf16 v[12:15], v[68:71], v[88:91], v[12:15]
    v_mfma_f32_16x16x32_bf16 v[8:11], v[72:75], v[88:91], v[8:11]
    v_mfma_f32_16x16x32_bf16 v[4:7], v[76:79], v[88:91], v[4:7]
    ds_read_b128 v[88:91], v117 offset:0
    s_waitcnt lgkmcnt(6)
    v_mfma_f32_16x16x32_bf16 v[44:47], v[80:83], v[92:95], v[44:47]
    v_mfma_f32_16x16x32_bf16 v[40:43], v[84:87], v[92:95], v[40:43]
    ds_read_b128 v[92:95], v122 offset:0
    v_add_u32 v122, v123, v122
    s_waitcnt lgkmcnt(6)
    v_mfma_f32_16x16x32_bf16 v[20:23], v[64:67], v[96:99], v[20:23]
    v_mfma_f32_16x16x32_bf16 v[16:19], v[68:71], v[96:99], v[16:19]
    v_mfma_f32_16x16x32_bf16 v[12:15], v[72:75], v[96:99], v[12:15]
    v_mfma_f32_16x16x32_bf16 v[8:11], v[76:79], v[96:99], v[8:11]
    ds_read_b128 v[96:99], v117 offset:1088
    s_waitcnt lgkmcnt(6)
    v_mfma_f32_16x16x32_bf16 v[48:51], v[80:83], v[100:103], v[48:51]
    v_mfma_f32_16x16x32_bf16 v[44:47], v[84:87], v[100:103], v[44:47]
    ds_read_b128 v[100:103], v121 offset:1024
    s_waitcnt lgkmcnt(6)
    v_mfma_f32_16x16x32_bf16 v[24:27], v[64:67], v[104:107], v[24:27]
    v_mfma_f32_16x16x32_bf16 v[20:23], v[68:71], v[104:107], v[20:23]
    v_mfma_f32_16x16x32_bf16 v[16:19], v[72:75], v[104:107], v[16:19]
    v_mfma_f32_16x16x32_bf16 v[12:15], v[76:79], v[104:107], v[12:15]
    ds_read_b128 v[104:107], v118 offset:0
    s_waitcnt lgkmcnt(6)
    v_mfma_f32_16x16x32_bf16 v[52:55], v[80:83], v[108:111], v[52:55]
    v_mfma_f32_16x16x32_bf16 v[48:51], v[84:87], v[108:111], v[48:51]
    ds_read_b128 v[108:111], v121 offset:2048
    s_waitcnt lgkmcnt(6)
    v_mfma_f32_16x16x32_bf16 v[28:31], v[64:67], v[112:115], v[28:31]
    v_mfma_f32_16x16x32_bf16 v[24:27], v[68:71], v[112:115], v[24:27]
    v_mfma_f32_16x16x32_bf16 v[20:23], v[72:75], v[112:115], v[20:23]
    v_mfma_f32_16x16x32_bf16 v[16:19], v[76:79], v[112:115], v[16:19]
    buffer_load_dwordx4 v[64:67], v125, s[12:15], s23 offen offset:0
    s_waitcnt lgkmcnt(5)
    v_mfma_f32_16x16x32_bf16 v[56:59], v[80:83], v[88:91], v[56:59]
    v_mfma_f32_16x16x32_bf16 v[52:55], v[84:87], v[88:91], v[52:55]
    s_waitcnt lgkmcnt(0)
    s_barrier
    v_mfma_f32_16x16x32_bf16 v[28:31], v[68:71], v[92:95], v[28:31]
    v_mfma_f32_16x16x32_bf16 v[24:27], v[72:75], v[92:95], v[24:27]
    v_mfma_f32_16x16x32_bf16 v[20:23], v[76:79], v[92:95], v[20:23]
    buffer_load_dwordx4 v[68:71], v125, s[12:15], s23 offen offset:2048
    v_mfma_f32_16x16x32_bf16 v[60:63], v[80:83], v[96:99], v[60:63]
    v_mfma_f32_16x16x32_bf16 v[56:59], v[84:87], v[96:99], v[56:59]
    buffer_load_dwordx4 v[80:83], v119, s[12:15], s23 offen offset:0
    v_mfma_f32_16x16x32_bf16 v[28:31], v[72:75], v[100:103], v[28:31]
    v_mfma_f32_16x16x32_bf16 v[24:27], v[76:79], v[100:103], v[24:27]
    buffer_load_dwordx4 v[72:75], v125, s[12:15], s26 offen offset:0
    v_mfma_f32_16x16x32_bf16 v[60:63], v[84:87], v[104:107], v[60:63]
    buffer_load_dwordx4 v[84:87], v119, s[12:15], s23 offen offset:2048
    v_mfma_f32_16x16x32_bf16 v[28:31], v[76:79], v[108:111], v[28:31]
    buffer_load_dwordx4 v[76:79], v125, s[12:15], s26 offen offset:2048
    s_add_u32 s23, s23, 57344
    s_add_u32 s26, s26, 57344
    s_sub_u32 s22, s22, 1
    s_cmp_eq_u32 s22, 0
    s_cbranch_scc1 L_conv1_kernel_mlast2
    ds_read_b128 v[88:91], v120 offset:8192
    ds_read_b128 v[92:95], v120 offset:9216
    ds_read_b128 v[96:99], v116 offset:8704
    ds_read_b128 v[100:103], v120 offset:10240
    ds_read_b128 v[104:107], v116 offset:9792
    ds_read_b128 v[108:111], v120 offset:11264
    ds_read_b128 v[112:115], v116 offset:10880
    s_waitcnt vmcnt(5) lgkmcnt(6)
    v_mfma_f32_16x16x32_bf16 v[0:3], v[64:67], v[88:91], v[0:3]
    ds_read_b128 v[88:91], v120 offset:12288
    s_waitcnt vmcnt(4) lgkmcnt(6)
    v_mfma_f32_16x16x32_bf16 v[4:7], v[64:67], v[92:95], v[4:7]
    v_mfma_f32_16x16x32_bf16 v[0:3], v[68:71], v[92:95], v[0:3]
    ds_read_b128 v[92:95], v116 offset:11968
    s_waitcnt vmcnt(3) lgkmcnt(6)
    v_mfma_f32_16x16x32_bf16 v[32:35], v[80:83], v[96:99], v[32:35]
    ds_read_b128 v[96:99], v120 offset:13312
    s_waitcnt vmcnt(2) lgkmcnt(6)
    v_mfma_f32_16x16x32_bf16 v[8:11], v[64:67], v[100:103], v[8:11]
    v_mfma_f32_16x16x32_bf16 v[4:7], v[68:71], v[100:103], v[4:7]
    v_mfma_f32_16x16x32_bf16 v[0:3], v[72:75], v[100:103], v[0:3]
    ds_read_b128 v[100:103], v116 offset:13056
    s_waitcnt vmcnt(1) lgkmcnt(6)
    v_mfma_f32_16x16x32_bf16 v[36:39], v[80:83], v[104:107], v[36:39]
    v_mfma_f32_16x16x32_bf16 v[32:35], v[84:87], v[104:107], v[32:35]
    ds_read_b128 v[104:107], v120 offset:14336
    s_waitcnt vmcnt(0) lgkmcnt(6)
    v_mfma_f32_16x16x32_bf16 v[12:15], v[64:67], v[108:111], v[12:15]
    v_mfma_f32_16x16x32_bf16 v[8:11], v[68:71], v[108:111], v[8:11]
    v_mfma_f32_16x16x32_bf16 v[4:7], v[72:75], v[108:111], v[4:7]
    v_mfma_f32_16x16x32_bf16 v[0:3], v[76:79], v[108:111], v[0:3]
    ds_read_b128 v[108:111], v116 offset:14144
    s_waitcnt lgkmcnt(6)
    v_mfma_f32_16x16x32_bf16 v[40:43], v[80:83], v[112:115], v[40:43]
    v_mfma_f32_16x16x32_bf16 v[36:39], v[84:87], v[112:115], v[36:39]
    ds_read_b128 v[112:115], v120 offset:15360
    s_waitcnt lgkmcnt(6)
    v_mfma_f32_16x16x32_bf16 v[16:19], v[64:67], v[88:91], v[16:19]
    v_mfma_f32_16x16x32_bf16 v[12:15], v[68:71], v[88:91], v[12:15]
    v_mfma_f32_16x16x32_bf16 v[8:11], v[72:75], v[88:91], v[8:11]
    v_mfma_f32_16x16x32_bf16 v[4:7], v[76:79], v[88:91], v[4:7]
    ds_read_b128 v[88:91], v117 offset:8704
    s_waitcnt lgkmcnt(6)
    v_mfma_f32_16x16x32_bf16 v[44:47], v[80:83], v[92:95], v[44:47]
    v_mfma_f32_16x16x32_bf16 v[40:43], v[84:87], v[92:95], v[40:43]
    ds_read_b128 v[92:95], v122 offset:0
    v_add_u32 v122, v124, v122
    s_waitcnt lgkmcnt(6)
    v_mfma_f32_16x16x32_bf16 v[20:23], v[64:67], v[96:99], v[20:23]
    v_mfma_f32_16x16x32_bf16 v[16:19], v[68:71], v[96:99], v[16:19]
    v_mfma_f32_16x16x32_bf16 v[12:15], v[72:75], v[96:99], v[12:15]
    v_mfma_f32_16x16x32_bf16 v[8:11], v[76:79], v[96:99], v[8:11]
    ds_read_b128 v[96:99], v117 offset:9792
    s_waitcnt lgkmcnt(6)
    v_mfma_f32_16x16x32_bf16 v[48:51], v[80:83], v[100:103], v[48:51]
    v_mfma_f32_16x16x32_bf16 v[44:47], v[84:87], v[100:103], v[44:47]
    ds_read_b128 v[100:103], v121 offset:9216
    s_waitcnt lgkmcnt(6)
    v_mfma_f32_16x16x32_bf16 v[24:27], v[64:67], v[104:107], v[24:27]
    v_mfma_f32_16x16x32_bf16 v[20:23], v[68:71], v[104:107], v[20:23]
    v_mfma_f32_16x16x32_bf16 v[16:19], v[72:75], v[104:107], v[16:19]
    v_mfma_f32_16x16x32_bf16 v[12:15], v[76:79], v[104:107], v[12:15]
    ds_read_b128 v[104:107], v118 offset:8704
    s_waitcnt lgkmcnt(6)
    v_mfma_f32_16x16x32_bf16 v[52:55], v[80:83], v[108:111], v[52:55]
    v_mfma_f32_16x16x32_bf16 v[48:51], v[84:87], v[108:111], v[48:51]
    ds_read_b128 v[108:111], v121 offset:10240
    s_waitcnt lgkmcnt(6)
    v_mfma_f32_16x16x32_bf16 v[28:31], v[64:67], v[112:115], v[28:31]
    v_mfma_f32_16x16x32_bf16 v[24:27], v[68:71], v[112:115], v[24:27]
    v_mfma_f32_16x16x32_bf16 v[20:23], v[72:75], v[112:115], v[20:23]
    v_mfma_f32_16x16x32_bf16 v[16:19], v[76:79], v[112:115], v[16:19]
    buffer_load_dwordx4 v[64:67], v125, s[12:15], s23 offen offset:0
    s_waitcnt lgkmcnt(5)
    v_mfma_f32_16x16x32_bf16 v[56:59], v[80:83], v[88:91], v[56:59]
    v_mfma_f32_16x16x32_bf16 v[52:55], v[84:87], v[88:91], v[52:55]
    s_waitcnt lgkmcnt(0)
    s_barrier
    v_mfma_f32_16x16x32_bf16 v[28:31], v[68:71], v[92:95], v[28:31]
    v_mfma_f32_16x16x32_bf16 v[24:27], v[72:75], v[92:95], v[24:27]
    v_mfma_f32_16x16x32_bf16 v[20:23], v[76:79], v[92:95], v[20:23]
    buffer_load_dwordx4 v[68:71], v125, s[12:15], s23 offen offset:2048
    v_mfma_f32_16x16x32_bf16 v[60:63], v[80:83], v[96:99], v[60:63]
    v_mfma_f32_16x16x32_bf16 v[56:59], v[84:87], v[96:99], v[56:59]
    buffer_load_dwordx4 v[80:83], v119, s[12:15], s23 offen offset:0
    v_mfma_f32_16x16x32_bf16 v[28:31], v[72:75], v[100:103], v[28:31]
    v_mfma_f32_16x16x32_bf16 v[24:27], v[76:79], v[100:103], v[24:27]
    buffer_load_dwordx4 v[72:75], v125, s[12:15], s26 offen offset:0
    v_mfma_f32_16x16x32_bf16 v[60:63], v[84:87], v[104:107], v[60:63]
    buffer_load_dwordx4 v[84:87], v119, s[12:15], s23 offen offset:2048
    v_mfma_f32_16x16x32_bf16 v[28:31], v[76:79], v[108:111], v[28:31]
    buffer_load_dwordx4 v[76:79], v125, s[12:15], s26 offen offset:2048
    s_add_u32 s23, s23, 57344
    s_add_u32 s26, s26, 57344
    s_branch L_conv1_kernel_mloop2
L_conv1_kernel_mlast2:
    v_and_b32 v125, 15, v127
    v_and_b32 v126, 7, v127
    v_lshlrev_b32 v126, 4, v126
    v_lshl_add_u32 v125, v125, 7, v126
    v_lshrrev_b32 v126, 4, v127
    v_lshl_add_u32 v125, v126, 11, v125
    s_mov_b32 s36, 65536
    s_cmp_eq_u32 s32, 1
    s_cselect_b32 s36, 121856, s36
    s_cmp_eq_u32 s32, 2
    s_cselect_b32 s36, 81920, s36
    s_cmp_eq_u32 s32, 3
    s_cselect_b32 s36, 130048, s36
    s_mov_b32 s37, 98304
    s_cmp_eq_u32 s32, 1
    s_cselect_b32 s37, 138240, s37
    s_cmp_eq_u32 s32, 2
    s_cselect_b32 s37, 146432, s37
    s_cmp_eq_u32 s32, 3
    s_cselect_b32 s37, 154624, s37
    v_add_u32 v126, s37, v125
    v_add_u32 v125, s36, v125
    ds_read_b128 v[88:91], v120 offset:8192
    ds_read_b128 v[92:95], v120 offset:9216
    ds_read_b128 v[96:99], v116 offset:8704
    ds_read_b128 v[100:103], v120 offset:10240
    ds_read_b128 v[104:107], v116 offset:9792
    ds_read_b128 v[108:111], v120 offset:11264
    ds_read_b128 v[112:115], v116 offset:10880
    s_waitcnt vmcnt(5) lgkmcnt(6)
    v_mfma_f32_16x16x32_bf16 v[0:3], v[64:67], v[88:91], v[0:3]
    ds_read_b128 v[88:91], v120 offset:12288
    s_waitcnt vmcnt(4) lgkmcnt(6)
    v_mfma_f32_16x16x32_bf16 v[4:7], v[64:67], v[92:95], v[4:7]
    v_mfma_f32_16x16x32_bf16 v[0:3], v[68:71], v[92:95], v[0:3]
    ds_read_b128 v[92:95], v116 offset:11968
    s_waitcnt vmcnt(3) lgkmcnt(6)
    v_mfma_f32_16x16x32_bf16 v[32:35], v[80:83], v[96:99], v[32:35]
    ds_read_b128 v[96:99], v120 offset:13312
    s_waitcnt vmcnt(2) lgkmcnt(6)
    v_mfma_f32_16x16x32_bf16 v[8:11], v[64:67], v[100:103], v[8:11]
    v_mfma_f32_16x16x32_bf16 v[4:7], v[68:71], v[100:103], v[4:7]
    v_mfma_f32_16x16x32_bf16 v[0:3], v[72:75], v[100:103], v[0:3]
    ds_read_b128 v[100:103], v116 offset:13056
    s_waitcnt vmcnt(1) lgkmcnt(6)
    v_mfma_f32_16x16x32_bf16 v[36:39], v[80:83], v[104:107], v[36:39]
    v_mfma_f32_16x16x32_bf16 v[32:35], v[84:87], v[104:107], v[32:35]
    ds_read_b128 v[104:107], v120 offset:14336
    s_waitcnt vmcnt(0) lgkmcnt(6)
    v_mfma_f32_16x16x32_bf16 v[12:15], v[64:67], v[108:111], v[12:15]
    v_mfma_f32_16x16x32_bf16 v[8:11], v[68:71], v[108:111], v[8:11]
    v_mfma_f32_16x16x32_bf16 v[4:7], v[72:75], v[108:111], v[4:7]
    v_mfma_f32_16x16x32_bf16 v[0:3], v[76:79], v[108:111], v[0:3]
    ds_read_b128 v[108:111], v116 offset:14144
    s_waitcnt lgkmcnt(6)
    v_mfma_f32_16x16x32_bf16 v[40:43], v[80:83], v[112:115], v[40:43]
    v_mfma_f32_16x16x32_bf16 v[36:39], v[84:87], v[112:115], v[36:39]
    ds_read_b128 v[112:115], v120 offset:15360
    s_waitcnt lgkmcnt(6)
    v_mfma_f32_16x16x32_bf16 v[16:19], v[64:67], v[88:91], v[16:19]
    v_mfma_f32_16x16x32_bf16 v[12:15], v[68:71], v[88:91], v[12:15]
    v_mfma_f32_16x16x32_bf16 v[8:11], v[72:75], v[88:91], v[8:11]
    v_mfma_f32_16x16x32_bf16 v[4:7], v[76:79], v[88:91], v[4:7]
    ds_read_b128 v[88:91], v117 offset:8704
    v_xor_b32 v124, 0, v126
    ds_write_b128 v124, v[32:35]
    s_waitcnt lgkmcnt(7)
    v_mfma_f32_16x16x32_bf16 v[44:47], v[80:83], v[92:95], v[44:47]
    v_mfma_f32_16x16x32_bf16 v[40:43], v[84:87], v[92:95], v[40:43]
    ds_read_b128 v[92:95], v122 offset:0
    v_xor_b32 v123, 0, v125
    ds_write_b128 v123, v[0:3]
    s_waitcnt lgkmcnt(8)
    v_mfma_f32_16x16x32_bf16 v[20:23], v[64:67], v[96:99], v[20:23]
    v_mfma_f32_16x16x32_bf16 v[16:19], v[68:71], v[96:99], v[16:19]
    v_mfma_f32_16x16x32_bf16 v[12:15], v[72:75], v[96:99], v[12:15]
    v_mfma_f32_16x16x32_bf16 v[8:11], v[76:79], v[96:99], v[8:11]
    ds_read_b128 v[96:99], v117 offset:9792
    v_xor_b32 v123, 16, v126
    ds_write_b128 v123, v[36:39]
    s_waitcnt lgkmcnt(9)
    v_mfma_f32_16x16x32_bf16 v[48:51], v[80:83], v[100:103], v[48:51]
    v_mfma_f32_16x16x32_bf16 v[44:47], v[84:87], v[100:103], v[44:47]
    ds_read_b128 v[100:103], v121 offset:9216
    v_xor_b32 v124, 16, v125
    ds_write_b128 v124, v[4:7]
    s_waitcnt lgkmcnt(10)
    v_mfma_f32_16x16x32_bf16 v[24:27], v[64:67], v[104:107], v[24:27]
    v_mfma_f32_16x16x32_bf16 v[20:23], v[68:71], v[104:107], v[20:23]
    v_mfma_f32_16x16x32_bf16 v[16:19], v[72:75], v[104:107], v[16:19]
    v_mfma_f32_16x16x32_bf16 v[12:15], v[76:79], v[104:107], v[12:15]
    ds_read_b128 v[104:107], v118 offset:8704
    v_xor_b32 v124, 32, v126
    ds_write_b128 v124, v[40:43]
    s_waitcnt lgkmcnt(11)
    v_mfma_f32_16x16x32_bf16 v[52:55], v[80:83], v[108:111], v[52:55]
    v_mfma_f32_16x16x32_bf16 v[48:51], v[84:87], v[108:111], v[48:51]
    ds_read_b128 v[108:111], v121 offset:10240
    v_xor_b32 v123, 32, v125
    ds_write_b128 v123, v[8:11]
    s_waitcnt lgkmcnt(12)
    v_mfma_f32_16x16x32_bf16 v[28:31], v[64:67], v[112:115], v[28:31]
    v_mfma_f32_16x16x32_bf16 v[24:27], v[68:71], v[112:115], v[24:27]
    v_mfma_f32_16x16x32_bf16 v[20:23], v[72:75], v[112:115], v[20:23]
    v_mfma_f32_16x16x32_bf16 v[16:19], v[76:79], v[112:115], v[16:19]
    v_xor_b32 v123, 48, v126
    ds_write_b128 v123, v[44:47]
    s_waitcnt lgkmcnt(12)
    v_mfma_f32_16x16x32_bf16 v[56:59], v[80:83], v[88:91], v[56:59]
    v_mfma_f32_16x16x32_bf16 v[52:55], v[84:87], v[88:91], v[52:55]
    v_xor_b32 v124, 48, v125
    ds_write_b128 v124, v[12:15]
    s_waitcnt lgkmcnt(11)
    v_mfma_f32_16x16x32_bf16 v[28:31], v[68:71], v[92:95], v[28:31]
    v_mfma_f32_16x16x32_bf16 v[24:27], v[72:75], v[92:95], v[24:27]
    v_mfma_f32_16x16x32_bf16 v[20:23], v[76:79], v[92:95], v[20:23]
    v_xor_b32 v124, 64, v126
    ds_write_b128 v124, v[48:51]
    s_waitcnt lgkmcnt(10)
    v_mfma_f32_16x16x32_bf16 v[60:63], v[80:83], v[96:99], v[60:63]
    v_mfma_f32_16x16x32_bf16 v[56:59], v[84:87], v[96:99], v[56:59]
    v_xor_b32 v123, 64, v125
    ds_write_b128 v123, v[16:19]
    s_waitcnt lgkmcnt(9)
    v_mfma_f32_16x16x32_bf16 v[28:31], v[72:75], v[100:103], v[28:31]
    v_mfma_f32_16x16x32_bf16 v[24:27], v[76:79], v[100:103], v[24:27]
    v_xor_b32 v123, 80, v126
    ds_write_b128 v123, v[52:55]
    s_waitcnt lgkmcnt(8)
    v_mfma_f32_16x16x32_bf16 v[60:63], v[84:87], v[104:107], v[60:63]
    v_xor_b32 v124, 80, v125
    ds_write_b128 v124, v[20:23]
    s_waitcnt lgkmcnt(7)
    v_mfma_f32_16x16x32_bf16 v[28:31], v[76:79], v[108:111], v[28:31]
    v_xor_b32 v124, 96, v126
    ds_write_b128 v124, v[56:59]
    s_nop 7
    v_xor_b32 v123, 96, v125
    ds_write_b128 v123, v[24:27]
    v_xor_b32 v123, 112, v126
    ds_write_b128 v123, v[60:63]
    v_xor_b32 v124, 112, v125
    ds_write_b128 v124, v[28:31]
    s_setprio 0
    s_branch L_conv1_kernel_epi
L_conv1_kernel_helper:
    s_setprio 3
    v_add_u32 v92, 0, v7
    v_add_u32 v93, 1024, v7
    v_add_u32 v94, 2048, v7
    v_add_u32 v95, 3072, v7
    v_and_b32 v76, 4, v5
    v_lshrrev_b32 v76, 1, v76
    v_xor_b32 v76, v6, v76
    v_lshlrev_b32 v76, 4, v76
    v_lshl_add_u32 v76, v5, 6, v76
    s_mov_b32 s24, 0
    buffer_load_dwordx4 v[0:3], v92, s[8:11], s24 offen offset:0
    buffer_load_dwordx4 v[16:19], v92, s[8:11], s24 offen offset:64
    v_add_u32 v92, 128, v92
    buffer_load_dwordx4 v[4:7], v93, s[8:11], s24 offen offset:0
    buffer_load_dwordx4 v[20:23], v93, s[8:11], s24 offen offset:64
    v_add_u32 v93, 128, v93
    buffer_load_dwordx4 v[8:11], v94, s[8:11], s24 offen offset:0
    buffer_load_dwordx4 v[24:27], v94, s[8:11], s24 offen offset:64
    v_add_u32 v94, 128, v94
    buffer_load_dwordx4 v[12:15], v95, s[8:11], s24 offen offset:0
    buffer_load_dwordx4 v[28:31], v95, s[8:11], s24 offen offset:64
    v_add_u32 v95, 128, v95
    s_barrier
    s_mul_i32 s36, s42, 1024
    v_add_u32 v96, s36, v76
    v_add_u32 v97, 65536, v96
    s_mul_i32 s36, s42, 1088
    s_add_u32 s36, s36, 98304
    v_add_u32 v98, s36, v76
    s_lshl_b32 s36, s29, 4
    s_lshl_b32 s37, s33, 3
    s_add_u32 s36, s36, s37
    s_mul_i32 s36, s36, 57344
    s_add_u32 s36, s36, 0
    s_add_u32 s12, s30, s36
    s_addc_u32 s13, s31, 0
    s_mov_b32 s14, 917504
    s_mov_b32 s15, 0x00020000
    s_bfe_u32 s36, s2, 196611
    s_lshl_b32 s36, s36, 3
    s_add_u32 s36, s36, s42
    s_lshl_b32 s36, s36, 14
    s_add_u32 s44, s36, s41
    s_add_u32 s44, s44, 256
    s_lshr_b32 s36, s2, 6
    s_lshl_b32 s36, s36, 3
    s_add_u32 s36, s36, s42
    s_mul_i32 s45, s36, 896
    s_add_u32 s45, s45, 57344
    s_waitcnt vmcnt(0)
    s_waitcnt lgkmcnt(0)
    s_mov_b32 s28, 0
    s_mov_b32 s22, 4
    s_cmp_ge_u32 s20, 12
    s_cbranch_scc1 L_conv1_kernel_h2
    s_waitcnt lgkmcnt(0)
    ds_write_b128 v96, v[0:3] offset:0
    ds_write_b128 v98, v[12:15] offset:0
    v_lshlrev_b32 v76, 16, v0
    v_and_b32 v84, s25, v0
    v_lshlrev_b32 v77, 16, v4
    v_and_b32 v85, s25, v4
    v_lshlrev_b32 v78, 16, v8
    v_and_b32 v86, s25, v8
    v_lshlrev_b32 v79, 16, v12
    v_and_b32 v87, s25, v12
    v_add_f32 v80, v76, v78
    v_add_f32 v88, v84, v86
    v_add_f32 v81, v77, v79
    v_add_f32 v89, v85, v87
    v_fma_f32 v82, v78, 4.0, v76
    v_fma_f32 v90, v86, 4.0, v84
    v_fma_f32 v83, v79, 4.0, v77
    v_fma_f32 v91, v87, 4.0, v85
    v_add_f32 v77, v80, v81
    v_add_f32 v85, v88, v89
    v_sub_f32 v78, v80, v81
    v_sub_f32 v86, v88, v89
    v_fma_f32 v79, v83, 2.0, v82
    v_fma_f32 v87, v91, 2.0, v90
    v_fma_f32 v82, v83, -2.0, v82
    v_fma_f32 v90, v91, -2.0, v90
    v_fmamk_f32 v80, v76, 0x41700000, v82
    v_fmamk_f32 v88, v84, 0x41700000, v90
    v_fmamk_f32 v80, v81, 0x41200000, v80
    v_fmamk_f32 v88, v89, 0x41200000, v88
    v_cvt_pk_bf16_f32 v4, v77, v85
    v_cvt_pk_bf16_f32 v8, v78, v86
    v_cvt_pk_bf16_f32 v64, v79, v87
    v_cvt_pk_bf16_f32 v68, v82, v90
    v_cvt_pk_bf16_f32 v72, v80, v88
    v_lshlrev_b32 v76, 16, v1
    v_and_b32 v84, s25, v1
    v_lshlrev_b32 v77, 16, v5
    v_and_b32 v85, s25, v5
    v_lshlrev_b32 v78, 16, v9
    v_and_b32 v86, s25, v9
    v_lshlrev_b32 v79, 16, v13
    v_and_b32 v87, s25, v13
    v_add_f32 v80, v76, v78
    v_add_f32 v88, v84, v86
    v_add_f32 v81, v77, v79
    v_add_f32 v89, v85, v87
    v_fma_f32 v82, v78, 4.0, v76
    v_fma_f32 v90, v86, 4.0, v84
    v_fma_f32 v83, v79, 4.0, v77
    v_fma_f32 v91, v87, 4.0, v85
    v_add_f32 v77, v80, v81
    v_add_f32 v85, v88, v89
    v_sub_f32 v78, v80, v81
    v_sub_f32 v86, v88, v89
    v_fma_f32 v79, v83, 2.0, v82
    v_fma_f32 v87, v91, 2.0, v90
    v_fma_f32 v82, v83, -2.0, v82
    v_fma_f32 v90, v91, -2.0, v90
    v_fmamk_f32 v80, v76, 0x41700000, v82
    v_fmamk_f32 v88, v84, 0x41700000, v90
    v_fmamk_f32 v80, v81, 0x41200000, v80
    v_fmamk_f32 v88, v89, 0x41200000, v88
    v_cvt_pk_bf16_f32 v5, v77, v85
    v_cvt_pk_bf16_f32 v9, v78, v86
    v_cvt_pk_bf16_f32 v65, v79, v87
    v_cvt_pk_bf16_f32 v69, v82, v90
    v_cvt_pk_bf16_f32 v73, v80, v88
    v_lshlrev_b32 v76, 16, v2
    v_and_b32 v84, s25, v2
    v_lshlrev_b32 v77, 16, v6
    v_and_b32 v85, s25, v6
    v_lshlrev_b32 v78, 16, v10
    v_and_b32 v86, s25, v10
    v_lshlrev_b32 v79, 16, v14
    v_and_b32 v87, s25, v14
    v_add_f32 v80, v76, v78
    v_add_f32 v88, v84, v86
    v_add_f32 v81, v77, v79
    v_add_f32 v89, v85, v87
    v_fma_f32 v82, v78, 4.0, v76
    v_fma_f32 v90, v86, 4.0, v84
    v_fma_f32 v83, v79, 4.0, v77
    v_fma_f32 v91, v87, 4.0, v85
    v_add_f32 v77, v80, v81
    v_add_f32 v85, v88, v89
    v_sub_f32 v78, v80, v81
    v_sub_f32 v86, v88, v89
    v_fma_f32 v79, v83, 2.0, v82
    v_fma_f32 v87, v91, 2.0, v90
    v_fma_f32 v82, v83, -2.0, v82
    v_fma_f32 v90, v91, -2.0, v90
    v_fmamk_f32 v80, v76, 0x41700000, v82
    v_fmamk_f32 v88, v84, 0x41700000, v90
    v_fmamk_f32 v80, v81, 0x41200000, v80
    v_fmamk_f32 v88, v89, 0x41200000, v88
    v_cvt_pk_bf16_f32 v6, v77, v85
    v_cvt_pk_bf16_f32 v10, v78, v86
    v_cvt_pk_bf16_f32 v66, v79, v87
    v_cvt_pk_bf16_f32 v70, v82, v90
    v_cvt_pk_bf16_f32 v74, v80, v88
    v_lshlrev_b32 v76, 16, v3
    v_and_b32 v84, s25, v3
    v_lshlrev_b32 v77, 16, v7
    v_and_b32 v85, s25, v7
    v_lshlrev_b32 v78, 16, v11
    v_and_b32 v86, s25, v11
    v_lshlrev_b32 v79, 16, v15
    v_and_b32 v87, s25, v15
    v_add_f32 v80, v76, v78
    v_add_f32 v88, v84, v86
    v_add_f32 v81, v77, v79
    v_add_f32 v89, v85, v87
    v_fma_f32 v82, v78, 4.0, v76
    v_fma_f32 v90, v86, 4.0, v84
    v_fma_f32 v83, v79, 4.0, v77
    v_fma_f32 v91, v87, 4.0, v85
    v_add_f32 v77, v80, v81
    v_add_f32 v85, v88, v89
    v_sub_f32 v78, v80, v81
    v_sub_f32 v86, v88, v89
    v_fma_f32 v79, v83, 2.0, v82
    v_fma_f32 v87, v91, 2.0, v90
    v_fma_f32 v82, v83, -2.0, v82
    v_fma_f32 v90, v91, -2.0, v90
    v_fmamk_f32 v80, v76, 0x41700000, v82
    v_fmamk_f32 v88, v84, 0x41700000, v90
    v_fmamk_f32 v80, v81, 0x41200000, v80
    v_fmamk_f32 v88, v89, 0x41200000, v88
    v_cvt_pk_bf16_f32 v7, v77, v85
    v_cvt_pk_bf16_f32 v11, v78, v86
    v_cvt_pk_bf16_f32 v67, v79, v87
    v_cvt_pk_bf16_f32 v71, v82, v90
    v_cvt_pk_bf16_f32 v75, v80, v88
    ds_write_b128 v96, v[4:7] offset:16384
    ds_write_b128 v96, v[8:11] offset:32768
    ds_write_b128 v96, v[64:67] offset:49152
    ds_write_b128 v97, v[68:71] offset:0
    ds_write_b128 v97, v[72:75] offset:16384
    buffer_load_dwordx4 v[32:35], v92, s[8:11], s24 offen offset:0
    buffer_load_dwordx4 v[48:51], v92, s[8:11], s24 offen offset:64
    v_add_u32 v92, 128, v92
    buffer_load_dwordx4 v[36:39], v93, s[8:11], s24 offen offset:0
    buffer_load_dwordx4 v[52:55], v93, s[8:11], s24 offen offset:64
    v_add_u32 v93, 128, v93
    s_waitcnt lgkmcnt(0)
    s_barrier
    s_setprio 1
L_conv1_kernel_hloop1:
    s_cmp_lt_u32 s28, 13
    s_cselect_b32 s24, 0, 2130706432
    v_lshlrev_b32 v76, 16, v16
    v_and_b32 v84, s25, v16
    v_lshlrev_b32 v77, 16, v20
    v_and_b32 v85, s25, v20
    v_lshlrev_b32 v78, 16, v24
    v_and_b32 v86, s25, v24
    v_lshlrev_b32 v79, 16, v28
    v_and_b32 v87, s25, v28
    v_add_f32 v80, v76, v78
    v_add_f32 v88, v84, v86
    v_add_f32 v81, v77, v79
    v_add_f32 v89, v85, v87
    v_fma_f32 v82, v78, 4.0, v76
    buffer_load_dwordx4 v[40:43], v94, s[8:11], s24 offen offset:0
    buffer_load_dwordx4 v[56:59], v94, s[8:11], s24 offen offset:64
    v_add_u32 v94, 128, v94
    v_fma_f32 v90, v86, 4.0, v84
    v_fma_f32 v83, v79, 4.0, v77
    v_fma_f32 v91, v87, 4.0, v85
    v_add_f32 v77, v80, v81
    v_add_f32 v85, v88, v89
    v_sub_f32 v78, v80, v81
    v_sub_f32 v86, v88, v89
    v_fma_f32 v79, v83, 2.0, v82
    v_fma_f32 v87, v91, 2.0, v90
    v_fma_f32 v82, v83, -2.0, v82
    v_fma_f32 v90, v91, -2.0, v90
    v_fmamk_f32 v80, v76, 0x41700000, v82
    v_fmamk_f32 v88, v84, 0x41700000, v90
    v_fmamk_f32 v80, v81, 0x41200000, v80
    v_fmamk_f32 v88, v89, 0x41200000, v88
    v_cvt_pk_bf16_f32 v20, v77, v85
    v_cvt_pk_bf16_f32 v24, v78, v86
    v_cvt_pk_bf16_f32 v64, v79, v87
    v_cvt_pk_bf16_f32 v68, v82, v90
    v_cvt_pk_bf16_f32 v72, v80, v88
    v_lshlrev_b32 v76, 16, v17
    v_and_b32 v84, s25, v17
    v_lshlrev_b32 v77, 16, v21
    v_and_b32 v85, s25, v21
    v_lshlrev_b32 v78, 16, v25
    v_and_b32 v86, s25, v25
    v_lshlrev_b32 v79, 16, v29
    v_and_b32 v87, s25, v29
    v_add_f32 v80, v76, v78
    v_add_f32 v88, v84, v86
    v_add_f32 v81, v77, v79
    v_add_f32 v89, v85, v87
    v_fma_f32 v82, v78, 4.0, v76
    v_fma_f32 v90, v86, 4.0, v84
    v_fma_f32 v83, v79, 4.0, v77
    v_fma_f32 v91, v87, 4.0, v85
    v_add_f32 v77, v80, v81
    v_add_f32 v85, v88, v89
    v_sub_f32 v78, v80, v81
    v_sub_f32 v86, v88, v89
    v_fma_f32 v79, v83, 2.0, v82
    v_fma_f32 v87, v91, 2.0, v90
    v_fma_f32 v82, v83, -2.0, v82
    v_fma_f32 v90, v91, -2.0, v90
    v_fmamk_f32 v80, v76, 0x41700000, v82
    v_fmamk_f32 v88, v84, 0x41700000, v90
    v_fmamk_f32 v80, v81, 0x41200000, v80
    v_fmamk_f32 v88, v89, 0x41200000, v88
    v_cvt_pk_bf16_f32 v21, v77, v85
    v_cvt_pk_bf16_f32 v25, v78, v86
    v_cvt_pk_bf16_f32 v65, v79, v87
    v_cvt_pk_bf16_f32 v69, v82, v90
    v_cvt_pk_bf16_f32 v73, v80, v88
    buffer_load_dwordx4 v[44:47], v95, s[8:11], s24 offen offset:0
    buffer_load_dwordx4 v[60:63], v95, s[8:11], s24 offen offset:64
    v_add_u32 v95, 128, v95
    v_lshlrev_b32 v76, 16, v18
    v_and_b32 v84, s25, v18
    v_lshlrev_b32 v77, 16, v22
    v_and_b32 v85, s25, v22
    v_lshlrev_b32 v78, 16, v26
    v_and_b32 v86, s25, v26
    v_lshlrev_b32 v79, 16, v30
    v_and_b32 v87, s25, v30
    v_add_f32 v80, v76, v78
    v_add_f32 v88, v84, v86
    v_add_f32 v81, v77, v79
    v_add_f32 v89, v85, v87
    v_fma_f32 v82, v78, 4.0, v76
    v_fma_f32 v90, v86, 4.0, v84
    v_fma_f32 v83, v79, 4.0, v77
    v_fma_f32 v91, v87, 4.0, v85
    v_add_f32 v77, v80, v81
    v_add_f32 v85, v88, v89
    v_sub_f32 v78, v80, v81
    v_sub_f32 v86, v88, v89
    v_fma_f32 v79, v83, 2.0, v82
    v_fma_f32 v87, v91, 2.0, v90
    v_fma_f32 v82, v83, -2.0, v82
    v_fma_f32 v90, v91, -2.0, v90
    v_fmamk_f32 v80, v76, 0x41700000, v82
    v_fmamk_f32 v88, v84, 0x41700000, v90
    v_fmamk_f32 v80, v81, 0x41200000, v80
    v_fmamk_f32 v88, v89, 0x41200000, v88
    v_cvt_pk_bf16_f32 v22, v77, v85
    v_cvt_pk_bf16_f32 v26, v78, v86
    v_cvt_pk_bf16_f32 v66, v79, v87
    v_cvt_pk_bf16_f32 v70, v82, v90
    v_cvt_pk_bf16_f32 v74, v80, v88
    v_lshlrev_b32 v76, 16, v19
    v_and_b32 v84, s25, v19
    v_lshlrev_b32 v77, 16, v23
    v_and_b32 v85, s25, v23
    v_lshlrev_b32 v78, 16, v27
    v_and_b32 v86, s25, v27
    v_lshlrev_b32 v79, 16, v31
    v_and_b32 v87, s25, v31
    v_add_f32 v80, v76, v78
    v_add_f32 v88, v84, v86
    v_add_f32 v81, v77, v79
    v_add_f32 v89, v85, v87
    v_fma_f32 v82, v78, 4.0, v76
    v_fma_f32 v90, v86, 4.0, v84
    v_fma_f32 v83, v79, 4.0, v77
    v_fma_f32 v91, v87, 4.0, v85
    v_add_f32 v77, v80, v81
    v_add_f32 v85, v88, v89
    v_sub_f32 v78, v80, v81
    v_sub_f32 v86, v88, v89
    v_fma_f32 v79, v83, 2.0, v82
    v_fma_f32 v87, v91, 2.0, v90
    v_fma_f32 v82, v83, -2.0, v82
    v_fma_f32 v90, v91, -2.0, v90
    v_fmamk_f32 v80, v76, 0x41700000, v82
    v_fmamk_f32 v88, v84, 0x41700000, v90
    v_fmamk_f32 v80, v81, 0x41200000, v80
    v_fmamk_f32 v88, v89, 0x41200000, v88
    v_cvt_pk_bf16_f32 v23, v77, v85
    v_cvt_pk_bf16_f32 v27, v78, v86
    v_cvt_pk_bf16_f32 v67, v79, v87
    v_cvt_pk_bf16_f32 v71, v82, v90
    v_cvt_pk_bf16_f32 v75, v80, v88
    s_waitcnt lgkmcnt(0)
    ds_write_b128 v96, v[64:67] offset:57344
    ds_write_b128 v97, v[68:71] offset:8192
    ds_write_b128 v97, v[72:75] offset:24576
    ds_write_b128 v96, v[16:19] offset:8192
    ds_write_b128 v96, v[20:23] offset:24576
    ds_write_b128 v96, v[24:27] offset:40960
    ds_write_b128 v98, v[28:31] offset:8704
    s_add_u32 s28, s28, 1
    s_waitcnt lgkmcnt(0)
    s_barrier
    s_cmp_lt_u32 s28, 13
    s_cselect_b32 s24, 0, 2130706432
    s_waitcnt vmcnt(0)
    v_lshlrev_b32 v76, 16, v32
    v_and_b32 v84, s25, v32
    v_lshlrev_b32 v77, 16, v36
    v_and_b32 v85, s25, v36
    v_lshlrev_b32 v78, 16, v40
    v_and_b32 v86, s25, v40
    v_lshlrev_b32 v79, 16, v44
    v_and_b32 v87, s25, v44
    v_add_f32 v80, v76, v78
    v_add_f32 v88, v84, v86
    v_add_f32 v81, v77, v79
    v_add_f32 v89, v85, v87
    v_fma_f32 v82, v78, 4.0, v76
    v_fma_f32 v90, v86, 4.0, v84
    v_fma_f32 v83, v79, 4.0, v77
    v_fma_f32 v91, v87, 4.0, v85
    v_add_f32 v77, v80, v81
    v_add_f32 v85, v88, v89
    v_sub_f32 v78, v80, v81
    v_sub_f32 v86, v88, v89
    v_fma_f32 v79, v83, 2.0, v82
    v_fma_f32 v87, v91, 2.0, v90
    v_fma_f32 v82, v83, -2.0, v82
    v_fma_f32 v90, v91, -2.0, v90
    v_fmamk_f32 v80, v76, 0x41700000, v82
    v_fmamk_f32 v88, v84, 0x41700000, v90
    v_fmamk_f32 v80, v81, 0x41200000, v80
    v_fmamk_f32 v88, v89, 0x41200000, v88
    v_cvt_pk_bf16_f32 v36, v77, v85
    v_cvt_pk_bf16_f32 v40, v78, v86
    v_cvt_pk_bf16_f32 v64, v79, v87
    v_cvt_pk_bf16_f32 v68, v82, v90
    v_cvt_pk_bf16_f32 v72, v80, v88
    v_lshlrev_b32 v76, 16, v33
    v_and_b32 v84, s25, v33
    v_lshlrev_b32 v77, 16, v37
    v_and_b32 v85, s25, v37
    v_lshlrev_b32 v78, 16, v41
    v_and_b32 v86, s25, v41
    buffer_load_dwordx4 v[0:3], v92, s[8:11], s24 offen offset:0
    buffer_load_dwordx4 v[16:19], v92, s[8:11], s24 offen offset:64
    v_add_u32 v92, 128, v92
    v_lshlrev_b32 v79, 16, v45
    v_and_b32 v87, s25, v45
    v_add_f32 v80, v76, v78
    v_add_f32 v88, v84, v86
    v_add_f32 v81, v77, v79
    v_add_f32 v89, v85, v87
    v_fma_f32 v82, v78, 4.0, v76
    v_fma_f32 v90, v86, 4.0, v84
    v_fma_f32 v83, v79, 4.0, v77
    v_fma_f32 v91, v87, 4.0, v85
    v_add_f32 v77, v80, v81
    v_add_f32 v85, v88, v89
    v_sub_f32 v78, v80, v81
    v_sub_f32 v86, v88, v89
    v_fma_f32 v79, v83, 2.0, v82
    v_fma_f32 v87, v91, 2.0, v90
    v_fma_f32 v82, v83, -2.0, v82
    v_fma_f32 v90, v91, -2.0, v90
    v_fmamk_f32 v80, v76, 0x41700000, v82
    v_fmamk_f32 v88, v84, 0x41700000, v90
    v_fmamk_f32 v80, v81, 0x41200000, v80
    v_fmamk_f32 v88, v89, 0x41200000, v88
    v_cvt_pk_bf16_f32 v37, v77, v85
    v_cvt_pk_bf16_f32 v41, v78, v86
    v_cvt_pk_bf16_f32 v65, v79, v87
    v_cvt_pk_bf16_f32 v69, v82, v90
    v_cvt_pk_bf16_f32 v73, v80, v88
    v_lshlrev_b32 v76, 16, v34
    v_and_b32 v84, s25, v34
    v_lshlrev_b32 v77, 16, v38
    v_and_b32 v85, s25, v38
    v_lshlrev_b32 v78, 16, v42
    v_and_b32 v86, s25, v42
    v_lshlrev_b32 v79, 16, v46
    v_and_b32 v87, s25, v46
    v_add_f32 v80, v76, v78
    v_add_f32 v88, v84, v86
    v_add_f32 v81, v77, v79
    v_add_f32 v89, v85, v87
    v_fma_f32 v82, v78, 4.0, v76
    v_fma_f32 v90, v86, 4.0, v84
    v_fma_f32 v83, v79, 4.0, v77
    v_fma_f32 v91, v87, 4.0, v85
    v_add_f32 v77, v80, v81
    v_add_f32 v85, v88, v89
    v_sub_f32 v78, v80, v81
    v_sub_f32 v86, v88, v89
    v_fma_f32 v79, v83, 2.0, v82
    v_fma_f32 v87, v91, 2.0, v90
    v_fma_f32 v82, v83, -2.0, v82
    v_fma_f32 v90, v91, -2.0, v90
    v_fmamk_f32 v80, v76, 0x41700000, v82
    v_fmamk_f32 v88, v84, 0x41700000, v90
    buffer_load_dwordx4 v[4:7], v93, s[8:11], s24 offen offset:0
    buffer_load_dwordx4 v[20:23], v93, s[8:11], s24 offen offset:64
    v_add_u32 v93, 128, v93
    v_fmamk_f32 v80, v81, 0x41200000, v80
    v_fmamk_f32 v88, v89, 0x41200000, v88
    v_cvt_pk_bf16_f32 v38, v77, v85
    v_cvt_pk_bf16_f32 v42, v78, v86
    v_cvt_pk_bf16_f32 v66, v79, v87
    v_cvt_pk_bf16_f32 v70, v82, v90
    v_cvt_pk_bf16_f32 v74, v80, v88
    v_lshlrev_b32 v76, 16, v35
    v_and_b32 v84, s25, v35
    v_lshlrev_b32 v77, 16, v39
    v_and_b32 v85, s25, v39
    v_lshlrev_b32 v78, 16, v43
    v_and_b32 v86, s25, v43
    v_lshlrev_b32 v79, 16, v47
    v_and_b32 v87, s25, v47
    v_add_f32 v80, v76, v78
    v_add_f32 v88, v84, v86
    v_add_f32 v81, v77, v79
    v_add_f32 v89, v85, v87
    v_fma_f32 v82, v78, 4.0, v76
    v_fma_f32 v90, v86, 4.0, v84
    v_fma_f32 v83, v79, 4.0, v77
    v_fma_f32 v91, v87, 4.0, v85
    v_add_f32 v77, v80, v81
    v_add_f32 v85, v88, v89
    v_sub_f32 v78, v80, v81
    v_sub_f32 v86, v88, v89
    v_fma_f32 v79, v83, 2.0, v82
    v_fma_f32 v87, v91, 2.0, v90
    v_fma_f32 v82, v83, -2.0, v82
    v_fma_f32 v90, v91, -2.0, v90
    v_fmamk_f32 v80, v76, 0x41700000, v82
    v_fmamk_f32 v88, v84, 0x41700000, v90
    v_fmamk_f32 v80, v81, 0x41200000, v80
    v_fmamk_f32 v88, v89, 0x41200000, v88
    v_cvt_pk_bf16_f32 v39, v77, v85
    v_cvt_pk_bf16_f32 v43, v78, v86
    v_cvt_pk_bf16_f32 v67, v79, v87
    v_cvt_pk_bf16_f32 v71, v82, v90
    v_cvt_pk_bf16_f32 v75, v80, v88
    s_waitcnt lgkmcnt(0)
    ds_write_b128 v96, v[64:67] offset:49152
    ds_write_b128 v97, v[68:71] offset:0
    ds_write_b128 v97, v[72:75] offset:16384
    ds_write_b128 v96, v[32:35] offset:0
    ds_write_b128 v96, v[36:39] offset:16384
    ds_write_b128 v96, v[40:43] offset:32768
    ds_write_b128 v98, v[44:47] offset:0
    s_add_u32 s28, s28, 1
    s_waitcnt lgkmcnt(0)
    s_barrier
    s_cmp_lt_u32 s28, 13
    s_cselect_b32 s24, 0, 2130706432
    v_lshlrev_b32 v76, 16, v48
    v_and_b32 v84, s25, v48
    v_lshlrev_b32 v77, 16, v52
    v_and_b32 v85, s25, v52
    v_lshlrev_b32 v78, 16, v56
    v_and_b32 v86, s25, v56
    v_lshlrev_b32 v79, 16, v60
    v_and_b32 v87, s25, v60
    v_add_f32 v80, v76, v78
    v_add_f32 v88, v84, v86
    v_add_f32 v81, v77, v79
    v_add_f32 v89, v85, v87
    v_fma_f32 v82, v78, 4.0, v76
    buffer_load_dwordx4 v[8:11], v94, s[8:11], s24 offen offset:0
    buffer_load_dwordx4 v[24:27], v94, s[8:11], s24 offen offset:64
    v_add_u32 v94, 128, v94
    v_fma_f32 v90, v86, 4.0, v84
    v_fma_f32 v83, v79, 4.0, v77
    v_fma_f32 v91, v87, 4.0, v85
    v_add_f32 v77, v80, v81
    v_add_f32 v85, v88, v89
    v_sub_f32 v78, v80, v81
    v_sub_f32 v86, v88, v89
    v_fma_f32 v79, v83, 2.0, v82
    v_fma_f32 v87, v91, 2.0, v90
    v_fma_f32 v82, v83, -2.0, v82
    v_fma_f32 v90, v91, -2.0, v90
    v_fmamk_f32 v80, v76, 0x41700000, v82
    v_fmamk_f32 v88, v84, 0x41700000, v90
    v_fmamk_f32 v80, v81, 0x41200000, v80
    v_fmamk_f32 v88, v89, 0x41200000, v88
    v_cvt_pk_bf16_f32 v52, v77, v85
    v_cvt_pk_bf16_f32 v56, v78, v86
    v_cvt_pk_bf16_f32 v64, v79, v87
    v_cvt_pk_bf16_f32 v68, v82, v90
    v_cvt_pk_bf16_f32 v72, v80, v88
    v_lshlrev_b32 v76, 16, v49
    v_and_b32 v84, s25, v49
    v_lshlrev_b32 v77, 16, v53
    v_and_b32 v85, s25, v53
    v_lshlrev_b32 v78, 16, v57
    v_and_b32 v86, s25, v57
    v_lshlrev_b32 v79, 16, v61
    v_and_b32 v87, s25, v61
    v_add_f32 v80, v76, v78
    v_add_f32 v88, v84, v86
    v_add_f32 v81, v77, v79
    v_add_f32 v89, v85, v87
    v_fma_f32 v82, v78, 4.0, v76
    v_fma_f32 v90, v86, 4.0, v84
    v_fma_f32 v83, v79, 4.0, v77
    v_fma_f32 v91, v87, 4.0, v85
    v_add_f32 v77, v80, v81
    v_add_f32 v85, v88, v89
    v_sub_f32 v78, v80, v81
    v_sub_f32 v86, v88, v89
    v_fma_f32 v79, v83, 2.0, v82
    v_fma_f32 v87, v91, 2.0, v90
    v_fma_f32 v82, v83, -2.0, v82
    v_fma_f32 v90, v91, -2.0, v90
    v_fmamk_f32 v80, v76, 0x41700000, v82
    v_fmamk_f32 v88, v84, 0x41700000, v90
    v_fmamk_f32 v80, v81, 0x41200000, v80
    v_fmamk_f32 v88, v89, 0x41200000, v88
    v_cvt_pk_bf16_f32 v53, v77, v85
    v_cvt_pk_bf16_f32 v57, v78, v86
    v_cvt_pk_bf16_f32 v65, v79, v87
    v_cvt_pk_bf16_f32 v69, v82, v90
    v_cvt_pk_bf16_f32 v73, v80, v88
    buffer_load_dwordx4 v[12:15], v95, s[8:11], s24 offen offset:0
    buffer_load_dwordx4 v[28:31], v95, s[8:11], s24 offen offset:64
    v_add_u32 v95, 128, v95
    v_lshlrev_b32 v76, 16, v50
    v_and_b32 v84, s25, v50
    v_lshlrev_b32 v77, 16, v54
    v_and_b32 v85, s25, v54
    v_lshlrev_b32 v78, 16, v58
    v_and_b32 v86, s25, v58
    v_lshlrev_b32 v79, 16, v62
    v_and_b32 v87, s25, v62
    v_add_f32 v80, v76, v78
    v_add_f32 v88, v84, v86
    v_add_f32 v81, v77, v79
    v_add_f32 v89, v85, v87
    v_fma_f32 v82, v78, 4.0, v76
    v_fma_f32 v90, v86, 4.0, v84
    v_fma_f32 v83, v79, 4.0, v77
    v_fma_f32 v91, v87, 4.0, v85
    v_add_f32 v77, v80, v81
    v_add_f32 v85, v88, v89
    v_sub_f32 v78, v80, v81
    v_sub_f32 v86, v88, v89
    v_fma_f32 v79, v83, 2.0, v82
    v_fma_f32 v87, v91, 2.0, v90
    v_fma_f32 v82, v83, -2.0, v82
    v_fma_f32 v90, v91, -2.0, v90
    v_fmamk_f32 v80, v76, 0x41700000, v82
    v_fmamk_f32 v88, v84, 0x41700000, v90
    v_fmamk_f32 v80, v81, 0x41200000, v80
    v_fmamk_f32 v88, v89, 0x41200000, v88
    v_cvt_pk_bf16_f32 v54, v77, v85
    v_cvt_pk_bf16_f32 v58, v78, v86
    v_cvt_pk_bf16_f32 v66, v79, v87
    v_cvt_pk_bf16_f32 v70, v82, v90
    v_cvt_pk_bf16_f32 v74, v80, v88
    v_lshlrev_b32 v76, 16, v51
    v_and_b32 v84, s25, v51
    v_lshlrev_b32 v77, 16, v55
    v_and_b32 v85, s25, v55
    v_lshlrev_b32 v78, 16, v59
    v_and_b32 v86, s25, v59
    v_lshlrev_b32 v79, 16, v63
    v_and_b32 v87, s25, v63
    v_add_f32 v80, v76, v78
    v_add_f32 v88, v84, v86
    v_add_f32 v81, v77, v79
    v_add_f32 v89, v85, v87
    v_fma_f32 v82, v78, 4.0, v76
    v_fma_f32 v90, v86, 4.0, v84
    v_fma_f32 v83, v79, 4.0, v77
    v_fma_f32 v91, v87, 4.0, v85
    v_add_f32 v77, v80, v81
    v_add_f32 v85, v88, v89
    v_sub_f32 v78, v80, v81
    v_sub_f32 v86, v88, v89
    v_fma_f32 v79, v83, 2.0, v82
    v_fma_f32 v87, v91, 2.0, v90
    v_fma_f32 v82, v83, -2.0, v82
    v_fma_f32 v90, v91, -2.0, v90
    v_fmamk_f32 v80, v76, 0x41700000, v82
    v_fmamk_f32 v88, v84, 0x41700000, v90
    v_fmamk_f32 v80, v81, 0x41200000, v80
    v_fmamk_f32 v88, v89, 0x41200000, v88
    v_cvt_pk_bf16_f32 v55, v77, v85
    v_cvt_pk_bf16_f32 v59, v78, v86
    v_cvt_pk_bf16_f32 v67, v79, v87
    v_cvt_pk_bf16_f32 v71, v82, v90
    v_cvt_pk_bf16_f32 v75, v80, v88
    s_waitcnt lgkmcnt(0)
    ds_write_b128 v96, v[64:67] offset:57344
    ds_write_b128 v97, v[68:71] offset:8192
    ds_write_b128 v97, v[72:75] offset:24576
    ds_write_b128 v96, v[48:51] offset:8192
    ds_write_b128 v96, v[52:55] offset:24576
    ds_write_b128 v96, v[56:59] offset:40960
    ds_write_b128 v98, v[60:63] offset:8704
    s_add_u32 s28, s28, 1
    s_waitcnt lgkmcnt(0)
    s_barrier
    s_cmp_eq_u32 s22, 1
    s_cbranch_scc1 L_conv1_kernel_hlast1
    s_cmp_lt_u32 s28, 13
    s_cselect_b32 s24, 0, 2130706432
    s_waitcnt vmcnt(0)
    v_lshlrev_b32 v76, 16, v0
    v_and_b32 v84, s25, v0
    v_lshlrev_b32 v77, 16, v4
    v_and_b32 v85, s25, v4
    v_lshlrev_b32 v78, 16, v8
    v_and_b32 v86, s25, v8
    v_lshlrev_b32 v79, 16, v12
    v_and_b32 v87, s25, v12
    v_add_f32 v80, v76, v78
    v_add_f32 v88, v84, v86
    v_add_f32 v81, v77, v79
    v_add_f32 v89, v85, v87
    v_fma_f32 v82, v78, 4.0, v76
    v_fma_f32 v90, v86, 4.0, v84
    v_fma_f32 v83, v79, 4.0, v77
    v_fma_f32 v91, v87, 4.0, v85
    v_add_f32 v77, v80, v81
    v_add_f32 v85, v88, v89
    v_sub_f32 v78, v80, v81
    v_sub_f32 v86, v88, v89
    v_fma_f32 v79, v83, 2.0, v82
    v_fma_f32 v87, v91, 2.0, v90
    v_fma_f32 v82, v83, -2.0, v82
    v_fma_f32 v90, v91, -2.0, v90
    v_fmamk_f32 v80, v76, 0x41700000, v82
    v_fmamk_f32 v88, v84, 0x41700000, v90
    v_fmamk_f32 v80, v81, 0x41200000, v80
    v_fmamk_f32 v88, v89, 0x41200000, v88
    v_cvt_pk_bf16_f32 v4, v77, v85
    v_cvt_pk_bf16_f32 v8, v78, v86
    v_cvt_pk_bf16_f32 v64, v79, v87
    v_cvt_pk_bf16_f32 v68, v82, v90
    v_cvt_pk_bf16_f32 v72, v80, v88
    v_lshlrev_b32 v76, 16, v1
    v_and_b32 v84, s25, v1
    v_lshlrev_b32 v77, 16, v5
    v_and_b32 v85, s25, v5
    v_lshlrev_b32 v78, 16, v9
    v_and_b32 v86, s25, v9
    buffer_load_dwordx4 v[32:35], v92, s[8:11], s24 offen offset:0
    buffer_load_dwordx4 v[48:51], v92, s[8:11], s24 offen offset:64
    v_add_u32 v92, 128, v92
    v_lshlrev_b32 v79, 16, v13
    v_and_b32 v87, s25, v13
    v_add_f32 v80, v76, v78
    v_add_f32 v88, v84, v86
    v_add_f32 v81, v77, v79
    v_add_f32 v89, v85, v87
    v_fma_f32 v82, v78, 4.0, v76
    v_fma_f32 v90, v86, 4.0, v84
    v_fma_f32 v83, v79, 4.0, v77
    v_fma_f32 v91, v87, 4.0, v85
    v_add_f32 v77, v80, v81
    v_add_f32 v85, v88, v89
    v_sub_f32 v78, v80, v81
    v_sub_f32 v86, v88, v89
    v_fma_f32 v79, v83, 2.0, v82
    v_fma_f32 v87, v91, 2.0, v90
    v_fma_f32 v82, v83, -2.0, v82
    v_fma_f32 v90, v91, -2.0, v90
    v_fmamk_f32 v80, v76, 0x41700000, v82
    v_fmamk_f32 v88, v84, 0x41700000, v90
    v_fmamk_f32 v80, v81, 0x41200000, v80
    v_fmamk_f32 v88, v89, 0x41200000, v88
    v_cvt_pk_bf16_f32 v5, v77, v85
    v_cvt_pk_bf16_f32 v9, v78, v86
    v_cvt_pk_bf16_f32 v65, v79, v87
    v_cvt_pk_bf16_f32 v69, v82, v90
    v_cvt_pk_bf16_f32 v73, v80, v88
    v_lshlrev_b32 v76, 16, v2
    v_and_b32 v84, s25, v2
    v_lshlrev_b32 v77, 16, v6
    v_and_b32 v85, s25, v6
    v_lshlrev_b32 v78, 16, v10
    v_and_b32 v86, s25, v10
    v_lshlrev_b32 v79, 16, v14
    v_and_b32 v87, s25, v14
    v_add_f32 v80, v76, v78
    v_add_f32 v88, v84, v86
    v_add_f32 v81, v77, v79
    v_add_f32 v89, v85, v87
    v_fma_f32 v82, v78, 4.0, v76
    v_fma_f32 v90, v86, 4.0, v84
    v_fma_f32 v83, v79, 4.0, v77
    v_fma_f32 v91, v87, 4.0, v85
    v_add_f32 v77, v80, v81
    v_add_f32 v85, v88, v89
    v_sub_f32 v78, v80, v81
    v_sub_f32 v86, v88, v89
    v_fma_f32 v79, v83, 2.0, v82
    v_fma_f32 v87, v91, 2.0, v90
    v_fma_f32 v82, v83, -2.0, v82
    v_fma_f32 v90, v91, -2.0, v90
    v_fmamk_f32 v80, v76, 0x41700000, v82
    v_fmamk_f32 v88, v84, 0x41700000, v90
    buffer_load_dwordx4 v[36:39], v93, s[8:11], s24 offen offset:0
    buffer_load_dwordx4 v[52:55], v93, s[8:11], s24 offen offset:64
    v_add_u32 v93, 128, v93
    v_fmamk_f32 v80, v81, 0x41200000, v80
    v_fmamk_f32 v88, v89, 0x41200000, v88
    v_cvt_pk_bf16_f32 v6, v77, v85
    v_cvt_pk_bf16_f32 v10, v78, v86
    v_cvt_pk_bf16_f32 v66, v79, v87
    v_cvt_pk_bf16_f32 v70, v82, v90
    v_cvt_pk_bf16_f32 v74, v80, v88
    v_lshlrev_b32 v76, 16, v3
    v_and_b32 v84, s25, v3
    v_lshlrev_b32 v77, 16, v7
    v_and_b32 v85, s25, v7
    v_lshlrev_b32 v78, 16, v11
    v_and_b32 v86, s25, v11
    v_lshlrev_b32 v79, 16, v15
    v_and_b32 v87, s25, v15
    v_add_f32 v80, v76, v78
    v_add_f32 v88, v84, v86
    v_add_f32 v81, v77, v79
    v_add_f32 v89, v85, v87
    v_fma_f32 v82, v78, 4.0, v76
    v_fma_f32 v90, v86, 4.0, v84
    v_fma_f32 v83, v79, 4.0, v77
    v_fma_f32 v91, v87, 4.0, v85
    v_add_f32 v77, v80, v81
    v_add_f32 v85, v88, v89
    v_sub_f32 v78, v80, v81
    v_sub_f32 v86, v88, v89
    v_fma_f32 v79, v83, 2.0, v82
    v_fma_f32 v87, v91, 2.0, v90
    v_fma_f32 v82, v83, -2.0, v82
    v_fma_f32 v90, v91, -2.0, v90
    v_fmamk_f32 v80, v76, 0x41700000, v82
    v_fmamk_f32 v88, v84, 0x41700000, v90
    v_fmamk_f32 v80, v81, 0x41200000, v80
    v_fmamk_f32 v88, v89, 0x41200000, v88
    v_cvt_pk_bf16_f32 v7, v77, v85
    v_cvt_pk_bf16_f32 v11, v78, v86
    v_cvt_pk_bf16_f32 v67, v79, v87
    v_cvt_pk_bf16_f32 v71, v82, v90
    v_cvt_pk_bf16_f32 v75, v80, v88
    s_waitcnt lgkmcnt(0)
    ds_write_b128 v96, v[64:67] offset:49152
    ds_write_b128 v97, v[68:71] offset:0
    ds_write_b128 v97, v[72:75] offset:16384
    ds_write_b128 v96, v[0:3] offset:0
    ds_write_b128 v96, v[4:7] offset:16384
    ds_write_b128 v96, v[8:11] offset:32768
    ds_write_b128 v98, v[12:15] offset:0
    s_add_u32 s28, s28, 1
    s_waitcnt lgkmcnt(0)
    s_barrier
    s_sub_u32 s22, s22, 1
    s_branch L_conv1_kernel_hloop1
L_conv1_kernel_hlast1:
    s_branch L_conv1_kernel_end
L_conv1_kernel_h2:
    s_waitcnt lgkmcnt(0)
    ds_write_b128 v96, v[0:3] offset:0
    ds_write_b128 v98, v[12:15] offset:0
    v_lshlrev_b32 v76, 16, v0
    v_and_b32 v84, s25, v0
    v_lshlrev_b32 v77, 16, v4
    v_and_b32 v85, s25, v4
    v_lshlrev_b32 v78, 16, v8
    v_and_b32 v86, s25, v8
    v_lshlrev_b32 v79, 16, v12
    v_and_b32 v87, s25, v12
    v_add_f32 v80, v76, v78
    v_add_f32 v88, v84, v86
    v_add_f32 v81, v77, v79
    v_add_f32 v89, v85, v87
    v_fma_f32 v82, v78, 4.0, v76
    v_fma_f32 v90, v86, 4.0, v84
    v_fma_f32 v83, v79, 4.0, v77
    v_fma_f32 v91, v87, 4.0, v85
    v_add_f32 v77, v80, v81
    v_add_f32 v85, v88, v89
    v_sub_f32 v78, v80, v81
    v_sub_f32 v86, v88, v89
    v_fma_f32 v79, v83, 2.0, v82
    v_fma_f32 v87, v91, 2.0, v90
    v_fma_f32 v82, v83, -2.0, v82
    v_fma_f32 v90, v91, -2.0, v90
    v_fmamk_f32 v80, v76, 0x41700000, v82
    v_fmamk_f32 v88, v84, 0x41700000, v90
    v_fmamk_f32 v80, v81, 0x41200000, v80
    v_fmamk_f32 v88, v89, 0x41200000, v88
    v_cvt_pk_bf16_f32 v4, v77, v85
    v_cvt_pk_bf16_f32 v8, v78, v86
    v_cvt_pk_bf16_f32 v64, v79, v87
    v_cvt_pk_bf16_f32 v68, v82, v90
    v_cvt_pk_bf16_f32 v72, v80, v88
    v_lshlrev_b32 v76, 16, v1
    v_and_b32 v84, s25, v1
    v_lshlrev_b32 v77, 16, v5
    v_and_b32 v85, s25, v5
    v_lshlrev_b32 v78, 16, v9
    v_and_b32 v86, s25, v9
    v_lshlrev_b32 v79, 16, v13
    v_and_b32 v87, s25, v13
    v_add_f32 v80, v76, v78
    v_add_f32 v88, v84, v86
    v_add_f32 v81, v77, v79
    v_add_f32 v89, v85, v87
    v_fma_f32 v82, v78, 4.0, v76
    v_fma_f32 v90, v86, 4.0, v84
    v_fma_f32 v83, v79, 4.0, v77
    v_fma_f32 v91, v87, 4.0, v85
    v_add_f32 v77, v80, v81
    v_add_f32 v85, v88, v89
    v_sub_f32 v78, v80, v81
    v_sub_f32 v86, v88, v89
    v_fma_f32 v79, v83, 2.0, v82
    v_fma_f32 v87, v91, 2.0, v90
    v_fma_f32 v82, v83, -2.0, v82
    v_fma_f32 v90, v91, -2.0, v90
    v_fmamk_f32 v80, v76, 0x41700000, v82
    v_fmamk_f32 v88, v84, 0x41700000, v90
    v_fmamk_f32 v80, v81, 0x41200000, v80
    v_fmamk_f32 v88, v89, 0x41200000, v88
    v_cvt_pk_bf16_f32 v5, v77, v85
    v_cvt_pk_bf16_f32 v9, v78, v86
    v_cvt_pk_bf16_f32 v65, v79, v87
    v_cvt_pk_bf16_f32 v69, v82, v90
    v_cvt_pk_bf16_f32 v73, v80, v88
    v_lshlrev_b32 v76, 16, v2
    v_and_b32 v84, s25, v2
    v_lshlrev_b32 v77, 16, v6
    v_and_b32 v85, s25, v6
    v_lshlrev_b32 v78, 16, v10
    v_and_b32 v86, s25, v10
    v_lshlrev_b32 v79, 16, v14
    v_and_b32 v87, s25, v14
    v_add_f32 v80, v76, v78
    v_add_f32 v88, v84, v86
    v_add_f32 v81, v77, v79
    v_add_f32 v89, v85, v87
    v_fma_f32 v82, v78, 4.0, v76
    v_fma_f32 v90, v86, 4.0, v84
    v_fma_f32 v83, v79, 4.0, v77
    v_fma_f32 v91, v87, 4.0, v85
    v_add_f32 v77, v80, v81
    v_add_f32 v85, v88, v89
    v_sub_f32 v78, v80, v81
    v_sub_f32 v86, v88, v89
    v_fma_f32 v79, v83, 2.0, v82
    v_fma_f32 v87, v91, 2.0, v90
    v_fma_f32 v82, v83, -2.0, v82
    v_fma_f32 v90, v91, -2.0, v90
    v_fmamk_f32 v80, v76, 0x41700000, v82
    v_fmamk_f32 v88, v84, 0x41700000, v90
    v_fmamk_f32 v80, v81, 0x41200000, v80
    v_fmamk_f32 v88, v89, 0x41200000, v88
    v_cvt_pk_bf16_f32 v6, v77, v85
    v_cvt_pk_bf16_f32 v10, v78, v86
    v_cvt_pk_bf16_f32 v66, v79, v87
    v_cvt_pk_bf16_f32 v70, v82, v90
    v_cvt_pk_bf16_f32 v74, v80, v88
    v_lshlrev_b32 v76, 16, v3
    v_and_b32 v84, s25, v3
    v_lshlrev_b32 v77, 16, v7
    v_and_b32 v85, s25, v7
    v_lshlrev_b32 v78, 16, v11
    v_and_b32 v86, s25, v11
    v_lshlrev_b32 v79, 16, v15
    v_and_b32 v87, s25, v15
    v_add_f32 v80, v76, v78
    v_add_f32 v88, v84, v86
    v_add_f32 v81, v77, v79
    v_add_f32 v89, v85, v87
    v_fma_f32 v82, v78, 4.0, v76
    v_fma_f32 v90, v86, 4.0, v84
    v_fma_f32 v83, v79, 4.0, v77
    v_fma_f32 v91, v87, 4.0, v85
    v_add_f32 v77, v80, v81
    v_add_f32 v85, v88, v89
    v_sub_f32 v78, v80, v81
    v_sub_f32 v86, v88, v89
    v_fma_f32 v79, v83, 2.0, v82
    v_fma_f32 v87, v91, 2.0, v90
    v_fma_f32 v82, v83, -2.0, v82
    v_fma_f32 v90, v91, -2.0, v90
    v_fmamk_f32 v80, v76, 0x41700000, v82
    v_fmamk_f32 v88, v84, 0x41700000, v90
    v_fmamk_f32 v80, v81, 0x41200000, v80
    v_fmamk_f32 v88, v89, 0x41200000, v88
    v_cvt_pk_bf16_f32 v7, v77, v85
    v_cvt_pk_bf16_f32 v11, v78, v86
    v_cvt_pk_bf16_f32 v67, v79, v87
    v_cvt_pk_bf16_f32 v71, v82, v90
    v_cvt_pk_bf16_f32 v75, v80, v88
    ds_write_b128 v96, v[4:7] offset:16384
    ds_write_b128 v96, v[8:11] offset:32768
    ds_write_b128 v96, v[64:67] offset:49152
    ds_write_b128 v97, v[68:71] offset:0
    ds_write_b128 v97, v[72:75] offset:16384
    buffer_load_dwordx4 v[32:35], v92, s[8:11], s24 offen offset:0
    buffer_load_dwordx4 v[48:51], v92, s[8:11], s24 offen offset:64
    v_add_u32 v92, 128, v92
    buffer_load_dwordx4 v[36:39], v93, s[8:11], s24 offen offset:0
    buffer_load_dwordx4 v[52:55], v93, s[8:11], s24 offen offset:64
    v_add_u32 v93, 128, v93
    buffer_load_dwordx4 v[40:43], v94, s[8:11], s24 offen offset:0
    buffer_load_dwordx4 v[56:59], v94, s[8:11], s24 offen offset:64
    v_add_u32 v94, 128, v94
    buffer_load_dwordx4 v[44:47], v95, s[8:11], s24 offen offset:0
    buffer_load_dwordx4 v[60:63], v95, s[8:11], s24 offen offset:64
    v_add_u32 v95, 128, v95
    s_waitcnt lgkmcnt(0)
    s_barrier
    s_setprio 0
    v_lshlrev_b32 v76, 16, v16
    v_and_b32 v84, s25, v16
    v_lshlrev_b32 v77, 16, v20
    v_and_b32 v85, s25, v20
    v_lshlrev_b32 v78, 16, v24
    v_and_b32 v86, s25, v24
    v_lshlrev_b32 v79, 16, v28
    v_and_b32 v87, s25, v28
    v_add_f32 v80, v76, v78
    v_add_f32 v88, v84, v86
    v_add_f32 v81, v77, v79
    v_add_f32 v89, v85, v87
    v_fma_f32 v82, v78, 4.0, v76
    v_fma_f32 v90, v86, 4.0, v84
    v_fma_f32 v83, v79, 4.0, v77
    v_fma_f32 v91, v87, 4.0, v85
    v_add_f32 v77, v80, v81
    v_add_f32 v85, v88, v89
    v_sub_f32 v78, v80, v81
    v_sub_f32 v86, v88, v89
    v_fma_f32 v79, v83, 2.0, v82
    v_fma_f32 v87, v91, 2.0, v90
    v_fma_f32 v82, v83, -2.0, v82
    v_fma_f32 v90, v91, -2.0, v90
    v_fmamk_f32 v80, v76, 0x41700000, v82
    v_fmamk_f32 v88, v84, 0x41700000, v90
    v_fmamk_f32 v80, v81, 0x41200000, v80
    v_fmamk_f32 v88, v89, 0x41200000, v88
    v_cvt_pk_bf16_f32 v20, v77, v85
    v_cvt_pk_bf16_f32 v24, v78, v86
    v_cvt_pk_bf16_f32 v64, v79, v87
    v_cvt_pk_bf16_f32 v68, v82, v90
    v_cvt_pk_bf16_f32 v72, v80, v88
    v_lshlrev_b32 v76, 16, v17
    v_and_b32 v84, s25, v17
    v_lshlrev_b32 v77, 16, v21
    v_and_b32 v85, s25, v21
    v_lshlrev_b32 v78, 16, v25
    v_and_b32 v86, s25, v25
    v_lshlrev_b32 v79, 16, v29
    v_and_b32 v87, s25, v29
    v_add_f32 v80, v76, v78
    v_add_f32 v88, v84, v86
    v_add_f32 v81, v77, v79
    v_add_f32 v89, v85, v87
    v_fma_f32 v82, v78, 4.0, v76
    v_fma_f32 v90, v86, 4.0, v84
    v_fma_f32 v83, v79, 4.0, v77
    v_fma_f32 v91, v87, 4.0, v85
    v_add_f32 v77, v80, v81
    v_add_f32 v85, v88, v89
    v_sub_f32 v78, v80, v81
    v_sub_f32 v86, v88, v89
    v_fma_f32 v79, v83, 2.0, v82
    v_fma_f32 v87, v91, 2.0, v90
    v_fma_f32 v82, v83, -2.0, v82
    v_fma_f32 v90, v91, -2.0, v90
    v_fmamk_f32 v80, v76, 0x41700000, v82
    v_fmamk_f32 v88, v84, 0x41700000, v90
    v_fmamk_f32 v80, v81, 0x41200000, v80
    v_fmamk_f32 v88, v89, 0x41200000, v88
    v_cvt_pk_bf16_f32 v21, v77, v85
    v_cvt_pk_bf16_f32 v25, v78, v86
    v_cvt_pk_bf16_f32 v65, v79, v87
    v_cvt_pk_bf16_f32 v69, v82, v90
    v_cvt_pk_bf16_f32 v73, v80, v88
    v_lshlrev_b32 v76, 16, v18
    v_and_b32 v84, s25, v18
    v_lshlrev_b32 v77, 16, v22
    v_and_b32 v85, s25, v22
    v_lshlrev_b32 v78, 16, v26
    v_and_b32 v86, s25, v26
    v_lshlrev_b32 v79, 16, v30
    v_and_b32 v87, s25, v30
    v_add_f32 v80, v76, v78
    v_add_f32 v88, v84, v86
    v_add_f32 v81, v77, v79
    v_add_f32 v89, v85, v87
    v_fma_f32 v82, v78, 4.0, v76
    v_fma_f32 v90, v86, 4.0, v84
    v_fma_f32 v83, v79, 4.0, v77
    v_fma_f32 v91, v87, 4.0, v85
    v_add_f32 v77, v80, v81
    v_add_f32 v85, v88, v89
    v_sub_f32 v78, v80, v81
    v_sub_f32 v86, v88, v89
    v_fma_f32 v79, v83, 2.0, v82
    v_fma_f32 v87, v91, 2.0, v90
    v_fma_f32 v82, v83, -2.0, v82
    v_fma_f32 v90, v91, -2.0, v90
    v_fmamk_f32 v80, v76, 0x41700000, v82
    v_fmamk_f32 v88, v84, 0x41700000, v90
    v_fmamk_f32 v80, v81, 0x41200000, v80
    v_fmamk_f32 v88, v89, 0x41200000, v88
    v_cvt_pk_bf16_f32 v22, v77, v85
    v_cvt_pk_bf16_f32 v26, v78, v86
    v_cvt_pk_bf16_f32 v66, v79, v87
    v_cvt_pk_bf16_f32 v70, v82, v90
    v_cvt_pk_bf16_f32 v74, v80, v88
    v_lshlrev_b32 v76, 16, v19
    v_and_b32 v84, s25, v19
    v_lshlrev_b32 v77, 16, v23
    v_and_b32 v85, s25, v23
    v_lshlrev_b32 v78, 16, v27
    v_and_b32 v86, s25, v27
    v_lshlrev_b32 v79, 16, v31
    v_and_b32 v87, s25, v31
    v_add_f32 v80, v76, v78
    v_add_f32 v88, v84, v86
    v_add_f32 v81, v77, v79
    v_add_f32 v89, v85, v87
    v_fma_f32 v82, v78, 4.0, v76
    v_fma_f32 v90, v86, 4.0, v84
    v_fma_f32 v83, v79, 4.0, v77
    v_fma_f32 v91, v87, 4.0, v85
    v_add_f32 v77, v80, v81
    v_add_f32 v85, v88, v89
    v_sub_f32 v78, v80, v81
    v_sub_f32 v86, v88, v89
    v_fma_f32 v79, v83, 2.0, v82
    v_fma_f32 v87, v91, 2.0, v90
    v_fma_f32 v82, v83, -2.0, v82
    v_fma_f32 v90, v91, -2.0, v90
    v_fmamk_f32 v80, v76, 0x41700000, v82
    v_fmamk_f32 v88, v84, 0x41700000, v90
    v_fmamk_f32 v80, v81, 0x41200000, v80
    v_fmamk_f32 v88, v89, 0x41200000, v88
    v_cvt_pk_bf16_f32 v23, v77, v85
    v_cvt_pk_bf16_f32 v27, v78, v86
    v_cvt_pk_bf16_f32 v67, v79, v87
    v_cvt_pk_bf16_f32 v71, v82, v90
    v_cvt_pk_bf16_f32 v75, v80, v88
L_conv1_kernel_hloop2:
    s_cmp_lt_u32 s28, 12
    s_cselect_b32 s24, 0, 2130706432
    ds_write_b128 v96, v[64:67] offset:57344
    ds_write_b128 v97, v[68:71] offset:8192
    ds_write_b128 v97, v[72:75] offset:24576
    ds_write_b128 v96, v[16:19] offset:8192
    ds_write_b128 v96, v[20:23] offset:24576
    ds_write_b128 v96, v[24:27] offset:40960
    ds_write_b128 v98, v[28:31] offset:8704
    s_waitcnt lgkmcnt(0)
    s_waitcnt vmcnt(0)
    v_lshlrev_b32 v76, 16, v32
    v_and_b32 v84, s25, v32
    v_lshlrev_b32 v77, 16, v36
    v_and_b32 v85, s25, v36
    v_lshlrev_b32 v78, 16, v40
    v_and_b32 v86, s25, v40
    v_lshlrev_b32 v79, 16, v44
    v_and_b32 v87, s25, v44
    v_add_f32 v80, v76, v78
    v_add_f32 v88, v84, v86
    v_add_f32 v81, v77, v79
    v_add_f32 v89, v85, v87
    v_fma_f32 v82, v78, 4.0, v76
    v_fma_f32 v90, v86, 4.0, v84
    v_fma_f32 v83, v79, 4.0, v77
    v_fma_f32 v91, v87, 4.0, v85
    v_add_f32 v77, v80, v81
    v_add_f32 v85, v88, v89
    v_sub_f32 v78, v80, v81
    v_sub_f32 v86, v88, v89
    v_fma_f32 v79, v83, 2.0, v82
    v_fma_f32 v87, v91, 2.0, v90
    v_fma_f32 v82, v83, -2.0, v82
    v_fma_f32 v90, v91, -2.0, v90
    v_fmamk_f32 v80, v76, 0x41700000, v82
    v_fmamk_f32 v88, v84, 0x41700000, v90
    v_fmamk_f32 v80, v81, 0x41200000, v80
    v_fmamk_f32 v88, v89, 0x41200000, v88
    v_cvt_pk_bf16_f32 v36, v77, v85
    v_cvt_pk_bf16_f32 v40, v78, v86
    v_cvt_pk_bf16_f32 v64, v79, v87
    v_cvt_pk_bf16_f32 v68, v82, v90
    v_cvt_pk_bf16_f32 v72, v80, v88
    v_lshlrev_b32 v76, 16, v33
    v_and_b32 v84, s25, v33
    v_lshlrev_b32 v77, 16, v37
    v_and_b32 v85, s25, v37
    v_lshlrev_b32 v78, 16, v41
    v_and_b32 v86, s25, v41
    buffer_load_dwordx4 v[0:3], v92, s[8:11], s24 offen offset:0
    buffer_load_dwordx4 v[16:19], v92, s[8:11], s24 offen offset:64
    v_add_u32 v92, 128, v92
    v_lshlrev_b32 v79, 16, v45
    v_and_b32 v87, s25, v45
    v_add_f32 v80, v76, v78
    v_add_f32 v88, v84, v86
    v_add_f32 v81, v77, v79
    v_add_f32 v89, v85, v87
    v_fma_f32 v82, v78, 4.0, v76
    v_fma_f32 v90, v86, 4.0, v84
    v_fma_f32 v83, v79, 4.0, v77
    v_fma_f32 v91, v87, 4.0, v85
    v_add_f32 v77, v80, v81
    v_add_f32 v85, v88, v89
    v_sub_f32 v78, v80, v81
    v_sub_f32 v86, v88, v89
    v_fma_f32 v79, v83, 2.0, v82
    v_fma_f32 v87, v91, 2.0, v90
    v_fma_f32 v82, v83, -2.0, v82
    v_fma_f32 v90, v91, -2.0, v90
    v_fmamk_f32 v80, v76, 0x41700000, v82
    v_fmamk_f32 v88, v84, 0x41700000, v90
    v_fmamk_f32 v80, v81, 0x41200000, v80
    v_fmamk_f32 v88, v89, 0x41200000, v88
    v_cvt_pk_bf16_f32 v37, v77, v85
    v_cvt_pk_bf16_f32 v41, v78, v86
    v_cvt_pk_bf16_f32 v65, v79, v87
    v_cvt_pk_bf16_f32 v69, v82, v90
    v_cvt_pk_bf16_f32 v73, v80, v88
    v_lshlrev_b32 v76, 16, v34
    v_and_b32 v84, s25, v34
    v_lshlrev_b32 v77, 16, v38
    v_and_b32 v85, s25, v38
    v_lshlrev_b32 v78, 16, v42
    v_and_b32 v86, s25, v42
    v_lshlrev_b32 v79, 16, v46
    v_and_b32 v87, s25, v46
    v_add_f32 v80, v76, v78
    v_add_f32 v88, v84, v86
    v_add_f32 v81, v77, v79
    v_add_f32 v89, v85, v87
    v_fma_f32 v82, v78, 4.0, v76
    v_fma_f32 v90, v86, 4.0, v84
    v_fma_f32 v83, v79, 4.0, v77
    v_fma_f32 v91, v87, 4.0, v85
    v_add_f32 v77, v80, v81
    v_add_f32 v85, v88, v89
    v_sub_f32 v78, v80, v81
    v_sub_f32 v86, v88, v89
    v_fma_f32 v79, v83, 2.0, v82
    v_fma_f32 v87, v91, 2.0, v90
    v_fma_f32 v82, v83, -2.0, v82
    v_fma_f32 v90, v91, -2.0, v90
    v_fmamk_f32 v80, v76, 0x41700000, v82
    v_fmamk_f32 v88, v84, 0x41700000, v90
    buffer_load_dwordx4 v[4:7], v93, s[8:11], s24 offen offset:0
    buffer_load_dwordx4 v[20:23], v93, s[8:11], s24 offen offset:64
    v_add_u32 v93, 128, v93
    v_fmamk_f32 v80, v81, 0x41200000, v80
    v_fmamk_f32 v88, v89, 0x41200000, v88
    v_cvt_pk_bf16_f32 v38, v77, v85
    v_cvt_pk_bf16_f32 v42, v78, v86
    v_cvt_pk_bf16_f32 v66, v79, v87
    v_cvt_pk_bf16_f32 v70, v82, v90
    v_cvt_pk_bf16_f32 v74, v80, v88
    v_lshlrev_b32 v76, 16, v35
    v_and_b32 v84, s25, v35
    v_lshlrev_b32 v77, 16, v39
    v_and_b32 v85, s25, v39
    v_lshlrev_b32 v78, 16, v43
    v_and_b32 v86, s25, v43
    v_lshlrev_b32 v79, 16, v47
    v_and_b32 v87, s25, v47
    v_add_f32 v80, v76, v78
    v_add_f32 v88, v84, v86
    v_add_f32 v81, v77, v79
    v_add_f32 v89, v85, v87
    v_fma_f32 v82, v78, 4.0, v76
    v_fma_f32 v90, v86, 4.0, v84
    v_fma_f32 v83, v79, 4.0, v77
    v_fma_f32 v91, v87, 4.0, v85
    v_add_f32 v77, v80, v81
    v_add_f32 v85, v88, v89
    v_sub_f32 v78, v80, v81
    v_sub_f32 v86, v88, v89
    v_fma_f32 v79, v83, 2.0, v82
    v_fma_f32 v87, v91, 2.0, v90
    v_fma_f32 v82, v83, -2.0, v82
    v_fma_f32 v90, v91, -2.0, v90
    v_fmamk_f32 v80, v76, 0x41700000, v82
    v_fmamk_f32 v88, v84, 0x41700000, v90
    v_fmamk_f32 v80, v81, 0x41200000, v80
    v_fmamk_f32 v88, v89, 0x41200000, v88
    v_cvt_pk_bf16_f32 v39, v77, v85
    v_cvt_pk_bf16_f32 v43, v78, v86
    v_cvt_pk_bf16_f32 v67, v79, v87
    v_cvt_pk_bf16_f32 v71, v82, v90
    v_cvt_pk_bf16_f32 v75, v80, v88
    s_add_u32 s28, s28, 1
    s_waitcnt lgkmcnt(0)
    s_barrier
    s_cmp_lt_u32 s28, 12
    s_cselect_b32 s24, 0, 2130706432
    ds_write_b128 v96, v[64:67] offset:49152
    ds_write_b128 v97, v[68:71] offset:0
    ds_write_b128 v97, v[72:75] offset:16384
    ds_write_b128 v96, v[32:35] offset:0
    ds_write_b128 v96, v[36:39] offset:16384
    ds_write_b128 v96, v[40:43] offset:32768
    ds_write_b128 v98, v[44:47] offset:0
    s_waitcnt lgkmcnt(0)
    v_lshlrev_b32 v76, 16, v48
    v_and_b32 v84, s25, v48
    buffer_load_dwordx4 v[8:11], v94, s[8:11], s24 offen offset:0
    buffer_load_dwordx4 v[24:27], v94, s[8:11], s24 offen offset:64
    v_add_u32 v94, 128, v94
    v_lshlrev_b32 v77, 16, v52
    v_and_b32 v85, s25, v52
    v_lshlrev_b32 v78, 16, v56
    v_and_b32 v86, s25, v56
    v_lshlrev_b32 v79, 16, v60
    v_and_b32 v87, s25, v60
    v_add_f32 v80, v76, v78
    v_add_f32 v88, v84, v86
    v_add_f32 v81, v77, v79
    v_add_f32 v89, v85, v87
    v_fma_f32 v82, v78, 4.0, v76
    v_fma_f32 v90, v86, 4.0, v84
    v_fma_f32 v83, v79, 4.0, v77
    v_fma_f32 v91, v87, 4.0, v85
    v_add_f32 v77, v80, v81
    v_add_f32 v85, v88, v89
    v_sub_f32 v78, v80, v81
    buffer_load_dwordx4 v[12:15], v95, s[8:11], s24 offen offset:0
    buffer_load_dwordx4 v[28:31], v95, s[8:11], s24 offen offset:64
    v_add_u32 v95, 128, v95
    v_sub_f32 v86, v88, v89
    v_fma_f32 v79, v83, 2.0, v82
    v_fma_f32 v87, v91, 2.0, v90
    v_fma_f32 v82, v83, -2.0, v82
    v_fma_f32 v90, v91, -2.0, v90
    v_fmamk_f32 v80, v76, 0x41700000, v82
    v_fmamk_f32 v88, v84, 0x41700000, v90
    v_fmamk_f32 v80, v81, 0x41200000, v80
    v_fmamk_f32 v88, v89, 0x41200000, v88
    v_cvt_pk_bf16_f32 v52, v77, v85
    v_cvt_pk_bf16_f32 v56, v78, v86
    v_cvt_pk_bf16_f32 v64, v79, v87
    v_cvt_pk_bf16_f32 v68, v82, v90
    v_cvt_pk_bf16_f32 v72, v80, v88
    v_lshlrev_b32 v76, 16, v49
    v_and_b32 v84, s25, v49
    v_lshlrev_b32 v77, 16, v53
    v_and_b32 v85, s25, v53
    v_lshlrev_b32 v78, 16, v57
    v_and_b32 v86, s25, v57
    v_lshlrev_b32 v79, 16, v61
    v_and_b32 v87, s25, v61
    v_add_f32 v80, v76, v78
    v_add_f32 v88, v84, v86
    v_add_f32 v81, v77, v79
    v_add_f32 v89, v85, v87
    v_fma_f32 v82, v78, 4.0, v76
    v_fma_f32 v90, v86, 4.0, v84
    v_fma_f32 v83, v79, 4.0, v77
    v_fma_f32 v91, v87, 4.0, v85
    v_add_f32 v77, v80, v81
    v_add_f32 v85, v88, v89
    v_sub_f32 v78, v80, v81
    v_sub_f32 v86, v88, v89
    v_fma_f32 v79, v83, 2.0, v82
    v_fma_f32 v87, v91, 2.0, v90
    v_fma_f32 v82, v83, -2.0, v82
    v_fma_f32 v90, v91, -2.0, v90
    v_fmamk_f32 v80, v76, 0x41700000, v82
    v_fmamk_f32 v88, v84, 0x41700000, v90
    v_fmamk_f32 v80, v81, 0x41200000, v80
    v_fmamk_f32 v88, v89, 0x41200000, v88
    v_cvt_pk_bf16_f32 v53, v77, v85
    v_cvt_pk_bf16_f32 v57, v78, v86
    v_cvt_pk_bf16_f32 v65, v79, v87
    v_cvt_pk_bf16_f32 v69, v82, v90
    v_cvt_pk_bf16_f32 v73, v80, v88
    v_lshlrev_b32 v76, 16, v50
    v_and_b32 v84, s25, v50
    v_lshlrev_b32 v77, 16, v54
    v_and_b32 v85, s25, v54
    v_lshlrev_b32 v78, 16, v58
    v_and_b32 v86, s25, v58
    v_lshlrev_b32 v79, 16, v62
    v_and_b32 v87, s25, v62
    v_add_f32 v80, v76, v78
    v_add_f32 v88, v84, v86
    v_add_f32 v81, v77, v79
    v_add_f32 v89, v85, v87
    v_fma_f32 v82, v78, 4.0, v76
    v_fma_f32 v90, v86, 4.0, v84
    v_fma_f32 v83, v79, 4.0, v77
    v_fma_f32 v91, v87, 4.0, v85
    v_add_f32 v77, v80, v81
    v_add_f32 v85, v88, v89
    v_sub_f32 v78, v80, v81
    v_sub_f32 v86, v88, v89
    v_fma_f32 v79, v83, 2.0, v82
    v_fma_f32 v87, v91, 2.0, v90
    v_fma_f32 v82, v83, -2.0, v82
    v_fma_f32 v90, v91, -2.0, v90
    v_fmamk_f32 v80, v76, 0x41700000, v82
    v_fmamk_f32 v88, v84, 0x41700000, v90
    v_fmamk_f32 v80, v81, 0x41200000, v80
    v_fmamk_f32 v88, v89, 0x41200000, v88
    v_cvt_pk_bf16_f32 v54, v77, v85
    v_cvt_pk_bf16_f32 v58, v78, v86
    v_cvt_pk_bf16_f32 v66, v79, v87
    v_cvt_pk_bf16_f32 v70, v82, v90
    v_cvt_pk_bf16_f32 v74, v80, v88
    v_lshlrev_b32 v76, 16, v51
    v_and_b32 v84, s25, v51
    v_lshlrev_b32 v77, 16, v55
    v_and_b32 v85, s25, v55
    v_lshlrev_b32 v78, 16, v59
    v_and_b32 v86, s25, v59
    v_lshlrev_b32 v79, 16, v63
    v_and_b32 v87, s25, v63
    v_add_f32 v80, v76, v78
    v_add_f32 v88, v84, v86
    v_add_f32 v81, v77, v79
    v_add_f32 v89, v85, v87
    v_fma_f32 v82, v78, 4.0, v76
    v_fma_f32 v90, v86, 4.0, v84
    v_fma_f32 v83, v79, 4.0, v77
    v_fma_f32 v91, v87, 4.0, v85
    v_add_f32 v77, v80, v81
    v_add_f32 v85, v88, v89
    v_sub_f32 v78, v80, v81
    v_sub_f32 v86, v88, v89
    v_fma_f32 v79, v83, 2.0, v82
    v_fma_f32 v87, v91, 2.0, v90
    v_fma_f32 v82, v83, -2.0, v82
    v_fma_f32 v90, v91, -2.0, v90
    v_fmamk_f32 v80, v76, 0x41700000, v82
    v_fmamk_f32 v88, v84, 0x41700000, v90
    v_fmamk_f32 v80, v81, 0x41200000, v80
    v_fmamk_f32 v88, v89, 0x41200000, v88
    v_cvt_pk_bf16_f32 v55, v77, v85
    v_cvt_pk_bf16_f32 v59, v78, v86
    v_cvt_pk_bf16_f32 v67, v79, v87
    v_cvt_pk_bf16_f32 v71, v82, v90
    v_cvt_pk_bf16_f32 v75, v80, v88
    s_add_u32 s28, s28, 1
    s_waitcnt lgkmcnt(0)
    s_barrier
    s_cmp_eq_u32 s22, 1
    s_cbranch_scc1 L_conv1_kernel_hlast2
    s_cmp_lt_u32 s28, 12
    s_cselect_b32 s24, 0, 2130706432
    ds_write_b128 v96, v[64:67] offset:57344
    ds_write_b128 v97, v[68:71] offset:8192
    ds_write_b128 v97, v[72:75] offset:24576
    ds_write_b128 v96, v[48:51] offset:8192
    ds_write_b128 v96, v[52:55] offset:24576
    ds_write_b128 v96, v[56:59] offset:40960
    ds_write_b128 v98, v[60:63] offset:8704
    s_waitcnt lgkmcnt(0)
    s_waitcnt vmcnt(0)
    v_lshlrev_b32 v76, 16, v0
    v_and_b32 v84, s25, v0
    v_lshlrev_b32 v77, 16, v4
    v_and_b32 v85, s25, v4
    v_lshlrev_b32 v78, 16, v8
    v_and_b32 v86, s25, v8
    v_lshlrev_b32 v79, 16, v12
    v_and_b32 v87, s25, v12
    v_add_f32 v80, v76, v78
    v_add_f32 v88, v84, v86
    v_add_f32 v81, v77, v79
    v_add_f32 v89, v85, v87
    v_fma_f32 v82, v78, 4.0, v76
    v_fma_f32 v90, v86, 4.0, v84
    v_fma_f32 v83, v79, 4.0, v77
    v_fma_f32 v91, v87, 4.0, v85
    v_add_f32 v77, v80, v81
    v_add_f32 v85, v88, v89
    v_sub_f32 v78, v80, v81
    v_sub_f32 v86, v88, v89
    v_fma_f32 v79, v83, 2.0, v82
    v_fma_f32 v87, v91, 2.0, v90
    v_fma_f32 v82, v83, -2.0, v82
    v_fma_f32 v90, v91, -2.0, v90
    v_fmamk_f32 v80, v76, 0x41700000, v82
    v_fmamk_f32 v88, v84, 0x41700000, v90
    v_fmamk_f32 v80, v81, 0x41200000, v80
    v_fmamk_f32 v88, v89, 0x41200000, v88
    v_cvt_pk_bf16_f32 v4, v77, v85
    v_cvt_pk_bf16_f32 v8, v78, v86
    v_cvt_pk_bf16_f32 v64, v79, v87
    v_cvt_pk_bf16_f32 v68, v82, v90
    v_cvt_pk_bf16_f32 v72, v80, v88
    v_lshlrev_b32 v76, 16, v1
    v_and_b32 v84, s25, v1
    v_lshlrev_b32 v77, 16, v5
    v_and_b32 v85, s25, v5
    v_lshlrev_b32 v78, 16, v9
    v_and_b32 v86, s25, v9
    buffer_load_dwordx4 v[32:35], v92, s[8:11], s24 offen offset:0
    buffer_load_dwordx4 v[48:51], v92, s[8:11], s24 offen offset:64
    v_add_u32 v92, 128, v92
    v_lshlrev_b32 v79, 16, v13
    v_and_b32 v87, s25, v13
    v_add_f32 v80, v76, v78
    v_add_f32 v88, v84, v86
    v_add_f32 v81, v77, v79
    v_add_f32 v89, v85, v87
    v_fma_f32 v82, v78, 4.0, v76
    v_fma_f32 v90, v86, 4.0, v84
    v_fma_f32 v83, v79, 4.0, v77
    v_fma_f32 v91, v87, 4.0, v85
    v_add_f32 v77, v80, v81
    v_add_f32 v85, v88, v89
    v_sub_f32 v78, v80, v81
    v_sub_f32 v86, v88, v89
    v_fma_f32 v79, v83, 2.0, v82
    v_fma_f32 v87, v91, 2.0, v90
    v_fma_f32 v82, v83, -2.0, v82
    v_fma_f32 v90, v91, -2.0, v90
    v_fmamk_f32 v80, v76, 0x41700000, v82
    v_fmamk_f32 v88, v84, 0x41700000, v90
    v_fmamk_f32 v80, v81, 0x41200000, v80
    v_fmamk_f32 v88, v89, 0x41200000, v88
    v_cvt_pk_bf16_f32 v5, v77, v85
    v_cvt_pk_bf16_f32 v9, v78, v86
    v_cvt_pk_bf16_f32 v65, v79, v87
    v_cvt_pk_bf16_f32 v69, v82, v90
    v_cvt_pk_bf16_f32 v73, v80, v88
    v_lshlrev_b32 v76, 16, v2
    v_and_b32 v84, s25, v2
    v_lshlrev_b32 v77, 16, v6
    v_and_b32 v85, s25, v6
    v_lshlrev_b32 v78, 16, v10
    v_and_b32 v86, s25, v10
    v_lshlrev_b32 v79, 16, v14
    v_and_b32 v87, s25, v14
    v_add_f32 v80, v76, v78
    v_add_f32 v88, v84, v86
    v_add_f32 v81, v77, v79
    v_add_f32 v89, v85, v87
    v_fma_f32 v82, v78, 4.0, v76
    v_fma_f32 v90, v86, 4.0, v84
    v_fma_f32 v83, v79, 4.0, v77
    v_fma_f32 v91, v87, 4.0, v85
    v_add_f32 v77, v80, v81
    v_add_f32 v85, v88, v89
    v_sub_f32 v78, v80, v81
    v_sub_f32 v86, v88, v89
    v_fma_f32 v79, v83, 2.0, v82
    v_fma_f32 v87, v91, 2.0, v90
    v_fma_f32 v82, v83, -2.0, v82
    v_fma_f32 v90, v91, -2.0, v90
    v_fmamk_f32 v80, v76, 0x41700000, v82
    v_fmamk_f32 v88, v84, 0x41700000, v90
    buffer_load_dwordx4 v[36:39], v93, s[8:11], s24 offen offset:0
    buffer_load_dwordx4 v[52:55], v93, s[8:11], s24 offen offset:64
    v_add_u32 v93, 128, v93
    v_fmamk_f32 v80, v81, 0x41200000, v80
    v_fmamk_f32 v88, v89, 0x41200000, v88
    v_cvt_pk_bf16_f32 v6, v77, v85
    v_cvt_pk_bf16_f32 v10, v78, v86
    v_cvt_pk_bf16_f32 v66, v79, v87
    v_cvt_pk_bf16_f32 v70, v82, v90
    v_cvt_pk_bf16_f32 v74, v80, v88
    v_lshlrev_b32 v76, 16, v3
    v_and_b32 v84, s25, v3
    v_lshlrev_b32 v77, 16, v7
    v_and_b32 v85, s25, v7
    v_lshlrev_b32 v78, 16, v11
    v_and_b32 v86, s25, v11
    v_lshlrev_b32 v79, 16, v15
    v_and_b32 v87, s25, v15
    v_add_f32 v80, v76, v78
    v_add_f32 v88, v84, v86
    v_add_f32 v81, v77, v79
    v_add_f32 v89, v85, v87
    v_fma_f32 v82, v78, 4.0, v76
    v_fma_f32 v90, v86, 4.0, v84
    v_fma_f32 v83, v79, 4.0, v77
    v_fma_f32 v91, v87, 4.0, v85
    v_add_f32 v77, v80, v81
    v_add_f32 v85, v88, v89
    v_sub_f32 v78, v80, v81
    v_sub_f32 v86, v88, v89
    v_fma_f32 v79, v83, 2.0, v82
    v_fma_f32 v87, v91, 2.0, v90
    v_fma_f32 v82, v83, -2.0, v82
    v_fma_f32 v90, v91, -2.0, v90
    v_fmamk_f32 v80, v76, 0x41700000, v82
    v_fmamk_f32 v88, v84, 0x41700000, v90
    v_fmamk_f32 v80, v81, 0x41200000, v80
    v_fmamk_f32 v88, v89, 0x41200000, v88
    v_cvt_pk_bf16_f32 v7, v77, v85
    v_cvt_pk_bf16_f32 v11, v78, v86
    v_cvt_pk_bf16_f32 v67, v79, v87
    v_cvt_pk_bf16_f32 v71, v82, v90
    v_cvt_pk_bf16_f32 v75, v80, v88
    s_add_u32 s28, s28, 1
    s_waitcnt lgkmcnt(0)
    s_barrier
    s_cmp_lt_u32 s28, 12
    s_cselect_b32 s24, 0, 2130706432
    ds_write_b128 v96, v[64:67] offset:49152
    ds_write_b128 v97, v[68:71] offset:0
    ds_write_b128 v97, v[72:75] offset:16384
    ds_write_b128 v96, v[0:3] offset:0
    ds_write_b128 v96, v[4:7] offset:16384
    ds_write_b128 v96, v[8:11] offset:32768
    ds_write_b128 v98, v[12:15] offset:0
    s_waitcnt lgkmcnt(0)
    v_lshlrev_b32 v76, 16, v16
    v_and_b32 v84, s25, v16
    buffer_load_dwordx4 v[40:43], v94, s[8:11], s24 offen offset:0
    buffer_load_dwordx4 v[56:59], v94, s[8:11], s24 offen offset:64
    v_add_u32 v94, 128, v94
    v_lshlrev_b32 v77, 16, v20
    v_and_b32 v85, s25, v20
    v_lshlrev_b32 v78, 16, v24
    v_and_b32 v86, s25, v24
    v_lshlrev_b32 v79, 16, v28
    v_and_b32 v87, s25, v28
    v_add_f32 v80, v76, v78
    v_add_f32 v88, v84, v86
    v_add_f32 v81, v77, v79
    v_add_f32 v89, v85, v87
    v_fma_f32 v82, v78, 4.0, v76
    v_fma_f32 v90, v86, 4.0, v84
    v_fma_f32 v83, v79, 4.0, v77
    v_fma_f32 v91, v87, 4.0, v85
    v_add_f32 v77, v80, v81
    v_add_f32 v85, v88, v89
    v_sub_f32 v78, v80, v81
    buffer_load_dwordx4 v[44:47], v95, s[8:11], s24 offen offset:0
    buffer_load_dwordx4 v[60:63], v95, s[8:11], s24 offen offset:64
    v_add_u32 v95, 128, v95
    v_sub_f32 v86, v88, v89
    v_fma_f32 v79, v83, 2.0, v82
    v_fma_f32 v87, v91, 2.0, v90
    v_fma_f32 v82, v83, -2.0, v82
    v_fma_f32 v90, v91, -2.0, v90
    v_fmamk_f32 v80, v76, 0x41700000, v82
    v_fmamk_f32 v88, v84, 0x41700000, v90
    v_fmamk_f32 v80, v81, 0x41200000, v80
    v_fmamk_f32 v88, v89, 0x41200000, v88
    v_cvt_pk_bf16_f32 v20, v77, v85
    v_cvt_pk_bf16_f32 v24, v78, v86
    v_cvt_pk_bf16_f32 v64, v79, v87
    v_cvt_pk_bf16_f32 v68, v82, v90
    v_cvt_pk_bf16_f32 v72, v80, v88
    v_lshlrev_b32 v76, 16, v17
    v_and_b32 v84, s25, v17
    v_lshlrev_b32 v77, 16, v21
    v_and_b32 v85, s25, v21
    v_lshlrev_b32 v78, 16, v25
    v_and_b32 v86, s25, v25
    v_lshlrev_b32 v79, 16, v29
    v_and_b32 v87, s25, v29
    v_add_f32 v80, v76, v78
    v_add_f32 v88, v84, v86
    v_add_f32 v81, v77, v79
    v_add_f32 v89, v85, v87
    v_fma_f32 v82, v78, 4.0, v76
    v_fma_f32 v90, v86, 4.0, v84
    v_fma_f32 v83, v79, 4.0, v77
    v_fma_f32 v91, v87, 4.0, v85
    v_add_f32 v77, v80, v81
    v_add_f32 v85, v88, v89
    v_sub_f32 v78, v80, v81
    v_sub_f32 v86, v88, v89
    v_fma_f32 v79, v83, 2.0, v82
    v_fma_f32 v87, v91, 2.0, v90
    v_fma_f32 v82, v83, -2.0, v82
    v_fma_f32 v90, v91, -2.0, v90
    v_fmamk_f32 v80, v76, 0x41700000, v82
    v_fmamk_f32 v88, v84, 0x41700000, v90
    v_fmamk_f32 v80, v81, 0x41200000, v80
    v_fmamk_f32 v88, v89, 0x41200000, v88
    v_cvt_pk_bf16_f32 v21, v77, v85
    v_cvt_pk_bf16_f32 v25, v78, v86
    v_cvt_pk_bf16_f32 v65, v79, v87
    v_cvt_pk_bf16_f32 v69, v82, v90
    v_cvt_pk_bf16_f32 v73, v80, v88
    v_lshlrev_b32 v76, 16, v18
    v_and_b32 v84, s25, v18
    v_lshlrev_b32 v77, 16, v22
    v_and_b32 v85, s25, v22
    v_lshlrev_b32 v78, 16, v26
    v_and_b32 v86, s25, v26
    v_lshlrev_b32 v79, 16, v30
    v_and_b32 v87, s25, v30
    v_add_f32 v80, v76, v78
    v_add_f32 v88, v84, v86
    v_add_f32 v81, v77, v79
    v_add_f32 v89, v85, v87
    v_fma_f32 v82, v78, 4.0, v76
    v_fma_f32 v90, v86, 4.0, v84
    v_fma_f32 v83, v79, 4.0, v77
    v_fma_f32 v91, v87, 4.0, v85
    v_add_f32 v77, v80, v81
    v_add_f32 v85, v88, v89
    v_sub_f32 v78, v80, v81
    v_sub_f32 v86, v88, v89
    v_fma_f32 v79, v83, 2.0, v82
    v_fma_f32 v87, v91, 2.0, v90
    v_fma_f32 v82, v83, -2.0, v82
    v_fma_f32 v90, v91, -2.0, v90
    v_fmamk_f32 v80, v76, 0x41700000, v82
    v_fmamk_f32 v88, v84, 0x41700000, v90
    v_fmamk_f32 v80, v81, 0x41200000, v80
    v_fmamk_f32 v88, v89, 0x41200000, v88
    v_cvt_pk_bf16_f32 v22, v77, v85
    v_cvt_pk_bf16_f32 v26, v78, v86
    v_cvt_pk_bf16_f32 v66, v79, v87
    v_cvt_pk_bf16_f32 v70, v82, v90
    v_cvt_pk_bf16_f32 v74, v80, v88
    v_lshlrev_b32 v76, 16, v19
    v_and_b32 v84, s25, v19
    v_lshlrev_b32 v77, 16, v23
    v_and_b32 v85, s25, v23
    v_lshlrev_b32 v78, 16, v27
    v_and_b32 v86, s25, v27
    v_lshlrev_b32 v79, 16, v31
    v_and_b32 v87, s25, v31
    v_add_f32 v80, v76, v78
    v_add_f32 v88, v84, v86
    v_add_f32 v81, v77, v79
    v_add_f32 v89, v85, v87
    v_fma_f32 v82, v78, 4.0, v76
    v_fma_f32 v90, v86, 4.0, v84
    v_fma_f32 v83, v79, 4.0, v77
    v_fma_f32 v91, v87, 4.0, v85
    v_add_f32 v77, v80, v81
    v_add_f32 v85, v88, v89
    v_sub_f32 v78, v80, v81
    v_sub_f32 v86, v88, v89
    v_fma_f32 v79, v83, 2.0, v82
    v_fma_f32 v87, v91, 2.0, v90
    v_fma_f32 v82, v83, -2.0, v82
    v_fma_f32 v90, v91, -2.0, v90
    v_fmamk_f32 v80, v76, 0x41700000, v82
    v_fmamk_f32 v88, v84, 0x41700000, v90
    v_fmamk_f32 v80, v81, 0x41200000, v80
    v_fmamk_f32 v88, v89, 0x41200000, v88
    v_cvt_pk_bf16_f32 v23, v77, v85
    v_cvt_pk_bf16_f32 v27, v78, v86
    v_cvt_pk_bf16_f32 v67, v79, v87
    v_cvt_pk_bf16_f32 v71, v82, v90
    v_cvt_pk_bf16_f32 v75, v80, v88
    s_add_u32 s28, s28, 1
    s_waitcnt lgkmcnt(0)
    s_barrier
    s_sub_u32 s22, s22, 1
    s_branch L_conv1_kernel_hloop2
L_conv1_kernel_hlast2:
    s_waitcnt vmcnt(0)
    s_mov_b32 s58, s20
    s_lshl_b32 s20, s2, 2
    s_add_u32 s20, s20, s32
    v_mov_b32 v1, v127
    s_load_dwordx2 s[8:9], s[0:1], 16
    s_lshr_b32 s22, s20, 8
    s_bfe_u32 s23, s20, 0x40004
    s_bfe_u32 s24, s20, 0x30001
    s_and_b32 s21, s20, 1
    v_lshrrev_b32 v2, 4, v1
    v_lshlrev_b32 v2, 12, v2
    v_and_b32 v3, 15, v1
    v_lshl_add_u32 v2, v3, 2, v2
    s_lshl_b32 s26, s22, 3
    s_lshr_b32 s27, s23, 3
    s_add_u32 s26, s26, s27
    s_lshl_b32 s26, s26, 17
    s_and_b32 s27, s23, 7
    s_lshl_b32 s27, s27, 14
    s_add_u32 s26, s26, s27
    s_lshl_b32 s27, s24, 6
    s_add_u32 s26, s26, s27
    s_mov_b32 s10, 4063232
    s_mov_b32 s11, 0x00020000
    s_add_u32 s37, s26, 262144
    s_add_u32 s38, s26, 524288
    s_add_u32 s39, s26, 786432
    s_waitcnt lgkmcnt(0)
    buffer_load_dword v16, v2, s[8:11], s26 offen offset:0
    buffer_load_dword v17, v2, s[8:11], s26 offen offset:512
    buffer_load_dword v24, v2, s[8:11], s37 offen offset:0
    buffer_load_dword v25, v2, s[8:11], s37 offen offset:512
    buffer_load_dword v32, v2, s[8:11], s38 offen offset:0
    buffer_load_dword v33, v2, s[8:11], s38 offen offset:512
    buffer_load_dword v40, v2, s[8:11], s39 offen offset:0
    buffer_load_dword v41, v2, s[8:11], s39 offen offset:512
    buffer_load_dword v18, v2, s[8:11], s26 offen offset:1024
    buffer_load_dword v19, v2, s[8:11], s26 offen offset:1536
    buffer_load_dword v26, v2, s[8:11], s37 offen offset:1024
    buffer_load_dword v27, v2, s[8:11], s37 offen offset:1536
    buffer_load_dword v34, v2, s[8:11], s38 offen offset:1024
    buffer_load_dword v35, v2, s[8:11], s38 offen offset:1536
    buffer_load_dword v42, v2, s[8:11], s39 offen offset:1024
    buffer_load_dword v43, v2, s[8:11], s39 offen offset:1536
    buffer_load_dword v20, v2, s[8:11], s26 offen offset:2048
    buffer_load_dword v21, v2, s[8:11], s26 offen offset:2560
    buffer_load_dword v28, v2, s[8:11], s37 offen offset:2048
    buffer_load_dword v29, v2, s[8:11], s37 offen offset:2560
    buffer_load_dword v36, v2, s[8:11], s38 offen offset:2048
    buffer_load_dword v37, v2, s[8:11], s38 offen offset:2560
    buffer_load_dword v44, v2, s[8:11], s39 offen offset:2048
    buffer_load_dword v45, v2, s[8:11], s39 offen offset:2560
    buffer_load_dword v22, v2, s[8:11], s26 offen offset:3072
    buffer_load_dword v23, v2, s[8:11], s26 offen offset:3584
    buffer_load_dword v30, v2, s[8:11], s37 offen offset:3072
    buffer_load_dword v31, v2, s[8:11], s37 offen offset:3584
    buffer_load_dword v38, v2, s[8:11], s38 offen offset:3072
    buffer_load_dword v39, v2, s[8:11], s38 offen offset:3584
    buffer_load_dword v46, v2, s[8:11], s39 offen offset:3072
    buffer_load_dword v47, v2, s[8:11], s39 offen offset:3584
    s_add_u32 s12, s30, 9437184
    s_addc_u32 s13, s31, 0
    s_mov_b32 s14, 7340032
    s_mov_b32 s15, 0x00020000
    v_lshlrev_b32 v4, 4, v1
    s_lshl_b32 s27, s24, 4
    s_add_u32 s27, s27, s23
    s_mul_i32 s27, s27, 57344
    s_lshl_b32 s28, s22, 11
    s_add_u32 s27, s27, s28
    s_lshl_b32 s28, s21, 10
    s_add_u32 s27, s27, s28
    s_cmp_eq_u32 s21, 0
    s_mov_b32 s32, 0x07060302
    s_cselect_b32 s32, 0x05040100, s32
    s_mov_b32 s33, 0x03020c0c
    s_cselect_b32 s33, 0x01000c0c, s33
    s_mov_b32 s35, 0x3d2aaaab
    s_mov_b32 s36, 0x3c638e39
    ds_write_b128 v96, v[64:67] offset:57344
    ds_write_b128 v97, v[68:71] offset:8192
    ds_write_b128 v97, v[72:75] offset:24576
    ds_write_b128 v96, v[48:51] offset:8192
    ds_write_b128 v96, v[52:55] offset:24576
    ds_write_b128 v96, v[56:59] offset:40960
    ds_write_b128 v98, v[60:63] offset:8704
    s_waitcnt lgkmcnt(0)
    s_barrier
    s_waitcnt vmcnt(24)
    v_perm_b32 v72, v17, v16, s32
    v_perm_b32 v48, v41, v40, s32
    v_perm_b32 v76, v76, v40, s33
    v_perm_b32 v84, v84, v41, s33
    v_perm_b32 v77, v77, v32, s33
    v_perm_b32 v85, v85, v33, s33
    v_perm_b32 v78, v78, v24, s33
    v_perm_b32 v86, v86, v25, s33
    v_perm_b32 v79, v79, v16, s33
    v_perm_b32 v87, v87, v17, s33
    v_add_f32 v80, v76, v78
    v_add_f32 v88, v84, v86
    v_add_f32 v81, v77, v79
    v_add_f32 v89, v85, v87
    v_fma_f32 v82, v78, 4.0, v76
    v_fma_f32 v90, v86, 4.0, v84
    v_fma_f32 v83, v79, 4.0, v77
    v_fma_f32 v91, v87, 4.0, v85
    v_add_f32 v77, v80, v81
    v_add_f32 v85, v88, v89
    v_sub_f32 v78, v80, v81
    v_sub_f32 v86, v88, v89
    v_fma_f32 v79, v83, 2.0, v82
    v_fma_f32 v87, v91, 2.0, v90
    v_fma_f32 v82, v83, -2.0, v82
    v_fma_f32 v90, v91, -2.0, v90
    v_fmamk_f32 v80, v76, 0x41700000, v82
    v_fmamk_f32 v88, v84, 0x41700000, v90
    v_fmamk_f32 v80, v81, 0x41200000, v80
    v_fmamk_f32 v88, v89, 0x41200000, v88
    v_mul_f32 v77, 0.5, v77
    v_mul_f32 v85, 0.5, v85
    v_mul_f32 v78, 0.5, v78
    v_mul_f32 v86, 0.5, v86
    v_mul_f32 v79, s35, v79
    v_mul_f32 v87, s35, v87
    v_mul_f32 v82, s35, v82
    v_mul_f32 v90, s35, v90
    v_mul_f32 v80, s36, v80
    v_mul_f32 v88, s36, v88
    v_cvt_pk_bf16_f32 v52, v77, v85
    v_cvt_pk_bf16_f32 v56, v78, v86
    v_cvt_pk_bf16_f32 v60, v79, v87
    v_cvt_pk_bf16_f32 v64, v82, v90
    v_cvt_pk_bf16_f32 v68, v80, v88
    s_waitcnt vmcnt(16)
    v_perm_b32 v73, v19, v18, s32
    v_perm_b32 v49, v43, v42, s32
    v_perm_b32 v76, v76, v42, s33
    v_perm_b32 v84, v84, v43, s33
    v_perm_b32 v77, v77, v34, s33
    v_perm_b32 v85, v85, v35, s33
    v_perm_b32 v78, v78, v26, s33
    v_perm_b32 v86, v86, v27, s33
    v_perm_b32 v79, v79, v18, s33
    v_perm_b32 v87, v87, v19, s33
    v_add_f32 v80, v76, v78
    v_add_f32 v88, v84, v86
    v_add_f32 v81, v77, v79
    v_add_f32 v89, v85, v87
    v_fma_f32 v82, v78, 4.0, v76
    v_fma_f32 v90, v86, 4.0, v84
    v_fma_f32 v83, v79, 4.0, v77
    v_fma_f32 v91, v87, 4.0, v85
    v_add_f32 v77, v80, v81
    v_add_f32 v85, v88, v89
    v_sub_f32 v78, v80, v81
    v_sub_f32 v86, v88, v89
    v_fma_f32 v79, v83, 2.0, v82
    v_fma_f32 v87, v91, 2.0, v90
    v_fma_f32 v82, v83, -2.0, v82
    v_fma_f32 v90, v91, -2.0, v90
    v_fmamk_f32 v80, v76, 0x41700000, v82
    v_fmamk_f32 v88, v84, 0x41700000, v90
    v_fmamk_f32 v80, v81, 0x41200000, v80
    v_fmamk_f32 v88, v89, 0x41200000, v88
    v_mul_f32 v77, 0.5, v77
    v_mul_f32 v85, 0.5, v85
    v_mul_f32 v78, 0.5, v78
    v_mul_f32 v86, 0.5, v86
    v_mul_f32 v79, s35, v79
    v_mul_f32 v87, s35, v87
    v_mul_f32 v82, s35, v82
    v_mul_f32 v90, s35, v90
    v_mul_f32 v80, s36, v80
    v_mul_f32 v88, s36, v88
    v_cvt_pk_bf16_f32 v53, v77, v85
    v_cvt_pk_bf16_f32 v57, v78, v86
    v_cvt_pk_bf16_f32 v61, v79, v87
    v_cvt_pk_bf16_f32 v65, v82, v90
    v_cvt_pk_bf16_f32 v69, v80, v88
    s_waitcnt vmcnt(8)
    v_perm_b32 v74, v21, v20, s32
    v_perm_b32 v50, v45, v44, s32
    v_perm_b32 v76, v76, v44, s33
    v_perm_b32 v84, v84, v45, s33
    v_perm_b32 v77, v77, v36, s33
    v_perm_b32 v85, v85, v37, s33
    v_perm_b32 v78, v78, v28, s33
    v_perm_b32 v86, v86, v29, s33
    v_perm_b32 v79, v79, v20, s33
    v_perm_b32 v87, v87, v21, s33
    v_add_f32 v80, v76, v78
    v_add_f32 v88, v84, v86
    v_add_f32 v81, v77, v79
    v_add_f32 v89, v85, v87
    v_fma_f32 v82, v78, 4.0, v76
    v_fma_f32 v90, v86, 4.0, v84
    v_fma_f32 v83, v79, 4.0, v77
    v_fma_f32 v91, v87, 4.0, v85
    v_add_f32 v77, v80, v81
    v_add_f32 v85, v88, v89
    v_sub_f32 v78, v80, v81
    v_sub_f32 v86, v88, v89
    v_fma_f32 v79, v83, 2.0, v82
    v_fma_f32 v87, v91, 2.0, v90
    v_fma_f32 v82, v83, -2.0, v82
    v_fma_f32 v90, v91, -2.0, v90
    v_fmamk_f32 v80, v76, 0x41700000, v82
    v_fmamk_f32 v88, v84, 0x41700000, v90
    v_fmamk_f32 v80, v81, 0x41200000, v80
    v_fmamk_f32 v88, v89, 0x41200000, v88
    v_mul_f32 v77, 0.5, v77
    v_mul_f32 v85, 0.5, v85
    v_mul_f32 v78, 0.5, v78
    v_mul_f32 v86, 0.5, v86
    v_mul_f32 v79, s35, v79
    v_mul_f32 v87, s35, v87
    v_mul_f32 v82, s35, v82
    v_mul_f32 v90, s35, v90
    v_mul_f32 v80, s36, v80
    v_mul_f32 v88, s36, v88
    v_cvt_pk_bf16_f32 v54, v77, v85
    v_cvt_pk_bf16_f32 v58, v78, v86
    v_cvt_pk_bf16_f32 v62, v79, v87
    v_cvt_pk_bf16_f32 v66, v82, v90
    v_cvt_pk_bf16_f32 v70, v80, v88
    s_waitcnt vmcnt(0)
    v_perm_b32 v75, v23, v22, s32
    v_perm_b32 v51, v47, v46, s32
    v_perm_b32 v76, v76, v46, s33
    v_perm_b32 v84, v84, v47, s33
    v_perm_b32 v77, v77, v38, s33
    v_perm_b32 v85, v85, v39, s33
    v_perm_b32 v78, v78, v30, s33
    v_perm_b32 v86, v86, v31, s33
    v_perm_b32 v79, v79, v22, s33
    v_perm_b32 v87, v87, v23, s33
    v_add_f32 v80, v76, v78
    v_add_f32 v88, v84, v86
    v_add_f32 v81, v77, v79
    v_add_f32 v89, v85, v87
    v_fma_f32 v82, v78, 4.0, v76
    v_fma_f32 v90, v86, 4.0, v84
    v_fma_f32 v83, v79, 4.0, v77
    v_fma_f32 v91, v87, 4.0, v85
    v_add_f32 v77, v80, v81
    v_add_f32 v85, v88, v89
    v_sub_f32 v78, v80, v81
    v_sub_f32 v86, v88, v89
    v_fma_f32 v79, v83, 2.0, v82
    v_fma_f32 v87, v91, 2.0, v90
    v_fma_f32 v82, v83, -2.0, v82
    v_fma_f32 v90, v91, -2.0, v90
    v_fmamk_f32 v80, v76, 0x41700000, v82
    v_fmamk_f32 v88, v84, 0x41700000, v90
    v_fmamk_f32 v80, v81, 0x41200000, v80
    v_fmamk_f32 v88, v89, 0x41200000, v88
    v_mul_f32 v77, 0.5, v77
    v_mul_f32 v85, 0.5, v85
    v_mul_f32 v78, 0.5, v78
    v_mul_f32 v86, 0.5, v86
    v_mul_f32 v79, s35, v79
    v_mul_f32 v87, s35, v87
    v_mul_f32 v82, s35, v82
    v_mul_f32 v90, s35, v90
    v_mul_f32 v80, s36, v80
    v_mul_f32 v88, s36, v88
    v_cvt_pk_bf16_f32 v55, v77, v85
    v_cvt_pk_bf16_f32 v59, v78, v86
    v_cvt_pk_bf16_f32 v63, v79, v87
    v_cvt_pk_bf16_f32 v67, v82, v90
    v_cvt_pk_bf16_f32 v71, v80, v88
    s_add_u32 s28, s27, 49152
    buffer_store_dwordx4 v[72:75], v4, s[12:15], s28 offen sc1
    s_add_u32 s28, s27, 0
    buffer_store_dwordx4 v[48:51], v4, s[12:15], s28 offen sc1
    s_add_u32 s28, s27, 8192
    buffer_store_dwordx4 v[52:55], v4, s[12:15], s28 offen sc1
    s_add_u32 s28, s27, 16384
    buffer_store_dwordx4 v[56:59], v4, s[12:15], s28 offen sc1
    s_add_u32 s28, s27, 24576
    buffer_store_dwordx4 v[60:63], v4, s[12:15], s28 offen sc1
    s_add_u32 s28, s27, 32768
    buffer_store_dwordx4 v[64:67], v4, s[12:15], s28 offen sc1
    s_add_u32 s28, s27, 40960
    buffer_store_dwordx4 v[68:71], v4, s[12:15], s28 offen sc1
    s_mov_b32 s20, s58
    s_branch L_conv1_kernel_end
L_conv1_kernel_epi:
    v_and_b32 v108, 15, v127
    v_lshrrev_b32 v109, 4, v127
    v_lshrrev_b32 v110, 3, v108
    s_lshl_b32 s36, s20, 1
    v_add_u32 v110, s36, v110
    v_xor_b32 v111, v110, v108
    v_and_b32 v111, 7, v111
    v_lshlrev_b32 v111, 4, v111
    v_lshl_add_u32 v111, v110, 7, v111
    v_lshl_add_u32 v120, v109, 11, v111
    v_add_u32 v121, 65536, v120
    v_add_u32 v125, 131072, v120
    s_lshl_b32 s36, s20, 9
    s_add_u32 s36, s36, 115712
    v_lshl_add_u32 v123, v109, 7, s36
    s_lshl_b32 s36, s20, 4
    v_add_u32 v108, s36, v108
    v_lshl_add_u32 v110, v108, 2, s21
    v_lshlrev_b32 v110, 9, v110
    v_lshl_add_u32 v110, v109, 4, v110
    s_lshl_b32 s36, s29, 6
    v_add_u32 v110, s36, v110
    v_mov_b32 v111, 2130706432
    v_cmp_gt_u32 vcc, 125, v108
    s_mov_b32 s4, 0xbeaaaaab
    s_mov_b32 s5, s4
    s_mov_b32 s6, 0x3e800000
    s_mov_b32 s7, s6
    s_mov_b32 s8, 0xc0a00000
    s_mov_b32 s9, s8
    s_mov_b32 s10, 0xc0638e39
    s_mov_b32 s11, s10
    s_mov_b32 s12, 0xbf638e39
    s_mov_b32 s13, s12
    s_mov_b32 s14, 0xbe638e39
    s_mov_b32 s15, s14
    s_mov_b32 s22, 0xbd638e39
    s_mov_b32 s23, s22
    s_mov_b32 s24, 0x3ff1c71c
    s_mov_b32 s25, s24
    s_mov_b32 s26, 0xbf2aaaab
    s_mov_b32 s27, s26
    s_mov_b32 s32, 0x3ecccccd
    s_mov_b32 s33, s32
    s_mov_b32 s34, 0xbd888889
    s_mov_b32 s35, s34
    s_mov_b32 s38, 0xbe4ccccd
    s_mov_b32 s39, s38
    s_mov_b32 s40, 0xbdd2d3e8
    s_mov_b32 s41, s40
    s_mov_b32 s42, 0x3f800000
    s_mov_b32 s43, s42
    s_waitcnt lgkmcnt(0)
    s_barrier
    v_cndmask_b32 v122, v111, v110, vcc
    ds_read_b128 v[0:3], v120 offset:0
    ds_read_b128 v[4:7], v120 offset:16384
    ds_read_b128 v[8:11], v120 offset:32768
    ds_read_b128 v[12:15], v120 offset:49152
    ds_read_b128 v[16:19], v121 offset:0
    ds_read_b128 v[20:23], v121 offset:16384
    ds_read_b128 v[24:27], v121 offset:32768
    ds_read_b128 v[28:31], v125 offset:15360
    ds_read_b128 v[32:35], v120 offset:8192
    ds_read_b128 v[36:39], v120 offset:24576
    ds_read_b128 v[40:43], v120 offset:40960
    ds_read_b128 v[44:47], v120 offset:57344
    ds_read_b128 v[48:51], v121 offset:56320
    ds_read_b128 v[52:55], v121 offset:64512
    ds_read_b128 v[56:59], v125 offset:7168
    s_waitcnt lgkmcnt(7)
    ds_read_b128 v[60:63], v125 offset:23552
    s_waitcnt lgkmcnt(8)
    v_pk_add_f32 v[88:89], v[24:25], v[28:29]
    v_pk_add_f32 v[90:91], v[26:27], v[30:31]
    v_pk_add_f32 v[24:25], v[4:5], v[8:9]
    v_pk_add_f32 v[26:27], v[6:7], v[10:11]
    v_pk_add_f32 v[4:5], v[4:5], v[8:9] neg_lo:[0,1] neg_hi:[0,1]
    v_pk_add_f32 v[6:7], v[6:7], v[10:11] neg_lo:[0,1] neg_hi:[0,1]
    v_pk_add_f32 v[72:73], v[12:13], v[16:17]
    v_pk_add_f32 v[74:75], v[14:15], v[18:19]
    v_pk_add_f32 v[12:13], v[12:13], v[16:17] neg_lo:[0,1] neg_hi:[0,1]
    v_pk_add_f32 v[14:15], v[14:15], v[18:19] neg_lo:[0,1] neg_hi:[0,1]
    v_pk_fma_f32 v[72:73], v[24:25], s[4:5], v[72:73]
    v_pk_fma_f32 v[74:75], v[26:27], s[4:5], v[74:75]
    v_pk_fma_f32 v[20:21], v[0:1], s[10:11], v[20:21]
    v_pk_fma_f32 v[22:23], v[2:3], s[10:11], v[22:23]
    v_pk_fma_f32 v[72:73], v[0:1], s[6:7], v[72:73]
    v_pk_fma_f32 v[74:75], v[2:3], s[6:7], v[74:75]
    v_pk_add_f32 v[24:25], v[24:25], v[0:1] neg_lo:[0,1] neg_hi:[0,1]
    v_pk_add_f32 v[26:27], v[26:27], v[2:3] neg_lo:[0,1] neg_hi:[0,1]
    v_pk_fma_f32 v[72:73], v[88:89], s[8:9], v[72:73]
    v_pk_fma_f32 v[74:75], v[90:91], s[8:9], v[74:75]
    v_pk_add_f32 v[24:25], v[24:25], v[88:89] neg_lo:[0,1] neg_hi:[0,1]
    v_pk_add_f32 v[26:27], v[26:27], v[90:91] neg_lo:[0,1] neg_hi:[0,1]
    v_pk_fma_f32 v[20:21], v[88:89], s[22:23], v[20:21]
    v_pk_fma_f32 v[22:23], v[90:91], s[22:23], v[22:23]
    v_pk_add_f32 v[8:9], v[24:25], v[72:73] neg_lo:[0,1] neg_hi:[0,1]
    v_pk_add_f32 v[10:11], v[26:27], v[74:75] neg_lo:[0,1] neg_hi:[0,1]
    v_pk_fma_f32 v[20:21], v[72:73], s[14:15], v[20:21]
    v_pk_fma_f32 v[22:23], v[74:75], s[14:15], v[22:23]
    v_pk_mul_f32 v[80:81], v[12:13], s[32:33]
    v_pk_mul_f32 v[82:83], v[14:15], s[32:33]
    v_pk_fma_f32 v[20:21], v[8:9], s[12:13], v[20:21]
    v_pk_fma_f32 v[22:23], v[10:11], s[12:13], v[22:23]
    v_pk_fma_f32 v[80:81], v[4:5], s[34:35], v[80:81]
    v_pk_fma_f32 v[82:83], v[6:7], s[34:35], v[82:83]
    v_pk_fma_f32 v[64:65], v[4:5], s[24:25], v[20:21] neg_lo:[0,0,1] neg_hi:[0,0,1]
    v_pk_fma_f32 v[66:67], v[6:7], s[24:25], v[22:23] neg_lo:[0,0,1] neg_hi:[0,0,1]
    v_pk_fma_f32 v[64:65], v[12:13], s[26:27], v[64:65]
    v_pk_fma_f32 v[66:67], v[14:15], s[26:27], v[66:67]
    v_pk_fma_f32 v[80:81], v[64:65], s[38:39], v[80:81]
    v_pk_fma_f32 v[82:83], v[66:67], s[38:39], v[82:83]
    v_pk_add_f32 v[4:5], v[4:5], v[64:65] neg_lo:[0,1] neg_hi:[0,1]
    v_pk_add_f32 v[6:7], v[6:7], v[66:67] neg_lo:[0,1] neg_hi:[0,1]
    v_pk_add_f32 v[4:5], v[4:5], v[80:81] neg_lo:[0,1] neg_hi:[0,1]
    v_pk_add_f32 v[6:7], v[6:7], v[82:83] neg_lo:[0,1] neg_hi:[0,1]
    s_waitcnt lgkmcnt(0)
    v_pk_add_f32 v[92:93], v[56:57], v[60:61]
    v_pk_add_f32 v[94:95], v[58:59], v[62:63]
    v_pk_add_f32 v[56:57], v[36:37], v[40:41]
    v_pk_add_f32 v[58:59], v[38:39], v[42:43]
    v_pk_add_f32 v[36:37], v[36:37], v[40:41] neg_lo:[0,1] neg_hi:[0,1]
    v_pk_add_f32 v[38:39], v[38:39], v[42:43] neg_lo:[0,1] neg_hi:[0,1]
    v_pk_add_f32 v[76:77], v[44:45], v[48:49]
    v_pk_add_f32 v[78:79], v[46:47], v[50:51]
    v_pk_add_f32 v[44:45], v[44:45], v[48:49] neg_lo:[0,1] neg_hi:[0,1]
    v_pk_add_f32 v[46:47], v[46:47], v[50:51] neg_lo:[0,1] neg_hi:[0,1]
    v_pk_fma_f32 v[76:77], v[56:57], s[4:5], v[76:77]
    v_pk_fma_f32 v[78:79], v[58:59], s[4:5], v[78:79]
    v_pk_fma_f32 v[52:53], v[32:33], s[10:11], v[52:53]
    v_pk_fma_f32 v[54:55], v[34:35], s[10:11], v[54:55]
    v_pk_fma_f32 v[76:77], v[32:33], s[6:7], v[76:77]
    v_pk_fma_f32 v[78:79], v[34:35], s[6:7], v[78:79]
    v_pk_add_f32 v[56:57], v[56:57], v[32:33] neg_lo:[0,1] neg_hi:[0,1]
    v_pk_add_f32 v[58:59], v[58:59], v[34:35] neg_lo:[0,1] neg_hi:[0,1]
    v_pk_fma_f32 v[76:77], v[92:93], s[8:9], v[76:77]
    v_pk_fma_f32 v[78:79], v[94:95], s[8:9], v[78:79]
    v_pk_add_f32 v[56:57], v[56:57], v[92:93] neg_lo:[0,1] neg_hi:[0,1]
    v_pk_add_f32 v[58:59], v[58:59], v[94:95] neg_lo:[0,1] neg_hi:[0,1]
    v_pk_fma_f32 v[52:53], v[92:93], s[22:23], v[52:53]
    v_pk_fma_f32 v[54:55], v[94:95], s[22:23], v[54:55]
    v_pk_add_f32 v[40:41], v[56:57], v[76:77] neg_lo:[0,1] neg_hi:[0,1]
    v_pk_add_f32 v[42:43], v[58:59], v[78:79] neg_lo:[0,1] neg_hi:[0,1]
    v_pk_fma_f32 v[52:53], v[76:77], s[14:15], v[52:53]
    v_pk_fma_f32 v[54:55], v[78:79], s[14:15], v[54:55]
    v_pk_mul_f32 v[84:85], v[44:45], s[32:33]
    v_pk_mul_f32 v[86:87], v[46:47], s[32:33]
    v_pk_fma_f32 v[52:53], v[40:41], s[12:13], v[52:53]
    v_pk_fma_f32 v[54:55], v[42:43], s[12:13], v[54:55]
    v_pk_fma_f32 v[84:85], v[36:37], s[34:35], v[84:85]
    v_pk_fma_f32 v[86:87], v[38:39], s[34:35], v[86:87]
    v_pk_fma_f32 v[68:69], v[36:37], s[24:25], v[52:53] neg_lo:[0,0,1] neg_hi:[0,0,1]
    v_pk_fma_f32 v[70:71], v[38:39], s[24:25], v[54:55] neg_lo:[0,0,1] neg_hi:[0,0,1]
    v_pk_fma_f32 v[68:69], v[44:45], s[26:27], v[68:69]
    v_pk_fma_f32 v[70:71], v[46:47], s[26:27], v[70:71]
    v_pk_fma_f32 v[84:85], v[68:69], s[38:39], v[84:85]
    v_pk_fma_f32 v[86:87], v[70:71], s[38:39], v[86:87]
    v_pk_add_f32 v[36:37], v[36:37], v[68:69] neg_lo:[0,1] neg_hi:[0,1]
    v_pk_add_f32 v[38:39], v[38:39], v[70:71] neg_lo:[0,1] neg_hi:[0,1]
    v_pk_add_f32 v[36:37], v[36:37], v[84:85] neg_lo:[0,1] neg_hi:[0,1]
    v_pk_add_f32 v[38:39], v[38:39], v[86:87] neg_lo:[0,1] neg_hi:[0,1]
    s_mov_b32 s36, 0x00010001
    s_mov_b32 s37, 0x00010001
    s_mov_b64 exec, s[36:37]
    ds_write_b128 v123, v[0:3] offset:0
    ds_write_b128 v123, v[32:35] offset:16
    ds_write_b128 v123, v[4:7] offset:32
    ds_write_b128 v123, v[36:39] offset:48
    ds_write_b128 v123, v[8:11] offset:64
    ds_write_b128 v123, v[40:43] offset:80
    s_mov_b64 exec, -1
    v_mov_b32 v44, 0xc0135761
    v_mov_b32 v45, v44
    v_pk_mul_f32 v[16:17], v[64:65], v[64:65]
    v_pk_mul_f32 v[18:19], v[66:67], v[66:67]
    v_pk_mul_f32 v[20:21], v[68:69], v[68:69]
    v_pk_mul_f32 v[22:23], v[70:71], v[70:71]
    v_pk_fma_f32 v[16:17], v[16:17], s[40:41], v[44:45]
    v_pk_fma_f32 v[18:19], v[18:19], s[40:41], v[44:45]
    v_pk_fma_f32 v[20:21], v[20:21], s[40:41], v[44:45]
    v_pk_fma_f32 v[22:23], v[22:23], s[40:41], v[44:45]
    v_pk_mul_f32 v[16:17], v[16:17], v[64:65]
    v_pk_mul_f32 v[18:19], v[18:19], v[66:67]
    v_pk_mul_f32 v[20:21], v[20:21], v[68:69]
    v_pk_mul_f32 v[22:23], v[22:23], v[70:71]
    v_exp_f32 v16, v16
    v_exp_f32 v17, v17
    v_exp_f32 v18, v18
    v_exp_f32 v19, v19
    v_exp_f32 v20, v20
    v_exp_f32 v21, v21
    v_exp_f32 v22, v22
    v_exp_f32 v23, v23
    v_pk_add_f32 v[16:17], v[16:17], s[42:43]
    v_pk_add_f32 v[18:19], v[18:19], s[42:43]
    v_pk_add_f32 v[20:21], v[20:21], s[42:43]
    v_pk_add_f32 v[22:23], v[22:23], s[42:43]
    v_rcp_f32 v16, v16
    v_rcp_f32 v17, v17
    v_rcp_f32 v18, v18
    v_rcp_f32 v19, v19
    v_rcp_f32 v20, v20
    v_rcp_f32 v21, v21
    v_rcp_f32 v22, v22
    v_rcp_f32 v23, v23
    v_pk_mul_f32 v[64:65], v[64:65], v[16:17]
    v_pk_mul_f32 v[66:67], v[66:67], v[18:19]
    v_pk_mul_f32 v[68:69], v[68:69], v[20:21]
    v_pk_mul_f32 v[70:71], v[70:71], v[22:23]
    v_cvt_pk_bf16_f32 v48, v64, v68
    v_cvt_pk_bf16_f32 v49, v65, v69
    v_cvt_pk_bf16_f32 v50, v66, v70
    v_cvt_pk_bf16_f32 v51, v67, v71
    buffer_store_dwordx4 v[48:51], v122, s[16:19], 0 offen offset:0 sc1
    s_waitcnt lgkmcnt(0)
    s_barrier
    ds_read_b128 v[96:99], v123 offset:512
    ds_read_b128 v[100:103], v123 offset:528
    ds_read_b128 v[104:107], v123 offset:544
    ds_read_b128 v[108:111], v123 offset:560
    ds_read_b128 v[112:115], v123 offset:576
    ds_read_b128 v[116:119], v123 offset:592
    s_waitcnt lgkmcnt(4)
    v_mov_b32_dpp v96, v0 row_shl:1 row_mask:0xf bank_mask:0xf
    v_mov_b32_dpp v97, v1 row_shl:1 row_mask:0xf bank_mask:0xf
    v_mov_b32_dpp v98, v2 row_shl:1 row_mask:0xf bank_mask:0xf
    v_mov_b32_dpp v99, v3 row_shl:1 row_mask:0xf bank_mask:0xf
    v_mov_b32_dpp v100, v32 row_shl:1 row_mask:0xf bank_mask:0xf
    v_mov_b32_dpp v101, v33 row_shl:1 row_mask:0xf bank_mask:0xf
    v_mov_b32_dpp v102, v34 row_shl:1 row_mask:0xf bank_mask:0xf
    v_mov_b32_dpp v103, v35 row_shl:1 row_mask:0xf bank_mask:0xf
    v_pk_add_f32 v[72:73], v[72:73], v[96:97]
    v_pk_add_f32 v[74:75], v[74:75], v[98:99]
    v_pk_add_f32 v[76:77], v[76:77], v[100:101]
    v_pk_add_f32 v[78:79], v[78:79], v[102:103]
    v_pk_mul_f32 v[24:25], v[72:73], v[72:73]
    v_pk_mul_f32 v[26:27], v[74:75], v[74:75]
    v_pk_mul_f32 v[28:29], v[76:77], v[76:77]
    v_pk_mul_f32 v[30:31], v[78:79], v[78:79]
    v_pk_fma_f32 v[24:25], v[24:25], s[40:41], v[44:45]
    v_pk_fma_f32 v[26:27], v[26:27], s[40:41], v[44:45]
    v_pk_fma_f32 v[28:29], v[28:29], s[40:41], v[44:45]
    v_pk_fma_f32 v[30:31], v[30:31], s[40:41], v[44:45]
    v_pk_mul_f32 v[24:25], v[24:25], v[72:73]
    v_pk_mul_f32 v[26:27], v[26:27], v[74:75]
    v_pk_mul_f32 v[28:29], v[28:29], v[76:77]
    v_pk_mul_f32 v[30:31], v[30:31], v[78:79]
    v_exp_f32 v24, v24
    v_exp_f32 v25, v25
    v_exp_f32 v26, v26
    v_exp_f32 v27, v27
    v_exp_f32 v28, v28
    v_exp_f32 v29, v29
    v_exp_f32 v30, v30
    v_exp_f32 v31, v31
    v_pk_add_f32 v[24:25], v[24:25], s[42:43]
    v_pk_add_f32 v[26:27], v[26:27], s[42:43]
    v_pk_add_f32 v[28:29], v[28:29], s[42:43]
    v_pk_add_f32 v[30:31], v[30:31], s[42:43]
    v_rcp_f32 v24, v24
    v_rcp_f32 v25, v25
    v_rcp_f32 v26, v26
    v_rcp_f32 v27, v27
    v_rcp_f32 v28, v28
    v_rcp_f32 v29, v29
    v_rcp_f32 v30, v30
    v_rcp_f32 v31, v31
    v_pk_mul_f32 v[72:73], v[72:73], v[24:25]
    v_pk_mul_f32 v[74:75], v[74:75], v[26:27]
    v_pk_mul_f32 v[76:77], v[76:77], v[28:29]
    v_pk_mul_f32 v[78:79], v[78:79], v[30:31]
    v_cvt_pk_bf16_f32 v52, v72, v76
    v_cvt_pk_bf16_f32 v53, v73, v77
    v_cvt_pk_bf16_f32 v54, v74, v78
    v_cvt_pk_bf16_f32 v55, v75, v79
    buffer_store_dwordx4 v[52:55], v122, s[16:19], 0 offen offset:512 sc1
    s_waitcnt lgkmcnt(2)
    v_mov_b32_dpp v104, v4 row_shl:1 row_mask:0xf bank_mask:0xf
    v_mov_b32_dpp v105, v5 row_shl:1 row_mask:0xf bank_mask:0xf
    v_mov_b32_dpp v106, v6 row_shl:1 row_mask:0xf bank_mask:0xf
    v_mov_b32_dpp v107, v7 row_shl:1 row_mask:0xf bank_mask:0xf
    v_mov_b32_dpp v108, v36 row_shl:1 row_mask:0xf bank_mask:0xf
    v_mov_b32_dpp v109, v37 row_shl:1 row_mask:0xf bank_mask:0xf
    v_mov_b32_dpp v110, v38 row_shl:1 row_mask:0xf bank_mask:0xf
    v_mov_b32_dpp v111, v39 row_shl:1 row_mask:0xf bank_mask:0xf
    v_pk_add_f32 v[80:81], v[80:81], v[104:105]
    v_pk_add_f32 v[82:83], v[82:83], v[106:107]
    v_pk_add_f32 v[84:85], v[84:85], v[108:109]
    v_pk_add_f32 v[86:87], v[86:87], v[110:111]
    v_pk_mul_f32 v[16:17], v[80:81], v[80:81]
    v_pk_mul_f32 v[18:19], v[82:83], v[82:83]
    v_pk_mul_f32 v[20:21], v[84:85], v[84:85]
    v_pk_mul_f32 v[22:23], v[86:87], v[86:87]
    v_pk_fma_f32 v[16:17], v[16:17], s[40:41], v[44:45]
    v_pk_fma_f32 v[18:19], v[18:19], s[40:41], v[44:45]
    v_pk_fma_f32 v[20:21], v[20:21], s[40:41], v[44:45]
    v_pk_fma_f32 v[22:23], v[22:23], s[40:41], v[44:45]
    v_pk_mul_f32 v[16:17], v[16:17], v[80:81]
    v_pk_mul_f32 v[18:19], v[18:19], v[82:83]
    v_pk_mul_f32 v[20:21], v[20:21], v[84:85]
    v_pk_mul_f32 v[22:23], v[22:23], v[86:87]
    v_exp_f32 v16, v16
    v_exp_f32 v17, v17
    v_exp_f32 v18, v18
    v_exp_f32 v19, v19
    v_exp_f32 v20, v20
    v_exp_f32 v21, v21
    v_exp_f32 v22, v22
    v_exp_f32 v23, v23
    v_pk_add_f32 v[16:17], v[16:17], s[42:43]
    v_pk_add_f32 v[18:19], v[18:19], s[42:43]
    v_pk_add_f32 v[20:21], v[20:21], s[42:43]
    v_pk_add_f32 v[22:23], v[22:23], s[42:43]
    v_rcp_f32 v16, v16
    v_rcp_f32 v17, v17
    v_rcp_f32 v18, v18
    v_rcp_f32 v19, v19
    v_rcp_f32 v20, v20
    v_rcp_f32 v21, v21
    v_rcp_f32 v22, v22
    v_rcp_f32 v23, v23
    v_pk_mul_f32 v[80:81], v[80:81], v[16:17]
    v_pk_mul_f32 v[82:83], v[82:83], v[18:19]
    v_pk_mul_f32 v[84:85], v[84:85], v[20:21]
    v_pk_mul_f32 v[86:87], v[86:87], v[22:23]
    v_cvt_pk_bf16_f32 v56, v80, v84
    v_cvt_pk_bf16_f32 v57, v81, v85
    v_cvt_pk_bf16_f32 v58, v82, v86
    v_cvt_pk_bf16_f32 v59, v83, v87
    buffer_store_dwordx4 v[56:59], v122, s[16:19], 0 offen offset:1024 sc1
    s_waitcnt lgkmcnt(0)
    v_mov_b32_dpp v112, v8 row_shl:1 row_mask:0xf bank_mask:0xf
    v_mov_b32_dpp v113, v9 row_shl:1 row_mask:0xf bank_mask:0xf
    v_mov_b32_dpp v114, v10 row_shl:1 row_mask:0xf bank_mask:0xf
    v_mov_b32_dpp v115, v11 row_shl:1 row_mask:0xf bank_mask:0xf
    v_mov_b32_dpp v116, v40 row_shl:1 row_mask:0xf bank_mask:0xf
    v_mov_b32_dpp v117, v41 row_shl:1 row_mask:0xf bank_mask:0xf
    v_mov_b32_dpp v118, v42 row_shl:1 row_mask:0xf bank_mask:0xf
    v_mov_b32_dpp v119, v43 row_shl:1 row_mask:0xf bank_mask:0xf
    v_pk_add_f32 v[88:89], v[88:89], v[112:113]
    v_pk_add_f32 v[90:91], v[90:91], v[114:115]
    v_pk_add_f32 v[92:93], v[92:93], v[116:117]
    v_pk_add_f32 v[94:95], v[94:95], v[118:119]
    v_pk_mul_f32 v[24:25], v[88:89], v[88:89]
    v_pk_mul_f32 v[26:27], v[90:91], v[90:91]
    v_pk_mul_f32 v[28:29], v[92:93], v[92:93]
    v_pk_mul_f32 v[30:31], v[94:95], v[94:95]
    v_pk_fma_f32 v[24:25], v[24:25], s[40:41], v[44:45]
    v_pk_fma_f32 v[26:27], v[26:27], s[40:41], v[44:45]
    v_pk_fma_f32 v[28:29], v[28:29], s[40:41], v[44:45]
    v_pk_fma_f32 v[30:31], v[30:31], s[40:41], v[44:45]
    v_pk_mul_f32 v[24:25], v[24:25], v[88:89]
    v_pk_mul_f32 v[26:27], v[26:27], v[90:91]
    v_pk_mul_f32 v[28:29], v[28:29], v[92:93]
    v_pk_mul_f32 v[30:31], v[30:31], v[94:95]
    v_exp_f32 v24, v24
    v_exp_f32 v25, v25
    v_exp_f32 v26, v26
    v_exp_f32 v27, v27
    v_exp_f32 v28, v28
    v_exp_f32 v29, v29
    v_exp_f32 v30, v30
    v_exp_f32 v31, v31
    v_pk_add_f32 v[24:25], v[24:25], s[42:43]
    v_pk_add_f32 v[26:27], v[26:27], s[42:43]
    v_pk_add_f32 v[28:29], v[28:29], s[42:43]
    v_pk_add_f32 v[30:31], v[30:31], s[42:43]
    v_rcp_f32 v24, v24
    v_rcp_f32 v25, v25
    v_rcp_f32 v26, v26
    v_rcp_f32 v27, v27
    v_rcp_f32 v28, v28
    v_rcp_f32 v29, v29
    v_rcp_f32 v30, v30
    v_rcp_f32 v31, v31
    v_pk_mul_f32 v[88:89], v[88:89], v[24:25]
    v_pk_mul_f32 v[90:91], v[90:91], v[26:27]
    v_pk_mul_f32 v[92:93], v[92:93], v[28:29]
    v_pk_mul_f32 v[94:95], v[94:95], v[30:31]
    v_cvt_pk_bf16_f32 v60, v88, v92
    v_cvt_pk_bf16_f32 v61, v89, v93
    v_cvt_pk_bf16_f32 v62, v90, v94
    v_cvt_pk_bf16_f32 v63, v91, v95
    buffer_store_dwordx4 v[60:63], v122, s[16:19], 0 offen offset:1536 sc1
L_conv1_kernel_end:
L_conv1_kernel_done:
    s_endpgm
.globl conv2_kernel
.p2align 8
.type conv2_kernel,@function
conv2_kernel:
    s_cmp_ge_u32 s2, 256
    s_cbranch_scc1 L_conv2_kernel_done
    s_load_dwordx2 s[4:5], s[0:1], 72
    s_load_dwordx2 s[30:31], s[0:1], 72
    v_readfirstlane_b32 s20, v0
    s_lshr_b32 s20, s20, 6
    s_and_b32 s36, s2, 0
    s_lshl_b32 s36, s36, 3
    s_bfe_u32 s37, s2, 196611
    s_or_b32 s29, s36, s37
    s_bfe_u32 s36, s2, 196608
    s_lshl_b32 s36, s36, 2
    s_lshr_b32 s37, s2, 6
    s_or_b32 s36, s36, s37
    s_lshr_b32 s33, s36, 4
    s_and_b32 s34, s36, 7
    s_bfe_u32 s35, s36, 0x10003
    s_mul_i32 s21, s34, 500
    s_and_b32 s32, s20, 3
    v_and_b32 v127, 63, v0
    v_lshrrev_b32 v5, 2, v127
    v_and_b32 v6, 3, v127
    v_lshlrev_b32 v7, 15, v5
    v_lshl_add_u32 v7, v6, 4, v7
    s_lshl_b32 s41, s21, 10
    s_lshl_b32 s37, s33, 9
    s_add_u32 s41, s41, s37
    s_sub_u32 s41, s41, 7680
    s_and_b32 s42, s20, 7
    s_lshl_b32 s37, s42, 12
    s_add_u32 s37, s37, s41
    v_add_u32 v7, s37, v7
    s_mul_i32 s36, s35, 4096000
    s_add_u32 s36, s36, 18874368
    s_mov_b32 s10, 4096000
    s_mov_b32 s11, 0x00020000
    s_mov_b32 s25, 0xffff0000
    s_waitcnt lgkmcnt(0)
    s_add_u32 s8, s4, s36
    s_addc_u32 s9, s5, 0
    s_cmp_ge_u32 s20, 8
    s_cbranch_scc1 L_conv2_kernel_helper
    s_add_u32 s37, s41, 524288
    v_lshl_add_u32 v108, v127, 4, s37
    s_lshl_b32 s36, s29, 4
    s_lshl_b32 s37, s33, 3
    s_add_u32 s36, s36, s37
    s_mul_i32 s36, s36, 57344
    s_add_u32 s36, s36, 9437184
    s_add_u32 s12, s30, s36
    s_addc_u32 s13, s31, 0
    s_mov_b32 s14, 458752
    s_mov_b32 s15, 0x00020000
    s_mul_i32 s36, s35, 2048000
    s_add_u32 s36, s36, 27262976
    s_mul_i32 s37, s33, 8388608
    s_add_u32 s36, s36, s37
    s_add_u32 s16, s30, s36
    s_addc_u32 s17, s31, 0
    s_mov_b32 s18, 2048000
    s_mov_b32 s19, 0x00020000
    v_and_b32 v10, 15, v127
    v_lshrrev_b32 v11, 4, v127
    v_add_u32 v8, 0, v10
    v_and_b32 v16, 4, v8
    v_lshrrev_b32 v16, 1, v16
    v_xor_b32 v16, v11, v16
    v_lshlrev_b32 v16, 4, v16
    v_lshl_add_u32 v8, v8, 6, v16
    v_add_u32 v9, 1, v10
    v_and_b32 v16, 4, v9
    v_lshrrev_b32 v16, 1, v16
    v_xor_b32 v16, v11, v16
    v_lshlrev_b32 v16, 4, v16
    v_lshl_add_u32 v9, v9, 6, v16
    s_lshr_b32 s38, s32, 1
    s_and_b32 s39, s32, 1
    s_add_u32 s40, s38, 4
    s_lshl_b32 s43, s39, 10
    s_cmp_lt_u32 s20, 4
    s_cselect_b32 s40, s20, s40
    s_cselect_b32 s36, 0, s43
    s_lshl_b32 s37, s40, 13
    s_add_u32 s37, s37, s36
    v_lshl_add_u32 v125, v127, 4, s37
    s_mul_i32 s37, s40, 16384
    v_add_u32 v120, s37, v8
    v_add_u32 v121, s37, v9
    s_lshl_b32 s37, s40, 10
    s_add_u32 s37, s37, 115712
    v_lshl_add_u32 v16, v11, 4, s37
    v_cmp_eq_u32 vcc, 15, v10
    v_mov_b32 v17, 8192
    v_mov_b32 v18, 4294959104
    v_mov_b32 v19, 64
    v_cndmask_b32 v122, v121, v16, vcc
    v_cndmask_b32 v123, v17, v19, vcc
    v_cndmask_b32 v124, v18, v19, vcc
    v_lshl_add_u32 v126, v127, 4, s37
    s_mov_b32 s44, 0x3f800000
    s_mov_b32 s45, 0x00000000
    s_mov_b32 s46, 0x00000000
    s_cmp_eq_u32 s40, 1
    s_cselect_b32 s45, 0x3f800000, s45
    s_cselect_b32 s46, 0x3f800000, s46
    s_cmp_eq_u32 s40, 2
    s_cselect_b32 s45, 0xbf800000, s45
    s_cselect_b32 s46, 0x3f800000, s46
    s_cmp_eq_u32 s40, 3
    s_cselect_b32 s45, 0x40000000, s45
    s_cselect_b32 s46, 0x40800000, s46
    s_cmp_eq_u32 s40, 4
    s_cselect_b32 s45, 0xc0000000, s45
    s_cselect_b32 s46, 0x40800000, s46
    s_cmp_eq_u32 s40, 5
    s_cselect_b32 s44, 0x41800000, s44
    s_cselect_b32 s45, 0x41000000, s45
    s_cselect_b32 s46, 0x40800000, s46
    s_cmp_ge_u32 s20, 4
    s_cbranch_scc1 L_conv2_kernel_m2
    v_mov_b32 v0, 0
    v_mov_b32 v1, 0
    v_mov_b32 v2, 0
    v_mov_b32 v3, 0
    v_mov_b32 v4, 0
    v_mov_b32 v5, 0
    v_mov_b32 v6, 0
    v_mov_b32 v7, 0
    v_mov_b32 v8, 0
    v_mov_b32 v9, 0
    v_mov_b32 v10, 0
    v_mov_b32 v11, 0
    v_mov_b32 v12, 0
    v_mov_b32 v13, 0
    v_mov_b32 v14, 0
    v_mov_b32 v15, 0
    v_mov_b32 v16, 0
    v_mov_b32 v17, 0
    v_mov_b32 v18, 0
    v_mov_b32 v19, 0
    v_mov_b32 v20, 0
    v_mov_b32 v21, 0
    v_mov_b32 v22, 0
    v_mov_b32 v23, 0
    v_mov_b32 v24, 0
    v_mov_b32 v25, 0
    v_mov_b32 v26, 0
    v_mov_b32 v27, 0
    v_mov_b32 v28, 0
    v_mov_b32 v29, 0
    v_mov_b32 v30, 0
    v_mov_b32 v31, 0
    v_mov_b32 v32, 0
    v_mov_b32 v33, 0
    v_mov_b32 v34, 0
    v_mov_b32 v35, 0
    v_mov_b32 v36, 0
    v_mov_b32 v37, 0
    v_mov_b32 v38, 0
    v_mov_b32 v39, 0
    v_mov_b32 v40, 0
    v_mov_b32 v41, 0
    v_mov_b32 v42, 0
    v_mov_b32 v43, 0
    v_mov_b32 v44, 0
    v_mov_b32 v45, 0
    v_mov_b32 v46, 0
    v_mov_b32 v47, 0
    v_mov_b32 v48, 0
    v_mov_b32 v49, 0
    v_mov_b32 v50, 0
    v_mov_b32 v51, 0
    v_mov_b32 v52, 0
    v_mov_b32 v53, 0
    v_mov_b32 v54, 0
    v_mov_b32 v55, 0
    v_mov_b32 v56, 0
    v_mov_b32 v57, 0
    v_mov_b32 v58, 0
    v_mov_b32 v59, 0
    v_mov_b32 v60, 0
    v_mov_b32 v61, 0
    v_mov_b32 v62, 0
    v_mov_b32 v63, 0
    s_barrier
    buffer_load_dwordx4 v[96:99], v108, s[8:11], 0 offen offset:0
    buffer_load_dwordx4 v[100:103], v108, s[8:11], 0 offen offset:1024
    buffer_load_dwordx4 v[104:107], v108, s[8:11], 0 offen offset:2048
    s_mov_b32 s23, 0
    s_mov_b32 s26, 4096
    buffer_load_dwordx4 v[64:67], v125, s[12:15], s23 offen offset:0
    buffer_load_dwordx4 v[68:71], v125, s[12:15], s23 offen offset:1024
    buffer_load_dwordx4 v[72:75], v125, s[12:15], s23 offen offset:2048
    buffer_load_dwordx4 v[76:79], v125, s[12:15], s23 offen offset:3072
    buffer_load_dwordx4 v[80:83], v125, s[12:15], s26 offen offset:0
    buffer_load_dwordx4 v[84:87], v125, s[12:15], s26 offen offset:1024
    buffer_load_dwordx4 v[88:91], v125, s[12:15], s26 offen offset:2048
    buffer_load_dwordx4 v[92:95], v125, s[12:15], s26 offen offset:3072
    s_mov_b32 s23, 57344
    s_mov_b32 s26, 61440
    s_waitcnt vmcnt(8)
    v_lshlrev_b32 v108, 16, v96
    v_and_b32 v111, s25, v96
    v_lshlrev_b32 v109, 16, v100
    v_and_b32 v112, s25, v100
    v_lshlrev_b32 v110, 16, v104
    v_and_b32 v113, s25, v104
    v_mul_f32 v114, s44, v108
    v_mul_f32 v115, s44, v111
    v_fmac_f32 v114, s45, v109
    v_fmac_f32 v115, s45, v112
    v_fmac_f32 v114, s46, v110
    v_fmac_f32 v115, s46, v113
    v_cvt_pk_bf16_f32 v96, v114, v115
    v_lshlrev_b32 v108, 16, v97
    v_and_b32 v111, s25, v97
    v_lshlrev_b32 v109, 16, v101
    v_and_b32 v112, s25, v101
    v_lshlrev_b32 v110, 16, v105
    v_and_b32 v113, s25, v105
    v_mul_f32 v114, s44, v108
    v_mul_f32 v115, s44, v111
    v_fmac_f32 v114, s45, v109
    v_fmac_f32 v115, s45, v112
    v_fmac_f32 v114, s46, v110
    v_fmac_f32 v115, s46, v113
    v_cvt_pk_bf16_f32 v97, v114, v115
    v_lshlrev_b32 v108, 16, v98
    v_and_b32 v111, s25, v98
    v_lshlrev_b32 v109, 16, v102
    v_and_b32 v112, s25, v102
    v_lshlrev_b32 v110, 16, v106
    v_and_b32 v113, s25, v106
    v_mul_f32 v114, s44, v108
    v_mul_f32 v115, s44, v111
    v_fmac_f32 v114, s45, v109
    v_fmac_f32 v115, s45, v112
    v_fmac_f32 v114, s46, v110
    v_fmac_f32 v115, s46, v113
    v_cvt_pk_bf16_f32 v98, v114, v115
    v_lshlrev_b32 v108, 16, v99
    v_and_b32 v111, s25, v99
    v_lshlrev_b32 v109, 16, v103
    v_and_b32 v112, s25, v103
    v_lshlrev_b32 v110, 16, v107
    v_and_b32 v113, s25, v107
    v_mul_f32 v114, s44, v108
    v_mul_f32 v115, s44, v111
    v_fmac_f32 v114, s45, v109
    v_fmac_f32 v115, s45, v112
    v_fmac_f32 v114, s46, v110
    v_fmac_f32 v115, s46, v113
    v_cvt_pk_bf16_f32 v99, v114, v115
    ds_write_b128 v126, v[96:99]
    s_waitcnt lgkmcnt(0)
    s_barrier
    s_mov_b32 s22, 4
    s_setprio 2
L_conv2_kernel_mloop1:
    ds_read_b128 v[96:99], v120 offset:0
    ds_read_b128 v[100:103], v120 offset:1024
    ds_read_b128 v[104:107], v120 offset:2048
    ds_read_b128 v[108:111], v120 offset:3072
    ds_read_b128 v[112:115], v120 offset:4096
    ds_read_b128 v[116:119], v120 offset:5120
    s_waitcnt vmcnt(6) lgkmcnt(5)
    v_mfma_f32_16x16x32_bf16 v[0:3], v[64:67], v[96:99], v[0:3]
    v_mfma_f32_16x16x32_bf16 v[32:35], v[68:71], v[96:99], v[32:35]
    ds_read_b128 v[96:99], v120 offset:6144
    s_waitcnt vmcnt(4) lgkmcnt(5)
    v_mfma_f32_16x16x32_bf16 v[4:7], v[64:67], v[100:103], v[4:7]
    v_mfma_f32_16x16x32_bf16 v[36:39], v[68:71], v[100:103], v[36:39]
    v_mfma_f32_16x16x32_bf16 v[0:3], v[72:75], v[100:103], v[0:3]
    v_mfma_f32_16x16x32_bf16 v[32:35], v[76:79], v[100:103], v[32:35]
    ds_read_b128 v[100:103], v120 offset:7168
    s_waitcnt vmcnt(2) lgkmcnt(5)
    v_mfma_f32_16x16x32_bf16 v[8:11], v[64:67], v[104:107], v[8:11]
    v_mfma_f32_16x16x32_bf16 v[40:43], v[68:71], v[104:107], v[40:43]
    v_mfma_f32_16x16x32_bf16 v[4:7], v[72:75], v[104:107], v[4:7]
    v_mfma_f32_16x16x32_bf16 v[36:39], v[76:79], v[104:107], v[36:39]
    v_mfma_f32_16x16x32_bf16 v[0:3], v[80:83], v[104:107], v[0:3]
    v_mfma_f32_16x16x32_bf16 v[32:35], v[84:87], v[104:107], v[32:35]
    ds_read_b128 v[104:107], v122 offset:0
    v_add_u32 v122, v123, v122
    s_waitcnt vmcnt(0) lgkmcnt(5)
    v_mfma_f32_16x16x32_bf16 v[12:15], v[64:67], v[108:111], v[12:15]
    v_mfma_f32_16x16x32_bf16 v[44:47], v[68:71], v[108:111], v[44:47]
    v_mfma_f32_16x16x32_bf16 v[8:11], v[72:75], v[108:111], v[8:11]
    v_mfma_f32_16x16x32_bf16 v[40:43], v[76:79], v[108:111], v[40:43]
    v_mfma_f32_16x16x32_bf16 v[4:7], v[80:83], v[108:111], v[4:7]
    v_mfma_f32_16x16x32_bf16 v[36:39], v[84:87], v[108:111], v[36:39]
    v_mfma_f32_16x16x32_bf16 v[0:3], v[88:91], v[108:111], v[0:3]
    v_mfma_f32_16x16x32_bf16 v[32:35], v[92:95], v[108:111], v[32:35]
    ds_read_b128 v[108:111], v121 offset:1024
    s_waitcnt lgkmcnt(5)
    v_mfma_f32_16x16x32_bf16 v[16:19], v[64:67], v[112:115], v[16:19]
    v_mfma_f32_16x16x32_bf16 v[48:51], v[68:71], v[112:115], v[48:51]
    v_mfma_f32_16x16x32_bf16 v[12:15], v[72:75], v[112:115], v[12:15]
    v_mfma_f32_16x16x32_bf16 v[44:47], v[76:79], v[112:115], v[44:47]
    v_mfma_f32_16x16x32_bf16 v[8:11], v[80:83], v[112:115], v[8:11]
    v_mfma_f32_16x16x32_bf16 v[40:43], v[84:87], v[112:115], v[40:43]
    v_mfma_f32_16x16x32_bf16 v[4:7], v[88:91], v[112:115], v[4:7]
    v_mfma_f32_16x16x32_bf16 v[36:39], v[92:95], v[112:115], v[36:39]
    ds_read_b128 v[112:115], v121 offset:2048
    s_waitcnt lgkmcnt(5)
    v_mfma_f32_16x16x32_bf16 v[20:23], v[64:67], v[116:119], v[20:23]
    v_mfma_f32_16x16x32_bf16 v[52:55], v[68:71], v[116:119], v[52:55]
    v_mfma_f32_16x16x32_bf16 v[16:19], v[72:75], v[116:119], v[16:19]
    v_mfma_f32_16x16x32_bf16 v[48:51], v[76:79], v[116:119], v[48:51]
    v_mfma_f32_16x16x32_bf16 v[12:15], v[80:83], v[116:119], v[12:15]
    v_mfma_f32_16x16x32_bf16 v[44:47], v[84:87], v[116:119], v[44:47]
    v_mfma_f32_16x16x32_bf16 v[8:11], v[88:91], v[116:119], v[8:11]
    v_mfma_f32_16x16x32_bf16 v[40:43], v[92:95], v[116:119], v[40:43]
    s_waitcnt lgkmcnt(4)
    v_mfma_f32_16x16x32_bf16 v[24:27], v[64:67], v[96:99], v[24:27]
    v_mfma_f32_16x16x32_bf16 v[56:59], v[68:71], v[96:99], v[56:59]
    v_mfma_f32_16x16x32_bf16 v[20:23], v[72:75], v[96:99], v[20:23]
    v_mfma_f32_16x16x32_bf16 v[52:55], v[76:79], v[96:99], v[52:55]
    v_mfma_f32_16x16x32_bf16 v[16:19], v[80:83], v[96:99], v[16:19]
    v_mfma_f32_16x16x32_bf16 v[48:51], v[84:87], v[96:99], v[48:51]
    v_mfma_f32_16x16x32_bf16 v[12:15], v[88:91], v[96:99], v[12:15]
    v_mfma_f32_16x16x32_bf16 v[44:47], v[92:95], v[96:99], v[44:47]
    s_waitcnt lgkmcnt(3)
    v_mfma_f32_16x16x32_bf16 v[28:31], v[64:67], v[100:103], v[28:31]
    v_mfma_f32_16x16x32_bf16 v[60:63], v[68:71], v[100:103], v[60:63]
    v_mfma_f32_16x16x32_bf16 v[24:27], v[72:75], v[100:103], v[24:27]
    v_mfma_f32_16x16x32_bf16 v[56:59], v[76:79], v[100:103], v[56:59]
    v_mfma_f32_16x16x32_bf16 v[20:23], v[80:83], v[100:103], v[20:23]
    v_mfma_f32_16x16x32_bf16 v[52:55], v[84:87], v[100:103], v[52:55]
    v_mfma_f32_16x16x32_bf16 v[16:19], v[88:91], v[100:103], v[16:19]
    v_mfma_f32_16x16x32_bf16 v[48:51], v[92:95], v[100:103], v[48:51]
    buffer_load_dwordx4 v[64:67], v125, s[12:15], s23 offen offset:0
    buffer_load_dwordx4 v[68:71], v125, s[12:15], s23 offen offset:1024
    s_waitcnt lgkmcnt(2)
    v_mfma_f32_16x16x32_bf16 v[28:31], v[72:75], v[104:107], v[28:31]
    v_mfma_f32_16x16x32_bf16 v[60:63], v[76:79], v[104:107], v[60:63]
    v_mfma_f32_16x16x32_bf16 v[24:27], v[80:83], v[104:107], v[24:27]
    v_mfma_f32_16x16x32_bf16 v[56:59], v[84:87], v[104:107], v[56:59]
    v_mfma_f32_16x16x32_bf16 v[20:23], v[88:91], v[104:107], v[20:23]
    v_mfma_f32_16x16x32_bf16 v[52:55], v[92:95], v[104:107], v[52:55]
    buffer_load_dwordx4 v[72:75], v125, s[12:15], s23 offen offset:2048
    buffer_load_dwordx4 v[76:79], v125, s[12:15], s23 offen offset:3072
    s_waitcnt lgkmcnt(1)
    v_mfma_f32_16x16x32_bf16 v[28:31], v[80:83], v[108:111], v[28:31]
    v_mfma_f32_16x16x32_bf16 v[60:63], v[84:87], v[108:111], v[60:63]
    v_mfma_f32_16x16x32_bf16 v[24:27], v[88:91], v[108:111], v[24:27]
    v_mfma_f32_16x16x32_bf16 v[56:59], v[92:95], v[108:111], v[56:59]
    buffer_load_dwordx4 v[80:83], v125, s[12:15], s26 offen offset:0
    buffer_load_dwordx4 v[84:87], v125, s[12:15], s26 offen offset:1024
    s_waitcnt lgkmcnt(0)
    v_mfma_f32_16x16x32_bf16 v[28:31], v[88:91], v[112:115], v[28:31]
    v_mfma_f32_16x16x32_bf16 v[60:63], v[92:95], v[112:115], v[60:63]
    buffer_load_dwordx4 v[88:91], v125, s[12:15], s26 offen offset:2048
    buffer_load_dwordx4 v[92:95], v125, s[12:15], s26 offen offset:3072
    s_add_u32 s23, s23, 57344
    s_add_u32 s26, s26, 57344
    s_barrier
    s_sub_u32 s22, s22, 1
    s_cmp_eq_u32 s22, 0
    s_cbranch_scc1 L_conv2_kernel_mlast1
    ds_read_b128 v[96:99], v120 offset:8192
    ds_read_b128 v[100:103], v120 offset:9216
    ds_read_b128 v[104:107], v120 offset:10240
    ds_read_b128 v[108:111], v120 offset:11264
    ds_read_b128 v[112:115], v120 offset:12288
    ds_read_b128 v[116:119], v120 offset:13312
    s_waitcnt vmcnt(6) lgkmcnt(5)
    v_mfma_f32_16x16x32_bf16 v[0:3], v[64:67], v[96:99], v[0:3]
    v_mfma_f32_16x16x32_bf16 v[32:35], v[68:71], v[96:99], v[32:35]
    ds_read_b128 v[96:99], v120 offset:14336
    s_waitcnt vmcnt(4) lgkmcnt(5)
    v_mfma_f32_16x16x32_bf16 v[4:7], v[64:67], v[100:103], v[4:7]
    v_mfma_f32_16x16x32_bf16 v[36:39], v[68:71], v[100:103], v[36:39]
    v_mfma_f32_16x16x32_bf16 v[0:3], v[72:75], v[100:103], v[0:3]
    v_mfma_f32_16x16x32_bf16 v[32:35], v[76:79], v[100:103], v[32:35]
    ds_read_b128 v[100:103], v120 offset:15360
    s_waitcnt vmcnt(2) lgkmcnt(5)
    v_mfma_f32_16x16x32_bf16 v[8:11], v[64:67], v[104:107], v[8:11]
    v_mfma_f32_16x16x32_bf16 v[40:43], v[68:71], v[104:107], v[40:43]
    v_mfma_f32_16x16x32_bf16 v[4:7], v[72:75], v[104:107], v[4:7]
    v_mfma_f32_16x16x32_bf16 v[36:39], v[76:79], v[104:107], v[36:39]
    v_mfma_f32_16x16x32_bf16 v[0:3], v[80:83], v[104:107], v[0:3]
    v_mfma_f32_16x16x32_bf16 v[32:35], v[84:87], v[104:107], v[32:35]
    ds_read_b128 v[104:107], v122 offset:0
    v_add_u32 v122, v124, v122
    s_waitcnt vmcnt(0) lgkmcnt(5)
    v_mfma_f32_16x16x32_bf16 v[12:15], v[64:67], v[108:111], v[12:15]
    v_mfma_f32_16x16x32_bf16 v[44:47], v[68:71], v[108:111], v[44:47]
    v_mfma_f32_16x16x32_bf16 v[8:11], v[72:75], v[108:111], v[8:11]
    v_mfma_f32_16x16x32_bf16 v[40:43], v[76:79], v[108:111], v[40:43]
    v_mfma_f32_16x16x32_bf16 v[4:7], v[80:83], v[108:111], v[4:7]
    v_mfma_f32_16x16x32_bf16 v[36:39], v[84:87], v[108:111], v[36:39]
    v_mfma_f32_16x16x32_bf16 v[0:3], v[88:91], v[108:111], v[0:3]
    v_mfma_f32_16x16x32_bf16 v[32:35], v[92:95], v[108:111], v[32:35]
    ds_read_b128 v[108:111], v121 offset:9216
    s_waitcnt lgkmcnt(5)
    v_mfma_f32_16x16x32_bf16 v[16:19], v[64:67], v[112:115], v[16:19]
    v_mfma_f32_16x16x32_bf16 v[48:51], v[68:71], v[112:115], v[48:51]
    v_mfma_f32_16x16x32_bf16 v[12:15], v[72:75], v[112:115], v[12:15]
    v_mfma_f32_16x16x32_bf16 v[44:47], v[76:79], v[112:115], v[44:47]
    v_mfma_f32_16x16x32_bf16 v[8:11], v[80:83], v[112:115], v[8:11]
    v_mfma_f32_16x16x32_bf16 v[40:43], v[84:87], v[112:115], v[40:43]
    v_mfma_f32_16x16x32_bf16 v[4:7], v[88:91], v[112:115], v[4:7]
    v_mfma_f32_16x16x32_bf16 v[36:39], v[92:95], v[112:115], v[36:39]
    ds_read_b128 v[112:115], v121 offset:10240
    s_waitcnt lgkmcnt(5)
    v_mfma_f32_16x16x32_bf16 v[20:23], v[64:67], v[116:119], v[20:23]
    v_mfma_f32_16x16x32_bf16 v[52:55], v[68:71], v[116:119], v[52:55]
    v_mfma_f32_16x16x32_bf16 v[16:19], v[72:75], v[116:119], v[16:19]
    v_mfma_f32_16x16x32_bf16 v[48:51], v[76:79], v[116:119], v[48:51]
    v_mfma_f32_16x16x32_bf16 v[12:15], v[80:83], v[116:119], v[12:15]
    v_mfma_f32_16x16x32_bf16 v[44:47], v[84:87], v[116:119], v[44:47]
    v_mfma_f32_16x16x32_bf16 v[8:11], v[88:91], v[116:119], v[8:11]
    v_mfma_f32_16x16x32_bf16 v[40:43], v[92:95], v[116:119], v[40:43]
    s_waitcnt lgkmcnt(4)
    v_mfma_f32_16x16x32_bf16 v[24:27], v[64:67], v[96:99], v[24:27]
    v_mfma_f32_16x16x32_bf16 v[56:59], v[68:71], v[96:99], v[56:59]
    v_mfma_f32_16x16x32_bf16 v[20:23], v[72:75], v[96:99], v[20:23]
    v_mfma_f32_16x16x32_bf16 v[52:55], v[76:79], v[96:99], v[52:55]
    v_mfma_f32_16x16x32_bf16 v[16:19], v[80:83], v[96:99], v[16:19]
    v_mfma_f32_16x16x32_bf16 v[48:51], v[84:87], v[96:99], v[48:51]
    v_mfma_f32_16x16x32_bf16 v[12:15], v[88:91], v[96:99], v[12:15]
    v_mfma_f32_16x16x32_bf16 v[44:47], v[92:95], v[96:99], v[44:47]
    s_waitcnt lgkmcnt(3)
    v_mfma_f32_16x16x32_bf16 v[28:31], v[64:67], v[100:103], v[28:31]
    v_mfma_f32_16x16x32_bf16 v[60:63], v[68:71], v[100:103], v[60:63]
    v_mfma_f32_16x16x32_bf16 v[24:27], v[72:75], v[100:103], v[24:27]
    v_mfma_f32_16x16x32_bf16 v[56:59], v[76:79], v[100:103], v[56:59]
    v_mfma_f32_16x16x32_bf16 v[20:23], v[80:83], v[100:103], v[20:23]
    v_mfma_f32_16x16x32_bf16 v[52:55], v[84:87], v[100:103], v[52:55]
    v_mfma_f32_16x16x32_bf16 v[16:19], v[88:91], v[100:103], v[16:19]
    v_mfma_f32_16x16x32_bf16 v[48:51], v[92:95], v[100:103], v[48:51]
    buffer_load_dwordx4 v[64:67], v125, s[12:15], s23 offen offset:0
    buffer_load_dwordx4 v[68:71], v125, s[12:15], s23 offen offset:1024
    s_waitcnt lgkmcnt(2)
    v_mfma_f32_16x16x32_bf16 v[28:31], v[72:75], v[104:107], v[28:31]
    v_mfma_f32_16x16x32_bf16 v[60:63], v[76:79], v[104:107], v[60:63]
    v_mfma_f32_16x16x32_bf16 v[24:27], v[80:83], v[104:107], v[24:27]
    v_mfma_f32_16x16x32_bf16 v[56:59], v[84:87], v[104:107], v[56:59]
    v_mfma_f32_16x16x32_bf16 v[20:23], v[88:91], v[104:107], v[20:23]
    v_mfma_f32_16x16x32_bf16 v[52:55], v[92:95], v[104:107], v[52:55]
    buffer_load_dwordx4 v[72:75], v125, s[12:15], s23 offen offset:2048
    buffer_load_dwordx4 v[76:79], v125, s[12:15], s23 offen offset:3072
    s_waitcnt lgkmcnt(1)
    v_mfma_f32_16x16x32_bf16 v[28:31], v[80:83], v[108:111], v[28:31]
    v_mfma_f32_16x16x32_bf16 v[60:63], v[84:87], v[108:111], v[60:63]
    v_mfma_f32_16x16x32_bf16 v[24:27], v[88:91], v[108:111], v[24:27]
    v_mfma_f32_16x16x32_bf16 v[56:59], v[92:95], v[108:111], v[56:59]
    buffer_load_dwordx4 v[80:83], v125, s[12:15], s26 offen offset:0
    buffer_load_dwordx4 v[84:87], v125, s[12:15], s26 offen offset:1024
    s_waitcnt lgkmcnt(0)
    v_mfma_f32_16x16x32_bf16 v[28:31], v[88:91], v[112:115], v[28:31]
    v_mfma_f32_16x16x32_bf16 v[60:63], v[92:95], v[112:115], v[60:63]
    buffer_load_dwordx4 v[88:91], v125, s[12:15], s26 offen offset:2048
    buffer_load_dwordx4 v[92:95], v125, s[12:15], s26 offen offset:3072
    s_add_u32 s23, s23, 57344
    s_add_u32 s26, s26, 57344
    s_barrier
    s_branch L_conv2_kernel_mloop1
L_conv2_kernel_mlast1:
    v_and_b32 v125, 15, v127
    v_and_b32 v126, 7, v127
    v_lshlrev_b32 v126, 4, v126
    v_lshl_add_u32 v125, v125, 7, v126
    v_lshrrev_b32 v126, 4, v127
    v_lshl_add_u32 v125, v126, 11, v125
    s_lshl_b32 s36, s20, 14
    s_add_u32 s37, s36, 8192
    v_add_u32 v126, s37, v125
    v_add_u32 v125, s36, v125
    ds_read_b128 v[96:99], v120 offset:8192
    ds_read_b128 v[100:103], v120 offset:9216
    ds_read_b128 v[104:107], v120 offset:10240
    ds_read_b128 v[108:111], v120 offset:11264
    ds_read_b128 v[112:115], v120 offset:12288
    ds_read_b128 v[116:119], v120 offset:13312
    s_waitcnt vmcnt(6) lgkmcnt(5)
    v_mfma_f32_16x16x32_bf16 v[0:3], v[64:67], v[96:99], v[0:3]
    v_mfma_f32_16x16x32_bf16 v[32:35], v[68:71], v[96:99], v[32:35]
    ds_read_b128 v[96:99], v120 offset:14336
    s_waitcnt vmcnt(4) lgkmcnt(5)
    v_mfma_f32_16x16x32_bf16 v[4:7], v[64:67], v[100:103], v[4:7]
    v_mfma_f32_16x16x32_bf16 v[36:39], v[68:71], v[100:103], v[36:39]
    v_mfma_f32_16x16x32_bf16 v[0:3], v[72:75], v[100:103], v[0:3]
    v_mfma_f32_16x16x32_bf16 v[32:35], v[76:79], v[100:103], v[32:35]
    ds_read_b128 v[100:103], v120 offset:15360
    s_waitcnt vmcnt(2) lgkmcnt(5)
    v_mfma_f32_16x16x32_bf16 v[8:11], v[64:67], v[104:107], v[8:11]
    v_mfma_f32_16x16x32_bf16 v[40:43], v[68:71], v[104:107], v[40:43]
    v_mfma_f32_16x16x32_bf16 v[4:7], v[72:75], v[104:107], v[4:7]
    v_mfma_f32_16x16x32_bf16 v[36:39], v[76:79], v[104:107], v[36:39]
    v_mfma_f32_16x16x32_bf16 v[0:3], v[80:83], v[104:107], v[0:3]
    v_mfma_f32_16x16x32_bf16 v[32:35], v[84:87], v[104:107], v[32:35]
    ds_read_b128 v[104:107], v122 offset:0
    s_waitcnt vmcnt(0) lgkmcnt(5)
    v_mfma_f32_16x16x32_bf16 v[12:15], v[64:67], v[108:111], v[12:15]
    v_mfma_f32_16x16x32_bf16 v[44:47], v[68:71], v[108:111], v[44:47]
    v_mfma_f32_16x16x32_bf16 v[8:11], v[72:75], v[108:111], v[8:11]
    v_mfma_f32_16x16x32_bf16 v[40:43], v[76:79], v[108:111], v[40:43]
    v_mfma_f32_16x16x32_bf16 v[4:7], v[80:83], v[108:111], v[4:7]
    v_mfma_f32_16x16x32_bf16 v[36:39], v[84:87], v[108:111], v[36:39]
    v_mfma_f32_16x16x32_bf16 v[0:3], v[88:91], v[108:111], v[0:3]
    v_mfma_f32_16x16x32_bf16 v[32:35], v[92:95], v[108:111], v[32:35]
    ds_read_b128 v[108:111], v121 offset:9216
    s_waitcnt lgkmcnt(5)
    v_mfma_f32_16x16x32_bf16 v[16:19], v[64:67], v[112:115], v[16:19]
    v_mfma_f32_16x16x32_bf16 v[48:51], v[68:71], v[112:115], v[48:51]
    v_mfma_f32_16x16x32_bf16 v[12:15], v[72:75], v[112:115], v[12:15]
    v_mfma_f32_16x16x32_bf16 v[44:47], v[76:79], v[112:115], v[44:47]
    v_mfma_f32_16x16x32_bf16 v[8:11], v[80:83], v[112:115], v[8:11]
    v_mfma_f32_16x16x32_bf16 v[40:43], v[84:87], v[112:115], v[40:43]
    v_mfma_f32_16x16x32_bf16 v[4:7], v[88:91], v[112:115], v[4:7]
    v_mfma_f32_16x16x32_bf16 v[36:39], v[92:95], v[112:115], v[36:39]
    ds_read_b128 v[112:115], v121 offset:10240
    v_xor_b32 v123, 0, v125
    ds_write_b128 v123, v[0:3]
    s_waitcnt lgkmcnt(6)
    v_mfma_f32_16x16x32_bf16 v[20:23], v[64:67], v[116:119], v[20:23]
    v_mfma_f32_16x16x32_bf16 v[52:55], v[68:71], v[116:119], v[52:55]
    v_mfma_f32_16x16x32_bf16 v[16:19], v[72:75], v[116:119], v[16:19]
    v_mfma_f32_16x16x32_bf16 v[48:51], v[76:79], v[116:119], v[48:51]
    v_mfma_f32_16x16x32_bf16 v[12:15], v[80:83], v[116:119], v[12:15]
    v_mfma_f32_16x16x32_bf16 v[44:47], v[84:87], v[116:119], v[44:47]
    v_mfma_f32_16x16x32_bf16 v[8:11], v[88:91], v[116:119], v[8:11]
    v_mfma_f32_16x16x32_bf16 v[40:43], v[92:95], v[116:119], v[40:43]
    v_xor_b32 v124, 16, v125
    ds_write_b128 v124, v[4:7]
    s_waitcnt lgkmcnt(2)
    v_mfma_f32_16x16x32_bf16 v[24:27], v[64:67], v[96:99], v[24:27]
    v_mfma_f32_16x16x32_bf16 v[56:59], v[68:71], v[96:99], v[56:59]
    v_mfma_f32_16x16x32_bf16 v[20:23], v[72:75], v[96:99], v[20:23]
    v_mfma_f32_16x16x32_bf16 v[52:55], v[76:79], v[96:99], v[52:55]
    v_mfma_f32_16x16x32_bf16 v[16:19], v[80:83], v[96:99], v[16:19]
    v_mfma_f32_16x16x32_bf16 v[48:51], v[84:87], v[96:99], v[48:51]
    v_mfma_f32_16x16x32_bf16 v[12:15], v[88:91], v[96:99], v[12:15]
    v_mfma_f32_16x16x32_bf16 v[44:47], v[92:95], v[96:99], v[44:47]
    v_xor_b32 v123, 32, v125
    ds_write_b128 v123, v[8:11]
    v_xor_b32 v124, 0, v126
    ds_write_b128 v124, v[32:35]
    v_mfma_f32_16x16x32_bf16 v[28:31], v[64:67], v[100:103], v[28:31]
    v_mfma_f32_16x16x32_bf16 v[60:63], v[68:71], v[100:103], v[60:63]
    v_mfma_f32_16x16x32_bf16 v[24:27], v[72:75], v[100:103], v[24:27]
    v_mfma_f32_16x16x32_bf16 v[56:59], v[76:79], v[100:103], v[56:59]
    v_mfma_f32_16x16x32_bf16 v[20:23], v[80:83], v[100:103], v[20:23]
    v_mfma_f32_16x16x32_bf16 v[52:55], v[84:87], v[100:103], v[52:55]
    v_mfma_f32_16x16x32_bf16 v[16:19], v[88:91], v[100:103], v[16:19]
    v_mfma_f32_16x16x32_bf16 v[48:51], v[92:95], v[100:103], v[48:51]
    v_xor_b32 v123, 16, v126
    ds_write_b128 v123, v[36:39]
    v_xor_b32 v124, 32, v126
    ds_write_b128 v124, v[40:43]
    v_mfma_f32_16x16x32_bf16 v[28:31], v[72:75], v[104:107], v[28:31]
    v_mfma_f32_16x16x32_bf16 v[60:63], v[76:79], v[104:107], v[60:63]
    v_mfma_f32_16x16x32_bf16 v[24:27], v[80:83], v[104:107], v[24:27]
    v_mfma_f32_16x16x32_bf16 v[56:59], v[84:87], v[104:107], v[56:59]
    v_mfma_f32_16x16x32_bf16 v[20:23], v[88:91], v[104:107], v[20:23]
    v_mfma_f32_16x16x32_bf16 v[52:55], v[92:95], v[104:107], v[52:55]
    v_xor_b32 v124, 48, v125
    ds_write_b128 v124, v[12:15]
    v_xor_b32 v123, 48, v126
    ds_write_b128 v123, v[44:47]
    v_mfma_f32_16x16x32_bf16 v[28:31], v[80:83], v[108:111], v[28:31]
    v_mfma_f32_16x16x32_bf16 v[60:63], v[84:87], v[108:111], v[60:63]
    v_mfma_f32_16x16x32_bf16 v[24:27], v[88:91], v[108:111], v[24:27]
    v_mfma_f32_16x16x32_bf16 v[56:59], v[92:95], v[108:111], v[56:59]
    v_xor_b32 v123, 64, v125
    ds_write_b128 v123, v[16:19]
    v_xor_b32 v124, 64, v126
    ds_write_b128 v124, v[48:51]
    v_mfma_f32_16x16x32_bf16 v[28:31], v[88:91], v[112:115], v[28:31]
    v_mfma_f32_16x16x32_bf16 v[60:63], v[92:95], v[112:115], v[60:63]
    v_xor_b32 v124, 80, v125
    ds_write_b128 v124, v[20:23]
    v_xor_b32 v123, 80, v126
    ds_write_b128 v123, v[52:55]
    s_nop 7
    v_xor_b32 v123, 96, v125
    ds_write_b128 v123, v[24:27]
    v_xor_b32 v124, 96, v126
    ds_write_b128 v124, v[56:59]
    v_xor_b32 v124, 112, v125
    ds_write_b128 v124, v[28:31]
    v_xor_b32 v123, 112, v126
    s_waitcnt lgkmcnt(8)
    ds_write_b128 v123, v[60:63]
    s_setprio 0
    s_branch L_conv2_kernel_epi
L_conv2_kernel_m2:
    s_mul_i32 s37, s38, 2176
    s_add_u32 s37, s37, 98304
    v_add_u32 v116, s37, v8
    v_add_u32 v118, s37, v9
    v_add_u32 v117, 104832, v8
    s_cmp_eq_u32 s38, 0
    s_cbranch_scc1 L_conv2_kernel_hh0
    v_add_u32 v117, 98304, v9
L_conv2_kernel_hh0:
    s_lshl_b32 s37, s38, 12
    s_add_u32 s37, s37, s43
    s_add_u32 s37, s37, 49152
    v_lshl_add_u32 v119, v127, 4, s37
    v_mov_b32 v0, 0
    v_mov_b32 v1, 0
    v_mov_b32 v2, 0
    v_mov_b32 v3, 0
    v_mov_b32 v4, 0
    v_mov_b32 v5, 0
    v_mov_b32 v6, 0
    v_mov_b32 v7, 0
    v_mov_b32 v8, 0
    v_mov_b32 v9, 0
    v_mov_b32 v10, 0
    v_mov_b32 v11, 0
    v_mov_b32 v12, 0
    v_mov_b32 v13, 0
    v_mov_b32 v14, 0
    v_mov_b32 v15, 0
    v_mov_b32 v16, 0
    v_mov_b32 v17, 0
    v_mov_b32 v18, 0
    v_mov_b32 v19, 0
    v_mov_b32 v20, 0
    v_mov_b32 v21, 0
    v_mov_b32 v22, 0
    v_mov_b32 v23, 0
    v_mov_b32 v24, 0
    v_mov_b32 v25, 0
    v_mov_b32 v26, 0
    v_mov_b32 v27, 0
    v_mov_b32 v28, 0
    v_mov_b32 v29, 0
    v_mov_b32 v30, 0
    v_mov_b32 v31, 0
    v_mov_b32 v32, 0
    v_mov_b32 v33, 0
    v_mov_b32 v34, 0
    v_mov_b32 v35, 0
    v_mov_b32 v36, 0
    v_mov_b32 v37, 0
    v_mov_b32 v38, 0
    v_mov_b32 v39, 0
    v_mov_b32 v40, 0
    v_mov_b32 v41, 0
    v_mov_b32 v42, 0
    v_mov_b32 v43, 0
    v_mov_b32 v44, 0
    v_mov_b32 v45, 0
    v_mov_b32 v46, 0
    v_mov_b32 v47, 0
    v_mov_b32 v48, 0
    v_mov_b32 v49, 0
    v_mov_b32 v50, 0
    v_mov_b32 v51, 0
    v_mov_b32 v52, 0
    v_mov_b32 v53, 0
    v_mov_b32 v54, 0
    v_mov_b32 v55, 0
    v_mov_b32 v56, 0
    v_mov_b32 v57, 0
    v_mov_b32 v58, 0
    v_mov_b32 v59, 0
    v_mov_b32 v60, 0
    v_mov_b32 v61, 0
    v_mov_b32 v62, 0
    v_mov_b32 v63, 0
    s_barrier
    buffer_load_dwordx4 v[96:99], v108, s[8:11], 0 offen offset:0
    buffer_load_dwordx4 v[100:103], v108, s[8:11], 0 offen offset:1024
    buffer_load_dwordx4 v[104:107], v108, s[8:11], 0 offen offset:2048
    s_mov_b32 s23, 0
    s_mov_b32 s26, 4096
    buffer_load_dwordx4 v[64:67], v125, s[12:15], s23 offen offset:0
    buffer_load_dwordx4 v[68:71], v125, s[12:15], s23 offen offset:2048
    buffer_load_dwordx4 v[80:83], v119, s[12:15], s23 offen offset:0
    buffer_load_dwordx4 v[72:75], v125, s[12:15], s26 offen offset:0
    buffer_load_dwordx4 v[84:87], v119, s[12:15], s23 offen offset:2048
    buffer_load_dwordx4 v[76:79], v125, s[12:15], s26 offen offset:2048
    s_mov_b32 s23, 57344
    s_mov_b32 s26, 61440
    s_waitcnt vmcnt(6)
    v_lshlrev_b32 v108, 16, v96
    v_and_b32 v111, s25, v96
    v_lshlrev_b32 v109, 16, v100
    v_and_b32 v112, s25, v100
    v_lshlrev_b32 v110, 16, v104
    v_and_b32 v113, s25, v104
    v_mul_f32 v114, s44, v108
    v_mul_f32 v115, s44, v111
    v_fmac_f32 v114, s45, v109
    v_fmac_f32 v115, s45, v112
    v_fmac_f32 v114, s46, v110
    v_fmac_f32 v115, s46, v113
    v_cvt_pk_bf16_f32 v96, v114, v115
    v_lshlrev_b32 v108, 16, v97
    v_and_b32 v111, s25, v97
    v_lshlrev_b32 v109, 16, v101
    v_and_b32 v112, s25, v101
    v_lshlrev_b32 v110, 16, v105
    v_and_b32 v113, s25, v105
    v_mul_f32 v114, s44, v108
    v_mul_f32 v115, s44, v111
    v_fmac_f32 v114, s45, v109
    v_fmac_f32 v115, s45, v112
    v_fmac_f32 v114, s46, v110
    v_fmac_f32 v115, s46, v113
    v_cvt_pk_bf16_f32 v97, v114, v115
    v_lshlrev_b32 v108, 16, v98
    v_and_b32 v111, s25, v98
    v_lshlrev_b32 v109, 16, v102
    v_and_b32 v112, s25, v102
    v_lshlrev_b32 v110, 16, v106
    v_and_b32 v113, s25, v106
    v_mul_f32 v114, s44, v108
    v_mul_f32 v115, s44, v111
    v_fmac_f32 v114, s45, v109
    v_fmac_f32 v115, s45, v112
    v_fmac_f32 v114, s46, v110
    v_fmac_f32 v115, s46, v113
    v_cvt_pk_bf16_f32 v98, v114, v115
    v_lshlrev_b32 v108, 16, v99
    v_and_b32 v111, s25, v99
    v_lshlrev_b32 v109, 16, v103
    v_and_b32 v112, s25, v103
    v_lshlrev_b32 v110, 16, v107
    v_and_b32 v113, s25, v107
    v_mul_f32 v114, s44, v108
    v_mul_f32 v115, s44, v111
    v_fmac_f32 v114, s45, v109
    v_fmac_f32 v115, s45, v112
    v_fmac_f32 v114, s46, v110
    v_fmac_f32 v115, s46, v113
    v_cvt_pk_bf16_f32 v99, v114, v115
    ds_write_b128 v126, v[96:99]
    v_and_b32 v126, 15, v127
    v_lshlrev_b32 v126, 2, v126
    v_add_u32 v126, 99328, v126
    ds_write_b32 v126, v0
    ds_write_b32 v126, v0 offset:8704
    s_waitcnt lgkmcnt(0)
    s_barrier
    s_mov_b32 s22, 4
    s_setprio 2
L_conv2_kernel_mloop2:
    ds_read_b128 v[88:91], v120 offset:0
    ds_read_b128 v[92:95], v120 offset:1024
    ds_read_b128 v[96:99], v116 offset:0
    ds_read_b128 v[100:103], v120 offset:2048
    ds_read_b128 v[104:107], v116 offset:1088
    ds_read_b128 v[108:111], v120 offset:3072
    ds_read_b128 v[112:115], v116 offset:2176
    s_waitcnt vmcnt(5) lgkmcnt(6)
    v_mfma_f32_16x16x32_bf16 v[0:3], v[64:67], v[88:91], v[0:3]
    ds_read_b128 v[88:91], v120 offset:4096
    s_waitcnt vmcnt(4) lgkmcnt(6)
    v_mfma_f32_16x16x32_bf16 v[4:7], v[64:67], v[92:95], v[4:7]
    v_mfma_f32_16x16x32_bf16 v[0:3], v[68:71], v[92:95], v[0:3]
    ds_read_b128 v[92:95], v116 offset:3264
    s_waitcnt vmcnt(3) lgkmcnt(6)
    v_mfma_f32_16x16x32_bf16 v[32:35], v[80:83], v[96:99], v[32:35]
    ds_read_b128 v[96:99], v120 offset:5120
    s_waitcnt vmcnt(2) lgkmcnt(6)
    v_mfma_f32_16x16x32_bf16 v[8:11], v[64:67], v[100:103], v[8:11]
    v_mfma_f32_16x16x32_bf16 v[4:7], v[68:71], v[100:103], v[4:7]
    v_mfma_f32_16x16x32_bf16 v[0:3], v[72:75], v[100:103], v[0:3]
    ds_read_b128 v[100:103], v116 offset:4352
    s_waitcnt vmcnt(1) lgkmcnt(6)
    v_mfma_f32_16x16x32_bf16 v[36:39], v[80:83], v[104:107], v[36:39]
    v_mfma_f32_16x16x32_bf16 v[32:35], v[84:87], v[104:107], v[32:35]
    ds_read_b128 v[104:107], v120 offset:6144
    s_waitcnt vmcnt(0) lgkmcnt(6)
    v_mfma_f32_16x16x32_bf16 v[12:15], v[64:67], v[108:111], v[12:15]
    v_mfma_f32_16x16x32_bf16 v[8:11], v[68:71], v[108:111], v[8:11]
    v_mfma_f32_16x16x32_bf16 v[4:7], v[72:75], v[108:111], v[4:7]
    v_mfma_f32_16x16x32_bf16 v[0:3], v[76:79], v[108:111], v[0:3]
    ds_read_b128 v[108:111], v116 offset:5440
    s_waitcnt lgkmcnt(6)
    v_mfma_f32_16x16x32_bf16 v[40:43], v[80:83], v[112:115], v[40:43]
    v_mfma_f32_16x16x32_bf16 v[36:39], v[84:87], v[112:115], v[36:39]
    ds_read_b128 v[112:115], v120 offset:7168
    s_waitcnt lgkmcnt(6)
    v_mfma_f32_16x16x32_bf16 v[16:19], v[64:67], v[88:91], v[16:19]
    v_mfma_f32_16x16x32_bf16 v[12:15], v[68:71], v[88:91], v[12:15]
    v_mfma_f32_16x16x32_bf16 v[8:11], v[72:75], v[88:91], v[8:11]
    v_mfma_f32_16x16x32_bf16 v[4:7], v[76:79], v[88:91], v[4:7]
    ds_read_b128 v[88:91], v117 offset:0
    s_waitcnt lgkmcnt(6)
    v_mfma_f32_16x16x32_bf16 v[44:47], v[80:83], v[92:95], v[44:47]
    v_mfma_f32_16x16x32_bf16 v[40:43], v[84:87], v[92:95], v[40:43]
    ds_read_b128 v[92:95], v122 offset:0
    v_add_u32 v122, v123, v122
    s_waitcnt lgkmcnt(6)
    v_mfma_f32_16x16x32_bf16 v[20:23], v[64:67], v[96:99], v[20:23]
    v_mfma_f32_16x16x32_bf16 v[16:19], v[68:71], v[96:99], v[16:19]
    v_mfma_f32_16x16x32_bf16 v[12:15], v[72:75], v[96:99], v[12:15]
    v_mfma_f32_16x16x32_bf16 v[8:11], v[76:79], v[96:99], v[8:11]
    ds_read_b128 v[96:99], v117 offset:1088
    s_waitcnt lgkmcnt(6)
    v_mfma_f32_16x16x32_bf16 v[48:51], v[80:83], v[100:103], v[48:51]
    v_mfma_f32_16x16x32_bf16 v[44:47], v[84:87], v[100:103], v[44:47]
    ds_read_b128 v[100:103], v121 offset:1024
    s_waitcnt lgkmcnt(6)
    v_mfma_f32_16x16x32_bf16 v[24:27], v[64:67], v[104:107], v[24:27]
    v_mfma_f32_16x16x32_bf16 v[20:23], v[68:71], v[104:107], v[20:23]
    v_mfma_f32_16x16x32_bf16 v[16:19], v[72:75], v[104:107], v[16:19]
    v_mfma_f32_16x16x32_bf16 v[12:15], v[76:79], v[104:107], v[12:15]
    ds_read_b128 v[104:107], v118 offset:0
    s_waitcnt lgkmcnt(6)
    v_mfma_f32_16x16x32_bf16 v[52:55], v[80:83], v[108:111], v[52:55]
    v_mfma_f32_16x16x32_bf16 v[48:51], v[84:87], v[108:111], v[48:51]
    ds_read_b128 v[108:111], v121 offset:2048
    s_waitcnt lgkmcnt(6)
    v_mfma_f32_16x16x32_bf16 v[28:31], v[64:67], v[112:115], v[28:31]
    v_mfma_f32_16x16x32_bf16 v[24:27], v[68:71], v[112:115], v[24:27]
    v_mfma_f32_16x16x32_bf16 v[20:23], v[72:75], v[112:115], v[20:23]
    v_mfma_f32_16x16x32_bf16 v[16:19], v[76:79], v[112:115], v[16:19]
    buffer_load_dwordx4 v[64:67], v125, s[12:15], s23 offen offset:0
    s_waitcnt lgkmcnt(5)
    v_mfma_f32_16x16x32_bf16 v[56:59], v[80:83], v[88:91], v[56:59]
    v_mfma_f32_16x16x32_bf16 v[52:55], v[84:87], v[88:91], v[52:55]
    s_waitcnt lgkmcnt(0)
    s_barrier
    v_mfma_f32_16x16x32_bf16 v[28:31], v[68:71], v[92:95], v[28:31]
    v_mfma_f32_16x16x32_bf16 v[24:27], v[72:75], v[92:95], v[24:27]
    v_mfma_f32_16x16x32_bf16 v[20:23], v[76:79], v[92:95], v[20:23]
    buffer_load_dwordx4 v[68:71], v125, s[12:15], s23 offen offset:2048
    v_mfma_f32_16x16x32_bf16 v[60:63], v[80:83], v[96:99], v[60:63]
    v_mfma_f32_16x16x32_bf16 v[56:59], v[84:87], v[96:99], v[56:59]
    buffer_load_dwordx4 v[80:83], v119, s[12:15], s23 offen offset:0
    v_mfma_f32_16x16x32_bf16 v[28:31], v[72:75], v[100:103], v[28:31]
    v_mfma_f32_16x16x32_bf16 v[24:27], v[76:79], v[100:103], v[24:27]
    buffer_load_dwordx4 v[72:75], v125, s[12:15], s26 offen offset:0
    v_mfma_f32_16x16x32_bf16 v[60:63], v[84:87], v[104:107], v[60:63]
    buffer_load_dwordx4 v[84:87], v119, s[12:15], s23 offen offset:2048
    v_mfma_f32_16x16x32_bf16 v[28:31], v[76:79], v[108:111], v[28:31]
    buffer_load_dwordx4 v[76:79], v125, s[12:15], s26 offen offset:2048
    s_add_u32 s23, s23, 57344
    s_add_u32 s26, s26, 57344
    s_sub_u32 s22, s22, 1
    s_cmp_eq_u32 s22, 0
    s_cbranch_scc1 L_conv2_kernel_mlast2
    ds_read_b128 v[88:91], v120 offset:8192
    ds_read_b128 v[92:95], v120 offset:9216
    ds_read_b128 v[96:99], v116 offset:8704
    ds_read_b128 v[100:103], v120 offset:10240
    ds_read_b128 v[104:107], v116 offset:9792
    ds_read_b128 v[108:111], v120 offset:11264
    ds_read_b128 v[112:115], v116 offset:10880
    s_waitcnt vmcnt(5) lgkmcnt(6)
    v_mfma_f32_16x16x32_bf16 v[0:3], v[64:67], v[88:91], v[0:3]
    ds_read_b128 v[88:91], v120 offset:12288
    s_waitcnt vmcnt(4) lgkmcnt(6)
    v_mfma_f32_16x16x32_bf16 v[4:7], v[64:67], v[92:95], v[4:7]
    v_mfma_f32_16x16x32_bf16 v[0:3], v[68:71], v[92:95], v[0:3]
    ds_read_b128 v[92:95], v116 offset:11968
    s_waitcnt vmcnt(3) lgkmcnt(6)
    v_mfma_f32_16x16x32_bf16 v[32:35], v[80:83], v[96:99], v[32:35]
    ds_read_b128 v[96:99], v120 offset:13312
    s_waitcnt vmcnt(2) lgkmcnt(6)
    v_mfma_f32_16x16x32_bf16 v[8:11], v[64:67], v[100:103], v[8:11]
    v_mfma_f32_16x16x32_bf16 v[4:7], v[68:71], v[100:103], v[4:7]
    v_mfma_f32_16x16x32_bf16 v[0:3], v[72:75], v[100:103], v[0:3]
    ds_read_b128 v[100:103], v116 offset:13056
    s_waitcnt vmcnt(1) lgkmcnt(6)
    v_mfma_f32_16x16x32_bf16 v[36:39], v[80:83], v[104:107], v[36:39]
    v_mfma_f32_16x16x32_bf16 v[32:35], v[84:87], v[104:107], v[32:35]
    ds_read_b128 v[104:107], v120 offset:14336
    s_waitcnt vmcnt(0) lgkmcnt(6)
    v_mfma_f32_16x16x32_bf16 v[12:15], v[64:67], v[108:111], v[12:15]
    v_mfma_f32_16x16x32_bf16 v[8:11], v[68:71], v[108:111], v[8:11]
    v_mfma_f32_16x16x32_bf16 v[4:7], v[72:75], v[108:111], v[4:7]
    v_mfma_f32_16x16x32_bf16 v[0:3], v[76:79], v[108:111], v[0:3]
    ds_read_b128 v[108:111], v116 offset:14144
    s_waitcnt lgkmcnt(6)
    v_mfma_f32_16x16x32_bf16 v[40:43], v[80:83], v[112:115], v[40:43]
    v_mfma_f32_16x16x32_bf16 v[36:39], v[84:87], v[112:115], v[36:39]
    ds_read_b128 v[112:115], v120 offset:15360
    s_waitcnt lgkmcnt(6)
    v_mfma_f32_16x16x32_bf16 v[16:19], v[64:67], v[88:91], v[16:19]
    v_mfma_f32_16x16x32_bf16 v[12:15], v[68:71], v[88:91], v[12:15]
    v_mfma_f32_16x16x32_bf16 v[8:11], v[72:75], v[88:91], v[8:11]
    v_mfma_f32_16x16x32_bf16 v[4:7], v[76:79], v[88:91], v[4:7]
    ds_read_b128 v[88:91], v117 offset:8704
    s_waitcnt lgkmcnt(6)
    v_mfma_f32_16x16x32_bf16 v[44:47], v[80:83], v[92:95], v[44:47]
    v_mfma_f32_16x16x32_bf16 v[40:43], v[84:87], v[92:95], v[40:43]
    ds_read_b128 v[92:95], v122 offset:0
    v_add_u32 v122, v124, v122
    s_waitcnt lgkmcnt(6)
    v_mfma_f32_16x16x32_bf16 v[20:23], v[64:67], v[96:99], v[20:23]
    v_mfma_f32_16x16x32_bf16 v[16:19], v[68:71], v[96:99], v[16:19]
    v_mfma_f32_16x16x32_bf16 v[12:15], v[72:75], v[96:99], v[12:15]
    v_mfma_f32_16x16x32_bf16 v[8:11], v[76:79], v[96:99], v[8:11]
    ds_read_b128 v[96:99], v117 offset:9792
    s_waitcnt lgkmcnt(6)
    v_mfma_f32_16x16x32_bf16 v[48:51], v[80:83], v[100:103], v[48:51]
    v_mfma_f32_16x16x32_bf16 v[44:47], v[84:87], v[100:103], v[44:47]
    ds_read_b128 v[100:103], v121 offset:9216
    s_waitcnt lgkmcnt(6)
    v_mfma_f32_16x16x32_bf16 v[24:27], v[64:67], v[104:107], v[24:27]
    v_mfma_f32_16x16x32_bf16 v[20:23], v[68:71], v[104:107], v[20:23]
    v_mfma_f32_16x16x32_bf16 v[16:19], v[72:75], v[104:107], v[16:19]
    v_mfma_f32_16x16x32_bf16 v[12:15], v[76:79], v[104:107], v[12:15]
    ds_read_b128 v[104:107], v118 offset:8704
    s_waitcnt lgkmcnt(6)
    v_mfma_f32_16x16x32_bf16 v[52:55], v[80:83], v[108:111], v[52:55]
    v_mfma_f32_16x16x32_bf16 v[48:51], v[84:87], v[108:111], v[48:51]
    ds_read_b128 v[108:111], v121 offset:10240
    s_waitcnt lgkmcnt(6)
    v_mfma_f32_16x16x32_bf16 v[28:31], v[64:67], v[112:115], v[28:31]
    v_mfma_f32_16x16x32_bf16 v[24:27], v[68:71], v[112:115], v[24:27]
    v_mfma_f32_16x16x32_bf16 v[20:23], v[72:75], v[112:115], v[20:23]
    v_mfma_f32_16x16x32_bf16 v[16:19], v[76:79], v[112:115], v[16:19]
    buffer_load_dwordx4 v[64:67], v125, s[12:15], s23 offen offset:0
    s_waitcnt lgkmcnt(5)
    v_mfma_f32_16x16x32_bf16 v[56:59], v[80:83], v[88:91], v[56:59]
    v_mfma_f32_16x16x32_bf16 v[52:55], v[84:87], v[88:91], v[52:55]
    s_waitcnt lgkmcnt(0)
    s_barrier
    v_mfma_f32_16x16x32_bf16 v[28:31], v[68:71], v[92:95], v[28:31]
    v_mfma_f32_16x16x32_bf16 v[24:27], v[72:75], v[92:95], v[24:27]
    v_mfma_f32_16x16x32_bf16 v[20:23], v[76:79], v[92:95], v[20:23]
    buffer_load_dwordx4 v[68:71], v125, s[12:15], s23 offen offset:2048
    v_mfma_f32_16x16x32_bf16 v[60:63], v[80:83], v[96:99], v[60:63]
    v_mfma_f32_16x16x32_bf16 v[56:59], v[84:87], v[96:99], v[56:59]
    buffer_load_dwordx4 v[80:83], v119, s[12:15], s23 offen offset:0
    v_mfma_f32_16x16x32_bf16 v[28:31], v[72:75], v[100:103], v[28:31]
    v_mfma_f32_16x16x32_bf16 v[24:27], v[76:79], v[100:103], v[24:27]
    buffer_load_dwordx4 v[72:75], v125, s[12:15], s26 offen offset:0
    v_mfma_f32_16x16x32_bf16 v[60:63], v[84:87], v[104:107], v[60:63]
    buffer_load_dwordx4 v[84:87], v119, s[12:15], s23 offen offset:2048
    v_mfma_f32_16x16x32_bf16 v[28:31], v[76:79], v[108:111], v[28:31]
    buffer_load_dwordx4 v[76:79], v125, s[12:15], s26 offen offset:2048
    s_add_u32 s23, s23, 57344
    s_add_u32 s26, s26, 57344
    s_branch L_conv2_kernel_mloop2
L_conv2_kernel_mlast2:
    v_and_b32 v125, 15, v127
    v_and_b32 v126, 7, v127
    v_lshlrev_b32 v126, 4, v126
    v_lshl_add_u32 v125, v125, 7, v126
    v_lshrrev_b32 v126, 4, v127
    v_lshl_add_u32 v125, v126, 11, v125
    s_mov_b32 s36, 65536
    s_cmp_eq_u32 s32, 1
    s_cselect_b32 s36, 121856, s36
    s_cmp_eq_u32 s32, 2
    s_cselect_b32 s36, 81920, s36
    s_cmp_eq_u32 s32, 3
    s_cselect_b32 s36, 130048, s36
    s_mov_b32 s37, 98304
    s_cmp_eq_u32 s32, 1
    s_cselect_b32 s37, 138240, s37
    s_cmp_eq_u32 s32, 2
    s_cselect_b32 s37, 146432, s37
    s_cmp_eq_u32 s32, 3
    s_cselect_b32 s37, 154624, s37
    v_add_u32 v126, s37, v125
    v_add_u32 v125, s36, v125
    ds_read_b128 v[88:91], v120 offset:8192
    ds_read_b128 v[92:95], v120 offset:9216
    ds_read_b128 v[96:99], v116 offset:8704
    ds_read_b128 v[100:103], v120 offset:10240
    ds_read_b128 v[104:107], v116 offset:9792
    ds_read_b128 v[108:111], v120 offset:11264
    ds_read_b128 v[112:115], v116 offset:10880
    s_waitcnt vmcnt(5) lgkmcnt(6)
    v_mfma_f32_16x16x32_bf16 v[0:3], v[64:67], v[88:91], v[0:3]
    ds_read_b128 v[88:91], v120 offset:12288
    s_waitcnt vmcnt(4) lgkmcnt(6)
    v_mfma_f32_16x16x32_bf16 v[4:7], v[64:67], v[92:95], v[4:7]
    v_mfma_f32_16x16x32_bf16 v[0:3], v[68:71], v[92:95], v[0:3]
    ds_read_b128 v[92:95], v116 offset:11968
    s_waitcnt vmcnt(3) lgkmcnt(6)
    v_mfma_f32_16x16x32_bf16 v[32:35], v[80:83], v[96:99], v[32:35]
    ds_read_b128 v[96:99], v120 offset:13312
    s_waitcnt vmcnt(2) lgkmcnt(6)
    v_mfma_f32_16x16x32_bf16 v[8:11], v[64:67], v[100:103], v[8:11]
    v_mfma_f32_16x16x32_bf16 v[4:7], v[68:71], v[100:103], v[4:7]
    v_mfma_f32_16x16x32_bf16 v[0:3], v[72:75], v[100:103], v[0:3]
    ds_read_b128 v[100:103], v116 offset:13056
    s_waitcnt vmcnt(1) lgkmcnt(6)
    v_mfma_f32_16x16x32_bf16 v[36:39], v[80:83], v[104:107], v[36:39]
    v_mfma_f32_16x16x32_bf16 v[32:35], v[84:87], v[104:107], v[32:35]
    ds_read_b128 v[104:107], v120 offset:14336
    s_waitcnt vmcnt(0) lgkmcnt(6)
    v_mfma_f32_16x16x32_bf16 v[12:15], v[64:67], v[108:111], v[12:15]
    v_mfma_f32_16x16x32_bf16 v[8:11], v[68:71], v[108:111], v[8:11]
    v_mfma_f32_16x16x32_bf16 v[4:7], v[72:75], v[108:111], v[4:7]
    v_mfma_f32_16x16x32_bf16 v[0:3], v[76:79], v[108:111], v[0:3]
    ds_read_b128 v[108:111], v116 offset:14144
    s_waitcnt lgkmcnt(6)
    v_mfma_f32_16x16x32_bf16 v[40:43], v[80:83], v[112:115], v[40:43]
    v_mfma_f32_16x16x32_bf16 v[36:39], v[84:87], v[112:115], v[36:39]
    ds_read_b128 v[112:115], v120 offset:15360
    s_waitcnt lgkmcnt(6)
    v_mfma_f32_16x16x32_bf16 v[16:19], v[64:67], v[88:91], v[16:19]
    v_mfma_f32_16x16x32_bf16 v[12:15], v[68:71], v[88:91], v[12:15]
    v_mfma_f32_16x16x32_bf16 v[8:11], v[72:75], v[88:91], v[8:11]
    v_mfma_f32_16x16x32_bf16 v[4:7], v[76:79], v[88:91], v[4:7]
    ds_read_b128 v[88:91], v117 offset:8704
    v_xor_b32 v124, 0, v126
    ds_write_b128 v124, v[32:35]
    s_waitcnt lgkmcnt(7)
    v_mfma_f32_16x16x32_bf16 v[44:47], v[80:83], v[92:95], v[44:47]
    v_mfma_f32_16x16x32_bf16 v[40:43], v[84:87], v[92:95], v[40:43]
    ds_read_b128 v[92:95], v122 offset:0
    v_xor_b32 v123, 0, v125
    ds_write_b128 v123, v[0:3]
    s_waitcnt lgkmcnt(8)
    v_mfma_f32_16x16x32_bf16 v[20:23], v[64:67], v[96:99], v[20:23]
    v_mfma_f32_16x16x32_bf16 v[16:19], v[68:71], v[96:99], v[16:19]
    v_mfma_f32_16x16x32_bf16 v[12:15], v[72:75], v[96:99], v[12:15]
    v_mfma_f32_16x16x32_bf16 v[8:11], v[76:79], v[96:99], v[8:11]
    ds_read_b128 v[96:99], v117 offset:9792
    v_xor_b32 v123, 16, v126
    ds_write_b128 v123, v[36:39]
    s_waitcnt lgkmcnt(9)
    v_mfma_f32_16x16x32_bf16 v[48:51], v[80:83], v[100:103], v[48:51]
    v_mfma_f32_16x16x32_bf16 v[44:47], v[84:87], v[100:103], v[44:47]
    ds_read_b128 v[100:103], v121 offset:9216
    v_xor_b32 v124, 16, v125
    ds_write_b128 v124, v[4:7]
    s_waitcnt lgkmcnt(10)
    v_mfma_f32_16x16x32_bf16 v[24:27], v[64:67], v[104:107], v[24:27]
    v_mfma_f32_16x16x32_bf16 v[20:23], v[68:71], v[104:107], v[20:23]
    v_mfma_f32_16x16x32_bf16 v[16:19], v[72:75], v[104:107], v[16:19]
    v_mfma_f32_16x16x32_bf16 v[12:15], v[76:79], v[104:107], v[12:15]
    ds_read_b128 v[104:107], v118 offset:8704
    v_xor_b32 v124, 32, v126
    ds_write_b128 v124, v[40:43]
    s_waitcnt lgkmcnt(11)
    v_mfma_f32_16x16x32_bf16 v[52:55], v[80:83], v[108:111], v[52:55]
    v_mfma_f32_16x16x32_bf16 v[48:51], v[84:87], v[108:111], v[48:51]
    ds_read_b128 v[108:111], v121 offset:10240
    v_xor_b32 v123, 32, v125
    ds_write_b128 v123, v[8:11]
    s_waitcnt lgkmcnt(12)
    v_mfma_f32_16x16x32_bf16 v[28:31], v[64:67], v[112:115], v[28:31]
    v_mfma_f32_16x16x32_bf16 v[24:27], v[68:71], v[112:115], v[24:27]
    v_mfma_f32_16x16x32_bf16 v[20:23], v[72:75], v[112:115], v[20:23]
    v_mfma_f32_16x16x32_bf16 v[16:19], v[76:79], v[112:115], v[16:19]
    v_xor_b32 v123, 48, v126
    ds_write_b128 v123, v[44:47]
    s_waitcnt lgkmcnt(12)
    v_mfma_f32_16x16x32_bf16 v[56:59], v[80:83], v[88:91], v[56:59]
    v_mfma_f32_16x16x32_bf16 v[52:55], v[84:87], v[88:91], v[52:55]
    v_xor_b32 v124, 48, v125
    ds_write_b128 v124, v[12:15]
    s_waitcnt lgkmcnt(11)
    v_mfma_f32_16x16x32_bf16 v[28:31], v[68:71], v[92:95], v[28:31]
    v_mfma_f32_16x16x32_bf16 v[24:27], v[72:75], v[92:95], v[24:27]
    v_mfma_f32_16x16x32_bf16 v[20:23], v[76:79], v[92:95], v[20:23]
    v_xor_b32 v124, 64, v126
    ds_write_b128 v124, v[48:51]
    s_waitcnt lgkmcnt(10)
    v_mfma_f32_16x16x32_bf16 v[60:63], v[80:83], v[96:99], v[60:63]
    v_mfma_f32_16x16x32_bf16 v[56:59], v[84:87], v[96:99], v[56:59]
    v_xor_b32 v123, 64, v125
    ds_write_b128 v123, v[16:19]
    s_waitcnt lgkmcnt(9)
    v_mfma_f32_16x16x32_bf16 v[28:31], v[72:75], v[100:103], v[28:31]
    v_mfma_f32_16x16x32_bf16 v[24:27], v[76:79], v[100:103], v[24:27]
    v_xor_b32 v123, 80, v126
    ds_write_b128 v123, v[52:55]
    s_waitcnt lgkmcnt(8)
    v_mfma_f32_16x16x32_bf16 v[60:63], v[84:87], v[104:107], v[60:63]
    v_xor_b32 v124, 80, v125
    ds_write_b128 v124, v[20:23]
    s_waitcnt lgkmcnt(7)
    v_mfma_f32_16x16x32_bf16 v[28:31], v[76:79], v[108:111], v[28:31]
    v_xor_b32 v124, 96, v126
    ds_write_b128 v124, v[56:59]
    s_nop 7
    v_xor_b32 v123, 96, v125
    ds_write_b128 v123, v[24:27]
    v_xor_b32 v123, 112, v126
    ds_write_b128 v123, v[60:63]
    v_xor_b32 v124, 112, v125
    ds_write_b128 v124, v[28:31]
    s_setprio 0
    s_branch L_conv2_kernel_epi
L_conv2_kernel_helper:
    s_setprio 3
    v_add_u32 v92, 0, v7
    v_add_u32 v93, 1024, v7
    v_add_u32 v94, 2048, v7
    v_add_u32 v95, 3072, v7
    v_and_b32 v76, 4, v5
    v_lshrrev_b32 v76, 1, v76
    v_xor_b32 v76, v6, v76
    v_lshlrev_b32 v76, 4, v76
    v_lshl_add_u32 v76, v5, 6, v76
    s_mov_b32 s24, 0
    buffer_load_dwordx4 v[0:3], v92, s[8:11], s24 offen offset:0
    buffer_load_dwordx4 v[16:19], v92, s[8:11], s24 offen offset:64
    v_add_u32 v92, 128, v92
    buffer_load_dwordx4 v[4:7], v93, s[8:11], s24 offen offset:0
    buffer_load_dwordx4 v[20:23], v93, s[8:11], s24 offen offset:64
    v_add_u32 v93, 128, v93
    buffer_load_dwordx4 v[8:11], v94, s[8:11], s24 offen offset:0
    buffer_load_dwordx4 v[24:27], v94, s[8:11], s24 offen offset:64
    v_add_u32 v94, 128, v94
    buffer_load_dwordx4 v[12:15], v95, s[8:11], s24 offen offset:0
    buffer_load_dwordx4 v[28:31], v95, s[8:11], s24 offen offset:64
    v_add_u32 v95, 128, v95
    s_barrier
    s_mul_i32 s36, s42, 1024
    v_add_u32 v96, s36, v76
    v_add_u32 v97, 65536, v96
    s_mul_i32 s36, s42, 1088
    s_add_u32 s36, s36, 98304
    v_add_u32 v98, s36, v76
    s_lshl_b32 s36, s29, 4
    s_lshl_b32 s37, s33, 3
    s_add_u32 s36, s36, s37
    s_mul_i32 s36, s36, 57344
    s_add_u32 s36, s36, 9437184
    s_add_u32 s12, s30, s36
    s_addc_u32 s13, s31, 0
    s_mov_b32 s14, 458752
    s_mov_b32 s15, 0x00020000
    s_bfe_u32 s36, s2, 196611
    s_lshl_b32 s36, s36, 3
    s_add_u32 s36, s36, s42
    s_lshl_b32 s36, s36, 14
    s_add_u32 s44, s36, s41
    s_add_u32 s44, s44, 256
    s_lshr_b32 s36, s2, 6
    s_lshl_b32 s36, s36, 3
    s_add_u32 s36, s36, s42
    s_mul_i32 s45, s36, 896
    s_add_u32 s45, s45, 57344
    s_waitcnt vmcnt(0)
    s_waitcnt lgkmcnt(0)
    s_mov_b32 s28, 0
    s_mov_b32 s22, 2
    s_cmp_ge_u32 s20, 12
    s_cbranch_scc1 L_conv2_kernel_h2
    s_waitcnt lgkmcnt(0)
    ds_write_b128 v96, v[0:3] offset:0
    ds_write_b128 v98, v[12:15] offset:0
    v_lshlrev_b32 v76, 16, v0
    v_and_b32 v84, s25, v0
    v_lshlrev_b32 v77, 16, v4
    v_and_b32 v85, s25, v4
    v_lshlrev_b32 v78, 16, v8
    v_and_b32 v86, s25, v8
    v_lshlrev_b32 v79, 16, v12
    v_and_b32 v87, s25, v12
    v_add_f32 v80, v76, v78
    v_add_f32 v88, v84, v86
    v_add_f32 v81, v77, v79
    v_add_f32 v89, v85, v87
    v_fma_f32 v82, v78, 4.0, v76
    v_fma_f32 v90, v86, 4.0, v84
    v_fma_f32 v83, v79, 4.0, v77
    v_fma_f32 v91, v87, 4.0, v85
    v_add_f32 v77, v80, v81
    v_add_f32 v85, v88, v89
    v_sub_f32 v78, v80, v81
    v_sub_f32 v86, v88, v89
    v_fma_f32 v79, v83, 2.0, v82
    v_fma_f32 v87, v91, 2.0, v90
    v_fma_f32 v82, v83, -2.0, v82
    v_fma_f32 v90, v91, -2.0, v90
    v_fmamk_f32 v80, v76, 0x41700000, v82
    v_fmamk_f32 v88, v84, 0x41700000, v90
    v_fmamk_f32 v80, v81, 0x41200000, v80
    v_fmamk_f32 v88, v89, 0x41200000, v88
    v_cvt_pk_bf16_f32 v4, v77, v85
    v_cvt_pk_bf16_f32 v8, v78, v86
    v_cvt_pk_bf16_f32 v64, v79, v87
    v_cvt_pk_bf16_f32 v68, v82, v90
    v_cvt_pk_bf16_f32 v72, v80, v88
    v_lshlrev_b32 v76, 16, v1
    v_and_b32 v84, s25, v1
    v_lshlrev_b32 v77, 16, v5
    v_and_b32 v85, s25, v5
    v_lshlrev_b32 v78, 16, v9
    v_and_b32 v86, s25, v9
    v_lshlrev_b32 v79, 16, v13
    v_and_b32 v87, s25, v13
    v_add_f32 v80, v76, v78
    v_add_f32 v88, v84, v86
    v_add_f32 v81, v77, v79
    v_add_f32 v89, v85, v87
    v_fma_f32 v82, v78, 4.0, v76
    v_fma_f32 v90, v86, 4.0, v84
    v_fma_f32 v83, v79, 4.0, v77
    v_fma_f32 v91, v87, 4.0, v85
    v_add_f32 v77, v80, v81
    v_add_f32 v85, v88, v89
    v_sub_f32 v78, v80, v81
    v_sub_f32 v86, v88, v89
    v_fma_f32 v79, v83, 2.0, v82
    v_fma_f32 v87, v91, 2.0, v90
    v_fma_f32 v82, v83, -2.0, v82
    v_fma_f32 v90, v91, -2.0, v90
    v_fmamk_f32 v80, v76, 0x41700000, v82
    v_fmamk_f32 v88, v84, 0x41700000, v90
    v_fmamk_f32 v80, v81, 0x41200000, v80
    v_fmamk_f32 v88, v89, 0x41200000, v88
    v_cvt_pk_bf16_f32 v5, v77, v85
    v_cvt_pk_bf16_f32 v9, v78, v86
    v_cvt_pk_bf16_f32 v65, v79, v87
    v_cvt_pk_bf16_f32 v69, v82, v90
    v_cvt_pk_bf16_f32 v73, v80, v88
    v_lshlrev_b32 v76, 16, v2
    v_and_b32 v84, s25, v2
    v_lshlrev_b32 v77, 16, v6
    v_and_b32 v85, s25, v6
    v_lshlrev_b32 v78, 16, v10
    v_and_b32 v86, s25, v10
    v_lshlrev_b32 v79, 16, v14
    v_and_b32 v87, s25, v14
    v_add_f32 v80, v76, v78
    v_add_f32 v88, v84, v86
    v_add_f32 v81, v77, v79
    v_add_f32 v89, v85, v87
    v_fma_f32 v82, v78, 4.0, v76
    v_fma_f32 v90, v86, 4.0, v84
    v_fma_f32 v83, v79, 4.0, v77
    v_fma_f32 v91, v87, 4.0, v85
    v_add_f32 v77, v80, v81
    v_add_f32 v85, v88, v89
    v_sub_f32 v78, v80, v81
    v_sub_f32 v86, v88, v89
    v_fma_f32 v79, v83, 2.0, v82
    v_fma_f32 v87, v91, 2.0, v90
    v_fma_f32 v82, v83, -2.0, v82
    v_fma_f32 v90, v91, -2.0, v90
    v_fmamk_f32 v80, v76, 0x41700000, v82
    v_fmamk_f32 v88, v84, 0x41700000, v90
    v_fmamk_f32 v80, v81, 0x41200000, v80
    v_fmamk_f32 v88, v89, 0x41200000, v88
    v_cvt_pk_bf16_f32 v6, v77, v85
    v_cvt_pk_bf16_f32 v10, v78, v86
    v_cvt_pk_bf16_f32 v66, v79, v87
    v_cvt_pk_bf16_f32 v70, v82, v90
    v_cvt_pk_bf16_f32 v74, v80, v88
    v_lshlrev_b32 v76, 16, v3
    v_and_b32 v84, s25, v3
    v_lshlrev_b32 v77, 16, v7
    v_and_b32 v85, s25, v7
    v_lshlrev_b32 v78, 16, v11
    v_and_b32 v86, s25, v11
    v_lshlrev_b32 v79, 16, v15
    v_and_b32 v87, s25, v15
    v_add_f32 v80, v76, v78
    v_add_f32 v88, v84, v86
    v_add_f32 v81, v77, v79
    v_add_f32 v89, v85, v87
    v_fma_f32 v82, v78, 4.0, v76
    v_fma_f32 v90, v86, 4.0, v84
    v_fma_f32 v83, v79, 4.0, v77
    v_fma_f32 v91, v87, 4.0, v85
    v_add_f32 v77, v80, v81
    v_add_f32 v85, v88, v89
    v_sub_f32 v78, v80, v81
    v_sub_f32 v86, v88, v89
    v_fma_f32 v79, v83, 2.0, v82
    v_fma_f32 v87, v91, 2.0, v90
    v_fma_f32 v82, v83, -2.0, v82
    v_fma_f32 v90, v91, -2.0, v90
    v_fmamk_f32 v80, v76, 0x41700000, v82
    v_fmamk_f32 v88, v84, 0x41700000, v90
    v_fmamk_f32 v80, v81, 0x41200000, v80
    v_fmamk_f32 v88, v89, 0x41200000, v88
    v_cvt_pk_bf16_f32 v7, v77, v85
    v_cvt_pk_bf16_f32 v11, v78, v86
    v_cvt_pk_bf16_f32 v67, v79, v87
    v_cvt_pk_bf16_f32 v71, v82, v90
    v_cvt_pk_bf16_f32 v75, v80, v88
    ds_write_b128 v96, v[4:7] offset:16384
    ds_write_b128 v96, v[8:11] offset:32768
    ds_write_b128 v96, v[64:67] offset:49152
    ds_write_b128 v97, v[68:71] offset:0
    ds_write_b128 v97, v[72:75] offset:16384
    buffer_load_dwordx4 v[32:35], v92, s[8:11], s24 offen offset:0
    buffer_load_dwordx4 v[48:51], v92, s[8:11], s24 offen offset:64
    v_add_u32 v92, 128, v92
    buffer_load_dwordx4 v[36:39], v93, s[8:11], s24 offen offset:0
    buffer_load_dwordx4 v[52:55], v93, s[8:11], s24 offen offset:64
    v_add_u32 v93, 128, v93
    s_waitcnt lgkmcnt(0)
    s_barrier
    s_setprio 1
L_conv2_kernel_hloop1:
    s_cmp_lt_u32 s28, 5
    s_cselect_b32 s24, 0, 2130706432
    v_lshlrev_b32 v76, 16, v16
    v_and_b32 v84, s25, v16
    v_lshlrev_b32 v77, 16, v20
    v_and_b32 v85, s25, v20
    v_lshlrev_b32 v78, 16, v24
    v_and_b32 v86, s25, v24
    v_lshlrev_b32 v79, 16, v28
    v_and_b32 v87, s25, v28
    v_add_f32 v80, v76, v78
    v_add_f32 v88, v84, v86
    v_add_f32 v81, v77, v79
    v_add_f32 v89, v85, v87
    v_fma_f32 v82, v78, 4.0, v76
    buffer_load_dwordx4 v[40:43], v94, s[8:11], s24 offen offset:0
    buffer_load_dwordx4 v[56:59], v94, s[8:11], s24 offen offset:64
    v_add_u32 v94, 128, v94
    v_fma_f32 v90, v86, 4.0, v84
    v_fma_f32 v83, v79, 4.0, v77
    v_fma_f32 v91, v87, 4.0, v85
    v_add_f32 v77, v80, v81
    v_add_f32 v85, v88, v89
    v_sub_f32 v78, v80, v81
    v_sub_f32 v86, v88, v89
    v_fma_f32 v79, v83, 2.0, v82
    v_fma_f32 v87, v91, 2.0, v90
    v_fma_f32 v82, v83, -2.0, v82
    v_fma_f32 v90, v91, -2.0, v90
    v_fmamk_f32 v80, v76, 0x41700000, v82
    v_fmamk_f32 v88, v84, 0x41700000, v90
    v_fmamk_f32 v80, v81, 0x41200000, v80
    v_fmamk_f32 v88, v89, 0x41200000, v88
    v_cvt_pk_bf16_f32 v20, v77, v85
    v_cvt_pk_bf16_f32 v24, v78, v86
    v_cvt_pk_bf16_f32 v64, v79, v87
    v_cvt_pk_bf16_f32 v68, v82, v90
    v_cvt_pk_bf16_f32 v72, v80, v88
    v_lshlrev_b32 v76, 16, v17
    v_and_b32 v84, s25, v17
    v_lshlrev_b32 v77, 16, v21
    v_and_b32 v85, s25, v21
    v_lshlrev_b32 v78, 16, v25
    v_and_b32 v86, s25, v25
    v_lshlrev_b32 v79, 16, v29
    v_and_b32 v87, s25, v29
    v_add_f32 v80, v76, v78
    v_add_f32 v88, v84, v86
    v_add_f32 v81, v77, v79
    v_add_f32 v89, v85, v87
    v_fma_f32 v82, v78, 4.0, v76
    v_fma_f32 v90, v86, 4.0, v84
    v_fma_f32 v83, v79, 4.0, v77
    v_fma_f32 v91, v87, 4.0, v85
    v_add_f32 v77, v80, v81
    v_add_f32 v85, v88, v89
    v_sub_f32 v78, v80, v81
    v_sub_f32 v86, v88, v89
    v_fma_f32 v79, v83, 2.0, v82
    v_fma_f32 v87, v91, 2.0, v90
    v_fma_f32 v82, v83, -2.0, v82
    v_fma_f32 v90, v91, -2.0, v90
    v_fmamk_f32 v80, v76, 0x41700000, v82
    v_fmamk_f32 v88, v84, 0x41700000, v90
    v_fmamk_f32 v80, v81, 0x41200000, v80
    v_fmamk_f32 v88, v89, 0x41200000, v88
    v_cvt_pk_bf16_f32 v21, v77, v85
    v_cvt_pk_bf16_f32 v25, v78, v86
    v_cvt_pk_bf16_f32 v65, v79, v87
    v_cvt_pk_bf16_f32 v69, v82, v90
    v_cvt_pk_bf16_f32 v73, v80, v88
    buffer_load_dwordx4 v[44:47], v95, s[8:11], s24 offen offset:0
    buffer_load_dwordx4 v[60:63], v95, s[8:11], s24 offen offset:64
    v_add_u32 v95, 128, v95
    v_lshlrev_b32 v76, 16, v18
    v_and_b32 v84, s25, v18
    v_lshlrev_b32 v77, 16, v22
    v_and_b32 v85, s25, v22
    v_lshlrev_b32 v78, 16, v26
    v_and_b32 v86, s25, v26
    v_lshlrev_b32 v79, 16, v30
    v_and_b32 v87, s25, v30
    v_add_f32 v80, v76, v78
    v_add_f32 v88, v84, v86
    v_add_f32 v81, v77, v79
    v_add_f32 v89, v85, v87
    v_fma_f32 v82, v78, 4.0, v76
    v_fma_f32 v90, v86, 4.0, v84
    v_fma_f32 v83, v79, 4.0, v77
    v_fma_f32 v91, v87, 4.0, v85
    v_add_f32 v77, v80, v81
    v_add_f32 v85, v88, v89
    v_sub_f32 v78, v80, v81
    v_sub_f32 v86, v88, v89
    v_fma_f32 v79, v83, 2.0, v82
    v_fma_f32 v87, v91, 2.0, v90
    v_fma_f32 v82, v83, -2.0, v82
    v_fma_f32 v90, v91, -2.0, v90
    v_fmamk_f32 v80, v76, 0x41700000, v82
    v_fmamk_f32 v88, v84, 0x41700000, v90
    v_fmamk_f32 v80, v81, 0x41200000, v80
    v_fmamk_f32 v88, v89, 0x41200000, v88
    v_cvt_pk_bf16_f32 v22, v77, v85
    v_cvt_pk_bf16_f32 v26, v78, v86
    v_cvt_pk_bf16_f32 v66, v79, v87
    v_cvt_pk_bf16_f32 v70, v82, v90
    v_cvt_pk_bf16_f32 v74, v80, v88
    v_lshlrev_b32 v76, 16, v19
    v_and_b32 v84, s25, v19
    v_lshlrev_b32 v77, 16, v23
    v_and_b32 v85, s25, v23
    v_lshlrev_b32 v78, 16, v27
    v_and_b32 v86, s25, v27
    v_lshlrev_b32 v79, 16, v31
    v_and_b32 v87, s25, v31
    v_add_f32 v80, v76, v78
    v_add_f32 v88, v84, v86
    v_add_f32 v81, v77, v79
    v_add_f32 v89, v85, v87
    v_fma_f32 v82, v78, 4.0, v76
    v_fma_f32 v90, v86, 4.0, v84
    v_fma_f32 v83, v79, 4.0, v77
    v_fma_f32 v91, v87, 4.0, v85
    v_add_f32 v77, v80, v81
    v_add_f32 v85, v88, v89
    v_sub_f32 v78, v80, v81
    v_sub_f32 v86, v88, v89
    v_fma_f32 v79, v83, 2.0, v82
    v_fma_f32 v87, v91, 2.0, v90
    v_fma_f32 v82, v83, -2.0, v82
    v_fma_f32 v90, v91, -2.0, v90
    v_fmamk_f32 v80, v76, 0x41700000, v82
    v_fmamk_f32 v88, v84, 0x41700000, v90
    v_fmamk_f32 v80, v81, 0x41200000, v80
    v_fmamk_f32 v88, v89, 0x41200000, v88
    v_cvt_pk_bf16_f32 v23, v77, v85
    v_cvt_pk_bf16_f32 v27, v78, v86
    v_cvt_pk_bf16_f32 v67, v79, v87
    v_cvt_pk_bf16_f32 v71, v82, v90
    v_cvt_pk_bf16_f32 v75, v80, v88
    s_waitcnt lgkmcnt(0)
    ds_write_b128 v96, v[64:67] offset:57344
    ds_write_b128 v97, v[68:71] offset:8192
    ds_write_b128 v97, v[72:75] offset:24576
    ds_write_b128 v96, v[16:19] offset:8192
    ds_write_b128 v96, v[20:23] offset:24576
    ds_write_b128 v96, v[24:27] offset:40960
    ds_write_b128 v98, v[28:31] offset:8704
    s_add_u32 s28, s28, 1
    s_waitcnt lgkmcnt(0)
    s_barrier
    s_cmp_lt_u32 s28, 5
    s_cselect_b32 s24, 0, 2130706432
    s_waitcnt vmcnt(0)
    v_lshlrev_b32 v76, 16, v32
    v_and_b32 v84, s25, v32
    v_lshlrev_b32 v77, 16, v36
    v_and_b32 v85, s25, v36
    v_lshlrev_b32 v78, 16, v40
    v_and_b32 v86, s25, v40
    v_lshlrev_b32 v79, 16, v44
    v_and_b32 v87, s25, v44
    v_add_f32 v80, v76, v78
    v_add_f32 v88, v84, v86
    v_add_f32 v81, v77, v79
    v_add_f32 v89, v85, v87
    v_fma_f32 v82, v78, 4.0, v76
    v_fma_f32 v90, v86, 4.0, v84
    v_fma_f32 v83, v79, 4.0, v77
    v_fma_f32 v91, v87, 4.0, v85
    v_add_f32 v77, v80, v81
    v_add_f32 v85, v88, v89
    v_sub_f32 v78, v80, v81
    v_sub_f32 v86, v88, v89
    v_fma_f32 v79, v83, 2.0, v82
    v_fma_f32 v87, v91, 2.0, v90
    v_fma_f32 v82, v83, -2.0, v82
    v_fma_f32 v90, v91, -2.0, v90
    v_fmamk_f32 v80, v76, 0x41700000, v82
    v_fmamk_f32 v88, v84, 0x41700000, v90
    v_fmamk_f32 v80, v81, 0x41200000, v80
    v_fmamk_f32 v88, v89, 0x41200000, v88
    v_cvt_pk_bf16_f32 v36, v77, v85
    v_cvt_pk_bf16_f32 v40, v78, v86
    v_cvt_pk_bf16_f32 v64, v79, v87
    v_cvt_pk_bf16_f32 v68, v82, v90
    v_cvt_pk_bf16_f32 v72, v80, v88
    v_lshlrev_b32 v76, 16, v33
    v_and_b32 v84, s25, v33
    v_lshlrev_b32 v77, 16, v37
    v_and_b32 v85, s25, v37
    v_lshlrev_b32 v78, 16, v41
    v_and_b32 v86, s25, v41
    buffer_load_dwordx4 v[0:3], v92, s[8:11], s24 offen offset:0
    buffer_load_dwordx4 v[16:19], v92, s[8:11], s24 offen offset:64
    v_add_u32 v92, 128, v92
    v_lshlrev_b32 v79, 16, v45
    v_and_b32 v87, s25, v45
    v_add_f32 v80, v76, v78
    v_add_f32 v88, v84, v86
    v_add_f32 v81, v77, v79
    v_add_f32 v89, v85, v87
    v_fma_f32 v82, v78, 4.0, v76
    v_fma_f32 v90, v86, 4.0, v84
    v_fma_f32 v83, v79, 4.0, v77
    v_fma_f32 v91, v87, 4.0, v85
    v_add_f32 v77, v80, v81
    v_add_f32 v85, v88, v89
    v_sub_f32 v78, v80, v81
    v_sub_f32 v86, v88, v89
    v_fma_f32 v79, v83, 2.0, v82
    v_fma_f32 v87, v91, 2.0, v90
    v_fma_f32 v82, v83, -2.0, v82
    v_fma_f32 v90, v91, -2.0, v90
    v_fmamk_f32 v80, v76, 0x41700000, v82
    v_fmamk_f32 v88, v84, 0x41700000, v90
    v_fmamk_f32 v80, v81, 0x41200000, v80
    v_fmamk_f32 v88, v89, 0x41200000, v88
    v_cvt_pk_bf16_f32 v37, v77, v85
    v_cvt_pk_bf16_f32 v41, v78, v86
    v_cvt_pk_bf16_f32 v65, v79, v87
    v_cvt_pk_bf16_f32 v69, v82, v90
    v_cvt_pk_bf16_f32 v73, v80, v88
    v_lshlrev_b32 v76, 16, v34
    v_and_b32 v84, s25, v34
    v_lshlrev_b32 v77, 16, v38
    v_and_b32 v85, s25, v38
    v_lshlrev_b32 v78, 16, v42
    v_and_b32 v86, s25, v42
    v_lshlrev_b32 v79, 16, v46
    v_and_b32 v87, s25, v46
    v_add_f32 v80, v76, v78
    v_add_f32 v88, v84, v86
    v_add_f32 v81, v77, v79
    v_add_f32 v89, v85, v87
    v_fma_f32 v82, v78, 4.0, v76
    v_fma_f32 v90, v86, 4.0, v84
    v_fma_f32 v83, v79, 4.0, v77
    v_fma_f32 v91, v87, 4.0, v85
    v_add_f32 v77, v80, v81
    v_add_f32 v85, v88, v89
    v_sub_f32 v78, v80, v81
    v_sub_f32 v86, v88, v89
    v_fma_f32 v79, v83, 2.0, v82
    v_fma_f32 v87, v91, 2.0, v90
    v_fma_f32 v82, v83, -2.0, v82
    v_fma_f32 v90, v91, -2.0, v90
    v_fmamk_f32 v80, v76, 0x41700000, v82
    v_fmamk_f32 v88, v84, 0x41700000, v90
    buffer_load_dwordx4 v[4:7], v93, s[8:11], s24 offen offset:0
    buffer_load_dwordx4 v[20:23], v93, s[8:11], s24 offen offset:64
    v_add_u32 v93, 128, v93
    v_fmamk_f32 v80, v81, 0x41200000, v80
    v_fmamk_f32 v88, v89, 0x41200000, v88
    v_cvt_pk_bf16_f32 v38, v77, v85
    v_cvt_pk_bf16_f32 v42, v78, v86
    v_cvt_pk_bf16_f32 v66, v79, v87
    v_cvt_pk_bf16_f32 v70, v82, v90
    v_cvt_pk_bf16_f32 v74, v80, v88
    v_lshlrev_b32 v76, 16, v35
    v_and_b32 v84, s25, v35
    v_lshlrev_b32 v77, 16, v39
    v_and_b32 v85, s25, v39
    v_lshlrev_b32 v78, 16, v43
    v_and_b32 v86, s25, v43
    v_lshlrev_b32 v79, 16, v47
    v_and_b32 v87, s25, v47
    v_add_f32 v80, v76, v78
    v_add_f32 v88, v84, v86
    v_add_f32 v81, v77, v79
    v_add_f32 v89, v85, v87
    v_fma_f32 v82, v78, 4.0, v76
    v_fma_f32 v90, v86, 4.0, v84
    v_fma_f32 v83, v79, 4.0, v77
    v_fma_f32 v91, v87, 4.0, v85
    v_add_f32 v77, v80, v81
    v_add_f32 v85, v88, v89
    v_sub_f32 v78, v80, v81
    v_sub_f32 v86, v88, v89
    v_fma_f32 v79, v83, 2.0, v82
    v_fma_f32 v87, v91, 2.0, v90
    v_fma_f32 v82, v83, -2.0, v82
    v_fma_f32 v90, v91, -2.0, v90
    v_fmamk_f32 v80, v76, 0x41700000, v82
    v_fmamk_f32 v88, v84, 0x41700000, v90
    v_fmamk_f32 v80, v81, 0x41200000, v80
    v_fmamk_f32 v88, v89, 0x41200000, v88
    v_cvt_pk_bf16_f32 v39, v77, v85
    v_cvt_pk_bf16_f32 v43, v78, v86
    v_cvt_pk_bf16_f32 v67, v79, v87
    v_cvt_pk_bf16_f32 v71, v82, v90
    v_cvt_pk_bf16_f32 v75, v80, v88
    s_waitcnt lgkmcnt(0)
    ds_write_b128 v96, v[64:67] offset:49152
    ds_write_b128 v97, v[68:71] offset:0
    ds_write_b128 v97, v[72:75] offset:16384
    ds_write_b128 v96, v[32:35] offset:0
    ds_write_b128 v96, v[36:39] offset:16384
    ds_write_b128 v96, v[40:43] offset:32768
    ds_write_b128 v98, v[44:47] offset:0
    s_add_u32 s28, s28, 1
    s_waitcnt lgkmcnt(0)
    s_barrier
    s_cmp_lt_u32 s28, 5
    s_cselect_b32 s24, 0, 2130706432
    v_lshlrev_b32 v76, 16, v48
    v_and_b32 v84, s25, v48
    v_lshlrev_b32 v77, 16, v52
    v_and_b32 v85, s25, v52
    v_lshlrev_b32 v78, 16, v56
    v_and_b32 v86, s25, v56
    v_lshlrev_b32 v79, 16, v60
    v_and_b32 v87, s25, v60
    v_add_f32 v80, v76, v78
    v_add_f32 v88, v84, v86
    v_add_f32 v81, v77, v79
    v_add_f32 v89, v85, v87
    v_fma_f32 v82, v78, 4.0, v76
    buffer_load_dwordx4 v[8:11], v94, s[8:11], s24 offen offset:0
    buffer_load_dwordx4 v[24:27], v94, s[8:11], s24 offen offset:64
    v_add_u32 v94, 128, v94
    v_fma_f32 v90, v86, 4.0, v84
    v_fma_f32 v83, v79, 4.0, v77
    v_fma_f32 v91, v87, 4.0, v85
    v_add_f32 v77, v80, v81
    v_add_f32 v85, v88, v89
    v_sub_f32 v78, v80, v81
    v_sub_f32 v86, v88, v89
    v_fma_f32 v79, v83, 2.0, v82
    v_fma_f32 v87, v91, 2.0, v90
    v_fma_f32 v82, v83, -2.0, v82
    v_fma_f32 v90, v91, -2.0, v90
    v_fmamk_f32 v80, v76, 0x41700000, v82
    v_fmamk_f32 v88, v84, 0x41700000, v90
    v_fmamk_f32 v80, v81, 0x41200000, v80
    v_fmamk_f32 v88, v89, 0x41200000, v88
    v_cvt_pk_bf16_f32 v52, v77, v85
    v_cvt_pk_bf16_f32 v56, v78, v86
    v_cvt_pk_bf16_f32 v64, v79, v87
    v_cvt_pk_bf16_f32 v68, v82, v90
    v_cvt_pk_bf16_f32 v72, v80, v88
    v_lshlrev_b32 v76, 16, v49
    v_and_b32 v84, s25, v49
    v_lshlrev_b32 v77, 16, v53
    v_and_b32 v85, s25, v53
    v_lshlrev_b32 v78, 16, v57
    v_and_b32 v86, s25, v57
    v_lshlrev_b32 v79, 16, v61
    v_and_b32 v87, s25, v61
    v_add_f32 v80, v76, v78
    v_add_f32 v88, v84, v86
    v_add_f32 v81, v77, v79
    v_add_f32 v89, v85, v87
    v_fma_f32 v82, v78, 4.0, v76
    v_fma_f32 v90, v86, 4.0, v84
    v_fma_f32 v83, v79, 4.0, v77
    v_fma_f32 v91, v87, 4.0, v85
    v_add_f32 v77, v80, v81
    v_add_f32 v85, v88, v89
    v_sub_f32 v78, v80, v81
    v_sub_f32 v86, v88, v89
    v_fma_f32 v79, v83, 2.0, v82
    v_fma_f32 v87, v91, 2.0, v90
    v_fma_f32 v82, v83, -2.0, v82
    v_fma_f32 v90, v91, -2.0, v90
    v_fmamk_f32 v80, v76, 0x41700000, v82
    v_fmamk_f32 v88, v84, 0x41700000, v90
    v_fmamk_f32 v80, v81, 0x41200000, v80
    v_fmamk_f32 v88, v89, 0x41200000, v88
    v_cvt_pk_bf16_f32 v53, v77, v85
    v_cvt_pk_bf16_f32 v57, v78, v86
    v_cvt_pk_bf16_f32 v65, v79, v87
    v_cvt_pk_bf16_f32 v69, v82, v90
    v_cvt_pk_bf16_f32 v73, v80, v88
    buffer_load_dwordx4 v[12:15], v95, s[8:11], s24 offen offset:0
    buffer_load_dwordx4 v[28:31], v95, s[8:11], s24 offen offset:64
    v_add_u32 v95, 128, v95
    v_lshlrev_b32 v76, 16, v50
    v_and_b32 v84, s25, v50
    v_lshlrev_b32 v77, 16, v54
    v_and_b32 v85, s25, v54
    v_lshlrev_b32 v78, 16, v58
    v_and_b32 v86, s25, v58
    v_lshlrev_b32 v79, 16, v62
    v_and_b32 v87, s25, v62
    v_add_f32 v80, v76, v78
    v_add_f32 v88, v84, v86
    v_add_f32 v81, v77, v79
    v_add_f32 v89, v85, v87
    v_fma_f32 v82, v78, 4.0, v76
    v_fma_f32 v90, v86, 4.0, v84
    v_fma_f32 v83, v79, 4.0, v77
    v_fma_f32 v91, v87, 4.0, v85
    v_add_f32 v77, v80, v81
    v_add_f32 v85, v88, v89
    v_sub_f32 v78, v80, v81
    v_sub_f32 v86, v88, v89
    v_fma_f32 v79, v83, 2.0, v82
    v_fma_f32 v87, v91, 2.0, v90
    v_fma_f32 v82, v83, -2.0, v82
    v_fma_f32 v90, v91, -2.0, v90
    v_fmamk_f32 v80, v76, 0x41700000, v82
    v_fmamk_f32 v88, v84, 0x41700000, v90
    v_fmamk_f32 v80, v81, 0x41200000, v80
    v_fmamk_f32 v88, v89, 0x41200000, v88
    v_cvt_pk_bf16_f32 v54, v77, v85
    v_cvt_pk_bf16_f32 v58, v78, v86
    v_cvt_pk_bf16_f32 v66, v79, v87
    v_cvt_pk_bf16_f32 v70, v82, v90
    v_cvt_pk_bf16_f32 v74, v80, v88
    v_lshlrev_b32 v76, 16, v51
    v_and_b32 v84, s25, v51
    v_lshlrev_b32 v77, 16, v55
    v_and_b32 v85, s25, v55
    v_lshlrev_b32 v78, 16, v59
    v_and_b32 v86, s25, v59
    v_lshlrev_b32 v79, 16, v63
    v_and_b32 v87, s25, v63
    v_add_f32 v80, v76, v78
    v_add_f32 v88, v84, v86
    v_add_f32 v81, v77, v79
    v_add_f32 v89, v85, v87
    v_fma_f32 v82, v78, 4.0, v76
    v_fma_f32 v90, v86, 4.0, v84
    v_fma_f32 v83, v79, 4.0, v77
    v_fma_f32 v91, v87, 4.0, v85
    v_add_f32 v77, v80, v81
    v_add_f32 v85, v88, v89
    v_sub_f32 v78, v80, v81
    v_sub_f32 v86, v88, v89
    v_fma_f32 v79, v83, 2.0, v82
    v_fma_f32 v87, v91, 2.0, v90
    v_fma_f32 v82, v83, -2.0, v82
    v_fma_f32 v90, v91, -2.0, v90
    v_fmamk_f32 v80, v76, 0x41700000, v82
    v_fmamk_f32 v88, v84, 0x41700000, v90
    v_fmamk_f32 v80, v81, 0x41200000, v80
    v_fmamk_f32 v88, v89, 0x41200000, v88
    v_cvt_pk_bf16_f32 v55, v77, v85
    v_cvt_pk_bf16_f32 v59, v78, v86
    v_cvt_pk_bf16_f32 v67, v79, v87
    v_cvt_pk_bf16_f32 v71, v82, v90
    v_cvt_pk_bf16_f32 v75, v80, v88
    s_waitcnt lgkmcnt(0)
    ds_write_b128 v96, v[64:67] offset:57344
    ds_write_b128 v97, v[68:71] offset:8192
    ds_write_b128 v97, v[72:75] offset:24576
    ds_write_b128 v96, v[48:51] offset:8192
    ds_write_b128 v96, v[52:55] offset:24576
    ds_write_b128 v96, v[56:59] offset:40960
    ds_write_b128 v98, v[60:63] offset:8704
    s_add_u32 s28, s28, 1
    s_waitcnt lgkmcnt(0)
    s_barrier
    s_cmp_eq_u32 s22, 1
    s_cbranch_scc1 L_conv2_kernel_hlast1
    s_cmp_lt_u32 s28, 5
    s_cselect_b32 s24, 0, 2130706432
    s_waitcnt vmcnt(0)
    v_lshlrev_b32 v76, 16, v0
    v_and_b32 v84, s25, v0
    v_lshlrev_b32 v77, 16, v4
    v_and_b32 v85, s25, v4
    v_lshlrev_b32 v78, 16, v8
    v_and_b32 v86, s25, v8
    v_lshlrev_b32 v79, 16, v12
    v_and_b32 v87, s25, v12
    v_add_f32 v80, v76, v78
    v_add_f32 v88, v84, v86
    v_add_f32 v81, v77, v79
    v_add_f32 v89, v85, v87
    v_fma_f32 v82, v78, 4.0, v76
    v_fma_f32 v90, v86, 4.0, v84
    v_fma_f32 v83, v79, 4.0, v77
    v_fma_f32 v91, v87, 4.0, v85
    v_add_f32 v77, v80, v81
    v_add_f32 v85, v88, v89
    v_sub_f32 v78, v80, v81
    v_sub_f32 v86, v88, v89
    v_fma_f32 v79, v83, 2.0, v82
    v_fma_f32 v87, v91, 2.0, v90
    v_fma_f32 v82, v83, -2.0, v82
    v_fma_f32 v90, v91, -2.0, v90
    v_fmamk_f32 v80, v76, 0x41700000, v82
    v_fmamk_f32 v88, v84, 0x41700000, v90
    v_fmamk_f32 v80, v81, 0x41200000, v80
    v_fmamk_f32 v88, v89, 0x41200000, v88
    v_cvt_pk_bf16_f32 v4, v77, v85
    v_cvt_pk_bf16_f32 v8, v78, v86
    v_cvt_pk_bf16_f32 v64, v79, v87
    v_cvt_pk_bf16_f32 v68, v82, v90
    v_cvt_pk_bf16_f32 v72, v80, v88
    v_lshlrev_b32 v76, 16, v1
    v_and_b32 v84, s25, v1
    v_lshlrev_b32 v77, 16, v5
    v_and_b32 v85, s25, v5
    v_lshlrev_b32 v78, 16, v9
    v_and_b32 v86, s25, v9
    buffer_load_dwordx4 v[32:35], v92, s[8:11], s24 offen offset:0
    buffer_load_dwordx4 v[48:51], v92, s[8:11], s24 offen offset:64
    v_add_u32 v92, 128, v92
    v_lshlrev_b32 v79, 16, v13
    v_and_b32 v87, s25, v13
    v_add_f32 v80, v76, v78
    v_add_f32 v88, v84, v86
    v_add_f32 v81, v77, v79
    v_add_f32 v89, v85, v87
    v_fma_f32 v82, v78, 4.0, v76
    v_fma_f32 v90, v86, 4.0, v84
    v_fma_f32 v83, v79, 4.0, v77
    v_fma_f32 v91, v87, 4.0, v85
    v_add_f32 v77, v80, v81
    v_add_f32 v85, v88, v89
    v_sub_f32 v78, v80, v81
    v_sub_f32 v86, v88, v89
    v_fma_f32 v79, v83, 2.0, v82
    v_fma_f32 v87, v91, 2.0, v90
    v_fma_f32 v82, v83, -2.0, v82
    v_fma_f32 v90, v91, -2.0, v90
    v_fmamk_f32 v80, v76, 0x41700000, v82
    v_fmamk_f32 v88, v84, 0x41700000, v90
    v_fmamk_f32 v80, v81, 0x41200000, v80
    v_fmamk_f32 v88, v89, 0x41200000, v88
    v_cvt_pk_bf16_f32 v5, v77, v85
    v_cvt_pk_bf16_f32 v9, v78, v86
    v_cvt_pk_bf16_f32 v65, v79, v87
    v_cvt_pk_bf16_f32 v69, v82, v90
    v_cvt_pk_bf16_f32 v73, v80, v88
    v_lshlrev_b32 v76, 16, v2
    v_and_b32 v84, s25, v2
    v_lshlrev_b32 v77, 16, v6
    v_and_b32 v85, s25, v6
    v_lshlrev_b32 v78, 16, v10
    v_and_b32 v86, s25, v10
    v_lshlrev_b32 v79, 16, v14
    v_and_b32 v87, s25, v14
    v_add_f32 v80, v76, v78
    v_add_f32 v88, v84, v86
    v_add_f32 v81, v77, v79
    v_add_f32 v89, v85, v87
    v_fma_f32 v82, v78, 4.0, v76
    v_fma_f32 v90, v86, 4.0, v84
    v_fma_f32 v83, v79, 4.0, v77
    v_fma_f32 v91, v87, 4.0, v85
    v_add_f32 v77, v80, v81
    v_add_f32 v85, v88, v89
    v_sub_f32 v78, v80, v81
    v_sub_f32 v86, v88, v89
    v_fma_f32 v79, v83, 2.0, v82
    v_fma_f32 v87, v91, 2.0, v90
    v_fma_f32 v82, v83, -2.0, v82
    v_fma_f32 v90, v91, -2.0, v90
    v_fmamk_f32 v80, v76, 0x41700000, v82
    v_fmamk_f32 v88, v84, 0x41700000, v90
    buffer_load_dwordx4 v[36:39], v93, s[8:11], s24 offen offset:0
    buffer_load_dwordx4 v[52:55], v93, s[8:11], s24 offen offset:64
    v_add_u32 v93, 128, v93
    v_fmamk_f32 v80, v81, 0x41200000, v80
    v_fmamk_f32 v88, v89, 0x41200000, v88
    v_cvt_pk_bf16_f32 v6, v77, v85
    v_cvt_pk_bf16_f32 v10, v78, v86
    v_cvt_pk_bf16_f32 v66, v79, v87
    v_cvt_pk_bf16_f32 v70, v82, v90
    v_cvt_pk_bf16_f32 v74, v80, v88
    v_lshlrev_b32 v76, 16, v3
    v_and_b32 v84, s25, v3
    v_lshlrev_b32 v77, 16, v7
    v_and_b32 v85, s25, v7
    v_lshlrev_b32 v78, 16, v11
    v_and_b32 v86, s25, v11
    v_lshlrev_b32 v79, 16, v15
    v_and_b32 v87, s25, v15
    v_add_f32 v80, v76, v78
    v_add_f32 v88, v84, v86
    v_add_f32 v81, v77, v79
    v_add_f32 v89, v85, v87
    v_fma_f32 v82, v78, 4.0, v76
    v_fma_f32 v90, v86, 4.0, v84
    v_fma_f32 v83, v79, 4.0, v77
    v_fma_f32 v91, v87, 4.0, v85
    v_add_f32 v77, v80, v81
    v_add_f32 v85, v88, v89
    v_sub_f32 v78, v80, v81
    v_sub_f32 v86, v88, v89
    v_fma_f32 v79, v83, 2.0, v82
    v_fma_f32 v87, v91, 2.0, v90
    v_fma_f32 v82, v83, -2.0, v82
    v_fma_f32 v90, v91, -2.0, v90
    v_fmamk_f32 v80, v76, 0x41700000, v82
    v_fmamk_f32 v88, v84, 0x41700000, v90
    v_fmamk_f32 v80, v81, 0x41200000, v80
    v_fmamk_f32 v88, v89, 0x41200000, v88
    v_cvt_pk_bf16_f32 v7, v77, v85
    v_cvt_pk_bf16_f32 v11, v78, v86
    v_cvt_pk_bf16_f32 v67, v79, v87
    v_cvt_pk_bf16_f32 v71, v82, v90
    v_cvt_pk_bf16_f32 v75, v80, v88
    s_waitcnt lgkmcnt(0)
    ds_write_b128 v96, v[64:67] offset:49152
    ds_write_b128 v97, v[68:71] offset:0
    ds_write_b128 v97, v[72:75] offset:16384
    ds_write_b128 v96, v[0:3] offset:0
    ds_write_b128 v96, v[4:7] offset:16384
    ds_write_b128 v96, v[8:11] offset:32768
    ds_write_b128 v98, v[12:15] offset:0
    s_add_u32 s28, s28, 1
    s_waitcnt lgkmcnt(0)
    s_barrier
    s_sub_u32 s22, s22, 1
    s_branch L_conv2_kernel_hloop1
L_conv2_kernel_hlast1:
    s_branch L_conv2_kernel_end
L_conv2_kernel_h2:
    s_waitcnt lgkmcnt(0)
    ds_write_b128 v96, v[0:3] offset:0
    ds_write_b128 v98, v[12:15] offset:0
    v_lshlrev_b32 v76, 16, v0
    v_and_b32 v84, s25, v0
    v_lshlrev_b32 v77, 16, v4
    v_and_b32 v85, s25, v4
    v_lshlrev_b32 v78, 16, v8
    v_and_b32 v86, s25, v8
    v_lshlrev_b32 v79, 16, v12
    v_and_b32 v87, s25, v12
    v_add_f32 v80, v76, v78
    v_add_f32 v88, v84, v86
    v_add_f32 v81, v77, v79
    v_add_f32 v89, v85, v87
    v_fma_f32 v82, v78, 4.0, v76
    v_fma_f32 v90, v86, 4.0, v84
    v_fma_f32 v83, v79, 4.0, v77
    v_fma_f32 v91, v87, 4.0, v85
    v_add_f32 v77, v80, v81
    v_add_f32 v85, v88, v89
    v_sub_f32 v78, v80, v81
    v_sub_f32 v86, v88, v89
    v_fma_f32 v79, v83, 2.0, v82
    v_fma_f32 v87, v91, 2.0, v90
    v_fma_f32 v82, v83, -2.0, v82
    v_fma_f32 v90, v91, -2.0, v90
    v_fmamk_f32 v80, v76, 0x41700000, v82
    v_fmamk_f32 v88, v84, 0x41700000, v90
    v_fmamk_f32 v80, v81, 0x41200000, v80
    v_fmamk_f32 v88, v89, 0x41200000, v88
    v_cvt_pk_bf16_f32 v4, v77, v85
    v_cvt_pk_bf16_f32 v8, v78, v86
    v_cvt_pk_bf16_f32 v64, v79, v87
    v_cvt_pk_bf16_f32 v68, v82, v90
    v_cvt_pk_bf16_f32 v72, v80, v88
    v_lshlrev_b32 v76, 16, v1
    v_and_b32 v84, s25, v1
    v_lshlrev_b32 v77, 16, v5
    v_and_b32 v85, s25, v5
    v_lshlrev_b32 v78, 16, v9
    v_and_b32 v86, s25, v9
    v_lshlrev_b32 v79, 16, v13
    v_and_b32 v87, s25, v13
    v_add_f32 v80, v76, v78
    v_add_f32 v88, v84, v86
    v_add_f32 v81, v77, v79
    v_add_f32 v89, v85, v87
    v_fma_f32 v82, v78, 4.0, v76
    v_fma_f32 v90, v86, 4.0, v84
    v_fma_f32 v83, v79, 4.0, v77
    v_fma_f32 v91, v87, 4.0, v85
    v_add_f32 v77, v80, v81
    v_add_f32 v85, v88, v89
    v_sub_f32 v78, v80, v81
    v_sub_f32 v86, v88, v89
    v_fma_f32 v79, v83, 2.0, v82
    v_fma_f32 v87, v91, 2.0, v90
    v_fma_f32 v82, v83, -2.0, v82
    v_fma_f32 v90, v91, -2.0, v90
    v_fmamk_f32 v80, v76, 0x41700000, v82
    v_fmamk_f32 v88, v84, 0x41700000, v90
    v_fmamk_f32 v80, v81, 0x41200000, v80
    v_fmamk_f32 v88, v89, 0x41200000, v88
    v_cvt_pk_bf16_f32 v5, v77, v85
    v_cvt_pk_bf16_f32 v9, v78, v86
    v_cvt_pk_bf16_f32 v65, v79, v87
    v_cvt_pk_bf16_f32 v69, v82, v90
    v_cvt_pk_bf16_f32 v73, v80, v88
    v_lshlrev_b32 v76, 16, v2
    v_and_b32 v84, s25, v2
    v_lshlrev_b32 v77, 16, v6
    v_and_b32 v85, s25, v6
    v_lshlrev_b32 v78, 16, v10
    v_and_b32 v86, s25, v10
    v_lshlrev_b32 v79, 16, v14
    v_and_b32 v87, s25, v14
    v_add_f32 v80, v76, v78
    v_add_f32 v88, v84, v86
    v_add_f32 v81, v77, v79
    v_add_f32 v89, v85, v87
    v_fma_f32 v82, v78, 4.0, v76
    v_fma_f32 v90, v86, 4.0, v84
    v_fma_f32 v83, v79, 4.0, v77
    v_fma_f32 v91, v87, 4.0, v85
    v_add_f32 v77, v80, v81
    v_add_f32 v85, v88, v89
    v_sub_f32 v78, v80, v81
    v_sub_f32 v86, v88, v89
    v_fma_f32 v79, v83, 2.0, v82
    v_fma_f32 v87, v91, 2.0, v90
    v_fma_f32 v82, v83, -2.0, v82
    v_fma_f32 v90, v91, -2.0, v90
    v_fmamk_f32 v80, v76, 0x41700000, v82
    v_fmamk_f32 v88, v84, 0x41700000, v90
    v_fmamk_f32 v80, v81, 0x41200000, v80
    v_fmamk_f32 v88, v89, 0x41200000, v88
    v_cvt_pk_bf16_f32 v6, v77, v85
    v_cvt_pk_bf16_f32 v10, v78, v86
    v_cvt_pk_bf16_f32 v66, v79, v87
    v_cvt_pk_bf16_f32 v70, v82, v90
    v_cvt_pk_bf16_f32 v74, v80, v88
    v_lshlrev_b32 v76, 16, v3
    v_and_b32 v84, s25, v3
    v_lshlrev_b32 v77, 16, v7
    v_and_b32 v85, s25, v7
    v_lshlrev_b32 v78, 16, v11
    v_and_b32 v86, s25, v11
    v_lshlrev_b32 v79, 16, v15
    v_and_b32 v87, s25, v15
    v_add_f32 v80, v76, v78
    v_add_f32 v88, v84, v86
    v_add_f32 v81, v77, v79
    v_add_f32 v89, v85, v87
    v_fma_f32 v82, v78, 4.0, v76
    v_fma_f32 v90, v86, 4.0, v84
    v_fma_f32 v83, v79, 4.0, v77
    v_fma_f32 v91, v87, 4.0, v85
    v_add_f32 v77, v80, v81
    v_add_f32 v85, v88, v89
    v_sub_f32 v78, v80, v81
    v_sub_f32 v86, v88, v89
    v_fma_f32 v79, v83, 2.0, v82
    v_fma_f32 v87, v91, 2.0, v90
    v_fma_f32 v82, v83, -2.0, v82
    v_fma_f32 v90, v91, -2.0, v90
    v_fmamk_f32 v80, v76, 0x41700000, v82
    v_fmamk_f32 v88, v84, 0x41700000, v90
    v_fmamk_f32 v80, v81, 0x41200000, v80
    v_fmamk_f32 v88, v89, 0x41200000, v88
    v_cvt_pk_bf16_f32 v7, v77, v85
    v_cvt_pk_bf16_f32 v11, v78, v86
    v_cvt_pk_bf16_f32 v67, v79, v87
    v_cvt_pk_bf16_f32 v71, v82, v90
    v_cvt_pk_bf16_f32 v75, v80, v88
    ds_write_b128 v96, v[4:7] offset:16384
    ds_write_b128 v96, v[8:11] offset:32768
    ds_write_b128 v96, v[64:67] offset:49152
    ds_write_b128 v97, v[68:71] offset:0
    ds_write_b128 v97, v[72:75] offset:16384
    buffer_load_dwordx4 v[32:35], v92, s[8:11], s24 offen offset:0
    buffer_load_dwordx4 v[48:51], v92, s[8:11], s24 offen offset:64
    v_add_u32 v92, 128, v92
    buffer_load_dwordx4 v[36:39], v93, s[8:11], s24 offen offset:0
    buffer_load_dwordx4 v[52:55], v93, s[8:11], s24 offen offset:64
    v_add_u32 v93, 128, v93
    buffer_load_dwordx4 v[40:43], v94, s[8:11], s24 offen offset:0
    buffer_load_dwordx4 v[56:59], v94, s[8:11], s24 offen offset:64
    v_add_u32 v94, 128, v94
    buffer_load_dwordx4 v[44:47], v95, s[8:11], s24 offen offset:0
    buffer_load_dwordx4 v[60:63], v95, s[8:11], s24 offen offset:64
    v_add_u32 v95, 128, v95
    s_waitcnt lgkmcnt(0)
    s_barrier
    s_setprio 0
    v_lshlrev_b32 v76, 16, v16
    v_and_b32 v84, s25, v16
    v_lshlrev_b32 v77, 16, v20
    v_and_b32 v85, s25, v20
    v_lshlrev_b32 v78, 16, v24
    v_and_b32 v86, s25, v24
    v_lshlrev_b32 v79, 16, v28
    v_and_b32 v87, s25, v28
    v_add_f32 v80, v76, v78
    v_add_f32 v88, v84, v86
    v_add_f32 v81, v77, v79
    v_add_f32 v89, v85, v87
    v_fma_f32 v82, v78, 4.0, v76
    v_fma_f32 v90, v86, 4.0, v84
    v_fma_f32 v83, v79, 4.0, v77
    v_fma_f32 v91, v87, 4.0, v85
    v_add_f32 v77, v80, v81
    v_add_f32 v85, v88, v89
    v_sub_f32 v78, v80, v81
    v_sub_f32 v86, v88, v89
    v_fma_f32 v79, v83, 2.0, v82
    v_fma_f32 v87, v91, 2.0, v90
    v_fma_f32 v82, v83, -2.0, v82
    v_fma_f32 v90, v91, -2.0, v90
    v_fmamk_f32 v80, v76, 0x41700000, v82
    v_fmamk_f32 v88, v84, 0x41700000, v90
    v_fmamk_f32 v80, v81, 0x41200000, v80
    v_fmamk_f32 v88, v89, 0x41200000, v88
    v_cvt_pk_bf16_f32 v20, v77, v85
    v_cvt_pk_bf16_f32 v24, v78, v86
    v_cvt_pk_bf16_f32 v64, v79, v87
    v_cvt_pk_bf16_f32 v68, v82, v90
    v_cvt_pk_bf16_f32 v72, v80, v88
    v_lshlrev_b32 v76, 16, v17
    v_and_b32 v84, s25, v17
    v_lshlrev_b32 v77, 16, v21
    v_and_b32 v85, s25, v21
    v_lshlrev_b32 v78, 16, v25
    v_and_b32 v86, s25, v25
    v_lshlrev_b32 v79, 16, v29
    v_and_b32 v87, s25, v29
    v_add_f32 v80, v76, v78
    v_add_f32 v88, v84, v86
    v_add_f32 v81, v77, v79
    v_add_f32 v89, v85, v87
    v_fma_f32 v82, v78, 4.0, v76
    v_fma_f32 v90, v86, 4.0, v84
    v_fma_f32 v83, v79, 4.0, v77
    v_fma_f32 v91, v87, 4.0, v85
    v_add_f32 v77, v80, v81
    v_add_f32 v85, v88, v89
    v_sub_f32 v78, v80, v81
    v_sub_f32 v86, v88, v89
    v_fma_f32 v79, v83, 2.0, v82
    v_fma_f32 v87, v91, 2.0, v90
    v_fma_f32 v82, v83, -2.0, v82
    v_fma_f32 v90, v91, -2.0, v90
    v_fmamk_f32 v80, v76, 0x41700000, v82
    v_fmamk_f32 v88, v84, 0x41700000, v90
    v_fmamk_f32 v80, v81, 0x41200000, v80
    v_fmamk_f32 v88, v89, 0x41200000, v88
    v_cvt_pk_bf16_f32 v21, v77, v85
    v_cvt_pk_bf16_f32 v25, v78, v86
    v_cvt_pk_bf16_f32 v65, v79, v87
    v_cvt_pk_bf16_f32 v69, v82, v90
    v_cvt_pk_bf16_f32 v73, v80, v88
    v_lshlrev_b32 v76, 16, v18
    v_and_b32 v84, s25, v18
    v_lshlrev_b32 v77, 16, v22
    v_and_b32 v85, s25, v22
    v_lshlrev_b32 v78, 16, v26
    v_and_b32 v86, s25, v26
    v_lshlrev_b32 v79, 16, v30
    v_and_b32 v87, s25, v30
    v_add_f32 v80, v76, v78
    v_add_f32 v88, v84, v86
    v_add_f32 v81, v77, v79
    v_add_f32 v89, v85, v87
    v_fma_f32 v82, v78, 4.0, v76
    v_fma_f32 v90, v86, 4.0, v84
    v_fma_f32 v83, v79, 4.0, v77
    v_fma_f32 v91, v87, 4.0, v85
    v_add_f32 v77, v80, v81
    v_add_f32 v85, v88, v89
    v_sub_f32 v78, v80, v81
    v_sub_f32 v86, v88, v89
    v_fma_f32 v79, v83, 2.0, v82
    v_fma_f32 v87, v91, 2.0, v90
    v_fma_f32 v82, v83, -2.0, v82
    v_fma_f32 v90, v91, -2.0, v90
    v_fmamk_f32 v80, v76, 0x41700000, v82
    v_fmamk_f32 v88, v84, 0x41700000, v90
    v_fmamk_f32 v80, v81, 0x41200000, v80
    v_fmamk_f32 v88, v89, 0x41200000, v88
    v_cvt_pk_bf16_f32 v22, v77, v85
    v_cvt_pk_bf16_f32 v26, v78, v86
    v_cvt_pk_bf16_f32 v66, v79, v87
    v_cvt_pk_bf16_f32 v70, v82, v90
    v_cvt_pk_bf16_f32 v74, v80, v88
    v_lshlrev_b32 v76, 16, v19
    v_and_b32 v84, s25, v19
    v_lshlrev_b32 v77, 16, v23
    v_and_b32 v85, s25, v23
    v_lshlrev_b32 v78, 16, v27
    v_and_b32 v86, s25, v27
    v_lshlrev_b32 v79, 16, v31
    v_and_b32 v87, s25, v31
    v_add_f32 v80, v76, v78
    v_add_f32 v88, v84, v86
    v_add_f32 v81, v77, v79
    v_add_f32 v89, v85, v87
    v_fma_f32 v82, v78, 4.0, v76
    v_fma_f32 v90, v86, 4.0, v84
    v_fma_f32 v83, v79, 4.0, v77
    v_fma_f32 v91, v87, 4.0, v85
    v_add_f32 v77, v80, v81
    v_add_f32 v85, v88, v89
    v_sub_f32 v78, v80, v81
    v_sub_f32 v86, v88, v89
    v_fma_f32 v79, v83, 2.0, v82
    v_fma_f32 v87, v91, 2.0, v90
    v_fma_f32 v82, v83, -2.0, v82
    v_fma_f32 v90, v91, -2.0, v90
    v_fmamk_f32 v80, v76, 0x41700000, v82
    v_fmamk_f32 v88, v84, 0x41700000, v90
    v_fmamk_f32 v80, v81, 0x41200000, v80
    v_fmamk_f32 v88, v89, 0x41200000, v88
    v_cvt_pk_bf16_f32 v23, v77, v85
    v_cvt_pk_bf16_f32 v27, v78, v86
    v_cvt_pk_bf16_f32 v67, v79, v87
    v_cvt_pk_bf16_f32 v71, v82, v90
    v_cvt_pk_bf16_f32 v75, v80, v88
L_conv2_kernel_hloop2:
    s_cmp_lt_u32 s28, 4
    s_cselect_b32 s24, 0, 2130706432
    ds_write_b128 v96, v[64:67] offset:57344
    ds_write_b128 v97, v[68:71] offset:8192
    ds_write_b128 v97, v[72:75] offset:24576
    ds_write_b128 v96, v[16:19] offset:8192
    ds_write_b128 v96, v[20:23] offset:24576
    ds_write_b128 v96, v[24:27] offset:40960
    ds_write_b128 v98, v[28:31] offset:8704
    s_waitcnt lgkmcnt(0)
    s_waitcnt vmcnt(0)
    v_lshlrev_b32 v76, 16, v32
    v_and_b32 v84, s25, v32
    v_lshlrev_b32 v77, 16, v36
    v_and_b32 v85, s25, v36
    v_lshlrev_b32 v78, 16, v40
    v_and_b32 v86, s25, v40
    v_lshlrev_b32 v79, 16, v44
    v_and_b32 v87, s25, v44
    v_add_f32 v80, v76, v78
    v_add_f32 v88, v84, v86
    v_add_f32 v81, v77, v79
    v_add_f32 v89, v85, v87
    v_fma_f32 v82, v78, 4.0, v76
    v_fma_f32 v90, v86, 4.0, v84
    v_fma_f32 v83, v79, 4.0, v77
    v_fma_f32 v91, v87, 4.0, v85
    v_add_f32 v77, v80, v81
    v_add_f32 v85, v88, v89
    v_sub_f32 v78, v80, v81
    v_sub_f32 v86, v88, v89
    v_fma_f32 v79, v83, 2.0, v82
    v_fma_f32 v87, v91, 2.0, v90
    v_fma_f32 v82, v83, -2.0, v82
    v_fma_f32 v90, v91, -2.0, v90
    v_fmamk_f32 v80, v76, 0x41700000, v82
    v_fmamk_f32 v88, v84, 0x41700000, v90
    v_fmamk_f32 v80, v81, 0x41200000, v80
    v_fmamk_f32 v88, v89, 0x41200000, v88
    v_cvt_pk_bf16_f32 v36, v77, v85
    v_cvt_pk_bf16_f32 v40, v78, v86
    v_cvt_pk_bf16_f32 v64, v79, v87
    v_cvt_pk_bf16_f32 v68, v82, v90
    v_cvt_pk_bf16_f32 v72, v80, v88
    v_lshlrev_b32 v76, 16, v33
    v_and_b32 v84, s25, v33
    v_lshlrev_b32 v77, 16, v37
    v_and_b32 v85, s25, v37
    v_lshlrev_b32 v78, 16, v41
    v_and_b32 v86, s25, v41
    buffer_load_dwordx4 v[0:3], v92, s[8:11], s24 offen offset:0
    buffer_load_dwordx4 v[16:19], v92, s[8:11], s24 offen offset:64
    v_add_u32 v92, 128, v92
    v_lshlrev_b32 v79, 16, v45
    v_and_b32 v87, s25, v45
    v_add_f32 v80, v76, v78
    v_add_f32 v88, v84, v86
    v_add_f32 v81, v77, v79
    v_add_f32 v89, v85, v87
    v_fma_f32 v82, v78, 4.0, v76
    v_fma_f32 v90, v86, 4.0, v84
    v_fma_f32 v83, v79, 4.0, v77
    v_fma_f32 v91, v87, 4.0, v85
    v_add_f32 v77, v80, v81
    v_add_f32 v85, v88, v89
    v_sub_f32 v78, v80, v81
    v_sub_f32 v86, v88, v89
    v_fma_f32 v79, v83, 2.0, v82
    v_fma_f32 v87, v91, 2.0, v90
    v_fma_f32 v82, v83, -2.0, v82
    v_fma_f32 v90, v91, -2.0, v90
    v_fmamk_f32 v80, v76, 0x41700000, v82
    v_fmamk_f32 v88, v84, 0x41700000, v90
    v_fmamk_f32 v80, v81, 0x41200000, v80
    v_fmamk_f32 v88, v89, 0x41200000, v88
    v_cvt_pk_bf16_f32 v37, v77, v85
    v_cvt_pk_bf16_f32 v41, v78, v86
    v_cvt_pk_bf16_f32 v65, v79, v87
    v_cvt_pk_bf16_f32 v69, v82, v90
    v_cvt_pk_bf16_f32 v73, v80, v88
    v_lshlrev_b32 v76, 16, v34
    v_and_b32 v84, s25, v34
    v_lshlrev_b32 v77, 16, v38
    v_and_b32 v85, s25, v38
    v_lshlrev_b32 v78, 16, v42
    v_and_b32 v86, s25, v42
    v_lshlrev_b32 v79, 16, v46
    v_and_b32 v87, s25, v46
    v_add_f32 v80, v76, v78
    v_add_f32 v88, v84, v86
    v_add_f32 v81, v77, v79
    v_add_f32 v89, v85, v87
    v_fma_f32 v82, v78, 4.0, v76
    v_fma_f32 v90, v86, 4.0, v84
    v_fma_f32 v83, v79, 4.0, v77
    v_fma_f32 v91, v87, 4.0, v85
    v_add_f32 v77, v80, v81
    v_add_f32 v85, v88, v89
    v_sub_f32 v78, v80, v81
    v_sub_f32 v86, v88, v89
    v_fma_f32 v79, v83, 2.0, v82
    v_fma_f32 v87, v91, 2.0, v90
    v_fma_f32 v82, v83, -2.0, v82
    v_fma_f32 v90, v91, -2.0, v90
    v_fmamk_f32 v80, v76, 0x41700000, v82
    v_fmamk_f32 v88, v84, 0x41700000, v90
    buffer_load_dwordx4 v[4:7], v93, s[8:11], s24 offen offset:0
    buffer_load_dwordx4 v[20:23], v93, s[8:11], s24 offen offset:64
    v_add_u32 v93, 128, v93
    v_fmamk_f32 v80, v81, 0x41200000, v80
    v_fmamk_f32 v88, v89, 0x41200000, v88
    v_cvt_pk_bf16_f32 v38, v77, v85
    v_cvt_pk_bf16_f32 v42, v78, v86
    v_cvt_pk_bf16_f32 v66, v79, v87
    v_cvt_pk_bf16_f32 v70, v82, v90
    v_cvt_pk_bf16_f32 v74, v80, v88
    v_lshlrev_b32 v76, 16, v35
    v_and_b32 v84, s25, v35
    v_lshlrev_b32 v77, 16, v39
    v_and_b32 v85, s25, v39
    v_lshlrev_b32 v78, 16, v43
    v_and_b32 v86, s25, v43
    v_lshlrev_b32 v79, 16, v47
    v_and_b32 v87, s25, v47
    v_add_f32 v80, v76, v78
    v_add_f32 v88, v84, v86
    v_add_f32 v81, v77, v79
    v_add_f32 v89, v85, v87
    v_fma_f32 v82, v78, 4.0, v76
    v_fma_f32 v90, v86, 4.0, v84
    v_fma_f32 v83, v79, 4.0, v77
    v_fma_f32 v91, v87, 4.0, v85
    v_add_f32 v77, v80, v81
    v_add_f32 v85, v88, v89
    v_sub_f32 v78, v80, v81
    v_sub_f32 v86, v88, v89
    v_fma_f32 v79, v83, 2.0, v82
    v_fma_f32 v87, v91, 2.0, v90
    v_fma_f32 v82, v83, -2.0, v82
    v_fma_f32 v90, v91, -2.0, v90
    v_fmamk_f32 v80, v76, 0x41700000, v82
    v_fmamk_f32 v88, v84, 0x41700000, v90
    v_fmamk_f32 v80, v81, 0x41200000, v80
    v_fmamk_f32 v88, v89, 0x41200000, v88
    v_cvt_pk_bf16_f32 v39, v77, v85
    v_cvt_pk_bf16_f32 v43, v78, v86
    v_cvt_pk_bf16_f32 v67, v79, v87
    v_cvt_pk_bf16_f32 v71, v82, v90
    v_cvt_pk_bf16_f32 v75, v80, v88
    s_add_u32 s28, s28, 1
    s_waitcnt lgkmcnt(0)
    s_barrier
    s_cmp_lt_u32 s28, 4
    s_cselect_b32 s24, 0, 2130706432
    ds_write_b128 v96, v[64:67] offset:49152
    ds_write_b128 v97, v[68:71] offset:0
    ds_write_b128 v97, v[72:75] offset:16384
    ds_write_b128 v96, v[32:35] offset:0
    ds_write_b128 v96, v[36:39] offset:16384
    ds_write_b128 v96, v[40:43] offset:32768
    ds_write_b128 v98, v[44:47] offset:0
    s_waitcnt lgkmcnt(0)
    v_lshlrev_b32 v76, 16, v48
    v_and_b32 v84, s25, v48
    buffer_load_dwordx4 v[8:11], v94, s[8:11], s24 offen offset:0
    buffer_load_dwordx4 v[24:27], v94, s[8:11], s24 offen offset:64
    v_add_u32 v94, 128, v94
    v_lshlrev_b32 v77, 16, v52
    v_and_b32 v85, s25, v52
    v_lshlrev_b32 v78, 16, v56
    v_and_b32 v86, s25, v56
    v_lshlrev_b32 v79, 16, v60
    v_and_b32 v87, s25, v60
    v_add_f32 v80, v76, v78
    v_add_f32 v88, v84, v86
    v_add_f32 v81, v77, v79
    v_add_f32 v89, v85, v87
    v_fma_f32 v82, v78, 4.0, v76
    v_fma_f32 v90, v86, 4.0, v84
    v_fma_f32 v83, v79, 4.0, v77
    v_fma_f32 v91, v87, 4.0, v85
    v_add_f32 v77, v80, v81
    v_add_f32 v85, v88, v89
    v_sub_f32 v78, v80, v81
    buffer_load_dwordx4 v[12:15], v95, s[8:11], s24 offen offset:0
    buffer_load_dwordx4 v[28:31], v95, s[8:11], s24 offen offset:64
    v_add_u32 v95, 128, v95
    v_sub_f32 v86, v88, v89
    v_fma_f32 v79, v83, 2.0, v82
    v_fma_f32 v87, v91, 2.0, v90
    v_fma_f32 v82, v83, -2.0, v82
    v_fma_f32 v90, v91, -2.0, v90
    v_fmamk_f32 v80, v76, 0x41700000, v82
    v_fmamk_f32 v88, v84, 0x41700000, v90
    v_fmamk_f32 v80, v81, 0x41200000, v80
    v_fmamk_f32 v88, v89, 0x41200000, v88
    v_cvt_pk_bf16_f32 v52, v77, v85
    v_cvt_pk_bf16_f32 v56, v78, v86
    v_cvt_pk_bf16_f32 v64, v79, v87
    v_cvt_pk_bf16_f32 v68, v82, v90
    v_cvt_pk_bf16_f32 v72, v80, v88
    v_lshlrev_b32 v76, 16, v49
    v_and_b32 v84, s25, v49
    v_lshlrev_b32 v77, 16, v53
    v_and_b32 v85, s25, v53
    v_lshlrev_b32 v78, 16, v57
    v_and_b32 v86, s25, v57
    v_lshlrev_b32 v79, 16, v61
    v_and_b32 v87, s25, v61
    v_add_f32 v80, v76, v78
    v_add_f32 v88, v84, v86
    v_add_f32 v81, v77, v79
    v_add_f32 v89, v85, v87
    v_fma_f32 v82, v78, 4.0, v76
    v_fma_f32 v90, v86, 4.0, v84
    v_fma_f32 v83, v79, 4.0, v77
    v_fma_f32 v91, v87, 4.0, v85
    v_add_f32 v77, v80, v81
    v_add_f32 v85, v88, v89
    v_sub_f32 v78, v80, v81
    v_sub_f32 v86, v88, v89
    v_fma_f32 v79, v83, 2.0, v82
    v_fma_f32 v87, v91, 2.0, v90
    v_fma_f32 v82, v83, -2.0, v82
    v_fma_f32 v90, v91, -2.0, v90
    v_fmamk_f32 v80, v76, 0x41700000, v82
    v_fmamk_f32 v88, v84, 0x41700000, v90
    v_fmamk_f32 v80, v81, 0x41200000, v80
    v_fmamk_f32 v88, v89, 0x41200000, v88
    v_cvt_pk_bf16_f32 v53, v77, v85
    v_cvt_pk_bf16_f32 v57, v78, v86
    v_cvt_pk_bf16_f32 v65, v79, v87
    v_cvt_pk_bf16_f32 v69, v82, v90
    v_cvt_pk_bf16_f32 v73, v80, v88
    v_lshlrev_b32 v76, 16, v50
    v_and_b32 v84, s25, v50
    v_lshlrev_b32 v77, 16, v54
    v_and_b32 v85, s25, v54
    v_lshlrev_b32 v78, 16, v58
    v_and_b32 v86, s25, v58
    v_lshlrev_b32 v79, 16, v62
    v_and_b32 v87, s25, v62
    v_add_f32 v80, v76, v78
    v_add_f32 v88, v84, v86
    v_add_f32 v81, v77, v79
    v_add_f32 v89, v85, v87
    v_fma_f32 v82, v78, 4.0, v76
    v_fma_f32 v90, v86, 4.0, v84
    v_fma_f32 v83, v79, 4.0, v77
    v_fma_f32 v91, v87, 4.0, v85
    v_add_f32 v77, v80, v81
    v_add_f32 v85, v88, v89
    v_sub_f32 v78, v80, v81
    v_sub_f32 v86, v88, v89
    v_fma_f32 v79, v83, 2.0, v82
    v_fma_f32 v87, v91, 2.0, v90
    v_fma_f32 v82, v83, -2.0, v82
    v_fma_f32 v90, v91, -2.0, v90
    v_fmamk_f32 v80, v76, 0x41700000, v82
    v_fmamk_f32 v88, v84, 0x41700000, v90
    v_fmamk_f32 v80, v81, 0x41200000, v80
    v_fmamk_f32 v88, v89, 0x41200000, v88
    v_cvt_pk_bf16_f32 v54, v77, v85
    v_cvt_pk_bf16_f32 v58, v78, v86
    v_cvt_pk_bf16_f32 v66, v79, v87
    v_cvt_pk_bf16_f32 v70, v82, v90
    v_cvt_pk_bf16_f32 v74, v80, v88
    v_lshlrev_b32 v76, 16, v51
    v_and_b32 v84, s25, v51
    v_lshlrev_b32 v77, 16, v55
    v_and_b32 v85, s25, v55
    v_lshlrev_b32 v78, 16, v59
    v_and_b32 v86, s25, v59
    v_lshlrev_b32 v79, 16, v63
    v_and_b32 v87, s25, v63
    v_add_f32 v80, v76, v78
    v_add_f32 v88, v84, v86
    v_add_f32 v81, v77, v79
    v_add_f32 v89, v85, v87
    v_fma_f32 v82, v78, 4.0, v76
    v_fma_f32 v90, v86, 4.0, v84
    v_fma_f32 v83, v79, 4.0, v77
    v_fma_f32 v91, v87, 4.0, v85
    v_add_f32 v77, v80, v81
    v_add_f32 v85, v88, v89
    v_sub_f32 v78, v80, v81
    v_sub_f32 v86, v88, v89
    v_fma_f32 v79, v83, 2.0, v82
    v_fma_f32 v87, v91, 2.0, v90
    v_fma_f32 v82, v83, -2.0, v82
    v_fma_f32 v90, v91, -2.0, v90
    v_fmamk_f32 v80, v76, 0x41700000, v82
    v_fmamk_f32 v88, v84, 0x41700000, v90
    v_fmamk_f32 v80, v81, 0x41200000, v80
    v_fmamk_f32 v88, v89, 0x41200000, v88
    v_cvt_pk_bf16_f32 v55, v77, v85
    v_cvt_pk_bf16_f32 v59, v78, v86
    v_cvt_pk_bf16_f32 v67, v79, v87
    v_cvt_pk_bf16_f32 v71, v82, v90
    v_cvt_pk_bf16_f32 v75, v80, v88
    s_add_u32 s28, s28, 1
    s_waitcnt lgkmcnt(0)
    s_barrier
    s_cmp_eq_u32 s22, 1
    s_cbranch_scc1 L_conv2_kernel_hlast2
    s_cmp_lt_u32 s28, 4
    s_cselect_b32 s24, 0, 2130706432
    ds_write_b128 v96, v[64:67] offset:57344
    ds_write_b128 v97, v[68:71] offset:8192
    ds_write_b128 v97, v[72:75] offset:24576
    ds_write_b128 v96, v[48:51] offset:8192
    ds_write_b128 v96, v[52:55] offset:24576
    ds_write_b128 v96, v[56:59] offset:40960
    ds_write_b128 v98, v[60:63] offset:8704
    s_waitcnt lgkmcnt(0)
    s_waitcnt vmcnt(0)
    v_lshlrev_b32 v76, 16, v0
    v_and_b32 v84, s25, v0
    v_lshlrev_b32 v77, 16, v4
    v_and_b32 v85, s25, v4
    v_lshlrev_b32 v78, 16, v8
    v_and_b32 v86, s25, v8
    v_lshlrev_b32 v79, 16, v12
    v_and_b32 v87, s25, v12
    v_add_f32 v80, v76, v78
    v_add_f32 v88, v84, v86
    v_add_f32 v81, v77, v79
    v_add_f32 v89, v85, v87
    v_fma_f32 v82, v78, 4.0, v76
    v_fma_f32 v90, v86, 4.0, v84
    v_fma_f32 v83, v79, 4.0, v77
    v_fma_f32 v91, v87, 4.0, v85
    v_add_f32 v77, v80, v81
    v_add_f32 v85, v88, v89
    v_sub_f32 v78, v80, v81
    v_sub_f32 v86, v88, v89
    v_fma_f32 v79, v83, 2.0, v82
    v_fma_f32 v87, v91, 2.0, v90
    v_fma_f32 v82, v83, -2.0, v82
    v_fma_f32 v90, v91, -2.0, v90
    v_fmamk_f32 v80, v76, 0x41700000, v82
    v_fmamk_f32 v88, v84, 0x41700000, v90
    v_fmamk_f32 v80, v81, 0x41200000, v80
    v_fmamk_f32 v88, v89, 0x41200000, v88
    v_cvt_pk_bf16_f32 v4, v77, v85
    v_cvt_pk_bf16_f32 v8, v78, v86
    v_cvt_pk_bf16_f32 v64, v79, v87
    v_cvt_pk_bf16_f32 v68, v82, v90
    v_cvt_pk_bf16_f32 v72, v80, v88
    v_lshlrev_b32 v76, 16, v1
    v_and_b32 v84, s25, v1
    v_lshlrev_b32 v77, 16, v5
    v_and_b32 v85, s25, v5
    v_lshlrev_b32 v78, 16, v9
    v_and_b32 v86, s25, v9
    buffer_load_dwordx4 v[32:35], v92, s[8:11], s24 offen offset:0
    buffer_load_dwordx4 v[48:51], v92, s[8:11], s24 offen offset:64
    v_add_u32 v92, 128, v92
    v_lshlrev_b32 v79, 16, v13
    v_and_b32 v87, s25, v13
    v_add_f32 v80, v76, v78
    v_add_f32 v88, v84, v86
    v_add_f32 v81, v77, v79
    v_add_f32 v89, v85, v87
    v_fma_f32 v82, v78, 4.0, v76
    v_fma_f32 v90, v86, 4.0, v84
    v_fma_f32 v83, v79, 4.0, v77
    v_fma_f32 v91, v87, 4.0, v85
    v_add_f32 v77, v80, v81
    v_add_f32 v85, v88, v89
    v_sub_f32 v78, v80, v81
    v_sub_f32 v86, v88, v89
    v_fma_f32 v79, v83, 2.0, v82
    v_fma_f32 v87, v91, 2.0, v90
    v_fma_f32 v82, v83, -2.0, v82
    v_fma_f32 v90, v91, -2.0, v90
    v_fmamk_f32 v80, v76, 0x41700000, v82
    v_fmamk_f32 v88, v84, 0x41700000, v90
    v_fmamk_f32 v80, v81, 0x41200000, v80
    v_fmamk_f32 v88, v89, 0x41200000, v88
    v_cvt_pk_bf16_f32 v5, v77, v85
    v_cvt_pk_bf16_f32 v9, v78, v86
    v_cvt_pk_bf16_f32 v65, v79, v87
    v_cvt_pk_bf16_f32 v69, v82, v90
    v_cvt_pk_bf16_f32 v73, v80, v88
    v_lshlrev_b32 v76, 16, v2
    v_and_b32 v84, s25, v2
    v_lshlrev_b32 v77, 16, v6
    v_and_b32 v85, s25, v6
    v_lshlrev_b32 v78, 16, v10
    v_and_b32 v86, s25, v10
    v_lshlrev_b32 v79, 16, v14
    v_and_b32 v87, s25, v14
    v_add_f32 v80, v76, v78
    v_add_f32 v88, v84, v86
    v_add_f32 v81, v77, v79
    v_add_f32 v89, v85, v87
    v_fma_f32 v82, v78, 4.0, v76
    v_fma_f32 v90, v86, 4.0, v84
    v_fma_f32 v83, v79, 4.0, v77
    v_fma_f32 v91, v87, 4.0, v85
    v_add_f32 v77, v80, v81
    v_add_f32 v85, v88, v89
    v_sub_f32 v78, v80, v81
    v_sub_f32 v86, v88, v89
    v_fma_f32 v79, v83, 2.0, v82
    v_fma_f32 v87, v91, 2.0, v90
    v_fma_f32 v82, v83, -2.0, v82
    v_fma_f32 v90, v91, -2.0, v90
    v_fmamk_f32 v80, v76, 0x41700000, v82
    v_fmamk_f32 v88, v84, 0x41700000, v90
    buffer_load_dwordx4 v[36:39], v93, s[8:11], s24 offen offset:0
    buffer_load_dwordx4 v[52:55], v93, s[8:11], s24 offen offset:64
    v_add_u32 v93, 128, v93
    v_fmamk_f32 v80, v81, 0x41200000, v80
    v_fmamk_f32 v88, v89, 0x41200000, v88
    v_cvt_pk_bf16_f32 v6, v77, v85
    v_cvt_pk_bf16_f32 v10, v78, v86
    v_cvt_pk_bf16_f32 v66, v79, v87
    v_cvt_pk_bf16_f32 v70, v82, v90
    v_cvt_pk_bf16_f32 v74, v80, v88
    v_lshlrev_b32 v76, 16, v3
    v_and_b32 v84, s25, v3
    v_lshlrev_b32 v77, 16, v7
    v_and_b32 v85, s25, v7
    v_lshlrev_b32 v78, 16, v11
    v_and_b32 v86, s25, v11
    v_lshlrev_b32 v79, 16, v15
    v_and_b32 v87, s25, v15
    v_add_f32 v80, v76, v78
    v_add_f32 v88, v84, v86
    v_add_f32 v81, v77, v79
    v_add_f32 v89, v85, v87
    v_fma_f32 v82, v78, 4.0, v76
    v_fma_f32 v90, v86, 4.0, v84
    v_fma_f32 v83, v79, 4.0, v77
    v_fma_f32 v91, v87, 4.0, v85
    v_add_f32 v77, v80, v81
    v_add_f32 v85, v88, v89
    v_sub_f32 v78, v80, v81
    v_sub_f32 v86, v88, v89
    v_fma_f32 v79, v83, 2.0, v82
    v_fma_f32 v87, v91, 2.0, v90
    v_fma_f32 v82, v83, -2.0, v82
    v_fma_f32 v90, v91, -2.0, v90
    v_fmamk_f32 v80, v76, 0x41700000, v82
    v_fmamk_f32 v88, v84, 0x41700000, v90
    v_fmamk_f32 v80, v81, 0x41200000, v80
    v_fmamk_f32 v88, v89, 0x41200000, v88
    v_cvt_pk_bf16_f32 v7, v77, v85
    v_cvt_pk_bf16_f32 v11, v78, v86
    v_cvt_pk_bf16_f32 v67, v79, v87
    v_cvt_pk_bf16_f32 v71, v82, v90
    v_cvt_pk_bf16_f32 v75, v80, v88
    s_add_u32 s28, s28, 1
    s_waitcnt lgkmcnt(0)
    s_barrier
    s_cmp_lt_u32 s28, 4
    s_cselect_b32 s24, 0, 2130706432
    ds_write_b128 v96, v[64:67] offset:49152
    ds_write_b128 v97, v[68:71] offset:0
    ds_write_b128 v97, v[72:75] offset:16384
    ds_write_b128 v96, v[0:3] offset:0
    ds_write_b128 v96, v[4:7] offset:16384
    ds_write_b128 v96, v[8:11] offset:32768
    ds_write_b128 v98, v[12:15] offset:0
    s_waitcnt lgkmcnt(0)
    v_lshlrev_b32 v76, 16, v16
    v_and_b32 v84, s25, v16
    buffer_load_dwordx4 v[40:43], v94, s[8:11], s24 offen offset:0
    buffer_load_dwordx4 v[56:59], v94, s[8:11], s24 offen offset:64
    v_add_u32 v94, 128, v94
    v_lshlrev_b32 v77, 16, v20
    v_and_b32 v85, s25, v20
    v_lshlrev_b32 v78, 16, v24
    v_and_b32 v86, s25, v24
    v_lshlrev_b32 v79, 16, v28
    v_and_b32 v87, s25, v28
    v_add_f32 v80, v76, v78
    v_add_f32 v88, v84, v86
    v_add_f32 v81, v77, v79
    v_add_f32 v89, v85, v87
    v_fma_f32 v82, v78, 4.0, v76
    v_fma_f32 v90, v86, 4.0, v84
    v_fma_f32 v83, v79, 4.0, v77
    v_fma_f32 v91, v87, 4.0, v85
    v_add_f32 v77, v80, v81
    v_add_f32 v85, v88, v89
    v_sub_f32 v78, v80, v81
    buffer_load_dwordx4 v[44:47], v95, s[8:11], s24 offen offset:0
    buffer_load_dwordx4 v[60:63], v95, s[8:11], s24 offen offset:64
    v_add_u32 v95, 128, v95
    v_sub_f32 v86, v88, v89
    v_fma_f32 v79, v83, 2.0, v82
    v_fma_f32 v87, v91, 2.0, v90
    v_fma_f32 v82, v83, -2.0, v82
    v_fma_f32 v90, v91, -2.0, v90
    v_fmamk_f32 v80, v76, 0x41700000, v82
    v_fmamk_f32 v88, v84, 0x41700000, v90
    v_fmamk_f32 v80, v81, 0x41200000, v80
    v_fmamk_f32 v88, v89, 0x41200000, v88
    v_cvt_pk_bf16_f32 v20, v77, v85
    v_cvt_pk_bf16_f32 v24, v78, v86
    v_cvt_pk_bf16_f32 v64, v79, v87
    v_cvt_pk_bf16_f32 v68, v82, v90
    v_cvt_pk_bf16_f32 v72, v80, v88
    v_lshlrev_b32 v76, 16, v17
    v_and_b32 v84, s25, v17
    v_lshlrev_b32 v77, 16, v21
    v_and_b32 v85, s25, v21
    v_lshlrev_b32 v78, 16, v25
    v_and_b32 v86, s25, v25
    v_lshlrev_b32 v79, 16, v29
    v_and_b32 v87, s25, v29
    v_add_f32 v80, v76, v78
    v_add_f32 v88, v84, v86
    v_add_f32 v81, v77, v79
    v_add_f32 v89, v85, v87
    v_fma_f32 v82, v78, 4.0, v76
    v_fma_f32 v90, v86, 4.0, v84
    v_fma_f32 v83, v79, 4.0, v77
    v_fma_f32 v91, v87, 4.0, v85
    v_add_f32 v77, v80, v81
    v_add_f32 v85, v88, v89
    v_sub_f32 v78, v80, v81
    v_sub_f32 v86, v88, v89
    v_fma_f32 v79, v83, 2.0, v82
    v_fma_f32 v87, v91, 2.0, v90
    v_fma_f32 v82, v83, -2.0, v82
    v_fma_f32 v90, v91, -2.0, v90
    v_fmamk_f32 v80, v76, 0x41700000, v82
    v_fmamk_f32 v88, v84, 0x41700000, v90
    v_fmamk_f32 v80, v81, 0x41200000, v80
    v_fmamk_f32 v88, v89, 0x41200000, v88
    v_cvt_pk_bf16_f32 v21, v77, v85
    v_cvt_pk_bf16_f32 v25, v78, v86
    v_cvt_pk_bf16_f32 v65, v79, v87
    v_cvt_pk_bf16_f32 v69, v82, v90
    v_cvt_pk_bf16_f32 v73, v80, v88
    v_lshlrev_b32 v76, 16, v18
    v_and_b32 v84, s25, v18
    v_lshlrev_b32 v77, 16, v22
    v_and_b32 v85, s25, v22
    v_lshlrev_b32 v78, 16, v26
    v_and_b32 v86, s25, v26
    v_lshlrev_b32 v79, 16, v30
    v_and_b32 v87, s25, v30
    v_add_f32 v80, v76, v78
    v_add_f32 v88, v84, v86
    v_add_f32 v81, v77, v79
    v_add_f32 v89, v85, v87
    v_fma_f32 v82, v78, 4.0, v76
    v_fma_f32 v90, v86, 4.0, v84
    v_fma_f32 v83, v79, 4.0, v77
    v_fma_f32 v91, v87, 4.0, v85
    v_add_f32 v77, v80, v81
    v_add_f32 v85, v88, v89
    v_sub_f32 v78, v80, v81
    v_sub_f32 v86, v88, v89
    v_fma_f32 v79, v83, 2.0, v82
    v_fma_f32 v87, v91, 2.0, v90
    v_fma_f32 v82, v83, -2.0, v82
    v_fma_f32 v90, v91, -2.0, v90
    v_fmamk_f32 v80, v76, 0x41700000, v82
    v_fmamk_f32 v88, v84, 0x41700000, v90
    v_fmamk_f32 v80, v81, 0x41200000, v80
    v_fmamk_f32 v88, v89, 0x41200000, v88
    v_cvt_pk_bf16_f32 v22, v77, v85
    v_cvt_pk_bf16_f32 v26, v78, v86
    v_cvt_pk_bf16_f32 v66, v79, v87
    v_cvt_pk_bf16_f32 v70, v82, v90
    v_cvt_pk_bf16_f32 v74, v80, v88
    v_lshlrev_b32 v76, 16, v19
    v_and_b32 v84, s25, v19
    v_lshlrev_b32 v77, 16, v23
    v_and_b32 v85, s25, v23
    v_lshlrev_b32 v78, 16, v27
    v_and_b32 v86, s25, v27
    v_lshlrev_b32 v79, 16, v31
    v_and_b32 v87, s25, v31
    v_add_f32 v80, v76, v78
    v_add_f32 v88, v84, v86
    v_add_f32 v81, v77, v79
    v_add_f32 v89, v85, v87
    v_fma_f32 v82, v78, 4.0, v76
    v_fma_f32 v90, v86, 4.0, v84
    v_fma_f32 v83, v79, 4.0, v77
    v_fma_f32 v91, v87, 4.0, v85
    v_add_f32 v77, v80, v81
    v_add_f32 v85, v88, v89
    v_sub_f32 v78, v80, v81
    v_sub_f32 v86, v88, v89
    v_fma_f32 v79, v83, 2.0, v82
    v_fma_f32 v87, v91, 2.0, v90
    v_fma_f32 v82, v83, -2.0, v82
    v_fma_f32 v90, v91, -2.0, v90
    v_fmamk_f32 v80, v76, 0x41700000, v82
    v_fmamk_f32 v88, v84, 0x41700000, v90
    v_fmamk_f32 v80, v81, 0x41200000, v80
    v_fmamk_f32 v88, v89, 0x41200000, v88
    v_cvt_pk_bf16_f32 v23, v77, v85
    v_cvt_pk_bf16_f32 v27, v78, v86
    v_cvt_pk_bf16_f32 v67, v79, v87
    v_cvt_pk_bf16_f32 v71, v82, v90
    v_cvt_pk_bf16_f32 v75, v80, v88
    s_add_u32 s28, s28, 1
    s_waitcnt lgkmcnt(0)
    s_barrier
    s_sub_u32 s22, s22, 1
    s_branch L_conv2_kernel_hloop2
L_conv2_kernel_hlast2:
    ds_write_b128 v96, v[64:67] offset:57344
    ds_write_b128 v97, v[68:71] offset:8192
    ds_write_b128 v97, v[72:75] offset:24576
    ds_write_b128 v96, v[48:51] offset:8192
    ds_write_b128 v96, v[52:55] offset:24576
    ds_write_b128 v96, v[56:59] offset:40960
    ds_write_b128 v98, v[60:63] offset:8704
    s_waitcnt lgkmcnt(0)
    s_barrier
    s_branch L_conv2_kernel_end
L_conv2_kernel_epi:
    v_and_b32 v108, 15, v127
    v_lshrrev_b32 v109, 4, v127
    v_lshrrev_b32 v110, 3, v108
    s_lshl_b32 s36, s20, 1
    v_add_u32 v110, s36, v110
    v_xor_b32 v111, v110, v108
    v_and_b32 v111, 7, v111
    v_lshlrev_b32 v111, 4, v111
    v_lshl_add_u32 v111, v110, 7, v111
    v_lshl_add_u32 v120, v109, 11, v111
    v_add_u32 v121, 65536, v120
    v_add_u32 v125, 131072, v120
    s_lshl_b32 s36, s20, 9
    s_add_u32 s36, s36, 115712
    v_lshl_add_u32 v123, v109, 7, s36
    s_lshl_b32 s36, s20, 4
    v_add_u32 v108, s36, v108
    v_lshl_add_u32 v110, v108, 2, s21
    v_lshlrev_b32 v110, 9, v110
    v_lshl_add_u32 v110, v109, 4, v110
    s_lshl_b32 s36, s29, 6
    v_add_u32 v110, s36, v110
    v_mov_b32 v111, 2130706432
    v_cmp_gt_u32 vcc, 125, v108
    s_mov_b32 s4, 0xbeaaaaab
    s_mov_b32 s5, s4
    s_mov_b32 s6, 0x3e800000
    s_mov_b32 s7, s6
    s_mov_b32 s8, 0xc0a00000
    s_mov_b32 s9, s8
    s_mov_b32 s10, 0xc0638e39
    s_mov_b32 s11, s10
    s_mov_b32 s12, 0xbf638e39
    s_mov_b32 s13, s12
    s_mov_b32 s14, 0xbe638e39
    s_mov_b32 s15, s14
    s_mov_b32 s22, 0xbd638e39
    s_mov_b32 s23, s22
    s_mov_b32 s24, 0x3ff1c71c
    s_mov_b32 s25, s24
    s_mov_b32 s26, 0xbf2aaaab
    s_mov_b32 s27, s26
    s_mov_b32 s32, 0x3ecccccd
    s_mov_b32 s33, s32
    s_mov_b32 s34, 0xbd888889
    s_mov_b32 s35, s34
    s_mov_b32 s38, 0xbe4ccccd
    s_mov_b32 s39, s38
    s_mov_b32 s40, 0xbdd2d3e8
    s_mov_b32 s41, s40
    s_mov_b32 s42, 0x3f800000
    s_mov_b32 s43, s42
    s_waitcnt lgkmcnt(0)
    s_barrier
    v_cndmask_b32 v122, v111, v110, vcc
    ds_read_b128 v[0:3], v120 offset:0
    ds_read_b128 v[4:7], v120 offset:16384
    ds_read_b128 v[8:11], v120 offset:32768
    ds_read_b128 v[12:15], v120 offset:49152
    ds_read_b128 v[16:19], v121 offset:0
    ds_read_b128 v[20:23], v121 offset:16384
    ds_read_b128 v[24:27], v121 offset:32768
    ds_read_b128 v[28:31], v125 offset:15360
    ds_read_b128 v[32:35], v120 offset:8192
    ds_read_b128 v[36:39], v120 offset:24576
    ds_read_b128 v[40:43], v120 offset:40960
    ds_read_b128 v[44:47], v120 offset:57344
    ds_read_b128 v[48:51], v121 offset:56320
    ds_read_b128 v[52:55], v121 offset:64512
    ds_read_b128 v[56:59], v125 offset:7168
    s_waitcnt lgkmcnt(7)
    ds_read_b128 v[60:63], v125 offset:23552
    s_waitcnt lgkmcnt(8)
    v_pk_add_f32 v[88:89], v[24:25], v[28:29]
    v_pk_add_f32 v[90:91], v[26:27], v[30:31]
    v_pk_add_f32 v[24:25], v[4:5], v[8:9]
    v_pk_add_f32 v[26:27], v[6:7], v[10:11]
    v_pk_add_f32 v[4:5], v[4:5], v[8:9] neg_lo:[0,1] neg_hi:[0,1]
    v_pk_add_f32 v[6:7], v[6:7], v[10:11] neg_lo:[0,1] neg_hi:[0,1]
    v_pk_add_f32 v[72:73], v[12:13], v[16:17]
    v_pk_add_f32 v[74:75], v[14:15], v[18:19]
    v_pk_add_f32 v[12:13], v[12:13], v[16:17] neg_lo:[0,1] neg_hi:[0,1]
    v_pk_add_f32 v[14:15], v[14:15], v[18:19] neg_lo:[0,1] neg_hi:[0,1]
    v_pk_fma_f32 v[72:73], v[24:25], s[4:5], v[72:73]
    v_pk_fma_f32 v[74:75], v[26:27], s[4:5], v[74:75]
    v_pk_fma_f32 v[20:21], v[0:1], s[10:11], v[20:21]
    v_pk_fma_f32 v[22:23], v[2:3], s[10:11], v[22:23]
    v_pk_fma_f32 v[72:73], v[0:1], s[6:7], v[72:73]
    v_pk_fma_f32 v[74:75], v[2:3], s[6:7], v[74:75]
    v_pk_add_f32 v[24:25], v[24:25], v[0:1] neg_lo:[0,1] neg_hi:[0,1]
    v_pk_add_f32 v[26:27], v[26:27], v[2:3] neg_lo:[0,1] neg_hi:[0,1]
    v_pk_fma_f32 v[72:73], v[88:89], s[8:9], v[72:73]
    v_pk_fma_f32 v[74:75], v[90:91], s[8:9], v[74:75]
    v_pk_add_f32 v[24:25], v[24:25], v[88:89] neg_lo:[0,1] neg_hi:[0,1]
    v_pk_add_f32 v[26:27], v[26:27], v[90:91] neg_lo:[0,1] neg_hi:[0,1]
    v_pk_fma_f32 v[20:21], v[88:89], s[22:23], v[20:21]
    v_pk_fma_f32 v[22:23], v[90:91], s[22:23], v[22:23]
    v_pk_add_f32 v[8:9], v[24:25], v[72:73] neg_lo:[0,1] neg_hi:[0,1]
    v_pk_add_f32 v[10:11], v[26:27], v[74:75] neg_lo:[0,1] neg_hi:[0,1]
    v_pk_fma_f32 v[20:21], v[72:73], s[14:15], v[20:21]
    v_pk_fma_f32 v[22:23], v[74:75], s[14:15], v[22:23]
    v_pk_mul_f32 v[80:81], v[12:13], s[32:33]
    v_pk_mul_f32 v[82:83], v[14:15], s[32:33]
    v_pk_fma_f32 v[20:21], v[8:9], s[12:13], v[20:21]
    v_pk_fma_f32 v[22:23], v[10:11], s[12:13], v[22:23]
    v_pk_fma_f32 v[80:81], v[4:5], s[34:35], v[80:81]
    v_pk_fma_f32 v[82:83], v[6:7], s[34:35], v[82:83]
    v_pk_fma_f32 v[64:65], v[4:5], s[24:25], v[20:21] neg_lo:[0,0,1] neg_hi:[0,0,1]
    v_pk_fma_f32 v[66:67], v[6:7], s[24:25], v[22:23] neg_lo:[0,0,1] neg_hi:[0,0,1]
    v_pk_fma_f32 v[64:65], v[12:13], s[26:27], v[64:65]
    v_pk_fma_f32 v[66:67], v[14:15], s[26:27], v[66:67]
    v_pk_fma_f32 v[80:81], v[64:65], s[38:39], v[80:81]
    v_pk_fma_f32 v[82:83], v[66:67], s[38:39], v[82:83]
    v_pk_add_f32 v[4:5], v[4:5], v[64:65] neg_lo:[0,1] neg_hi:[0,1]
    v_pk_add_f32 v[6:7], v[6:7], v[66:67] neg_lo:[0,1] neg_hi:[0,1]
    v_pk_add_f32 v[4:5], v[4:5], v[80:81] neg_lo:[0,1] neg_hi:[0,1]
    v_pk_add_f32 v[6:7], v[6:7], v[82:83] neg_lo:[0,1] neg_hi:[0,1]
    s_waitcnt lgkmcnt(0)
    v_pk_add_f32 v[92:93], v[56:57], v[60:61]
    v_pk_add_f32 v[94:95], v[58:59], v[62:63]
    v_pk_add_f32 v[56:57], v[36:37], v[40:41]
    v_pk_add_f32 v[58:59], v[38:39], v[42:43]
    v_pk_add_f32 v[36:37], v[36:37], v[40:41] neg_lo:[0,1] neg_hi:[0,1]
    v_pk_add_f32 v[38:39], v[38:39], v[42:43] neg_lo:[0,1] neg_hi:[0,1]
    v_pk_add_f32 v[76:77], v[44:45], v[48:49]
    v_pk_add_f32 v[78:79], v[46:47], v[50:51]
    v_pk_add_f32 v[44:45], v[44:45], v[48:49] neg_lo:[0,1] neg_hi:[0,1]
    v_pk_add_f32 v[46:47], v[46:47], v[50:51] neg_lo:[0,1] neg_hi:[0,1]
    v_pk_fma_f32 v[76:77], v[56:57], s[4:5], v[76:77]
    v_pk_fma_f32 v[78:79], v[58:59], s[4:5], v[78:79]
    v_pk_fma_f32 v[52:53], v[32:33], s[10:11], v[52:53]
    v_pk_fma_f32 v[54:55], v[34:35], s[10:11], v[54:55]
    v_pk_fma_f32 v[76:77], v[32:33], s[6:7], v[76:77]
    v_pk_fma_f32 v[78:79], v[34:35], s[6:7], v[78:79]
    v_pk_add_f32 v[56:57], v[56:57], v[32:33] neg_lo:[0,1] neg_hi:[0,1]
    v_pk_add_f32 v[58:59], v[58:59], v[34:35] neg_lo:[0,1] neg_hi:[0,1]
    v_pk_fma_f32 v[76:77], v[92:93], s[8:9], v[76:77]
    v_pk_fma_f32 v[78:79], v[94:95], s[8:9], v[78:79]
    v_pk_add_f32 v[56:57], v[56:57], v[92:93] neg_lo:[0,1] neg_hi:[0,1]
    v_pk_add_f32 v[58:59], v[58:59], v[94:95] neg_lo:[0,1] neg_hi:[0,1]
    v_pk_fma_f32 v[52:53], v[92:93], s[22:23], v[52:53]
    v_pk_fma_f32 v[54:55], v[94:95], s[22:23], v[54:55]
    v_pk_add_f32 v[40:41], v[56:57], v[76:77] neg_lo:[0,1] neg_hi:[0,1]
    v_pk_add_f32 v[42:43], v[58:59], v[78:79] neg_lo:[0,1] neg_hi:[0,1]
    v_pk_fma_f32 v[52:53], v[76:77], s[14:15], v[52:53]
    v_pk_fma_f32 v[54:55], v[78:79], s[14:15], v[54:55]
    v_pk_mul_f32 v[84:85], v[44:45], s[32:33]
    v_pk_mul_f32 v[86:87], v[46:47], s[32:33]
    v_pk_fma_f32 v[52:53], v[40:41], s[12:13], v[52:53]
    v_pk_fma_f32 v[54:55], v[42:43], s[12:13], v[54:55]
    v_pk_fma_f32 v[84:85], v[36:37], s[34:35], v[84:85]
    v_pk_fma_f32 v[86:87], v[38:39], s[34:35], v[86:87]
    v_pk_fma_f32 v[68:69], v[36:37], s[24:25], v[52:53] neg_lo:[0,0,1] neg_hi:[0,0,1]
    v_pk_fma_f32 v[70:71], v[38:39], s[24:25], v[54:55] neg_lo:[0,0,1] neg_hi:[0,0,1]
    v_pk_fma_f32 v[68:69], v[44:45], s[26:27], v[68:69]
    v_pk_fma_f32 v[70:71], v[46:47], s[26:27], v[70:71]
    v_pk_fma_f32 v[84:85], v[68:69], s[38:39], v[84:85]
    v_pk_fma_f32 v[86:87], v[70:71], s[38:39], v[86:87]
    v_pk_add_f32 v[36:37], v[36:37], v[68:69] neg_lo:[0,1] neg_hi:[0,1]
    v_pk_add_f32 v[38:39], v[38:39], v[70:71] neg_lo:[0,1] neg_hi:[0,1]
    v_pk_add_f32 v[36:37], v[36:37], v[84:85] neg_lo:[0,1] neg_hi:[0,1]
    v_pk_add_f32 v[38:39], v[38:39], v[86:87] neg_lo:[0,1] neg_hi:[0,1]
    s_mov_b32 s36, 0x00010001
    s_mov_b32 s37, 0x00010001
    s_mov_b64 exec, s[36:37]
    ds_write_b128 v123, v[0:3] offset:0
    ds_write_b128 v123, v[32:35] offset:16
    ds_write_b128 v123, v[4:7] offset:32
    ds_write_b128 v123, v[36:39] offset:48
    ds_write_b128 v123, v[8:11] offset:64
    ds_write_b128 v123, v[40:43] offset:80
    s_mov_b64 exec, -1
    v_mov_b32 v44, 0xc0135761
    v_mov_b32 v45, v44
    v_cvt_pk_bf16_f32 v48, v64, v68
    v_cvt_pk_bf16_f32 v49, v65, v69
    v_cvt_pk_bf16_f32 v50, v66, v70
    v_cvt_pk_bf16_f32 v51, v67, v71
    buffer_store_dwordx4 v[48:51], v122, s[16:19], 0 offen offset:0 sc1
    s_waitcnt lgkmcnt(0)
    s_barrier
    ds_read_b128 v[96:99], v123 offset:512
    ds_read_b128 v[100:103], v123 offset:528
    ds_read_b128 v[104:107], v123 offset:544
    ds_read_b128 v[108:111], v123 offset:560
    ds_read_b128 v[112:115], v123 offset:576
    ds_read_b128 v[116:119], v123 offset:592
    s_waitcnt lgkmcnt(4)
    v_mov_b32_dpp v96, v0 row_shl:1 row_mask:0xf bank_mask:0xf
    v_mov_b32_dpp v97, v1 row_shl:1 row_mask:0xf bank_mask:0xf
    v_mov_b32_dpp v98, v2 row_shl:1 row_mask:0xf bank_mask:0xf
    v_mov_b32_dpp v99, v3 row_shl:1 row_mask:0xf bank_mask:0xf
    v_mov_b32_dpp v100, v32 row_shl:1 row_mask:0xf bank_mask:0xf
    v_mov_b32_dpp v101, v33 row_shl:1 row_mask:0xf bank_mask:0xf
    v_mov_b32_dpp v102, v34 row_shl:1 row_mask:0xf bank_mask:0xf
    v_mov_b32_dpp v103, v35 row_shl:1 row_mask:0xf bank_mask:0xf
    v_pk_add_f32 v[72:73], v[72:73], v[96:97]
    v_pk_add_f32 v[74:75], v[74:75], v[98:99]
    v_pk_add_f32 v[76:77], v[76:77], v[100:101]
    v_pk_add_f32 v[78:79], v[78:79], v[102:103]
    v_cvt_pk_bf16_f32 v52, v72, v76
    v_cvt_pk_bf16_f32 v53, v73, v77
    v_cvt_pk_bf16_f32 v54, v74, v78
    v_cvt_pk_bf16_f32 v55, v75, v79
    buffer_store_dwordx4 v[52:55], v122, s[16:19], 0 offen offset:512 sc1
    s_waitcnt lgkmcnt(2)
    v_mov_b32_dpp v104, v4 row_shl:1 row_mask:0xf bank_mask:0xf
    v_mov_b32_dpp v105, v5 row_shl:1 row_mask:0xf bank_mask:0xf
    v_mov_b32_dpp v106, v6 row_shl:1 row_mask:0xf bank_mask:0xf
    v_mov_b32_dpp v107, v7 row_shl:1 row_mask:0xf bank_mask:0xf
    v_mov_b32_dpp v108, v36 row_shl:1 row_mask:0xf bank_mask:0xf
    v_mov_b32_dpp v109, v37 row_shl:1 row_mask:0xf bank_mask:0xf
    v_mov_b32_dpp v110, v38 row_shl:1 row_mask:0xf bank_mask:0xf
    v_mov_b32_dpp v111, v39 row_shl:1 row_mask:0xf bank_mask:0xf
    v_pk_add_f32 v[80:81], v[80:81], v[104:105]
    v_pk_add_f32 v[82:83], v[82:83], v[106:107]
    v_pk_add_f32 v[84:85], v[84:85], v[108:109]
    v_pk_add_f32 v[86:87], v[86:87], v[110:111]
    v_cvt_pk_bf16_f32 v56, v80, v84
    v_cvt_pk_bf16_f32 v57, v81, v85
    v_cvt_pk_bf16_f32 v58, v82, v86
    v_cvt_pk_bf16_f32 v59, v83, v87
    buffer_store_dwordx4 v[56:59], v122, s[16:19], 0 offen offset:1024 sc1
    s_waitcnt lgkmcnt(0)
    v_mov_b32_dpp v112, v8 row_shl:1 row_mask:0xf bank_mask:0xf
    v_mov_b32_dpp v113, v9 row_shl:1 row_mask:0xf bank_mask:0xf
    v_mov_b32_dpp v114, v10 row_shl:1 row_mask:0xf bank_mask:0xf
    v_mov_b32_dpp v115, v11 row_shl:1 row_mask:0xf bank_mask:0xf
    v_mov_b32_dpp v116, v40 row_shl:1 row_mask:0xf bank_mask:0xf
    v_mov_b32_dpp v117, v41 row_shl:1 row_mask:0xf bank_mask:0xf
    v_mov_b32_dpp v118, v42 row_shl:1 row_mask:0xf bank_mask:0xf
    v_mov_b32_dpp v119, v43 row_shl:1 row_mask:0xf bank_mask:0xf
    v_pk_add_f32 v[88:89], v[88:89], v[112:113]
    v_pk_add_f32 v[90:91], v[90:91], v[114:115]
    v_pk_add_f32 v[92:93], v[92:93], v[116:117]
    v_pk_add_f32 v[94:95], v[94:95], v[118:119]
    v_cvt_pk_bf16_f32 v60, v88, v92
    v_cvt_pk_bf16_f32 v61, v89, v93
    v_cvt_pk_bf16_f32 v62, v90, v94
    v_cvt_pk_bf16_f32 v63, v91, v95
    buffer_store_dwordx4 v[60:63], v122, s[16:19], 0 offen offset:1536 sc1
L_conv2_kernel_end:
L_conv2_kernel_done:
    s_endpgm
.globl joint_kernel
.p2align 8
.type joint_kernel,@function
joint_kernel:
    s_cmp_ge_u32 s2, 250
    s_cbranch_scc1 L_joint_kernel_done
    s_load_dwordx2 s[28:29], s[0:1], 56
    s_load_dwordx2 s[30:31], s[0:1], 72
    v_readfirstlane_b32 s20, v0
    s_lshr_b32 s20, s20, 6
    s_and_b32 s21, s20, 3
    v_and_b32 v255, 63, v0
    v_lshlrev_b32 v254, 4, v255
    s_cmp_ge_u32 s20, 4
    s_mov_b32 s33, 44171264
    s_cselect_b32 s33, 44040192, s33
    s_lshl_b32 s36, s21, 15
    s_add_u32 s33, s33, s36
    s_mov_b32 s14, 32768
    s_mov_b32 s15, 0x00020000
    s_lshl_b32 s35, s2, 14
    s_add_u32 s35, s35, 27262976
    s_mov_b32 s10, 8404992
    s_mov_b32 s11, 0x00020000
    s_waitcnt lgkmcnt(0)
    s_add_u32 s12, s30, s33
    s_addc_u32 s13, s31, 0
    s_cmp_ge_u32 s20, 4
    s_cbranch_scc1 L_joint_kernel_T
    s_add_u32 s8, s30, s35
    s_addc_u32 s9, s31, 0
    s_lshl_b32 s36, s20, 12
    s_add_u32 s37, s36, 8388608
    buffer_load_dwordx4 v[128:131], v254, s[8:11], s36 offen offset:0
    buffer_load_dwordx4 v[144:147], v254, s[8:11], s37 offen offset:0
    buffer_load_dwordx4 v[132:135], v254, s[8:11], s36 offen offset:1024
    buffer_load_dwordx4 v[148:151], v254, s[8:11], s37 offen offset:1024
    buffer_load_dwordx4 v[136:139], v254, s[8:11], s36 offen offset:2048
    buffer_load_dwordx4 v[152:155], v254, s[8:11], s37 offen offset:2048
    buffer_load_dwordx4 v[140:143], v254, s[8:11], s36 offen offset:3072
    buffer_load_dwordx4 v[156:159], v254, s[8:11], s37 offen offset:3072
    s_cmp_ge_u32 s2, 125
    s_cselect_b32 s34, 8192, 0
    s_add_u32 s34, s34, 44302336
    s_add_u32 s40, s30, s34
    s_addc_u32 s41, s31, 0
    s_mov_b32 s42, 24576
    s_mov_b32 s43, 0x00020000
    s_lshl_b32 s38, s20, 11
    s_add_u32 s39, s38, 16384
    buffer_load_dwordx4 v[192:195], v254, s[40:43], s38 offen offset:0
    buffer_load_dwordx4 v[196:199], v254, s[40:43], s38 offen offset:1024
    buffer_load_dwordx4 v[200:203], v254, s[40:43], s39 offen offset:0
    buffer_load_dwordx4 v[204:207], v254, s[40:43], s39 offen offset:1024
    s_barrier
    s_lshl_b32 s35, s2, 17
    s_add_u32 s16, s28, s35
    s_addc_u32 s17, s29, 0
    s_mov_b32 s18, 131072
    s_mov_b32 s19, 0x00020000
    s_mov_b32 s44, 0xbdd2d3e8
    v_mov_b32 v253, 0xc0135761
    s_mul_i32 s36, s20, 4224
    v_lshrrev_b32 v252, 5, v255
    v_lshlrev_b32 v252, 4, v252
    v_add3_u32 v252, v252, v254, s36
    s_mov_b32 s45, 0xffff0000
    v_add_u32 v251, s38, v254
    s_mov_b32 s46, s44
    s_mov_b32 s47, s44
    s_mov_b32 s48, 1.0
    s_mov_b32 s49, 1.0
    v_mov_b32 v248, v253
    v_mov_b32 v249, v253
    s_mov_b32 s22, 2
L_joint_kernel_floop:
    s_waitcnt vmcnt(10)
    v_lshlrev_b32 v168, 16, v128
    v_and_b32 v169, s45, v128
    v_lshlrev_b32 v232, 16, v144
    v_and_b32 v233, s45, v144
    v_lshlrev_b32 v170, 16, v129
    v_and_b32 v171, s45, v129
    v_lshlrev_b32 v234, 16, v145
    v_and_b32 v235, s45, v145
    v_lshlrev_b32 v172, 16, v130
    v_and_b32 v173, s45, v130
    v_lshlrev_b32 v236, 16, v146
    v_and_b32 v237, s45, v146
    v_lshlrev_b32 v174, 16, v131
    v_and_b32 v175, s45, v131
    v_lshlrev_b32 v238, 16, v147
    v_and_b32 v239, s45, v147
    v_pk_add_f32 v[168:169], v[168:169], v[232:233]
    v_pk_add_f32 v[170:171], v[170:171], v[234:235]
    v_pk_add_f32 v[172:173], v[172:173], v[236:237]
    v_pk_add_f32 v[174:175], v[174:175], v[238:239]
    v_pk_mul_f32 v[232:233], v[168:169], v[168:169]
    v_pk_mul_f32 v[234:235], v[170:171], v[170:171]
    v_pk_mul_f32 v[236:237], v[172:173], v[172:173]
    v_pk_mul_f32 v[238:239], v[174:175], v[174:175]
    v_pk_fma_f32 v[232:233], v[232:233], s[46:47], v[248:249]
    v_pk_fma_f32 v[234:235], v[234:235], s[46:47], v[248:249]
    v_pk_fma_f32 v[236:237], v[236:237], s[46:47], v[248:249]
    v_pk_fma_f32 v[238:239], v[238:239], s[46:47], v[248:249]
    v_pk_mul_f32 v[232:233], v[232:233], v[168:169]
    v_pk_mul_f32 v[234:235], v[234:235], v[170:171]
    v_pk_mul_f32 v[236:237], v[236:237], v[172:173]
    v_pk_mul_f32 v[238:239], v[238:239], v[174:175]
    v_exp_f32 v232, v232
    v_exp_f32 v233, v233
    v_exp_f32 v234, v234
    v_exp_f32 v235, v235
    v_exp_f32 v236, v236
    v_exp_f32 v237, v237
    v_exp_f32 v238, v238
    v_exp_f32 v239, v239
    v_pk_add_f32 v[232:233], v[232:233], s[48:49]
    v_pk_add_f32 v[234:235], v[234:235], s[48:49]
    v_pk_add_f32 v[236:237], v[236:237], s[48:49]
    v_pk_add_f32 v[238:239], v[238:239], s[48:49]
    v_rcp_f32 v232, v232
    v_rcp_f32 v233, v233
    v_rcp_f32 v234, v234
    v_rcp_f32 v235, v235
    v_rcp_f32 v236, v236
    v_rcp_f32 v237, v237
    v_rcp_f32 v238, v238
    v_rcp_f32 v239, v239
    v_pk_mul_f32 v[168:169], v[168:169], v[232:233]
    v_pk_mul_f32 v[170:171], v[170:171], v[234:235]
    v_pk_mul_f32 v[172:173], v[172:173], v[236:237]
    v_pk_mul_f32 v[174:175], v[174:175], v[238:239]
    v_cvt_pk_bf16_f32 v240, v168, v169
    v_cvt_pk_bf16_f32 v241, v170, v171
    v_cvt_pk_bf16_f32 v242, v172, v173
    v_cvt_pk_bf16_f32 v243, v174, v175
    ds_write_b128 v252, v[240:243] offset:49152
    s_waitcnt vmcnt(8)
    v_lshlrev_b32 v168, 16, v132
    v_and_b32 v169, s45, v132
    v_lshlrev_b32 v232, 16, v148
    v_and_b32 v233, s45, v148
    v_lshlrev_b32 v170, 16, v133
    v_and_b32 v171, s45, v133
    v_lshlrev_b32 v234, 16, v149
    v_and_b32 v235, s45, v149
    v_lshlrev_b32 v172, 16, v134
    v_and_b32 v173, s45, v134
    v_lshlrev_b32 v236, 16, v150
    v_and_b32 v237, s45, v150
    v_lshlrev_b32 v174, 16, v135
    v_and_b32 v175, s45, v135
    v_lshlrev_b32 v238, 16, v151
    v_and_b32 v239, s45, v151
    v_pk_add_f32 v[168:169], v[168:169], v[232:233]
    v_pk_add_f32 v[170:171], v[170:171], v[234:235]
    v_pk_add_f32 v[172:173], v[172:173], v[236:237]
    v_pk_add_f32 v[174:175], v[174:175], v[238:239]
    v_pk_mul_f32 v[232:233], v[168:169], v[168:169]
    v_pk_mul_f32 v[234:235], v[170:171], v[170:171]
    v_pk_mul_f32 v[236:237], v[172:173], v[172:173]
    v_pk_mul_f32 v[238:239], v[174:175], v[174:175]
    v_pk_fma_f32 v[232:233], v[232:233], s[46:47], v[248:249]
    v_pk_fma_f32 v[234:235], v[234:235], s[46:47], v[248:249]
    v_pk_fma_f32 v[236:237], v[236:237], s[46:47], v[248:249]
    v_pk_fma_f32 v[238:239], v[238:239], s[46:47], v[248:249]
    v_pk_mul_f32 v[232:233], v[232:233], v[168:169]
    v_pk_mul_f32 v[234:235], v[234:235], v[170:171]
    v_pk_mul_f32 v[236:237], v[236:237], v[172:173]
    v_pk_mul_f32 v[238:239], v[238:239], v[174:175]
    v_exp_f32 v232, v232
    v_exp_f32 v233, v233
    v_exp_f32 v234, v234
    v_exp_f32 v235, v235
    v_exp_f32 v236, v236
    v_exp_f32 v237, v237
    v_exp_f32 v238, v238
    v_exp_f32 v239, v239
    v_pk_add_f32 v[232:233], v[232:233], s[48:49]
    v_pk_add_f32 v[234:235], v[234:235], s[48:49]
    v_pk_add_f32 v[236:237], v[236:237], s[48:49]
    v_pk_add_f32 v[238:239], v[238:239], s[48:49]
    v_rcp_f32 v232, v232
    v_rcp_f32 v233, v233
    v_rcp_f32 v234, v234
    v_rcp_f32 v235, v235
    v_rcp_f32 v236, v236
    v_rcp_f32 v237, v237
    v_rcp_f32 v238, v238
    v_rcp_f32 v239, v239
    v_pk_mul_f32 v[168:169], v[168:169], v[232:233]
    v_pk_mul_f32 v[170:171], v[170:171], v[234:235]
    v_pk_mul_f32 v[172:173], v[172:173], v[236:237]
    v_pk_mul_f32 v[174:175], v[174:175], v[238:239]
    v_cvt_pk_bf16_f32 v244, v168, v169
    v_cvt_pk_bf16_f32 v245, v170, v171
    v_cvt_pk_bf16_f32 v246, v172, v173
    v_cvt_pk_bf16_f32 v247, v174, v175
    ds_write_b128 v252, v[244:247] offset:50208
    s_waitcnt vmcnt(4)
    v_pk_mov_b32 v[128:129], v[136:137], v[136:137] op_sel:[0,1]
    v_pk_mov_b32 v[144:145], v[152:153], v[152:153] op_sel:[0,1]
    v_pk_mov_b32 v[130:131], v[138:139], v[138:139] op_sel:[0,1]
    v_pk_mov_b32 v[146:147], v[154:155], v[154:155] op_sel:[0,1]
    v_pk_mov_b32 v[132:133], v[140:141], v[140:141] op_sel:[0,1]
    v_pk_mov_b32 v[148:149], v[156:157], v[156:157] op_sel:[0,1]
    v_pk_mov_b32 v[134:135], v[142:143], v[142:143] op_sel:[0,1]
    v_pk_mov_b32 v[150:151], v[158:159], v[158:159] op_sel:[0,1]
    v_add_u32 v252, 2112, v252
    s_sub_u32 s22, s22, 1
    s_cmp_lg_u32 s22, 0
    s_cbranch_scc1 L_joint_kernel_floop
    s_waitcnt vmcnt(0)
    ds_write_b128 v251, v[192:195] offset:32768
    ds_write_b128 v251, v[196:199] offset:33792
    ds_write_b128 v251, v[200:203] offset:40960
    ds_write_b128 v251, v[204:207] offset:41984
    s_waitcnt lgkmcnt(0)
    s_barrier
    s_mov_b32 s36, 0
    buffer_load_dwordx4 v[0:3], v254, s[12:15], s36 offen offset:0
    buffer_load_dwordx4 v[4:7], v254, s[12:15], s36 offen offset:1024
    buffer_load_dwordx4 v[8:11], v254, s[12:15], s36 offen offset:2048
    buffer_load_dwordx4 v[12:15], v254, s[12:15], s36 offen offset:3072
    s_mov_b32 s36, 4096
    buffer_load_dwordx4 v[16:19], v254, s[12:15], s36 offen offset:0
    buffer_load_dwordx4 v[20:23], v254, s[12:15], s36 offen offset:1024
    buffer_load_dwordx4 v[24:27], v254, s[12:15], s36 offen offset:2048
    buffer_load_dwordx4 v[28:31], v254, s[12:15], s36 offen offset:3072
    s_mov_b32 s36, 8192
    buffer_load_dwordx4 v[32:35], v254, s[12:15], s36 offen offset:0
    buffer_load_dwordx4 v[36:39], v254, s[12:15], s36 offen offset:1024
    buffer_load_dwordx4 v[40:43], v254, s[12:15], s36 offen offset:2048
    buffer_load_dwordx4 v[44:47], v254, s[12:15], s36 offen offset:3072
    s_mov_b32 s36, 12288
    buffer_load_dwordx4 v[48:51], v254, s[12:15], s36 offen offset:0
    buffer_load_dwordx4 v[52:55], v254, s[12:15], s36 offen offset:1024
    buffer_load_dwordx4 v[56:59], v254, s[12:15], s36 offen offset:2048
    buffer_load_dwordx4 v[60:63], v254, s[12:15], s36 offen offset:3072
    s_mov_b32 s36, 16384
    buffer_load_dwordx4 v[64:67], v254, s[12:15], s36 offen offset:0
    buffer_load_dwordx4 v[68:71], v254, s[12:15], s36 offen offset:1024
    buffer_load_dwordx4 v[72:75], v254, s[12:15], s36 offen offset:2048
    buffer_load_dwordx4 v[76:79], v254, s[12:15], s36 offen offset:3072
    s_mov_b32 s36, 20480
    buffer_load_dwordx4 v[80:83], v254, s[12:15], s36 offen offset:0
    buffer_load_dwordx4 v[84:87], v254, s[12:15], s36 offen offset:1024
    buffer_load_dwordx4 v[88:91], v254, s[12:15], s36 offen offset:2048
    buffer_load_dwordx4 v[92:95], v254, s[12:15], s36 offen offset:3072
    s_mov_b32 s36, 24576
    buffer_load_dwordx4 v[96:99], v254, s[12:15], s36 offen offset:0
    buffer_load_dwordx4 v[100:103], v254, s[12:15], s36 offen offset:1024
    buffer_load_dwordx4 v[104:107], v254, s[12:15], s36 offen offset:2048
    buffer_load_dwordx4 v[108:111], v254, s[12:15], s36 offen offset:3072
    s_mov_b32 s36, 28672
    buffer_load_dwordx4 v[112:115], v254, s[12:15], s36 offen offset:0
    buffer_load_dwordx4 v[116:119], v254, s[12:15], s36 offen offset:1024
    buffer_load_dwordx4 v[120:123], v254, s[12:15], s36 offen offset:2048
    buffer_load_dwordx4 v[124:127], v254, s[12:15], s36 offen offset:3072
    v_lshrrev_b32 v250, 5, v255
    v_lshlrev_b32 v250, 14, v250
    v_and_b32 v249, 31, v255
    v_lshl_add_u32 v250, v249, 2, v250
    s_lshl_b32 s36, s21, 7
    v_add_u32 v250, s36, v250
    s_mov_b32 s44, 0
    s_mov_b32 s45, 4096
    s_mov_b32 s46, 8192
    s_mov_b32 s47, 12288
    s_mov_b32 s48, 32768
    s_mov_b32 s49, 36864
    s_mov_b32 s50, 40960
    s_mov_b32 s51, 45056
    s_mov_b32 s52, 65536
    s_mov_b32 s53, 69632
    s_mov_b32 s54, 73728
    s_mov_b32 s55, 77824
    s_mov_b32 s56, 98304
    s_mov_b32 s57, 102400
    s_mov_b32 s58, 106496
    s_mov_b32 s59, 110592
    s_barrier
    ds_read_b128 v[192:195], v254 offset:0
    ds_read_b128 v[196:199], v254 offset:1024
    ds_read_b128 v[200:203], v254 offset:2048
    ds_read_b128 v[204:207], v254 offset:3072
    s_waitcnt vmcnt(30) lgkmcnt(3)
    v_mfma_f32_32x32x16_bf16 v[128:143], v[192:195], v[0:3], 0
    ds_read_b128 v[208:211], v254 offset:4096
    v_mfma_f32_32x32x16_bf16 v[144:159], v[192:195], v[4:7], 0
    s_waitcnt vmcnt(28) lgkmcnt(3)
    v_mfma_f32_32x32x16_bf16 v[128:143], v[196:199], v[8:11], v[128:143]
    ds_read_b128 v[212:215], v254 offset:5120
    v_mfma_f32_32x32x16_bf16 v[144:159], v[196:199], v[12:15], v[144:159]
    s_waitcnt vmcnt(26) lgkmcnt(3)
    v_mfma_f32_32x32x16_bf16 v[128:143], v[200:203], v[16:19], v[128:143]
    ds_read_b128 v[216:219], v254 offset:6144
    v_mfma_f32_32x32x16_bf16 v[144:159], v[200:203], v[20:23], v[144:159]
    s_waitcnt vmcnt(24) lgkmcnt(3)
    v_mfma_f32_32x32x16_bf16 v[128:143], v[204:207], v[24:27], v[128:143]
    ds_read_b128 v[220:223], v254 offset:7168
    v_mfma_f32_32x32x16_bf16 v[144:159], v[204:207], v[28:31], v[144:159]
    s_waitcnt vmcnt(22) lgkmcnt(3)
    v_mfma_f32_32x32x16_bf16 v[128:143], v[208:211], v[32:35], v[128:143]
    ds_read_b128 v[192:195], v254 offset:8192
    v_mfma_f32_32x32x16_bf16 v[144:159], v[208:211], v[36:39], v[144:159]
    s_waitcnt vmcnt(20) lgkmcnt(3)
    v_mfma_f32_32x32x16_bf16 v[128:143], v[212:215], v[40:43], v[128:143]
    ds_read_b128 v[196:199], v254 offset:9216
    v_mfma_f32_32x32x16_bf16 v[144:159], v[212:215], v[44:47], v[144:159]
    s_waitcnt vmcnt(18) lgkmcnt(3)
    v_mfma_f32_32x32x16_bf16 v[128:143], v[216:219], v[48:51], v[128:143]
    ds_read_b128 v[200:203], v254 offset:10240
    v_mfma_f32_32x32x16_bf16 v[144:159], v[216:219], v[52:55], v[144:159]
    s_waitcnt vmcnt(16) lgkmcnt(3)
    v_mfma_f32_32x32x16_bf16 v[128:143], v[220:223], v[56:59], v[128:143]
    ds_read_b128 v[204:207], v254 offset:11264
    v_mfma_f32_32x32x16_bf16 v[144:159], v[220:223], v[60:63], v[144:159]
    s_waitcnt vmcnt(14) lgkmcnt(3)
    v_mfma_f32_32x32x16_bf16 v[128:143], v[192:195], v[64:67], v[128:143]
    ds_read_b128 v[208:211], v254 offset:12288
    v_mfma_f32_32x32x16_bf16 v[144:159], v[192:195], v[68:71], v[144:159]
    s_waitcnt vmcnt(12) lgkmcnt(3)
    v_mfma_f32_32x32x16_bf16 v[128:143], v[196:199], v[72:75], v[128:143]
    ds_read_b128 v[212:215], v254 offset:13312
    v_mfma_f32_32x32x16_bf16 v[144:159], v[196:199], v[76:79], v[144:159]
    s_waitcnt vmcnt(10) lgkmcnt(3)
    v_mfma_f32_32x32x16_bf16 v[128:143], v[200:203], v[80:83], v[128:143]
    ds_read_b128 v[216:219], v254 offset:14336
    v_mfma_f32_32x32x16_bf16 v[144:159], v[200:203], v[84:87], v[144:159]
    s_waitcnt vmcnt(8) lgkmcnt(3)
    v_mfma_f32_32x32x16_bf16 v[128:143], v[204:207], v[88:91], v[128:143]
    ds_read_b128 v[220:223], v254 offset:15360
    v_mfma_f32_32x32x16_bf16 v[144:159], v[204:207], v[92:95], v[144:159]
    s_waitcnt lgkmcnt(0)
    s_barrier
    s_waitcnt vmcnt(6)
    v_mfma_f32_32x32x16_bf16 v[128:143], v[208:211], v[96:99], v[128:143]
    ds_read_b128 v[192:195], v254 offset:16384
    v_mfma_f32_32x32x16_bf16 v[144:159], v[208:211], v[100:103], v[144:159]
    s_waitcnt vmcnt(4)
    v_mfma_f32_32x32x16_bf16 v[128:143], v[212:215], v[104:107], v[128:143]
    ds_read_b128 v[196:199], v254 offset:17408
    v_mfma_f32_32x32x16_bf16 v[144:159], v[212:215], v[108:111], v[144:159]
    s_waitcnt vmcnt(2)
    v_mfma_f32_32x32x16_bf16 v[128:143], v[216:219], v[112:115], v[128:143]
    ds_read_b128 v[200:203], v254 offset:18432
    v_mfma_f32_32x32x16_bf16 v[144:159], v[216:219], v[116:119], v[144:159]
    s_waitcnt vmcnt(0)
    v_mfma_f32_32x32x16_bf16 v[128:143], v[220:223], v[120:123], v[128:143]
    ds_read_b128 v[204:207], v254 offset:19456
    v_mfma_f32_32x32x16_bf16 v[144:159], v[220:223], v[124:127], v[144:159]
    s_mov_b32 s22, 4
    s_nop 0
L_joint_kernel_oloop:
    s_waitcnt lgkmcnt(3)
    s_nop 0
    v_mfma_f32_32x32x16_bf16 v[160:175], v[192:195], v[0:3], 0
    ds_read_b128 v[208:211], v254 offset:20480
    v_mfma_f32_32x32x16_bf16 v[176:191], v[192:195], v[4:7], 0
    s_waitcnt lgkmcnt(3)
    s_nop 0
    v_mfma_f32_32x32x16_bf16 v[160:175], v[196:199], v[8:11], v[160:175]
    ds_read_b128 v[212:215], v254 offset:21504
    v_mfma_f32_32x32x16_bf16 v[176:191], v[196:199], v[12:15], v[176:191]
    s_waitcnt lgkmcnt(3)
    s_nop 0
    v_mfma_f32_32x32x16_bf16 v[160:175], v[200:203], v[16:19], v[160:175]
    ds_read_b128 v[216:219], v254 offset:22528
    v_mfma_f32_32x32x16_bf16 v[176:191], v[200:203], v[20:23], v[176:191]
    s_waitcnt lgkmcnt(3)
    s_nop 0
    v_mfma_f32_32x32x16_bf16 v[160:175], v[204:207], v[24:27], v[160:175]
    ds_read_b128 v[220:223], v254 offset:23552
    v_mfma_f32_32x32x16_bf16 v[176:191], v[204:207], v[28:31], v[176:191]
    s_waitcnt lgkmcnt(3)
    s_nop 0
    v_mfma_f32_32x32x16_bf16 v[160:175], v[208:211], v[32:35], v[160:175]
    ds_read_b128 v[192:195], v254 offset:24576
    v_cvt_pk_bf16_f32 v224, v128, v144
    buffer_store_dword v224, v250, s[16:19], s44 offen nt
    v_mfma_f32_32x32x16_bf16 v[176:191], v[208:211], v[36:39], v[176:191]
    v_cvt_pk_bf16_f32 v225, v129, v145
    buffer_store_dword v225, v250, s[16:19], s45 offen nt
    s_waitcnt lgkmcnt(3)
    s_nop 0
    v_mfma_f32_32x32x16_bf16 v[160:175], v[212:215], v[40:43], v[160:175]
    ds_read_b128 v[196:199], v254 offset:25600
    v_cvt_pk_bf16_f32 v226, v130, v146
    buffer_store_dword v226, v250, s[16:19], s46 offen nt
    v_mfma_f32_32x32x16_bf16 v[176:191], v[212:215], v[44:47], v[176:191]
    v_cvt_pk_bf16_f32 v227, v131, v147
    buffer_store_dword v227, v250, s[16:19], s47 offen nt
    s_waitcnt lgkmcnt(3)
    s_nop 0
    v_mfma_f32_32x32x16_bf16 v[160:175], v[216:219], v[48:51], v[160:175]
    ds_read_b128 v[200:203], v254 offset:26624
    v_cvt_pk_bf16_f32 v228, v132, v148
    buffer_store_dword v228, v250, s[16:19], s48 offen nt
    v_mfma_f32_32x32x16_bf16 v[176:191], v[216:219], v[52:55], v[176:191]
    v_cvt_pk_bf16_f32 v229, v133, v149
    buffer_store_dword v229, v250, s[16:19], s49 offen nt
    s_waitcnt lgkmcnt(3)
    s_nop 0
    v_mfma_f32_32x32x16_bf16 v[160:175], v[220:223], v[56:59], v[160:175]
    ds_read_b128 v[204:207], v254 offset:27648
    v_cvt_pk_bf16_f32 v230, v134, v150
    buffer_store_dword v230, v250, s[16:19], s50 offen nt
    v_mfma_f32_32x32x16_bf16 v[176:191], v[220:223], v[60:63], v[176:191]
    v_cvt_pk_bf16_f32 v231, v135, v151
    buffer_store_dword v231, v250, s[16:19], s51 offen nt
    s_waitcnt lgkmcnt(3)
    s_nop 0
    v_mfma_f32_32x32x16_bf16 v[160:175], v[192:195], v[64:67], v[160:175]
    ds_read_b128 v[208:211], v254 offset:28672
    v_cvt_pk_bf16_f32 v232, v136, v152
    buffer_store_dword v232, v250, s[16:19], s52 offen nt
    v_mfma_f32_32x32x16_bf16 v[176:191], v[192:195], v[68:71], v[176:191]
    v_cvt_pk_bf16_f32 v233, v137, v153
    buffer_store_dword v233, v250, s[16:19], s53 offen nt
    s_waitcnt lgkmcnt(3)
    s_nop 0
    v_mfma_f32_32x32x16_bf16 v[160:175], v[196:199], v[72:75], v[160:175]
    ds_read_b128 v[212:215], v254 offset:29696
    v_cvt_pk_bf16_f32 v234, v138, v154
    v_mfma_f32_32x32x16_bf16 v[176:191], v[196:199], v[76:79], v[176:191]
    buffer_store_dword v234, v250, s[16:19], s54 offen nt
    s_waitcnt lgkmcnt(3)
    s_nop 0
    v_mfma_f32_32x32x16_bf16 v[160:175], v[200:203], v[80:83], v[160:175]
    ds_read_b128 v[216:219], v254 offset:30720
    v_cvt_pk_bf16_f32 v235, v139, v155
    v_mfma_f32_32x32x16_bf16 v[176:191], v[200:203], v[84:87], v[176:191]
    buffer_store_dword v235, v250, s[16:19], s55 offen nt
    s_waitcnt lgkmcnt(3)
    s_nop 0
    v_mfma_f32_32x32x16_bf16 v[160:175], v[204:207], v[88:91], v[160:175]
    ds_read_b128 v[220:223], v254 offset:31744
    v_cvt_pk_bf16_f32 v236, v140, v156
    v_mfma_f32_32x32x16_bf16 v[176:191], v[204:207], v[92:95], v[176:191]
    buffer_store_dword v236, v250, s[16:19], s56 offen nt
    s_waitcnt lgkmcnt(0)
    s_barrier
    v_mfma_f32_32x32x16_bf16 v[160:175], v[208:211], v[96:99], v[160:175]
    ds_read_b128 v[192:195], v254 offset:0
    v_cvt_pk_bf16_f32 v237, v141, v157
    v_mfma_f32_32x32x16_bf16 v[176:191], v[208:211], v[100:103], v[176:191]
    buffer_store_dword v237, v250, s[16:19], s57 offen nt
    v_mfma_f32_32x32x16_bf16 v[160:175], v[212:215], v[104:107], v[160:175]
    ds_read_b128 v[196:199], v254 offset:1024
    v_cvt_pk_bf16_f32 v238, v142, v158
    v_mfma_f32_32x32x16_bf16 v[176:191], v[212:215], v[108:111], v[176:191]
    buffer_store_dword v238, v250, s[16:19], s58 offen nt
    v_mfma_f32_32x32x16_bf16 v[160:175], v[216:219], v[112:115], v[160:175]
    ds_read_b128 v[200:203], v254 offset:2048
    v_cvt_pk_bf16_f32 v239, v143, v159
    v_mfma_f32_32x32x16_bf16 v[176:191], v[216:219], v[116:119], v[176:191]
    buffer_store_dword v239, v250, s[16:19], s59 offen nt
    v_mfma_f32_32x32x16_bf16 v[160:175], v[220:223], v[120:123], v[160:175]
    ds_read_b128 v[204:207], v254 offset:3072
    v_add_u32 v250, 512, v250
    v_mfma_f32_32x32x16_bf16 v[176:191], v[220:223], v[124:127], v[176:191]
    s_sub_u32 s22, s22, 1
    s_cmp_eq_u32 s22, 0
    s_cbranch_scc1 L_joint_kernel_oend
    s_waitcnt lgkmcnt(3)
    v_mfma_f32_32x32x16_bf16 v[128:143], v[192:195], v[0:3], 0
    ds_read_b128 v[208:211], v254 offset:4096
    v_mfma_f32_32x32x16_bf16 v[144:159], v[192:195], v[4:7], 0
    s_waitcnt lgkmcnt(3)
    s_nop 0
    v_mfma_f32_32x32x16_bf16 v[128:143], v[196:199], v[8:11], v[128:143]
    ds_read_b128 v[212:215], v254 offset:5120
    v_mfma_f32_32x32x16_bf16 v[144:159], v[196:199], v[12:15], v[144:159]
    s_waitcnt lgkmcnt(3)
    s_nop 0
    v_mfma_f32_32x32x16_bf16 v[128:143], v[200:203], v[16:19], v[128:143]
    ds_read_b128 v[216:219], v254 offset:6144
    v_mfma_f32_32x32x16_bf16 v[144:159], v[200:203], v[20:23], v[144:159]
    s_waitcnt lgkmcnt(3)
    s_nop 0
    v_mfma_f32_32x32x16_bf16 v[128:143], v[204:207], v[24:27], v[128:143]
    ds_read_b128 v[220:223], v254 offset:7168
    v_mfma_f32_32x32x16_bf16 v[144:159], v[204:207], v[28:31], v[144:159]
    s_waitcnt lgkmcnt(3)
    s_nop 0
    v_mfma_f32_32x32x16_bf16 v[128:143], v[208:211], v[32:35], v[128:143]
    ds_read_b128 v[192:195], v254 offset:8192
    v_cvt_pk_bf16_f32 v224, v160, v176
    buffer_store_dword v224, v250, s[16:19], s44 offen nt
    v_mfma_f32_32x32x16_bf16 v[144:159], v[208:211], v[36:39], v[144:159]
    v_cvt_pk_bf16_f32 v225, v161, v177
    buffer_store_dword v225, v250, s[16:19], s45 offen nt
    s_waitcnt lgkmcnt(3)
    s_nop 0
    v_mfma_f32_32x32x16_bf16 v[128:143], v[212:215], v[40:43], v[128:143]
    ds_read_b128 v[196:199], v254 offset:9216
    v_cvt_pk_bf16_f32 v226, v162, v178
    buffer_store_dword v226, v250, s[16:19], s46 offen nt
    v_mfma_f32_32x32x16_bf16 v[144:159], v[212:215], v[44:47], v[144:159]
    v_cvt_pk_bf16_f32 v227, v163, v179
    buffer_store_dword v227, v250, s[16:19], s47 offen nt
    s_waitcnt lgkmcnt(3)
    s_nop 0
    v_mfma_f32_32x32x16_bf16 v[128:143], v[216:219], v[48:51], v[128:143]
    ds_read_b128 v[200:203], v254 offset:10240
    v_cvt_pk_bf16_f32 v228, v164, v180
    buffer_store_dword v228, v250, s[16:19], s48 offen nt
    v_mfma_f32_32x32x16_bf16 v[144:159], v[216:219], v[52:55], v[144:159]
    v_cvt_pk_bf16_f32 v229, v165, v181
    buffer_store_dword v229, v250, s[16:19], s49 offen nt
    s_waitcnt lgkmcnt(3)
    s_nop 0
    v_mfma_f32_32x32x16_bf16 v[128:143], v[220:223], v[56:59], v[128:143]
    ds_read_b128 v[204:207], v254 offset:11264
    v_cvt_pk_bf16_f32 v230, v166, v182
    buffer_store_dword v230, v250, s[16:19], s50 offen nt
    v_mfma_f32_32x32x16_bf16 v[144:159], v[220:223], v[60:63], v[144:159]
    v_cvt_pk_bf16_f32 v231, v167, v183
    buffer_store_dword v231, v250, s[16:19], s51 offen nt
    s_waitcnt lgkmcnt(3)
    s_nop 0
    v_mfma_f32_32x32x16_bf16 v[128:143], v[192:195], v[64:67], v[128:143]
    ds_read_b128 v[208:211], v254 offset:12288
    v_cvt_pk_bf16_f32 v232, v168, v184
    buffer_store_dword v232, v250, s[16:19], s52 offen nt
    v_mfma_f32_32x32x16_bf16 v[144:159], v[192:195], v[68:71], v[144:159]
    v_cvt_pk_bf16_f32 v233, v169, v185
    buffer_store_dword v233, v250, s[16:19], s53 offen nt
    s_waitcnt lgkmcnt(3)
    s_nop 0
    v_mfma_f32_32x32x16_bf16 v[128:143], v[196:199], v[72:75], v[128:143]
    ds_read_b128 v[212:215], v254 offset:13312
    v_cvt_pk_bf16_f32 v234, v170, v186
    v_mfma_f32_32x32x16_bf16 v[144:159], v[196:199], v[76:79], v[144:159]
    buffer_store_dword v234, v250, s[16:19], s54 offen nt
    s_waitcnt lgkmcnt(3)
    s_nop 0
    v_mfma_f32_32x32x16_bf16 v[128:143], v[200:203], v[80:83], v[128:143]
    ds_read_b128 v[216:219], v254 offset:14336
    v_cvt_pk_bf16_f32 v235, v171, v187
    v_mfma_f32_32x32x16_bf16 v[144:159], v[200:203], v[84:87], v[144:159]
    buffer_store_dword v235, v250, s[16:19], s55 offen nt
    s_waitcnt lgkmcnt(3)
    s_nop 0
    v_mfma_f32_32x32x16_bf16 v[128:143], v[204:207], v[88:91], v[128:143]
    ds_read_b128 v[220:223], v254 offset:15360
    v_cvt_pk_bf16_f32 v236, v172, v188
    v_mfma_f32_32x32x16_bf16 v[144:159], v[204:207], v[92:95], v[144:159]
    buffer_store_dword v236, v250, s[16:19], s56 offen nt
    s_waitcnt lgkmcnt(0)
    s_barrier
    v_mfma_f32_32x32x16_bf16 v[128:143], v[208:211], v[96:99], v[128:143]
    ds_read_b128 v[192:195], v254 offset:16384
    v_cvt_pk_bf16_f32 v237, v173, v189
    v_mfma_f32_32x32x16_bf16 v[144:159], v[208:211], v[100:103], v[144:159]
    buffer_store_dword v237, v250, s[16:19], s57 offen nt
    v_mfma_f32_32x32x16_bf16 v[128:143], v[212:215], v[104:107], v[128:143]
    ds_read_b128 v[196:199], v254 offset:17408
    v_cvt_pk_bf16_f32 v238, v174, v190
    v_mfma_f32_32x32x16_bf16 v[144:159], v[212:215], v[108:111], v[144:159]
    buffer_store_dword v238, v250, s[16:19], s58 offen nt
    v_mfma_f32_32x32x16_bf16 v[128:143], v[216:219], v[112:115], v[128:143]
    ds_read_b128 v[200:203], v254 offset:18432
    v_cvt_pk_bf16_f32 v239, v175, v191
    v_mfma_f32_32x32x16_bf16 v[144:159], v[216:219], v[116:119], v[144:159]
    buffer_store_dword v239, v250, s[16:19], s59 offen nt
    v_mfma_f32_32x32x16_bf16 v[128:143], v[220:223], v[120:123], v[128:143]
    ds_read_b128 v[204:207], v254 offset:19456
    v_add_u32 v250, 512, v250
    v_mfma_f32_32x32x16_bf16 v[144:159], v[220:223], v[124:127], v[144:159]
    s_waitcnt vmcnt(24)
    s_branch L_joint_kernel_oloop
L_joint_kernel_oend:
    s_nop 15
    v_cvt_pk_bf16_f32 v224, v160, v176
    buffer_store_dword v224, v250, s[16:19], s44 offen nt
    v_cvt_pk_bf16_f32 v225, v161, v177
    buffer_store_dword v225, v250, s[16:19], s45 offen nt
    v_cvt_pk_bf16_f32 v226, v162, v178
    buffer_store_dword v226, v250, s[16:19], s46 offen nt
    v_cvt_pk_bf16_f32 v227, v163, v179
    buffer_store_dword v227, v250, s[16:19], s47 offen nt
    v_cvt_pk_bf16_f32 v228, v164, v180
    buffer_store_dword v228, v250, s[16:19], s48 offen nt
    v_cvt_pk_bf16_f32 v229, v165, v181
    buffer_store_dword v229, v250, s[16:19], s49 offen nt
    v_cvt_pk_bf16_f32 v230, v166, v182
    buffer_store_dword v230, v250, s[16:19], s50 offen nt
    v_cvt_pk_bf16_f32 v231, v167, v183
    buffer_store_dword v231, v250, s[16:19], s51 offen nt
    v_cvt_pk_bf16_f32 v232, v168, v184
    buffer_store_dword v232, v250, s[16:19], s52 offen nt
    v_cvt_pk_bf16_f32 v233, v169, v185
    buffer_store_dword v233, v250, s[16:19], s53 offen nt
    v_cvt_pk_bf16_f32 v234, v170, v186
    buffer_store_dword v234, v250, s[16:19], s54 offen nt
    v_cvt_pk_bf16_f32 v235, v171, v187
    buffer_store_dword v235, v250, s[16:19], s55 offen nt
    v_cvt_pk_bf16_f32 v236, v172, v188
    buffer_store_dword v236, v250, s[16:19], s56 offen nt
    v_cvt_pk_bf16_f32 v237, v173, v189
    buffer_store_dword v237, v250, s[16:19], s57 offen nt
    v_cvt_pk_bf16_f32 v238, v174, v190
    buffer_store_dword v238, v250, s[16:19], s58 offen nt
    v_cvt_pk_bf16_f32 v239, v175, v191
    buffer_store_dword v239, v250, s[16:19], s59 offen nt
    v_add_u32 v250, 512, v250
    s_branch L_joint_kernel_fin
L_joint_kernel_T:
    s_setprio 3
    s_add_u32 s36, s30, 44335104
    s_addc_u32 s37, s31, 0
    s_load_dwordx16 s[44:59], s[36:37], 0
    v_and_b32 v250, 31, v255
    v_mul_u32_u24 v250, 528, v250
    v_lshrrev_b32 v249, 5, v255
    v_lshl_add_u32 v250, v249, 4, v250
    v_lshlrev_b32 v249, 5, v249
    s_lshl_b32 s36, s21, 8
    v_add_u32 v249, s36, v249
    s_lshl_b32 s36, s21, 12
    v_add_u32 v248, s36, v254
    s_barrier
    s_mov_b32 s36, 0
    buffer_load_dwordx4 v[0:3], v254, s[12:15], s36 offen offset:0
    buffer_load_dwordx4 v[4:7], v254, s[12:15], s36 offen offset:1024
    buffer_load_dwordx4 v[8:11], v254, s[12:15], s36 offen offset:2048
    buffer_load_dwordx4 v[12:15], v254, s[12:15], s36 offen offset:3072
    s_mov_b32 s36, 4096
    buffer_load_dwordx4 v[16:19], v254, s[12:15], s36 offen offset:0
    buffer_load_dwordx4 v[20:23], v254, s[12:15], s36 offen offset:1024
    buffer_load_dwordx4 v[24:27], v254, s[12:15], s36 offen offset:2048
    buffer_load_dwordx4 v[28:31], v254, s[12:15], s36 offen offset:3072
    s_mov_b32 s36, 8192
    buffer_load_dwordx4 v[32:35], v254, s[12:15], s36 offen offset:0
    buffer_load_dwordx4 v[36:39], v254, s[12:15], s36 offen offset:1024
    buffer_load_dwordx4 v[40:43], v254, s[12:15], s36 offen offset:2048
    buffer_load_dwordx4 v[44:47], v254, s[12:15], s36 offen offset:3072
    s_mov_b32 s36, 12288
    buffer_load_dwordx4 v[48:51], v254, s[12:15], s36 offen offset:0
    buffer_load_dwordx4 v[52:55], v254, s[12:15], s36 offen offset:1024
    buffer_load_dwordx4 v[56:59], v254, s[12:15], s36 offen offset:2048
    buffer_load_dwordx4 v[60:63], v254, s[12:15], s36 offen offset:3072
    s_mov_b32 s36, 16384
    buffer_load_dwordx4 v[64:67], v254, s[12:15], s36 offen offset:0
    buffer_load_dwordx4 v[68:71], v254, s[12:15], s36 offen offset:1024
    buffer_load_dwordx4 v[72:75], v254, s[12:15], s36 offen offset:2048
    buffer_load_dwordx4 v[76:79], v254, s[12:15], s36 offen offset:3072
    s_mov_b32 s36, 20480
    buffer_load_dwordx4 v[80:83], v254, s[12:15], s36 offen offset:0
    buffer_load_dwordx4 v[84:87], v254, s[12:15], s36 offen offset:1024
    buffer_load_dwordx4 v[88:91], v254, s[12:15], s36 offen offset:2048
    buffer_load_dwordx4 v[92:95], v254, s[12:15], s36 offen offset:3072
    s_mov_b32 s36, 24576
    buffer_load_dwordx4 v[96:99], v254, s[12:15], s36 offen offset:0
    buffer_load_dwordx4 v[100:103], v254, s[12:15], s36 offen offset:1024
    buffer_load_dwordx4 v[104:107], v254, s[12:15], s36 offen offset:2048
    buffer_load_dwordx4 v[108:111], v254, s[12:15], s36 offen offset:3072
    s_mov_b32 s36, 28672
    buffer_load_dwordx4 v[112:115], v254, s[12:15], s36 offen offset:0
    buffer_load_dwordx4 v[116:119], v254, s[12:15], s36 offen offset:1024
    buffer_load_dwordx4 v[120:123], v254, s[12:15], s36 offen offset:2048
    buffer_load_dwordx4 v[124:127], v254, s[12:15], s36 offen offset:3072
    s_waitcnt lgkmcnt(0)
    s_setprio 0
    s_or_b32 s44, s44, s45
    s_or_b32 s44, s44, s46
    s_or_b32 s44, s44, s47
    s_or_b32 s44, s44, s48
    s_or_b32 s44, s44, s49
    s_or_b32 s44, s44, s50
    s_or_b32 s44, s44, s51
    s_or_b32 s44, s44, s52
    s_or_b32 s44, s44, s53
    s_or_b32 s44, s44, s54
    s_or_b32 s44, s44, s55
    s_or_b32 s44, s44, s56
    s_or_b32 s44, s44, s57
    s_or_b32 s44, s44, s58
    s_or_b32 s44, s44, s59
    s_barrier
    ds_read_b128 v[160:163], v250 offset:49152
    ds_read_b128 v[164:167], v250 offset:49184
    ds_read_b128 v[168:171], v250 offset:49216
    ds_read_b128 v[172:175], v250 offset:49248
    ds_read_b128 v[176:179], v250 offset:49280
    ds_read_b128 v[180:183], v250 offset:49312
    ds_read_b128 v[184:187], v250 offset:49344
    ds_read_b128 v[188:191], v250 offset:49376
    s_waitcnt vmcnt(30) lgkmcnt(7)
    v_mfma_f32_32x32x16_bf16 v[128:143], v[0:3], v[160:163], 0
    v_mfma_f32_32x32x16_bf16 v[144:159], v[4:7], v[160:163], 0
    ds_read_b128 v[160:163], v250 offset:49408
    s_waitcnt vmcnt(28) lgkmcnt(7)
    v_mfma_f32_32x32x16_bf16 v[128:143], v[8:11], v[164:167], v[128:143]
    v_mfma_f32_32x32x16_bf16 v[144:159], v[12:15], v[164:167], v[144:159]
    ds_read_b128 v[164:167], v250 offset:49440
    s_waitcnt vmcnt(26) lgkmcnt(7)
    v_mfma_f32_32x32x16_bf16 v[128:143], v[16:19], v[168:171], v[128:143]
    v_mfma_f32_32x32x16_bf16 v[144:159], v[20:23], v[168:171], v[144:159]
    ds_read_b128 v[168:171], v250 offset:49472
    s_waitcnt vmcnt(24) lgkmcnt(7)
    v_mfma_f32_32x32x16_bf16 v[128:143], v[24:27], v[172:175], v[128:143]
    v_mfma_f32_32x32x16_bf16 v[144:159], v[28:31], v[172:175], v[144:159]
    ds_read_b128 v[172:175], v250 offset:49504
    s_waitcnt vmcnt(22) lgkmcnt(7)
    v_mfma_f32_32x32x16_bf16 v[128:143], v[32:35], v[176:179], v[128:143]
    v_mfma_f32_32x32x16_bf16 v[144:159], v[36:39], v[176:179], v[144:159]
    ds_read_b128 v[176:179], v250 offset:49536
    s_waitcnt vmcnt(20) lgkmcnt(7)
    v_mfma_f32_32x32x16_bf16 v[128:143], v[40:43], v[180:183], v[128:143]
    v_mfma_f32_32x32x16_bf16 v[144:159], v[44:47], v[180:183], v[144:159]
    ds_read_b128 v[180:183], v250 offset:49568
    s_waitcnt vmcnt(18) lgkmcnt(7)
    v_mfma_f32_32x32x16_bf16 v[128:143], v[48:51], v[184:187], v[128:143]
    v_mfma_f32_32x32x16_bf16 v[144:159], v[52:55], v[184:187], v[144:159]
    ds_read_b128 v[184:187], v250 offset:49600
    s_waitcnt vmcnt(16) lgkmcnt(7)
    v_mfma_f32_32x32x16_bf16 v[128:143], v[56:59], v[188:191], v[128:143]
    v_mfma_f32_32x32x16_bf16 v[144:159], v[60:63], v[188:191], v[144:159]
    ds_read_b128 v[188:191], v250 offset:49632
    s_waitcnt vmcnt(14) lgkmcnt(7)
    v_mfma_f32_32x32x16_bf16 v[128:143], v[64:67], v[160:163], v[128:143]
    v_mfma_f32_32x32x16_bf16 v[144:159], v[68:71], v[160:163], v[144:159]
    s_waitcnt vmcnt(12) lgkmcnt(6)
    v_mfma_f32_32x32x16_bf16 v[128:143], v[72:75], v[164:167], v[128:143]
    v_mfma_f32_32x32x16_bf16 v[144:159], v[76:79], v[164:167], v[144:159]
    s_waitcnt vmcnt(10) lgkmcnt(5)
    v_mfma_f32_32x32x16_bf16 v[128:143], v[80:83], v[168:171], v[128:143]
    v_mfma_f32_32x32x16_bf16 v[144:159], v[84:87], v[168:171], v[144:159]
    s_waitcnt vmcnt(8) lgkmcnt(4)
    v_mfma_f32_32x32x16_bf16 v[128:143], v[88:91], v[172:175], v[128:143]
    v_mfma_f32_32x32x16_bf16 v[144:159], v[92:95], v[172:175], v[144:159]
    s_waitcnt vmcnt(6) lgkmcnt(3)
    v_mfma_f32_32x32x16_bf16 v[128:143], v[96:99], v[176:179], v[128:143]
    v_mfma_f32_32x32x16_bf16 v[144:159], v[100:103], v[176:179], v[144:159]
    s_waitcnt vmcnt(4) lgkmcnt(2)
    v_mfma_f32_32x32x16_bf16 v[128:143], v[104:107], v[180:183], v[128:143]
    v_mfma_f32_32x32x16_bf16 v[144:159], v[108:111], v[180:183], v[144:159]
    s_waitcnt vmcnt(2) lgkmcnt(1)
    v_mfma_f32_32x32x16_bf16 v[128:143], v[112:115], v[184:187], v[128:143]
    v_mfma_f32_32x32x16_bf16 v[144:159], v[116:119], v[184:187], v[144:159]
    s_waitcnt vmcnt(0) lgkmcnt(0)
    v_mfma_f32_32x32x16_bf16 v[128:143], v[120:123], v[188:191], v[128:143]
    v_mfma_f32_32x32x16_bf16 v[144:159], v[124:127], v[188:191], v[144:159]
    s_mov_b32 s46, 0xffff0000
    s_mov_b32 s45, 0x4038aa3b
    s_nop 10
    v_cvt_pk_bf16_f32 v224, v128, v144
    v_cvt_pk_bf16_f32 v225, v129, v145
    v_cvt_pk_bf16_f32 v226, v130, v146
    v_cvt_pk_bf16_f32 v227, v131, v147
    v_cvt_pk_bf16_f32 v228, v132, v148
    v_cvt_pk_bf16_f32 v229, v133, v149
    v_cvt_pk_bf16_f32 v230, v134, v150
    v_cvt_pk_bf16_f32 v231, v135, v151
    v_cvt_pk_bf16_f32 v232, v136, v152
    v_cvt_pk_bf16_f32 v233, v137, v153
    v_cvt_pk_bf16_f32 v234, v138, v154
    v_cvt_pk_bf16_f32 v235, v139, v155
    v_cvt_pk_bf16_f32 v236, v140, v156
    v_cvt_pk_bf16_f32 v237, v141, v157
    v_cvt_pk_bf16_f32 v238, v142, v158
    v_cvt_pk_bf16_f32 v239, v143, v159
    v_lshlrev_b32 v0, 16, v224
    v_and_b32 v1, s46, v224
    v_lshlrev_b32 v2, 16, v225
    v_and_b32 v3, s46, v225
    v_lshlrev_b32 v4, 16, v226
    v_and_b32 v5, s46, v226
    v_lshlrev_b32 v6, 16, v227
    v_and_b32 v7, s46, v227
    v_lshlrev_b32 v8, 16, v228
    v_and_b32 v9, s46, v228
    v_lshlrev_b32 v10, 16, v229
    v_and_b32 v11, s46, v229
    v_lshlrev_b32 v12, 16, v230
    v_and_b32 v13, s46, v230
    v_lshlrev_b32 v14, 16, v231
    v_and_b32 v15, s46, v231
    v_lshlrev_b32 v16, 16, v232
    v_and_b32 v17, s46, v232
    v_lshlrev_b32 v18, 16, v233
    v_and_b32 v19, s46, v233
    v_lshlrev_b32 v20, 16, v234
    v_and_b32 v21, s46, v234
    v_lshlrev_b32 v22, 16, v235
    v_and_b32 v23, s46, v235
    v_lshlrev_b32 v24, 16, v236
    v_and_b32 v25, s46, v236
    v_lshlrev_b32 v26, 16, v237
    v_and_b32 v27, s46, v237
    v_lshlrev_b32 v28, 16, v238
    v_and_b32 v29, s46, v238
    v_lshlrev_b32 v30, 16, v239
    v_and_b32 v31, s46, v239
    s_mov_b32 s48, s45
    s_mov_b32 s49, s45
    v_pk_mul_f32 v[0:1], v[0:1], s[48:49]
    v_pk_mul_f32 v[2:3], v[2:3], s[48:49]
    v_pk_mul_f32 v[4:5], v[4:5], s[48:49]
    v_pk_mul_f32 v[6:7], v[6:7], s[48:49]
    v_pk_mul_f32 v[8:9], v[8:9], s[48:49]
    v_pk_mul_f32 v[10:11], v[10:11], s[48:49]
    v_pk_mul_f32 v[12:13], v[12:13], s[48:49]
    v_pk_mul_f32 v[14:15], v[14:15], s[48:49]
    v_pk_mul_f32 v[16:17], v[16:17], s[48:49]
    v_pk_mul_f32 v[18:19], v[18:19], s[48:49]
    v_pk_mul_f32 v[20:21], v[20:21], s[48:49]
    v_pk_mul_f32 v[22:23], v[22:23], s[48:49]
    v_pk_mul_f32 v[24:25], v[24:25], s[48:49]
    v_pk_mul_f32 v[26:27], v[26:27], s[48:49]
    v_pk_mul_f32 v[28:29], v[28:29], s[48:49]
    v_pk_mul_f32 v[30:31], v[30:31], s[48:49]
    v_max_f32 v64, |v0|, |v1|
    v_max3_f32 v64, |v2|, |v3|, v64
    v_max3_f32 v64, |v4|, |v5|, v64
    v_max3_f32 v64, |v6|, |v7|, v64
    v_max3_f32 v64, |v8|, |v9|, v64
    v_max3_f32 v64, |v10|, |v11|, v64
    v_max3_f32 v64, |v12|, |v13|, v64
    v_max3_f32 v64, |v14|, |v15|, v64
    v_max3_f32 v64, |v16|, |v17|, v64
    v_max3_f32 v64, |v18|, |v19|, v64
    v_max3_f32 v64, |v20|, |v21|, v64
    v_max3_f32 v64, |v22|, |v23|, v64
    v_max3_f32 v64, |v24|, |v25|, v64
    v_max3_f32 v64, |v26|, |v27|, v64
    v_max3_f32 v64, |v28|, |v29|, v64
    v_max3_f32 v64, |v30|, |v31|, v64
    v_cmp_lt_f32 vcc, 0x42f00000, v64
    s_mov_b32 s22, 4
    s_or_b32 s44, s44, vcc_lo
    s_or_b32 s44, s44, vcc_hi
    s_cmp_lg_u32 s44, 0
    s_cbranch_scc1 L_joint_kernel_tslow
    ds_read_b128 v[192:195], v249 offset:40960
    ds_read_b128 v[196:199], v249 offset:40976
    ds_read_b128 v[200:203], v249 offset:41024
    ds_read_b128 v[204:207], v249 offset:41040
    ds_read_b128 v[208:211], v249 offset:41088
    ds_read_b128 v[212:215], v249 offset:41104
    ds_read_b128 v[216:219], v249 offset:41152
    ds_read_b128 v[220:223], v249 offset:41168
    v_add_u32 v249, 1024, v249
    v_exp_f32 v0, v0
    v_exp_f32 v1, v1
    v_exp_f32 v2, v2
    v_exp_f32 v3, v3
    v_exp_f32 v4, v4
    v_exp_f32 v5, v5
    v_exp_f32 v6, v6
    v_exp_f32 v7, v7
    v_exp_f32 v8, v8
    v_exp_f32 v9, v9
    v_exp_f32 v10, v10
    v_exp_f32 v11, v11
    v_exp_f32 v12, v12
    v_exp_f32 v13, v13
    v_exp_f32 v14, v14
    v_exp_f32 v15, v15
    v_exp_f32 v16, v16
    v_exp_f32 v17, v17
    v_exp_f32 v18, v18
    v_exp_f32 v19, v19
    v_exp_f32 v20, v20
    v_exp_f32 v21, v21
    v_exp_f32 v22, v22
    v_exp_f32 v23, v23
    v_exp_f32 v24, v24
    v_exp_f32 v25, v25
    v_exp_f32 v26, v26
    v_exp_f32 v27, v27
    v_exp_f32 v28, v28
    v_exp_f32 v29, v29
    v_exp_f32 v30, v30
    v_exp_f32 v31, v31
    s_waitcnt lgkmcnt(0)
L_joint_kernel_tloop1:
    v_fma_f32 v32, v192, v0, 1.0
    v_fma_f32 v33, v193, v1, 1.0
    v_fma_f32 v34, v194, v2, 1.0
    v_fma_f32 v35, v195, v3, 1.0
    v_fma_f32 v36, v196, v4, 1.0
    v_fma_f32 v37, v197, v5, 1.0
    v_fma_f32 v38, v198, v6, 1.0
    v_fma_f32 v39, v199, v7, 1.0
    v_rcp_f32 v32, v32
    v_rcp_f32 v33, v33
    v_rcp_f32 v34, v34
    v_rcp_f32 v35, v35
    v_rcp_f32 v36, v36
    v_rcp_f32 v37, v37
    v_rcp_f32 v38, v38
    v_rcp_f32 v39, v39
    v_fma_f32 v32, v32, -2.0, 1.0
    v_fma_f32 v33, v33, -2.0, 1.0
    v_fma_f32 v34, v34, -2.0, 1.0
    v_fma_f32 v35, v35, -2.0, 1.0
    v_fma_f32 v36, v36, -2.0, 1.0
    v_fma_f32 v37, v37, -2.0, 1.0
    v_fma_f32 v38, v38, -2.0, 1.0
    v_fma_f32 v39, v39, -2.0, 1.0
    v_cvt_pk_bf16_f32 v224, v32, v33
    v_cvt_pk_bf16_f32 v225, v34, v35
    v_cvt_pk_bf16_f32 v226, v36, v37
    v_cvt_pk_bf16_f32 v227, v38, v39
    ds_write_b128 v248, v[224:227] offset:0
    v_fma_f32 v40, v200, v8, 1.0
    v_fma_f32 v41, v201, v9, 1.0
    v_fma_f32 v42, v202, v10, 1.0
    v_fma_f32 v43, v203, v11, 1.0
    v_fma_f32 v44, v204, v12, 1.0
    v_fma_f32 v45, v205, v13, 1.0
    v_fma_f32 v46, v206, v14, 1.0
    v_fma_f32 v47, v207, v15, 1.0
    v_rcp_f32 v40, v40
    v_rcp_f32 v41, v41
    v_rcp_f32 v42, v42
    v_rcp_f32 v43, v43
    v_rcp_f32 v44, v44
    v_rcp_f32 v45, v45
    v_rcp_f32 v46, v46
    v_rcp_f32 v47, v47
    v_fma_f32 v40, v40, -2.0, 1.0
    v_fma_f32 v41, v41, -2.0, 1.0
    v_fma_f32 v42, v42, -2.0, 1.0
    v_fma_f32 v43, v43, -2.0, 1.0
    v_fma_f32 v44, v44, -2.0, 1.0
    v_fma_f32 v45, v45, -2.0, 1.0
    v_fma_f32 v46, v46, -2.0, 1.0
    v_fma_f32 v47, v47, -2.0, 1.0
    v_cvt_pk_bf16_f32 v228, v40, v41
    v_cvt_pk_bf16_f32 v229, v42, v43
    v_cvt_pk_bf16_f32 v230, v44, v45
    v_cvt_pk_bf16_f32 v231, v46, v47
    ds_write_b128 v248, v[228:231] offset:1024
    v_fma_f32 v48, v208, v16, 1.0
    v_fma_f32 v49, v209, v17, 1.0
    v_fma_f32 v50, v210, v18, 1.0
    v_fma_f32 v51, v211, v19, 1.0
    v_fma_f32 v52, v212, v20, 1.0
    v_fma_f32 v53, v213, v21, 1.0
    v_fma_f32 v54, v214, v22, 1.0
    v_fma_f32 v55, v215, v23, 1.0
    v_rcp_f32 v48, v48
    v_rcp_f32 v49, v49
    v_rcp_f32 v50, v50
    v_rcp_f32 v51, v51
    v_rcp_f32 v52, v52
    v_rcp_f32 v53, v53
    v_rcp_f32 v54, v54
    v_rcp_f32 v55, v55
    v_fma_f32 v48, v48, -2.0, 1.0
    v_fma_f32 v49, v49, -2.0, 1.0
    v_fma_f32 v50, v50, -2.0, 1.0
    v_fma_f32 v51, v51, -2.0, 1.0
    v_fma_f32 v52, v52, -2.0, 1.0
    v_fma_f32 v53, v53, -2.0, 1.0
    v_fma_f32 v54, v54, -2.0, 1.0
    v_fma_f32 v55, v55, -2.0, 1.0
    v_cvt_pk_bf16_f32 v232, v48, v49
    v_cvt_pk_bf16_f32 v233, v50, v51
    v_cvt_pk_bf16_f32 v234, v52, v53
    v_cvt_pk_bf16_f32 v235, v54, v55
    ds_write_b128 v248, v[232:235] offset:2048
    v_fma_f32 v56, v216, v24, 1.0
    v_fma_f32 v57, v217, v25, 1.0
    v_fma_f32 v58, v218, v26, 1.0
    v_fma_f32 v59, v219, v27, 1.0
    v_fma_f32 v60, v220, v28, 1.0
    v_fma_f32 v61, v221, v29, 1.0
    v_fma_f32 v62, v222, v30, 1.0
    v_fma_f32 v63, v223, v31, 1.0
    ds_read_b128 v[192:195], v249 offset:40960
    ds_read_b128 v[196:199], v249 offset:40976
    ds_read_b128 v[200:203], v249 offset:41024
    ds_read_b128 v[204:207], v249 offset:41040
    ds_read_b128 v[208:211], v249 offset:41088
    ds_read_b128 v[212:215], v249 offset:41104
    ds_read_b128 v[216:219], v249 offset:41152
    ds_read_b128 v[220:223], v249 offset:41168
    v_add_u32 v249, 1024, v249
    v_rcp_f32 v56, v56
    v_rcp_f32 v57, v57
    v_rcp_f32 v58, v58
    v_rcp_f32 v59, v59
    v_rcp_f32 v60, v60
    v_rcp_f32 v61, v61
    v_rcp_f32 v62, v62
    v_rcp_f32 v63, v63
    v_fma_f32 v56, v56, -2.0, 1.0
    v_fma_f32 v57, v57, -2.0, 1.0
    v_fma_f32 v58, v58, -2.0, 1.0
    v_fma_f32 v59, v59, -2.0, 1.0
    v_fma_f32 v60, v60, -2.0, 1.0
    v_fma_f32 v61, v61, -2.0, 1.0
    v_fma_f32 v62, v62, -2.0, 1.0
    v_fma_f32 v63, v63, -2.0, 1.0
    v_cvt_pk_bf16_f32 v236, v56, v57
    v_cvt_pk_bf16_f32 v237, v58, v59
    v_cvt_pk_bf16_f32 v238, v60, v61
    v_cvt_pk_bf16_f32 v239, v62, v63
    ds_write_b128 v248, v[236:239] offset:3072
    s_waitcnt lgkmcnt(0)
    s_barrier
    v_fma_f32 v32, v192, v0, 1.0
    v_fma_f32 v33, v193, v1, 1.0
    v_fma_f32 v34, v194, v2, 1.0
    v_fma_f32 v35, v195, v3, 1.0
    v_fma_f32 v36, v196, v4, 1.0
    v_fma_f32 v37, v197, v5, 1.0
    v_fma_f32 v38, v198, v6, 1.0
    v_fma_f32 v39, v199, v7, 1.0
    v_rcp_f32 v32, v32
    v_rcp_f32 v33, v33
    v_rcp_f32 v34, v34
    v_rcp_f32 v35, v35
    v_rcp_f32 v36, v36
    v_rcp_f32 v37, v37
    v_rcp_f32 v38, v38
    v_rcp_f32 v39, v39
    v_fma_f32 v32, v32, -2.0, 1.0
    v_fma_f32 v33, v33, -2.0, 1.0
    v_fma_f32 v34, v34, -2.0, 1.0
    v_fma_f32 v35, v35, -2.0, 1.0
    v_fma_f32 v36, v36, -2.0, 1.0
    v_fma_f32 v37, v37, -2.0, 1.0
    v_fma_f32 v38, v38, -2.0, 1.0
    v_fma_f32 v39, v39, -2.0, 1.0
    v_cvt_pk_bf16_f32 v224, v32, v33
    v_cvt_pk_bf16_f32 v225, v34, v35
    v_cvt_pk_bf16_f32 v226, v36, v37
    v_cvt_pk_bf16_f32 v227, v38, v39
    ds_write_b128 v248, v[224:227] offset:16384
    v_fma_f32 v40, v200, v8, 1.0
    v_fma_f32 v41, v201, v9, 1.0
    v_fma_f32 v42, v202, v10, 1.0
    v_fma_f32 v43, v203, v11, 1.0
    v_fma_f32 v44, v204, v12, 1.0
    v_fma_f32 v45, v205, v13, 1.0
    v_fma_f32 v46, v206, v14, 1.0
    v_fma_f32 v47, v207, v15, 1.0
    v_rcp_f32 v40, v40
    v_rcp_f32 v41, v41
    v_rcp_f32 v42, v42
    v_rcp_f32 v43, v43
    v_rcp_f32 v44, v44
    v_rcp_f32 v45, v45
    v_rcp_f32 v46, v46
    v_rcp_f32 v47, v47
    v_fma_f32 v40, v40, -2.0, 1.0
    v_fma_f32 v41, v41, -2.0, 1.0
    v_fma_f32 v42, v42, -2.0, 1.0
    v_fma_f32 v43, v43, -2.0, 1.0
    v_fma_f32 v44, v44, -2.0, 1.0
    v_fma_f32 v45, v45, -2.0, 1.0
    v_fma_f32 v46, v46, -2.0, 1.0
    v_fma_f32 v47, v47, -2.0, 1.0
    v_cvt_pk_bf16_f32 v228, v40, v41
    v_cvt_pk_bf16_f32 v229, v42, v43
    v_cvt_pk_bf16_f32 v230, v44, v45
    v_cvt_pk_bf16_f32 v231, v46, v47
    ds_write_b128 v248, v[228:231] offset:17408
    v_fma_f32 v48, v208, v16, 1.0
    v_fma_f32 v49, v209, v17, 1.0
    v_fma_f32 v50, v210, v18, 1.0
    v_fma_f32 v51, v211, v19, 1.0
    v_fma_f32 v52, v212, v20, 1.0
    v_fma_f32 v53, v213, v21, 1.0
    v_fma_f32 v54, v214, v22, 1.0
    v_fma_f32 v55, v215, v23, 1.0
    v_rcp_f32 v48, v48
    v_rcp_f32 v49, v49
    v_rcp_f32 v50, v50
    v_rcp_f32 v51, v51
    v_rcp_f32 v52, v52
    v_rcp_f32 v53, v53
    v_rcp_f32 v54, v54
    v_rcp_f32 v55, v55
    v_fma_f32 v48, v48, -2.0, 1.0
    v_fma_f32 v49, v49, -2.0, 1.0
    v_fma_f32 v50, v50, -2.0, 1.0
    v_fma_f32 v51, v51, -2.0, 1.0
    v_fma_f32 v52, v52, -2.0, 1.0
    v_fma_f32 v53, v53, -2.0, 1.0
    v_fma_f32 v54, v54, -2.0, 1.0
    v_fma_f32 v55, v55, -2.0, 1.0
    v_cvt_pk_bf16_f32 v232, v48, v49
    v_cvt_pk_bf16_f32 v233, v50, v51
    v_cvt_pk_bf16_f32 v234, v52, v53
    v_cvt_pk_bf16_f32 v235, v54, v55
    ds_write_b128 v248, v[232:235] offset:18432
    v_fma_f32 v56, v216, v24, 1.0
    v_fma_f32 v57, v217, v25, 1.0
    v_fma_f32 v58, v218, v26, 1.0
    v_fma_f32 v59, v219, v27, 1.0
    v_fma_f32 v60, v220, v28, 1.0
    v_fma_f32 v61, v221, v29, 1.0
    v_fma_f32 v62, v222, v30, 1.0
    v_fma_f32 v63, v223, v31, 1.0
    ds_read_b128 v[192:195], v249 offset:40960
    ds_read_b128 v[196:199], v249 offset:40976
    ds_read_b128 v[200:203], v249 offset:41024
    ds_read_b128 v[204:207], v249 offset:41040
    ds_read_b128 v[208:211], v249 offset:41088
    ds_read_b128 v[212:215], v249 offset:41104
    ds_read_b128 v[216:219], v249 offset:41152
    ds_read_b128 v[220:223], v249 offset:41168
    v_add_u32 v249, 1024, v249
    v_rcp_f32 v56, v56
    v_rcp_f32 v57, v57
    v_rcp_f32 v58, v58
    v_rcp_f32 v59, v59
    v_rcp_f32 v60, v60
    v_rcp_f32 v61, v61
    v_rcp_f32 v62, v62
    v_rcp_f32 v63, v63
    v_fma_f32 v56, v56, -2.0, 1.0
    v_fma_f32 v57, v57, -2.0, 1.0
    v_fma_f32 v58, v58, -2.0, 1.0
    v_fma_f32 v59, v59, -2.0, 1.0
    v_fma_f32 v60, v60, -2.0, 1.0
    v_fma_f32 v61, v61, -2.0, 1.0
    v_fma_f32 v62, v62, -2.0, 1.0
    v_fma_f32 v63, v63, -2.0, 1.0
    v_cvt_pk_bf16_f32 v236, v56, v57
    v_cvt_pk_bf16_f32 v237, v58, v59
    v_cvt_pk_bf16_f32 v238, v60, v61
    v_cvt_pk_bf16_f32 v239, v62, v63
    ds_write_b128 v248, v[236:239] offset:19456
    s_waitcnt lgkmcnt(0)
    s_barrier
    s_sub_u32 s22, s22, 1
    s_cmp_lg_u32 s22, 0
    s_cbranch_scc1 L_joint_kernel_tloop1
    s_branch L_joint_kernel_fin
L_joint_kernel_tslow:
    ds_read_b128 v[192:195], v249 offset:32768
    ds_read_b128 v[196:199], v249 offset:32784
    ds_read_b128 v[200:203], v249 offset:32832
    ds_read_b128 v[204:207], v249 offset:32848
    ds_read_b128 v[208:211], v249 offset:32896
    ds_read_b128 v[212:215], v249 offset:32912
    ds_read_b128 v[216:219], v249 offset:32960
    ds_read_b128 v[220:223], v249 offset:32976
    v_add_u32 v249, 1024, v249
    s_waitcnt lgkmcnt(0)
L_joint_kernel_tloop0:
    v_add_f32 v32, v192, v0
    v_add_f32 v33, v193, v1
    v_add_f32 v34, v194, v2
    v_add_f32 v35, v195, v3
    v_add_f32 v36, v196, v4
    v_add_f32 v37, v197, v5
    v_add_f32 v38, v198, v6
    v_add_f32 v39, v199, v7
    v_exp_f32 v32, v32
    v_exp_f32 v33, v33
    v_exp_f32 v34, v34
    v_exp_f32 v35, v35
    v_exp_f32 v36, v36
    v_exp_f32 v37, v37
    v_exp_f32 v38, v38
    v_exp_f32 v39, v39
    v_add_f32 v32, 1.0, v32
    v_add_f32 v33, 1.0, v33
    v_add_f32 v34, 1.0, v34
    v_add_f32 v35, 1.0, v35
    v_add_f32 v36, 1.0, v36
    v_add_f32 v37, 1.0, v37
    v_add_f32 v38, 1.0, v38
    v_add_f32 v39, 1.0, v39
    v_rcp_f32 v32, v32
    v_rcp_f32 v33, v33
    v_rcp_f32 v34, v34
    v_rcp_f32 v35, v35
    v_rcp_f32 v36, v36
    v_rcp_f32 v37, v37
    v_rcp_f32 v38, v38
    v_rcp_f32 v39, v39
    v_fma_f32 v32, v32, -2.0, 1.0
    v_fma_f32 v33, v33, -2.0, 1.0
    v_fma_f32 v34, v34, -2.0, 1.0
    v_fma_f32 v35, v35, -2.0, 1.0
    v_fma_f32 v36, v36, -2.0, 1.0
    v_fma_f32 v37, v37, -2.0, 1.0
    v_fma_f32 v38, v38, -2.0, 1.0
    v_fma_f32 v39, v39, -2.0, 1.0
    v_cvt_pk_bf16_f32 v224, v32, v33
    v_cvt_pk_bf16_f32 v225, v34, v35
    v_cvt_pk_bf16_f32 v226, v36, v37
    v_cvt_pk_bf16_f32 v227, v38, v39
    ds_write_b128 v248, v[224:227] offset:0
    v_add_f32 v40, v200, v8
    v_add_f32 v41, v201, v9
    v_add_f32 v42, v202, v10
    v_add_f32 v43, v203, v11
    v_add_f32 v44, v204, v12
    v_add_f32 v45, v205, v13
    v_add_f32 v46, v206, v14
    v_add_f32 v47, v207, v15
    v_exp_f32 v40, v40
    v_exp_f32 v41, v41
    v_exp_f32 v42, v42
    v_exp_f32 v43, v43
    v_exp_f32 v44, v44
    v_exp_f32 v45, v45
    v_exp_f32 v46, v46
    v_exp_f32 v47, v47
    v_add_f32 v40, 1.0, v40
    v_add_f32 v41, 1.0, v41
    v_add_f32 v42, 1.0, v42
    v_add_f32 v43, 1.0, v43
    v_add_f32 v44, 1.0, v44
    v_add_f32 v45, 1.0, v45
    v_add_f32 v46, 1.0, v46
    v_add_f32 v47, 1.0, v47
    v_rcp_f32 v40, v40
    v_rcp_f32 v41, v41
    v_rcp_f32 v42, v42
    v_rcp_f32 v43, v43
    v_rcp_f32 v44, v44
    v_rcp_f32 v45, v45
    v_rcp_f32 v46, v46
    v_rcp_f32 v47, v47
    v_fma_f32 v40, v40, -2.0, 1.0
    v_fma_f32 v41, v41, -2.0, 1.0
    v_fma_f32 v42, v42, -2.0, 1.0
    v_fma_f32 v43, v43, -2.0, 1.0
    v_fma_f32 v44, v44, -2.0, 1.0
    v_fma_f32 v45, v45, -2.0, 1.0
    v_fma_f32 v46, v46, -2.0, 1.0
    v_fma_f32 v47, v47, -2.0, 1.0
    v_cvt_pk_bf16_f32 v228, v40, v41
    v_cvt_pk_bf16_f32 v229, v42, v43
    v_cvt_pk_bf16_f32 v230, v44, v45
    v_cvt_pk_bf16_f32 v231, v46, v47
    ds_write_b128 v248, v[228:231] offset:1024
    v_add_f32 v48, v208, v16
    v_add_f32 v49, v209, v17
    v_add_f32 v50, v210, v18
    v_add_f32 v51, v211, v19
    v_add_f32 v52, v212, v20
    v_add_f32 v53, v213, v21
    v_add_f32 v54, v214, v22
    v_add_f32 v55, v215, v23
    v_exp_f32 v48, v48
    v_exp_f32 v49, v49
    v_exp_f32 v50, v50
    v_exp_f32 v51, v51
    v_exp_f32 v52, v52
    v_exp_f32 v53, v53
    v_exp_f32 v54, v54
    v_exp_f32 v55, v55
    v_add_f32 v48, 1.0, v48
    v_add_f32 v49, 1.0, v49
    v_add_f32 v50, 1.0, v50
    v_add_f32 v51, 1.0, v51
    v_add_f32 v52, 1.0, v52
    v_add_f32 v53, 1.0, v53
    v_add_f32 v54, 1.0, v54
    v_add_f32 v55, 1.0, v55
    v_rcp_f32 v48, v48
    v_rcp_f32 v49, v49
    v_rcp_f32 v50, v50
    v_rcp_f32 v51, v51
    v_rcp_f32 v52, v52
    v_rcp_f32 v53, v53
    v_rcp_f32 v54, v54
    v_rcp_f32 v55, v55
    v_fma_f32 v48, v48, -2.0, 1.0
    v_fma_f32 v49, v49, -2.0, 1.0
    v_fma_f32 v50, v50, -2.0, 1.0
    v_fma_f32 v51, v51, -2.0, 1.0
    v_fma_f32 v52, v52, -2.0, 1.0
    v_fma_f32 v53, v53, -2.0, 1.0
    v_fma_f32 v54, v54, -2.0, 1.0
    v_fma_f32 v55, v55, -2.0, 1.0
    v_cvt_pk_bf16_f32 v232, v48, v49
    v_cvt_pk_bf16_f32 v233, v50, v51
    v_cvt_pk_bf16_f32 v234, v52, v53
    v_cvt_pk_bf16_f32 v235, v54, v55
    ds_write_b128 v248, v[232:235] offset:2048
    v_add_f32 v56, v216, v24
    v_add_f32 v57, v217, v25
    v_add_f32 v58, v218, v26
    v_add_f32 v59, v219, v27
    v_add_f32 v60, v220, v28
    v_add_f32 v61, v221, v29
    v_add_f32 v62, v222, v30
    v_add_f32 v63, v223, v31
    ds_read_b128 v[192:195], v249 offset:32768
    ds_read_b128 v[196:199], v249 offset:32784
    ds_read_b128 v[200:203], v249 offset:32832
    ds_read_b128 v[204:207], v249 offset:32848
    ds_read_b128 v[208:211], v249 offset:32896
    ds_read_b128 v[212:215], v249 offset:32912
    ds_read_b128 v[216:219], v249 offset:32960
    ds_read_b128 v[220:223], v249 offset:32976
    v_add_u32 v249, 1024, v249
    v_exp_f32 v56, v56
    v_exp_f32 v57, v57
    v_exp_f32 v58, v58
    v_exp_f32 v59, v59
    v_exp_f32 v60, v60
    v_exp_f32 v61, v61
    v_exp_f32 v62, v62
    v_exp_f32 v63, v63
    v_add_f32 v56, 1.0, v56
    v_add_f32 v57, 1.0, v57
    v_add_f32 v58, 1.0, v58
    v_add_f32 v59, 1.0, v59
    v_add_f32 v60, 1.0, v60
    v_add_f32 v61, 1.0, v61
    v_add_f32 v62, 1.0, v62
    v_add_f32 v63, 1.0, v63
    v_rcp_f32 v56, v56
    v_rcp_f32 v57, v57
    v_rcp_f32 v58, v58
    v_rcp_f32 v59, v59
    v_rcp_f32 v60, v60
    v_rcp_f32 v61, v61
    v_rcp_f32 v62, v62
    v_rcp_f32 v63, v63
    v_fma_f32 v56, v56, -2.0, 1.0
    v_fma_f32 v57, v57, -2.0, 1.0
    v_fma_f32 v58, v58, -2.0, 1.0
    v_fma_f32 v59, v59, -2.0, 1.0
    v_fma_f32 v60, v60, -2.0, 1.0
    v_fma_f32 v61, v61, -2.0, 1.0
    v_fma_f32 v62, v62, -2.0, 1.0
    v_fma_f32 v63, v63, -2.0, 1.0
    v_cvt_pk_bf16_f32 v236, v56, v57
    v_cvt_pk_bf16_f32 v237, v58, v59
    v_cvt_pk_bf16_f32 v238, v60, v61
    v_cvt_pk_bf16_f32 v239, v62, v63
    ds_write_b128 v248, v[236:239] offset:3072
    s_waitcnt lgkmcnt(0)
    s_barrier
    v_add_f32 v32, v192, v0
    v_add_f32 v33, v193, v1
    v_add_f32 v34, v194, v2
    v_add_f32 v35, v195, v3
    v_add_f32 v36, v196, v4
    v_add_f32 v37, v197, v5
    v_add_f32 v38, v198, v6
    v_add_f32 v39, v199, v7
    v_exp_f32 v32, v32
    v_exp_f32 v33, v33
    v_exp_f32 v34, v34
    v_exp_f32 v35, v35
    v_exp_f32 v36, v36
    v_exp_f32 v37, v37
    v_exp_f32 v38, v38
    v_exp_f32 v39, v39
    v_add_f32 v32, 1.0, v32
    v_add_f32 v33, 1.0, v33
    v_add_f32 v34, 1.0, v34
    v_add_f32 v35, 1.0, v35
    v_add_f32 v36, 1.0, v36
    v_add_f32 v37, 1.0, v37
    v_add_f32 v38, 1.0, v38
    v_add_f32 v39, 1.0, v39
    v_rcp_f32 v32, v32
    v_rcp_f32 v33, v33
    v_rcp_f32 v34, v34
    v_rcp_f32 v35, v35
    v_rcp_f32 v36, v36
    v_rcp_f32 v37, v37
    v_rcp_f32 v38, v38
    v_rcp_f32 v39, v39
    v_fma_f32 v32, v32, -2.0, 1.0
    v_fma_f32 v33, v33, -2.0, 1.0
    v_fma_f32 v34, v34, -2.0, 1.0
    v_fma_f32 v35, v35, -2.0, 1.0
    v_fma_f32 v36, v36, -2.0, 1.0
    v_fma_f32 v37, v37, -2.0, 1.0
    v_fma_f32 v38, v38, -2.0, 1.0
    v_fma_f32 v39, v39, -2.0, 1.0
    v_cvt_pk_bf16_f32 v224, v32, v33
    v_cvt_pk_bf16_f32 v225, v34, v35
    v_cvt_pk_bf16_f32 v226, v36, v37
    v_cvt_pk_bf16_f32 v227, v38, v39
    ds_write_b128 v248, v[224:227] offset:16384
    v_add_f32 v40, v200, v8
    v_add_f32 v41, v201, v9
    v_add_f32 v42, v202, v10
    v_add_f32 v43, v203, v11
    v_add_f32 v44, v204, v12
    v_add_f32 v45, v205, v13
    v_add_f32 v46, v206, v14
    v_add_f32 v47, v207, v15
    v_exp_f32 v40, v40
    v_exp_f32 v41, v41
    v_exp_f32 v42, v42
    v_exp_f32 v43, v43
    v_exp_f32 v44, v44
    v_exp_f32 v45, v45
    v_exp_f32 v46, v46
    v_exp_f32 v47, v47
    v_add_f32 v40, 1.0, v40
    v_add_f32 v41, 1.0, v41
    v_add_f32 v42, 1.0, v42
    v_add_f32 v43, 1.0, v43
    v_add_f32 v44, 1.0, v44
    v_add_f32 v45, 1.0, v45
    v_add_f32 v46, 1.0, v46
    v_add_f32 v47, 1.0, v47
    v_rcp_f32 v40, v40
    v_rcp_f32 v41, v41
    v_rcp_f32 v42, v42
    v_rcp_f32 v43, v43
    v_rcp_f32 v44, v44
    v_rcp_f32 v45, v45
    v_rcp_f32 v46, v46
    v_rcp_f32 v47, v47
    v_fma_f32 v40, v40, -2.0, 1.0
    v_fma_f32 v41, v41, -2.0, 1.0
    v_fma_f32 v42, v42, -2.0, 1.0
    v_fma_f32 v43, v43, -2.0, 1.0
    v_fma_f32 v44, v44, -2.0, 1.0
    v_fma_f32 v45, v45, -2.0, 1.0
    v_fma_f32 v46, v46, -2.0, 1.0
    v_fma_f32 v47, v47, -2.0, 1.0
    v_cvt_pk_bf16_f32 v228, v40, v41
    v_cvt_pk_bf16_f32 v229, v42, v43
    v_cvt_pk_bf16_f32 v230, v44, v45
    v_cvt_pk_bf16_f32 v231, v46, v47
    ds_write_b128 v248, v[228:231] offset:17408
    v_add_f32 v48, v208, v16
    v_add_f32 v49, v209, v17
    v_add_f32 v50, v210, v18
    v_add_f32 v51, v211, v19
    v_add_f32 v52, v212, v20
    v_add_f32 v53, v213, v21
    v_add_f32 v54, v214, v22
    v_add_f32 v55, v215, v23
    v_exp_f32 v48, v48
    v_exp_f32 v49, v49
    v_exp_f32 v50, v50
    v_exp_f32 v51, v51
    v_exp_f32 v52, v52
    v_exp_f32 v53, v53
    v_exp_f32 v54, v54
    v_exp_f32 v55, v55
    v_add_f32 v48, 1.0, v48
    v_add_f32 v49, 1.0, v49
    v_add_f32 v50, 1.0, v50
    v_add_f32 v51, 1.0, v51
    v_add_f32 v52, 1.0, v52
    v_add_f32 v53, 1.0, v53
    v_add_f32 v54, 1.0, v54
    v_add_f32 v55, 1.0, v55
    v_rcp_f32 v48, v48
    v_rcp_f32 v49, v49
    v_rcp_f32 v50, v50
    v_rcp_f32 v51, v51
    v_rcp_f32 v52, v52
    v_rcp_f32 v53, v53
    v_rcp_f32 v54, v54
    v_rcp_f32 v55, v55
    v_fma_f32 v48, v48, -2.0, 1.0
    v_fma_f32 v49, v49, -2.0, 1.0
    v_fma_f32 v50, v50, -2.0, 1.0
    v_fma_f32 v51, v51, -2.0, 1.0
    v_fma_f32 v52, v52, -2.0, 1.0
    v_fma_f32 v53, v53, -2.0, 1.0
    v_fma_f32 v54, v54, -2.0, 1.0
    v_fma_f32 v55, v55, -2.0, 1.0
    v_cvt_pk_bf16_f32 v232, v48, v49
    v_cvt_pk_bf16_f32 v233, v50, v51
    v_cvt_pk_bf16_f32 v234, v52, v53
    v_cvt_pk_bf16_f32 v235, v54, v55
    ds_write_b128 v248, v[232:235] offset:18432
    v_add_f32 v56, v216, v24
    v_add_f32 v57, v217, v25
    v_add_f32 v58, v218, v26
    v_add_f32 v59, v219, v27
    v_add_f32 v60, v220, v28
    v_add_f32 v61, v221, v29
    v_add_f32 v62, v222, v30
    v_add_f32 v63, v223, v31
    ds_read_b128 v[192:195], v249 offset:32768
    ds_read_b128 v[196:199], v249 offset:32784
    ds_read_b128 v[200:203], v249 offset:32832
    ds_read_b128 v[204:207], v249 offset:32848
    ds_read_b128 v[208:211], v249 offset:32896
    ds_read_b128 v[212:215], v249 offset:32912
    ds_read_b128 v[216:219], v249 offset:32960
    ds_read_b128 v[220:223], v249 offset:32976
    v_add_u32 v249, 1024, v249
    v_exp_f32 v56, v56
    v_exp_f32 v57, v57
    v_exp_f32 v58, v58
    v_exp_f32 v59, v59
    v_exp_f32 v60, v60
    v_exp_f32 v61, v61
    v_exp_f32 v62, v62
    v_exp_f32 v63, v63
    v_add_f32 v56, 1.0, v56
    v_add_f32 v57, 1.0, v57
    v_add_f32 v58, 1.0, v58
    v_add_f32 v59, 1.0, v59
    v_add_f32 v60, 1.0, v60
    v_add_f32 v61, 1.0, v61
    v_add_f32 v62, 1.0, v62
    v_add_f32 v63, 1.0, v63
    v_rcp_f32 v56, v56
    v_rcp_f32 v57, v57
    v_rcp_f32 v58, v58
    v_rcp_f32 v59, v59
    v_rcp_f32 v60, v60
    v_rcp_f32 v61, v61
    v_rcp_f32 v62, v62
    v_rcp_f32 v63, v63
    v_fma_f32 v56, v56, -2.0, 1.0
    v_fma_f32 v57, v57, -2.0, 1.0
    v_fma_f32 v58, v58, -2.0, 1.0
    v_fma_f32 v59, v59, -2.0, 1.0
    v_fma_f32 v60, v60, -2.0, 1.0
    v_fma_f32 v61, v61, -2.0, 1.0
    v_fma_f32 v62, v62, -2.0, 1.0
    v_fma_f32 v63, v63, -2.0, 1.0
    v_cvt_pk_bf16_f32 v236, v56, v57
    v_cvt_pk_bf16_f32 v237, v58, v59
    v_cvt_pk_bf16_f32 v238, v60, v61
    v_cvt_pk_bf16_f32 v239, v62, v63
    ds_write_b128 v248, v[236:239] offset:19456
    s_waitcnt lgkmcnt(0)
    s_barrier
    s_sub_u32 s22, s22, 1
    s_cmp_lg_u32 s22, 0
    s_cbranch_scc1 L_joint_kernel_tloop0
L_joint_kernel_fin:
L_joint_kernel_done:
    s_endpgm
.section .rodata,"a"
.p2align 6
.amdhsa_kernel prep_kernel
  .amdhsa_next_free_vgpr 128
  .amdhsa_next_free_sgpr 102
  .amdhsa_accum_offset 128
  .amdhsa_group_segment_fixed_size 0
  .amdhsa_kernarg_size 80
  .amdhsa_user_sgpr_count 2
  .amdhsa_user_sgpr_kernarg_segment_ptr 1
  .amdhsa_system_sgpr_workgroup_id_x 1
.end_amdhsa_kernel
.p2align 6
.amdhsa_kernel conv1_kernel
  .amdhsa_next_free_vgpr 128
  .amdhsa_next_free_sgpr 102
  .amdhsa_accum_offset 128
  .amdhsa_group_segment_fixed_size 0
  .amdhsa_kernarg_size 80
  .amdhsa_user_sgpr_count 2
  .amdhsa_user_sgpr_kernarg_segment_ptr 1
  .amdhsa_system_sgpr_workgroup_id_x 1
.end_amdhsa_kernel
.p2align 6
.amdhsa_kernel conv2_kernel
  .amdhsa_next_free_vgpr 128
  .amdhsa_next_free_sgpr 102
  .amdhsa_accum_offset 128
  .amdhsa_group_segment_fixed_size 0
  .amdhsa_kernarg_size 80
  .amdhsa_user_sgpr_count 2
  .amdhsa_user_sgpr_kernarg_segment_ptr 1
  .amdhsa_system_sgpr_workgroup_id_x 1
.end_amdhsa_kernel
.p2align 6
.amdhsa_kernel joint_kernel
  .amdhsa_next_free_vgpr 256
  .amdhsa_next_free_sgpr 102
  .amdhsa_accum_offset 256
  .amdhsa_group_segment_fixed_size 0
  .amdhsa_kernarg_size 80
  .amdhsa_user_sgpr_count 2
  .amdhsa_user_sgpr_kernarg_segment_ptr 1
  .amdhsa_system_sgpr_workgroup_id_x 1
.end_amdhsa_kernel
```

```asm
; @launch kernel=prep_kernel grid=(268,1,1) block=(256,1,1) lds=32768
; @launch kernel=conv1_kernel grid=(256,1,1) block=(1024,1,1) lds=162816
; @launch kernel=conv2_kernel grid=(256,1,1) block=(1024,1,1) lds=162816
; @launch kernel=joint_kernel grid=(250,1,1) block=(512,1,1) lds=66048
.amdgcn_target "amdgcn-amd-amdhsa--gfx950"
.text
.globl prep_kernel
.p2align 8
.type prep_kernel,@function
prep_kernel:
    s_cmp_ge_u32 s2, 268
    s_cbranch_scc1 L_prep_kernel_done
    s_getpc_b64 s[62:63]
L_prep_kernel_pc:
    s_and_b32 s3, s2, 8
    s_lshl_b32 s3, s3, 12
    v_lshlrev_b32 v120, 7, v0
    v_add_u32 v120, s3, v120
    v_min_u32 v120, L_joint_kernel_done-L_prep_kernel_pc, v120
    v_mov_b32 v121, s63
    v_add_co_u32 v120, vcc, s62, v120
    v_addc_co_u32 v121, vcc, 0, v121, vcc
    global_load_dword v122, v[120:121], off
    s_cmp_lt_u32 s2, 12
    s_cbranch_scc1 L_prep_kernel_small
    s_sub_u32 s2, s2, 12
    v_readfirstlane_b32 s20, v0
    s_lshr_b32 s20, s20, 6
    s_lshl_b32 s21, s2, 2
    s_add_u32 s20, s20, s21
    v_and_b32 v1, 63, v0
    s_load_dwordx2 s[8:9], s[0:1], 8
    s_load_dwordx2 s[30:31], s[0:1], 72
    s_lshr_b32 s22, s20, 8
    s_bfe_u32 s23, s20, 0x40004
    s_bfe_u32 s24, s20, 0x30001
    s_and_b32 s21, s20, 1
    v_lshrrev_b32 v2, 4, v1
    v_lshlrev_b32 v2, 12, v2
    v_and_b32 v3, 15, v1
    v_lshl_add_u32 v2, v3, 2, v2
    s_lshl_b32 s26, s22, 3
    s_lshr_b32 s27, s23, 3
    s_add_u32 s26, s26, s27
    s_lshl_b32 s26, s26, 17
    s_and_b32 s27, s23, 7
    s_lshl_b32 s27, s27, 14
    s_add_u32 s26, s26, s27
    s_lshl_b32 s27, s24, 6
    s_add_u32 s26, s26, s27
    s_mov_b32 s10, 4063232
    s_mov_b32 s11, 0x00020000
    s_add_u32 s37, s26, 262144
    s_add_u32 s38, s26, 524288
    s_add_u32 s39, s26, 786432
    s_waitcnt lgkmcnt(0)
    buffer_load_dword v16, v2, s[8:11], s26 offen offset:0
    buffer_load_dword v17, v2, s[8:11], s26 offen offset:512
    buffer_load_dword v24, v2, s[8:11], s37 offen offset:0
    buffer_load_dword v25, v2, s[8:11], s37 offen offset:512
    buffer_load_dword v32, v2, s[8:11], s38 offen offset:0
    buffer_load_dword v33, v2, s[8:11], s38 offen offset:512
    buffer_load_dword v40, v2, s[8:11], s39 offen offset:0
    buffer_load_dword v41, v2, s[8:11], s39 offen offset:512
    buffer_load_dword v18, v2, s[8:11], s26 offen offset:1024
    buffer_load_dword v19, v2, s[8:11], s26 offen offset:1536
    buffer_load_dword v26, v2, s[8:11], s37 offen offset:1024
    buffer_load_dword v27, v2, s[8:11], s37 offen offset:1536
    buffer_load_dword v34, v2, s[8:11], s38 offen offset:1024
    buffer_load_dword v35, v2, s[8:11], s38 offen offset:1536
    buffer_load_dword v42, v2, s[8:11], s39 offen offset:1024
    buffer_load_dword v43, v2, s[8:11], s39 offen offset:1536
    buffer_load_dword v20, v2, s[8:11], s26 offen offset:2048
    buffer_load_dword v21, v2, s[8:11], s26 offen offset:2560
    buffer_load_dword v28, v2, s[8:11], s37 offen offset:2048
    buffer_load_dword v29, v2, s[8:11], s37 offen offset:2560
    buffer_load_dword v36, v2, s[8:11], s38 offen offset:2048
    buffer_load_dword v37, v2, s[8:11], s38 offen offset:2560
    buffer_load_dword v44, v2, s[8:11], s39 offen offset:2048
    buffer_load_dword v45, v2, s[8:11], s39 offen offset:2560
    buffer_load_dword v22, v2, s[8:11], s26 offen offset:3072
    buffer_load_dword v23, v2, s[8:11], s26 offen offset:3584
    buffer_load_dword v30, v2, s[8:11], s37 offen offset:3072
    buffer_load_dword v31, v2, s[8:11], s37 offen offset:3584
    buffer_load_dword v38, v2, s[8:11], s38 offen offset:3072
    buffer_load_dword v39, v2, s[8:11], s38 offen offset:3584
    buffer_load_dword v46, v2, s[8:11], s39 offen offset:3072
    buffer_load_dword v47, v2, s[8:11], s39 offen offset:3584
    s_add_u32 s12, s30, 0
    s_addc_u32 s13, s31, 0
    s_mov_b32 s14, 7340032
    s_mov_b32 s15, 0x00020000
    v_lshlrev_b32 v4, 4, v1
    s_lshl_b32 s27, s24, 4
    s_add_u32 s27, s27, s23
    s_mul_i32 s27, s27, 57344
    s_lshl_b32 s28, s22, 11
    s_add_u32 s27, s27, s28
    s_lshl_b32 s28, s21, 10
    s_add_u32 s27, s27, s28
    s_cmp_eq_u32 s21, 0
    s_mov_b32 s32, 0x07060302
    s_cselect_b32 s32, 0x05040100, s32
    s_mov_b32 s33, 0x03020c0c
    s_cselect_b32 s33, 0x01000c0c, s33
    s_mov_b32 s35, 0x3d2aaaab
    s_mov_b32 s36, 0x3c638e39
    s_waitcnt vmcnt(24)
    v_perm_b32 v72, v17, v16, s32
    v_perm_b32 v48, v41, v40, s32
    v_perm_b32 v76, v76, v40, s33
    v_perm_b32 v84, v84, v41, s33
    v_perm_b32 v77, v77, v32, s33
    v_perm_b32 v85, v85, v33, s33
    v_perm_b32 v78, v78, v24, s33
    v_perm_b32 v86, v86, v25, s33
    v_perm_b32 v79, v79, v16, s33
    v_perm_b32 v87, v87, v17, s33
    v_add_f32 v80, v76, v78
    v_add_f32 v88, v84, v86
    v_add_f32 v81, v77, v79
    v_add_f32 v89, v85, v87
    v_fma_f32 v82, v78, 4.0, v76
    v_fma_f32 v90, v86, 4.0, v84
    v_fma_f32 v83, v79, 4.0, v77
    v_fma_f32 v91, v87, 4.0, v85
    v_add_f32 v77, v80, v81
    v_add_f32 v85, v88, v89
    v_sub_f32 v78, v80, v81
    v_sub_f32 v86, v88, v89
    v_fma_f32 v79, v83, 2.0, v82
    v_fma_f32 v87, v91, 2.0, v90
    v_fma_f32 v82, v83, -2.0, v82
    v_fma_f32 v90, v91, -2.0, v90
    v_fmamk_f32 v80, v76, 0x41700000, v82
    v_fmamk_f32 v88, v84, 0x41700000, v90
    v_fmamk_f32 v80, v81, 0x41200000, v80
    v_fmamk_f32 v88, v89, 0x41200000, v88
    v_mul_f32 v77, 0.5, v77
    v_mul_f32 v85, 0.5, v85
    v_mul_f32 v78, 0.5, v78
    v_mul_f32 v86, 0.5, v86
    v_mul_f32 v79, s35, v79
    v_mul_f32 v87, s35, v87
    v_mul_f32 v82, s35, v82
    v_mul_f32 v90, s35, v90
    v_mul_f32 v80, s36, v80
    v_mul_f32 v88, s36, v88
    v_cvt_pk_bf16_f32 v52, v77, v85
    v_cvt_pk_bf16_f32 v56, v78, v86
    v_cvt_pk_bf16_f32 v60, v79, v87
    v_cvt_pk_bf16_f32 v64, v82, v90
    v_cvt_pk_bf16_f32 v68, v80, v88
    s_waitcnt vmcnt(16)
    v_perm_b32 v73, v19, v18, s32
    v_perm_b32 v49, v43, v42, s32
    v_perm_b32 v76, v76, v42, s33
    v_perm_b32 v84, v84, v43, s33
    v_perm_b32 v77, v77, v34, s33
    v_perm_b32 v85, v85, v35, s33
    v_perm_b32 v78, v78, v26, s33
    v_perm_b32 v86, v86, v27, s33
    v_perm_b32 v79, v79, v18, s33
    v_perm_b32 v87, v87, v19, s33
    v_add_f32 v80, v76, v78
    v_add_f32 v88, v84, v86
    v_add_f32 v81, v77, v79
    v_add_f32 v89, v85, v87
    v_fma_f32 v82, v78, 4.0, v76
    v_fma_f32 v90, v86, 4.0, v84
    v_fma_f32 v83, v79, 4.0, v77
    v_fma_f32 v91, v87, 4.0, v85
    v_add_f32 v77, v80, v81
    v_add_f32 v85, v88, v89
    v_sub_f32 v78, v80, v81
    v_sub_f32 v86, v88, v89
    v_fma_f32 v79, v83, 2.0, v82
    v_fma_f32 v87, v91, 2.0, v90
    v_fma_f32 v82, v83, -2.0, v82
    v_fma_f32 v90, v91, -2.0, v90
    v_fmamk_f32 v80, v76, 0x41700000, v82
    v_fmamk_f32 v88, v84, 0x41700000, v90
    v_fmamk_f32 v80, v81, 0x41200000, v80
    v_fmamk_f32 v88, v89, 0x41200000, v88
    v_mul_f32 v77, 0.5, v77
    v_mul_f32 v85, 0.5, v85
    v_mul_f32 v78, 0.5, v78
    v_mul_f32 v86, 0.5, v86
    v_mul_f32 v79, s35, v79
    v_mul_f32 v87, s35, v87
    v_mul_f32 v82, s35, v82
    v_mul_f32 v90, s35, v90
    v_mul_f32 v80, s36, v80
    v_mul_f32 v88, s36, v88
    v_cvt_pk_bf16_f32 v53, v77, v85
    v_cvt_pk_bf16_f32 v57, v78, v86
    v_cvt_pk_bf16_f32 v61, v79, v87
    v_cvt_pk_bf16_f32 v65, v82, v90
    v_cvt_pk_bf16_f32 v69, v80, v88
    s_waitcnt vmcnt(8)
    v_perm_b32 v74, v21, v20, s32
    v_perm_b32 v50, v45, v44, s32
    v_perm_b32 v76, v76, v44, s33
    v_perm_b32 v84, v84, v45, s33
    v_perm_b32 v77, v77, v36, s33
    v_perm_b32 v85, v85, v37, s33
    v_perm_b32 v78, v78, v28, s33
    v_perm_b32 v86, v86, v29, s33
    v_perm_b32 v79, v79, v20, s33
    v_perm_b32 v87, v87, v21, s33
    v_add_f32 v80, v76, v78
    v_add_f32 v88, v84, v86
    v_add_f32 v81, v77, v79
    v_add_f32 v89, v85, v87
    v_fma_f32 v82, v78, 4.0, v76
    v_fma_f32 v90, v86, 4.0, v84
    v_fma_f32 v83, v79, 4.0, v77
    v_fma_f32 v91, v87, 4.0, v85
    v_add_f32 v77, v80, v81
    v_add_f32 v85, v88, v89
    v_sub_f32 v78, v80, v81
    v_sub_f32 v86, v88, v89
    v_fma_f32 v79, v83, 2.0, v82
    v_fma_f32 v87, v91, 2.0, v90
    v_fma_f32 v82, v83, -2.0, v82
    v_fma_f32 v90, v91, -2.0, v90
    v_fmamk_f32 v80, v76, 0x41700000, v82
    v_fmamk_f32 v88, v84, 0x41700000, v90
    v_fmamk_f32 v80, v81, 0x41200000, v80
    v_fmamk_f32 v88, v89, 0x41200000, v88
    v_mul_f32 v77, 0.5, v77
    v_mul_f32 v85, 0.5, v85
    v_mul_f32 v78, 0.5, v78
    v_mul_f32 v86, 0.5, v86
    v_mul_f32 v79, s35, v79
    v_mul_f32 v87, s35, v87
    v_mul_f32 v82, s35, v82
    v_mul_f32 v90, s35, v90
    v_mul_f32 v80, s36, v80
    v_mul_f32 v88, s36, v88
    v_cvt_pk_bf16_f32 v54, v77, v85
    v_cvt_pk_bf16_f32 v58, v78, v86
    v_cvt_pk_bf16_f32 v62, v79, v87
    v_cvt_pk_bf16_f32 v66, v82, v90
    v_cvt_pk_bf16_f32 v70, v80, v88
    s_waitcnt vmcnt(0)
    v_perm_b32 v75, v23, v22, s32
    v_perm_b32 v51, v47, v46, s32
    v_perm_b32 v76, v76, v46, s33
    v_perm_b32 v84, v84, v47, s33
    v_perm_b32 v77, v77, v38, s33
    v_perm_b32 v85, v85, v39, s33
    v_perm_b32 v78, v78, v30, s33
    v_perm_b32 v86, v86, v31, s33
    v_perm_b32 v79, v79, v22, s33
    v_perm_b32 v87, v87, v23, s33
    v_add_f32 v80, v76, v78
    v_add_f32 v88, v84, v86
    v_add_f32 v81, v77, v79
    v_add_f32 v89, v85, v87
    v_fma_f32 v82, v78, 4.0, v76
    v_fma_f32 v90, v86, 4.0, v84
    v_fma_f32 v83, v79, 4.0, v77
    v_fma_f32 v91, v87, 4.0, v85
    v_add_f32 v77, v80, v81
    v_add_f32 v85, v88, v89
    v_sub_f32 v78, v80, v81
    v_sub_f32 v86, v88, v89
    v_fma_f32 v79, v83, 2.0, v82
    v_fma_f32 v87, v91, 2.0, v90
    v_fma_f32 v82, v83, -2.0, v82
    v_fma_f32 v90, v91, -2.0, v90
    v_fmamk_f32 v80, v76, 0x41700000, v82
    v_fmamk_f32 v88, v84, 0x41700000, v90
    v_fmamk_f32 v80, v81, 0x41200000, v80
    v_fmamk_f32 v88, v89, 0x41200000, v88
    v_mul_f32 v77, 0.5, v77
    v_mul_f32 v85, 0.5, v85
    v_mul_f32 v78, 0.5, v78
    v_mul_f32 v86, 0.5, v86
    v_mul_f32 v79, s35, v79
    v_mul_f32 v87, s35, v87
    v_mul_f32 v82, s35, v82
    v_mul_f32 v90, s35, v90
    v_mul_f32 v80, s36, v80
    v_mul_f32 v88, s36, v88
    v_cvt_pk_bf16_f32 v55, v77, v85
    v_cvt_pk_bf16_f32 v59, v78, v86
    v_cvt_pk_bf16_f32 v63, v79, v87
    v_cvt_pk_bf16_f32 v67, v82, v90
    v_cvt_pk_bf16_f32 v71, v80, v88
    s_add_u32 s28, s27, 49152
    buffer_store_dwordx4 v[72:75], v4, s[12:15], s28 offen sc1
    s_add_u32 s28, s27, 0
    buffer_store_dwordx4 v[48:51], v4, s[12:15], s28 offen sc1
    s_add_u32 s28, s27, 8192
    buffer_store_dwordx4 v[52:55], v4, s[12:15], s28 offen sc1
    s_add_u32 s28, s27, 16384
    buffer_store_dwordx4 v[56:59], v4, s[12:15], s28 offen sc1
    s_add_u32 s28, s27, 24576
    buffer_store_dwordx4 v[60:63], v4, s[12:15], s28 offen sc1
    s_add_u32 s28, s27, 32768
    buffer_store_dwordx4 v[64:67], v4, s[12:15], s28 offen sc1
    s_add_u32 s28, s27, 40960
    buffer_store_dwordx4 v[68:71], v4, s[12:15], s28 offen sc1
L_prep_kernel_done:
    s_endpgm
L_prep_kernel_small:
    s_load_dwordx4 s[4:7], s[0:1], 24
    s_load_dwordx4 s[36:39], s[0:1], 40
    s_load_dwordx2 s[30:31], s[0:1], 72
    v_readfirstlane_b32 s20, v0
    s_lshr_b32 s20, s20, 6
    s_lshr_b32 s21, s2, 2
    s_and_b32 s22, s2, 3
    v_and_b32 v1, 63, v0
    v_lshrrev_b32 v2, 5, v1
    v_and_b32 v3, 31, v1
    v_lshlrev_b32 v5, 12, v2
    v_lshl_add_u32 v5, v3, 2, v5
    s_lshl_b32 s23, s20, 15
    s_lshl_b32 s24, s22, 7
    s_add_u32 s23, s23, s24
    s_mov_b32 s32, 0x05040100
    s_mov_b32 s33, 0x07060302
    s_waitcnt lgkmcnt(0)
    s_cmp_eq_u32 s21, 1
    s_cselect_b32 s8, s38, s6
    s_cselect_b32 s9, s39, s7
    s_cmp_eq_u32 s21, 2
    s_cselect_b32 s8, s36, s8
    s_cselect_b32 s9, s37, s9
    s_mov_b32 s10, 131072
    s_mov_b32 s11, 0x00020000
    buffer_load_dword v16, v5, s[8:11], s23 offen offset:0
    buffer_load_dword v17, v5, s[8:11], s23 offen offset:512
    buffer_load_dword v18, v5, s[8:11], s23 offen offset:1024
    buffer_load_dword v19, v5, s[8:11], s23 offen offset:1536
    buffer_load_dword v20, v5, s[8:11], s23 offen offset:2048
    buffer_load_dword v21, v5, s[8:11], s23 offen offset:2560
    buffer_load_dword v22, v5, s[8:11], s23 offen offset:3072
    buffer_load_dword v23, v5, s[8:11], s23 offen offset:3584
    s_add_u32 s23, s23, 8192
    buffer_load_dword v24, v5, s[8:11], s23 offen offset:0
    buffer_load_dword v25, v5, s[8:11], s23 offen offset:512
    buffer_load_dword v26, v5, s[8:11], s23 offen offset:1024
    buffer_load_dword v27, v5, s[8:11], s23 offen offset:1536
    buffer_load_dword v28, v5, s[8:11], s23 offen offset:2048
    buffer_load_dword v29, v5, s[8:11], s23 offen offset:2560
    buffer_load_dword v30, v5, s[8:11], s23 offen offset:3072
    buffer_load_dword v31, v5, s[8:11], s23 offen offset:3584
    s_add_u32 s23, s23, 8192
    buffer_load_dword v32, v5, s[8:11], s23 offen offset:0
    buffer_load_dword v33, v5, s[8:11], s23 offen offset:512
    buffer_load_dword v34, v5, s[8:11], s23 offen offset:1024
    buffer_load_dword v35, v5, s[8:11], s23 offen offset:1536
    buffer_load_dword v36, v5, s[8:11], s23 offen offset:2048
    buffer_load_dword v37, v5, s[8:11], s23 offen offset:2560
    buffer_load_dword v38, v5, s[8:11], s23 offen offset:3072
    buffer_load_dword v39, v5, s[8:11], s23 offen offset:3584
    s_add_u32 s23, s23, 8192
    buffer_load_dword v40, v5, s[8:11], s23 offen offset:0
    buffer_load_dword v41, v5, s[8:11], s23 offen offset:512
    buffer_load_dword v42, v5, s[8:11], s23 offen offset:1024
    buffer_load_dword v43, v5, s[8:11], s23 offen offset:1536
    buffer_load_dword v44, v5, s[8:11], s23 offen offset:2048
    buffer_load_dword v45, v5, s[8:11], s23 offen offset:2560
    buffer_load_dword v46, v5, s[8:11], s23 offen offset:3072
    buffer_load_dword v47, v5, s[8:11], s23 offen offset:3584
    s_mov_b32 s16, s4
    s_mov_b32 s17, s5
    s_mov_b32 s18, 8192
    s_mov_b32 s19, 0x00020000
    v_lshlrev_b32 v6, 9, v3
    v_lshl_add_u32 v6, v2, 4, v6
    s_lshl_b32 s24, s20, 7
    buffer_load_dwordx4 v[80:83], v6, s[16:19], s24 offen offset:0
    buffer_load_dwordx4 v[84:87], v6, s[16:19], s24 offen offset:32
    buffer_load_dwordx4 v[88:91], v6, s[16:19], s24 offen offset:64
    buffer_load_dwordx4 v[92:95], v6, s[16:19], s24 offen offset:96
    s_lshl_b32 s24, s21, 17
    s_add_u32 s24, s24, 44040192
    s_add_u32 s12, s30, s24
    s_addc_u32 s13, s31, 0
    s_mov_b32 s14, 131072
    s_mov_b32 s15, 0x00020000
    s_waitcnt vmcnt(0)
    v_perm_b32 v48, v17, v16, s32
    v_perm_b32 v49, v19, v18, s32
    v_perm_b32 v50, v21, v20, s32
    v_perm_b32 v51, v23, v22, s32
    v_perm_b32 v52, v17, v16, s33
    v_perm_b32 v53, v19, v18, s33
    v_perm_b32 v54, v21, v20, s33
    v_perm_b32 v55, v23, v22, s33
    v_perm_b32 v56, v25, v24, s32
    v_perm_b32 v57, v27, v26, s32
    v_perm_b32 v58, v29, v28, s32
    v_perm_b32 v59, v31, v30, s32
    v_perm_b32 v60, v25, v24, s33
    v_perm_b32 v61, v27, v26, s33
    v_perm_b32 v62, v29, v28, s33
    v_perm_b32 v63, v31, v30, s33
    v_perm_b32 v64, v33, v32, s32
    v_perm_b32 v65, v35, v34, s32
    v_perm_b32 v66, v37, v36, s32
    v_perm_b32 v67, v39, v38, s32
    v_perm_b32 v68, v33, v32, s33
    v_perm_b32 v69, v35, v34, s33
    v_perm_b32 v70, v37, v36, s33
    v_perm_b32 v71, v39, v38, s33
    v_perm_b32 v72, v41, v40, s32
    v_perm_b32 v73, v43, v42, s32
    v_perm_b32 v74, v45, v44, s32
    v_perm_b32 v75, v47, v46, s32
    v_perm_b32 v76, v41, v40, s33
    v_perm_b32 v77, v43, v42, s33
    v_perm_b32 v78, v45, v44, s33
    v_perm_b32 v79, v47, v46, s33
    s_cmp_eq_u32 s21, 2
    s_cbranch_scc1 L_prep_kernel_ge
    v_lshlrev_b32 v4, 4, v1
    s_lshl_b32 s24, s22, 15
    s_lshl_b32 s25, s20, 13
    s_add_u32 s24, s24, s25
    s_add_u32 s25, s24, 4096
    buffer_store_dwordx4 v[48:51], v4, s[12:15], s24 offen offset:0
    buffer_store_dwordx4 v[52:55], v4, s[12:15], s24 offen offset:1024
    buffer_store_dwordx4 v[56:59], v4, s[12:15], s24 offen offset:2048
    buffer_store_dwordx4 v[60:63], v4, s[12:15], s24 offen offset:3072
    buffer_store_dwordx4 v[64:67], v4, s[12:15], s25 offen offset:0
    buffer_store_dwordx4 v[68:71], v4, s[12:15], s25 offen offset:1024
    buffer_store_dwordx4 v[72:75], v4, s[12:15], s25 offen offset:2048
    buffer_store_dwordx4 v[76:79], v4, s[12:15], s25 offen offset:3072
    s_endpgm
L_prep_kernel_ge:
    v_mfma_f32_32x32x16_bf16 v[96:111], v[48:51], v[80:83], 0
    v_mfma_f32_32x32x16_bf16 v[112:127], v[52:55], v[80:83], 0
    v_mfma_f32_32x32x16_bf16 v[96:111], v[56:59], v[84:87], v[96:111]
    v_mfma_f32_32x32x16_bf16 v[112:127], v[60:63], v[84:87], v[112:127]
    v_mfma_f32_32x32x16_bf16 v[96:111], v[64:67], v[88:91], v[96:111]
    v_mfma_f32_32x32x16_bf16 v[112:127], v[68:71], v[88:91], v[112:127]
    v_mfma_f32_32x32x16_bf16 v[96:111], v[72:75], v[92:95], v[96:111]
    v_mfma_f32_32x32x16_bf16 v[112:127], v[76:79], v[92:95], v[112:127]
    v_lshlrev_b32 v4, 4, v1
    s_lshl_b32 s24, s20, 13
    v_add_u32 v7, s24, v4
    s_nop 15
    ds_write_b128 v7, v[96:99] offset:0
    ds_write_b128 v7, v[100:103] offset:1024
    ds_write_b128 v7, v[104:107] offset:2048
    ds_write_b128 v7, v[108:111] offset:3072
    ds_write_b128 v7, v[112:115] offset:4096
    ds_write_b128 v7, v[116:119] offset:5120
    ds_write_b128 v7, v[120:123] offset:6144
    ds_write_b128 v7, v[124:127] offset:7168
    s_waitcnt lgkmcnt(0)
    s_barrier
    s_lshl_b32 s24, s20, 10
    v_add_u32 v7, s24, v4
    ds_read_b128 v[16:19], v7 offset:0
    ds_read_b128 v[20:23], v7 offset:4096
    ds_read_b128 v[24:27], v7 offset:8192
    ds_read_b128 v[28:31], v7 offset:12288
    ds_read_b128 v[32:35], v7 offset:16384
    ds_read_b128 v[36:39], v7 offset:20480
    ds_read_b128 v[40:43], v7 offset:24576
    ds_read_b128 v[44:47], v7 offset:28672
    s_mov_b32 s14, 16384
    v_lshlrev_b32 v8, 10, v3
    v_lshl_add_u32 v8, v2, 5, v8
    s_lshl_b32 s24, s22, 8
    s_lshl_b32 s25, s20, 6
    s_add_u32 s24, s24, s25
    s_mov_b32 s34, 0xffff0000
    s_mov_b32 s35, 0x4038aa3b
    s_waitcnt lgkmcnt(0)
    v_add_f32 v16, v16, v24
    v_add_f32 v16, v16, v32
    v_add_f32 v16, v16, v40
    v_add_f32 v17, v17, v25
    v_add_f32 v17, v17, v33
    v_add_f32 v17, v17, v41
    v_add_f32 v18, v18, v26
    v_add_f32 v18, v18, v34
    v_add_f32 v18, v18, v42
    v_add_f32 v19, v19, v27
    v_add_f32 v19, v19, v35
    v_add_f32 v19, v19, v43
    v_add_f32 v20, v20, v28
    v_add_f32 v20, v20, v36
    v_add_f32 v20, v20, v44
    v_add_f32 v21, v21, v29
    v_add_f32 v21, v21, v37
    v_add_f32 v21, v21, v45
    v_add_f32 v22, v22, v30
    v_add_f32 v22, v22, v38
    v_add_f32 v22, v22, v46
    v_add_f32 v23, v23, v31
    v_add_f32 v23, v23, v39
    v_add_f32 v23, v23, v47
    v_cvt_pk_bf16_f32 v48, v16, v20
    v_cvt_pk_bf16_f32 v49, v17, v21
    v_cvt_pk_bf16_f32 v50, v18, v22
    v_cvt_pk_bf16_f32 v51, v19, v23
    v_lshlrev_b32 v56, 16, v48
    v_and_b32 v57, s34, v48
    v_lshlrev_b32 v58, 16, v49
    v_and_b32 v59, s34, v49
    v_lshlrev_b32 v60, 16, v50
    v_and_b32 v61, s34, v50
    v_lshlrev_b32 v62, 16, v51
    v_and_b32 v63, s34, v51
    v_mul_f32 v56, s35, v56
    v_mul_f32 v57, s35, v57
    v_mul_f32 v58, s35, v58
    v_mul_f32 v59, s35, v59
    v_mul_f32 v60, s35, v60
    v_mul_f32 v61, s35, v61
    v_mul_f32 v62, s35, v62
    v_mul_f32 v63, s35, v63
    buffer_store_dwordx4 v[56:59], v8, s[12:15], s24 offen
    buffer_store_dwordx4 v[60:63], v8, s[12:15], s24 offen offset:16
    v_exp_f32 v64, v56
    v_exp_f32 v65, v57
    v_exp_f32 v66, v58
    v_exp_f32 v67, v59
    v_exp_f32 v68, v60
    v_exp_f32 v69, v61
    v_exp_f32 v70, v62
    v_exp_f32 v71, v63
    v_max3_f32 v72, |v56|, |v57|, |v58|
    v_max3_f32 v72, |v59|, |v60|, v72
    v_max3_f32 v72, |v61|, |v62|, v72
    v_max_f32 v72, |v63|, v72
    s_add_u32 s12, s12, 16384
    s_addc_u32 s13, s13, 0
    v_cmp_lt_f32 vcc, 0x42f00000, v72
    buffer_store_dwordx4 v[64:67], v8, s[12:15], s24 offen
    buffer_store_dwordx4 v[68:71], v8, s[12:15], s24 offen offset:16
    s_add_u32 s12, s12, 16384
    s_addc_u32 s13, s13, 0
    s_or_b32 s26, vcc_lo, vcc_hi
    s_lshr_b32 s24, s24, 4
    v_mov_b32 v73, s26
    v_mov_b32 v74, 0
    buffer_store_dword v73, v74, s[12:15], s24 offen
    s_endpgm
.globl conv1_kernel
.p2align 8
.type conv1_kernel,@function
conv1_kernel:
    s_cmp_ge_u32 s2, 256
    s_cbranch_scc1 L_conv1_kernel_done
    s_load_dwordx2 s[4:5], s[0:1], 0
    s_load_dwordx2 s[30:31], s[0:1], 72
    v_readfirstlane_b32 s20, v0
    s_lshr_b32 s20, s20, 6
    s_and_b32 s36, s2, 0
    s_lshl_b32 s36, s36, 3
    s_bfe_u32 s37, s2, 196611
    s_or_b32 s29, s36, s37
    s_bfe_u32 s36, s2, 196608
    s_lshl_b32 s36, s36, 2
    s_lshr_b32 s37, s2, 6
    s_or_b32 s36, s36, s37
    s_mov_b32 s33, 0
    s_and_b32 s34, s36, 15
    s_lshr_b32 s35, s36, 4
    s_mul_i32 s21, s34, 500
    s_and_b32 s32, s20, 3
    v_and_b32 v127, 63, v0
    v_lshrrev_b32 v5, 2, v127
    v_and_b32 v6, 3, v127
    v_lshlrev_b32 v7, 15, v5
    v_lshl_add_u32 v7, v6, 4, v7
    s_lshl_b32 s41, s21, 10
    s_lshl_b32 s37, s33, 9
    s_add_u32 s41, s41, s37
    s_sub_u32 s41, s41, 7680
    s_and_b32 s42, s20, 7
    s_lshl_b32 s37, s42, 12
    s_add_u32 s37, s37, s41
    v_add_u32 v7, s37, v7
    s_mul_i32 s36, s35, 8192000
    s_mov_b32 s10, 8192000
    s_mov_b32 s11, 0x00020000
    s_mov_b32 s25, 0xffff0000
    s_waitcnt lgkmcnt(0)
    s_add_u32 s8, s4, s36
    s_addc_u32 s9, s5, 0
    s_cmp_ge_u32 s20, 8
    s_cbranch_scc1 L_conv1_kernel_helper
    s_add_u32 s37, s41, 524288
    v_lshl_add_u32 v108, v127, 4, s37
    s_lshl_b32 s36, s29, 4
    s_lshl_b32 s37, s33, 3
    s_add_u32 s36, s36, s37
    s_mul_i32 s36, s36, 57344
    s_add_u32 s36, s36, 0
    s_add_u32 s12, s30, s36
    s_addc_u32 s13, s31, 0
    s_mov_b32 s14, 917504
    s_mov_b32 s15, 0x00020000
    s_mul_i32 s36, s35, 4096000
    s_add_u32 s36, s36, 18874368
    s_add_u32 s16, s30, s36
    s_addc_u32 s17, s31, 0
    s_mov_b32 s18, 4096000
    s_mov_b32 s19, 0x00020000
    v_and_b32 v10, 15, v127
    v_lshrrev_b32 v11, 4, v127
    v_add_u32 v8, 0, v10
    v_and_b32 v16, 4, v8
    v_lshrrev_b32 v16, 1, v16
    v_xor_b32 v16, v11, v16
    v_lshlrev_b32 v16, 4, v16
    v_lshl_add_u32 v8, v8, 6, v16
    v_add_u32 v9, 1, v10
    v_and_b32 v16, 4, v9
    v_lshrrev_b32 v16, 1, v16
    v_xor_b32 v16, v11, v16
    v_lshlrev_b32 v16, 4, v16
    v_lshl_add_u32 v9, v9, 6, v16
    s_lshr_b32 s38, s32, 1
    s_and_b32 s39, s32, 1
    s_add_u32 s40, s38, 4
    s_lshl_b32 s43, s39, 10
    s_cmp_lt_u32 s20, 4
    s_cselect_b32 s40, s20, s40
    s_cselect_b32 s36, 0, s43
    s_lshl_b32 s37, s40, 13
    s_add_u32 s37, s37, s36
    v_lshl_add_u32 v125, v127, 4, s37
    s_mul_i32 s37, s40, 16384
    v_add_u32 v120, s37, v8
    v_add_u32 v121, s37, v9
    s_lshl_b32 s37, s40, 10
    s_add_u32 s37, s37, 115712
    v_lshl_add_u32 v16, v11, 4, s37
    v_cmp_eq_u32 vcc, 15, v10
    v_mov_b32 v17, 8192
    v_mov_b32 v18, 4294959104
    v_mov_b32 v19, 64
    v_cndmask_b32 v122, v121, v16, vcc
    v_cndmask_b32 v123, v17, v19, vcc
    v_cndmask_b32 v124, v18, v19, vcc
    v_lshl_add_u32 v126, v127, 4, s37
    s_mov_b32 s44, 0x3f800000
    s_mov_b32 s45, 0x00000000
    s_mov_b32 s46, 0x00000000
    s_cmp_eq_u32 s40, 1
    s_cselect_b32 s45, 0x3f800000, s45
    s_cselect_b32 s46, 0x3f800000, s46
    s_cmp_eq_u32 s40, 2
    s_cselect_b32 s45, 0xbf800000, s45
    s_cselect_b32 s46, 0x3f800000, s46
    s_cmp_eq_u32 s40, 3
    s_cselect_b32 s45, 0x40000000, s45
    s_cselect_b32 s46, 0x40800000, s46
    s_cmp_eq_u32 s40, 4
    s_cselect_b32 s45, 0xc0000000, s45
    s_cselect_b32 s46, 0x40800000, s46
    s_cmp_eq_u32 s40, 5
    s_cselect_b32 s44, 0x41800000, s44
    s_cselect_b32 s45, 0x41000000, s45
    s_cselect_b32 s46, 0x40800000, s46
    s_cmp_ge_u32 s20, 4
    s_cbranch_scc1 L_conv1_kernel_m2
    v_mov_b32 v0, 0
    v_mov_b32 v1, 0
    v_mov_b32 v2, 0
    v_mov_b32 v3, 0
    v_mov_b32 v4, 0
    v_mov_b32 v5, 0
    v_mov_b32 v6, 0
    v_mov_b32 v7, 0
    v_mov_b32 v8, 0
    v_mov_b32 v9, 0
    v_mov_b32 v10, 0
    v_mov_b32 v11, 0
    v_mov_b32 v12, 0
    v_mov_b32 v13, 0
    v_mov_b32 v14, 0
    v_mov_b32 v15, 0
    v_mov_b32 v16, 0
    v_mov_b32 v17, 0
    v_mov_b32 v18, 0
    v_mov_b32 v19, 0
    v_mov_b32 v20, 0
    v_mov_b32 v21, 0
    v_mov_b32 v22, 0
    v_mov_b32 v23, 0
    v_mov_b32 v24, 0
    v_mov_b32 v25, 0
    v_mov_b32 v26, 0
    v_mov_b32 v27, 0
    v_mov_b32 v28, 0
    v_mov_b32 v29, 0
    v_mov_b32 v30, 0
    v_mov_b32 v31, 0
    v_mov_b32 v32, 0
    v_mov_b32 v33, 0
    v_mov_b32 v34, 0
    v_mov_b32 v35, 0
    v_mov_b32 v36, 0
    v_mov_b32 v37, 0
    v_mov_b32 v38, 0
    v_mov_b32 v39, 0
    v_mov_b32 v40, 0
    v_mov_b32 v41, 0
    v_mov_b32 v42, 0
    v_mov_b32 v43, 0
    v_mov_b32 v44, 0
    v_mov_b32 v45, 0
    v_mov_b32 v46, 0
    v_mov_b32 v47, 0
    v_mov_b32 v48, 0
    v_mov_b32 v49, 0
    v_mov_b32 v50, 0
    v_mov_b32 v51, 0
    v_mov_b32 v52, 0
    v_mov_b32 v53, 0
    v_mov_b32 v54, 0
    v_mov_b32 v55, 0
    v_mov_b32 v56, 0
    v_mov_b32 v57, 0
    v_mov_b32 v58, 0
    v_mov_b32 v59, 0
    v_mov_b32 v60, 0
    v_mov_b32 v61, 0
    v_mov_b32 v62, 0
    v_mov_b32 v63, 0
    s_barrier
    buffer_load_dwordx4 v[96:99], v108, s[8:11], 0 offen offset:0
    buffer_load_dwordx4 v[100:103], v108, s[8:11], 0 offen offset:1024
    buffer_load_dwordx4 v[104:107], v108, s[8:11], 0 offen offset:2048
    s_mov_b32 s23, 0
    s_mov_b32 s26, 4096
    buffer_load_dwordx4 v[64:67], v125, s[12:15], s23 offen offset:0
    buffer_load_dwordx4 v[68:71], v125, s[12:15], s23 offen offset:1024
    buffer_load_dwordx4 v[72:75], v125, s[12:15], s23 offen offset:2048
    buffer_load_dwordx4 v[76:79], v125, s[12:15], s23 offen offset:3072
    buffer_load_dwordx4 v[80:83], v125, s[12:15], s26 offen offset:0
    buffer_load_dwordx4 v[84:87], v125, s[12:15], s26 offen offset:1024
    buffer_load_dwordx4 v[88:91], v125, s[12:15], s26 offen offset:2048
    buffer_load_dwordx4 v[92:95], v125, s[12:15], s26 offen offset:3072
    s_mov_b32 s23, 57344
    s_mov_b32 s26, 61440
    s_waitcnt vmcnt(8)
    v_lshlrev_b32 v108, 16, v96
    v_and_b32 v111, s25, v96
    v_lshlrev_b32 v109, 16, v100
    v_and_b32 v112, s25, v100
    v_lshlrev_b32 v110, 16, v104
    v_and_b32 v113, s25, v104
    v_mul_f32 v114, s44, v108
    v_mul_f32 v115, s44, v111
    v_fmac_f32 v114, s45, v109
    v_fmac_f32 v115, s45, v112
    v_fmac_f32 v114, s46, v110
    v_fmac_f32 v115, s46, v113
    v_cvt_pk_bf16_f32 v96, v114, v115
    v_lshlrev_b32 v108, 16, v97
    v_and_b32 v111, s25, v97
    v_lshlrev_b32 v109, 16, v101
    v_and_b32 v112, s25, v101
    v_lshlrev_b32 v110, 16, v105
    v_and_b32 v113, s25, v105
    v_mul_f32 v114, s44, v108
    v_mul_f32 v115, s44, v111
    v_fmac_f32 v114, s45, v109
    v_fmac_f32 v115, s45, v112
    v_fmac_f32 v114, s46, v110
    v_fmac_f32 v115, s46, v113
    v_cvt_pk_bf16_f32 v97, v114, v115
    v_lshlrev_b32 v108, 16, v98
    v_and_b32 v111, s25, v98
    v_lshlrev_b32 v109, 16, v102
    v_and_b32 v112, s25, v102
    v_lshlrev_b32 v110, 16, v106
    v_and_b32 v113, s25, v106
    v_mul_f32 v114, s44, v108
    v_mul_f32 v115, s44, v111
    v_fmac_f32 v114, s45, v109
    v_fmac_f32 v115, s45, v112
    v_fmac_f32 v114, s46, v110
    v_fmac_f32 v115, s46, v113
    v_cvt_pk_bf16_f32 v98, v114, v115
    v_lshlrev_b32 v108, 16, v99
    v_and_b32 v111, s25, v99
    v_lshlrev_b32 v109, 16, v103
    v_and_b32 v112, s25, v103
    v_lshlrev_b32 v110, 16, v107
    v_and_b32 v113, s25, v107
    v_mul_f32 v114, s44, v108
    v_mul_f32 v115, s44, v111
    v_fmac_f32 v114, s45, v109
    v_fmac_f32 v115, s45, v112
    v_fmac_f32 v114, s46, v110
    v_fmac_f32 v115, s46, v113
    v_cvt_pk_bf16_f32 v99, v114, v115
    ds_write_b128 v126, v[96:99]
    s_waitcnt lgkmcnt(0)
    s_barrier
    s_mov_b32 s22, 8
    s_setprio 2
L_conv1_kernel_mloop1:
    ds_read_b128 v[96:99], v120 offset:0
    ds_read_b128 v[100:103], v120 offset:1024
    ds_read_b128 v[104:107], v120 offset:2048
    ds_read_b128 v[108:111], v120 offset:3072
    ds_read_b128 v[112:115], v120 offset:4096
    ds_read_b128 v[116:119], v120 offset:5120
    s_waitcnt vmcnt(6) lgkmcnt(5)
    v_mfma_f32_16x16x32_bf16 v[0:3], v[64:67], v[96:99], v[0:3]
    v_mfma_f32_16x16x32_bf16 v[32:35], v[68:71], v[96:99], v[32:35]
    ds_read_b128 v[96:99], v120 offset:6144
    s_waitcnt vmcnt(4) lgkmcnt(5)
    v_mfma_f32_16x16x32_bf16 v[4:7], v[64:67], v[100:103], v[4:7]
    v_mfma_f32_16x16x32_bf16 v[36:39], v[68:71], v[100:103], v[36:39]
    v_mfma_f32_16x16x32_bf16 v[0:3], v[72:75], v[100:103], v[0:3]
    v_mfma_f32_16x16x32_bf16 v[32:35], v[76:79], v[100:103], v[32:35]
    ds_read_b128 v[100:103], v120 offset:7168
    s_waitcnt vmcnt(2) lgkmcnt(5)
    v_mfma_f32_16x16x32_bf16 v[8:11], v[64:67], v[104:107], v[8:11]
    v_mfma_f32_16x16x32_bf16 v[40:43], v[68:71], v[104:107], v[40:43]
    v_mfma_f32_16x16x32_bf16 v[4:7], v[72:75], v[104:107], v[4:7]
    v_mfma_f32_16x16x32_bf16 v[36:39], v[76:79], v[104:107], v[36:39]
    v_mfma_f32_16x16x32_bf16 v[0:3], v[80:83], v[104:107], v[0:3]
    v_mfma_f32_16x16x32_bf16 v[32:35], v[84:87], v[104:107], v[32:35]
    ds_read_b128 v[104:107], v122 offset:0
    v_add_u32 v122, v123, v122
    s_waitcnt vmcnt(0) lgkmcnt(5)
    v_mfma_f32_16x16x32_bf16 v[12:15], v[64:67], v[108:111], v[12:15]
    v_mfma_f32_16x16x32_bf16 v[44:47], v[68:71], v[108:111], v[44:47]
    v_mfma_f32_16x16x32_bf16 v[8:11], v[72:75], v[108:111], v[8:11]
    v_mfma_f32_16x16x32_bf16 v[40:43], v[76:79], v[108:111], v[40:43]
    v_mfma_f32_16x16x32_bf16 v[4:7], v[80:83], v[108:111], v[4:7]
    v_mfma_f32_16x16x32_bf16 v[36:39], v[84:87], v[108:111], v[36:39]
    v_mfma_f32_16x16x32_bf16 v[0:3], v[88:91], v[108:111], v[0:3]
    v_mfma_f32_16x16x32_bf16 v[32:35], v[92:95], v[108:111], v[32:35]
    ds_read_b128 v[108:111], v121 offset:1024
    s_waitcnt lgkmcnt(5)
    v_mfma_f32_16x16x32_bf16 v[16:19], v[64:67], v[112:115], v[16:19]
    v_mfma_f32_16x16x32_bf16 v[48:51], v[68:71], v[112:115], v[48:51]
    v_mfma_f32_16x16x32_bf16 v[12:15], v[72:75], v[112:115], v[12:15]
    v_mfma_f32_16x16x32_bf16 v[44:47], v[76:79], v[112:115], v[44:47]
    v_mfma_f32_16x16x32_bf16 v[8:11], v[80:83], v[112:115], v[8:11]
    v_mfma_f32_16x16x32_bf16 v[40:43], v[84:87], v[112:115], v[40:43]
    v_mfma_f32_16x16x32_bf16 v[4:7], v[88:91], v[112:115], v[4:7]
    v_mfma_f32_16x16x32_bf16 v[36:39], v[92:95], v[112:115], v[36:39]
    ds_read_b128 v[112:115], v121 offset:2048
    s_waitcnt lgkmcnt(5)
    v_mfma_f32_16x16x32_bf16 v[20:23], v[64:67], v[116:119], v[20:23]
    v_mfma_f32_16x16x32_bf16 v[52:55], v[68:71], v[116:119], v[52:55]
    v_mfma_f32_16x16x32_bf16 v[16:19], v[72:75], v[116:119], v[16:19]
    v_mfma_f32_16x16x32_bf16 v[48:51], v[76:79], v[116:119], v[48:51]
    v_mfma_f32_16x16x32_bf16 v[12:15], v[80:83], v[116:119], v[12:15]
    v_mfma_f32_16x16x32_bf16 v[44:47], v[84:87], v[116:119], v[44:47]
    v_mfma_f32_16x16x32_bf16 v[8:11], v[88:91], v[116:119], v[8:11]
    v_mfma_f32_16x16x32_bf16 v[40:43], v[92:95], v[116:119], v[40:43]
    s_waitcnt lgkmcnt(4)
    v_mfma_f32_16x16x32_bf16 v[24:27], v[64:67], v[96:99], v[24:27]
    v_mfma_f32_16x16x32_bf16 v[56:59], v[68:71], v[96:99], v[56:59]
    v_mfma_f32_16x16x32_bf16 v[20:23], v[72:75], v[96:99], v[20:23]
    v_mfma_f32_16x16x32_bf16 v[52:55], v[76:79], v[96:99], v[52:55]
    v_mfma_f32_16x16x32_bf16 v[16:19], v[80:83], v[96:99], v[16:19]
    v_mfma_f32_16x16x32_bf16 v[48:51], v[84:87], v[96:99], v[48:51]
    v_mfma_f32_16x16x32_bf16 v[12:15], v[88:91], v[96:99], v[12:15]
    v_mfma_f32_16x16x32_bf16 v[44:47], v[92:95], v[96:99], v[44:47]
    s_waitcnt lgkmcnt(3)
    v_mfma_f32_16x16x32_bf16 v[28:31], v[64:67], v[100:103], v[28:31]
    v_mfma_f32_16x16x32_bf16 v[60:63], v[68:71], v[100:103], v[60:63]
    v_mfma_f32_16x16x32_bf16 v[24:27], v[72:75], v[100:103], v[24:27]
    v_mfma_f32_16x16x32_bf16 v[56:59], v[76:79], v[100:103], v[56:59]
    v_mfma_f32_16x16x32_bf16 v[20:23], v[80:83], v[100:103], v[20:23]
    v_mfma_f32_16x16x32_bf16 v[52:55], v[84:87], v[100:103], v[52:55]
    v_mfma_f32_16x16x32_bf16 v[16:19], v[88:91], v[100:103], v[16:19]
    v_mfma_f32_16x16x32_bf16 v[48:51], v[92:95], v[100:103], v[48:51]
    buffer_load_dwordx4 v[64:67], v125, s[12:15], s23 offen offset:0
    buffer_load_dwordx4 v[68:71], v125, s[12:15], s23 offen offset:1024
    s_waitcnt lgkmcnt(2)
    v_mfma_f32_16x16x32_bf16 v[28:31], v[72:75], v[104:107], v[28:31]
    v_mfma_f32_16x16x32_bf16 v[60:63], v[76:79], v[104:107], v[60:63]
    v_mfma_f32_16x16x32_bf16 v[24:27], v[80:83], v[104:107], v[24:27]
    v_mfma_f32_16x16x32_bf16 v[56:59], v[84:87], v[104:107], v[56:59]
    v_mfma_f32_16x16x32_bf16 v[20:23], v[88:91], v[104:107], v[20:23]
    v_mfma_f32_16x16x32_bf16 v[52:55], v[92:95], v[104:107], v[52:55]
    buffer_load_dwordx4 v[72:75], v125, s[12:15], s23 offen offset:2048
    buffer_load_dwordx4 v[76:79], v125, s[12:15], s23 offen offset:3072
    s_waitcnt lgkmcnt(1)
    v_mfma_f32_16x16x32_bf16 v[28:31], v[80:83], v[108:111], v[28:31]
    v_mfma_f32_16x16x32_bf16 v[60:63], v[84:87], v[108:111], v[60:63]
    v_mfma_f32_16x16x32_bf16 v[24:27], v[88:91], v[108:111], v[24:27]
    v_mfma_f32_16x16x32_bf16 v[56:59], v[92:95], v[108:111], v[56:59]
    buffer_load_dwordx4 v[80:83], v125, s[12:15], s26 offen offset:0
    buffer_load_dwordx4 v[84:87], v125, s[12:15], s26 offen offset:1024
    s_waitcnt lgkmcnt(0)
    v_mfma_f32_16x16x32_bf16 v[28:31], v[88:91], v[112:115], v[28:31]
    v_mfma_f32_16x16x32_bf16 v[60:63], v[92:95], v[112:115], v[60:63]
    buffer_load_dwordx4 v[88:91], v125, s[12:15], s26 offen offset:2048
    buffer_load_dwordx4 v[92:95], v125, s[12:15], s26 offen offset:3072
    s_add_u32 s23, s23, 57344
    s_add_u32 s26, s26, 57344
    s_barrier
    s_sub_u32 s22, s22, 1
    s_cmp_eq_u32 s22, 0
    s_cbranch_scc1 L_conv1_kernel_mlast1
    ds_read_b128 v[96:99], v120 offset:8192
    ds_read_b128 v[100:103], v120 offset:9216
    ds_read_b128 v[104:107], v120 offset:10240
    ds_read_b128 v[108:111], v120 offset:11264
    ds_read_b128 v[112:115], v120 offset:12288
    ds_read_b128 v[116:119], v120 offset:13312
    s_waitcnt vmcnt(6) lgkmcnt(5)
    v_mfma_f32_16x16x32_bf16 v[0:3], v[64:67], v[96:99], v[0:3]
    v_mfma_f32_16x16x32_bf16 v[32:35], v[68:71], v[96:99], v[32:35]
    ds_read_b128 v[96:99], v120 offset:14336
    s_waitcnt vmcnt(4) lgkmcnt(5)
    v_mfma_f32_16x16x32_bf16 v[4:7], v[64:67], v[100:103], v[4:7]
    v_mfma_f32_16x16x32_bf16 v[36:39], v[68:71], v[100:103], v[36:39]
    v_mfma_f32_16x16x32_bf16 v[0:3], v[72:75], v[100:103], v[0:3]
    v_mfma_f32_16x16x32_bf16 v[32:35], v[76:79], v[100:103], v[32:35]
    ds_read_b128 v[100:103], v120 offset:15360
    s_waitcnt vmcnt(2) lgkmcnt(5)
    v_mfma_f32_16x16x32_bf16 v[8:11], v[64:67], v[104:107], v[8:11]
    v_mfma_f32_16x16x32_bf16 v[40:43], v[68:71], v[104:107], v[40:43]
    v_mfma_f32_16x16x32_bf16 v[4:7], v[72:75], v[104:107], v[4:7]
    v_mfma_f32_16x16x32_bf16 v[36:39], v[76:79], v[104:107], v[36:39]
    v_mfma_f32_16x16x32_bf16 v[0:3], v[80:83], v[104:107], v[0:3]
    v_mfma_f32_16x16x32_bf16 v[32:35], v[84:87], v[104:107], v[32:35]
    ds_read_b128 v[104:107], v122 offset:0
    v_add_u32 v122, v124, v122
    s_waitcnt vmcnt(0) lgkmcnt(5)
    v_mfma_f32_16x16x32_bf16 v[12:15], v[64:67], v[108:111], v[12:15]
    v_mfma_f32_16x16x32_bf16 v[44:47], v[68:71], v[108:111], v[44:47]
    v_mfma_f32_16x16x32_bf16 v[8:11], v[72:75], v[108:111], v[8:11]
    v_mfma_f32_16x16x32_bf16 v[40:43], v[76:79], v[108:111], v[40:43]
    v_mfma_f32_16x16x32_bf16 v[4:7], v[80:83], v[108:111], v[4:7]
    v_mfma_f32_16x16x32_bf16 v[36:39], v[84:87], v[108:111], v[36:39]
    v_mfma_f32_16x16x32_bf16 v[0:3], v[88:91], v[108:111], v[0:3]
    v_mfma_f32_16x16x32_bf16 v[32:35], v[92:95], v[108:111], v[32:35]
    ds_read_b128 v[108:111], v121 offset:9216
    s_waitcnt lgkmcnt(5)
    v_mfma_f32_16x16x32_bf16 v[16:19], v[64:67], v[112:115], v[16:19]
    v_mfma_f32_16x16x32_bf16 v[48:51], v[68:71], v[112:115], v[48:51]
    v_mfma_f32_16x16x32_bf16 v[12:15], v[72:75], v[112:115], v[12:15]
    v_mfma_f32_16x16x32_bf16 v[44:47], v[76:79], v[112:115], v[44:47]
    v_mfma_f32_16x16x32_bf16 v[8:11], v[80:83], v[112:115], v[8:11]
    v_mfma_f32_16x16x32_bf16 v[40:43], v[84:87], v[112:115], v[40:43]
    v_mfma_f32_16x16x32_bf16 v[4:7], v[88:91], v[112:115], v[4:7]
    v_mfma_f32_16x16x32_bf16 v[36:39], v[92:95], v[112:115], v[36:39]
    ds_read_b128 v[112:115], v121 offset:10240
    s_waitcnt lgkmcnt(5)
    v_mfma_f32_16x16x32_bf16 v[20:23], v[64:67], v[116:119], v[20:23]
    v_mfma_f32_16x16x32_bf16 v[52:55], v[68:71], v[116:119], v[52:55]
    v_mfma_f32_16x16x32_bf16 v[16:19], v[72:75], v[116:119], v[16:19]
    v_mfma_f32_16x16x32_bf16 v[48:51], v[76:79], v[116:119], v[48:51]
    v_mfma_f32_16x16x32_bf16 v[12:15], v[80:83], v[116:119], v[12:15]
    v_mfma_f32_16x16x32_bf16 v[44:47], v[84:87], v[116:119], v[44:47]
    v_mfma_f32_16x16x32_bf16 v[8:11], v[88:91], v[116:119], v[8:11]
    v_mfma_f32_16x16x32_bf16 v[40:43], v[92:95], v[116:119], v[40:43]
    s_waitcnt lgkmcnt(4)
    v_mfma_f32_16x16x32_bf16 v[24:27], v[64:67], v[96:99], v[24:27]
    v_mfma_f32_16x16x32_bf16 v[56:59], v[68:71], v[96:99], v[56:59]
    v_mfma_f32_16x16x32_bf16 v[20:23], v[72:75], v[96:99], v[20:23]
    v_mfma_f32_16x16x32_bf16 v[52:55], v[76:79], v[96:99], v[52:55]
    v_mfma_f32_16x16x32_bf16 v[16:19], v[80:83], v[96:99], v[16:19]
    v_mfma_f32_16x16x32_bf16 v[48:51], v[84:87], v[96:99], v[48:51]
    v_mfma_f32_16x16x32_bf16 v[12:15], v[88:91], v[96:99], v[12:15]
    v_mfma_f32_16x16x32_bf16 v[44:47], v[92:95], v[96:99], v[44:47]
    s_waitcnt lgkmcnt(3)
    v_mfma_f32_16x16x32_bf16 v[28:31], v[64:67], v[100:103], v[28:31]
    v_mfma_f32_16x16x32_bf16 v[60:63], v[68:71], v[100:103], v[60:63]
    v_mfma_f32_16x16x32_bf16 v[24:27], v[72:75], v[100:103], v[24:27]
    v_mfma_f32_16x16x32_bf16 v[56:59], v[76:79], v[100:103], v[56:59]
    v_mfma_f32_16x16x32_bf16 v[20:23], v[80:83], v[100:103], v[20:23]
    v_mfma_f32_16x16x32_bf16 v[52:55], v[84:87], v[100:103], v[52:55]
    v_mfma_f32_16x16x32_bf16 v[16:19], v[88:91], v[100:103], v[16:19]
    v_mfma_f32_16x16x32_bf16 v[48:51], v[92:95], v[100:103], v[48:51]
    buffer_load_dwordx4 v[64:67], v125, s[12:15], s23 offen offset:0
    buffer_load_dwordx4 v[68:71], v125, s[12:15], s23 offen offset:1024
    s_waitcnt lgkmcnt(2)
    v_mfma_f32_16x16x32_bf16 v[28:31], v[72:75], v[104:107], v[28:31]
    v_mfma_f32_16x16x32_bf16 v[60:63], v[76:79], v[104:107], v[60:63]
    v_mfma_f32_16x16x32_bf16 v[24:27], v[80:83], v[104:107], v[24:27]
    v_mfma_f32_16x16x32_bf16 v[56:59], v[84:87], v[104:107], v[56:59]
    v_mfma_f32_16x16x32_bf16 v[20:23], v[88:91], v[104:107], v[20:23]
    v_mfma_f32_16x16x32_bf16 v[52:55], v[92:95], v[104:107], v[52:55]
    buffer_load_dwordx4 v[72:75], v125, s[12:15], s23 offen offset:2048
    buffer_load_dwordx4 v[76:79], v125, s[12:15], s23 offen offset:3072
    s_waitcnt lgkmcnt(1)
    v_mfma_f32_16x16x32_bf16 v[28:31], v[80:83], v[108:111], v[28:31]
    v_mfma_f32_16x16x32_bf16 v[60:63], v[84:87], v[108:111], v[60:63]
    v_mfma_f32_16x16x32_bf16 v[24:27], v[88:91], v[108:111], v[24:27]
    v_mfma_f32_16x16x32_bf16 v[56:59], v[92:95], v[108:111], v[56:59]
    buffer_load_dwordx4 v[80:83], v125, s[12:15], s26 offen offset:0
    buffer_load_dwordx4 v[84:87], v125, s[12:15], s26 offen offset:1024
    s_waitcnt lgkmcnt(0)
    v_mfma_f32_16x16x32_bf16 v[28:31], v[88:91], v[112:115], v[28:31]
    v_mfma_f32_16x16x32_bf16 v[60:63], v[92:95], v[112:115], v[60:63]
    buffer_load_dwordx4 v[88:91], v125, s[12:15], s26 offen offset:2048
    buffer_load_dwordx4 v[92:95], v125, s[12:15], s26 offen offset:3072
    s_add_u32 s23, s23, 57344
    s_add_u32 s26, s26, 57344
    s_barrier
    s_branch L_conv1_kernel_mloop1
L_conv1_kernel_mlast1:
    v_and_b32 v125, 15, v127
    v_and_b32 v126, 7, v127
    v_lshlrev_b32 v126, 4, v126
    v_lshl_add_u32 v125, v125, 7, v126
    v_lshrrev_b32 v126, 4, v127
    v_lshl_add_u32 v125, v126, 11, v125
    s_lshl_b32 s36, s20, 14
    s_add_u32 s37, s36, 8192
    v_add_u32 v126, s37, v125
    v_add_u32 v125, s36, v125
    ds_read_b128 v[96:99], v120 offset:8192
    ds_read_b128 v[100:103], v120 offset:9216
    ds_read_b128 v[104:107], v120 offset:10240
    ds_read_b128 v[108:111], v120 offset:11264
    ds_read_b128 v[112:115], v120 offset:12288
    ds_read_b128 v[116:119], v120 offset:13312
    s_waitcnt vmcnt(6) lgkmcnt(5)
    v_mfma_f32_16x16x32_bf16 v[0:3], v[64:67], v[96:99], v[0:3]
    v_mfma_f32_16x16x32_bf16 v[32:35], v[68:71], v[96:99], v[32:35]
    ds_read_b128 v[96:99], v120 offset:14336
    s_waitcnt vmcnt(4) lgkmcnt(5)
    v_mfma_f32_16x16x32_bf16 v[4:7], v[64:67], v[100:103], v[4:7]
    v_mfma_f32_16x16x32_bf16 v[36:39], v[68:71], v[100:103], v[36:39]
    v_mfma_f32_16x16x32_bf16 v[0:3], v[72:75], v[100:103], v[0:3]
    v_mfma_f32_16x16x32_bf16 v[32:35], v[76:79], v[100:103], v[32:35]
    ds_read_b128 v[100:103], v120 offset:15360
    s_waitcnt vmcnt(2) lgkmcnt(5)
    v_mfma_f32_16x16x32_bf16 v[8:11], v[64:67], v[104:107], v[8:11]
    v_mfma_f32_16x16x32_bf16 v[40:43], v[68:71], v[104:107], v[40:43]
    v_mfma_f32_16x16x32_bf16 v[4:7], v[72:75], v[104:107], v[4:7]
    v_mfma_f32_16x16x32_bf16 v[36:39], v[76:79], v[104:107], v[36:39]
    v_mfma_f32_16x16x32_bf16 v[0:3], v[80:83], v[104:107], v[0:3]
    v_mfma_f32_16x16x32_bf16 v[32:35], v[84:87], v[104:107], v[32:35]
    ds_read_b128 v[104:107], v122 offset:0
    s_waitcnt vmcnt(0) lgkmcnt(5)
    v_mfma_f32_16x16x32_bf16 v[12:15], v[64:67], v[108:111], v[12:15]
    v_mfma_f32_16x16x32_bf16 v[44:47], v[68:71], v[108:111], v[44:47]
    v_mfma_f32_16x16x32_bf16 v[8:11], v[72:75], v[108:111], v[8:11]
    v_mfma_f32_16x16x32_bf16 v[40:43], v[76:79], v[108:111], v[40:43]
    v_mfma_f32_16x16x32_bf16 v[4:7], v[80:83], v[108:111], v[4:7]
    v_mfma_f32_16x16x32_bf16 v[36:39], v[84:87], v[108:111], v[36:39]
    v_mfma_f32_16x16x32_bf16 v[0:3], v[88:91], v[108:111], v[0:3]
    v_mfma_f32_16x16x32_bf16 v[32:35], v[92:95], v[108:111], v[32:35]
    ds_read_b128 v[108:111], v121 offset:9216
    s_waitcnt lgkmcnt(5)
    v_mfma_f32_16x16x32_bf16 v[16:19], v[64:67], v[112:115], v[16:19]
    v_mfma_f32_16x16x32_bf16 v[48:51], v[68:71], v[112:115], v[48:51]
    v_mfma_f32_16x16x32_bf16 v[12:15], v[72:75], v[112:115], v[12:15]
    v_mfma_f32_16x16x32_bf16 v[44:47], v[76:79], v[112:115], v[44:47]
    v_mfma_f32_16x16x32_bf16 v[8:11], v[80:83], v[112:115], v[8:11]
    v_mfma_f32_16x16x32_bf16 v[40:43], v[84:87], v[112:115], v[40:43]
    v_mfma_f32_16x16x32_bf16 v[4:7], v[88:91], v[112:115], v[4:7]
    v_mfma_f32_16x16x32_bf16 v[36:39], v[92:95], v[112:115], v[36:39]
    ds_read_b128 v[112:115], v121 offset:10240
    v_xor_b32 v123, 0, v125
    ds_write_b128 v123, v[0:3]
    s_waitcnt lgkmcnt(6)
    v_mfma_f32_16x16x32_bf16 v[20:23], v[64:67], v[116:119], v[20:23]
    v_mfma_f32_16x16x32_bf16 v[52:55], v[68:71], v[116:119], v[52:55]
    v_mfma_f32_16x16x32_bf16 v[16:19], v[72:75], v[116:119], v[16:19]
    v_mfma_f32_16x16x32_bf16 v[48:51], v[76:79], v[116:119], v[48:51]
    v_mfma_f32_16x16x32_bf16 v[12:15], v[80:83], v[116:119], v[12:15]
    v_mfma_f32_16x16x32_bf16 v[44:47], v[84:87], v[116:119], v[44:47]
    v_mfma_f32_16x16x32_bf16 v[8:11], v[88:91], v[116:119], v[8:11]
    v_mfma_f32_16x16x32_bf16 v[40:43], v[92:95], v[116:119], v[40:43]
    v_xor_b32 v124, 16, v125
    ds_write_b128 v124, v[4:7]
    s_waitcnt lgkmcnt(2)
    v_mfma_f32_16x16x32_bf16 v[24:27], v[64:67], v[96:99], v[24:27]
    v_mfma_f32_16x16x32_bf16 v[56:59], v[68:71], v[96:99], v[56:59]
    v_mfma_f32_16x16x32_bf16 v[20:23], v[72:75], v[96:99], v[20:23]
    v_mfma_f32_16x16x32_bf16 v[52:55], v[76:79], v[96:99], v[52:55]
    v_mfma_f32_16x16x32_bf16 v[16:19], v[80:83], v[96:99], v[16:19]
    v_mfma_f32_16x16x32_bf16 v[48:51], v[84:87], v[96:99], v[48:51]
    v_mfma_f32_16x16x32_bf16 v[12:15], v[88:91], v[96:99], v[12:15]
    v_mfma_f32_16x16x32_bf16 v[44:47], v[92:95], v[96:99], v[44:47]
    v_xor_b32 v123, 32, v125
    ds_write_b128 v123, v[8:11]
    v_xor_b32 v124, 0, v126
    ds_write_b128 v124, v[32:35]
    v_mfma_f32_16x16x32_bf16 v[28:31], v[64:67], v[100:103], v[28:31]
    v_mfma_f32_16x16x32_bf16 v[60:63], v[68:71], v[100:103], v[60:63]
    v_mfma_f32_16x16x32_bf16 v[24:27], v[72:75], v[100:103], v[24:27]
    v_mfma_f32_16x16x32_bf16 v[56:59], v[76:79], v[100:103], v[56:59]
    v_mfma_f32_16x16x32_bf16 v[20:23], v[80:83], v[100:103], v[20:23]
    v_mfma_f32_16x16x32_bf16 v[52:55], v[84:87], v[100:103], v[52:55]
    v_mfma_f32_16x16x32_bf16 v[16:19], v[88:91], v[100:103], v[16:19]
    v_mfma_f32_16x16x32_bf16 v[48:51], v[92:95], v[100:103], v[48:51]
    v_xor_b32 v123, 16, v126
    ds_write_b128 v123, v[36:39]
    v_xor_b32 v124, 32, v126
    ds_write_b128 v124, v[40:43]
    v_mfma_f32_16x16x32_bf16 v[28:31], v[72:75], v[104:107], v[28:31]
    v_mfma_f32_16x16x32_bf16 v[60:63], v[76:79], v[104:107], v[60:63]
    v_mfma_f32_16x16x32_bf16 v[24:27], v[80:83], v[104:107], v[24:27]
    v_mfma_f32_16x16x32_bf16 v[56:59], v[84:87], v[104:107], v[56:59]
    v_mfma_f32_16x16x32_bf16 v[20:23], v[88:91], v[104:107], v[20:23]
    v_mfma_f32_16x16x32_bf16 v[52:55], v[92:95], v[104:107], v[52:55]
    v_xor_b32 v124, 48, v125
    ds_write_b128 v124, v[12:15]
    v_xor_b32 v123, 48, v126
    ds_write_b128 v123, v[44:47]
    v_mfma_f32_16x16x32_bf16 v[28:31], v[80:83], v[108:111], v[28:31]
    v_mfma_f32_16x16x32_bf16 v[60:63], v[84:87], v[108:111], v[60:63]
    v_mfma_f32_16x16x32_bf16 v[24:27], v[88:91], v[108:111], v[24:27]
    v_mfma_f32_16x16x32_bf16 v[56:59], v[92:95], v[108:111], v[56:59]
    v_xor_b32 v123, 64, v125
    ds_write_b128 v123, v[16:19]
    v_xor_b32 v124, 64, v126
    ds_write_b128 v124, v[48:51]
    v_mfma_f32_16x16x32_bf16 v[28:31], v[88:91], v[112:115], v[28:31]
    v_mfma_f32_16x16x32_bf16 v[60:63], v[92:95], v[112:115], v[60:63]
    v_xor_b32 v124, 80, v125
    ds_write_b128 v124, v[20:23]
    v_xor_b32 v123, 80, v126
    ds_write_b128 v123, v[52:55]
    s_nop 7
    v_xor_b32 v123, 96, v125
    ds_write_b128 v123, v[24:27]
    v_xor_b32 v124, 96, v126
    ds_write_b128 v124, v[56:59]
    v_xor_b32 v124, 112, v125
    ds_write_b128 v124, v[28:31]
    v_xor_b32 v123, 112, v126
    s_waitcnt lgkmcnt(8)
    ds_write_b128 v123, v[60:63]
    s_setprio 0
    s_branch L_conv1_kernel_epi
L_conv1_kernel_m2:
    s_mul_i32 s37, s38, 2176
    s_add_u32 s37, s37, 98304
    v_add_u32 v116, s37, v8
    v_add_u32 v118, s37, v9
    v_add_u32 v117, 104832, v8
    s_cmp_eq_u32 s38, 0
    s_cbranch_scc1 L_conv1_kernel_hh0
    v_add_u32 v117, 98304, v9
L_conv1_kernel_hh0:
    s_lshl_b32 s37, s38, 12
    s_add_u32 s37, s37, s43
    s_add_u32 s37, s37, 49152
    v_lshl_add_u32 v119, v127, 4, s37
    v_mov_b32 v0, 0
    v_mov_b32 v1, 0
    v_mov_b32 v2, 0
    v_mov_b32 v3, 0
    v_mov_b32 v4, 0
    v_mov_b32 v5, 0
    v_mov_b32 v6, 0
    v_mov_b32 v7, 0
    v_mov_b32 v8, 0
    v_mov_b32 v9, 0
    v_mov_b32 v10, 0
    v_mov_b32 v11, 0
    v_mov_b32 v12, 0
    v_mov_b32 v13, 0
    v_mov_b32 v14, 0
    v_mov_b32 v15, 0
    v_mov_b32 v16, 0
    v_mov_b32 v17, 0
    v_mov_b32 v18, 0
    v_mov_b32 v19, 0
    v_mov_b32 v20, 0
    v_mov_b32 v21, 0
    v_mov_b32 v22, 0
    v_mov_b32 v23, 0
    v_mov_b32 v24, 0
    v_mov_b32 v25, 0
    v_mov_b32 v26, 0
    v_mov_b32 v27, 0
    v_mov_b32 v28, 0
    v_mov_b32 v29, 0
    v_mov_b32 v30, 0
    v_mov_b32 v31, 0
    v_mov_b32 v32, 0
    v_mov_b32 v33, 0
    v_mov_b32 v34, 0
    v_mov_b32 v35, 0
    v_mov_b32 v36, 0
    v_mov_b32 v37, 0
    v_mov_b32 v38, 0
    v_mov_b32 v39, 0
    v_mov_b32 v40, 0
    v_mov_b32 v41, 0
    v_mov_b32 v42, 0
    v_mov_b32 v43, 0
    v_mov_b32 v44, 0
    v_mov_b32 v45, 0
    v_mov_b32 v46, 0
    v_mov_b32 v47, 0
    v_mov_b32 v48, 0
    v_mov_b32 v49, 0
    v_mov_b32 v50, 0
    v_mov_b32 v51, 0
    v_mov_b32 v52, 0
    v_mov_b32 v53, 0
    v_mov_b32 v54, 0
    v_mov_b32 v55, 0
    v_mov_b32 v56, 0
    v_mov_b32 v57, 0
    v_mov_b32 v58, 0
    v_mov_b32 v59, 0
    v_mov_b32 v60, 0
    v_mov_b32 v61, 0
    v_mov_b32 v62, 0
    v_mov_b32 v63, 0
    s_barrier
    buffer_load_dwordx4 v[96:99], v108, s[8:11], 0 offen offset:0
    buffer_load_dwordx4 v[100:103], v108, s[8:11], 0 offen offset:1024
    buffer_load_dwordx4 v[104:107], v108, s[8:11], 0 offen offset:2048
    s_mov_b32 s23, 0
    s_mov_b32 s26, 4096
    buffer_load_dwordx4 v[64:67], v125, s[12:15], s23 offen offset:0
    buffer_load_dwordx4 v[68:71], v125, s[12:15], s23 offen offset:2048
    buffer_load_dwordx4 v[80:83], v119, s[12:15], s23 offen offset:0
    buffer_load_dwordx4 v[72:75], v125, s[12:15], s26 offen offset:0
    buffer_load_dwordx4 v[84:87], v119, s[12:15], s23 offen offset:2048
    buffer_load_dwordx4 v[76:79], v125, s[12:15], s26 offen offset:2048
    s_mov_b32 s23, 57344
    s_mov_b32 s26, 61440
    s_waitcnt vmcnt(6)
    v_lshlrev_b32 v108, 16, v96
    v_and_b32 v111, s25, v96
    v_lshlrev_b32 v109, 16, v100
    v_and_b32 v112, s25, v100
    v_lshlrev_b32 v110, 16, v104
    v_and_b32 v113, s25, v104
    v_mul_f32 v114, s44, v108
    v_mul_f32 v115, s44, v111
    v_fmac_f32 v114, s45, v109
    v_fmac_f32 v115, s45, v112
    v_fmac_f32 v114, s46, v110
    v_fmac_f32 v115, s46, v113
    v_cvt_pk_bf16_f32 v96, v114, v115
    v_lshlrev_b32 v108, 16, v97
    v_and_b32 v111, s25, v97
    v_lshlrev_b32 v109, 16, v101
    v_and_b32 v112, s25, v101
    v_lshlrev_b32 v110, 16, v105
    v_and_b32 v113, s25, v105
    v_mul_f32 v114, s44, v108
    v_mul_f32 v115, s44, v111
    v_fmac_f32 v114, s45, v109
    v_fmac_f32 v115, s45, v112
    v_fmac_f32 v114, s46, v110
    v_fmac_f32 v115, s46, v113
    v_cvt_pk_bf16_f32 v97, v114, v115
    v_lshlrev_b32 v108, 16, v98
    v_and_b32 v111, s25, v98
    v_lshlrev_b32 v109, 16, v102
    v_and_b32 v112, s25, v102
    v_lshlrev_b32 v110, 16, v106
    v_and_b32 v113, s25, v106
    v_mul_f32 v114, s44, v108
    v_mul_f32 v115, s44, v111
    v_fmac_f32 v114, s45, v109
    v_fmac_f32 v115, s45, v112
    v_fmac_f32 v114, s46, v110
    v_fmac_f32 v115, s46, v113
    v_cvt_pk_bf16_f32 v98, v114, v115
    v_lshlrev_b32 v108, 16, v99
    v_and_b32 v111, s25, v99
    v_lshlrev_b32 v109, 16, v103
    v_and_b32 v112, s25, v103
    v_lshlrev_b32 v110, 16, v107
    v_and_b32 v113, s25, v107
    v_mul_f32 v114, s44, v108
    v_mul_f32 v115, s44, v111
    v_fmac_f32 v114, s45, v109
    v_fmac_f32 v115, s45, v112
    v_fmac_f32 v114, s46, v110
    v_fmac_f32 v115, s46, v113
    v_cvt_pk_bf16_f32 v99, v114, v115
    ds_write_b128 v126, v[96:99]
    v_and_b32 v126, 15, v127
    v_lshlrev_b32 v126, 2, v126
    v_add_u32 v126, 99328, v126
    ds_write_b32 v126, v0
    ds_write_b32 v126, v0 offset:8704
    s_waitcnt lgkmcnt(0)
    s_barrier
    s_mov_b32 s22, 8
    s_setprio 2
L_conv1_kernel_mloop2:
    ds_read_b128 v[88:91], v120 offset:0
    ds_read_b128 v[92:95], v120 offset:1024
    ds_read_b128 v[96:99], v116 offset:0
    ds_read_b128 v[100:103], v120 offset:2048
    ds_read_b128 v[104:107], v116 offset:1088
    ds_read_b128 v[108:111], v120 offset:3072
    ds_read_b128 v[112:115], v116 offset:2176
    s_waitcnt vmcnt(5) lgkmcnt(6)
    v_mfma_f32_16x16x32_bf16 v[0:3], v[64:67], v[88:91], v[0:3]
    ds_read_b128 v[88:91], v120 offset:4096
    s_waitcnt vmcnt(4) lgkmcnt(6)
    v_mfma_f32_16x16x32_bf16 v[4:7], v[64:67], v[92:95], v[4:7]
    v_mfma_f32_16x16x32_bf16 v[0:3], v[68:71], v[92:95], v[0:3]
    ds_read_b128 v[92:95], v116 offset:3264
    s_waitcnt vmcnt(3) lgkmcnt(6)
    v_mfma_f32_16x16x32_bf16 v[32:35], v[80:83], v[96:99], v[32:35]
    ds_read_b128 v[96:99], v120 offset:5120
    s_waitcnt vmcnt(2) lgkmcnt(6)
    v_mfma_f32_16x16x32_bf16 v[8:11], v[64:67], v[100:103], v[8:11]
    v_mfma_f32_16x16x32_bf16 v[4:7], v[68:71], v[100:103], v[4:7]
    v_mfma_f32_16x16x32_bf16 v[0:3], v[72:75], v[100:103], v[0:3]
    ds_read_b128 v[100:103], v116 offset:4352
    s_waitcnt vmcnt(1) lgkmcnt(6)
    v_mfma_f32_16x16x32_bf16 v[36:39], v[80:83], v[104:107], v[36:39]
    v_mfma_f32_16x16x32_bf16 v[32:35], v[84:87], v[104:107], v[32:35]
    ds_read_b128 v[104:107], v120 offset:6144
    s_waitcnt vmcnt(0) lgkmcnt(6)
    v_mfma_f32_16x16x32_bf16 v[12:15], v[64:67], v[108:111], v[12:15]
    v_mfma_f32_16x16x32_bf16 v[8:11], v[68:71], v[108:111], v[8:11]
    v_mfma_f32_16x16x32_bf16 v[4:7], v[72:75], v[108:111], v[4:7]
    v_mfma_f32_16x16x32_bf16 v[0:3], v[76:79], v[108:111], v[0:3]
    ds_read_b128 v[108:111], v116 offset:5440
    s_waitcnt lgkmcnt(6)
    v_mfma_f32_16x16x32_bf16 v[40:43], v[80:83], v[112:115], v[40:43]
    v_mfma_f32_16x16x32_bf16 v[36:39], v[84:87], v[112:115], v[36:39]
    ds_read_b128 v[112:115], v120 offset:7168
    s_waitcnt lgkmcnt(6)
    v_mfma_f32_16x16x32_bf16 v[16:19], v[64:67], v[88:91], v[16:19]
    v_mfma_f32_16x16x32_bf16 v[12:15], v[68:71], v[88:91], v[12:15]
    v_mfma_f32_16x16x32_bf16 v[8:11], v[72:75], v[88:91], v[8:11]
    v_mfma_f32_16x16x32_bf16 v[4:7], v[76:79], v[88:91], v[4:7]
    ds_read_b128 v[88:91], v117 offset:0
    s_waitcnt lgkmcnt(6)
    v_mfma_f32_16x16x32_bf16 v[44:47], v[80:83], v[92:95], v[44:47]
    v_mfma_f32_16x16x32_bf16 v[40:43], v[84:87], v[92:95], v[40:43]
    ds_read_b128 v[92:95], v122 offset:0
    v_add_u32 v122, v123, v122
    s_waitcnt lgkmcnt(6)
    v_mfma_f32_16x16x32_bf16 v[20:23], v[64:67], v[96:99], v[20:23]
    v_mfma_f32_16x16x32_bf16 v[16:19], v[68:71], v[96:99], v[16:19]
    v_mfma_f32_16x16x32_bf16 v[12:15], v[72:75], v[96:99], v[12:15]
    v_mfma_f32_16x16x32_bf16 v[8:11], v[76:79], v[96:99], v[8:11]
    ds_read_b128 v[96:99], v117 offset:1088
    s_waitcnt lgkmcnt(6)
    v_mfma_f32_16x16x32_bf16 v[48:51], v[80:83], v[100:103], v[48:51]
    v_mfma_f32_16x16x32_bf16 v[44:47], v[84:87], v[100:103], v[44:47]
    ds_read_b128 v[100:103], v121 offset:1024
    s_waitcnt lgkmcnt(6)
    v_mfma_f32_16x16x32_bf16 v[24:27], v[64:67], v[104:107], v[24:27]
    v_mfma_f32_16x16x32_bf16 v[20:23], v[68:71], v[104:107], v[20:23]
    v_mfma_f32_16x16x32_bf16 v[16:19], v[72:75], v[104:107], v[16:19]
    v_mfma_f32_16x16x32_bf16 v[12:15], v[76:79], v[104:107], v[12:15]
    ds_read_b128 v[104:107], v118 offset:0
    s_waitcnt lgkmcnt(6)
    v_mfma_f32_16x16x32_bf16 v[52:55], v[80:83], v[108:111], v[52:55]
    v_mfma_f32_16x16x32_bf16 v[48:51], v[84:87], v[108:111], v[48:51]
    ds_read_b128 v[108:111], v121 offset:2048
    s_waitcnt lgkmcnt(6)
    v_mfma_f32_16x16x32_bf16 v[28:31], v[64:67], v[112:115], v[28:31]
    v_mfma_f32_16x16x32_bf16 v[24:27], v[68:71], v[112:115], v[24:27]
    v_mfma_f32_16x16x32_bf16 v[20:23], v[72:75], v[112:115], v[20:23]
    v_mfma_f32_16x16x32_bf16 v[16:19], v[76:79], v[112:115], v[16:19]
    buffer_load_dwordx4 v[64:67], v125, s[12:15], s23 offen offset:0
    s_waitcnt lgkmcnt(5)
    v_mfma_f32_16x16x32_bf16 v[56:59], v[80:83], v[88:91], v[56:59]
    v_mfma_f32_16x16x32_bf16 v[52:55], v[84:87], v[88:91], v[52:55]
    s_waitcnt lgkmcnt(0)
    s_barrier
    v_mfma_f32_16x16x32_bf16 v[28:31], v[68:71], v[92:95], v[28:31]
    v_mfma_f32_16x16x32_bf16 v[24:27], v[72:75], v[92:95], v[24:27]
    v_mfma_f32_16x16x32_bf16 v[20:23], v[76:79], v[92:95], v[20:23]
    buffer_load_dwordx4 v[68:71], v125, s[12:15], s23 offen offset:2048
    v_mfma_f32_16x16x32_bf16 v[60:63], v[80:83], v[96:99], v[60:63]
    v_mfma_f32_16x16x32_bf16 v[56:59], v[84:87], v[96:99], v[56:59]
    buffer_load_dwordx4 v[80:83], v119, s[12:15], s23 offen offset:0
    v_mfma_f32_16x16x32_bf16 v[28:31], v[72:75], v[100:103], v[28:31]
    v_mfma_f32_16x16x32_bf16 v[24:27], v[76:79], v[100:103], v[24:27]
    buffer_load_dwordx4 v[72:75], v125, s[12:15], s26 offen offset:0
    v_mfma_f32_16x16x32_bf16 v[60:63], v[84:87], v[104:107], v[60:63]
    buffer_load_dwordx4 v[84:87], v119, s[12:15], s23 offen offset:2048
    v_mfma_f32_16x16x32_bf16 v[28:31], v[76:79], v[108:111], v[28:31]
    buffer_load_dwordx4 v[76:79], v125, s[12:15], s26 offen offset:2048
    s_add_u32 s23, s23, 57344
    s_add_u32 s26, s26, 57344
    s_sub_u32 s22, s22, 1
    s_cmp_eq_u32 s22, 0
    s_cbranch_scc1 L_conv1_kernel_mlast2
    ds_read_b128 v[88:91], v120 offset:8192
    ds_read_b128 v[92:95], v120 offset:9216
    ds_read_b128 v[96:99], v116 offset:8704
    ds_read_b128 v[100:103], v120 offset:10240
    ds_read_b128 v[104:107], v116 offset:9792
    ds_read_b128 v[108:111], v120 offset:11264
    ds_read_b128 v[112:115], v116 offset:10880
    s_waitcnt vmcnt(5) lgkmcnt(6)
    v_mfma_f32_16x16x32_bf16 v[0:3], v[64:67], v[88:91], v[0:3]
    ds_read_b128 v[88:91], v120 offset:12288
    s_waitcnt vmcnt(4) lgkmcnt(6)
    v_mfma_f32_16x16x32_bf16 v[4:7], v[64:67], v[92:95], v[4:7]
    v_mfma_f32_16x16x32_bf16 v[0:3], v[68:71], v[92:95], v[0:3]
    ds_read_b128 v[92:95], v116 offset:11968
    s_waitcnt vmcnt(3) lgkmcnt(6)
    v_mfma_f32_16x16x32_bf16 v[32:35], v[80:83], v[96:99], v[32:35]
    ds_read_b128 v[96:99], v120 offset:13312
    s_waitcnt vmcnt(2) lgkmcnt(6)
    v_mfma_f32_16x16x32_bf16 v[8:11], v[64:67], v[100:103], v[8:11]
    v_mfma_f32_16x16x32_bf16 v[4:7], v[68:71], v[100:103], v[4:7]
    v_mfma_f32_16x16x32_bf16 v[0:3], v[72:75], v[100:103], v[0:3]
    ds_read_b128 v[100:103], v116 offset:13056
    s_waitcnt vmcnt(1) lgkmcnt(6)
    v_mfma_f32_16x16x32_bf16 v[36:39], v[80:83], v[104:107], v[36:39]
    v_mfma_f32_16x16x32_bf16 v[32:35], v[84:87], v[104:107], v[32:35]
    ds_read_b128 v[104:107], v120 offset:14336
    s_waitcnt vmcnt(0) lgkmcnt(6)
    v_mfma_f32_16x16x32_bf16 v[12:15], v[64:67], v[108:111], v[12:15]
    v_mfma_f32_16x16x32_bf16 v[8:11], v[68:71], v[108:111], v[8:11]
    v_mfma_f32_16x16x32_bf16 v[4:7], v[72:75], v[108:111], v[4:7]
    v_mfma_f32_16x16x32_bf16 v[0:3], v[76:79], v[108:111], v[0:3]
    ds_read_b128 v[108:111], v116 offset:14144
    s_waitcnt lgkmcnt(6)
    v_mfma_f32_16x16x32_bf16 v[40:43], v[80:83], v[112:115], v[40:43]
    v_mfma_f32_16x16x32_bf16 v[36:39], v[84:87], v[112:115], v[36:39]
    ds_read_b128 v[112:115], v120 offset:15360
    s_waitcnt lgkmcnt(6)
    v_mfma_f32_16x16x32_bf16 v[16:19], v[64:67], v[88:91], v[16:19]
    v_mfma_f32_16x16x32_bf16 v[12:15], v[68:71], v[88:91], v[12:15]
    v_mfma_f32_16x16x32_bf16 v[8:11], v[72:75], v[88:91], v[8:11]
    v_mfma_f32_16x16x32_bf16 v[4:7], v[76:79], v[88:91], v[4:7]
    ds_read_b128 v[88:91], v117 offset:8704
    s_waitcnt lgkmcnt(6)
    v_mfma_f32_16x16x32_bf16 v[44:47], v[80:83], v[92:95], v[44:47]
    v_mfma_f32_16x16x32_bf16 v[40:43], v[84:87], v[92:95], v[40:43]
    ds_read_b128 v[92:95], v122 offset:0
    v_add_u32 v122, v124, v122
    s_waitcnt lgkmcnt(6)
    v_mfma_f32_16x16x32_bf16 v[20:23], v[64:67], v[96:99], v[20:23]
    v_mfma_f32_16x16x32_bf16 v[16:19], v[68:71], v[96:99], v[16:19]
    v_mfma_f32_16x16x32_bf16 v[12:15], v[72:75], v[96:99], v[12:15]
    v_mfma_f32_16x16x32_bf16 v[8:11], v[76:79], v[96:99], v[8:11]
    ds_read_b128 v[96:99], v117 offset:9792
    s_waitcnt lgkmcnt(6)
    v_mfma_f32_16x16x32_bf16 v[48:51], v[80:83], v[100:103], v[48:51]
    v_mfma_f32_16x16x32_bf16 v[44:47], v[84:87], v[100:103], v[44:47]
    ds_read_b128 v[100:103], v121 offset:9216
    s_waitcnt lgkmcnt(6)
    v_mfma_f32_16x16x32_bf16 v[24:27], v[64:67], v[104:107], v[24:27]
    v_mfma_f32_16x16x32_bf16 v[20:23], v[68:71], v[104:107], v[20:23]
    v_mfma_f32_16x16x32_bf16 v[16:19], v[72:75], v[104:107], v[16:19]
    v_mfma_f32_16x16x32_bf16 v[12:15], v[76:79], v[104:107], v[12:15]
    ds_read_b128 v[104:107], v118 offset:8704
    s_waitcnt lgkmcnt(6)
    v_mfma_f32_16x16x32_bf16 v[52:55], v[80:83], v[108:111], v[52:55]
    v_mfma_f32_16x16x32_bf16 v[48:51], v[84:87], v[108:111], v[48:51]
    ds_read_b128 v[108:111], v121 offset:10240
    s_waitcnt lgkmcnt(6)
    v_mfma_f32_16x16x32_bf16 v[28:31], v[64:67], v[112:115], v[28:31]
    v_mfma_f32_16x16x32_bf16 v[24:27], v[68:71], v[112:115], v[24:27]
    v_mfma_f32_16x16x32_bf16 v[20:23], v[72:75], v[112:115], v[20:23]
    v_mfma_f32_16x16x32_bf16 v[16:19], v[76:79], v[112:115], v[16:19]
    buffer_load_dwordx4 v[64:67], v125, s[12:15], s23 offen offset:0
    s_waitcnt lgkmcnt(5)
    v_mfma_f32_16x16x32_bf16 v[56:59], v[80:83], v[88:91], v[56:59]
    v_mfma_f32_16x16x32_bf16 v[52:55], v[84:87], v[88:91], v[52:55]
    s_waitcnt lgkmcnt(0)
    s_barrier
    v_mfma_f32_16x16x32_bf16 v[28:31], v[68:71], v[92:95], v[28:31]
    v_mfma_f32_16x16x32_bf16 v[24:27], v[72:75], v[92:95], v[24:27]
    v_mfma_f32_16x16x32_bf16 v[20:23], v[76:79], v[92:95], v[20:23]
    buffer_load_dwordx4 v[68:71], v125, s[12:15], s23 offen offset:2048
    v_mfma_f32_16x16x32_bf16 v[60:63], v[80:83], v[96:99], v[60:63]
    v_mfma_f32_16x16x32_bf16 v[56:59], v[84:87], v[96:99], v[56:59]
    buffer_load_dwordx4 v[80:83], v119, s[12:15], s23 offen offset:0
    v_mfma_f32_16x16x32_bf16 v[28:31], v[72:75], v[100:103], v[28:31]
    v_mfma_f32_16x16x32_bf16 v[24:27], v[76:79], v[100:103], v[24:27]
    buffer_load_dwordx4 v[72:75], v125, s[12:15], s26 offen offset:0
    v_mfma_f32_16x16x32_bf16 v[60:63], v[84:87], v[104:107], v[60:63]
    buffer_load_dwordx4 v[84:87], v119, s[12:15], s23 offen offset:2048
    v_mfma_f32_16x16x32_bf16 v[28:31], v[76:79], v[108:111], v[28:31]
    buffer_load_dwordx4 v[76:79], v125, s[12:15], s26 offen offset:2048
    s_add_u32 s23, s23, 57344
    s_add_u32 s26, s26, 57344
    s_branch L_conv1_kernel_mloop2
L_conv1_kernel_mlast2:
    v_and_b32 v125, 15, v127
    v_and_b32 v126, 7, v127
    v_lshlrev_b32 v126, 4, v126
    v_lshl_add_u32 v125, v125, 7, v126
    v_lshrrev_b32 v126, 4, v127
    v_lshl_add_u32 v125, v126, 11, v125
    s_mov_b32 s36, 65536
    s_cmp_eq_u32 s32, 1
    s_cselect_b32 s36, 121856, s36
    s_cmp_eq_u32 s32, 2
    s_cselect_b32 s36, 81920, s36
    s_cmp_eq_u32 s32, 3
    s_cselect_b32 s36, 130048, s36
    s_mov_b32 s37, 98304
    s_cmp_eq_u32 s32, 1
    s_cselect_b32 s37, 138240, s37
    s_cmp_eq_u32 s32, 2
    s_cselect_b32 s37, 146432, s37
    s_cmp_eq_u32 s32, 3
    s_cselect_b32 s37, 154624, s37
    v_add_u32 v126, s37, v125
    v_add_u32 v125, s36, v125
    ds_read_b128 v[88:91], v120 offset:8192
    ds_read_b128 v[92:95], v120 offset:9216
    ds_read_b128 v[96:99], v116 offset:8704
    ds_read_b128 v[100:103], v120 offset:10240
    ds_read_b128 v[104:107], v116 offset:9792
    ds_read_b128 v[108:111], v120 offset:11264
    ds_read_b128 v[112:115], v116 offset:10880
    s_waitcnt vmcnt(5) lgkmcnt(6)
    v_mfma_f32_16x16x32_bf16 v[0:3], v[64:67], v[88:91], v[0:3]
    ds_read_b128 v[88:91], v120 offset:12288
    s_waitcnt vmcnt(4) lgkmcnt(6)
    v_mfma_f32_16x16x32_bf16 v[4:7], v[64:67], v[92:95], v[4:7]
    v_mfma_f32_16x16x32_bf16 v[0:3], v[68:71], v[92:95], v[0:3]
    ds_read_b128 v[92:95], v116 offset:11968
    s_waitcnt vmcnt(3) lgkmcnt(6)
    v_mfma_f32_16x16x32_bf16 v[32:35], v[80:83], v[96:99], v[32:35]
    ds_read_b128 v[96:99], v120 offset:13312
    s_waitcnt vmcnt(2) lgkmcnt(6)
    v_mfma_f32_16x16x32_bf16 v[8:11], v[64:67], v[100:103], v[8:11]
    v_mfma_f32_16x16x32_bf16 v[4:7], v[68:71], v[100:103], v[4:7]
    v_mfma_f32_16x16x32_bf16 v[0:3], v[72:75], v[100:103], v[0:3]
    ds_read_b128 v[100:103], v116 offset:13056
    s_waitcnt vmcnt(1) lgkmcnt(6)
    v_mfma_f32_16x16x32_bf16 v[36:39], v[80:83], v[104:107], v[36:39]
    v_mfma_f32_16x16x32_bf16 v[32:35], v[84:87], v[104:107], v[32:35]
    ds_read_b128 v[104:107], v120 offset:14336
    s_waitcnt vmcnt(0) lgkmcnt(6)
    v_mfma_f32_16x16x32_bf16 v[12:15], v[64:67], v[108:111], v[12:15]
    v_mfma_f32_16x16x32_bf16 v[8:11], v[68:71], v[108:111], v[8:11]
    v_mfma_f32_16x16x32_bf16 v[4:7], v[72:75], v[108:111], v[4:7]
    v_mfma_f32_16x16x32_bf16 v[0:3], v[76:79], v[108:111], v[0:3]
    ds_read_b128 v[108:111], v116 offset:14144
    s_waitcnt lgkmcnt(6)
    v_mfma_f32_16x16x32_bf16 v[40:43], v[80:83], v[112:115], v[40:43]
    v_mfma_f32_16x16x32_bf16 v[36:39], v[84:87], v[112:115], v[36:39]
    ds_read_b128 v[112:115], v120 offset:15360
    s_waitcnt lgkmcnt(6)
    v_mfma_f32_16x16x32_bf16 v[16:19], v[64:67], v[88:91], v[16:19]
    v_mfma_f32_16x16x32_bf16 v[12:15], v[68:71], v[88:91], v[12:15]
    v_mfma_f32_16x16x32_bf16 v[8:11], v[72:75], v[88:91], v[8:11]
    v_mfma_f32_16x16x32_bf16 v[4:7], v[76:79], v[88:91], v[4:7]
    ds_read_b128 v[88:91], v117 offset:8704
    v_xor_b32 v124, 0, v126
    ds_write_b128 v124, v[32:35]
    s_waitcnt lgkmcnt(7)
    v_mfma_f32_16x16x32_bf16 v[44:47], v[80:83], v[92:95], v[44:47]
    v_mfma_f32_16x16x32_bf16 v[40:43], v[84:87], v[92:95], v[40:43]
    ds_read_b128 v[92:95], v122 offset:0
    v_xor_b32 v123, 0, v125
    ds_write_b128 v123, v[0:3]
    s_waitcnt lgkmcnt(8)
    v_mfma_f32_16x16x32_bf16 v[20:23], v[64:67], v[96:99], v[20:23]
    v_mfma_f32_16x16x32_bf16 v[16:19], v[68:71], v[96:99], v[16:19]
    v_mfma_f32_16x16x32_bf16 v[12:15], v[72:75], v[96:99], v[12:15]
    v_mfma_f32_16x16x32_bf16 v[8:11], v[76:79], v[96:99], v[8:11]
    ds_read_b128 v[96:99], v117 offset:9792
    v_xor_b32 v123, 16, v126
    ds_write_b128 v123, v[36:39]
    s_waitcnt lgkmcnt(9)
    v_mfma_f32_16x16x32_bf16 v[48:51], v[80:83], v[100:103], v[48:51]
    v_mfma_f32_16x16x32_bf16 v[44:47], v[84:87], v[100:103], v[44:47]
    ds_read_b128 v[100:103], v121 offset:9216
    v_xor_b32 v124, 16, v125
    ds_write_b128 v124, v[4:7]
    s_waitcnt lgkmcnt(10)
    v_mfma_f32_16x16x32_bf16 v[24:27], v[64:67], v[104:107], v[24:27]
    v_mfma_f32_16x16x32_bf16 v[20:23], v[68:71], v[104:107], v[20:23]
    v_mfma_f32_16x16x32_bf16 v[16:19], v[72:75], v[104:107], v[16:19]
    v_mfma_f32_16x16x32_bf16 v[12:15], v[76:79], v[104:107], v[12:15]
    ds_read_b128 v[104:107], v118 offset:8704
    v_xor_b32 v124, 32, v126
    ds_write_b128 v124, v[40:43]
    s_waitcnt lgkmcnt(11)
    v_mfma_f32_16x16x32_bf16 v[52:55], v[80:83], v[108:111], v[52:55]
    v_mfma_f32_16x16x32_bf16 v[48:51], v[84:87], v[108:111], v[48:51]
    ds_read_b128 v[108:111], v121 offset:10240
    v_xor_b32 v123, 32, v125
    ds_write_b128 v123, v[8:11]
    s_waitcnt lgkmcnt(12)
    v_mfma_f32_16x16x32_bf16 v[28:31], v[64:67], v[112:115], v[28:31]
    v_mfma_f32_16x16x32_bf16 v[24:27], v[68:71], v[112:115], v[24:27]
    v_mfma_f32_16x16x32_bf16 v[20:23], v[72:75], v[112:115], v[20:23]
    v_mfma_f32_16x16x32_bf16 v[16:19], v[76:79], v[112:115], v[16:19]
    v_xor_b32 v123, 48, v126
    ds_write_b128 v123, v[44:47]
    s_waitcnt lgkmcnt(12)
    v_mfma_f32_16x16x32_bf16 v[56:59], v[80:83], v[88:91], v[56:59]
    v_mfma_f32_16x16x32_bf16 v[52:55], v[84:87], v[88:91], v[52:55]
    v_xor_b32 v124, 48, v125
    ds_write_b128 v124, v[12:15]
    s_waitcnt lgkmcnt(11)
    v_mfma_f32_16x16x32_bf16 v[28:31], v[68:71], v[92:95], v[28:31]
    v_mfma_f32_16x16x32_bf16 v[24:27], v[72:75], v[92:95], v[24:27]
    v_mfma_f32_16x16x32_bf16 v[20:23], v[76:79], v[92:95], v[20:23]
    v_xor_b32 v124, 64, v126
    ds_write_b128 v124, v[48:51]
    s_waitcnt lgkmcnt(10)
    v_mfma_f32_16x16x32_bf16 v[60:63], v[80:83], v[96:99], v[60:63]
    v_mfma_f32_16x16x32_bf16 v[56:59], v[84:87], v[96:99], v[56:59]
    v_xor_b32 v123, 64, v125
    ds_write_b128 v123, v[16:19]
    s_waitcnt lgkmcnt(9)
    v_mfma_f32_16x16x32_bf16 v[28:31], v[72:75], v[100:103], v[28:31]
    v_mfma_f32_16x16x32_bf16 v[24:27], v[76:79], v[100:103], v[24:27]
    v_xor_b32 v123, 80, v126
    ds_write_b128 v123, v[52:55]
    s_waitcnt lgkmcnt(8)
    v_mfma_f32_16x16x32_bf16 v[60:63], v[84:87], v[104:107], v[60:63]
    v_xor_b32 v124, 80, v125
    ds_write_b128 v124, v[20:23]
    s_waitcnt lgkmcnt(7)
    v_mfma_f32_16x16x32_bf16 v[28:31], v[76:79], v[108:111], v[28:31]
    v_xor_b32 v124, 96, v126
    ds_write_b128 v124, v[56:59]
    s_nop 7
    v_xor_b32 v123, 96, v125
    ds_write_b128 v123, v[24:27]
    v_xor_b32 v123, 112, v126
    ds_write_b128 v123, v[60:63]
    v_xor_b32 v124, 112, v125
    ds_write_b128 v124, v[28:31]
    s_setprio 0
    s_branch L_conv1_kernel_epi
L_conv1_kernel_helper:
    s_setprio 3
    v_add_u32 v92, 0, v7
    v_add_u32 v93, 1024, v7
    v_add_u32 v94, 2048, v7
    v_add_u32 v95, 3072, v7
    v_and_b32 v76, 4, v5
    v_lshrrev_b32 v76, 1, v76
    v_xor_b32 v76, v6, v76
    v_lshlrev_b32 v76, 4, v76
    v_lshl_add_u32 v76, v5, 6, v76
    s_mov_b32 s24, 0
    buffer_load_dwordx4 v[0:3], v92, s[8:11], s24 offen offset:0
    buffer_load_dwordx4 v[16:19], v92, s[8:11], s24 offen offset:64
    v_add_u32 v92, 128, v92
    buffer_load_dwordx4 v[4:7], v93, s[8:11], s24 offen offset:0
    buffer_load_dwordx4 v[20:23], v93, s[8:11], s24 offen offset:64
    v_add_u32 v93, 128, v93
    buffer_load_dwordx4 v[8:11], v94, s[8:11], s24 offen offset:0
    buffer_load_dwordx4 v[24:27], v94, s[8:11], s24 offen offset:64
    v_add_u32 v94, 128, v94
    buffer_load_dwordx4 v[12:15], v95, s[8:11], s24 offen offset:0
    buffer_load_dwordx4 v[28:31], v95, s[8:11], s24 offen offset:64
    v_add_u32 v95, 128, v95
    s_barrier
    s_mul_i32 s36, s42, 1024
    v_add_u32 v96, s36, v76
    v_add_u32 v97, 65536, v96
    s_mul_i32 s36, s42, 1088
    s_add_u32 s36, s36, 98304
    v_add_u32 v98, s36, v76
    s_waitcnt vmcnt(0)
    s_mov_b32 s28, 0
    s_mov_b32 s22, 4
    s_cmp_ge_u32 s20, 12
    s_cbranch_scc1 L_conv1_kernel_h2
    ds_write_b128 v96, v[0:3] offset:0
    ds_write_b128 v98, v[12:15] offset:0
    v_lshlrev_b32 v76, 16, v0
    v_and_b32 v84, s25, v0
    v_lshlrev_b32 v77, 16, v4
    v_and_b32 v85, s25, v4
    v_lshlrev_b32 v78, 16, v8
    v_and_b32 v86, s25, v8
    v_lshlrev_b32 v79, 16, v12
    v_and_b32 v87, s25, v12
    v_add_f32 v80, v76, v78
    v_add_f32 v88, v84, v86
    v_add_f32 v81, v77, v79
    v_add_f32 v89, v85, v87
    v_fma_f32 v82, v78, 4.0, v76
    v_fma_f32 v90, v86, 4.0, v84
    v_fma_f32 v83, v79, 4.0, v77
    v_fma_f32 v91, v87, 4.0, v85
    v_add_f32 v77, v80, v81
    v_add_f32 v85, v88, v89
    v_sub_f32 v78, v80, v81
    v_sub_f32 v86, v88, v89
    v_fma_f32 v79, v83, 2.0, v82
    v_fma_f32 v87, v91, 2.0, v90
    v_fma_f32 v82, v83, -2.0, v82
    v_fma_f32 v90, v91, -2.0, v90
    v_fmamk_f32 v80, v76, 0x41700000, v82
    v_fmamk_f32 v88, v84, 0x41700000, v90
    v_fmamk_f32 v80, v81, 0x41200000, v80
    v_fmamk_f32 v88, v89, 0x41200000, v88
    v_cvt_pk_bf16_f32 v4, v77, v85
    v_cvt_pk_bf16_f32 v8, v78, v86
    v_cvt_pk_bf16_f32 v64, v79, v87
    v_cvt_pk_bf16_f32 v68, v82, v90
    v_cvt_pk_bf16_f32 v72, v80, v88
    v_lshlrev_b32 v76, 16, v1
    v_and_b32 v84, s25, v1
    v_lshlrev_b32 v77, 16, v5
    v_and_b32 v85, s25, v5
    v_lshlrev_b32 v78, 16, v9
    v_and_b32 v86, s25, v9
    v_lshlrev_b32 v79, 16, v13
    v_and_b32 v87, s25, v13
    v_add_f32 v80, v76, v78
    v_add_f32 v88, v84, v86
    v_add_f32 v81, v77, v79
    v_add_f32 v89, v85, v87
    v_fma_f32 v82, v78, 4.0, v76
    v_fma_f32 v90, v86, 4.0, v84
    v_fma_f32 v83, v79, 4.0, v77
    v_fma_f32 v91, v87, 4.0, v85
    v_add_f32 v77, v80, v81
    v_add_f32 v85, v88, v89
    v_sub_f32 v78, v80, v81
    v_sub_f32 v86, v88, v89
    v_fma_f32 v79, v83, 2.0, v82
    v_fma_f32 v87, v91, 2.0, v90
    v_fma_f32 v82, v83, -2.0, v82
    v_fma_f32 v90, v91, -2.0, v90
    v_fmamk_f32 v80, v76, 0x41700000, v82
    v_fmamk_f32 v88, v84, 0x41700000, v90
    v_fmamk_f32 v80, v81, 0x41200000, v80
    v_fmamk_f32 v88, v89, 0x41200000, v88
    v_cvt_pk_bf16_f32 v5, v77, v85
    v_cvt_pk_bf16_f32 v9, v78, v86
    v_cvt_pk_bf16_f32 v65, v79, v87
    v_cvt_pk_bf16_f32 v69, v82, v90
    v_cvt_pk_bf16_f32 v73, v80, v88
    v_lshlrev_b32 v76, 16, v2
    v_and_b32 v84, s25, v2
    v_lshlrev_b32 v77, 16, v6
    v_and_b32 v85, s25, v6
    v_lshlrev_b32 v78, 16, v10
    v_and_b32 v86, s25, v10
    v_lshlrev_b32 v79, 16, v14
    v_and_b32 v87, s25, v14
    v_add_f32 v80, v76, v78
    v_add_f32 v88, v84, v86
    v_add_f32 v81, v77, v79
    v_add_f32 v89, v85, v87
    v_fma_f32 v82, v78, 4.0, v76
    v_fma_f32 v90, v86, 4.0, v84
    v_fma_f32 v83, v79, 4.0, v77
    v_fma_f32 v91, v87, 4.0, v85
    v_add_f32 v77, v80, v81
    v_add_f32 v85, v88, v89
    v_sub_f32 v78, v80, v81
    v_sub_f32 v86, v88, v89
    v_fma_f32 v79, v83, 2.0, v82
    v_fma_f32 v87, v91, 2.0, v90
    v_fma_f32 v82, v83, -2.0, v82
    v_fma_f32 v90, v91, -2.0, v90
    v_fmamk_f32 v80, v76, 0x41700000, v82
    v_fmamk_f32 v88, v84, 0x41700000, v90
    v_fmamk_f32 v80, v81, 0x41200000, v80
    v_fmamk_f32 v88, v89, 0x41200000, v88
    v_cvt_pk_bf16_f32 v6, v77, v85
    v_cvt_pk_bf16_f32 v10, v78, v86
    v_cvt_pk_bf16_f32 v66, v79, v87
    v_cvt_pk_bf16_f32 v70, v82, v90
    v_cvt_pk_bf16_f32 v74, v80, v88
    v_lshlrev_b32 v76, 16, v3
    v_and_b32 v84, s25, v3
    v_lshlrev_b32 v77, 16, v7
    v_and_b32 v85, s25, v7
    v_lshlrev_b32 v78, 16, v11
    v_and_b32 v86, s25, v11
    v_lshlrev_b32 v79, 16, v15
    v_and_b32 v87, s25, v15
    v_add_f32 v80, v76, v78
    v_add_f32 v88, v84, v86
    v_add_f32 v81, v77, v79
    v_add_f32 v89, v85, v87
    v_fma_f32 v82, v78, 4.0, v76
    v_fma_f32 v90, v86, 4.0, v84
    v_fma_f32 v83, v79, 4.0, v77
    v_fma_f32 v91, v87, 4.0, v85
    v_add_f32 v77, v80, v81
    v_add_f32 v85, v88, v89
    v_sub_f32 v78, v80, v81
    v_sub_f32 v86, v88, v89
    v_fma_f32 v79, v83, 2.0, v82
    v_fma_f32 v87, v91, 2.0, v90
    v_fma_f32 v82, v83, -2.0, v82
    v_fma_f32 v90, v91, -2.0, v90
    v_fmamk_f32 v80, v76, 0x41700000, v82
    v_fmamk_f32 v88, v84, 0x41700000, v90
    v_fmamk_f32 v80, v81, 0x41200000, v80
    v_fmamk_f32 v88, v89, 0x41200000, v88
    v_cvt_pk_bf16_f32 v7, v77, v85
    v_cvt_pk_bf16_f32 v11, v78, v86
    v_cvt_pk_bf16_f32 v67, v79, v87
    v_cvt_pk_bf16_f32 v71, v82, v90
    v_cvt_pk_bf16_f32 v75, v80, v88
    ds_write_b128 v96, v[64:67] offset:49152
    ds_write_b128 v97, v[68:71] offset:0
    ds_write_b128 v97, v[72:75] offset:16384
    ds_write_b128 v96, v[4:7] offset:16384
    ds_write_b128 v96, v[8:11] offset:32768
    buffer_load_dwordx4 v[32:35], v92, s[8:11], s24 offen offset:0
    buffer_load_dwordx4 v[48:51], v92, s[8:11], s24 offen offset:64
    v_add_u32 v92, 128, v92
    buffer_load_dwordx4 v[36:39], v93, s[8:11], s24 offen offset:0
    buffer_load_dwordx4 v[52:55], v93, s[8:11], s24 offen offset:64
    v_add_u32 v93, 128, v93
    s_waitcnt lgkmcnt(0)
    s_barrier
    s_setprio 1
L_conv1_kernel_hloop1:
    s_cmp_lt_u32 s28, 13
    s_cselect_b32 s24, 0, 2130706432
    v_lshlrev_b32 v76, 16, v16
    v_and_b32 v84, s25, v16
    v_lshlrev_b32 v77, 16, v20
    v_and_b32 v85, s25, v20
    v_lshlrev_b32 v78, 16, v24
    v_and_b32 v86, s25, v24
    v_lshlrev_b32 v79, 16, v28
    v_and_b32 v87, s25, v28
    v_add_f32 v80, v76, v78
    v_add_f32 v88, v84, v86
    v_add_f32 v81, v77, v79
    v_add_f32 v89, v85, v87
    v_fma_f32 v82, v78, 4.0, v76
    buffer_load_dwordx4 v[40:43], v94, s[8:11], s24 offen offset:0
    buffer_load_dwordx4 v[56:59], v94, s[8:11], s24 offen offset:64
    v_add_u32 v94, 128, v94
    v_fma_f32 v90, v86, 4.0, v84
    v_fma_f32 v83, v79, 4.0, v77
    v_fma_f32 v91, v87, 4.0, v85
    v_add_f32 v77, v80, v81
    v_add_f32 v85, v88, v89
    v_sub_f32 v78, v80, v81
    v_sub_f32 v86, v88, v89
    v_fma_f32 v79, v83, 2.0, v82
    v_fma_f32 v87, v91, 2.0, v90
    v_fma_f32 v82, v83, -2.0, v82
    v_fma_f32 v90, v91, -2.0, v90
    v_fmamk_f32 v80, v76, 0x41700000, v82
    v_fmamk_f32 v88, v84, 0x41700000, v90
    v_fmamk_f32 v80, v81, 0x41200000, v80
    v_fmamk_f32 v88, v89, 0x41200000, v88
    v_cvt_pk_bf16_f32 v20, v77, v85
    v_cvt_pk_bf16_f32 v24, v78, v86
    v_cvt_pk_bf16_f32 v64, v79, v87
    v_cvt_pk_bf16_f32 v68, v82, v90
    v_cvt_pk_bf16_f32 v72, v80, v88
    v_lshlrev_b32 v76, 16, v17
    v_and_b32 v84, s25, v17
    v_lshlrev_b32 v77, 16, v21
    v_and_b32 v85, s25, v21
    v_lshlrev_b32 v78, 16, v25
    v_and_b32 v86, s25, v25
    v_lshlrev_b32 v79, 16, v29
    v_and_b32 v87, s25, v29
    v_add_f32 v80, v76, v78
    v_add_f32 v88, v84, v86
    v_add_f32 v81, v77, v79
    v_add_f32 v89, v85, v87
    v_fma_f32 v82, v78, 4.0, v76
    v_fma_f32 v90, v86, 4.0, v84
    v_fma_f32 v83, v79, 4.0, v77
    v_fma_f32 v91, v87, 4.0, v85
    v_add_f32 v77, v80, v81
    v_add_f32 v85, v88, v89
    v_sub_f32 v78, v80, v81
    v_sub_f32 v86, v88, v89
    v_fma_f32 v79, v83, 2.0, v82
    v_fma_f32 v87, v91, 2.0, v90
    v_fma_f32 v82, v83, -2.0, v82
    v_fma_f32 v90, v91, -2.0, v90
    v_fmamk_f32 v80, v76, 0x41700000, v82
    v_fmamk_f32 v88, v84, 0x41700000, v90
    v_fmamk_f32 v80, v81, 0x41200000, v80
    v_fmamk_f32 v88, v89, 0x41200000, v88
    v_cvt_pk_bf16_f32 v21, v77, v85
    v_cvt_pk_bf16_f32 v25, v78, v86
    v_cvt_pk_bf16_f32 v65, v79, v87
    v_cvt_pk_bf16_f32 v69, v82, v90
    v_cvt_pk_bf16_f32 v73, v80, v88
    buffer_load_dwordx4 v[44:47], v95, s[8:11], s24 offen offset:0
    buffer_load_dwordx4 v[60:63], v95, s[8:11], s24 offen offset:64
    v_add_u32 v95, 128, v95
    v_lshlrev_b32 v76, 16, v18
    v_and_b32 v84, s25, v18
    v_lshlrev_b32 v77, 16, v22
    v_and_b32 v85, s25, v22
    v_lshlrev_b32 v78, 16, v26
    v_and_b32 v86, s25, v26
    v_lshlrev_b32 v79, 16, v30
    v_and_b32 v87, s25, v30
    v_add_f32 v80, v76, v78
    v_add_f32 v88, v84, v86
    v_add_f32 v81, v77, v79
    v_add_f32 v89, v85, v87
    v_fma_f32 v82, v78, 4.0, v76
    v_fma_f32 v90, v86, 4.0, v84
    v_fma_f32 v83, v79, 4.0, v77
    v_fma_f32 v91, v87, 4.0, v85
    v_add_f32 v77, v80, v81
    v_add_f32 v85, v88, v89
    v_sub_f32 v78, v80, v81
    v_sub_f32 v86, v88, v89
    v_fma_f32 v79, v83, 2.0, v82
    v_fma_f32 v87, v91, 2.0, v90
    v_fma_f32 v82, v83, -2.0, v82
    v_fma_f32 v90, v91, -2.0, v90
    v_fmamk_f32 v80, v76, 0x41700000, v82
    v_fmamk_f32 v88, v84, 0x41700000, v90
    v_fmamk_f32 v80, v81, 0x41200000, v80
    v_fmamk_f32 v88, v89, 0x41200000, v88
    v_cvt_pk_bf16_f32 v22, v77, v85
    v_cvt_pk_bf16_f32 v26, v78, v86
    v_cvt_pk_bf16_f32 v66, v79, v87
    v_cvt_pk_bf16_f32 v70, v82, v90
    v_cvt_pk_bf16_f32 v74, v80, v88
    v_lshlrev_b32 v76, 16, v19
    v_and_b32 v84, s25, v19
    v_lshlrev_b32 v77, 16, v23
    v_and_b32 v85, s25, v23
    v_lshlrev_b32 v78, 16, v27
    v_and_b32 v86, s25, v27
    v_lshlrev_b32 v79, 16, v31
    v_and_b32 v87, s25, v31
    v_add_f32 v80, v76, v78
    v_add_f32 v88, v84, v86
    v_add_f32 v81, v77, v79
    v_add_f32 v89, v85, v87
    v_fma_f32 v82, v78, 4.0, v76
    v_fma_f32 v90, v86, 4.0, v84
    v_fma_f32 v83, v79, 4.0, v77
    v_fma_f32 v91, v87, 4.0, v85
    v_add_f32 v77, v80, v81
    v_add_f32 v85, v88, v89
    v_sub_f32 v78, v80, v81
    v_sub_f32 v86, v88, v89
    v_fma_f32 v79, v83, 2.0, v82
    v_fma_f32 v87, v91, 2.0, v90
    v_fma_f32 v82, v83, -2.0, v82
    v_fma_f32 v90, v91, -2.0, v90
    v_fmamk_f32 v80, v76, 0x41700000, v82
    v_fmamk_f32 v88, v84, 0x41700000, v90
    v_fmamk_f32 v80, v81, 0x41200000, v80
    v_fmamk_f32 v88, v89, 0x41200000, v88
    v_cvt_pk_bf16_f32 v23, v77, v85
    v_cvt_pk_bf16_f32 v27, v78, v86
    v_cvt_pk_bf16_f32 v67, v79, v87
    v_cvt_pk_bf16_f32 v71, v82, v90
    v_cvt_pk_bf16_f32 v75, v80, v88
    ds_write_b128 v96, v[64:67] offset:57344
    ds_write_b128 v97, v[68:71] offset:8192
    ds_write_b128 v97, v[72:75] offset:24576
    ds_write_b128 v96, v[16:19] offset:8192
    ds_write_b128 v96, v[20:23] offset:24576
    ds_write_b128 v96, v[24:27] offset:40960
    ds_write_b128 v98, v[28:31] offset:8704
    s_add_u32 s28, s28, 1
    s_waitcnt lgkmcnt(0)
    s_barrier
    s_cmp_lt_u32 s28, 13
    s_cselect_b32 s24, 0, 2130706432
    s_waitcnt vmcnt(0)
    v_lshlrev_b32 v76, 16, v32
    v_and_b32 v84, s25, v32
    v_lshlrev_b32 v77, 16, v36
    v_and_b32 v85, s25, v36
    v_lshlrev_b32 v78, 16, v40
    v_and_b32 v86, s25, v40
    v_lshlrev_b32 v79, 16, v44
    v_and_b32 v87, s25, v44
    v_add_f32 v80, v76, v78
    v_add_f32 v88, v84, v86
    v_add_f32 v81, v77, v79
    v_add_f32 v89, v85, v87
    v_fma_f32 v82, v78, 4.0, v76
    v_fma_f32 v90, v86, 4.0, v84
    v_fma_f32 v83, v79, 4.0, v77
    v_fma_f32 v91, v87, 4.0, v85
    v_add_f32 v77, v80, v81
    v_add_f32 v85, v88, v89
    v_sub_f32 v78, v80, v81
    v_sub_f32 v86, v88, v89
    v_fma_f32 v79, v83, 2.0, v82
    v_fma_f32 v87, v91, 2.0, v90
    v_fma_f32 v82, v83, -2.0, v82
    v_fma_f32 v90, v91, -2.0, v90
    v_fmamk_f32 v80, v76, 0x41700000, v82
    v_fmamk_f32 v88, v84, 0x41700000, v90
    v_fmamk_f32 v80, v81, 0x41200000, v80
    v_fmamk_f32 v88, v89, 0x41200000, v88
    v_cvt_pk_bf16_f32 v36, v77, v85
    v_cvt_pk_bf16_f32 v40, v78, v86
    v_cvt_pk_bf16_f32 v64, v79, v87
    v_cvt_pk_bf16_f32 v68, v82, v90
    v_cvt_pk_bf16_f32 v72, v80, v88
    v_lshlrev_b32 v76, 16, v33
    v_and_b32 v84, s25, v33
    v_lshlrev_b32 v77, 16, v37
    v_and_b32 v85, s25, v37
    v_lshlrev_b32 v78, 16, v41
    v_and_b32 v86, s25, v41
    buffer_load_dwordx4 v[0:3], v92, s[8:11], s24 offen offset:0
    buffer_load_dwordx4 v[16:19], v92, s[8:11], s24 offen offset:64
    v_add_u32 v92, 128, v92
    v_lshlrev_b32 v79, 16, v45
    v_and_b32 v87, s25, v45
    v_add_f32 v80, v76, v78
    v_add_f32 v88, v84, v86
    v_add_f32 v81, v77, v79
    v_add_f32 v89, v85, v87
    v_fma_f32 v82, v78, 4.0, v76
    v_fma_f32 v90, v86, 4.0, v84
    v_fma_f32 v83, v79, 4.0, v77
    v_fma_f32 v91, v87, 4.0, v85
    v_add_f32 v77, v80, v81
    v_add_f32 v85, v88, v89
    v_sub_f32 v78, v80, v81
    v_sub_f32 v86, v88, v89
    v_fma_f32 v79, v83, 2.0, v82
    v_fma_f32 v87, v91, 2.0, v90
    v_fma_f32 v82, v83, -2.0, v82
    v_fma_f32 v90, v91, -2.0, v90
    v_fmamk_f32 v80, v76, 0x41700000, v82
    v_fmamk_f32 v88, v84, 0x41700000, v90
    v_fmamk_f32 v80, v81, 0x41200000, v80
    v_fmamk_f32 v88, v89, 0x41200000, v88
    v_cvt_pk_bf16_f32 v37, v77, v85
    v_cvt_pk_bf16_f32 v41, v78, v86
    v_cvt_pk_bf16_f32 v65, v79, v87
    v_cvt_pk_bf16_f32 v69, v82, v90
    v_cvt_pk_bf16_f32 v73, v80, v88
    v_lshlrev_b32 v76, 16, v34
    v_and_b32 v84, s25, v34
    v_lshlrev_b32 v77, 16, v38
    v_and_b32 v85, s25, v38
    v_lshlrev_b32 v78, 16, v42
    v_and_b32 v86, s25, v42
    v_lshlrev_b32 v79, 16, v46
    v_and_b32 v87, s25, v46
    v_add_f32 v80, v76, v78
    v_add_f32 v88, v84, v86
    v_add_f32 v81, v77, v79
    v_add_f32 v89, v85, v87
    v_fma_f32 v82, v78, 4.0, v76
    v_fma_f32 v90, v86, 4.0, v84
    v_fma_f32 v83, v79, 4.0, v77
    v_fma_f32 v91, v87, 4.0, v85
    v_add_f32 v77, v80, v81
    v_add_f32 v85, v88, v89
    v_sub_f32 v78, v80, v81
    v_sub_f32 v86, v88, v89
    v_fma_f32 v79, v83, 2.0, v82
    v_fma_f32 v87, v91, 2.0, v90
    v_fma_f32 v82, v83, -2.0, v82
    v_fma_f32 v90, v91, -2.0, v90
    v_fmamk_f32 v80, v76, 0x41700000, v82
    v_fmamk_f32 v88, v84, 0x41700000, v90
    buffer_load_dwordx4 v[4:7], v93, s[8:11], s24 offen offset:0
    buffer_load_dwordx4 v[20:23], v93, s[8:11], s24 offen offset:64
    v_add_u32 v93, 128, v93
    v_fmamk_f32 v80, v81, 0x41200000, v80
    v_fmamk_f32 v88, v89, 0x41200000, v88
    v_cvt_pk_bf16_f32 v38, v77, v85
    v_cvt_pk_bf16_f32 v42, v78, v86
    v_cvt_pk_bf16_f32 v66, v79, v87
    v_cvt_pk_bf16_f32 v70, v82, v90
    v_cvt_pk_bf16_f32 v74, v80, v88
    v_lshlrev_b32 v76, 16, v35
    v_and_b32 v84, s25, v35
    v_lshlrev_b32 v77, 16, v39
    v_and_b32 v85, s25, v39
    v_lshlrev_b32 v78, 16, v43
    v_and_b32 v86, s25, v43
    v_lshlrev_b32 v79, 16, v47
    v_and_b32 v87, s25, v47
    v_add_f32 v80, v76, v78
    v_add_f32 v88, v84, v86
    v_add_f32 v81, v77, v79
    v_add_f32 v89, v85, v87
    v_fma_f32 v82, v78, 4.0, v76
    v_fma_f32 v90, v86, 4.0, v84
    v_fma_f32 v83, v79, 4.0, v77
    v_fma_f32 v91, v87, 4.0, v85
    v_add_f32 v77, v80, v81
    v_add_f32 v85, v88, v89
    v_sub_f32 v78, v80, v81
    v_sub_f32 v86, v88, v89
    v_fma_f32 v79, v83, 2.0, v82
    v_fma_f32 v87, v91, 2.0, v90
    v_fma_f32 v82, v83, -2.0, v82
    v_fma_f32 v90, v91, -2.0, v90
    v_fmamk_f32 v80, v76, 0x41700000, v82
    v_fmamk_f32 v88, v84, 0x41700000, v90
    v_fmamk_f32 v80, v81, 0x41200000, v80
    v_fmamk_f32 v88, v89, 0x41200000, v88
    v_cvt_pk_bf16_f32 v39, v77, v85
    v_cvt_pk_bf16_f32 v43, v78, v86
    v_cvt_pk_bf16_f32 v67, v79, v87
    v_cvt_pk_bf16_f32 v71, v82, v90
    v_cvt_pk_bf16_f32 v75, v80, v88
    ds_write_b128 v96, v[64:67] offset:49152
    ds_write_b128 v97, v[68:71] offset:0
    ds_write_b128 v97, v[72:75] offset:16384
    ds_write_b128 v96, v[32:35] offset:0
    ds_write_b128 v96, v[36:39] offset:16384
    ds_write_b128 v96, v[40:43] offset:32768
    ds_write_b128 v98, v[44:47] offset:0
    s_add_u32 s28, s28, 1
    s_waitcnt lgkmcnt(0)
    s_barrier
    s_cmp_lt_u32 s28, 13
    s_cselect_b32 s24, 0, 2130706432
    v_lshlrev_b32 v76, 16, v48
    v_and_b32 v84, s25, v48
    v_lshlrev_b32 v77, 16, v52
    v_and_b32 v85, s25, v52
    v_lshlrev_b32 v78, 16, v56
    v_and_b32 v86, s25, v56
    v_lshlrev_b32 v79, 16, v60
    v_and_b32 v87, s25, v60
    v_add_f32 v80, v76, v78
    v_add_f32 v88, v84, v86
    v_add_f32 v81, v77, v79
    v_add_f32 v89, v85, v87
    v_fma_f32 v82, v78, 4.0, v76
    buffer_load_dwordx4 v[8:11], v94, s[8:11], s24 offen offset:0
    buffer_load_dwordx4 v[24:27], v94, s[8:11], s24 offen offset:64
    v_add_u32 v94, 128, v94
    v_fma_f32 v90, v86, 4.0, v84
    v_fma_f32 v83, v79, 4.0, v77
    v_fma_f32 v91, v87, 4.0, v85
    v_add_f32 v77, v80, v81
    v_add_f32 v85, v88, v89
    v_sub_f32 v78, v80, v81
    v_sub_f32 v86, v88, v89
    v_fma_f32 v79, v83, 2.0, v82
    v_fma_f32 v87, v91, 2.0, v90
    v_fma_f32 v82, v83, -2.0, v82
    v_fma_f32 v90, v91, -2.0, v90
    v_fmamk_f32 v80, v76, 0x41700000, v82
    v_fmamk_f32 v88, v84, 0x41700000, v90
    v_fmamk_f32 v80, v81, 0x41200000, v80
    v_fmamk_f32 v88, v89, 0x41200000, v88
    v_cvt_pk_bf16_f32 v52, v77, v85
    v_cvt_pk_bf16_f32 v56, v78, v86
    v_cvt_pk_bf16_f32 v64, v79, v87
    v_cvt_pk_bf16_f32 v68, v82, v90
    v_cvt_pk_bf16_f32 v72, v80, v88
    v_lshlrev_b32 v76, 16, v49
    v_and_b32 v84, s25, v49
    v_lshlrev_b32 v77, 16, v53
    v_and_b32 v85, s25, v53
    v_lshlrev_b32 v78, 16, v57
    v_and_b32 v86, s25, v57
    v_lshlrev_b32 v79, 16, v61
    v_and_b32 v87, s25, v61
    v_add_f32 v80, v76, v78
    v_add_f32 v88, v84, v86
    v_add_f32 v81, v77, v79
    v_add_f32 v89, v85, v87
    v_fma_f32 v82, v78, 4.0, v76
    v_fma_f32 v90, v86, 4.0, v84
    v_fma_f32 v83, v79, 4.0, v77
    v_fma_f32 v91, v87, 4.0, v85
    v_add_f32 v77, v80, v81
    v_add_f32 v85, v88, v89
    v_sub_f32 v78, v80, v81
    v_sub_f32 v86, v88, v89
    v_fma_f32 v79, v83, 2.0, v82
    v_fma_f32 v87, v91, 2.0, v90
    v_fma_f32 v82, v83, -2.0, v82
    v_fma_f32 v90, v91, -2.0, v90
    v_fmamk_f32 v80, v76, 0x41700000, v82
    v_fmamk_f32 v88, v84, 0x41700000, v90
    v_fmamk_f32 v80, v81, 0x41200000, v80
    v_fmamk_f32 v88, v89, 0x41200000, v88
    v_cvt_pk_bf16_f32 v53, v77, v85
    v_cvt_pk_bf16_f32 v57, v78, v86
    v_cvt_pk_bf16_f32 v65, v79, v87
    v_cvt_pk_bf16_f32 v69, v82, v90
    v_cvt_pk_bf16_f32 v73, v80, v88
    buffer_load_dwordx4 v[12:15], v95, s[8:11], s24 offen offset:0
    buffer_load_dwordx4 v[28:31], v95, s[8:11], s24 offen offset:64
    v_add_u32 v95, 128, v95
    v_lshlrev_b32 v76, 16, v50
    v_and_b32 v84, s25, v50
    v_lshlrev_b32 v77, 16, v54
    v_and_b32 v85, s25, v54
    v_lshlrev_b32 v78, 16, v58
    v_and_b32 v86, s25, v58
    v_lshlrev_b32 v79, 16, v62
    v_and_b32 v87, s25, v62
    v_add_f32 v80, v76, v78
    v_add_f32 v88, v84, v86
    v_add_f32 v81, v77, v79
    v_add_f32 v89, v85, v87
    v_fma_f32 v82, v78, 4.0, v76
    v_fma_f32 v90, v86, 4.0, v84
    v_fma_f32 v83, v79, 4.0, v77
    v_fma_f32 v91, v87, 4.0, v85
    v_add_f32 v77, v80, v81
    v_add_f32 v85, v88, v89
    v_sub_f32 v78, v80, v81
    v_sub_f32 v86, v88, v89
    v_fma_f32 v79, v83, 2.0, v82
    v_fma_f32 v87, v91, 2.0, v90
    v_fma_f32 v82, v83, -2.0, v82
    v_fma_f32 v90, v91, -2.0, v90
    v_fmamk_f32 v80, v76, 0x41700000, v82
    v_fmamk_f32 v88, v84, 0x41700000, v90
    v_fmamk_f32 v80, v81, 0x41200000, v80
    v_fmamk_f32 v88, v89, 0x41200000, v88
    v_cvt_pk_bf16_f32 v54, v77, v85
    v_cvt_pk_bf16_f32 v58, v78, v86
    v_cvt_pk_bf16_f32 v66, v79, v87
    v_cvt_pk_bf16_f32 v70, v82, v90
    v_cvt_pk_bf16_f32 v74, v80, v88
    v_lshlrev_b32 v76, 16, v51
    v_and_b32 v84, s25, v51
    v_lshlrev_b32 v77, 16, v55
    v_and_b32 v85, s25, v55
    v_lshlrev_b32 v78, 16, v59
    v_and_b32 v86, s25, v59
    v_lshlrev_b32 v79, 16, v63
    v_and_b32 v87, s25, v63
    v_add_f32 v80, v76, v78
    v_add_f32 v88, v84, v86
    v_add_f32 v81, v77, v79
    v_add_f32 v89, v85, v87
    v_fma_f32 v82, v78, 4.0, v76
    v_fma_f32 v90, v86, 4.0, v84
    v_fma_f32 v83, v79, 4.0, v77
    v_fma_f32 v91, v87, 4.0, v85
    v_add_f32 v77, v80, v81
    v_add_f32 v85, v88, v89
    v_sub_f32 v78, v80, v81
    v_sub_f32 v86, v88, v89
    v_fma_f32 v79, v83, 2.0, v82
    v_fma_f32 v87, v91, 2.0, v90
    v_fma_f32 v82, v83, -2.0, v82
    v_fma_f32 v90, v91, -2.0, v90
    v_fmamk_f32 v80, v76, 0x41700000, v82
    v_fmamk_f32 v88, v84, 0x41700000, v90
    v_fmamk_f32 v80, v81, 0x41200000, v80
    v_fmamk_f32 v88, v89, 0x41200000, v88
    v_cvt_pk_bf16_f32 v55, v77, v85
    v_cvt_pk_bf16_f32 v59, v78, v86
    v_cvt_pk_bf16_f32 v67, v79, v87
    v_cvt_pk_bf16_f32 v71, v82, v90
    v_cvt_pk_bf16_f32 v75, v80, v88
    ds_write_b128 v96, v[64:67] offset:57344
    ds_write_b128 v97, v[68:71] offset:8192
    ds_write_b128 v97, v[72:75] offset:24576
    ds_write_b128 v96, v[48:51] offset:8192
    ds_write_b128 v96, v[52:55] offset:24576
    ds_write_b128 v96, v[56:59] offset:40960
    ds_write_b128 v98, v[60:63] offset:8704
    s_add_u32 s28, s28, 1
    s_waitcnt lgkmcnt(0)
    s_barrier
    s_cmp_eq_u32 s22, 1
    s_cbranch_scc1 L_conv1_kernel_hlast1
    s_cmp_lt_u32 s28, 13
    s_cselect_b32 s24, 0, 2130706432
    s_waitcnt vmcnt(0)
    v_lshlrev_b32 v76, 16, v0
    v_and_b32 v84, s25, v0
    v_lshlrev_b32 v77, 16, v4
    v_and_b32 v85, s25, v4
    v_lshlrev_b32 v78, 16, v8
    v_and_b32 v86, s25, v8
    v_lshlrev_b32 v79, 16, v12
    v_and_b32 v87, s25, v12
    v_add_f32 v80, v76, v78
    v_add_f32 v88, v84, v86
    v_add_f32 v81, v77, v79
    v_add_f32 v89, v85, v87
    v_fma_f32 v82, v78, 4.0, v76
    v_fma_f32 v90, v86, 4.0, v84
    v_fma_f32 v83, v79, 4.0, v77
    v_fma_f32 v91, v87, 4.0, v85
    v_add_f32 v77, v80, v81
    v_add_f32 v85, v88, v89
    v_sub_f32 v78, v80, v81
    v_sub_f32 v86, v88, v89
    v_fma_f32 v79, v83, 2.0, v82
    v_fma_f32 v87, v91, 2.0, v90
    v_fma_f32 v82, v83, -2.0, v82
    v_fma_f32 v90, v91, -2.0, v90
    v_fmamk_f32 v80, v76, 0x41700000, v82
    v_fmamk_f32 v88, v84, 0x41700000, v90
    v_fmamk_f32 v80, v81, 0x41200000, v80
    v_fmamk_f32 v88, v89, 0x41200000, v88
    v_cvt_pk_bf16_f32 v4, v77, v85
    v_cvt_pk_bf16_f32 v8, v78, v86
    v_cvt_pk_bf16_f32 v64, v79, v87
    v_cvt_pk_bf16_f32 v68, v82, v90
    v_cvt_pk_bf16_f32 v72, v80, v88
    v_lshlrev_b32 v76, 16, v1
    v_and_b32 v84, s25, v1
    v_lshlrev_b32 v77, 16, v5
    v_and_b32 v85, s25, v5
    v_lshlrev_b32 v78, 16, v9
    v_and_b32 v86, s25, v9
    buffer_load_dwordx4 v[32:35], v92, s[8:11], s24 offen offset:0
    buffer_load_dwordx4 v[48:51], v92, s[8:11], s24 offen offset:64
    v_add_u32 v92, 128, v92
    v_lshlrev_b32 v79, 16, v13
    v_and_b32 v87, s25, v13
    v_add_f32 v80, v76, v78
    v_add_f32 v88, v84, v86
    v_add_f32 v81, v77, v79
    v_add_f32 v89, v85, v87
    v_fma_f32 v82, v78, 4.0, v76
    v_fma_f32 v90, v86, 4.0, v84
    v_fma_f32 v83, v79, 4.0, v77
    v_fma_f32 v91, v87, 4.0, v85
    v_add_f32 v77, v80, v81
    v_add_f32 v85, v88, v89
    v_sub_f32 v78, v80, v81
    v_sub_f32 v86, v88, v89
    v_fma_f32 v79, v83, 2.0, v82
    v_fma_f32 v87, v91, 2.0, v90
    v_fma_f32 v82, v83, -2.0, v82
    v_fma_f32 v90, v91, -2.0, v90
    v_fmamk_f32 v80, v76, 0x41700000, v82
    v_fmamk_f32 v88, v84, 0x41700000, v90
    v_fmamk_f32 v80, v81, 0x41200000, v80
    v_fmamk_f32 v88, v89, 0x41200000, v88
    v_cvt_pk_bf16_f32 v5, v77, v85
    v_cvt_pk_bf16_f32 v9, v78, v86
    v_cvt_pk_bf16_f32 v65, v79, v87
    v_cvt_pk_bf16_f32 v69, v82, v90
    v_cvt_pk_bf16_f32 v73, v80, v88
    v_lshlrev_b32 v76, 16, v2
    v_and_b32 v84, s25, v2
    v_lshlrev_b32 v77, 16, v6
    v_and_b32 v85, s25, v6
    v_lshlrev_b32 v78, 16, v10
    v_and_b32 v86, s25, v10
    v_lshlrev_b32 v79, 16, v14
    v_and_b32 v87, s25, v14
    v_add_f32 v80, v76, v78
    v_add_f32 v88, v84, v86
    v_add_f32 v81, v77, v79
    v_add_f32 v89, v85, v87
    v_fma_f32 v82, v78, 4.0, v76
    v_fma_f32 v90, v86, 4.0, v84
    v_fma_f32 v83, v79, 4.0, v77
    v_fma_f32 v91, v87, 4.0, v85
    v_add_f32 v77, v80, v81
    v_add_f32 v85, v88, v89
    v_sub_f32 v78, v80, v81
    v_sub_f32 v86, v88, v89
    v_fma_f32 v79, v83, 2.0, v82
    v_fma_f32 v87, v91, 2.0, v90
    v_fma_f32 v82, v83, -2.0, v82
    v_fma_f32 v90, v91, -2.0, v90
    v_fmamk_f32 v80, v76, 0x41700000, v82
    v_fmamk_f32 v88, v84, 0x41700000, v90
    buffer_load_dwordx4 v[36:39], v93, s[8:11], s24 offen offset:0
    buffer_load_dwordx4 v[52:55], v93, s[8:11], s24 offen offset:64
    v_add_u32 v93, 128, v93
    v_fmamk_f32 v80, v81, 0x41200000, v80
    v_fmamk_f32 v88, v89, 0x41200000, v88
    v_cvt_pk_bf16_f32 v6, v77, v85
    v_cvt_pk_bf16_f32 v10, v78, v86
    v_cvt_pk_bf16_f32 v66, v79, v87
    v_cvt_pk_bf16_f32 v70, v82, v90
    v_cvt_pk_bf16_f32 v74, v80, v88
    v_lshlrev_b32 v76, 16, v3
    v_and_b32 v84, s25, v3
    v_lshlrev_b32 v77, 16, v7
    v_and_b32 v85, s25, v7
    v_lshlrev_b32 v78, 16, v11
    v_and_b32 v86, s25, v11
    v_lshlrev_b32 v79, 16, v15
    v_and_b32 v87, s25, v15
    v_add_f32 v80, v76, v78
    v_add_f32 v88, v84, v86
    v_add_f32 v81, v77, v79
    v_add_f32 v89, v85, v87
    v_fma_f32 v82, v78, 4.0, v76
    v_fma_f32 v90, v86, 4.0, v84
    v_fma_f32 v83, v79, 4.0, v77
    v_fma_f32 v91, v87, 4.0, v85
    v_add_f32 v77, v80, v81
    v_add_f32 v85, v88, v89
    v_sub_f32 v78, v80, v81
    v_sub_f32 v86, v88, v89
    v_fma_f32 v79, v83, 2.0, v82
    v_fma_f32 v87, v91, 2.0, v90
    v_fma_f32 v82, v83, -2.0, v82
    v_fma_f32 v90, v91, -2.0, v90
    v_fmamk_f32 v80, v76, 0x41700000, v82
    v_fmamk_f32 v88, v84, 0x41700000, v90
    v_fmamk_f32 v80, v81, 0x41200000, v80
    v_fmamk_f32 v88, v89, 0x41200000, v88
    v_cvt_pk_bf16_f32 v7, v77, v85
    v_cvt_pk_bf16_f32 v11, v78, v86
    v_cvt_pk_bf16_f32 v67, v79, v87
    v_cvt_pk_bf16_f32 v71, v82, v90
    v_cvt_pk_bf16_f32 v75, v80, v88
    ds_write_b128 v96, v[64:67] offset:49152
    ds_write_b128 v97, v[68:71] offset:0
    ds_write_b128 v97, v[72:75] offset:16384
    ds_write_b128 v96, v[0:3] offset:0
    ds_write_b128 v96, v[4:7] offset:16384
    ds_write_b128 v96, v[8:11] offset:32768
    ds_write_b128 v98, v[12:15] offset:0
    s_add_u32 s28, s28, 1
    s_waitcnt lgkmcnt(0)
    s_barrier
    s_sub_u32 s22, s22, 1
    s_branch L_conv1_kernel_hloop1
L_conv1_kernel_hlast1:
    s_branch L_conv1_kernel_end
L_conv1_kernel_h2:
    ds_write_b128 v96, v[0:3] offset:0
    ds_write_b128 v98, v[12:15] offset:0
    v_lshlrev_b32 v76, 16, v0
    v_and_b32 v84, s25, v0
    v_lshlrev_b32 v77, 16, v4
    v_and_b32 v85, s25, v4
    v_lshlrev_b32 v78, 16, v8
    v_and_b32 v86, s25, v8
    v_lshlrev_b32 v79, 16, v12
    v_and_b32 v87, s25, v12
    v_add_f32 v80, v76, v78
    v_add_f32 v88, v84, v86
    v_add_f32 v81, v77, v79
    v_add_f32 v89, v85, v87
    v_fma_f32 v82, v78, 4.0, v76
    v_fma_f32 v90, v86, 4.0, v84
    v_fma_f32 v83, v79, 4.0, v77
    v_fma_f32 v91, v87, 4.0, v85
    v_add_f32 v77, v80, v81
    v_add_f32 v85, v88, v89
    v_sub_f32 v78, v80, v81
    v_sub_f32 v86, v88, v89
    v_fma_f32 v79, v83, 2.0, v82
    v_fma_f32 v87, v91, 2.0, v90
    v_fma_f32 v82, v83, -2.0, v82
    v_fma_f32 v90, v91, -2.0, v90
    v_fmamk_f32 v80, v76, 0x41700000, v82
    v_fmamk_f32 v88, v84, 0x41700000, v90
    v_fmamk_f32 v80, v81, 0x41200000, v80
    v_fmamk_f32 v88, v89, 0x41200000, v88
    v_cvt_pk_bf16_f32 v4, v77, v85
    v_cvt_pk_bf16_f32 v8, v78, v86
    v_cvt_pk_bf16_f32 v64, v79, v87
    v_cvt_pk_bf16_f32 v68, v82, v90
    v_cvt_pk_bf16_f32 v72, v80, v88
    v_lshlrev_b32 v76, 16, v1
    v_and_b32 v84, s25, v1
    v_lshlrev_b32 v77, 16, v5
    v_and_b32 v85, s25, v5
    v_lshlrev_b32 v78, 16, v9
    v_and_b32 v86, s25, v9
    v_lshlrev_b32 v79, 16, v13
    v_and_b32 v87, s25, v13
    v_add_f32 v80, v76, v78
    v_add_f32 v88, v84, v86
    v_add_f32 v81, v77, v79
    v_add_f32 v89, v85, v87
    v_fma_f32 v82, v78, 4.0, v76
    v_fma_f32 v90, v86, 4.0, v84
    v_fma_f32 v83, v79, 4.0, v77
    v_fma_f32 v91, v87, 4.0, v85
    v_add_f32 v77, v80, v81
    v_add_f32 v85, v88, v89
    v_sub_f32 v78, v80, v81
    v_sub_f32 v86, v88, v89
    v_fma_f32 v79, v83, 2.0, v82
    v_fma_f32 v87, v91, 2.0, v90
    v_fma_f32 v82, v83, -2.0, v82
    v_fma_f32 v90, v91, -2.0, v90
    v_fmamk_f32 v80, v76, 0x41700000, v82
    v_fmamk_f32 v88, v84, 0x41700000, v90
    v_fmamk_f32 v80, v81, 0x41200000, v80
    v_fmamk_f32 v88, v89, 0x41200000, v88
    v_cvt_pk_bf16_f32 v5, v77, v85
    v_cvt_pk_bf16_f32 v9, v78, v86
    v_cvt_pk_bf16_f32 v65, v79, v87
    v_cvt_pk_bf16_f32 v69, v82, v90
    v_cvt_pk_bf16_f32 v73, v80, v88
    v_lshlrev_b32 v76, 16, v2
    v_and_b32 v84, s25, v2
    v_lshlrev_b32 v77, 16, v6
    v_and_b32 v85, s25, v6
    v_lshlrev_b32 v78, 16, v10
    v_and_b32 v86, s25, v10
    v_lshlrev_b32 v79, 16, v14
    v_and_b32 v87, s25, v14
    v_add_f32 v80, v76, v78
    v_add_f32 v88, v84, v86
    v_add_f32 v81, v77, v79
    v_add_f32 v89, v85, v87
    v_fma_f32 v82, v78, 4.0, v76
    v_fma_f32 v90, v86, 4.0, v84
    v_fma_f32 v83, v79, 4.0, v77
    v_fma_f32 v91, v87, 4.0, v85
    v_add_f32 v77, v80, v81
    v_add_f32 v85, v88, v89
    v_sub_f32 v78, v80, v81
    v_sub_f32 v86, v88, v89
    v_fma_f32 v79, v83, 2.0, v82
    v_fma_f32 v87, v91, 2.0, v90
    v_fma_f32 v82, v83, -2.0, v82
    v_fma_f32 v90, v91, -2.0, v90
    v_fmamk_f32 v80, v76, 0x41700000, v82
    v_fmamk_f32 v88, v84, 0x41700000, v90
    v_fmamk_f32 v80, v81, 0x41200000, v80
    v_fmamk_f32 v88, v89, 0x41200000, v88
    v_cvt_pk_bf16_f32 v6, v77, v85
    v_cvt_pk_bf16_f32 v10, v78, v86
    v_cvt_pk_bf16_f32 v66, v79, v87
    v_cvt_pk_bf16_f32 v70, v82, v90
    v_cvt_pk_bf16_f32 v74, v80, v88
    v_lshlrev_b32 v76, 16, v3
    v_and_b32 v84, s25, v3
    v_lshlrev_b32 v77, 16, v7
    v_and_b32 v85, s25, v7
    v_lshlrev_b32 v78, 16, v11
    v_and_b32 v86, s25, v11
    v_lshlrev_b32 v79, 16, v15
    v_and_b32 v87, s25, v15
    v_add_f32 v80, v76, v78
    v_add_f32 v88, v84, v86
    v_add_f32 v81, v77, v79
    v_add_f32 v89, v85, v87
    v_fma_f32 v82, v78, 4.0, v76
    v_fma_f32 v90, v86, 4.0, v84
    v_fma_f32 v83, v79, 4.0, v77
    v_fma_f32 v91, v87, 4.0, v85
    v_add_f32 v77, v80, v81
    v_add_f32 v85, v88, v89
    v_sub_f32 v78, v80, v81
    v_sub_f32 v86, v88, v89
    v_fma_f32 v79, v83, 2.0, v82
    v_fma_f32 v87, v91, 2.0, v90
    v_fma_f32 v82, v83, -2.0, v82
    v_fma_f32 v90, v91, -2.0, v90
    v_fmamk_f32 v80, v76, 0x41700000, v82
    v_fmamk_f32 v88, v84, 0x41700000, v90
    v_fmamk_f32 v80, v81, 0x41200000, v80
    v_fmamk_f32 v88, v89, 0x41200000, v88
    v_cvt_pk_bf16_f32 v7, v77, v85
    v_cvt_pk_bf16_f32 v11, v78, v86
    v_cvt_pk_bf16_f32 v67, v79, v87
    v_cvt_pk_bf16_f32 v71, v82, v90
    v_cvt_pk_bf16_f32 v75, v80, v88
    ds_write_b128 v96, v[64:67] offset:49152
    ds_write_b128 v97, v[68:71] offset:0
    ds_write_b128 v97, v[72:75] offset:16384
    ds_write_b128 v96, v[4:7] offset:16384
    ds_write_b128 v96, v[8:11] offset:32768
    buffer_load_dwordx4 v[32:35], v92, s[8:11], s24 offen offset:0
    buffer_load_dwordx4 v[48:51], v92, s[8:11], s24 offen offset:64
    v_add_u32 v92, 128, v92
    buffer_load_dwordx4 v[36:39], v93, s[8:11], s24 offen offset:0
    buffer_load_dwordx4 v[52:55], v93, s[8:11], s24 offen offset:64
    v_add_u32 v93, 128, v93
    buffer_load_dwordx4 v[40:43], v94, s[8:11], s24 offen offset:0
    buffer_load_dwordx4 v[56:59], v94, s[8:11], s24 offen offset:64
    v_add_u32 v94, 128, v94
    buffer_load_dwordx4 v[44:47], v95, s[8:11], s24 offen offset:0
    buffer_load_dwordx4 v[60:63], v95, s[8:11], s24 offen offset:64
    v_add_u32 v95, 128, v95
    s_waitcnt lgkmcnt(0)
    s_barrier
    s_setprio 0
    v_lshlrev_b32 v76, 16, v16
    v_and_b32 v84, s25, v16
    v_lshlrev_b32 v77, 16, v20
    v_and_b32 v85, s25, v20
    v_lshlrev_b32 v78, 16, v24
    v_and_b32 v86, s25, v24
    v_lshlrev_b32 v79, 16, v28
    v_and_b32 v87, s25, v28
    v_add_f32 v80, v76, v78
    v_add_f32 v88, v84, v86
    v_add_f32 v81, v77, v79
    v_add_f32 v89, v85, v87
    v_fma_f32 v82, v78, 4.0, v76
    v_fma_f32 v90, v86, 4.0, v84
    v_fma_f32 v83, v79, 4.0, v77
    v_fma_f32 v91, v87, 4.0, v85
    v_add_f32 v77, v80, v81
    v_add_f32 v85, v88, v89
    v_sub_f32 v78, v80, v81
    v_sub_f32 v86, v88, v89
    v_fma_f32 v79, v83, 2.0, v82
    v_fma_f32 v87, v91, 2.0, v90
    v_fma_f32 v82, v83, -2.0, v82
    v_fma_f32 v90, v91, -2.0, v90
    v_fmamk_f32 v80, v76, 0x41700000, v82
    v_fmamk_f32 v88, v84, 0x41700000, v90
    v_fmamk_f32 v80, v81, 0x41200000, v80
    v_fmamk_f32 v88, v89, 0x41200000, v88
    v_cvt_pk_bf16_f32 v20, v77, v85
    v_cvt_pk_bf16_f32 v24, v78, v86
    v_cvt_pk_bf16_f32 v64, v79, v87
    v_cvt_pk_bf16_f32 v68, v82, v90
    v_cvt_pk_bf16_f32 v72, v80, v88
    v_lshlrev_b32 v76, 16, v17
    v_and_b32 v84, s25, v17
    v_lshlrev_b32 v77, 16, v21
    v_and_b32 v85, s25, v21
    v_lshlrev_b32 v78, 16, v25
    v_and_b32 v86, s25, v25
    v_lshlrev_b32 v79, 16, v29
    v_and_b32 v87, s25, v29
    v_add_f32 v80, v76, v78
    v_add_f32 v88, v84, v86
    v_add_f32 v81, v77, v79
    v_add_f32 v89, v85, v87
    v_fma_f32 v82, v78, 4.0, v76
    v_fma_f32 v90, v86, 4.0, v84
    v_fma_f32 v83, v79, 4.0, v77
    v_fma_f32 v91, v87, 4.0, v85
    v_add_f32 v77, v80, v81
    v_add_f32 v85, v88, v89
    v_sub_f32 v78, v80, v81
    v_sub_f32 v86, v88, v89
    v_fma_f32 v79, v83, 2.0, v82
    v_fma_f32 v87, v91, 2.0, v90
    v_fma_f32 v82, v83, -2.0, v82
    v_fma_f32 v90, v91, -2.0, v90
    v_fmamk_f32 v80, v76, 0x41700000, v82
    v_fmamk_f32 v88, v84, 0x41700000, v90
    v_fmamk_f32 v80, v81, 0x41200000, v80
    v_fmamk_f32 v88, v89, 0x41200000, v88
    v_cvt_pk_bf16_f32 v21, v77, v85
    v_cvt_pk_bf16_f32 v25, v78, v86
    v_cvt_pk_bf16_f32 v65, v79, v87
    v_cvt_pk_bf16_f32 v69, v82, v90
    v_cvt_pk_bf16_f32 v73, v80, v88
    v_lshlrev_b32 v76, 16, v18
    v_and_b32 v84, s25, v18
    v_lshlrev_b32 v77, 16, v22
    v_and_b32 v85, s25, v22
    v_lshlrev_b32 v78, 16, v26
    v_and_b32 v86, s25, v26
    v_lshlrev_b32 v79, 16, v30
    v_and_b32 v87, s25, v30
    v_add_f32 v80, v76, v78
    v_add_f32 v88, v84, v86
    v_add_f32 v81, v77, v79
    v_add_f32 v89, v85, v87
    v_fma_f32 v82, v78, 4.0, v76
    v_fma_f32 v90, v86, 4.0, v84
    v_fma_f32 v83, v79, 4.0, v77
    v_fma_f32 v91, v87, 4.0, v85
    v_add_f32 v77, v80, v81
    v_add_f32 v85, v88, v89
    v_sub_f32 v78, v80, v81
    v_sub_f32 v86, v88, v89
    v_fma_f32 v79, v83, 2.0, v82
    v_fma_f32 v87, v91, 2.0, v90
    v_fma_f32 v82, v83, -2.0, v82
    v_fma_f32 v90, v91, -2.0, v90
    v_fmamk_f32 v80, v76, 0x41700000, v82
    v_fmamk_f32 v88, v84, 0x41700000, v90
    v_fmamk_f32 v80, v81, 0x41200000, v80
    v_fmamk_f32 v88, v89, 0x41200000, v88
    v_cvt_pk_bf16_f32 v22, v77, v85
    v_cvt_pk_bf16_f32 v26, v78, v86
    v_cvt_pk_bf16_f32 v66, v79, v87
    v_cvt_pk_bf16_f32 v70, v82, v90
    v_cvt_pk_bf16_f32 v74, v80, v88
    v_lshlrev_b32 v76, 16, v19
    v_and_b32 v84, s25, v19
    v_lshlrev_b32 v77, 16, v23
    v_and_b32 v85, s25, v23
    v_lshlrev_b32 v78, 16, v27
    v_and_b32 v86, s25, v27
    v_lshlrev_b32 v79, 16, v31
    v_and_b32 v87, s25, v31
    v_add_f32 v80, v76, v78
    v_add_f32 v88, v84, v86
    v_add_f32 v81, v77, v79
    v_add_f32 v89, v85, v87
    v_fma_f32 v82, v78, 4.0, v76
    v_fma_f32 v90, v86, 4.0, v84
    v_fma_f32 v83, v79, 4.0, v77
    v_fma_f32 v91, v87, 4.0, v85
    v_add_f32 v77, v80, v81
    v_add_f32 v85, v88, v89
    v_sub_f32 v78, v80, v81
    v_sub_f32 v86, v88, v89
    v_fma_f32 v79, v83, 2.0, v82
    v_fma_f32 v87, v91, 2.0, v90
    v_fma_f32 v82, v83, -2.0, v82
    v_fma_f32 v90, v91, -2.0, v90
    v_fmamk_f32 v80, v76, 0x41700000, v82
    v_fmamk_f32 v88, v84, 0x41700000, v90
    v_fmamk_f32 v80, v81, 0x41200000, v80
    v_fmamk_f32 v88, v89, 0x41200000, v88
    v_cvt_pk_bf16_f32 v23, v77, v85
    v_cvt_pk_bf16_f32 v27, v78, v86
    v_cvt_pk_bf16_f32 v67, v79, v87
    v_cvt_pk_bf16_f32 v71, v82, v90
    v_cvt_pk_bf16_f32 v75, v80, v88
L_conv1_kernel_hloop2:
    s_cmp_lt_u32 s28, 12
    s_cselect_b32 s24, 0, 2130706432
    ds_write_b128 v96, v[64:67] offset:57344
    ds_write_b128 v97, v[68:71] offset:8192
    ds_write_b128 v97, v[72:75] offset:24576
    ds_write_b128 v96, v[16:19] offset:8192
    ds_write_b128 v96, v[20:23] offset:24576
    ds_write_b128 v96, v[24:27] offset:40960
    ds_write_b128 v98, v[28:31] offset:8704
    s_waitcnt vmcnt(0)
    v_lshlrev_b32 v76, 16, v32
    v_and_b32 v84, s25, v32
    v_lshlrev_b32 v77, 16, v36
    v_and_b32 v85, s25, v36
    v_lshlrev_b32 v78, 16, v40
    v_and_b32 v86, s25, v40
    v_lshlrev_b32 v79, 16, v44
    v_and_b32 v87, s25, v44
    v_add_f32 v80, v76, v78
    v_add_f32 v88, v84, v86
    v_add_f32 v81, v77, v79
    v_add_f32 v89, v85, v87
    v_fma_f32 v82, v78, 4.0, v76
    v_fma_f32 v90, v86, 4.0, v84
    v_fma_f32 v83, v79, 4.0, v77
    v_fma_f32 v91, v87, 4.0, v85
    v_add_f32 v77, v80, v81
    v_add_f32 v85, v88, v89
    v_sub_f32 v78, v80, v81
    v_sub_f32 v86, v88, v89
    v_fma_f32 v79, v83, 2.0, v82
    v_fma_f32 v87, v91, 2.0, v90
    v_fma_f32 v82, v83, -2.0, v82
    v_fma_f32 v90, v91, -2.0, v90
    v_fmamk_f32 v80, v76, 0x41700000, v82
    v_fmamk_f32 v88, v84, 0x41700000, v90
    buffer_load_dwordx4 v[0:3], v92, s[8:11], s24 offen offset:0
    buffer_load_dwordx4 v[16:19], v92, s[8:11], s24 offen offset:64
    v_add_u32 v92, 128, v92
    v_fmamk_f32 v80, v81, 0x41200000, v80
    v_fmamk_f32 v88, v89, 0x41200000, v88
    v_cvt_pk_bf16_f32 v36, v77, v85
    v_cvt_pk_bf16_f32 v40, v78, v86
    v_cvt_pk_bf16_f32 v64, v79, v87
    v_cvt_pk_bf16_f32 v68, v82, v90
    v_cvt_pk_bf16_f32 v72, v80, v88
    v_lshlrev_b32 v76, 16, v33
    v_and_b32 v84, s25, v33
    v_lshlrev_b32 v77, 16, v37
    v_and_b32 v85, s25, v37
    v_lshlrev_b32 v78, 16, v41
    v_and_b32 v86, s25, v41
    v_lshlrev_b32 v79, 16, v45
    v_and_b32 v87, s25, v45
    v_add_f32 v80, v76, v78
    v_add_f32 v88, v84, v86
    v_add_f32 v81, v77, v79
    v_add_f32 v89, v85, v87
    v_fma_f32 v82, v78, 4.0, v76
    v_fma_f32 v90, v86, 4.0, v84
    v_fma_f32 v83, v79, 4.0, v77
    v_fma_f32 v91, v87, 4.0, v85
    v_add_f32 v77, v80, v81
    v_add_f32 v85, v88, v89
    v_sub_f32 v78, v80, v81
    v_sub_f32 v86, v88, v89
    v_fma_f32 v79, v83, 2.0, v82
    v_fma_f32 v87, v91, 2.0, v90
    v_fma_f32 v82, v83, -2.0, v82
    v_fma_f32 v90, v91, -2.0, v90
    v_fmamk_f32 v80, v76, 0x41700000, v82
    v_fmamk_f32 v88, v84, 0x41700000, v90
    v_fmamk_f32 v80, v81, 0x41200000, v80
    v_fmamk_f32 v88, v89, 0x41200000, v88
    v_cvt_pk_bf16_f32 v37, v77, v85
    v_cvt_pk_bf16_f32 v41, v78, v86
    v_cvt_pk_bf16_f32 v65, v79, v87
    v_cvt_pk_bf16_f32 v69, v82, v90
    v_cvt_pk_bf16_f32 v73, v80, v88
    v_lshlrev_b32 v76, 16, v34
    v_and_b32 v84, s25, v34
    v_lshlrev_b32 v77, 16, v38
    v_and_b32 v85, s25, v38
    v_lshlrev_b32 v78, 16, v42
    v_and_b32 v86, s25, v42
    v_lshlrev_b32 v79, 16, v46
    v_and_b32 v87, s25, v46
    v_add_f32 v80, v76, v78
    v_add_f32 v88, v84, v86
    v_add_f32 v81, v77, v79
    v_add_f32 v89, v85, v87
    v_fma_f32 v82, v78, 4.0, v76
    buffer_load_dwordx4 v[4:7], v93, s[8:11], s24 offen offset:0
    buffer_load_dwordx4 v[20:23], v93, s[8:11], s24 offen offset:64
    v_add_u32 v93, 128, v93
    v_fma_f32 v90, v86, 4.0, v84
    v_fma_f32 v83, v79, 4.0, v77
    v_fma_f32 v91, v87, 4.0, v85
    v_add_f32 v77, v80, v81
    v_add_f32 v85, v88, v89
    v_sub_f32 v78, v80, v81
    v_sub_f32 v86, v88, v89
    v_fma_f32 v79, v83, 2.0, v82
    v_fma_f32 v87, v91, 2.0, v90
    v_fma_f32 v82, v83, -2.0, v82
    v_fma_f32 v90, v91, -2.0, v90
    v_fmamk_f32 v80, v76, 0x41700000, v82
    v_fmamk_f32 v88, v84, 0x41700000, v90
    v_fmamk_f32 v80, v81, 0x41200000, v80
    v_fmamk_f32 v88, v89, 0x41200000, v88
    v_cvt_pk_bf16_f32 v38, v77, v85
    v_cvt_pk_bf16_f32 v42, v78, v86
    v_cvt_pk_bf16_f32 v66, v79, v87
    v_cvt_pk_bf16_f32 v70, v82, v90
    v_cvt_pk_bf16_f32 v74, v80, v88
    v_lshlrev_b32 v76, 16, v35
    v_and_b32 v84, s25, v35
    v_lshlrev_b32 v77, 16, v39
    v_and_b32 v85, s25, v39
    v_lshlrev_b32 v78, 16, v43
    v_and_b32 v86, s25, v43
    v_lshlrev_b32 v79, 16, v47
    v_and_b32 v87, s25, v47
    v_add_f32 v80, v76, v78
    v_add_f32 v88, v84, v86
    v_add_f32 v81, v77, v79
    v_add_f32 v89, v85, v87
    v_fma_f32 v82, v78, 4.0, v76
    v_fma_f32 v90, v86, 4.0, v84
    v_fma_f32 v83, v79, 4.0, v77
    v_fma_f32 v91, v87, 4.0, v85
    v_add_f32 v77, v80, v81
    v_add_f32 v85, v88, v89
    v_sub_f32 v78, v80, v81
    v_sub_f32 v86, v88, v89
    v_fma_f32 v79, v83, 2.0, v82
    v_fma_f32 v87, v91, 2.0, v90
    v_fma_f32 v82, v83, -2.0, v82
    v_fma_f32 v90, v91, -2.0, v90
    v_fmamk_f32 v80, v76, 0x41700000, v82
    v_fmamk_f32 v88, v84, 0x41700000, v90
    v_fmamk_f32 v80, v81, 0x41200000, v80
    v_fmamk_f32 v88, v89, 0x41200000, v88
    v_cvt_pk_bf16_f32 v39, v77, v85
    v_cvt_pk_bf16_f32 v43, v78, v86
    v_cvt_pk_bf16_f32 v67, v79, v87
    v_cvt_pk_bf16_f32 v71, v82, v90
    v_cvt_pk_bf16_f32 v75, v80, v88
    s_add_u32 s28, s28, 1
    s_waitcnt lgkmcnt(0)
    s_barrier
    s_cmp_lt_u32 s28, 12
    s_cselect_b32 s24, 0, 2130706432
    ds_write_b128 v96, v[64:67] offset:49152
    ds_write_b128 v97, v[68:71] offset:0
    ds_write_b128 v97, v[72:75] offset:16384
    ds_write_b128 v96, v[32:35] offset:0
    ds_write_b128 v96, v[36:39] offset:16384
    ds_write_b128 v96, v[40:43] offset:32768
    ds_write_b128 v98, v[44:47] offset:0
    v_lshlrev_b32 v76, 16, v48
    v_and_b32 v84, s25, v48
    buffer_load_dwordx4 v[8:11], v94, s[8:11], s24 offen offset:0
    buffer_load_dwordx4 v[24:27], v94, s[8:11], s24 offen offset:64
    v_add_u32 v94, 128, v94
    v_lshlrev_b32 v77, 16, v52
    v_and_b32 v85, s25, v52
    v_lshlrev_b32 v78, 16, v56
    v_and_b32 v86, s25, v56
    v_lshlrev_b32 v79, 16, v60
    v_and_b32 v87, s25, v60
    v_add_f32 v80, v76, v78
    v_add_f32 v88, v84, v86
    v_add_f32 v81, v77, v79
    v_add_f32 v89, v85, v87
    v_fma_f32 v82, v78, 4.0, v76
    v_fma_f32 v90, v86, 4.0, v84
    v_fma_f32 v83, v79, 4.0, v77
    v_fma_f32 v91, v87, 4.0, v85
    v_add_f32 v77, v80, v81
    v_add_f32 v85, v88, v89
    v_sub_f32 v78, v80, v81
    buffer_load_dwordx4 v[12:15], v95, s[8:11], s24 offen offset:0
    buffer_load_dwordx4 v[28:31], v95, s[8:11], s24 offen offset:64
    v_add_u32 v95, 128, v95
    v_sub_f32 v86, v88, v89
    v_fma_f32 v79, v83, 2.0, v82
    v_fma_f32 v87, v91, 2.0, v90
    v_fma_f32 v82, v83, -2.0, v82
    v_fma_f32 v90, v91, -2.0, v90
    v_fmamk_f32 v80, v76, 0x41700000, v82
    v_fmamk_f32 v88, v84, 0x41700000, v90
    v_fmamk_f32 v80, v81, 0x41200000, v80
    v_fmamk_f32 v88, v89, 0x41200000, v88
    v_cvt_pk_bf16_f32 v52, v77, v85
    v_cvt_pk_bf16_f32 v56, v78, v86
    v_cvt_pk_bf16_f32 v64, v79, v87
    v_cvt_pk_bf16_f32 v68, v82, v90
    v_cvt_pk_bf16_f32 v72, v80, v88
    v_lshlrev_b32 v76, 16, v49
    v_and_b32 v84, s25, v49
    v_lshlrev_b32 v77, 16, v53
    v_and_b32 v85, s25, v53
    v_lshlrev_b32 v78, 16, v57
    v_and_b32 v86, s25, v57
    v_lshlrev_b32 v79, 16, v61
    v_and_b32 v87, s25, v61
    v_add_f32 v80, v76, v78
    v_add_f32 v88, v84, v86
    v_add_f32 v81, v77, v79
    v_add_f32 v89, v85, v87
    v_fma_f32 v82, v78, 4.0, v76
    v_fma_f32 v90, v86, 4.0, v84
    v_fma_f32 v83, v79, 4.0, v77
    v_fma_f32 v91, v87, 4.0, v85
    v_add_f32 v77, v80, v81
    v_add_f32 v85, v88, v89
    v_sub_f32 v78, v80, v81
    v_sub_f32 v86, v88, v89
    v_fma_f32 v79, v83, 2.0, v82
    v_fma_f32 v87, v91, 2.0, v90
    v_fma_f32 v82, v83, -2.0, v82
    v_fma_f32 v90, v91, -2.0, v90
    v_fmamk_f32 v80, v76, 0x41700000, v82
    v_fmamk_f32 v88, v84, 0x41700000, v90
    v_fmamk_f32 v80, v81, 0x41200000, v80
    v_fmamk_f32 v88, v89, 0x41200000, v88
    v_cvt_pk_bf16_f32 v53, v77, v85
    v_cvt_pk_bf16_f32 v57, v78, v86
    v_cvt_pk_bf16_f32 v65, v79, v87
    v_cvt_pk_bf16_f32 v69, v82, v90
    v_cvt_pk_bf16_f32 v73, v80, v88
    v_lshlrev_b32 v76, 16, v50
    v_and_b32 v84, s25, v50
    v_lshlrev_b32 v77, 16, v54
    v_and_b32 v85, s25, v54
    v_lshlrev_b32 v78, 16, v58
    v_and_b32 v86, s25, v58
    v_lshlrev_b32 v79, 16, v62
    v_and_b32 v87, s25, v62
    v_add_f32 v80, v76, v78
    v_add_f32 v88, v84, v86
    v_add_f32 v81, v77, v79
    v_add_f32 v89, v85, v87
    v_fma_f32 v82, v78, 4.0, v76
    v_fma_f32 v90, v86, 4.0, v84
    v_fma_f32 v83, v79, 4.0, v77
    v_fma_f32 v91, v87, 4.0, v85
    v_add_f32 v77, v80, v81
    v_add_f32 v85, v88, v89
    v_sub_f32 v78, v80, v81
    v_sub_f32 v86, v88, v89
    v_fma_f32 v79, v83, 2.0, v82
    v_fma_f32 v87, v91, 2.0, v90
    v_fma_f32 v82, v83, -2.0, v82
    v_fma_f32 v90, v91, -2.0, v90
    v_fmamk_f32 v80, v76, 0x41700000, v82
    v_fmamk_f32 v88, v84, 0x41700000, v90
    v_fmamk_f32 v80, v81, 0x41200000, v80
    v_fmamk_f32 v88, v89, 0x41200000, v88
    v_cvt_pk_bf16_f32 v54, v77, v85
    v_cvt_pk_bf16_f32 v58, v78, v86
    v_cvt_pk_bf16_f32 v66, v79, v87
    v_cvt_pk_bf16_f32 v70, v82, v90
    v_cvt_pk_bf16_f32 v74, v80, v88
    v_lshlrev_b32 v76, 16, v51
    v_and_b32 v84, s25, v51
    v_lshlrev_b32 v77, 16, v55
    v_and_b32 v85, s25, v55
    v_lshlrev_b32 v78, 16, v59
    v_and_b32 v86, s25, v59
    v_lshlrev_b32 v79, 16, v63
    v_and_b32 v87, s25, v63
    v_add_f32 v80, v76, v78
    v_add_f32 v88, v84, v86
    v_add_f32 v81, v77, v79
    v_add_f32 v89, v85, v87
    v_fma_f32 v82, v78, 4.0, v76
    v_fma_f32 v90, v86, 4.0, v84
    v_fma_f32 v83, v79, 4.0, v77
    v_fma_f32 v91, v87, 4.0, v85
    v_add_f32 v77, v80, v81
    v_add_f32 v85, v88, v89
    v_sub_f32 v78, v80, v81
    v_sub_f32 v86, v88, v89
    v_fma_f32 v79, v83, 2.0, v82
    v_fma_f32 v87, v91, 2.0, v90
    v_fma_f32 v82, v83, -2.0, v82
    v_fma_f32 v90, v91, -2.0, v90
    v_fmamk_f32 v80, v76, 0x41700000, v82
    v_fmamk_f32 v88, v84, 0x41700000, v90
    v_fmamk_f32 v80, v81, 0x41200000, v80
    v_fmamk_f32 v88, v89, 0x41200000, v88
    v_cvt_pk_bf16_f32 v55, v77, v85
    v_cvt_pk_bf16_f32 v59, v78, v86
    v_cvt_pk_bf16_f32 v67, v79, v87
    v_cvt_pk_bf16_f32 v71, v82, v90
    v_cvt_pk_bf16_f32 v75, v80, v88
    s_add_u32 s28, s28, 1
    s_waitcnt lgkmcnt(0)
    s_barrier
    s_cmp_eq_u32 s22, 1
    s_cbranch_scc1 L_conv1_kernel_hlast2
    s_cmp_lt_u32 s28, 12
    s_cselect_b32 s24, 0, 2130706432
    ds_write_b128 v96, v[64:67] offset:57344
    ds_write_b128 v97, v[68:71] offset:8192
    ds_write_b128 v97, v[72:75] offset:24576
    ds_write_b128 v96, v[48:51] offset:8192
    ds_write_b128 v96, v[52:55] offset:24576
    ds_write_b128 v96, v[56:59] offset:40960
    ds_write_b128 v98, v[60:63] offset:8704
    s_waitcnt vmcnt(0)
    v_lshlrev_b32 v76, 16, v0
    v_and_b32 v84, s25, v0
    v_lshlrev_b32 v77, 16, v4
    v_and_b32 v85, s25, v4
    v_lshlrev_b32 v78, 16, v8
    v_and_b32 v86, s25, v8
    v_lshlrev_b32 v79, 16, v12
    v_and_b32 v87, s25, v12
    v_add_f32 v80, v76, v78
    v_add_f32 v88, v84, v86
    v_add_f32 v81, v77, v79
    v_add_f32 v89, v85, v87
    v_fma_f32 v82, v78, 4.0, v76
    v_fma_f32 v90, v86, 4.0, v84
    v_fma_f32 v83, v79, 4.0, v77
    v_fma_f32 v91, v87, 4.0, v85
    v_add_f32 v77, v80, v81
    v_add_f32 v85, v88, v89
    v_sub_f32 v78, v80, v81
    v_sub_f32 v86, v88, v89
    v_fma_f32 v79, v83, 2.0, v82
    v_fma_f32 v87, v91, 2.0, v90
    v_fma_f32 v82, v83, -2.0, v82
    v_fma_f32 v90, v91, -2.0, v90
    v_fmamk_f32 v80, v76, 0x41700000, v82
    v_fmamk_f32 v88, v84, 0x41700000, v90
    buffer_load_dwordx4 v[32:35], v92, s[8:11], s24 offen offset:0
    buffer_load_dwordx4 v[48:51], v92, s[8:11], s24 offen offset:64
    v_add_u32 v92, 128, v92
    v_fmamk_f32 v80, v81, 0x41200000, v80
    v_fmamk_f32 v88, v89, 0x41200000, v88
    v_cvt_pk_bf16_f32 v4, v77, v85
    v_cvt_pk_bf16_f32 v8, v78, v86
    v_cvt_pk_bf16_f32 v64, v79, v87
    v_cvt_pk_bf16_f32 v68, v82, v90
    v_cvt_pk_bf16_f32 v72, v80, v88
    v_lshlrev_b32 v76, 16, v1
    v_and_b32 v84, s25, v1
    v_lshlrev_b32 v77, 16, v5
    v_and_b32 v85, s25, v5
    v_lshlrev_b32 v78, 16, v9
    v_and_b32 v86, s25, v9
    v_lshlrev_b32 v79, 16, v13
    v_and_b32 v87, s25, v13
    v_add_f32 v80, v76, v78
    v_add_f32 v88, v84, v86
    v_add_f32 v81, v77, v79
    v_add_f32 v89, v85, v87
    v_fma_f32 v82, v78, 4.0, v76
    v_fma_f32 v90, v86, 4.0, v84
    v_fma_f32 v83, v79, 4.0, v77
    v_fma_f32 v91, v87, 4.0, v85
    v_add_f32 v77, v80, v81
    v_add_f32 v85, v88, v89
    v_sub_f32 v78, v80, v81
    v_sub_f32 v86, v88, v89
    v_fma_f32 v79, v83, 2.0, v82
    v_fma_f32 v87, v91, 2.0, v90
    v_fma_f32 v82, v83, -2.0, v82
    v_fma_f32 v90, v91, -2.0, v90
    v_fmamk_f32 v80, v76, 0x41700000, v82
    v_fmamk_f32 v88, v84, 0x41700000, v90
    v_fmamk_f32 v80, v81, 0x41200000, v80
    v_fmamk_f32 v88, v89, 0x41200000, v88
    v_cvt_pk_bf16_f32 v5, v77, v85
    v_cvt_pk_bf16_f32 v9, v78, v86
    v_cvt_pk_bf16_f32 v65, v79, v87
    v_cvt_pk_bf16_f32 v69, v82, v90
    v_cvt_pk_bf16_f32 v73, v80, v88
    v_lshlrev_b32 v76, 16, v2
    v_and_b32 v84, s25, v2
    v_lshlrev_b32 v77, 16, v6
    v_and_b32 v85, s25, v6
    v_lshlrev_b32 v78, 16, v10
    v_and_b32 v86, s25, v10
    v_lshlrev_b32 v79, 16, v14
    v_and_b32 v87, s25, v14
    v_add_f32 v80, v76, v78
    v_add_f32 v88, v84, v86
    v_add_f32 v81, v77, v79
    v_add_f32 v89, v85, v87
    v_fma_f32 v82, v78, 4.0, v76
    buffer_load_dwordx4 v[36:39], v93, s[8:11], s24 offen offset:0
    buffer_load_dwordx4 v[52:55], v93, s[8:11], s24 offen offset:64
    v_add_u32 v93, 128, v93
    v_fma_f32 v90, v86, 4.0, v84
    v_fma_f32 v83, v79, 4.0, v77
    v_fma_f32 v91, v87, 4.0, v85
    v_add_f32 v77, v80, v81
    v_add_f32 v85, v88, v89
    v_sub_f32 v78, v80, v81
    v_sub_f32 v86, v88, v89
    v_fma_f32 v79, v83, 2.0, v82
    v_fma_f32 v87, v91, 2.0, v90
    v_fma_f32 v82, v83, -2.0, v82
    v_fma_f32 v90, v91, -2.0, v90
    v_fmamk_f32 v80, v76, 0x41700000, v82
    v_fmamk_f32 v88, v84, 0x41700000, v90
    v_fmamk_f32 v80, v81, 0x41200000, v80
    v_fmamk_f32 v88, v89, 0x41200000, v88
    v_cvt_pk_bf16_f32 v6, v77, v85
    v_cvt_pk_bf16_f32 v10, v78, v86
    v_cvt_pk_bf16_f32 v66, v79, v87
    v_cvt_pk_bf16_f32 v70, v82, v90
    v_cvt_pk_bf16_f32 v74, v80, v88
    v_lshlrev_b32 v76, 16, v3
    v_and_b32 v84, s25, v3
    v_lshlrev_b32 v77, 16, v7
    v_and_b32 v85, s25, v7
    v_lshlrev_b32 v78, 16, v11
    v_and_b32 v86, s25, v11
    v_lshlrev_b32 v79, 16, v15
    v_and_b32 v87, s25, v15
    v_add_f32 v80, v76, v78
    v_add_f32 v88, v84, v86
    v_add_f32 v81, v77, v79
    v_add_f32 v89, v85, v87
    v_fma_f32 v82, v78, 4.0, v76
    v_fma_f32 v90, v86, 4.0, v84
    v_fma_f32 v83, v79, 4.0, v77
    v_fma_f32 v91, v87, 4.0, v85
    v_add_f32 v77, v80, v81
    v_add_f32 v85, v88, v89
    v_sub_f32 v78, v80, v81
    v_sub_f32 v86, v88, v89
    v_fma_f32 v79, v83, 2.0, v82
    v_fma_f32 v87, v91, 2.0, v90
    v_fma_f32 v82, v83, -2.0, v82
    v_fma_f32 v90, v91, -2.0, v90
    v_fmamk_f32 v80, v76, 0x41700000, v82
    v_fmamk_f32 v88, v84, 0x41700000, v90
    v_fmamk_f32 v80, v81, 0x41200000, v80
    v_fmamk_f32 v88, v89, 0x41200000, v88
    v_cvt_pk_bf16_f32 v7, v77, v85
    v_cvt_pk_bf16_f32 v11, v78, v86
    v_cvt_pk_bf16_f32 v67, v79, v87
    v_cvt_pk_bf16_f32 v71, v82, v90
    v_cvt_pk_bf16_f32 v75, v80, v88
    s_add_u32 s28, s28, 1
    s_waitcnt lgkmcnt(0)
    s_barrier
    s_cmp_lt_u32 s28, 12
    s_cselect_b32 s24, 0, 2130706432
    ds_write_b128 v96, v[64:67] offset:49152
    ds_write_b128 v97, v[68:71] offset:0
    ds_write_b128 v97, v[72:75] offset:16384
    ds_write_b128 v96, v[0:3] offset:0
    ds_write_b128 v96, v[4:7] offset:16384
    ds_write_b128 v96, v[8:11] offset:32768
    ds_write_b128 v98, v[12:15] offset:0
    v_lshlrev_b32 v76, 16, v16
    v_and_b32 v84, s25, v16
    buffer_load_dwordx4 v[40:43], v94, s[8:11], s24 offen offset:0
    buffer_load_dwordx4 v[56:59], v94, s[8:11], s24 offen offset:64
    v_add_u32 v94, 128, v94
    v_lshlrev_b32 v77, 16, v20
    v_and_b32 v85, s25, v20
    v_lshlrev_b32 v78, 16, v24
    v_and_b32 v86, s25, v24
    v_lshlrev_b32 v79, 16, v28
    v_and_b32 v87, s25, v28
    v_add_f32 v80, v76, v78
    v_add_f32 v88, v84, v86
    v_add_f32 v81, v77, v79
    v_add_f32 v89, v85, v87
    v_fma_f32 v82, v78, 4.0, v76
    v_fma_f32 v90, v86, 4.0, v84
    v_fma_f32 v83, v79, 4.0, v77
    v_fma_f32 v91, v87, 4.0, v85
    v_add_f32 v77, v80, v81
    v_add_f32 v85, v88, v89
    v_sub_f32 v78, v80, v81
    buffer_load_dwordx4 v[44:47], v95, s[8:11], s24 offen offset:0
    buffer_load_dwordx4 v[60:63], v95, s[8:11], s24 offen offset:64
    v_add_u32 v95, 128, v95
    v_sub_f32 v86, v88, v89
    v_fma_f32 v79, v83, 2.0, v82
    v_fma_f32 v87, v91, 2.0, v90
    v_fma_f32 v82, v83, -2.0, v82
    v_fma_f32 v90, v91, -2.0, v90
    v_fmamk_f32 v80, v76, 0x41700000, v82
    v_fmamk_f32 v88, v84, 0x41700000, v90
    v_fmamk_f32 v80, v81, 0x41200000, v80
    v_fmamk_f32 v88, v89, 0x41200000, v88
    v_cvt_pk_bf16_f32 v20, v77, v85
    v_cvt_pk_bf16_f32 v24, v78, v86
    v_cvt_pk_bf16_f32 v64, v79, v87
    v_cvt_pk_bf16_f32 v68, v82, v90
    v_cvt_pk_bf16_f32 v72, v80, v88
    v_lshlrev_b32 v76, 16, v17
    v_and_b32 v84, s25, v17
    v_lshlrev_b32 v77, 16, v21
    v_and_b32 v85, s25, v21
    v_lshlrev_b32 v78, 16, v25
    v_and_b32 v86, s25, v25
    v_lshlrev_b32 v79, 16, v29
    v_and_b32 v87, s25, v29
    v_add_f32 v80, v76, v78
    v_add_f32 v88, v84, v86
    v_add_f32 v81, v77, v79
    v_add_f32 v89, v85, v87
    v_fma_f32 v82, v78, 4.0, v76
    v_fma_f32 v90, v86, 4.0, v84
    v_fma_f32 v83, v79, 4.0, v77
    v_fma_f32 v91, v87, 4.0, v85
    v_add_f32 v77, v80, v81
    v_add_f32 v85, v88, v89
    v_sub_f32 v78, v80, v81
    v_sub_f32 v86, v88, v89
    v_fma_f32 v79, v83, 2.0, v82
    v_fma_f32 v87, v91, 2.0, v90
    v_fma_f32 v82, v83, -2.0, v82
    v_fma_f32 v90, v91, -2.0, v90
    v_fmamk_f32 v80, v76, 0x41700000, v82
    v_fmamk_f32 v88, v84, 0x41700000, v90
    v_fmamk_f32 v80, v81, 0x41200000, v80
    v_fmamk_f32 v88, v89, 0x41200000, v88
    v_cvt_pk_bf16_f32 v21, v77, v85
    v_cvt_pk_bf16_f32 v25, v78, v86
    v_cvt_pk_bf16_f32 v65, v79, v87
    v_cvt_pk_bf16_f32 v69, v82, v90
    v_cvt_pk_bf16_f32 v73, v80, v88
    v_lshlrev_b32 v76, 16, v18
    v_and_b32 v84, s25, v18
    v_lshlrev_b32 v77, 16, v22
    v_and_b32 v85, s25, v22
    v_lshlrev_b32 v78, 16, v26
    v_and_b32 v86, s25, v26
    v_lshlrev_b32 v79, 16, v30
    v_and_b32 v87, s25, v30
    v_add_f32 v80, v76, v78
    v_add_f32 v88, v84, v86
    v_add_f32 v81, v77, v79
    v_add_f32 v89, v85, v87
    v_fma_f32 v82, v78, 4.0, v76
    v_fma_f32 v90, v86, 4.0, v84
    v_fma_f32 v83, v79, 4.0, v77
    v_fma_f32 v91, v87, 4.0, v85
    v_add_f32 v77, v80, v81
    v_add_f32 v85, v88, v89
    v_sub_f32 v78, v80, v81
    v_sub_f32 v86, v88, v89
    v_fma_f32 v79, v83, 2.0, v82
    v_fma_f32 v87, v91, 2.0, v90
    v_fma_f32 v82, v83, -2.0, v82
    v_fma_f32 v90, v91, -2.0, v90
    v_fmamk_f32 v80, v76, 0x41700000, v82
    v_fmamk_f32 v88, v84, 0x41700000, v90
    v_fmamk_f32 v80, v81, 0x41200000, v80
    v_fmamk_f32 v88, v89, 0x41200000, v88
    v_cvt_pk_bf16_f32 v22, v77, v85
    v_cvt_pk_bf16_f32 v26, v78, v86
    v_cvt_pk_bf16_f32 v66, v79, v87
    v_cvt_pk_bf16_f32 v70, v82, v90
    v_cvt_pk_bf16_f32 v74, v80, v88
    v_lshlrev_b32 v76, 16, v19
    v_and_b32 v84, s25, v19
    v_lshlrev_b32 v77, 16, v23
    v_and_b32 v85, s25, v23
    v_lshlrev_b32 v78, 16, v27
    v_and_b32 v86, s25, v27
    v_lshlrev_b32 v79, 16, v31
    v_and_b32 v87, s25, v31
    v_add_f32 v80, v76, v78
    v_add_f32 v88, v84, v86
    v_add_f32 v81, v77, v79
    v_add_f32 v89, v85, v87
    v_fma_f32 v82, v78, 4.0, v76
    v_fma_f32 v90, v86, 4.0, v84
    v_fma_f32 v83, v79, 4.0, v77
    v_fma_f32 v91, v87, 4.0, v85
    v_add_f32 v77, v80, v81
    v_add_f32 v85, v88, v89
    v_sub_f32 v78, v80, v81
    v_sub_f32 v86, v88, v89
    v_fma_f32 v79, v83, 2.0, v82
    v_fma_f32 v87, v91, 2.0, v90
    v_fma_f32 v82, v83, -2.0, v82
    v_fma_f32 v90, v91, -2.0, v90
    v_fmamk_f32 v80, v76, 0x41700000, v82
    v_fmamk_f32 v88, v84, 0x41700000, v90
    v_fmamk_f32 v80, v81, 0x41200000, v80
    v_fmamk_f32 v88, v89, 0x41200000, v88
    v_cvt_pk_bf16_f32 v23, v77, v85
    v_cvt_pk_bf16_f32 v27, v78, v86
    v_cvt_pk_bf16_f32 v67, v79, v87
    v_cvt_pk_bf16_f32 v71, v82, v90
    v_cvt_pk_bf16_f32 v75, v80, v88
    s_add_u32 s28, s28, 1
    s_waitcnt lgkmcnt(0)
    s_barrier
    s_sub_u32 s22, s22, 1
    s_branch L_conv1_kernel_hloop2
L_conv1_kernel_hlast2:
    s_waitcnt vmcnt(0)
    s_mov_b32 s58, s20
    s_lshl_b32 s20, s2, 2
    s_add_u32 s20, s20, s32
    v_mov_b32 v1, v127
    s_load_dwordx2 s[8:9], s[0:1], 16
    s_lshr_b32 s22, s20, 8
    s_bfe_u32 s23, s20, 0x40004
    s_bfe_u32 s24, s20, 0x30001
    s_and_b32 s21, s20, 1
    v_lshrrev_b32 v2, 4, v1
    v_lshlrev_b32 v2, 12, v2
    v_and_b32 v3, 15, v1
    v_lshl_add_u32 v2, v3, 2, v2
    s_lshl_b32 s26, s22, 3
    s_lshr_b32 s27, s23, 3
    s_add_u32 s26, s26, s27
    s_lshl_b32 s26, s26, 17
    s_and_b32 s27, s23, 7
    s_lshl_b32 s27, s27, 14
    s_add_u32 s26, s26, s27
    s_lshl_b32 s27, s24, 6
    s_add_u32 s26, s26, s27
    s_mov_b32 s10, 4063232
    s_mov_b32 s11, 0x00020000
    s_add_u32 s37, s26, 262144
    s_add_u32 s38, s26, 524288
    s_add_u32 s39, s26, 786432
    s_waitcnt lgkmcnt(0)
    buffer_load_dword v16, v2, s[8:11], s26 offen offset:0
    buffer_load_dword v17, v2, s[8:11], s26 offen offset:512
    buffer_load_dword v24, v2, s[8:11], s37 offen offset:0
    buffer_load_dword v25, v2, s[8:11], s37 offen offset:512
    buffer_load_dword v32, v2, s[8:11], s38 offen offset:0
    buffer_load_dword v33, v2, s[8:11], s38 offen offset:512
    buffer_load_dword v40, v2, s[8:11], s39 offen offset:0
    buffer_load_dword v41, v2, s[8:11], s39 offen offset:512
    buffer_load_dword v18, v2, s[8:11], s26 offen offset:1024
    buffer_load_dword v19, v2, s[8:11], s26 offen offset:1536
    buffer_load_dword v26, v2, s[8:11], s37 offen offset:1024
    buffer_load_dword v27, v2, s[8:11], s37 offen offset:1536
    buffer_load_dword v34, v2, s[8:11], s38 offen offset:1024
    buffer_load_dword v35, v2, s[8:11], s38 offen offset:1536
    buffer_load_dword v42, v2, s[8:11], s39 offen offset:1024
    buffer_load_dword v43, v2, s[8:11], s39 offen offset:1536
    buffer_load_dword v20, v2, s[8:11], s26 offen offset:2048
    buffer_load_dword v21, v2, s[8:11], s26 offen offset:2560
    buffer_load_dword v28, v2, s[8:11], s37 offen offset:2048
    buffer_load_dword v29, v2, s[8:11], s37 offen offset:2560
    buffer_load_dword v36, v2, s[8:11], s38 offen offset:2048
    buffer_load_dword v37, v2, s[8:11], s38 offen offset:2560
    buffer_load_dword v44, v2, s[8:11], s39 offen offset:2048
    buffer_load_dword v45, v2, s[8:11], s39 offen offset:2560
    buffer_load_dword v22, v2, s[8:11], s26 offen offset:3072
    buffer_load_dword v23, v2, s[8:11], s26 offen offset:3584
    buffer_load_dword v30, v2, s[8:11], s37 offen offset:3072
    buffer_load_dword v31, v2, s[8:11], s37 offen offset:3584
    buffer_load_dword v38, v2, s[8:11], s38 offen offset:3072
    buffer_load_dword v39, v2, s[8:11], s38 offen offset:3584
    buffer_load_dword v46, v2, s[8:11], s39 offen offset:3072
    buffer_load_dword v47, v2, s[8:11], s39 offen offset:3584
    s_add_u32 s12, s30, 9437184
    s_addc_u32 s13, s31, 0
    s_mov_b32 s14, 7340032
    s_mov_b32 s15, 0x00020000
    v_lshlrev_b32 v4, 4, v1
    s_lshl_b32 s27, s24, 4
    s_add_u32 s27, s27, s23
    s_mul_i32 s27, s27, 57344
    s_lshl_b32 s28, s22, 11
    s_add_u32 s27, s27, s28
    s_lshl_b32 s28, s21, 10
    s_add_u32 s27, s27, s28
    s_cmp_eq_u32 s21, 0
    s_mov_b32 s32, 0x07060302
    s_cselect_b32 s32, 0x05040100, s32
    s_mov_b32 s33, 0x03020c0c
    s_cselect_b32 s33, 0x01000c0c, s33
    s_mov_b32 s35, 0x3d2aaaab
    s_mov_b32 s36, 0x3c638e39
    s_mov_b32 s25, 0xffff0000
    ds_write_b128 v96, v[64:67] offset:57344
    ds_write_b128 v97, v[68:71] offset:8192
    ds_write_b128 v97, v[72:75] offset:24576
    ds_write_b128 v96, v[48:51] offset:8192
    ds_write_b128 v96, v[52:55] offset:24576
    ds_write_b128 v96, v[56:59] offset:40960
    ds_write_b128 v98, v[60:63] offset:8704
    s_waitcnt lgkmcnt(0)
    s_barrier
    s_waitcnt vmcnt(24)
    v_perm_b32 v72, v17, v16, s32
    v_perm_b32 v48, v41, v40, s32
    v_perm_b32 v76, v76, v40, s33
    v_perm_b32 v84, v84, v41, s33
    v_perm_b32 v77, v77, v32, s33
    v_perm_b32 v85, v85, v33, s33
    v_perm_b32 v78, v78, v24, s33
    v_perm_b32 v86, v86, v25, s33
    v_perm_b32 v79, v79, v16, s33
    v_perm_b32 v87, v87, v17, s33
    v_add_f32 v80, v76, v78
    v_add_f32 v88, v84, v86
    v_add_f32 v81, v77, v79
    v_add_f32 v89, v85, v87
    v_fma_f32 v82, v78, 4.0, v76
    v_fma_f32 v90, v86, 4.0, v84
    v_fma_f32 v83, v79, 4.0, v77
    v_fma_f32 v91, v87, 4.0, v85
    v_add_f32 v77, v80, v81
    v_add_f32 v85, v88, v89
    v_sub_f32 v78, v80, v81
    v_sub_f32 v86, v88, v89
    v_fma_f32 v79, v83, 2.0, v82
    v_fma_f32 v87, v91, 2.0, v90
    v_fma_f32 v82, v83, -2.0, v82
    v_fma_f32 v90, v91, -2.0, v90
    v_fmamk_f32 v80, v76, 0x41700000, v82
    v_fmamk_f32 v88, v84, 0x41700000, v90
    v_fmamk_f32 v80, v81, 0x41200000, v80
    v_fmamk_f32 v88, v89, 0x41200000, v88
    v_mul_f32 v77, 0.5, v77
    v_mul_f32 v85, 0.5, v85
    v_mul_f32 v78, 0.5, v78
    v_mul_f32 v86, 0.5, v86
    v_mul_f32 v79, s35, v79
    v_mul_f32 v87, s35, v87
    v_mul_f32 v82, s35, v82
    v_mul_f32 v90, s35, v90
    v_mul_f32 v80, s36, v80
    v_mul_f32 v88, s36, v88
    v_cvt_pk_bf16_f32 v52, v77, v85
    v_cvt_pk_bf16_f32 v56, v78, v86
    v_cvt_pk_bf16_f32 v60, v79, v87
    v_cvt_pk_bf16_f32 v64, v82, v90
    v_cvt_pk_bf16_f32 v68, v80, v88
    s_waitcnt vmcnt(16)
    v_perm_b32 v73, v19, v18, s32
    v_perm_b32 v49, v43, v42, s32
    v_perm_b32 v76, v76, v42, s33
    v_perm_b32 v84, v84, v43, s33
    v_perm_b32 v77, v77, v34, s33
    v_perm_b32 v85, v85, v35, s33
    v_perm_b32 v78, v78, v26, s33
    v_perm_b32 v86, v86, v27, s33
    v_perm_b32 v79, v79, v18, s33
    v_perm_b32 v87, v87, v19, s33
    v_add_f32 v80, v76, v78
    v_add_f32 v88, v84, v86
    v_add_f32 v81, v77, v79
    v_add_f32 v89, v85, v87
    v_fma_f32 v82, v78, 4.0, v76
    v_fma_f32 v90, v86, 4.0, v84
    v_fma_f32 v83, v79, 4.0, v77
    v_fma_f32 v91, v87, 4.0, v85
    v_add_f32 v77, v80, v81
    v_add_f32 v85, v88, v89
    v_sub_f32 v78, v80, v81
    v_sub_f32 v86, v88, v89
    v_fma_f32 v79, v83, 2.0, v82
    v_fma_f32 v87, v91, 2.0, v90
    v_fma_f32 v82, v83, -2.0, v82
    v_fma_f32 v90, v91, -2.0, v90
    v_fmamk_f32 v80, v76, 0x41700000, v82
    v_fmamk_f32 v88, v84, 0x41700000, v90
    v_fmamk_f32 v80, v81, 0x41200000, v80
    v_fmamk_f32 v88, v89, 0x41200000, v88
    v_mul_f32 v77, 0.5, v77
    v_mul_f32 v85, 0.5, v85
    v_mul_f32 v78, 0.5, v78
    v_mul_f32 v86, 0.5, v86
    v_mul_f32 v79, s35, v79
    v_mul_f32 v87, s35, v87
    v_mul_f32 v82, s35, v82
    v_mul_f32 v90, s35, v90
    v_mul_f32 v80, s36, v80
    v_mul_f32 v88, s36, v88
    v_cvt_pk_bf16_f32 v53, v77, v85
    v_cvt_pk_bf16_f32 v57, v78, v86
    v_cvt_pk_bf16_f32 v61, v79, v87
    v_cvt_pk_bf16_f32 v65, v82, v90
    v_cvt_pk_bf16_f32 v69, v80, v88
    s_waitcnt vmcnt(8)
    v_perm_b32 v74, v21, v20, s32
    v_perm_b32 v50, v45, v44, s32
    v_perm_b32 v76, v76, v44, s33
    v_perm_b32 v84, v84, v45, s33
    v_perm_b32 v77, v77, v36, s33
    v_perm_b32 v85, v85, v37, s33
    v_perm_b32 v78, v78, v28, s33
    v_perm_b32 v86, v86, v29, s33
    v_perm_b32 v79, v79, v20, s33
    v_perm_b32 v87, v87, v21, s33
    v_add_f32 v80, v76, v78
    v_add_f32 v88, v84, v86
    v_add_f32 v81, v77, v79
    v_add_f32 v89, v85, v87
    v_fma_f32 v82, v78, 4.0, v76
    v_fma_f32 v90, v86, 4.0, v84
    v_fma_f32 v83, v79, 4.0, v77
    v_fma_f32 v91, v87, 4.0, v85
    v_add_f32 v77, v80, v81
    v_add_f32 v85, v88, v89
    v_sub_f32 v78, v80, v81
    v_sub_f32 v86, v88, v89
    v_fma_f32 v79, v83, 2.0, v82
    v_fma_f32 v87, v91, 2.0, v90
    v_fma_f32 v82, v83, -2.0, v82
    v_fma_f32 v90, v91, -2.0, v90
    v_fmamk_f32 v80, v76, 0x41700000, v82
    v_fmamk_f32 v88, v84, 0x41700000, v90
    v_fmamk_f32 v80, v81, 0x41200000, v80
    v_fmamk_f32 v88, v89, 0x41200000, v88
    v_mul_f32 v77, 0.5, v77
    v_mul_f32 v85, 0.5, v85
    v_mul_f32 v78, 0.5, v78
    v_mul_f32 v86, 0.5, v86
    v_mul_f32 v79, s35, v79
    v_mul_f32 v87, s35, v87
    v_mul_f32 v82, s35, v82
    v_mul_f32 v90, s35, v90
    v_mul_f32 v80, s36, v80
    v_mul_f32 v88, s36, v88
    v_cvt_pk_bf16_f32 v54, v77, v85
    v_cvt_pk_bf16_f32 v58, v78, v86
    v_cvt_pk_bf16_f32 v62, v79, v87
    v_cvt_pk_bf16_f32 v66, v82, v90
    v_cvt_pk_bf16_f32 v70, v80, v88
    s_waitcnt vmcnt(0)
    v_perm_b32 v75, v23, v22, s32
    v_perm_b32 v51, v47, v46, s32
    v_perm_b32 v76, v76, v46, s33
    v_perm_b32 v84, v84, v47, s33
    v_perm_b32 v77, v77, v38, s33
    v_perm_b32 v85, v85, v39, s33
    v_perm_b32 v78, v78, v30, s33
    v_perm_b32 v86, v86, v31, s33
    v_perm_b32 v79, v79, v22, s33
    v_perm_b32 v87, v87, v23, s33
    v_add_f32 v80, v76, v78
    v_add_f32 v88, v84, v86
    v_add_f32 v81, v77, v79
    v_add_f32 v89, v85, v87
    v_fma_f32 v82, v78, 4.0, v76
    v_fma_f32 v90, v86, 4.0, v84
    v_fma_f32 v83, v79, 4.0, v77
    v_fma_f32 v91, v87, 4.0, v85
    v_add_f32 v77, v80, v81
    v_add_f32 v85, v88, v89
    v_sub_f32 v78, v80, v81
    v_sub_f32 v86, v88, v89
    v_fma_f32 v79, v83, 2.0, v82
    v_fma_f32 v87, v91, 2.0, v90
    v_fma_f32 v82, v83, -2.0, v82
    v_fma_f32 v90, v91, -2.0, v90
    v_fmamk_f32 v80, v76, 0x41700000, v82
    v_fmamk_f32 v88, v84, 0x41700000, v90
    v_fmamk_f32 v80, v81, 0x41200000, v80
    v_fmamk_f32 v88, v89, 0x41200000, v88
    v_mul_f32 v77, 0.5, v77
    v_mul_f32 v85, 0.5, v85
    v_mul_f32 v78, 0.5, v78
    v_mul_f32 v86, 0.5, v86
    v_mul_f32 v79, s35, v79
    v_mul_f32 v87, s35, v87
    v_mul_f32 v82, s35, v82
    v_mul_f32 v90, s35, v90
    v_mul_f32 v80, s36, v80
    v_mul_f32 v88, s36, v88
    v_cvt_pk_bf16_f32 v55, v77, v85
    v_cvt_pk_bf16_f32 v59, v78, v86
    v_cvt_pk_bf16_f32 v63, v79, v87
    v_cvt_pk_bf16_f32 v67, v82, v90
    v_cvt_pk_bf16_f32 v71, v80, v88
    s_add_u32 s28, s27, 49152
    buffer_store_dwordx4 v[72:75], v4, s[12:15], s28 offen sc1
    s_add_u32 s28, s27, 0
    buffer_store_dwordx4 v[48:51], v4, s[12:15], s28 offen sc1
    s_add_u32 s28, s27, 8192
    buffer_store_dwordx4 v[52:55], v4, s[12:15], s28 offen sc1
    s_add_u32 s28, s27, 16384
    buffer_store_dwordx4 v[56:59], v4, s[12:15], s28 offen sc1
    s_add_u32 s28, s27, 24576
    buffer_store_dwordx4 v[60:63], v4, s[12:15], s28 offen sc1
    s_add_u32 s28, s27, 32768
    buffer_store_dwordx4 v[64:67], v4, s[12:15], s28 offen sc1
    s_add_u32 s28, s27, 40960
    buffer_store_dwordx4 v[68:71], v4, s[12:15], s28 offen sc1
    s_mov_b32 s20, s58
    s_branch L_conv1_kernel_end
L_conv1_kernel_epi:
    v_and_b32 v108, 15, v127
    v_lshrrev_b32 v109, 4, v127
    v_lshrrev_b32 v110, 3, v108
    s_lshl_b32 s36, s20, 1
    v_add_u32 v110, s36, v110
    v_xor_b32 v111, v110, v108
    v_and_b32 v111, 7, v111
    v_lshlrev_b32 v111, 4, v111
    v_lshl_add_u32 v111, v110, 7, v111
    v_lshl_add_u32 v120, v109, 11, v111
    v_add_u32 v121, 65536, v120
    v_add_u32 v125, 131072, v120
    s_lshl_b32 s36, s20, 9
    s_add_u32 s36, s36, 115712
    v_lshl_add_u32 v123, v109, 7, s36
    s_lshl_b32 s36, s20, 4
    v_add_u32 v108, s36, v108
    v_lshl_add_u32 v110, v108, 2, s21
    v_lshlrev_b32 v110, 9, v110
    v_lshl_add_u32 v110, v109, 4, v110
    s_lshl_b32 s36, s29, 6
    v_add_u32 v110, s36, v110
    v_mov_b32 v111, 2130706432
    v_cmp_gt_u32 vcc, 125, v108
    s_mov_b32 s4, 0xbeaaaaab
    s_mov_b32 s5, s4
    s_mov_b32 s6, 0x3e800000
    s_mov_b32 s7, s6
    s_mov_b32 s8, 0xc0a00000
    s_mov_b32 s9, s8
    s_mov_b32 s10, 0xc0638e39
    s_mov_b32 s11, s10
    s_mov_b32 s12, 0xbf638e39
    s_mov_b32 s13, s12
    s_mov_b32 s14, 0xbe638e39
    s_mov_b32 s15, s14
    s_mov_b32 s22, 0xbd638e39
    s_mov_b32 s23, s22
    s_mov_b32 s24, 0x3ff1c71c
    s_mov_b32 s25, s24
    s_mov_b32 s26, 0xbf2aaaab
    s_mov_b32 s27, s26
    s_mov_b32 s32, 0x3ecccccd
    s_mov_b32 s33, s32
    s_mov_b32 s34, 0xbd888889
    s_mov_b32 s35, s34
    s_mov_b32 s38, 0xbe4ccccd
    s_mov_b32 s39, s38
    s_mov_b32 s40, 0xbdd2d3e8
    s_mov_b32 s41, s40
    s_mov_b32 s42, 0x3f800000
    s_mov_b32 s43, s42
    s_waitcnt lgkmcnt(0)
    s_barrier
    v_cndmask_b32 v122, v111, v110, vcc
    ds_read_b128 v[0:3], v120 offset:0
    ds_read_b128 v[4:7], v120 offset:16384
    ds_read_b128 v[8:11], v120 offset:32768
    ds_read_b128 v[12:15], v120 offset:49152
    ds_read_b128 v[16:19], v121 offset:0
    ds_read_b128 v[20:23], v121 offset:16384
    ds_read_b128 v[24:27], v121 offset:32768
    ds_read_b128 v[28:31], v125 offset:15360
    ds_read_b128 v[32:35], v120 offset:8192
    ds_read_b128 v[36:39], v120 offset:24576
    ds_read_b128 v[40:43], v120 offset:40960
    ds_read_b128 v[44:47], v120 offset:57344
    ds_read_b128 v[48:51], v121 offset:56320
    ds_read_b128 v[52:55], v121 offset:64512
    ds_read_b128 v[56:59], v125 offset:7168
    s_waitcnt lgkmcnt(7)
    ds_read_b128 v[60:63], v125 offset:23552
    s_waitcnt lgkmcnt(8)
    v_pk_add_f32 v[88:89], v[24:25], v[28:29]
    v_pk_add_f32 v[90:91], v[26:27], v[30:31]
    v_pk_add_f32 v[24:25], v[4:5], v[8:9]
    v_pk_add_f32 v[26:27], v[6:7], v[10:11]
    v_pk_add_f32 v[4:5], v[4:5], v[8:9] neg_lo:[0,1] neg_hi:[0,1]
    v_pk_add_f32 v[6:7], v[6:7], v[10:11] neg_lo:[0,1] neg_hi:[0,1]
    v_pk_add_f32 v[72:73], v[12:13], v[16:17]
    v_pk_add_f32 v[74:75], v[14:15], v[18:19]
    v_pk_add_f32 v[12:13], v[12:13], v[16:17] neg_lo:[0,1] neg_hi:[0,1]
    v_pk_add_f32 v[14:15], v[14:15], v[18:19] neg_lo:[0,1] neg_hi:[0,1]
    v_pk_fma_f32 v[72:73], v[24:25], s[4:5], v[72:73]
    v_pk_fma_f32 v[74:75], v[26:27], s[4:5], v[74:75]
    v_pk_fma_f32 v[20:21], v[0:1], s[10:11], v[20:21]
    v_pk_fma_f32 v[22:23], v[2:3], s[10:11], v[22:23]
    v_pk_fma_f32 v[72:73], v[0:1], s[6:7], v[72:73]
    v_pk_fma_f32 v[74:75], v[2:3], s[6:7], v[74:75]
    v_pk_add_f32 v[24:25], v[24:25], v[0:1] neg_lo:[0,1] neg_hi:[0,1]
    v_pk_add_f32 v[26:27], v[26:27], v[2:3] neg_lo:[0,1] neg_hi:[0,1]
    v_pk_fma_f32 v[72:73], v[88:89], s[8:9], v[72:73]
    v_pk_fma_f32 v[74:75], v[90:91], s[8:9], v[74:75]
    v_pk_add_f32 v[24:25], v[24:25], v[88:89] neg_lo:[0,1] neg_hi:[0,1]
    v_pk_add_f32 v[26:27], v[26:27], v[90:91] neg_lo:[0,1] neg_hi:[0,1]
    v_pk_fma_f32 v[20:21], v[88:89], s[22:23], v[20:21]
    v_pk_fma_f32 v[22:23], v[90:91], s[22:23], v[22:23]
    v_pk_add_f32 v[8:9], v[24:25], v[72:73] neg_lo:[0,1] neg_hi:[0,1]
    v_pk_add_f32 v[10:11], v[26:27], v[74:75] neg_lo:[0,1] neg_hi:[0,1]
    v_pk_fma_f32 v[20:21], v[72:73], s[14:15], v[20:21]
    v_pk_fma_f32 v[22:23], v[74:75], s[14:15], v[22:23]
    v_pk_mul_f32 v[80:81], v[12:13], s[32:33]
    v_pk_mul_f32 v[82:83], v[14:15], s[32:33]
    v_pk_fma_f32 v[20:21], v[8:9], s[12:13], v[20:21]
    v_pk_fma_f32 v[22:23], v[10:11], s[12:13], v[22:23]
    v_pk_fma_f32 v[80:81], v[4:5], s[34:35], v[80:81]
    v_pk_fma_f32 v[82:83], v[6:7], s[34:35], v[82:83]
    v_pk_fma_f32 v[64:65], v[4:5], s[24:25], v[20:21] neg_lo:[0,0,1] neg_hi:[0,0,1]
    v_pk_fma_f32 v[66:67], v[6:7], s[24:25], v[22:23] neg_lo:[0,0,1] neg_hi:[0,0,1]
    v_pk_fma_f32 v[64:65], v[12:13], s[26:27], v[64:65]
    v_pk_fma_f32 v[66:67], v[14:15], s[26:27], v[66:67]
    v_pk_fma_f32 v[80:81], v[64:65], s[38:39], v[80:81]
    v_pk_fma_f32 v[82:83], v[66:67], s[38:39], v[82:83]
    v_pk_add_f32 v[4:5], v[4:5], v[64:65] neg_lo:[0,1] neg_hi:[0,1]
    v_pk_add_f32 v[6:7], v[6:7], v[66:67] neg_lo:[0,1] neg_hi:[0,1]
    v_pk_add_f32 v[4:5], v[4:5], v[80:81] neg_lo:[0,1] neg_hi:[0,1]
    v_pk_add_f32 v[6:7], v[6:7], v[82:83] neg_lo:[0,1] neg_hi:[0,1]
    s_waitcnt lgkmcnt(0)
    v_pk_add_f32 v[92:93], v[56:57], v[60:61]
    v_pk_add_f32 v[94:95], v[58:59], v[62:63]
    v_pk_add_f32 v[56:57], v[36:37], v[40:41]
    v_pk_add_f32 v[58:59], v[38:39], v[42:43]
    v_pk_add_f32 v[36:37], v[36:37], v[40:41] neg_lo:[0,1] neg_hi:[0,1]
    v_pk_add_f32 v[38:39], v[38:39], v[42:43] neg_lo:[0,1] neg_hi:[0,1]
    v_pk_add_f32 v[76:77], v[44:45], v[48:49]
    v_pk_add_f32 v[78:79], v[46:47], v[50:51]
    v_pk_add_f32 v[44:45], v[44:45], v[48:49] neg_lo:[0,1] neg_hi:[0,1]
    v_pk_add_f32 v[46:47], v[46:47], v[50:51] neg_lo:[0,1] neg_hi:[0,1]
    v_pk_fma_f32 v[76:77], v[56:57], s[4:5], v[76:77]
    v_pk_fma_f32 v[78:79], v[58:59], s[4:5], v[78:79]
    v_pk_fma_f32 v[52:53], v[32:33], s[10:11], v[52:53]
    v_pk_fma_f32 v[54:55], v[34:35], s[10:11], v[54:55]
    v_pk_fma_f32 v[76:77], v[32:33], s[6:7], v[76:77]
    v_pk_fma_f32 v[78:79], v[34:35], s[6:7], v[78:79]
    v_pk_add_f32 v[56:57], v[56:57], v[32:33] neg_lo:[0,1] neg_hi:[0,1]
    v_pk_add_f32 v[58:59], v[58:59], v[34:35] neg_lo:[0,1] neg_hi:[0,1]
    v_pk_fma_f32 v[76:77], v[92:93], s[8:9], v[76:77]
    v_pk_fma_f32 v[78:79], v[94:95], s[8:9], v[78:79]
    v_pk_add_f32 v[56:57], v[56:57], v[92:93] neg_lo:[0,1] neg_hi:[0,1]
    v_pk_add_f32 v[58:59], v[58:59], v[94:95] neg_lo:[0,1] neg_hi:[0,1]
    v_pk_fma_f32 v[52:53], v[92:93], s[22:23], v[52:53]
    v_pk_fma_f32 v[54:55], v[94:95], s[22:23], v[54:55]
    v_pk_add_f32 v[40:41], v[56:57], v[76:77] neg_lo:[0,1] neg_hi:[0,1]
    v_pk_add_f32 v[42:43], v[58:59], v[78:79] neg_lo:[0,1] neg_hi:[0,1]
    v_pk_fma_f32 v[52:53], v[76:77], s[14:15], v[52:53]
    v_pk_fma_f32 v[54:55], v[78:79], s[14:15], v[54:55]
    v_pk_mul_f32 v[84:85], v[44:45], s[32:33]
    v_pk_mul_f32 v[86:87], v[46:47], s[32:33]
    v_pk_fma_f32 v[52:53], v[40:41], s[12:13], v[52:53]
    v_pk_fma_f32 v[54:55], v[42:43], s[12:13], v[54:55]
    v_pk_fma_f32 v[84:85], v[36:37], s[34:35], v[84:85]
    v_pk_fma_f32 v[86:87], v[38:39], s[34:35], v[86:87]
    v_pk_fma_f32 v[68:69], v[36:37], s[24:25], v[52:53] neg_lo:[0,0,1] neg_hi:[0,0,1]
    v_pk_fma_f32 v[70:71], v[38:39], s[24:25], v[54:55] neg_lo:[0,0,1] neg_hi:[0,0,1]
    v_pk_fma_f32 v[68:69], v[44:45], s[26:27], v[68:69]
    v_pk_fma_f32 v[70:71], v[46:47], s[26:27], v[70:71]
    v_pk_fma_f32 v[84:85], v[68:69], s[38:39], v[84:85]
    v_pk_fma_f32 v[86:87], v[70:71], s[38:39], v[86:87]
    v_pk_add_f32 v[36:37], v[36:37], v[68:69] neg_lo:[0,1] neg_hi:[0,1]
    v_pk_add_f32 v[38:39], v[38:39], v[70:71] neg_lo:[0,1] neg_hi:[0,1]
    v_pk_add_f32 v[36:37], v[36:37], v[84:85] neg_lo:[0,1] neg_hi:[0,1]
    v_pk_add_f32 v[38:39], v[38:39], v[86:87] neg_lo:[0,1] neg_hi:[0,1]
    s_mov_b32 s36, 0x00010001
    s_mov_b32 s37, 0x00010001
    s_mov_b64 exec, s[36:37]
    ds_write_b128 v123, v[0:3] offset:0
    ds_write_b128 v123, v[32:35] offset:16
    ds_write_b128 v123, v[4:7] offset:32
    ds_write_b128 v123, v[36:39] offset:48
    ds_write_b128 v123, v[8:11] offset:64
    ds_write_b128 v123, v[40:43] offset:80
    s_mov_b64 exec, -1
    v_mov_b32 v44, 0xc0135761
    v_mov_b32 v45, v44
    v_pk_mul_f32 v[16:17], v[64:65], v[64:65]
    v_pk_mul_f32 v[18:19], v[66:67], v[66:67]
    v_pk_mul_f32 v[20:21], v[68:69], v[68:69]
    v_pk_mul_f32 v[22:23], v[70:71], v[70:71]
    v_pk_fma_f32 v[16:17], v[16:17], s[40:41], v[44:45]
    v_pk_fma_f32 v[18:19], v[18:19], s[40:41], v[44:45]
    v_pk_fma_f32 v[20:21], v[20:21], s[40:41], v[44:45]
    v_pk_fma_f32 v[22:23], v[22:23], s[40:41], v[44:45]
    v_pk_mul_f32 v[16:17], v[16:17], v[64:65]
    v_pk_mul_f32 v[18:19], v[18:19], v[66:67]
    v_pk_mul_f32 v[20:21], v[20:21], v[68:69]
    v_pk_mul_f32 v[22:23], v[22:23], v[70:71]
    v_exp_f32 v16, v16
    v_exp_f32 v17, v17
    v_exp_f32 v18, v18
    v_exp_f32 v19, v19
    v_exp_f32 v20, v20
    v_exp_f32 v21, v21
    v_exp_f32 v22, v22
    v_exp_f32 v23, v23
    v_pk_add_f32 v[16:17], v[16:17], s[42:43]
    v_pk_add_f32 v[18:19], v[18:19], s[42:43]
    v_pk_add_f32 v[20:21], v[20:21], s[42:43]
    v_pk_add_f32 v[22:23], v[22:23], s[42:43]
    v_rcp_f32 v16, v16
    v_rcp_f32 v17, v17
    v_rcp_f32 v18, v18
    v_rcp_f32 v19, v19
    v_rcp_f32 v20, v20
    v_rcp_f32 v21, v21
    v_rcp_f32 v22, v22
    v_rcp_f32 v23, v23
    v_pk_mul_f32 v[64:65], v[64:65], v[16:17]
    v_pk_mul_f32 v[66:67], v[66:67], v[18:19]
    v_pk_mul_f32 v[68:69], v[68:69], v[20:21]
    v_pk_mul_f32 v[70:71], v[70:71], v[22:23]
    v_cvt_pk_bf16_f32 v48, v64, v68
    v_cvt_pk_bf16_f32 v49, v65, v69
    v_cvt_pk_bf16_f32 v50, v66, v70
    v_cvt_pk_bf16_f32 v51, v67, v71
    buffer_store_dwordx4 v[48:51], v122, s[16:19], 0 offen offset:0 sc1
    s_waitcnt lgkmcnt(0)
    s_barrier
    ds_read_b128 v[96:99], v123 offset:512
    ds_read_b128 v[100:103], v123 offset:528
    ds_read_b128 v[104:107], v123 offset:544
    ds_read_b128 v[108:111], v123 offset:560
    ds_read_b128 v[112:115], v123 offset:576
    ds_read_b128 v[116:119], v123 offset:592
    s_waitcnt lgkmcnt(4)
    v_mov_b32_dpp v96, v0 row_shl:1 row_mask:0xf bank_mask:0xf
    v_mov_b32_dpp v97, v1 row_shl:1 row_mask:0xf bank_mask:0xf
    v_mov_b32_dpp v98, v2 row_shl:1 row_mask:0xf bank_mask:0xf
    v_mov_b32_dpp v99, v3 row_shl:1 row_mask:0xf bank_mask:0xf
    v_mov_b32_dpp v100, v32 row_shl:1 row_mask:0xf bank_mask:0xf
    v_mov_b32_dpp v101, v33 row_shl:1 row_mask:0xf bank_mask:0xf
    v_mov_b32_dpp v102, v34 row_shl:1 row_mask:0xf bank_mask:0xf
    v_mov_b32_dpp v103, v35 row_shl:1 row_mask:0xf bank_mask:0xf
    v_pk_add_f32 v[72:73], v[72:73], v[96:97]
    v_pk_add_f32 v[74:75], v[74:75], v[98:99]
    v_pk_add_f32 v[76:77], v[76:77], v[100:101]
    v_pk_add_f32 v[78:79], v[78:79], v[102:103]
    v_pk_mul_f32 v[24:25], v[72:73], v[72:73]
    v_pk_mul_f32 v[26:27], v[74:75], v[74:75]
    v_pk_mul_f32 v[28:29], v[76:77], v[76:77]
    v_pk_mul_f32 v[30:31], v[78:79], v[78:79]
    v_pk_fma_f32 v[24:25], v[24:25], s[40:41], v[44:45]
    v_pk_fma_f32 v[26:27], v[26:27], s[40:41], v[44:45]
    v_pk_fma_f32 v[28:29], v[28:29], s[40:41], v[44:45]
    v_pk_fma_f32 v[30:31], v[30:31], s[40:41], v[44:45]
    v_pk_mul_f32 v[24:25], v[24:25], v[72:73]
    v_pk_mul_f32 v[26:27], v[26:27], v[74:75]
    v_pk_mul_f32 v[28:29], v[28:29], v[76:77]
    v_pk_mul_f32 v[30:31], v[30:31], v[78:79]
    v_exp_f32 v24, v24
    v_exp_f32 v25, v25
    v_exp_f32 v26, v26
    v_exp_f32 v27, v27
    v_exp_f32 v28, v28
    v_exp_f32 v29, v29
    v_exp_f32 v30, v30
    v_exp_f32 v31, v31
    v_pk_add_f32 v[24:25], v[24:25], s[42:43]
    v_pk_add_f32 v[26:27], v[26:27], s[42:43]
    v_pk_add_f32 v[28:29], v[28:29], s[42:43]
    v_pk_add_f32 v[30:31], v[30:31], s[42:43]
    v_rcp_f32 v24, v24
    v_rcp_f32 v25, v25
    v_rcp_f32 v26, v26
    v_rcp_f32 v27, v27
    v_rcp_f32 v28, v28
    v_rcp_f32 v29, v29
    v_rcp_f32 v30, v30
    v_rcp_f32 v31, v31
    v_pk_mul_f32 v[72:73], v[72:73], v[24:25]
    v_pk_mul_f32 v[74:75], v[74:75], v[26:27]
    v_pk_mul_f32 v[76:77], v[76:77], v[28:29]
    v_pk_mul_f32 v[78:79], v[78:79], v[30:31]
    v_cvt_pk_bf16_f32 v52, v72, v76
    v_cvt_pk_bf16_f32 v53, v73, v77
    v_cvt_pk_bf16_f32 v54, v74, v78
    v_cvt_pk_bf16_f32 v55, v75, v79
    buffer_store_dwordx4 v[52:55], v122, s[16:19], 0 offen offset:512 sc1
    s_waitcnt lgkmcnt(2)
    v_mov_b32_dpp v104, v4 row_shl:1 row_mask:0xf bank_mask:0xf
    v_mov_b32_dpp v105, v5 row_shl:1 row_mask:0xf bank_mask:0xf
    v_mov_b32_dpp v106, v6 row_shl:1 row_mask:0xf bank_mask:0xf
    v_mov_b32_dpp v107, v7 row_shl:1 row_mask:0xf bank_mask:0xf
    v_mov_b32_dpp v108, v36 row_shl:1 row_mask:0xf bank_mask:0xf
    v_mov_b32_dpp v109, v37 row_shl:1 row_mask:0xf bank_mask:0xf
    v_mov_b32_dpp v110, v38 row_shl:1 row_mask:0xf bank_mask:0xf
    v_mov_b32_dpp v111, v39 row_shl:1 row_mask:0xf bank_mask:0xf
    v_pk_add_f32 v[80:81], v[80:81], v[104:105]
    v_pk_add_f32 v[82:83], v[82:83], v[106:107]
    v_pk_add_f32 v[84:85], v[84:85], v[108:109]
    v_pk_add_f32 v[86:87], v[86:87], v[110:111]
    v_pk_mul_f32 v[16:17], v[80:81], v[80:81]
    v_pk_mul_f32 v[18:19], v[82:83], v[82:83]
    v_pk_mul_f32 v[20:21], v[84:85], v[84:85]
    v_pk_mul_f32 v[22:23], v[86:87], v[86:87]
    v_pk_fma_f32 v[16:17], v[16:17], s[40:41], v[44:45]
    v_pk_fma_f32 v[18:19], v[18:19], s[40:41], v[44:45]
    v_pk_fma_f32 v[20:21], v[20:21], s[40:41], v[44:45]
    v_pk_fma_f32 v[22:23], v[22:23], s[40:41], v[44:45]
    v_pk_mul_f32 v[16:17], v[16:17], v[80:81]
    v_pk_mul_f32 v[18:19], v[18:19], v[82:83]
    v_pk_mul_f32 v[20:21], v[20:21], v[84:85]
    v_pk_mul_f32 v[22:23], v[22:23], v[86:87]
    v_exp_f32 v16, v16
    v_exp_f32 v17, v17
    v_exp_f32 v18, v18
    v_exp_f32 v19, v19
    v_exp_f32 v20, v20
    v_exp_f32 v21, v21
    v_exp_f32 v22, v22
    v_exp_f32 v23, v23
    v_pk_add_f32 v[16:17], v[16:17], s[42:43]
    v_pk_add_f32 v[18:19], v[18:19], s[42:43]
    v_pk_add_f32 v[20:21], v[20:21], s[42:43]
    v_pk_add_f32 v[22:23], v[22:23], s[42:43]
    v_rcp_f32 v16, v16
    v_rcp_f32 v17, v17
    v_rcp_f32 v18, v18
    v_rcp_f32 v19, v19
    v_rcp_f32 v20, v20
    v_rcp_f32 v21, v21
    v_rcp_f32 v22, v22
    v_rcp_f32 v23, v23
    v_pk_mul_f32 v[80:81], v[80:81], v[16:17]
    v_pk_mul_f32 v[82:83], v[82:83], v[18:19]
    v_pk_mul_f32 v[84:85], v[84:85], v[20:21]
    v_pk_mul_f32 v[86:87], v[86:87], v[22:23]
    v_cvt_pk_bf16_f32 v56, v80, v84
    v_cvt_pk_bf16_f32 v57, v81, v85
    v_cvt_pk_bf16_f32 v58, v82, v86
    v_cvt_pk_bf16_f32 v59, v83, v87
    buffer_store_dwordx4 v[56:59], v122, s[16:19], 0 offen offset:1024 sc1
    s_waitcnt lgkmcnt(0)
    v_mov_b32_dpp v112, v8 row_shl:1 row_mask:0xf bank_mask:0xf
    v_mov_b32_dpp v113, v9 row_shl:1 row_mask:0xf bank_mask:0xf
    v_mov_b32_dpp v114, v10 row_shl:1 row_mask:0xf bank_mask:0xf
    v_mov_b32_dpp v115, v11 row_shl:1 row_mask:0xf bank_mask:0xf
    v_mov_b32_dpp v116, v40 row_shl:1 row_mask:0xf bank_mask:0xf
    v_mov_b32_dpp v117, v41 row_shl:1 row_mask:0xf bank_mask:0xf
    v_mov_b32_dpp v118, v42 row_shl:1 row_mask:0xf bank_mask:0xf
    v_mov_b32_dpp v119, v43 row_shl:1 row_mask:0xf bank_mask:0xf
    v_pk_add_f32 v[88:89], v[88:89], v[112:113]
    v_pk_add_f32 v[90:91], v[90:91], v[114:115]
    v_pk_add_f32 v[92:93], v[92:93], v[116:117]
    v_pk_add_f32 v[94:95], v[94:95], v[118:119]
    v_pk_mul_f32 v[24:25], v[88:89], v[88:89]
    v_pk_mul_f32 v[26:27], v[90:91], v[90:91]
    v_pk_mul_f32 v[28:29], v[92:93], v[92:93]
    v_pk_mul_f32 v[30:31], v[94:95], v[94:95]
    v_pk_fma_f32 v[24:25], v[24:25], s[40:41], v[44:45]
    v_pk_fma_f32 v[26:27], v[26:27], s[40:41], v[44:45]
    v_pk_fma_f32 v[28:29], v[28:29], s[40:41], v[44:45]
    v_pk_fma_f32 v[30:31], v[30:31], s[40:41], v[44:45]
    v_pk_mul_f32 v[24:25], v[24:25], v[88:89]
    v_pk_mul_f32 v[26:27], v[26:27], v[90:91]
    v_pk_mul_f32 v[28:29], v[28:29], v[92:93]
    v_pk_mul_f32 v[30:31], v[30:31], v[94:95]
    v_exp_f32 v24, v24
    v_exp_f32 v25, v25
    v_exp_f32 v26, v26
    v_exp_f32 v27, v27
    v_exp_f32 v28, v28
    v_exp_f32 v29, v29
    v_exp_f32 v30, v30
    v_exp_f32 v31, v31
    v_pk_add_f32 v[24:25], v[24:25], s[42:43]
    v_pk_add_f32 v[26:27], v[26:27], s[42:43]
    v_pk_add_f32 v[28:29], v[28:29], s[42:43]
    v_pk_add_f32 v[30:31], v[30:31], s[42:43]
    v_rcp_f32 v24, v24
    v_rcp_f32 v25, v25
    v_rcp_f32 v26, v26
    v_rcp_f32 v27, v27
    v_rcp_f32 v28, v28
    v_rcp_f32 v29, v29
    v_rcp_f32 v30, v30
    v_rcp_f32 v31, v31
    v_pk_mul_f32 v[88:89], v[88:89], v[24:25]
    v_pk_mul_f32 v[90:91], v[90:91], v[26:27]
    v_pk_mul_f32 v[92:93], v[92:93], v[28:29]
    v_pk_mul_f32 v[94:95], v[94:95], v[30:31]
    v_cvt_pk_bf16_f32 v60, v88, v92
    v_cvt_pk_bf16_f32 v61, v89, v93
    v_cvt_pk_bf16_f32 v62, v90, v94
    v_cvt_pk_bf16_f32 v63, v91, v95
    buffer_store_dwordx4 v[60:63], v122, s[16:19], 0 offen offset:1536 sc1
L_conv1_kernel_end:
L_conv1_kernel_done:
    s_endpgm
.globl conv2_kernel
.p2align 8
.type conv2_kernel,@function
conv2_kernel:
    s_cmp_ge_u32 s2, 256
    s_cbranch_scc1 L_conv2_kernel_done
    s_load_dwordx2 s[4:5], s[0:1], 72
    s_load_dwordx2 s[30:31], s[0:1], 72
    v_readfirstlane_b32 s20, v0
    s_lshr_b32 s20, s20, 6
    s_and_b32 s36, s2, 0
    s_lshl_b32 s36, s36, 3
    s_bfe_u32 s37, s2, 196611
    s_or_b32 s29, s36, s37
    s_bfe_u32 s36, s2, 196608
    s_lshl_b32 s36, s36, 2
    s_lshr_b32 s37, s2, 6
    s_or_b32 s36, s36, s37
    s_lshr_b32 s33, s36, 4
    s_and_b32 s34, s36, 7
    s_bfe_u32 s35, s36, 0x10003
    s_mul_i32 s21, s34, 500
    s_and_b32 s32, s20, 3
    v_and_b32 v127, 63, v0
    v_lshrrev_b32 v5, 2, v127
    v_and_b32 v6, 3, v127
    v_lshlrev_b32 v7, 15, v5
    v_lshl_add_u32 v7, v6, 4, v7
    s_lshl_b32 s41, s21, 10
    s_lshl_b32 s37, s33, 9
    s_add_u32 s41, s41, s37
    s_sub_u32 s41, s41, 7680
    s_and_b32 s42, s20, 7
    s_lshl_b32 s37, s42, 12
    s_add_u32 s37, s37, s41
    v_add_u32 v7, s37, v7
    s_mul_i32 s36, s35, 4096000
    s_add_u32 s36, s36, 18874368
    s_mov_b32 s10, 4096000
    s_mov_b32 s11, 0x00020000
    s_mov_b32 s25, 0xffff0000
    s_waitcnt lgkmcnt(0)
    s_add_u32 s8, s4, s36
    s_addc_u32 s9, s5, 0
    s_cmp_ge_u32 s20, 8
    s_cbranch_scc1 L_conv2_kernel_helper
    s_add_u32 s37, s41, 524288
    v_lshl_add_u32 v108, v127, 4, s37
    s_lshl_b32 s36, s29, 4
    s_lshl_b32 s37, s33, 3
    s_add_u32 s36, s36, s37
    s_mul_i32 s36, s36, 57344
    s_add_u32 s36, s36, 9437184
    s_add_u32 s12, s30, s36
    s_addc_u32 s13, s31, 0
    s_mov_b32 s14, 458752
    s_mov_b32 s15, 0x00020000
    s_mul_i32 s36, s35, 2048000
    s_add_u32 s36, s36, 27262976
    s_mul_i32 s37, s33, 8388608
    s_add_u32 s36, s36, s37
    s_add_u32 s16, s30, s36
    s_addc_u32 s17, s31, 0
    s_mov_b32 s18, 2048000
    s_mov_b32 s19, 0x00020000
    v_and_b32 v10, 15, v127
    v_lshrrev_b32 v11, 4, v127
    v_add_u32 v8, 0, v10
    v_and_b32 v16, 4, v8
    v_lshrrev_b32 v16, 1, v16
    v_xor_b32 v16, v11, v16
    v_lshlrev_b32 v16, 4, v16
    v_lshl_add_u32 v8, v8, 6, v16
    v_add_u32 v9, 1, v10
    v_and_b32 v16, 4, v9
    v_lshrrev_b32 v16, 1, v16
    v_xor_b32 v16, v11, v16
    v_lshlrev_b32 v16, 4, v16
    v_lshl_add_u32 v9, v9, 6, v16
    s_lshr_b32 s38, s32, 1
    s_and_b32 s39, s32, 1
    s_add_u32 s40, s38, 4
    s_lshl_b32 s43, s39, 10
    s_cmp_lt_u32 s20, 4
    s_cselect_b32 s40, s20, s40
    s_cselect_b32 s36, 0, s43
    s_lshl_b32 s37, s40, 13
    s_add_u32 s37, s37, s36
    v_lshl_add_u32 v125, v127, 4, s37
    s_mul_i32 s37, s40, 16384
    v_add_u32 v120, s37, v8
    v_add_u32 v121, s37, v9
    s_lshl_b32 s37, s40, 10
    s_add_u32 s37, s37, 115712
    v_lshl_add_u32 v16, v11, 4, s37
    v_cmp_eq_u32 vcc, 15, v10
    v_mov_b32 v17, 8192
    v_mov_b32 v18, 4294959104
    v_mov_b32 v19, 64
    v_cndmask_b32 v122, v121, v16, vcc
    v_cndmask_b32 v123, v17, v19, vcc
    v_cndmask_b32 v124, v18, v19, vcc
    v_lshl_add_u32 v126, v127, 4, s37
    s_mov_b32 s44, 0x3f800000
    s_mov_b32 s45, 0x00000000
    s_mov_b32 s46, 0x00000000
    s_cmp_eq_u32 s40, 1
    s_cselect_b32 s45, 0x3f800000, s45
    s_cselect_b32 s46, 0x3f800000, s46
    s_cmp_eq_u32 s40, 2
    s_cselect_b32 s45, 0xbf800000, s45
    s_cselect_b32 s46, 0x3f800000, s46
    s_cmp_eq_u32 s40, 3
    s_cselect_b32 s45, 0x40000000, s45
    s_cselect_b32 s46, 0x40800000, s46
    s_cmp_eq_u32 s40, 4
    s_cselect_b32 s45, 0xc0000000, s45
    s_cselect_b32 s46, 0x40800000, s46
    s_cmp_eq_u32 s40, 5
    s_cselect_b32 s44, 0x41800000, s44
    s_cselect_b32 s45, 0x41000000, s45
    s_cselect_b32 s46, 0x40800000, s46
    s_cmp_ge_u32 s20, 4
    s_cbranch_scc1 L_conv2_kernel_m2
    v_mov_b32 v0, 0
    v_mov_b32 v1, 0
    v_mov_b32 v2, 0
    v_mov_b32 v3, 0
    v_mov_b32 v4, 0
    v_mov_b32 v5, 0
    v_mov_b32 v6, 0
    v_mov_b32 v7, 0
    v_mov_b32 v8, 0
    v_mov_b32 v9, 0
    v_mov_b32 v10, 0
    v_mov_b32 v11, 0
    v_mov_b32 v12, 0
    v_mov_b32 v13, 0
    v_mov_b32 v14, 0
    v_mov_b32 v15, 0
    v_mov_b32 v16, 0
    v_mov_b32 v17, 0
    v_mov_b32 v18, 0
    v_mov_b32 v19, 0
    v_mov_b32 v20, 0
    v_mov_b32 v21, 0
    v_mov_b32 v22, 0
    v_mov_b32 v23, 0
    v_mov_b32 v24, 0
    v_mov_b32 v25, 0
    v_mov_b32 v26, 0
    v_mov_b32 v27, 0
    v_mov_b32 v28, 0
    v_mov_b32 v29, 0
    v_mov_b32 v30, 0
    v_mov_b32 v31, 0
    v_mov_b32 v32, 0
    v_mov_b32 v33, 0
    v_mov_b32 v34, 0
    v_mov_b32 v35, 0
    v_mov_b32 v36, 0
    v_mov_b32 v37, 0
    v_mov_b32 v38, 0
    v_mov_b32 v39, 0
    v_mov_b32 v40, 0
    v_mov_b32 v41, 0
    v_mov_b32 v42, 0
    v_mov_b32 v43, 0
    v_mov_b32 v44, 0
    v_mov_b32 v45, 0
    v_mov_b32 v46, 0
    v_mov_b32 v47, 0
    v_mov_b32 v48, 0
    v_mov_b32 v49, 0
    v_mov_b32 v50, 0
    v_mov_b32 v51, 0
    v_mov_b32 v52, 0
    v_mov_b32 v53, 0
    v_mov_b32 v54, 0
    v_mov_b32 v55, 0
    v_mov_b32 v56, 0
    v_mov_b32 v57, 0
    v_mov_b32 v58, 0
    v_mov_b32 v59, 0
    v_mov_b32 v60, 0
    v_mov_b32 v61, 0
    v_mov_b32 v62, 0
    v_mov_b32 v63, 0
    s_barrier
    buffer_load_dwordx4 v[96:99], v108, s[8:11], 0 offen offset:0
    buffer_load_dwordx4 v[100:103], v108, s[8:11], 0 offen offset:1024
    buffer_load_dwordx4 v[104:107], v108, s[8:11], 0 offen offset:2048
    s_mov_b32 s23, 0
    s_mov_b32 s26, 4096
    buffer_load_dwordx4 v[64:67], v125, s[12:15], s23 offen offset:0
    buffer_load_dwordx4 v[68:71], v125, s[12:15], s23 offen offset:1024
    buffer_load_dwordx4 v[72:75], v125, s[12:15], s23 offen offset:2048
    buffer_load_dwordx4 v[76:79], v125, s[12:15], s23 offen offset:3072
    buffer_load_dwordx4 v[80:83], v125, s[12:15], s26 offen offset:0
    buffer_load_dwordx4 v[84:87], v125, s[12:15], s26 offen offset:1024
    buffer_load_dwordx4 v[88:91], v125, s[12:15], s26 offen offset:2048
    buffer_load_dwordx4 v[92:95], v125, s[12:15], s26 offen offset:3072
    s_mov_b32 s23, 57344
    s_mov_b32 s26, 61440
    s_waitcnt vmcnt(8)
    v_lshlrev_b32 v108, 16, v96
    v_and_b32 v111, s25, v96
    v_lshlrev_b32 v109, 16, v100
    v_and_b32 v112, s25, v100
    v_lshlrev_b32 v110, 16, v104
    v_and_b32 v113, s25, v104
    v_mul_f32 v114, s44, v108
    v_mul_f32 v115, s44, v111
    v_fmac_f32 v114, s45, v109
    v_fmac_f32 v115, s45, v112
    v_fmac_f32 v114, s46, v110
    v_fmac_f32 v115, s46, v113
    v_cvt_pk_bf16_f32 v96, v114, v115
    v_lshlrev_b32 v108, 16, v97
    v_and_b32 v111, s25, v97
    v_lshlrev_b32 v109, 16, v101
    v_and_b32 v112, s25, v101
    v_lshlrev_b32 v110, 16, v105
    v_and_b32 v113, s25, v105
    v_mul_f32 v114, s44, v108
    v_mul_f32 v115, s44, v111
    v_fmac_f32 v114, s45, v109
    v_fmac_f32 v115, s45, v112
    v_fmac_f32 v114, s46, v110
    v_fmac_f32 v115, s46, v113
    v_cvt_pk_bf16_f32 v97, v114, v115
    v_lshlrev_b32 v108, 16, v98
    v_and_b32 v111, s25, v98
    v_lshlrev_b32 v109, 16, v102
    v_and_b32 v112, s25, v102
    v_lshlrev_b32 v110, 16, v106
    v_and_b32 v113, s25, v106
    v_mul_f32 v114, s44, v108
    v_mul_f32 v115, s44, v111
    v_fmac_f32 v114, s45, v109
    v_fmac_f32 v115, s45, v112
    v_fmac_f32 v114, s46, v110
    v_fmac_f32 v115, s46, v113
    v_cvt_pk_bf16_f32 v98, v114, v115
    v_lshlrev_b32 v108, 16, v99
    v_and_b32 v111, s25, v99
    v_lshlrev_b32 v109, 16, v103
    v_and_b32 v112, s25, v103
    v_lshlrev_b32 v110, 16, v107
    v_and_b32 v113, s25, v107
    v_mul_f32 v114, s44, v108
    v_mul_f32 v115, s44, v111
    v_fmac_f32 v114, s45, v109
    v_fmac_f32 v115, s45, v112
    v_fmac_f32 v114, s46, v110
    v_fmac_f32 v115, s46, v113
    v_cvt_pk_bf16_f32 v99, v114, v115
    ds_write_b128 v126, v[96:99]
    s_waitcnt lgkmcnt(0)
    s_barrier
    s_mov_b32 s22, 4
    s_setprio 2
L_conv2_kernel_mloop1:
    ds_read_b128 v[96:99], v120 offset:0
    ds_read_b128 v[100:103], v120 offset:1024
    ds_read_b128 v[104:107], v120 offset:2048
    ds_read_b128 v[108:111], v120 offset:3072
    ds_read_b128 v[112:115], v120 offset:4096
    ds_read_b128 v[116:119], v120 offset:5120
    s_waitcnt vmcnt(6) lgkmcnt(5)
    v_mfma_f32_16x16x32_bf16 v[0:3], v[64:67], v[96:99], v[0:3]
    v_mfma_f32_16x16x32_bf16 v[32:35], v[68:71], v[96:99], v[32:35]
    ds_read_b128 v[96:99], v120 offset:6144
    s_waitcnt vmcnt(4) lgkmcnt(5)
    v_mfma_f32_16x16x32_bf16 v[4:7], v[64:67], v[100:103], v[4:7]
    v_mfma_f32_16x16x32_bf16 v[36:39], v[68:71], v[100:103], v[36:39]
    v_mfma_f32_16x16x32_bf16 v[0:3], v[72:75], v[100:103], v[0:3]
    v_mfma_f32_16x16x32_bf16 v[32:35], v[76:79], v[100:103], v[32:35]
    ds_read_b128 v[100:103], v120 offset:7168
    s_waitcnt vmcnt(2) lgkmcnt(5)
    v_mfma_f32_16x16x32_bf16 v[8:11], v[64:67], v[104:107], v[8:11]
    v_mfma_f32_16x16x32_bf16 v[40:43], v[68:71], v[104:107], v[40:43]
    v_mfma_f32_16x16x32_bf16 v[4:7], v[72:75], v[104:107], v[4:7]
    v_mfma_f32_16x16x32_bf16 v[36:39], v[76:79], v[104:107], v[36:39]
    v_mfma_f32_16x16x32_bf16 v[0:3], v[80:83], v[104:107], v[0:3]
    v_mfma_f32_16x16x32_bf16 v[32:35], v[84:87], v[104:107], v[32:35]
    ds_read_b128 v[104:107], v122 offset:0
    v_add_u32 v122, v123, v122
    s_waitcnt vmcnt(0) lgkmcnt(5)
    v_mfma_f32_16x16x32_bf16 v[12:15], v[64:67], v[108:111], v[12:15]
    v_mfma_f32_16x16x32_bf16 v[44:47], v[68:71], v[108:111], v[44:47]
    v_mfma_f32_16x16x32_bf16 v[8:11], v[72:75], v[108:111], v[8:11]
    v_mfma_f32_16x16x32_bf16 v[40:43], v[76:79], v[108:111], v[40:43]
    v_mfma_f32_16x16x32_bf16 v[4:7], v[80:83], v[108:111], v[4:7]
    v_mfma_f32_16x16x32_bf16 v[36:39], v[84:87], v[108:111], v[36:39]
    v_mfma_f32_16x16x32_bf16 v[0:3], v[88:91], v[108:111], v[0:3]
    v_mfma_f32_16x16x32_bf16 v[32:35], v[92:95], v[108:111], v[32:35]
    ds_read_b128 v[108:111], v121 offset:1024
    s_waitcnt lgkmcnt(5)
    v_mfma_f32_16x16x32_bf16 v[16:19], v[64:67], v[112:115], v[16:19]
    v_mfma_f32_16x16x32_bf16 v[48:51], v[68:71], v[112:115], v[48:51]
    v_mfma_f32_16x16x32_bf16 v[12:15], v[72:75], v[112:115], v[12:15]
    v_mfma_f32_16x16x32_bf16 v[44:47], v[76:79], v[112:115], v[44:47]
    v_mfma_f32_16x16x32_bf16 v[8:11], v[80:83], v[112:115], v[8:11]
    v_mfma_f32_16x16x32_bf16 v[40:43], v[84:87], v[112:115], v[40:43]
    v_mfma_f32_16x16x32_bf16 v[4:7], v[88:91], v[112:115], v[4:7]
    v_mfma_f32_16x16x32_bf16 v[36:39], v[92:95], v[112:115], v[36:39]
    ds_read_b128 v[112:115], v121 offset:2048
    s_waitcnt lgkmcnt(5)
    v_mfma_f32_16x16x32_bf16 v[20:23], v[64:67], v[116:119], v[20:23]
    v_mfma_f32_16x16x32_bf16 v[52:55], v[68:71], v[116:119], v[52:55]
    v_mfma_f32_16x16x32_bf16 v[16:19], v[72:75], v[116:119], v[16:19]
    v_mfma_f32_16x16x32_bf16 v[48:51], v[76:79], v[116:119], v[48:51]
    v_mfma_f32_16x16x32_bf16 v[12:15], v[80:83], v[116:119], v[12:15]
    v_mfma_f32_16x16x32_bf16 v[44:47], v[84:87], v[116:119], v[44:47]
    v_mfma_f32_16x16x32_bf16 v[8:11], v[88:91], v[116:119], v[8:11]
    v_mfma_f32_16x16x32_bf16 v[40:43], v[92:95], v[116:119], v[40:43]
    s_waitcnt lgkmcnt(4)
    v_mfma_f32_16x16x32_bf16 v[24:27], v[64:67], v[96:99], v[24:27]
    v_mfma_f32_16x16x32_bf16 v[56:59], v[68:71], v[96:99], v[56:59]
    v_mfma_f32_16x16x32_bf16 v[20:23], v[72:75], v[96:99], v[20:23]
    v_mfma_f32_16x16x32_bf16 v[52:55], v[76:79], v[96:99], v[52:55]
    v_mfma_f32_16x16x32_bf16 v[16:19], v[80:83], v[96:99], v[16:19]
    v_mfma_f32_16x16x32_bf16 v[48:51], v[84:87], v[96:99], v[48:51]
    v_mfma_f32_16x16x32_bf16 v[12:15], v[88:91], v[96:99], v[12:15]
    v_mfma_f32_16x16x32_bf16 v[44:47], v[92:95], v[96:99], v[44:47]
    s_waitcnt lgkmcnt(3)
    v_mfma_f32_16x16x32_bf16 v[28:31], v[64:67], v[100:103], v[28:31]
    v_mfma_f32_16x16x32_bf16 v[60:63], v[68:71], v[100:103], v[60:63]
    v_mfma_f32_16x16x32_bf16 v[24:27], v[72:75], v[100:103], v[24:27]
    v_mfma_f32_16x16x32_bf16 v[56:59], v[76:79], v[100:103], v[56:59]
    v_mfma_f32_16x16x32_bf16 v[20:23], v[80:83], v[100:103], v[20:23]
    v_mfma_f32_16x16x32_bf16 v[52:55], v[84:87], v[100:103], v[52:55]
    v_mfma_f32_16x16x32_bf16 v[16:19], v[88:91], v[100:103], v[16:19]
    v_mfma_f32_16x16x32_bf16 v[48:51], v[92:95], v[100:103], v[48:51]
    buffer_load_dwordx4 v[64:67], v125, s[12:15], s23 offen offset:0
    buffer_load_dwordx4 v[68:71], v125, s[12:15], s23 offen offset:1024
    s_waitcnt lgkmcnt(2)
    v_mfma_f32_16x16x32_bf16 v[28:31], v[72:75], v[104:107], v[28:31]
    v_mfma_f32_16x16x32_bf16 v[60:63], v[76:79], v[104:107], v[60:63]
    v_mfma_f32_16x16x32_bf16 v[24:27], v[80:83], v[104:107], v[24:27]
    v_mfma_f32_16x16x32_bf16 v[56:59], v[84:87], v[104:107], v[56:59]
    v_mfma_f32_16x16x32_bf16 v[20:23], v[88:91], v[104:107], v[20:23]
    v_mfma_f32_16x16x32_bf16 v[52:55], v[92:95], v[104:107], v[52:55]
    buffer_load_dwordx4 v[72:75], v125, s[12:15], s23 offen offset:2048
    buffer_load_dwordx4 v[76:79], v125, s[12:15], s23 offen offset:3072
    s_waitcnt lgkmcnt(1)
    v_mfma_f32_16x16x32_bf16 v[28:31], v[80:83], v[108:111], v[28:31]
    v_mfma_f32_16x16x32_bf16 v[60:63], v[84:87], v[108:111], v[60:63]
    v_mfma_f32_16x16x32_bf16 v[24:27], v[88:91], v[108:111], v[24:27]
    v_mfma_f32_16x16x32_bf16 v[56:59], v[92:95], v[108:111], v[56:59]
    buffer_load_dwordx4 v[80:83], v125, s[12:15], s26 offen offset:0
    buffer_load_dwordx4 v[84:87], v125, s[12:15], s26 offen offset:1024
    s_waitcnt lgkmcnt(0)
    v_mfma_f32_16x16x32_bf16 v[28:31], v[88:91], v[112:115], v[28:31]
    v_mfma_f32_16x16x32_bf16 v[60:63], v[92:95], v[112:115], v[60:63]
    buffer_load_dwordx4 v[88:91], v125, s[12:15], s26 offen offset:2048
    buffer_load_dwordx4 v[92:95], v125, s[12:15], s26 offen offset:3072
    s_add_u32 s23, s23, 57344
    s_add_u32 s26, s26, 57344
    s_barrier
    s_sub_u32 s22, s22, 1
    s_cmp_eq_u32 s22, 0
    s_cbranch_scc1 L_conv2_kernel_mlast1
    ds_read_b128 v[96:99], v120 offset:8192
    ds_read_b128 v[100:103], v120 offset:9216
    ds_read_b128 v[104:107], v120 offset:10240
    ds_read_b128 v[108:111], v120 offset:11264
    ds_read_b128 v[112:115], v120 offset:12288
    ds_read_b128 v[116:119], v120 offset:13312
    s_waitcnt vmcnt(6) lgkmcnt(5)
    v_mfma_f32_16x16x32_bf16 v[0:3], v[64:67], v[96:99], v[0:3]
    v_mfma_f32_16x16x32_bf16 v[32:35], v[68:71], v[96:99], v[32:35]
    ds_read_b128 v[96:99], v120 offset:14336
    s_waitcnt vmcnt(4) lgkmcnt(5)
    v_mfma_f32_16x16x32_bf16 v[4:7], v[64:67], v[100:103], v[4:7]
    v_mfma_f32_16x16x32_bf16 v[36:39], v[68:71], v[100:103], v[36:39]
    v_mfma_f32_16x16x32_bf16 v[0:3], v[72:75], v[100:103], v[0:3]
    v_mfma_f32_16x16x32_bf16 v[32:35], v[76:79], v[100:103], v[32:35]
    ds_read_b128 v[100:103], v120 offset:15360
    s_waitcnt vmcnt(2) lgkmcnt(5)
    v_mfma_f32_16x16x32_bf16 v[8:11], v[64:67], v[104:107], v[8:11]
    v_mfma_f32_16x16x32_bf16 v[40:43], v[68:71], v[104:107], v[40:43]
    v_mfma_f32_16x16x32_bf16 v[4:7], v[72:75], v[104:107], v[4:7]
    v_mfma_f32_16x16x32_bf16 v[36:39], v[76:79], v[104:107], v[36:39]
    v_mfma_f32_16x16x32_bf16 v[0:3], v[80:83], v[104:107], v[0:3]
    v_mfma_f32_16x16x32_bf16 v[32:35], v[84:87], v[104:107], v[32:35]
    ds_read_b128 v[104:107], v122 offset:0
    v_add_u32 v122, v124, v122
    s_waitcnt vmcnt(0) lgkmcnt(5)
    v_mfma_f32_16x16x32_bf16 v[12:15], v[64:67], v[108:111], v[12:15]
    v_mfma_f32_16x16x32_bf16 v[44:47], v[68:71], v[108:111], v[44:47]
    v_mfma_f32_16x16x32_bf16 v[8:11], v[72:75], v[108:111], v[8:11]
    v_mfma_f32_16x16x32_bf16 v[40:43], v[76:79], v[108:111], v[40:43]
    v_mfma_f32_16x16x32_bf16 v[4:7], v[80:83], v[108:111], v[4:7]
    v_mfma_f32_16x16x32_bf16 v[36:39], v[84:87], v[108:111], v[36:39]
    v_mfma_f32_16x16x32_bf16 v[0:3], v[88:91], v[108:111], v[0:3]
    v_mfma_f32_16x16x32_bf16 v[32:35], v[92:95], v[108:111], v[32:35]
    ds_read_b128 v[108:111], v121 offset:9216
    s_waitcnt lgkmcnt(5)
    v_mfma_f32_16x16x32_bf16 v[16:19], v[64:67], v[112:115], v[16:19]
    v_mfma_f32_16x16x32_bf16 v[48:51], v[68:71], v[112:115], v[48:51]
    v_mfma_f32_16x16x32_bf16 v[12:15], v[72:75], v[112:115], v[12:15]
    v_mfma_f32_16x16x32_bf16 v[44:47], v[76:79], v[112:115], v[44:47]
    v_mfma_f32_16x16x32_bf16 v[8:11], v[80:83], v[112:115], v[8:11]
    v_mfma_f32_16x16x32_bf16 v[40:43], v[84:87], v[112:115], v[40:43]
    v_mfma_f32_16x16x32_bf16 v[4:7], v[88:91], v[112:115], v[4:7]
    v_mfma_f32_16x16x32_bf16 v[36:39], v[92:95], v[112:115], v[36:39]
    ds_read_b128 v[112:115], v121 offset:10240
    s_waitcnt lgkmcnt(5)
    v_mfma_f32_16x16x32_bf16 v[20:23], v[64:67], v[116:119], v[20:23]
    v_mfma_f32_16x16x32_bf16 v[52:55], v[68:71], v[116:119], v[52:55]
    v_mfma_f32_16x16x32_bf16 v[16:19], v[72:75], v[116:119], v[16:19]
    v_mfma_f32_16x16x32_bf16 v[48:51], v[76:79], v[116:119], v[48:51]
    v_mfma_f32_16x16x32_bf16 v[12:15], v[80:83], v[116:119], v[12:15]
    v_mfma_f32_16x16x32_bf16 v[44:47], v[84:87], v[116:119], v[44:47]
    v_mfma_f32_16x16x32_bf16 v[8:11], v[88:91], v[116:119], v[8:11]
    v_mfma_f32_16x16x32_bf16 v[40:43], v[92:95], v[116:119], v[40:43]
    s_waitcnt lgkmcnt(4)
    v_mfma_f32_16x16x32_bf16 v[24:27], v[64:67], v[96:99], v[24:27]
    v_mfma_f32_16x16x32_bf16 v[56:59], v[68:71], v[96:99], v[56:59]
    v_mfma_f32_16x16x32_bf16 v[20:23], v[72:75], v[96:99], v[20:23]
    v_mfma_f32_16x16x32_bf16 v[52:55], v[76:79], v[96:99], v[52:55]
    v_mfma_f32_16x16x32_bf16 v[16:19], v[80:83], v[96:99], v[16:19]
    v_mfma_f32_16x16x32_bf16 v[48:51], v[84:87], v[96:99], v[48:51]
    v_mfma_f32_16x16x32_bf16 v[12:15], v[88:91], v[96:99], v[12:15]
    v_mfma_f32_16x16x32_bf16 v[44:47], v[92:95], v[96:99], v[44:47]
    s_waitcnt lgkmcnt(3)
    v_mfma_f32_16x16x32_bf16 v[28:31], v[64:67], v[100:103], v[28:31]
    v_mfma_f32_16x16x32_bf16 v[60:63], v[68:71], v[100:103], v[60:63]
    v_mfma_f32_16x16x32_bf16 v[24:27], v[72:75], v[100:103], v[24:27]
    v_mfma_f32_16x16x32_bf16 v[56:59], v[76:79], v[100:103], v[56:59]
    v_mfma_f32_16x16x32_bf16 v[20:23], v[80:83], v[100:103], v[20:23]
    v_mfma_f32_16x16x32_bf16 v[52:55], v[84:87], v[100:103], v[52:55]
    v_mfma_f32_16x16x32_bf16 v[16:19], v[88:91], v[100:103], v[16:19]
    v_mfma_f32_16x16x32_bf16 v[48:51], v[92:95], v[100:103], v[48:51]
    buffer_load_dwordx4 v[64:67], v125, s[12:15], s23 offen offset:0
    buffer_load_dwordx4 v[68:71], v125, s[12:15], s23 offen offset:1024
    s_waitcnt lgkmcnt(2)
    v_mfma_f32_16x16x32_bf16 v[28:31], v[72:75], v[104:107], v[28:31]
    v_mfma_f32_16x16x32_bf16 v[60:63], v[76:79], v[104:107], v[60:63]
    v_mfma_f32_16x16x32_bf16 v[24:27], v[80:83], v[104:107], v[24:27]
    v_mfma_f32_16x16x32_bf16 v[56:59], v[84:87], v[104:107], v[56:59]
    v_mfma_f32_16x16x32_bf16 v[20:23], v[88:91], v[104:107], v[20:23]
    v_mfma_f32_16x16x32_bf16 v[52:55], v[92:95], v[104:107], v[52:55]
    buffer_load_dwordx4 v[72:75], v125, s[12:15], s23 offen offset:2048
    buffer_load_dwordx4 v[76:79], v125, s[12:15], s23 offen offset:3072
    s_waitcnt lgkmcnt(1)
    v_mfma_f32_16x16x32_bf16 v[28:31], v[80:83], v[108:111], v[28:31]
    v_mfma_f32_16x16x32_bf16 v[60:63], v[84:87], v[108:111], v[60:63]
    v_mfma_f32_16x16x32_bf16 v[24:27], v[88:91], v[108:111], v[24:27]
    v_mfma_f32_16x16x32_bf16 v[56:59], v[92:95], v[108:111], v[56:59]
    buffer_load_dwordx4 v[80:83], v125, s[12:15], s26 offen offset:0
    buffer_load_dwordx4 v[84:87], v125, s[12:15], s26 offen offset:1024
    s_waitcnt lgkmcnt(0)
    v_mfma_f32_16x16x32_bf16 v[28:31], v[88:91], v[112:115], v[28:31]
    v_mfma_f32_16x16x32_bf16 v[60:63], v[92:95], v[112:115], v[60:63]
    buffer_load_dwordx4 v[88:91], v125, s[12:15], s26 offen offset:2048
    buffer_load_dwordx4 v[92:95], v125, s[12:15], s26 offen offset:3072
    s_add_u32 s23, s23, 57344
    s_add_u32 s26, s26, 57344
    s_barrier
    s_branch L_conv2_kernel_mloop1
L_conv2_kernel_mlast1:
    v_and_b32 v125, 15, v127
    v_and_b32 v126, 7, v127
    v_lshlrev_b32 v126, 4, v126
    v_lshl_add_u32 v125, v125, 7, v126
    v_lshrrev_b32 v126, 4, v127
    v_lshl_add_u32 v125, v126, 11, v125
    s_lshl_b32 s36, s20, 14
    s_add_u32 s37, s36, 8192
    v_add_u32 v126, s37, v125
    v_add_u32 v125, s36, v125
    ds_read_b128 v[96:99], v120 offset:8192
    ds_read_b128 v[100:103], v120 offset:9216
    ds_read_b128 v[104:107], v120 offset:10240
    ds_read_b128 v[108:111], v120 offset:11264
    ds_read_b128 v[112:115], v120 offset:12288
    ds_read_b128 v[116:119], v120 offset:13312
    s_waitcnt vmcnt(6) lgkmcnt(5)
    v_mfma_f32_16x16x32_bf16 v[0:3], v[64:67], v[96:99], v[0:3]
    v_mfma_f32_16x16x32_bf16 v[32:35], v[68:71], v[96:99], v[32:35]
    ds_read_b128 v[96:99], v120 offset:14336
    s_waitcnt vmcnt(4) lgkmcnt(5)
    v_mfma_f32_16x16x32_bf16 v[4:7], v[64:67], v[100:103], v[4:7]
    v_mfma_f32_16x16x32_bf16 v[36:39], v[68:71], v[100:103], v[36:39]
    v_mfma_f32_16x16x32_bf16 v[0:3], v[72:75], v[100:103], v[0:3]
    v_mfma_f32_16x16x32_bf16 v[32:35], v[76:79], v[100:103], v[32:35]
    ds_read_b128 v[100:103], v120 offset:15360
    s_waitcnt vmcnt(2) lgkmcnt(5)
    v_mfma_f32_16x16x32_bf16 v[8:11], v[64:67], v[104:107], v[8:11]
    v_mfma_f32_16x16x32_bf16 v[40:43], v[68:71], v[104:107], v[40:43]
    v_mfma_f32_16x16x32_bf16 v[4:7], v[72:75], v[104:107], v[4:7]
    v_mfma_f32_16x16x32_bf16 v[36:39], v[76:79], v[104:107], v[36:39]
    v_mfma_f32_16x16x32_bf16 v[0:3], v[80:83], v[104:107], v[0:3]
    v_mfma_f32_16x16x32_bf16 v[32:35], v[84:87], v[104:107], v[32:35]
    ds_read_b128 v[104:107], v122 offset:0
    s_waitcnt vmcnt(0) lgkmcnt(5)
    v_mfma_f32_16x16x32_bf16 v[12:15], v[64:67], v[108:111], v[12:15]
    v_mfma_f32_16x16x32_bf16 v[44:47], v[68:71], v[108:111], v[44:47]
    v_mfma_f32_16x16x32_bf16 v[8:11], v[72:75], v[108:111], v[8:11]
    v_mfma_f32_16x16x32_bf16 v[40:43], v[76:79], v[108:111], v[40:43]
    v_mfma_f32_16x16x32_bf16 v[4:7], v[80:83], v[108:111], v[4:7]
    v_mfma_f32_16x16x32_bf16 v[36:39], v[84:87], v[108:111], v[36:39]
    v_mfma_f32_16x16x32_bf16 v[0:3], v[88:91], v[108:111], v[0:3]
    v_mfma_f32_16x16x32_bf16 v[32:35], v[92:95], v[108:111], v[32:35]
    ds_read_b128 v[108:111], v121 offset:9216
    s_waitcnt lgkmcnt(5)
    v_mfma_f32_16x16x32_bf16 v[16:19], v[64:67], v[112:115], v[16:19]
    v_mfma_f32_16x16x32_bf16 v[48:51], v[68:71], v[112:115], v[48:51]
    v_mfma_f32_16x16x32_bf16 v[12:15], v[72:75], v[112:115], v[12:15]
    v_mfma_f32_16x16x32_bf16 v[44:47], v[76:79], v[112:115], v[44:47]
    v_mfma_f32_16x16x32_bf16 v[8:11], v[80:83], v[112:115], v[8:11]
    v_mfma_f32_16x16x32_bf16 v[40:43], v[84:87], v[112:115], v[40:43]
    v_mfma_f32_16x16x32_bf16 v[4:7], v[88:91], v[112:115], v[4:7]
    v_mfma_f32_16x16x32_bf16 v[36:39], v[92:95], v[112:115], v[36:39]
    ds_read_b128 v[112:115], v121 offset:10240
    v_xor_b32 v123, 0, v125
    ds_write_b128 v123, v[0:3]
    s_waitcnt lgkmcnt(6)
    v_mfma_f32_16x16x32_bf16 v[20:23], v[64:67], v[116:119], v[20:23]
    v_mfma_f32_16x16x32_bf16 v[52:55], v[68:71], v[116:119], v[52:55]
    v_mfma_f32_16x16x32_bf16 v[16:19], v[72:75], v[116:119], v[16:19]
    v_mfma_f32_16x16x32_bf16 v[48:51], v[76:79], v[116:119], v[48:51]
    v_mfma_f32_16x16x32_bf16 v[12:15], v[80:83], v[116:119], v[12:15]
    v_mfma_f32_16x16x32_bf16 v[44:47], v[84:87], v[116:119], v[44:47]
    v_mfma_f32_16x16x32_bf16 v[8:11], v[88:91], v[116:119], v[8:11]
    v_mfma_f32_16x16x32_bf16 v[40:43], v[92:95], v[116:119], v[40:43]
    v_xor_b32 v124, 16, v125
    ds_write_b128 v124, v[4:7]
    s_waitcnt lgkmcnt(2)
    v_mfma_f32_16x16x32_bf16 v[24:27], v[64:67], v[96:99], v[24:27]
    v_mfma_f32_16x16x32_bf16 v[56:59], v[68:71], v[96:99], v[56:59]
    v_mfma_f32_16x16x32_bf16 v[20:23], v[72:75], v[96:99], v[20:23]
    v_mfma_f32_16x16x32_bf16 v[52:55], v[76:79], v[96:99], v[52:55]
    v_mfma_f32_16x16x32_bf16 v[16:19], v[80:83], v[96:99], v[16:19]
    v_mfma_f32_16x16x32_bf16 v[48:51], v[84:87], v[96:99], v[48:51]
    v_mfma_f32_16x16x32_bf16 v[12:15], v[88:91], v[96:99], v[12:15]
    v_mfma_f32_16x16x32_bf16 v[44:47], v[92:95], v[96:99], v[44:47]
    v_xor_b32 v123, 32, v125
    ds_write_b128 v123, v[8:11]
    v_xor_b32 v124, 0, v126
    ds_write_b128 v124, v[32:35]
    v_mfma_f32_16x16x32_bf16 v[28:31], v[64:67], v[100:103], v[28:31]
    v_mfma_f32_16x16x32_bf16 v[60:63], v[68:71], v[100:103], v[60:63]
    v_mfma_f32_16x16x32_bf16 v[24:27], v[72:75], v[100:103], v[24:27]
    v_mfma_f32_16x16x32_bf16 v[56:59], v[76:79], v[100:103], v[56:59]
    v_mfma_f32_16x16x32_bf16 v[20:23], v[80:83], v[100:103], v[20:23]
    v_mfma_f32_16x16x32_bf16 v[52:55], v[84:87], v[100:103], v[52:55]
    v_mfma_f32_16x16x32_bf16 v[16:19], v[88:91], v[100:103], v[16:19]
    v_mfma_f32_16x16x32_bf16 v[48:51], v[92:95], v[100:103], v[48:51]
    v_xor_b32 v123, 16, v126
    ds_write_b128 v123, v[36:39]
    v_xor_b32 v124, 32, v126
    ds_write_b128 v124, v[40:43]
    v_mfma_f32_16x16x32_bf16 v[28:31], v[72:75], v[104:107], v[28:31]
    v_mfma_f32_16x16x32_bf16 v[60:63], v[76:79], v[104:107], v[60:63]
    v_mfma_f32_16x16x32_bf16 v[24:27], v[80:83], v[104:107], v[24:27]
    v_mfma_f32_16x16x32_bf16 v[56:59], v[84:87], v[104:107], v[56:59]
    v_mfma_f32_16x16x32_bf16 v[20:23], v[88:91], v[104:107], v[20:23]
    v_mfma_f32_16x16x32_bf16 v[52:55], v[92:95], v[104:107], v[52:55]
    v_xor_b32 v124, 48, v125
    ds_write_b128 v124, v[12:15]
    v_xor_b32 v123, 48, v126
    ds_write_b128 v123, v[44:47]
    v_mfma_f32_16x16x32_bf16 v[28:31], v[80:83], v[108:111], v[28:31]
    v_mfma_f32_16x16x32_bf16 v[60:63], v[84:87], v[108:111], v[60:63]
    v_mfma_f32_16x16x32_bf16 v[24:27], v[88:91], v[108:111], v[24:27]
    v_mfma_f32_16x16x32_bf16 v[56:59], v[92:95], v[108:111], v[56:59]
    v_xor_b32 v123, 64, v125
    ds_write_b128 v123, v[16:19]
    v_xor_b32 v124, 64, v126
    ds_write_b128 v124, v[48:51]
    v_mfma_f32_16x16x32_bf16 v[28:31], v[88:91], v[112:115], v[28:31]
    v_mfma_f32_16x16x32_bf16 v[60:63], v[92:95], v[112:115], v[60:63]
    v_xor_b32 v124, 80, v125
    ds_write_b128 v124, v[20:23]
    v_xor_b32 v123, 80, v126
    ds_write_b128 v123, v[52:55]
    s_nop 7
    v_xor_b32 v123, 96, v125
    ds_write_b128 v123, v[24:27]
    v_xor_b32 v124, 96, v126
    ds_write_b128 v124, v[56:59]
    v_xor_b32 v124, 112, v125
    ds_write_b128 v124, v[28:31]
    v_xor_b32 v123, 112, v126
    s_waitcnt lgkmcnt(8)
    ds_write_b128 v123, v[60:63]
    s_setprio 0
    s_branch L_conv2_kernel_epi
L_conv2_kernel_m2:
    s_mul_i32 s37, s38, 2176
    s_add_u32 s37, s37, 98304
    v_add_u32 v116, s37, v8
    v_add_u32 v118, s37, v9
    v_add_u32 v117, 104832, v8
    s_cmp_eq_u32 s38, 0
    s_cbranch_scc1 L_conv2_kernel_hh0
    v_add_u32 v117, 98304, v9
L_conv2_kernel_hh0:
    s_lshl_b32 s37, s38, 12
    s_add_u32 s37, s37, s43
    s_add_u32 s37, s37, 49152
    v_lshl_add_u32 v119, v127, 4, s37
    v_mov_b32 v0, 0
    v_mov_b32 v1, 0
    v_mov_b32 v2, 0
    v_mov_b32 v3, 0
    v_mov_b32 v4, 0
    v_mov_b32 v5, 0
    v_mov_b32 v6, 0
    v_mov_b32 v7, 0
    v_mov_b32 v8, 0
    v_mov_b32 v9, 0
    v_mov_b32 v10, 0
    v_mov_b32 v11, 0
    v_mov_b32 v12, 0
    v_mov_b32 v13, 0
    v_mov_b32 v14, 0
    v_mov_b32 v15, 0
    v_mov_b32 v16, 0
    v_mov_b32 v17, 0
    v_mov_b32 v18, 0
    v_mov_b32 v19, 0
    v_mov_b32 v20, 0
    v_mov_b32 v21, 0
    v_mov_b32 v22, 0
    v_mov_b32 v23, 0
    v_mov_b32 v24, 0
    v_mov_b32 v25, 0
    v_mov_b32 v26, 0
    v_mov_b32 v27, 0
    v_mov_b32 v28, 0
    v_mov_b32 v29, 0
    v_mov_b32 v30, 0
    v_mov_b32 v31, 0
    v_mov_b32 v32, 0
    v_mov_b32 v33, 0
    v_mov_b32 v34, 0
    v_mov_b32 v35, 0
    v_mov_b32 v36, 0
    v_mov_b32 v37, 0
    v_mov_b32 v38, 0
    v_mov_b32 v39, 0
    v_mov_b32 v40, 0
    v_mov_b32 v41, 0
    v_mov_b32 v42, 0
    v_mov_b32 v43, 0
    v_mov_b32 v44, 0
    v_mov_b32 v45, 0
    v_mov_b32 v46, 0
    v_mov_b32 v47, 0
    v_mov_b32 v48, 0
    v_mov_b32 v49, 0
    v_mov_b32 v50, 0
    v_mov_b32 v51, 0
    v_mov_b32 v52, 0
    v_mov_b32 v53, 0
    v_mov_b32 v54, 0
    v_mov_b32 v55, 0
    v_mov_b32 v56, 0
    v_mov_b32 v57, 0
    v_mov_b32 v58, 0
    v_mov_b32 v59, 0
    v_mov_b32 v60, 0
    v_mov_b32 v61, 0
    v_mov_b32 v62, 0
    v_mov_b32 v63, 0
    s_barrier
    buffer_load_dwordx4 v[96:99], v108, s[8:11], 0 offen offset:0
    buffer_load_dwordx4 v[100:103], v108, s[8:11], 0 offen offset:1024
    buffer_load_dwordx4 v[104:107], v108, s[8:11], 0 offen offset:2048
    s_mov_b32 s23, 0
    s_mov_b32 s26, 4096
    buffer_load_dwordx4 v[64:67], v125, s[12:15], s23 offen offset:0
    buffer_load_dwordx4 v[68:71], v125, s[12:15], s23 offen offset:2048
    buffer_load_dwordx4 v[80:83], v119, s[12:15], s23 offen offset:0
    buffer_load_dwordx4 v[72:75], v125, s[12:15], s26 offen offset:0
    buffer_load_dwordx4 v[84:87], v119, s[12:15], s23 offen offset:2048
    buffer_load_dwordx4 v[76:79], v125, s[12:15], s26 offen offset:2048
    s_mov_b32 s23, 57344
    s_mov_b32 s26, 61440
    s_waitcnt vmcnt(6)
    v_lshlrev_b32 v108, 16, v96
    v_and_b32 v111, s25, v96
    v_lshlrev_b32 v109, 16, v100
    v_and_b32 v112, s25, v100
    v_lshlrev_b32 v110, 16, v104
    v_and_b32 v113, s25, v104
    v_mul_f32 v114, s44, v108
    v_mul_f32 v115, s44, v111
    v_fmac_f32 v114, s45, v109
    v_fmac_f32 v115, s45, v112
    v_fmac_f32 v114, s46, v110
    v_fmac_f32 v115, s46, v113
    v_cvt_pk_bf16_f32 v96, v114, v115
    v_lshlrev_b32 v108, 16, v97
    v_and_b32 v111, s25, v97
    v_lshlrev_b32 v109, 16, v101
    v_and_b32 v112, s25, v101
    v_lshlrev_b32 v110, 16, v105
    v_and_b32 v113, s25, v105
    v_mul_f32 v114, s44, v108
    v_mul_f32 v115, s44, v111
    v_fmac_f32 v114, s45, v109
    v_fmac_f32 v115, s45, v112
    v_fmac_f32 v114, s46, v110
    v_fmac_f32 v115, s46, v113
    v_cvt_pk_bf16_f32 v97, v114, v115
    v_lshlrev_b32 v108, 16, v98
    v_and_b32 v111, s25, v98
    v_lshlrev_b32 v109, 16, v102
    v_and_b32 v112, s25, v102
    v_lshlrev_b32 v110, 16, v106
    v_and_b32 v113, s25, v106
    v_mul_f32 v114, s44, v108
    v_mul_f32 v115, s44, v111
    v_fmac_f32 v114, s45, v109
    v_fmac_f32 v115, s45, v112
    v_fmac_f32 v114, s46, v110
    v_fmac_f32 v115, s46, v113
    v_cvt_pk_bf16_f32 v98, v114, v115
    v_lshlrev_b32 v108, 16, v99
    v_and_b32 v111, s25, v99
    v_lshlrev_b32 v109, 16, v103
    v_and_b32 v112, s25, v103
    v_lshlrev_b32 v110, 16, v107
    v_and_b32 v113, s25, v107
    v_mul_f32 v114, s44, v108
    v_mul_f32 v115, s44, v111
    v_fmac_f32 v114, s45, v109
    v_fmac_f32 v115, s45, v112
    v_fmac_f32 v114, s46, v110
    v_fmac_f32 v115, s46, v113
    v_cvt_pk_bf16_f32 v99, v114, v115
    ds_write_b128 v126, v[96:99]
    v_and_b32 v126, 15, v127
    v_lshlrev_b32 v126, 2, v126
    v_add_u32 v126, 99328, v126
    ds_write_b32 v126, v0
    ds_write_b32 v126, v0 offset:8704
    s_waitcnt lgkmcnt(0)
    s_barrier
    s_mov_b32 s22, 4
    s_setprio 2
L_conv2_kernel_mloop2:
    ds_read_b128 v[88:91], v120 offset:0
    ds_read_b128 v[92:95], v120 offset:1024
    ds_read_b128 v[96:99], v116 offset:0
    ds_read_b128 v[100:103], v120 offset:2048
    ds_read_b128 v[104:107], v116 offset:1088
    ds_read_b128 v[108:111], v120 offset:3072
    ds_read_b128 v[112:115], v116 offset:2176
    s_waitcnt vmcnt(5) lgkmcnt(6)
    v_mfma_f32_16x16x32_bf16 v[0:3], v[64:67], v[88:91], v[0:3]
    ds_read_b128 v[88:91], v120 offset:4096
    s_waitcnt vmcnt(4) lgkmcnt(6)
    v_mfma_f32_16x16x32_bf16 v[4:7], v[64:67], v[92:95], v[4:7]
    v_mfma_f32_16x16x32_bf16 v[0:3], v[68:71], v[92:95], v[0:3]
    ds_read_b128 v[92:95], v116 offset:3264
    s_waitcnt vmcnt(3) lgkmcnt(6)
    v_mfma_f32_16x16x32_bf16 v[32:35], v[80:83], v[96:99], v[32:35]
    ds_read_b128 v[96:99], v120 offset:5120
    s_waitcnt vmcnt(2) lgkmcnt(6)
    v_mfma_f32_16x16x32_bf16 v[8:11], v[64:67], v[100:103], v[8:11]
    v_mfma_f32_16x16x32_bf16 v[4:7], v[68:71], v[100:103], v[4:7]
    v_mfma_f32_16x16x32_bf16 v[0:3], v[72:75], v[100:103], v[0:3]
    ds_read_b128 v[100:103], v116 offset:4352
    s_waitcnt vmcnt(1) lgkmcnt(6)
    v_mfma_f32_16x16x32_bf16 v[36:39], v[80:83], v[104:107], v[36:39]
    v_mfma_f32_16x16x32_bf16 v[32:35], v[84:87], v[104:107], v[32:35]
    ds_read_b128 v[104:107], v120 offset:6144
    s_waitcnt vmcnt(0) lgkmcnt(6)
    v_mfma_f32_16x16x32_bf16 v[12:15], v[64:67], v[108:111], v[12:15]
    v_mfma_f32_16x16x32_bf16 v[8:11], v[68:71], v[108:111], v[8:11]
    v_mfma_f32_16x16x32_bf16 v[4:7], v[72:75], v[108:111], v[4:7]
    v_mfma_f32_16x16x32_bf16 v[0:3], v[76:79], v[108:111], v[0:3]
    ds_read_b128 v[108:111], v116 offset:5440
    s_waitcnt lgkmcnt(6)
    v_mfma_f32_16x16x32_bf16 v[40:43], v[80:83], v[112:115], v[40:43]
    v_mfma_f32_16x16x32_bf16 v[36:39], v[84:87], v[112:115], v[36:39]
    ds_read_b128 v[112:115], v120 offset:7168
    s_waitcnt lgkmcnt(6)
    v_mfma_f32_16x16x32_bf16 v[16:19], v[64:67], v[88:91], v[16:19]
    v_mfma_f32_16x16x32_bf16 v[12:15], v[68:71], v[88:91], v[12:15]
    v_mfma_f32_16x16x32_bf16 v[8:11], v[72:75], v[88:91], v[8:11]
    v_mfma_f32_16x16x32_bf16 v[4:7], v[76:79], v[88:91], v[4:7]
    ds_read_b128 v[88:91], v117 offset:0
    s_waitcnt lgkmcnt(6)
    v_mfma_f32_16x16x32_bf16 v[44:47], v[80:83], v[92:95], v[44:47]
    v_mfma_f32_16x16x32_bf16 v[40:43], v[84:87], v[92:95], v[40:43]
    ds_read_b128 v[92:95], v122 offset:0
    v_add_u32 v122, v123, v122
    s_waitcnt lgkmcnt(6)
    v_mfma_f32_16x16x32_bf16 v[20:23], v[64:67], v[96:99], v[20:23]
    v_mfma_f32_16x16x32_bf16 v[16:19], v[68:71], v[96:99], v[16:19]
    v_mfma_f32_16x16x32_bf16 v[12:15], v[72:75], v[96:99], v[12:15]
    v_mfma_f32_16x16x32_bf16 v[8:11], v[76:79], v[96:99], v[8:11]
    ds_read_b128 v[96:99], v117 offset:1088
    s_waitcnt lgkmcnt(6)
    v_mfma_f32_16x16x32_bf16 v[48:51], v[80:83], v[100:103], v[48:51]
    v_mfma_f32_16x16x32_bf16 v[44:47], v[84:87], v[100:103], v[44:47]
    ds_read_b128 v[100:103], v121 offset:1024
    s_waitcnt lgkmcnt(6)
    v_mfma_f32_16x16x32_bf16 v[24:27], v[64:67], v[104:107], v[24:27]
    v_mfma_f32_16x16x32_bf16 v[20:23], v[68:71], v[104:107], v[20:23]
    v_mfma_f32_16x16x32_bf16 v[16:19], v[72:75], v[104:107], v[16:19]
    v_mfma_f32_16x16x32_bf16 v[12:15], v[76:79], v[104:107], v[12:15]
    ds_read_b128 v[104:107], v118 offset:0
    s_waitcnt lgkmcnt(6)
    v_mfma_f32_16x16x32_bf16 v[52:55], v[80:83], v[108:111], v[52:55]
    v_mfma_f32_16x16x32_bf16 v[48:51], v[84:87], v[108:111], v[48:51]
    ds_read_b128 v[108:111], v121 offset:2048
    s_waitcnt lgkmcnt(6)
    v_mfma_f32_16x16x32_bf16 v[28:31], v[64:67], v[112:115], v[28:31]
    v_mfma_f32_16x16x32_bf16 v[24:27], v[68:71], v[112:115], v[24:27]
    v_mfma_f32_16x16x32_bf16 v[20:23], v[72:75], v[112:115], v[20:23]
    v_mfma_f32_16x16x32_bf16 v[16:19], v[76:79], v[112:115], v[16:19]
    buffer_load_dwordx4 v[64:67], v125, s[12:15], s23 offen offset:0
    s_waitcnt lgkmcnt(5)
    v_mfma_f32_16x16x32_bf16 v[56:59], v[80:83], v[88:91], v[56:59]
    v_mfma_f32_16x16x32_bf16 v[52:55], v[84:87], v[88:91], v[52:55]
    s_waitcnt lgkmcnt(0)
    s_barrier
    v_mfma_f32_16x16x32_bf16 v[28:31], v[68:71], v[92:95], v[28:31]
    v_mfma_f32_16x16x32_bf16 v[24:27], v[72:75], v[92:95], v[24:27]
    v_mfma_f32_16x16x32_bf16 v[20:23], v[76:79], v[92:95], v[20:23]
    buffer_load_dwordx4 v[68:71], v125, s[12:15], s23 offen offset:2048
    v_mfma_f32_16x16x32_bf16 v[60:63], v[80:83], v[96:99], v[60:63]
    v_mfma_f32_16x16x32_bf16 v[56:59], v[84:87], v[96:99], v[56:59]
    buffer_load_dwordx4 v[80:83], v119, s[12:15], s23 offen offset:0
    v_mfma_f32_16x16x32_bf16 v[28:31], v[72:75], v[100:103], v[28:31]
    v_mfma_f32_16x16x32_bf16 v[24:27], v[76:79], v[100:103], v[24:27]
    buffer_load_dwordx4 v[72:75], v125, s[12:15], s26 offen offset:0
    v_mfma_f32_16x16x32_bf16 v[60:63], v[84:87], v[104:107], v[60:63]
    buffer_load_dwordx4 v[84:87], v119, s[12:15], s23 offen offset:2048
    v_mfma_f32_16x16x32_bf16 v[28:31], v[76:79], v[108:111], v[28:31]
    buffer_load_dwordx4 v[76:79], v125, s[12:15], s26 offen offset:2048
    s_add_u32 s23, s23, 57344
    s_add_u32 s26, s26, 57344
    s_sub_u32 s22, s22, 1
    s_cmp_eq_u32 s22, 0
    s_cbranch_scc1 L_conv2_kernel_mlast2
    ds_read_b128 v[88:91], v120 offset:8192
    ds_read_b128 v[92:95], v120 offset:9216
    ds_read_b128 v[96:99], v116 offset:8704
    ds_read_b128 v[100:103], v120 offset:10240
    ds_read_b128 v[104:107], v116 offset:9792
    ds_read_b128 v[108:111], v120 offset:11264
    ds_read_b128 v[112:115], v116 offset:10880
    s_waitcnt vmcnt(5) lgkmcnt(6)
    v_mfma_f32_16x16x32_bf16 v[0:3], v[64:67], v[88:91], v[0:3]
    ds_read_b128 v[88:91], v120 offset:12288
    s_waitcnt vmcnt(4) lgkmcnt(6)
    v_mfma_f32_16x16x32_bf16 v[4:7], v[64:67], v[92:95], v[4:7]
    v_mfma_f32_16x16x32_bf16 v[0:3], v[68:71], v[92:95], v[0:3]
    ds_read_b128 v[92:95], v116 offset:11968
    s_waitcnt vmcnt(3) lgkmcnt(6)
    v_mfma_f32_16x16x32_bf16 v[32:35], v[80:83], v[96:99], v[32:35]
    ds_read_b128 v[96:99], v120 offset:13312
    s_waitcnt vmcnt(2) lgkmcnt(6)
    v_mfma_f32_16x16x32_bf16 v[8:11], v[64:67], v[100:103], v[8:11]
    v_mfma_f32_16x16x32_bf16 v[4:7], v[68:71], v[100:103], v[4:7]
    v_mfma_f32_16x16x32_bf16 v[0:3], v[72:75], v[100:103], v[0:3]
    ds_read_b128 v[100:103], v116 offset:13056
    s_waitcnt vmcnt(1) lgkmcnt(6)
    v_mfma_f32_16x16x32_bf16 v[36:39], v[80:83], v[104:107], v[36:39]
    v_mfma_f32_16x16x32_bf16 v[32:35], v[84:87], v[104:107], v[32:35]
    ds_read_b128 v[104:107], v120 offset:14336
    s_waitcnt vmcnt(0) lgkmcnt(6)
    v_mfma_f32_16x16x32_bf16 v[12:15], v[64:67], v[108:111], v[12:15]
    v_mfma_f32_16x16x32_bf16 v[8:11], v[68:71], v[108:111], v[8:11]
    v_mfma_f32_16x16x32_bf16 v[4:7], v[72:75], v[108:111], v[4:7]
    v_mfma_f32_16x16x32_bf16 v[0:3], v[76:79], v[108:111], v[0:3]
    ds_read_b128 v[108:111], v116 offset:14144
    s_waitcnt lgkmcnt(6)
    v_mfma_f32_16x16x32_bf16 v[40:43], v[80:83], v[112:115], v[40:43]
    v_mfma_f32_16x16x32_bf16 v[36:39], v[84:87], v[112:115], v[36:39]
    ds_read_b128 v[112:115], v120 offset:15360
    s_waitcnt lgkmcnt(6)
    v_mfma_f32_16x16x32_bf16 v[16:19], v[64:67], v[88:91], v[16:19]
    v_mfma_f32_16x16x32_bf16 v[12:15], v[68:71], v[88:91], v[12:15]
    v_mfma_f32_16x16x32_bf16 v[8:11], v[72:75], v[88:91], v[8:11]
    v_mfma_f32_16x16x32_bf16 v[4:7], v[76:79], v[88:91], v[4:7]
    ds_read_b128 v[88:91], v117 offset:8704
    s_waitcnt lgkmcnt(6)
    v_mfma_f32_16x16x32_bf16 v[44:47], v[80:83], v[92:95], v[44:47]
    v_mfma_f32_16x16x32_bf16 v[40:43], v[84:87], v[92:95], v[40:43]
    ds_read_b128 v[92:95], v122 offset:0
    v_add_u32 v122, v124, v122
    s_waitcnt lgkmcnt(6)
    v_mfma_f32_16x16x32_bf16 v[20:23], v[64:67], v[96:99], v[20:23]
    v_mfma_f32_16x16x32_bf16 v[16:19], v[68:71], v[96:99], v[16:19]
    v_mfma_f32_16x16x32_bf16 v[12:15], v[72:75], v[96:99], v[12:15]
    v_mfma_f32_16x16x32_bf16 v[8:11], v[76:79], v[96:99], v[8:11]
    ds_read_b128 v[96:99], v117 offset:9792
    s_waitcnt lgkmcnt(6)
    v_mfma_f32_16x16x32_bf16 v[48:51], v[80:83], v[100:103], v[48:51]
    v_mfma_f32_16x16x32_bf16 v[44:47], v[84:87], v[100:103], v[44:47]
    ds_read_b128 v[100:103], v121 offset:9216
    s_waitcnt lgkmcnt(6)
    v_mfma_f32_16x16x32_bf16 v[24:27], v[64:67], v[104:107], v[24:27]
    v_mfma_f32_16x16x32_bf16 v[20:23], v[68:71], v[104:107], v[20:23]
    v_mfma_f32_16x16x32_bf16 v[16:19], v[72:75], v[104:107], v[16:19]
    v_mfma_f32_16x16x32_bf16 v[12:15], v[76:79], v[104:107], v[12:15]
    ds_read_b128 v[104:107], v118 offset:8704
    s_waitcnt lgkmcnt(6)
    v_mfma_f32_16x16x32_bf16 v[52:55], v[80:83], v[108:111], v[52:55]
    v_mfma_f32_16x16x32_bf16 v[48:51], v[84:87], v[108:111], v[48:51]
    ds_read_b128 v[108:111], v121 offset:10240
    s_waitcnt lgkmcnt(6)
    v_mfma_f32_16x16x32_bf16 v[28:31], v[64:67], v[112:115], v[28:31]
    v_mfma_f32_16x16x32_bf16 v[24:27], v[68:71], v[112:115], v[24:27]
    v_mfma_f32_16x16x32_bf16 v[20:23], v[72:75], v[112:115], v[20:23]
    v_mfma_f32_16x16x32_bf16 v[16:19], v[76:79], v[112:115], v[16:19]
    buffer_load_dwordx4 v[64:67], v125, s[12:15], s23 offen offset:0
    s_waitcnt lgkmcnt(5)
    v_mfma_f32_16x16x32_bf16 v[56:59], v[80:83], v[88:91], v[56:59]
    v_mfma_f32_16x16x32_bf16 v[52:55], v[84:87], v[88:91], v[52:55]
    s_waitcnt lgkmcnt(0)
    s_barrier
    v_mfma_f32_16x16x32_bf16 v[28:31], v[68:71], v[92:95], v[28:31]
    v_mfma_f32_16x16x32_bf16 v[24:27], v[72:75], v[92:95], v[24:27]
    v_mfma_f32_16x16x32_bf16 v[20:23], v[76:79], v[92:95], v[20:23]
    buffer_load_dwordx4 v[68:71], v125, s[12:15], s23 offen offset:2048
    v_mfma_f32_16x16x32_bf16 v[60:63], v[80:83], v[96:99], v[60:63]
    v_mfma_f32_16x16x32_bf16 v[56:59], v[84:87], v[96:99], v[56:59]
    buffer_load_dwordx4 v[80:83], v119, s[12:15], s23 offen offset:0
    v_mfma_f32_16x16x32_bf16 v[28:31], v[72:75], v[100:103], v[28:31]
    v_mfma_f32_16x16x32_bf16 v[24:27], v[76:79], v[100:103], v[24:27]
    buffer_load_dwordx4 v[72:75], v125, s[12:15], s26 offen offset:0
    v_mfma_f32_16x16x32_bf16 v[60:63], v[84:87], v[104:107], v[60:63]
    buffer_load_dwordx4 v[84:87], v119, s[12:15], s23 offen offset:2048
    v_mfma_f32_16x16x32_bf16 v[28:31], v[76:79], v[108:111], v[28:31]
    buffer_load_dwordx4 v[76:79], v125, s[12:15], s26 offen offset:2048
    s_add_u32 s23, s23, 57344
    s_add_u32 s26, s26, 57344
    s_branch L_conv2_kernel_mloop2
L_conv2_kernel_mlast2:
    v_and_b32 v125, 15, v127
    v_and_b32 v126, 7, v127
    v_lshlrev_b32 v126, 4, v126
    v_lshl_add_u32 v125, v125, 7, v126
    v_lshrrev_b32 v126, 4, v127
    v_lshl_add_u32 v125, v126, 11, v125
    s_mov_b32 s36, 65536
    s_cmp_eq_u32 s32, 1
    s_cselect_b32 s36, 121856, s36
    s_cmp_eq_u32 s32, 2
    s_cselect_b32 s36, 81920, s36
    s_cmp_eq_u32 s32, 3
    s_cselect_b32 s36, 130048, s36
    s_mov_b32 s37, 98304
    s_cmp_eq_u32 s32, 1
    s_cselect_b32 s37, 138240, s37
    s_cmp_eq_u32 s32, 2
    s_cselect_b32 s37, 146432, s37
    s_cmp_eq_u32 s32, 3
    s_cselect_b32 s37, 154624, s37
    v_add_u32 v126, s37, v125
    v_add_u32 v125, s36, v125
    ds_read_b128 v[88:91], v120 offset:8192
    ds_read_b128 v[92:95], v120 offset:9216
    ds_read_b128 v[96:99], v116 offset:8704
    ds_read_b128 v[100:103], v120 offset:10240
    ds_read_b128 v[104:107], v116 offset:9792
    ds_read_b128 v[108:111], v120 offset:11264
    ds_read_b128 v[112:115], v116 offset:10880
    s_waitcnt vmcnt(5) lgkmcnt(6)
    v_mfma_f32_16x16x32_bf16 v[0:3], v[64:67], v[88:91], v[0:3]
    ds_read_b128 v[88:91], v120 offset:12288
    s_waitcnt vmcnt(4) lgkmcnt(6)
    v_mfma_f32_16x16x32_bf16 v[4:7], v[64:67], v[92:95], v[4:7]
    v_mfma_f32_16x16x32_bf16 v[0:3], v[68:71], v[92:95], v[0:3]
    ds_read_b128 v[92:95], v116 offset:11968
    s_waitcnt vmcnt(3) lgkmcnt(6)
    v_mfma_f32_16x16x32_bf16 v[32:35], v[80:83], v[96:99], v[32:35]
    ds_read_b128 v[96:99], v120 offset:13312
    s_waitcnt vmcnt(2) lgkmcnt(6)
    v_mfma_f32_16x16x32_bf16 v[8:11], v[64:67], v[100:103], v[8:11]
    v_mfma_f32_16x16x32_bf16 v[4:7], v[68:71], v[100:103], v[4:7]
    v_mfma_f32_16x16x32_bf16 v[0:3], v[72:75], v[100:103], v[0:3]
    ds_read_b128 v[100:103], v116 offset:13056
    s_waitcnt vmcnt(1) lgkmcnt(6)
    v_mfma_f32_16x16x32_bf16 v[36:39], v[80:83], v[104:107], v[36:39]
    v_mfma_f32_16x16x32_bf16 v[32:35], v[84:87], v[104:107], v[32:35]
    ds_read_b128 v[104:107], v120 offset:14336
    s_waitcnt vmcnt(0) lgkmcnt(6)
    v_mfma_f32_16x16x32_bf16 v[12:15], v[64:67], v[108:111], v[12:15]
    v_mfma_f32_16x16x32_bf16 v[8:11], v[68:71], v[108:111], v[8:11]
    v_mfma_f32_16x16x32_bf16 v[4:7], v[72:75], v[108:111], v[4:7]
    v_mfma_f32_16x16x32_bf16 v[0:3], v[76:79], v[108:111], v[0:3]
    ds_read_b128 v[108:111], v116 offset:14144
    s_waitcnt lgkmcnt(6)
    v_mfma_f32_16x16x32_bf16 v[40:43], v[80:83], v[112:115], v[40:43]
    v_mfma_f32_16x16x32_bf16 v[36:39], v[84:87], v[112:115], v[36:39]
    ds_read_b128 v[112:115], v120 offset:15360
    s_waitcnt lgkmcnt(6)
    v_mfma_f32_16x16x32_bf16 v[16:19], v[64:67], v[88:91], v[16:19]
    v_mfma_f32_16x16x32_bf16 v[12:15], v[68:71], v[88:91], v[12:15]
    v_mfma_f32_16x16x32_bf16 v[8:11], v[72:75], v[88:91], v[8:11]
    v_mfma_f32_16x16x32_bf16 v[4:7], v[76:79], v[88:91], v[4:7]
    ds_read_b128 v[88:91], v117 offset:8704
    v_xor_b32 v124, 0, v126
    ds_write_b128 v124, v[32:35]
    s_waitcnt lgkmcnt(7)
    v_mfma_f32_16x16x32_bf16 v[44:47], v[80:83], v[92:95], v[44:47]
    v_mfma_f32_16x16x32_bf16 v[40:43], v[84:87], v[92:95], v[40:43]
    ds_read_b128 v[92:95], v122 offset:0
    v_xor_b32 v123, 0, v125
    ds_write_b128 v123, v[0:3]
    s_waitcnt lgkmcnt(8)
    v_mfma_f32_16x16x32_bf16 v[20:23], v[64:67], v[96:99], v[20:23]
    v_mfma_f32_16x16x32_bf16 v[16:19], v[68:71], v[96:99], v[16:19]
    v_mfma_f32_16x16x32_bf16 v[12:15], v[72:75], v[96:99], v[12:15]
    v_mfma_f32_16x16x32_bf16 v[8:11], v[76:79], v[96:99], v[8:11]
    ds_read_b128 v[96:99], v117 offset:9792
    v_xor_b32 v123, 16, v126
    ds_write_b128 v123, v[36:39]
    s_waitcnt lgkmcnt(9)
    v_mfma_f32_16x16x32_bf16 v[48:51], v[80:83], v[100:103], v[48:51]
    v_mfma_f32_16x16x32_bf16 v[44:47], v[84:87], v[100:103], v[44:47]
    ds_read_b128 v[100:103], v121 offset:9216
    v_xor_b32 v124, 16, v125
    ds_write_b128 v124, v[4:7]
    s_waitcnt lgkmcnt(10)
    v_mfma_f32_16x16x32_bf16 v[24:27], v[64:67], v[104:107], v[24:27]
    v_mfma_f32_16x16x32_bf16 v[20:23], v[68:71], v[104:107], v[20:23]
    v_mfma_f32_16x16x32_bf16 v[16:19], v[72:75], v[104:107], v[16:19]
    v_mfma_f32_16x16x32_bf16 v[12:15], v[76:79], v[104:107], v[12:15]
    ds_read_b128 v[104:107], v118 offset:8704
    v_xor_b32 v124, 32, v126
    ds_write_b128 v124, v[40:43]
    s_waitcnt lgkmcnt(11)
    v_mfma_f32_16x16x32_bf16 v[52:55], v[80:83], v[108:111], v[52:55]
    v_mfma_f32_16x16x32_bf16 v[48:51], v[84:87], v[108:111], v[48:51]
    ds_read_b128 v[108:111], v121 offset:10240
    v_xor_b32 v123, 32, v125
    ds_write_b128 v123, v[8:11]
    s_waitcnt lgkmcnt(12)
    v_mfma_f32_16x16x32_bf16 v[28:31], v[64:67], v[112:115], v[28:31]
    v_mfma_f32_16x16x32_bf16 v[24:27], v[68:71], v[112:115], v[24:27]
    v_mfma_f32_16x16x32_bf16 v[20:23], v[72:75], v[112:115], v[20:23]
    v_mfma_f32_16x16x32_bf16 v[16:19], v[76:79], v[112:115], v[16:19]
    v_xor_b32 v123, 48, v126
    ds_write_b128 v123, v[44:47]
    s_waitcnt lgkmcnt(12)
    v_mfma_f32_16x16x32_bf16 v[56:59], v[80:83], v[88:91], v[56:59]
    v_mfma_f32_16x16x32_bf16 v[52:55], v[84:87], v[88:91], v[52:55]
    v_xor_b32 v124, 48, v125
    ds_write_b128 v124, v[12:15]
    s_waitcnt lgkmcnt(11)
    v_mfma_f32_16x16x32_bf16 v[28:31], v[68:71], v[92:95], v[28:31]
    v_mfma_f32_16x16x32_bf16 v[24:27], v[72:75], v[92:95], v[24:27]
    v_mfma_f32_16x16x32_bf16 v[20:23], v[76:79], v[92:95], v[20:23]
    v_xor_b32 v124, 64, v126
    ds_write_b128 v124, v[48:51]
    s_waitcnt lgkmcnt(10)
    v_mfma_f32_16x16x32_bf16 v[60:63], v[80:83], v[96:99], v[60:63]
    v_mfma_f32_16x16x32_bf16 v[56:59], v[84:87], v[96:99], v[56:59]
    v_xor_b32 v123, 64, v125
    ds_write_b128 v123, v[16:19]
    s_waitcnt lgkmcnt(9)
    v_mfma_f32_16x16x32_bf16 v[28:31], v[72:75], v[100:103], v[28:31]
    v_mfma_f32_16x16x32_bf16 v[24:27], v[76:79], v[100:103], v[24:27]
    v_xor_b32 v123, 80, v126
    ds_write_b128 v123, v[52:55]
    s_waitcnt lgkmcnt(8)
    v_mfma_f32_16x16x32_bf16 v[60:63], v[84:87], v[104:107], v[60:63]
    v_xor_b32 v124, 80, v125
    ds_write_b128 v124, v[20:23]
    s_waitcnt lgkmcnt(7)
    v_mfma_f32_16x16x32_bf16 v[28:31], v[76:79], v[108:111], v[28:31]
    v_xor_b32 v124, 96, v126
    ds_write_b128 v124, v[56:59]
    s_nop 7
    v_xor_b32 v123, 96, v125
    ds_write_b128 v123, v[24:27]
    v_xor_b32 v123, 112, v126
    ds_write_b128 v123, v[60:63]
    v_xor_b32 v124, 112, v125
    ds_write_b128 v124, v[28:31]
    s_setprio 0
    s_branch L_conv2_kernel_epi
L_conv2_kernel_helper:
    s_setprio 3
    v_add_u32 v92, 0, v7
    v_add_u32 v93, 1024, v7
    v_add_u32 v94, 2048, v7
    v_add_u32 v95, 3072, v7
    v_and_b32 v76, 4, v5
    v_lshrrev_b32 v76, 1, v76
    v_xor_b32 v76, v6, v76
    v_lshlrev_b32 v76, 4, v76
    v_lshl_add_u32 v76, v5, 6, v76
    s_mov_b32 s24, 0
    buffer_load_dwordx4 v[0:3], v92, s[8:11], s24 offen offset:0
    buffer_load_dwordx4 v[16:19], v92, s[8:11], s24 offen offset:64
    v_add_u32 v92, 128, v92
    buffer_load_dwordx4 v[4:7], v93, s[8:11], s24 offen offset:0
    buffer_load_dwordx4 v[20:23], v93, s[8:11], s24 offen offset:64
    v_add_u32 v93, 128, v93
    buffer_load_dwordx4 v[8:11], v94, s[8:11], s24 offen offset:0
    buffer_load_dwordx4 v[24:27], v94, s[8:11], s24 offen offset:64
    v_add_u32 v94, 128, v94
    buffer_load_dwordx4 v[12:15], v95, s[8:11], s24 offen offset:0
    buffer_load_dwordx4 v[28:31], v95, s[8:11], s24 offen offset:64
    v_add_u32 v95, 128, v95
    s_barrier
    s_mul_i32 s36, s42, 1024
    v_add_u32 v96, s36, v76
    v_add_u32 v97, 65536, v96
    s_mul_i32 s36, s42, 1088
    s_add_u32 s36, s36, 98304
    v_add_u32 v98, s36, v76
    s_waitcnt vmcnt(0)
    s_mov_b32 s28, 0
    s_mov_b32 s22, 2
    s_cmp_ge_u32 s20, 12
    s_cbranch_scc1 L_conv2_kernel_h2
    ds_write_b128 v96, v[0:3] offset:0
    ds_write_b128 v98, v[12:15] offset:0
    v_lshlrev_b32 v76, 16, v0
    v_and_b32 v84, s25, v0
    v_lshlrev_b32 v77, 16, v4
    v_and_b32 v85, s25, v4
    v_lshlrev_b32 v78, 16, v8
    v_and_b32 v86, s25, v8
    v_lshlrev_b32 v79, 16, v12
    v_and_b32 v87, s25, v12
    v_add_f32 v80, v76, v78
    v_add_f32 v88, v84, v86
    v_add_f32 v81, v77, v79
    v_add_f32 v89, v85, v87
    v_fma_f32 v82, v78, 4.0, v76
    v_fma_f32 v90, v86, 4.0, v84
    v_fma_f32 v83, v79, 4.0, v77
    v_fma_f32 v91, v87, 4.0, v85
    v_add_f32 v77, v80, v81
    v_add_f32 v85, v88, v89
    v_sub_f32 v78, v80, v81
    v_sub_f32 v86, v88, v89
    v_fma_f32 v79, v83, 2.0, v82
    v_fma_f32 v87, v91, 2.0, v90
    v_fma_f32 v82, v83, -2.0, v82
    v_fma_f32 v90, v91, -2.0, v90
    v_fmamk_f32 v80, v76, 0x41700000, v82
    v_fmamk_f32 v88, v84, 0x41700000, v90
    v_fmamk_f32 v80, v81, 0x41200000, v80
    v_fmamk_f32 v88, v89, 0x41200000, v88
    v_cvt_pk_bf16_f32 v4, v77, v85
    v_cvt_pk_bf16_f32 v8, v78, v86
    v_cvt_pk_bf16_f32 v64, v79, v87
    v_cvt_pk_bf16_f32 v68, v82, v90
    v_cvt_pk_bf16_f32 v72, v80, v88
    v_lshlrev_b32 v76, 16, v1
    v_and_b32 v84, s25, v1
    v_lshlrev_b32 v77, 16, v5
    v_and_b32 v85, s25, v5
    v_lshlrev_b32 v78, 16, v9
    v_and_b32 v86, s25, v9
    v_lshlrev_b32 v79, 16, v13
    v_and_b32 v87, s25, v13
    v_add_f32 v80, v76, v78
    v_add_f32 v88, v84, v86
    v_add_f32 v81, v77, v79
    v_add_f32 v89, v85, v87
    v_fma_f32 v82, v78, 4.0, v76
    v_fma_f32 v90, v86, 4.0, v84
    v_fma_f32 v83, v79, 4.0, v77
    v_fma_f32 v91, v87, 4.0, v85
    v_add_f32 v77, v80, v81
    v_add_f32 v85, v88, v89
    v_sub_f32 v78, v80, v81
    v_sub_f32 v86, v88, v89
    v_fma_f32 v79, v83, 2.0, v82
    v_fma_f32 v87, v91, 2.0, v90
    v_fma_f32 v82, v83, -2.0, v82
    v_fma_f32 v90, v91, -2.0, v90
    v_fmamk_f32 v80, v76, 0x41700000, v82
    v_fmamk_f32 v88, v84, 0x41700000, v90
    v_fmamk_f32 v80, v81, 0x41200000, v80
    v_fmamk_f32 v88, v89, 0x41200000, v88
    v_cvt_pk_bf16_f32 v5, v77, v85
    v_cvt_pk_bf16_f32 v9, v78, v86
    v_cvt_pk_bf16_f32 v65, v79, v87
    v_cvt_pk_bf16_f32 v69, v82, v90
    v_cvt_pk_bf16_f32 v73, v80, v88
    v_lshlrev_b32 v76, 16, v2
    v_and_b32 v84, s25, v2
    v_lshlrev_b32 v77, 16, v6
    v_and_b32 v85, s25, v6
    v_lshlrev_b32 v78, 16, v10
    v_and_b32 v86, s25, v10
    v_lshlrev_b32 v79, 16, v14
    v_and_b32 v87, s25, v14
    v_add_f32 v80, v76, v78
    v_add_f32 v88, v84, v86
    v_add_f32 v81, v77, v79
    v_add_f32 v89, v85, v87
    v_fma_f32 v82, v78, 4.0, v76
    v_fma_f32 v90, v86, 4.0, v84
    v_fma_f32 v83, v79, 4.0, v77
    v_fma_f32 v91, v87, 4.0, v85
    v_add_f32 v77, v80, v81
    v_add_f32 v85, v88, v89
    v_sub_f32 v78, v80, v81
    v_sub_f32 v86, v88, v89
    v_fma_f32 v79, v83, 2.0, v82
    v_fma_f32 v87, v91, 2.0, v90
    v_fma_f32 v82, v83, -2.0, v82
    v_fma_f32 v90, v91, -2.0, v90
    v_fmamk_f32 v80, v76, 0x41700000, v82
    v_fmamk_f32 v88, v84, 0x41700000, v90
    v_fmamk_f32 v80, v81, 0x41200000, v80
    v_fmamk_f32 v88, v89, 0x41200000, v88
    v_cvt_pk_bf16_f32 v6, v77, v85
    v_cvt_pk_bf16_f32 v10, v78, v86
    v_cvt_pk_bf16_f32 v66, v79, v87
    v_cvt_pk_bf16_f32 v70, v82, v90
    v_cvt_pk_bf16_f32 v74, v80, v88
    v_lshlrev_b32 v76, 16, v3
    v_and_b32 v84, s25, v3
    v_lshlrev_b32 v77, 16, v7
    v_and_b32 v85, s25, v7
    v_lshlrev_b32 v78, 16, v11
    v_and_b32 v86, s25, v11
    v_lshlrev_b32 v79, 16, v15
    v_and_b32 v87, s25, v15
    v_add_f32 v80, v76, v78
    v_add_f32 v88, v84, v86
    v_add_f32 v81, v77, v79
    v_add_f32 v89, v85, v87
    v_fma_f32 v82, v78, 4.0, v76
    v_fma_f32 v90, v86, 4.0, v84
    v_fma_f32 v83, v79, 4.0, v77
    v_fma_f32 v91, v87, 4.0, v85
    v_add_f32 v77, v80, v81
    v_add_f32 v85, v88, v89
    v_sub_f32 v78, v80, v81
    v_sub_f32 v86, v88, v89
    v_fma_f32 v79, v83, 2.0, v82
    v_fma_f32 v87, v91, 2.0, v90
    v_fma_f32 v82, v83, -2.0, v82
    v_fma_f32 v90, v91, -2.0, v90
    v_fmamk_f32 v80, v76, 0x41700000, v82
    v_fmamk_f32 v88, v84, 0x41700000, v90
    v_fmamk_f32 v80, v81, 0x41200000, v80
    v_fmamk_f32 v88, v89, 0x41200000, v88
    v_cvt_pk_bf16_f32 v7, v77, v85
    v_cvt_pk_bf16_f32 v11, v78, v86
    v_cvt_pk_bf16_f32 v67, v79, v87
    v_cvt_pk_bf16_f32 v71, v82, v90
    v_cvt_pk_bf16_f32 v75, v80, v88
    ds_write_b128 v96, v[64:67] offset:49152
    ds_write_b128 v97, v[68:71] offset:0
    ds_write_b128 v97, v[72:75] offset:16384
    ds_write_b128 v96, v[4:7] offset:16384
    ds_write_b128 v96, v[8:11] offset:32768
    buffer_load_dwordx4 v[32:35], v92, s[8:11], s24 offen offset:0
    buffer_load_dwordx4 v[48:51], v92, s[8:11], s24 offen offset:64
    v_add_u32 v92, 128, v92
    buffer_load_dwordx4 v[36:39], v93, s[8:11], s24 offen offset:0
    buffer_load_dwordx4 v[52:55], v93, s[8:11], s24 offen offset:64
    v_add_u32 v93, 128, v93
    s_waitcnt lgkmcnt(0)
    s_barrier
    s_setprio 1
L_conv2_kernel_hloop1:
    s_cmp_lt_u32 s28, 5
    s_cselect_b32 s24, 0, 2130706432
    v_lshlrev_b32 v76, 16, v16
    v_and_b32 v84, s25, v16
    v_lshlrev_b32 v77, 16, v20
    v_and_b32 v85, s25, v20
    v_lshlrev_b32 v78, 16, v24
    v_and_b32 v86, s25, v24
    v_lshlrev_b32 v79, 16, v28
    v_and_b32 v87, s25, v28
    v_add_f32 v80, v76, v78
    v_add_f32 v88, v84, v86
    v_add_f32 v81, v77, v79
    v_add_f32 v89, v85, v87
    v_fma_f32 v82, v78, 4.0, v76
    buffer_load_dwordx4 v[40:43], v94, s[8:11], s24 offen offset:0
    buffer_load_dwordx4 v[56:59], v94, s[8:11], s24 offen offset:64
    v_add_u32 v94, 128, v94
    v_fma_f32 v90, v86, 4.0, v84
    v_fma_f32 v83, v79, 4.0, v77
    v_fma_f32 v91, v87, 4.0, v85
    v_add_f32 v77, v80, v81
    v_add_f32 v85, v88, v89
    v_sub_f32 v78, v80, v81
    v_sub_f32 v86, v88, v89
    v_fma_f32 v79, v83, 2.0, v82
    v_fma_f32 v87, v91, 2.0, v90
    v_fma_f32 v82, v83, -2.0, v82
    v_fma_f32 v90, v91, -2.0, v90
    v_fmamk_f32 v80, v76, 0x41700000, v82
    v_fmamk_f32 v88, v84, 0x41700000, v90
    v_fmamk_f32 v80, v81, 0x41200000, v80
    v_fmamk_f32 v88, v89, 0x41200000, v88
    v_cvt_pk_bf16_f32 v20, v77, v85
    v_cvt_pk_bf16_f32 v24, v78, v86
    v_cvt_pk_bf16_f32 v64, v79, v87
    v_cvt_pk_bf16_f32 v68, v82, v90
    v_cvt_pk_bf16_f32 v72, v80, v88
    v_lshlrev_b32 v76, 16, v17
    v_and_b32 v84, s25, v17
    v_lshlrev_b32 v77, 16, v21
    v_and_b32 v85, s25, v21
    v_lshlrev_b32 v78, 16, v25
    v_and_b32 v86, s25, v25
    v_lshlrev_b32 v79, 16, v29
    v_and_b32 v87, s25, v29
    v_add_f32 v80, v76, v78
    v_add_f32 v88, v84, v86
    v_add_f32 v81, v77, v79
    v_add_f32 v89, v85, v87
    v_fma_f32 v82, v78, 4.0, v76
    v_fma_f32 v90, v86, 4.0, v84
    v_fma_f32 v83, v79, 4.0, v77
    v_fma_f32 v91, v87, 4.0, v85
    v_add_f32 v77, v80, v81
    v_add_f32 v85, v88, v89
    v_sub_f32 v78, v80, v81
    v_sub_f32 v86, v88, v89
    v_fma_f32 v79, v83, 2.0, v82
    v_fma_f32 v87, v91, 2.0, v90
    v_fma_f32 v82, v83, -2.0, v82
    v_fma_f32 v90, v91, -2.0, v90
    v_fmamk_f32 v80, v76, 0x41700000, v82
    v_fmamk_f32 v88, v84, 0x41700000, v90
    v_fmamk_f32 v80, v81, 0x41200000, v80
    v_fmamk_f32 v88, v89, 0x41200000, v88
    v_cvt_pk_bf16_f32 v21, v77, v85
    v_cvt_pk_bf16_f32 v25, v78, v86
    v_cvt_pk_bf16_f32 v65, v79, v87
    v_cvt_pk_bf16_f32 v69, v82, v90
    v_cvt_pk_bf16_f32 v73, v80, v88
    buffer_load_dwordx4 v[44:47], v95, s[8:11], s24 offen offset:0
    buffer_load_dwordx4 v[60:63], v95, s[8:11], s24 offen offset:64
    v_add_u32 v95, 128, v95
    v_lshlrev_b32 v76, 16, v18
    v_and_b32 v84, s25, v18
    v_lshlrev_b32 v77, 16, v22
    v_and_b32 v85, s25, v22
    v_lshlrev_b32 v78, 16, v26
    v_and_b32 v86, s25, v26
    v_lshlrev_b32 v79, 16, v30
    v_and_b32 v87, s25, v30
    v_add_f32 v80, v76, v78
    v_add_f32 v88, v84, v86
    v_add_f32 v81, v77, v79
    v_add_f32 v89, v85, v87
    v_fma_f32 v82, v78, 4.0, v76
    v_fma_f32 v90, v86, 4.0, v84
    v_fma_f32 v83, v79, 4.0, v77
    v_fma_f32 v91, v87, 4.0, v85
    v_add_f32 v77, v80, v81
    v_add_f32 v85, v88, v89
    v_sub_f32 v78, v80, v81
    v_sub_f32 v86, v88, v89
    v_fma_f32 v79, v83, 2.0, v82
    v_fma_f32 v87, v91, 2.0, v90
    v_fma_f32 v82, v83, -2.0, v82
    v_fma_f32 v90, v91, -2.0, v90
    v_fmamk_f32 v80, v76, 0x41700000, v82
    v_fmamk_f32 v88, v84, 0x41700000, v90
    v_fmamk_f32 v80, v81, 0x41200000, v80
    v_fmamk_f32 v88, v89, 0x41200000, v88
    v_cvt_pk_bf16_f32 v22, v77, v85
    v_cvt_pk_bf16_f32 v26, v78, v86
    v_cvt_pk_bf16_f32 v66, v79, v87
    v_cvt_pk_bf16_f32 v70, v82, v90
    v_cvt_pk_bf16_f32 v74, v80, v88
    v_lshlrev_b32 v76, 16, v19
    v_and_b32 v84, s25, v19
    v_lshlrev_b32 v77, 16, v23
    v_and_b32 v85, s25, v23
    v_lshlrev_b32 v78, 16, v27
    v_and_b32 v86, s25, v27
    v_lshlrev_b32 v79, 16, v31
    v_and_b32 v87, s25, v31
    v_add_f32 v80, v76, v78
    v_add_f32 v88, v84, v86
    v_add_f32 v81, v77, v79
    v_add_f32 v89, v85, v87
    v_fma_f32 v82, v78, 4.0, v76
    v_fma_f32 v90, v86, 4.0, v84
    v_fma_f32 v83, v79, 4.0, v77
    v_fma_f32 v91, v87, 4.0, v85
    v_add_f32 v77, v80, v81
    v_add_f32 v85, v88, v89
    v_sub_f32 v78, v80, v81
    v_sub_f32 v86, v88, v89
    v_fma_f32 v79, v83, 2.0, v82
    v_fma_f32 v87, v91, 2.0, v90
    v_fma_f32 v82, v83, -2.0, v82
    v_fma_f32 v90, v91, -2.0, v90
    v_fmamk_f32 v80, v76, 0x41700000, v82
    v_fmamk_f32 v88, v84, 0x41700000, v90
    v_fmamk_f32 v80, v81, 0x41200000, v80
    v_fmamk_f32 v88, v89, 0x41200000, v88
    v_cvt_pk_bf16_f32 v23, v77, v85
    v_cvt_pk_bf16_f32 v27, v78, v86
    v_cvt_pk_bf16_f32 v67, v79, v87
    v_cvt_pk_bf16_f32 v71, v82, v90
    v_cvt_pk_bf16_f32 v75, v80, v88
    ds_write_b128 v96, v[64:67] offset:57344
    ds_write_b128 v97, v[68:71] offset:8192
    ds_write_b128 v97, v[72:75] offset:24576
    ds_write_b128 v96, v[16:19] offset:8192
    ds_write_b128 v96, v[20:23] offset:24576
    ds_write_b128 v96, v[24:27] offset:40960
    ds_write_b128 v98, v[28:31] offset:8704
    s_add_u32 s28, s28, 1
    s_waitcnt lgkmcnt(0)
    s_barrier
    s_cmp_lt_u32 s28, 5
    s_cselect_b32 s24, 0, 2130706432
    s_waitcnt vmcnt(0)
    v_lshlrev_b32 v76, 16, v32
    v_and_b32 v84, s25, v32
    v_lshlrev_b32 v77, 16, v36
    v_and_b32 v85, s25, v36
    v_lshlrev_b32 v78, 16, v40
    v_and_b32 v86, s25, v40
    v_lshlrev_b32 v79, 16, v44
    v_and_b32 v87, s25, v44
    v_add_f32 v80, v76, v78
    v_add_f32 v88, v84, v86
    v_add_f32 v81, v77, v79
    v_add_f32 v89, v85, v87
    v_fma_f32 v82, v78, 4.0, v76
    v_fma_f32 v90, v86, 4.0, v84
    v_fma_f32 v83, v79, 4.0, v77
    v_fma_f32 v91, v87, 4.0, v85
    v_add_f32 v77, v80, v81
    v_add_f32 v85, v88, v89
    v_sub_f32 v78, v80, v81
    v_sub_f32 v86, v88, v89
    v_fma_f32 v79, v83, 2.0, v82
    v_fma_f32 v87, v91, 2.0, v90
    v_fma_f32 v82, v83, -2.0, v82
    v_fma_f32 v90, v91, -2.0, v90
    v_fmamk_f32 v80, v76, 0x41700000, v82
    v_fmamk_f32 v88, v84, 0x41700000, v90
    v_fmamk_f32 v80, v81, 0x41200000, v80
    v_fmamk_f32 v88, v89, 0x41200000, v88
    v_cvt_pk_bf16_f32 v36, v77, v85
    v_cvt_pk_bf16_f32 v40, v78, v86
    v_cvt_pk_bf16_f32 v64, v79, v87
    v_cvt_pk_bf16_f32 v68, v82, v90
    v_cvt_pk_bf16_f32 v72, v80, v88
    v_lshlrev_b32 v76, 16, v33
    v_and_b32 v84, s25, v33
    v_lshlrev_b32 v77, 16, v37
    v_and_b32 v85, s25, v37
    v_lshlrev_b32 v78, 16, v41
    v_and_b32 v86, s25, v41
    buffer_load_dwordx4 v[0:3], v92, s[8:11], s24 offen offset:0
    buffer_load_dwordx4 v[16:19], v92, s[8:11], s24 offen offset:64
    v_add_u32 v92, 128, v92
    v_lshlrev_b32 v79, 16, v45
    v_and_b32 v87, s25, v45
    v_add_f32 v80, v76, v78
    v_add_f32 v88, v84, v86
    v_add_f32 v81, v77, v79
    v_add_f32 v89, v85, v87
    v_fma_f32 v82, v78, 4.0, v76
    v_fma_f32 v90, v86, 4.0, v84
    v_fma_f32 v83, v79, 4.0, v77
    v_fma_f32 v91, v87, 4.0, v85
    v_add_f32 v77, v80, v81
    v_add_f32 v85, v88, v89
    v_sub_f32 v78, v80, v81
    v_sub_f32 v86, v88, v89
    v_fma_f32 v79, v83, 2.0, v82
    v_fma_f32 v87, v91, 2.0, v90
    v_fma_f32 v82, v83, -2.0, v82
    v_fma_f32 v90, v91, -2.0, v90
    v_fmamk_f32 v80, v76, 0x41700000, v82
    v_fmamk_f32 v88, v84, 0x41700000, v90
    v_fmamk_f32 v80, v81, 0x41200000, v80
    v_fmamk_f32 v88, v89, 0x41200000, v88
    v_cvt_pk_bf16_f32 v37, v77, v85
    v_cvt_pk_bf16_f32 v41, v78, v86
    v_cvt_pk_bf16_f32 v65, v79, v87
    v_cvt_pk_bf16_f32 v69, v82, v90
    v_cvt_pk_bf16_f32 v73, v80, v88
    v_lshlrev_b32 v76, 16, v34
    v_and_b32 v84, s25, v34
    v_lshlrev_b32 v77, 16, v38
    v_and_b32 v85, s25, v38
    v_lshlrev_b32 v78, 16, v42
    v_and_b32 v86, s25, v42
    v_lshlrev_b32 v79, 16, v46
    v_and_b32 v87, s25, v46
    v_add_f32 v80, v76, v78
    v_add_f32 v88, v84, v86
    v_add_f32 v81, v77, v79
    v_add_f32 v89, v85, v87
    v_fma_f32 v82, v78, 4.0, v76
    v_fma_f32 v90, v86, 4.0, v84
    v_fma_f32 v83, v79, 4.0, v77
    v_fma_f32 v91, v87, 4.0, v85
    v_add_f32 v77, v80, v81
    v_add_f32 v85, v88, v89
    v_sub_f32 v78, v80, v81
    v_sub_f32 v86, v88, v89
    v_fma_f32 v79, v83, 2.0, v82
    v_fma_f32 v87, v91, 2.0, v90
    v_fma_f32 v82, v83, -2.0, v82
    v_fma_f32 v90, v91, -2.0, v90
    v_fmamk_f32 v80, v76, 0x41700000, v82
    v_fmamk_f32 v88, v84, 0x41700000, v90
    buffer_load_dwordx4 v[4:7], v93, s[8:11], s24 offen offset:0
    buffer_load_dwordx4 v[20:23], v93, s[8:11], s24 offen offset:64
    v_add_u32 v93, 128, v93
    v_fmamk_f32 v80, v81, 0x41200000, v80
    v_fmamk_f32 v88, v89, 0x41200000, v88
    v_cvt_pk_bf16_f32 v38, v77, v85
    v_cvt_pk_bf16_f32 v42, v78, v86
    v_cvt_pk_bf16_f32 v66, v79, v87
    v_cvt_pk_bf16_f32 v70, v82, v90
    v_cvt_pk_bf16_f32 v74, v80, v88
    v_lshlrev_b32 v76, 16, v35
    v_and_b32 v84, s25, v35
    v_lshlrev_b32 v77, 16, v39
    v_and_b32 v85, s25, v39
    v_lshlrev_b32 v78, 16, v43
    v_and_b32 v86, s25, v43
    v_lshlrev_b32 v79, 16, v47
    v_and_b32 v87, s25, v47
    v_add_f32 v80, v76, v78
    v_add_f32 v88, v84, v86
    v_add_f32 v81, v77, v79
    v_add_f32 v89, v85, v87
    v_fma_f32 v82, v78, 4.0, v76
    v_fma_f32 v90, v86, 4.0, v84
    v_fma_f32 v83, v79, 4.0, v77
    v_fma_f32 v91, v87, 4.0, v85
    v_add_f32 v77, v80, v81
    v_add_f32 v85, v88, v89
    v_sub_f32 v78, v80, v81
    v_sub_f32 v86, v88, v89
    v_fma_f32 v79, v83, 2.0, v82
    v_fma_f32 v87, v91, 2.0, v90
    v_fma_f32 v82, v83, -2.0, v82
    v_fma_f32 v90, v91, -2.0, v90
    v_fmamk_f32 v80, v76, 0x41700000, v82
    v_fmamk_f32 v88, v84, 0x41700000, v90
    v_fmamk_f32 v80, v81, 0x41200000, v80
    v_fmamk_f32 v88, v89, 0x41200000, v88
    v_cvt_pk_bf16_f32 v39, v77, v85
    v_cvt_pk_bf16_f32 v43, v78, v86
    v_cvt_pk_bf16_f32 v67, v79, v87
    v_cvt_pk_bf16_f32 v71, v82, v90
    v_cvt_pk_bf16_f32 v75, v80, v88
    ds_write_b128 v96, v[64:67] offset:49152
    ds_write_b128 v97, v[68:71] offset:0
    ds_write_b128 v97, v[72:75] offset:16384
    ds_write_b128 v96, v[32:35] offset:0
    ds_write_b128 v96, v[36:39] offset:16384
    ds_write_b128 v96, v[40:43] offset:32768
    ds_write_b128 v98, v[44:47] offset:0
    s_add_u32 s28, s28, 1
    s_waitcnt lgkmcnt(0)
    s_barrier
    s_cmp_lt_u32 s28, 5
    s_cselect_b32 s24, 0, 2130706432
    v_lshlrev_b32 v76, 16, v48
    v_and_b32 v84, s25, v48
    v_lshlrev_b32 v77, 16, v52
    v_and_b32 v85, s25, v52
    v_lshlrev_b32 v78, 16, v56
    v_and_b32 v86, s25, v56
    v_lshlrev_b32 v79, 16, v60
    v_and_b32 v87, s25, v60
    v_add_f32 v80, v76, v78
    v_add_f32 v88, v84, v86
    v_add_f32 v81, v77, v79
    v_add_f32 v89, v85, v87
    v_fma_f32 v82, v78, 4.0, v76
    buffer_load_dwordx4 v[8:11], v94, s[8:11], s24 offen offset:0
    buffer_load_dwordx4 v[24:27], v94, s[8:11], s24 offen offset:64
    v_add_u32 v94, 128, v94
    v_fma_f32 v90, v86, 4.0, v84
    v_fma_f32 v83, v79, 4.0, v77
    v_fma_f32 v91, v87, 4.0, v85
    v_add_f32 v77, v80, v81
    v_add_f32 v85, v88, v89
    v_sub_f32 v78, v80, v81
    v_sub_f32 v86, v88, v89
    v_fma_f32 v79, v83, 2.0, v82
    v_fma_f32 v87, v91, 2.0, v90
    v_fma_f32 v82, v83, -2.0, v82
    v_fma_f32 v90, v91, -2.0, v90
    v_fmamk_f32 v80, v76, 0x41700000, v82
    v_fmamk_f32 v88, v84, 0x41700000, v90
    v_fmamk_f32 v80, v81, 0x41200000, v80
    v_fmamk_f32 v88, v89, 0x41200000, v88
    v_cvt_pk_bf16_f32 v52, v77, v85
    v_cvt_pk_bf16_f32 v56, v78, v86
    v_cvt_pk_bf16_f32 v64, v79, v87
    v_cvt_pk_bf16_f32 v68, v82, v90
    v_cvt_pk_bf16_f32 v72, v80, v88
    v_lshlrev_b32 v76, 16, v49
    v_and_b32 v84, s25, v49
    v_lshlrev_b32 v77, 16, v53
    v_and_b32 v85, s25, v53
    v_lshlrev_b32 v78, 16, v57
    v_and_b32 v86, s25, v57
    v_lshlrev_b32 v79, 16, v61
    v_and_b32 v87, s25, v61
    v_add_f32 v80, v76, v78
    v_add_f32 v88, v84, v86
    v_add_f32 v81, v77, v79
    v_add_f32 v89, v85, v87
    v_fma_f32 v82, v78, 4.0, v76
    v_fma_f32 v90, v86, 4.0, v84
    v_fma_f32 v83, v79, 4.0, v77
    v_fma_f32 v91, v87, 4.0, v85
    v_add_f32 v77, v80, v81
    v_add_f32 v85, v88, v89
    v_sub_f32 v78, v80, v81
    v_sub_f32 v86, v88, v89
    v_fma_f32 v79, v83, 2.0, v82
    v_fma_f32 v87, v91, 2.0, v90
    v_fma_f32 v82, v83, -2.0, v82
    v_fma_f32 v90, v91, -2.0, v90
    v_fmamk_f32 v80, v76, 0x41700000, v82
    v_fmamk_f32 v88, v84, 0x41700000, v90
    v_fmamk_f32 v80, v81, 0x41200000, v80
    v_fmamk_f32 v88, v89, 0x41200000, v88
    v_cvt_pk_bf16_f32 v53, v77, v85
    v_cvt_pk_bf16_f32 v57, v78, v86
    v_cvt_pk_bf16_f32 v65, v79, v87
    v_cvt_pk_bf16_f32 v69, v82, v90
    v_cvt_pk_bf16_f32 v73, v80, v88
    buffer_load_dwordx4 v[12:15], v95, s[8:11], s24 offen offset:0
    buffer_load_dwordx4 v[28:31], v95, s[8:11], s24 offen offset:64
    v_add_u32 v95, 128, v95
    v_lshlrev_b32 v76, 16, v50
    v_and_b32 v84, s25, v50
    v_lshlrev_b32 v77, 16, v54
    v_and_b32 v85, s25, v54
    v_lshlrev_b32 v78, 16, v58
    v_and_b32 v86, s25, v58
    v_lshlrev_b32 v79, 16, v62
    v_and_b32 v87, s25, v62
    v_add_f32 v80, v76, v78
    v_add_f32 v88, v84, v86
    v_add_f32 v81, v77, v79
    v_add_f32 v89, v85, v87
    v_fma_f32 v82, v78, 4.0, v76
    v_fma_f32 v90, v86, 4.0, v84
    v_fma_f32 v83, v79, 4.0, v77
    v_fma_f32 v91, v87, 4.0, v85
    v_add_f32 v77, v80, v81
    v_add_f32 v85, v88, v89
    v_sub_f32 v78, v80, v81
    v_sub_f32 v86, v88, v89
    v_fma_f32 v79, v83, 2.0, v82
    v_fma_f32 v87, v91, 2.0, v90
    v_fma_f32 v82, v83, -2.0, v82
    v_fma_f32 v90, v91, -2.0, v90
    v_fmamk_f32 v80, v76, 0x41700000, v82
    v_fmamk_f32 v88, v84, 0x41700000, v90
    v_fmamk_f32 v80, v81, 0x41200000, v80
    v_fmamk_f32 v88, v89, 0x41200000, v88
    v_cvt_pk_bf16_f32 v54, v77, v85
    v_cvt_pk_bf16_f32 v58, v78, v86
    v_cvt_pk_bf16_f32 v66, v79, v87
    v_cvt_pk_bf16_f32 v70, v82, v90
    v_cvt_pk_bf16_f32 v74, v80, v88
    v_lshlrev_b32 v76, 16, v51
    v_and_b32 v84, s25, v51
    v_lshlrev_b32 v77, 16, v55
    v_and_b32 v85, s25, v55
    v_lshlrev_b32 v78, 16, v59
    v_and_b32 v86, s25, v59
    v_lshlrev_b32 v79, 16, v63
    v_and_b32 v87, s25, v63
    v_add_f32 v80, v76, v78
    v_add_f32 v88, v84, v86
    v_add_f32 v81, v77, v79
    v_add_f32 v89, v85, v87
    v_fma_f32 v82, v78, 4.0, v76
    v_fma_f32 v90, v86, 4.0, v84
    v_fma_f32 v83, v79, 4.0, v77
    v_fma_f32 v91, v87, 4.0, v85
    v_add_f32 v77, v80, v81
    v_add_f32 v85, v88, v89
    v_sub_f32 v78, v80, v81
    v_sub_f32 v86, v88, v89
    v_fma_f32 v79, v83, 2.0, v82
    v_fma_f32 v87, v91, 2.0, v90
    v_fma_f32 v82, v83, -2.0, v82
    v_fma_f32 v90, v91, -2.0, v90
    v_fmamk_f32 v80, v76, 0x41700000, v82
    v_fmamk_f32 v88, v84, 0x41700000, v90
    v_fmamk_f32 v80, v81, 0x41200000, v80
    v_fmamk_f32 v88, v89, 0x41200000, v88
    v_cvt_pk_bf16_f32 v55, v77, v85
    v_cvt_pk_bf16_f32 v59, v78, v86
    v_cvt_pk_bf16_f32 v67, v79, v87
    v_cvt_pk_bf16_f32 v71, v82, v90
    v_cvt_pk_bf16_f32 v75, v80, v88
    ds_write_b128 v96, v[64:67] offset:57344
    ds_write_b128 v97, v[68:71] offset:8192
    ds_write_b128 v97, v[72:75] offset:24576
    ds_write_b128 v96, v[48:51] offset:8192
    ds_write_b128 v96, v[52:55] offset:24576
    ds_write_b128 v96, v[56:59] offset:40960
    ds_write_b128 v98, v[60:63] offset:8704
    s_add_u32 s28, s28, 1
    s_waitcnt lgkmcnt(0)
    s_barrier
    s_cmp_eq_u32 s22, 1
    s_cbranch_scc1 L_conv2_kernel_hlast1
    s_cmp_lt_u32 s28, 5
    s_cselect_b32 s24, 0, 2130706432
    s_waitcnt vmcnt(0)
    v_lshlrev_b32 v76, 16, v0
    v_and_b32 v84, s25, v0
    v_lshlrev_b32 v77, 16, v4
    v_and_b32 v85, s25, v4
    v_lshlrev_b32 v78, 16, v8
    v_and_b32 v86, s25, v8
    v_lshlrev_b32 v79, 16, v12
    v_and_b32 v87, s25, v12
    v_add_f32 v80, v76, v78
    v_add_f32 v88, v84, v86
    v_add_f32 v81, v77, v79
    v_add_f32 v89, v85, v87
    v_fma_f32 v82, v78, 4.0, v76
    v_fma_f32 v90, v86, 4.0, v84
    v_fma_f32 v83, v79, 4.0, v77
    v_fma_f32 v91, v87, 4.0, v85
    v_add_f32 v77, v80, v81
    v_add_f32 v85, v88, v89
    v_sub_f32 v78, v80, v81
    v_sub_f32 v86, v88, v89
    v_fma_f32 v79, v83, 2.0, v82
    v_fma_f32 v87, v91, 2.0, v90
    v_fma_f32 v82, v83, -2.0, v82
    v_fma_f32 v90, v91, -2.0, v90
    v_fmamk_f32 v80, v76, 0x41700000, v82
    v_fmamk_f32 v88, v84, 0x41700000, v90
    v_fmamk_f32 v80, v81, 0x41200000, v80
    v_fmamk_f32 v88, v89, 0x41200000, v88
    v_cvt_pk_bf16_f32 v4, v77, v85
    v_cvt_pk_bf16_f32 v8, v78, v86
    v_cvt_pk_bf16_f32 v64, v79, v87
    v_cvt_pk_bf16_f32 v68, v82, v90
    v_cvt_pk_bf16_f32 v72, v80, v88
    v_lshlrev_b32 v76, 16, v1
    v_and_b32 v84, s25, v1
    v_lshlrev_b32 v77, 16, v5
    v_and_b32 v85, s25, v5
    v_lshlrev_b32 v78, 16, v9
    v_and_b32 v86, s25, v9
    buffer_load_dwordx4 v[32:35], v92, s[8:11], s24 offen offset:0
    buffer_load_dwordx4 v[48:51], v92, s[8:11], s24 offen offset:64
    v_add_u32 v92, 128, v92
    v_lshlrev_b32 v79, 16, v13
    v_and_b32 v87, s25, v13
    v_add_f32 v80, v76, v78
    v_add_f32 v88, v84, v86
    v_add_f32 v81, v77, v79
    v_add_f32 v89, v85, v87
    v_fma_f32 v82, v78, 4.0, v76
    v_fma_f32 v90, v86, 4.0, v84
    v_fma_f32 v83, v79, 4.0, v77
    v_fma_f32 v91, v87, 4.0, v85
    v_add_f32 v77, v80, v81
    v_add_f32 v85, v88, v89
    v_sub_f32 v78, v80, v81
    v_sub_f32 v86, v88, v89
    v_fma_f32 v79, v83, 2.0, v82
    v_fma_f32 v87, v91, 2.0, v90
    v_fma_f32 v82, v83, -2.0, v82
    v_fma_f32 v90, v91, -2.0, v90
    v_fmamk_f32 v80, v76, 0x41700000, v82
    v_fmamk_f32 v88, v84, 0x41700000, v90
    v_fmamk_f32 v80, v81, 0x41200000, v80
    v_fmamk_f32 v88, v89, 0x41200000, v88
    v_cvt_pk_bf16_f32 v5, v77, v85
    v_cvt_pk_bf16_f32 v9, v78, v86
    v_cvt_pk_bf16_f32 v65, v79, v87
    v_cvt_pk_bf16_f32 v69, v82, v90
    v_cvt_pk_bf16_f32 v73, v80, v88
    v_lshlrev_b32 v76, 16, v2
    v_and_b32 v84, s25, v2
    v_lshlrev_b32 v77, 16, v6
    v_and_b32 v85, s25, v6
    v_lshlrev_b32 v78, 16, v10
    v_and_b32 v86, s25, v10
    v_lshlrev_b32 v79, 16, v14
    v_and_b32 v87, s25, v14
    v_add_f32 v80, v76, v78
    v_add_f32 v88, v84, v86
    v_add_f32 v81, v77, v79
    v_add_f32 v89, v85, v87
    v_fma_f32 v82, v78, 4.0, v76
    v_fma_f32 v90, v86, 4.0, v84
    v_fma_f32 v83, v79, 4.0, v77
    v_fma_f32 v91, v87, 4.0, v85
    v_add_f32 v77, v80, v81
    v_add_f32 v85, v88, v89
    v_sub_f32 v78, v80, v81
    v_sub_f32 v86, v88, v89
    v_fma_f32 v79, v83, 2.0, v82
    v_fma_f32 v87, v91, 2.0, v90
    v_fma_f32 v82, v83, -2.0, v82
    v_fma_f32 v90, v91, -2.0, v90
    v_fmamk_f32 v80, v76, 0x41700000, v82
    v_fmamk_f32 v88, v84, 0x41700000, v90
    buffer_load_dwordx4 v[36:39], v93, s[8:11], s24 offen offset:0
    buffer_load_dwordx4 v[52:55], v93, s[8:11], s24 offen offset:64
    v_add_u32 v93, 128, v93
    v_fmamk_f32 v80, v81, 0x41200000, v80
    v_fmamk_f32 v88, v89, 0x41200000, v88
    v_cvt_pk_bf16_f32 v6, v77, v85
    v_cvt_pk_bf16_f32 v10, v78, v86
    v_cvt_pk_bf16_f32 v66, v79, v87
    v_cvt_pk_bf16_f32 v70, v82, v90
    v_cvt_pk_bf16_f32 v74, v80, v88
    v_lshlrev_b32 v76, 16, v3
    v_and_b32 v84, s25, v3
    v_lshlrev_b32 v77, 16, v7
    v_and_b32 v85, s25, v7
    v_lshlrev_b32 v78, 16, v11
    v_and_b32 v86, s25, v11
    v_lshlrev_b32 v79, 16, v15
    v_and_b32 v87, s25, v15
    v_add_f32 v80, v76, v78
    v_add_f32 v88, v84, v86
    v_add_f32 v81, v77, v79
    v_add_f32 v89, v85, v87
    v_fma_f32 v82, v78, 4.0, v76
    v_fma_f32 v90, v86, 4.0, v84
    v_fma_f32 v83, v79, 4.0, v77
    v_fma_f32 v91, v87, 4.0, v85
    v_add_f32 v77, v80, v81
    v_add_f32 v85, v88, v89
    v_sub_f32 v78, v80, v81
    v_sub_f32 v86, v88, v89
    v_fma_f32 v79, v83, 2.0, v82
    v_fma_f32 v87, v91, 2.0, v90
    v_fma_f32 v82, v83, -2.0, v82
    v_fma_f32 v90, v91, -2.0, v90
    v_fmamk_f32 v80, v76, 0x41700000, v82
    v_fmamk_f32 v88, v84, 0x41700000, v90
    v_fmamk_f32 v80, v81, 0x41200000, v80
    v_fmamk_f32 v88, v89, 0x41200000, v88
    v_cvt_pk_bf16_f32 v7, v77, v85
    v_cvt_pk_bf16_f32 v11, v78, v86
    v_cvt_pk_bf16_f32 v67, v79, v87
    v_cvt_pk_bf16_f32 v71, v82, v90
    v_cvt_pk_bf16_f32 v75, v80, v88
    ds_write_b128 v96, v[64:67] offset:49152
    ds_write_b128 v97, v[68:71] offset:0
    ds_write_b128 v97, v[72:75] offset:16384
    ds_write_b128 v96, v[0:3] offset:0
    ds_write_b128 v96, v[4:7] offset:16384
    ds_write_b128 v96, v[8:11] offset:32768
    ds_write_b128 v98, v[12:15] offset:0
    s_add_u32 s28, s28, 1
    s_waitcnt lgkmcnt(0)
    s_barrier
    s_sub_u32 s22, s22, 1
    s_branch L_conv2_kernel_hloop1
L_conv2_kernel_hlast1:
    s_branch L_conv2_kernel_end
L_conv2_kernel_h2:
    ds_write_b128 v96, v[0:3] offset:0
    ds_write_b128 v98, v[12:15] offset:0
    v_lshlrev_b32 v76, 16, v0
    v_and_b32 v84, s25, v0
    v_lshlrev_b32 v77, 16, v4
    v_and_b32 v85, s25, v4
    v_lshlrev_b32 v78, 16, v8
    v_and_b32 v86, s25, v8
    v_lshlrev_b32 v79, 16, v12
    v_and_b32 v87, s25, v12
    v_add_f32 v80, v76, v78
    v_add_f32 v88, v84, v86
    v_add_f32 v81, v77, v79
    v_add_f32 v89, v85, v87
    v_fma_f32 v82, v78, 4.0, v76
    v_fma_f32 v90, v86, 4.0, v84
    v_fma_f32 v83, v79, 4.0, v77
    v_fma_f32 v91, v87, 4.0, v85
    v_add_f32 v77, v80, v81
    v_add_f32 v85, v88, v89
    v_sub_f32 v78, v80, v81
    v_sub_f32 v86, v88, v89
    v_fma_f32 v79, v83, 2.0, v82
    v_fma_f32 v87, v91, 2.0, v90
    v_fma_f32 v82, v83, -2.0, v82
    v_fma_f32 v90, v91, -2.0, v90
    v_fmamk_f32 v80, v76, 0x41700000, v82
    v_fmamk_f32 v88, v84, 0x41700000, v90
    v_fmamk_f32 v80, v81, 0x41200000, v80
    v_fmamk_f32 v88, v89, 0x41200000, v88
    v_cvt_pk_bf16_f32 v4, v77, v85
    v_cvt_pk_bf16_f32 v8, v78, v86
    v_cvt_pk_bf16_f32 v64, v79, v87
    v_cvt_pk_bf16_f32 v68, v82, v90
    v_cvt_pk_bf16_f32 v72, v80, v88
    v_lshlrev_b32 v76, 16, v1
    v_and_b32 v84, s25, v1
    v_lshlrev_b32 v77, 16, v5
    v_and_b32 v85, s25, v5
    v_lshlrev_b32 v78, 16, v9
    v_and_b32 v86, s25, v9
    v_lshlrev_b32 v79, 16, v13
    v_and_b32 v87, s25, v13
    v_add_f32 v80, v76, v78
    v_add_f32 v88, v84, v86
    v_add_f32 v81, v77, v79
    v_add_f32 v89, v85, v87
    v_fma_f32 v82, v78, 4.0, v76
    v_fma_f32 v90, v86, 4.0, v84
    v_fma_f32 v83, v79, 4.0, v77
    v_fma_f32 v91, v87, 4.0, v85
    v_add_f32 v77, v80, v81
    v_add_f32 v85, v88, v89
    v_sub_f32 v78, v80, v81
    v_sub_f32 v86, v88, v89
    v_fma_f32 v79, v83, 2.0, v82
    v_fma_f32 v87, v91, 2.0, v90
    v_fma_f32 v82, v83, -2.0, v82
    v_fma_f32 v90, v91, -2.0, v90
    v_fmamk_f32 v80, v76, 0x41700000, v82
    v_fmamk_f32 v88, v84, 0x41700000, v90
    v_fmamk_f32 v80, v81, 0x41200000, v80
    v_fmamk_f32 v88, v89, 0x41200000, v88
    v_cvt_pk_bf16_f32 v5, v77, v85
    v_cvt_pk_bf16_f32 v9, v78, v86
    v_cvt_pk_bf16_f32 v65, v79, v87
    v_cvt_pk_bf16_f32 v69, v82, v90
    v_cvt_pk_bf16_f32 v73, v80, v88
    v_lshlrev_b32 v76, 16, v2
    v_and_b32 v84, s25, v2
    v_lshlrev_b32 v77, 16, v6
    v_and_b32 v85, s25, v6
    v_lshlrev_b32 v78, 16, v10
    v_and_b32 v86, s25, v10
    v_lshlrev_b32 v79, 16, v14
    v_and_b32 v87, s25, v14
    v_add_f32 v80, v76, v78
    v_add_f32 v88, v84, v86
    v_add_f32 v81, v77, v79
    v_add_f32 v89, v85, v87
    v_fma_f32 v82, v78, 4.0, v76
    v_fma_f32 v90, v86, 4.0, v84
    v_fma_f32 v83, v79, 4.0, v77
    v_fma_f32 v91, v87, 4.0, v85
    v_add_f32 v77, v80, v81
    v_add_f32 v85, v88, v89
    v_sub_f32 v78, v80, v81
    v_sub_f32 v86, v88, v89
    v_fma_f32 v79, v83, 2.0, v82
    v_fma_f32 v87, v91, 2.0, v90
    v_fma_f32 v82, v83, -2.0, v82
    v_fma_f32 v90, v91, -2.0, v90
    v_fmamk_f32 v80, v76, 0x41700000, v82
    v_fmamk_f32 v88, v84, 0x41700000, v90
    v_fmamk_f32 v80, v81, 0x41200000, v80
    v_fmamk_f32 v88, v89, 0x41200000, v88
    v_cvt_pk_bf16_f32 v6, v77, v85
    v_cvt_pk_bf16_f32 v10, v78, v86
    v_cvt_pk_bf16_f32 v66, v79, v87
    v_cvt_pk_bf16_f32 v70, v82, v90
    v_cvt_pk_bf16_f32 v74, v80, v88
    v_lshlrev_b32 v76, 16, v3
    v_and_b32 v84, s25, v3
    v_lshlrev_b32 v77, 16, v7
    v_and_b32 v85, s25, v7
    v_lshlrev_b32 v78, 16, v11
    v_and_b32 v86, s25, v11
    v_lshlrev_b32 v79, 16, v15
    v_and_b32 v87, s25, v15
    v_add_f32 v80, v76, v78
    v_add_f32 v88, v84, v86
    v_add_f32 v81, v77, v79
    v_add_f32 v89, v85, v87
    v_fma_f32 v82, v78, 4.0, v76
    v_fma_f32 v90, v86, 4.0, v84
    v_fma_f32 v83, v79, 4.0, v77
    v_fma_f32 v91, v87, 4.0, v85
    v_add_f32 v77, v80, v81
    v_add_f32 v85, v88, v89
    v_sub_f32 v78, v80, v81
    v_sub_f32 v86, v88, v89
    v_fma_f32 v79, v83, 2.0, v82
    v_fma_f32 v87, v91, 2.0, v90
    v_fma_f32 v82, v83, -2.0, v82
    v_fma_f32 v90, v91, -2.0, v90
    v_fmamk_f32 v80, v76, 0x41700000, v82
    v_fmamk_f32 v88, v84, 0x41700000, v90
    v_fmamk_f32 v80, v81, 0x41200000, v80
    v_fmamk_f32 v88, v89, 0x41200000, v88
    v_cvt_pk_bf16_f32 v7, v77, v85
    v_cvt_pk_bf16_f32 v11, v78, v86
    v_cvt_pk_bf16_f32 v67, v79, v87
    v_cvt_pk_bf16_f32 v71, v82, v90
    v_cvt_pk_bf16_f32 v75, v80, v88
    ds_write_b128 v96, v[64:67] offset:49152
    ds_write_b128 v97, v[68:71] offset:0
    ds_write_b128 v97, v[72:75] offset:16384
    ds_write_b128 v96, v[4:7] offset:16384
    ds_write_b128 v96, v[8:11] offset:32768
    buffer_load_dwordx4 v[32:35], v92, s[8:11], s24 offen offset:0
    buffer_load_dwordx4 v[48:51], v92, s[8:11], s24 offen offset:64
    v_add_u32 v92, 128, v92
    buffer_load_dwordx4 v[36:39], v93, s[8:11], s24 offen offset:0
    buffer_load_dwordx4 v[52:55], v93, s[8:11], s24 offen offset:64
    v_add_u32 v93, 128, v93
    buffer_load_dwordx4 v[40:43], v94, s[8:11], s24 offen offset:0
    buffer_load_dwordx4 v[56:59], v94, s[8:11], s24 offen offset:64
    v_add_u32 v94, 128, v94
    buffer_load_dwordx4 v[44:47], v95, s[8:11], s24 offen offset:0
    buffer_load_dwordx4 v[60:63], v95, s[8:11], s24 offen offset:64
    v_add_u32 v95, 128, v95
    s_waitcnt lgkmcnt(0)
    s_barrier
    s_setprio 0
    v_lshlrev_b32 v76, 16, v16
    v_and_b32 v84, s25, v16
    v_lshlrev_b32 v77, 16, v20
    v_and_b32 v85, s25, v20
    v_lshlrev_b32 v78, 16, v24
    v_and_b32 v86, s25, v24
    v_lshlrev_b32 v79, 16, v28
    v_and_b32 v87, s25, v28
    v_add_f32 v80, v76, v78
    v_add_f32 v88, v84, v86
    v_add_f32 v81, v77, v79
    v_add_f32 v89, v85, v87
    v_fma_f32 v82, v78, 4.0, v76
    v_fma_f32 v90, v86, 4.0, v84
    v_fma_f32 v83, v79, 4.0, v77
    v_fma_f32 v91, v87, 4.0, v85
    v_add_f32 v77, v80, v81
    v_add_f32 v85, v88, v89
    v_sub_f32 v78, v80, v81
    v_sub_f32 v86, v88, v89
    v_fma_f32 v79, v83, 2.0, v82
    v_fma_f32 v87, v91, 2.0, v90
    v_fma_f32 v82, v83, -2.0, v82
    v_fma_f32 v90, v91, -2.0, v90
    v_fmamk_f32 v80, v76, 0x41700000, v82
    v_fmamk_f32 v88, v84, 0x41700000, v90
    v_fmamk_f32 v80, v81, 0x41200000, v80
    v_fmamk_f32 v88, v89, 0x41200000, v88
    v_cvt_pk_bf16_f32 v20, v77, v85
    v_cvt_pk_bf16_f32 v24, v78, v86
    v_cvt_pk_bf16_f32 v64, v79, v87
    v_cvt_pk_bf16_f32 v68, v82, v90
    v_cvt_pk_bf16_f32 v72, v80, v88
    v_lshlrev_b32 v76, 16, v17
    v_and_b32 v84, s25, v17
    v_lshlrev_b32 v77, 16, v21
    v_and_b32 v85, s25, v21
    v_lshlrev_b32 v78, 16, v25
    v_and_b32 v86, s25, v25
    v_lshlrev_b32 v79, 16, v29
    v_and_b32 v87, s25, v29
    v_add_f32 v80, v76, v78
    v_add_f32 v88, v84, v86
    v_add_f32 v81, v77, v79
    v_add_f32 v89, v85, v87
    v_fma_f32 v82, v78, 4.0, v76
    v_fma_f32 v90, v86, 4.0, v84
    v_fma_f32 v83, v79, 4.0, v77
    v_fma_f32 v91, v87, 4.0, v85
    v_add_f32 v77, v80, v81
    v_add_f32 v85, v88, v89
    v_sub_f32 v78, v80, v81
    v_sub_f32 v86, v88, v89
    v_fma_f32 v79, v83, 2.0, v82
    v_fma_f32 v87, v91, 2.0, v90
    v_fma_f32 v82, v83, -2.0, v82
    v_fma_f32 v90, v91, -2.0, v90
    v_fmamk_f32 v80, v76, 0x41700000, v82
    v_fmamk_f32 v88, v84, 0x41700000, v90
    v_fmamk_f32 v80, v81, 0x41200000, v80
    v_fmamk_f32 v88, v89, 0x41200000, v88
    v_cvt_pk_bf16_f32 v21, v77, v85
    v_cvt_pk_bf16_f32 v25, v78, v86
    v_cvt_pk_bf16_f32 v65, v79, v87
    v_cvt_pk_bf16_f32 v69, v82, v90
    v_cvt_pk_bf16_f32 v73, v80, v88
    v_lshlrev_b32 v76, 16, v18
    v_and_b32 v84, s25, v18
    v_lshlrev_b32 v77, 16, v22
    v_and_b32 v85, s25, v22
    v_lshlrev_b32 v78, 16, v26
    v_and_b32 v86, s25, v26
    v_lshlrev_b32 v79, 16, v30
    v_and_b32 v87, s25, v30
    v_add_f32 v80, v76, v78
    v_add_f32 v88, v84, v86
    v_add_f32 v81, v77, v79
    v_add_f32 v89, v85, v87
    v_fma_f32 v82, v78, 4.0, v76
    v_fma_f32 v90, v86, 4.0, v84
    v_fma_f32 v83, v79, 4.0, v77
    v_fma_f32 v91, v87, 4.0, v85
    v_add_f32 v77, v80, v81
    v_add_f32 v85, v88, v89
    v_sub_f32 v78, v80, v81
    v_sub_f32 v86, v88, v89
    v_fma_f32 v79, v83, 2.0, v82
    v_fma_f32 v87, v91, 2.0, v90
    v_fma_f32 v82, v83, -2.0, v82
    v_fma_f32 v90, v91, -2.0, v90
    v_fmamk_f32 v80, v76, 0x41700000, v82
    v_fmamk_f32 v88, v84, 0x41700000, v90
    v_fmamk_f32 v80, v81, 0x41200000, v80
    v_fmamk_f32 v88, v89, 0x41200000, v88
    v_cvt_pk_bf16_f32 v22, v77, v85
    v_cvt_pk_bf16_f32 v26, v78, v86
    v_cvt_pk_bf16_f32 v66, v79, v87
    v_cvt_pk_bf16_f32 v70, v82, v90
    v_cvt_pk_bf16_f32 v74, v80, v88
    v_lshlrev_b32 v76, 16, v19
    v_and_b32 v84, s25, v19
    v_lshlrev_b32 v77, 16, v23
    v_and_b32 v85, s25, v23
    v_lshlrev_b32 v78, 16, v27
    v_and_b32 v86, s25, v27
    v_lshlrev_b32 v79, 16, v31
    v_and_b32 v87, s25, v31
    v_add_f32 v80, v76, v78
    v_add_f32 v88, v84, v86
    v_add_f32 v81, v77, v79
    v_add_f32 v89, v85, v87
    v_fma_f32 v82, v78, 4.0, v76
    v_fma_f32 v90, v86, 4.0, v84
    v_fma_f32 v83, v79, 4.0, v77
    v_fma_f32 v91, v87, 4.0, v85
    v_add_f32 v77, v80, v81
    v_add_f32 v85, v88, v89
    v_sub_f32 v78, v80, v81
    v_sub_f32 v86, v88, v89
    v_fma_f32 v79, v83, 2.0, v82
    v_fma_f32 v87, v91, 2.0, v90
    v_fma_f32 v82, v83, -2.0, v82
    v_fma_f32 v90, v91, -2.0, v90
    v_fmamk_f32 v80, v76, 0x41700000, v82
    v_fmamk_f32 v88, v84, 0x41700000, v90
    v_fmamk_f32 v80, v81, 0x41200000, v80
    v_fmamk_f32 v88, v89, 0x41200000, v88
    v_cvt_pk_bf16_f32 v23, v77, v85
    v_cvt_pk_bf16_f32 v27, v78, v86
    v_cvt_pk_bf16_f32 v67, v79, v87
    v_cvt_pk_bf16_f32 v71, v82, v90
    v_cvt_pk_bf16_f32 v75, v80, v88
L_conv2_kernel_hloop2:
    s_cmp_lt_u32 s28, 4
    s_cselect_b32 s24, 0, 2130706432
    ds_write_b128 v96, v[64:67] offset:57344
    ds_write_b128 v97, v[68:71] offset:8192
    ds_write_b128 v97, v[72:75] offset:24576
    ds_write_b128 v96, v[16:19] offset:8192
    ds_write_b128 v96, v[20:23] offset:24576
    ds_write_b128 v96, v[24:27] offset:40960
    ds_write_b128 v98, v[28:31] offset:8704
    s_waitcnt vmcnt(0)
    v_lshlrev_b32 v76, 16, v32
    v_and_b32 v84, s25, v32
    v_lshlrev_b32 v77, 16, v36
    v_and_b32 v85, s25, v36
    v_lshlrev_b32 v78, 16, v40
    v_and_b32 v86, s25, v40
    v_lshlrev_b32 v79, 16, v44
    v_and_b32 v87, s25, v44
    v_add_f32 v80, v76, v78
    v_add_f32 v88, v84, v86
    v_add_f32 v81, v77, v79
    v_add_f32 v89, v85, v87
    v_fma_f32 v82, v78, 4.0, v76
    v_fma_f32 v90, v86, 4.0, v84
    v_fma_f32 v83, v79, 4.0, v77
    v_fma_f32 v91, v87, 4.0, v85
    v_add_f32 v77, v80, v81
    v_add_f32 v85, v88, v89
    v_sub_f32 v78, v80, v81
    v_sub_f32 v86, v88, v89
    v_fma_f32 v79, v83, 2.0, v82
    v_fma_f32 v87, v91, 2.0, v90
    v_fma_f32 v82, v83, -2.0, v82
    v_fma_f32 v90, v91, -2.0, v90
    v_fmamk_f32 v80, v76, 0x41700000, v82
    v_fmamk_f32 v88, v84, 0x41700000, v90
    buffer_load_dwordx4 v[0:3], v92, s[8:11], s24 offen offset:0
    buffer_load_dwordx4 v[16:19], v92, s[8:11], s24 offen offset:64
    v_add_u32 v92, 128, v92
    v_fmamk_f32 v80, v81, 0x41200000, v80
    v_fmamk_f32 v88, v89, 0x41200000, v88
    v_cvt_pk_bf16_f32 v36, v77, v85
    v_cvt_pk_bf16_f32 v40, v78, v86
    v_cvt_pk_bf16_f32 v64, v79, v87
    v_cvt_pk_bf16_f32 v68, v82, v90
    v_cvt_pk_bf16_f32 v72, v80, v88
    v_lshlrev_b32 v76, 16, v33
    v_and_b32 v84, s25, v33
    v_lshlrev_b32 v77, 16, v37
    v_and_b32 v85, s25, v37
    v_lshlrev_b32 v78, 16, v41
    v_and_b32 v86, s25, v41
    v_lshlrev_b32 v79, 16, v45
    v_and_b32 v87, s25, v45
    v_add_f32 v80, v76, v78
    v_add_f32 v88, v84, v86
    v_add_f32 v81, v77, v79
    v_add_f32 v89, v85, v87
    v_fma_f32 v82, v78, 4.0, v76
    v_fma_f32 v90, v86, 4.0, v84
    v_fma_f32 v83, v79, 4.0, v77
    v_fma_f32 v91, v87, 4.0, v85
    v_add_f32 v77, v80, v81
    v_add_f32 v85, v88, v89
    v_sub_f32 v78, v80, v81
    v_sub_f32 v86, v88, v89
    v_fma_f32 v79, v83, 2.0, v82
    v_fma_f32 v87, v91, 2.0, v90
    v_fma_f32 v82, v83, -2.0, v82
    v_fma_f32 v90, v91, -2.0, v90
    v_fmamk_f32 v80, v76, 0x41700000, v82
    v_fmamk_f32 v88, v84, 0x41700000, v90
    v_fmamk_f32 v80, v81, 0x41200000, v80
    v_fmamk_f32 v88, v89, 0x41200000, v88
    v_cvt_pk_bf16_f32 v37, v77, v85
    v_cvt_pk_bf16_f32 v41, v78, v86
    v_cvt_pk_bf16_f32 v65, v79, v87
    v_cvt_pk_bf16_f32 v69, v82, v90
    v_cvt_pk_bf16_f32 v73, v80, v88
    v_lshlrev_b32 v76, 16, v34
    v_and_b32 v84, s25, v34
    v_lshlrev_b32 v77, 16, v38
    v_and_b32 v85, s25, v38
    v_lshlrev_b32 v78, 16, v42
    v_and_b32 v86, s25, v42
    v_lshlrev_b32 v79, 16, v46
    v_and_b32 v87, s25, v46
    v_add_f32 v80, v76, v78
    v_add_f32 v88, v84, v86
    v_add_f32 v81, v77, v79
    v_add_f32 v89, v85, v87
    v_fma_f32 v82, v78, 4.0, v76
    buffer_load_dwordx4 v[4:7], v93, s[8:11], s24 offen offset:0
    buffer_load_dwordx4 v[20:23], v93, s[8:11], s24 offen offset:64
    v_add_u32 v93, 128, v93
    v_fma_f32 v90, v86, 4.0, v84
    v_fma_f32 v83, v79, 4.0, v77
    v_fma_f32 v91, v87, 4.0, v85
    v_add_f32 v77, v80, v81
    v_add_f32 v85, v88, v89
    v_sub_f32 v78, v80, v81
    v_sub_f32 v86, v88, v89
    v_fma_f32 v79, v83, 2.0, v82
    v_fma_f32 v87, v91, 2.0, v90
    v_fma_f32 v82, v83, -2.0, v82
    v_fma_f32 v90, v91, -2.0, v90
    v_fmamk_f32 v80, v76, 0x41700000, v82
    v_fmamk_f32 v88, v84, 0x41700000, v90
    v_fmamk_f32 v80, v81, 0x41200000, v80
    v_fmamk_f32 v88, v89, 0x41200000, v88
    v_cvt_pk_bf16_f32 v38, v77, v85
    v_cvt_pk_bf16_f32 v42, v78, v86
    v_cvt_pk_bf16_f32 v66, v79, v87
    v_cvt_pk_bf16_f32 v70, v82, v90
    v_cvt_pk_bf16_f32 v74, v80, v88
    v_lshlrev_b32 v76, 16, v35
    v_and_b32 v84, s25, v35
    v_lshlrev_b32 v77, 16, v39
    v_and_b32 v85, s25, v39
    v_lshlrev_b32 v78, 16, v43
    v_and_b32 v86, s25, v43
    v_lshlrev_b32 v79, 16, v47
    v_and_b32 v87, s25, v47
    v_add_f32 v80, v76, v78
    v_add_f32 v88, v84, v86
    v_add_f32 v81, v77, v79
    v_add_f32 v89, v85, v87
    v_fma_f32 v82, v78, 4.0, v76
    v_fma_f32 v90, v86, 4.0, v84
    v_fma_f32 v83, v79, 4.0, v77
    v_fma_f32 v91, v87, 4.0, v85
    v_add_f32 v77, v80, v81
    v_add_f32 v85, v88, v89
    v_sub_f32 v78, v80, v81
    v_sub_f32 v86, v88, v89
    v_fma_f32 v79, v83, 2.0, v82
    v_fma_f32 v87, v91, 2.0, v90
    v_fma_f32 v82, v83, -2.0, v82
    v_fma_f32 v90, v91, -2.0, v90
    v_fmamk_f32 v80, v76, 0x41700000, v82
    v_fmamk_f32 v88, v84, 0x41700000, v90
    v_fmamk_f32 v80, v81, 0x41200000, v80
    v_fmamk_f32 v88, v89, 0x41200000, v88
    v_cvt_pk_bf16_f32 v39, v77, v85
    v_cvt_pk_bf16_f32 v43, v78, v86
    v_cvt_pk_bf16_f32 v67, v79, v87
    v_cvt_pk_bf16_f32 v71, v82, v90
    v_cvt_pk_bf16_f32 v75, v80, v88
    s_add_u32 s28, s28, 1
    s_waitcnt lgkmcnt(0)
    s_barrier
    s_cmp_lt_u32 s28, 4
    s_cselect_b32 s24, 0, 2130706432
    ds_write_b128 v96, v[64:67] offset:49152
    ds_write_b128 v97, v[68:71] offset:0
    ds_write_b128 v97, v[72:75] offset:16384
    ds_write_b128 v96, v[32:35] offset:0
    ds_write_b128 v96, v[36:39] offset:16384
    ds_write_b128 v96, v[40:43] offset:32768
    ds_write_b128 v98, v[44:47] offset:0
    v_lshlrev_b32 v76, 16, v48
    v_and_b32 v84, s25, v48
    buffer_load_dwordx4 v[8:11], v94, s[8:11], s24 offen offset:0
    buffer_load_dwordx4 v[24:27], v94, s[8:11], s24 offen offset:64
    v_add_u32 v94, 128, v94
    v_lshlrev_b32 v77, 16, v52
    v_and_b32 v85, s25, v52
    v_lshlrev_b32 v78, 16, v56
    v_and_b32 v86, s25, v56
    v_lshlrev_b32 v79, 16, v60
    v_and_b32 v87, s25, v60
    v_add_f32 v80, v76, v78
    v_add_f32 v88, v84, v86
    v_add_f32 v81, v77, v79
    v_add_f32 v89, v85, v87
    v_fma_f32 v82, v78, 4.0, v76
    v_fma_f32 v90, v86, 4.0, v84
    v_fma_f32 v83, v79, 4.0, v77
    v_fma_f32 v91, v87, 4.0, v85
    v_add_f32 v77, v80, v81
    v_add_f32 v85, v88, v89
    v_sub_f32 v78, v80, v81
    buffer_load_dwordx4 v[12:15], v95, s[8:11], s24 offen offset:0
    buffer_load_dwordx4 v[28:31], v95, s[8:11], s24 offen offset:64
    v_add_u32 v95, 128, v95
    v_sub_f32 v86, v88, v89
    v_fma_f32 v79, v83, 2.0, v82
    v_fma_f32 v87, v91, 2.0, v90
    v_fma_f32 v82, v83, -2.0, v82
    v_fma_f32 v90, v91, -2.0, v90
    v_fmamk_f32 v80, v76, 0x41700000, v82
    v_fmamk_f32 v88, v84, 0x41700000, v90
    v_fmamk_f32 v80, v81, 0x41200000, v80
    v_fmamk_f32 v88, v89, 0x41200000, v88
    v_cvt_pk_bf16_f32 v52, v77, v85
    v_cvt_pk_bf16_f32 v56, v78, v86
    v_cvt_pk_bf16_f32 v64, v79, v87
    v_cvt_pk_bf16_f32 v68, v82, v90
    v_cvt_pk_bf16_f32 v72, v80, v88
    v_lshlrev_b32 v76, 16, v49
    v_and_b32 v84, s25, v49
    v_lshlrev_b32 v77, 16, v53
    v_and_b32 v85, s25, v53
    v_lshlrev_b32 v78, 16, v57
    v_and_b32 v86, s25, v57
    v_lshlrev_b32 v79, 16, v61
    v_and_b32 v87, s25, v61
    v_add_f32 v80, v76, v78
    v_add_f32 v88, v84, v86
    v_add_f32 v81, v77, v79
    v_add_f32 v89, v85, v87
    v_fma_f32 v82, v78, 4.0, v76
    v_fma_f32 v90, v86, 4.0, v84
    v_fma_f32 v83, v79, 4.0, v77
    v_fma_f32 v91, v87, 4.0, v85
    v_add_f32 v77, v80, v81
    v_add_f32 v85, v88, v89
    v_sub_f32 v78, v80, v81
    v_sub_f32 v86, v88, v89
    v_fma_f32 v79, v83, 2.0, v82
    v_fma_f32 v87, v91, 2.0, v90
    v_fma_f32 v82, v83, -2.0, v82
    v_fma_f32 v90, v91, -2.0, v90
    v_fmamk_f32 v80, v76, 0x41700000, v82
    v_fmamk_f32 v88, v84, 0x41700000, v90
    v_fmamk_f32 v80, v81, 0x41200000, v80
    v_fmamk_f32 v88, v89, 0x41200000, v88
    v_cvt_pk_bf16_f32 v53, v77, v85
    v_cvt_pk_bf16_f32 v57, v78, v86
    v_cvt_pk_bf16_f32 v65, v79, v87
    v_cvt_pk_bf16_f32 v69, v82, v90
    v_cvt_pk_bf16_f32 v73, v80, v88
    v_lshlrev_b32 v76, 16, v50
    v_and_b32 v84, s25, v50
    v_lshlrev_b32 v77, 16, v54
    v_and_b32 v85, s25, v54
    v_lshlrev_b32 v78, 16, v58
    v_and_b32 v86, s25, v58
    v_lshlrev_b32 v79, 16, v62
    v_and_b32 v87, s25, v62
    v_add_f32 v80, v76, v78
    v_add_f32 v88, v84, v86
    v_add_f32 v81, v77, v79
    v_add_f32 v89, v85, v87
    v_fma_f32 v82, v78, 4.0, v76
    v_fma_f32 v90, v86, 4.0, v84
    v_fma_f32 v83, v79, 4.0, v77
    v_fma_f32 v91, v87, 4.0, v85
    v_add_f32 v77, v80, v81
    v_add_f32 v85, v88, v89
    v_sub_f32 v78, v80, v81
    v_sub_f32 v86, v88, v89
    v_fma_f32 v79, v83, 2.0, v82
    v_fma_f32 v87, v91, 2.0, v90
    v_fma_f32 v82, v83, -2.0, v82
    v_fma_f32 v90, v91, -2.0, v90
    v_fmamk_f32 v80, v76, 0x41700000, v82
    v_fmamk_f32 v88, v84, 0x41700000, v90
    v_fmamk_f32 v80, v81, 0x41200000, v80
    v_fmamk_f32 v88, v89, 0x41200000, v88
    v_cvt_pk_bf16_f32 v54, v77, v85
    v_cvt_pk_bf16_f32 v58, v78, v86
    v_cvt_pk_bf16_f32 v66, v79, v87
    v_cvt_pk_bf16_f32 v70, v82, v90
    v_cvt_pk_bf16_f32 v74, v80, v88
    v_lshlrev_b32 v76, 16, v51
    v_and_b32 v84, s25, v51
    v_lshlrev_b32 v77, 16, v55
    v_and_b32 v85, s25, v55
    v_lshlrev_b32 v78, 16, v59
    v_and_b32 v86, s25, v59
    v_lshlrev_b32 v79, 16, v63
    v_and_b32 v87, s25, v63
    v_add_f32 v80, v76, v78
    v_add_f32 v88, v84, v86
    v_add_f32 v81, v77, v79
    v_add_f32 v89, v85, v87
    v_fma_f32 v82, v78, 4.0, v76
    v_fma_f32 v90, v86, 4.0, v84
    v_fma_f32 v83, v79, 4.0, v77
    v_fma_f32 v91, v87, 4.0, v85
    v_add_f32 v77, v80, v81
    v_add_f32 v85, v88, v89
    v_sub_f32 v78, v80, v81
    v_sub_f32 v86, v88, v89
    v_fma_f32 v79, v83, 2.0, v82
    v_fma_f32 v87, v91, 2.0, v90
    v_fma_f32 v82, v83, -2.0, v82
    v_fma_f32 v90, v91, -2.0, v90
    v_fmamk_f32 v80, v76, 0x41700000, v82
    v_fmamk_f32 v88, v84, 0x41700000, v90
    v_fmamk_f32 v80, v81, 0x41200000, v80
    v_fmamk_f32 v88, v89, 0x41200000, v88
    v_cvt_pk_bf16_f32 v55, v77, v85
    v_cvt_pk_bf16_f32 v59, v78, v86
    v_cvt_pk_bf16_f32 v67, v79, v87
    v_cvt_pk_bf16_f32 v71, v82, v90
    v_cvt_pk_bf16_f32 v75, v80, v88
    s_add_u32 s28, s28, 1
    s_waitcnt lgkmcnt(0)
    s_barrier
    s_cmp_eq_u32 s22, 1
    s_cbranch_scc1 L_conv2_kernel_hlast2
    s_cmp_lt_u32 s28, 4
    s_cselect_b32 s24, 0, 2130706432
    ds_write_b128 v96, v[64:67] offset:57344
    ds_write_b128 v97, v[68:71] offset:8192
    ds_write_b128 v97, v[72:75] offset:24576
    ds_write_b128 v96, v[48:51] offset:8192
    ds_write_b128 v96, v[52:55] offset:24576
    ds_write_b128 v96, v[56:59] offset:40960
    ds_write_b128 v98, v[60:63] offset:8704
    s_waitcnt vmcnt(0)
    v_lshlrev_b32 v76, 16, v0
    v_and_b32 v84, s25, v0
    v_lshlrev_b32 v77, 16, v4
    v_and_b32 v85, s25, v4
    v_lshlrev_b32 v78, 16, v8
    v_and_b32 v86, s25, v8
    v_lshlrev_b32 v79, 16, v12
    v_and_b32 v87, s25, v12
    v_add_f32 v80, v76, v78
    v_add_f32 v88, v84, v86
    v_add_f32 v81, v77, v79
    v_add_f32 v89, v85, v87
    v_fma_f32 v82, v78, 4.0, v76
    v_fma_f32 v90, v86, 4.0, v84
    v_fma_f32 v83, v79, 4.0, v77
    v_fma_f32 v91, v87, 4.0, v85
    v_add_f32 v77, v80, v81
    v_add_f32 v85, v88, v89
    v_sub_f32 v78, v80, v81
    v_sub_f32 v86, v88, v89
    v_fma_f32 v79, v83, 2.0, v82
    v_fma_f32 v87, v91, 2.0, v90
    v_fma_f32 v82, v83, -2.0, v82
    v_fma_f32 v90, v91, -2.0, v90
    v_fmamk_f32 v80, v76, 0x41700000, v82
    v_fmamk_f32 v88, v84, 0x41700000, v90
    buffer_load_dwordx4 v[32:35], v92, s[8:11], s24 offen offset:0
    buffer_load_dwordx4 v[48:51], v92, s[8:11], s24 offen offset:64
    v_add_u32 v92, 128, v92
    v_fmamk_f32 v80, v81, 0x41200000, v80
    v_fmamk_f32 v88, v89, 0x41200000, v88
    v_cvt_pk_bf16_f32 v4, v77, v85
    v_cvt_pk_bf16_f32 v8, v78, v86
    v_cvt_pk_bf16_f32 v64, v79, v87
    v_cvt_pk_bf16_f32 v68, v82, v90
    v_cvt_pk_bf16_f32 v72, v80, v88
    v_lshlrev_b32 v76, 16, v1
    v_and_b32 v84, s25, v1
    v_lshlrev_b32 v77, 16, v5
    v_and_b32 v85, s25, v5
    v_lshlrev_b32 v78, 16, v9
    v_and_b32 v86, s25, v9
    v_lshlrev_b32 v79, 16, v13
    v_and_b32 v87, s25, v13
    v_add_f32 v80, v76, v78
    v_add_f32 v88, v84, v86
    v_add_f32 v81, v77, v79
    v_add_f32 v89, v85, v87
    v_fma_f32 v82, v78, 4.0, v76
    v_fma_f32 v90, v86, 4.0, v84
    v_fma_f32 v83, v79, 4.0, v77
    v_fma_f32 v91, v87, 4.0, v85
    v_add_f32 v77, v80, v81
    v_add_f32 v85, v88, v89
    v_sub_f32 v78, v80, v81
    v_sub_f32 v86, v88, v89
    v_fma_f32 v79, v83, 2.0, v82
    v_fma_f32 v87, v91, 2.0, v90
    v_fma_f32 v82, v83, -2.0, v82
    v_fma_f32 v90, v91, -2.0, v90
    v_fmamk_f32 v80, v76, 0x41700000, v82
    v_fmamk_f32 v88, v84, 0x41700000, v90
    v_fmamk_f32 v80, v81, 0x41200000, v80
    v_fmamk_f32 v88, v89, 0x41200000, v88
    v_cvt_pk_bf16_f32 v5, v77, v85
    v_cvt_pk_bf16_f32 v9, v78, v86
    v_cvt_pk_bf16_f32 v65, v79, v87
    v_cvt_pk_bf16_f32 v69, v82, v90
    v_cvt_pk_bf16_f32 v73, v80, v88
    v_lshlrev_b32 v76, 16, v2
    v_and_b32 v84, s25, v2
    v_lshlrev_b32 v77, 16, v6
    v_and_b32 v85, s25, v6
    v_lshlrev_b32 v78, 16, v10
    v_and_b32 v86, s25, v10
    v_lshlrev_b32 v79, 16, v14
    v_and_b32 v87, s25, v14
    v_add_f32 v80, v76, v78
    v_add_f32 v88, v84, v86
    v_add_f32 v81, v77, v79
    v_add_f32 v89, v85, v87
    v_fma_f32 v82, v78, 4.0, v76
    buffer_load_dwordx4 v[36:39], v93, s[8:11], s24 offen offset:0
    buffer_load_dwordx4 v[52:55], v93, s[8:11], s24 offen offset:64
    v_add_u32 v93, 128, v93
    v_fma_f32 v90, v86, 4.0, v84
    v_fma_f32 v83, v79, 4.0, v77
    v_fma_f32 v91, v87, 4.0, v85
    v_add_f32 v77, v80, v81
    v_add_f32 v85, v88, v89
    v_sub_f32 v78, v80, v81
    v_sub_f32 v86, v88, v89
    v_fma_f32 v79, v83, 2.0, v82
    v_fma_f32 v87, v91, 2.0, v90
    v_fma_f32 v82, v83, -2.0, v82
    v_fma_f32 v90, v91, -2.0, v90
    v_fmamk_f32 v80, v76, 0x41700000, v82
    v_fmamk_f32 v88, v84, 0x41700000, v90
    v_fmamk_f32 v80, v81, 0x41200000, v80
    v_fmamk_f32 v88, v89, 0x41200000, v88
    v_cvt_pk_bf16_f32 v6, v77, v85
    v_cvt_pk_bf16_f32 v10, v78, v86
    v_cvt_pk_bf16_f32 v66, v79, v87
    v_cvt_pk_bf16_f32 v70, v82, v90
    v_cvt_pk_bf16_f32 v74, v80, v88
    v_lshlrev_b32 v76, 16, v3
    v_and_b32 v84, s25, v3
    v_lshlrev_b32 v77, 16, v7
    v_and_b32 v85, s25, v7
    v_lshlrev_b32 v78, 16, v11
    v_and_b32 v86, s25, v11
    v_lshlrev_b32 v79, 16, v15
    v_and_b32 v87, s25, v15
    v_add_f32 v80, v76, v78
    v_add_f32 v88, v84, v86
    v_add_f32 v81, v77, v79
    v_add_f32 v89, v85, v87
    v_fma_f32 v82, v78, 4.0, v76
    v_fma_f32 v90, v86, 4.0, v84
    v_fma_f32 v83, v79, 4.0, v77
    v_fma_f32 v91, v87, 4.0, v85
    v_add_f32 v77, v80, v81
    v_add_f32 v85, v88, v89
    v_sub_f32 v78, v80, v81
    v_sub_f32 v86, v88, v89
    v_fma_f32 v79, v83, 2.0, v82
    v_fma_f32 v87, v91, 2.0, v90
    v_fma_f32 v82, v83, -2.0, v82
    v_fma_f32 v90, v91, -2.0, v90
    v_fmamk_f32 v80, v76, 0x41700000, v82
    v_fmamk_f32 v88, v84, 0x41700000, v90
    v_fmamk_f32 v80, v81, 0x41200000, v80
    v_fmamk_f32 v88, v89, 0x41200000, v88
    v_cvt_pk_bf16_f32 v7, v77, v85
    v_cvt_pk_bf16_f32 v11, v78, v86
    v_cvt_pk_bf16_f32 v67, v79, v87
    v_cvt_pk_bf16_f32 v71, v82, v90
    v_cvt_pk_bf16_f32 v75, v80, v88
    s_add_u32 s28, s28, 1
    s_waitcnt lgkmcnt(0)
    s_barrier
    s_cmp_lt_u32 s28, 4
    s_cselect_b32 s24, 0, 2130706432
    ds_write_b128 v96, v[64:67] offset:49152
    ds_write_b128 v97, v[68:71] offset:0
    ds_write_b128 v97, v[72:75] offset:16384
    ds_write_b128 v96, v[0:3] offset:0
    ds_write_b128 v96, v[4:7] offset:16384
    ds_write_b128 v96, v[8:11] offset:32768
    ds_write_b128 v98, v[12:15] offset:0
    v_lshlrev_b32 v76, 16, v16
    v_and_b32 v84, s25, v16
    buffer_load_dwordx4 v[40:43], v94, s[8:11], s24 offen offset:0
    buffer_load_dwordx4 v[56:59], v94, s[8:11], s24 offen offset:64
    v_add_u32 v94, 128, v94
    v_lshlrev_b32 v77, 16, v20
    v_and_b32 v85, s25, v20
    v_lshlrev_b32 v78, 16, v24
    v_and_b32 v86, s25, v24
    v_lshlrev_b32 v79, 16, v28
    v_and_b32 v87, s25, v28
    v_add_f32 v80, v76, v78
    v_add_f32 v88, v84, v86
    v_add_f32 v81, v77, v79
    v_add_f32 v89, v85, v87
    v_fma_f32 v82, v78, 4.0, v76
    v_fma_f32 v90, v86, 4.0, v84
    v_fma_f32 v83, v79, 4.0, v77
    v_fma_f32 v91, v87, 4.0, v85
    v_add_f32 v77, v80, v81
    v_add_f32 v85, v88, v89
    v_sub_f32 v78, v80, v81
    buffer_load_dwordx4 v[44:47], v95, s[8:11], s24 offen offset:0
    buffer_load_dwordx4 v[60:63], v95, s[8:11], s24 offen offset:64
    v_add_u32 v95, 128, v95
    v_sub_f32 v86, v88, v89
    v_fma_f32 v79, v83, 2.0, v82
    v_fma_f32 v87, v91, 2.0, v90
    v_fma_f32 v82, v83, -2.0, v82
    v_fma_f32 v90, v91, -2.0, v90
    v_fmamk_f32 v80, v76, 0x41700000, v82
    v_fmamk_f32 v88, v84, 0x41700000, v90
    v_fmamk_f32 v80, v81, 0x41200000, v80
    v_fmamk_f32 v88, v89, 0x41200000, v88
    v_cvt_pk_bf16_f32 v20, v77, v85
    v_cvt_pk_bf16_f32 v24, v78, v86
    v_cvt_pk_bf16_f32 v64, v79, v87
    v_cvt_pk_bf16_f32 v68, v82, v90
    v_cvt_pk_bf16_f32 v72, v80, v88
    v_lshlrev_b32 v76, 16, v17
    v_and_b32 v84, s25, v17
    v_lshlrev_b32 v77, 16, v21
    v_and_b32 v85, s25, v21
    v_lshlrev_b32 v78, 16, v25
    v_and_b32 v86, s25, v25
    v_lshlrev_b32 v79, 16, v29
    v_and_b32 v87, s25, v29
    v_add_f32 v80, v76, v78
    v_add_f32 v88, v84, v86
    v_add_f32 v81, v77, v79
    v_add_f32 v89, v85, v87
    v_fma_f32 v82, v78, 4.0, v76
    v_fma_f32 v90, v86, 4.0, v84
    v_fma_f32 v83, v79, 4.0, v77
    v_fma_f32 v91, v87, 4.0, v85
    v_add_f32 v77, v80, v81
    v_add_f32 v85, v88, v89
    v_sub_f32 v78, v80, v81
    v_sub_f32 v86, v88, v89
    v_fma_f32 v79, v83, 2.0, v82
    v_fma_f32 v87, v91, 2.0, v90
    v_fma_f32 v82, v83, -2.0, v82
    v_fma_f32 v90, v91, -2.0, v90
    v_fmamk_f32 v80, v76, 0x41700000, v82
    v_fmamk_f32 v88, v84, 0x41700000, v90
    v_fmamk_f32 v80, v81, 0x41200000, v80
    v_fmamk_f32 v88, v89, 0x41200000, v88
    v_cvt_pk_bf16_f32 v21, v77, v85
    v_cvt_pk_bf16_f32 v25, v78, v86
    v_cvt_pk_bf16_f32 v65, v79, v87
    v_cvt_pk_bf16_f32 v69, v82, v90
    v_cvt_pk_bf16_f32 v73, v80, v88
    v_lshlrev_b32 v76, 16, v18
    v_and_b32 v84, s25, v18
    v_lshlrev_b32 v77, 16, v22
    v_and_b32 v85, s25, v22
    v_lshlrev_b32 v78, 16, v26
    v_and_b32 v86, s25, v26
    v_lshlrev_b32 v79, 16, v30
    v_and_b32 v87, s25, v30
    v_add_f32 v80, v76, v78
    v_add_f32 v88, v84, v86
    v_add_f32 v81, v77, v79
    v_add_f32 v89, v85, v87
    v_fma_f32 v82, v78, 4.0, v76
    v_fma_f32 v90, v86, 4.0, v84
    v_fma_f32 v83, v79, 4.0, v77
    v_fma_f32 v91, v87, 4.0, v85
    v_add_f32 v77, v80, v81
    v_add_f32 v85, v88, v89
    v_sub_f32 v78, v80, v81
    v_sub_f32 v86, v88, v89
    v_fma_f32 v79, v83, 2.0, v82
    v_fma_f32 v87, v91, 2.0, v90
    v_fma_f32 v82, v83, -2.0, v82
    v_fma_f32 v90, v91, -2.0, v90
    v_fmamk_f32 v80, v76, 0x41700000, v82
    v_fmamk_f32 v88, v84, 0x41700000, v90
    v_fmamk_f32 v80, v81, 0x41200000, v80
    v_fmamk_f32 v88, v89, 0x41200000, v88
    v_cvt_pk_bf16_f32 v22, v77, v85
    v_cvt_pk_bf16_f32 v26, v78, v86
    v_cvt_pk_bf16_f32 v66, v79, v87
    v_cvt_pk_bf16_f32 v70, v82, v90
    v_cvt_pk_bf16_f32 v74, v80, v88
    v_lshlrev_b32 v76, 16, v19
    v_and_b32 v84, s25, v19
    v_lshlrev_b32 v77, 16, v23
    v_and_b32 v85, s25, v23
    v_lshlrev_b32 v78, 16, v27
    v_and_b32 v86, s25, v27
    v_lshlrev_b32 v79, 16, v31
    v_and_b32 v87, s25, v31
    v_add_f32 v80, v76, v78
    v_add_f32 v88, v84, v86
    v_add_f32 v81, v77, v79
    v_add_f32 v89, v85, v87
    v_fma_f32 v82, v78, 4.0, v76
    v_fma_f32 v90, v86, 4.0, v84
    v_fma_f32 v83, v79, 4.0, v77
    v_fma_f32 v91, v87, 4.0, v85
    v_add_f32 v77, v80, v81
    v_add_f32 v85, v88, v89
    v_sub_f32 v78, v80, v81
    v_sub_f32 v86, v88, v89
    v_fma_f32 v79, v83, 2.0, v82
    v_fma_f32 v87, v91, 2.0, v90
    v_fma_f32 v82, v83, -2.0, v82
    v_fma_f32 v90, v91, -2.0, v90
    v_fmamk_f32 v80, v76, 0x41700000, v82
    v_fmamk_f32 v88, v84, 0x41700000, v90
    v_fmamk_f32 v80, v81, 0x41200000, v80
    v_fmamk_f32 v88, v89, 0x41200000, v88
    v_cvt_pk_bf16_f32 v23, v77, v85
    v_cvt_pk_bf16_f32 v27, v78, v86
    v_cvt_pk_bf16_f32 v67, v79, v87
    v_cvt_pk_bf16_f32 v71, v82, v90
    v_cvt_pk_bf16_f32 v75, v80, v88
    s_add_u32 s28, s28, 1
    s_waitcnt lgkmcnt(0)
    s_barrier
    s_sub_u32 s22, s22, 1
    s_branch L_conv2_kernel_hloop2
L_conv2_kernel_hlast2:
    s_mov_b32 s25, 0xffff0000
    ds_write_b128 v96, v[64:67] offset:57344
    ds_write_b128 v97, v[68:71] offset:8192
    ds_write_b128 v97, v[72:75] offset:24576
    ds_write_b128 v96, v[48:51] offset:8192
    ds_write_b128 v96, v[52:55] offset:24576
    ds_write_b128 v96, v[56:59] offset:40960
    ds_write_b128 v98, v[60:63] offset:8704
    s_waitcnt lgkmcnt(0)
    s_barrier
    s_branch L_conv2_kernel_end
L_conv2_kernel_epi:
    v_and_b32 v108, 15, v127
    v_lshrrev_b32 v109, 4, v127
    v_lshrrev_b32 v110, 3, v108
    s_lshl_b32 s36, s20, 1
    v_add_u32 v110, s36, v110
    v_xor_b32 v111, v110, v108
    v_and_b32 v111, 7, v111
    v_lshlrev_b32 v111, 4, v111
    v_lshl_add_u32 v111, v110, 7, v111
    v_lshl_add_u32 v120, v109, 11, v111
    v_add_u32 v121, 65536, v120
    v_add_u32 v125, 131072, v120
    s_lshl_b32 s36, s20, 9
    s_add_u32 s36, s36, 115712
    v_lshl_add_u32 v123, v109, 7, s36
    s_lshl_b32 s36, s20, 4
    v_add_u32 v108, s36, v108
    v_lshl_add_u32 v110, v108, 2, s21
    v_lshlrev_b32 v110, 9, v110
    v_lshl_add_u32 v110, v109, 4, v110
    s_lshl_b32 s36, s29, 6
    v_add_u32 v110, s36, v110
    v_mov_b32 v111, 2130706432
    v_cmp_gt_u32 vcc, 125, v108
    s_mov_b32 s4, 0xbeaaaaab
    s_mov_b32 s5, s4
    s_mov_b32 s6, 0x3e800000
    s_mov_b32 s7, s6
    s_mov_b32 s8, 0xc0a00000
    s_mov_b32 s9, s8
    s_mov_b32 s10, 0xc0638e39
    s_mov_b32 s11, s10
    s_mov_b32 s12, 0xbf638e39
    s_mov_b32 s13, s12
    s_mov_b32 s14, 0xbe638e39
    s_mov_b32 s15, s14
    s_mov_b32 s22, 0xbd638e39
    s_mov_b32 s23, s22
    s_mov_b32 s24, 0x3ff1c71c
    s_mov_b32 s25, s24
    s_mov_b32 s26, 0xbf2aaaab
    s_mov_b32 s27, s26
    s_mov_b32 s32, 0x3ecccccd
    s_mov_b32 s33, s32
    s_mov_b32 s34, 0xbd888889
    s_mov_b32 s35, s34
    s_mov_b32 s38, 0xbe4ccccd
    s_mov_b32 s39, s38
    s_mov_b32 s40, 0xbdd2d3e8
    s_mov_b32 s41, s40
    s_mov_b32 s42, 0x3f800000
    s_mov_b32 s43, s42
    s_waitcnt lgkmcnt(0)
    s_barrier
    v_cndmask_b32 v122, v111, v110, vcc
    ds_read_b128 v[0:3], v120 offset:0
    ds_read_b128 v[4:7], v120 offset:16384
    ds_read_b128 v[8:11], v120 offset:32768
    ds_read_b128 v[12:15], v120 offset:49152
    ds_read_b128 v[16:19], v121 offset:0
    ds_read_b128 v[20:23], v121 offset:16384
    ds_read_b128 v[24:27], v121 offset:32768
    ds_read_b128 v[28:31], v125 offset:15360
    ds_read_b128 v[32:35], v120 offset:8192
    ds_read_b128 v[36:39], v120 offset:24576
    ds_read_b128 v[40:43], v120 offset:40960
    ds_read_b128 v[44:47], v120 offset:57344
    ds_read_b128 v[48:51], v121 offset:56320
    ds_read_b128 v[52:55], v121 offset:64512
    ds_read_b128 v[56:59], v125 offset:7168
    s_waitcnt lgkmcnt(7)
    ds_read_b128 v[60:63], v125 offset:23552
    s_waitcnt lgkmcnt(8)
    v_pk_add_f32 v[88:89], v[24:25], v[28:29]
    v_pk_add_f32 v[90:91], v[26:27], v[30:31]
    v_pk_add_f32 v[24:25], v[4:5], v[8:9]
    v_pk_add_f32 v[26:27], v[6:7], v[10:11]
    v_pk_add_f32 v[4:5], v[4:5], v[8:9] neg_lo:[0,1] neg_hi:[0,1]
    v_pk_add_f32 v[6:7], v[6:7], v[10:11] neg_lo:[0,1] neg_hi:[0,1]
    v_pk_add_f32 v[72:73], v[12:13], v[16:17]
    v_pk_add_f32 v[74:75], v[14:15], v[18:19]
    v_pk_add_f32 v[12:13], v[12:13], v[16:17] neg_lo:[0,1] neg_hi:[0,1]
    v_pk_add_f32 v[14:15], v[14:15], v[18:19] neg_lo:[0,1] neg_hi:[0,1]
    v_pk_fma_f32 v[72:73], v[24:25], s[4:5], v[72:73]
    v_pk_fma_f32 v[74:75], v[26:27], s[4:5], v[74:75]
    v_pk_fma_f32 v[20:21], v[0:1], s[10:11], v[20:21]
    v_pk_fma_f32 v[22:23], v[2:3], s[10:11], v[22:23]
    v_pk_fma_f32 v[72:73], v[0:1], s[6:7], v[72:73]
    v_pk_fma_f32 v[74:75], v[2:3], s[6:7], v[74:75]
    v_pk_add_f32 v[24:25], v[24:25], v[0:1] neg_lo:[0,1] neg_hi:[0,1]
    v_pk_add_f32 v[26:27], v[26:27], v[2:3] neg_lo:[0,1] neg_hi:[0,1]
    v_pk_fma_f32 v[72:73], v[88:89], s[8:9], v[72:73]
    v_pk_fma_f32 v[74:75], v[90:91], s[8:9], v[74:75]
    v_pk_add_f32 v[24:25], v[24:25], v[88:89] neg_lo:[0,1] neg_hi:[0,1]
    v_pk_add_f32 v[26:27], v[26:27], v[90:91] neg_lo:[0,1] neg_hi:[0,1]
    v_pk_fma_f32 v[20:21], v[88:89], s[22:23], v[20:21]
    v_pk_fma_f32 v[22:23], v[90:91], s[22:23], v[22:23]
    v_pk_add_f32 v[8:9], v[24:25], v[72:73] neg_lo:[0,1] neg_hi:[0,1]
    v_pk_add_f32 v[10:11], v[26:27], v[74:75] neg_lo:[0,1] neg_hi:[0,1]
    v_pk_fma_f32 v[20:21], v[72:73], s[14:15], v[20:21]
    v_pk_fma_f32 v[22:23], v[74:75], s[14:15], v[22:23]
    v_pk_mul_f32 v[80:81], v[12:13], s[32:33]
    v_pk_mul_f32 v[82:83], v[14:15], s[32:33]
    v_pk_fma_f32 v[20:21], v[8:9], s[12:13], v[20:21]
    v_pk_fma_f32 v[22:23], v[10:11], s[12:13], v[22:23]
    v_pk_fma_f32 v[80:81], v[4:5], s[34:35], v[80:81]
    v_pk_fma_f32 v[82:83], v[6:7], s[34:35], v[82:83]
    v_pk_fma_f32 v[64:65], v[4:5], s[24:25], v[20:21] neg_lo:[0,0,1] neg_hi:[0,0,1]
    v_pk_fma_f32 v[66:67], v[6:7], s[24:25], v[22:23] neg_lo:[0,0,1] neg_hi:[0,0,1]
    v_pk_fma_f32 v[64:65], v[12:13], s[26:27], v[64:65]
    v_pk_fma_f32 v[66:67], v[14:15], s[26:27], v[66:67]
    v_pk_fma_f32 v[80:81], v[64:65], s[38:39], v[80:81]
    v_pk_fma_f32 v[82:83], v[66:67], s[38:39], v[82:83]
    v_pk_add_f32 v[4:5], v[4:5], v[64:65] neg_lo:[0,1] neg_hi:[0,1]
    v_pk_add_f32 v[6:7], v[6:7], v[66:67] neg_lo:[0,1] neg_hi:[0,1]
    v_pk_add_f32 v[4:5], v[4:5], v[80:81] neg_lo:[0,1] neg_hi:[0,1]
    v_pk_add_f32 v[6:7], v[6:7], v[82:83] neg_lo:[0,1] neg_hi:[0,1]
    s_waitcnt lgkmcnt(0)
    v_pk_add_f32 v[92:93], v[56:57], v[60:61]
    v_pk_add_f32 v[94:95], v[58:59], v[62:63]
    v_pk_add_f32 v[56:57], v[36:37], v[40:41]
    v_pk_add_f32 v[58:59], v[38:39], v[42:43]
    v_pk_add_f32 v[36:37], v[36:37], v[40:41] neg_lo:[0,1] neg_hi:[0,1]
    v_pk_add_f32 v[38:39], v[38:39], v[42:43] neg_lo:[0,1] neg_hi:[0,1]
    v_pk_add_f32 v[76:77], v[44:45], v[48:49]
    v_pk_add_f32 v[78:79], v[46:47], v[50:51]
    v_pk_add_f32 v[44:45], v[44:45], v[48:49] neg_lo:[0,1] neg_hi:[0,1]
    v_pk_add_f32 v[46:47], v[46:47], v[50:51] neg_lo:[0,1] neg_hi:[0,1]
    v_pk_fma_f32 v[76:77], v[56:57], s[4:5], v[76:77]
    v_pk_fma_f32 v[78:79], v[58:59], s[4:5], v[78:79]
    v_pk_fma_f32 v[52:53], v[32:33], s[10:11], v[52:53]
    v_pk_fma_f32 v[54:55], v[34:35], s[10:11], v[54:55]
    v_pk_fma_f32 v[76:77], v[32:33], s[6:7], v[76:77]
    v_pk_fma_f32 v[78:79], v[34:35], s[6:7], v[78:79]
    v_pk_add_f32 v[56:57], v[56:57], v[32:33] neg_lo:[0,1] neg_hi:[0,1]
    v_pk_add_f32 v[58:59], v[58:59], v[34:35] neg_lo:[0,1] neg_hi:[0,1]
    v_pk_fma_f32 v[76:77], v[92:93], s[8:9], v[76:77]
    v_pk_fma_f32 v[78:79], v[94:95], s[8:9], v[78:79]
    v_pk_add_f32 v[56:57], v[56:57], v[92:93] neg_lo:[0,1] neg_hi:[0,1]
    v_pk_add_f32 v[58:59], v[58:59], v[94:95] neg_lo:[0,1] neg_hi:[0,1]
    v_pk_fma_f32 v[52:53], v[92:93], s[22:23], v[52:53]
    v_pk_fma_f32 v[54:55], v[94:95], s[22:23], v[54:55]
    v_pk_add_f32 v[40:41], v[56:57], v[76:77] neg_lo:[0,1] neg_hi:[0,1]
    v_pk_add_f32 v[42:43], v[58:59], v[78:79] neg_lo:[0,1] neg_hi:[0,1]
    v_pk_fma_f32 v[52:53], v[76:77], s[14:15], v[52:53]
    v_pk_fma_f32 v[54:55], v[78:79], s[14:15], v[54:55]
    v_pk_mul_f32 v[84:85], v[44:45], s[32:33]
    v_pk_mul_f32 v[86:87], v[46:47], s[32:33]
    v_pk_fma_f32 v[52:53], v[40:41], s[12:13], v[52:53]
    v_pk_fma_f32 v[54:55], v[42:43], s[12:13], v[54:55]
    v_pk_fma_f32 v[84:85], v[36:37], s[34:35], v[84:85]
    v_pk_fma_f32 v[86:87], v[38:39], s[34:35], v[86:87]
    v_pk_fma_f32 v[68:69], v[36:37], s[24:25], v[52:53] neg_lo:[0,0,1] neg_hi:[0,0,1]
    v_pk_fma_f32 v[70:71], v[38:39], s[24:25], v[54:55] neg_lo:[0,0,1] neg_hi:[0,0,1]
    v_pk_fma_f32 v[68:69], v[44:45], s[26:27], v[68:69]
    v_pk_fma_f32 v[70:71], v[46:47], s[26:27], v[70:71]
    v_pk_fma_f32 v[84:85], v[68:69], s[38:39], v[84:85]
    v_pk_fma_f32 v[86:87], v[70:71], s[38:39], v[86:87]
    v_pk_add_f32 v[36:37], v[36:37], v[68:69] neg_lo:[0,1] neg_hi:[0,1]
    v_pk_add_f32 v[38:39], v[38:39], v[70:71] neg_lo:[0,1] neg_hi:[0,1]
    v_pk_add_f32 v[36:37], v[36:37], v[84:85] neg_lo:[0,1] neg_hi:[0,1]
    v_pk_add_f32 v[38:39], v[38:39], v[86:87] neg_lo:[0,1] neg_hi:[0,1]
    s_mov_b32 s36, 0x00010001
    s_mov_b32 s37, 0x00010001
    s_mov_b64 exec, s[36:37]
    ds_write_b128 v123, v[0:3] offset:0
    ds_write_b128 v123, v[32:35] offset:16
    ds_write_b128 v123, v[4:7] offset:32
    ds_write_b128 v123, v[36:39] offset:48
    ds_write_b128 v123, v[8:11] offset:64
    ds_write_b128 v123, v[40:43] offset:80
    s_mov_b64 exec, -1
    v_mov_b32 v44, 0xc0135761
    v_mov_b32 v45, v44
    v_cvt_pk_bf16_f32 v48, v64, v68
    v_cvt_pk_bf16_f32 v49, v65, v69
    v_cvt_pk_bf16_f32 v50, v66, v70
    v_cvt_pk_bf16_f32 v51, v67, v71
    buffer_store_dwordx4 v[48:51], v122, s[16:19], 0 offen offset:0 sc1
    s_waitcnt lgkmcnt(0)
    s_barrier
    ds_read_b128 v[96:99], v123 offset:512
    ds_read_b128 v[100:103], v123 offset:528
    ds_read_b128 v[104:107], v123 offset:544
    ds_read_b128 v[108:111], v123 offset:560
    ds_read_b128 v[112:115], v123 offset:576
    ds_read_b128 v[116:119], v123 offset:592
    s_waitcnt lgkmcnt(4)
    v_mov_b32_dpp v96, v0 row_shl:1 row_mask:0xf bank_mask:0xf
    v_mov_b32_dpp v97, v1 row_shl:1 row_mask:0xf bank_mask:0xf
    v_mov_b32_dpp v98, v2 row_shl:1 row_mask:0xf bank_mask:0xf
    v_mov_b32_dpp v99, v3 row_shl:1 row_mask:0xf bank_mask:0xf
    v_mov_b32_dpp v100, v32 row_shl:1 row_mask:0xf bank_mask:0xf
    v_mov_b32_dpp v101, v33 row_shl:1 row_mask:0xf bank_mask:0xf
    v_mov_b32_dpp v102, v34 row_shl:1 row_mask:0xf bank_mask:0xf
    v_mov_b32_dpp v103, v35 row_shl:1 row_mask:0xf bank_mask:0xf
    v_pk_add_f32 v[72:73], v[72:73], v[96:97]
    v_pk_add_f32 v[74:75], v[74:75], v[98:99]
    v_pk_add_f32 v[76:77], v[76:77], v[100:101]
    v_pk_add_f32 v[78:79], v[78:79], v[102:103]
    v_cvt_pk_bf16_f32 v52, v72, v76
    v_cvt_pk_bf16_f32 v53, v73, v77
    v_cvt_pk_bf16_f32 v54, v74, v78
    v_cvt_pk_bf16_f32 v55, v75, v79
    buffer_store_dwordx4 v[52:55], v122, s[16:19], 0 offen offset:512 sc1
    s_waitcnt lgkmcnt(2)
    v_mov_b32_dpp v104, v4 row_shl:1 row_mask:0xf bank_mask:0xf
    v_mov_b32_dpp v105, v5 row_shl:1 row_mask:0xf bank_mask:0xf
    v_mov_b32_dpp v106, v6 row_shl:1 row_mask:0xf bank_mask:0xf
    v_mov_b32_dpp v107, v7 row_shl:1 row_mask:0xf bank_mask:0xf
    v_mov_b32_dpp v108, v36 row_shl:1 row_mask:0xf bank_mask:0xf
    v_mov_b32_dpp v109, v37 row_shl:1 row_mask:0xf bank_mask:0xf
    v_mov_b32_dpp v110, v38 row_shl:1 row_mask:0xf bank_mask:0xf
    v_mov_b32_dpp v111, v39 row_shl:1 row_mask:0xf bank_mask:0xf
    v_pk_add_f32 v[80:81], v[80:81], v[104:105]
    v_pk_add_f32 v[82:83], v[82:83], v[106:107]
    v_pk_add_f32 v[84:85], v[84:85], v[108:109]
    v_pk_add_f32 v[86:87], v[86:87], v[110:111]
    v_cvt_pk_bf16_f32 v56, v80, v84
    v_cvt_pk_bf16_f32 v57, v81, v85
    v_cvt_pk_bf16_f32 v58, v82, v86
    v_cvt_pk_bf16_f32 v59, v83, v87
    buffer_store_dwordx4 v[56:59], v122, s[16:19], 0 offen offset:1024 sc1
    s_waitcnt lgkmcnt(0)
    v_mov_b32_dpp v112, v8 row_shl:1 row_mask:0xf bank_mask:0xf
    v_mov_b32_dpp v113, v9 row_shl:1 row_mask:0xf bank_mask:0xf
    v_mov_b32_dpp v114, v10 row_shl:1 row_mask:0xf bank_mask:0xf
    v_mov_b32_dpp v115, v11 row_shl:1 row_mask:0xf bank_mask:0xf
    v_mov_b32_dpp v116, v40 row_shl:1 row_mask:0xf bank_mask:0xf
    v_mov_b32_dpp v117, v41 row_shl:1 row_mask:0xf bank_mask:0xf
    v_mov_b32_dpp v118, v42 row_shl:1 row_mask:0xf bank_mask:0xf
    v_mov_b32_dpp v119, v43 row_shl:1 row_mask:0xf bank_mask:0xf
    v_pk_add_f32 v[88:89], v[88:89], v[112:113]
    v_pk_add_f32 v[90:91], v[90:91], v[114:115]
    v_pk_add_f32 v[92:93], v[92:93], v[116:117]
    v_pk_add_f32 v[94:95], v[94:95], v[118:119]
    v_cvt_pk_bf16_f32 v60, v88, v92
    v_cvt_pk_bf16_f32 v61, v89, v93
    v_cvt_pk_bf16_f32 v62, v90, v94
    v_cvt_pk_bf16_f32 v63, v91, v95
    buffer_store_dwordx4 v[60:63], v122, s[16:19], 0 offen offset:1536 sc1
L_conv2_kernel_end:
L_conv2_kernel_done:
    s_endpgm
.globl joint_kernel
.p2align 8
.type joint_kernel,@function
joint_kernel:
    s_cmp_ge_u32 s2, 250
    s_cbranch_scc1 L_joint_kernel_done
    s_load_dwordx2 s[28:29], s[0:1], 56
    s_load_dwordx2 s[30:31], s[0:1], 72
    v_readfirstlane_b32 s20, v0
    s_lshr_b32 s20, s20, 6
    s_and_b32 s21, s20, 3
    v_and_b32 v255, 63, v0
    v_lshlrev_b32 v254, 4, v255
    s_cmp_ge_u32 s20, 4
    s_mov_b32 s33, 44171264
    s_cselect_b32 s33, 44040192, s33
    s_lshl_b32 s36, s21, 15
    s_add_u32 s33, s33, s36
    s_mov_b32 s14, 32768
    s_mov_b32 s15, 0x00020000
    s_lshl_b32 s35, s2, 14
    s_add_u32 s35, s35, 27262976
    s_mov_b32 s10, 8404992
    s_mov_b32 s11, 0x00020000
    s_waitcnt lgkmcnt(0)
    s_add_u32 s12, s30, s33
    s_addc_u32 s13, s31, 0
    s_cmp_ge_u32 s20, 4
    s_cbranch_scc1 L_joint_kernel_T
    s_add_u32 s8, s30, s35
    s_addc_u32 s9, s31, 0
    s_lshl_b32 s36, s20, 12
    s_add_u32 s37, s36, 8388608
    buffer_load_dwordx4 v[128:131], v254, s[8:11], s36 offen offset:0
    buffer_load_dwordx4 v[144:147], v254, s[8:11], s37 offen offset:0
    buffer_load_dwordx4 v[132:135], v254, s[8:11], s36 offen offset:1024
    buffer_load_dwordx4 v[148:151], v254, s[8:11], s37 offen offset:1024
    buffer_load_dwordx4 v[136:139], v254, s[8:11], s36 offen offset:2048
    buffer_load_dwordx4 v[152:155], v254, s[8:11], s37 offen offset:2048
    buffer_load_dwordx4 v[140:143], v254, s[8:11], s36 offen offset:3072
    buffer_load_dwordx4 v[156:159], v254, s[8:11], s37 offen offset:3072
    s_cmp_ge_u32 s2, 125
    s_cselect_b32 s34, 8192, 0
    s_add_u32 s34, s34, 44302336
    s_add_u32 s40, s30, s34
    s_addc_u32 s41, s31, 0
    s_mov_b32 s42, 24576
    s_mov_b32 s43, 0x00020000
    s_lshl_b32 s38, s20, 11
    s_add_u32 s39, s38, 16384
    buffer_load_dwordx4 v[192:195], v254, s[40:43], s38 offen offset:0
    buffer_load_dwordx4 v[196:199], v254, s[40:43], s38 offen offset:1024
    buffer_load_dwordx4 v[200:203], v254, s[40:43], s39 offen offset:0
    buffer_load_dwordx4 v[204:207], v254, s[40:43], s39 offen offset:1024
    s_barrier
    s_lshl_b32 s35, s2, 17
    s_add_u32 s16, s28, s35
    s_addc_u32 s17, s29, 0
    s_mov_b32 s18, 131072
    s_mov_b32 s19, 0x00020000
    s_mov_b32 s44, 0xbdd2d3e8
    v_mov_b32 v253, 0xc0135761
    s_mul_i32 s36, s20, 4224
    v_lshrrev_b32 v252, 5, v255
    v_lshlrev_b32 v252, 4, v252
    v_add3_u32 v252, v252, v254, s36
    s_mov_b32 s45, 0xffff0000
    v_add_u32 v251, s38, v254
    s_mov_b32 s46, s44
    s_mov_b32 s47, s44
    s_mov_b32 s48, 1.0
    s_mov_b32 s49, 1.0
    v_mov_b32 v248, v253
    v_mov_b32 v249, v253
    s_mov_b32 s22, 2
L_joint_kernel_floop:
    s_waitcnt vmcnt(10)
    v_lshlrev_b32 v168, 16, v128
    v_and_b32 v169, s45, v128
    v_lshlrev_b32 v232, 16, v144
    v_and_b32 v233, s45, v144
    v_lshlrev_b32 v170, 16, v129
    v_and_b32 v171, s45, v129
    v_lshlrev_b32 v234, 16, v145
    v_and_b32 v235, s45, v145
    v_lshlrev_b32 v172, 16, v130
    v_and_b32 v173, s45, v130
    v_lshlrev_b32 v236, 16, v146
    v_and_b32 v237, s45, v146
    v_lshlrev_b32 v174, 16, v131
    v_and_b32 v175, s45, v131
    v_lshlrev_b32 v238, 16, v147
    v_and_b32 v239, s45, v147
    v_pk_add_f32 v[168:169], v[168:169], v[232:233]
    v_pk_add_f32 v[170:171], v[170:171], v[234:235]
    v_pk_add_f32 v[172:173], v[172:173], v[236:237]
    v_pk_add_f32 v[174:175], v[174:175], v[238:239]
    v_pk_mul_f32 v[232:233], v[168:169], v[168:169]
    v_pk_mul_f32 v[234:235], v[170:171], v[170:171]
    v_pk_mul_f32 v[236:237], v[172:173], v[172:173]
    v_pk_mul_f32 v[238:239], v[174:175], v[174:175]
    v_pk_fma_f32 v[232:233], v[232:233], s[46:47], v[248:249]
    v_pk_fma_f32 v[234:235], v[234:235], s[46:47], v[248:249]
    v_pk_fma_f32 v[236:237], v[236:237], s[46:47], v[248:249]
    v_pk_fma_f32 v[238:239], v[238:239], s[46:47], v[248:249]
    v_pk_mul_f32 v[232:233], v[232:233], v[168:169]
    v_pk_mul_f32 v[234:235], v[234:235], v[170:171]
    v_pk_mul_f32 v[236:237], v[236:237], v[172:173]
    v_pk_mul_f32 v[238:239], v[238:239], v[174:175]
    v_exp_f32 v232, v232
    v_exp_f32 v233, v233
    v_exp_f32 v234, v234
    v_exp_f32 v235, v235
    v_exp_f32 v236, v236
    v_exp_f32 v237, v237
    v_exp_f32 v238, v238
    v_exp_f32 v239, v239
    v_pk_add_f32 v[232:233], v[232:233], s[48:49]
    v_pk_add_f32 v[234:235], v[234:235], s[48:49]
    v_pk_add_f32 v[236:237], v[236:237], s[48:49]
    v_pk_add_f32 v[238:239], v[238:239], s[48:49]
    v_rcp_f32 v232, v232
    v_rcp_f32 v233, v233
    v_rcp_f32 v234, v234
    v_rcp_f32 v235, v235
    v_rcp_f32 v236, v236
    v_rcp_f32 v237, v237
    v_rcp_f32 v238, v238
    v_rcp_f32 v239, v239
    v_pk_mul_f32 v[168:169], v[168:169], v[232:233]
    v_pk_mul_f32 v[170:171], v[170:171], v[234:235]
    v_pk_mul_f32 v[172:173], v[172:173], v[236:237]
    v_pk_mul_f32 v[174:175], v[174:175], v[238:239]
    v_cvt_pk_bf16_f32 v240, v168, v169
    v_cvt_pk_bf16_f32 v241, v170, v171
    v_cvt_pk_bf16_f32 v242, v172, v173
    v_cvt_pk_bf16_f32 v243, v174, v175
    ds_write_b128 v252, v[240:243] offset:49152
    s_waitcnt vmcnt(8)
    v_lshlrev_b32 v168, 16, v132
    v_and_b32 v169, s45, v132
    v_lshlrev_b32 v232, 16, v148
    v_and_b32 v233, s45, v148
    v_lshlrev_b32 v170, 16, v133
    v_and_b32 v171, s45, v133
    v_lshlrev_b32 v234, 16, v149
    v_and_b32 v235, s45, v149
    v_lshlrev_b32 v172, 16, v134
    v_and_b32 v173, s45, v134
    v_lshlrev_b32 v236, 16, v150
    v_and_b32 v237, s45, v150
    v_lshlrev_b32 v174, 16, v135
    v_and_b32 v175, s45, v135
    v_lshlrev_b32 v238, 16, v151
    v_and_b32 v239, s45, v151
    v_pk_add_f32 v[168:169], v[168:169], v[232:233]
    v_pk_add_f32 v[170:171], v[170:171], v[234:235]
    v_pk_add_f32 v[172:173], v[172:173], v[236:237]
    v_pk_add_f32 v[174:175], v[174:175], v[238:239]
    v_pk_mul_f32 v[232:233], v[168:169], v[168:169]
    v_pk_mul_f32 v[234:235], v[170:171], v[170:171]
    v_pk_mul_f32 v[236:237], v[172:173], v[172:173]
    v_pk_mul_f32 v[238:239], v[174:175], v[174:175]
    v_pk_fma_f32 v[232:233], v[232:233], s[46:47], v[248:249]
    v_pk_fma_f32 v[234:235], v[234:235], s[46:47], v[248:249]
    v_pk_fma_f32 v[236:237], v[236:237], s[46:47], v[248:249]
    v_pk_fma_f32 v[238:239], v[238:239], s[46:47], v[248:249]
    v_pk_mul_f32 v[232:233], v[232:233], v[168:169]
    v_pk_mul_f32 v[234:235], v[234:235], v[170:171]
    v_pk_mul_f32 v[236:237], v[236:237], v[172:173]
    v_pk_mul_f32 v[238:239], v[238:239], v[174:175]
    v_exp_f32 v232, v232
    v_exp_f32 v233, v233
    v_exp_f32 v234, v234
    v_exp_f32 v235, v235
    v_exp_f32 v236, v236
    v_exp_f32 v237, v237
    v_exp_f32 v238, v238
    v_exp_f32 v239, v239
    v_pk_add_f32 v[232:233], v[232:233], s[48:49]
    v_pk_add_f32 v[234:235], v[234:235], s[48:49]
    v_pk_add_f32 v[236:237], v[236:237], s[48:49]
    v_pk_add_f32 v[238:239], v[238:239], s[48:49]
    v_rcp_f32 v232, v232
    v_rcp_f32 v233, v233
    v_rcp_f32 v234, v234
    v_rcp_f32 v235, v235
    v_rcp_f32 v236, v236
    v_rcp_f32 v237, v237
    v_rcp_f32 v238, v238
    v_rcp_f32 v239, v239
    v_pk_mul_f32 v[168:169], v[168:169], v[232:233]
    v_pk_mul_f32 v[170:171], v[170:171], v[234:235]
    v_pk_mul_f32 v[172:173], v[172:173], v[236:237]
    v_pk_mul_f32 v[174:175], v[174:175], v[238:239]
    v_cvt_pk_bf16_f32 v244, v168, v169
    v_cvt_pk_bf16_f32 v245, v170, v171
    v_cvt_pk_bf16_f32 v246, v172, v173
    v_cvt_pk_bf16_f32 v247, v174, v175
    ds_write_b128 v252, v[244:247] offset:50208
    s_waitcnt vmcnt(4)
    v_pk_mov_b32 v[128:129], v[136:137], v[136:137] op_sel:[0,1]
    v_pk_mov_b32 v[144:145], v[152:153], v[152:153] op_sel:[0,1]
    v_pk_mov_b32 v[130:131], v[138:139], v[138:139] op_sel:[0,1]
    v_pk_mov_b32 v[146:147], v[154:155], v[154:155] op_sel:[0,1]
    v_pk_mov_b32 v[132:133], v[140:141], v[140:141] op_sel:[0,1]
    v_pk_mov_b32 v[148:149], v[156:157], v[156:157] op_sel:[0,1]
    v_pk_mov_b32 v[134:135], v[142:143], v[142:143] op_sel:[0,1]
    v_pk_mov_b32 v[150:151], v[158:159], v[158:159] op_sel:[0,1]
    v_add_u32 v252, 2112, v252
    s_sub_u32 s22, s22, 1
    s_cmp_lg_u32 s22, 0
    s_cbranch_scc1 L_joint_kernel_floop
    s_waitcnt vmcnt(0)
    ds_write_b128 v251, v[192:195] offset:32768
    ds_write_b128 v251, v[196:199] offset:33792
    ds_write_b128 v251, v[200:203] offset:40960
    ds_write_b128 v251, v[204:207] offset:41984
    s_waitcnt lgkmcnt(0)
    s_barrier
    s_mov_b32 s36, 0
    buffer_load_dwordx4 v[0:3], v254, s[12:15], s36 offen offset:0
    buffer_load_dwordx4 v[4:7], v254, s[12:15], s36 offen offset:1024
    buffer_load_dwordx4 v[8:11], v254, s[12:15], s36 offen offset:2048
    buffer_load_dwordx4 v[12:15], v254, s[12:15], s36 offen offset:3072
    s_mov_b32 s36, 4096
    buffer_load_dwordx4 v[16:19], v254, s[12:15], s36 offen offset:0
    buffer_load_dwordx4 v[20:23], v254, s[12:15], s36 offen offset:1024
    buffer_load_dwordx4 v[24:27], v254, s[12:15], s36 offen offset:2048
    buffer_load_dwordx4 v[28:31], v254, s[12:15], s36 offen offset:3072
    s_mov_b32 s36, 8192
    buffer_load_dwordx4 v[32:35], v254, s[12:15], s36 offen offset:0
    buffer_load_dwordx4 v[36:39], v254, s[12:15], s36 offen offset:1024
    buffer_load_dwordx4 v[40:43], v254, s[12:15], s36 offen offset:2048
    buffer_load_dwordx4 v[44:47], v254, s[12:15], s36 offen offset:3072
    s_mov_b32 s36, 12288
    buffer_load_dwordx4 v[48:51], v254, s[12:15], s36 offen offset:0
    buffer_load_dwordx4 v[52:55], v254, s[12:15], s36 offen offset:1024
    buffer_load_dwordx4 v[56:59], v254, s[12:15], s36 offen offset:2048
    buffer_load_dwordx4 v[60:63], v254, s[12:15], s36 offen offset:3072
    s_mov_b32 s36, 16384
    buffer_load_dwordx4 v[64:67], v254, s[12:15], s36 offen offset:0
    buffer_load_dwordx4 v[68:71], v254, s[12:15], s36 offen offset:1024
    buffer_load_dwordx4 v[72:75], v254, s[12:15], s36 offen offset:2048
    buffer_load_dwordx4 v[76:79], v254, s[12:15], s36 offen offset:3072
    s_mov_b32 s36, 20480
    buffer_load_dwordx4 v[80:83], v254, s[12:15], s36 offen offset:0
    buffer_load_dwordx4 v[84:87], v254, s[12:15], s36 offen offset:1024
    buffer_load_dwordx4 v[88:91], v254, s[12:15], s36 offen offset:2048
    buffer_load_dwordx4 v[92:95], v254, s[12:15], s36 offen offset:3072
    s_mov_b32 s36, 24576
    buffer_load_dwordx4 v[96:99], v254, s[12:15], s36 offen offset:0
    buffer_load_dwordx4 v[100:103], v254, s[12:15], s36 offen offset:1024
    buffer_load_dwordx4 v[104:107], v254, s[12:15], s36 offen offset:2048
    buffer_load_dwordx4 v[108:111], v254, s[12:15], s36 offen offset:3072
    s_mov_b32 s36, 28672
    buffer_load_dwordx4 v[112:115], v254, s[12:15], s36 offen offset:0
    buffer_load_dwordx4 v[116:119], v254, s[12:15], s36 offen offset:1024
    buffer_load_dwordx4 v[120:123], v254, s[12:15], s36 offen offset:2048
    buffer_load_dwordx4 v[124:127], v254, s[12:15], s36 offen offset:3072
    v_lshrrev_b32 v250, 5, v255
    v_lshlrev_b32 v250, 14, v250
    v_and_b32 v249, 31, v255
    v_lshl_add_u32 v250, v249, 2, v250
    s_lshl_b32 s36, s21, 7
    v_add_u32 v250, s36, v250
    s_mov_b32 s44, 0
    s_mov_b32 s45, 4096
    s_mov_b32 s46, 8192
    s_mov_b32 s47, 12288
    s_mov_b32 s48, 32768
    s_mov_b32 s49, 36864
    s_mov_b32 s50, 40960
    s_mov_b32 s51, 45056
    s_mov_b32 s52, 65536
    s_mov_b32 s53, 69632
    s_mov_b32 s54, 73728
    s_mov_b32 s55, 77824
    s_mov_b32 s56, 98304
    s_mov_b32 s57, 102400
    s_mov_b32 s58, 106496
    s_mov_b32 s59, 110592
    s_barrier
    ds_read_b128 v[192:195], v254 offset:0
    ds_read_b128 v[196:199], v254 offset:1024
    ds_read_b128 v[200:203], v254 offset:2048
    ds_read_b128 v[204:207], v254 offset:3072
    s_waitcnt vmcnt(30) lgkmcnt(3)
    v_mfma_f32_32x32x16_bf16 v[128:143], v[192:195], v[0:3], 0
    ds_read_b128 v[208:211], v254 offset:4096
    v_mfma_f32_32x32x16_bf16 v[144:159], v[192:195], v[4:7], 0
    s_waitcnt vmcnt(28) lgkmcnt(3)
    v_mfma_f32_32x32x16_bf16 v[128:143], v[196:199], v[8:11], v[128:143]
    ds_read_b128 v[212:215], v254 offset:5120
    v_mfma_f32_32x32x16_bf16 v[144:159], v[196:199], v[12:15], v[144:159]
    s_waitcnt vmcnt(26) lgkmcnt(3)
    v_mfma_f32_32x32x16_bf16 v[128:143], v[200:203], v[16:19], v[128:143]
    ds_read_b128 v[216:219], v254 offset:6144
    v_mfma_f32_32x32x16_bf16 v[144:159], v[200:203], v[20:23], v[144:159]
    s_waitcnt vmcnt(24) lgkmcnt(3)
    v_mfma_f32_32x32x16_bf16 v[128:143], v[204:207], v[24:27], v[128:143]
    ds_read_b128 v[220:223], v254 offset:7168
    v_mfma_f32_32x32x16_bf16 v[144:159], v[204:207], v[28:31], v[144:159]
    s_waitcnt vmcnt(22) lgkmcnt(3)
    v_mfma_f32_32x32x16_bf16 v[128:143], v[208:211], v[32:35], v[128:143]
    ds_read_b128 v[192:195], v254 offset:8192
    v_mfma_f32_32x32x16_bf16 v[144:159], v[208:211], v[36:39], v[144:159]
    s_waitcnt vmcnt(20) lgkmcnt(3)
    v_mfma_f32_32x32x16_bf16 v[128:143], v[212:215], v[40:43], v[128:143]
    ds_read_b128 v[196:199], v254 offset:9216
    v_mfma_f32_32x32x16_bf16 v[144:159], v[212:215], v[44:47], v[144:159]
    s_waitcnt vmcnt(18) lgkmcnt(3)
    v_mfma_f32_32x32x16_bf16 v[128:143], v[216:219], v[48:51], v[128:143]
    ds_read_b128 v[200:203], v254 offset:10240
    v_mfma_f32_32x32x16_bf16 v[144:159], v[216:219], v[52:55], v[144:159]
    s_waitcnt vmcnt(16) lgkmcnt(3)
    v_mfma_f32_32x32x16_bf16 v[128:143], v[220:223], v[56:59], v[128:143]
    ds_read_b128 v[204:207], v254 offset:11264
    v_mfma_f32_32x32x16_bf16 v[144:159], v[220:223], v[60:63], v[144:159]
    s_waitcnt vmcnt(14) lgkmcnt(3)
    v_mfma_f32_32x32x16_bf16 v[128:143], v[192:195], v[64:67], v[128:143]
    ds_read_b128 v[208:211], v254 offset:12288
    v_mfma_f32_32x32x16_bf16 v[144:159], v[192:195], v[68:71], v[144:159]
    s_waitcnt vmcnt(12) lgkmcnt(3)
    v_mfma_f32_32x32x16_bf16 v[128:143], v[196:199], v[72:75], v[128:143]
    ds_read_b128 v[212:215], v254 offset:13312
    v_mfma_f32_32x32x16_bf16 v[144:159], v[196:199], v[76:79], v[144:159]
    s_waitcnt vmcnt(10) lgkmcnt(3)
    v_mfma_f32_32x32x16_bf16 v[128:143], v[200:203], v[80:83], v[128:143]
    ds_read_b128 v[216:219], v254 offset:14336
    v_mfma_f32_32x32x16_bf16 v[144:159], v[200:203], v[84:87], v[144:159]
    s_waitcnt vmcnt(8) lgkmcnt(3)
    v_mfma_f32_32x32x16_bf16 v[128:143], v[204:207], v[88:91], v[128:143]
    ds_read_b128 v[220:223], v254 offset:15360
    v_mfma_f32_32x32x16_bf16 v[144:159], v[204:207], v[92:95], v[144:159]
    s_waitcnt lgkmcnt(0)
    s_barrier
    s_waitcnt vmcnt(6)
    v_mfma_f32_32x32x16_bf16 v[128:143], v[208:211], v[96:99], v[128:143]
    ds_read_b128 v[192:195], v254 offset:16384
    v_mfma_f32_32x32x16_bf16 v[144:159], v[208:211], v[100:103], v[144:159]
    s_waitcnt vmcnt(4)
    v_mfma_f32_32x32x16_bf16 v[128:143], v[212:215], v[104:107], v[128:143]
    ds_read_b128 v[196:199], v254 offset:17408
    v_mfma_f32_32x32x16_bf16 v[144:159], v[212:215], v[108:111], v[144:159]
    s_waitcnt vmcnt(2)
    v_mfma_f32_32x32x16_bf16 v[128:143], v[216:219], v[112:115], v[128:143]
    ds_read_b128 v[200:203], v254 offset:18432
    v_mfma_f32_32x32x16_bf16 v[144:159], v[216:219], v[116:119], v[144:159]
    s_waitcnt vmcnt(0)
    v_mfma_f32_32x32x16_bf16 v[128:143], v[220:223], v[120:123], v[128:143]
    ds_read_b128 v[204:207], v254 offset:19456
    v_mfma_f32_32x32x16_bf16 v[144:159], v[220:223], v[124:127], v[144:159]
    s_mov_b32 s22, 4
    s_nop 0
L_joint_kernel_oloop:
    s_waitcnt lgkmcnt(3)
    s_nop 0
    v_mfma_f32_32x32x16_bf16 v[160:175], v[192:195], v[0:3], 0
    ds_read_b128 v[208:211], v254 offset:20480
    v_mfma_f32_32x32x16_bf16 v[176:191], v[192:195], v[4:7], 0
    s_waitcnt lgkmcnt(3)
    s_nop 0
    v_mfma_f32_32x32x16_bf16 v[160:175], v[196:199], v[8:11], v[160:175]
    ds_read_b128 v[212:215], v254 offset:21504
    v_mfma_f32_32x32x16_bf16 v[176:191], v[196:199], v[12:15], v[176:191]
    s_waitcnt lgkmcnt(3)
    s_nop 0
    v_mfma_f32_32x32x16_bf16 v[160:175], v[200:203], v[16:19], v[160:175]
    ds_read_b128 v[216:219], v254 offset:22528
    v_mfma_f32_32x32x16_bf16 v[176:191], v[200:203], v[20:23], v[176:191]
    s_waitcnt lgkmcnt(3)
    s_nop 0
    v_mfma_f32_32x32x16_bf16 v[160:175], v[204:207], v[24:27], v[160:175]
    ds_read_b128 v[220:223], v254 offset:23552
    v_mfma_f32_32x32x16_bf16 v[176:191], v[204:207], v[28:31], v[176:191]
    s_waitcnt lgkmcnt(3)
    s_nop 0
    v_mfma_f32_32x32x16_bf16 v[160:175], v[208:211], v[32:35], v[160:175]
    ds_read_b128 v[192:195], v254 offset:24576
    v_cvt_pk_bf16_f32 v224, v128, v144
    buffer_store_dword v224, v250, s[16:19], s44 offen nt
    v_mfma_f32_32x32x16_bf16 v[176:191], v[208:211], v[36:39], v[176:191]
    v_cvt_pk_bf16_f32 v225, v129, v145
    buffer_store_dword v225, v250, s[16:19], s45 offen nt
    s_waitcnt lgkmcnt(3)
    s_nop 0
    v_mfma_f32_32x32x16_bf16 v[160:175], v[212:215], v[40:43], v[160:175]
    ds_read_b128 v[196:199], v254 offset:25600
    v_cvt_pk_bf16_f32 v226, v130, v146
    buffer_store_dword v226, v250, s[16:19], s46 offen nt
    v_mfma_f32_32x32x16_bf16 v[176:191], v[212:215], v[44:47], v[176:191]
    v_cvt_pk_bf16_f32 v227, v131, v147
    buffer_store_dword v227, v250, s[16:19], s47 offen nt
    s_waitcnt lgkmcnt(3)
    s_nop 0
    v_mfma_f32_32x32x16_bf16 v[160:175], v[216:219], v[48:51], v[160:175]
    ds_read_b128 v[200:203], v254 offset:26624
    v_cvt_pk_bf16_f32 v228, v132, v148
    buffer_store_dword v228, v250, s[16:19], s48 offen nt
    v_mfma_f32_32x32x16_bf16 v[176:191], v[216:219], v[52:55], v[176:191]
    v_cvt_pk_bf16_f32 v229, v133, v149
    buffer_store_dword v229, v250, s[16:19], s49 offen nt
    s_waitcnt lgkmcnt(3)
    s_nop 0
    v_mfma_f32_32x32x16_bf16 v[160:175], v[220:223], v[56:59], v[160:175]
    ds_read_b128 v[204:207], v254 offset:27648
    v_cvt_pk_bf16_f32 v230, v134, v150
    buffer_store_dword v230, v250, s[16:19], s50 offen nt
    v_mfma_f32_32x32x16_bf16 v[176:191], v[220:223], v[60:63], v[176:191]
    v_cvt_pk_bf16_f32 v231, v135, v151
    buffer_store_dword v231, v250, s[16:19], s51 offen nt
    s_waitcnt lgkmcnt(3)
    s_nop 0
    v_mfma_f32_32x32x16_bf16 v[160:175], v[192:195], v[64:67], v[160:175]
    ds_read_b128 v[208:211], v254 offset:28672
    v_cvt_pk_bf16_f32 v232, v136, v152
    buffer_store_dword v232, v250, s[16:19], s52 offen nt
    v_mfma_f32_32x32x16_bf16 v[176:191], v[192:195], v[68:71], v[176:191]
    v_cvt_pk_bf16_f32 v233, v137, v153
    buffer_store_dword v233, v250, s[16:19], s53 offen nt
    s_waitcnt lgkmcnt(3)
    s_nop 0
    v_mfma_f32_32x32x16_bf16 v[160:175], v[196:199], v[72:75], v[160:175]
    ds_read_b128 v[212:215], v254 offset:29696
    v_cvt_pk_bf16_f32 v234, v138, v154
    v_mfma_f32_32x32x16_bf16 v[176:191], v[196:199], v[76:79], v[176:191]
    buffer_store_dword v234, v250, s[16:19], s54 offen nt
    s_waitcnt lgkmcnt(3)
    s_nop 0
    v_mfma_f32_32x32x16_bf16 v[160:175], v[200:203], v[80:83], v[160:175]
    ds_read_b128 v[216:219], v254 offset:30720
    v_cvt_pk_bf16_f32 v235, v139, v155
    v_mfma_f32_32x32x16_bf16 v[176:191], v[200:203], v[84:87], v[176:191]
    buffer_store_dword v235, v250, s[16:19], s55 offen nt
    s_waitcnt lgkmcnt(3)
    s_nop 0
    v_mfma_f32_32x32x16_bf16 v[160:175], v[204:207], v[88:91], v[160:175]
    ds_read_b128 v[220:223], v254 offset:31744
    v_cvt_pk_bf16_f32 v236, v140, v156
    v_mfma_f32_32x32x16_bf16 v[176:191], v[204:207], v[92:95], v[176:191]
    buffer_store_dword v236, v250, s[16:19], s56 offen nt
    s_waitcnt lgkmcnt(0)
    s_barrier
    v_mfma_f32_32x32x16_bf16 v[160:175], v[208:211], v[96:99], v[160:175]
    ds_read_b128 v[192:195], v254 offset:0
    v_cvt_pk_bf16_f32 v237, v141, v157
    v_mfma_f32_32x32x16_bf16 v[176:191], v[208:211], v[100:103], v[176:191]
    buffer_store_dword v237, v250, s[16:19], s57 offen nt
    v_mfma_f32_32x32x16_bf16 v[160:175], v[212:215], v[104:107], v[160:175]
    ds_read_b128 v[196:199], v254 offset:1024
    v_cvt_pk_bf16_f32 v238, v142, v158
    v_mfma_f32_32x32x16_bf16 v[176:191], v[212:215], v[108:111], v[176:191]
    buffer_store_dword v238, v250, s[16:19], s58 offen nt
    v_mfma_f32_32x32x16_bf16 v[160:175], v[216:219], v[112:115], v[160:175]
    ds_read_b128 v[200:203], v254 offset:2048
    v_cvt_pk_bf16_f32 v239, v143, v159
    v_mfma_f32_32x32x16_bf16 v[176:191], v[216:219], v[116:119], v[176:191]
    buffer_store_dword v239, v250, s[16:19], s59 offen nt
    v_mfma_f32_32x32x16_bf16 v[160:175], v[220:223], v[120:123], v[160:175]
    ds_read_b128 v[204:207], v254 offset:3072
    v_add_u32 v250, 512, v250
    v_mfma_f32_32x32x16_bf16 v[176:191], v[220:223], v[124:127], v[176:191]
    s_sub_u32 s22, s22, 1
    s_cmp_eq_u32 s22, 0
    s_cbranch_scc1 L_joint_kernel_oend
    s_waitcnt lgkmcnt(3)
    v_mfma_f32_32x32x16_bf16 v[128:143], v[192:195], v[0:3], 0
    ds_read_b128 v[208:211], v254 offset:4096
    v_mfma_f32_32x32x16_bf16 v[144:159], v[192:195], v[4:7], 0
    s_waitcnt lgkmcnt(3)
    s_nop 0
    v_mfma_f32_32x32x16_bf16 v[128:143], v[196:199], v[8:11], v[128:143]
    ds_read_b128 v[212:215], v254 offset:5120
    v_mfma_f32_32x32x16_bf16 v[144:159], v[196:199], v[12:15], v[144:159]
    s_waitcnt lgkmcnt(3)
    s_nop 0
    v_mfma_f32_32x32x16_bf16 v[128:143], v[200:203], v[16:19], v[128:143]
    ds_read_b128 v[216:219], v254 offset:6144
    v_mfma_f32_32x32x16_bf16 v[144:159], v[200:203], v[20:23], v[144:159]
    s_waitcnt lgkmcnt(3)
    s_nop 0
    v_mfma_f32_32x32x16_bf16 v[128:143], v[204:207], v[24:27], v[128:143]
    ds_read_b128 v[220:223], v254 offset:7168
    v_mfma_f32_32x32x16_bf16 v[144:159], v[204:207], v[28:31], v[144:159]
    s_waitcnt lgkmcnt(3)
    s_nop 0
    v_mfma_f32_32x32x16_bf16 v[128:143], v[208:211], v[32:35], v[128:143]
    ds_read_b128 v[192:195], v254 offset:8192
    v_cvt_pk_bf16_f32 v224, v160, v176
    buffer_store_dword v224, v250, s[16:19], s44 offen nt
    v_mfma_f32_32x32x16_bf16 v[144:159], v[208:211], v[36:39], v[144:159]
    v_cvt_pk_bf16_f32 v225, v161, v177
    buffer_store_dword v225, v250, s[16:19], s45 offen nt
    s_waitcnt lgkmcnt(3)
    s_nop 0
    v_mfma_f32_32x32x16_bf16 v[128:143], v[212:215], v[40:43], v[128:143]
    ds_read_b128 v[196:199], v254 offset:9216
    v_cvt_pk_bf16_f32 v226, v162, v178
    buffer_store_dword v226, v250, s[16:19], s46 offen nt
    v_mfma_f32_32x32x16_bf16 v[144:159], v[212:215], v[44:47], v[144:159]
    v_cvt_pk_bf16_f32 v227, v163, v179
    buffer_store_dword v227, v250, s[16:19], s47 offen nt
    s_waitcnt lgkmcnt(3)
    s_nop 0
    v_mfma_f32_32x32x16_bf16 v[128:143], v[216:219], v[48:51], v[128:143]
    ds_read_b128 v[200:203], v254 offset:10240
    v_cvt_pk_bf16_f32 v228, v164, v180
    buffer_store_dword v228, v250, s[16:19], s48 offen nt
    v_mfma_f32_32x32x16_bf16 v[144:159], v[216:219], v[52:55], v[144:159]
    v_cvt_pk_bf16_f32 v229, v165, v181
    buffer_store_dword v229, v250, s[16:19], s49 offen nt
    s_waitcnt lgkmcnt(3)
    s_nop 0
    v_mfma_f32_32x32x16_bf16 v[128:143], v[220:223], v[56:59], v[128:143]
    ds_read_b128 v[204:207], v254 offset:11264
    v_cvt_pk_bf16_f32 v230, v166, v182
    buffer_store_dword v230, v250, s[16:19], s50 offen nt
    v_mfma_f32_32x32x16_bf16 v[144:159], v[220:223], v[60:63], v[144:159]
    v_cvt_pk_bf16_f32 v231, v167, v183
    buffer_store_dword v231, v250, s[16:19], s51 offen nt
    s_waitcnt lgkmcnt(3)
    s_nop 0
    v_mfma_f32_32x32x16_bf16 v[128:143], v[192:195], v[64:67], v[128:143]
    ds_read_b128 v[208:211], v254 offset:12288
    v_cvt_pk_bf16_f32 v232, v168, v184
    buffer_store_dword v232, v250, s[16:19], s52 offen nt
    v_mfma_f32_32x32x16_bf16 v[144:159], v[192:195], v[68:71], v[144:159]
    v_cvt_pk_bf16_f32 v233, v169, v185
    buffer_store_dword v233, v250, s[16:19], s53 offen nt
    s_waitcnt lgkmcnt(3)
    s_nop 0
    v_mfma_f32_32x32x16_bf16 v[128:143], v[196:199], v[72:75], v[128:143]
    ds_read_b128 v[212:215], v254 offset:13312
    v_cvt_pk_bf16_f32 v234, v170, v186
    v_mfma_f32_32x32x16_bf16 v[144:159], v[196:199], v[76:79], v[144:159]
    buffer_store_dword v234, v250, s[16:19], s54 offen nt
    s_waitcnt lgkmcnt(3)
    s_nop 0
    v_mfma_f32_32x32x16_bf16 v[128:143], v[200:203], v[80:83], v[128:143]
    ds_read_b128 v[216:219], v254 offset:14336
    v_cvt_pk_bf16_f32 v235, v171, v187
    v_mfma_f32_32x32x16_bf16 v[144:159], v[200:203], v[84:87], v[144:159]
    buffer_store_dword v235, v250, s[16:19], s55 offen nt
    s_waitcnt lgkmcnt(3)
    s_nop 0
    v_mfma_f32_32x32x16_bf16 v[128:143], v[204:207], v[88:91], v[128:143]
    ds_read_b128 v[220:223], v254 offset:15360
    v_cvt_pk_bf16_f32 v236, v172, v188
    v_mfma_f32_32x32x16_bf16 v[144:159], v[204:207], v[92:95], v[144:159]
    buffer_store_dword v236, v250, s[16:19], s56 offen nt
    s_waitcnt lgkmcnt(0)
    s_barrier
    v_mfma_f32_32x32x16_bf16 v[128:143], v[208:211], v[96:99], v[128:143]
    ds_read_b128 v[192:195], v254 offset:16384
    v_cvt_pk_bf16_f32 v237, v173, v189
    v_mfma_f32_32x32x16_bf16 v[144:159], v[208:211], v[100:103], v[144:159]
    buffer_store_dword v237, v250, s[16:19], s57 offen nt
    v_mfma_f32_32x32x16_bf16 v[128:143], v[212:215], v[104:107], v[128:143]
    ds_read_b128 v[196:199], v254 offset:17408
    v_cvt_pk_bf16_f32 v238, v174, v190
    v_mfma_f32_32x32x16_bf16 v[144:159], v[212:215], v[108:111], v[144:159]
    buffer_store_dword v238, v250, s[16:19], s58 offen nt
    v_mfma_f32_32x32x16_bf16 v[128:143], v[216:219], v[112:115], v[128:143]
    ds_read_b128 v[200:203], v254 offset:18432
    v_cvt_pk_bf16_f32 v239, v175, v191
    v_mfma_f32_32x32x16_bf16 v[144:159], v[216:219], v[116:119], v[144:159]
    buffer_store_dword v239, v250, s[16:19], s59 offen nt
    v_mfma_f32_32x32x16_bf16 v[128:143], v[220:223], v[120:123], v[128:143]
    ds_read_b128 v[204:207], v254 offset:19456
    v_add_u32 v250, 512, v250
    v_mfma_f32_32x32x16_bf16 v[144:159], v[220:223], v[124:127], v[144:159]
    s_waitcnt vmcnt(24)
    s_branch L_joint_kernel_oloop
L_joint_kernel_oend:
    s_nop 15
    v_cvt_pk_bf16_f32 v224, v160, v176
    buffer_store_dword v224, v250, s[16:19], s44 offen nt
    v_cvt_pk_bf16_f32 v225, v161, v177
    buffer_store_dword v225, v250, s[16:19], s45 offen nt
    v_cvt_pk_bf16_f32 v226, v162, v178
    buffer_store_dword v226, v250, s[16:19], s46 offen nt
    v_cvt_pk_bf16_f32 v227, v163, v179
    buffer_store_dword v227, v250, s[16:19], s47 offen nt
    v_cvt_pk_bf16_f32 v228, v164, v180
    buffer_store_dword v228, v250, s[16:19], s48 offen nt
    v_cvt_pk_bf16_f32 v229, v165, v181
    buffer_store_dword v229, v250, s[16:19], s49 offen nt
    v_cvt_pk_bf16_f32 v230, v166, v182
    buffer_store_dword v230, v250, s[16:19], s50 offen nt
    v_cvt_pk_bf16_f32 v231, v167, v183
    buffer_store_dword v231, v250, s[16:19], s51 offen nt
    v_cvt_pk_bf16_f32 v232, v168, v184
    buffer_store_dword v232, v250, s[16:19], s52 offen nt
    v_cvt_pk_bf16_f32 v233, v169, v185
    buffer_store_dword v233, v250, s[16:19], s53 offen nt
    v_cvt_pk_bf16_f32 v234, v170, v186
    buffer_store_dword v234, v250, s[16:19], s54 offen nt
    v_cvt_pk_bf16_f32 v235, v171, v187
    buffer_store_dword v235, v250, s[16:19], s55 offen nt
    v_cvt_pk_bf16_f32 v236, v172, v188
    buffer_store_dword v236, v250, s[16:19], s56 offen nt
    v_cvt_pk_bf16_f32 v237, v173, v189
    buffer_store_dword v237, v250, s[16:19], s57 offen nt
    v_cvt_pk_bf16_f32 v238, v174, v190
    buffer_store_dword v238, v250, s[16:19], s58 offen nt
    v_cvt_pk_bf16_f32 v239, v175, v191
    buffer_store_dword v239, v250, s[16:19], s59 offen nt
    v_add_u32 v250, 512, v250
    s_branch L_joint_kernel_fin
L_joint_kernel_T:
    s_setprio 3
    s_add_u32 s36, s30, 44335104
    s_addc_u32 s37, s31, 0
    s_load_dwordx16 s[44:59], s[36:37], 0
    v_and_b32 v250, 31, v255
    v_mul_u32_u24 v250, 528, v250
    v_lshrrev_b32 v249, 5, v255
    v_lshl_add_u32 v250, v249, 4, v250
    v_lshlrev_b32 v249, 5, v249
    s_lshl_b32 s36, s21, 8
    v_add_u32 v249, s36, v249
    s_lshl_b32 s36, s21, 12
    v_add_u32 v248, s36, v254
    s_barrier
    s_mov_b32 s36, 0
    buffer_load_dwordx4 v[0:3], v254, s[12:15], s36 offen offset:0
    buffer_load_dwordx4 v[4:7], v254, s[12:15], s36 offen offset:1024
    buffer_load_dwordx4 v[8:11], v254, s[12:15], s36 offen offset:2048
    buffer_load_dwordx4 v[12:15], v254, s[12:15], s36 offen offset:3072
    s_mov_b32 s36, 4096
    buffer_load_dwordx4 v[16:19], v254, s[12:15], s36 offen offset:0
    buffer_load_dwordx4 v[20:23], v254, s[12:15], s36 offen offset:1024
    buffer_load_dwordx4 v[24:27], v254, s[12:15], s36 offen offset:2048
    buffer_load_dwordx4 v[28:31], v254, s[12:15], s36 offen offset:3072
    s_mov_b32 s36, 8192
    buffer_load_dwordx4 v[32:35], v254, s[12:15], s36 offen offset:0
    buffer_load_dwordx4 v[36:39], v254, s[12:15], s36 offen offset:1024
    buffer_load_dwordx4 v[40:43], v254, s[12:15], s36 offen offset:2048
    buffer_load_dwordx4 v[44:47], v254, s[12:15], s36 offen offset:3072
    s_mov_b32 s36, 12288
    buffer_load_dwordx4 v[48:51], v254, s[12:15], s36 offen offset:0
    buffer_load_dwordx4 v[52:55], v254, s[12:15], s36 offen offset:1024
    buffer_load_dwordx4 v[56:59], v254, s[12:15], s36 offen offset:2048
    buffer_load_dwordx4 v[60:63], v254, s[12:15], s36 offen offset:3072
    s_mov_b32 s36, 16384
    buffer_load_dwordx4 v[64:67], v254, s[12:15], s36 offen offset:0
    buffer_load_dwordx4 v[68:71], v254, s[12:15], s36 offen offset:1024
    buffer_load_dwordx4 v[72:75], v254, s[12:15], s36 offen offset:2048
    buffer_load_dwordx4 v[76:79], v254, s[12:15], s36 offen offset:3072
    s_mov_b32 s36, 20480
    buffer_load_dwordx4 v[80:83], v254, s[12:15], s36 offen offset:0
    buffer_load_dwordx4 v[84:87], v254, s[12:15], s36 offen offset:1024
    buffer_load_dwordx4 v[88:91], v254, s[12:15], s36 offen offset:2048
    buffer_load_dwordx4 v[92:95], v254, s[12:15], s36 offen offset:3072
    s_mov_b32 s36, 24576
    buffer_load_dwordx4 v[96:99], v254, s[12:15], s36 offen offset:0
    buffer_load_dwordx4 v[100:103], v254, s[12:15], s36 offen offset:1024
    buffer_load_dwordx4 v[104:107], v254, s[12:15], s36 offen offset:2048
    buffer_load_dwordx4 v[108:111], v254, s[12:15], s36 offen offset:3072
    s_mov_b32 s36, 28672
    buffer_load_dwordx4 v[112:115], v254, s[12:15], s36 offen offset:0
    buffer_load_dwordx4 v[116:119], v254, s[12:15], s36 offen offset:1024
    buffer_load_dwordx4 v[120:123], v254, s[12:15], s36 offen offset:2048
    buffer_load_dwordx4 v[124:127], v254, s[12:15], s36 offen offset:3072
    s_waitcnt lgkmcnt(0)
    s_setprio 0
    s_or_b32 s44, s44, s45
    s_or_b32 s44, s44, s46
    s_or_b32 s44, s44, s47
    s_or_b32 s44, s44, s48
    s_or_b32 s44, s44, s49
    s_or_b32 s44, s44, s50
    s_or_b32 s44, s44, s51
    s_or_b32 s44, s44, s52
    s_or_b32 s44, s44, s53
    s_or_b32 s44, s44, s54
    s_or_b32 s44, s44, s55
    s_or_b32 s44, s44, s56
    s_or_b32 s44, s44, s57
    s_or_b32 s44, s44, s58
    s_or_b32 s44, s44, s59
    s_barrier
    ds_read_b128 v[160:163], v250 offset:49152
    ds_read_b128 v[164:167], v250 offset:49184
    ds_read_b128 v[168:171], v250 offset:49216
    ds_read_b128 v[172:175], v250 offset:49248
    ds_read_b128 v[176:179], v250 offset:49280
    ds_read_b128 v[180:183], v250 offset:49312
    ds_read_b128 v[184:187], v250 offset:49344
    ds_read_b128 v[188:191], v250 offset:49376
    s_waitcnt vmcnt(30) lgkmcnt(7)
    v_mfma_f32_32x32x16_bf16 v[128:143], v[0:3], v[160:163], 0
    v_mfma_f32_32x32x16_bf16 v[144:159], v[4:7], v[160:163], 0
    ds_read_b128 v[160:163], v250 offset:49408
    s_waitcnt vmcnt(28) lgkmcnt(7)
    v_mfma_f32_32x32x16_bf16 v[128:143], v[8:11], v[164:167], v[128:143]
    v_mfma_f32_32x32x16_bf16 v[144:159], v[12:15], v[164:167], v[144:159]
    ds_read_b128 v[164:167], v250 offset:49440
    s_waitcnt vmcnt(26) lgkmcnt(7)
    v_mfma_f32_32x32x16_bf16 v[128:143], v[16:19], v[168:171], v[128:143]
    v_mfma_f32_32x32x16_bf16 v[144:159], v[20:23], v[168:171], v[144:159]
    ds_read_b128 v[168:171], v250 offset:49472
    s_waitcnt vmcnt(24) lgkmcnt(7)
    v_mfma_f32_32x32x16_bf16 v[128:143], v[24:27], v[172:175], v[128:143]
    v_mfma_f32_32x32x16_bf16 v[144:159], v[28:31], v[172:175], v[144:159]
    ds_read_b128 v[172:175], v250 offset:49504
    s_waitcnt vmcnt(22) lgkmcnt(7)
    v_mfma_f32_32x32x16_bf16 v[128:143], v[32:35], v[176:179], v[128:143]
    v_mfma_f32_32x32x16_bf16 v[144:159], v[36:39], v[176:179], v[144:159]
    ds_read_b128 v[176:179], v250 offset:49536
    s_waitcnt vmcnt(20) lgkmcnt(7)
    v_mfma_f32_32x32x16_bf16 v[128:143], v[40:43], v[180:183], v[128:143]
    v_mfma_f32_32x32x16_bf16 v[144:159], v[44:47], v[180:183], v[144:159]
    ds_read_b128 v[180:183], v250 offset:49568
    s_waitcnt vmcnt(18) lgkmcnt(7)
    v_mfma_f32_32x32x16_bf16 v[128:143], v[48:51], v[184:187], v[128:143]
    v_mfma_f32_32x32x16_bf16 v[144:159], v[52:55], v[184:187], v[144:159]
    ds_read_b128 v[184:187], v250 offset:49600
    s_waitcnt vmcnt(16) lgkmcnt(7)
    v_mfma_f32_32x32x16_bf16 v[128:143], v[56:59], v[188:191], v[128:143]
    v_mfma_f32_32x32x16_bf16 v[144:159], v[60:63], v[188:191], v[144:159]
    ds_read_b128 v[188:191], v250 offset:49632
    s_waitcnt vmcnt(14) lgkmcnt(7)
    v_mfma_f32_32x32x16_bf16 v[128:143], v[64:67], v[160:163], v[128:143]
    v_mfma_f32_32x32x16_bf16 v[144:159], v[68:71], v[160:163], v[144:159]
    s_waitcnt vmcnt(12) lgkmcnt(6)
    v_mfma_f32_32x32x16_bf16 v[128:143], v[72:75], v[164:167], v[128:143]
    v_mfma_f32_32x32x16_bf16 v[144:159], v[76:79], v[164:167], v[144:159]
    s_waitcnt vmcnt(10) lgkmcnt(5)
    v_mfma_f32_32x32x16_bf16 v[128:143], v[80:83], v[168:171], v[128:143]
    v_mfma_f32_32x32x16_bf16 v[144:159], v[84:87], v[168:171], v[144:159]
    s_waitcnt vmcnt(8) lgkmcnt(4)
    v_mfma_f32_32x32x16_bf16 v[128:143], v[88:91], v[172:175], v[128:143]
    v_mfma_f32_32x32x16_bf16 v[144:159], v[92:95], v[172:175], v[144:159]
    s_waitcnt vmcnt(6) lgkmcnt(3)
    v_mfma_f32_32x32x16_bf16 v[128:143], v[96:99], v[176:179], v[128:143]
    v_mfma_f32_32x32x16_bf16 v[144:159], v[100:103], v[176:179], v[144:159]
    s_waitcnt vmcnt(4) lgkmcnt(2)
    v_mfma_f32_32x32x16_bf16 v[128:143], v[104:107], v[180:183], v[128:143]
    v_mfma_f32_32x32x16_bf16 v[144:159], v[108:111], v[180:183], v[144:159]
    s_waitcnt vmcnt(2) lgkmcnt(1)
    v_mfma_f32_32x32x16_bf16 v[128:143], v[112:115], v[184:187], v[128:143]
    v_mfma_f32_32x32x16_bf16 v[144:159], v[116:119], v[184:187], v[144:159]
    s_waitcnt vmcnt(0) lgkmcnt(0)
    v_mfma_f32_32x32x16_bf16 v[128:143], v[120:123], v[188:191], v[128:143]
    v_mfma_f32_32x32x16_bf16 v[144:159], v[124:127], v[188:191], v[144:159]
    s_mov_b32 s46, 0xffff0000
    s_mov_b32 s45, 0x4038aa3b
    s_nop 10
    v_cvt_pk_bf16_f32 v224, v128, v144
    v_cvt_pk_bf16_f32 v225, v129, v145
    v_cvt_pk_bf16_f32 v226, v130, v146
    v_cvt_pk_bf16_f32 v227, v131, v147
    v_cvt_pk_bf16_f32 v228, v132, v148
    v_cvt_pk_bf16_f32 v229, v133, v149
    v_cvt_pk_bf16_f32 v230, v134, v150
    v_cvt_pk_bf16_f32 v231, v135, v151
    v_cvt_pk_bf16_f32 v232, v136, v152
    v_cvt_pk_bf16_f32 v233, v137, v153
    v_cvt_pk_bf16_f32 v234, v138, v154
    v_cvt_pk_bf16_f32 v235, v139, v155
    v_cvt_pk_bf16_f32 v236, v140, v156
    v_cvt_pk_bf16_f32 v237, v141, v157
    v_cvt_pk_bf16_f32 v238, v142, v158
    v_cvt_pk_bf16_f32 v239, v143, v159
    v_lshlrev_b32 v0, 16, v224
    v_and_b32 v1, s46, v224
    v_lshlrev_b32 v2, 16, v225
    v_and_b32 v3, s46, v225
    v_lshlrev_b32 v4, 16, v226
    v_and_b32 v5, s46, v226
    v_lshlrev_b32 v6, 16, v227
    v_and_b32 v7, s46, v227
    v_lshlrev_b32 v8, 16, v228
    v_and_b32 v9, s46, v228
    v_lshlrev_b32 v10, 16, v229
    v_and_b32 v11, s46, v229
    v_lshlrev_b32 v12, 16, v230
    v_and_b32 v13, s46, v230
    v_lshlrev_b32 v14, 16, v231
    v_and_b32 v15, s46, v231
    v_lshlrev_b32 v16, 16, v232
    v_and_b32 v17, s46, v232
    v_lshlrev_b32 v18, 16, v233
    v_and_b32 v19, s46, v233
    v_lshlrev_b32 v20, 16, v234
    v_and_b32 v21, s46, v234
    v_lshlrev_b32 v22, 16, v235
    v_and_b32 v23, s46, v235
    v_lshlrev_b32 v24, 16, v236
    v_and_b32 v25, s46, v236
    v_lshlrev_b32 v26, 16, v237
    v_and_b32 v27, s46, v237
    v_lshlrev_b32 v28, 16, v238
    v_and_b32 v29, s46, v238
    v_lshlrev_b32 v30, 16, v239
    v_and_b32 v31, s46, v239
    s_mov_b32 s48, s45
    s_mov_b32 s49, s45
    v_pk_mul_f32 v[0:1], v[0:1], s[48:49]
    v_pk_mul_f32 v[2:3], v[2:3], s[48:49]
    v_pk_mul_f32 v[4:5], v[4:5], s[48:49]
    v_pk_mul_f32 v[6:7], v[6:7], s[48:49]
    v_pk_mul_f32 v[8:9], v[8:9], s[48:49]
    v_pk_mul_f32 v[10:11], v[10:11], s[48:49]
    v_pk_mul_f32 v[12:13], v[12:13], s[48:49]
    v_pk_mul_f32 v[14:15], v[14:15], s[48:49]
    v_pk_mul_f32 v[16:17], v[16:17], s[48:49]
    v_pk_mul_f32 v[18:19], v[18:19], s[48:49]
    v_pk_mul_f32 v[20:21], v[20:21], s[48:49]
    v_pk_mul_f32 v[22:23], v[22:23], s[48:49]
    v_pk_mul_f32 v[24:25], v[24:25], s[48:49]
    v_pk_mul_f32 v[26:27], v[26:27], s[48:49]
    v_pk_mul_f32 v[28:29], v[28:29], s[48:49]
    v_pk_mul_f32 v[30:31], v[30:31], s[48:49]
    v_max_f32 v64, |v0|, |v1|
    v_max3_f32 v64, |v2|, |v3|, v64
    v_max3_f32 v64, |v4|, |v5|, v64
    v_max3_f32 v64, |v6|, |v7|, v64
    v_max3_f32 v64, |v8|, |v9|, v64
    v_max3_f32 v64, |v10|, |v11|, v64
    v_max3_f32 v64, |v12|, |v13|, v64
    v_max3_f32 v64, |v14|, |v15|, v64
    v_max3_f32 v64, |v16|, |v17|, v64
    v_max3_f32 v64, |v18|, |v19|, v64
    v_max3_f32 v64, |v20|, |v21|, v64
    v_max3_f32 v64, |v22|, |v23|, v64
    v_max3_f32 v64, |v24|, |v25|, v64
    v_max3_f32 v64, |v26|, |v27|, v64
    v_max3_f32 v64, |v28|, |v29|, v64
    v_max3_f32 v64, |v30|, |v31|, v64
    v_cmp_lt_f32 vcc, 0x42f00000, v64
    s_mov_b32 s22, 4
    s_or_b32 s44, s44, vcc_lo
    s_or_b32 s44, s44, vcc_hi
    s_cmp_lg_u32 s44, 0
    s_cbranch_scc1 L_joint_kernel_tslow
    ds_read_b128 v[192:195], v249 offset:40960
    ds_read_b128 v[196:199], v249 offset:40976
    ds_read_b128 v[200:203], v249 offset:41024
    ds_read_b128 v[204:207], v249 offset:41040
    ds_read_b128 v[208:211], v249 offset:41088
    ds_read_b128 v[212:215], v249 offset:41104
    ds_read_b128 v[216:219], v249 offset:41152
    ds_read_b128 v[220:223], v249 offset:41168
    v_add_u32 v249, 1024, v249
    v_exp_f32 v0, v0
    v_exp_f32 v1, v1
    v_exp_f32 v2, v2
    v_exp_f32 v3, v3
    v_exp_f32 v4, v4
    v_exp_f32 v5, v5
    v_exp_f32 v6, v6
    v_exp_f32 v7, v7
    v_exp_f32 v8, v8
    v_exp_f32 v9, v9
    v_exp_f32 v10, v10
    v_exp_f32 v11, v11
    v_exp_f32 v12, v12
    v_exp_f32 v13, v13
    v_exp_f32 v14, v14
    v_exp_f32 v15, v15
    v_exp_f32 v16, v16
    v_exp_f32 v17, v17
    v_exp_f32 v18, v18
    v_exp_f32 v19, v19
    v_exp_f32 v20, v20
    v_exp_f32 v21, v21
    v_exp_f32 v22, v22
    v_exp_f32 v23, v23
    v_exp_f32 v24, v24
    v_exp_f32 v25, v25
    v_exp_f32 v26, v26
    v_exp_f32 v27, v27
    v_exp_f32 v28, v28
    v_exp_f32 v29, v29
    v_exp_f32 v30, v30
    v_exp_f32 v31, v31
    s_waitcnt lgkmcnt(0)
L_joint_kernel_tloop1:
    v_fma_f32 v32, v192, v0, 1.0
    v_fma_f32 v33, v193, v1, 1.0
    v_fma_f32 v34, v194, v2, 1.0
    v_fma_f32 v35, v195, v3, 1.0
    v_fma_f32 v36, v196, v4, 1.0
    v_fma_f32 v37, v197, v5, 1.0
    v_fma_f32 v38, v198, v6, 1.0
    v_fma_f32 v39, v199, v7, 1.0
    v_rcp_f32 v32, v32
    v_rcp_f32 v33, v33
    v_rcp_f32 v34, v34
    v_rcp_f32 v35, v35
    v_rcp_f32 v36, v36
    v_rcp_f32 v37, v37
    v_rcp_f32 v38, v38
    v_rcp_f32 v39, v39
    v_fma_f32 v32, v32, -2.0, 1.0
    v_fma_f32 v33, v33, -2.0, 1.0
    v_fma_f32 v34, v34, -2.0, 1.0
    v_fma_f32 v35, v35, -2.0, 1.0
    v_fma_f32 v36, v36, -2.0, 1.0
    v_fma_f32 v37, v37, -2.0, 1.0
    v_fma_f32 v38, v38, -2.0, 1.0
    v_fma_f32 v39, v39, -2.0, 1.0
    v_cvt_pk_bf16_f32 v224, v32, v33
    v_cvt_pk_bf16_f32 v225, v34, v35
    v_cvt_pk_bf16_f32 v226, v36, v37
    v_cvt_pk_bf16_f32 v227, v38, v39
    ds_write_b128 v248, v[224:227] offset:0
    v_fma_f32 v40, v200, v8, 1.0
    v_fma_f32 v41, v201, v9, 1.0
    v_fma_f32 v42, v202, v10, 1.0
    v_fma_f32 v43, v203, v11, 1.0
    v_fma_f32 v44, v204, v12, 1.0
    v_fma_f32 v45, v205, v13, 1.0
    v_fma_f32 v46, v206, v14, 1.0
    v_fma_f32 v47, v207, v15, 1.0
    v_rcp_f32 v40, v40
    v_rcp_f32 v41, v41
    v_rcp_f32 v42, v42
    v_rcp_f32 v43, v43
    v_rcp_f32 v44, v44
    v_rcp_f32 v45, v45
    v_rcp_f32 v46, v46
    v_rcp_f32 v47, v47
    v_fma_f32 v40, v40, -2.0, 1.0
    v_fma_f32 v41, v41, -2.0, 1.0
    v_fma_f32 v42, v42, -2.0, 1.0
    v_fma_f32 v43, v43, -2.0, 1.0
    v_fma_f32 v44, v44, -2.0, 1.0
    v_fma_f32 v45, v45, -2.0, 1.0
    v_fma_f32 v46, v46, -2.0, 1.0
    v_fma_f32 v47, v47, -2.0, 1.0
    v_cvt_pk_bf16_f32 v228, v40, v41
    v_cvt_pk_bf16_f32 v229, v42, v43
    v_cvt_pk_bf16_f32 v230, v44, v45
    v_cvt_pk_bf16_f32 v231, v46, v47
    ds_write_b128 v248, v[228:231] offset:1024
    v_fma_f32 v48, v208, v16, 1.0
    v_fma_f32 v49, v209, v17, 1.0
    v_fma_f32 v50, v210, v18, 1.0
    v_fma_f32 v51, v211, v19, 1.0
    v_fma_f32 v52, v212, v20, 1.0
    v_fma_f32 v53, v213, v21, 1.0
    v_fma_f32 v54, v214, v22, 1.0
    v_fma_f32 v55, v215, v23, 1.0
    v_rcp_f32 v48, v48
    v_rcp_f32 v49, v49
    v_rcp_f32 v50, v50
    v_rcp_f32 v51, v51
    v_rcp_f32 v52, v52
    v_rcp_f32 v53, v53
    v_rcp_f32 v54, v54
    v_rcp_f32 v55, v55
    v_fma_f32 v48, v48, -2.0, 1.0
    v_fma_f32 v49, v49, -2.0, 1.0
    v_fma_f32 v50, v50, -2.0, 1.0
    v_fma_f32 v51, v51, -2.0, 1.0
    v_fma_f32 v52, v52, -2.0, 1.0
    v_fma_f32 v53, v53, -2.0, 1.0
    v_fma_f32 v54, v54, -2.0, 1.0
    v_fma_f32 v55, v55, -2.0, 1.0
    v_cvt_pk_bf16_f32 v232, v48, v49
    v_cvt_pk_bf16_f32 v233, v50, v51
    v_cvt_pk_bf16_f32 v234, v52, v53
    v_cvt_pk_bf16_f32 v235, v54, v55
    ds_write_b128 v248, v[232:235] offset:2048
    v_fma_f32 v56, v216, v24, 1.0
    v_fma_f32 v57, v217, v25, 1.0
    v_fma_f32 v58, v218, v26, 1.0
    v_fma_f32 v59, v219, v27, 1.0
    v_fma_f32 v60, v220, v28, 1.0
    v_fma_f32 v61, v221, v29, 1.0
    v_fma_f32 v62, v222, v30, 1.0
    v_fma_f32 v63, v223, v31, 1.0
    ds_read_b128 v[192:195], v249 offset:40960
    ds_read_b128 v[196:199], v249 offset:40976
    ds_read_b128 v[200:203], v249 offset:41024
    ds_read_b128 v[204:207], v249 offset:41040
    ds_read_b128 v[208:211], v249 offset:41088
    ds_read_b128 v[212:215], v249 offset:41104
    ds_read_b128 v[216:219], v249 offset:41152
    ds_read_b128 v[220:223], v249 offset:41168
    v_add_u32 v249, 1024, v249
    v_rcp_f32 v56, v56
    v_rcp_f32 v57, v57
    v_rcp_f32 v58, v58
    v_rcp_f32 v59, v59
    v_rcp_f32 v60, v60
    v_rcp_f32 v61, v61
    v_rcp_f32 v62, v62
    v_rcp_f32 v63, v63
    v_fma_f32 v56, v56, -2.0, 1.0
    v_fma_f32 v57, v57, -2.0, 1.0
    v_fma_f32 v58, v58, -2.0, 1.0
    v_fma_f32 v59, v59, -2.0, 1.0
    v_fma_f32 v60, v60, -2.0, 1.0
    v_fma_f32 v61, v61, -2.0, 1.0
    v_fma_f32 v62, v62, -2.0, 1.0
    v_fma_f32 v63, v63, -2.0, 1.0
    v_cvt_pk_bf16_f32 v236, v56, v57
    v_cvt_pk_bf16_f32 v237, v58, v59
    v_cvt_pk_bf16_f32 v238, v60, v61
    v_cvt_pk_bf16_f32 v239, v62, v63
    ds_write_b128 v248, v[236:239] offset:3072
    s_waitcnt lgkmcnt(0)
    s_barrier
    v_fma_f32 v32, v192, v0, 1.0
    v_fma_f32 v33, v193, v1, 1.0
    v_fma_f32 v34, v194, v2, 1.0
    v_fma_f32 v35, v195, v3, 1.0
    v_fma_f32 v36, v196, v4, 1.0
    v_fma_f32 v37, v197, v5, 1.0
    v_fma_f32 v38, v198, v6, 1.0
    v_fma_f32 v39, v199, v7, 1.0
    v_rcp_f32 v32, v32
    v_rcp_f32 v33, v33
    v_rcp_f32 v34, v34
    v_rcp_f32 v35, v35
    v_rcp_f32 v36, v36
    v_rcp_f32 v37, v37
    v_rcp_f32 v38, v38
    v_rcp_f32 v39, v39
    v_fma_f32 v32, v32, -2.0, 1.0
    v_fma_f32 v33, v33, -2.0, 1.0
    v_fma_f32 v34, v34, -2.0, 1.0
    v_fma_f32 v35, v35, -2.0, 1.0
    v_fma_f32 v36, v36, -2.0, 1.0
    v_fma_f32 v37, v37, -2.0, 1.0
    v_fma_f32 v38, v38, -2.0, 1.0
    v_fma_f32 v39, v39, -2.0, 1.0
    v_cvt_pk_bf16_f32 v224, v32, v33
    v_cvt_pk_bf16_f32 v225, v34, v35
    v_cvt_pk_bf16_f32 v226, v36, v37
    v_cvt_pk_bf16_f32 v227, v38, v39
    ds_write_b128 v248, v[224:227] offset:16384
    v_fma_f32 v40, v200, v8, 1.0
    v_fma_f32 v41, v201, v9, 1.0
    v_fma_f32 v42, v202, v10, 1.0
    v_fma_f32 v43, v203, v11, 1.0
    v_fma_f32 v44, v204, v12, 1.0
    v_fma_f32 v45, v205, v13, 1.0
    v_fma_f32 v46, v206, v14, 1.0
    v_fma_f32 v47, v207, v15, 1.0
    v_rcp_f32 v40, v40
    v_rcp_f32 v41, v41
    v_rcp_f32 v42, v42
    v_rcp_f32 v43, v43
    v_rcp_f32 v44, v44
    v_rcp_f32 v45, v45
    v_rcp_f32 v46, v46
    v_rcp_f32 v47, v47
    v_fma_f32 v40, v40, -2.0, 1.0
    v_fma_f32 v41, v41, -2.0, 1.0
    v_fma_f32 v42, v42, -2.0, 1.0
    v_fma_f32 v43, v43, -2.0, 1.0
    v_fma_f32 v44, v44, -2.0, 1.0
    v_fma_f32 v45, v45, -2.0, 1.0
    v_fma_f32 v46, v46, -2.0, 1.0
    v_fma_f32 v47, v47, -2.0, 1.0
    v_cvt_pk_bf16_f32 v228, v40, v41
    v_cvt_pk_bf16_f32 v229, v42, v43
    v_cvt_pk_bf16_f32 v230, v44, v45
    v_cvt_pk_bf16_f32 v231, v46, v47
    ds_write_b128 v248, v[228:231] offset:17408
    v_fma_f32 v48, v208, v16, 1.0
    v_fma_f32 v49, v209, v17, 1.0
    v_fma_f32 v50, v210, v18, 1.0
    v_fma_f32 v51, v211, v19, 1.0
    v_fma_f32 v52, v212, v20, 1.0
    v_fma_f32 v53, v213, v21, 1.0
    v_fma_f32 v54, v214, v22, 1.0
    v_fma_f32 v55, v215, v23, 1.0
    v_rcp_f32 v48, v48
    v_rcp_f32 v49, v49
    v_rcp_f32 v50, v50
    v_rcp_f32 v51, v51
    v_rcp_f32 v52, v52
    v_rcp_f32 v53, v53
    v_rcp_f32 v54, v54
    v_rcp_f32 v55, v55
    v_fma_f32 v48, v48, -2.0, 1.0
    v_fma_f32 v49, v49, -2.0, 1.0
    v_fma_f32 v50, v50, -2.0, 1.0
    v_fma_f32 v51, v51, -2.0, 1.0
    v_fma_f32 v52, v52, -2.0, 1.0
    v_fma_f32 v53, v53, -2.0, 1.0
    v_fma_f32 v54, v54, -2.0, 1.0
    v_fma_f32 v55, v55, -2.0, 1.0
    v_cvt_pk_bf16_f32 v232, v48, v49
    v_cvt_pk_bf16_f32 v233, v50, v51
    v_cvt_pk_bf16_f32 v234, v52, v53
    v_cvt_pk_bf16_f32 v235, v54, v55
    ds_write_b128 v248, v[232:235] offset:18432
    v_fma_f32 v56, v216, v24, 1.0
    v_fma_f32 v57, v217, v25, 1.0
    v_fma_f32 v58, v218, v26, 1.0
    v_fma_f32 v59, v219, v27, 1.0
    v_fma_f32 v60, v220, v28, 1.0
    v_fma_f32 v61, v221, v29, 1.0
    v_fma_f32 v62, v222, v30, 1.0
    v_fma_f32 v63, v223, v31, 1.0
    ds_read_b128 v[192:195], v249 offset:40960
    ds_read_b128 v[196:199], v249 offset:40976
    ds_read_b128 v[200:203], v249 offset:41024
    ds_read_b128 v[204:207], v249 offset:41040
    ds_read_b128 v[208:211], v249 offset:41088
    ds_read_b128 v[212:215], v249 offset:41104
    ds_read_b128 v[216:219], v249 offset:41152
    ds_read_b128 v[220:223], v249 offset:41168
    v_add_u32 v249, 1024, v249
    v_rcp_f32 v56, v56
    v_rcp_f32 v57, v57
    v_rcp_f32 v58, v58
    v_rcp_f32 v59, v59
    v_rcp_f32 v60, v60
    v_rcp_f32 v61, v61
    v_rcp_f32 v62, v62
    v_rcp_f32 v63, v63
    v_fma_f32 v56, v56, -2.0, 1.0
    v_fma_f32 v57, v57, -2.0, 1.0
    v_fma_f32 v58, v58, -2.0, 1.0
    v_fma_f32 v59, v59, -2.0, 1.0
    v_fma_f32 v60, v60, -2.0, 1.0
    v_fma_f32 v61, v61, -2.0, 1.0
    v_fma_f32 v62, v62, -2.0, 1.0
    v_fma_f32 v63, v63, -2.0, 1.0
    v_cvt_pk_bf16_f32 v236, v56, v57
    v_cvt_pk_bf16_f32 v237, v58, v59
    v_cvt_pk_bf16_f32 v238, v60, v61
    v_cvt_pk_bf16_f32 v239, v62, v63
    ds_write_b128 v248, v[236:239] offset:19456
    s_waitcnt lgkmcnt(0)
    s_barrier
    s_sub_u32 s22, s22, 1
    s_cmp_lg_u32 s22, 0
    s_cbranch_scc1 L_joint_kernel_tloop1
    s_branch L_joint_kernel_fin
L_joint_kernel_tslow:
    ds_read_b128 v[192:195], v249 offset:32768
    ds_read_b128 v[196:199], v249 offset:32784
    ds_read_b128 v[200:203], v249 offset:32832
    ds_read_b128 v[204:207], v249 offset:32848
    ds_read_b128 v[208:211], v249 offset:32896
    ds_read_b128 v[212:215], v249 offset:32912
    ds_read_b128 v[216:219], v249 offset:32960
    ds_read_b128 v[220:223], v249 offset:32976
    v_add_u32 v249, 1024, v249
    s_waitcnt lgkmcnt(0)
L_joint_kernel_tloop0:
    v_add_f32 v32, v192, v0
    v_add_f32 v33, v193, v1
    v_add_f32 v34, v194, v2
    v_add_f32 v35, v195, v3
    v_add_f32 v36, v196, v4
    v_add_f32 v37, v197, v5
    v_add_f32 v38, v198, v6
    v_add_f32 v39, v199, v7
    v_exp_f32 v32, v32
    v_exp_f32 v33, v33
    v_exp_f32 v34, v34
    v_exp_f32 v35, v35
    v_exp_f32 v36, v36
    v_exp_f32 v37, v37
    v_exp_f32 v38, v38
    v_exp_f32 v39, v39
    v_add_f32 v32, 1.0, v32
    v_add_f32 v33, 1.0, v33
    v_add_f32 v34, 1.0, v34
    v_add_f32 v35, 1.0, v35
    v_add_f32 v36, 1.0, v36
    v_add_f32 v37, 1.0, v37
    v_add_f32 v38, 1.0, v38
    v_add_f32 v39, 1.0, v39
    v_rcp_f32 v32, v32
    v_rcp_f32 v33, v33
    v_rcp_f32 v34, v34
    v_rcp_f32 v35, v35
    v_rcp_f32 v36, v36
    v_rcp_f32 v37, v37
    v_rcp_f32 v38, v38
    v_rcp_f32 v39, v39
    v_fma_f32 v32, v32, -2.0, 1.0
    v_fma_f32 v33, v33, -2.0, 1.0
    v_fma_f32 v34, v34, -2.0, 1.0
    v_fma_f32 v35, v35, -2.0, 1.0
    v_fma_f32 v36, v36, -2.0, 1.0
    v_fma_f32 v37, v37, -2.0, 1.0
    v_fma_f32 v38, v38, -2.0, 1.0
    v_fma_f32 v39, v39, -2.0, 1.0
    v_cvt_pk_bf16_f32 v224, v32, v33
    v_cvt_pk_bf16_f32 v225, v34, v35
    v_cvt_pk_bf16_f32 v226, v36, v37
    v_cvt_pk_bf16_f32 v227, v38, v39
    ds_write_b128 v248, v[224:227] offset:0
    v_add_f32 v40, v200, v8
    v_add_f32 v41, v201, v9
    v_add_f32 v42, v202, v10
    v_add_f32 v43, v203, v11
    v_add_f32 v44, v204, v12
    v_add_f32 v45, v205, v13
    v_add_f32 v46, v206, v14
    v_add_f32 v47, v207, v15
    v_exp_f32 v40, v40
    v_exp_f32 v41, v41
    v_exp_f32 v42, v42
    v_exp_f32 v43, v43
    v_exp_f32 v44, v44
    v_exp_f32 v45, v45
    v_exp_f32 v46, v46
    v_exp_f32 v47, v47
    v_add_f32 v40, 1.0, v40
    v_add_f32 v41, 1.0, v41
    v_add_f32 v42, 1.0, v42
    v_add_f32 v43, 1.0, v43
    v_add_f32 v44, 1.0, v44
    v_add_f32 v45, 1.0, v45
    v_add_f32 v46, 1.0, v46
    v_add_f32 v47, 1.0, v47
    v_rcp_f32 v40, v40
    v_rcp_f32 v41, v41
    v_rcp_f32 v42, v42
    v_rcp_f32 v43, v43
    v_rcp_f32 v44, v44
    v_rcp_f32 v45, v45
    v_rcp_f32 v46, v46
    v_rcp_f32 v47, v47
    v_fma_f32 v40, v40, -2.0, 1.0
    v_fma_f32 v41, v41, -2.0, 1.0
    v_fma_f32 v42, v42, -2.0, 1.0
    v_fma_f32 v43, v43, -2.0, 1.0
    v_fma_f32 v44, v44, -2.0, 1.0
    v_fma_f32 v45, v45, -2.0, 1.0
    v_fma_f32 v46, v46, -2.0, 1.0
    v_fma_f32 v47, v47, -2.0, 1.0
    v_cvt_pk_bf16_f32 v228, v40, v41
    v_cvt_pk_bf16_f32 v229, v42, v43
    v_cvt_pk_bf16_f32 v230, v44, v45
    v_cvt_pk_bf16_f32 v231, v46, v47
    ds_write_b128 v248, v[228:231] offset:1024
    v_add_f32 v48, v208, v16
    v_add_f32 v49, v209, v17
    v_add_f32 v50, v210, v18
    v_add_f32 v51, v211, v19
    v_add_f32 v52, v212, v20
    v_add_f32 v53, v213, v21
    v_add_f32 v54, v214, v22
    v_add_f32 v55, v215, v23
    v_exp_f32 v48, v48
    v_exp_f32 v49, v49
    v_exp_f32 v50, v50
    v_exp_f32 v51, v51
    v_exp_f32 v52, v52
    v_exp_f32 v53, v53
    v_exp_f32 v54, v54
    v_exp_f32 v55, v55
    v_add_f32 v48, 1.0, v48
    v_add_f32 v49, 1.0, v49
    v_add_f32 v50, 1.0, v50
    v_add_f32 v51, 1.0, v51
    v_add_f32 v52, 1.0, v52
    v_add_f32 v53, 1.0, v53
    v_add_f32 v54, 1.0, v54
    v_add_f32 v55, 1.0, v55
    v_rcp_f32 v48, v48
    v_rcp_f32 v49, v49
    v_rcp_f32 v50, v50
    v_rcp_f32 v51, v51
    v_rcp_f32 v52, v52
    v_rcp_f32 v53, v53
    v_rcp_f32 v54, v54
    v_rcp_f32 v55, v55
    v_fma_f32 v48, v48, -2.0, 1.0
    v_fma_f32 v49, v49, -2.0, 1.0
    v_fma_f32 v50, v50, -2.0, 1.0
    v_fma_f32 v51, v51, -2.0, 1.0
    v_fma_f32 v52, v52, -2.0, 1.0
    v_fma_f32 v53, v53, -2.0, 1.0
    v_fma_f32 v54, v54, -2.0, 1.0
    v_fma_f32 v55, v55, -2.0, 1.0
    v_cvt_pk_bf16_f32 v232, v48, v49
    v_cvt_pk_bf16_f32 v233, v50, v51
    v_cvt_pk_bf16_f32 v234, v52, v53
    v_cvt_pk_bf16_f32 v235, v54, v55
    ds_write_b128 v248, v[232:235] offset:2048
    v_add_f32 v56, v216, v24
    v_add_f32 v57, v217, v25
    v_add_f32 v58, v218, v26
    v_add_f32 v59, v219, v27
    v_add_f32 v60, v220, v28
    v_add_f32 v61, v221, v29
    v_add_f32 v62, v222, v30
    v_add_f32 v63, v223, v31
    ds_read_b128 v[192:195], v249 offset:32768
    ds_read_b128 v[196:199], v249 offset:32784
    ds_read_b128 v[200:203], v249 offset:32832
    ds_read_b128 v[204:207], v249 offset:32848
    ds_read_b128 v[208:211], v249 offset:32896
    ds_read_b128 v[212:215], v249 offset:32912
    ds_read_b128 v[216:219], v249 offset:32960
    ds_read_b128 v[220:223], v249 offset:32976
    v_add_u32 v249, 1024, v249
    v_exp_f32 v56, v56
    v_exp_f32 v57, v57
    v_exp_f32 v58, v58
    v_exp_f32 v59, v59
    v_exp_f32 v60, v60
    v_exp_f32 v61, v61
    v_exp_f32 v62, v62
    v_exp_f32 v63, v63
    v_add_f32 v56, 1.0, v56
    v_add_f32 v57, 1.0, v57
    v_add_f32 v58, 1.0, v58
    v_add_f32 v59, 1.0, v59
    v_add_f32 v60, 1.0, v60
    v_add_f32 v61, 1.0, v61
    v_add_f32 v62, 1.0, v62
    v_add_f32 v63, 1.0, v63
    v_rcp_f32 v56, v56
    v_rcp_f32 v57, v57
    v_rcp_f32 v58, v58
    v_rcp_f32 v59, v59
    v_rcp_f32 v60, v60
    v_rcp_f32 v61, v61
    v_rcp_f32 v62, v62
    v_rcp_f32 v63, v63
    v_fma_f32 v56, v56, -2.0, 1.0
    v_fma_f32 v57, v57, -2.0, 1.0
    v_fma_f32 v58, v58, -2.0, 1.0
    v_fma_f32 v59, v59, -2.0, 1.0
    v_fma_f32 v60, v60, -2.0, 1.0
    v_fma_f32 v61, v61, -2.0, 1.0
    v_fma_f32 v62, v62, -2.0, 1.0
    v_fma_f32 v63, v63, -2.0, 1.0
    v_cvt_pk_bf16_f32 v236, v56, v57
    v_cvt_pk_bf16_f32 v237, v58, v59
    v_cvt_pk_bf16_f32 v238, v60, v61
    v_cvt_pk_bf16_f32 v239, v62, v63
    ds_write_b128 v248, v[236:239] offset:3072
    s_waitcnt lgkmcnt(0)
    s_barrier
    v_add_f32 v32, v192, v0
    v_add_f32 v33, v193, v1
    v_add_f32 v34, v194, v2
    v_add_f32 v35, v195, v3
    v_add_f32 v36, v196, v4
    v_add_f32 v37, v197, v5
    v_add_f32 v38, v198, v6
    v_add_f32 v39, v199, v7
    v_exp_f32 v32, v32
    v_exp_f32 v33, v33
    v_exp_f32 v34, v34
    v_exp_f32 v35, v35
    v_exp_f32 v36, v36
    v_exp_f32 v37, v37
    v_exp_f32 v38, v38
    v_exp_f32 v39, v39
    v_add_f32 v32, 1.0, v32
    v_add_f32 v33, 1.0, v33
    v_add_f32 v34, 1.0, v34
    v_add_f32 v35, 1.0, v35
    v_add_f32 v36, 1.0, v36
    v_add_f32 v37, 1.0, v37
    v_add_f32 v38, 1.0, v38
    v_add_f32 v39, 1.0, v39
    v_rcp_f32 v32, v32
    v_rcp_f32 v33, v33
    v_rcp_f32 v34, v34
    v_rcp_f32 v35, v35
    v_rcp_f32 v36, v36
    v_rcp_f32 v37, v37
    v_rcp_f32 v38, v38
    v_rcp_f32 v39, v39
    v_fma_f32 v32, v32, -2.0, 1.0
    v_fma_f32 v33, v33, -2.0, 1.0
    v_fma_f32 v34, v34, -2.0, 1.0
    v_fma_f32 v35, v35, -2.0, 1.0
    v_fma_f32 v36, v36, -2.0, 1.0
    v_fma_f32 v37, v37, -2.0, 1.0
    v_fma_f32 v38, v38, -2.0, 1.0
    v_fma_f32 v39, v39, -2.0, 1.0
    v_cvt_pk_bf16_f32 v224, v32, v33
    v_cvt_pk_bf16_f32 v225, v34, v35
    v_cvt_pk_bf16_f32 v226, v36, v37
    v_cvt_pk_bf16_f32 v227, v38, v39
    ds_write_b128 v248, v[224:227] offset:16384
    v_add_f32 v40, v200, v8
    v_add_f32 v41, v201, v9
    v_add_f32 v42, v202, v10
    v_add_f32 v43, v203, v11
    v_add_f32 v44, v204, v12
    v_add_f32 v45, v205, v13
    v_add_f32 v46, v206, v14
    v_add_f32 v47, v207, v15
    v_exp_f32 v40, v40
    v_exp_f32 v41, v41
    v_exp_f32 v42, v42
    v_exp_f32 v43, v43
    v_exp_f32 v44, v44
    v_exp_f32 v45, v45
    v_exp_f32 v46, v46
    v_exp_f32 v47, v47
    v_add_f32 v40, 1.0, v40
    v_add_f32 v41, 1.0, v41
    v_add_f32 v42, 1.0, v42
    v_add_f32 v43, 1.0, v43
    v_add_f32 v44, 1.0, v44
    v_add_f32 v45, 1.0, v45
    v_add_f32 v46, 1.0, v46
    v_add_f32 v47, 1.0, v47
    v_rcp_f32 v40, v40
    v_rcp_f32 v41, v41
    v_rcp_f32 v42, v42
    v_rcp_f32 v43, v43
    v_rcp_f32 v44, v44
    v_rcp_f32 v45, v45
    v_rcp_f32 v46, v46
    v_rcp_f32 v47, v47
    v_fma_f32 v40, v40, -2.0, 1.0
    v_fma_f32 v41, v41, -2.0, 1.0
    v_fma_f32 v42, v42, -2.0, 1.0
    v_fma_f32 v43, v43, -2.0, 1.0
    v_fma_f32 v44, v44, -2.0, 1.0
    v_fma_f32 v45, v45, -2.0, 1.0
    v_fma_f32 v46, v46, -2.0, 1.0
    v_fma_f32 v47, v47, -2.0, 1.0
    v_cvt_pk_bf16_f32 v228, v40, v41
    v_cvt_pk_bf16_f32 v229, v42, v43
    v_cvt_pk_bf16_f32 v230, v44, v45
    v_cvt_pk_bf16_f32 v231, v46, v47
    ds_write_b128 v248, v[228:231] offset:17408
    v_add_f32 v48, v208, v16
    v_add_f32 v49, v209, v17
    v_add_f32 v50, v210, v18
    v_add_f32 v51, v211, v19
    v_add_f32 v52, v212, v20
    v_add_f32 v53, v213, v21
    v_add_f32 v54, v214, v22
    v_add_f32 v55, v215, v23
    v_exp_f32 v48, v48
    v_exp_f32 v49, v49
    v_exp_f32 v50, v50
    v_exp_f32 v51, v51
    v_exp_f32 v52, v52
    v_exp_f32 v53, v53
    v_exp_f32 v54, v54
    v_exp_f32 v55, v55
    v_add_f32 v48, 1.0, v48
    v_add_f32 v49, 1.0, v49
    v_add_f32 v50, 1.0, v50
    v_add_f32 v51, 1.0, v51
    v_add_f32 v52, 1.0, v52
    v_add_f32 v53, 1.0, v53
    v_add_f32 v54, 1.0, v54
    v_add_f32 v55, 1.0, v55
    v_rcp_f32 v48, v48
    v_rcp_f32 v49, v49
    v_rcp_f32 v50, v50
    v_rcp_f32 v51, v51
    v_rcp_f32 v52, v52
    v_rcp_f32 v53, v53
    v_rcp_f32 v54, v54
    v_rcp_f32 v55, v55
    v_fma_f32 v48, v48, -2.0, 1.0
    v_fma_f32 v49, v49, -2.0, 1.0
    v_fma_f32 v50, v50, -2.0, 1.0
    v_fma_f32 v51, v51, -2.0, 1.0
    v_fma_f32 v52, v52, -2.0, 1.0
    v_fma_f32 v53, v53, -2.0, 1.0
    v_fma_f32 v54, v54, -2.0, 1.0
    v_fma_f32 v55, v55, -2.0, 1.0
    v_cvt_pk_bf16_f32 v232, v48, v49
    v_cvt_pk_bf16_f32 v233, v50, v51
    v_cvt_pk_bf16_f32 v234, v52, v53
    v_cvt_pk_bf16_f32 v235, v54, v55
    ds_write_b128 v248, v[232:235] offset:18432
    v_add_f32 v56, v216, v24
    v_add_f32 v57, v217, v25
    v_add_f32 v58, v218, v26
    v_add_f32 v59, v219, v27
    v_add_f32 v60, v220, v28
    v_add_f32 v61, v221, v29
    v_add_f32 v62, v222, v30
    v_add_f32 v63, v223, v31
    ds_read_b128 v[192:195], v249 offset:32768
    ds_read_b128 v[196:199], v249 offset:32784
    ds_read_b128 v[200:203], v249 offset:32832
    ds_read_b128 v[204:207], v249 offset:32848
    ds_read_b128 v[208:211], v249 offset:32896
    ds_read_b128 v[212:215], v249 offset:32912
    ds_read_b128 v[216:219], v249 offset:32960
    ds_read_b128 v[220:223], v249 offset:32976
    v_add_u32 v249, 1024, v249
    v_exp_f32 v56, v56
    v_exp_f32 v57, v57
    v_exp_f32 v58, v58
    v_exp_f32 v59, v59
    v_exp_f32 v60, v60
    v_exp_f32 v61, v61
    v_exp_f32 v62, v62
    v_exp_f32 v63, v63
    v_add_f32 v56, 1.0, v56
    v_add_f32 v57, 1.0, v57
    v_add_f32 v58, 1.0, v58
    v_add_f32 v59, 1.0, v59
    v_add_f32 v60, 1.0, v60
    v_add_f32 v61, 1.0, v61
    v_add_f32 v62, 1.0, v62
    v_add_f32 v63, 1.0, v63
    v_rcp_f32 v56, v56
    v_rcp_f32 v57, v57
    v_rcp_f32 v58, v58
    v_rcp_f32 v59, v59
    v_rcp_f32 v60, v60
    v_rcp_f32 v61, v61
    v_rcp_f32 v62, v62
    v_rcp_f32 v63, v63
    v_fma_f32 v56, v56, -2.0, 1.0
    v_fma_f32 v57, v57, -2.0, 1.0
    v_fma_f32 v58, v58, -2.0, 1.0
    v_fma_f32 v59, v59, -2.0, 1.0
    v_fma_f32 v60, v60, -2.0, 1.0
    v_fma_f32 v61, v61, -2.0, 1.0
    v_fma_f32 v62, v62, -2.0, 1.0
    v_fma_f32 v63, v63, -2.0, 1.0
    v_cvt_pk_bf16_f32 v236, v56, v57
    v_cvt_pk_bf16_f32 v237, v58, v59
    v_cvt_pk_bf16_f32 v238, v60, v61
    v_cvt_pk_bf16_f32 v239, v62, v63
    ds_write_b128 v248, v[236:239] offset:19456
    s_waitcnt lgkmcnt(0)
    s_barrier
    s_sub_u32 s22, s22, 1
    s_cmp_lg_u32 s22, 0
    s_cbranch_scc1 L_joint_kernel_tloop0
L_joint_kernel_fin:
L_joint_kernel_done:
    s_endpgm
.section .rodata,"a"
.p2align 6
.amdhsa_kernel prep_kernel
  .amdhsa_next_free_vgpr 128
  .amdhsa_next_free_sgpr 102
  .amdhsa_accum_offset 128
  .amdhsa_group_segment_fixed_size 0
  .amdhsa_kernarg_size 80
  .amdhsa_user_sgpr_count 2
  .amdhsa_user_sgpr_kernarg_segment_ptr 1
  .amdhsa_system_sgpr_workgroup_id_x 1
.end_amdhsa_kernel
.p2align 6
.amdhsa_kernel conv1_kernel
  .amdhsa_next_free_vgpr 128
  .amdhsa_next_free_sgpr 102
  .amdhsa_accum_offset 128
  .amdhsa_group_segment_fixed_size 0
  .amdhsa_kernarg_size 80
  .amdhsa_user_sgpr_count 2
  .amdhsa_user_sgpr_kernarg_segment_ptr 1
  .amdhsa_system_sgpr_workgroup_id_x 1
.end_amdhsa_kernel
.p2align 6
.amdhsa_kernel conv2_kernel
  .amdhsa_next_free_vgpr 128
  .amdhsa_next_free_sgpr 102
  .amdhsa_accum_offset 128
  .amdhsa_group_segment_fixed_size 0
  .amdhsa_kernarg_size 80
  .amdhsa_user_sgpr_count 2
  .amdhsa_user_sgpr_kernarg_segment_ptr 1
  .amdhsa_system_sgpr_workgroup_id_x 1
.end_amdhsa_kernel
.p2align 6
.amdhsa_kernel joint_kernel
  .amdhsa_next_free_vgpr 256
  .amdhsa_next_free_sgpr 102
  .amdhsa_accum_offset 256
  .amdhsa_group_segment_fixed_size 0
  .amdhsa_kernarg_size 80
  .amdhsa_user_sgpr_count 2
  .amdhsa_user_sgpr_kernarg_segment_ptr 1
  .amdhsa_system_sgpr_workgroup_id_x 1
.end_amdhsa_kernel
```

```asm
; @launch kernel=prep_kernel grid=(268,1,1) block=(256,1,1) lds=32768
; @launch kernel=conv1_kernel grid=(256,1,1) block=(1024,1,1) lds=162816
; @launch kernel=conv2_kernel grid=(256,1,1) block=(1024,1,1) lds=162816
; @launch kernel=joint_kernel grid=(250,1,1) block=(512,1,1) lds=97152
.amdgcn_target "amdgcn-amd-amdhsa--gfx950"
.text
.globl prep_kernel
.p2align 8
.type prep_kernel,@function
prep_kernel:
    s_cmp_ge_u32 s2, 268
    s_cbranch_scc1 L_prep_kernel_done
    s_getpc_b64 s[62:63]
L_prep_kernel_pc:
    s_and_b32 s3, s2, 8
    s_lshl_b32 s3, s3, 12
    v_lshlrev_b32 v120, 7, v0
    v_add_u32 v120, s3, v120
    v_min_u32 v120, L_joint_kernel_done-L_prep_kernel_pc, v120
    v_mov_b32 v121, s63
    v_add_co_u32 v120, vcc, s62, v120
    v_addc_co_u32 v121, vcc, 0, v121, vcc
    global_load_dword v122, v[120:121], off
    s_cmp_lt_u32 s2, 12
    s_cbranch_scc1 L_prep_kernel_small
    s_sub_u32 s2, s2, 12
    v_readfirstlane_b32 s20, v0
    s_lshr_b32 s20, s20, 6
    s_lshl_b32 s21, s2, 2
    s_add_u32 s20, s20, s21
    v_and_b32 v1, 63, v0
    s_load_dwordx2 s[8:9], s[0:1], 8
    s_load_dwordx2 s[30:31], s[0:1], 72
    s_lshr_b32 s22, s20, 8
    s_bfe_u32 s23, s20, 0x40004
    s_bfe_u32 s24, s20, 0x30001
    s_and_b32 s21, s20, 1
    v_lshrrev_b32 v2, 4, v1
    v_lshlrev_b32 v2, 12, v2
    v_and_b32 v3, 15, v1
    v_lshl_add_u32 v2, v3, 2, v2
    s_lshl_b32 s26, s22, 3
    s_lshr_b32 s27, s23, 3
    s_add_u32 s26, s26, s27
    s_lshl_b32 s26, s26, 17
    s_and_b32 s27, s23, 7
    s_lshl_b32 s27, s27, 14
    s_add_u32 s26, s26, s27
    s_lshl_b32 s27, s24, 6
    s_add_u32 s26, s26, s27
    s_mov_b32 s10, 4063232
    s_mov_b32 s11, 0x00020000
    s_add_u32 s37, s26, 262144
    s_add_u32 s38, s26, 524288
    s_add_u32 s39, s26, 786432
    s_waitcnt lgkmcnt(0)
    buffer_load_dword v16, v2, s[8:11], s26 offen offset:0
    buffer_load_dword v17, v2, s[8:11], s26 offen offset:512
    buffer_load_dword v24, v2, s[8:11], s37 offen offset:0
    buffer_load_dword v25, v2, s[8:11], s37 offen offset:512
    buffer_load_dword v32, v2, s[8:11], s38 offen offset:0
    buffer_load_dword v33, v2, s[8:11], s38 offen offset:512
    buffer_load_dword v40, v2, s[8:11], s39 offen offset:0
    buffer_load_dword v41, v2, s[8:11], s39 offen offset:512
    buffer_load_dword v18, v2, s[8:11], s26 offen offset:1024
    buffer_load_dword v19, v2, s[8:11], s26 offen offset:1536
    buffer_load_dword v26, v2, s[8:11], s37 offen offset:1024
    buffer_load_dword v27, v2, s[8:11], s37 offen offset:1536
    buffer_load_dword v34, v2, s[8:11], s38 offen offset:1024
    buffer_load_dword v35, v2, s[8:11], s38 offen offset:1536
    buffer_load_dword v42, v2, s[8:11], s39 offen offset:1024
    buffer_load_dword v43, v2, s[8:11], s39 offen offset:1536
    buffer_load_dword v20, v2, s[8:11], s26 offen offset:2048
    buffer_load_dword v21, v2, s[8:11], s26 offen offset:2560
    buffer_load_dword v28, v2, s[8:11], s37 offen offset:2048
    buffer_load_dword v29, v2, s[8:11], s37 offen offset:2560
    buffer_load_dword v36, v2, s[8:11], s38 offen offset:2048
    buffer_load_dword v37, v2, s[8:11], s38 offen offset:2560
    buffer_load_dword v44, v2, s[8:11], s39 offen offset:2048
    buffer_load_dword v45, v2, s[8:11], s39 offen offset:2560
    buffer_load_dword v22, v2, s[8:11], s26 offen offset:3072
    buffer_load_dword v23, v2, s[8:11], s26 offen offset:3584
    buffer_load_dword v30, v2, s[8:11], s37 offen offset:3072
    buffer_load_dword v31, v2, s[8:11], s37 offen offset:3584
    buffer_load_dword v38, v2, s[8:11], s38 offen offset:3072
    buffer_load_dword v39, v2, s[8:11], s38 offen offset:3584
    buffer_load_dword v46, v2, s[8:11], s39 offen offset:3072
    buffer_load_dword v47, v2, s[8:11], s39 offen offset:3584
    s_add_u32 s12, s30, 0
    s_addc_u32 s13, s31, 0
    s_mov_b32 s14, 7340032
    s_mov_b32 s15, 0x00020000
    v_lshlrev_b32 v4, 4, v1
    s_lshl_b32 s27, s24, 4
    s_add_u32 s27, s27, s23
    s_mul_i32 s27, s27, 57344
    s_lshl_b32 s28, s22, 11
    s_add_u32 s27, s27, s28
    s_lshl_b32 s28, s21, 10
    s_add_u32 s27, s27, s28
    s_cmp_eq_u32 s21, 0
    s_mov_b32 s32, 0x07060302
    s_cselect_b32 s32, 0x05040100, s32
    s_mov_b32 s33, 0x03020c0c
    s_cselect_b32 s33, 0x01000c0c, s33
    s_mov_b32 s35, 0x3d2aaaab
    s_mov_b32 s36, 0x3c638e39
    s_waitcnt vmcnt(24)
    v_perm_b32 v72, v17, v16, s32
    v_perm_b32 v48, v41, v40, s32
    v_perm_b32 v76, v76, v40, s33
    v_perm_b32 v84, v84, v41, s33
    v_perm_b32 v77, v77, v32, s33
    v_perm_b32 v85, v85, v33, s33
    v_perm_b32 v78, v78, v24, s33
    v_perm_b32 v86, v86, v25, s33
    v_perm_b32 v79, v79, v16, s33
    v_perm_b32 v87, v87, v17, s33
    v_add_f32 v80, v76, v78
    v_add_f32 v88, v84, v86
    v_add_f32 v81, v77, v79
    v_add_f32 v89, v85, v87
    v_fma_f32 v82, v78, 4.0, v76
    v_fma_f32 v90, v86, 4.0, v84
    v_fma_f32 v83, v79, 4.0, v77
    v_fma_f32 v91, v87, 4.0, v85
    v_add_f32 v77, v80, v81
    v_add_f32 v85, v88, v89
    v_sub_f32 v78, v80, v81
    v_sub_f32 v86, v88, v89
    v_fma_f32 v79, v83, 2.0, v82
    v_fma_f32 v87, v91, 2.0, v90
    v_fma_f32 v82, v83, -2.0, v82
    v_fma_f32 v90, v91, -2.0, v90
    v_fmamk_f32 v80, v76, 0x41700000, v82
    v_fmamk_f32 v88, v84, 0x41700000, v90
    v_fmamk_f32 v80, v81, 0x41200000, v80
    v_fmamk_f32 v88, v89, 0x41200000, v88
    v_mul_f32 v77, 0.5, v77
    v_mul_f32 v85, 0.5, v85
    v_mul_f32 v78, 0.5, v78
    v_mul_f32 v86, 0.5, v86
    v_mul_f32 v79, s35, v79
    v_mul_f32 v87, s35, v87
    v_mul_f32 v82, s35, v82
    v_mul_f32 v90, s35, v90
    v_mul_f32 v80, s36, v80
    v_mul_f32 v88, s36, v88
    v_cvt_pk_bf16_f32 v52, v77, v85
    v_cvt_pk_bf16_f32 v56, v78, v86
    v_cvt_pk_bf16_f32 v60, v79, v87
    v_cvt_pk_bf16_f32 v64, v82, v90
    v_cvt_pk_bf16_f32 v68, v80, v88
    s_waitcnt vmcnt(16)
    v_perm_b32 v73, v19, v18, s32
    v_perm_b32 v49, v43, v42, s32
    v_perm_b32 v76, v76, v42, s33
    v_perm_b32 v84, v84, v43, s33
    v_perm_b32 v77, v77, v34, s33
    v_perm_b32 v85, v85, v35, s33
    v_perm_b32 v78, v78, v26, s33
    v_perm_b32 v86, v86, v27, s33
    v_perm_b32 v79, v79, v18, s33
    v_perm_b32 v87, v87, v19, s33
    v_add_f32 v80, v76, v78
    v_add_f32 v88, v84, v86
    v_add_f32 v81, v77, v79
    v_add_f32 v89, v85, v87
    v_fma_f32 v82, v78, 4.0, v76
    v_fma_f32 v90, v86, 4.0, v84
    v_fma_f32 v83, v79, 4.0, v77
    v_fma_f32 v91, v87, 4.0, v85
    v_add_f32 v77, v80, v81
    v_add_f32 v85, v88, v89
    v_sub_f32 v78, v80, v81
    v_sub_f32 v86, v88, v89
    v_fma_f32 v79, v83, 2.0, v82
    v_fma_f32 v87, v91, 2.0, v90
    v_fma_f32 v82, v83, -2.0, v82
    v_fma_f32 v90, v91, -2.0, v90
    v_fmamk_f32 v80, v76, 0x41700000, v82
    v_fmamk_f32 v88, v84, 0x41700000, v90
    v_fmamk_f32 v80, v81, 0x41200000, v80
    v_fmamk_f32 v88, v89, 0x41200000, v88
    v_mul_f32 v77, 0.5, v77
    v_mul_f32 v85, 0.5, v85
    v_mul_f32 v78, 0.5, v78
    v_mul_f32 v86, 0.5, v86
    v_mul_f32 v79, s35, v79
    v_mul_f32 v87, s35, v87
    v_mul_f32 v82, s35, v82
    v_mul_f32 v90, s35, v90
    v_mul_f32 v80, s36, v80
    v_mul_f32 v88, s36, v88
    v_cvt_pk_bf16_f32 v53, v77, v85
    v_cvt_pk_bf16_f32 v57, v78, v86
    v_cvt_pk_bf16_f32 v61, v79, v87
    v_cvt_pk_bf16_f32 v65, v82, v90
    v_cvt_pk_bf16_f32 v69, v80, v88
    s_waitcnt vmcnt(8)
    v_perm_b32 v74, v21, v20, s32
    v_perm_b32 v50, v45, v44, s32
    v_perm_b32 v76, v76, v44, s33
    v_perm_b32 v84, v84, v45, s33
    v_perm_b32 v77, v77, v36, s33
    v_perm_b32 v85, v85, v37, s33
    v_perm_b32 v78, v78, v28, s33
    v_perm_b32 v86, v86, v29, s33
    v_perm_b32 v79, v79, v20, s33
    v_perm_b32 v87, v87, v21, s33
    v_add_f32 v80, v76, v78
    v_add_f32 v88, v84, v86
    v_add_f32 v81, v77, v79
    v_add_f32 v89, v85, v87
    v_fma_f32 v82, v78, 4.0, v76
    v_fma_f32 v90, v86, 4.0, v84
    v_fma_f32 v83, v79, 4.0, v77
    v_fma_f32 v91, v87, 4.0, v85
    v_add_f32 v77, v80, v81
    v_add_f32 v85, v88, v89
    v_sub_f32 v78, v80, v81
    v_sub_f32 v86, v88, v89
    v_fma_f32 v79, v83, 2.0, v82
    v_fma_f32 v87, v91, 2.0, v90
    v_fma_f32 v82, v83, -2.0, v82
    v_fma_f32 v90, v91, -2.0, v90
    v_fmamk_f32 v80, v76, 0x41700000, v82
    v_fmamk_f32 v88, v84, 0x41700000, v90
    v_fmamk_f32 v80, v81, 0x41200000, v80
    v_fmamk_f32 v88, v89, 0x41200000, v88
    v_mul_f32 v77, 0.5, v77
    v_mul_f32 v85, 0.5, v85
    v_mul_f32 v78, 0.5, v78
    v_mul_f32 v86, 0.5, v86
    v_mul_f32 v79, s35, v79
    v_mul_f32 v87, s35, v87
    v_mul_f32 v82, s35, v82
    v_mul_f32 v90, s35, v90
    v_mul_f32 v80, s36, v80
    v_mul_f32 v88, s36, v88
    v_cvt_pk_bf16_f32 v54, v77, v85
    v_cvt_pk_bf16_f32 v58, v78, v86
    v_cvt_pk_bf16_f32 v62, v79, v87
    v_cvt_pk_bf16_f32 v66, v82, v90
    v_cvt_pk_bf16_f32 v70, v80, v88
    s_waitcnt vmcnt(0)
    v_perm_b32 v75, v23, v22, s32
    v_perm_b32 v51, v47, v46, s32
    v_perm_b32 v76, v76, v46, s33
    v_perm_b32 v84, v84, v47, s33
    v_perm_b32 v77, v77, v38, s33
    v_perm_b32 v85, v85, v39, s33
    v_perm_b32 v78, v78, v30, s33
    v_perm_b32 v86, v86, v31, s33
    v_perm_b32 v79, v79, v22, s33
    v_perm_b32 v87, v87, v23, s33
    v_add_f32 v80, v76, v78
    v_add_f32 v88, v84, v86
    v_add_f32 v81, v77, v79
    v_add_f32 v89, v85, v87
    v_fma_f32 v82, v78, 4.0, v76
    v_fma_f32 v90, v86, 4.0, v84
    v_fma_f32 v83, v79, 4.0, v77
    v_fma_f32 v91, v87, 4.0, v85
    v_add_f32 v77, v80, v81
    v_add_f32 v85, v88, v89
    v_sub_f32 v78, v80, v81
    v_sub_f32 v86, v88, v89
    v_fma_f32 v79, v83, 2.0, v82
    v_fma_f32 v87, v91, 2.0, v90
    v_fma_f32 v82, v83, -2.0, v82
    v_fma_f32 v90, v91, -2.0, v90
    v_fmamk_f32 v80, v76, 0x41700000, v82
    v_fmamk_f32 v88, v84, 0x41700000, v90
    v_fmamk_f32 v80, v81, 0x41200000, v80
    v_fmamk_f32 v88, v89, 0x41200000, v88
    v_mul_f32 v77, 0.5, v77
    v_mul_f32 v85, 0.5, v85
    v_mul_f32 v78, 0.5, v78
    v_mul_f32 v86, 0.5, v86
    v_mul_f32 v79, s35, v79
    v_mul_f32 v87, s35, v87
    v_mul_f32 v82, s35, v82
    v_mul_f32 v90, s35, v90
    v_mul_f32 v80, s36, v80
    v_mul_f32 v88, s36, v88
    v_cvt_pk_bf16_f32 v55, v77, v85
    v_cvt_pk_bf16_f32 v59, v78, v86
    v_cvt_pk_bf16_f32 v63, v79, v87
    v_cvt_pk_bf16_f32 v67, v82, v90
    v_cvt_pk_bf16_f32 v71, v80, v88
    s_add_u32 s28, s27, 49152
    buffer_store_dwordx4 v[72:75], v4, s[12:15], s28 offen sc1
    s_add_u32 s28, s27, 0
    buffer_store_dwordx4 v[48:51], v4, s[12:15], s28 offen sc1
    s_add_u32 s28, s27, 8192
    buffer_store_dwordx4 v[52:55], v4, s[12:15], s28 offen sc1
    s_add_u32 s28, s27, 16384
    buffer_store_dwordx4 v[56:59], v4, s[12:15], s28 offen sc1
    s_add_u32 s28, s27, 24576
    buffer_store_dwordx4 v[60:63], v4, s[12:15], s28 offen sc1
    s_add_u32 s28, s27, 32768
    buffer_store_dwordx4 v[64:67], v4, s[12:15], s28 offen sc1
    s_add_u32 s28, s27, 40960
    buffer_store_dwordx4 v[68:71], v4, s[12:15], s28 offen sc1
L_prep_kernel_done:
    s_endpgm
L_prep_kernel_small:
    s_load_dwordx4 s[4:7], s[0:1], 24
    s_load_dwordx4 s[36:39], s[0:1], 40
    s_load_dwordx2 s[30:31], s[0:1], 72
    v_readfirstlane_b32 s20, v0
    s_lshr_b32 s20, s20, 6
    s_lshr_b32 s21, s2, 2
    s_and_b32 s22, s2, 3
    v_and_b32 v1, 63, v0
    v_lshrrev_b32 v2, 5, v1
    v_and_b32 v3, 31, v1
    v_lshlrev_b32 v5, 12, v2
    v_lshl_add_u32 v5, v3, 2, v5
    s_lshl_b32 s23, s20, 15
    s_lshl_b32 s24, s22, 7
    s_add_u32 s23, s23, s24
    s_mov_b32 s32, 0x05040100
    s_mov_b32 s33, 0x07060302
    s_waitcnt lgkmcnt(0)
    s_cmp_eq_u32 s21, 1
    s_cselect_b32 s8, s38, s6
    s_cselect_b32 s9, s39, s7
    s_cmp_eq_u32 s21, 2
    s_cselect_b32 s8, s36, s8
    s_cselect_b32 s9, s37, s9
    s_mov_b32 s10, 131072
    s_mov_b32 s11, 0x00020000
    buffer_load_dword v16, v5, s[8:11], s23 offen offset:0
    buffer_load_dword v17, v5, s[8:11], s23 offen offset:512
    buffer_load_dword v18, v5, s[8:11], s23 offen offset:1024
    buffer_load_dword v19, v5, s[8:11], s23 offen offset:1536
    buffer_load_dword v20, v5, s[8:11], s23 offen offset:2048
    buffer_load_dword v21, v5, s[8:11], s23 offen offset:2560
    buffer_load_dword v22, v5, s[8:11], s23 offen offset:3072
    buffer_load_dword v23, v5, s[8:11], s23 offen offset:3584
    s_add_u32 s23, s23, 8192
    buffer_load_dword v24, v5, s[8:11], s23 offen offset:0
    buffer_load_dword v25, v5, s[8:11], s23 offen offset:512
    buffer_load_dword v26, v5, s[8:11], s23 offen offset:1024
    buffer_load_dword v27, v5, s[8:11], s23 offen offset:1536
    buffer_load_dword v28, v5, s[8:11], s23 offen offset:2048
    buffer_load_dword v29, v5, s[8:11], s23 offen offset:2560
    buffer_load_dword v30, v5, s[8:11], s23 offen offset:3072
    buffer_load_dword v31, v5, s[8:11], s23 offen offset:3584
    s_add_u32 s23, s23, 8192
    buffer_load_dword v32, v5, s[8:11], s23 offen offset:0
    buffer_load_dword v33, v5, s[8:11], s23 offen offset:512
    buffer_load_dword v34, v5, s[8:11], s23 offen offset:1024
    buffer_load_dword v35, v5, s[8:11], s23 offen offset:1536
    buffer_load_dword v36, v5, s[8:11], s23 offen offset:2048
    buffer_load_dword v37, v5, s[8:11], s23 offen offset:2560
    buffer_load_dword v38, v5, s[8:11], s23 offen offset:3072
    buffer_load_dword v39, v5, s[8:11], s23 offen offset:3584
    s_add_u32 s23, s23, 8192
    buffer_load_dword v40, v5, s[8:11], s23 offen offset:0
    buffer_load_dword v41, v5, s[8:11], s23 offen offset:512
    buffer_load_dword v42, v5, s[8:11], s23 offen offset:1024
    buffer_load_dword v43, v5, s[8:11], s23 offen offset:1536
    buffer_load_dword v44, v5, s[8:11], s23 offen offset:2048
    buffer_load_dword v45, v5, s[8:11], s23 offen offset:2560
    buffer_load_dword v46, v5, s[8:11], s23 offen offset:3072
    buffer_load_dword v47, v5, s[8:11], s23 offen offset:3584
    s_mov_b32 s16, s4
    s_mov_b32 s17, s5
    s_mov_b32 s18, 8192
    s_mov_b32 s19, 0x00020000
    v_lshlrev_b32 v6, 9, v3
    v_lshl_add_u32 v6, v2, 4, v6
    s_lshl_b32 s24, s20, 7
    buffer_load_dwordx4 v[80:83], v6, s[16:19], s24 offen offset:0
    buffer_load_dwordx4 v[84:87], v6, s[16:19], s24 offen offset:32
    buffer_load_dwordx4 v[88:91], v6, s[16:19], s24 offen offset:64
    buffer_load_dwordx4 v[92:95], v6, s[16:19], s24 offen offset:96
    s_lshl_b32 s24, s21, 17
    s_add_u32 s24, s24, 44040192
    s_add_u32 s12, s30, s24
    s_addc_u32 s13, s31, 0
    s_mov_b32 s14, 131072
    s_mov_b32 s15, 0x00020000
    s_waitcnt vmcnt(0)
    v_perm_b32 v48, v17, v16, s32
    v_perm_b32 v49, v19, v18, s32
    v_perm_b32 v50, v21, v20, s32
    v_perm_b32 v51, v23, v22, s32
    v_perm_b32 v52, v17, v16, s33
    v_perm_b32 v53, v19, v18, s33
    v_perm_b32 v54, v21, v20, s33
    v_perm_b32 v55, v23, v22, s33
    v_perm_b32 v56, v25, v24, s32
    v_perm_b32 v57, v27, v26, s32
    v_perm_b32 v58, v29, v28, s32
    v_perm_b32 v59, v31, v30, s32
    v_perm_b32 v60, v25, v24, s33
    v_perm_b32 v61, v27, v26, s33
    v_perm_b32 v62, v29, v28, s33
    v_perm_b32 v63, v31, v30, s33
    v_perm_b32 v64, v33, v32, s32
    v_perm_b32 v65, v35, v34, s32
    v_perm_b32 v66, v37, v36, s32
    v_perm_b32 v67, v39, v38, s32
    v_perm_b32 v68, v33, v32, s33
    v_perm_b32 v69, v35, v34, s33
    v_perm_b32 v70, v37, v36, s33
    v_perm_b32 v71, v39, v38, s33
    v_perm_b32 v72, v41, v40, s32
    v_perm_b32 v73, v43, v42, s32
    v_perm_b32 v74, v45, v44, s32
    v_perm_b32 v75, v47, v46, s32
    v_perm_b32 v76, v41, v40, s33
    v_perm_b32 v77, v43, v42, s33
    v_perm_b32 v78, v45, v44, s33
    v_perm_b32 v79, v47, v46, s33
    s_cmp_eq_u32 s21, 2
    s_cbranch_scc1 L_prep_kernel_ge
    v_lshlrev_b32 v4, 4, v1
    s_lshl_b32 s24, s22, 15
    s_lshl_b32 s25, s20, 13
    s_add_u32 s24, s24, s25
    s_add_u32 s25, s24, 4096
    buffer_store_dwordx4 v[48:51], v4, s[12:15], s24 offen offset:0
    buffer_store_dwordx4 v[52:55], v4, s[12:15], s24 offen offset:1024
    buffer_store_dwordx4 v[56:59], v4, s[12:15], s24 offen offset:2048
    buffer_store_dwordx4 v[60:63], v4, s[12:15], s24 offen offset:3072
    buffer_store_dwordx4 v[64:67], v4, s[12:15], s25 offen offset:0
    buffer_store_dwordx4 v[68:71], v4, s[12:15], s25 offen offset:1024
    buffer_store_dwordx4 v[72:75], v4, s[12:15], s25 offen offset:2048
    buffer_store_dwordx4 v[76:79], v4, s[12:15], s25 offen offset:3072
    s_endpgm
L_prep_kernel_ge:
    v_mfma_f32_32x32x16_bf16 v[96:111], v[48:51], v[80:83], 0
    v_mfma_f32_32x32x16_bf16 v[112:127], v[52:55], v[80:83], 0
    v_mfma_f32_32x32x16_bf16 v[96:111], v[56:59], v[84:87], v[96:111]
    v_mfma_f32_32x32x16_bf16 v[112:127], v[60:63], v[84:87], v[112:127]
    v_mfma_f32_32x32x16_bf16 v[96:111], v[64:67], v[88:91], v[96:111]
    v_mfma_f32_32x32x16_bf16 v[112:127], v[68:71], v[88:91], v[112:127]
    v_mfma_f32_32x32x16_bf16 v[96:111], v[72:75], v[92:95], v[96:111]
    v_mfma_f32_32x32x16_bf16 v[112:127], v[76:79], v[92:95], v[112:127]
    v_lshlrev_b32 v4, 4, v1
    s_lshl_b32 s24, s20, 13
    v_add_u32 v7, s24, v4
    s_nop 15
    ds_write_b128 v7, v[96:99] offset:0
    ds_write_b128 v7, v[100:103] offset:1024
    ds_write_b128 v7, v[104:107] offset:2048
    ds_write_b128 v7, v[108:111] offset:3072
    ds_write_b128 v7, v[112:115] offset:4096
    ds_write_b128 v7, v[116:119] offset:5120
    ds_write_b128 v7, v[120:123] offset:6144
    ds_write_b128 v7, v[124:127] offset:7168
    s_waitcnt lgkmcnt(0)
    s_barrier
    s_lshl_b32 s24, s20, 10
    v_add_u32 v7, s24, v4
    ds_read_b128 v[16:19], v7 offset:0
    ds_read_b128 v[20:23], v7 offset:4096
    ds_read_b128 v[24:27], v7 offset:8192
    ds_read_b128 v[28:31], v7 offset:12288
    ds_read_b128 v[32:35], v7 offset:16384
    ds_read_b128 v[36:39], v7 offset:20480
    ds_read_b128 v[40:43], v7 offset:24576
    ds_read_b128 v[44:47], v7 offset:28672
    s_mov_b32 s14, 16384
    v_lshlrev_b32 v8, 10, v3
    v_lshl_add_u32 v8, v2, 5, v8
    s_lshl_b32 s24, s22, 8
    s_lshl_b32 s25, s20, 6
    s_add_u32 s24, s24, s25
    s_mov_b32 s34, 0xffff0000
    s_mov_b32 s35, 0x4038aa3b
    s_waitcnt lgkmcnt(0)
    v_add_f32 v16, v16, v24
    v_add_f32 v16, v16, v32
    v_add_f32 v16, v16, v40
    v_add_f32 v17, v17, v25
    v_add_f32 v17, v17, v33
    v_add_f32 v17, v17, v41
    v_add_f32 v18, v18, v26
    v_add_f32 v18, v18, v34
    v_add_f32 v18, v18, v42
    v_add_f32 v19, v19, v27
    v_add_f32 v19, v19, v35
    v_add_f32 v19, v19, v43
    v_add_f32 v20, v20, v28
    v_add_f32 v20, v20, v36
    v_add_f32 v20, v20, v44
    v_add_f32 v21, v21, v29
    v_add_f32 v21, v21, v37
    v_add_f32 v21, v21, v45
    v_add_f32 v22, v22, v30
    v_add_f32 v22, v22, v38
    v_add_f32 v22, v22, v46
    v_add_f32 v23, v23, v31
    v_add_f32 v23, v23, v39
    v_add_f32 v23, v23, v47
    v_cvt_pk_bf16_f32 v48, v16, v20
    v_cvt_pk_bf16_f32 v49, v17, v21
    v_cvt_pk_bf16_f32 v50, v18, v22
    v_cvt_pk_bf16_f32 v51, v19, v23
    v_lshlrev_b32 v56, 16, v48
    v_and_b32 v57, s34, v48
    v_lshlrev_b32 v58, 16, v49
    v_and_b32 v59, s34, v49
    v_lshlrev_b32 v60, 16, v50
    v_and_b32 v61, s34, v50
    v_lshlrev_b32 v62, 16, v51
    v_and_b32 v63, s34, v51
    v_mul_f32 v56, s35, v56
    v_mul_f32 v57, s35, v57
    v_mul_f32 v58, s35, v58
    v_mul_f32 v59, s35, v59
    v_mul_f32 v60, s35, v60
    v_mul_f32 v61, s35, v61
    v_mul_f32 v62, s35, v62
    v_mul_f32 v63, s35, v63
    buffer_store_dwordx4 v[56:59], v8, s[12:15], s24 offen
    buffer_store_dwordx4 v[60:63], v8, s[12:15], s24 offen offset:16
    v_exp_f32 v64, v56
    v_exp_f32 v65, v57
    v_exp_f32 v66, v58
    v_exp_f32 v67, v59
    v_exp_f32 v68, v60
    v_exp_f32 v69, v61
    v_exp_f32 v70, v62
    v_exp_f32 v71, v63
    v_max3_f32 v72, |v56|, |v57|, |v58|
    v_max3_f32 v72, |v59|, |v60|, v72
    v_max3_f32 v72, |v61|, |v62|, v72
    v_max_f32 v72, |v63|, v72
    s_add_u32 s12, s12, 16384
    s_addc_u32 s13, s13, 0
    v_cmp_lt_f32 vcc, 0x42f00000, v72
    buffer_store_dwordx4 v[64:67], v8, s[12:15], s24 offen
    buffer_store_dwordx4 v[68:71], v8, s[12:15], s24 offen offset:16
    s_add_u32 s12, s12, 16384
    s_addc_u32 s13, s13, 0
    s_or_b32 s26, vcc_lo, vcc_hi
    s_lshr_b32 s24, s24, 4
    v_mov_b32 v73, s26
    v_mov_b32 v74, 0
    buffer_store_dword v73, v74, s[12:15], s24 offen
    s_endpgm
.globl conv1_kernel
.p2align 8
.type conv1_kernel,@function
conv1_kernel:
    s_cmp_ge_u32 s2, 256
    s_cbranch_scc1 L_conv1_kernel_done
    s_load_dwordx2 s[4:5], s[0:1], 0
    s_load_dwordx2 s[30:31], s[0:1], 72
    v_readfirstlane_b32 s20, v0
    s_lshr_b32 s20, s20, 6
    s_and_b32 s36, s2, 0
    s_lshl_b32 s36, s36, 3
    s_bfe_u32 s37, s2, 196611
    s_or_b32 s29, s36, s37
    s_bfe_u32 s36, s2, 196608
    s_lshl_b32 s36, s36, 2
    s_lshr_b32 s37, s2, 6
    s_or_b32 s36, s36, s37
    s_mov_b32 s33, 0
    s_and_b32 s34, s36, 15
    s_lshr_b32 s35, s36, 4
    s_mul_i32 s21, s34, 500
    s_and_b32 s32, s20, 3
    v_and_b32 v127, 63, v0
    v_lshrrev_b32 v5, 2, v127
    v_and_b32 v6, 3, v127
    v_lshlrev_b32 v7, 15, v5
    v_lshl_add_u32 v7, v6, 4, v7
    s_lshl_b32 s41, s21, 10
    s_lshl_b32 s37, s33, 9
    s_add_u32 s41, s41, s37
    s_sub_u32 s41, s41, 7680
    s_and_b32 s42, s20, 7
    s_lshl_b32 s37, s42, 12
    s_add_u32 s37, s37, s41
    v_add_u32 v7, s37, v7
    s_mul_i32 s36, s35, 8192000
    s_mov_b32 s10, 8192000
    s_mov_b32 s11, 0x00020000
    s_mov_b32 s25, 0xffff0000
    s_waitcnt lgkmcnt(0)
    s_add_u32 s8, s4, s36
    s_addc_u32 s9, s5, 0
    s_cmp_ge_u32 s20, 8
    s_cbranch_scc1 L_conv1_kernel_helper
    s_add_u32 s37, s41, 524288
    v_lshl_add_u32 v108, v127, 4, s37
    s_lshl_b32 s36, s29, 4
    s_lshl_b32 s37, s33, 3
    s_add_u32 s36, s36, s37
    s_mul_i32 s36, s36, 57344
    s_add_u32 s36, s36, 0
    s_add_u32 s12, s30, s36
    s_addc_u32 s13, s31, 0
    s_mov_b32 s14, 917504
    s_mov_b32 s15, 0x00020000
    s_mul_i32 s36, s35, 4096000
    s_add_u32 s36, s36, 18874368
    s_add_u32 s16, s30, s36
    s_addc_u32 s17, s31, 0
    s_mov_b32 s18, 4096000
    s_mov_b32 s19, 0x00020000
    v_and_b32 v10, 15, v127
    v_lshrrev_b32 v11, 4, v127
    v_add_u32 v8, 0, v10
    v_and_b32 v16, 4, v8
    v_lshrrev_b32 v16, 1, v16
    v_xor_b32 v16, v11, v16
    v_lshlrev_b32 v16, 4, v16
    v_lshl_add_u32 v8, v8, 6, v16
    v_add_u32 v9, 1, v10
    v_and_b32 v16, 4, v9
    v_lshrrev_b32 v16, 1, v16
    v_xor_b32 v16, v11, v16
    v_lshlrev_b32 v16, 4, v16
    v_lshl_add_u32 v9, v9, 6, v16
    s_lshr_b32 s38, s32, 1
    s_and_b32 s39, s32, 1
    s_add_u32 s40, s38, 4
    s_lshl_b32 s43, s39, 10
    s_cmp_lt_u32 s20, 4
    s_cselect_b32 s40, s20, s40
    s_cselect_b32 s36, 0, s43
    s_lshl_b32 s37, s40, 13
    s_add_u32 s37, s37, s36
    v_lshl_add_u32 v125, v127, 4, s37
    s_mul_i32 s37, s40, 16384
    v_add_u32 v120, s37, v8
    v_add_u32 v121, s37, v9
    s_lshl_b32 s37, s40, 10
    s_add_u32 s37, s37, 115712
    v_lshl_add_u32 v16, v11, 4, s37
    v_cmp_eq_u32 vcc, 15, v10
    v_mov_b32 v17, 8192
    v_mov_b32 v18, 4294959104
    v_mov_b32 v19, 64
    v_cndmask_b32 v122, v121, v16, vcc
    v_cndmask_b32 v123, v17, v19, vcc
    v_cndmask_b32 v124, v18, v19, vcc
    v_lshl_add_u32 v126, v127, 4, s37
    s_mov_b32 s44, 0x3f800000
    s_mov_b32 s45, 0x00000000
    s_mov_b32 s46, 0x00000000
    s_cmp_eq_u32 s40, 1
    s_cselect_b32 s45, 0x3f800000, s45
    s_cselect_b32 s46, 0x3f800000, s46
    s_cmp_eq_u32 s40, 2
    s_cselect_b32 s45, 0xbf800000, s45
    s_cselect_b32 s46, 0x3f800000, s46
    s_cmp_eq_u32 s40, 3
    s_cselect_b32 s45, 0x40000000, s45
    s_cselect_b32 s46, 0x40800000, s46
    s_cmp_eq_u32 s40, 4
    s_cselect_b32 s45, 0xc0000000, s45
    s_cselect_b32 s46, 0x40800000, s46
    s_cmp_eq_u32 s40, 5
    s_cselect_b32 s44, 0x41800000, s44
    s_cselect_b32 s45, 0x41000000, s45
    s_cselect_b32 s46, 0x40800000, s46
    s_cmp_ge_u32 s20, 4
    s_cbranch_scc1 L_conv1_kernel_m2
    v_mov_b32 v0, 0
    v_mov_b32 v1, 0
    v_mov_b32 v2, 0
    v_mov_b32 v3, 0
    v_mov_b32 v4, 0
    v_mov_b32 v5, 0
    v_mov_b32 v6, 0
    v_mov_b32 v7, 0
    v_mov_b32 v8, 0
    v_mov_b32 v9, 0
    v_mov_b32 v10, 0
    v_mov_b32 v11, 0
    v_mov_b32 v12, 0
    v_mov_b32 v13, 0
    v_mov_b32 v14, 0
    v_mov_b32 v15, 0
    v_mov_b32 v16, 0
    v_mov_b32 v17, 0
    v_mov_b32 v18, 0
    v_mov_b32 v19, 0
    v_mov_b32 v20, 0
    v_mov_b32 v21, 0
    v_mov_b32 v22, 0
    v_mov_b32 v23, 0
    v_mov_b32 v24, 0
    v_mov_b32 v25, 0
    v_mov_b32 v26, 0
    v_mov_b32 v27, 0
    v_mov_b32 v28, 0
    v_mov_b32 v29, 0
    v_mov_b32 v30, 0
    v_mov_b32 v31, 0
    v_mov_b32 v32, 0
    v_mov_b32 v33, 0
    v_mov_b32 v34, 0
    v_mov_b32 v35, 0
    v_mov_b32 v36, 0
    v_mov_b32 v37, 0
    v_mov_b32 v38, 0
    v_mov_b32 v39, 0
    v_mov_b32 v40, 0
    v_mov_b32 v41, 0
    v_mov_b32 v42, 0
    v_mov_b32 v43, 0
    v_mov_b32 v44, 0
    v_mov_b32 v45, 0
    v_mov_b32 v46, 0
    v_mov_b32 v47, 0
    v_mov_b32 v48, 0
    v_mov_b32 v49, 0
    v_mov_b32 v50, 0
    v_mov_b32 v51, 0
    v_mov_b32 v52, 0
    v_mov_b32 v53, 0
    v_mov_b32 v54, 0
    v_mov_b32 v55, 0
    v_mov_b32 v56, 0
    v_mov_b32 v57, 0
    v_mov_b32 v58, 0
    v_mov_b32 v59, 0
    v_mov_b32 v60, 0
    v_mov_b32 v61, 0
    v_mov_b32 v62, 0
    v_mov_b32 v63, 0
    s_barrier
    buffer_load_dwordx4 v[96:99], v108, s[8:11], 0 offen offset:0
    buffer_load_dwordx4 v[100:103], v108, s[8:11], 0 offen offset:1024
    buffer_load_dwordx4 v[104:107], v108, s[8:11], 0 offen offset:2048
    s_mov_b32 s23, 0
    s_mov_b32 s26, 4096
    buffer_load_dwordx4 v[64:67], v125, s[12:15], s23 offen offset:0
    buffer_load_dwordx4 v[68:71], v125, s[12:15], s23 offen offset:1024
    buffer_load_dwordx4 v[72:75], v125, s[12:15], s23 offen offset:2048
    buffer_load_dwordx4 v[76:79], v125, s[12:15], s23 offen offset:3072
    buffer_load_dwordx4 v[80:83], v125, s[12:15], s26 offen offset:0
    buffer_load_dwordx4 v[84:87], v125, s[12:15], s26 offen offset:1024
    buffer_load_dwordx4 v[88:91], v125, s[12:15], s26 offen offset:2048
    buffer_load_dwordx4 v[92:95], v125, s[12:15], s26 offen offset:3072
    s_mov_b32 s23, 57344
    s_mov_b32 s26, 61440
    s_waitcnt vmcnt(8)
    v_lshlrev_b32 v108, 16, v96
    v_and_b32 v111, s25, v96
    v_lshlrev_b32 v109, 16, v100
    v_and_b32 v112, s25, v100
    v_lshlrev_b32 v110, 16, v104
    v_and_b32 v113, s25, v104
    v_mul_f32 v114, s44, v108
    v_mul_f32 v115, s44, v111
    v_fmac_f32 v114, s45, v109
    v_fmac_f32 v115, s45, v112
    v_fmac_f32 v114, s46, v110
    v_fmac_f32 v115, s46, v113
    v_cvt_pk_bf16_f32 v96, v114, v115
    v_lshlrev_b32 v108, 16, v97
    v_and_b32 v111, s25, v97
    v_lshlrev_b32 v109, 16, v101
    v_and_b32 v112, s25, v101
    v_lshlrev_b32 v110, 16, v105
    v_and_b32 v113, s25, v105
    v_mul_f32 v114, s44, v108
    v_mul_f32 v115, s44, v111
    v_fmac_f32 v114, s45, v109
    v_fmac_f32 v115, s45, v112
    v_fmac_f32 v114, s46, v110
    v_fmac_f32 v115, s46, v113
    v_cvt_pk_bf16_f32 v97, v114, v115
    v_lshlrev_b32 v108, 16, v98
    v_and_b32 v111, s25, v98
    v_lshlrev_b32 v109, 16, v102
    v_and_b32 v112, s25, v102
    v_lshlrev_b32 v110, 16, v106
    v_and_b32 v113, s25, v106
    v_mul_f32 v114, s44, v108
    v_mul_f32 v115, s44, v111
    v_fmac_f32 v114, s45, v109
    v_fmac_f32 v115, s45, v112
    v_fmac_f32 v114, s46, v110
    v_fmac_f32 v115, s46, v113
    v_cvt_pk_bf16_f32 v98, v114, v115
    v_lshlrev_b32 v108, 16, v99
    v_and_b32 v111, s25, v99
    v_lshlrev_b32 v109, 16, v103
    v_and_b32 v112, s25, v103
    v_lshlrev_b32 v110, 16, v107
    v_and_b32 v113, s25, v107
    v_mul_f32 v114, s44, v108
    v_mul_f32 v115, s44, v111
    v_fmac_f32 v114, s45, v109
    v_fmac_f32 v115, s45, v112
    v_fmac_f32 v114, s46, v110
    v_fmac_f32 v115, s46, v113
    v_cvt_pk_bf16_f32 v99, v114, v115
    ds_write_b128 v126, v[96:99]
    s_waitcnt lgkmcnt(0)
    s_barrier
    s_mov_b32 s22, 8
    s_setprio 2
L_conv1_kernel_mloop1:
    ds_read_b128 v[96:99], v120 offset:0
    ds_read_b128 v[100:103], v120 offset:1024
    ds_read_b128 v[104:107], v120 offset:2048
    ds_read_b128 v[108:111], v120 offset:3072
    ds_read_b128 v[112:115], v120 offset:4096
    ds_read_b128 v[116:119], v120 offset:5120
    s_waitcnt vmcnt(6) lgkmcnt(5)
    v_mfma_f32_16x16x32_bf16 v[0:3], v[64:67], v[96:99], v[0:3]
    v_mfma_f32_16x16x32_bf16 v[32:35], v[68:71], v[96:99], v[32:35]
    ds_read_b128 v[96:99], v120 offset:6144
    s_waitcnt vmcnt(4) lgkmcnt(5)
    v_mfma_f32_16x16x32_bf16 v[4:7], v[64:67], v[100:103], v[4:7]
    v_mfma_f32_16x16x32_bf16 v[36:39], v[68:71], v[100:103], v[36:39]
    v_mfma_f32_16x16x32_bf16 v[0:3], v[72:75], v[100:103], v[0:3]
    v_mfma_f32_16x16x32_bf16 v[32:35], v[76:79], v[100:103], v[32:35]
    ds_read_b128 v[100:103], v120 offset:7168
    s_waitcnt vmcnt(2) lgkmcnt(5)
    v_mfma_f32_16x16x32_bf16 v[8:11], v[64:67], v[104:107], v[8:11]
    v_mfma_f32_16x16x32_bf16 v[40:43], v[68:71], v[104:107], v[40:43]
    v_mfma_f32_16x16x32_bf16 v[4:7], v[72:75], v[104:107], v[4:7]
    v_mfma_f32_16x16x32_bf16 v[36:39], v[76:79], v[104:107], v[36:39]
    v_mfma_f32_16x16x32_bf16 v[0:3], v[80:83], v[104:107], v[0:3]
    v_mfma_f32_16x16x32_bf16 v[32:35], v[84:87], v[104:107], v[32:35]
    ds_read_b128 v[104:107], v122 offset:0
    v_add_u32 v122, v123, v122
    s_waitcnt vmcnt(0) lgkmcnt(5)
    v_mfma_f32_16x16x32_bf16 v[12:15], v[64:67], v[108:111], v[12:15]
    v_mfma_f32_16x16x32_bf16 v[44:47], v[68:71], v[108:111], v[44:47]
    v_mfma_f32_16x16x32_bf16 v[8:11], v[72:75], v[108:111], v[8:11]
    v_mfma_f32_16x16x32_bf16 v[40:43], v[76:79], v[108:111], v[40:43]
    v_mfma_f32_16x16x32_bf16 v[4:7], v[80:83], v[108:111], v[4:7]
    v_mfma_f32_16x16x32_bf16 v[36:39], v[84:87], v[108:111], v[36:39]
    v_mfma_f32_16x16x32_bf16 v[0:3], v[88:91], v[108:111], v[0:3]
    v_mfma_f32_16x16x32_bf16 v[32:35], v[92:95], v[108:111], v[32:35]
    ds_read_b128 v[108:111], v121 offset:1024
    s_waitcnt lgkmcnt(5)
    v_mfma_f32_16x16x32_bf16 v[16:19], v[64:67], v[112:115], v[16:19]
    v_mfma_f32_16x16x32_bf16 v[48:51], v[68:71], v[112:115], v[48:51]
    v_mfma_f32_16x16x32_bf16 v[12:15], v[72:75], v[112:115], v[12:15]
    v_mfma_f32_16x16x32_bf16 v[44:47], v[76:79], v[112:115], v[44:47]
    v_mfma_f32_16x16x32_bf16 v[8:11], v[80:83], v[112:115], v[8:11]
    v_mfma_f32_16x16x32_bf16 v[40:43], v[84:87], v[112:115], v[40:43]
    v_mfma_f32_16x16x32_bf16 v[4:7], v[88:91], v[112:115], v[4:7]
    v_mfma_f32_16x16x32_bf16 v[36:39], v[92:95], v[112:115], v[36:39]
    ds_read_b128 v[112:115], v121 offset:2048
    s_waitcnt lgkmcnt(5)
    v_mfma_f32_16x16x32_bf16 v[20:23], v[64:67], v[116:119], v[20:23]
    v_mfma_f32_16x16x32_bf16 v[52:55], v[68:71], v[116:119], v[52:55]
    v_mfma_f32_16x16x32_bf16 v[16:19], v[72:75], v[116:119], v[16:19]
    v_mfma_f32_16x16x32_bf16 v[48:51], v[76:79], v[116:119], v[48:51]
    v_mfma_f32_16x16x32_bf16 v[12:15], v[80:83], v[116:119], v[12:15]
    v_mfma_f32_16x16x32_bf16 v[44:47], v[84:87], v[116:119], v[44:47]
    v_mfma_f32_16x16x32_bf16 v[8:11], v[88:91], v[116:119], v[8:11]
    v_mfma_f32_16x16x32_bf16 v[40:43], v[92:95], v[116:119], v[40:43]
    s_waitcnt lgkmcnt(4)
    v_mfma_f32_16x16x32_bf16 v[24:27], v[64:67], v[96:99], v[24:27]
    v_mfma_f32_16x16x32_bf16 v[56:59], v[68:71], v[96:99], v[56:59]
    v_mfma_f32_16x16x32_bf16 v[20:23], v[72:75], v[96:99], v[20:23]
    v_mfma_f32_16x16x32_bf16 v[52:55], v[76:79], v[96:99], v[52:55]
    v_mfma_f32_16x16x32_bf16 v[16:19], v[80:83], v[96:99], v[16:19]
    v_mfma_f32_16x16x32_bf16 v[48:51], v[84:87], v[96:99], v[48:51]
    v_mfma_f32_16x16x32_bf16 v[12:15], v[88:91], v[96:99], v[12:15]
    v_mfma_f32_16x16x32_bf16 v[44:47], v[92:95], v[96:99], v[44:47]
    s_waitcnt lgkmcnt(3)
    v_mfma_f32_16x16x32_bf16 v[28:31], v[64:67], v[100:103], v[28:31]
    v_mfma_f32_16x16x32_bf16 v[60:63], v[68:71], v[100:103], v[60:63]
    v_mfma_f32_16x16x32_bf16 v[24:27], v[72:75], v[100:103], v[24:27]
    v_mfma_f32_16x16x32_bf16 v[56:59], v[76:79], v[100:103], v[56:59]
    v_mfma_f32_16x16x32_bf16 v[20:23], v[80:83], v[100:103], v[20:23]
    v_mfma_f32_16x16x32_bf16 v[52:55], v[84:87], v[100:103], v[52:55]
    v_mfma_f32_16x16x32_bf16 v[16:19], v[88:91], v[100:103], v[16:19]
    v_mfma_f32_16x16x32_bf16 v[48:51], v[92:95], v[100:103], v[48:51]
    buffer_load_dwordx4 v[64:67], v125, s[12:15], s23 offen offset:0
    buffer_load_dwordx4 v[68:71], v125, s[12:15], s23 offen offset:1024
    s_waitcnt lgkmcnt(2)
    v_mfma_f32_16x16x32_bf16 v[28:31], v[72:75], v[104:107], v[28:31]
    v_mfma_f32_16x16x32_bf16 v[60:63], v[76:79], v[104:107], v[60:63]
    v_mfma_f32_16x16x32_bf16 v[24:27], v[80:83], v[104:107], v[24:27]
    v_mfma_f32_16x16x32_bf16 v[56:59], v[84:87], v[104:107], v[56:59]
    v_mfma_f32_16x16x32_bf16 v[20:23], v[88:91], v[104:107], v[20:23]
    v_mfma_f32_16x16x32_bf16 v[52:55], v[92:95], v[104:107], v[52:55]
    buffer_load_dwordx4 v[72:75], v125, s[12:15], s23 offen offset:2048
    buffer_load_dwordx4 v[76:79], v125, s[12:15], s23 offen offset:3072
    s_waitcnt lgkmcnt(1)
    v_mfma_f32_16x16x32_bf16 v[28:31], v[80:83], v[108:111], v[28:31]
    v_mfma_f32_16x16x32_bf16 v[60:63], v[84:87], v[108:111], v[60:63]
    v_mfma_f32_16x16x32_bf16 v[24:27], v[88:91], v[108:111], v[24:27]
    v_mfma_f32_16x16x32_bf16 v[56:59], v[92:95], v[108:111], v[56:59]
    buffer_load_dwordx4 v[80:83], v125, s[12:15], s26 offen offset:0
    buffer_load_dwordx4 v[84:87], v125, s[12:15], s26 offen offset:1024
    s_waitcnt lgkmcnt(0)
    v_mfma_f32_16x16x32_bf16 v[28:31], v[88:91], v[112:115], v[28:31]
    v_mfma_f32_16x16x32_bf16 v[60:63], v[92:95], v[112:115], v[60:63]
    buffer_load_dwordx4 v[88:91], v125, s[12:15], s26 offen offset:2048
    buffer_load_dwordx4 v[92:95], v125, s[12:15], s26 offen offset:3072
    s_add_u32 s23, s23, 57344
    s_add_u32 s26, s26, 57344
    s_barrier
    s_sub_u32 s22, s22, 1
    s_cmp_eq_u32 s22, 0
    s_cbranch_scc1 L_conv1_kernel_mlast1
    ds_read_b128 v[96:99], v120 offset:8192
    ds_read_b128 v[100:103], v120 offset:9216
    ds_read_b128 v[104:107], v120 offset:10240
    ds_read_b128 v[108:111], v120 offset:11264
    ds_read_b128 v[112:115], v120 offset:12288
    ds_read_b128 v[116:119], v120 offset:13312
    s_waitcnt vmcnt(6) lgkmcnt(5)
    v_mfma_f32_16x16x32_bf16 v[0:3], v[64:67], v[96:99], v[0:3]
    v_mfma_f32_16x16x32_bf16 v[32:35], v[68:71], v[96:99], v[32:35]
    ds_read_b128 v[96:99], v120 offset:14336
    s_waitcnt vmcnt(4) lgkmcnt(5)
    v_mfma_f32_16x16x32_bf16 v[4:7], v[64:67], v[100:103], v[4:7]
    v_mfma_f32_16x16x32_bf16 v[36:39], v[68:71], v[100:103], v[36:39]
    v_mfma_f32_16x16x32_bf16 v[0:3], v[72:75], v[100:103], v[0:3]
    v_mfma_f32_16x16x32_bf16 v[32:35], v[76:79], v[100:103], v[32:35]
    ds_read_b128 v[100:103], v120 offset:15360
    s_waitcnt vmcnt(2) lgkmcnt(5)
    v_mfma_f32_16x16x32_bf16 v[8:11], v[64:67], v[104:107], v[8:11]
    v_mfma_f32_16x16x32_bf16 v[40:43], v[68:71], v[104:107], v[40:43]
    v_mfma_f32_16x16x32_bf16 v[4:7], v[72:75], v[104:107], v[4:7]
    v_mfma_f32_16x16x32_bf16 v[36:39], v[76:79], v[104:107], v[36:39]
    v_mfma_f32_16x16x32_bf16 v[0:3], v[80:83], v[104:107], v[0:3]
    v_mfma_f32_16x16x32_bf16 v[32:35], v[84:87], v[104:107], v[32:35]
    ds_read_b128 v[104:107], v122 offset:0
    v_add_u32 v122, v124, v122
    s_waitcnt vmcnt(0) lgkmcnt(5)
    v_mfma_f32_16x16x32_bf16 v[12:15], v[64:67], v[108:111], v[12:15]
    v_mfma_f32_16x16x32_bf16 v[44:47], v[68:71], v[108:111], v[44:47]
    v_mfma_f32_16x16x32_bf16 v[8:11], v[72:75], v[108:111], v[8:11]
    v_mfma_f32_16x16x32_bf16 v[40:43], v[76:79], v[108:111], v[40:43]
    v_mfma_f32_16x16x32_bf16 v[4:7], v[80:83], v[108:111], v[4:7]
    v_mfma_f32_16x16x32_bf16 v[36:39], v[84:87], v[108:111], v[36:39]
    v_mfma_f32_16x16x32_bf16 v[0:3], v[88:91], v[108:111], v[0:3]
    v_mfma_f32_16x16x32_bf16 v[32:35], v[92:95], v[108:111], v[32:35]
    ds_read_b128 v[108:111], v121 offset:9216
    s_waitcnt lgkmcnt(5)
    v_mfma_f32_16x16x32_bf16 v[16:19], v[64:67], v[112:115], v[16:19]
    v_mfma_f32_16x16x32_bf16 v[48:51], v[68:71], v[112:115], v[48:51]
    v_mfma_f32_16x16x32_bf16 v[12:15], v[72:75], v[112:115], v[12:15]
    v_mfma_f32_16x16x32_bf16 v[44:47], v[76:79], v[112:115], v[44:47]
    v_mfma_f32_16x16x32_bf16 v[8:11], v[80:83], v[112:115], v[8:11]
    v_mfma_f32_16x16x32_bf16 v[40:43], v[84:87], v[112:115], v[40:43]
    v_mfma_f32_16x16x32_bf16 v[4:7], v[88:91], v[112:115], v[4:7]
    v_mfma_f32_16x16x32_bf16 v[36:39], v[92:95], v[112:115], v[36:39]
    ds_read_b128 v[112:115], v121 offset:10240
    s_waitcnt lgkmcnt(5)
    v_mfma_f32_16x16x32_bf16 v[20:23], v[64:67], v[116:119], v[20:23]
    v_mfma_f32_16x16x32_bf16 v[52:55], v[68:71], v[116:119], v[52:55]
    v_mfma_f32_16x16x32_bf16 v[16:19], v[72:75], v[116:119], v[16:19]
    v_mfma_f32_16x16x32_bf16 v[48:51], v[76:79], v[116:119], v[48:51]
    v_mfma_f32_16x16x32_bf16 v[12:15], v[80:83], v[116:119], v[12:15]
    v_mfma_f32_16x16x32_bf16 v[44:47], v[84:87], v[116:119], v[44:47]
    v_mfma_f32_16x16x32_bf16 v[8:11], v[88:91], v[116:119], v[8:11]
    v_mfma_f32_16x16x32_bf16 v[40:43], v[92:95], v[116:119], v[40:43]
    s_waitcnt lgkmcnt(4)
    v_mfma_f32_16x16x32_bf16 v[24:27], v[64:67], v[96:99], v[24:27]
    v_mfma_f32_16x16x32_bf16 v[56:59], v[68:71], v[96:99], v[56:59]
    v_mfma_f32_16x16x32_bf16 v[20:23], v[72:75], v[96:99], v[20:23]
    v_mfma_f32_16x16x32_bf16 v[52:55], v[76:79], v[96:99], v[52:55]
    v_mfma_f32_16x16x32_bf16 v[16:19], v[80:83], v[96:99], v[16:19]
    v_mfma_f32_16x16x32_bf16 v[48:51], v[84:87], v[96:99], v[48:51]
    v_mfma_f32_16x16x32_bf16 v[12:15], v[88:91], v[96:99], v[12:15]
    v_mfma_f32_16x16x32_bf16 v[44:47], v[92:95], v[96:99], v[44:47]
    s_waitcnt lgkmcnt(3)
    v_mfma_f32_16x16x32_bf16 v[28:31], v[64:67], v[100:103], v[28:31]
    v_mfma_f32_16x16x32_bf16 v[60:63], v[68:71], v[100:103], v[60:63]
    v_mfma_f32_16x16x32_bf16 v[24:27], v[72:75], v[100:103], v[24:27]
    v_mfma_f32_16x16x32_bf16 v[56:59], v[76:79], v[100:103], v[56:59]
    v_mfma_f32_16x16x32_bf16 v[20:23], v[80:83], v[100:103], v[20:23]
    v_mfma_f32_16x16x32_bf16 v[52:55], v[84:87], v[100:103], v[52:55]
    v_mfma_f32_16x16x32_bf16 v[16:19], v[88:91], v[100:103], v[16:19]
    v_mfma_f32_16x16x32_bf16 v[48:51], v[92:95], v[100:103], v[48:51]
    buffer_load_dwordx4 v[64:67], v125, s[12:15], s23 offen offset:0
    buffer_load_dwordx4 v[68:71], v125, s[12:15], s23 offen offset:1024
    s_waitcnt lgkmcnt(2)
    v_mfma_f32_16x16x32_bf16 v[28:31], v[72:75], v[104:107], v[28:31]
    v_mfma_f32_16x16x32_bf16 v[60:63], v[76:79], v[104:107], v[60:63]
    v_mfma_f32_16x16x32_bf16 v[24:27], v[80:83], v[104:107], v[24:27]
    v_mfma_f32_16x16x32_bf16 v[56:59], v[84:87], v[104:107], v[56:59]
    v_mfma_f32_16x16x32_bf16 v[20:23], v[88:91], v[104:107], v[20:23]
    v_mfma_f32_16x16x32_bf16 v[52:55], v[92:95], v[104:107], v[52:55]
    buffer_load_dwordx4 v[72:75], v125, s[12:15], s23 offen offset:2048
    buffer_load_dwordx4 v[76:79], v125, s[12:15], s23 offen offset:3072
    s_waitcnt lgkmcnt(1)
    v_mfma_f32_16x16x32_bf16 v[28:31], v[80:83], v[108:111], v[28:31]
    v_mfma_f32_16x16x32_bf16 v[60:63], v[84:87], v[108:111], v[60:63]
    v_mfma_f32_16x16x32_bf16 v[24:27], v[88:91], v[108:111], v[24:27]
    v_mfma_f32_16x16x32_bf16 v[56:59], v[92:95], v[108:111], v[56:59]
    buffer_load_dwordx4 v[80:83], v125, s[12:15], s26 offen offset:0
    buffer_load_dwordx4 v[84:87], v125, s[12:15], s26 offen offset:1024
    s_waitcnt lgkmcnt(0)
    v_mfma_f32_16x16x32_bf16 v[28:31], v[88:91], v[112:115], v[28:31]
    v_mfma_f32_16x16x32_bf16 v[60:63], v[92:95], v[112:115], v[60:63]
    buffer_load_dwordx4 v[88:91], v125, s[12:15], s26 offen offset:2048
    buffer_load_dwordx4 v[92:95], v125, s[12:15], s26 offen offset:3072
    s_add_u32 s23, s23, 57344
    s_add_u32 s26, s26, 57344
    s_barrier
    s_branch L_conv1_kernel_mloop1
L_conv1_kernel_mlast1:
    v_and_b32 v125, 15, v127
    v_and_b32 v126, 7, v127
    v_lshlrev_b32 v126, 4, v126
    v_lshl_add_u32 v125, v125, 7, v126
    v_lshrrev_b32 v126, 4, v127
    v_lshl_add_u32 v125, v126, 11, v125
    s_lshl_b32 s36, s20, 14
    s_add_u32 s37, s36, 8192
    v_add_u32 v126, s37, v125
    v_add_u32 v125, s36, v125
    ds_read_b128 v[96:99], v120 offset:8192
    ds_read_b128 v[100:103], v120 offset:9216
    ds_read_b128 v[104:107], v120 offset:10240
    ds_read_b128 v[108:111], v120 offset:11264
    ds_read_b128 v[112:115], v120 offset:12288
    ds_read_b128 v[116:119], v120 offset:13312
    s_waitcnt vmcnt(6) lgkmcnt(5)
    v_mfma_f32_16x16x32_bf16 v[0:3], v[64:67], v[96:99], v[0:3]
    v_mfma_f32_16x16x32_bf16 v[32:35], v[68:71], v[96:99], v[32:35]
    ds_read_b128 v[96:99], v120 offset:14336
    s_waitcnt vmcnt(4) lgkmcnt(5)
    v_mfma_f32_16x16x32_bf16 v[4:7], v[64:67], v[100:103], v[4:7]
    v_mfma_f32_16x16x32_bf16 v[36:39], v[68:71], v[100:103], v[36:39]
    v_mfma_f32_16x16x32_bf16 v[0:3], v[72:75], v[100:103], v[0:3]
    v_mfma_f32_16x16x32_bf16 v[32:35], v[76:79], v[100:103], v[32:35]
    ds_read_b128 v[100:103], v120 offset:15360
    s_waitcnt vmcnt(2) lgkmcnt(5)
    v_mfma_f32_16x16x32_bf16 v[8:11], v[64:67], v[104:107], v[8:11]
    v_mfma_f32_16x16x32_bf16 v[40:43], v[68:71], v[104:107], v[40:43]
    v_mfma_f32_16x16x32_bf16 v[4:7], v[72:75], v[104:107], v[4:7]
    v_mfma_f32_16x16x32_bf16 v[36:39], v[76:79], v[104:107], v[36:39]
    v_mfma_f32_16x16x32_bf16 v[0:3], v[80:83], v[104:107], v[0:3]
    v_mfma_f32_16x16x32_bf16 v[32:35], v[84:87], v[104:107], v[32:35]
    ds_read_b128 v[104:107], v122 offset:0
    s_waitcnt vmcnt(0) lgkmcnt(5)
    v_mfma_f32_16x16x32_bf16 v[12:15], v[64:67], v[108:111], v[12:15]
    v_mfma_f32_16x16x32_bf16 v[44:47], v[68:71], v[108:111], v[44:47]
    v_mfma_f32_16x16x32_bf16 v[8:11], v[72:75], v[108:111], v[8:11]
    v_mfma_f32_16x16x32_bf16 v[40:43], v[76:79], v[108:111], v[40:43]
    v_mfma_f32_16x16x32_bf16 v[4:7], v[80:83], v[108:111], v[4:7]
    v_mfma_f32_16x16x32_bf16 v[36:39], v[84:87], v[108:111], v[36:39]
    v_mfma_f32_16x16x32_bf16 v[0:3], v[88:91], v[108:111], v[0:3]
    v_mfma_f32_16x16x32_bf16 v[32:35], v[92:95], v[108:111], v[32:35]
    ds_read_b128 v[108:111], v121 offset:9216
    s_waitcnt lgkmcnt(5)
    v_mfma_f32_16x16x32_bf16 v[16:19], v[64:67], v[112:115], v[16:19]
    v_mfma_f32_16x16x32_bf16 v[48:51], v[68:71], v[112:115], v[48:51]
    v_mfma_f32_16x16x32_bf16 v[12:15], v[72:75], v[112:115], v[12:15]
    v_mfma_f32_16x16x32_bf16 v[44:47], v[76:79], v[112:115], v[44:47]
    v_mfma_f32_16x16x32_bf16 v[8:11], v[80:83], v[112:115], v[8:11]
    v_mfma_f32_16x16x32_bf16 v[40:43], v[84:87], v[112:115], v[40:43]
    v_mfma_f32_16x16x32_bf16 v[4:7], v[88:91], v[112:115], v[4:7]
    v_mfma_f32_16x16x32_bf16 v[36:39], v[92:95], v[112:115], v[36:39]
    ds_read_b128 v[112:115], v121 offset:10240
    v_xor_b32 v123, 0, v125
    ds_write_b128 v123, v[0:3]
    s_waitcnt lgkmcnt(6)
    v_mfma_f32_16x16x32_bf16 v[20:23], v[64:67], v[116:119], v[20:23]
    v_mfma_f32_16x16x32_bf16 v[52:55], v[68:71], v[116:119], v[52:55]
    v_mfma_f32_16x16x32_bf16 v[16:19], v[72:75], v[116:119], v[16:19]
    v_mfma_f32_16x16x32_bf16 v[48:51], v[76:79], v[116:119], v[48:51]
    v_mfma_f32_16x16x32_bf16 v[12:15], v[80:83], v[116:119], v[12:15]
    v_mfma_f32_16x16x32_bf16 v[44:47], v[84:87], v[116:119], v[44:47]
    v_mfma_f32_16x16x32_bf16 v[8:11], v[88:91], v[116:119], v[8:11]
    v_mfma_f32_16x16x32_bf16 v[40:43], v[92:95], v[116:119], v[40:43]
    v_xor_b32 v124, 16, v125
    ds_write_b128 v124, v[4:7]
    s_waitcnt lgkmcnt(2)
    v_mfma_f32_16x16x32_bf16 v[24:27], v[64:67], v[96:99], v[24:27]
    v_mfma_f32_16x16x32_bf16 v[56:59], v[68:71], v[96:99], v[56:59]
    v_mfma_f32_16x16x32_bf16 v[20:23], v[72:75], v[96:99], v[20:23]
    v_mfma_f32_16x16x32_bf16 v[52:55], v[76:79], v[96:99], v[52:55]
    v_mfma_f32_16x16x32_bf16 v[16:19], v[80:83], v[96:99], v[16:19]
    v_mfma_f32_16x16x32_bf16 v[48:51], v[84:87], v[96:99], v[48:51]
    v_mfma_f32_16x16x32_bf16 v[12:15], v[88:91], v[96:99], v[12:15]
    v_mfma_f32_16x16x32_bf16 v[44:47], v[92:95], v[96:99], v[44:47]
    v_xor_b32 v123, 32, v125
    ds_write_b128 v123, v[8:11]
    v_xor_b32 v124, 0, v126
    ds_write_b128 v124, v[32:35]
    v_mfma_f32_16x16x32_bf16 v[28:31], v[64:67], v[100:103], v[28:31]
    v_mfma_f32_16x16x32_bf16 v[60:63], v[68:71], v[100:103], v[60:63]
    v_mfma_f32_16x16x32_bf16 v[24:27], v[72:75], v[100:103], v[24:27]
    v_mfma_f32_16x16x32_bf16 v[56:59], v[76:79], v[100:103], v[56:59]
    v_mfma_f32_16x16x32_bf16 v[20:23], v[80:83], v[100:103], v[20:23]
    v_mfma_f32_16x16x32_bf16 v[52:55], v[84:87], v[100:103], v[52:55]
    v_mfma_f32_16x16x32_bf16 v[16:19], v[88:91], v[100:103], v[16:19]
    v_mfma_f32_16x16x32_bf16 v[48:51], v[92:95], v[100:103], v[48:51]
    v_xor_b32 v123, 16, v126
    ds_write_b128 v123, v[36:39]
    v_xor_b32 v124, 32, v126
    ds_write_b128 v124, v[40:43]
    v_mfma_f32_16x16x32_bf16 v[28:31], v[72:75], v[104:107], v[28:31]
    v_mfma_f32_16x16x32_bf16 v[60:63], v[76:79], v[104:107], v[60:63]
    v_mfma_f32_16x16x32_bf16 v[24:27], v[80:83], v[104:107], v[24:27]
    v_mfma_f32_16x16x32_bf16 v[56:59], v[84:87], v[104:107], v[56:59]
    v_mfma_f32_16x16x32_bf16 v[20:23], v[88:91], v[104:107], v[20:23]
    v_mfma_f32_16x16x32_bf16 v[52:55], v[92:95], v[104:107], v[52:55]
    v_xor_b32 v124, 48, v125
    ds_write_b128 v124, v[12:15]
    v_xor_b32 v123, 48, v126
    ds_write_b128 v123, v[44:47]
    v_mfma_f32_16x16x32_bf16 v[28:31], v[80:83], v[108:111], v[28:31]
    v_mfma_f32_16x16x32_bf16 v[60:63], v[84:87], v[108:111], v[60:63]
    v_mfma_f32_16x16x32_bf16 v[24:27], v[88:91], v[108:111], v[24:27]
    v_mfma_f32_16x16x32_bf16 v[56:59], v[92:95], v[108:111], v[56:59]
    v_xor_b32 v123, 64, v125
    ds_write_b128 v123, v[16:19]
    v_xor_b32 v124, 64, v126
    ds_write_b128 v124, v[48:51]
    v_mfma_f32_16x16x32_bf16 v[28:31], v[88:91], v[112:115], v[28:31]
    v_mfma_f32_16x16x32_bf16 v[60:63], v[92:95], v[112:115], v[60:63]
    v_xor_b32 v124, 80, v125
    ds_write_b128 v124, v[20:23]
    v_xor_b32 v123, 80, v126
    ds_write_b128 v123, v[52:55]
    s_nop 7
    v_xor_b32 v123, 96, v125
    ds_write_b128 v123, v[24:27]
    v_xor_b32 v124, 96, v126
    ds_write_b128 v124, v[56:59]
    v_xor_b32 v124, 112, v125
    ds_write_b128 v124, v[28:31]
    v_xor_b32 v123, 112, v126
    s_waitcnt lgkmcnt(8)
    ds_write_b128 v123, v[60:63]
    s_setprio 0
    s_branch L_conv1_kernel_epi
L_conv1_kernel_m2:
    s_mul_i32 s37, s38, 2176
    s_add_u32 s37, s37, 98304
    v_add_u32 v116, s37, v8
    v_add_u32 v118, s37, v9
    v_add_u32 v117, 104832, v8
    s_cmp_eq_u32 s38, 0
    s_cbranch_scc1 L_conv1_kernel_hh0
    v_add_u32 v117, 98304, v9
L_conv1_kernel_hh0:
    s_lshl_b32 s37, s38, 12
    s_add_u32 s37, s37, s43
    s_add_u32 s37, s37, 49152
    v_lshl_add_u32 v119, v127, 4, s37
    v_mov_b32 v0, 0
    v_mov_b32 v1, 0
    v_mov_b32 v2, 0
    v_mov_b32 v3, 0
    v_mov_b32 v4, 0
    v_mov_b32 v5, 0
    v_mov_b32 v6, 0
    v_mov_b32 v7, 0
    v_mov_b32 v8, 0
    v_mov_b32 v9, 0
    v_mov_b32 v10, 0
    v_mov_b32 v11, 0
    v_mov_b32 v12, 0
    v_mov_b32 v13, 0
    v_mov_b32 v14, 0
    v_mov_b32 v15, 0
    v_mov_b32 v16, 0
    v_mov_b32 v17, 0
    v_mov_b32 v18, 0
    v_mov_b32 v19, 0
    v_mov_b32 v20, 0
    v_mov_b32 v21, 0
    v_mov_b32 v22, 0
    v_mov_b32 v23, 0
    v_mov_b32 v24, 0
    v_mov_b32 v25, 0
    v_mov_b32 v26, 0
    v_mov_b32 v27, 0
    v_mov_b32 v28, 0
    v_mov_b32 v29, 0
    v_mov_b32 v30, 0
    v_mov_b32 v31, 0
    v_mov_b32 v32, 0
    v_mov_b32 v33, 0
    v_mov_b32 v34, 0
    v_mov_b32 v35, 0
    v_mov_b32 v36, 0
    v_mov_b32 v37, 0
    v_mov_b32 v38, 0
    v_mov_b32 v39, 0
    v_mov_b32 v40, 0
    v_mov_b32 v41, 0
    v_mov_b32 v42, 0
    v_mov_b32 v43, 0
    v_mov_b32 v44, 0
    v_mov_b32 v45, 0
    v_mov_b32 v46, 0
    v_mov_b32 v47, 0
    v_mov_b32 v48, 0
    v_mov_b32 v49, 0
    v_mov_b32 v50, 0
    v_mov_b32 v51, 0
    v_mov_b32 v52, 0
    v_mov_b32 v53, 0
    v_mov_b32 v54, 0
    v_mov_b32 v55, 0
    v_mov_b32 v56, 0
    v_mov_b32 v57, 0
    v_mov_b32 v58, 0
    v_mov_b32 v59, 0
    v_mov_b32 v60, 0
    v_mov_b32 v61, 0
    v_mov_b32 v62, 0
    v_mov_b32 v63, 0
    s_barrier
    buffer_load_dwordx4 v[96:99], v108, s[8:11], 0 offen offset:0
    buffer_load_dwordx4 v[100:103], v108, s[8:11], 0 offen offset:1024
    buffer_load_dwordx4 v[104:107], v108, s[8:11], 0 offen offset:2048
    s_mov_b32 s23, 0
    s_mov_b32 s26, 4096
    buffer_load_dwordx4 v[64:67], v125, s[12:15], s23 offen offset:0
    buffer_load_dwordx4 v[68:71], v125, s[12:15], s23 offen offset:2048
    buffer_load_dwordx4 v[80:83], v119, s[12:15], s23 offen offset:0
    buffer_load_dwordx4 v[72:75], v125, s[12:15], s26 offen offset:0
    buffer_load_dwordx4 v[84:87], v119, s[12:15], s23 offen offset:2048
    buffer_load_dwordx4 v[76:79], v125, s[12:15], s26 offen offset:2048
    s_mov_b32 s23, 57344
    s_mov_b32 s26, 61440
    s_waitcnt vmcnt(6)
    v_lshlrev_b32 v108, 16, v96
    v_and_b32 v111, s25, v96
    v_lshlrev_b32 v109, 16, v100
    v_and_b32 v112, s25, v100
    v_lshlrev_b32 v110, 16, v104
    v_and_b32 v113, s25, v104
    v_mul_f32 v114, s44, v108
    v_mul_f32 v115, s44, v111
    v_fmac_f32 v114, s45, v109
    v_fmac_f32 v115, s45, v112
    v_fmac_f32 v114, s46, v110
    v_fmac_f32 v115, s46, v113
    v_cvt_pk_bf16_f32 v96, v114, v115
    v_lshlrev_b32 v108, 16, v97
    v_and_b32 v111, s25, v97
    v_lshlrev_b32 v109, 16, v101
    v_and_b32 v112, s25, v101
    v_lshlrev_b32 v110, 16, v105
    v_and_b32 v113, s25, v105
    v_mul_f32 v114, s44, v108
    v_mul_f32 v115, s44, v111
    v_fmac_f32 v114, s45, v109
    v_fmac_f32 v115, s45, v112
    v_fmac_f32 v114, s46, v110
    v_fmac_f32 v115, s46, v113
    v_cvt_pk_bf16_f32 v97, v114, v115
    v_lshlrev_b32 v108, 16, v98
    v_and_b32 v111, s25, v98
    v_lshlrev_b32 v109, 16, v102
    v_and_b32 v112, s25, v102
    v_lshlrev_b32 v110, 16, v106
    v_and_b32 v113, s25, v106
    v_mul_f32 v114, s44, v108
    v_mul_f32 v115, s44, v111
    v_fmac_f32 v114, s45, v109
    v_fmac_f32 v115, s45, v112
    v_fmac_f32 v114, s46, v110
    v_fmac_f32 v115, s46, v113
    v_cvt_pk_bf16_f32 v98, v114, v115
    v_lshlrev_b32 v108, 16, v99
    v_and_b32 v111, s25, v99
    v_lshlrev_b32 v109, 16, v103
    v_and_b32 v112, s25, v103
    v_lshlrev_b32 v110, 16, v107
    v_and_b32 v113, s25, v107
    v_mul_f32 v114, s44, v108
    v_mul_f32 v115, s44, v111
    v_fmac_f32 v114, s45, v109
    v_fmac_f32 v115, s45, v112
    v_fmac_f32 v114, s46, v110
    v_fmac_f32 v115, s46, v113
    v_cvt_pk_bf16_f32 v99, v114, v115
    ds_write_b128 v126, v[96:99]
    v_and_b32 v126, 15, v127
    v_lshlrev_b32 v126, 2, v126
    v_add_u32 v126, 99328, v126
    ds_write_b32 v126, v0
    ds_write_b32 v126, v0 offset:8704
    s_waitcnt lgkmcnt(0)
    s_barrier
    s_mov_b32 s22, 8
    s_setprio 2
L_conv1_kernel_mloop2:
    ds_read_b128 v[88:91], v120 offset:0
    ds_read_b128 v[92:95], v120 offset:1024
    ds_read_b128 v[96:99], v116 offset:0
    ds_read_b128 v[100:103], v120 offset:2048
    ds_read_b128 v[104:107], v116 offset:1088
    ds_read_b128 v[108:111], v120 offset:3072
    ds_read_b128 v[112:115], v116 offset:2176
    s_waitcnt vmcnt(5) lgkmcnt(6)
    v_mfma_f32_16x16x32_bf16 v[0:3], v[64:67], v[88:91], v[0:3]
    ds_read_b128 v[88:91], v120 offset:4096
    s_waitcnt vmcnt(4) lgkmcnt(6)
    v_mfma_f32_16x16x32_bf16 v[4:7], v[64:67], v[92:95], v[4:7]
    v_mfma_f32_16x16x32_bf16 v[0:3], v[68:71], v[92:95], v[0:3]
    ds_read_b128 v[92:95], v116 offset:3264
    s_waitcnt vmcnt(3) lgkmcnt(6)
    v_mfma_f32_16x16x32_bf16 v[32:35], v[80:83], v[96:99], v[32:35]
    ds_read_b128 v[96:99], v120 offset:5120
    s_waitcnt vmcnt(2) lgkmcnt(6)
    v_mfma_f32_16x16x32_bf16 v[8:11], v[64:67], v[100:103], v[8:11]
    v_mfma_f32_16x16x32_bf16 v[4:7], v[68:71], v[100:103], v[4:7]
    v_mfma_f32_16x16x32_bf16 v[0:3], v[72:75], v[100:103], v[0:3]
    ds_read_b128 v[100:103], v116 offset:4352
    s_waitcnt vmcnt(1) lgkmcnt(6)
    v_mfma_f32_16x16x32_bf16 v[36:39], v[80:83], v[104:107], v[36:39]
    v_mfma_f32_16x16x32_bf16 v[32:35], v[84:87], v[104:107], v[32:35]
    ds_read_b128 v[104:107], v120 offset:6144
    s_waitcnt vmcnt(0) lgkmcnt(6)
    v_mfma_f32_16x16x32_bf16 v[12:15], v[64:67], v[108:111], v[12:15]
    v_mfma_f32_16x16x32_bf16 v[8:11], v[68:71], v[108:111], v[8:11]
    v_mfma_f32_16x16x32_bf16 v[4:7], v[72:75], v[108:111], v[4:7]
    v_mfma_f32_16x16x32_bf16 v[0:3], v[76:79], v[108:111], v[0:3]
    ds_read_b128 v[108:111], v116 offset:5440
    s_waitcnt lgkmcnt(6)
    v_mfma_f32_16x16x32_bf16 v[40:43], v[80:83], v[112:115], v[40:43]
    v_mfma_f32_16x16x32_bf16 v[36:39], v[84:87], v[112:115], v[36:39]
    ds_read_b128 v[112:115], v120 offset:7168
    s_waitcnt lgkmcnt(6)
    v_mfma_f32_16x16x32_bf16 v[16:19], v[64:67], v[88:91], v[16:19]
    v_mfma_f32_16x16x32_bf16 v[12:15], v[68:71], v[88:91], v[12:15]
    v_mfma_f32_16x16x32_bf16 v[8:11], v[72:75], v[88:91], v[8:11]
    v_mfma_f32_16x16x32_bf16 v[4:7], v[76:79], v[88:91], v[4:7]
    ds_read_b128 v[88:91], v117 offset:0
    s_waitcnt lgkmcnt(6)
    v_mfma_f32_16x16x32_bf16 v[44:47], v[80:83], v[92:95], v[44:47]
    v_mfma_f32_16x16x32_bf16 v[40:43], v[84:87], v[92:95], v[40:43]
    ds_read_b128 v[92:95], v122 offset:0
    v_add_u32 v122, v123, v122
    s_waitcnt lgkmcnt(6)
    v_mfma_f32_16x16x32_bf16 v[20:23], v[64:67], v[96:99], v[20:23]
    v_mfma_f32_16x16x32_bf16 v[16:19], v[68:71], v[96:99], v[16:19]
    v_mfma_f32_16x16x32_bf16 v[12:15], v[72:75], v[96:99], v[12:15]
    v_mfma_f32_16x16x32_bf16 v[8:11], v[76:79], v[96:99], v[8:11]
    ds_read_b128 v[96:99], v117 offset:1088
    s_waitcnt lgkmcnt(6)
    v_mfma_f32_16x16x32_bf16 v[48:51], v[80:83], v[100:103], v[48:51]
    v_mfma_f32_16x16x32_bf16 v[44:47], v[84:87], v[100:103], v[44:47]
    ds_read_b128 v[100:103], v121 offset:1024
    s_waitcnt lgkmcnt(6)
    v_mfma_f32_16x16x32_bf16 v[24:27], v[64:67], v[104:107], v[24:27]
    v_mfma_f32_16x16x32_bf16 v[20:23], v[68:71], v[104:107], v[20:23]
    v_mfma_f32_16x16x32_bf16 v[16:19], v[72:75], v[104:107], v[16:19]
    v_mfma_f32_16x16x32_bf16 v[12:15], v[76:79], v[104:107], v[12:15]
    ds_read_b128 v[104:107], v118 offset:0
    s_waitcnt lgkmcnt(6)
    v_mfma_f32_16x16x32_bf16 v[52:55], v[80:83], v[108:111], v[52:55]
    v_mfma_f32_16x16x32_bf16 v[48:51], v[84:87], v[108:111], v[48:51]
    ds_read_b128 v[108:111], v121 offset:2048
    s_waitcnt lgkmcnt(6)
    v_mfma_f32_16x16x32_bf16 v[28:31], v[64:67], v[112:115], v[28:31]
    v_mfma_f32_16x16x32_bf16 v[24:27], v[68:71], v[112:115], v[24:27]
    v_mfma_f32_16x16x32_bf16 v[20:23], v[72:75], v[112:115], v[20:23]
    v_mfma_f32_16x16x32_bf16 v[16:19], v[76:79], v[112:115], v[16:19]
    buffer_load_dwordx4 v[64:67], v125, s[12:15], s23 offen offset:0
    s_waitcnt lgkmcnt(5)
    v_mfma_f32_16x16x32_bf16 v[56:59], v[80:83], v[88:91], v[56:59]
    v_mfma_f32_16x16x32_bf16 v[52:55], v[84:87], v[88:91], v[52:55]
    s_waitcnt lgkmcnt(0)
    s_barrier
    v_mfma_f32_16x16x32_bf16 v[28:31], v[68:71], v[92:95], v[28:31]
    v_mfma_f32_16x16x32_bf16 v[24:27], v[72:75], v[92:95], v[24:27]
    v_mfma_f32_16x16x32_bf16 v[20:23], v[76:79], v[92:95], v[20:23]
    buffer_load_dwordx4 v[68:71], v125, s[12:15], s23 offen offset:2048
    v_mfma_f32_16x16x32_bf16 v[60:63], v[80:83], v[96:99], v[60:63]
    v_mfma_f32_16x16x32_bf16 v[56:59], v[84:87], v[96:99], v[56:59]
    buffer_load_dwordx4 v[80:83], v119, s[12:15], s23 offen offset:0
    v_mfma_f32_16x16x32_bf16 v[28:31], v[72:75], v[100:103], v[28:31]
    v_mfma_f32_16x16x32_bf16 v[24:27], v[76:79], v[100:103], v[24:27]
    buffer_load_dwordx4 v[72:75], v125, s[12:15], s26 offen offset:0
    v_mfma_f32_16x16x32_bf16 v[60:63], v[84:87], v[104:107], v[60:63]
    buffer_load_dwordx4 v[84:87], v119, s[12:15], s23 offen offset:2048
    v_mfma_f32_16x16x32_bf16 v[28:31], v[76:79], v[108:111], v[28:31]
    buffer_load_dwordx4 v[76:79], v125, s[12:15], s26 offen offset:2048
    s_add_u32 s23, s23, 57344
    s_add_u32 s26, s26, 57344
    s_sub_u32 s22, s22, 1
    s_cmp_eq_u32 s22, 0
    s_cbranch_scc1 L_conv1_kernel_mlast2
    ds_read_b128 v[88:91], v120 offset:8192
    ds_read_b128 v[92:95], v120 offset:9216
    ds_read_b128 v[96:99], v116 offset:8704
    ds_read_b128 v[100:103], v120 offset:10240
    ds_read_b128 v[104:107], v116 offset:9792
    ds_read_b128 v[108:111], v120 offset:11264
    ds_read_b128 v[112:115], v116 offset:10880
    s_waitcnt vmcnt(5) lgkmcnt(6)
    v_mfma_f32_16x16x32_bf16 v[0:3], v[64:67], v[88:91], v[0:3]
    ds_read_b128 v[88:91], v120 offset:12288
    s_waitcnt vmcnt(4) lgkmcnt(6)
    v_mfma_f32_16x16x32_bf16 v[4:7], v[64:67], v[92:95], v[4:7]
    v_mfma_f32_16x16x32_bf16 v[0:3], v[68:71], v[92:95], v[0:3]
    ds_read_b128 v[92:95], v116 offset:11968
    s_waitcnt vmcnt(3) lgkmcnt(6)
    v_mfma_f32_16x16x32_bf16 v[32:35], v[80:83], v[96:99], v[32:35]
    ds_read_b128 v[96:99], v120 offset:13312
    s_waitcnt vmcnt(2) lgkmcnt(6)
    v_mfma_f32_16x16x32_bf16 v[8:11], v[64:67], v[100:103], v[8:11]
    v_mfma_f32_16x16x32_bf16 v[4:7], v[68:71], v[100:103], v[4:7]
    v_mfma_f32_16x16x32_bf16 v[0:3], v[72:75], v[100:103], v[0:3]
    ds_read_b128 v[100:103], v116 offset:13056
    s_waitcnt vmcnt(1) lgkmcnt(6)
    v_mfma_f32_16x16x32_bf16 v[36:39], v[80:83], v[104:107], v[36:39]
    v_mfma_f32_16x16x32_bf16 v[32:35], v[84:87], v[104:107], v[32:35]
    ds_read_b128 v[104:107], v120 offset:14336
    s_waitcnt vmcnt(0) lgkmcnt(6)
    v_mfma_f32_16x16x32_bf16 v[12:15], v[64:67], v[108:111], v[12:15]
    v_mfma_f32_16x16x32_bf16 v[8:11], v[68:71], v[108:111], v[8:11]
    v_mfma_f32_16x16x32_bf16 v[4:7], v[72:75], v[108:111], v[4:7]
    v_mfma_f32_16x16x32_bf16 v[0:3], v[76:79], v[108:111], v[0:3]
    ds_read_b128 v[108:111], v116 offset:14144
    s_waitcnt lgkmcnt(6)
    v_mfma_f32_16x16x32_bf16 v[40:43], v[80:83], v[112:115], v[40:43]
    v_mfma_f32_16x16x32_bf16 v[36:39], v[84:87], v[112:115], v[36:39]
    ds_read_b128 v[112:115], v120 offset:15360
    s_waitcnt lgkmcnt(6)
    v_mfma_f32_16x16x32_bf16 v[16:19], v[64:67], v[88:91], v[16:19]
    v_mfma_f32_16x16x32_bf16 v[12:15], v[68:71], v[88:91], v[12:15]
    v_mfma_f32_16x16x32_bf16 v[8:11], v[72:75], v[88:91], v[8:11]
    v_mfma_f32_16x16x32_bf16 v[4:7], v[76:79], v[88:91], v[4:7]
    ds_read_b128 v[88:91], v117 offset:8704
    s_waitcnt lgkmcnt(6)
    v_mfma_f32_16x16x32_bf16 v[44:47], v[80:83], v[92:95], v[44:47]
    v_mfma_f32_16x16x32_bf16 v[40:43], v[84:87], v[92:95], v[40:43]
    ds_read_b128 v[92:95], v122 offset:0
    v_add_u32 v122, v124, v122
    s_waitcnt lgkmcnt(6)
    v_mfma_f32_16x16x32_bf16 v[20:23], v[64:67], v[96:99], v[20:23]
    v_mfma_f32_16x16x32_bf16 v[16:19], v[68:71], v[96:99], v[16:19]
    v_mfma_f32_16x16x32_bf16 v[12:15], v[72:75], v[96:99], v[12:15]
    v_mfma_f32_16x16x32_bf16 v[8:11], v[76:79], v[96:99], v[8:11]
    ds_read_b128 v[96:99], v117 offset:9792
    s_waitcnt lgkmcnt(6)
    v_mfma_f32_16x16x32_bf16 v[48:51], v[80:83], v[100:103], v[48:51]
    v_mfma_f32_16x16x32_bf16 v[44:47], v[84:87], v[100:103], v[44:47]
    ds_read_b128 v[100:103], v121 offset:9216
    s_waitcnt lgkmcnt(6)
    v_mfma_f32_16x16x32_bf16 v[24:27], v[64:67], v[104:107], v[24:27]
    v_mfma_f32_16x16x32_bf16 v[20:23], v[68:71], v[104:107], v[20:23]
    v_mfma_f32_16x16x32_bf16 v[16:19], v[72:75], v[104:107], v[16:19]
    v_mfma_f32_16x16x32_bf16 v[12:15], v[76:79], v[104:107], v[12:15]
    ds_read_b128 v[104:107], v118 offset:8704
    s_waitcnt lgkmcnt(6)
    v_mfma_f32_16x16x32_bf16 v[52:55], v[80:83], v[108:111], v[52:55]
    v_mfma_f32_16x16x32_bf16 v[48:51], v[84:87], v[108:111], v[48:51]
    ds_read_b128 v[108:111], v121 offset:10240
    s_waitcnt lgkmcnt(6)
    v_mfma_f32_16x16x32_bf16 v[28:31], v[64:67], v[112:115], v[28:31]
    v_mfma_f32_16x16x32_bf16 v[24:27], v[68:71], v[112:115], v[24:27]
    v_mfma_f32_16x16x32_bf16 v[20:23], v[72:75], v[112:115], v[20:23]
    v_mfma_f32_16x16x32_bf16 v[16:19], v[76:79], v[112:115], v[16:19]
    buffer_load_dwordx4 v[64:67], v125, s[12:15], s23 offen offset:0
    s_waitcnt lgkmcnt(5)
    v_mfma_f32_16x16x32_bf16 v[56:59], v[80:83], v[88:91], v[56:59]
    v_mfma_f32_16x16x32_bf16 v[52:55], v[84:87], v[88:91], v[52:55]
    s_waitcnt lgkmcnt(0)
    s_barrier
    v_mfma_f32_16x16x32_bf16 v[28:31], v[68:71], v[92:95], v[28:31]
    v_mfma_f32_16x16x32_bf16 v[24:27], v[72:75], v[92:95], v[24:27]
    v_mfma_f32_16x16x32_bf16 v[20:23], v[76:79], v[92:95], v[20:23]
    buffer_load_dwordx4 v[68:71], v125, s[12:15], s23 offen offset:2048
    v_mfma_f32_16x16x32_bf16 v[60:63], v[80:83], v[96:99], v[60:63]
    v_mfma_f32_16x16x32_bf16 v[56:59], v[84:87], v[96:99], v[56:59]
    buffer_load_dwordx4 v[80:83], v119, s[12:15], s23 offen offset:0
    v_mfma_f32_16x16x32_bf16 v[28:31], v[72:75], v[100:103], v[28:31]
    v_mfma_f32_16x16x32_bf16 v[24:27], v[76:79], v[100:103], v[24:27]
    buffer_load_dwordx4 v[72:75], v125, s[12:15], s26 offen offset:0
    v_mfma_f32_16x16x32_bf16 v[60:63], v[84:87], v[104:107], v[60:63]
    buffer_load_dwordx4 v[84:87], v119, s[12:15], s23 offen offset:2048
    v_mfma_f32_16x16x32_bf16 v[28:31], v[76:79], v[108:111], v[28:31]
    buffer_load_dwordx4 v[76:79], v125, s[12:15], s26 offen offset:2048
    s_add_u32 s23, s23, 57344
    s_add_u32 s26, s26, 57344
    s_branch L_conv1_kernel_mloop2
L_conv1_kernel_mlast2:
    v_and_b32 v125, 15, v127
    v_and_b32 v126, 7, v127
    v_lshlrev_b32 v126, 4, v126
    v_lshl_add_u32 v125, v125, 7, v126
    v_lshrrev_b32 v126, 4, v127
    v_lshl_add_u32 v125, v126, 11, v125
    s_mov_b32 s36, 65536
    s_cmp_eq_u32 s32, 1
    s_cselect_b32 s36, 121856, s36
    s_cmp_eq_u32 s32, 2
    s_cselect_b32 s36, 81920, s36
    s_cmp_eq_u32 s32, 3
    s_cselect_b32 s36, 130048, s36
    s_mov_b32 s37, 98304
    s_cmp_eq_u32 s32, 1
    s_cselect_b32 s37, 138240, s37
    s_cmp_eq_u32 s32, 2
    s_cselect_b32 s37, 146432, s37
    s_cmp_eq_u32 s32, 3
    s_cselect_b32 s37, 154624, s37
    v_add_u32 v126, s37, v125
    v_add_u32 v125, s36, v125
    ds_read_b128 v[88:91], v120 offset:8192
    ds_read_b128 v[92:95], v120 offset:9216
    ds_read_b128 v[96:99], v116 offset:8704
    ds_read_b128 v[100:103], v120 offset:10240
    ds_read_b128 v[104:107], v116 offset:9792
    ds_read_b128 v[108:111], v120 offset:11264
    ds_read_b128 v[112:115], v116 offset:10880
    s_waitcnt vmcnt(5) lgkmcnt(6)
    v_mfma_f32_16x16x32_bf16 v[0:3], v[64:67], v[88:91], v[0:3]
    ds_read_b128 v[88:91], v120 offset:12288
    s_waitcnt vmcnt(4) lgkmcnt(6)
    v_mfma_f32_16x16x32_bf16 v[4:7], v[64:67], v[92:95], v[4:7]
    v_mfma_f32_16x16x32_bf16 v[0:3], v[68:71], v[92:95], v[0:3]
    ds_read_b128 v[92:95], v116 offset:11968
    s_waitcnt vmcnt(3) lgkmcnt(6)
    v_mfma_f32_16x16x32_bf16 v[32:35], v[80:83], v[96:99], v[32:35]
    ds_read_b128 v[96:99], v120 offset:13312
    s_waitcnt vmcnt(2) lgkmcnt(6)
    v_mfma_f32_16x16x32_bf16 v[8:11], v[64:67], v[100:103], v[8:11]
    v_mfma_f32_16x16x32_bf16 v[4:7], v[68:71], v[100:103], v[4:7]
    v_mfma_f32_16x16x32_bf16 v[0:3], v[72:75], v[100:103], v[0:3]
    ds_read_b128 v[100:103], v116 offset:13056
    s_waitcnt vmcnt(1) lgkmcnt(6)
    v_mfma_f32_16x16x32_bf16 v[36:39], v[80:83], v[104:107], v[36:39]
    v_mfma_f32_16x16x32_bf16 v[32:35], v[84:87], v[104:107], v[32:35]
    ds_read_b128 v[104:107], v120 offset:14336
    s_waitcnt vmcnt(0) lgkmcnt(6)
    v_mfma_f32_16x16x32_bf16 v[12:15], v[64:67], v[108:111], v[12:15]
    v_mfma_f32_16x16x32_bf16 v[8:11], v[68:71], v[108:111], v[8:11]
    v_mfma_f32_16x16x32_bf16 v[4:7], v[72:75], v[108:111], v[4:7]
    v_mfma_f32_16x16x32_bf16 v[0:3], v[76:79], v[108:111], v[0:3]
    ds_read_b128 v[108:111], v116 offset:14144
    s_waitcnt lgkmcnt(6)
    v_mfma_f32_16x16x32_bf16 v[40:43], v[80:83], v[112:115], v[40:43]
    v_mfma_f32_16x16x32_bf16 v[36:39], v[84:87], v[112:115], v[36:39]
    ds_read_b128 v[112:115], v120 offset:15360
    s_waitcnt lgkmcnt(6)
    v_mfma_f32_16x16x32_bf16 v[16:19], v[64:67], v[88:91], v[16:19]
    v_mfma_f32_16x16x32_bf16 v[12:15], v[68:71], v[88:91], v[12:15]
    v_mfma_f32_16x16x32_bf16 v[8:11], v[72:75], v[88:91], v[8:11]
    v_mfma_f32_16x16x32_bf16 v[4:7], v[76:79], v[88:91], v[4:7]
    ds_read_b128 v[88:91], v117 offset:8704
    v_xor_b32 v124, 0, v126
    ds_write_b128 v124, v[32:35]
    s_waitcnt lgkmcnt(7)
    v_mfma_f32_16x16x32_bf16 v[44:47], v[80:83], v[92:95], v[44:47]
    v_mfma_f32_16x16x32_bf16 v[40:43], v[84:87], v[92:95], v[40:43]
    ds_read_b128 v[92:95], v122 offset:0
    v_xor_b32 v123, 0, v125
    ds_write_b128 v123, v[0:3]
    s_waitcnt lgkmcnt(8)
    v_mfma_f32_16x16x32_bf16 v[20:23], v[64:67], v[96:99], v[20:23]
    v_mfma_f32_16x16x32_bf16 v[16:19], v[68:71], v[96:99], v[16:19]
    v_mfma_f32_16x16x32_bf16 v[12:15], v[72:75], v[96:99], v[12:15]
    v_mfma_f32_16x16x32_bf16 v[8:11], v[76:79], v[96:99], v[8:11]
    ds_read_b128 v[96:99], v117 offset:9792
    v_xor_b32 v123, 16, v126
    ds_write_b128 v123, v[36:39]
    s_waitcnt lgkmcnt(9)
    v_mfma_f32_16x16x32_bf16 v[48:51], v[80:83], v[100:103], v[48:51]
    v_mfma_f32_16x16x32_bf16 v[44:47], v[84:87], v[100:103], v[44:47]
    ds_read_b128 v[100:103], v121 offset:9216
    v_xor_b32 v124, 16, v125
    ds_write_b128 v124, v[4:7]
    s_waitcnt lgkmcnt(10)
    v_mfma_f32_16x16x32_bf16 v[24:27], v[64:67], v[104:107], v[24:27]
    v_mfma_f32_16x16x32_bf16 v[20:23], v[68:71], v[104:107], v[20:23]
    v_mfma_f32_16x16x32_bf16 v[16:19], v[72:75], v[104:107], v[16:19]
    v_mfma_f32_16x16x32_bf16 v[12:15], v[76:79], v[104:107], v[12:15]
    ds_read_b128 v[104:107], v118 offset:8704
    v_xor_b32 v124, 32, v126
    ds_write_b128 v124, v[40:43]
    s_waitcnt lgkmcnt(11)
    v_mfma_f32_16x16x32_bf16 v[52:55], v[80:83], v[108:111], v[52:55]
    v_mfma_f32_16x16x32_bf16 v[48:51], v[84:87], v[108:111], v[48:51]
    ds_read_b128 v[108:111], v121 offset:10240
    v_xor_b32 v123, 32, v125
    ds_write_b128 v123, v[8:11]
    s_waitcnt lgkmcnt(12)
    v_mfma_f32_16x16x32_bf16 v[28:31], v[64:67], v[112:115], v[28:31]
    v_mfma_f32_16x16x32_bf16 v[24:27], v[68:71], v[112:115], v[24:27]
    v_mfma_f32_16x16x32_bf16 v[20:23], v[72:75], v[112:115], v[20:23]
    v_mfma_f32_16x16x32_bf16 v[16:19], v[76:79], v[112:115], v[16:19]
    v_xor_b32 v123, 48, v126
    ds_write_b128 v123, v[44:47]
    s_waitcnt lgkmcnt(12)
    v_mfma_f32_16x16x32_bf16 v[56:59], v[80:83], v[88:91], v[56:59]
    v_mfma_f32_16x16x32_bf16 v[52:55], v[84:87], v[88:91], v[52:55]
    v_xor_b32 v124, 48, v125
    ds_write_b128 v124, v[12:15]
    s_waitcnt lgkmcnt(11)
    v_mfma_f32_16x16x32_bf16 v[28:31], v[68:71], v[92:95], v[28:31]
    v_mfma_f32_16x16x32_bf16 v[24:27], v[72:75], v[92:95], v[24:27]
    v_mfma_f32_16x16x32_bf16 v[20:23], v[76:79], v[92:95], v[20:23]
    v_xor_b32 v124, 64, v126
    ds_write_b128 v124, v[48:51]
    s_waitcnt lgkmcnt(10)
    v_mfma_f32_16x16x32_bf16 v[60:63], v[80:83], v[96:99], v[60:63]
    v_mfma_f32_16x16x32_bf16 v[56:59], v[84:87], v[96:99], v[56:59]
    v_xor_b32 v123, 64, v125
    ds_write_b128 v123, v[16:19]
    s_waitcnt lgkmcnt(9)
    v_mfma_f32_16x16x32_bf16 v[28:31], v[72:75], v[100:103], v[28:31]
    v_mfma_f32_16x16x32_bf16 v[24:27], v[76:79], v[100:103], v[24:27]
    v_xor_b32 v123, 80, v126
    ds_write_b128 v123, v[52:55]
    s_waitcnt lgkmcnt(8)
    v_mfma_f32_16x16x32_bf16 v[60:63], v[84:87], v[104:107], v[60:63]
    v_xor_b32 v124, 80, v125
    ds_write_b128 v124, v[20:23]
    s_waitcnt lgkmcnt(7)
    v_mfma_f32_16x16x32_bf16 v[28:31], v[76:79], v[108:111], v[28:31]
    v_xor_b32 v124, 96, v126
    ds_write_b128 v124, v[56:59]
    s_nop 7
    v_xor_b32 v123, 96, v125
    ds_write_b128 v123, v[24:27]
    v_xor_b32 v123, 112, v126
    ds_write_b128 v123, v[60:63]
    v_xor_b32 v124, 112, v125
    ds_write_b128 v124, v[28:31]
    s_setprio 0
    s_branch L_conv1_kernel_epi
L_conv1_kernel_helper:
    s_setprio 3
    v_add_u32 v92, 0, v7
    v_add_u32 v93, 1024, v7
    v_add_u32 v94, 2048, v7
    v_add_u32 v95, 3072, v7
    v_and_b32 v76, 4, v5
    v_lshrrev_b32 v76, 1, v76
    v_xor_b32 v76, v6, v76
    v_lshlrev_b32 v76, 4, v76
    v_lshl_add_u32 v76, v5, 6, v76
    s_mov_b32 s24, 0
    buffer_load_dwordx4 v[0:3], v92, s[8:11], s24 offen offset:0
    buffer_load_dwordx4 v[16:19], v92, s[8:11], s24 offen offset:64
    v_add_u32 v92, 128, v92
    buffer_load_dwordx4 v[4:7], v93, s[8:11], s24 offen offset:0
    buffer_load_dwordx4 v[20:23], v93, s[8:11], s24 offen offset:64
    v_add_u32 v93, 128, v93
    buffer_load_dwordx4 v[8:11], v94, s[8:11], s24 offen offset:0
    buffer_load_dwordx4 v[24:27], v94, s[8:11], s24 offen offset:64
    v_add_u32 v94, 128, v94
    buffer_load_dwordx4 v[12:15], v95, s[8:11], s24 offen offset:0
    buffer_load_dwordx4 v[28:31], v95, s[8:11], s24 offen offset:64
    v_add_u32 v95, 128, v95
    s_barrier
    s_mul_i32 s36, s42, 1024
    v_add_u32 v96, s36, v76
    v_add_u32 v97, 65536, v96
    s_mul_i32 s36, s42, 1088
    s_add_u32 s36, s36, 98304
    v_add_u32 v98, s36, v76
    s_waitcnt vmcnt(0)
    s_mov_b32 s28, 0
    s_mov_b32 s22, 4
    s_cmp_ge_u32 s20, 12
    s_cbranch_scc1 L_conv1_kernel_h2
    ds_write_b128 v96, v[0:3] offset:0
    ds_write_b128 v98, v[12:15] offset:0
    v_lshlrev_b32 v76, 16, v0
    v_and_b32 v84, s25, v0
    v_lshlrev_b32 v77, 16, v4
    v_and_b32 v85, s25, v4
    v_lshlrev_b32 v78, 16, v8
    v_and_b32 v86, s25, v8
    v_lshlrev_b32 v79, 16, v12
    v_and_b32 v87, s25, v12
    v_add_f32 v80, v76, v78
    v_add_f32 v88, v84, v86
    v_add_f32 v81, v77, v79
    v_add_f32 v89, v85, v87
    v_fma_f32 v82, v78, 4.0, v76
    v_fma_f32 v90, v86, 4.0, v84
    v_fma_f32 v83, v79, 4.0, v77
    v_fma_f32 v91, v87, 4.0, v85
    v_add_f32 v77, v80, v81
    v_add_f32 v85, v88, v89
    v_sub_f32 v78, v80, v81
    v_sub_f32 v86, v88, v89
    v_fma_f32 v79, v83, 2.0, v82
    v_fma_f32 v87, v91, 2.0, v90
    v_fma_f32 v82, v83, -2.0, v82
    v_fma_f32 v90, v91, -2.0, v90
    v_fmamk_f32 v80, v76, 0x41700000, v82
    v_fmamk_f32 v88, v84, 0x41700000, v90
    v_fmamk_f32 v80, v81, 0x41200000, v80
    v_fmamk_f32 v88, v89, 0x41200000, v88
    v_cvt_pk_bf16_f32 v4, v77, v85
    v_cvt_pk_bf16_f32 v8, v78, v86
    v_cvt_pk_bf16_f32 v64, v79, v87
    v_cvt_pk_bf16_f32 v68, v82, v90
    v_cvt_pk_bf16_f32 v72, v80, v88
    v_lshlrev_b32 v76, 16, v1
    v_and_b32 v84, s25, v1
    v_lshlrev_b32 v77, 16, v5
    v_and_b32 v85, s25, v5
    v_lshlrev_b32 v78, 16, v9
    v_and_b32 v86, s25, v9
    v_lshlrev_b32 v79, 16, v13
    v_and_b32 v87, s25, v13
    v_add_f32 v80, v76, v78
    v_add_f32 v88, v84, v86
    v_add_f32 v81, v77, v79
    v_add_f32 v89, v85, v87
    v_fma_f32 v82, v78, 4.0, v76
    v_fma_f32 v90, v86, 4.0, v84
    v_fma_f32 v83, v79, 4.0, v77
    v_fma_f32 v91, v87, 4.0, v85
    v_add_f32 v77, v80, v81
    v_add_f32 v85, v88, v89
    v_sub_f32 v78, v80, v81
    v_sub_f32 v86, v88, v89
    v_fma_f32 v79, v83, 2.0, v82
    v_fma_f32 v87, v91, 2.0, v90
    v_fma_f32 v82, v83, -2.0, v82
    v_fma_f32 v90, v91, -2.0, v90
    v_fmamk_f32 v80, v76, 0x41700000, v82
    v_fmamk_f32 v88, v84, 0x41700000, v90
    v_fmamk_f32 v80, v81, 0x41200000, v80
    v_fmamk_f32 v88, v89, 0x41200000, v88
    v_cvt_pk_bf16_f32 v5, v77, v85
    v_cvt_pk_bf16_f32 v9, v78, v86
    v_cvt_pk_bf16_f32 v65, v79, v87
    v_cvt_pk_bf16_f32 v69, v82, v90
    v_cvt_pk_bf16_f32 v73, v80, v88
    v_lshlrev_b32 v76, 16, v2
    v_and_b32 v84, s25, v2
    v_lshlrev_b32 v77, 16, v6
    v_and_b32 v85, s25, v6
    v_lshlrev_b32 v78, 16, v10
    v_and_b32 v86, s25, v10
    v_lshlrev_b32 v79, 16, v14
    v_and_b32 v87, s25, v14
    v_add_f32 v80, v76, v78
    v_add_f32 v88, v84, v86
    v_add_f32 v81, v77, v79
    v_add_f32 v89, v85, v87
    v_fma_f32 v82, v78, 4.0, v76
    v_fma_f32 v90, v86, 4.0, v84
    v_fma_f32 v83, v79, 4.0, v77
    v_fma_f32 v91, v87, 4.0, v85
    v_add_f32 v77, v80, v81
    v_add_f32 v85, v88, v89
    v_sub_f32 v78, v80, v81
    v_sub_f32 v86, v88, v89
    v_fma_f32 v79, v83, 2.0, v82
    v_fma_f32 v87, v91, 2.0, v90
    v_fma_f32 v82, v83, -2.0, v82
    v_fma_f32 v90, v91, -2.0, v90
    v_fmamk_f32 v80, v76, 0x41700000, v82
    v_fmamk_f32 v88, v84, 0x41700000, v90
    v_fmamk_f32 v80, v81, 0x41200000, v80
    v_fmamk_f32 v88, v89, 0x41200000, v88
    v_cvt_pk_bf16_f32 v6, v77, v85
    v_cvt_pk_bf16_f32 v10, v78, v86
    v_cvt_pk_bf16_f32 v66, v79, v87
    v_cvt_pk_bf16_f32 v70, v82, v90
    v_cvt_pk_bf16_f32 v74, v80, v88
    v_lshlrev_b32 v76, 16, v3
    v_and_b32 v84, s25, v3
    v_lshlrev_b32 v77, 16, v7
    v_and_b32 v85, s25, v7
    v_lshlrev_b32 v78, 16, v11
    v_and_b32 v86, s25, v11
    v_lshlrev_b32 v79, 16, v15
    v_and_b32 v87, s25, v15
    v_add_f32 v80, v76, v78
    v_add_f32 v88, v84, v86
    v_add_f32 v81, v77, v79
    v_add_f32 v89, v85, v87
    v_fma_f32 v82, v78, 4.0, v76
    v_fma_f32 v90, v86, 4.0, v84
    v_fma_f32 v83, v79, 4.0, v77
    v_fma_f32 v91, v87, 4.0, v85
    v_add_f32 v77, v80, v81
    v_add_f32 v85, v88, v89
    v_sub_f32 v78, v80, v81
    v_sub_f32 v86, v88, v89
    v_fma_f32 v79, v83, 2.0, v82
    v_fma_f32 v87, v91, 2.0, v90
    v_fma_f32 v82, v83, -2.0, v82
    v_fma_f32 v90, v91, -2.0, v90
    v_fmamk_f32 v80, v76, 0x41700000, v82
    v_fmamk_f32 v88, v84, 0x41700000, v90
    v_fmamk_f32 v80, v81, 0x41200000, v80
    v_fmamk_f32 v88, v89, 0x41200000, v88
    v_cvt_pk_bf16_f32 v7, v77, v85
    v_cvt_pk_bf16_f32 v11, v78, v86
    v_cvt_pk_bf16_f32 v67, v79, v87
    v_cvt_pk_bf16_f32 v71, v82, v90
    v_cvt_pk_bf16_f32 v75, v80, v88
    ds_write_b128 v96, v[64:67] offset:49152
    ds_write_b128 v97, v[68:71] offset:0
    ds_write_b128 v97, v[72:75] offset:16384
    ds_write_b128 v96, v[4:7] offset:16384
    ds_write_b128 v96, v[8:11] offset:32768
    buffer_load_dwordx4 v[32:35], v92, s[8:11], s24 offen offset:0
    buffer_load_dwordx4 v[48:51], v92, s[8:11], s24 offen offset:64
    v_add_u32 v92, 128, v92
    buffer_load_dwordx4 v[36:39], v93, s[8:11], s24 offen offset:0
    buffer_load_dwordx4 v[52:55], v93, s[8:11], s24 offen offset:64
    v_add_u32 v93, 128, v93
    s_waitcnt lgkmcnt(0)
    s_barrier
    s_setprio 1
L_conv1_kernel_hloop1:
    s_cmp_lt_u32 s28, 13
    s_cselect_b32 s24, 0, 2130706432
    v_lshlrev_b32 v76, 16, v16
    v_and_b32 v84, s25, v16
    v_lshlrev_b32 v77, 16, v20
    v_and_b32 v85, s25, v20
    v_lshlrev_b32 v78, 16, v24
    v_and_b32 v86, s25, v24
    v_lshlrev_b32 v79, 16, v28
    v_and_b32 v87, s25, v28
    v_add_f32 v80, v76, v78
    v_add_f32 v88, v84, v86
    v_add_f32 v81, v77, v79
    v_add_f32 v89, v85, v87
    v_fma_f32 v82, v78, 4.0, v76
    buffer_load_dwordx4 v[40:43], v94, s[8:11], s24 offen offset:0
    buffer_load_dwordx4 v[56:59], v94, s[8:11], s24 offen offset:64
    v_add_u32 v94, 128, v94
    v_fma_f32 v90, v86, 4.0, v84
    v_fma_f32 v83, v79, 4.0, v77
    v_fma_f32 v91, v87, 4.0, v85
    v_add_f32 v77, v80, v81
    v_add_f32 v85, v88, v89
    v_sub_f32 v78, v80, v81
    v_sub_f32 v86, v88, v89
    v_fma_f32 v79, v83, 2.0, v82
    v_fma_f32 v87, v91, 2.0, v90
    v_fma_f32 v82, v83, -2.0, v82
    v_fma_f32 v90, v91, -2.0, v90
    v_fmamk_f32 v80, v76, 0x41700000, v82
    v_fmamk_f32 v88, v84, 0x41700000, v90
    v_fmamk_f32 v80, v81, 0x41200000, v80
    v_fmamk_f32 v88, v89, 0x41200000, v88
    v_cvt_pk_bf16_f32 v20, v77, v85
    v_cvt_pk_bf16_f32 v24, v78, v86
    v_cvt_pk_bf16_f32 v64, v79, v87
    v_cvt_pk_bf16_f32 v68, v82, v90
    v_cvt_pk_bf16_f32 v72, v80, v88
    v_lshlrev_b32 v76, 16, v17
    v_and_b32 v84, s25, v17
    v_lshlrev_b32 v77, 16, v21
    v_and_b32 v85, s25, v21
    v_lshlrev_b32 v78, 16, v25
    v_and_b32 v86, s25, v25
    v_lshlrev_b32 v79, 16, v29
    v_and_b32 v87, s25, v29
    v_add_f32 v80, v76, v78
    v_add_f32 v88, v84, v86
    v_add_f32 v81, v77, v79
    v_add_f32 v89, v85, v87
    v_fma_f32 v82, v78, 4.0, v76
    v_fma_f32 v90, v86, 4.0, v84
    v_fma_f32 v83, v79, 4.0, v77
    v_fma_f32 v91, v87, 4.0, v85
    v_add_f32 v77, v80, v81
    v_add_f32 v85, v88, v89
    v_sub_f32 v78, v80, v81
    v_sub_f32 v86, v88, v89
    v_fma_f32 v79, v83, 2.0, v82
    v_fma_f32 v87, v91, 2.0, v90
    v_fma_f32 v82, v83, -2.0, v82
    v_fma_f32 v90, v91, -2.0, v90
    v_fmamk_f32 v80, v76, 0x41700000, v82
    v_fmamk_f32 v88, v84, 0x41700000, v90
    v_fmamk_f32 v80, v81, 0x41200000, v80
    v_fmamk_f32 v88, v89, 0x41200000, v88
    v_cvt_pk_bf16_f32 v21, v77, v85
    v_cvt_pk_bf16_f32 v25, v78, v86
    v_cvt_pk_bf16_f32 v65, v79, v87
    v_cvt_pk_bf16_f32 v69, v82, v90
    v_cvt_pk_bf16_f32 v73, v80, v88
    buffer_load_dwordx4 v[44:47], v95, s[8:11], s24 offen offset:0
    buffer_load_dwordx4 v[60:63], v95, s[8:11], s24 offen offset:64
    v_add_u32 v95, 128, v95
    v_lshlrev_b32 v76, 16, v18
    v_and_b32 v84, s25, v18
    v_lshlrev_b32 v77, 16, v22
    v_and_b32 v85, s25, v22
    v_lshlrev_b32 v78, 16, v26
    v_and_b32 v86, s25, v26
    v_lshlrev_b32 v79, 16, v30
    v_and_b32 v87, s25, v30
    v_add_f32 v80, v76, v78
    v_add_f32 v88, v84, v86
    v_add_f32 v81, v77, v79
    v_add_f32 v89, v85, v87
    v_fma_f32 v82, v78, 4.0, v76
    v_fma_f32 v90, v86, 4.0, v84
    v_fma_f32 v83, v79, 4.0, v77
    v_fma_f32 v91, v87, 4.0, v85
    v_add_f32 v77, v80, v81
    v_add_f32 v85, v88, v89
    v_sub_f32 v78, v80, v81
    v_sub_f32 v86, v88, v89
    v_fma_f32 v79, v83, 2.0, v82
    v_fma_f32 v87, v91, 2.0, v90
    v_fma_f32 v82, v83, -2.0, v82
    v_fma_f32 v90, v91, -2.0, v90
    v_fmamk_f32 v80, v76, 0x41700000, v82
    v_fmamk_f32 v88, v84, 0x41700000, v90
    v_fmamk_f32 v80, v81, 0x41200000, v80
    v_fmamk_f32 v88, v89, 0x41200000, v88
    v_cvt_pk_bf16_f32 v22, v77, v85
    v_cvt_pk_bf16_f32 v26, v78, v86
    v_cvt_pk_bf16_f32 v66, v79, v87
    v_cvt_pk_bf16_f32 v70, v82, v90
    v_cvt_pk_bf16_f32 v74, v80, v88
    v_lshlrev_b32 v76, 16, v19
    v_and_b32 v84, s25, v19
    v_lshlrev_b32 v77, 16, v23
    v_and_b32 v85, s25, v23
    v_lshlrev_b32 v78, 16, v27
    v_and_b32 v86, s25, v27
    v_lshlrev_b32 v79, 16, v31
    v_and_b32 v87, s25, v31
    v_add_f32 v80, v76, v78
    v_add_f32 v88, v84, v86
    v_add_f32 v81, v77, v79
    v_add_f32 v89, v85, v87
    v_fma_f32 v82, v78, 4.0, v76
    v_fma_f32 v90, v86, 4.0, v84
    v_fma_f32 v83, v79, 4.0, v77
    v_fma_f32 v91, v87, 4.0, v85
    v_add_f32 v77, v80, v81
    v_add_f32 v85, v88, v89
    v_sub_f32 v78, v80, v81
    v_sub_f32 v86, v88, v89
    v_fma_f32 v79, v83, 2.0, v82
    v_fma_f32 v87, v91, 2.0, v90
    v_fma_f32 v82, v83, -2.0, v82
    v_fma_f32 v90, v91, -2.0, v90
    v_fmamk_f32 v80, v76, 0x41700000, v82
    v_fmamk_f32 v88, v84, 0x41700000, v90
    v_fmamk_f32 v80, v81, 0x41200000, v80
    v_fmamk_f32 v88, v89, 0x41200000, v88
    v_cvt_pk_bf16_f32 v23, v77, v85
    v_cvt_pk_bf16_f32 v27, v78, v86
    v_cvt_pk_bf16_f32 v67, v79, v87
    v_cvt_pk_bf16_f32 v71, v82, v90
    v_cvt_pk_bf16_f32 v75, v80, v88
    ds_write_b128 v96, v[64:67] offset:57344
    ds_write_b128 v97, v[68:71] offset:8192
    ds_write_b128 v97, v[72:75] offset:24576
    ds_write_b128 v96, v[16:19] offset:8192
    ds_write_b128 v96, v[20:23] offset:24576
    ds_write_b128 v96, v[24:27] offset:40960
    ds_write_b128 v98, v[28:31] offset:8704
    s_add_u32 s28, s28, 1
    s_waitcnt lgkmcnt(0)
    s_barrier
    s_cmp_lt_u32 s28, 13
    s_cselect_b32 s24, 0, 2130706432
    s_waitcnt vmcnt(0)
    v_lshlrev_b32 v76, 16, v32
    v_and_b32 v84, s25, v32
    v_lshlrev_b32 v77, 16, v36
    v_and_b32 v85, s25, v36
    v_lshlrev_b32 v78, 16, v40
    v_and_b32 v86, s25, v40
    v_lshlrev_b32 v79, 16, v44
    v_and_b32 v87, s25, v44
    v_add_f32 v80, v76, v78
    v_add_f32 v88, v84, v86
    v_add_f32 v81, v77, v79
    v_add_f32 v89, v85, v87
    v_fma_f32 v82, v78, 4.0, v76
    v_fma_f32 v90, v86, 4.0, v84
    v_fma_f32 v83, v79, 4.0, v77
    v_fma_f32 v91, v87, 4.0, v85
    v_add_f32 v77, v80, v81
    v_add_f32 v85, v88, v89
    v_sub_f32 v78, v80, v81
    v_sub_f32 v86, v88, v89
    v_fma_f32 v79, v83, 2.0, v82
    v_fma_f32 v87, v91, 2.0, v90
    v_fma_f32 v82, v83, -2.0, v82
    v_fma_f32 v90, v91, -2.0, v90
    v_fmamk_f32 v80, v76, 0x41700000, v82
    v_fmamk_f32 v88, v84, 0x41700000, v90
    v_fmamk_f32 v80, v81, 0x41200000, v80
    v_fmamk_f32 v88, v89, 0x41200000, v88
    v_cvt_pk_bf16_f32 v36, v77, v85
    v_cvt_pk_bf16_f32 v40, v78, v86
    v_cvt_pk_bf16_f32 v64, v79, v87
    v_cvt_pk_bf16_f32 v68, v82, v90
    v_cvt_pk_bf16_f32 v72, v80, v88
    v_lshlrev_b32 v76, 16, v33
    v_and_b32 v84, s25, v33
    v_lshlrev_b32 v77, 16, v37
    v_and_b32 v85, s25, v37
    v_lshlrev_b32 v78, 16, v41
    v_and_b32 v86, s25, v41
    buffer_load_dwordx4 v[0:3], v92, s[8:11], s24 offen offset:0
    buffer_load_dwordx4 v[16:19], v92, s[8:11], s24 offen offset:64
    v_add_u32 v92, 128, v92
    v_lshlrev_b32 v79, 16, v45
    v_and_b32 v87, s25, v45
    v_add_f32 v80, v76, v78
    v_add_f32 v88, v84, v86
    v_add_f32 v81, v77, v79
    v_add_f32 v89, v85, v87
    v_fma_f32 v82, v78, 4.0, v76
    v_fma_f32 v90, v86, 4.0, v84
    v_fma_f32 v83, v79, 4.0, v77
    v_fma_f32 v91, v87, 4.0, v85
    v_add_f32 v77, v80, v81
    v_add_f32 v85, v88, v89
    v_sub_f32 v78, v80, v81
    v_sub_f32 v86, v88, v89
    v_fma_f32 v79, v83, 2.0, v82
    v_fma_f32 v87, v91, 2.0, v90
    v_fma_f32 v82, v83, -2.0, v82
    v_fma_f32 v90, v91, -2.0, v90
    v_fmamk_f32 v80, v76, 0x41700000, v82
    v_fmamk_f32 v88, v84, 0x41700000, v90
    v_fmamk_f32 v80, v81, 0x41200000, v80
    v_fmamk_f32 v88, v89, 0x41200000, v88
    v_cvt_pk_bf16_f32 v37, v77, v85
    v_cvt_pk_bf16_f32 v41, v78, v86
    v_cvt_pk_bf16_f32 v65, v79, v87
    v_cvt_pk_bf16_f32 v69, v82, v90
    v_cvt_pk_bf16_f32 v73, v80, v88
    v_lshlrev_b32 v76, 16, v34
    v_and_b32 v84, s25, v34
    v_lshlrev_b32 v77, 16, v38
    v_and_b32 v85, s25, v38
    v_lshlrev_b32 v78, 16, v42
    v_and_b32 v86, s25, v42
    v_lshlrev_b32 v79, 16, v46
    v_and_b32 v87, s25, v46
    v_add_f32 v80, v76, v78
    v_add_f32 v88, v84, v86
    v_add_f32 v81, v77, v79
    v_add_f32 v89, v85, v87
    v_fma_f32 v82, v78, 4.0, v76
    v_fma_f32 v90, v86, 4.0, v84
    v_fma_f32 v83, v79, 4.0, v77
    v_fma_f32 v91, v87, 4.0, v85
    v_add_f32 v77, v80, v81
    v_add_f32 v85, v88, v89
    v_sub_f32 v78, v80, v81
    v_sub_f32 v86, v88, v89
    v_fma_f32 v79, v83, 2.0, v82
    v_fma_f32 v87, v91, 2.0, v90
    v_fma_f32 v82, v83, -2.0, v82
    v_fma_f32 v90, v91, -2.0, v90
    v_fmamk_f32 v80, v76, 0x41700000, v82
    v_fmamk_f32 v88, v84, 0x41700000, v90
    buffer_load_dwordx4 v[4:7], v93, s[8:11], s24 offen offset:0
    buffer_load_dwordx4 v[20:23], v93, s[8:11], s24 offen offset:64
    v_add_u32 v93, 128, v93
    v_fmamk_f32 v80, v81, 0x41200000, v80
    v_fmamk_f32 v88, v89, 0x41200000, v88
    v_cvt_pk_bf16_f32 v38, v77, v85
    v_cvt_pk_bf16_f32 v42, v78, v86
    v_cvt_pk_bf16_f32 v66, v79, v87
    v_cvt_pk_bf16_f32 v70, v82, v90
    v_cvt_pk_bf16_f32 v74, v80, v88
    v_lshlrev_b32 v76, 16, v35
    v_and_b32 v84, s25, v35
    v_lshlrev_b32 v77, 16, v39
    v_and_b32 v85, s25, v39
    v_lshlrev_b32 v78, 16, v43
    v_and_b32 v86, s25, v43
    v_lshlrev_b32 v79, 16, v47
    v_and_b32 v87, s25, v47
    v_add_f32 v80, v76, v78
    v_add_f32 v88, v84, v86
    v_add_f32 v81, v77, v79
    v_add_f32 v89, v85, v87
    v_fma_f32 v82, v78, 4.0, v76
    v_fma_f32 v90, v86, 4.0, v84
    v_fma_f32 v83, v79, 4.0, v77
    v_fma_f32 v91, v87, 4.0, v85
    v_add_f32 v77, v80, v81
    v_add_f32 v85, v88, v89
    v_sub_f32 v78, v80, v81
    v_sub_f32 v86, v88, v89
    v_fma_f32 v79, v83, 2.0, v82
    v_fma_f32 v87, v91, 2.0, v90
    v_fma_f32 v82, v83, -2.0, v82
    v_fma_f32 v90, v91, -2.0, v90
    v_fmamk_f32 v80, v76, 0x41700000, v82
    v_fmamk_f32 v88, v84, 0x41700000, v90
    v_fmamk_f32 v80, v81, 0x41200000, v80
    v_fmamk_f32 v88, v89, 0x41200000, v88
    v_cvt_pk_bf16_f32 v39, v77, v85
    v_cvt_pk_bf16_f32 v43, v78, v86
    v_cvt_pk_bf16_f32 v67, v79, v87
    v_cvt_pk_bf16_f32 v71, v82, v90
    v_cvt_pk_bf16_f32 v75, v80, v88
    ds_write_b128 v96, v[64:67] offset:49152
    ds_write_b128 v97, v[68:71] offset:0
    ds_write_b128 v97, v[72:75] offset:16384
    ds_write_b128 v96, v[32:35] offset:0
    ds_write_b128 v96, v[36:39] offset:16384
    ds_write_b128 v96, v[40:43] offset:32768
    ds_write_b128 v98, v[44:47] offset:0
    s_add_u32 s28, s28, 1
    s_waitcnt lgkmcnt(0)
    s_barrier
    s_cmp_lt_u32 s28, 13
    s_cselect_b32 s24, 0, 2130706432
    v_lshlrev_b32 v76, 16, v48
    v_and_b32 v84, s25, v48
    v_lshlrev_b32 v77, 16, v52
    v_and_b32 v85, s25, v52
    v_lshlrev_b32 v78, 16, v56
    v_and_b32 v86, s25, v56
    v_lshlrev_b32 v79, 16, v60
    v_and_b32 v87, s25, v60
    v_add_f32 v80, v76, v78
    v_add_f32 v88, v84, v86
    v_add_f32 v81, v77, v79
    v_add_f32 v89, v85, v87
    v_fma_f32 v82, v78, 4.0, v76
    buffer_load_dwordx4 v[8:11], v94, s[8:11], s24 offen offset:0
    buffer_load_dwordx4 v[24:27], v94, s[8:11], s24 offen offset:64
    v_add_u32 v94, 128, v94
    v_fma_f32 v90, v86, 4.0, v84
    v_fma_f32 v83, v79, 4.0, v77
    v_fma_f32 v91, v87, 4.0, v85
    v_add_f32 v77, v80, v81
    v_add_f32 v85, v88, v89
    v_sub_f32 v78, v80, v81
    v_sub_f32 v86, v88, v89
    v_fma_f32 v79, v83, 2.0, v82
    v_fma_f32 v87, v91, 2.0, v90
    v_fma_f32 v82, v83, -2.0, v82
    v_fma_f32 v90, v91, -2.0, v90
    v_fmamk_f32 v80, v76, 0x41700000, v82
    v_fmamk_f32 v88, v84, 0x41700000, v90
    v_fmamk_f32 v80, v81, 0x41200000, v80
    v_fmamk_f32 v88, v89, 0x41200000, v88
    v_cvt_pk_bf16_f32 v52, v77, v85
    v_cvt_pk_bf16_f32 v56, v78, v86
    v_cvt_pk_bf16_f32 v64, v79, v87
    v_cvt_pk_bf16_f32 v68, v82, v90
    v_cvt_pk_bf16_f32 v72, v80, v88
    v_lshlrev_b32 v76, 16, v49
    v_and_b32 v84, s25, v49
    v_lshlrev_b32 v77, 16, v53
    v_and_b32 v85, s25, v53
    v_lshlrev_b32 v78, 16, v57
    v_and_b32 v86, s25, v57
    v_lshlrev_b32 v79, 16, v61
    v_and_b32 v87, s25, v61
    v_add_f32 v80, v76, v78
    v_add_f32 v88, v84, v86
    v_add_f32 v81, v77, v79
    v_add_f32 v89, v85, v87
    v_fma_f32 v82, v78, 4.0, v76
    v_fma_f32 v90, v86, 4.0, v84
    v_fma_f32 v83, v79, 4.0, v77
    v_fma_f32 v91, v87, 4.0, v85
    v_add_f32 v77, v80, v81
    v_add_f32 v85, v88, v89
    v_sub_f32 v78, v80, v81
    v_sub_f32 v86, v88, v89
    v_fma_f32 v79, v83, 2.0, v82
    v_fma_f32 v87, v91, 2.0, v90
    v_fma_f32 v82, v83, -2.0, v82
    v_fma_f32 v90, v91, -2.0, v90
    v_fmamk_f32 v80, v76, 0x41700000, v82
    v_fmamk_f32 v88, v84, 0x41700000, v90
    v_fmamk_f32 v80, v81, 0x41200000, v80
    v_fmamk_f32 v88, v89, 0x41200000, v88
    v_cvt_pk_bf16_f32 v53, v77, v85
    v_cvt_pk_bf16_f32 v57, v78, v86
    v_cvt_pk_bf16_f32 v65, v79, v87
    v_cvt_pk_bf16_f32 v69, v82, v90
    v_cvt_pk_bf16_f32 v73, v80, v88
    buffer_load_dwordx4 v[12:15], v95, s[8:11], s24 offen offset:0
    buffer_load_dwordx4 v[28:31], v95, s[8:11], s24 offen offset:64
    v_add_u32 v95, 128, v95
    v_lshlrev_b32 v76, 16, v50
    v_and_b32 v84, s25, v50
    v_lshlrev_b32 v77, 16, v54
    v_and_b32 v85, s25, v54
    v_lshlrev_b32 v78, 16, v58
    v_and_b32 v86, s25, v58
    v_lshlrev_b32 v79, 16, v62
    v_and_b32 v87, s25, v62
    v_add_f32 v80, v76, v78
    v_add_f32 v88, v84, v86
    v_add_f32 v81, v77, v79
    v_add_f32 v89, v85, v87
    v_fma_f32 v82, v78, 4.0, v76
    v_fma_f32 v90, v86, 4.0, v84
    v_fma_f32 v83, v79, 4.0, v77
    v_fma_f32 v91, v87, 4.0, v85
    v_add_f32 v77, v80, v81
    v_add_f32 v85, v88, v89
    v_sub_f32 v78, v80, v81
    v_sub_f32 v86, v88, v89
    v_fma_f32 v79, v83, 2.0, v82
    v_fma_f32 v87, v91, 2.0, v90
    v_fma_f32 v82, v83, -2.0, v82
    v_fma_f32 v90, v91, -2.0, v90
    v_fmamk_f32 v80, v76, 0x41700000, v82
    v_fmamk_f32 v88, v84, 0x41700000, v90
    v_fmamk_f32 v80, v81, 0x41200000, v80
    v_fmamk_f32 v88, v89, 0x41200000, v88
    v_cvt_pk_bf16_f32 v54, v77, v85
    v_cvt_pk_bf16_f32 v58, v78, v86
    v_cvt_pk_bf16_f32 v66, v79, v87
    v_cvt_pk_bf16_f32 v70, v82, v90
    v_cvt_pk_bf16_f32 v74, v80, v88
    v_lshlrev_b32 v76, 16, v51
    v_and_b32 v84, s25, v51
    v_lshlrev_b32 v77, 16, v55
    v_and_b32 v85, s25, v55
    v_lshlrev_b32 v78, 16, v59
    v_and_b32 v86, s25, v59
    v_lshlrev_b32 v79, 16, v63
    v_and_b32 v87, s25, v63
    v_add_f32 v80, v76, v78
    v_add_f32 v88, v84, v86
    v_add_f32 v81, v77, v79
    v_add_f32 v89, v85, v87
    v_fma_f32 v82, v78, 4.0, v76
    v_fma_f32 v90, v86, 4.0, v84
    v_fma_f32 v83, v79, 4.0, v77
    v_fma_f32 v91, v87, 4.0, v85
    v_add_f32 v77, v80, v81
    v_add_f32 v85, v88, v89
    v_sub_f32 v78, v80, v81
    v_sub_f32 v86, v88, v89
    v_fma_f32 v79, v83, 2.0, v82
    v_fma_f32 v87, v91, 2.0, v90
    v_fma_f32 v82, v83, -2.0, v82
    v_fma_f32 v90, v91, -2.0, v90
    v_fmamk_f32 v80, v76, 0x41700000, v82
    v_fmamk_f32 v88, v84, 0x41700000, v90
    v_fmamk_f32 v80, v81, 0x41200000, v80
    v_fmamk_f32 v88, v89, 0x41200000, v88
    v_cvt_pk_bf16_f32 v55, v77, v85
    v_cvt_pk_bf16_f32 v59, v78, v86
    v_cvt_pk_bf16_f32 v67, v79, v87
    v_cvt_pk_bf16_f32 v71, v82, v90
    v_cvt_pk_bf16_f32 v75, v80, v88
    ds_write_b128 v96, v[64:67] offset:57344
    ds_write_b128 v97, v[68:71] offset:8192
    ds_write_b128 v97, v[72:75] offset:24576
    ds_write_b128 v96, v[48:51] offset:8192
    ds_write_b128 v96, v[52:55] offset:24576
    ds_write_b128 v96, v[56:59] offset:40960
    ds_write_b128 v98, v[60:63] offset:8704
    s_add_u32 s28, s28, 1
    s_waitcnt lgkmcnt(0)
    s_barrier
    s_cmp_eq_u32 s22, 1
    s_cbranch_scc1 L_conv1_kernel_hlast1
    s_cmp_lt_u32 s28, 13
    s_cselect_b32 s24, 0, 2130706432
    s_waitcnt vmcnt(0)
    v_lshlrev_b32 v76, 16, v0
    v_and_b32 v84, s25, v0
    v_lshlrev_b32 v77, 16, v4
    v_and_b32 v85, s25, v4
    v_lshlrev_b32 v78, 16, v8
    v_and_b32 v86, s25, v8
    v_lshlrev_b32 v79, 16, v12
    v_and_b32 v87, s25, v12
    v_add_f32 v80, v76, v78
    v_add_f32 v88, v84, v86
    v_add_f32 v81, v77, v79
    v_add_f32 v89, v85, v87
    v_fma_f32 v82, v78, 4.0, v76
    v_fma_f32 v90, v86, 4.0, v84
    v_fma_f32 v83, v79, 4.0, v77
    v_fma_f32 v91, v87, 4.0, v85
    v_add_f32 v77, v80, v81
    v_add_f32 v85, v88, v89
    v_sub_f32 v78, v80, v81
    v_sub_f32 v86, v88, v89
    v_fma_f32 v79, v83, 2.0, v82
    v_fma_f32 v87, v91, 2.0, v90
    v_fma_f32 v82, v83, -2.0, v82
    v_fma_f32 v90, v91, -2.0, v90
    v_fmamk_f32 v80, v76, 0x41700000, v82
    v_fmamk_f32 v88, v84, 0x41700000, v90
    v_fmamk_f32 v80, v81, 0x41200000, v80
    v_fmamk_f32 v88, v89, 0x41200000, v88
    v_cvt_pk_bf16_f32 v4, v77, v85
    v_cvt_pk_bf16_f32 v8, v78, v86
    v_cvt_pk_bf16_f32 v64, v79, v87
    v_cvt_pk_bf16_f32 v68, v82, v90
    v_cvt_pk_bf16_f32 v72, v80, v88
    v_lshlrev_b32 v76, 16, v1
    v_and_b32 v84, s25, v1
    v_lshlrev_b32 v77, 16, v5
    v_and_b32 v85, s25, v5
    v_lshlrev_b32 v78, 16, v9
    v_and_b32 v86, s25, v9
    buffer_load_dwordx4 v[32:35], v92, s[8:11], s24 offen offset:0
    buffer_load_dwordx4 v[48:51], v92, s[8:11], s24 offen offset:64
    v_add_u32 v92, 128, v92
    v_lshlrev_b32 v79, 16, v13
    v_and_b32 v87, s25, v13
    v_add_f32 v80, v76, v78
    v_add_f32 v88, v84, v86
    v_add_f32 v81, v77, v79
    v_add_f32 v89, v85, v87
    v_fma_f32 v82, v78, 4.0, v76
    v_fma_f32 v90, v86, 4.0, v84
    v_fma_f32 v83, v79, 4.0, v77
    v_fma_f32 v91, v87, 4.0, v85
    v_add_f32 v77, v80, v81
    v_add_f32 v85, v88, v89
    v_sub_f32 v78, v80, v81
    v_sub_f32 v86, v88, v89
    v_fma_f32 v79, v83, 2.0, v82
    v_fma_f32 v87, v91, 2.0, v90
    v_fma_f32 v82, v83, -2.0, v82
    v_fma_f32 v90, v91, -2.0, v90
    v_fmamk_f32 v80, v76, 0x41700000, v82
    v_fmamk_f32 v88, v84, 0x41700000, v90
    v_fmamk_f32 v80, v81, 0x41200000, v80
    v_fmamk_f32 v88, v89, 0x41200000, v88
    v_cvt_pk_bf16_f32 v5, v77, v85
    v_cvt_pk_bf16_f32 v9, v78, v86
    v_cvt_pk_bf16_f32 v65, v79, v87
    v_cvt_pk_bf16_f32 v69, v82, v90
    v_cvt_pk_bf16_f32 v73, v80, v88
    v_lshlrev_b32 v76, 16, v2
    v_and_b32 v84, s25, v2
    v_lshlrev_b32 v77, 16, v6
    v_and_b32 v85, s25, v6
    v_lshlrev_b32 v78, 16, v10
    v_and_b32 v86, s25, v10
    v_lshlrev_b32 v79, 16, v14
    v_and_b32 v87, s25, v14
    v_add_f32 v80, v76, v78
    v_add_f32 v88, v84, v86
    v_add_f32 v81, v77, v79
    v_add_f32 v89, v85, v87
    v_fma_f32 v82, v78, 4.0, v76
    v_fma_f32 v90, v86, 4.0, v84
    v_fma_f32 v83, v79, 4.0, v77
    v_fma_f32 v91, v87, 4.0, v85
    v_add_f32 v77, v80, v81
    v_add_f32 v85, v88, v89
    v_sub_f32 v78, v80, v81
    v_sub_f32 v86, v88, v89
    v_fma_f32 v79, v83, 2.0, v82
    v_fma_f32 v87, v91, 2.0, v90
    v_fma_f32 v82, v83, -2.0, v82
    v_fma_f32 v90, v91, -2.0, v90
    v_fmamk_f32 v80, v76, 0x41700000, v82
    v_fmamk_f32 v88, v84, 0x41700000, v90
    buffer_load_dwordx4 v[36:39], v93, s[8:11], s24 offen offset:0
    buffer_load_dwordx4 v[52:55], v93, s[8:11], s24 offen offset:64
    v_add_u32 v93, 128, v93
    v_fmamk_f32 v80, v81, 0x41200000, v80
    v_fmamk_f32 v88, v89, 0x41200000, v88
    v_cvt_pk_bf16_f32 v6, v77, v85
    v_cvt_pk_bf16_f32 v10, v78, v86
    v_cvt_pk_bf16_f32 v66, v79, v87
    v_cvt_pk_bf16_f32 v70, v82, v90
    v_cvt_pk_bf16_f32 v74, v80, v88
    v_lshlrev_b32 v76, 16, v3
    v_and_b32 v84, s25, v3
    v_lshlrev_b32 v77, 16, v7
    v_and_b32 v85, s25, v7
    v_lshlrev_b32 v78, 16, v11
    v_and_b32 v86, s25, v11
    v_lshlrev_b32 v79, 16, v15
    v_and_b32 v87, s25, v15
    v_add_f32 v80, v76, v78
    v_add_f32 v88, v84, v86
    v_add_f32 v81, v77, v79
    v_add_f32 v89, v85, v87
    v_fma_f32 v82, v78, 4.0, v76
    v_fma_f32 v90, v86, 4.0, v84
    v_fma_f32 v83, v79, 4.0, v77
    v_fma_f32 v91, v87, 4.0, v85
    v_add_f32 v77, v80, v81
    v_add_f32 v85, v88, v89
    v_sub_f32 v78, v80, v81
    v_sub_f32 v86, v88, v89
    v_fma_f32 v79, v83, 2.0, v82
    v_fma_f32 v87, v91, 2.0, v90
    v_fma_f32 v82, v83, -2.0, v82
    v_fma_f32 v90, v91, -2.0, v90
    v_fmamk_f32 v80, v76, 0x41700000, v82
    v_fmamk_f32 v88, v84, 0x41700000, v90
    v_fmamk_f32 v80, v81, 0x41200000, v80
    v_fmamk_f32 v88, v89, 0x41200000, v88
    v_cvt_pk_bf16_f32 v7, v77, v85
    v_cvt_pk_bf16_f32 v11, v78, v86
    v_cvt_pk_bf16_f32 v67, v79, v87
    v_cvt_pk_bf16_f32 v71, v82, v90
    v_cvt_pk_bf16_f32 v75, v80, v88
    ds_write_b128 v96, v[64:67] offset:49152
    ds_write_b128 v97, v[68:71] offset:0
    ds_write_b128 v97, v[72:75] offset:16384
    ds_write_b128 v96, v[0:3] offset:0
    ds_write_b128 v96, v[4:7] offset:16384
    ds_write_b128 v96, v[8:11] offset:32768
    ds_write_b128 v98, v[12:15] offset:0
    s_add_u32 s28, s28, 1
    s_waitcnt lgkmcnt(0)
    s_barrier
    s_sub_u32 s22, s22, 1
    s_branch L_conv1_kernel_hloop1
L_conv1_kernel_hlast1:
    s_branch L_conv1_kernel_end
L_conv1_kernel_h2:
    ds_write_b128 v96, v[0:3] offset:0
    ds_write_b128 v98, v[12:15] offset:0
    v_lshlrev_b32 v76, 16, v0
    v_and_b32 v84, s25, v0
    v_lshlrev_b32 v77, 16, v4
    v_and_b32 v85, s25, v4
    v_lshlrev_b32 v78, 16, v8
    v_and_b32 v86, s25, v8
    v_lshlrev_b32 v79, 16, v12
    v_and_b32 v87, s25, v12
    v_add_f32 v80, v76, v78
    v_add_f32 v88, v84, v86
    v_add_f32 v81, v77, v79
    v_add_f32 v89, v85, v87
    v_fma_f32 v82, v78, 4.0, v76
    v_fma_f32 v90, v86, 4.0, v84
    v_fma_f32 v83, v79, 4.0, v77
    v_fma_f32 v91, v87, 4.0, v85
    v_add_f32 v77, v80, v81
    v_add_f32 v85, v88, v89
    v_sub_f32 v78, v80, v81
    v_sub_f32 v86, v88, v89
    v_fma_f32 v79, v83, 2.0, v82
    v_fma_f32 v87, v91, 2.0, v90
    v_fma_f32 v82, v83, -2.0, v82
    v_fma_f32 v90, v91, -2.0, v90
    v_fmamk_f32 v80, v76, 0x41700000, v82
    v_fmamk_f32 v88, v84, 0x41700000, v90
    v_fmamk_f32 v80, v81, 0x41200000, v80
    v_fmamk_f32 v88, v89, 0x41200000, v88
    v_cvt_pk_bf16_f32 v4, v77, v85
    v_cvt_pk_bf16_f32 v8, v78, v86
    v_cvt_pk_bf16_f32 v64, v79, v87
    v_cvt_pk_bf16_f32 v68, v82, v90
    v_cvt_pk_bf16_f32 v72, v80, v88
    v_lshlrev_b32 v76, 16, v1
    v_and_b32 v84, s25, v1
    v_lshlrev_b32 v77, 16, v5
    v_and_b32 v85, s25, v5
    v_lshlrev_b32 v78, 16, v9
    v_and_b32 v86, s25, v9
    v_lshlrev_b32 v79, 16, v13
    v_and_b32 v87, s25, v13
    v_add_f32 v80, v76, v78
    v_add_f32 v88, v84, v86
    v_add_f32 v81, v77, v79
    v_add_f32 v89, v85, v87
    v_fma_f32 v82, v78, 4.0, v76
    v_fma_f32 v90, v86, 4.0, v84
    v_fma_f32 v83, v79, 4.0, v77
    v_fma_f32 v91, v87, 4.0, v85
    v_add_f32 v77, v80, v81
    v_add_f32 v85, v88, v89
    v_sub_f32 v78, v80, v81
    v_sub_f32 v86, v88, v89
    v_fma_f32 v79, v83, 2.0, v82
    v_fma_f32 v87, v91, 2.0, v90
    v_fma_f32 v82, v83, -2.0, v82
    v_fma_f32 v90, v91, -2.0, v90
    v_fmamk_f32 v80, v76, 0x41700000, v82
    v_fmamk_f32 v88, v84, 0x41700000, v90
    v_fmamk_f32 v80, v81, 0x41200000, v80
    v_fmamk_f32 v88, v89, 0x41200000, v88
    v_cvt_pk_bf16_f32 v5, v77, v85
    v_cvt_pk_bf16_f32 v9, v78, v86
    v_cvt_pk_bf16_f32 v65, v79, v87
    v_cvt_pk_bf16_f32 v69, v82, v90
    v_cvt_pk_bf16_f32 v73, v80, v88
    v_lshlrev_b32 v76, 16, v2
    v_and_b32 v84, s25, v2
    v_lshlrev_b32 v77, 16, v6
    v_and_b32 v85, s25, v6
    v_lshlrev_b32 v78, 16, v10
    v_and_b32 v86, s25, v10
    v_lshlrev_b32 v79, 16, v14
    v_and_b32 v87, s25, v14
    v_add_f32 v80, v76, v78
    v_add_f32 v88, v84, v86
    v_add_f32 v81, v77, v79
    v_add_f32 v89, v85, v87
    v_fma_f32 v82, v78, 4.0, v76
    v_fma_f32 v90, v86, 4.0, v84
    v_fma_f32 v83, v79, 4.0, v77
    v_fma_f32 v91, v87, 4.0, v85
    v_add_f32 v77, v80, v81
    v_add_f32 v85, v88, v89
    v_sub_f32 v78, v80, v81
    v_sub_f32 v86, v88, v89
    v_fma_f32 v79, v83, 2.0, v82
    v_fma_f32 v87, v91, 2.0, v90
    v_fma_f32 v82, v83, -2.0, v82
    v_fma_f32 v90, v91, -2.0, v90
    v_fmamk_f32 v80, v76, 0x41700000, v82
    v_fmamk_f32 v88, v84, 0x41700000, v90
    v_fmamk_f32 v80, v81, 0x41200000, v80
    v_fmamk_f32 v88, v89, 0x41200000, v88
    v_cvt_pk_bf16_f32 v6, v77, v85
    v_cvt_pk_bf16_f32 v10, v78, v86
    v_cvt_pk_bf16_f32 v66, v79, v87
    v_cvt_pk_bf16_f32 v70, v82, v90
    v_cvt_pk_bf16_f32 v74, v80, v88
    v_lshlrev_b32 v76, 16, v3
    v_and_b32 v84, s25, v3
    v_lshlrev_b32 v77, 16, v7
    v_and_b32 v85, s25, v7
    v_lshlrev_b32 v78, 16, v11
    v_and_b32 v86, s25, v11
    v_lshlrev_b32 v79, 16, v15
    v_and_b32 v87, s25, v15
    v_add_f32 v80, v76, v78
    v_add_f32 v88, v84, v86
    v_add_f32 v81, v77, v79
    v_add_f32 v89, v85, v87
    v_fma_f32 v82, v78, 4.0, v76
    v_fma_f32 v90, v86, 4.0, v84
    v_fma_f32 v83, v79, 4.0, v77
    v_fma_f32 v91, v87, 4.0, v85
    v_add_f32 v77, v80, v81
    v_add_f32 v85, v88, v89
    v_sub_f32 v78, v80, v81
    v_sub_f32 v86, v88, v89
    v_fma_f32 v79, v83, 2.0, v82
    v_fma_f32 v87, v91, 2.0, v90
    v_fma_f32 v82, v83, -2.0, v82
    v_fma_f32 v90, v91, -2.0, v90
    v_fmamk_f32 v80, v76, 0x41700000, v82
    v_fmamk_f32 v88, v84, 0x41700000, v90
    v_fmamk_f32 v80, v81, 0x41200000, v80
    v_fmamk_f32 v88, v89, 0x41200000, v88
    v_cvt_pk_bf16_f32 v7, v77, v85
    v_cvt_pk_bf16_f32 v11, v78, v86
    v_cvt_pk_bf16_f32 v67, v79, v87
    v_cvt_pk_bf16_f32 v71, v82, v90
    v_cvt_pk_bf16_f32 v75, v80, v88
    ds_write_b128 v96, v[64:67] offset:49152
    ds_write_b128 v97, v[68:71] offset:0
    ds_write_b128 v97, v[72:75] offset:16384
    ds_write_b128 v96, v[4:7] offset:16384
    ds_write_b128 v96, v[8:11] offset:32768
    buffer_load_dwordx4 v[32:35], v92, s[8:11], s24 offen offset:0
    buffer_load_dwordx4 v[48:51], v92, s[8:11], s24 offen offset:64
    v_add_u32 v92, 128, v92
    buffer_load_dwordx4 v[36:39], v93, s[8:11], s24 offen offset:0
    buffer_load_dwordx4 v[52:55], v93, s[8:11], s24 offen offset:64
    v_add_u32 v93, 128, v93
    buffer_load_dwordx4 v[40:43], v94, s[8:11], s24 offen offset:0
    buffer_load_dwordx4 v[56:59], v94, s[8:11], s24 offen offset:64
    v_add_u32 v94, 128, v94
    buffer_load_dwordx4 v[44:47], v95, s[8:11], s24 offen offset:0
    buffer_load_dwordx4 v[60:63], v95, s[8:11], s24 offen offset:64
    v_add_u32 v95, 128, v95
    s_waitcnt lgkmcnt(0)
    s_barrier
    s_setprio 0
    v_lshlrev_b32 v76, 16, v16
    v_and_b32 v84, s25, v16
    v_lshlrev_b32 v77, 16, v20
    v_and_b32 v85, s25, v20
    v_lshlrev_b32 v78, 16, v24
    v_and_b32 v86, s25, v24
    v_lshlrev_b32 v79, 16, v28
    v_and_b32 v87, s25, v28
    v_add_f32 v80, v76, v78
    v_add_f32 v88, v84, v86
    v_add_f32 v81, v77, v79
    v_add_f32 v89, v85, v87
    v_fma_f32 v82, v78, 4.0, v76
    v_fma_f32 v90, v86, 4.0, v84
    v_fma_f32 v83, v79, 4.0, v77
    v_fma_f32 v91, v87, 4.0, v85
    v_add_f32 v77, v80, v81
    v_add_f32 v85, v88, v89
    v_sub_f32 v78, v80, v81
    v_sub_f32 v86, v88, v89
    v_fma_f32 v79, v83, 2.0, v82
    v_fma_f32 v87, v91, 2.0, v90
    v_fma_f32 v82, v83, -2.0, v82
    v_fma_f32 v90, v91, -2.0, v90
    v_fmamk_f32 v80, v76, 0x41700000, v82
    v_fmamk_f32 v88, v84, 0x41700000, v90
    v_fmamk_f32 v80, v81, 0x41200000, v80
    v_fmamk_f32 v88, v89, 0x41200000, v88
    v_cvt_pk_bf16_f32 v20, v77, v85
    v_cvt_pk_bf16_f32 v24, v78, v86
    v_cvt_pk_bf16_f32 v64, v79, v87
    v_cvt_pk_bf16_f32 v68, v82, v90
    v_cvt_pk_bf16_f32 v72, v80, v88
    v_lshlrev_b32 v76, 16, v17
    v_and_b32 v84, s25, v17
    v_lshlrev_b32 v77, 16, v21
    v_and_b32 v85, s25, v21
    v_lshlrev_b32 v78, 16, v25
    v_and_b32 v86, s25, v25
    v_lshlrev_b32 v79, 16, v29
    v_and_b32 v87, s25, v29
    v_add_f32 v80, v76, v78
    v_add_f32 v88, v84, v86
    v_add_f32 v81, v77, v79
    v_add_f32 v89, v85, v87
    v_fma_f32 v82, v78, 4.0, v76
    v_fma_f32 v90, v86, 4.0, v84
    v_fma_f32 v83, v79, 4.0, v77
    v_fma_f32 v91, v87, 4.0, v85
    v_add_f32 v77, v80, v81
    v_add_f32 v85, v88, v89
    v_sub_f32 v78, v80, v81
    v_sub_f32 v86, v88, v89
    v_fma_f32 v79, v83, 2.0, v82
    v_fma_f32 v87, v91, 2.0, v90
    v_fma_f32 v82, v83, -2.0, v82
    v_fma_f32 v90, v91, -2.0, v90
    v_fmamk_f32 v80, v76, 0x41700000, v82
    v_fmamk_f32 v88, v84, 0x41700000, v90
    v_fmamk_f32 v80, v81, 0x41200000, v80
    v_fmamk_f32 v88, v89, 0x41200000, v88
    v_cvt_pk_bf16_f32 v21, v77, v85
    v_cvt_pk_bf16_f32 v25, v78, v86
    v_cvt_pk_bf16_f32 v65, v79, v87
    v_cvt_pk_bf16_f32 v69, v82, v90
    v_cvt_pk_bf16_f32 v73, v80, v88
    v_lshlrev_b32 v76, 16, v18
    v_and_b32 v84, s25, v18
    v_lshlrev_b32 v77, 16, v22
    v_and_b32 v85, s25, v22
    v_lshlrev_b32 v78, 16, v26
    v_and_b32 v86, s25, v26
    v_lshlrev_b32 v79, 16, v30
    v_and_b32 v87, s25, v30
    v_add_f32 v80, v76, v78
    v_add_f32 v88, v84, v86
    v_add_f32 v81, v77, v79
    v_add_f32 v89, v85, v87
    v_fma_f32 v82, v78, 4.0, v76
    v_fma_f32 v90, v86, 4.0, v84
    v_fma_f32 v83, v79, 4.0, v77
    v_fma_f32 v91, v87, 4.0, v85
    v_add_f32 v77, v80, v81
    v_add_f32 v85, v88, v89
    v_sub_f32 v78, v80, v81
    v_sub_f32 v86, v88, v89
    v_fma_f32 v79, v83, 2.0, v82
    v_fma_f32 v87, v91, 2.0, v90
    v_fma_f32 v82, v83, -2.0, v82
    v_fma_f32 v90, v91, -2.0, v90
    v_fmamk_f32 v80, v76, 0x41700000, v82
    v_fmamk_f32 v88, v84, 0x41700000, v90
    v_fmamk_f32 v80, v81, 0x41200000, v80
    v_fmamk_f32 v88, v89, 0x41200000, v88
    v_cvt_pk_bf16_f32 v22, v77, v85
    v_cvt_pk_bf16_f32 v26, v78, v86
    v_cvt_pk_bf16_f32 v66, v79, v87
    v_cvt_pk_bf16_f32 v70, v82, v90
    v_cvt_pk_bf16_f32 v74, v80, v88
    v_lshlrev_b32 v76, 16, v19
    v_and_b32 v84, s25, v19
    v_lshlrev_b32 v77, 16, v23
    v_and_b32 v85, s25, v23
    v_lshlrev_b32 v78, 16, v27
    v_and_b32 v86, s25, v27
    v_lshlrev_b32 v79, 16, v31
    v_and_b32 v87, s25, v31
    v_add_f32 v80, v76, v78
    v_add_f32 v88, v84, v86
    v_add_f32 v81, v77, v79
    v_add_f32 v89, v85, v87
    v_fma_f32 v82, v78, 4.0, v76
    v_fma_f32 v90, v86, 4.0, v84
    v_fma_f32 v83, v79, 4.0, v77
    v_fma_f32 v91, v87, 4.0, v85
    v_add_f32 v77, v80, v81
    v_add_f32 v85, v88, v89
    v_sub_f32 v78, v80, v81
    v_sub_f32 v86, v88, v89
    v_fma_f32 v79, v83, 2.0, v82
    v_fma_f32 v87, v91, 2.0, v90
    v_fma_f32 v82, v83, -2.0, v82
    v_fma_f32 v90, v91, -2.0, v90
    v_fmamk_f32 v80, v76, 0x41700000, v82
    v_fmamk_f32 v88, v84, 0x41700000, v90
    v_fmamk_f32 v80, v81, 0x41200000, v80
    v_fmamk_f32 v88, v89, 0x41200000, v88
    v_cvt_pk_bf16_f32 v23, v77, v85
    v_cvt_pk_bf16_f32 v27, v78, v86
    v_cvt_pk_bf16_f32 v67, v79, v87
    v_cvt_pk_bf16_f32 v71, v82, v90
    v_cvt_pk_bf16_f32 v75, v80, v88
L_conv1_kernel_hloop2:
    s_cmp_lt_u32 s28, 12
    s_cselect_b32 s24, 0, 2130706432
    ds_write_b128 v96, v[64:67] offset:57344
    ds_write_b128 v97, v[68:71] offset:8192
    ds_write_b128 v97, v[72:75] offset:24576
    ds_write_b128 v96, v[16:19] offset:8192
    ds_write_b128 v96, v[20:23] offset:24576
    ds_write_b128 v96, v[24:27] offset:40960
    ds_write_b128 v98, v[28:31] offset:8704
    s_waitcnt vmcnt(0)
    v_lshlrev_b32 v76, 16, v32
    v_and_b32 v84, s25, v32
    v_lshlrev_b32 v77, 16, v36
    v_and_b32 v85, s25, v36
    v_lshlrev_b32 v78, 16, v40
    v_and_b32 v86, s25, v40
    v_lshlrev_b32 v79, 16, v44
    v_and_b32 v87, s25, v44
    v_add_f32 v80, v76, v78
    v_add_f32 v88, v84, v86
    v_add_f32 v81, v77, v79
    v_add_f32 v89, v85, v87
    v_fma_f32 v82, v78, 4.0, v76
    v_fma_f32 v90, v86, 4.0, v84
    v_fma_f32 v83, v79, 4.0, v77
    v_fma_f32 v91, v87, 4.0, v85
    v_add_f32 v77, v80, v81
    v_add_f32 v85, v88, v89
    v_sub_f32 v78, v80, v81
    v_sub_f32 v86, v88, v89
    v_fma_f32 v79, v83, 2.0, v82
    v_fma_f32 v87, v91, 2.0, v90
    v_fma_f32 v82, v83, -2.0, v82
    v_fma_f32 v90, v91, -2.0, v90
    v_fmamk_f32 v80, v76, 0x41700000, v82
    v_fmamk_f32 v88, v84, 0x41700000, v90
    buffer_load_dwordx4 v[0:3], v92, s[8:11], s24 offen offset:0
    buffer_load_dwordx4 v[16:19], v92, s[8:11], s24 offen offset:64
    v_add_u32 v92, 128, v92
    v_fmamk_f32 v80, v81, 0x41200000, v80
    v_fmamk_f32 v88, v89, 0x41200000, v88
    v_cvt_pk_bf16_f32 v36, v77, v85
    v_cvt_pk_bf16_f32 v40, v78, v86
    v_cvt_pk_bf16_f32 v64, v79, v87
    v_cvt_pk_bf16_f32 v68, v82, v90
    v_cvt_pk_bf16_f32 v72, v80, v88
    v_lshlrev_b32 v76, 16, v33
    v_and_b32 v84, s25, v33
    v_lshlrev_b32 v77, 16, v37
    v_and_b32 v85, s25, v37
    v_lshlrev_b32 v78, 16, v41
    v_and_b32 v86, s25, v41
    v_lshlrev_b32 v79, 16, v45
    v_and_b32 v87, s25, v45
    v_add_f32 v80, v76, v78
    v_add_f32 v88, v84, v86
    v_add_f32 v81, v77, v79
    v_add_f32 v89, v85, v87
    v_fma_f32 v82, v78, 4.0, v76
    v_fma_f32 v90, v86, 4.0, v84
    v_fma_f32 v83, v79, 4.0, v77
    v_fma_f32 v91, v87, 4.0, v85
    v_add_f32 v77, v80, v81
    v_add_f32 v85, v88, v89
    v_sub_f32 v78, v80, v81
    v_sub_f32 v86, v88, v89
    v_fma_f32 v79, v83, 2.0, v82
    v_fma_f32 v87, v91, 2.0, v90
    v_fma_f32 v82, v83, -2.0, v82
    v_fma_f32 v90, v91, -2.0, v90
    v_fmamk_f32 v80, v76, 0x41700000, v82
    v_fmamk_f32 v88, v84, 0x41700000, v90
    v_fmamk_f32 v80, v81, 0x41200000, v80
    v_fmamk_f32 v88, v89, 0x41200000, v88
    v_cvt_pk_bf16_f32 v37, v77, v85
    v_cvt_pk_bf16_f32 v41, v78, v86
    v_cvt_pk_bf16_f32 v65, v79, v87
    v_cvt_pk_bf16_f32 v69, v82, v90
    v_cvt_pk_bf16_f32 v73, v80, v88
    v_lshlrev_b32 v76, 16, v34
    v_and_b32 v84, s25, v34
    v_lshlrev_b32 v77, 16, v38
    v_and_b32 v85, s25, v38
    v_lshlrev_b32 v78, 16, v42
    v_and_b32 v86, s25, v42
    v_lshlrev_b32 v79, 16, v46
    v_and_b32 v87, s25, v46
    v_add_f32 v80, v76, v78
    v_add_f32 v88, v84, v86
    v_add_f32 v81, v77, v79
    v_add_f32 v89, v85, v87
    v_fma_f32 v82, v78, 4.0, v76
    buffer_load_dwordx4 v[4:7], v93, s[8:11], s24 offen offset:0
    buffer_load_dwordx4 v[20:23], v93, s[8:11], s24 offen offset:64
    v_add_u32 v93, 128, v93
    v_fma_f32 v90, v86, 4.0, v84
    v_fma_f32 v83, v79, 4.0, v77
    v_fma_f32 v91, v87, 4.0, v85
    v_add_f32 v77, v80, v81
    v_add_f32 v85, v88, v89
    v_sub_f32 v78, v80, v81
    v_sub_f32 v86, v88, v89
    v_fma_f32 v79, v83, 2.0, v82
    v_fma_f32 v87, v91, 2.0, v90
    v_fma_f32 v82, v83, -2.0, v82
    v_fma_f32 v90, v91, -2.0, v90
    v_fmamk_f32 v80, v76, 0x41700000, v82
    v_fmamk_f32 v88, v84, 0x41700000, v90
    v_fmamk_f32 v80, v81, 0x41200000, v80
    v_fmamk_f32 v88, v89, 0x41200000, v88
    v_cvt_pk_bf16_f32 v38, v77, v85
    v_cvt_pk_bf16_f32 v42, v78, v86
    v_cvt_pk_bf16_f32 v66, v79, v87
    v_cvt_pk_bf16_f32 v70, v82, v90
    v_cvt_pk_bf16_f32 v74, v80, v88
    v_lshlrev_b32 v76, 16, v35
    v_and_b32 v84, s25, v35
    v_lshlrev_b32 v77, 16, v39
    v_and_b32 v85, s25, v39
    v_lshlrev_b32 v78, 16, v43
    v_and_b32 v86, s25, v43
    v_lshlrev_b32 v79, 16, v47
    v_and_b32 v87, s25, v47
    v_add_f32 v80, v76, v78
    v_add_f32 v88, v84, v86
    v_add_f32 v81, v77, v79
    v_add_f32 v89, v85, v87
    v_fma_f32 v82, v78, 4.0, v76
    v_fma_f32 v90, v86, 4.0, v84
    v_fma_f32 v83, v79, 4.0, v77
    v_fma_f32 v91, v87, 4.0, v85
    v_add_f32 v77, v80, v81
    v_add_f32 v85, v88, v89
    v_sub_f32 v78, v80, v81
    v_sub_f32 v86, v88, v89
    v_fma_f32 v79, v83, 2.0, v82
    v_fma_f32 v87, v91, 2.0, v90
    v_fma_f32 v82, v83, -2.0, v82
    v_fma_f32 v90, v91, -2.0, v90
    v_fmamk_f32 v80, v76, 0x41700000, v82
    v_fmamk_f32 v88, v84, 0x41700000, v90
    v_fmamk_f32 v80, v81, 0x41200000, v80
    v_fmamk_f32 v88, v89, 0x41200000, v88
    v_cvt_pk_bf16_f32 v39, v77, v85
    v_cvt_pk_bf16_f32 v43, v78, v86
    v_cvt_pk_bf16_f32 v67, v79, v87
    v_cvt_pk_bf16_f32 v71, v82, v90
    v_cvt_pk_bf16_f32 v75, v80, v88
    s_add_u32 s28, s28, 1
    s_waitcnt lgkmcnt(0)
    s_barrier
    s_cmp_lt_u32 s28, 12
    s_cselect_b32 s24, 0, 2130706432
    ds_write_b128 v96, v[64:67] offset:49152
    ds_write_b128 v97, v[68:71] offset:0
    ds_write_b128 v97, v[72:75] offset:16384
    ds_write_b128 v96, v[32:35] offset:0
    ds_write_b128 v96, v[36:39] offset:16384
    ds_write_b128 v96, v[40:43] offset:32768
    ds_write_b128 v98, v[44:47] offset:0
    v_lshlrev_b32 v76, 16, v48
    v_and_b32 v84, s25, v48
    buffer_load_dwordx4 v[8:11], v94, s[8:11], s24 offen offset:0
    buffer_load_dwordx4 v[24:27], v94, s[8:11], s24 offen offset:64
    v_add_u32 v94, 128, v94
    v_lshlrev_b32 v77, 16, v52
    v_and_b32 v85, s25, v52
    v_lshlrev_b32 v78, 16, v56
    v_and_b32 v86, s25, v56
    v_lshlrev_b32 v79, 16, v60
    v_and_b32 v87, s25, v60
    v_add_f32 v80, v76, v78
    v_add_f32 v88, v84, v86
    v_add_f32 v81, v77, v79
    v_add_f32 v89, v85, v87
    v_fma_f32 v82, v78, 4.0, v76
    v_fma_f32 v90, v86, 4.0, v84
    v_fma_f32 v83, v79, 4.0, v77
    v_fma_f32 v91, v87, 4.0, v85
    v_add_f32 v77, v80, v81
    v_add_f32 v85, v88, v89
    v_sub_f32 v78, v80, v81
    buffer_load_dwordx4 v[12:15], v95, s[8:11], s24 offen offset:0
    buffer_load_dwordx4 v[28:31], v95, s[8:11], s24 offen offset:64
    v_add_u32 v95, 128, v95
    v_sub_f32 v86, v88, v89
    v_fma_f32 v79, v83, 2.0, v82
    v_fma_f32 v87, v91, 2.0, v90
    v_fma_f32 v82, v83, -2.0, v82
    v_fma_f32 v90, v91, -2.0, v90
    v_fmamk_f32 v80, v76, 0x41700000, v82
    v_fmamk_f32 v88, v84, 0x41700000, v90
    v_fmamk_f32 v80, v81, 0x41200000, v80
    v_fmamk_f32 v88, v89, 0x41200000, v88
    v_cvt_pk_bf16_f32 v52, v77, v85
    v_cvt_pk_bf16_f32 v56, v78, v86
    v_cvt_pk_bf16_f32 v64, v79, v87
    v_cvt_pk_bf16_f32 v68, v82, v90
    v_cvt_pk_bf16_f32 v72, v80, v88
    v_lshlrev_b32 v76, 16, v49
    v_and_b32 v84, s25, v49
    v_lshlrev_b32 v77, 16, v53
    v_and_b32 v85, s25, v53
    v_lshlrev_b32 v78, 16, v57
    v_and_b32 v86, s25, v57
    v_lshlrev_b32 v79, 16, v61
    v_and_b32 v87, s25, v61
    v_add_f32 v80, v76, v78
    v_add_f32 v88, v84, v86
    v_add_f32 v81, v77, v79
    v_add_f32 v89, v85, v87
    v_fma_f32 v82, v78, 4.0, v76
    v_fma_f32 v90, v86, 4.0, v84
    v_fma_f32 v83, v79, 4.0, v77
    v_fma_f32 v91, v87, 4.0, v85
    v_add_f32 v77, v80, v81
    v_add_f32 v85, v88, v89
    v_sub_f32 v78, v80, v81
    v_sub_f32 v86, v88, v89
    v_fma_f32 v79, v83, 2.0, v82
    v_fma_f32 v87, v91, 2.0, v90
    v_fma_f32 v82, v83, -2.0, v82
    v_fma_f32 v90, v91, -2.0, v90
    v_fmamk_f32 v80, v76, 0x41700000, v82
    v_fmamk_f32 v88, v84, 0x41700000, v90
    v_fmamk_f32 v80, v81, 0x41200000, v80
    v_fmamk_f32 v88, v89, 0x41200000, v88
    v_cvt_pk_bf16_f32 v53, v77, v85
    v_cvt_pk_bf16_f32 v57, v78, v86
    v_cvt_pk_bf16_f32 v65, v79, v87
    v_cvt_pk_bf16_f32 v69, v82, v90
    v_cvt_pk_bf16_f32 v73, v80, v88
    v_lshlrev_b32 v76, 16, v50
    v_and_b32 v84, s25, v50
    v_lshlrev_b32 v77, 16, v54
    v_and_b32 v85, s25, v54
    v_lshlrev_b32 v78, 16, v58
    v_and_b32 v86, s25, v58
    v_lshlrev_b32 v79, 16, v62
    v_and_b32 v87, s25, v62
    v_add_f32 v80, v76, v78
    v_add_f32 v88, v84, v86
    v_add_f32 v81, v77, v79
    v_add_f32 v89, v85, v87
    v_fma_f32 v82, v78, 4.0, v76
    v_fma_f32 v90, v86, 4.0, v84
    v_fma_f32 v83, v79, 4.0, v77
    v_fma_f32 v91, v87, 4.0, v85
    v_add_f32 v77, v80, v81
    v_add_f32 v85, v88, v89
    v_sub_f32 v78, v80, v81
    v_sub_f32 v86, v88, v89
    v_fma_f32 v79, v83, 2.0, v82
    v_fma_f32 v87, v91, 2.0, v90
    v_fma_f32 v82, v83, -2.0, v82
    v_fma_f32 v90, v91, -2.0, v90
    v_fmamk_f32 v80, v76, 0x41700000, v82
    v_fmamk_f32 v88, v84, 0x41700000, v90
    v_fmamk_f32 v80, v81, 0x41200000, v80
    v_fmamk_f32 v88, v89, 0x41200000, v88
    v_cvt_pk_bf16_f32 v54, v77, v85
    v_cvt_pk_bf16_f32 v58, v78, v86
    v_cvt_pk_bf16_f32 v66, v79, v87
    v_cvt_pk_bf16_f32 v70, v82, v90
    v_cvt_pk_bf16_f32 v74, v80, v88
    v_lshlrev_b32 v76, 16, v51
    v_and_b32 v84, s25, v51
    v_lshlrev_b32 v77, 16, v55
    v_and_b32 v85, s25, v55
    v_lshlrev_b32 v78, 16, v59
    v_and_b32 v86, s25, v59
    v_lshlrev_b32 v79, 16, v63
    v_and_b32 v87, s25, v63
    v_add_f32 v80, v76, v78
    v_add_f32 v88, v84, v86
    v_add_f32 v81, v77, v79
    v_add_f32 v89, v85, v87
    v_fma_f32 v82, v78, 4.0, v76
    v_fma_f32 v90, v86, 4.0, v84
    v_fma_f32 v83, v79, 4.0, v77
    v_fma_f32 v91, v87, 4.0, v85
    v_add_f32 v77, v80, v81
    v_add_f32 v85, v88, v89
    v_sub_f32 v78, v80, v81
    v_sub_f32 v86, v88, v89
    v_fma_f32 v79, v83, 2.0, v82
    v_fma_f32 v87, v91, 2.0, v90
    v_fma_f32 v82, v83, -2.0, v82
    v_fma_f32 v90, v91, -2.0, v90
    v_fmamk_f32 v80, v76, 0x41700000, v82
    v_fmamk_f32 v88, v84, 0x41700000, v90
    v_fmamk_f32 v80, v81, 0x41200000, v80
    v_fmamk_f32 v88, v89, 0x41200000, v88
    v_cvt_pk_bf16_f32 v55, v77, v85
    v_cvt_pk_bf16_f32 v59, v78, v86
    v_cvt_pk_bf16_f32 v67, v79, v87
    v_cvt_pk_bf16_f32 v71, v82, v90
    v_cvt_pk_bf16_f32 v75, v80, v88
    s_add_u32 s28, s28, 1
    s_waitcnt lgkmcnt(0)
    s_barrier
    s_cmp_eq_u32 s22, 1
    s_cbranch_scc1 L_conv1_kernel_hlast2
    s_cmp_lt_u32 s28, 12
    s_cselect_b32 s24, 0, 2130706432
    ds_write_b128 v96, v[64:67] offset:57344
    ds_write_b128 v97, v[68:71] offset:8192
    ds_write_b128 v97, v[72:75] offset:24576
    ds_write_b128 v96, v[48:51] offset:8192
    ds_write_b128 v96, v[52:55] offset:24576
    ds_write_b128 v96, v[56:59] offset:40960
    ds_write_b128 v98, v[60:63] offset:8704
    s_waitcnt vmcnt(0)
    v_lshlrev_b32 v76, 16, v0
    v_and_b32 v84, s25, v0
    v_lshlrev_b32 v77, 16, v4
    v_and_b32 v85, s25, v4
    v_lshlrev_b32 v78, 16, v8
    v_and_b32 v86, s25, v8
    v_lshlrev_b32 v79, 16, v12
    v_and_b32 v87, s25, v12
    v_add_f32 v80, v76, v78
    v_add_f32 v88, v84, v86
    v_add_f32 v81, v77, v79
    v_add_f32 v89, v85, v87
    v_fma_f32 v82, v78, 4.0, v76
    v_fma_f32 v90, v86, 4.0, v84
    v_fma_f32 v83, v79, 4.0, v77
    v_fma_f32 v91, v87, 4.0, v85
    v_add_f32 v77, v80, v81
    v_add_f32 v85, v88, v89
    v_sub_f32 v78, v80, v81
    v_sub_f32 v86, v88, v89
    v_fma_f32 v79, v83, 2.0, v82
    v_fma_f32 v87, v91, 2.0, v90
    v_fma_f32 v82, v83, -2.0, v82
    v_fma_f32 v90, v91, -2.0, v90
    v_fmamk_f32 v80, v76, 0x41700000, v82
    v_fmamk_f32 v88, v84, 0x41700000, v90
    buffer_load_dwordx4 v[32:35], v92, s[8:11], s24 offen offset:0
    buffer_load_dwordx4 v[48:51], v92, s[8:11], s24 offen offset:64
    v_add_u32 v92, 128, v92
    v_fmamk_f32 v80, v81, 0x41200000, v80
    v_fmamk_f32 v88, v89, 0x41200000, v88
    v_cvt_pk_bf16_f32 v4, v77, v85
    v_cvt_pk_bf16_f32 v8, v78, v86
    v_cvt_pk_bf16_f32 v64, v79, v87
    v_cvt_pk_bf16_f32 v68, v82, v90
    v_cvt_pk_bf16_f32 v72, v80, v88
    v_lshlrev_b32 v76, 16, v1
    v_and_b32 v84, s25, v1
    v_lshlrev_b32 v77, 16, v5
    v_and_b32 v85, s25, v5
    v_lshlrev_b32 v78, 16, v9
    v_and_b32 v86, s25, v9
    v_lshlrev_b32 v79, 16, v13
    v_and_b32 v87, s25, v13
    v_add_f32 v80, v76, v78
    v_add_f32 v88, v84, v86
    v_add_f32 v81, v77, v79
    v_add_f32 v89, v85, v87
    v_fma_f32 v82, v78, 4.0, v76
    v_fma_f32 v90, v86, 4.0, v84
    v_fma_f32 v83, v79, 4.0, v77
    v_fma_f32 v91, v87, 4.0, v85
    v_add_f32 v77, v80, v81
    v_add_f32 v85, v88, v89
    v_sub_f32 v78, v80, v81
    v_sub_f32 v86, v88, v89
    v_fma_f32 v79, v83, 2.0, v82
    v_fma_f32 v87, v91, 2.0, v90
    v_fma_f32 v82, v83, -2.0, v82
    v_fma_f32 v90, v91, -2.0, v90
    v_fmamk_f32 v80, v76, 0x41700000, v82
    v_fmamk_f32 v88, v84, 0x41700000, v90
    v_fmamk_f32 v80, v81, 0x41200000, v80
    v_fmamk_f32 v88, v89, 0x41200000, v88
    v_cvt_pk_bf16_f32 v5, v77, v85
    v_cvt_pk_bf16_f32 v9, v78, v86
    v_cvt_pk_bf16_f32 v65, v79, v87
    v_cvt_pk_bf16_f32 v69, v82, v90
    v_cvt_pk_bf16_f32 v73, v80, v88
    v_lshlrev_b32 v76, 16, v2
    v_and_b32 v84, s25, v2
    v_lshlrev_b32 v77, 16, v6
    v_and_b32 v85, s25, v6
    v_lshlrev_b32 v78, 16, v10
    v_and_b32 v86, s25, v10
    v_lshlrev_b32 v79, 16, v14
    v_and_b32 v87, s25, v14
    v_add_f32 v80, v76, v78
    v_add_f32 v88, v84, v86
    v_add_f32 v81, v77, v79
    v_add_f32 v89, v85, v87
    v_fma_f32 v82, v78, 4.0, v76
    buffer_load_dwordx4 v[36:39], v93, s[8:11], s24 offen offset:0
    buffer_load_dwordx4 v[52:55], v93, s[8:11], s24 offen offset:64
    v_add_u32 v93, 128, v93
    v_fma_f32 v90, v86, 4.0, v84
    v_fma_f32 v83, v79, 4.0, v77
    v_fma_f32 v91, v87, 4.0, v85
    v_add_f32 v77, v80, v81
    v_add_f32 v85, v88, v89
    v_sub_f32 v78, v80, v81
    v_sub_f32 v86, v88, v89
    v_fma_f32 v79, v83, 2.0, v82
    v_fma_f32 v87, v91, 2.0, v90
    v_fma_f32 v82, v83, -2.0, v82
    v_fma_f32 v90, v91, -2.0, v90
    v_fmamk_f32 v80, v76, 0x41700000, v82
    v_fmamk_f32 v88, v84, 0x41700000, v90
    v_fmamk_f32 v80, v81, 0x41200000, v80
    v_fmamk_f32 v88, v89, 0x41200000, v88
    v_cvt_pk_bf16_f32 v6, v77, v85
    v_cvt_pk_bf16_f32 v10, v78, v86
    v_cvt_pk_bf16_f32 v66, v79, v87
    v_cvt_pk_bf16_f32 v70, v82, v90
    v_cvt_pk_bf16_f32 v74, v80, v88
    v_lshlrev_b32 v76, 16, v3
    v_and_b32 v84, s25, v3
    v_lshlrev_b32 v77, 16, v7
    v_and_b32 v85, s25, v7
    v_lshlrev_b32 v78, 16, v11
    v_and_b32 v86, s25, v11
    v_lshlrev_b32 v79, 16, v15
    v_and_b32 v87, s25, v15
    v_add_f32 v80, v76, v78
    v_add_f32 v88, v84, v86
    v_add_f32 v81, v77, v79
    v_add_f32 v89, v85, v87
    v_fma_f32 v82, v78, 4.0, v76
    v_fma_f32 v90, v86, 4.0, v84
    v_fma_f32 v83, v79, 4.0, v77
    v_fma_f32 v91, v87, 4.0, v85
    v_add_f32 v77, v80, v81
    v_add_f32 v85, v88, v89
    v_sub_f32 v78, v80, v81
    v_sub_f32 v86, v88, v89
    v_fma_f32 v79, v83, 2.0, v82
    v_fma_f32 v87, v91, 2.0, v90
    v_fma_f32 v82, v83, -2.0, v82
    v_fma_f32 v90, v91, -2.0, v90
    v_fmamk_f32 v80, v76, 0x41700000, v82
    v_fmamk_f32 v88, v84, 0x41700000, v90
    v_fmamk_f32 v80, v81, 0x41200000, v80
    v_fmamk_f32 v88, v89, 0x41200000, v88
    v_cvt_pk_bf16_f32 v7, v77, v85
    v_cvt_pk_bf16_f32 v11, v78, v86
    v_cvt_pk_bf16_f32 v67, v79, v87
    v_cvt_pk_bf16_f32 v71, v82, v90
    v_cvt_pk_bf16_f32 v75, v80, v88
    s_add_u32 s28, s28, 1
    s_waitcnt lgkmcnt(0)
    s_barrier
    s_cmp_lt_u32 s28, 12
    s_cselect_b32 s24, 0, 2130706432
    ds_write_b128 v96, v[64:67] offset:49152
    ds_write_b128 v97, v[68:71] offset:0
    ds_write_b128 v97, v[72:75] offset:16384
    ds_write_b128 v96, v[0:3] offset:0
    ds_write_b128 v96, v[4:7] offset:16384
    ds_write_b128 v96, v[8:11] offset:32768
    ds_write_b128 v98, v[12:15] offset:0
    v_lshlrev_b32 v76, 16, v16
    v_and_b32 v84, s25, v16
    buffer_load_dwordx4 v[40:43], v94, s[8:11], s24 offen offset:0
    buffer_load_dwordx4 v[56:59], v94, s[8:11], s24 offen offset:64
    v_add_u32 v94, 128, v94
    v_lshlrev_b32 v77, 16, v20
    v_and_b32 v85, s25, v20
    v_lshlrev_b32 v78, 16, v24
    v_and_b32 v86, s25, v24
    v_lshlrev_b32 v79, 16, v28
    v_and_b32 v87, s25, v28
    v_add_f32 v80, v76, v78
    v_add_f32 v88, v84, v86
    v_add_f32 v81, v77, v79
    v_add_f32 v89, v85, v87
    v_fma_f32 v82, v78, 4.0, v76
    v_fma_f32 v90, v86, 4.0, v84
    v_fma_f32 v83, v79, 4.0, v77
    v_fma_f32 v91, v87, 4.0, v85
    v_add_f32 v77, v80, v81
    v_add_f32 v85, v88, v89
    v_sub_f32 v78, v80, v81
    buffer_load_dwordx4 v[44:47], v95, s[8:11], s24 offen offset:0
    buffer_load_dwordx4 v[60:63], v95, s[8:11], s24 offen offset:64
    v_add_u32 v95, 128, v95
    v_sub_f32 v86, v88, v89
    v_fma_f32 v79, v83, 2.0, v82
    v_fma_f32 v87, v91, 2.0, v90
    v_fma_f32 v82, v83, -2.0, v82
    v_fma_f32 v90, v91, -2.0, v90
    v_fmamk_f32 v80, v76, 0x41700000, v82
    v_fmamk_f32 v88, v84, 0x41700000, v90
    v_fmamk_f32 v80, v81, 0x41200000, v80
    v_fmamk_f32 v88, v89, 0x41200000, v88
    v_cvt_pk_bf16_f32 v20, v77, v85
    v_cvt_pk_bf16_f32 v24, v78, v86
    v_cvt_pk_bf16_f32 v64, v79, v87
    v_cvt_pk_bf16_f32 v68, v82, v90
    v_cvt_pk_bf16_f32 v72, v80, v88
    v_lshlrev_b32 v76, 16, v17
    v_and_b32 v84, s25, v17
    v_lshlrev_b32 v77, 16, v21
    v_and_b32 v85, s25, v21
    v_lshlrev_b32 v78, 16, v25
    v_and_b32 v86, s25, v25
    v_lshlrev_b32 v79, 16, v29
    v_and_b32 v87, s25, v29
    v_add_f32 v80, v76, v78
    v_add_f32 v88, v84, v86
    v_add_f32 v81, v77, v79
    v_add_f32 v89, v85, v87
    v_fma_f32 v82, v78, 4.0, v76
    v_fma_f32 v90, v86, 4.0, v84
    v_fma_f32 v83, v79, 4.0, v77
    v_fma_f32 v91, v87, 4.0, v85
    v_add_f32 v77, v80, v81
    v_add_f32 v85, v88, v89
    v_sub_f32 v78, v80, v81
    v_sub_f32 v86, v88, v89
    v_fma_f32 v79, v83, 2.0, v82
    v_fma_f32 v87, v91, 2.0, v90
    v_fma_f32 v82, v83, -2.0, v82
    v_fma_f32 v90, v91, -2.0, v90
    v_fmamk_f32 v80, v76, 0x41700000, v82
    v_fmamk_f32 v88, v84, 0x41700000, v90
    v_fmamk_f32 v80, v81, 0x41200000, v80
    v_fmamk_f32 v88, v89, 0x41200000, v88
    v_cvt_pk_bf16_f32 v21, v77, v85
    v_cvt_pk_bf16_f32 v25, v78, v86
    v_cvt_pk_bf16_f32 v65, v79, v87
    v_cvt_pk_bf16_f32 v69, v82, v90
    v_cvt_pk_bf16_f32 v73, v80, v88
    v_lshlrev_b32 v76, 16, v18
    v_and_b32 v84, s25, v18
    v_lshlrev_b32 v77, 16, v22
    v_and_b32 v85, s25, v22
    v_lshlrev_b32 v78, 16, v26
    v_and_b32 v86, s25, v26
    v_lshlrev_b32 v79, 16, v30
    v_and_b32 v87, s25, v30
    v_add_f32 v80, v76, v78
    v_add_f32 v88, v84, v86
    v_add_f32 v81, v77, v79
    v_add_f32 v89, v85, v87
    v_fma_f32 v82, v78, 4.0, v76
    v_fma_f32 v90, v86, 4.0, v84
    v_fma_f32 v83, v79, 4.0, v77
    v_fma_f32 v91, v87, 4.0, v85
    v_add_f32 v77, v80, v81
    v_add_f32 v85, v88, v89
    v_sub_f32 v78, v80, v81
    v_sub_f32 v86, v88, v89
    v_fma_f32 v79, v83, 2.0, v82
    v_fma_f32 v87, v91, 2.0, v90
    v_fma_f32 v82, v83, -2.0, v82
    v_fma_f32 v90, v91, -2.0, v90
    v_fmamk_f32 v80, v76, 0x41700000, v82
    v_fmamk_f32 v88, v84, 0x41700000, v90
    v_fmamk_f32 v80, v81, 0x41200000, v80
    v_fmamk_f32 v88, v89, 0x41200000, v88
    v_cvt_pk_bf16_f32 v22, v77, v85
    v_cvt_pk_bf16_f32 v26, v78, v86
    v_cvt_pk_bf16_f32 v66, v79, v87
    v_cvt_pk_bf16_f32 v70, v82, v90
    v_cvt_pk_bf16_f32 v74, v80, v88
    v_lshlrev_b32 v76, 16, v19
    v_and_b32 v84, s25, v19
    v_lshlrev_b32 v77, 16, v23
    v_and_b32 v85, s25, v23
    v_lshlrev_b32 v78, 16, v27
    v_and_b32 v86, s25, v27
    v_lshlrev_b32 v79, 16, v31
    v_and_b32 v87, s25, v31
    v_add_f32 v80, v76, v78
    v_add_f32 v88, v84, v86
    v_add_f32 v81, v77, v79
    v_add_f32 v89, v85, v87
    v_fma_f32 v82, v78, 4.0, v76
    v_fma_f32 v90, v86, 4.0, v84
    v_fma_f32 v83, v79, 4.0, v77
    v_fma_f32 v91, v87, 4.0, v85
    v_add_f32 v77, v80, v81
    v_add_f32 v85, v88, v89
    v_sub_f32 v78, v80, v81
    v_sub_f32 v86, v88, v89
    v_fma_f32 v79, v83, 2.0, v82
    v_fma_f32 v87, v91, 2.0, v90
    v_fma_f32 v82, v83, -2.0, v82
    v_fma_f32 v90, v91, -2.0, v90
    v_fmamk_f32 v80, v76, 0x41700000, v82
    v_fmamk_f32 v88, v84, 0x41700000, v90
    v_fmamk_f32 v80, v81, 0x41200000, v80
    v_fmamk_f32 v88, v89, 0x41200000, v88
    v_cvt_pk_bf16_f32 v23, v77, v85
    v_cvt_pk_bf16_f32 v27, v78, v86
    v_cvt_pk_bf16_f32 v67, v79, v87
    v_cvt_pk_bf16_f32 v71, v82, v90
    v_cvt_pk_bf16_f32 v75, v80, v88
    s_add_u32 s28, s28, 1
    s_waitcnt lgkmcnt(0)
    s_barrier
    s_sub_u32 s22, s22, 1
    s_branch L_conv1_kernel_hloop2
L_conv1_kernel_hlast2:
    s_waitcnt vmcnt(0)
    s_mov_b32 s58, s20
    s_lshl_b32 s20, s2, 2
    s_add_u32 s20, s20, s32
    v_mov_b32 v1, v127
    s_load_dwordx2 s[8:9], s[0:1], 16
    s_lshr_b32 s22, s20, 8
    s_bfe_u32 s23, s20, 0x40004
    s_bfe_u32 s24, s20, 0x30001
    s_and_b32 s21, s20, 1
    v_lshrrev_b32 v2, 4, v1
    v_lshlrev_b32 v2, 12, v2
    v_and_b32 v3, 15, v1
    v_lshl_add_u32 v2, v3, 2, v2
    s_lshl_b32 s26, s22, 3
    s_lshr_b32 s27, s23, 3
    s_add_u32 s26, s26, s27
    s_lshl_b32 s26, s26, 17
    s_and_b32 s27, s23, 7
    s_lshl_b32 s27, s27, 14
    s_add_u32 s26, s26, s27
    s_lshl_b32 s27, s24, 6
    s_add_u32 s26, s26, s27
    s_mov_b32 s10, 4063232
    s_mov_b32 s11, 0x00020000
    s_add_u32 s37, s26, 262144
    s_add_u32 s38, s26, 524288
    s_add_u32 s39, s26, 786432
    s_waitcnt lgkmcnt(0)
    buffer_load_dword v16, v2, s[8:11], s26 offen offset:0
    buffer_load_dword v17, v2, s[8:11], s26 offen offset:512
    buffer_load_dword v24, v2, s[8:11], s37 offen offset:0
    buffer_load_dword v25, v2, s[8:11], s37 offen offset:512
    buffer_load_dword v32, v2, s[8:11], s38 offen offset:0
    buffer_load_dword v33, v2, s[8:11], s38 offen offset:512
    buffer_load_dword v40, v2, s[8:11], s39 offen offset:0
    buffer_load_dword v41, v2, s[8:11], s39 offen offset:512
    buffer_load_dword v18, v2, s[8:11], s26 offen offset:1024
    buffer_load_dword v19, v2, s[8:11], s26 offen offset:1536
    buffer_load_dword v26, v2, s[8:11], s37 offen offset:1024
    buffer_load_dword v27, v2, s[8:11], s37 offen offset:1536
    buffer_load_dword v34, v2, s[8:11], s38 offen offset:1024
    buffer_load_dword v35, v2, s[8:11], s38 offen offset:1536
    buffer_load_dword v42, v2, s[8:11], s39 offen offset:1024
    buffer_load_dword v43, v2, s[8:11], s39 offen offset:1536
    buffer_load_dword v20, v2, s[8:11], s26 offen offset:2048
    buffer_load_dword v21, v2, s[8:11], s26 offen offset:2560
    buffer_load_dword v28, v2, s[8:11], s37 offen offset:2048
    buffer_load_dword v29, v2, s[8:11], s37 offen offset:2560
    buffer_load_dword v36, v2, s[8:11], s38 offen offset:2048
    buffer_load_dword v37, v2, s[8:11], s38 offen offset:2560
    buffer_load_dword v44, v2, s[8:11], s39 offen offset:2048
    buffer_load_dword v45, v2, s[8:11], s39 offen offset:2560
    buffer_load_dword v22, v2, s[8:11], s26 offen offset:3072
    buffer_load_dword v23, v2, s[8:11], s26 offen offset:3584
    buffer_load_dword v30, v2, s[8:11], s37 offen offset:3072
    buffer_load_dword v31, v2, s[8:11], s37 offen offset:3584
    buffer_load_dword v38, v2, s[8:11], s38 offen offset:3072
    buffer_load_dword v39, v2, s[8:11], s38 offen offset:3584
    buffer_load_dword v46, v2, s[8:11], s39 offen offset:3072
    buffer_load_dword v47, v2, s[8:11], s39 offen offset:3584
    s_add_u32 s12, s30, 9437184
    s_addc_u32 s13, s31, 0
    s_mov_b32 s14, 7340032
    s_mov_b32 s15, 0x00020000
    v_lshlrev_b32 v4, 4, v1
    s_lshl_b32 s27, s24, 4
    s_add_u32 s27, s27, s23
    s_mul_i32 s27, s27, 57344
    s_lshl_b32 s28, s22, 11
    s_add_u32 s27, s27, s28
    s_lshl_b32 s28, s21, 10
    s_add_u32 s27, s27, s28
    s_cmp_eq_u32 s21, 0
    s_mov_b32 s32, 0x07060302
    s_cselect_b32 s32, 0x05040100, s32
    s_mov_b32 s33, 0x03020c0c
    s_cselect_b32 s33, 0x01000c0c, s33
    s_mov_b32 s35, 0x3d2aaaab
    s_mov_b32 s36, 0x3c638e39
    s_mov_b32 s25, 0xffff0000
    ds_write_b128 v96, v[64:67] offset:57344
    ds_write_b128 v97, v[68:71] offset:8192
    ds_write_b128 v97, v[72:75] offset:24576
    ds_write_b128 v96, v[48:51] offset:8192
    ds_write_b128 v96, v[52:55] offset:24576
    ds_write_b128 v96, v[56:59] offset:40960
    ds_write_b128 v98, v[60:63] offset:8704
    s_waitcnt lgkmcnt(0)
    s_barrier
    s_waitcnt vmcnt(24)
    v_perm_b32 v72, v17, v16, s32
    v_perm_b32 v48, v41, v40, s32
    v_perm_b32 v76, v76, v40, s33
    v_perm_b32 v84, v84, v41, s33
    v_perm_b32 v77, v77, v32, s33
    v_perm_b32 v85, v85, v33, s33
    v_perm_b32 v78, v78, v24, s33
    v_perm_b32 v86, v86, v25, s33
    v_perm_b32 v79, v79, v16, s33
    v_perm_b32 v87, v87, v17, s33
    v_add_f32 v80, v76, v78
    v_add_f32 v88, v84, v86
    v_add_f32 v81, v77, v79
    v_add_f32 v89, v85, v87
    v_fma_f32 v82, v78, 4.0, v76
    v_fma_f32 v90, v86, 4.0, v84
    v_fma_f32 v83, v79, 4.0, v77
    v_fma_f32 v91, v87, 4.0, v85
    v_add_f32 v77, v80, v81
    v_add_f32 v85, v88, v89
    v_sub_f32 v78, v80, v81
    v_sub_f32 v86, v88, v89
    v_fma_f32 v79, v83, 2.0, v82
    v_fma_f32 v87, v91, 2.0, v90
    v_fma_f32 v82, v83, -2.0, v82
    v_fma_f32 v90, v91, -2.0, v90
    v_fmamk_f32 v80, v76, 0x41700000, v82
    v_fmamk_f32 v88, v84, 0x41700000, v90
    v_fmamk_f32 v80, v81, 0x41200000, v80
    v_fmamk_f32 v88, v89, 0x41200000, v88
    v_mul_f32 v77, 0.5, v77
    v_mul_f32 v85, 0.5, v85
    v_mul_f32 v78, 0.5, v78
    v_mul_f32 v86, 0.5, v86
    v_mul_f32 v79, s35, v79
    v_mul_f32 v87, s35, v87
    v_mul_f32 v82, s35, v82
    v_mul_f32 v90, s35, v90
    v_mul_f32 v80, s36, v80
    v_mul_f32 v88, s36, v88
    v_cvt_pk_bf16_f32 v52, v77, v85
    v_cvt_pk_bf16_f32 v56, v78, v86
    v_cvt_pk_bf16_f32 v60, v79, v87
    v_cvt_pk_bf16_f32 v64, v82, v90
    v_cvt_pk_bf16_f32 v68, v80, v88
    s_waitcnt vmcnt(16)
    v_perm_b32 v73, v19, v18, s32
    v_perm_b32 v49, v43, v42, s32
    v_perm_b32 v76, v76, v42, s33
    v_perm_b32 v84, v84, v43, s33
    v_perm_b32 v77, v77, v34, s33
    v_perm_b32 v85, v85, v35, s33
    v_perm_b32 v78, v78, v26, s33
    v_perm_b32 v86, v86, v27, s33
    v_perm_b32 v79, v79, v18, s33
    v_perm_b32 v87, v87, v19, s33
    v_add_f32 v80, v76, v78
    v_add_f32 v88, v84, v86
    v_add_f32 v81, v77, v79
    v_add_f32 v89, v85, v87
    v_fma_f32 v82, v78, 4.0, v76
    v_fma_f32 v90, v86, 4.0, v84
    v_fma_f32 v83, v79, 4.0, v77
    v_fma_f32 v91, v87, 4.0, v85
    v_add_f32 v77, v80, v81
    v_add_f32 v85, v88, v89
    v_sub_f32 v78, v80, v81
    v_sub_f32 v86, v88, v89
    v_fma_f32 v79, v83, 2.0, v82
    v_fma_f32 v87, v91, 2.0, v90
    v_fma_f32 v82, v83, -2.0, v82
    v_fma_f32 v90, v91, -2.0, v90
    v_fmamk_f32 v80, v76, 0x41700000, v82
    v_fmamk_f32 v88, v84, 0x41700000, v90
    v_fmamk_f32 v80, v81, 0x41200000, v80
    v_fmamk_f32 v88, v89, 0x41200000, v88
    v_mul_f32 v77, 0.5, v77
    v_mul_f32 v85, 0.5, v85
    v_mul_f32 v78, 0.5, v78
    v_mul_f32 v86, 0.5, v86
    v_mul_f32 v79, s35, v79
    v_mul_f32 v87, s35, v87
    v_mul_f32 v82, s35, v82
    v_mul_f32 v90, s35, v90
    v_mul_f32 v80, s36, v80
    v_mul_f32 v88, s36, v88
    v_cvt_pk_bf16_f32 v53, v77, v85
    v_cvt_pk_bf16_f32 v57, v78, v86
    v_cvt_pk_bf16_f32 v61, v79, v87
    v_cvt_pk_bf16_f32 v65, v82, v90
    v_cvt_pk_bf16_f32 v69, v80, v88
    s_waitcnt vmcnt(8)
    v_perm_b32 v74, v21, v20, s32
    v_perm_b32 v50, v45, v44, s32
    v_perm_b32 v76, v76, v44, s33
    v_perm_b32 v84, v84, v45, s33
    v_perm_b32 v77, v77, v36, s33
    v_perm_b32 v85, v85, v37, s33
    v_perm_b32 v78, v78, v28, s33
    v_perm_b32 v86, v86, v29, s33
    v_perm_b32 v79, v79, v20, s33
    v_perm_b32 v87, v87, v21, s33
    v_add_f32 v80, v76, v78
    v_add_f32 v88, v84, v86
    v_add_f32 v81, v77, v79
    v_add_f32 v89, v85, v87
    v_fma_f32 v82, v78, 4.0, v76
    v_fma_f32 v90, v86, 4.0, v84
    v_fma_f32 v83, v79, 4.0, v77
    v_fma_f32 v91, v87, 4.0, v85
    v_add_f32 v77, v80, v81
    v_add_f32 v85, v88, v89
    v_sub_f32 v78, v80, v81
    v_sub_f32 v86, v88, v89
    v_fma_f32 v79, v83, 2.0, v82
    v_fma_f32 v87, v91, 2.0, v90
    v_fma_f32 v82, v83, -2.0, v82
    v_fma_f32 v90, v91, -2.0, v90
    v_fmamk_f32 v80, v76, 0x41700000, v82
    v_fmamk_f32 v88, v84, 0x41700000, v90
    v_fmamk_f32 v80, v81, 0x41200000, v80
    v_fmamk_f32 v88, v89, 0x41200000, v88
    v_mul_f32 v77, 0.5, v77
    v_mul_f32 v85, 0.5, v85
    v_mul_f32 v78, 0.5, v78
    v_mul_f32 v86, 0.5, v86
    v_mul_f32 v79, s35, v79
    v_mul_f32 v87, s35, v87
    v_mul_f32 v82, s35, v82
    v_mul_f32 v90, s35, v90
    v_mul_f32 v80, s36, v80
    v_mul_f32 v88, s36, v88
    v_cvt_pk_bf16_f32 v54, v77, v85
    v_cvt_pk_bf16_f32 v58, v78, v86
    v_cvt_pk_bf16_f32 v62, v79, v87
    v_cvt_pk_bf16_f32 v66, v82, v90
    v_cvt_pk_bf16_f32 v70, v80, v88
    s_waitcnt vmcnt(0)
    v_perm_b32 v75, v23, v22, s32
    v_perm_b32 v51, v47, v46, s32
    v_perm_b32 v76, v76, v46, s33
    v_perm_b32 v84, v84, v47, s33
    v_perm_b32 v77, v77, v38, s33
    v_perm_b32 v85, v85, v39, s33
    v_perm_b32 v78, v78, v30, s33
    v_perm_b32 v86, v86, v31, s33
    v_perm_b32 v79, v79, v22, s33
    v_perm_b32 v87, v87, v23, s33
    v_add_f32 v80, v76, v78
    v_add_f32 v88, v84, v86
    v_add_f32 v81, v77, v79
    v_add_f32 v89, v85, v87
    v_fma_f32 v82, v78, 4.0, v76
    v_fma_f32 v90, v86, 4.0, v84
    v_fma_f32 v83, v79, 4.0, v77
    v_fma_f32 v91, v87, 4.0, v85
    v_add_f32 v77, v80, v81
    v_add_f32 v85, v88, v89
    v_sub_f32 v78, v80, v81
    v_sub_f32 v86, v88, v89
    v_fma_f32 v79, v83, 2.0, v82
    v_fma_f32 v87, v91, 2.0, v90
    v_fma_f32 v82, v83, -2.0, v82
    v_fma_f32 v90, v91, -2.0, v90
    v_fmamk_f32 v80, v76, 0x41700000, v82
    v_fmamk_f32 v88, v84, 0x41700000, v90
    v_fmamk_f32 v80, v81, 0x41200000, v80
    v_fmamk_f32 v88, v89, 0x41200000, v88
    v_mul_f32 v77, 0.5, v77
    v_mul_f32 v85, 0.5, v85
    v_mul_f32 v78, 0.5, v78
    v_mul_f32 v86, 0.5, v86
    v_mul_f32 v79, s35, v79
    v_mul_f32 v87, s35, v87
    v_mul_f32 v82, s35, v82
    v_mul_f32 v90, s35, v90
    v_mul_f32 v80, s36, v80
    v_mul_f32 v88, s36, v88
    v_cvt_pk_bf16_f32 v55, v77, v85
    v_cvt_pk_bf16_f32 v59, v78, v86
    v_cvt_pk_bf16_f32 v63, v79, v87
    v_cvt_pk_bf16_f32 v67, v82, v90
    v_cvt_pk_bf16_f32 v71, v80, v88
    s_add_u32 s28, s27, 49152
    buffer_store_dwordx4 v[72:75], v4, s[12:15], s28 offen sc1
    s_add_u32 s28, s27, 0
    buffer_store_dwordx4 v[48:51], v4, s[12:15], s28 offen sc1
    s_add_u32 s28, s27, 8192
    buffer_store_dwordx4 v[52:55], v4, s[12:15], s28 offen sc1
    s_add_u32 s28, s27, 16384
    buffer_store_dwordx4 v[56:59], v4, s[12:15], s28 offen sc1
    s_add_u32 s28, s27, 24576
    buffer_store_dwordx4 v[60:63], v4, s[12:15], s28 offen sc1
    s_add_u32 s28, s27, 32768
    buffer_store_dwordx4 v[64:67], v4, s[12:15], s28 offen sc1
    s_add_u32 s28, s27, 40960
    buffer_store_dwordx4 v[68:71], v4, s[12:15], s28 offen sc1
    s_mov_b32 s20, s58
    s_branch L_conv1_kernel_end
L_conv1_kernel_epi:
    v_and_b32 v108, 15, v127
    v_lshrrev_b32 v109, 4, v127
    v_lshrrev_b32 v110, 3, v108
    s_lshl_b32 s36, s20, 1
    v_add_u32 v110, s36, v110
    v_xor_b32 v111, v110, v108
    v_and_b32 v111, 7, v111
    v_lshlrev_b32 v111, 4, v111
    v_lshl_add_u32 v111, v110, 7, v111
    v_lshl_add_u32 v120, v109, 11, v111
    v_add_u32 v121, 65536, v120
    v_add_u32 v125, 131072, v120
    s_lshl_b32 s36, s20, 9
    s_add_u32 s36, s36, 115712
    v_lshl_add_u32 v123, v109, 7, s36
    s_lshl_b32 s36, s20, 4
    v_add_u32 v108, s36, v108
    v_lshl_add_u32 v110, v108, 2, s21
    v_lshlrev_b32 v110, 9, v110
    v_lshl_add_u32 v110, v109, 4, v110
    s_lshl_b32 s36, s29, 6
    v_add_u32 v110, s36, v110
    v_mov_b32 v111, 2130706432
    v_cmp_gt_u32 vcc, 125, v108
    s_mov_b32 s4, 0xbeaaaaab
    s_mov_b32 s5, s4
    s_mov_b32 s6, 0x3e800000
    s_mov_b32 s7, s6
    s_mov_b32 s8, 0xc0a00000
    s_mov_b32 s9, s8
    s_mov_b32 s10, 0xc0638e39
    s_mov_b32 s11, s10
    s_mov_b32 s12, 0xbf638e39
    s_mov_b32 s13, s12
    s_mov_b32 s14, 0xbe638e39
    s_mov_b32 s15, s14
    s_mov_b32 s22, 0xbd638e39
    s_mov_b32 s23, s22
    s_mov_b32 s24, 0x3ff1c71c
    s_mov_b32 s25, s24
    s_mov_b32 s26, 0xbf2aaaab
    s_mov_b32 s27, s26
    s_mov_b32 s32, 0x3ecccccd
    s_mov_b32 s33, s32
    s_mov_b32 s34, 0xbd888889
    s_mov_b32 s35, s34
    s_mov_b32 s38, 0xbe4ccccd
    s_mov_b32 s39, s38
    s_mov_b32 s40, 0xbdd2d3e8
    s_mov_b32 s41, s40
    s_mov_b32 s42, 0x3f800000
    s_mov_b32 s43, s42
    s_waitcnt lgkmcnt(0)
    s_barrier
    v_cndmask_b32 v122, v111, v110, vcc
    ds_read_b128 v[0:3], v120 offset:0
    ds_read_b128 v[4:7], v120 offset:16384
    ds_read_b128 v[8:11], v120 offset:32768
    ds_read_b128 v[12:15], v120 offset:49152
    ds_read_b128 v[16:19], v121 offset:0
    ds_read_b128 v[20:23], v121 offset:16384
    ds_read_b128 v[24:27], v121 offset:32768
    ds_read_b128 v[28:31], v125 offset:15360
    ds_read_b128 v[32:35], v120 offset:8192
    ds_read_b128 v[36:39], v120 offset:24576
    ds_read_b128 v[40:43], v120 offset:40960
    ds_read_b128 v[44:47], v120 offset:57344
    ds_read_b128 v[48:51], v121 offset:56320
    ds_read_b128 v[52:55], v121 offset:64512
    ds_read_b128 v[56:59], v125 offset:7168
    s_waitcnt lgkmcnt(7)
    ds_read_b128 v[60:63], v125 offset:23552
    s_waitcnt lgkmcnt(8)
    v_pk_add_f32 v[88:89], v[24:25], v[28:29]
    v_pk_add_f32 v[90:91], v[26:27], v[30:31]
    v_pk_add_f32 v[24:25], v[4:5], v[8:9]
    v_pk_add_f32 v[26:27], v[6:7], v[10:11]
    v_pk_add_f32 v[4:5], v[4:5], v[8:9] neg_lo:[0,1] neg_hi:[0,1]
    v_pk_add_f32 v[6:7], v[6:7], v[10:11] neg_lo:[0,1] neg_hi:[0,1]
    v_pk_add_f32 v[72:73], v[12:13], v[16:17]
    v_pk_add_f32 v[74:75], v[14:15], v[18:19]
    v_pk_add_f32 v[12:13], v[12:13], v[16:17] neg_lo:[0,1] neg_hi:[0,1]
    v_pk_add_f32 v[14:15], v[14:15], v[18:19] neg_lo:[0,1] neg_hi:[0,1]
    v_pk_fma_f32 v[72:73], v[24:25], s[4:5], v[72:73]
    v_pk_fma_f32 v[74:75], v[26:27], s[4:5], v[74:75]
    v_pk_fma_f32 v[20:21], v[0:1], s[10:11], v[20:21]
    v_pk_fma_f32 v[22:23], v[2:3], s[10:11], v[22:23]
    v_pk_fma_f32 v[72:73], v[0:1], s[6:7], v[72:73]
    v_pk_fma_f32 v[74:75], v[2:3], s[6:7], v[74:75]
    v_pk_add_f32 v[24:25], v[24:25], v[0:1] neg_lo:[0,1] neg_hi:[0,1]
    v_pk_add_f32 v[26:27], v[26:27], v[2:3] neg_lo:[0,1] neg_hi:[0,1]
    v_pk_fma_f32 v[72:73], v[88:89], s[8:9], v[72:73]
    v_pk_fma_f32 v[74:75], v[90:91], s[8:9], v[74:75]
    v_pk_add_f32 v[24:25], v[24:25], v[88:89] neg_lo:[0,1] neg_hi:[0,1]
    v_pk_add_f32 v[26:27], v[26:27], v[90:91] neg_lo:[0,1] neg_hi:[0,1]
    v_pk_fma_f32 v[20:21], v[88:89], s[22:23], v[20:21]
    v_pk_fma_f32 v[22:23], v[90:91], s[22:23], v[22:23]
    v_pk_add_f32 v[8:9], v[24:25], v[72:73] neg_lo:[0,1] neg_hi:[0,1]
    v_pk_add_f32 v[10:11], v[26:27], v[74:75] neg_lo:[0,1] neg_hi:[0,1]
    v_pk_fma_f32 v[20:21], v[72:73], s[14:15], v[20:21]
    v_pk_fma_f32 v[22:23], v[74:75], s[14:15], v[22:23]
    v_pk_mul_f32 v[80:81], v[12:13], s[32:33]
    v_pk_mul_f32 v[82:83], v[14:15], s[32:33]
    v_pk_fma_f32 v[20:21], v[8:9], s[12:13], v[20:21]
    v_pk_fma_f32 v[22:23], v[10:11], s[12:13], v[22:23]
    v_pk_fma_f32 v[80:81], v[4:5], s[34:35], v[80:81]
    v_pk_fma_f32 v[82:83], v[6:7], s[34:35], v[82:83]
    v_pk_fma_f32 v[64:65], v[4:5], s[24:25], v[20:21] neg_lo:[0,0,1] neg_hi:[0,0,1]
    v_pk_fma_f32 v[66:67], v[6:7], s[24:25], v[22:23] neg_lo:[0,0,1] neg_hi:[0,0,1]
    v_pk_fma_f32 v[64:65], v[12:13], s[26:27], v[64:65]
    v_pk_fma_f32 v[66:67], v[14:15], s[26:27], v[66:67]
    v_pk_fma_f32 v[80:81], v[64:65], s[38:39], v[80:81]
    v_pk_fma_f32 v[82:83], v[66:67], s[38:39], v[82:83]
    v_pk_add_f32 v[4:5], v[4:5], v[64:65] neg_lo:[0,1] neg_hi:[0,1]
    v_pk_add_f32 v[6:7], v[6:7], v[66:67] neg_lo:[0,1] neg_hi:[0,1]
    v_pk_add_f32 v[4:5], v[4:5], v[80:81] neg_lo:[0,1] neg_hi:[0,1]
    v_pk_add_f32 v[6:7], v[6:7], v[82:83] neg_lo:[0,1] neg_hi:[0,1]
    s_waitcnt lgkmcnt(0)
    v_pk_add_f32 v[92:93], v[56:57], v[60:61]
    v_pk_add_f32 v[94:95], v[58:59], v[62:63]
    v_pk_add_f32 v[56:57], v[36:37], v[40:41]
    v_pk_add_f32 v[58:59], v[38:39], v[42:43]
    v_pk_add_f32 v[36:37], v[36:37], v[40:41] neg_lo:[0,1] neg_hi:[0,1]
    v_pk_add_f32 v[38:39], v[38:39], v[42:43] neg_lo:[0,1] neg_hi:[0,1]
    v_pk_add_f32 v[76:77], v[44:45], v[48:49]
    v_pk_add_f32 v[78:79], v[46:47], v[50:51]
    v_pk_add_f32 v[44:45], v[44:45], v[48:49] neg_lo:[0,1] neg_hi:[0,1]
    v_pk_add_f32 v[46:47], v[46:47], v[50:51] neg_lo:[0,1] neg_hi:[0,1]
    v_pk_fma_f32 v[76:77], v[56:57], s[4:5], v[76:77]
    v_pk_fma_f32 v[78:79], v[58:59], s[4:5], v[78:79]
    v_pk_fma_f32 v[52:53], v[32:33], s[10:11], v[52:53]
    v_pk_fma_f32 v[54:55], v[34:35], s[10:11], v[54:55]
    v_pk_fma_f32 v[76:77], v[32:33], s[6:7], v[76:77]
    v_pk_fma_f32 v[78:79], v[34:35], s[6:7], v[78:79]
    v_pk_add_f32 v[56:57], v[56:57], v[32:33] neg_lo:[0,1] neg_hi:[0,1]
    v_pk_add_f32 v[58:59], v[58:59], v[34:35] neg_lo:[0,1] neg_hi:[0,1]
    v_pk_fma_f32 v[76:77], v[92:93], s[8:9], v[76:77]
    v_pk_fma_f32 v[78:79], v[94:95], s[8:9], v[78:79]
    v_pk_add_f32 v[56:57], v[56:57], v[92:93] neg_lo:[0,1] neg_hi:[0,1]
    v_pk_add_f32 v[58:59], v[58:59], v[94:95] neg_lo:[0,1] neg_hi:[0,1]
    v_pk_fma_f32 v[52:53], v[92:93], s[22:23], v[52:53]
    v_pk_fma_f32 v[54:55], v[94:95], s[22:23], v[54:55]
    v_pk_add_f32 v[40:41], v[56:57], v[76:77] neg_lo:[0,1] neg_hi:[0,1]
    v_pk_add_f32 v[42:43], v[58:59], v[78:79] neg_lo:[0,1] neg_hi:[0,1]
    v_pk_fma_f32 v[52:53], v[76:77], s[14:15], v[52:53]
    v_pk_fma_f32 v[54:55], v[78:79], s[14:15], v[54:55]
    v_pk_mul_f32 v[84:85], v[44:45], s[32:33]
    v_pk_mul_f32 v[86:87], v[46:47], s[32:33]
    v_pk_fma_f32 v[52:53], v[40:41], s[12:13], v[52:53]
    v_pk_fma_f32 v[54:55], v[42:43], s[12:13], v[54:55]
    v_pk_fma_f32 v[84:85], v[36:37], s[34:35], v[84:85]
    v_pk_fma_f32 v[86:87], v[38:39], s[34:35], v[86:87]
    v_pk_fma_f32 v[68:69], v[36:37], s[24:25], v[52:53] neg_lo:[0,0,1] neg_hi:[0,0,1]
    v_pk_fma_f32 v[70:71], v[38:39], s[24:25], v[54:55] neg_lo:[0,0,1] neg_hi:[0,0,1]
    v_pk_fma_f32 v[68:69], v[44:45], s[26:27], v[68:69]
    v_pk_fma_f32 v[70:71], v[46:47], s[26:27], v[70:71]
    v_pk_fma_f32 v[84:85], v[68:69], s[38:39], v[84:85]
    v_pk_fma_f32 v[86:87], v[70:71], s[38:39], v[86:87]
    v_pk_add_f32 v[36:37], v[36:37], v[68:69] neg_lo:[0,1] neg_hi:[0,1]
    v_pk_add_f32 v[38:39], v[38:39], v[70:71] neg_lo:[0,1] neg_hi:[0,1]
    v_pk_add_f32 v[36:37], v[36:37], v[84:85] neg_lo:[0,1] neg_hi:[0,1]
    v_pk_add_f32 v[38:39], v[38:39], v[86:87] neg_lo:[0,1] neg_hi:[0,1]
    s_mov_b32 s36, 0x00010001
    s_mov_b32 s37, 0x00010001
    s_mov_b64 exec, s[36:37]
    ds_write_b128 v123, v[0:3] offset:0
    ds_write_b128 v123, v[32:35] offset:16
    ds_write_b128 v123, v[4:7] offset:32
    ds_write_b128 v123, v[36:39] offset:48
    ds_write_b128 v123, v[8:11] offset:64
    ds_write_b128 v123, v[40:43] offset:80
    s_mov_b64 exec, -1
    v_mov_b32 v44, 0xc0135761
    v_mov_b32 v45, v44
    v_pk_mul_f32 v[16:17], v[64:65], v[64:65]
    v_pk_mul_f32 v[18:19], v[66:67], v[66:67]
    v_pk_mul_f32 v[20:21], v[68:69], v[68:69]
    v_pk_mul_f32 v[22:23], v[70:71], v[70:71]
    v_pk_fma_f32 v[16:17], v[16:17], s[40:41], v[44:45]
    v_pk_fma_f32 v[18:19], v[18:19], s[40:41], v[44:45]
    v_pk_fma_f32 v[20:21], v[20:21], s[40:41], v[44:45]
    v_pk_fma_f32 v[22:23], v[22:23], s[40:41], v[44:45]
    v_pk_mul_f32 v[16:17], v[16:17], v[64:65]
    v_pk_mul_f32 v[18:19], v[18:19], v[66:67]
    v_pk_mul_f32 v[20:21], v[20:21], v[68:69]
    v_pk_mul_f32 v[22:23], v[22:23], v[70:71]
    v_exp_f32 v16, v16
    v_exp_f32 v17, v17
    v_exp_f32 v18, v18
    v_exp_f32 v19, v19
    v_exp_f32 v20, v20
    v_exp_f32 v21, v21
    v_exp_f32 v22, v22
    v_exp_f32 v23, v23
    v_pk_add_f32 v[16:17], v[16:17], s[42:43]
    v_pk_add_f32 v[18:19], v[18:19], s[42:43]
    v_pk_add_f32 v[20:21], v[20:21], s[42:43]
    v_pk_add_f32 v[22:23], v[22:23], s[42:43]
    v_rcp_f32 v16, v16
    v_rcp_f32 v17, v17
    v_rcp_f32 v18, v18
    v_rcp_f32 v19, v19
    v_rcp_f32 v20, v20
    v_rcp_f32 v21, v21
    v_rcp_f32 v22, v22
    v_rcp_f32 v23, v23
    v_pk_mul_f32 v[64:65], v[64:65], v[16:17]
    v_pk_mul_f32 v[66:67], v[66:67], v[18:19]
    v_pk_mul_f32 v[68:69], v[68:69], v[20:21]
    v_pk_mul_f32 v[70:71], v[70:71], v[22:23]
    v_cvt_pk_bf16_f32 v48, v64, v68
    v_cvt_pk_bf16_f32 v49, v65, v69
    v_cvt_pk_bf16_f32 v50, v66, v70
    v_cvt_pk_bf16_f32 v51, v67, v71
    buffer_store_dwordx4 v[48:51], v122, s[16:19], 0 offen offset:0 sc1
    s_waitcnt lgkmcnt(0)
    s_barrier
    ds_read_b128 v[96:99], v123 offset:512
    ds_read_b128 v[100:103], v123 offset:528
    ds_read_b128 v[104:107], v123 offset:544
    ds_read_b128 v[108:111], v123 offset:560
    ds_read_b128 v[112:115], v123 offset:576
    ds_read_b128 v[116:119], v123 offset:592
    s_waitcnt lgkmcnt(4)
    v_mov_b32_dpp v96, v0 row_shl:1 row_mask:0xf bank_mask:0xf
    v_mov_b32_dpp v97, v1 row_shl:1 row_mask:0xf bank_mask:0xf
    v_mov_b32_dpp v98, v2 row_shl:1 row_mask:0xf bank_mask:0xf
    v_mov_b32_dpp v99, v3 row_shl:1 row_mask:0xf bank_mask:0xf
    v_mov_b32_dpp v100, v32 row_shl:1 row_mask:0xf bank_mask:0xf
    v_mov_b32_dpp v101, v33 row_shl:1 row_mask:0xf bank_mask:0xf
    v_mov_b32_dpp v102, v34 row_shl:1 row_mask:0xf bank_mask:0xf
    v_mov_b32_dpp v103, v35 row_shl:1 row_mask:0xf bank_mask:0xf
    v_pk_add_f32 v[72:73], v[72:73], v[96:97]
    v_pk_add_f32 v[74:75], v[74:75], v[98:99]
    v_pk_add_f32 v[76:77], v[76:77], v[100:101]
    v_pk_add_f32 v[78:79], v[78:79], v[102:103]
    v_pk_mul_f32 v[24:25], v[72:73], v[72:73]
    v_pk_mul_f32 v[26:27], v[74:75], v[74:75]
    v_pk_mul_f32 v[28:29], v[76:77], v[76:77]
    v_pk_mul_f32 v[30:31], v[78:79], v[78:79]
    v_pk_fma_f32 v[24:25], v[24:25], s[40:41], v[44:45]
    v_pk_fma_f32 v[26:27], v[26:27], s[40:41], v[44:45]
    v_pk_fma_f32 v[28:29], v[28:29], s[40:41], v[44:45]
    v_pk_fma_f32 v[30:31], v[30:31], s[40:41], v[44:45]
    v_pk_mul_f32 v[24:25], v[24:25], v[72:73]
    v_pk_mul_f32 v[26:27], v[26:27], v[74:75]
    v_pk_mul_f32 v[28:29], v[28:29], v[76:77]
    v_pk_mul_f32 v[30:31], v[30:31], v[78:79]
    v_exp_f32 v24, v24
    v_exp_f32 v25, v25
    v_exp_f32 v26, v26
    v_exp_f32 v27, v27
    v_exp_f32 v28, v28
    v_exp_f32 v29, v29
    v_exp_f32 v30, v30
    v_exp_f32 v31, v31
    v_pk_add_f32 v[24:25], v[24:25], s[42:43]
    v_pk_add_f32 v[26:27], v[26:27], s[42:43]
    v_pk_add_f32 v[28:29], v[28:29], s[42:43]
    v_pk_add_f32 v[30:31], v[30:31], s[42:43]
    v_rcp_f32 v24, v24
    v_rcp_f32 v25, v25
    v_rcp_f32 v26, v26
    v_rcp_f32 v27, v27
    v_rcp_f32 v28, v28
    v_rcp_f32 v29, v29
    v_rcp_f32 v30, v30
    v_rcp_f32 v31, v31
    v_pk_mul_f32 v[72:73], v[72:73], v[24:25]
    v_pk_mul_f32 v[74:75], v[74:75], v[26:27]
    v_pk_mul_f32 v[76:77], v[76:77], v[28:29]
    v_pk_mul_f32 v[78:79], v[78:79], v[30:31]
    v_cvt_pk_bf16_f32 v52, v72, v76
    v_cvt_pk_bf16_f32 v53, v73, v77
    v_cvt_pk_bf16_f32 v54, v74, v78
    v_cvt_pk_bf16_f32 v55, v75, v79
    buffer_store_dwordx4 v[52:55], v122, s[16:19], 0 offen offset:512 sc1
    s_waitcnt lgkmcnt(2)
    v_mov_b32_dpp v104, v4 row_shl:1 row_mask:0xf bank_mask:0xf
    v_mov_b32_dpp v105, v5 row_shl:1 row_mask:0xf bank_mask:0xf
    v_mov_b32_dpp v106, v6 row_shl:1 row_mask:0xf bank_mask:0xf
    v_mov_b32_dpp v107, v7 row_shl:1 row_mask:0xf bank_mask:0xf
    v_mov_b32_dpp v108, v36 row_shl:1 row_mask:0xf bank_mask:0xf
    v_mov_b32_dpp v109, v37 row_shl:1 row_mask:0xf bank_mask:0xf
    v_mov_b32_dpp v110, v38 row_shl:1 row_mask:0xf bank_mask:0xf
    v_mov_b32_dpp v111, v39 row_shl:1 row_mask:0xf bank_mask:0xf
    v_pk_add_f32 v[80:81], v[80:81], v[104:105]
    v_pk_add_f32 v[82:83], v[82:83], v[106:107]
    v_pk_add_f32 v[84:85], v[84:85], v[108:109]
    v_pk_add_f32 v[86:87], v[86:87], v[110:111]
    v_pk_mul_f32 v[16:17], v[80:81], v[80:81]
    v_pk_mul_f32 v[18:19], v[82:83], v[82:83]
    v_pk_mul_f32 v[20:21], v[84:85], v[84:85]
    v_pk_mul_f32 v[22:23], v[86:87], v[86:87]
    v_pk_fma_f32 v[16:17], v[16:17], s[40:41], v[44:45]
    v_pk_fma_f32 v[18:19], v[18:19], s[40:41], v[44:45]
    v_pk_fma_f32 v[20:21], v[20:21], s[40:41], v[44:45]
    v_pk_fma_f32 v[22:23], v[22:23], s[40:41], v[44:45]
    v_pk_mul_f32 v[16:17], v[16:17], v[80:81]
    v_pk_mul_f32 v[18:19], v[18:19], v[82:83]
    v_pk_mul_f32 v[20:21], v[20:21], v[84:85]
    v_pk_mul_f32 v[22:23], v[22:23], v[86:87]
    v_exp_f32 v16, v16
    v_exp_f32 v17, v17
    v_exp_f32 v18, v18
    v_exp_f32 v19, v19
    v_exp_f32 v20, v20
    v_exp_f32 v21, v21
    v_exp_f32 v22, v22
    v_exp_f32 v23, v23
    v_pk_add_f32 v[16:17], v[16:17], s[42:43]
    v_pk_add_f32 v[18:19], v[18:19], s[42:43]
    v_pk_add_f32 v[20:21], v[20:21], s[42:43]
    v_pk_add_f32 v[22:23], v[22:23], s[42:43]
    v_rcp_f32 v16, v16
    v_rcp_f32 v17, v17
    v_rcp_f32 v18, v18
    v_rcp_f32 v19, v19
    v_rcp_f32 v20, v20
    v_rcp_f32 v21, v21
    v_rcp_f32 v22, v22
    v_rcp_f32 v23, v23
    v_pk_mul_f32 v[80:81], v[80:81], v[16:17]
    v_pk_mul_f32 v[82:83], v[82:83], v[18:19]
    v_pk_mul_f32 v[84:85], v[84:85], v[20:21]
    v_pk_mul_f32 v[86:87], v[86:87], v[22:23]
    v_cvt_pk_bf16_f32 v56, v80, v84
    v_cvt_pk_bf16_f32 v57, v81, v85
    v_cvt_pk_bf16_f32 v58, v82, v86
    v_cvt_pk_bf16_f32 v59, v83, v87
    buffer_store_dwordx4 v[56:59], v122, s[16:19], 0 offen offset:1024 sc1
    s_waitcnt lgkmcnt(0)
    v_mov_b32_dpp v112, v8 row_shl:1 row_mask:0xf bank_mask:0xf
    v_mov_b32_dpp v113, v9 row_shl:1 row_mask:0xf bank_mask:0xf
    v_mov_b32_dpp v114, v10 row_shl:1 row_mask:0xf bank_mask:0xf
    v_mov_b32_dpp v115, v11 row_shl:1 row_mask:0xf bank_mask:0xf
    v_mov_b32_dpp v116, v40 row_shl:1 row_mask:0xf bank_mask:0xf
    v_mov_b32_dpp v117, v41 row_shl:1 row_mask:0xf bank_mask:0xf
    v_mov_b32_dpp v118, v42 row_shl:1 row_mask:0xf bank_mask:0xf
    v_mov_b32_dpp v119, v43 row_shl:1 row_mask:0xf bank_mask:0xf
    v_pk_add_f32 v[88:89], v[88:89], v[112:113]
    v_pk_add_f32 v[90:91], v[90:91], v[114:115]
    v_pk_add_f32 v[92:93], v[92:93], v[116:117]
    v_pk_add_f32 v[94:95], v[94:95], v[118:119]
    v_pk_mul_f32 v[24:25], v[88:89], v[88:89]
    v_pk_mul_f32 v[26:27], v[90:91], v[90:91]
    v_pk_mul_f32 v[28:29], v[92:93], v[92:93]
    v_pk_mul_f32 v[30:31], v[94:95], v[94:95]
    v_pk_fma_f32 v[24:25], v[24:25], s[40:41], v[44:45]
    v_pk_fma_f32 v[26:27], v[26:27], s[40:41], v[44:45]
    v_pk_fma_f32 v[28:29], v[28:29], s[40:41], v[44:45]
    v_pk_fma_f32 v[30:31], v[30:31], s[40:41], v[44:45]
    v_pk_mul_f32 v[24:25], v[24:25], v[88:89]
    v_pk_mul_f32 v[26:27], v[26:27], v[90:91]
    v_pk_mul_f32 v[28:29], v[28:29], v[92:93]
    v_pk_mul_f32 v[30:31], v[30:31], v[94:95]
    v_exp_f32 v24, v24
    v_exp_f32 v25, v25
    v_exp_f32 v26, v26
    v_exp_f32 v27, v27
    v_exp_f32 v28, v28
    v_exp_f32 v29, v29
    v_exp_f32 v30, v30
    v_exp_f32 v31, v31
    v_pk_add_f32 v[24:25], v[24:25], s[42:43]
    v_pk_add_f32 v[26:27], v[26:27], s[42:43]
    v_pk_add_f32 v[28:29], v[28:29], s[42:43]
    v_pk_add_f32 v[30:31], v[30:31], s[42:43]
    v_rcp_f32 v24, v24
    v_rcp_f32 v25, v25
    v_rcp_f32 v26, v26
    v_rcp_f32 v27, v27
    v_rcp_f32 v28, v28
    v_rcp_f32 v29, v29
    v_rcp_f32 v30, v30
    v_rcp_f32 v31, v31
    v_pk_mul_f32 v[88:89], v[88:89], v[24:25]
    v_pk_mul_f32 v[90:91], v[90:91], v[26:27]
    v_pk_mul_f32 v[92:93], v[92:93], v[28:29]
    v_pk_mul_f32 v[94:95], v[94:95], v[30:31]
    v_cvt_pk_bf16_f32 v60, v88, v92
    v_cvt_pk_bf16_f32 v61, v89, v93
    v_cvt_pk_bf16_f32 v62, v90, v94
    v_cvt_pk_bf16_f32 v63, v91, v95
    buffer_store_dwordx4 v[60:63], v122, s[16:19], 0 offen offset:1536 sc1
L_conv1_kernel_end:
L_conv1_kernel_done:
    s_endpgm
.globl conv2_kernel
.p2align 8
.type conv2_kernel,@function
conv2_kernel:
    s_cmp_ge_u32 s2, 256
    s_cbranch_scc1 L_conv2_kernel_done
    s_load_dwordx2 s[4:5], s[0:1], 72
    s_load_dwordx2 s[30:31], s[0:1], 72
    v_readfirstlane_b32 s20, v0
    s_lshr_b32 s20, s20, 6
    s_and_b32 s36, s2, 0
    s_lshl_b32 s36, s36, 3
    s_bfe_u32 s37, s2, 196611
    s_or_b32 s29, s36, s37
    s_bfe_u32 s36, s2, 196608
    s_lshl_b32 s36, s36, 2
    s_lshr_b32 s37, s2, 6
    s_or_b32 s36, s36, s37
    s_lshr_b32 s33, s36, 4
    s_and_b32 s34, s36, 7
    s_bfe_u32 s35, s36, 0x10003
    s_mul_i32 s21, s34, 500
    s_and_b32 s32, s20, 3
    v_and_b32 v127, 63, v0
    v_lshrrev_b32 v5, 2, v127
    v_and_b32 v6, 3, v127
    v_lshlrev_b32 v7, 15, v5
    v_lshl_add_u32 v7, v6, 4, v7
    s_lshl_b32 s41, s21, 10
    s_lshl_b32 s37, s33, 9
    s_add_u32 s41, s41, s37
    s_sub_u32 s41, s41, 7680
    s_and_b32 s42, s20, 7
    s_lshl_b32 s37, s42, 12
    s_add_u32 s37, s37, s41
    v_add_u32 v7, s37, v7
    s_mul_i32 s36, s35, 4096000
    s_add_u32 s36, s36, 18874368
    s_mov_b32 s10, 4096000
    s_mov_b32 s11, 0x00020000
    s_mov_b32 s25, 0xffff0000
    s_waitcnt lgkmcnt(0)
    s_add_u32 s8, s4, s36
    s_addc_u32 s9, s5, 0
    s_cmp_ge_u32 s20, 8
    s_cbranch_scc1 L_conv2_kernel_helper
    s_add_u32 s37, s41, 524288
    v_lshl_add_u32 v108, v127, 4, s37
    s_lshl_b32 s36, s29, 4
    s_lshl_b32 s37, s33, 3
    s_add_u32 s36, s36, s37
    s_mul_i32 s36, s36, 57344
    s_add_u32 s36, s36, 9437184
    s_add_u32 s12, s30, s36
    s_addc_u32 s13, s31, 0
    s_mov_b32 s14, 458752
    s_mov_b32 s15, 0x00020000
    s_mul_i32 s36, s35, 2048000
    s_add_u32 s36, s36, 27262976
    s_mul_i32 s37, s33, 8388608
    s_add_u32 s36, s36, s37
    s_add_u32 s16, s30, s36
    s_addc_u32 s17, s31, 0
    s_mov_b32 s18, 2048000
    s_mov_b32 s19, 0x00020000
    v_and_b32 v10, 15, v127
    v_lshrrev_b32 v11, 4, v127
    v_add_u32 v8, 0, v10
    v_and_b32 v16, 4, v8
    v_lshrrev_b32 v16, 1, v16
    v_xor_b32 v16, v11, v16
    v_lshlrev_b32 v16, 4, v16
    v_lshl_add_u32 v8, v8, 6, v16
    v_add_u32 v9, 1, v10
    v_and_b32 v16, 4, v9
    v_lshrrev_b32 v16, 1, v16
    v_xor_b32 v16, v11, v16
    v_lshlrev_b32 v16, 4, v16
    v_lshl_add_u32 v9, v9, 6, v16
    s_lshr_b32 s38, s32, 1
    s_and_b32 s39, s32, 1
    s_add_u32 s40, s38, 4
    s_lshl_b32 s43, s39, 10
    s_cmp_lt_u32 s20, 4
    s_cselect_b32 s40, s20, s40
    s_cselect_b32 s36, 0, s43
    s_lshl_b32 s37, s40, 13
    s_add_u32 s37, s37, s36
    v_lshl_add_u32 v125, v127, 4, s37
    s_mul_i32 s37, s40, 16384
    v_add_u32 v120, s37, v8
    v_add_u32 v121, s37, v9
    s_lshl_b32 s37, s40, 10
    s_add_u32 s37, s37, 115712
    v_lshl_add_u32 v16, v11, 4, s37
    v_cmp_eq_u32 vcc, 15, v10
    v_mov_b32 v17, 8192
    v_mov_b32 v18, 4294959104
    v_mov_b32 v19, 64
    v_cndmask_b32 v122, v121, v16, vcc
    v_cndmask_b32 v123, v17, v19, vcc
    v_cndmask_b32 v124, v18, v19, vcc
    v_lshl_add_u32 v126, v127, 4, s37
    s_mov_b32 s44, 0x3f800000
    s_mov_b32 s45, 0x00000000
    s_mov_b32 s46, 0x00000000
    s_cmp_eq_u32 s40, 1
    s_cselect_b32 s45, 0x3f800000, s45
    s_cselect_b32 s46, 0x3f800000, s46
    s_cmp_eq_u32 s40, 2
    s_cselect_b32 s45, 0xbf800000, s45
    s_cselect_b32 s46, 0x3f800000, s46
    s_cmp_eq_u32 s40, 3
    s_cselect_b32 s45, 0x40000000, s45
    s_cselect_b32 s46, 0x40800000, s46
    s_cmp_eq_u32 s40, 4
    s_cselect_b32 s45, 0xc0000000, s45
    s_cselect_b32 s46, 0x40800000, s46
    s_cmp_eq_u32 s40, 5
    s_cselect_b32 s44, 0x41800000, s44
    s_cselect_b32 s45, 0x41000000, s45
    s_cselect_b32 s46, 0x40800000, s46
    s_cmp_ge_u32 s20, 4
    s_cbranch_scc1 L_conv2_kernel_m2
    v_mov_b32 v0, 0
    v_mov_b32 v1, 0
    v_mov_b32 v2, 0
    v_mov_b32 v3, 0
    v_mov_b32 v4, 0
    v_mov_b32 v5, 0
    v_mov_b32 v6, 0
    v_mov_b32 v7, 0
    v_mov_b32 v8, 0
    v_mov_b32 v9, 0
    v_mov_b32 v10, 0
    v_mov_b32 v11, 0
    v_mov_b32 v12, 0
    v_mov_b32 v13, 0
    v_mov_b32 v14, 0
    v_mov_b32 v15, 0
    v_mov_b32 v16, 0
    v_mov_b32 v17, 0
    v_mov_b32 v18, 0
    v_mov_b32 v19, 0
    v_mov_b32 v20, 0
    v_mov_b32 v21, 0
    v_mov_b32 v22, 0
    v_mov_b32 v23, 0
    v_mov_b32 v24, 0
    v_mov_b32 v25, 0
    v_mov_b32 v26, 0
    v_mov_b32 v27, 0
    v_mov_b32 v28, 0
    v_mov_b32 v29, 0
    v_mov_b32 v30, 0
    v_mov_b32 v31, 0
    v_mov_b32 v32, 0
    v_mov_b32 v33, 0
    v_mov_b32 v34, 0
    v_mov_b32 v35, 0
    v_mov_b32 v36, 0
    v_mov_b32 v37, 0
    v_mov_b32 v38, 0
    v_mov_b32 v39, 0
    v_mov_b32 v40, 0
    v_mov_b32 v41, 0
    v_mov_b32 v42, 0
    v_mov_b32 v43, 0
    v_mov_b32 v44, 0
    v_mov_b32 v45, 0
    v_mov_b32 v46, 0
    v_mov_b32 v47, 0
    v_mov_b32 v48, 0
    v_mov_b32 v49, 0
    v_mov_b32 v50, 0
    v_mov_b32 v51, 0
    v_mov_b32 v52, 0
    v_mov_b32 v53, 0
    v_mov_b32 v54, 0
    v_mov_b32 v55, 0
    v_mov_b32 v56, 0
    v_mov_b32 v57, 0
    v_mov_b32 v58, 0
    v_mov_b32 v59, 0
    v_mov_b32 v60, 0
    v_mov_b32 v61, 0
    v_mov_b32 v62, 0
    v_mov_b32 v63, 0
    s_barrier
    buffer_load_dwordx4 v[96:99], v108, s[8:11], 0 offen offset:0
    buffer_load_dwordx4 v[100:103], v108, s[8:11], 0 offen offset:1024
    buffer_load_dwordx4 v[104:107], v108, s[8:11], 0 offen offset:2048
    s_mov_b32 s23, 0
    s_mov_b32 s26, 4096
    buffer_load_dwordx4 v[64:67], v125, s[12:15], s23 offen offset:0
    buffer_load_dwordx4 v[68:71], v125, s[12:15], s23 offen offset:1024
    buffer_load_dwordx4 v[72:75], v125, s[12:15], s23 offen offset:2048
    buffer_load_dwordx4 v[76:79], v125, s[12:15], s23 offen offset:3072
    buffer_load_dwordx4 v[80:83], v125, s[12:15], s26 offen offset:0
    buffer_load_dwordx4 v[84:87], v125, s[12:15], s26 offen offset:1024
    buffer_load_dwordx4 v[88:91], v125, s[12:15], s26 offen offset:2048
    buffer_load_dwordx4 v[92:95], v125, s[12:15], s26 offen offset:3072
    s_mov_b32 s23, 57344
    s_mov_b32 s26, 61440
    s_waitcnt vmcnt(8)
    v_lshlrev_b32 v108, 16, v96
    v_and_b32 v111, s25, v96
    v_lshlrev_b32 v109, 16, v100
    v_and_b32 v112, s25, v100
    v_lshlrev_b32 v110, 16, v104
    v_and_b32 v113, s25, v104
    v_mul_f32 v114, s44, v108
    v_mul_f32 v115, s44, v111
    v_fmac_f32 v114, s45, v109
    v_fmac_f32 v115, s45, v112
    v_fmac_f32 v114, s46, v110
    v_fmac_f32 v115, s46, v113
    v_cvt_pk_bf16_f32 v96, v114, v115
    v_lshlrev_b32 v108, 16, v97
    v_and_b32 v111, s25, v97
    v_lshlrev_b32 v109, 16, v101
    v_and_b32 v112, s25, v101
    v_lshlrev_b32 v110, 16, v105
    v_and_b32 v113, s25, v105
    v_mul_f32 v114, s44, v108
    v_mul_f32 v115, s44, v111
    v_fmac_f32 v114, s45, v109
    v_fmac_f32 v115, s45, v112
    v_fmac_f32 v114, s46, v110
    v_fmac_f32 v115, s46, v113
    v_cvt_pk_bf16_f32 v97, v114, v115
    v_lshlrev_b32 v108, 16, v98
    v_and_b32 v111, s25, v98
    v_lshlrev_b32 v109, 16, v102
    v_and_b32 v112, s25, v102
    v_lshlrev_b32 v110, 16, v106
    v_and_b32 v113, s25, v106
    v_mul_f32 v114, s44, v108
    v_mul_f32 v115, s44, v111
    v_fmac_f32 v114, s45, v109
    v_fmac_f32 v115, s45, v112
    v_fmac_f32 v114, s46, v110
    v_fmac_f32 v115, s46, v113
    v_cvt_pk_bf16_f32 v98, v114, v115
    v_lshlrev_b32 v108, 16, v99
    v_and_b32 v111, s25, v99
    v_lshlrev_b32 v109, 16, v103
    v_and_b32 v112, s25, v103
    v_lshlrev_b32 v110, 16, v107
    v_and_b32 v113, s25, v107
    v_mul_f32 v114, s44, v108
    v_mul_f32 v115, s44, v111
    v_fmac_f32 v114, s45, v109
    v_fmac_f32 v115, s45, v112
    v_fmac_f32 v114, s46, v110
    v_fmac_f32 v115, s46, v113
    v_cvt_pk_bf16_f32 v99, v114, v115
    ds_write_b128 v126, v[96:99]
    s_waitcnt lgkmcnt(0)
    s_barrier
    s_mov_b32 s22, 4
    s_setprio 2
L_conv2_kernel_mloop1:
    ds_read_b128 v[96:99], v120 offset:0
    ds_read_b128 v[100:103], v120 offset:1024
    ds_read_b128 v[104:107], v120 offset:2048
    ds_read_b128 v[108:111], v120 offset:3072
    ds_read_b128 v[112:115], v120 offset:4096
    ds_read_b128 v[116:119], v120 offset:5120
    s_waitcnt vmcnt(6) lgkmcnt(5)
    v_mfma_f32_16x16x32_bf16 v[0:3], v[64:67], v[96:99], v[0:3]
    v_mfma_f32_16x16x32_bf16 v[32:35], v[68:71], v[96:99], v[32:35]
    ds_read_b128 v[96:99], v120 offset:6144
    s_waitcnt vmcnt(4) lgkmcnt(5)
    v_mfma_f32_16x16x32_bf16 v[4:7], v[64:67], v[100:103], v[4:7]
    v_mfma_f32_16x16x32_bf16 v[36:39], v[68:71], v[100:103], v[36:39]
    v_mfma_f32_16x16x32_bf16 v[0:3], v[72:75], v[100:103], v[0:3]
    v_mfma_f32_16x16x32_bf16 v[32:35], v[76:79], v[100:103], v[32:35]
    ds_read_b128 v[100:103], v120 offset:7168
    s_waitcnt vmcnt(2) lgkmcnt(5)
    v_mfma_f32_16x16x32_bf16 v[8:11], v[64:67], v[104:107], v[8:11]
    v_mfma_f32_16x16x32_bf16 v[40:43], v[68:71], v[104:107], v[40:43]
    v_mfma_f32_16x16x32_bf16 v[4:7], v[72:75], v[104:107], v[4:7]
    v_mfma_f32_16x16x32_bf16 v[36:39], v[76:79], v[104:107], v[36:39]
    v_mfma_f32_16x16x32_bf16 v[0:3], v[80:83], v[104:107], v[0:3]
    v_mfma_f32_16x16x32_bf16 v[32:35], v[84:87], v[104:107], v[32:35]
    ds_read_b128 v[104:107], v122 offset:0
    v_add_u32 v122, v123, v122
    s_waitcnt vmcnt(0) lgkmcnt(5)
    v_mfma_f32_16x16x32_bf16 v[12:15], v[64:67], v[108:111], v[12:15]
    v_mfma_f32_16x16x32_bf16 v[44:47], v[68:71], v[108:111], v[44:47]
    v_mfma_f32_16x16x32_bf16 v[8:11], v[72:75], v[108:111], v[8:11]
    v_mfma_f32_16x16x32_bf16 v[40:43], v[76:79], v[108:111], v[40:43]
    v_mfma_f32_16x16x32_bf16 v[4:7], v[80:83], v[108:111], v[4:7]
    v_mfma_f32_16x16x32_bf16 v[36:39], v[84:87], v[108:111], v[36:39]
    v_mfma_f32_16x16x32_bf16 v[0:3], v[88:91], v[108:111], v[0:3]
    v_mfma_f32_16x16x32_bf16 v[32:35], v[92:95], v[108:111], v[32:35]
    ds_read_b128 v[108:111], v121 offset:1024
    s_waitcnt lgkmcnt(5)
    v_mfma_f32_16x16x32_bf16 v[16:19], v[64:67], v[112:115], v[16:19]
    v_mfma_f32_16x16x32_bf16 v[48:51], v[68:71], v[112:115], v[48:51]
    v_mfma_f32_16x16x32_bf16 v[12:15], v[72:75], v[112:115], v[12:15]
    v_mfma_f32_16x16x32_bf16 v[44:47], v[76:79], v[112:115], v[44:47]
    v_mfma_f32_16x16x32_bf16 v[8:11], v[80:83], v[112:115], v[8:11]
    v_mfma_f32_16x16x32_bf16 v[40:43], v[84:87], v[112:115], v[40:43]
    v_mfma_f32_16x16x32_bf16 v[4:7], v[88:91], v[112:115], v[4:7]
    v_mfma_f32_16x16x32_bf16 v[36:39], v[92:95], v[112:115], v[36:39]
    ds_read_b128 v[112:115], v121 offset:2048
    s_waitcnt lgkmcnt(5)
    v_mfma_f32_16x16x32_bf16 v[20:23], v[64:67], v[116:119], v[20:23]
    v_mfma_f32_16x16x32_bf16 v[52:55], v[68:71], v[116:119], v[52:55]
    v_mfma_f32_16x16x32_bf16 v[16:19], v[72:75], v[116:119], v[16:19]
    v_mfma_f32_16x16x32_bf16 v[48:51], v[76:79], v[116:119], v[48:51]
    v_mfma_f32_16x16x32_bf16 v[12:15], v[80:83], v[116:119], v[12:15]
    v_mfma_f32_16x16x32_bf16 v[44:47], v[84:87], v[116:119], v[44:47]
    v_mfma_f32_16x16x32_bf16 v[8:11], v[88:91], v[116:119], v[8:11]
    v_mfma_f32_16x16x32_bf16 v[40:43], v[92:95], v[116:119], v[40:43]
    s_waitcnt lgkmcnt(4)
    v_mfma_f32_16x16x32_bf16 v[24:27], v[64:67], v[96:99], v[24:27]
    v_mfma_f32_16x16x32_bf16 v[56:59], v[68:71], v[96:99], v[56:59]
    v_mfma_f32_16x16x32_bf16 v[20:23], v[72:75], v[96:99], v[20:23]
    v_mfma_f32_16x16x32_bf16 v[52:55], v[76:79], v[96:99], v[52:55]
    v_mfma_f32_16x16x32_bf16 v[16:19], v[80:83], v[96:99], v[16:19]
    v_mfma_f32_16x16x32_bf16 v[48:51], v[84:87], v[96:99], v[48:51]
    v_mfma_f32_16x16x32_bf16 v[12:15], v[88:91], v[96:99], v[12:15]
    v_mfma_f32_16x16x32_bf16 v[44:47], v[92:95], v[96:99], v[44:47]
    s_waitcnt lgkmcnt(3)
    v_mfma_f32_16x16x32_bf16 v[28:31], v[64:67], v[100:103], v[28:31]
    v_mfma_f32_16x16x32_bf16 v[60:63], v[68:71], v[100:103], v[60:63]
    v_mfma_f32_16x16x32_bf16 v[24:27], v[72:75], v[100:103], v[24:27]
    v_mfma_f32_16x16x32_bf16 v[56:59], v[76:79], v[100:103], v[56:59]
    v_mfma_f32_16x16x32_bf16 v[20:23], v[80:83], v[100:103], v[20:23]
    v_mfma_f32_16x16x32_bf16 v[52:55], v[84:87], v[100:103], v[52:55]
    v_mfma_f32_16x16x32_bf16 v[16:19], v[88:91], v[100:103], v[16:19]
    v_mfma_f32_16x16x32_bf16 v[48:51], v[92:95], v[100:103], v[48:51]
    buffer_load_dwordx4 v[64:67], v125, s[12:15], s23 offen offset:0
    buffer_load_dwordx4 v[68:71], v125, s[12:15], s23 offen offset:1024
    s_waitcnt lgkmcnt(2)
    v_mfma_f32_16x16x32_bf16 v[28:31], v[72:75], v[104:107], v[28:31]
    v_mfma_f32_16x16x32_bf16 v[60:63], v[76:79], v[104:107], v[60:63]
    v_mfma_f32_16x16x32_bf16 v[24:27], v[80:83], v[104:107], v[24:27]
    v_mfma_f32_16x16x32_bf16 v[56:59], v[84:87], v[104:107], v[56:59]
    v_mfma_f32_16x16x32_bf16 v[20:23], v[88:91], v[104:107], v[20:23]
    v_mfma_f32_16x16x32_bf16 v[52:55], v[92:95], v[104:107], v[52:55]
    buffer_load_dwordx4 v[72:75], v125, s[12:15], s23 offen offset:2048
    buffer_load_dwordx4 v[76:79], v125, s[12:15], s23 offen offset:3072
    s_waitcnt lgkmcnt(1)
    v_mfma_f32_16x16x32_bf16 v[28:31], v[80:83], v[108:111], v[28:31]
    v_mfma_f32_16x16x32_bf16 v[60:63], v[84:87], v[108:111], v[60:63]
    v_mfma_f32_16x16x32_bf16 v[24:27], v[88:91], v[108:111], v[24:27]
    v_mfma_f32_16x16x32_bf16 v[56:59], v[92:95], v[108:111], v[56:59]
    buffer_load_dwordx4 v[80:83], v125, s[12:15], s26 offen offset:0
    buffer_load_dwordx4 v[84:87], v125, s[12:15], s26 offen offset:1024
    s_waitcnt lgkmcnt(0)
    v_mfma_f32_16x16x32_bf16 v[28:31], v[88:91], v[112:115], v[28:31]
    v_mfma_f32_16x16x32_bf16 v[60:63], v[92:95], v[112:115], v[60:63]
    buffer_load_dwordx4 v[88:91], v125, s[12:15], s26 offen offset:2048
    buffer_load_dwordx4 v[92:95], v125, s[12:15], s26 offen offset:3072
    s_add_u32 s23, s23, 57344
    s_add_u32 s26, s26, 57344
    s_barrier
    s_sub_u32 s22, s22, 1
    s_cmp_eq_u32 s22, 0
    s_cbranch_scc1 L_conv2_kernel_mlast1
    ds_read_b128 v[96:99], v120 offset:8192
    ds_read_b128 v[100:103], v120 offset:9216
    ds_read_b128 v[104:107], v120 offset:10240
    ds_read_b128 v[108:111], v120 offset:11264
    ds_read_b128 v[112:115], v120 offset:12288
    ds_read_b128 v[116:119], v120 offset:13312
    s_waitcnt vmcnt(6) lgkmcnt(5)
    v_mfma_f32_16x16x32_bf16 v[0:3], v[64:67], v[96:99], v[0:3]
    v_mfma_f32_16x16x32_bf16 v[32:35], v[68:71], v[96:99], v[32:35]
    ds_read_b128 v[96:99], v120 offset:14336
    s_waitcnt vmcnt(4) lgkmcnt(5)
    v_mfma_f32_16x16x32_bf16 v[4:7], v[64:67], v[100:103], v[4:7]
    v_mfma_f32_16x16x32_bf16 v[36:39], v[68:71], v[100:103], v[36:39]
    v_mfma_f32_16x16x32_bf16 v[0:3], v[72:75], v[100:103], v[0:3]
    v_mfma_f32_16x16x32_bf16 v[32:35], v[76:79], v[100:103], v[32:35]
    ds_read_b128 v[100:103], v120 offset:15360
    s_waitcnt vmcnt(2) lgkmcnt(5)
    v_mfma_f32_16x16x32_bf16 v[8:11], v[64:67], v[104:107], v[8:11]
    v_mfma_f32_16x16x32_bf16 v[40:43], v[68:71], v[104:107], v[40:43]
    v_mfma_f32_16x16x32_bf16 v[4:7], v[72:75], v[104:107], v[4:7]
    v_mfma_f32_16x16x32_bf16 v[36:39], v[76:79], v[104:107], v[36:39]
    v_mfma_f32_16x16x32_bf16 v[0:3], v[80:83], v[104:107], v[0:3]
    v_mfma_f32_16x16x32_bf16 v[32:35], v[84:87], v[104:107], v[32:35]
    ds_read_b128 v[104:107], v122 offset:0
    v_add_u32 v122, v124, v122
    s_waitcnt vmcnt(0) lgkmcnt(5)
    v_mfma_f32_16x16x32_bf16 v[12:15], v[64:67], v[108:111], v[12:15]
    v_mfma_f32_16x16x32_bf16 v[44:47], v[68:71], v[108:111], v[44:47]
    v_mfma_f32_16x16x32_bf16 v[8:11], v[72:75], v[108:111], v[8:11]
    v_mfma_f32_16x16x32_bf16 v[40:43], v[76:79], v[108:111], v[40:43]
    v_mfma_f32_16x16x32_bf16 v[4:7], v[80:83], v[108:111], v[4:7]
    v_mfma_f32_16x16x32_bf16 v[36:39], v[84:87], v[108:111], v[36:39]
    v_mfma_f32_16x16x32_bf16 v[0:3], v[88:91], v[108:111], v[0:3]
    v_mfma_f32_16x16x32_bf16 v[32:35], v[92:95], v[108:111], v[32:35]
    ds_read_b128 v[108:111], v121 offset:9216
    s_waitcnt lgkmcnt(5)
    v_mfma_f32_16x16x32_bf16 v[16:19], v[64:67], v[112:115], v[16:19]
    v_mfma_f32_16x16x32_bf16 v[48:51], v[68:71], v[112:115], v[48:51]
    v_mfma_f32_16x16x32_bf16 v[12:15], v[72:75], v[112:115], v[12:15]
    v_mfma_f32_16x16x32_bf16 v[44:47], v[76:79], v[112:115], v[44:47]
    v_mfma_f32_16x16x32_bf16 v[8:11], v[80:83], v[112:115], v[8:11]
    v_mfma_f32_16x16x32_bf16 v[40:43], v[84:87], v[112:115], v[40:43]
    v_mfma_f32_16x16x32_bf16 v[4:7], v[88:91], v[112:115], v[4:7]
    v_mfma_f32_16x16x32_bf16 v[36:39], v[92:95], v[112:115], v[36:39]
    ds_read_b128 v[112:115], v121 offset:10240
    s_waitcnt lgkmcnt(5)
    v_mfma_f32_16x16x32_bf16 v[20:23], v[64:67], v[116:119], v[20:23]
    v_mfma_f32_16x16x32_bf16 v[52:55], v[68:71], v[116:119], v[52:55]
    v_mfma_f32_16x16x32_bf16 v[16:19], v[72:75], v[116:119], v[16:19]
    v_mfma_f32_16x16x32_bf16 v[48:51], v[76:79], v[116:119], v[48:51]
    v_mfma_f32_16x16x32_bf16 v[12:15], v[80:83], v[116:119], v[12:15]
    v_mfma_f32_16x16x32_bf16 v[44:47], v[84:87], v[116:119], v[44:47]
    v_mfma_f32_16x16x32_bf16 v[8:11], v[88:91], v[116:119], v[8:11]
    v_mfma_f32_16x16x32_bf16 v[40:43], v[92:95], v[116:119], v[40:43]
    s_waitcnt lgkmcnt(4)
    v_mfma_f32_16x16x32_bf16 v[24:27], v[64:67], v[96:99], v[24:27]
    v_mfma_f32_16x16x32_bf16 v[56:59], v[68:71], v[96:99], v[56:59]
    v_mfma_f32_16x16x32_bf16 v[20:23], v[72:75], v[96:99], v[20:23]
    v_mfma_f32_16x16x32_bf16 v[52:55], v[76:79], v[96:99], v[52:55]
    v_mfma_f32_16x16x32_bf16 v[16:19], v[80:83], v[96:99], v[16:19]
    v_mfma_f32_16x16x32_bf16 v[48:51], v[84:87], v[96:99], v[48:51]
    v_mfma_f32_16x16x32_bf16 v[12:15], v[88:91], v[96:99], v[12:15]
    v_mfma_f32_16x16x32_bf16 v[44:47], v[92:95], v[96:99], v[44:47]
    s_waitcnt lgkmcnt(3)
    v_mfma_f32_16x16x32_bf16 v[28:31], v[64:67], v[100:103], v[28:31]
    v_mfma_f32_16x16x32_bf16 v[60:63], v[68:71], v[100:103], v[60:63]
    v_mfma_f32_16x16x32_bf16 v[24:27], v[72:75], v[100:103], v[24:27]
    v_mfma_f32_16x16x32_bf16 v[56:59], v[76:79], v[100:103], v[56:59]
    v_mfma_f32_16x16x32_bf16 v[20:23], v[80:83], v[100:103], v[20:23]
    v_mfma_f32_16x16x32_bf16 v[52:55], v[84:87], v[100:103], v[52:55]
    v_mfma_f32_16x16x32_bf16 v[16:19], v[88:91], v[100:103], v[16:19]
    v_mfma_f32_16x16x32_bf16 v[48:51], v[92:95], v[100:103], v[48:51]
    buffer_load_dwordx4 v[64:67], v125, s[12:15], s23 offen offset:0
    buffer_load_dwordx4 v[68:71], v125, s[12:15], s23 offen offset:1024
    s_waitcnt lgkmcnt(2)
    v_mfma_f32_16x16x32_bf16 v[28:31], v[72:75], v[104:107], v[28:31]
    v_mfma_f32_16x16x32_bf16 v[60:63], v[76:79], v[104:107], v[60:63]
    v_mfma_f32_16x16x32_bf16 v[24:27], v[80:83], v[104:107], v[24:27]
    v_mfma_f32_16x16x32_bf16 v[56:59], v[84:87], v[104:107], v[56:59]
    v_mfma_f32_16x16x32_bf16 v[20:23], v[88:91], v[104:107], v[20:23]
    v_mfma_f32_16x16x32_bf16 v[52:55], v[92:95], v[104:107], v[52:55]
    buffer_load_dwordx4 v[72:75], v125, s[12:15], s23 offen offset:2048
    buffer_load_dwordx4 v[76:79], v125, s[12:15], s23 offen offset:3072
    s_waitcnt lgkmcnt(1)
    v_mfma_f32_16x16x32_bf16 v[28:31], v[80:83], v[108:111], v[28:31]
    v_mfma_f32_16x16x32_bf16 v[60:63], v[84:87], v[108:111], v[60:63]
    v_mfma_f32_16x16x32_bf16 v[24:27], v[88:91], v[108:111], v[24:27]
    v_mfma_f32_16x16x32_bf16 v[56:59], v[92:95], v[108:111], v[56:59]
    buffer_load_dwordx4 v[80:83], v125, s[12:15], s26 offen offset:0
    buffer_load_dwordx4 v[84:87], v125, s[12:15], s26 offen offset:1024
    s_waitcnt lgkmcnt(0)
    v_mfma_f32_16x16x32_bf16 v[28:31], v[88:91], v[112:115], v[28:31]
    v_mfma_f32_16x16x32_bf16 v[60:63], v[92:95], v[112:115], v[60:63]
    buffer_load_dwordx4 v[88:91], v125, s[12:15], s26 offen offset:2048
    buffer_load_dwordx4 v[92:95], v125, s[12:15], s26 offen offset:3072
    s_add_u32 s23, s23, 57344
    s_add_u32 s26, s26, 57344
    s_barrier
    s_branch L_conv2_kernel_mloop1
L_conv2_kernel_mlast1:
    v_and_b32 v125, 15, v127
    v_and_b32 v126, 7, v127
    v_lshlrev_b32 v126, 4, v126
    v_lshl_add_u32 v125, v125, 7, v126
    v_lshrrev_b32 v126, 4, v127
    v_lshl_add_u32 v125, v126, 11, v125
    s_lshl_b32 s36, s20, 14
    s_add_u32 s37, s36, 8192
    v_add_u32 v126, s37, v125
    v_add_u32 v125, s36, v125
    ds_read_b128 v[96:99], v120 offset:8192
    ds_read_b128 v[100:103], v120 offset:9216
    ds_read_b128 v[104:107], v120 offset:10240
    ds_read_b128 v[108:111], v120 offset:11264
    ds_read_b128 v[112:115], v120 offset:12288
    ds_read_b128 v[116:119], v120 offset:13312
    s_waitcnt vmcnt(6) lgkmcnt(5)
    v_mfma_f32_16x16x32_bf16 v[0:3], v[64:67], v[96:99], v[0:3]
    v_mfma_f32_16x16x32_bf16 v[32:35], v[68:71], v[96:99], v[32:35]
    ds_read_b128 v[96:99], v120 offset:14336
    s_waitcnt vmcnt(4) lgkmcnt(5)
    v_mfma_f32_16x16x32_bf16 v[4:7], v[64:67], v[100:103], v[4:7]
    v_mfma_f32_16x16x32_bf16 v[36:39], v[68:71], v[100:103], v[36:39]
    v_mfma_f32_16x16x32_bf16 v[0:3], v[72:75], v[100:103], v[0:3]
    v_mfma_f32_16x16x32_bf16 v[32:35], v[76:79], v[100:103], v[32:35]
    ds_read_b128 v[100:103], v120 offset:15360
    s_waitcnt vmcnt(2) lgkmcnt(5)
    v_mfma_f32_16x16x32_bf16 v[8:11], v[64:67], v[104:107], v[8:11]
    v_mfma_f32_16x16x32_bf16 v[40:43], v[68:71], v[104:107], v[40:43]
    v_mfma_f32_16x16x32_bf16 v[4:7], v[72:75], v[104:107], v[4:7]
    v_mfma_f32_16x16x32_bf16 v[36:39], v[76:79], v[104:107], v[36:39]
    v_mfma_f32_16x16x32_bf16 v[0:3], v[80:83], v[104:107], v[0:3]
    v_mfma_f32_16x16x32_bf16 v[32:35], v[84:87], v[104:107], v[32:35]
    ds_read_b128 v[104:107], v122 offset:0
    s_waitcnt vmcnt(0) lgkmcnt(5)
    v_mfma_f32_16x16x32_bf16 v[12:15], v[64:67], v[108:111], v[12:15]
    v_mfma_f32_16x16x32_bf16 v[44:47], v[68:71], v[108:111], v[44:47]
    v_mfma_f32_16x16x32_bf16 v[8:11], v[72:75], v[108:111], v[8:11]
    v_mfma_f32_16x16x32_bf16 v[40:43], v[76:79], v[108:111], v[40:43]
    v_mfma_f32_16x16x32_bf16 v[4:7], v[80:83], v[108:111], v[4:7]
    v_mfma_f32_16x16x32_bf16 v[36:39], v[84:87], v[108:111], v[36:39]
    v_mfma_f32_16x16x32_bf16 v[0:3], v[88:91], v[108:111], v[0:3]
    v_mfma_f32_16x16x32_bf16 v[32:35], v[92:95], v[108:111], v[32:35]
    ds_read_b128 v[108:111], v121 offset:9216
    s_waitcnt lgkmcnt(5)
    v_mfma_f32_16x16x32_bf16 v[16:19], v[64:67], v[112:115], v[16:19]
    v_mfma_f32_16x16x32_bf16 v[48:51], v[68:71], v[112:115], v[48:51]
    v_mfma_f32_16x16x32_bf16 v[12:15], v[72:75], v[112:115], v[12:15]
    v_mfma_f32_16x16x32_bf16 v[44:47], v[76:79], v[112:115], v[44:47]
    v_mfma_f32_16x16x32_bf16 v[8:11], v[80:83], v[112:115], v[8:11]
    v_mfma_f32_16x16x32_bf16 v[40:43], v[84:87], v[112:115], v[40:43]
    v_mfma_f32_16x16x32_bf16 v[4:7], v[88:91], v[112:115], v[4:7]
    v_mfma_f32_16x16x32_bf16 v[36:39], v[92:95], v[112:115], v[36:39]
    ds_read_b128 v[112:115], v121 offset:10240
    v_xor_b32 v123, 0, v125
    ds_write_b128 v123, v[0:3]
    s_waitcnt lgkmcnt(6)
    v_mfma_f32_16x16x32_bf16 v[20:23], v[64:67], v[116:119], v[20:23]
    v_mfma_f32_16x16x32_bf16 v[52:55], v[68:71], v[116:119], v[52:55]
    v_mfma_f32_16x16x32_bf16 v[16:19], v[72:75], v[116:119], v[16:19]
    v_mfma_f32_16x16x32_bf16 v[48:51], v[76:79], v[116:119], v[48:51]
    v_mfma_f32_16x16x32_bf16 v[12:15], v[80:83], v[116:119], v[12:15]
    v_mfma_f32_16x16x32_bf16 v[44:47], v[84:87], v[116:119], v[44:47]
    v_mfma_f32_16x16x32_bf16 v[8:11], v[88:91], v[116:119], v[8:11]
    v_mfma_f32_16x16x32_bf16 v[40:43], v[92:95], v[116:119], v[40:43]
    v_xor_b32 v124, 16, v125
    ds_write_b128 v124, v[4:7]
    s_waitcnt lgkmcnt(2)
    v_mfma_f32_16x16x32_bf16 v[24:27], v[64:67], v[96:99], v[24:27]
    v_mfma_f32_16x16x32_bf16 v[56:59], v[68:71], v[96:99], v[56:59]
    v_mfma_f32_16x16x32_bf16 v[20:23], v[72:75], v[96:99], v[20:23]
    v_mfma_f32_16x16x32_bf16 v[52:55], v[76:79], v[96:99], v[52:55]
    v_mfma_f32_16x16x32_bf16 v[16:19], v[80:83], v[96:99], v[16:19]
    v_mfma_f32_16x16x32_bf16 v[48:51], v[84:87], v[96:99], v[48:51]
    v_mfma_f32_16x16x32_bf16 v[12:15], v[88:91], v[96:99], v[12:15]
    v_mfma_f32_16x16x32_bf16 v[44:47], v[92:95], v[96:99], v[44:47]
    v_xor_b32 v123, 32, v125
    ds_write_b128 v123, v[8:11]
    v_xor_b32 v124, 0, v126
    ds_write_b128 v124, v[32:35]
    v_mfma_f32_16x16x32_bf16 v[28:31], v[64:67], v[100:103], v[28:31]
    v_mfma_f32_16x16x32_bf16 v[60:63], v[68:71], v[100:103], v[60:63]
    v_mfma_f32_16x16x32_bf16 v[24:27], v[72:75], v[100:103], v[24:27]
    v_mfma_f32_16x16x32_bf16 v[56:59], v[76:79], v[100:103], v[56:59]
    v_mfma_f32_16x16x32_bf16 v[20:23], v[80:83], v[100:103], v[20:23]
    v_mfma_f32_16x16x32_bf16 v[52:55], v[84:87], v[100:103], v[52:55]
    v_mfma_f32_16x16x32_bf16 v[16:19], v[88:91], v[100:103], v[16:19]
    v_mfma_f32_16x16x32_bf16 v[48:51], v[92:95], v[100:103], v[48:51]
    v_xor_b32 v123, 16, v126
    ds_write_b128 v123, v[36:39]
    v_xor_b32 v124, 32, v126
    ds_write_b128 v124, v[40:43]
    v_mfma_f32_16x16x32_bf16 v[28:31], v[72:75], v[104:107], v[28:31]
    v_mfma_f32_16x16x32_bf16 v[60:63], v[76:79], v[104:107], v[60:63]
    v_mfma_f32_16x16x32_bf16 v[24:27], v[80:83], v[104:107], v[24:27]
    v_mfma_f32_16x16x32_bf16 v[56:59], v[84:87], v[104:107], v[56:59]
    v_mfma_f32_16x16x32_bf16 v[20:23], v[88:91], v[104:107], v[20:23]
    v_mfma_f32_16x16x32_bf16 v[52:55], v[92:95], v[104:107], v[52:55]
    v_xor_b32 v124, 48, v125
    ds_write_b128 v124, v[12:15]
    v_xor_b32 v123, 48, v126
    ds_write_b128 v123, v[44:47]
    v_mfma_f32_16x16x32_bf16 v[28:31], v[80:83], v[108:111], v[28:31]
    v_mfma_f32_16x16x32_bf16 v[60:63], v[84:87], v[108:111], v[60:63]
    v_mfma_f32_16x16x32_bf16 v[24:27], v[88:91], v[108:111], v[24:27]
    v_mfma_f32_16x16x32_bf16 v[56:59], v[92:95], v[108:111], v[56:59]
    v_xor_b32 v123, 64, v125
    ds_write_b128 v123, v[16:19]
    v_xor_b32 v124, 64, v126
    ds_write_b128 v124, v[48:51]
    v_mfma_f32_16x16x32_bf16 v[28:31], v[88:91], v[112:115], v[28:31]
    v_mfma_f32_16x16x32_bf16 v[60:63], v[92:95], v[112:115], v[60:63]
    v_xor_b32 v124, 80, v125
    ds_write_b128 v124, v[20:23]
    v_xor_b32 v123, 80, v126
    ds_write_b128 v123, v[52:55]
    s_nop 7
    v_xor_b32 v123, 96, v125
    ds_write_b128 v123, v[24:27]
    v_xor_b32 v124, 96, v126
    ds_write_b128 v124, v[56:59]
    v_xor_b32 v124, 112, v125
    ds_write_b128 v124, v[28:31]
    v_xor_b32 v123, 112, v126
    s_waitcnt lgkmcnt(8)
    ds_write_b128 v123, v[60:63]
    s_setprio 0
    s_branch L_conv2_kernel_epi
L_conv2_kernel_m2:
    s_mul_i32 s37, s38, 2176
    s_add_u32 s37, s37, 98304
    v_add_u32 v116, s37, v8
    v_add_u32 v118, s37, v9
    v_add_u32 v117, 104832, v8
    s_cmp_eq_u32 s38, 0
    s_cbranch_scc1 L_conv2_kernel_hh0
    v_add_u32 v117, 98304, v9
L_conv2_kernel_hh0:
    s_lshl_b32 s37, s38, 12
    s_add_u32 s37, s37, s43
    s_add_u32 s37, s37, 49152
    v_lshl_add_u32 v119, v127, 4, s37
    v_mov_b32 v0, 0
    v_mov_b32 v1, 0
    v_mov_b32 v2, 0
    v_mov_b32 v3, 0
    v_mov_b32 v4, 0
    v_mov_b32 v5, 0
    v_mov_b32 v6, 0
    v_mov_b32 v7, 0
    v_mov_b32 v8, 0
    v_mov_b32 v9, 0
    v_mov_b32 v10, 0
    v_mov_b32 v11, 0
    v_mov_b32 v12, 0
    v_mov_b32 v13, 0
    v_mov_b32 v14, 0
    v_mov_b32 v15, 0
    v_mov_b32 v16, 0
    v_mov_b32 v17, 0
    v_mov_b32 v18, 0
    v_mov_b32 v19, 0
    v_mov_b32 v20, 0
    v_mov_b32 v21, 0
    v_mov_b32 v22, 0
    v_mov_b32 v23, 0
    v_mov_b32 v24, 0
    v_mov_b32 v25, 0
    v_mov_b32 v26, 0
    v_mov_b32 v27, 0
    v_mov_b32 v28, 0
    v_mov_b32 v29, 0
    v_mov_b32 v30, 0
    v_mov_b32 v31, 0
    v_mov_b32 v32, 0
    v_mov_b32 v33, 0
    v_mov_b32 v34, 0
    v_mov_b32 v35, 0
    v_mov_b32 v36, 0
    v_mov_b32 v37, 0
    v_mov_b32 v38, 0
    v_mov_b32 v39, 0
    v_mov_b32 v40, 0
    v_mov_b32 v41, 0
    v_mov_b32 v42, 0
    v_mov_b32 v43, 0
    v_mov_b32 v44, 0
    v_mov_b32 v45, 0
    v_mov_b32 v46, 0
    v_mov_b32 v47, 0
    v_mov_b32 v48, 0
    v_mov_b32 v49, 0
    v_mov_b32 v50, 0
    v_mov_b32 v51, 0
    v_mov_b32 v52, 0
    v_mov_b32 v53, 0
    v_mov_b32 v54, 0
    v_mov_b32 v55, 0
    v_mov_b32 v56, 0
    v_mov_b32 v57, 0
    v_mov_b32 v58, 0
    v_mov_b32 v59, 0
    v_mov_b32 v60, 0
    v_mov_b32 v61, 0
    v_mov_b32 v62, 0
    v_mov_b32 v63, 0
    s_barrier
    buffer_load_dwordx4 v[96:99], v108, s[8:11], 0 offen offset:0
    buffer_load_dwordx4 v[100:103], v108, s[8:11], 0 offen offset:1024
    buffer_load_dwordx4 v[104:107], v108, s[8:11], 0 offen offset:2048
    s_mov_b32 s23, 0
    s_mov_b32 s26, 4096
    buffer_load_dwordx4 v[64:67], v125, s[12:15], s23 offen offset:0
    buffer_load_dwordx4 v[68:71], v125, s[12:15], s23 offen offset:2048
    buffer_load_dwordx4 v[80:83], v119, s[12:15], s23 offen offset:0
    buffer_load_dwordx4 v[72:75], v125, s[12:15], s26 offen offset:0
    buffer_load_dwordx4 v[84:87], v119, s[12:15], s23 offen offset:2048
    buffer_load_dwordx4 v[76:79], v125, s[12:15], s26 offen offset:2048
    s_mov_b32 s23, 57344
    s_mov_b32 s26, 61440
    s_waitcnt vmcnt(6)
    v_lshlrev_b32 v108, 16, v96
    v_and_b32 v111, s25, v96
    v_lshlrev_b32 v109, 16, v100
    v_and_b32 v112, s25, v100
    v_lshlrev_b32 v110, 16, v104
    v_and_b32 v113, s25, v104
    v_mul_f32 v114, s44, v108
    v_mul_f32 v115, s44, v111
    v_fmac_f32 v114, s45, v109
    v_fmac_f32 v115, s45, v112
    v_fmac_f32 v114, s46, v110
    v_fmac_f32 v115, s46, v113
    v_cvt_pk_bf16_f32 v96, v114, v115
    v_lshlrev_b32 v108, 16, v97
    v_and_b32 v111, s25, v97
    v_lshlrev_b32 v109, 16, v101
    v_and_b32 v112, s25, v101
    v_lshlrev_b32 v110, 16, v105
    v_and_b32 v113, s25, v105
    v_mul_f32 v114, s44, v108
    v_mul_f32 v115, s44, v111
    v_fmac_f32 v114, s45, v109
    v_fmac_f32 v115, s45, v112
    v_fmac_f32 v114, s46, v110
    v_fmac_f32 v115, s46, v113
    v_cvt_pk_bf16_f32 v97, v114, v115
    v_lshlrev_b32 v108, 16, v98
    v_and_b32 v111, s25, v98
    v_lshlrev_b32 v109, 16, v102
    v_and_b32 v112, s25, v102
    v_lshlrev_b32 v110, 16, v106
    v_and_b32 v113, s25, v106
    v_mul_f32 v114, s44, v108
    v_mul_f32 v115, s44, v111
    v_fmac_f32 v114, s45, v109
    v_fmac_f32 v115, s45, v112
    v_fmac_f32 v114, s46, v110
    v_fmac_f32 v115, s46, v113
    v_cvt_pk_bf16_f32 v98, v114, v115
    v_lshlrev_b32 v108, 16, v99
    v_and_b32 v111, s25, v99
    v_lshlrev_b32 v109, 16, v103
    v_and_b32 v112, s25, v103
    v_lshlrev_b32 v110, 16, v107
    v_and_b32 v113, s25, v107
    v_mul_f32 v114, s44, v108
    v_mul_f32 v115, s44, v111
    v_fmac_f32 v114, s45, v109
    v_fmac_f32 v115, s45, v112
    v_fmac_f32 v114, s46, v110
    v_fmac_f32 v115, s46, v113
    v_cvt_pk_bf16_f32 v99, v114, v115
    ds_write_b128 v126, v[96:99]
    v_and_b32 v126, 15, v127
    v_lshlrev_b32 v126, 2, v126
    v_add_u32 v126, 99328, v126
    ds_write_b32 v126, v0
    ds_write_b32 v126, v0 offset:8704
    s_waitcnt lgkmcnt(0)
    s_barrier
    s_mov_b32 s22, 4
    s_setprio 2
L_conv2_kernel_mloop2:
    ds_read_b128 v[88:91], v120 offset:0
    ds_read_b128 v[92:95], v120 offset:1024
    ds_read_b128 v[96:99], v116 offset:0
    ds_read_b128 v[100:103], v120 offset:2048
    ds_read_b128 v[104:107], v116 offset:1088
    ds_read_b128 v[108:111], v120 offset:3072
    ds_read_b128 v[112:115], v116 offset:2176
    s_waitcnt vmcnt(5) lgkmcnt(6)
    v_mfma_f32_16x16x32_bf16 v[0:3], v[64:67], v[88:91], v[0:3]
    ds_read_b128 v[88:91], v120 offset:4096
    s_waitcnt vmcnt(4) lgkmcnt(6)
    v_mfma_f32_16x16x32_bf16 v[4:7], v[64:67], v[92:95], v[4:7]
    v_mfma_f32_16x16x32_bf16 v[0:3], v[68:71], v[92:95], v[0:3]
    ds_read_b128 v[92:95], v116 offset:3264
    s_waitcnt vmcnt(3) lgkmcnt(6)
    v_mfma_f32_16x16x32_bf16 v[32:35], v[80:83], v[96:99], v[32:35]
    ds_read_b128 v[96:99], v120 offset:5120
    s_waitcnt vmcnt(2) lgkmcnt(6)
    v_mfma_f32_16x16x32_bf16 v[8:11], v[64:67], v[100:103], v[8:11]
    v_mfma_f32_16x16x32_bf16 v[4:7], v[68:71], v[100:103], v[4:7]
    v_mfma_f32_16x16x32_bf16 v[0:3], v[72:75], v[100:103], v[0:3]
    ds_read_b128 v[100:103], v116 offset:4352
    s_waitcnt vmcnt(1) lgkmcnt(6)
    v_mfma_f32_16x16x32_bf16 v[36:39], v[80:83], v[104:107], v[36:39]
    v_mfma_f32_16x16x32_bf16 v[32:35], v[84:87], v[104:107], v[32:35]
    ds_read_b128 v[104:107], v120 offset:6144
    s_waitcnt vmcnt(0) lgkmcnt(6)
    v_mfma_f32_16x16x32_bf16 v[12:15], v[64:67], v[108:111], v[12:15]
    v_mfma_f32_16x16x32_bf16 v[8:11], v[68:71], v[108:111], v[8:11]
    v_mfma_f32_16x16x32_bf16 v[4:7], v[72:75], v[108:111], v[4:7]
    v_mfma_f32_16x16x32_bf16 v[0:3], v[76:79], v[108:111], v[0:3]
    ds_read_b128 v[108:111], v116 offset:5440
    s_waitcnt lgkmcnt(6)
    v_mfma_f32_16x16x32_bf16 v[40:43], v[80:83], v[112:115], v[40:43]
    v_mfma_f32_16x16x32_bf16 v[36:39], v[84:87], v[112:115], v[36:39]
    ds_read_b128 v[112:115], v120 offset:7168
    s_waitcnt lgkmcnt(6)
    v_mfma_f32_16x16x32_bf16 v[16:19], v[64:67], v[88:91], v[16:19]
    v_mfma_f32_16x16x32_bf16 v[12:15], v[68:71], v[88:91], v[12:15]
    v_mfma_f32_16x16x32_bf16 v[8:11], v[72:75], v[88:91], v[8:11]
    v_mfma_f32_16x16x32_bf16 v[4:7], v[76:79], v[88:91], v[4:7]
    ds_read_b128 v[88:91], v117 offset:0
    s_waitcnt lgkmcnt(6)
    v_mfma_f32_16x16x32_bf16 v[44:47], v[80:83], v[92:95], v[44:47]
    v_mfma_f32_16x16x32_bf16 v[40:43], v[84:87], v[92:95], v[40:43]
    ds_read_b128 v[92:95], v122 offset:0
    v_add_u32 v122, v123, v122
    s_waitcnt lgkmcnt(6)
    v_mfma_f32_16x16x32_bf16 v[20:23], v[64:67], v[96:99], v[20:23]
    v_mfma_f32_16x16x32_bf16 v[16:19], v[68:71], v[96:99], v[16:19]
    v_mfma_f32_16x16x32_bf16 v[12:15], v[72:75], v[96:99], v[12:15]
    v_mfma_f32_16x16x32_bf16 v[8:11], v[76:79], v[96:99], v[8:11]
    ds_read_b128 v[96:99], v117 offset:1088
    s_waitcnt lgkmcnt(6)
    v_mfma_f32_16x16x32_bf16 v[48:51], v[80:83], v[100:103], v[48:51]
    v_mfma_f32_16x16x32_bf16 v[44:47], v[84:87], v[100:103], v[44:47]
    ds_read_b128 v[100:103], v121 offset:1024
    s_waitcnt lgkmcnt(6)
    v_mfma_f32_16x16x32_bf16 v[24:27], v[64:67], v[104:107], v[24:27]
    v_mfma_f32_16x16x32_bf16 v[20:23], v[68:71], v[104:107], v[20:23]
    v_mfma_f32_16x16x32_bf16 v[16:19], v[72:75], v[104:107], v[16:19]
    v_mfma_f32_16x16x32_bf16 v[12:15], v[76:79], v[104:107], v[12:15]
    ds_read_b128 v[104:107], v118 offset:0
    s_waitcnt lgkmcnt(6)
    v_mfma_f32_16x16x32_bf16 v[52:55], v[80:83], v[108:111], v[52:55]
    v_mfma_f32_16x16x32_bf16 v[48:51], v[84:87], v[108:111], v[48:51]
    ds_read_b128 v[108:111], v121 offset:2048
    s_waitcnt lgkmcnt(6)
    v_mfma_f32_16x16x32_bf16 v[28:31], v[64:67], v[112:115], v[28:31]
    v_mfma_f32_16x16x32_bf16 v[24:27], v[68:71], v[112:115], v[24:27]
    v_mfma_f32_16x16x32_bf16 v[20:23], v[72:75], v[112:115], v[20:23]
    v_mfma_f32_16x16x32_bf16 v[16:19], v[76:79], v[112:115], v[16:19]
    buffer_load_dwordx4 v[64:67], v125, s[12:15], s23 offen offset:0
    s_waitcnt lgkmcnt(5)
    v_mfma_f32_16x16x32_bf16 v[56:59], v[80:83], v[88:91], v[56:59]
    v_mfma_f32_16x16x32_bf16 v[52:55], v[84:87], v[88:91], v[52:55]
    s_waitcnt lgkmcnt(0)
    s_barrier
    v_mfma_f32_16x16x32_bf16 v[28:31], v[68:71], v[92:95], v[28:31]
    v_mfma_f32_16x16x32_bf16 v[24:27], v[72:75], v[92:95], v[24:27]
    v_mfma_f32_16x16x32_bf16 v[20:23], v[76:79], v[92:95], v[20:23]
    buffer_load_dwordx4 v[68:71], v125, s[12:15], s23 offen offset:2048
    v_mfma_f32_16x16x32_bf16 v[60:63], v[80:83], v[96:99], v[60:63]
    v_mfma_f32_16x16x32_bf16 v[56:59], v[84:87], v[96:99], v[56:59]
    buffer_load_dwordx4 v[80:83], v119, s[12:15], s23 offen offset:0
    v_mfma_f32_16x16x32_bf16 v[28:31], v[72:75], v[100:103], v[28:31]
    v_mfma_f32_16x16x32_bf16 v[24:27], v[76:79], v[100:103], v[24:27]
    buffer_load_dwordx4 v[72:75], v125, s[12:15], s26 offen offset:0
    v_mfma_f32_16x16x32_bf16 v[60:63], v[84:87], v[104:107], v[60:63]
    buffer_load_dwordx4 v[84:87], v119, s[12:15], s23 offen offset:2048
    v_mfma_f32_16x16x32_bf16 v[28:31], v[76:79], v[108:111], v[28:31]
    buffer_load_dwordx4 v[76:79], v125, s[12:15], s26 offen offset:2048
    s_add_u32 s23, s23, 57344
    s_add_u32 s26, s26, 57344
    s_sub_u32 s22, s22, 1
    s_cmp_eq_u32 s22, 0
    s_cbranch_scc1 L_conv2_kernel_mlast2
    ds_read_b128 v[88:91], v120 offset:8192
    ds_read_b128 v[92:95], v120 offset:9216
    ds_read_b128 v[96:99], v116 offset:8704
    ds_read_b128 v[100:103], v120 offset:10240
    ds_read_b128 v[104:107], v116 offset:9792
    ds_read_b128 v[108:111], v120 offset:11264
    ds_read_b128 v[112:115], v116 offset:10880
    s_waitcnt vmcnt(5) lgkmcnt(6)
    v_mfma_f32_16x16x32_bf16 v[0:3], v[64:67], v[88:91], v[0:3]
    ds_read_b128 v[88:91], v120 offset:12288
    s_waitcnt vmcnt(4) lgkmcnt(6)
    v_mfma_f32_16x16x32_bf16 v[4:7], v[64:67], v[92:95], v[4:7]
    v_mfma_f32_16x16x32_bf16 v[0:3], v[68:71], v[92:95], v[0:3]
    ds_read_b128 v[92:95], v116 offset:11968
    s_waitcnt vmcnt(3) lgkmcnt(6)
    v_mfma_f32_16x16x32_bf16 v[32:35], v[80:83], v[96:99], v[32:35]
    ds_read_b128 v[96:99], v120 offset:13312
    s_waitcnt vmcnt(2) lgkmcnt(6)
    v_mfma_f32_16x16x32_bf16 v[8:11], v[64:67], v[100:103], v[8:11]
    v_mfma_f32_16x16x32_bf16 v[4:7], v[68:71], v[100:103], v[4:7]
    v_mfma_f32_16x16x32_bf16 v[0:3], v[72:75], v[100:103], v[0:3]
    ds_read_b128 v[100:103], v116 offset:13056
    s_waitcnt vmcnt(1) lgkmcnt(6)
    v_mfma_f32_16x16x32_bf16 v[36:39], v[80:83], v[104:107], v[36:39]
    v_mfma_f32_16x16x32_bf16 v[32:35], v[84:87], v[104:107], v[32:35]
    ds_read_b128 v[104:107], v120 offset:14336
    s_waitcnt vmcnt(0) lgkmcnt(6)
    v_mfma_f32_16x16x32_bf16 v[12:15], v[64:67], v[108:111], v[12:15]
    v_mfma_f32_16x16x32_bf16 v[8:11], v[68:71], v[108:111], v[8:11]
    v_mfma_f32_16x16x32_bf16 v[4:7], v[72:75], v[108:111], v[4:7]
    v_mfma_f32_16x16x32_bf16 v[0:3], v[76:79], v[108:111], v[0:3]
    ds_read_b128 v[108:111], v116 offset:14144
    s_waitcnt lgkmcnt(6)
    v_mfma_f32_16x16x32_bf16 v[40:43], v[80:83], v[112:115], v[40:43]
    v_mfma_f32_16x16x32_bf16 v[36:39], v[84:87], v[112:115], v[36:39]
    ds_read_b128 v[112:115], v120 offset:15360
    s_waitcnt lgkmcnt(6)
    v_mfma_f32_16x16x32_bf16 v[16:19], v[64:67], v[88:91], v[16:19]
    v_mfma_f32_16x16x32_bf16 v[12:15], v[68:71], v[88:91], v[12:15]
    v_mfma_f32_16x16x32_bf16 v[8:11], v[72:75], v[88:91], v[8:11]
    v_mfma_f32_16x16x32_bf16 v[4:7], v[76:79], v[88:91], v[4:7]
    ds_read_b128 v[88:91], v117 offset:8704
    s_waitcnt lgkmcnt(6)
    v_mfma_f32_16x16x32_bf16 v[44:47], v[80:83], v[92:95], v[44:47]
    v_mfma_f32_16x16x32_bf16 v[40:43], v[84:87], v[92:95], v[40:43]
    ds_read_b128 v[92:95], v122 offset:0
    v_add_u32 v122, v124, v122
    s_waitcnt lgkmcnt(6)
    v_mfma_f32_16x16x32_bf16 v[20:23], v[64:67], v[96:99], v[20:23]
    v_mfma_f32_16x16x32_bf16 v[16:19], v[68:71], v[96:99], v[16:19]
    v_mfma_f32_16x16x32_bf16 v[12:15], v[72:75], v[96:99], v[12:15]
    v_mfma_f32_16x16x32_bf16 v[8:11], v[76:79], v[96:99], v[8:11]
    ds_read_b128 v[96:99], v117 offset:9792
    s_waitcnt lgkmcnt(6)
    v_mfma_f32_16x16x32_bf16 v[48:51], v[80:83], v[100:103], v[48:51]
    v_mfma_f32_16x16x32_bf16 v[44:47], v[84:87], v[100:103], v[44:47]
    ds_read_b128 v[100:103], v121 offset:9216
    s_waitcnt lgkmcnt(6)
    v_mfma_f32_16x16x32_bf16 v[24:27], v[64:67], v[104:107], v[24:27]
    v_mfma_f32_16x16x32_bf16 v[20:23], v[68:71], v[104:107], v[20:23]
    v_mfma_f32_16x16x32_bf16 v[16:19], v[72:75], v[104:107], v[16:19]
    v_mfma_f32_16x16x32_bf16 v[12:15], v[76:79], v[104:107], v[12:15]
    ds_read_b128 v[104:107], v118 offset:8704
    s_waitcnt lgkmcnt(6)
    v_mfma_f32_16x16x32_bf16 v[52:55], v[80:83], v[108:111], v[52:55]
    v_mfma_f32_16x16x32_bf16 v[48:51], v[84:87], v[108:111], v[48:51]
    ds_read_b128 v[108:111], v121 offset:10240
    s_waitcnt lgkmcnt(6)
    v_mfma_f32_16x16x32_bf16 v[28:31], v[64:67], v[112:115], v[28:31]
    v_mfma_f32_16x16x32_bf16 v[24:27], v[68:71], v[112:115], v[24:27]
    v_mfma_f32_16x16x32_bf16 v[20:23], v[72:75], v[112:115], v[20:23]
    v_mfma_f32_16x16x32_bf16 v[16:19], v[76:79], v[112:115], v[16:19]
    buffer_load_dwordx4 v[64:67], v125, s[12:15], s23 offen offset:0
    s_waitcnt lgkmcnt(5)
    v_mfma_f32_16x16x32_bf16 v[56:59], v[80:83], v[88:91], v[56:59]
    v_mfma_f32_16x16x32_bf16 v[52:55], v[84:87], v[88:91], v[52:55]
    s_waitcnt lgkmcnt(0)
    s_barrier
    v_mfma_f32_16x16x32_bf16 v[28:31], v[68:71], v[92:95], v[28:31]
    v_mfma_f32_16x16x32_bf16 v[24:27], v[72:75], v[92:95], v[24:27]
    v_mfma_f32_16x16x32_bf16 v[20:23], v[76:79], v[92:95], v[20:23]
    buffer_load_dwordx4 v[68:71], v125, s[12:15], s23 offen offset:2048
    v_mfma_f32_16x16x32_bf16 v[60:63], v[80:83], v[96:99], v[60:63]
    v_mfma_f32_16x16x32_bf16 v[56:59], v[84:87], v[96:99], v[56:59]
    buffer_load_dwordx4 v[80:83], v119, s[12:15], s23 offen offset:0
    v_mfma_f32_16x16x32_bf16 v[28:31], v[72:75], v[100:103], v[28:31]
    v_mfma_f32_16x16x32_bf16 v[24:27], v[76:79], v[100:103], v[24:27]
    buffer_load_dwordx4 v[72:75], v125, s[12:15], s26 offen offset:0
    v_mfma_f32_16x16x32_bf16 v[60:63], v[84:87], v[104:107], v[60:63]
    buffer_load_dwordx4 v[84:87], v119, s[12:15], s23 offen offset:2048
    v_mfma_f32_16x16x32_bf16 v[28:31], v[76:79], v[108:111], v[28:31]
    buffer_load_dwordx4 v[76:79], v125, s[12:15], s26 offen offset:2048
    s_add_u32 s23, s23, 57344
    s_add_u32 s26, s26, 57344
    s_branch L_conv2_kernel_mloop2
L_conv2_kernel_mlast2:
    v_and_b32 v125, 15, v127
    v_and_b32 v126, 7, v127
    v_lshlrev_b32 v126, 4, v126
    v_lshl_add_u32 v125, v125, 7, v126
    v_lshrrev_b32 v126, 4, v127
    v_lshl_add_u32 v125, v126, 11, v125
    s_mov_b32 s36, 65536
    s_cmp_eq_u32 s32, 1
    s_cselect_b32 s36, 121856, s36
    s_cmp_eq_u32 s32, 2
    s_cselect_b32 s36, 81920, s36
    s_cmp_eq_u32 s32, 3
    s_cselect_b32 s36, 130048, s36
    s_mov_b32 s37, 98304
    s_cmp_eq_u32 s32, 1
    s_cselect_b32 s37, 138240, s37
    s_cmp_eq_u32 s32, 2
    s_cselect_b32 s37, 146432, s37
    s_cmp_eq_u32 s32, 3
    s_cselect_b32 s37, 154624, s37
    v_add_u32 v126, s37, v125
    v_add_u32 v125, s36, v125
    ds_read_b128 v[88:91], v120 offset:8192
    ds_read_b128 v[92:95], v120 offset:9216
    ds_read_b128 v[96:99], v116 offset:8704
    ds_read_b128 v[100:103], v120 offset:10240
    ds_read_b128 v[104:107], v116 offset:9792
    ds_read_b128 v[108:111], v120 offset:11264
    ds_read_b128 v[112:115], v116 offset:10880
    s_waitcnt vmcnt(5) lgkmcnt(6)
    v_mfma_f32_16x16x32_bf16 v[0:3], v[64:67], v[88:91], v[0:3]
    ds_read_b128 v[88:91], v120 offset:12288
    s_waitcnt vmcnt(4) lgkmcnt(6)
    v_mfma_f32_16x16x32_bf16 v[4:7], v[64:67], v[92:95], v[4:7]
    v_mfma_f32_16x16x32_bf16 v[0:3], v[68:71], v[92:95], v[0:3]
    ds_read_b128 v[92:95], v116 offset:11968
    s_waitcnt vmcnt(3) lgkmcnt(6)
    v_mfma_f32_16x16x32_bf16 v[32:35], v[80:83], v[96:99], v[32:35]
    ds_read_b128 v[96:99], v120 offset:13312
    s_waitcnt vmcnt(2) lgkmcnt(6)
    v_mfma_f32_16x16x32_bf16 v[8:11], v[64:67], v[100:103], v[8:11]
    v_mfma_f32_16x16x32_bf16 v[4:7], v[68:71], v[100:103], v[4:7]
    v_mfma_f32_16x16x32_bf16 v[0:3], v[72:75], v[100:103], v[0:3]
    ds_read_b128 v[100:103], v116 offset:13056
    s_waitcnt vmcnt(1) lgkmcnt(6)
    v_mfma_f32_16x16x32_bf16 v[36:39], v[80:83], v[104:107], v[36:39]
    v_mfma_f32_16x16x32_bf16 v[32:35], v[84:87], v[104:107], v[32:35]
    ds_read_b128 v[104:107], v120 offset:14336
    s_waitcnt vmcnt(0) lgkmcnt(6)
    v_mfma_f32_16x16x32_bf16 v[12:15], v[64:67], v[108:111], v[12:15]
    v_mfma_f32_16x16x32_bf16 v[8:11], v[68:71], v[108:111], v[8:11]
    v_mfma_f32_16x16x32_bf16 v[4:7], v[72:75], v[108:111], v[4:7]
    v_mfma_f32_16x16x32_bf16 v[0:3], v[76:79], v[108:111], v[0:3]
    ds_read_b128 v[108:111], v116 offset:14144
    s_waitcnt lgkmcnt(6)
    v_mfma_f32_16x16x32_bf16 v[40:43], v[80:83], v[112:115], v[40:43]
    v_mfma_f32_16x16x32_bf16 v[36:39], v[84:87], v[112:115], v[36:39]
    ds_read_b128 v[112:115], v120 offset:15360
    s_waitcnt lgkmcnt(6)
    v_mfma_f32_16x16x32_bf16 v[16:19], v[64:67], v[88:91], v[16:19]
    v_mfma_f32_16x16x32_bf16 v[12:15], v[68:71], v[88:91], v[12:15]
    v_mfma_f32_16x16x32_bf16 v[8:11], v[72:75], v[88:91], v[8:11]
    v_mfma_f32_16x16x32_bf16 v[4:7], v[76:79], v[88:91], v[4:7]
    ds_read_b128 v[88:91], v117 offset:8704
    v_xor_b32 v124, 0, v126
    ds_write_b128 v124, v[32:35]
    s_waitcnt lgkmcnt(7)
    v_mfma_f32_16x16x32_bf16 v[44:47], v[80:83], v[92:95], v[44:47]
    v_mfma_f32_16x16x32_bf16 v[40:43], v[84:87], v[92:95], v[40:43]
    ds_read_b128 v[92:95], v122 offset:0
    v_xor_b32 v123, 0, v125
    ds_write_b128 v123, v[0:3]
    s_waitcnt lgkmcnt(8)
    v_mfma_f32_16x16x32_bf16 v[20:23], v[64:67], v[96:99], v[20:23]
    v_mfma_f32_16x16x32_bf16 v[16:19], v[68:71], v[96:99], v[16:19]
    v_mfma_f32_16x16x32_bf16 v[12:15], v[72:75], v[96:99], v[12:15]
    v_mfma_f32_16x16x32_bf16 v[8:11], v[76:79], v[96:99], v[8:11]
    ds_read_b128 v[96:99], v117 offset:9792
    v_xor_b32 v123, 16, v126
    ds_write_b128 v123, v[36:39]
    s_waitcnt lgkmcnt(9)
    v_mfma_f32_16x16x32_bf16 v[48:51], v[80:83], v[100:103], v[48:51]
    v_mfma_f32_16x16x32_bf16 v[44:47], v[84:87], v[100:103], v[44:47]
    ds_read_b128 v[100:103], v121 offset:9216
    v_xor_b32 v124, 16, v125
    ds_write_b128 v124, v[4:7]
    s_waitcnt lgkmcnt(10)
    v_mfma_f32_16x16x32_bf16 v[24:27], v[64:67], v[104:107], v[24:27]
    v_mfma_f32_16x16x32_bf16 v[20:23], v[68:71], v[104:107], v[20:23]
    v_mfma_f32_16x16x32_bf16 v[16:19], v[72:75], v[104:107], v[16:19]
    v_mfma_f32_16x16x32_bf16 v[12:15], v[76:79], v[104:107], v[12:15]
    ds_read_b128 v[104:107], v118 offset:8704
    v_xor_b32 v124, 32, v126
    ds_write_b128 v124, v[40:43]
    s_waitcnt lgkmcnt(11)
    v_mfma_f32_16x16x32_bf16 v[52:55], v[80:83], v[108:111], v[52:55]
    v_mfma_f32_16x16x32_bf16 v[48:51], v[84:87], v[108:111], v[48:51]
    ds_read_b128 v[108:111], v121 offset:10240
    v_xor_b32 v123, 32, v125
    ds_write_b128 v123, v[8:11]
    s_waitcnt lgkmcnt(12)
    v_mfma_f32_16x16x32_bf16 v[28:31], v[64:67], v[112:115], v[28:31]
    v_mfma_f32_16x16x32_bf16 v[24:27], v[68:71], v[112:115], v[24:27]
    v_mfma_f32_16x16x32_bf16 v[20:23], v[72:75], v[112:115], v[20:23]
    v_mfma_f32_16x16x32_bf16 v[16:19], v[76:79], v[112:115], v[16:19]
    v_xor_b32 v123, 48, v126
    ds_write_b128 v123, v[44:47]
    s_waitcnt lgkmcnt(12)
    v_mfma_f32_16x16x32_bf16 v[56:59], v[80:83], v[88:91], v[56:59]
    v_mfma_f32_16x16x32_bf16 v[52:55], v[84:87], v[88:91], v[52:55]
    v_xor_b32 v124, 48, v125
    ds_write_b128 v124, v[12:15]
    s_waitcnt lgkmcnt(11)
    v_mfma_f32_16x16x32_bf16 v[28:31], v[68:71], v[92:95], v[28:31]
    v_mfma_f32_16x16x32_bf16 v[24:27], v[72:75], v[92:95], v[24:27]
    v_mfma_f32_16x16x32_bf16 v[20:23], v[76:79], v[92:95], v[20:23]
    v_xor_b32 v124, 64, v126
    ds_write_b128 v124, v[48:51]
    s_waitcnt lgkmcnt(10)
    v_mfma_f32_16x16x32_bf16 v[60:63], v[80:83], v[96:99], v[60:63]
    v_mfma_f32_16x16x32_bf16 v[56:59], v[84:87], v[96:99], v[56:59]
    v_xor_b32 v123, 64, v125
    ds_write_b128 v123, v[16:19]
    s_waitcnt lgkmcnt(9)
    v_mfma_f32_16x16x32_bf16 v[28:31], v[72:75], v[100:103], v[28:31]
    v_mfma_f32_16x16x32_bf16 v[24:27], v[76:79], v[100:103], v[24:27]
    v_xor_b32 v123, 80, v126
    ds_write_b128 v123, v[52:55]
    s_waitcnt lgkmcnt(8)
    v_mfma_f32_16x16x32_bf16 v[60:63], v[84:87], v[104:107], v[60:63]
    v_xor_b32 v124, 80, v125
    ds_write_b128 v124, v[20:23]
    s_waitcnt lgkmcnt(7)
    v_mfma_f32_16x16x32_bf16 v[28:31], v[76:79], v[108:111], v[28:31]
    v_xor_b32 v124, 96, v126
    ds_write_b128 v124, v[56:59]
    s_nop 7
    v_xor_b32 v123, 96, v125
    ds_write_b128 v123, v[24:27]
    v_xor_b32 v123, 112, v126
    ds_write_b128 v123, v[60:63]
    v_xor_b32 v124, 112, v125
    ds_write_b128 v124, v[28:31]
    s_setprio 0
    s_branch L_conv2_kernel_epi
L_conv2_kernel_helper:
    s_setprio 3
    v_add_u32 v92, 0, v7
    v_add_u32 v93, 1024, v7
    v_add_u32 v94, 2048, v7
    v_add_u32 v95, 3072, v7
    v_and_b32 v76, 4, v5
    v_lshrrev_b32 v76, 1, v76
    v_xor_b32 v76, v6, v76
    v_lshlrev_b32 v76, 4, v76
    v_lshl_add_u32 v76, v5, 6, v76
    s_mov_b32 s24, 0
    buffer_load_dwordx4 v[0:3], v92, s[8:11], s24 offen offset:0
    buffer_load_dwordx4 v[16:19], v92, s[8:11], s24 offen offset:64
    v_add_u32 v92, 128, v92
    buffer_load_dwordx4 v[4:7], v93, s[8:11], s24 offen offset:0
    buffer_load_dwordx4 v[20:23], v93, s[8:11], s24 offen offset:64
    v_add_u32 v93, 128, v93
    buffer_load_dwordx4 v[8:11], v94, s[8:11], s24 offen offset:0
    buffer_load_dwordx4 v[24:27], v94, s[8:11], s24 offen offset:64
    v_add_u32 v94, 128, v94
    buffer_load_dwordx4 v[12:15], v95, s[8:11], s24 offen offset:0
    buffer_load_dwordx4 v[28:31], v95, s[8:11], s24 offen offset:64
    v_add_u32 v95, 128, v95
    s_barrier
    s_mul_i32 s36, s42, 1024
    v_add_u32 v96, s36, v76
    v_add_u32 v97, 65536, v96
    s_mul_i32 s36, s42, 1088
    s_add_u32 s36, s36, 98304
    v_add_u32 v98, s36, v76
    s_waitcnt vmcnt(0)
    s_mov_b32 s28, 0
    s_mov_b32 s22, 2
    s_cmp_ge_u32 s20, 12
    s_cbranch_scc1 L_conv2_kernel_h2
    ds_write_b128 v96, v[0:3] offset:0
    ds_write_b128 v98, v[12:15] offset:0
    v_lshlrev_b32 v76, 16, v0
    v_and_b32 v84, s25, v0
    v_lshlrev_b32 v77, 16, v4
    v_and_b32 v85, s25, v4
    v_lshlrev_b32 v78, 16, v8
    v_and_b32 v86, s25, v8
    v_lshlrev_b32 v79, 16, v12
    v_and_b32 v87, s25, v12
    v_add_f32 v80, v76, v78
    v_add_f32 v88, v84, v86
    v_add_f32 v81, v77, v79
    v_add_f32 v89, v85, v87
    v_fma_f32 v82, v78, 4.0, v76
    v_fma_f32 v90, v86, 4.0, v84
    v_fma_f32 v83, v79, 4.0, v77
    v_fma_f32 v91, v87, 4.0, v85
    v_add_f32 v77, v80, v81
    v_add_f32 v85, v88, v89
    v_sub_f32 v78, v80, v81
    v_sub_f32 v86, v88, v89
    v_fma_f32 v79, v83, 2.0, v82
    v_fma_f32 v87, v91, 2.0, v90
    v_fma_f32 v82, v83, -2.0, v82
    v_fma_f32 v90, v91, -2.0, v90
    v_fmamk_f32 v80, v76, 0x41700000, v82
    v_fmamk_f32 v88, v84, 0x41700000, v90
    v_fmamk_f32 v80, v81, 0x41200000, v80
    v_fmamk_f32 v88, v89, 0x41200000, v88
    v_cvt_pk_bf16_f32 v4, v77, v85
    v_cvt_pk_bf16_f32 v8, v78, v86
    v_cvt_pk_bf16_f32 v64, v79, v87
    v_cvt_pk_bf16_f32 v68, v82, v90
    v_cvt_pk_bf16_f32 v72, v80, v88
    v_lshlrev_b32 v76, 16, v1
    v_and_b32 v84, s25, v1
    v_lshlrev_b32 v77, 16, v5
    v_and_b32 v85, s25, v5
    v_lshlrev_b32 v78, 16, v9
    v_and_b32 v86, s25, v9
    v_lshlrev_b32 v79, 16, v13
    v_and_b32 v87, s25, v13
    v_add_f32 v80, v76, v78
    v_add_f32 v88, v84, v86
    v_add_f32 v81, v77, v79
    v_add_f32 v89, v85, v87
    v_fma_f32 v82, v78, 4.0, v76
    v_fma_f32 v90, v86, 4.0, v84
    v_fma_f32 v83, v79, 4.0, v77
    v_fma_f32 v91, v87, 4.0, v85
    v_add_f32 v77, v80, v81
    v_add_f32 v85, v88, v89
    v_sub_f32 v78, v80, v81
    v_sub_f32 v86, v88, v89
    v_fma_f32 v79, v83, 2.0, v82
    v_fma_f32 v87, v91, 2.0, v90
    v_fma_f32 v82, v83, -2.0, v82
    v_fma_f32 v90, v91, -2.0, v90
    v_fmamk_f32 v80, v76, 0x41700000, v82
    v_fmamk_f32 v88, v84, 0x41700000, v90
    v_fmamk_f32 v80, v81, 0x41200000, v80
    v_fmamk_f32 v88, v89, 0x41200000, v88
    v_cvt_pk_bf16_f32 v5, v77, v85
    v_cvt_pk_bf16_f32 v9, v78, v86
    v_cvt_pk_bf16_f32 v65, v79, v87
    v_cvt_pk_bf16_f32 v69, v82, v90
    v_cvt_pk_bf16_f32 v73, v80, v88
    v_lshlrev_b32 v76, 16, v2
    v_and_b32 v84, s25, v2
    v_lshlrev_b32 v77, 16, v6
    v_and_b32 v85, s25, v6
    v_lshlrev_b32 v78, 16, v10
    v_and_b32 v86, s25, v10
    v_lshlrev_b32 v79, 16, v14
    v_and_b32 v87, s25, v14
    v_add_f32 v80, v76, v78
    v_add_f32 v88, v84, v86
    v_add_f32 v81, v77, v79
    v_add_f32 v89, v85, v87
    v_fma_f32 v82, v78, 4.0, v76
    v_fma_f32 v90, v86, 4.0, v84
    v_fma_f32 v83, v79, 4.0, v77
    v_fma_f32 v91, v87, 4.0, v85
    v_add_f32 v77, v80, v81
    v_add_f32 v85, v88, v89
    v_sub_f32 v78, v80, v81
    v_sub_f32 v86, v88, v89
    v_fma_f32 v79, v83, 2.0, v82
    v_fma_f32 v87, v91, 2.0, v90
    v_fma_f32 v82, v83, -2.0, v82
    v_fma_f32 v90, v91, -2.0, v90
    v_fmamk_f32 v80, v76, 0x41700000, v82
    v_fmamk_f32 v88, v84, 0x41700000, v90
    v_fmamk_f32 v80, v81, 0x41200000, v80
    v_fmamk_f32 v88, v89, 0x41200000, v88
    v_cvt_pk_bf16_f32 v6, v77, v85
    v_cvt_pk_bf16_f32 v10, v78, v86
    v_cvt_pk_bf16_f32 v66, v79, v87
    v_cvt_pk_bf16_f32 v70, v82, v90
    v_cvt_pk_bf16_f32 v74, v80, v88
    v_lshlrev_b32 v76, 16, v3
    v_and_b32 v84, s25, v3
    v_lshlrev_b32 v77, 16, v7
    v_and_b32 v85, s25, v7
    v_lshlrev_b32 v78, 16, v11
    v_and_b32 v86, s25, v11
    v_lshlrev_b32 v79, 16, v15
    v_and_b32 v87, s25, v15
    v_add_f32 v80, v76, v78
    v_add_f32 v88, v84, v86
    v_add_f32 v81, v77, v79
    v_add_f32 v89, v85, v87
    v_fma_f32 v82, v78, 4.0, v76
    v_fma_f32 v90, v86, 4.0, v84
    v_fma_f32 v83, v79, 4.0, v77
    v_fma_f32 v91, v87, 4.0, v85
    v_add_f32 v77, v80, v81
    v_add_f32 v85, v88, v89
    v_sub_f32 v78, v80, v81
    v_sub_f32 v86, v88, v89
    v_fma_f32 v79, v83, 2.0, v82
    v_fma_f32 v87, v91, 2.0, v90
    v_fma_f32 v82, v83, -2.0, v82
    v_fma_f32 v90, v91, -2.0, v90
    v_fmamk_f32 v80, v76, 0x41700000, v82
    v_fmamk_f32 v88, v84, 0x41700000, v90
    v_fmamk_f32 v80, v81, 0x41200000, v80
    v_fmamk_f32 v88, v89, 0x41200000, v88
    v_cvt_pk_bf16_f32 v7, v77, v85
    v_cvt_pk_bf16_f32 v11, v78, v86
    v_cvt_pk_bf16_f32 v67, v79, v87
    v_cvt_pk_bf16_f32 v71, v82, v90
    v_cvt_pk_bf16_f32 v75, v80, v88
    ds_write_b128 v96, v[64:67] offset:49152
    ds_write_b128 v97, v[68:71] offset:0
    ds_write_b128 v97, v[72:75] offset:16384
    ds_write_b128 v96, v[4:7] offset:16384
    ds_write_b128 v96, v[8:11] offset:32768
    buffer_load_dwordx4 v[32:35], v92, s[8:11], s24 offen offset:0
    buffer_load_dwordx4 v[48:51], v92, s[8:11], s24 offen offset:64
    v_add_u32 v92, 128, v92
    buffer_load_dwordx4 v[36:39], v93, s[8:11], s24 offen offset:0
    buffer_load_dwordx4 v[52:55], v93, s[8:11], s24 offen offset:64
    v_add_u32 v93, 128, v93
    s_waitcnt lgkmcnt(0)
    s_barrier
    s_setprio 1
L_conv2_kernel_hloop1:
    s_cmp_lt_u32 s28, 5
    s_cselect_b32 s24, 0, 2130706432
    v_lshlrev_b32 v76, 16, v16
    v_and_b32 v84, s25, v16
    v_lshlrev_b32 v77, 16, v20
    v_and_b32 v85, s25, v20
    v_lshlrev_b32 v78, 16, v24
    v_and_b32 v86, s25, v24
    v_lshlrev_b32 v79, 16, v28
    v_and_b32 v87, s25, v28
    v_add_f32 v80, v76, v78
    v_add_f32 v88, v84, v86
    v_add_f32 v81, v77, v79
    v_add_f32 v89, v85, v87
    v_fma_f32 v82, v78, 4.0, v76
    buffer_load_dwordx4 v[40:43], v94, s[8:11], s24 offen offset:0
    buffer_load_dwordx4 v[56:59], v94, s[8:11], s24 offen offset:64
    v_add_u32 v94, 128, v94
    v_fma_f32 v90, v86, 4.0, v84
    v_fma_f32 v83, v79, 4.0, v77
    v_fma_f32 v91, v87, 4.0, v85
    v_add_f32 v77, v80, v81
    v_add_f32 v85, v88, v89
    v_sub_f32 v78, v80, v81
    v_sub_f32 v86, v88, v89
    v_fma_f32 v79, v83, 2.0, v82
    v_fma_f32 v87, v91, 2.0, v90
    v_fma_f32 v82, v83, -2.0, v82
    v_fma_f32 v90, v91, -2.0, v90
    v_fmamk_f32 v80, v76, 0x41700000, v82
    v_fmamk_f32 v88, v84, 0x41700000, v90
    v_fmamk_f32 v80, v81, 0x41200000, v80
    v_fmamk_f32 v88, v89, 0x41200000, v88
    v_cvt_pk_bf16_f32 v20, v77, v85
    v_cvt_pk_bf16_f32 v24, v78, v86
    v_cvt_pk_bf16_f32 v64, v79, v87
    v_cvt_pk_bf16_f32 v68, v82, v90
    v_cvt_pk_bf16_f32 v72, v80, v88
    v_lshlrev_b32 v76, 16, v17
    v_and_b32 v84, s25, v17
    v_lshlrev_b32 v77, 16, v21
    v_and_b32 v85, s25, v21
    v_lshlrev_b32 v78, 16, v25
    v_and_b32 v86, s25, v25
    v_lshlrev_b32 v79, 16, v29
    v_and_b32 v87, s25, v29
    v_add_f32 v80, v76, v78
    v_add_f32 v88, v84, v86
    v_add_f32 v81, v77, v79
    v_add_f32 v89, v85, v87
    v_fma_f32 v82, v78, 4.0, v76
    v_fma_f32 v90, v86, 4.0, v84
    v_fma_f32 v83, v79, 4.0, v77
    v_fma_f32 v91, v87, 4.0, v85
    v_add_f32 v77, v80, v81
    v_add_f32 v85, v88, v89
    v_sub_f32 v78, v80, v81
    v_sub_f32 v86, v88, v89
    v_fma_f32 v79, v83, 2.0, v82
    v_fma_f32 v87, v91, 2.0, v90
    v_fma_f32 v82, v83, -2.0, v82
    v_fma_f32 v90, v91, -2.0, v90
    v_fmamk_f32 v80, v76, 0x41700000, v82
    v_fmamk_f32 v88, v84, 0x41700000, v90
    v_fmamk_f32 v80, v81, 0x41200000, v80
    v_fmamk_f32 v88, v89, 0x41200000, v88
    v_cvt_pk_bf16_f32 v21, v77, v85
    v_cvt_pk_bf16_f32 v25, v78, v86
    v_cvt_pk_bf16_f32 v65, v79, v87
    v_cvt_pk_bf16_f32 v69, v82, v90
    v_cvt_pk_bf16_f32 v73, v80, v88
    buffer_load_dwordx4 v[44:47], v95, s[8:11], s24 offen offset:0
    buffer_load_dwordx4 v[60:63], v95, s[8:11], s24 offen offset:64
    v_add_u32 v95, 128, v95
    v_lshlrev_b32 v76, 16, v18
    v_and_b32 v84, s25, v18
    v_lshlrev_b32 v77, 16, v22
    v_and_b32 v85, s25, v22
    v_lshlrev_b32 v78, 16, v26
    v_and_b32 v86, s25, v26
    v_lshlrev_b32 v79, 16, v30
    v_and_b32 v87, s25, v30
    v_add_f32 v80, v76, v78
    v_add_f32 v88, v84, v86
    v_add_f32 v81, v77, v79
    v_add_f32 v89, v85, v87
    v_fma_f32 v82, v78, 4.0, v76
    v_fma_f32 v90, v86, 4.0, v84
    v_fma_f32 v83, v79, 4.0, v77
    v_fma_f32 v91, v87, 4.0, v85
    v_add_f32 v77, v80, v81
    v_add_f32 v85, v88, v89
    v_sub_f32 v78, v80, v81
    v_sub_f32 v86, v88, v89
    v_fma_f32 v79, v83, 2.0, v82
    v_fma_f32 v87, v91, 2.0, v90
    v_fma_f32 v82, v83, -2.0, v82
    v_fma_f32 v90, v91, -2.0, v90
    v_fmamk_f32 v80, v76, 0x41700000, v82
    v_fmamk_f32 v88, v84, 0x41700000, v90
    v_fmamk_f32 v80, v81, 0x41200000, v80
    v_fmamk_f32 v88, v89, 0x41200000, v88
    v_cvt_pk_bf16_f32 v22, v77, v85
    v_cvt_pk_bf16_f32 v26, v78, v86
    v_cvt_pk_bf16_f32 v66, v79, v87
    v_cvt_pk_bf16_f32 v70, v82, v90
    v_cvt_pk_bf16_f32 v74, v80, v88
    v_lshlrev_b32 v76, 16, v19
    v_and_b32 v84, s25, v19
    v_lshlrev_b32 v77, 16, v23
    v_and_b32 v85, s25, v23
    v_lshlrev_b32 v78, 16, v27
    v_and_b32 v86, s25, v27
    v_lshlrev_b32 v79, 16, v31
    v_and_b32 v87, s25, v31
    v_add_f32 v80, v76, v78
    v_add_f32 v88, v84, v86
    v_add_f32 v81, v77, v79
    v_add_f32 v89, v85, v87
    v_fma_f32 v82, v78, 4.0, v76
    v_fma_f32 v90, v86, 4.0, v84
    v_fma_f32 v83, v79, 4.0, v77
    v_fma_f32 v91, v87, 4.0, v85
    v_add_f32 v77, v80, v81
    v_add_f32 v85, v88, v89
    v_sub_f32 v78, v80, v81
    v_sub_f32 v86, v88, v89
    v_fma_f32 v79, v83, 2.0, v82
    v_fma_f32 v87, v91, 2.0, v90
    v_fma_f32 v82, v83, -2.0, v82
    v_fma_f32 v90, v91, -2.0, v90
    v_fmamk_f32 v80, v76, 0x41700000, v82
    v_fmamk_f32 v88, v84, 0x41700000, v90
    v_fmamk_f32 v80, v81, 0x41200000, v80
    v_fmamk_f32 v88, v89, 0x41200000, v88
    v_cvt_pk_bf16_f32 v23, v77, v85
    v_cvt_pk_bf16_f32 v27, v78, v86
    v_cvt_pk_bf16_f32 v67, v79, v87
    v_cvt_pk_bf16_f32 v71, v82, v90
    v_cvt_pk_bf16_f32 v75, v80, v88
    ds_write_b128 v96, v[64:67] offset:57344
    ds_write_b128 v97, v[68:71] offset:8192
    ds_write_b128 v97, v[72:75] offset:24576
    ds_write_b128 v96, v[16:19] offset:8192
    ds_write_b128 v96, v[20:23] offset:24576
    ds_write_b128 v96, v[24:27] offset:40960
    ds_write_b128 v98, v[28:31] offset:8704
    s_add_u32 s28, s28, 1
    s_waitcnt lgkmcnt(0)
    s_barrier
    s_cmp_lt_u32 s28, 5
    s_cselect_b32 s24, 0, 2130706432
    s_waitcnt vmcnt(0)
    v_lshlrev_b32 v76, 16, v32
    v_and_b32 v84, s25, v32
    v_lshlrev_b32 v77, 16, v36
    v_and_b32 v85, s25, v36
    v_lshlrev_b32 v78, 16, v40
    v_and_b32 v86, s25, v40
    v_lshlrev_b32 v79, 16, v44
    v_and_b32 v87, s25, v44
    v_add_f32 v80, v76, v78
    v_add_f32 v88, v84, v86
    v_add_f32 v81, v77, v79
    v_add_f32 v89, v85, v87
    v_fma_f32 v82, v78, 4.0, v76
    v_fma_f32 v90, v86, 4.0, v84
    v_fma_f32 v83, v79, 4.0, v77
    v_fma_f32 v91, v87, 4.0, v85
    v_add_f32 v77, v80, v81
    v_add_f32 v85, v88, v89
    v_sub_f32 v78, v80, v81
    v_sub_f32 v86, v88, v89
    v_fma_f32 v79, v83, 2.0, v82
    v_fma_f32 v87, v91, 2.0, v90
    v_fma_f32 v82, v83, -2.0, v82
    v_fma_f32 v90, v91, -2.0, v90
    v_fmamk_f32 v80, v76, 0x41700000, v82
    v_fmamk_f32 v88, v84, 0x41700000, v90
    v_fmamk_f32 v80, v81, 0x41200000, v80
    v_fmamk_f32 v88, v89, 0x41200000, v88
    v_cvt_pk_bf16_f32 v36, v77, v85
    v_cvt_pk_bf16_f32 v40, v78, v86
    v_cvt_pk_bf16_f32 v64, v79, v87
    v_cvt_pk_bf16_f32 v68, v82, v90
    v_cvt_pk_bf16_f32 v72, v80, v88
    v_lshlrev_b32 v76, 16, v33
    v_and_b32 v84, s25, v33
    v_lshlrev_b32 v77, 16, v37
    v_and_b32 v85, s25, v37
    v_lshlrev_b32 v78, 16, v41
    v_and_b32 v86, s25, v41
    buffer_load_dwordx4 v[0:3], v92, s[8:11], s24 offen offset:0
    buffer_load_dwordx4 v[16:19], v92, s[8:11], s24 offen offset:64
    v_add_u32 v92, 128, v92
    v_lshlrev_b32 v79, 16, v45
    v_and_b32 v87, s25, v45
    v_add_f32 v80, v76, v78
    v_add_f32 v88, v84, v86
    v_add_f32 v81, v77, v79
    v_add_f32 v89, v85, v87
    v_fma_f32 v82, v78, 4.0, v76
    v_fma_f32 v90, v86, 4.0, v84
    v_fma_f32 v83, v79, 4.0, v77
    v_fma_f32 v91, v87, 4.0, v85
    v_add_f32 v77, v80, v81
    v_add_f32 v85, v88, v89
    v_sub_f32 v78, v80, v81
    v_sub_f32 v86, v88, v89
    v_fma_f32 v79, v83, 2.0, v82
    v_fma_f32 v87, v91, 2.0, v90
    v_fma_f32 v82, v83, -2.0, v82
    v_fma_f32 v90, v91, -2.0, v90
    v_fmamk_f32 v80, v76, 0x41700000, v82
    v_fmamk_f32 v88, v84, 0x41700000, v90
    v_fmamk_f32 v80, v81, 0x41200000, v80
    v_fmamk_f32 v88, v89, 0x41200000, v88
    v_cvt_pk_bf16_f32 v37, v77, v85
    v_cvt_pk_bf16_f32 v41, v78, v86
    v_cvt_pk_bf16_f32 v65, v79, v87
    v_cvt_pk_bf16_f32 v69, v82, v90
    v_cvt_pk_bf16_f32 v73, v80, v88
    v_lshlrev_b32 v76, 16, v34
    v_and_b32 v84, s25, v34
    v_lshlrev_b32 v77, 16, v38
    v_and_b32 v85, s25, v38
    v_lshlrev_b32 v78, 16, v42
    v_and_b32 v86, s25, v42
    v_lshlrev_b32 v79, 16, v46
    v_and_b32 v87, s25, v46
    v_add_f32 v80, v76, v78
    v_add_f32 v88, v84, v86
    v_add_f32 v81, v77, v79
    v_add_f32 v89, v85, v87
    v_fma_f32 v82, v78, 4.0, v76
    v_fma_f32 v90, v86, 4.0, v84
    v_fma_f32 v83, v79, 4.0, v77
    v_fma_f32 v91, v87, 4.0, v85
    v_add_f32 v77, v80, v81
    v_add_f32 v85, v88, v89
    v_sub_f32 v78, v80, v81
    v_sub_f32 v86, v88, v89
    v_fma_f32 v79, v83, 2.0, v82
    v_fma_f32 v87, v91, 2.0, v90
    v_fma_f32 v82, v83, -2.0, v82
    v_fma_f32 v90, v91, -2.0, v90
    v_fmamk_f32 v80, v76, 0x41700000, v82
    v_fmamk_f32 v88, v84, 0x41700000, v90
    buffer_load_dwordx4 v[4:7], v93, s[8:11], s24 offen offset:0
    buffer_load_dwordx4 v[20:23], v93, s[8:11], s24 offen offset:64
    v_add_u32 v93, 128, v93
    v_fmamk_f32 v80, v81, 0x41200000, v80
    v_fmamk_f32 v88, v89, 0x41200000, v88
    v_cvt_pk_bf16_f32 v38, v77, v85
    v_cvt_pk_bf16_f32 v42, v78, v86
    v_cvt_pk_bf16_f32 v66, v79, v87
    v_cvt_pk_bf16_f32 v70, v82, v90
    v_cvt_pk_bf16_f32 v74, v80, v88
    v_lshlrev_b32 v76, 16, v35
    v_and_b32 v84, s25, v35
    v_lshlrev_b32 v77, 16, v39
    v_and_b32 v85, s25, v39
    v_lshlrev_b32 v78, 16, v43
    v_and_b32 v86, s25, v43
    v_lshlrev_b32 v79, 16, v47
    v_and_b32 v87, s25, v47
    v_add_f32 v80, v76, v78
    v_add_f32 v88, v84, v86
    v_add_f32 v81, v77, v79
    v_add_f32 v89, v85, v87
    v_fma_f32 v82, v78, 4.0, v76
    v_fma_f32 v90, v86, 4.0, v84
    v_fma_f32 v83, v79, 4.0, v77
    v_fma_f32 v91, v87, 4.0, v85
    v_add_f32 v77, v80, v81
    v_add_f32 v85, v88, v89
    v_sub_f32 v78, v80, v81
    v_sub_f32 v86, v88, v89
    v_fma_f32 v79, v83, 2.0, v82
    v_fma_f32 v87, v91, 2.0, v90
    v_fma_f32 v82, v83, -2.0, v82
    v_fma_f32 v90, v91, -2.0, v90
    v_fmamk_f32 v80, v76, 0x41700000, v82
    v_fmamk_f32 v88, v84, 0x41700000, v90
    v_fmamk_f32 v80, v81, 0x41200000, v80
    v_fmamk_f32 v88, v89, 0x41200000, v88
    v_cvt_pk_bf16_f32 v39, v77, v85
    v_cvt_pk_bf16_f32 v43, v78, v86
    v_cvt_pk_bf16_f32 v67, v79, v87
    v_cvt_pk_bf16_f32 v71, v82, v90
    v_cvt_pk_bf16_f32 v75, v80, v88
    ds_write_b128 v96, v[64:67] offset:49152
    ds_write_b128 v97, v[68:71] offset:0
    ds_write_b128 v97, v[72:75] offset:16384
    ds_write_b128 v96, v[32:35] offset:0
    ds_write_b128 v96, v[36:39] offset:16384
    ds_write_b128 v96, v[40:43] offset:32768
    ds_write_b128 v98, v[44:47] offset:0
    s_add_u32 s28, s28, 1
    s_waitcnt lgkmcnt(0)
    s_barrier
    s_cmp_lt_u32 s28, 5
    s_cselect_b32 s24, 0, 2130706432
    v_lshlrev_b32 v76, 16, v48
    v_and_b32 v84, s25, v48
    v_lshlrev_b32 v77, 16, v52
    v_and_b32 v85, s25, v52
    v_lshlrev_b32 v78, 16, v56
    v_and_b32 v86, s25, v56
    v_lshlrev_b32 v79, 16, v60
    v_and_b32 v87, s25, v60
    v_add_f32 v80, v76, v78
    v_add_f32 v88, v84, v86
    v_add_f32 v81, v77, v79
    v_add_f32 v89, v85, v87
    v_fma_f32 v82, v78, 4.0, v76
    buffer_load_dwordx4 v[8:11], v94, s[8:11], s24 offen offset:0
    buffer_load_dwordx4 v[24:27], v94, s[8:11], s24 offen offset:64
    v_add_u32 v94, 128, v94
    v_fma_f32 v90, v86, 4.0, v84
    v_fma_f32 v83, v79, 4.0, v77
    v_fma_f32 v91, v87, 4.0, v85
    v_add_f32 v77, v80, v81
    v_add_f32 v85, v88, v89
    v_sub_f32 v78, v80, v81
    v_sub_f32 v86, v88, v89
    v_fma_f32 v79, v83, 2.0, v82
    v_fma_f32 v87, v91, 2.0, v90
    v_fma_f32 v82, v83, -2.0, v82
    v_fma_f32 v90, v91, -2.0, v90
    v_fmamk_f32 v80, v76, 0x41700000, v82
    v_fmamk_f32 v88, v84, 0x41700000, v90
    v_fmamk_f32 v80, v81, 0x41200000, v80
    v_fmamk_f32 v88, v89, 0x41200000, v88
    v_cvt_pk_bf16_f32 v52, v77, v85
    v_cvt_pk_bf16_f32 v56, v78, v86
    v_cvt_pk_bf16_f32 v64, v79, v87
    v_cvt_pk_bf16_f32 v68, v82, v90
    v_cvt_pk_bf16_f32 v72, v80, v88
    v_lshlrev_b32 v76, 16, v49
    v_and_b32 v84, s25, v49
    v_lshlrev_b32 v77, 16, v53
    v_and_b32 v85, s25, v53
    v_lshlrev_b32 v78, 16, v57
    v_and_b32 v86, s25, v57
    v_lshlrev_b32 v79, 16, v61
    v_and_b32 v87, s25, v61
    v_add_f32 v80, v76, v78
    v_add_f32 v88, v84, v86
    v_add_f32 v81, v77, v79
    v_add_f32 v89, v85, v87
    v_fma_f32 v82, v78, 4.0, v76
    v_fma_f32 v90, v86, 4.0, v84
    v_fma_f32 v83, v79, 4.0, v77
    v_fma_f32 v91, v87, 4.0, v85
    v_add_f32 v77, v80, v81
    v_add_f32 v85, v88, v89
    v_sub_f32 v78, v80, v81
    v_sub_f32 v86, v88, v89
    v_fma_f32 v79, v83, 2.0, v82
    v_fma_f32 v87, v91, 2.0, v90
    v_fma_f32 v82, v83, -2.0, v82
    v_fma_f32 v90, v91, -2.0, v90
    v_fmamk_f32 v80, v76, 0x41700000, v82
    v_fmamk_f32 v88, v84, 0x41700000, v90
    v_fmamk_f32 v80, v81, 0x41200000, v80
    v_fmamk_f32 v88, v89, 0x41200000, v88
    v_cvt_pk_bf16_f32 v53, v77, v85
    v_cvt_pk_bf16_f32 v57, v78, v86
    v_cvt_pk_bf16_f32 v65, v79, v87
    v_cvt_pk_bf16_f32 v69, v82, v90
    v_cvt_pk_bf16_f32 v73, v80, v88
    buffer_load_dwordx4 v[12:15], v95, s[8:11], s24 offen offset:0
    buffer_load_dwordx4 v[28:31], v95, s[8:11], s24 offen offset:64
    v_add_u32 v95, 128, v95
    v_lshlrev_b32 v76, 16, v50
    v_and_b32 v84, s25, v50
    v_lshlrev_b32 v77, 16, v54
    v_and_b32 v85, s25, v54
    v_lshlrev_b32 v78, 16, v58
    v_and_b32 v86, s25, v58
    v_lshlrev_b32 v79, 16, v62
    v_and_b32 v87, s25, v62
    v_add_f32 v80, v76, v78
    v_add_f32 v88, v84, v86
    v_add_f32 v81, v77, v79
    v_add_f32 v89, v85, v87
    v_fma_f32 v82, v78, 4.0, v76
    v_fma_f32 v90, v86, 4.0, v84
    v_fma_f32 v83, v79, 4.0, v77
    v_fma_f32 v91, v87, 4.0, v85
    v_add_f32 v77, v80, v81
    v_add_f32 v85, v88, v89
    v_sub_f32 v78, v80, v81
    v_sub_f32 v86, v88, v89
    v_fma_f32 v79, v83, 2.0, v82
    v_fma_f32 v87, v91, 2.0, v90
    v_fma_f32 v82, v83, -2.0, v82
    v_fma_f32 v90, v91, -2.0, v90
    v_fmamk_f32 v80, v76, 0x41700000, v82
    v_fmamk_f32 v88, v84, 0x41700000, v90
    v_fmamk_f32 v80, v81, 0x41200000, v80
    v_fmamk_f32 v88, v89, 0x41200000, v88
    v_cvt_pk_bf16_f32 v54, v77, v85
    v_cvt_pk_bf16_f32 v58, v78, v86
    v_cvt_pk_bf16_f32 v66, v79, v87
    v_cvt_pk_bf16_f32 v70, v82, v90
    v_cvt_pk_bf16_f32 v74, v80, v88
    v_lshlrev_b32 v76, 16, v51
    v_and_b32 v84, s25, v51
    v_lshlrev_b32 v77, 16, v55
    v_and_b32 v85, s25, v55
    v_lshlrev_b32 v78, 16, v59
    v_and_b32 v86, s25, v59
    v_lshlrev_b32 v79, 16, v63
    v_and_b32 v87, s25, v63
    v_add_f32 v80, v76, v78
    v_add_f32 v88, v84, v86
    v_add_f32 v81, v77, v79
    v_add_f32 v89, v85, v87
    v_fma_f32 v82, v78, 4.0, v76
    v_fma_f32 v90, v86, 4.0, v84
    v_fma_f32 v83, v79, 4.0, v77
    v_fma_f32 v91, v87, 4.0, v85
    v_add_f32 v77, v80, v81
    v_add_f32 v85, v88, v89
    v_sub_f32 v78, v80, v81
    v_sub_f32 v86, v88, v89
    v_fma_f32 v79, v83, 2.0, v82
    v_fma_f32 v87, v91, 2.0, v90
    v_fma_f32 v82, v83, -2.0, v82
    v_fma_f32 v90, v91, -2.0, v90
    v_fmamk_f32 v80, v76, 0x41700000, v82
    v_fmamk_f32 v88, v84, 0x41700000, v90
    v_fmamk_f32 v80, v81, 0x41200000, v80
    v_fmamk_f32 v88, v89, 0x41200000, v88
    v_cvt_pk_bf16_f32 v55, v77, v85
    v_cvt_pk_bf16_f32 v59, v78, v86
    v_cvt_pk_bf16_f32 v67, v79, v87
    v_cvt_pk_bf16_f32 v71, v82, v90
    v_cvt_pk_bf16_f32 v75, v80, v88
    ds_write_b128 v96, v[64:67] offset:57344
    ds_write_b128 v97, v[68:71] offset:8192
    ds_write_b128 v97, v[72:75] offset:24576
    ds_write_b128 v96, v[48:51] offset:8192
    ds_write_b128 v96, v[52:55] offset:24576
    ds_write_b128 v96, v[56:59] offset:40960
    ds_write_b128 v98, v[60:63] offset:8704
    s_add_u32 s28, s28, 1
    s_waitcnt lgkmcnt(0)
    s_barrier
    s_cmp_eq_u32 s22, 1
    s_cbranch_scc1 L_conv2_kernel_hlast1
    s_cmp_lt_u32 s28, 5
    s_cselect_b32 s24, 0, 2130706432
    s_waitcnt vmcnt(0)
    v_lshlrev_b32 v76, 16, v0
    v_and_b32 v84, s25, v0
    v_lshlrev_b32 v77, 16, v4
    v_and_b32 v85, s25, v4
    v_lshlrev_b32 v78, 16, v8
    v_and_b32 v86, s25, v8
    v_lshlrev_b32 v79, 16, v12
    v_and_b32 v87, s25, v12
    v_add_f32 v80, v76, v78
    v_add_f32 v88, v84, v86
    v_add_f32 v81, v77, v79
    v_add_f32 v89, v85, v87
    v_fma_f32 v82, v78, 4.0, v76
    v_fma_f32 v90, v86, 4.0, v84
    v_fma_f32 v83, v79, 4.0, v77
    v_fma_f32 v91, v87, 4.0, v85
    v_add_f32 v77, v80, v81
    v_add_f32 v85, v88, v89
    v_sub_f32 v78, v80, v81
    v_sub_f32 v86, v88, v89
    v_fma_f32 v79, v83, 2.0, v82
    v_fma_f32 v87, v91, 2.0, v90
    v_fma_f32 v82, v83, -2.0, v82
    v_fma_f32 v90, v91, -2.0, v90
    v_fmamk_f32 v80, v76, 0x41700000, v82
    v_fmamk_f32 v88, v84, 0x41700000, v90
    v_fmamk_f32 v80, v81, 0x41200000, v80
    v_fmamk_f32 v88, v89, 0x41200000, v88
    v_cvt_pk_bf16_f32 v4, v77, v85
    v_cvt_pk_bf16_f32 v8, v78, v86
    v_cvt_pk_bf16_f32 v64, v79, v87
    v_cvt_pk_bf16_f32 v68, v82, v90
    v_cvt_pk_bf16_f32 v72, v80, v88
    v_lshlrev_b32 v76, 16, v1
    v_and_b32 v84, s25, v1
    v_lshlrev_b32 v77, 16, v5
    v_and_b32 v85, s25, v5
    v_lshlrev_b32 v78, 16, v9
    v_and_b32 v86, s25, v9
    buffer_load_dwordx4 v[32:35], v92, s[8:11], s24 offen offset:0
    buffer_load_dwordx4 v[48:51], v92, s[8:11], s24 offen offset:64
    v_add_u32 v92, 128, v92
    v_lshlrev_b32 v79, 16, v13
    v_and_b32 v87, s25, v13
    v_add_f32 v80, v76, v78
    v_add_f32 v88, v84, v86
    v_add_f32 v81, v77, v79
    v_add_f32 v89, v85, v87
    v_fma_f32 v82, v78, 4.0, v76
    v_fma_f32 v90, v86, 4.0, v84
    v_fma_f32 v83, v79, 4.0, v77
    v_fma_f32 v91, v87, 4.0, v85
    v_add_f32 v77, v80, v81
    v_add_f32 v85, v88, v89
    v_sub_f32 v78, v80, v81
    v_sub_f32 v86, v88, v89
    v_fma_f32 v79, v83, 2.0, v82
    v_fma_f32 v87, v91, 2.0, v90
    v_fma_f32 v82, v83, -2.0, v82
    v_fma_f32 v90, v91, -2.0, v90
    v_fmamk_f32 v80, v76, 0x41700000, v82
    v_fmamk_f32 v88, v84, 0x41700000, v90
    v_fmamk_f32 v80, v81, 0x41200000, v80
    v_fmamk_f32 v88, v89, 0x41200000, v88
    v_cvt_pk_bf16_f32 v5, v77, v85
    v_cvt_pk_bf16_f32 v9, v78, v86
    v_cvt_pk_bf16_f32 v65, v79, v87
    v_cvt_pk_bf16_f32 v69, v82, v90
    v_cvt_pk_bf16_f32 v73, v80, v88
    v_lshlrev_b32 v76, 16, v2
    v_and_b32 v84, s25, v2
    v_lshlrev_b32 v77, 16, v6
    v_and_b32 v85, s25, v6
    v_lshlrev_b32 v78, 16, v10
    v_and_b32 v86, s25, v10
    v_lshlrev_b32 v79, 16, v14
    v_and_b32 v87, s25, v14
    v_add_f32 v80, v76, v78
    v_add_f32 v88, v84, v86
    v_add_f32 v81, v77, v79
    v_add_f32 v89, v85, v87
    v_fma_f32 v82, v78, 4.0, v76
    v_fma_f32 v90, v86, 4.0, v84
    v_fma_f32 v83, v79, 4.0, v77
    v_fma_f32 v91, v87, 4.0, v85
    v_add_f32 v77, v80, v81
    v_add_f32 v85, v88, v89
    v_sub_f32 v78, v80, v81
    v_sub_f32 v86, v88, v89
    v_fma_f32 v79, v83, 2.0, v82
    v_fma_f32 v87, v91, 2.0, v90
    v_fma_f32 v82, v83, -2.0, v82
    v_fma_f32 v90, v91, -2.0, v90
    v_fmamk_f32 v80, v76, 0x41700000, v82
    v_fmamk_f32 v88, v84, 0x41700000, v90
    buffer_load_dwordx4 v[36:39], v93, s[8:11], s24 offen offset:0
    buffer_load_dwordx4 v[52:55], v93, s[8:11], s24 offen offset:64
    v_add_u32 v93, 128, v93
    v_fmamk_f32 v80, v81, 0x41200000, v80
    v_fmamk_f32 v88, v89, 0x41200000, v88
    v_cvt_pk_bf16_f32 v6, v77, v85
    v_cvt_pk_bf16_f32 v10, v78, v86
    v_cvt_pk_bf16_f32 v66, v79, v87
    v_cvt_pk_bf16_f32 v70, v82, v90
    v_cvt_pk_bf16_f32 v74, v80, v88
    v_lshlrev_b32 v76, 16, v3
    v_and_b32 v84, s25, v3
    v_lshlrev_b32 v77, 16, v7
    v_and_b32 v85, s25, v7
    v_lshlrev_b32 v78, 16, v11
    v_and_b32 v86, s25, v11
    v_lshlrev_b32 v79, 16, v15
    v_and_b32 v87, s25, v15
    v_add_f32 v80, v76, v78
    v_add_f32 v88, v84, v86
    v_add_f32 v81, v77, v79
    v_add_f32 v89, v85, v87
    v_fma_f32 v82, v78, 4.0, v76
    v_fma_f32 v90, v86, 4.0, v84
    v_fma_f32 v83, v79, 4.0, v77
    v_fma_f32 v91, v87, 4.0, v85
    v_add_f32 v77, v80, v81
    v_add_f32 v85, v88, v89
    v_sub_f32 v78, v80, v81
    v_sub_f32 v86, v88, v89
    v_fma_f32 v79, v83, 2.0, v82
    v_fma_f32 v87, v91, 2.0, v90
    v_fma_f32 v82, v83, -2.0, v82
    v_fma_f32 v90, v91, -2.0, v90
    v_fmamk_f32 v80, v76, 0x41700000, v82
    v_fmamk_f32 v88, v84, 0x41700000, v90
    v_fmamk_f32 v80, v81, 0x41200000, v80
    v_fmamk_f32 v88, v89, 0x41200000, v88
    v_cvt_pk_bf16_f32 v7, v77, v85
    v_cvt_pk_bf16_f32 v11, v78, v86
    v_cvt_pk_bf16_f32 v67, v79, v87
    v_cvt_pk_bf16_f32 v71, v82, v90
    v_cvt_pk_bf16_f32 v75, v80, v88
    ds_write_b128 v96, v[64:67] offset:49152
    ds_write_b128 v97, v[68:71] offset:0
    ds_write_b128 v97, v[72:75] offset:16384
    ds_write_b128 v96, v[0:3] offset:0
    ds_write_b128 v96, v[4:7] offset:16384
    ds_write_b128 v96, v[8:11] offset:32768
    ds_write_b128 v98, v[12:15] offset:0
    s_add_u32 s28, s28, 1
    s_waitcnt lgkmcnt(0)
    s_barrier
    s_sub_u32 s22, s22, 1
    s_branch L_conv2_kernel_hloop1
L_conv2_kernel_hlast1:
    s_branch L_conv2_kernel_end
L_conv2_kernel_h2:
    ds_write_b128 v96, v[0:3] offset:0
    ds_write_b128 v98, v[12:15] offset:0
    v_lshlrev_b32 v76, 16, v0
    v_and_b32 v84, s25, v0
    v_lshlrev_b32 v77, 16, v4
    v_and_b32 v85, s25, v4
    v_lshlrev_b32 v78, 16, v8
    v_and_b32 v86, s25, v8
    v_lshlrev_b32 v79, 16, v12
    v_and_b32 v87, s25, v12
    v_add_f32 v80, v76, v78
    v_add_f32 v88, v84, v86
    v_add_f32 v81, v77, v79
    v_add_f32 v89, v85, v87
    v_fma_f32 v82, v78, 4.0, v76
    v_fma_f32 v90, v86, 4.0, v84
    v_fma_f32 v83, v79, 4.0, v77
    v_fma_f32 v91, v87, 4.0, v85
    v_add_f32 v77, v80, v81
    v_add_f32 v85, v88, v89
    v_sub_f32 v78, v80, v81
    v_sub_f32 v86, v88, v89
    v_fma_f32 v79, v83, 2.0, v82
    v_fma_f32 v87, v91, 2.0, v90
    v_fma_f32 v82, v83, -2.0, v82
    v_fma_f32 v90, v91, -2.0, v90
    v_fmamk_f32 v80, v76, 0x41700000, v82
    v_fmamk_f32 v88, v84, 0x41700000, v90
    v_fmamk_f32 v80, v81, 0x41200000, v80
    v_fmamk_f32 v88, v89, 0x41200000, v88
    v_cvt_pk_bf16_f32 v4, v77, v85
    v_cvt_pk_bf16_f32 v8, v78, v86
    v_cvt_pk_bf16_f32 v64, v79, v87
    v_cvt_pk_bf16_f32 v68, v82, v90
    v_cvt_pk_bf16_f32 v72, v80, v88
    v_lshlrev_b32 v76, 16, v1
    v_and_b32 v84, s25, v1
    v_lshlrev_b32 v77, 16, v5
    v_and_b32 v85, s25, v5
    v_lshlrev_b32 v78, 16, v9
    v_and_b32 v86, s25, v9
    v_lshlrev_b32 v79, 16, v13
    v_and_b32 v87, s25, v13
    v_add_f32 v80, v76, v78
    v_add_f32 v88, v84, v86
    v_add_f32 v81, v77, v79
    v_add_f32 v89, v85, v87
    v_fma_f32 v82, v78, 4.0, v76
    v_fma_f32 v90, v86, 4.0, v84
    v_fma_f32 v83, v79, 4.0, v77
    v_fma_f32 v91, v87, 4.0, v85
    v_add_f32 v77, v80, v81
    v_add_f32 v85, v88, v89
    v_sub_f32 v78, v80, v81
    v_sub_f32 v86, v88, v89
    v_fma_f32 v79, v83, 2.0, v82
    v_fma_f32 v87, v91, 2.0, v90
    v_fma_f32 v82, v83, -2.0, v82
    v_fma_f32 v90, v91, -2.0, v90
    v_fmamk_f32 v80, v76, 0x41700000, v82
    v_fmamk_f32 v88, v84, 0x41700000, v90
    v_fmamk_f32 v80, v81, 0x41200000, v80
    v_fmamk_f32 v88, v89, 0x41200000, v88
    v_cvt_pk_bf16_f32 v5, v77, v85
    v_cvt_pk_bf16_f32 v9, v78, v86
    v_cvt_pk_bf16_f32 v65, v79, v87
    v_cvt_pk_bf16_f32 v69, v82, v90
    v_cvt_pk_bf16_f32 v73, v80, v88
    v_lshlrev_b32 v76, 16, v2
    v_and_b32 v84, s25, v2
    v_lshlrev_b32 v77, 16, v6
    v_and_b32 v85, s25, v6
    v_lshlrev_b32 v78, 16, v10
    v_and_b32 v86, s25, v10
    v_lshlrev_b32 v79, 16, v14
    v_and_b32 v87, s25, v14
    v_add_f32 v80, v76, v78
    v_add_f32 v88, v84, v86
    v_add_f32 v81, v77, v79
    v_add_f32 v89, v85, v87
    v_fma_f32 v82, v78, 4.0, v76
    v_fma_f32 v90, v86, 4.0, v84
    v_fma_f32 v83, v79, 4.0, v77
    v_fma_f32 v91, v87, 4.0, v85
    v_add_f32 v77, v80, v81
    v_add_f32 v85, v88, v89
    v_sub_f32 v78, v80, v81
    v_sub_f32 v86, v88, v89
    v_fma_f32 v79, v83, 2.0, v82
    v_fma_f32 v87, v91, 2.0, v90
    v_fma_f32 v82, v83, -2.0, v82
    v_fma_f32 v90, v91, -2.0, v90
    v_fmamk_f32 v80, v76, 0x41700000, v82
    v_fmamk_f32 v88, v84, 0x41700000, v90
    v_fmamk_f32 v80, v81, 0x41200000, v80
    v_fmamk_f32 v88, v89, 0x41200000, v88
    v_cvt_pk_bf16_f32 v6, v77, v85
    v_cvt_pk_bf16_f32 v10, v78, v86
    v_cvt_pk_bf16_f32 v66, v79, v87
    v_cvt_pk_bf16_f32 v70, v82, v90
    v_cvt_pk_bf16_f32 v74, v80, v88
    v_lshlrev_b32 v76, 16, v3
    v_and_b32 v84, s25, v3
    v_lshlrev_b32 v77, 16, v7
    v_and_b32 v85, s25, v7
    v_lshlrev_b32 v78, 16, v11
    v_and_b32 v86, s25, v11
    v_lshlrev_b32 v79, 16, v15
    v_and_b32 v87, s25, v15
    v_add_f32 v80, v76, v78
    v_add_f32 v88, v84, v86
    v_add_f32 v81, v77, v79
    v_add_f32 v89, v85, v87
    v_fma_f32 v82, v78, 4.0, v76
    v_fma_f32 v90, v86, 4.0, v84
    v_fma_f32 v83, v79, 4.0, v77
    v_fma_f32 v91, v87, 4.0, v85
    v_add_f32 v77, v80, v81
    v_add_f32 v85, v88, v89
    v_sub_f32 v78, v80, v81
    v_sub_f32 v86, v88, v89
    v_fma_f32 v79, v83, 2.0, v82
    v_fma_f32 v87, v91, 2.0, v90
    v_fma_f32 v82, v83, -2.0, v82
    v_fma_f32 v90, v91, -2.0, v90
    v_fmamk_f32 v80, v76, 0x41700000, v82
    v_fmamk_f32 v88, v84, 0x41700000, v90
    v_fmamk_f32 v80, v81, 0x41200000, v80
    v_fmamk_f32 v88, v89, 0x41200000, v88
    v_cvt_pk_bf16_f32 v7, v77, v85
    v_cvt_pk_bf16_f32 v11, v78, v86
    v_cvt_pk_bf16_f32 v67, v79, v87
    v_cvt_pk_bf16_f32 v71, v82, v90
    v_cvt_pk_bf16_f32 v75, v80, v88
    ds_write_b128 v96, v[64:67] offset:49152
    ds_write_b128 v97, v[68:71] offset:0
    ds_write_b128 v97, v[72:75] offset:16384
    ds_write_b128 v96, v[4:7] offset:16384
    ds_write_b128 v96, v[8:11] offset:32768
    buffer_load_dwordx4 v[32:35], v92, s[8:11], s24 offen offset:0
    buffer_load_dwordx4 v[48:51], v92, s[8:11], s24 offen offset:64
    v_add_u32 v92, 128, v92
    buffer_load_dwordx4 v[36:39], v93, s[8:11], s24 offen offset:0
    buffer_load_dwordx4 v[52:55], v93, s[8:11], s24 offen offset:64
    v_add_u32 v93, 128, v93
    buffer_load_dwordx4 v[40:43], v94, s[8:11], s24 offen offset:0
    buffer_load_dwordx4 v[56:59], v94, s[8:11], s24 offen offset:64
    v_add_u32 v94, 128, v94
    buffer_load_dwordx4 v[44:47], v95, s[8:11], s24 offen offset:0
    buffer_load_dwordx4 v[60:63], v95, s[8:11], s24 offen offset:64
    v_add_u32 v95, 128, v95
    s_waitcnt lgkmcnt(0)
    s_barrier
    s_setprio 0
    v_lshlrev_b32 v76, 16, v16
    v_and_b32 v84, s25, v16
    v_lshlrev_b32 v77, 16, v20
    v_and_b32 v85, s25, v20
    v_lshlrev_b32 v78, 16, v24
    v_and_b32 v86, s25, v24
    v_lshlrev_b32 v79, 16, v28
    v_and_b32 v87, s25, v28
    v_add_f32 v80, v76, v78
    v_add_f32 v88, v84, v86
    v_add_f32 v81, v77, v79
    v_add_f32 v89, v85, v87
    v_fma_f32 v82, v78, 4.0, v76
    v_fma_f32 v90, v86, 4.0, v84
    v_fma_f32 v83, v79, 4.0, v77
    v_fma_f32 v91, v87, 4.0, v85
    v_add_f32 v77, v80, v81
    v_add_f32 v85, v88, v89
    v_sub_f32 v78, v80, v81
    v_sub_f32 v86, v88, v89
    v_fma_f32 v79, v83, 2.0, v82
    v_fma_f32 v87, v91, 2.0, v90
    v_fma_f32 v82, v83, -2.0, v82
    v_fma_f32 v90, v91, -2.0, v90
    v_fmamk_f32 v80, v76, 0x41700000, v82
    v_fmamk_f32 v88, v84, 0x41700000, v90
    v_fmamk_f32 v80, v81, 0x41200000, v80
    v_fmamk_f32 v88, v89, 0x41200000, v88
    v_cvt_pk_bf16_f32 v20, v77, v85
    v_cvt_pk_bf16_f32 v24, v78, v86
    v_cvt_pk_bf16_f32 v64, v79, v87
    v_cvt_pk_bf16_f32 v68, v82, v90
    v_cvt_pk_bf16_f32 v72, v80, v88
    v_lshlrev_b32 v76, 16, v17
    v_and_b32 v84, s25, v17
    v_lshlrev_b32 v77, 16, v21
    v_and_b32 v85, s25, v21
    v_lshlrev_b32 v78, 16, v25
    v_and_b32 v86, s25, v25
    v_lshlrev_b32 v79, 16, v29
    v_and_b32 v87, s25, v29
    v_add_f32 v80, v76, v78
    v_add_f32 v88, v84, v86
    v_add_f32 v81, v77, v79
    v_add_f32 v89, v85, v87
    v_fma_f32 v82, v78, 4.0, v76
    v_fma_f32 v90, v86, 4.0, v84
    v_fma_f32 v83, v79, 4.0, v77
    v_fma_f32 v91, v87, 4.0, v85
    v_add_f32 v77, v80, v81
    v_add_f32 v85, v88, v89
    v_sub_f32 v78, v80, v81
    v_sub_f32 v86, v88, v89
    v_fma_f32 v79, v83, 2.0, v82
    v_fma_f32 v87, v91, 2.0, v90
    v_fma_f32 v82, v83, -2.0, v82
    v_fma_f32 v90, v91, -2.0, v90
    v_fmamk_f32 v80, v76, 0x41700000, v82
    v_fmamk_f32 v88, v84, 0x41700000, v90
    v_fmamk_f32 v80, v81, 0x41200000, v80
    v_fmamk_f32 v88, v89, 0x41200000, v88
    v_cvt_pk_bf16_f32 v21, v77, v85
    v_cvt_pk_bf16_f32 v25, v78, v86
    v_cvt_pk_bf16_f32 v65, v79, v87
    v_cvt_pk_bf16_f32 v69, v82, v90
    v_cvt_pk_bf16_f32 v73, v80, v88
    v_lshlrev_b32 v76, 16, v18
    v_and_b32 v84, s25, v18
    v_lshlrev_b32 v77, 16, v22
    v_and_b32 v85, s25, v22
    v_lshlrev_b32 v78, 16, v26
    v_and_b32 v86, s25, v26
    v_lshlrev_b32 v79, 16, v30
    v_and_b32 v87, s25, v30
    v_add_f32 v80, v76, v78
    v_add_f32 v88, v84, v86
    v_add_f32 v81, v77, v79
    v_add_f32 v89, v85, v87
    v_fma_f32 v82, v78, 4.0, v76
    v_fma_f32 v90, v86, 4.0, v84
    v_fma_f32 v83, v79, 4.0, v77
    v_fma_f32 v91, v87, 4.0, v85
    v_add_f32 v77, v80, v81
    v_add_f32 v85, v88, v89
    v_sub_f32 v78, v80, v81
    v_sub_f32 v86, v88, v89
    v_fma_f32 v79, v83, 2.0, v82
    v_fma_f32 v87, v91, 2.0, v90
    v_fma_f32 v82, v83, -2.0, v82
    v_fma_f32 v90, v91, -2.0, v90
    v_fmamk_f32 v80, v76, 0x41700000, v82
    v_fmamk_f32 v88, v84, 0x41700000, v90
    v_fmamk_f32 v80, v81, 0x41200000, v80
    v_fmamk_f32 v88, v89, 0x41200000, v88
    v_cvt_pk_bf16_f32 v22, v77, v85
    v_cvt_pk_bf16_f32 v26, v78, v86
    v_cvt_pk_bf16_f32 v66, v79, v87
    v_cvt_pk_bf16_f32 v70, v82, v90
    v_cvt_pk_bf16_f32 v74, v80, v88
    v_lshlrev_b32 v76, 16, v19
    v_and_b32 v84, s25, v19
    v_lshlrev_b32 v77, 16, v23
    v_and_b32 v85, s25, v23
    v_lshlrev_b32 v78, 16, v27
    v_and_b32 v86, s25, v27
    v_lshlrev_b32 v79, 16, v31
    v_and_b32 v87, s25, v31
    v_add_f32 v80, v76, v78
    v_add_f32 v88, v84, v86
    v_add_f32 v81, v77, v79
    v_add_f32 v89, v85, v87
    v_fma_f32 v82, v78, 4.0, v76
    v_fma_f32 v90, v86, 4.0, v84
    v_fma_f32 v83, v79, 4.0, v77
    v_fma_f32 v91, v87, 4.0, v85
    v_add_f32 v77, v80, v81
    v_add_f32 v85, v88, v89
    v_sub_f32 v78, v80, v81
    v_sub_f32 v86, v88, v89
    v_fma_f32 v79, v83, 2.0, v82
    v_fma_f32 v87, v91, 2.0, v90
    v_fma_f32 v82, v83, -2.0, v82
    v_fma_f32 v90, v91, -2.0, v90
    v_fmamk_f32 v80, v76, 0x41700000, v82
    v_fmamk_f32 v88, v84, 0x41700000, v90
    v_fmamk_f32 v80, v81, 0x41200000, v80
    v_fmamk_f32 v88, v89, 0x41200000, v88
    v_cvt_pk_bf16_f32 v23, v77, v85
    v_cvt_pk_bf16_f32 v27, v78, v86
    v_cvt_pk_bf16_f32 v67, v79, v87
    v_cvt_pk_bf16_f32 v71, v82, v90
    v_cvt_pk_bf16_f32 v75, v80, v88
L_conv2_kernel_hloop2:
    s_cmp_lt_u32 s28, 4
    s_cselect_b32 s24, 0, 2130706432
    ds_write_b128 v96, v[64:67] offset:57344
    ds_write_b128 v97, v[68:71] offset:8192
    ds_write_b128 v97, v[72:75] offset:24576
    ds_write_b128 v96, v[16:19] offset:8192
    ds_write_b128 v96, v[20:23] offset:24576
    ds_write_b128 v96, v[24:27] offset:40960
    ds_write_b128 v98, v[28:31] offset:8704
    s_waitcnt vmcnt(0)
    v_lshlrev_b32 v76, 16, v32
    v_and_b32 v84, s25, v32
    v_lshlrev_b32 v77, 16, v36
    v_and_b32 v85, s25, v36
    v_lshlrev_b32 v78, 16, v40
    v_and_b32 v86, s25, v40
    v_lshlrev_b32 v79, 16, v44
    v_and_b32 v87, s25, v44
    v_add_f32 v80, v76, v78
    v_add_f32 v88, v84, v86
    v_add_f32 v81, v77, v79
    v_add_f32 v89, v85, v87
    v_fma_f32 v82, v78, 4.0, v76
    v_fma_f32 v90, v86, 4.0, v84
    v_fma_f32 v83, v79, 4.0, v77
    v_fma_f32 v91, v87, 4.0, v85
    v_add_f32 v77, v80, v81
    v_add_f32 v85, v88, v89
    v_sub_f32 v78, v80, v81
    v_sub_f32 v86, v88, v89
    v_fma_f32 v79, v83, 2.0, v82
    v_fma_f32 v87, v91, 2.0, v90
    v_fma_f32 v82, v83, -2.0, v82
    v_fma_f32 v90, v91, -2.0, v90
    v_fmamk_f32 v80, v76, 0x41700000, v82
    v_fmamk_f32 v88, v84, 0x41700000, v90
    buffer_load_dwordx4 v[0:3], v92, s[8:11], s24 offen offset:0
    buffer_load_dwordx4 v[16:19], v92, s[8:11], s24 offen offset:64
    v_add_u32 v92, 128, v92
    v_fmamk_f32 v80, v81, 0x41200000, v80
    v_fmamk_f32 v88, v89, 0x41200000, v88
    v_cvt_pk_bf16_f32 v36, v77, v85
    v_cvt_pk_bf16_f32 v40, v78, v86
    v_cvt_pk_bf16_f32 v64, v79, v87
    v_cvt_pk_bf16_f32 v68, v82, v90
    v_cvt_pk_bf16_f32 v72, v80, v88
    v_lshlrev_b32 v76, 16, v33
    v_and_b32 v84, s25, v33
    v_lshlrev_b32 v77, 16, v37
    v_and_b32 v85, s25, v37
    v_lshlrev_b32 v78, 16, v41
    v_and_b32 v86, s25, v41
    v_lshlrev_b32 v79, 16, v45
    v_and_b32 v87, s25, v45
    v_add_f32 v80, v76, v78
    v_add_f32 v88, v84, v86
    v_add_f32 v81, v77, v79
    v_add_f32 v89, v85, v87
    v_fma_f32 v82, v78, 4.0, v76
    v_fma_f32 v90, v86, 4.0, v84
    v_fma_f32 v83, v79, 4.0, v77
    v_fma_f32 v91, v87, 4.0, v85
    v_add_f32 v77, v80, v81
    v_add_f32 v85, v88, v89
    v_sub_f32 v78, v80, v81
    v_sub_f32 v86, v88, v89
    v_fma_f32 v79, v83, 2.0, v82
    v_fma_f32 v87, v91, 2.0, v90
    v_fma_f32 v82, v83, -2.0, v82
    v_fma_f32 v90, v91, -2.0, v90
    v_fmamk_f32 v80, v76, 0x41700000, v82
    v_fmamk_f32 v88, v84, 0x41700000, v90
    v_fmamk_f32 v80, v81, 0x41200000, v80
    v_fmamk_f32 v88, v89, 0x41200000, v88
    v_cvt_pk_bf16_f32 v37, v77, v85
    v_cvt_pk_bf16_f32 v41, v78, v86
    v_cvt_pk_bf16_f32 v65, v79, v87
    v_cvt_pk_bf16_f32 v69, v82, v90
    v_cvt_pk_bf16_f32 v73, v80, v88
    v_lshlrev_b32 v76, 16, v34
    v_and_b32 v84, s25, v34
    v_lshlrev_b32 v77, 16, v38
    v_and_b32 v85, s25, v38
    v_lshlrev_b32 v78, 16, v42
    v_and_b32 v86, s25, v42
    v_lshlrev_b32 v79, 16, v46
    v_and_b32 v87, s25, v46
    v_add_f32 v80, v76, v78
    v_add_f32 v88, v84, v86
    v_add_f32 v81, v77, v79
    v_add_f32 v89, v85, v87
    v_fma_f32 v82, v78, 4.0, v76
    buffer_load_dwordx4 v[4:7], v93, s[8:11], s24 offen offset:0
    buffer_load_dwordx4 v[20:23], v93, s[8:11], s24 offen offset:64
    v_add_u32 v93, 128, v93
    v_fma_f32 v90, v86, 4.0, v84
    v_fma_f32 v83, v79, 4.0, v77
    v_fma_f32 v91, v87, 4.0, v85
    v_add_f32 v77, v80, v81
    v_add_f32 v85, v88, v89
    v_sub_f32 v78, v80, v81
    v_sub_f32 v86, v88, v89
    v_fma_f32 v79, v83, 2.0, v82
    v_fma_f32 v87, v91, 2.0, v90
    v_fma_f32 v82, v83, -2.0, v82
    v_fma_f32 v90, v91, -2.0, v90
    v_fmamk_f32 v80, v76, 0x41700000, v82
    v_fmamk_f32 v88, v84, 0x41700000, v90
    v_fmamk_f32 v80, v81, 0x41200000, v80
    v_fmamk_f32 v88, v89, 0x41200000, v88
    v_cvt_pk_bf16_f32 v38, v77, v85
    v_cvt_pk_bf16_f32 v42, v78, v86
    v_cvt_pk_bf16_f32 v66, v79, v87
    v_cvt_pk_bf16_f32 v70, v82, v90
    v_cvt_pk_bf16_f32 v74, v80, v88
    v_lshlrev_b32 v76, 16, v35
    v_and_b32 v84, s25, v35
    v_lshlrev_b32 v77, 16, v39
    v_and_b32 v85, s25, v39
    v_lshlrev_b32 v78, 16, v43
    v_and_b32 v86, s25, v43
    v_lshlrev_b32 v79, 16, v47
    v_and_b32 v87, s25, v47
    v_add_f32 v80, v76, v78
    v_add_f32 v88, v84, v86
    v_add_f32 v81, v77, v79
    v_add_f32 v89, v85, v87
    v_fma_f32 v82, v78, 4.0, v76
    v_fma_f32 v90, v86, 4.0, v84
    v_fma_f32 v83, v79, 4.0, v77
    v_fma_f32 v91, v87, 4.0, v85
    v_add_f32 v77, v80, v81
    v_add_f32 v85, v88, v89
    v_sub_f32 v78, v80, v81
    v_sub_f32 v86, v88, v89
    v_fma_f32 v79, v83, 2.0, v82
    v_fma_f32 v87, v91, 2.0, v90
    v_fma_f32 v82, v83, -2.0, v82
    v_fma_f32 v90, v91, -2.0, v90
    v_fmamk_f32 v80, v76, 0x41700000, v82
    v_fmamk_f32 v88, v84, 0x41700000, v90
    v_fmamk_f32 v80, v81, 0x41200000, v80
    v_fmamk_f32 v88, v89, 0x41200000, v88
    v_cvt_pk_bf16_f32 v39, v77, v85
    v_cvt_pk_bf16_f32 v43, v78, v86
    v_cvt_pk_bf16_f32 v67, v79, v87
    v_cvt_pk_bf16_f32 v71, v82, v90
    v_cvt_pk_bf16_f32 v75, v80, v88
    s_add_u32 s28, s28, 1
    s_waitcnt lgkmcnt(0)
    s_barrier
    s_cmp_lt_u32 s28, 4
    s_cselect_b32 s24, 0, 2130706432
    ds_write_b128 v96, v[64:67] offset:49152
    ds_write_b128 v97, v[68:71] offset:0
    ds_write_b128 v97, v[72:75] offset:16384
    ds_write_b128 v96, v[32:35] offset:0
    ds_write_b128 v96, v[36:39] offset:16384
    ds_write_b128 v96, v[40:43] offset:32768
    ds_write_b128 v98, v[44:47] offset:0
    v_lshlrev_b32 v76, 16, v48
    v_and_b32 v84, s25, v48
    buffer_load_dwordx4 v[8:11], v94, s[8:11], s24 offen offset:0
    buffer_load_dwordx4 v[24:27], v94, s[8:11], s24 offen offset:64
    v_add_u32 v94, 128, v94
    v_lshlrev_b32 v77, 16, v52
    v_and_b32 v85, s25, v52
    v_lshlrev_b32 v78, 16, v56
    v_and_b32 v86, s25, v56
    v_lshlrev_b32 v79, 16, v60
    v_and_b32 v87, s25, v60
    v_add_f32 v80, v76, v78
    v_add_f32 v88, v84, v86
    v_add_f32 v81, v77, v79
    v_add_f32 v89, v85, v87
    v_fma_f32 v82, v78, 4.0, v76
    v_fma_f32 v90, v86, 4.0, v84
    v_fma_f32 v83, v79, 4.0, v77
    v_fma_f32 v91, v87, 4.0, v85
    v_add_f32 v77, v80, v81
    v_add_f32 v85, v88, v89
    v_sub_f32 v78, v80, v81
    buffer_load_dwordx4 v[12:15], v95, s[8:11], s24 offen offset:0
    buffer_load_dwordx4 v[28:31], v95, s[8:11], s24 offen offset:64
    v_add_u32 v95, 128, v95
    v_sub_f32 v86, v88, v89
    v_fma_f32 v79, v83, 2.0, v82
    v_fma_f32 v87, v91, 2.0, v90
    v_fma_f32 v82, v83, -2.0, v82
    v_fma_f32 v90, v91, -2.0, v90
    v_fmamk_f32 v80, v76, 0x41700000, v82
    v_fmamk_f32 v88, v84, 0x41700000, v90
    v_fmamk_f32 v80, v81, 0x41200000, v80
    v_fmamk_f32 v88, v89, 0x41200000, v88
    v_cvt_pk_bf16_f32 v52, v77, v85
    v_cvt_pk_bf16_f32 v56, v78, v86
    v_cvt_pk_bf16_f32 v64, v79, v87
    v_cvt_pk_bf16_f32 v68, v82, v90
    v_cvt_pk_bf16_f32 v72, v80, v88
    v_lshlrev_b32 v76, 16, v49
    v_and_b32 v84, s25, v49
    v_lshlrev_b32 v77, 16, v53
    v_and_b32 v85, s25, v53
    v_lshlrev_b32 v78, 16, v57
    v_and_b32 v86, s25, v57
    v_lshlrev_b32 v79, 16, v61
    v_and_b32 v87, s25, v61
    v_add_f32 v80, v76, v78
    v_add_f32 v88, v84, v86
    v_add_f32 v81, v77, v79
    v_add_f32 v89, v85, v87
    v_fma_f32 v82, v78, 4.0, v76
    v_fma_f32 v90, v86, 4.0, v84
    v_fma_f32 v83, v79, 4.0, v77
    v_fma_f32 v91, v87, 4.0, v85
    v_add_f32 v77, v80, v81
    v_add_f32 v85, v88, v89
    v_sub_f32 v78, v80, v81
    v_sub_f32 v86, v88, v89
    v_fma_f32 v79, v83, 2.0, v82
    v_fma_f32 v87, v91, 2.0, v90
    v_fma_f32 v82, v83, -2.0, v82
    v_fma_f32 v90, v91, -2.0, v90
    v_fmamk_f32 v80, v76, 0x41700000, v82
    v_fmamk_f32 v88, v84, 0x41700000, v90
    v_fmamk_f32 v80, v81, 0x41200000, v80
    v_fmamk_f32 v88, v89, 0x41200000, v88
    v_cvt_pk_bf16_f32 v53, v77, v85
    v_cvt_pk_bf16_f32 v57, v78, v86
    v_cvt_pk_bf16_f32 v65, v79, v87
    v_cvt_pk_bf16_f32 v69, v82, v90
    v_cvt_pk_bf16_f32 v73, v80, v88
    v_lshlrev_b32 v76, 16, v50
    v_and_b32 v84, s25, v50
    v_lshlrev_b32 v77, 16, v54
    v_and_b32 v85, s25, v54
    v_lshlrev_b32 v78, 16, v58
    v_and_b32 v86, s25, v58
    v_lshlrev_b32 v79, 16, v62
    v_and_b32 v87, s25, v62
    v_add_f32 v80, v76, v78
    v_add_f32 v88, v84, v86
    v_add_f32 v81, v77, v79
    v_add_f32 v89, v85, v87
    v_fma_f32 v82, v78, 4.0, v76
    v_fma_f32 v90, v86, 4.0, v84
    v_fma_f32 v83, v79, 4.0, v77
    v_fma_f32 v91, v87, 4.0, v85
    v_add_f32 v77, v80, v81
    v_add_f32 v85, v88, v89
    v_sub_f32 v78, v80, v81
    v_sub_f32 v86, v88, v89
    v_fma_f32 v79, v83, 2.0, v82
    v_fma_f32 v87, v91, 2.0, v90
    v_fma_f32 v82, v83, -2.0, v82
    v_fma_f32 v90, v91, -2.0, v90
    v_fmamk_f32 v80, v76, 0x41700000, v82
    v_fmamk_f32 v88, v84, 0x41700000, v90
    v_fmamk_f32 v80, v81, 0x41200000, v80
    v_fmamk_f32 v88, v89, 0x41200000, v88
    v_cvt_pk_bf16_f32 v54, v77, v85
    v_cvt_pk_bf16_f32 v58, v78, v86
    v_cvt_pk_bf16_f32 v66, v79, v87
    v_cvt_pk_bf16_f32 v70, v82, v90
    v_cvt_pk_bf16_f32 v74, v80, v88
    v_lshlrev_b32 v76, 16, v51
    v_and_b32 v84, s25, v51
    v_lshlrev_b32 v77, 16, v55
    v_and_b32 v85, s25, v55
    v_lshlrev_b32 v78, 16, v59
    v_and_b32 v86, s25, v59
    v_lshlrev_b32 v79, 16, v63
    v_and_b32 v87, s25, v63
    v_add_f32 v80, v76, v78
    v_add_f32 v88, v84, v86
    v_add_f32 v81, v77, v79
    v_add_f32 v89, v85, v87
    v_fma_f32 v82, v78, 4.0, v76
    v_fma_f32 v90, v86, 4.0, v84
    v_fma_f32 v83, v79, 4.0, v77
    v_fma_f32 v91, v87, 4.0, v85
    v_add_f32 v77, v80, v81
    v_add_f32 v85, v88, v89
    v_sub_f32 v78, v80, v81
    v_sub_f32 v86, v88, v89
    v_fma_f32 v79, v83, 2.0, v82
    v_fma_f32 v87, v91, 2.0, v90
    v_fma_f32 v82, v83, -2.0, v82
    v_fma_f32 v90, v91, -2.0, v90
    v_fmamk_f32 v80, v76, 0x41700000, v82
    v_fmamk_f32 v88, v84, 0x41700000, v90
    v_fmamk_f32 v80, v81, 0x41200000, v80
    v_fmamk_f32 v88, v89, 0x41200000, v88
    v_cvt_pk_bf16_f32 v55, v77, v85
    v_cvt_pk_bf16_f32 v59, v78, v86
    v_cvt_pk_bf16_f32 v67, v79, v87
    v_cvt_pk_bf16_f32 v71, v82, v90
    v_cvt_pk_bf16_f32 v75, v80, v88
    s_add_u32 s28, s28, 1
    s_waitcnt lgkmcnt(0)
    s_barrier
    s_cmp_eq_u32 s22, 1
    s_cbranch_scc1 L_conv2_kernel_hlast2
    s_cmp_lt_u32 s28, 4
    s_cselect_b32 s24, 0, 2130706432
    ds_write_b128 v96, v[64:67] offset:57344
    ds_write_b128 v97, v[68:71] offset:8192
    ds_write_b128 v97, v[72:75] offset:24576
    ds_write_b128 v96, v[48:51] offset:8192
    ds_write_b128 v96, v[52:55] offset:24576
    ds_write_b128 v96, v[56:59] offset:40960
    ds_write_b128 v98, v[60:63] offset:8704
    s_waitcnt vmcnt(0)
    v_lshlrev_b32 v76, 16, v0
    v_and_b32 v84, s25, v0
    v_lshlrev_b32 v77, 16, v4
    v_and_b32 v85, s25, v4
    v_lshlrev_b32 v78, 16, v8
    v_and_b32 v86, s25, v8
    v_lshlrev_b32 v79, 16, v12
    v_and_b32 v87, s25, v12
    v_add_f32 v80, v76, v78
    v_add_f32 v88, v84, v86
    v_add_f32 v81, v77, v79
    v_add_f32 v89, v85, v87
    v_fma_f32 v82, v78, 4.0, v76
    v_fma_f32 v90, v86, 4.0, v84
    v_fma_f32 v83, v79, 4.0, v77
    v_fma_f32 v91, v87, 4.0, v85
    v_add_f32 v77, v80, v81
    v_add_f32 v85, v88, v89
    v_sub_f32 v78, v80, v81
    v_sub_f32 v86, v88, v89
    v_fma_f32 v79, v83, 2.0, v82
    v_fma_f32 v87, v91, 2.0, v90
    v_fma_f32 v82, v83, -2.0, v82
    v_fma_f32 v90, v91, -2.0, v90
    v_fmamk_f32 v80, v76, 0x41700000, v82
    v_fmamk_f32 v88, v84, 0x41700000, v90
    buffer_load_dwordx4 v[32:35], v92, s[8:11], s24 offen offset:0
    buffer_load_dwordx4 v[48:51], v92, s[8:11], s24 offen offset:64
    v_add_u32 v92, 128, v92
    v_fmamk_f32 v80, v81, 0x41200000, v80
    v_fmamk_f32 v88, v89, 0x41200000, v88
    v_cvt_pk_bf16_f32 v4, v77, v85
    v_cvt_pk_bf16_f32 v8, v78, v86
    v_cvt_pk_bf16_f32 v64, v79, v87
    v_cvt_pk_bf16_f32 v68, v82, v90
    v_cvt_pk_bf16_f32 v72, v80, v88
    v_lshlrev_b32 v76, 16, v1
    v_and_b32 v84, s25, v1
    v_lshlrev_b32 v77, 16, v5
    v_and_b32 v85, s25, v5
    v_lshlrev_b32 v78, 16, v9
    v_and_b32 v86, s25, v9
    v_lshlrev_b32 v79, 16, v13
    v_and_b32 v87, s25, v13
    v_add_f32 v80, v76, v78
    v_add_f32 v88, v84, v86
    v_add_f32 v81, v77, v79
    v_add_f32 v89, v85, v87
    v_fma_f32 v82, v78, 4.0, v76
    v_fma_f32 v90, v86, 4.0, v84
    v_fma_f32 v83, v79, 4.0, v77
    v_fma_f32 v91, v87, 4.0, v85
    v_add_f32 v77, v80, v81
    v_add_f32 v85, v88, v89
    v_sub_f32 v78, v80, v81
    v_sub_f32 v86, v88, v89
    v_fma_f32 v79, v83, 2.0, v82
    v_fma_f32 v87, v91, 2.0, v90
    v_fma_f32 v82, v83, -2.0, v82
    v_fma_f32 v90, v91, -2.0, v90
    v_fmamk_f32 v80, v76, 0x41700000, v82
    v_fmamk_f32 v88, v84, 0x41700000, v90
    v_fmamk_f32 v80, v81, 0x41200000, v80
    v_fmamk_f32 v88, v89, 0x41200000, v88
    v_cvt_pk_bf16_f32 v5, v77, v85
    v_cvt_pk_bf16_f32 v9, v78, v86
    v_cvt_pk_bf16_f32 v65, v79, v87
    v_cvt_pk_bf16_f32 v69, v82, v90
    v_cvt_pk_bf16_f32 v73, v80, v88
    v_lshlrev_b32 v76, 16, v2
    v_and_b32 v84, s25, v2
    v_lshlrev_b32 v77, 16, v6
    v_and_b32 v85, s25, v6
    v_lshlrev_b32 v78, 16, v10
    v_and_b32 v86, s25, v10
    v_lshlrev_b32 v79, 16, v14
    v_and_b32 v87, s25, v14
    v_add_f32 v80, v76, v78
    v_add_f32 v88, v84, v86
    v_add_f32 v81, v77, v79
    v_add_f32 v89, v85, v87
    v_fma_f32 v82, v78, 4.0, v76
    buffer_load_dwordx4 v[36:39], v93, s[8:11], s24 offen offset:0
    buffer_load_dwordx4 v[52:55], v93, s[8:11], s24 offen offset:64
    v_add_u32 v93, 128, v93
    v_fma_f32 v90, v86, 4.0, v84
    v_fma_f32 v83, v79, 4.0, v77
    v_fma_f32 v91, v87, 4.0, v85
    v_add_f32 v77, v80, v81
    v_add_f32 v85, v88, v89
    v_sub_f32 v78, v80, v81
    v_sub_f32 v86, v88, v89
    v_fma_f32 v79, v83, 2.0, v82
    v_fma_f32 v87, v91, 2.0, v90
    v_fma_f32 v82, v83, -2.0, v82
    v_fma_f32 v90, v91, -2.0, v90
    v_fmamk_f32 v80, v76, 0x41700000, v82
    v_fmamk_f32 v88, v84, 0x41700000, v90
    v_fmamk_f32 v80, v81, 0x41200000, v80
    v_fmamk_f32 v88, v89, 0x41200000, v88
    v_cvt_pk_bf16_f32 v6, v77, v85
    v_cvt_pk_bf16_f32 v10, v78, v86
    v_cvt_pk_bf16_f32 v66, v79, v87
    v_cvt_pk_bf16_f32 v70, v82, v90
    v_cvt_pk_bf16_f32 v74, v80, v88
    v_lshlrev_b32 v76, 16, v3
    v_and_b32 v84, s25, v3
    v_lshlrev_b32 v77, 16, v7
    v_and_b32 v85, s25, v7
    v_lshlrev_b32 v78, 16, v11
    v_and_b32 v86, s25, v11
    v_lshlrev_b32 v79, 16, v15
    v_and_b32 v87, s25, v15
    v_add_f32 v80, v76, v78
    v_add_f32 v88, v84, v86
    v_add_f32 v81, v77, v79
    v_add_f32 v89, v85, v87
    v_fma_f32 v82, v78, 4.0, v76
    v_fma_f32 v90, v86, 4.0, v84
    v_fma_f32 v83, v79, 4.0, v77
    v_fma_f32 v91, v87, 4.0, v85
    v_add_f32 v77, v80, v81
    v_add_f32 v85, v88, v89
    v_sub_f32 v78, v80, v81
    v_sub_f32 v86, v88, v89
    v_fma_f32 v79, v83, 2.0, v82
    v_fma_f32 v87, v91, 2.0, v90
    v_fma_f32 v82, v83, -2.0, v82
    v_fma_f32 v90, v91, -2.0, v90
    v_fmamk_f32 v80, v76, 0x41700000, v82
    v_fmamk_f32 v88, v84, 0x41700000, v90
    v_fmamk_f32 v80, v81, 0x41200000, v80
    v_fmamk_f32 v88, v89, 0x41200000, v88
    v_cvt_pk_bf16_f32 v7, v77, v85
    v_cvt_pk_bf16_f32 v11, v78, v86
    v_cvt_pk_bf16_f32 v67, v79, v87
    v_cvt_pk_bf16_f32 v71, v82, v90
    v_cvt_pk_bf16_f32 v75, v80, v88
    s_add_u32 s28, s28, 1
    s_waitcnt lgkmcnt(0)
    s_barrier
    s_cmp_lt_u32 s28, 4
    s_cselect_b32 s24, 0, 2130706432
    ds_write_b128 v96, v[64:67] offset:49152
    ds_write_b128 v97, v[68:71] offset:0
    ds_write_b128 v97, v[72:75] offset:16384
    ds_write_b128 v96, v[0:3] offset:0
    ds_write_b128 v96, v[4:7] offset:16384
    ds_write_b128 v96, v[8:11] offset:32768
    ds_write_b128 v98, v[12:15] offset:0
    v_lshlrev_b32 v76, 16, v16
    v_and_b32 v84, s25, v16
    buffer_load_dwordx4 v[40:43], v94, s[8:11], s24 offen offset:0
    buffer_load_dwordx4 v[56:59], v94, s[8:11], s24 offen offset:64
    v_add_u32 v94, 128, v94
    v_lshlrev_b32 v77, 16, v20
    v_and_b32 v85, s25, v20
    v_lshlrev_b32 v78, 16, v24
    v_and_b32 v86, s25, v24
    v_lshlrev_b32 v79, 16, v28
    v_and_b32 v87, s25, v28
    v_add_f32 v80, v76, v78
    v_add_f32 v88, v84, v86
    v_add_f32 v81, v77, v79
    v_add_f32 v89, v85, v87
    v_fma_f32 v82, v78, 4.0, v76
    v_fma_f32 v90, v86, 4.0, v84
    v_fma_f32 v83, v79, 4.0, v77
    v_fma_f32 v91, v87, 4.0, v85
    v_add_f32 v77, v80, v81
    v_add_f32 v85, v88, v89
    v_sub_f32 v78, v80, v81
    buffer_load_dwordx4 v[44:47], v95, s[8:11], s24 offen offset:0
    buffer_load_dwordx4 v[60:63], v95, s[8:11], s24 offen offset:64
    v_add_u32 v95, 128, v95
    v_sub_f32 v86, v88, v89
    v_fma_f32 v79, v83, 2.0, v82
    v_fma_f32 v87, v91, 2.0, v90
    v_fma_f32 v82, v83, -2.0, v82
    v_fma_f32 v90, v91, -2.0, v90
    v_fmamk_f32 v80, v76, 0x41700000, v82
    v_fmamk_f32 v88, v84, 0x41700000, v90
    v_fmamk_f32 v80, v81, 0x41200000, v80
    v_fmamk_f32 v88, v89, 0x41200000, v88
    v_cvt_pk_bf16_f32 v20, v77, v85
    v_cvt_pk_bf16_f32 v24, v78, v86
    v_cvt_pk_bf16_f32 v64, v79, v87
    v_cvt_pk_bf16_f32 v68, v82, v90
    v_cvt_pk_bf16_f32 v72, v80, v88
    v_lshlrev_b32 v76, 16, v17
    v_and_b32 v84, s25, v17
    v_lshlrev_b32 v77, 16, v21
    v_and_b32 v85, s25, v21
    v_lshlrev_b32 v78, 16, v25
    v_and_b32 v86, s25, v25
    v_lshlrev_b32 v79, 16, v29
    v_and_b32 v87, s25, v29
    v_add_f32 v80, v76, v78
    v_add_f32 v88, v84, v86
    v_add_f32 v81, v77, v79
    v_add_f32 v89, v85, v87
    v_fma_f32 v82, v78, 4.0, v76
    v_fma_f32 v90, v86, 4.0, v84
    v_fma_f32 v83, v79, 4.0, v77
    v_fma_f32 v91, v87, 4.0, v85
    v_add_f32 v77, v80, v81
    v_add_f32 v85, v88, v89
    v_sub_f32 v78, v80, v81
    v_sub_f32 v86, v88, v89
    v_fma_f32 v79, v83, 2.0, v82
    v_fma_f32 v87, v91, 2.0, v90
    v_fma_f32 v82, v83, -2.0, v82
    v_fma_f32 v90, v91, -2.0, v90
    v_fmamk_f32 v80, v76, 0x41700000, v82
    v_fmamk_f32 v88, v84, 0x41700000, v90
    v_fmamk_f32 v80, v81, 0x41200000, v80
    v_fmamk_f32 v88, v89, 0x41200000, v88
    v_cvt_pk_bf16_f32 v21, v77, v85
    v_cvt_pk_bf16_f32 v25, v78, v86
    v_cvt_pk_bf16_f32 v65, v79, v87
    v_cvt_pk_bf16_f32 v69, v82, v90
    v_cvt_pk_bf16_f32 v73, v80, v88
    v_lshlrev_b32 v76, 16, v18
    v_and_b32 v84, s25, v18
    v_lshlrev_b32 v77, 16, v22
    v_and_b32 v85, s25, v22
    v_lshlrev_b32 v78, 16, v26
    v_and_b32 v86, s25, v26
    v_lshlrev_b32 v79, 16, v30
    v_and_b32 v87, s25, v30
    v_add_f32 v80, v76, v78
    v_add_f32 v88, v84, v86
    v_add_f32 v81, v77, v79
    v_add_f32 v89, v85, v87
    v_fma_f32 v82, v78, 4.0, v76
    v_fma_f32 v90, v86, 4.0, v84
    v_fma_f32 v83, v79, 4.0, v77
    v_fma_f32 v91, v87, 4.0, v85
    v_add_f32 v77, v80, v81
    v_add_f32 v85, v88, v89
    v_sub_f32 v78, v80, v81
    v_sub_f32 v86, v88, v89
    v_fma_f32 v79, v83, 2.0, v82
    v_fma_f32 v87, v91, 2.0, v90
    v_fma_f32 v82, v83, -2.0, v82
    v_fma_f32 v90, v91, -2.0, v90
    v_fmamk_f32 v80, v76, 0x41700000, v82
    v_fmamk_f32 v88, v84, 0x41700000, v90
    v_fmamk_f32 v80, v81, 0x41200000, v80
    v_fmamk_f32 v88, v89, 0x41200000, v88
    v_cvt_pk_bf16_f32 v22, v77, v85
    v_cvt_pk_bf16_f32 v26, v78, v86
    v_cvt_pk_bf16_f32 v66, v79, v87
    v_cvt_pk_bf16_f32 v70, v82, v90
    v_cvt_pk_bf16_f32 v74, v80, v88
    v_lshlrev_b32 v76, 16, v19
    v_and_b32 v84, s25, v19
    v_lshlrev_b32 v77, 16, v23
    v_and_b32 v85, s25, v23
    v_lshlrev_b32 v78, 16, v27
    v_and_b32 v86, s25, v27
    v_lshlrev_b32 v79, 16, v31
    v_and_b32 v87, s25, v31
    v_add_f32 v80, v76, v78
    v_add_f32 v88, v84, v86
    v_add_f32 v81, v77, v79
    v_add_f32 v89, v85, v87
    v_fma_f32 v82, v78, 4.0, v76
    v_fma_f32 v90, v86, 4.0, v84
    v_fma_f32 v83, v79, 4.0, v77
    v_fma_f32 v91, v87, 4.0, v85
    v_add_f32 v77, v80, v81
    v_add_f32 v85, v88, v89
    v_sub_f32 v78, v80, v81
    v_sub_f32 v86, v88, v89
    v_fma_f32 v79, v83, 2.0, v82
    v_fma_f32 v87, v91, 2.0, v90
    v_fma_f32 v82, v83, -2.0, v82
    v_fma_f32 v90, v91, -2.0, v90
    v_fmamk_f32 v80, v76, 0x41700000, v82
    v_fmamk_f32 v88, v84, 0x41700000, v90
    v_fmamk_f32 v80, v81, 0x41200000, v80
    v_fmamk_f32 v88, v89, 0x41200000, v88
    v_cvt_pk_bf16_f32 v23, v77, v85
    v_cvt_pk_bf16_f32 v27, v78, v86
    v_cvt_pk_bf16_f32 v67, v79, v87
    v_cvt_pk_bf16_f32 v71, v82, v90
    v_cvt_pk_bf16_f32 v75, v80, v88
    s_add_u32 s28, s28, 1
    s_waitcnt lgkmcnt(0)
    s_barrier
    s_sub_u32 s22, s22, 1
    s_branch L_conv2_kernel_hloop2
L_conv2_kernel_hlast2:
    s_mov_b32 s25, 0xffff0000
    ds_write_b128 v96, v[64:67] offset:57344
    ds_write_b128 v97, v[68:71] offset:8192
    ds_write_b128 v97, v[72:75] offset:24576
    ds_write_b128 v96, v[48:51] offset:8192
    ds_write_b128 v96, v[52:55] offset:24576
    ds_write_b128 v96, v[56:59] offset:40960
    ds_write_b128 v98, v[60:63] offset:8704
    s_waitcnt lgkmcnt(0)
    s_barrier
    s_branch L_conv2_kernel_end
L_conv2_kernel_epi:
    v_and_b32 v108, 15, v127
    v_lshrrev_b32 v109, 4, v127
    v_lshrrev_b32 v110, 3, v108
    s_lshl_b32 s36, s20, 1
    v_add_u32 v110, s36, v110
    v_xor_b32 v111, v110, v108
    v_and_b32 v111, 7, v111
    v_lshlrev_b32 v111, 4, v111
    v_lshl_add_u32 v111, v110, 7, v111
    v_lshl_add_u32 v120, v109, 11, v111
    v_add_u32 v121, 65536, v120
    v_add_u32 v125, 131072, v120
    s_lshl_b32 s36, s20, 9
    s_add_u32 s36, s36, 115712
    v_lshl_add_u32 v123, v109, 7, s36
    s_lshl_b32 s36, s20, 4
    v_add_u32 v108, s36, v108
    v_lshl_add_u32 v110, v108, 2, s21
    v_lshlrev_b32 v110, 9, v110
    v_lshl_add_u32 v110, v109, 4, v110
    s_lshl_b32 s36, s29, 6
    v_add_u32 v110, s36, v110
    v_mov_b32 v111, 2130706432
    v_cmp_gt_u32 vcc, 125, v108
    s_mov_b32 s4, 0xbeaaaaab
    s_mov_b32 s5, s4
    s_mov_b32 s6, 0x3e800000
    s_mov_b32 s7, s6
    s_mov_b32 s8, 0xc0a00000
    s_mov_b32 s9, s8
    s_mov_b32 s10, 0xc0638e39
    s_mov_b32 s11, s10
    s_mov_b32 s12, 0xbf638e39
    s_mov_b32 s13, s12
    s_mov_b32 s14, 0xbe638e39
    s_mov_b32 s15, s14
    s_mov_b32 s22, 0xbd638e39
    s_mov_b32 s23, s22
    s_mov_b32 s24, 0x3ff1c71c
    s_mov_b32 s25, s24
    s_mov_b32 s26, 0xbf2aaaab
    s_mov_b32 s27, s26
    s_mov_b32 s32, 0x3ecccccd
    s_mov_b32 s33, s32
    s_mov_b32 s34, 0xbd888889
    s_mov_b32 s35, s34
    s_mov_b32 s38, 0xbe4ccccd
    s_mov_b32 s39, s38
    s_mov_b32 s40, 0xbdd2d3e8
    s_mov_b32 s41, s40
    s_mov_b32 s42, 0x3f800000
    s_mov_b32 s43, s42
    s_waitcnt lgkmcnt(0)
    s_barrier
    v_cndmask_b32 v122, v111, v110, vcc
    ds_read_b128 v[0:3], v120 offset:0
    ds_read_b128 v[4:7], v120 offset:16384
    ds_read_b128 v[8:11], v120 offset:32768
    ds_read_b128 v[12:15], v120 offset:49152
    ds_read_b128 v[16:19], v121 offset:0
    ds_read_b128 v[20:23], v121 offset:16384
    ds_read_b128 v[24:27], v121 offset:32768
    ds_read_b128 v[28:31], v125 offset:15360
    ds_read_b128 v[32:35], v120 offset:8192
    ds_read_b128 v[36:39], v120 offset:24576
    ds_read_b128 v[40:43], v120 offset:40960
    ds_read_b128 v[44:47], v120 offset:57344
    ds_read_b128 v[48:51], v121 offset:56320
    ds_read_b128 v[52:55], v121 offset:64512
    ds_read_b128 v[56:59], v125 offset:7168
    s_waitcnt lgkmcnt(7)
    ds_read_b128 v[60:63], v125 offset:23552
    s_waitcnt lgkmcnt(8)
    v_pk_add_f32 v[88:89], v[24:25], v[28:29]
    v_pk_add_f32 v[90:91], v[26:27], v[30:31]
    v_pk_add_f32 v[24:25], v[4:5], v[8:9]
    v_pk_add_f32 v[26:27], v[6:7], v[10:11]
    v_pk_add_f32 v[4:5], v[4:5], v[8:9] neg_lo:[0,1] neg_hi:[0,1]
    v_pk_add_f32 v[6:7], v[6:7], v[10:11] neg_lo:[0,1] neg_hi:[0,1]
    v_pk_add_f32 v[72:73], v[12:13], v[16:17]
    v_pk_add_f32 v[74:75], v[14:15], v[18:19]
    v_pk_add_f32 v[12:13], v[12:13], v[16:17] neg_lo:[0,1] neg_hi:[0,1]
    v_pk_add_f32 v[14:15], v[14:15], v[18:19] neg_lo:[0,1] neg_hi:[0,1]
    v_pk_fma_f32 v[72:73], v[24:25], s[4:5], v[72:73]
    v_pk_fma_f32 v[74:75], v[26:27], s[4:5], v[74:75]
    v_pk_fma_f32 v[20:21], v[0:1], s[10:11], v[20:21]
    v_pk_fma_f32 v[22:23], v[2:3], s[10:11], v[22:23]
    v_pk_fma_f32 v[72:73], v[0:1], s[6:7], v[72:73]
    v_pk_fma_f32 v[74:75], v[2:3], s[6:7], v[74:75]
    v_pk_add_f32 v[24:25], v[24:25], v[0:1] neg_lo:[0,1] neg_hi:[0,1]
    v_pk_add_f32 v[26:27], v[26:27], v[2:3] neg_lo:[0,1] neg_hi:[0,1]
    v_pk_fma_f32 v[72:73], v[88:89], s[8:9], v[72:73]
    v_pk_fma_f32 v[74:75], v[90:91], s[8:9], v[74:75]
    v_pk_add_f32 v[24:25], v[24:25], v[88:89] neg_lo:[0,1] neg_hi:[0,1]
    v_pk_add_f32 v[26:27], v[26:27], v[90:91] neg_lo:[0,1] neg_hi:[0,1]
    v_pk_fma_f32 v[20:21], v[88:89], s[22:23], v[20:21]
    v_pk_fma_f32 v[22:23], v[90:91], s[22:23], v[22:23]
    v_pk_add_f32 v[8:9], v[24:25], v[72:73] neg_lo:[0,1] neg_hi:[0,1]
    v_pk_add_f32 v[10:11], v[26:27], v[74:75] neg_lo:[0,1] neg_hi:[0,1]
    v_pk_fma_f32 v[20:21], v[72:73], s[14:15], v[20:21]
    v_pk_fma_f32 v[22:23], v[74:75], s[14:15], v[22:23]
    v_pk_mul_f32 v[80:81], v[12:13], s[32:33]
    v_pk_mul_f32 v[82:83], v[14:15], s[32:33]
    v_pk_fma_f32 v[20:21], v[8:9], s[12:13], v[20:21]
    v_pk_fma_f32 v[22:23], v[10:11], s[12:13], v[22:23]
    v_pk_fma_f32 v[80:81], v[4:5], s[34:35], v[80:81]
    v_pk_fma_f32 v[82:83], v[6:7], s[34:35], v[82:83]
    v_pk_fma_f32 v[64:65], v[4:5], s[24:25], v[20:21] neg_lo:[0,0,1] neg_hi:[0,0,1]
    v_pk_fma_f32 v[66:67], v[6:7], s[24:25], v[22:23] neg_lo:[0,0,1] neg_hi:[0,0,1]
    v_pk_fma_f32 v[64:65], v[12:13], s[26:27], v[64:65]
    v_pk_fma_f32 v[66:67], v[14:15], s[26:27], v[66:67]
    v_pk_fma_f32 v[80:81], v[64:65], s[38:39], v[80:81]
    v_pk_fma_f32 v[82:83], v[66:67], s[38:39], v[82:83]
    v_pk_add_f32 v[4:5], v[4:5], v[64:65] neg_lo:[0,1] neg_hi:[0,1]
    v_pk_add_f32 v[6:7], v[6:7], v[66:67] neg_lo:[0,1] neg_hi:[0,1]
    v_pk_add_f32 v[4:5], v[4:5], v[80:81] neg_lo:[0,1] neg_hi:[0,1]
    v_pk_add_f32 v[6:7], v[6:7], v[82:83] neg_lo:[0,1] neg_hi:[0,1]
    s_waitcnt lgkmcnt(0)
    v_pk_add_f32 v[92:93], v[56:57], v[60:61]
    v_pk_add_f32 v[94:95], v[58:59], v[62:63]
    v_pk_add_f32 v[56:57], v[36:37], v[40:41]
    v_pk_add_f32 v[58:59], v[38:39], v[42:43]
    v_pk_add_f32 v[36:37], v[36:37], v[40:41] neg_lo:[0,1] neg_hi:[0,1]
    v_pk_add_f32 v[38:39], v[38:39], v[42:43] neg_lo:[0,1] neg_hi:[0,1]
    v_pk_add_f32 v[76:77], v[44:45], v[48:49]
    v_pk_add_f32 v[78:79], v[46:47], v[50:51]
    v_pk_add_f32 v[44:45], v[44:45], v[48:49] neg_lo:[0,1] neg_hi:[0,1]
    v_pk_add_f32 v[46:47], v[46:47], v[50:51] neg_lo:[0,1] neg_hi:[0,1]
    v_pk_fma_f32 v[76:77], v[56:57], s[4:5], v[76:77]
    v_pk_fma_f32 v[78:79], v[58:59], s[4:5], v[78:79]
    v_pk_fma_f32 v[52:53], v[32:33], s[10:11], v[52:53]
    v_pk_fma_f32 v[54:55], v[34:35], s[10:11], v[54:55]
    v_pk_fma_f32 v[76:77], v[32:33], s[6:7], v[76:77]
    v_pk_fma_f32 v[78:79], v[34:35], s[6:7], v[78:79]
    v_pk_add_f32 v[56:57], v[56:57], v[32:33] neg_lo:[0,1] neg_hi:[0,1]
    v_pk_add_f32 v[58:59], v[58:59], v[34:35] neg_lo:[0,1] neg_hi:[0,1]
    v_pk_fma_f32 v[76:77], v[92:93], s[8:9], v[76:77]
    v_pk_fma_f32 v[78:79], v[94:95], s[8:9], v[78:79]
    v_pk_add_f32 v[56:57], v[56:57], v[92:93] neg_lo:[0,1] neg_hi:[0,1]
    v_pk_add_f32 v[58:59], v[58:59], v[94:95] neg_lo:[0,1] neg_hi:[0,1]
    v_pk_fma_f32 v[52:53], v[92:93], s[22:23], v[52:53]
    v_pk_fma_f32 v[54:55], v[94:95], s[22:23], v[54:55]
    v_pk_add_f32 v[40:41], v[56:57], v[76:77] neg_lo:[0,1] neg_hi:[0,1]
    v_pk_add_f32 v[42:43], v[58:59], v[78:79] neg_lo:[0,1] neg_hi:[0,1]
    v_pk_fma_f32 v[52:53], v[76:77], s[14:15], v[52:53]
    v_pk_fma_f32 v[54:55], v[78:79], s[14:15], v[54:55]
    v_pk_mul_f32 v[84:85], v[44:45], s[32:33]
    v_pk_mul_f32 v[86:87], v[46:47], s[32:33]
    v_pk_fma_f32 v[52:53], v[40:41], s[12:13], v[52:53]
    v_pk_fma_f32 v[54:55], v[42:43], s[12:13], v[54:55]
    v_pk_fma_f32 v[84:85], v[36:37], s[34:35], v[84:85]
    v_pk_fma_f32 v[86:87], v[38:39], s[34:35], v[86:87]
    v_pk_fma_f32 v[68:69], v[36:37], s[24:25], v[52:53] neg_lo:[0,0,1] neg_hi:[0,0,1]
    v_pk_fma_f32 v[70:71], v[38:39], s[24:25], v[54:55] neg_lo:[0,0,1] neg_hi:[0,0,1]
    v_pk_fma_f32 v[68:69], v[44:45], s[26:27], v[68:69]
    v_pk_fma_f32 v[70:71], v[46:47], s[26:27], v[70:71]
    v_pk_fma_f32 v[84:85], v[68:69], s[38:39], v[84:85]
    v_pk_fma_f32 v[86:87], v[70:71], s[38:39], v[86:87]
    v_pk_add_f32 v[36:37], v[36:37], v[68:69] neg_lo:[0,1] neg_hi:[0,1]
    v_pk_add_f32 v[38:39], v[38:39], v[70:71] neg_lo:[0,1] neg_hi:[0,1]
    v_pk_add_f32 v[36:37], v[36:37], v[84:85] neg_lo:[0,1] neg_hi:[0,1]
    v_pk_add_f32 v[38:39], v[38:39], v[86:87] neg_lo:[0,1] neg_hi:[0,1]
    s_mov_b32 s36, 0x00010001
    s_mov_b32 s37, 0x00010001
    s_mov_b64 exec, s[36:37]
    ds_write_b128 v123, v[0:3] offset:0
    ds_write_b128 v123, v[32:35] offset:16
    ds_write_b128 v123, v[4:7] offset:32
    ds_write_b128 v123, v[36:39] offset:48
    ds_write_b128 v123, v[8:11] offset:64
    ds_write_b128 v123, v[40:43] offset:80
    s_mov_b64 exec, -1
    v_mov_b32 v44, 0xc0135761
    v_mov_b32 v45, v44
    v_cvt_pk_bf16_f32 v48, v64, v68
    v_cvt_pk_bf16_f32 v49, v65, v69
    v_cvt_pk_bf16_f32 v50, v66, v70
    v_cvt_pk_bf16_f32 v51, v67, v71
    buffer_store_dwordx4 v[48:51], v122, s[16:19], 0 offen offset:0 sc1
    s_waitcnt lgkmcnt(0)
    s_barrier
    ds_read_b128 v[96:99], v123 offset:512
    ds_read_b128 v[100:103], v123 offset:528
    ds_read_b128 v[104:107], v123 offset:544
    ds_read_b128 v[108:111], v123 offset:560
    ds_read_b128 v[112:115], v123 offset:576
    ds_read_b128 v[116:119], v123 offset:592
    s_waitcnt lgkmcnt(4)
    v_mov_b32_dpp v96, v0 row_shl:1 row_mask:0xf bank_mask:0xf
    v_mov_b32_dpp v97, v1 row_shl:1 row_mask:0xf bank_mask:0xf
    v_mov_b32_dpp v98, v2 row_shl:1 row_mask:0xf bank_mask:0xf
    v_mov_b32_dpp v99, v3 row_shl:1 row_mask:0xf bank_mask:0xf
    v_mov_b32_dpp v100, v32 row_shl:1 row_mask:0xf bank_mask:0xf
    v_mov_b32_dpp v101, v33 row_shl:1 row_mask:0xf bank_mask:0xf
    v_mov_b32_dpp v102, v34 row_shl:1 row_mask:0xf bank_mask:0xf
    v_mov_b32_dpp v103, v35 row_shl:1 row_mask:0xf bank_mask:0xf
    v_pk_add_f32 v[72:73], v[72:73], v[96:97]
    v_pk_add_f32 v[74:75], v[74:75], v[98:99]
    v_pk_add_f32 v[76:77], v[76:77], v[100:101]
    v_pk_add_f32 v[78:79], v[78:79], v[102:103]
    v_cvt_pk_bf16_f32 v52, v72, v76
    v_cvt_pk_bf16_f32 v53, v73, v77
    v_cvt_pk_bf16_f32 v54, v74, v78
    v_cvt_pk_bf16_f32 v55, v75, v79
    buffer_store_dwordx4 v[52:55], v122, s[16:19], 0 offen offset:512 sc1
    s_waitcnt lgkmcnt(2)
    v_mov_b32_dpp v104, v4 row_shl:1 row_mask:0xf bank_mask:0xf
    v_mov_b32_dpp v105, v5 row_shl:1 row_mask:0xf bank_mask:0xf
    v_mov_b32_dpp v106, v6 row_shl:1 row_mask:0xf bank_mask:0xf
    v_mov_b32_dpp v107, v7 row_shl:1 row_mask:0xf bank_mask:0xf
    v_mov_b32_dpp v108, v36 row_shl:1 row_mask:0xf bank_mask:0xf
    v_mov_b32_dpp v109, v37 row_shl:1 row_mask:0xf bank_mask:0xf
    v_mov_b32_dpp v110, v38 row_shl:1 row_mask:0xf bank_mask:0xf
    v_mov_b32_dpp v111, v39 row_shl:1 row_mask:0xf bank_mask:0xf
    v_pk_add_f32 v[80:81], v[80:81], v[104:105]
    v_pk_add_f32 v[82:83], v[82:83], v[106:107]
    v_pk_add_f32 v[84:85], v[84:85], v[108:109]
    v_pk_add_f32 v[86:87], v[86:87], v[110:111]
    v_cvt_pk_bf16_f32 v56, v80, v84
    v_cvt_pk_bf16_f32 v57, v81, v85
    v_cvt_pk_bf16_f32 v58, v82, v86
    v_cvt_pk_bf16_f32 v59, v83, v87
    buffer_store_dwordx4 v[56:59], v122, s[16:19], 0 offen offset:1024 sc1
    s_waitcnt lgkmcnt(0)
    v_mov_b32_dpp v112, v8 row_shl:1 row_mask:0xf bank_mask:0xf
    v_mov_b32_dpp v113, v9 row_shl:1 row_mask:0xf bank_mask:0xf
    v_mov_b32_dpp v114, v10 row_shl:1 row_mask:0xf bank_mask:0xf
    v_mov_b32_dpp v115, v11 row_shl:1 row_mask:0xf bank_mask:0xf
    v_mov_b32_dpp v116, v40 row_shl:1 row_mask:0xf bank_mask:0xf
    v_mov_b32_dpp v117, v41 row_shl:1 row_mask:0xf bank_mask:0xf
    v_mov_b32_dpp v118, v42 row_shl:1 row_mask:0xf bank_mask:0xf
    v_mov_b32_dpp v119, v43 row_shl:1 row_mask:0xf bank_mask:0xf
    v_pk_add_f32 v[88:89], v[88:89], v[112:113]
    v_pk_add_f32 v[90:91], v[90:91], v[114:115]
    v_pk_add_f32 v[92:93], v[92:93], v[116:117]
    v_pk_add_f32 v[94:95], v[94:95], v[118:119]
    v_cvt_pk_bf16_f32 v60, v88, v92
    v_cvt_pk_bf16_f32 v61, v89, v93
    v_cvt_pk_bf16_f32 v62, v90, v94
    v_cvt_pk_bf16_f32 v63, v91, v95
    buffer_store_dwordx4 v[60:63], v122, s[16:19], 0 offen offset:1536 sc1
L_conv2_kernel_end:
L_conv2_kernel_done:
    s_endpgm
.globl joint_kernel
.p2align 8
.type joint_kernel,@function
joint_kernel:
    s_cmp_ge_u32 s2, 250
    s_cbranch_scc1 L_joint_kernel_done
    s_load_dwordx2 s[28:29], s[0:1], 56
    s_load_dwordx2 s[30:31], s[0:1], 72
    v_readfirstlane_b32 s20, v0
    s_lshr_b32 s20, s20, 6
    s_and_b32 s21, s20, 3
    v_and_b32 v255, 63, v0
    v_lshlrev_b32 v254, 4, v255
    s_cmp_ge_u32 s20, 4
    s_mov_b32 s33, 44171264
    s_cselect_b32 s33, 44040192, s33
    s_lshl_b32 s36, s21, 15
    s_add_u32 s33, s33, s36
    s_mov_b32 s14, 32768
    s_mov_b32 s15, 0x00020000
    s_lshl_b32 s35, s2, 14
    s_add_u32 s35, s35, 27262976
    s_mov_b32 s10, 8404992
    s_mov_b32 s11, 0x00020000
    s_waitcnt lgkmcnt(0)
    s_add_u32 s12, s30, s33
    s_addc_u32 s13, s31, 0
    s_cmp_ge_u32 s20, 4
    s_cbranch_scc1 L_joint_kernel_T
    s_add_u32 s8, s30, s35
    s_addc_u32 s9, s31, 0
    s_lshl_b32 s36, s20, 12
    s_add_u32 s37, s36, 8388608
    buffer_load_dwordx4 v[128:131], v254, s[8:11], s36 offen offset:0
    buffer_load_dwordx4 v[144:147], v254, s[8:11], s37 offen offset:0
    buffer_load_dwordx4 v[132:135], v254, s[8:11], s36 offen offset:1024
    buffer_load_dwordx4 v[148:151], v254, s[8:11], s37 offen offset:1024
    buffer_load_dwordx4 v[136:139], v254, s[8:11], s36 offen offset:2048
    buffer_load_dwordx4 v[152:155], v254, s[8:11], s37 offen offset:2048
    buffer_load_dwordx4 v[140:143], v254, s[8:11], s36 offen offset:3072
    buffer_load_dwordx4 v[156:159], v254, s[8:11], s37 offen offset:3072
    s_cmp_ge_u32 s2, 125
    s_cselect_b32 s34, 8192, 0
    s_add_u32 s34, s34, 44302336
    s_add_u32 s40, s30, s34
    s_addc_u32 s41, s31, 0
    s_mov_b32 s42, 24576
    s_mov_b32 s43, 0x00020000
    s_lshl_b32 s38, s20, 11
    s_add_u32 s38, s38, 16384
    buffer_load_dwordx4 v[192:195], v254, s[40:43], s38 offen offset:0
    buffer_load_dwordx4 v[196:199], v254, s[40:43], s38 offen offset:1024
    s_barrier
    s_lshl_b32 s35, s2, 17
    s_add_u32 s16, s28, s35
    s_addc_u32 s17, s29, 0
    s_mov_b32 s18, 131072
    s_mov_b32 s19, 0x00020000
    s_mov_b32 s44, 0xbdd2d3e8
    v_mov_b32 v253, 0xc0135761
    s_mul_i32 s36, s20, 4224
    v_lshrrev_b32 v252, 5, v255
    v_lshlrev_b32 v252, 4, v252
    v_add3_u32 v252, v252, v254, s36
    s_mov_b32 s45, 0xffff0000
    s_mov_b32 s46, s44
    s_mov_b32 s47, s44
    s_mov_b32 s48, 1.0
    s_mov_b32 s49, 1.0
    v_mov_b32 v248, v253
    v_mov_b32 v249, v253
    s_mov_b32 s22, 2
L_joint_kernel_floop:
    s_waitcnt vmcnt(8)
    v_lshlrev_b32 v168, 16, v128
    v_and_b32 v169, s45, v128
    v_lshlrev_b32 v232, 16, v144
    v_and_b32 v233, s45, v144
    v_lshlrev_b32 v170, 16, v129
    v_and_b32 v171, s45, v129
    v_lshlrev_b32 v234, 16, v145
    v_and_b32 v235, s45, v145
    v_lshlrev_b32 v172, 16, v130
    v_and_b32 v173, s45, v130
    v_lshlrev_b32 v236, 16, v146
    v_and_b32 v237, s45, v146
    v_lshlrev_b32 v174, 16, v131
    v_and_b32 v175, s45, v131
    v_lshlrev_b32 v238, 16, v147
    v_and_b32 v239, s45, v147
    v_pk_add_f32 v[168:169], v[168:169], v[232:233]
    v_pk_add_f32 v[170:171], v[170:171], v[234:235]
    v_pk_add_f32 v[172:173], v[172:173], v[236:237]
    v_pk_add_f32 v[174:175], v[174:175], v[238:239]
    v_pk_mul_f32 v[232:233], v[168:169], v[168:169]
    v_pk_mul_f32 v[234:235], v[170:171], v[170:171]
    v_pk_mul_f32 v[236:237], v[172:173], v[172:173]
    v_pk_mul_f32 v[238:239], v[174:175], v[174:175]
    v_pk_fma_f32 v[232:233], v[232:233], s[46:47], v[248:249]
    v_pk_fma_f32 v[234:235], v[234:235], s[46:47], v[248:249]
    v_pk_fma_f32 v[236:237], v[236:237], s[46:47], v[248:249]
    v_pk_fma_f32 v[238:239], v[238:239], s[46:47], v[248:249]
    v_pk_mul_f32 v[232:233], v[232:233], v[168:169]
    v_pk_mul_f32 v[234:235], v[234:235], v[170:171]
    v_pk_mul_f32 v[236:237], v[236:237], v[172:173]
    v_pk_mul_f32 v[238:239], v[238:239], v[174:175]
    v_exp_f32 v232, v232
    v_exp_f32 v233, v233
    v_exp_f32 v234, v234
    v_exp_f32 v235, v235
    v_exp_f32 v236, v236
    v_exp_f32 v237, v237
    v_exp_f32 v238, v238
    v_exp_f32 v239, v239
    v_pk_add_f32 v[232:233], v[232:233], s[48:49]
    v_pk_add_f32 v[234:235], v[234:235], s[48:49]
    v_pk_add_f32 v[236:237], v[236:237], s[48:49]
    v_pk_add_f32 v[238:239], v[238:239], s[48:49]
    v_rcp_f32 v232, v232
    v_rcp_f32 v233, v233
    v_rcp_f32 v234, v234
    v_rcp_f32 v235, v235
    v_rcp_f32 v236, v236
    v_rcp_f32 v237, v237
    v_rcp_f32 v238, v238
    v_rcp_f32 v239, v239
    v_pk_mul_f32 v[168:169], v[168:169], v[232:233]
    v_pk_mul_f32 v[170:171], v[170:171], v[234:235]
    v_pk_mul_f32 v[172:173], v[172:173], v[236:237]
    v_pk_mul_f32 v[174:175], v[174:175], v[238:239]
    v_cvt_pk_bf16_f32 v240, v168, v169
    v_cvt_pk_bf16_f32 v241, v170, v171
    v_cvt_pk_bf16_f32 v242, v172, v173
    v_cvt_pk_bf16_f32 v243, v174, v175
    ds_write_b128 v252, v[240:243] offset:32768
    s_waitcnt vmcnt(6)
    v_lshlrev_b32 v168, 16, v132
    v_and_b32 v169, s45, v132
    v_lshlrev_b32 v232, 16, v148
    v_and_b32 v233, s45, v148
    v_lshlrev_b32 v170, 16, v133
    v_and_b32 v171, s45, v133
    v_lshlrev_b32 v234, 16, v149
    v_and_b32 v235, s45, v149
    v_lshlrev_b32 v172, 16, v134
    v_and_b32 v173, s45, v134
    v_lshlrev_b32 v236, 16, v150
    v_and_b32 v237, s45, v150
    v_lshlrev_b32 v174, 16, v135
    v_and_b32 v175, s45, v135
    v_lshlrev_b32 v238, 16, v151
    v_and_b32 v239, s45, v151
    v_pk_add_f32 v[168:169], v[168:169], v[232:233]
    v_pk_add_f32 v[170:171], v[170:171], v[234:235]
    v_pk_add_f32 v[172:173], v[172:173], v[236:237]
    v_pk_add_f32 v[174:175], v[174:175], v[238:239]
    v_pk_mul_f32 v[232:233], v[168:169], v[168:169]
    v_pk_mul_f32 v[234:235], v[170:171], v[170:171]
    v_pk_mul_f32 v[236:237], v[172:173], v[172:173]
    v_pk_mul_f32 v[238:239], v[174:175], v[174:175]
    v_pk_fma_f32 v[232:233], v[232:233], s[46:47], v[248:249]
    v_pk_fma_f32 v[234:235], v[234:235], s[46:47], v[248:249]
    v_pk_fma_f32 v[236:237], v[236:237], s[46:47], v[248:249]
    v_pk_fma_f32 v[238:239], v[238:239], s[46:47], v[248:249]
    v_pk_mul_f32 v[232:233], v[232:233], v[168:169]
    v_pk_mul_f32 v[234:235], v[234:235], v[170:171]
    v_pk_mul_f32 v[236:237], v[236:237], v[172:173]
    v_pk_mul_f32 v[238:239], v[238:239], v[174:175]
    v_exp_f32 v232, v232
    v_exp_f32 v233, v233
    v_exp_f32 v234, v234
    v_exp_f32 v235, v235
    v_exp_f32 v236, v236
    v_exp_f32 v237, v237
    v_exp_f32 v238, v238
    v_exp_f32 v239, v239
    v_pk_add_f32 v[232:233], v[232:233], s[48:49]
    v_pk_add_f32 v[234:235], v[234:235], s[48:49]
    v_pk_add_f32 v[236:237], v[236:237], s[48:49]
    v_pk_add_f32 v[238:239], v[238:239], s[48:49]
    v_rcp_f32 v232, v232
    v_rcp_f32 v233, v233
    v_rcp_f32 v234, v234
    v_rcp_f32 v235, v235
    v_rcp_f32 v236, v236
    v_rcp_f32 v237, v237
    v_rcp_f32 v238, v238
    v_rcp_f32 v239, v239
    v_pk_mul_f32 v[168:169], v[168:169], v[232:233]
    v_pk_mul_f32 v[170:171], v[170:171], v[234:235]
    v_pk_mul_f32 v[172:173], v[172:173], v[236:237]
    v_pk_mul_f32 v[174:175], v[174:175], v[238:239]
    v_cvt_pk_bf16_f32 v244, v168, v169
    v_cvt_pk_bf16_f32 v245, v170, v171
    v_cvt_pk_bf16_f32 v246, v172, v173
    v_cvt_pk_bf16_f32 v247, v174, v175
    ds_write_b128 v252, v[244:247] offset:33824
    s_waitcnt vmcnt(0)
    v_pk_mov_b32 v[128:129], v[136:137], v[136:137] op_sel:[0,1]
    v_pk_mov_b32 v[144:145], v[152:153], v[152:153] op_sel:[0,1]
    v_pk_mov_b32 v[130:131], v[138:139], v[138:139] op_sel:[0,1]
    v_pk_mov_b32 v[146:147], v[154:155], v[154:155] op_sel:[0,1]
    v_pk_mov_b32 v[132:133], v[140:141], v[140:141] op_sel:[0,1]
    v_pk_mov_b32 v[148:149], v[156:157], v[156:157] op_sel:[0,1]
    v_pk_mov_b32 v[134:135], v[142:143], v[142:143] op_sel:[0,1]
    v_pk_mov_b32 v[150:151], v[158:159], v[158:159] op_sel:[0,1]
    v_add_u32 v252, 2112, v252
    s_sub_u32 s22, s22, 1
    s_cmp_lg_u32 s22, 0
    s_cbranch_scc1 L_joint_kernel_floop
    s_mul_i32 s36, s20, 2080
    s_add_u32 s36, s36, 88832
    v_add_u32 v251, s36, v254
    ds_write_b128 v251, v[192:195] offset:0
    ds_write_b128 v251, v[196:199] offset:1040
    s_waitcnt lgkmcnt(0)
    s_barrier
    s_mov_b32 s36, 0
    buffer_load_dwordx4 v[0:3], v254, s[12:15], s36 offen offset:0
    buffer_load_dwordx4 v[4:7], v254, s[12:15], s36 offen offset:1024
    buffer_load_dwordx4 v[8:11], v254, s[12:15], s36 offen offset:2048
    buffer_load_dwordx4 v[12:15], v254, s[12:15], s36 offen offset:3072
    s_mov_b32 s36, 4096
    buffer_load_dwordx4 v[16:19], v254, s[12:15], s36 offen offset:0
    buffer_load_dwordx4 v[20:23], v254, s[12:15], s36 offen offset:1024
    buffer_load_dwordx4 v[24:27], v254, s[12:15], s36 offen offset:2048
    buffer_load_dwordx4 v[28:31], v254, s[12:15], s36 offen offset:3072
    s_mov_b32 s36, 8192
    buffer_load_dwordx4 v[32:35], v254, s[12:15], s36 offen offset:0
    buffer_load_dwordx4 v[36:39], v254, s[12:15], s36 offen offset:1024
    buffer_load_dwordx4 v[40:43], v254, s[12:15], s36 offen offset:2048
    buffer_load_dwordx4 v[44:47], v254, s[12:15], s36 offen offset:3072
    s_mov_b32 s36, 12288
    buffer_load_dwordx4 v[48:51], v254, s[12:15], s36 offen offset:0
    buffer_load_dwordx4 v[52:55], v254, s[12:15], s36 offen offset:1024
    buffer_load_dwordx4 v[56:59], v254, s[12:15], s36 offen offset:2048
    buffer_load_dwordx4 v[60:63], v254, s[12:15], s36 offen offset:3072
    s_mov_b32 s36, 16384
    buffer_load_dwordx4 v[64:67], v254, s[12:15], s36 offen offset:0
    buffer_load_dwordx4 v[68:71], v254, s[12:15], s36 offen offset:1024
    buffer_load_dwordx4 v[72:75], v254, s[12:15], s36 offen offset:2048
    buffer_load_dwordx4 v[76:79], v254, s[12:15], s36 offen offset:3072
    s_mov_b32 s36, 20480
    buffer_load_dwordx4 v[80:83], v254, s[12:15], s36 offen offset:0
    buffer_load_dwordx4 v[84:87], v254, s[12:15], s36 offen offset:1024
    buffer_load_dwordx4 v[88:91], v254, s[12:15], s36 offen offset:2048
    buffer_load_dwordx4 v[92:95], v254, s[12:15], s36 offen offset:3072
    s_mov_b32 s36, 24576
    buffer_load_dwordx4 v[96:99], v254, s[12:15], s36 offen offset:0
    buffer_load_dwordx4 v[100:103], v254, s[12:15], s36 offen offset:1024
    buffer_load_dwordx4 v[104:107], v254, s[12:15], s36 offen offset:2048
    buffer_load_dwordx4 v[108:111], v254, s[12:15], s36 offen offset:3072
    s_mov_b32 s36, 28672
    buffer_load_dwordx4 v[112:115], v254, s[12:15], s36 offen offset:0
    buffer_load_dwordx4 v[116:119], v254, s[12:15], s36 offen offset:1024
    buffer_load_dwordx4 v[120:123], v254, s[12:15], s36 offen offset:2048
    buffer_load_dwordx4 v[124:127], v254, s[12:15], s36 offen offset:3072
    v_lshrrev_b32 v250, 5, v255
    v_lshlrev_b32 v250, 11, v250
    v_and_b32 v249, 31, v255
    v_lshl_add_u32 v250, v249, 2, v250
    s_lshl_b32 s36, s21, 7
    v_add_u32 v250, s36, v250
    s_mov_b32 s44, 0
    s_mov_b32 s45, 4096
    s_mov_b32 s46, 8192
    s_mov_b32 s47, 12288
    s_barrier
    ds_read_b128 v[192:195], v254 offset:0
    ds_read_b128 v[196:199], v254 offset:1024
    ds_read_b128 v[200:203], v254 offset:2048
    ds_read_b128 v[204:207], v254 offset:3072
    s_waitcnt vmcnt(30) lgkmcnt(3)
    v_mfma_f32_32x32x16_bf16 v[128:143], v[192:195], v[0:3], 0
    ds_read_b128 v[208:211], v254 offset:4096
    v_mfma_f32_32x32x16_bf16 v[144:159], v[192:195], v[4:7], 0
    s_waitcnt vmcnt(28) lgkmcnt(3)
    v_mfma_f32_32x32x16_bf16 v[128:143], v[196:199], v[8:11], v[128:143]
    ds_read_b128 v[212:215], v254 offset:5120
    v_mfma_f32_32x32x16_bf16 v[144:159], v[196:199], v[12:15], v[144:159]
    s_waitcnt vmcnt(26) lgkmcnt(3)
    v_mfma_f32_32x32x16_bf16 v[128:143], v[200:203], v[16:19], v[128:143]
    ds_read_b128 v[216:219], v254 offset:6144
    v_mfma_f32_32x32x16_bf16 v[144:159], v[200:203], v[20:23], v[144:159]
    s_waitcnt vmcnt(24) lgkmcnt(3)
    v_mfma_f32_32x32x16_bf16 v[128:143], v[204:207], v[24:27], v[128:143]
    ds_read_b128 v[220:223], v254 offset:7168
    v_mfma_f32_32x32x16_bf16 v[144:159], v[204:207], v[28:31], v[144:159]
    s_waitcnt vmcnt(22) lgkmcnt(3)
    v_mfma_f32_32x32x16_bf16 v[128:143], v[208:211], v[32:35], v[128:143]
    ds_read_b128 v[192:195], v254 offset:8192
    v_mfma_f32_32x32x16_bf16 v[144:159], v[208:211], v[36:39], v[144:159]
    s_waitcnt vmcnt(20) lgkmcnt(3)
    v_mfma_f32_32x32x16_bf16 v[128:143], v[212:215], v[40:43], v[128:143]
    ds_read_b128 v[196:199], v254 offset:9216
    v_mfma_f32_32x32x16_bf16 v[144:159], v[212:215], v[44:47], v[144:159]
    s_waitcnt vmcnt(18) lgkmcnt(3)
    v_mfma_f32_32x32x16_bf16 v[128:143], v[216:219], v[48:51], v[128:143]
    ds_read_b128 v[200:203], v254 offset:10240
    v_mfma_f32_32x32x16_bf16 v[144:159], v[216:219], v[52:55], v[144:159]
    s_waitcnt vmcnt(16) lgkmcnt(3)
    v_mfma_f32_32x32x16_bf16 v[128:143], v[220:223], v[56:59], v[128:143]
    ds_read_b128 v[204:207], v254 offset:11264
    v_mfma_f32_32x32x16_bf16 v[144:159], v[220:223], v[60:63], v[144:159]
    s_waitcnt vmcnt(14) lgkmcnt(3)
    v_mfma_f32_32x32x16_bf16 v[128:143], v[192:195], v[64:67], v[128:143]
    ds_read_b128 v[208:211], v254 offset:12288
    v_mfma_f32_32x32x16_bf16 v[144:159], v[192:195], v[68:71], v[144:159]
    s_waitcnt vmcnt(12) lgkmcnt(3)
    v_mfma_f32_32x32x16_bf16 v[128:143], v[196:199], v[72:75], v[128:143]
    ds_read_b128 v[212:215], v254 offset:13312
    v_mfma_f32_32x32x16_bf16 v[144:159], v[196:199], v[76:79], v[144:159]
    s_waitcnt vmcnt(10) lgkmcnt(3)
    v_mfma_f32_32x32x16_bf16 v[128:143], v[200:203], v[80:83], v[128:143]
    ds_read_b128 v[216:219], v254 offset:14336
    v_mfma_f32_32x32x16_bf16 v[144:159], v[200:203], v[84:87], v[144:159]
    s_waitcnt vmcnt(8) lgkmcnt(3)
    v_mfma_f32_32x32x16_bf16 v[128:143], v[204:207], v[88:91], v[128:143]
    ds_read_b128 v[220:223], v254 offset:15360
    v_mfma_f32_32x32x16_bf16 v[144:159], v[204:207], v[92:95], v[144:159]
    s_waitcnt lgkmcnt(0)
    s_barrier
    s_waitcnt vmcnt(6)
    v_mfma_f32_32x32x16_bf16 v[128:143], v[208:211], v[96:99], v[128:143]
    ds_read_b128 v[192:195], v254 offset:16384
    v_mfma_f32_32x32x16_bf16 v[144:159], v[208:211], v[100:103], v[144:159]
    s_waitcnt vmcnt(4)
    v_mfma_f32_32x32x16_bf16 v[128:143], v[212:215], v[104:107], v[128:143]
    ds_read_b128 v[196:199], v254 offset:17408
    v_mfma_f32_32x32x16_bf16 v[144:159], v[212:215], v[108:111], v[144:159]
    s_waitcnt vmcnt(2)
    v_mfma_f32_32x32x16_bf16 v[128:143], v[216:219], v[112:115], v[128:143]
    ds_read_b128 v[200:203], v254 offset:18432
    v_mfma_f32_32x32x16_bf16 v[144:159], v[216:219], v[116:119], v[144:159]
    s_waitcnt vmcnt(0)
    v_mfma_f32_32x32x16_bf16 v[128:143], v[220:223], v[120:123], v[128:143]
    ds_read_b128 v[204:207], v254 offset:19456
    v_mfma_f32_32x32x16_bf16 v[144:159], v[220:223], v[124:127], v[144:159]
    s_mov_b32 s22, 4
L_joint_kernel_oloop:
    s_waitcnt lgkmcnt(3)
    s_nop 0
    v_mfma_f32_32x32x16_bf16 v[160:175], v[192:195], v[0:3], 0
    ds_read_b128 v[208:211], v254 offset:20480
    v_mfma_f32_32x32x16_bf16 v[176:191], v[192:195], v[4:7], 0
    s_waitcnt lgkmcnt(3)
    s_nop 0
    v_mfma_f32_32x32x16_bf16 v[160:175], v[196:199], v[8:11], v[160:175]
    ds_read_b128 v[212:215], v254 offset:21504
    v_mfma_f32_32x32x16_bf16 v[176:191], v[196:199], v[12:15], v[176:191]
    s_waitcnt lgkmcnt(3)
    s_nop 0
    v_mfma_f32_32x32x16_bf16 v[160:175], v[200:203], v[16:19], v[160:175]
    ds_read_b128 v[216:219], v254 offset:22528
    v_mfma_f32_32x32x16_bf16 v[176:191], v[200:203], v[20:23], v[176:191]
    s_waitcnt lgkmcnt(3)
    s_nop 0
    v_mfma_f32_32x32x16_bf16 v[160:175], v[204:207], v[24:27], v[160:175]
    ds_read_b128 v[220:223], v254 offset:23552
    v_mfma_f32_32x32x16_bf16 v[176:191], v[204:207], v[28:31], v[176:191]
    s_waitcnt lgkmcnt(3)
    s_nop 0
    v_mfma_f32_32x32x16_bf16 v[160:175], v[208:211], v[32:35], v[160:175]
    ds_read_b128 v[192:195], v254 offset:24576
    v_cvt_pk_bf16_f32 v224, v128, v144
    buffer_store_dword v224, v250, s[16:19], s44 offen offset:0 nt
    v_mfma_f32_32x32x16_bf16 v[176:191], v[208:211], v[36:39], v[176:191]
    v_cvt_pk_bf16_f32 v225, v129, v145
    buffer_store_dword v225, v250, s[16:19], s44 offen offset:512 nt
    s_waitcnt lgkmcnt(3)
    s_nop 0
    v_mfma_f32_32x32x16_bf16 v[160:175], v[212:215], v[40:43], v[160:175]
    ds_read_b128 v[196:199], v254 offset:25600
    v_cvt_pk_bf16_f32 v226, v130, v146
    buffer_store_dword v226, v250, s[16:19], s44 offen offset:1024 nt
    v_mfma_f32_32x32x16_bf16 v[176:191], v[212:215], v[44:47], v[176:191]
    v_cvt_pk_bf16_f32 v227, v131, v147
    buffer_store_dword v227, v250, s[16:19], s44 offen offset:1536 nt
    s_waitcnt lgkmcnt(3)
    s_nop 0
    v_mfma_f32_32x32x16_bf16 v[160:175], v[216:219], v[48:51], v[160:175]
    ds_read_b128 v[200:203], v254 offset:26624
    v_cvt_pk_bf16_f32 v228, v132, v148
    buffer_store_dword v228, v250, s[16:19], s45 offen offset:0 nt
    v_mfma_f32_32x32x16_bf16 v[176:191], v[216:219], v[52:55], v[176:191]
    v_cvt_pk_bf16_f32 v229, v133, v149
    buffer_store_dword v229, v250, s[16:19], s45 offen offset:512 nt
    s_waitcnt lgkmcnt(3)
    s_nop 0
    v_mfma_f32_32x32x16_bf16 v[160:175], v[220:223], v[56:59], v[160:175]
    ds_read_b128 v[204:207], v254 offset:27648
    v_cvt_pk_bf16_f32 v230, v134, v150
    buffer_store_dword v230, v250, s[16:19], s45 offen offset:1024 nt
    v_mfma_f32_32x32x16_bf16 v[176:191], v[220:223], v[60:63], v[176:191]
    v_cvt_pk_bf16_f32 v231, v135, v151
    buffer_store_dword v231, v250, s[16:19], s45 offen offset:1536 nt
    s_waitcnt lgkmcnt(3)
    s_nop 0
    v_mfma_f32_32x32x16_bf16 v[160:175], v[192:195], v[64:67], v[160:175]
    ds_read_b128 v[208:211], v254 offset:28672
    v_cvt_pk_bf16_f32 v232, v136, v152
    buffer_store_dword v232, v250, s[16:19], s46 offen offset:0 nt
    v_mfma_f32_32x32x16_bf16 v[176:191], v[192:195], v[68:71], v[176:191]
    v_cvt_pk_bf16_f32 v233, v137, v153
    buffer_store_dword v233, v250, s[16:19], s46 offen offset:512 nt
    s_waitcnt lgkmcnt(3)
    s_nop 0
    v_mfma_f32_32x32x16_bf16 v[160:175], v[196:199], v[72:75], v[160:175]
    ds_read_b128 v[212:215], v254 offset:29696
    v_cvt_pk_bf16_f32 v234, v138, v154
    buffer_store_dword v234, v250, s[16:19], s46 offen offset:1024 nt
    v_mfma_f32_32x32x16_bf16 v[176:191], v[196:199], v[76:79], v[176:191]
    v_cvt_pk_bf16_f32 v235, v139, v155
    buffer_store_dword v235, v250, s[16:19], s46 offen offset:1536 nt
    s_waitcnt lgkmcnt(3)
    s_nop 0
    v_mfma_f32_32x32x16_bf16 v[160:175], v[200:203], v[80:83], v[160:175]
    ds_read_b128 v[216:219], v254 offset:30720
    v_cvt_pk_bf16_f32 v236, v140, v156
    v_mfma_f32_32x32x16_bf16 v[176:191], v[200:203], v[84:87], v[176:191]
    buffer_store_dword v236, v250, s[16:19], s47 offen offset:0 nt
    s_waitcnt lgkmcnt(3)
    s_nop 0
    v_mfma_f32_32x32x16_bf16 v[160:175], v[204:207], v[88:91], v[160:175]
    ds_read_b128 v[220:223], v254 offset:31744
    v_cvt_pk_bf16_f32 v237, v141, v157
    v_mfma_f32_32x32x16_bf16 v[176:191], v[204:207], v[92:95], v[176:191]
    buffer_store_dword v237, v250, s[16:19], s47 offen offset:512 nt
    s_waitcnt lgkmcnt(0)
    s_barrier
    v_mfma_f32_32x32x16_bf16 v[160:175], v[208:211], v[96:99], v[160:175]
    ds_read_b128 v[192:195], v254 offset:0
    v_cvt_pk_bf16_f32 v238, v142, v158
    v_mfma_f32_32x32x16_bf16 v[176:191], v[208:211], v[100:103], v[176:191]
    buffer_store_dword v238, v250, s[16:19], s47 offen offset:1024 nt
    v_mfma_f32_32x32x16_bf16 v[160:175], v[212:215], v[104:107], v[160:175]
    ds_read_b128 v[196:199], v254 offset:1024
    v_cvt_pk_bf16_f32 v239, v143, v159
    v_mfma_f32_32x32x16_bf16 v[176:191], v[212:215], v[108:111], v[176:191]
    buffer_store_dword v239, v250, s[16:19], s47 offen offset:1536 nt
    v_mfma_f32_32x32x16_bf16 v[160:175], v[216:219], v[112:115], v[160:175]
    ds_read_b128 v[200:203], v254 offset:2048
    v_add_u32 v250, 16384, v250
    v_mfma_f32_32x32x16_bf16 v[176:191], v[216:219], v[116:119], v[176:191]
    v_mfma_f32_32x32x16_bf16 v[160:175], v[220:223], v[120:123], v[160:175]
    ds_read_b128 v[204:207], v254 offset:3072
    v_mfma_f32_32x32x16_bf16 v[176:191], v[220:223], v[124:127], v[176:191]
    s_sub_u32 s22, s22, 1
    s_cmp_eq_u32 s22, 0
    s_cbranch_scc1 L_joint_kernel_oend
    s_waitcnt lgkmcnt(3)
    v_mfma_f32_32x32x16_bf16 v[128:143], v[192:195], v[0:3], 0
    ds_read_b128 v[208:211], v254 offset:4096
    v_mfma_f32_32x32x16_bf16 v[144:159], v[192:195], v[4:7], 0
    s_waitcnt lgkmcnt(3)
    s_nop 0
    v_mfma_f32_32x32x16_bf16 v[128:143], v[196:199], v[8:11], v[128:143]
    ds_read_b128 v[212:215], v254 offset:5120
    v_mfma_f32_32x32x16_bf16 v[144:159], v[196:199], v[12:15], v[144:159]
    s_waitcnt lgkmcnt(3)
    s_nop 0
    v_mfma_f32_32x32x16_bf16 v[128:143], v[200:203], v[16:19], v[128:143]
    ds_read_b128 v[216:219], v254 offset:6144
    v_mfma_f32_32x32x16_bf16 v[144:159], v[200:203], v[20:23], v[144:159]
    s_waitcnt lgkmcnt(3)
    s_nop 0
    v_mfma_f32_32x32x16_bf16 v[128:143], v[204:207], v[24:27], v[128:143]
    ds_read_b128 v[220:223], v254 offset:7168
    v_mfma_f32_32x32x16_bf16 v[144:159], v[204:207], v[28:31], v[144:159]
    s_waitcnt lgkmcnt(3)
    s_nop 0
    v_mfma_f32_32x32x16_bf16 v[128:143], v[208:211], v[32:35], v[128:143]
    ds_read_b128 v[192:195], v254 offset:8192
    v_cvt_pk_bf16_f32 v224, v160, v176
    buffer_store_dword v224, v250, s[16:19], s44 offen offset:0 nt
    v_mfma_f32_32x32x16_bf16 v[144:159], v[208:211], v[36:39], v[144:159]
    v_cvt_pk_bf16_f32 v225, v161, v177
    buffer_store_dword v225, v250, s[16:19], s44 offen offset:512 nt
    s_waitcnt lgkmcnt(3)
    s_nop 0
    v_mfma_f32_32x32x16_bf16 v[128:143], v[212:215], v[40:43], v[128:143]
    ds_read_b128 v[196:199], v254 offset:9216
    v_cvt_pk_bf16_f32 v226, v162, v178
    buffer_store_dword v226, v250, s[16:19], s44 offen offset:1024 nt
    v_mfma_f32_32x32x16_bf16 v[144:159], v[212:215], v[44:47], v[144:159]
    v_cvt_pk_bf16_f32 v227, v163, v179
    buffer_store_dword v227, v250, s[16:19], s44 offen offset:1536 nt
    s_waitcnt lgkmcnt(3)
    s_nop 0
    v_mfma_f32_32x32x16_bf16 v[128:143], v[216:219], v[48:51], v[128:143]
    ds_read_b128 v[200:203], v254 offset:10240
    v_cvt_pk_bf16_f32 v228, v164, v180
    buffer_store_dword v228, v250, s[16:19], s45 offen offset:0 nt
    v_mfma_f32_32x32x16_bf16 v[144:159], v[216:219], v[52:55], v[144:159]
    v_cvt_pk_bf16_f32 v229, v165, v181
    buffer_store_dword v229, v250, s[16:19], s45 offen offset:512 nt
    s_waitcnt lgkmcnt(3)
    s_nop 0
    v_mfma_f32_32x32x16_bf16 v[128:143], v[220:223], v[56:59], v[128:143]
    ds_read_b128 v[204:207], v254 offset:11264
    v_cvt_pk_bf16_f32 v230, v166, v182
    buffer_store_dword v230, v250, s[16:19], s45 offen offset:1024 nt
    v_mfma_f32_32x32x16_bf16 v[144:159], v[220:223], v[60:63], v[144:159]
    v_cvt_pk_bf16_f32 v231, v167, v183
    buffer_store_dword v231, v250, s[16:19], s45 offen offset:1536 nt
    s_waitcnt lgkmcnt(3)
    s_nop 0
    v_mfma_f32_32x32x16_bf16 v[128:143], v[192:195], v[64:67], v[128:143]
    ds_read_b128 v[208:211], v254 offset:12288
    v_cvt_pk_bf16_f32 v232, v168, v184
    buffer_store_dword v232, v250, s[16:19], s46 offen offset:0 nt
    v_mfma_f32_32x32x16_bf16 v[144:159], v[192:195], v[68:71], v[144:159]
    v_cvt_pk_bf16_f32 v233, v169, v185
    buffer_store_dword v233, v250, s[16:19], s46 offen offset:512 nt
    s_waitcnt lgkmcnt(3)
    s_nop 0
    v_mfma_f32_32x32x16_bf16 v[128:143], v[196:199], v[72:75], v[128:143]
    ds_read_b128 v[212:215], v254 offset:13312
    v_cvt_pk_bf16_f32 v234, v170, v186
    buffer_store_dword v234, v250, s[16:19], s46 offen offset:1024 nt
    v_mfma_f32_32x32x16_bf16 v[144:159], v[196:199], v[76:79], v[144:159]
    v_cvt_pk_bf16_f32 v235, v171, v187
    buffer_store_dword v235, v250, s[16:19], s46 offen offset:1536 nt
    s_waitcnt lgkmcnt(3)
    s_nop 0
    v_mfma_f32_32x32x16_bf16 v[128:143], v[200:203], v[80:83], v[128:143]
    ds_read_b128 v[216:219], v254 offset:14336
    v_cvt_pk_bf16_f32 v236, v172, v188
    v_mfma_f32_32x32x16_bf16 v[144:159], v[200:203], v[84:87], v[144:159]
    buffer_store_dword v236, v250, s[16:19], s47 offen offset:0 nt
    s_waitcnt lgkmcnt(3)
    s_nop 0
    v_mfma_f32_32x32x16_bf16 v[128:143], v[204:207], v[88:91], v[128:143]
    ds_read_b128 v[220:223], v254 offset:15360
    v_cvt_pk_bf16_f32 v237, v173, v189
    v_mfma_f32_32x32x16_bf16 v[144:159], v[204:207], v[92:95], v[144:159]
    buffer_store_dword v237, v250, s[16:19], s47 offen offset:512 nt
    s_waitcnt lgkmcnt(0)
    s_barrier
    v_mfma_f32_32x32x16_bf16 v[128:143], v[208:211], v[96:99], v[128:143]
    ds_read_b128 v[192:195], v254 offset:16384
    v_cvt_pk_bf16_f32 v238, v174, v190
    v_mfma_f32_32x32x16_bf16 v[144:159], v[208:211], v[100:103], v[144:159]
    buffer_store_dword v238, v250, s[16:19], s47 offen offset:1024 nt
    v_mfma_f32_32x32x16_bf16 v[128:143], v[212:215], v[104:107], v[128:143]
    ds_read_b128 v[196:199], v254 offset:17408
    v_cvt_pk_bf16_f32 v239, v175, v191
    v_mfma_f32_32x32x16_bf16 v[144:159], v[212:215], v[108:111], v[144:159]
    buffer_store_dword v239, v250, s[16:19], s47 offen offset:1536 nt
    v_mfma_f32_32x32x16_bf16 v[128:143], v[216:219], v[112:115], v[128:143]
    ds_read_b128 v[200:203], v254 offset:18432
    v_add_u32 v250, 16384, v250
    v_mfma_f32_32x32x16_bf16 v[144:159], v[216:219], v[116:119], v[144:159]
    v_mfma_f32_32x32x16_bf16 v[128:143], v[220:223], v[120:123], v[128:143]
    ds_read_b128 v[204:207], v254 offset:19456
    v_mfma_f32_32x32x16_bf16 v[144:159], v[220:223], v[124:127], v[144:159]
    s_waitcnt vmcnt(24)
    s_branch L_joint_kernel_oloop
L_joint_kernel_oend:
    s_nop 15
    v_cvt_pk_bf16_f32 v224, v160, v176
    buffer_store_dword v224, v250, s[16:19], s44 offen offset:0 nt
    v_cvt_pk_bf16_f32 v225, v161, v177
    buffer_store_dword v225, v250, s[16:19], s44 offen offset:512 nt
    v_cvt_pk_bf16_f32 v226, v162, v178
    buffer_store_dword v226, v250, s[16:19], s44 offen offset:1024 nt
    v_cvt_pk_bf16_f32 v227, v163, v179
    buffer_store_dword v227, v250, s[16:19], s44 offen offset:1536 nt
    v_cvt_pk_bf16_f32 v228, v164, v180
    buffer_store_dword v228, v250, s[16:19], s45 offen offset:0 nt
    v_cvt_pk_bf16_f32 v229, v165, v181
    buffer_store_dword v229, v250, s[16:19], s45 offen offset:512 nt
    v_cvt_pk_bf16_f32 v230, v166, v182
    buffer_store_dword v230, v250, s[16:19], s45 offen offset:1024 nt
    v_cvt_pk_bf16_f32 v231, v167, v183
    buffer_store_dword v231, v250, s[16:19], s45 offen offset:1536 nt
    v_cvt_pk_bf16_f32 v232, v168, v184
    buffer_store_dword v232, v250, s[16:19], s46 offen offset:0 nt
    v_cvt_pk_bf16_f32 v233, v169, v185
    buffer_store_dword v233, v250, s[16:19], s46 offen offset:512 nt
    v_cvt_pk_bf16_f32 v234, v170, v186
    buffer_store_dword v234, v250, s[16:19], s46 offen offset:1024 nt
    v_cvt_pk_bf16_f32 v235, v171, v187
    buffer_store_dword v235, v250, s[16:19], s46 offen offset:1536 nt
    v_cvt_pk_bf16_f32 v236, v172, v188
    buffer_store_dword v236, v250, s[16:19], s47 offen offset:0 nt
    v_cvt_pk_bf16_f32 v237, v173, v189
    buffer_store_dword v237, v250, s[16:19], s47 offen offset:512 nt
    v_cvt_pk_bf16_f32 v238, v174, v190
    buffer_store_dword v238, v250, s[16:19], s47 offen offset:1024 nt
    v_cvt_pk_bf16_f32 v239, v175, v191
    buffer_store_dword v239, v250, s[16:19], s47 offen offset:1536 nt
    v_add_u32 v250, 16384, v250
    s_branch L_joint_kernel_fin
L_joint_kernel_T:
    s_setprio 3
    s_add_u32 s36, s30, 44335104
    s_addc_u32 s37, s31, 0
    s_load_dwordx16 s[44:59], s[36:37], 0
    s_cmp_ge_u32 s2, 125
    s_cselect_b32 s34, 8192, 0
    s_add_u32 s34, s34, 44302336
    s_add_u32 s40, s30, s34
    s_addc_u32 s41, s31, 0
    s_mov_b32 s42, 24576
    s_mov_b32 s43, 0x00020000
    v_and_b32 v248, 31, v255
    v_lshrrev_b32 v246, 5, v255
    v_mul_u32_u24 v250, 528, v248
    v_lshl_add_u32 v250, v246, 4, v250
    v_lshlrev_b32 v246, 5, v246
    v_and_b32 v249, 7, v255
    v_lshl_add_u32 v249, v249, 10, v246
    s_lshl_b32 s38, s21, 8
    s_add_u32 s39, s38, 16384
    v_and_b32 v245, 7, v255
    v_mul_u32_u24 v245, 1040, v245
    s_add_u32 s36, s38, 88832
    v_add3_u32 v245, v245, v246, s36
    s_mul_i32 s36, s21, 9792
    s_add_u32 s36, s36, 49664
    v_add_u32 v246, s36, v246
    v_mul_u32_u24 v247, 272, v248
    v_add_u32 v247, v247, v246
    v_lshrrev_b32 v248, 3, v248
    v_mul_u32_u24 v248, 272, v248
    v_add_u32 v246, v248, v246
    s_lshl_b32 s36, s21, 12
    v_add_u32 v248, s36, v254
    s_barrier
    s_mov_b32 s36, 0
    buffer_load_dwordx4 v[0:3], v254, s[12:15], s36 offen offset:0
    buffer_load_dwordx4 v[4:7], v254, s[12:15], s36 offen offset:1024
    buffer_load_dwordx4 v[8:11], v254, s[12:15], s36 offen offset:2048
    buffer_load_dwordx4 v[12:15], v254, s[12:15], s36 offen offset:3072
    s_mov_b32 s36, 4096
    buffer_load_dwordx4 v[16:19], v254, s[12:15], s36 offen offset:0
    buffer_load_dwordx4 v[20:23], v254, s[12:15], s36 offen offset:1024
    buffer_load_dwordx4 v[24:27], v254, s[12:15], s36 offen offset:2048
    buffer_load_dwordx4 v[28:31], v254, s[12:15], s36 offen offset:3072
    s_mov_b32 s36, 8192
    buffer_load_dwordx4 v[32:35], v254, s[12:15], s36 offen offset:0
    buffer_load_dwordx4 v[36:39], v254, s[12:15], s36 offen offset:1024
    buffer_load_dwordx4 v[40:43], v254, s[12:15], s36 offen offset:2048
    buffer_load_dwordx4 v[44:47], v254, s[12:15], s36 offen offset:3072
    s_mov_b32 s36, 12288
    buffer_load_dwordx4 v[48:51], v254, s[12:15], s36 offen offset:0
    buffer_load_dwordx4 v[52:55], v254, s[12:15], s36 offen offset:1024
    buffer_load_dwordx4 v[56:59], v254, s[12:15], s36 offen offset:2048
    buffer_load_dwordx4 v[60:63], v254, s[12:15], s36 offen offset:3072
    s_mov_b32 s36, 16384
    buffer_load_dwordx4 v[64:67], v254, s[12:15], s36 offen offset:0
    buffer_load_dwordx4 v[68:71], v254, s[12:15], s36 offen offset:1024
    buffer_load_dwordx4 v[72:75], v254, s[12:15], s36 offen offset:2048
    buffer_load_dwordx4 v[76:79], v254, s[12:15], s36 offen offset:3072
    s_mov_b32 s36, 20480
    buffer_load_dwordx4 v[80:83], v254, s[12:15], s36 offen offset:0
    buffer_load_dwordx4 v[84:87], v254, s[12:15], s36 offen offset:1024
    buffer_load_dwordx4 v[88:91], v254, s[12:15], s36 offen offset:2048
    buffer_load_dwordx4 v[92:95], v254, s[12:15], s36 offen offset:3072
    s_mov_b32 s36, 24576
    buffer_load_dwordx4 v[96:99], v254, s[12:15], s36 offen offset:0
    buffer_load_dwordx4 v[100:103], v254, s[12:15], s36 offen offset:1024
    buffer_load_dwordx4 v[104:107], v254, s[12:15], s36 offen offset:2048
    buffer_load_dwordx4 v[108:111], v254, s[12:15], s36 offen offset:3072
    s_mov_b32 s36, 28672
    buffer_load_dwordx4 v[112:115], v254, s[12:15], s36 offen offset:0
    buffer_load_dwordx4 v[116:119], v254, s[12:15], s36 offen offset:1024
    buffer_load_dwordx4 v[120:123], v254, s[12:15], s36 offen offset:2048
    buffer_load_dwordx4 v[124:127], v254, s[12:15], s36 offen offset:3072
    s_waitcnt lgkmcnt(0)
    s_setprio 0
    s_or_b32 s44, s44, s45
    s_or_b32 s44, s44, s46
    s_or_b32 s44, s44, s47
    s_or_b32 s44, s44, s48
    s_or_b32 s44, s44, s49
    s_or_b32 s44, s44, s50
    s_or_b32 s44, s44, s51
    s_or_b32 s44, s44, s52
    s_or_b32 s44, s44, s53
    s_or_b32 s44, s44, s54
    s_or_b32 s44, s44, s55
    s_or_b32 s44, s44, s56
    s_or_b32 s44, s44, s57
    s_or_b32 s44, s44, s58
    s_or_b32 s44, s44, s59
    s_barrier
    ds_read_b128 v[160:163], v250 offset:32768
    ds_read_b128 v[164:167], v250 offset:32800
    ds_read_b128 v[168:171], v250 offset:32832
    ds_read_b128 v[172:175], v250 offset:32864
    ds_read_b128 v[176:179], v250 offset:32896
    ds_read_b128 v[180:183], v250 offset:32928
    ds_read_b128 v[184:187], v250 offset:32960
    ds_read_b128 v[188:191], v250 offset:32992
    s_waitcnt vmcnt(30) lgkmcnt(7)
    v_mfma_f32_32x32x16_bf16 v[128:143], v[0:3], v[160:163], 0
    v_mfma_f32_32x32x16_bf16 v[144:159], v[4:7], v[160:163], 0
    ds_read_b128 v[160:163], v250 offset:33024
    s_waitcnt vmcnt(28) lgkmcnt(7)
    v_mfma_f32_32x32x16_bf16 v[128:143], v[8:11], v[164:167], v[128:143]
    v_mfma_f32_32x32x16_bf16 v[144:159], v[12:15], v[164:167], v[144:159]
    ds_read_b128 v[164:167], v250 offset:33056
    s_waitcnt vmcnt(26) lgkmcnt(7)
    v_mfma_f32_32x32x16_bf16 v[128:143], v[16:19], v[168:171], v[128:143]
    v_mfma_f32_32x32x16_bf16 v[144:159], v[20:23], v[168:171], v[144:159]
    ds_read_b128 v[168:171], v250 offset:33088
    s_waitcnt vmcnt(24) lgkmcnt(7)
    v_mfma_f32_32x32x16_bf16 v[128:143], v[24:27], v[172:175], v[128:143]
    v_mfma_f32_32x32x16_bf16 v[144:159], v[28:31], v[172:175], v[144:159]
    ds_read_b128 v[172:175], v250 offset:33120
    s_waitcnt vmcnt(22) lgkmcnt(7)
    v_mfma_f32_32x32x16_bf16 v[128:143], v[32:35], v[176:179], v[128:143]
    v_mfma_f32_32x32x16_bf16 v[144:159], v[36:39], v[176:179], v[144:159]
    ds_read_b128 v[176:179], v250 offset:33152
    s_waitcnt vmcnt(20) lgkmcnt(7)
    v_mfma_f32_32x32x16_bf16 v[128:143], v[40:43], v[180:183], v[128:143]
    v_mfma_f32_32x32x16_bf16 v[144:159], v[44:47], v[180:183], v[144:159]
    ds_read_b128 v[180:183], v250 offset:33184
    s_waitcnt vmcnt(18) lgkmcnt(7)
    v_mfma_f32_32x32x16_bf16 v[128:143], v[48:51], v[184:187], v[128:143]
    v_mfma_f32_32x32x16_bf16 v[144:159], v[52:55], v[184:187], v[144:159]
    ds_read_b128 v[184:187], v250 offset:33216
    s_waitcnt vmcnt(16) lgkmcnt(7)
    v_mfma_f32_32x32x16_bf16 v[128:143], v[56:59], v[188:191], v[128:143]
    v_mfma_f32_32x32x16_bf16 v[144:159], v[60:63], v[188:191], v[144:159]
    ds_read_b128 v[188:191], v250 offset:33248
    s_waitcnt vmcnt(14) lgkmcnt(7)
    v_mfma_f32_32x32x16_bf16 v[128:143], v[64:67], v[160:163], v[128:143]
    v_mfma_f32_32x32x16_bf16 v[144:159], v[68:71], v[160:163], v[144:159]
    ds_read_b128 v[192:195], v245 offset:0
    s_waitcnt vmcnt(12) lgkmcnt(7)
    v_mfma_f32_32x32x16_bf16 v[128:143], v[72:75], v[164:167], v[128:143]
    v_mfma_f32_32x32x16_bf16 v[144:159], v[76:79], v[164:167], v[144:159]
    ds_read_b128 v[196:199], v245 offset:16
    s_waitcnt vmcnt(10) lgkmcnt(7)
    v_mfma_f32_32x32x16_bf16 v[128:143], v[80:83], v[168:171], v[128:143]
    v_mfma_f32_32x32x16_bf16 v[144:159], v[84:87], v[168:171], v[144:159]
    ds_read_b128 v[200:203], v245 offset:64
    s_waitcnt vmcnt(8) lgkmcnt(7)
    v_mfma_f32_32x32x16_bf16 v[128:143], v[88:91], v[172:175], v[128:143]
    v_mfma_f32_32x32x16_bf16 v[144:159], v[92:95], v[172:175], v[144:159]
    ds_read_b128 v[204:207], v245 offset:80
    s_waitcnt vmcnt(6) lgkmcnt(7)
    v_mfma_f32_32x32x16_bf16 v[128:143], v[96:99], v[176:179], v[128:143]
    v_mfma_f32_32x32x16_bf16 v[144:159], v[100:103], v[176:179], v[144:159]
    ds_read_b128 v[208:211], v245 offset:128
    s_waitcnt vmcnt(4) lgkmcnt(7)
    v_mfma_f32_32x32x16_bf16 v[128:143], v[104:107], v[180:183], v[128:143]
    v_mfma_f32_32x32x16_bf16 v[144:159], v[108:111], v[180:183], v[144:159]
    ds_read_b128 v[212:215], v245 offset:144
    s_waitcnt vmcnt(2) lgkmcnt(7)
    v_mfma_f32_32x32x16_bf16 v[128:143], v[112:115], v[184:187], v[128:143]
    v_mfma_f32_32x32x16_bf16 v[144:159], v[116:119], v[184:187], v[144:159]
    ds_read_b128 v[216:219], v245 offset:192
    s_waitcnt vmcnt(0) lgkmcnt(7)
    v_mfma_f32_32x32x16_bf16 v[128:143], v[120:123], v[188:191], v[128:143]
    v_mfma_f32_32x32x16_bf16 v[144:159], v[124:127], v[188:191], v[144:159]
    ds_read_b128 v[220:223], v245 offset:208
    s_mov_b32 s46, 0xffff0000
    s_mov_b32 s45, 0x4038aa3b
    s_nop 10
    s_mov_b32 s48, s45
    s_mov_b32 s49, s45
    v_mov_b32 v96, 0
    s_waitcnt lgkmcnt(0)
    v_cvt_pk_bf16_f32 v224, v128, v144
    v_cvt_pk_bf16_f32 v225, v129, v145
    v_cvt_pk_bf16_f32 v226, v130, v146
    v_cvt_pk_bf16_f32 v227, v131, v147
    v_lshlrev_b32 v0, 16, v224
    v_and_b32 v1, s46, v224
    v_lshlrev_b32 v2, 16, v225
    v_and_b32 v3, s46, v225
    v_lshlrev_b32 v4, 16, v226
    v_and_b32 v5, s46, v226
    v_lshlrev_b32 v6, 16, v227
    v_and_b32 v7, s46, v227
    v_pk_mul_f32 v[0:1], v[0:1], s[48:49]
    v_pk_mul_f32 v[2:3], v[2:3], s[48:49]
    v_pk_mul_f32 v[4:5], v[4:5], s[48:49]
    v_pk_mul_f32 v[6:7], v[6:7], s[48:49]
    v_exp_f32 v32, v0
    v_exp_f32 v33, v1
    v_exp_f32 v34, v2
    v_exp_f32 v35, v3
    v_max3_f32 v96, |v0|, |v1|, v96
    v_max3_f32 v96, |v2|, |v3|, v96
    ds_write_b128 v247, v[32:35] offset:0
    v_exp_f32 v36, v4
    v_exp_f32 v37, v5
    v_exp_f32 v38, v6
    v_exp_f32 v39, v7
    v_max3_f32 v96, |v4|, |v5|, v96
    v_max3_f32 v96, |v6|, |v7|, v96
    ds_write_b128 v247, v[36:39] offset:16
    v_cvt_pk_bf16_f32 v228, v132, v148
    v_cvt_pk_bf16_f32 v229, v133, v149
    v_cvt_pk_bf16_f32 v230, v134, v150
    v_cvt_pk_bf16_f32 v231, v135, v151
    v_lshlrev_b32 v8, 16, v228
    v_and_b32 v9, s46, v228
    v_lshlrev_b32 v10, 16, v229
    v_and_b32 v11, s46, v229
    v_lshlrev_b32 v12, 16, v230
    v_and_b32 v13, s46, v230
    v_lshlrev_b32 v14, 16, v231
    v_and_b32 v15, s46, v231
    v_pk_mul_f32 v[8:9], v[8:9], s[48:49]
    v_pk_mul_f32 v[10:11], v[10:11], s[48:49]
    v_pk_mul_f32 v[12:13], v[12:13], s[48:49]
    v_pk_mul_f32 v[14:15], v[14:15], s[48:49]
    v_exp_f32 v40, v8
    v_exp_f32 v41, v9
    v_exp_f32 v42, v10
    v_exp_f32 v43, v11
    v_max3_f32 v96, |v8|, |v9|, v96
    v_max3_f32 v96, |v10|, |v11|, v96
    ds_write_b128 v247, v[40:43] offset:64
    v_exp_f32 v44, v12
    v_exp_f32 v45, v13
    v_exp_f32 v46, v14
    v_exp_f32 v47, v15
    v_max3_f32 v96, |v12|, |v13|, v96
    v_max3_f32 v96, |v14|, |v15|, v96
    ds_write_b128 v247, v[44:47] offset:80
    v_cvt_pk_bf16_f32 v232, v136, v152
    v_cvt_pk_bf16_f32 v233, v137, v153
    v_cvt_pk_bf16_f32 v234, v138, v154
    v_cvt_pk_bf16_f32 v235, v139, v155
    v_lshlrev_b32 v16, 16, v232
    v_and_b32 v17, s46, v232
    v_lshlrev_b32 v18, 16, v233
    v_and_b32 v19, s46, v233
    v_lshlrev_b32 v20, 16, v234
    v_and_b32 v21, s46, v234
    v_lshlrev_b32 v22, 16, v235
    v_and_b32 v23, s46, v235
    v_pk_mul_f32 v[16:17], v[16:17], s[48:49]
    v_pk_mul_f32 v[18:19], v[18:19], s[48:49]
    v_pk_mul_f32 v[20:21], v[20:21], s[48:49]
    v_pk_mul_f32 v[22:23], v[22:23], s[48:49]
    v_exp_f32 v48, v16
    v_exp_f32 v49, v17
    v_exp_f32 v50, v18
    v_exp_f32 v51, v19
    v_max3_f32 v96, |v16|, |v17|, v96
    v_max3_f32 v96, |v18|, |v19|, v96
    ds_write_b128 v247, v[48:51] offset:128
    v_exp_f32 v52, v20
    v_exp_f32 v53, v21
    v_exp_f32 v54, v22
    v_exp_f32 v55, v23
    v_max3_f32 v96, |v20|, |v21|, v96
    v_max3_f32 v96, |v22|, |v23|, v96
    ds_write_b128 v247, v[52:55] offset:144
    v_cvt_pk_bf16_f32 v236, v140, v156
    v_cvt_pk_bf16_f32 v237, v141, v157
    v_cvt_pk_bf16_f32 v238, v142, v158
    v_cvt_pk_bf16_f32 v239, v143, v159
    v_lshlrev_b32 v24, 16, v236
    v_and_b32 v25, s46, v236
    v_lshlrev_b32 v26, 16, v237
    v_and_b32 v27, s46, v237
    v_lshlrev_b32 v28, 16, v238
    v_and_b32 v29, s46, v238
    v_lshlrev_b32 v30, 16, v239
    v_and_b32 v31, s46, v239
    v_pk_mul_f32 v[24:25], v[24:25], s[48:49]
    v_pk_mul_f32 v[26:27], v[26:27], s[48:49]
    v_pk_mul_f32 v[28:29], v[28:29], s[48:49]
    v_pk_mul_f32 v[30:31], v[30:31], s[48:49]
    v_exp_f32 v56, v24
    v_exp_f32 v57, v25
    v_exp_f32 v58, v26
    v_exp_f32 v59, v27
    v_max3_f32 v96, |v24|, |v25|, v96
    v_max3_f32 v96, |v26|, |v27|, v96
    ds_write_b128 v247, v[56:59] offset:192
    v_exp_f32 v60, v28
    v_exp_f32 v61, v29
    v_exp_f32 v62, v30
    v_exp_f32 v63, v31
    v_max3_f32 v96, |v28|, |v29|, v96
    v_max3_f32 v96, |v30|, |v31|, v96
    ds_write_b128 v247, v[60:63] offset:208
    v_cmp_lt_f32 vcc, 0x42f00000, v96
    s_mov_b32 s22, 4
    s_or_b32 s44, s44, vcc_lo
    s_or_b32 s44, s44, vcc_hi
    s_cmp_lg_u32 s44, 0
    s_cbranch_scc1 L_joint_kernel_tslow
    s_waitcnt lgkmcnt(4)
    ds_read_b128 v[64:67], v246 offset:0
    ds_read_b128 v[68:71], v246 offset:16
    ds_read_b128 v[72:75], v246 offset:64
    ds_read_b128 v[76:79], v246 offset:80
    ds_read_b128 v[80:83], v246 offset:128
    ds_read_b128 v[84:87], v246 offset:144
    ds_read_b128 v[88:91], v246 offset:192
    ds_read_b128 v[92:95], v246 offset:208
    v_add_u32 v246, 1088, v246
    s_waitcnt vmcnt(0) lgkmcnt(0)
L_joint_kernel_tloop1:
    v_fma_f32 v32, v192, v64, 1.0
    v_fma_f32 v33, v193, v65, 1.0
    v_fma_f32 v34, v194, v66, 1.0
    v_fma_f32 v35, v195, v67, 1.0
    v_fma_f32 v36, v196, v68, 1.0
    v_fma_f32 v37, v197, v69, 1.0
    v_fma_f32 v38, v198, v70, 1.0
    v_fma_f32 v39, v199, v71, 1.0
    v_rcp_f32 v32, v32
    v_rcp_f32 v33, v33
    v_rcp_f32 v34, v34
    v_rcp_f32 v35, v35
    v_rcp_f32 v36, v36
    v_rcp_f32 v37, v37
    v_rcp_f32 v38, v38
    v_rcp_f32 v39, v39
    v_fma_f32 v32, v32, -2.0, 1.0
    v_fma_f32 v33, v33, -2.0, 1.0
    v_fma_f32 v34, v34, -2.0, 1.0
    v_fma_f32 v35, v35, -2.0, 1.0
    v_fma_f32 v36, v36, -2.0, 1.0
    v_fma_f32 v37, v37, -2.0, 1.0
    v_fma_f32 v38, v38, -2.0, 1.0
    v_fma_f32 v39, v39, -2.0, 1.0
    v_cvt_pk_bf16_f32 v224, v32, v33
    v_cvt_pk_bf16_f32 v225, v34, v35
    v_cvt_pk_bf16_f32 v226, v36, v37
    v_cvt_pk_bf16_f32 v227, v38, v39
    ds_write_b128 v248, v[224:227] offset:0
    v_fma_f32 v40, v200, v72, 1.0
    v_fma_f32 v41, v201, v73, 1.0
    v_fma_f32 v42, v202, v74, 1.0
    v_fma_f32 v43, v203, v75, 1.0
    v_fma_f32 v44, v204, v76, 1.0
    v_fma_f32 v45, v205, v77, 1.0
    v_fma_f32 v46, v206, v78, 1.0
    v_fma_f32 v47, v207, v79, 1.0
    v_rcp_f32 v40, v40
    v_rcp_f32 v41, v41
    v_rcp_f32 v42, v42
    v_rcp_f32 v43, v43
    v_rcp_f32 v44, v44
    v_rcp_f32 v45, v45
    v_rcp_f32 v46, v46
    v_rcp_f32 v47, v47
    v_fma_f32 v40, v40, -2.0, 1.0
    v_fma_f32 v41, v41, -2.0, 1.0
    v_fma_f32 v42, v42, -2.0, 1.0
    v_fma_f32 v43, v43, -2.0, 1.0
    v_fma_f32 v44, v44, -2.0, 1.0
    v_fma_f32 v45, v45, -2.0, 1.0
    v_fma_f32 v46, v46, -2.0, 1.0
    v_fma_f32 v47, v47, -2.0, 1.0
    v_cvt_pk_bf16_f32 v228, v40, v41
    v_cvt_pk_bf16_f32 v229, v42, v43
    v_cvt_pk_bf16_f32 v230, v44, v45
    v_cvt_pk_bf16_f32 v231, v46, v47
    ds_write_b128 v248, v[228:231] offset:1024
    v_fma_f32 v48, v208, v80, 1.0
    v_fma_f32 v49, v209, v81, 1.0
    v_fma_f32 v50, v210, v82, 1.0
    v_fma_f32 v51, v211, v83, 1.0
    v_fma_f32 v52, v212, v84, 1.0
    v_fma_f32 v53, v213, v85, 1.0
    v_fma_f32 v54, v214, v86, 1.0
    v_fma_f32 v55, v215, v87, 1.0
    v_rcp_f32 v48, v48
    v_rcp_f32 v49, v49
    v_rcp_f32 v50, v50
    v_rcp_f32 v51, v51
    v_rcp_f32 v52, v52
    v_rcp_f32 v53, v53
    v_rcp_f32 v54, v54
    v_rcp_f32 v55, v55
    v_fma_f32 v48, v48, -2.0, 1.0
    v_fma_f32 v49, v49, -2.0, 1.0
    v_fma_f32 v50, v50, -2.0, 1.0
    v_fma_f32 v51, v51, -2.0, 1.0
    v_fma_f32 v52, v52, -2.0, 1.0
    v_fma_f32 v53, v53, -2.0, 1.0
    v_fma_f32 v54, v54, -2.0, 1.0
    v_fma_f32 v55, v55, -2.0, 1.0
    v_cvt_pk_bf16_f32 v232, v48, v49
    v_cvt_pk_bf16_f32 v233, v50, v51
    v_cvt_pk_bf16_f32 v234, v52, v53
    v_cvt_pk_bf16_f32 v235, v54, v55
    ds_write_b128 v248, v[232:235] offset:2048
    v_fma_f32 v56, v216, v88, 1.0
    v_fma_f32 v57, v217, v89, 1.0
    v_fma_f32 v58, v218, v90, 1.0
    v_fma_f32 v59, v219, v91, 1.0
    v_fma_f32 v60, v220, v92, 1.0
    v_fma_f32 v61, v221, v93, 1.0
    v_fma_f32 v62, v222, v94, 1.0
    v_fma_f32 v63, v223, v95, 1.0
    ds_read_b128 v[64:67], v246 offset:0
    ds_read_b128 v[68:71], v246 offset:16
    ds_read_b128 v[72:75], v246 offset:64
    ds_read_b128 v[76:79], v246 offset:80
    ds_read_b128 v[80:83], v246 offset:128
    ds_read_b128 v[84:87], v246 offset:144
    ds_read_b128 v[88:91], v246 offset:192
    ds_read_b128 v[92:95], v246 offset:208
    v_add_u32 v246, 1088, v246
    v_rcp_f32 v56, v56
    v_rcp_f32 v57, v57
    v_rcp_f32 v58, v58
    v_rcp_f32 v59, v59
    v_rcp_f32 v60, v60
    v_rcp_f32 v61, v61
    v_rcp_f32 v62, v62
    v_rcp_f32 v63, v63
    v_fma_f32 v56, v56, -2.0, 1.0
    v_fma_f32 v57, v57, -2.0, 1.0
    v_fma_f32 v58, v58, -2.0, 1.0
    v_fma_f32 v59, v59, -2.0, 1.0
    v_fma_f32 v60, v60, -2.0, 1.0
    v_fma_f32 v61, v61, -2.0, 1.0
    v_fma_f32 v62, v62, -2.0, 1.0
    v_fma_f32 v63, v63, -2.0, 1.0
    v_cvt_pk_bf16_f32 v236, v56, v57
    v_cvt_pk_bf16_f32 v237, v58, v59
    v_cvt_pk_bf16_f32 v238, v60, v61
    v_cvt_pk_bf16_f32 v239, v62, v63
    ds_write_b128 v248, v[236:239] offset:3072
    s_waitcnt lgkmcnt(0)
    s_barrier
    v_fma_f32 v32, v192, v64, 1.0
    v_fma_f32 v33, v193, v65, 1.0
    v_fma_f32 v34, v194, v66, 1.0
    v_fma_f32 v35, v195, v67, 1.0
    v_fma_f32 v36, v196, v68, 1.0
    v_fma_f32 v37, v197, v69, 1.0
    v_fma_f32 v38, v198, v70, 1.0
    v_fma_f32 v39, v199, v71, 1.0
    v_rcp_f32 v32, v32
    v_rcp_f32 v33, v33
    v_rcp_f32 v34, v34
    v_rcp_f32 v35, v35
    v_rcp_f32 v36, v36
    v_rcp_f32 v37, v37
    v_rcp_f32 v38, v38
    v_rcp_f32 v39, v39
    v_fma_f32 v32, v32, -2.0, 1.0
    v_fma_f32 v33, v33, -2.0, 1.0
    v_fma_f32 v34, v34, -2.0, 1.0
    v_fma_f32 v35, v35, -2.0, 1.0
    v_fma_f32 v36, v36, -2.0, 1.0
    v_fma_f32 v37, v37, -2.0, 1.0
    v_fma_f32 v38, v38, -2.0, 1.0
    v_fma_f32 v39, v39, -2.0, 1.0
    v_cvt_pk_bf16_f32 v224, v32, v33
    v_cvt_pk_bf16_f32 v225, v34, v35
    v_cvt_pk_bf16_f32 v226, v36, v37
    v_cvt_pk_bf16_f32 v227, v38, v39
    ds_write_b128 v248, v[224:227] offset:16384
    v_fma_f32 v40, v200, v72, 1.0
    v_fma_f32 v41, v201, v73, 1.0
    v_fma_f32 v42, v202, v74, 1.0
    v_fma_f32 v43, v203, v75, 1.0
    v_fma_f32 v44, v204, v76, 1.0
    v_fma_f32 v45, v205, v77, 1.0
    v_fma_f32 v46, v206, v78, 1.0
    v_fma_f32 v47, v207, v79, 1.0
    v_rcp_f32 v40, v40
    v_rcp_f32 v41, v41
    v_rcp_f32 v42, v42
    v_rcp_f32 v43, v43
    v_rcp_f32 v44, v44
    v_rcp_f32 v45, v45
    v_rcp_f32 v46, v46
    v_rcp_f32 v47, v47
    v_fma_f32 v40, v40, -2.0, 1.0
    v_fma_f32 v41, v41, -2.0, 1.0
    v_fma_f32 v42, v42, -2.0, 1.0
    v_fma_f32 v43, v43, -2.0, 1.0
    v_fma_f32 v44, v44, -2.0, 1.0
    v_fma_f32 v45, v45, -2.0, 1.0
    v_fma_f32 v46, v46, -2.0, 1.0
    v_fma_f32 v47, v47, -2.0, 1.0
    v_cvt_pk_bf16_f32 v228, v40, v41
    v_cvt_pk_bf16_f32 v229, v42, v43
    v_cvt_pk_bf16_f32 v230, v44, v45
    v_cvt_pk_bf16_f32 v231, v46, v47
    ds_write_b128 v248, v[228:231] offset:17408
    v_fma_f32 v48, v208, v80, 1.0
    v_fma_f32 v49, v209, v81, 1.0
    v_fma_f32 v50, v210, v82, 1.0
    v_fma_f32 v51, v211, v83, 1.0
    v_fma_f32 v52, v212, v84, 1.0
    v_fma_f32 v53, v213, v85, 1.0
    v_fma_f32 v54, v214, v86, 1.0
    v_fma_f32 v55, v215, v87, 1.0
    v_rcp_f32 v48, v48
    v_rcp_f32 v49, v49
    v_rcp_f32 v50, v50
    v_rcp_f32 v51, v51
    v_rcp_f32 v52, v52
    v_rcp_f32 v53, v53
    v_rcp_f32 v54, v54
    v_rcp_f32 v55, v55
    v_fma_f32 v48, v48, -2.0, 1.0
    v_fma_f32 v49, v49, -2.0, 1.0
    v_fma_f32 v50, v50, -2.0, 1.0
    v_fma_f32 v51, v51, -2.0, 1.0
    v_fma_f32 v52, v52, -2.0, 1.0
    v_fma_f32 v53, v53, -2.0, 1.0
    v_fma_f32 v54, v54, -2.0, 1.0
    v_fma_f32 v55, v55, -2.0, 1.0
    v_cvt_pk_bf16_f32 v232, v48, v49
    v_cvt_pk_bf16_f32 v233, v50, v51
    v_cvt_pk_bf16_f32 v234, v52, v53
    v_cvt_pk_bf16_f32 v235, v54, v55
    ds_write_b128 v248, v[232:235] offset:18432
    v_fma_f32 v56, v216, v88, 1.0
    v_fma_f32 v57, v217, v89, 1.0
    v_fma_f32 v58, v218, v90, 1.0
    v_fma_f32 v59, v219, v91, 1.0
    v_fma_f32 v60, v220, v92, 1.0
    v_fma_f32 v61, v221, v93, 1.0
    v_fma_f32 v62, v222, v94, 1.0
    v_fma_f32 v63, v223, v95, 1.0
    ds_read_b128 v[64:67], v246 offset:0
    ds_read_b128 v[68:71], v246 offset:16
    ds_read_b128 v[72:75], v246 offset:64
    ds_read_b128 v[76:79], v246 offset:80
    ds_read_b128 v[80:83], v246 offset:128
    ds_read_b128 v[84:87], v246 offset:144
    ds_read_b128 v[88:91], v246 offset:192
    ds_read_b128 v[92:95], v246 offset:208
    v_add_u32 v246, 1088, v246
    v_rcp_f32 v56, v56
    v_rcp_f32 v57, v57
    v_rcp_f32 v58, v58
    v_rcp_f32 v59, v59
    v_rcp_f32 v60, v60
    v_rcp_f32 v61, v61
    v_rcp_f32 v62, v62
    v_rcp_f32 v63, v63
    v_fma_f32 v56, v56, -2.0, 1.0
    v_fma_f32 v57, v57, -2.0, 1.0
    v_fma_f32 v58, v58, -2.0, 1.0
    v_fma_f32 v59, v59, -2.0, 1.0
    v_fma_f32 v60, v60, -2.0, 1.0
    v_fma_f32 v61, v61, -2.0, 1.0
    v_fma_f32 v62, v62, -2.0, 1.0
    v_fma_f32 v63, v63, -2.0, 1.0
    v_cvt_pk_bf16_f32 v236, v56, v57
    v_cvt_pk_bf16_f32 v237, v58, v59
    v_cvt_pk_bf16_f32 v238, v60, v61
    v_cvt_pk_bf16_f32 v239, v62, v63
    ds_write_b128 v248, v[236:239] offset:19456
    s_waitcnt lgkmcnt(0)
    s_barrier
    s_sub_u32 s22, s22, 1
    s_cmp_lg_u32 s22, 0
    s_cbranch_scc1 L_joint_kernel_tloop1
    s_branch L_joint_kernel_fin
L_joint_kernel_tslow:
    s_waitcnt vmcnt(0)
    buffer_load_dwordx4 v[192:195], v249, s[40:43], s38 offen offset:0
    buffer_load_dwordx4 v[196:199], v249, s[40:43], s38 offen offset:16
    buffer_load_dwordx4 v[200:203], v249, s[40:43], s38 offen offset:64
    buffer_load_dwordx4 v[204:207], v249, s[40:43], s38 offen offset:80
    buffer_load_dwordx4 v[208:211], v249, s[40:43], s38 offen offset:128
    buffer_load_dwordx4 v[212:215], v249, s[40:43], s38 offen offset:144
    buffer_load_dwordx4 v[216:219], v249, s[40:43], s38 offen offset:192
    buffer_load_dwordx4 v[220:223], v249, s[40:43], s38 offen offset:208
    s_waitcnt lgkmcnt(0)
    ds_write_b128 v247, v[0:3] offset:0
    ds_write_b128 v247, v[4:7] offset:16
    ds_write_b128 v247, v[8:11] offset:64
    ds_write_b128 v247, v[12:15] offset:80
    ds_write_b128 v247, v[16:19] offset:128
    ds_write_b128 v247, v[20:23] offset:144
    ds_write_b128 v247, v[24:27] offset:192
    ds_write_b128 v247, v[28:31] offset:208
    s_waitcnt lgkmcnt(4)
    ds_read_b128 v[64:67], v246 offset:0
    ds_read_b128 v[68:71], v246 offset:16
    ds_read_b128 v[72:75], v246 offset:64
    ds_read_b128 v[76:79], v246 offset:80
    ds_read_b128 v[80:83], v246 offset:128
    ds_read_b128 v[84:87], v246 offset:144
    ds_read_b128 v[88:91], v246 offset:192
    ds_read_b128 v[92:95], v246 offset:208
    v_add_u32 v246, 1088, v246
    s_waitcnt vmcnt(0) lgkmcnt(0)
L_joint_kernel_tloop0:
    v_add_f32 v32, v192, v64
    v_add_f32 v33, v193, v65
    v_add_f32 v34, v194, v66
    v_add_f32 v35, v195, v67
    v_add_f32 v36, v196, v68
    v_add_f32 v37, v197, v69
    v_add_f32 v38, v198, v70
    v_add_f32 v39, v199, v71
    v_exp_f32 v32, v32
    v_exp_f32 v33, v33
    v_exp_f32 v34, v34
    v_exp_f32 v35, v35
    v_exp_f32 v36, v36
    v_exp_f32 v37, v37
    v_exp_f32 v38, v38
    v_exp_f32 v39, v39
    v_add_f32 v32, 1.0, v32
    v_add_f32 v33, 1.0, v33
    v_add_f32 v34, 1.0, v34
    v_add_f32 v35, 1.0, v35
    v_add_f32 v36, 1.0, v36
    v_add_f32 v37, 1.0, v37
    v_add_f32 v38, 1.0, v38
    v_add_f32 v39, 1.0, v39
    v_rcp_f32 v32, v32
    v_rcp_f32 v33, v33
    v_rcp_f32 v34, v34
    v_rcp_f32 v35, v35
    v_rcp_f32 v36, v36
    v_rcp_f32 v37, v37
    v_rcp_f32 v38, v38
    v_rcp_f32 v39, v39
    v_fma_f32 v32, v32, -2.0, 1.0
    v_fma_f32 v33, v33, -2.0, 1.0
    v_fma_f32 v34, v34, -2.0, 1.0
    v_fma_f32 v35, v35, -2.0, 1.0
    v_fma_f32 v36, v36, -2.0, 1.0
    v_fma_f32 v37, v37, -2.0, 1.0
    v_fma_f32 v38, v38, -2.0, 1.0
    v_fma_f32 v39, v39, -2.0, 1.0
    v_cvt_pk_bf16_f32 v224, v32, v33
    v_cvt_pk_bf16_f32 v225, v34, v35
    v_cvt_pk_bf16_f32 v226, v36, v37
    v_cvt_pk_bf16_f32 v227, v38, v39
    ds_write_b128 v248, v[224:227] offset:0
    v_add_f32 v40, v200, v72
    v_add_f32 v41, v201, v73
    v_add_f32 v42, v202, v74
    v_add_f32 v43, v203, v75
    v_add_f32 v44, v204, v76
    v_add_f32 v45, v205, v77
    v_add_f32 v46, v206, v78
    v_add_f32 v47, v207, v79
    v_exp_f32 v40, v40
    v_exp_f32 v41, v41
    v_exp_f32 v42, v42
    v_exp_f32 v43, v43
    v_exp_f32 v44, v44
    v_exp_f32 v45, v45
    v_exp_f32 v46, v46
    v_exp_f32 v47, v47
    v_add_f32 v40, 1.0, v40
    v_add_f32 v41, 1.0, v41
    v_add_f32 v42, 1.0, v42
    v_add_f32 v43, 1.0, v43
    v_add_f32 v44, 1.0, v44
    v_add_f32 v45, 1.0, v45
    v_add_f32 v46, 1.0, v46
    v_add_f32 v47, 1.0, v47
    v_rcp_f32 v40, v40
    v_rcp_f32 v41, v41
    v_rcp_f32 v42, v42
    v_rcp_f32 v43, v43
    v_rcp_f32 v44, v44
    v_rcp_f32 v45, v45
    v_rcp_f32 v46, v46
    v_rcp_f32 v47, v47
    v_fma_f32 v40, v40, -2.0, 1.0
    v_fma_f32 v41, v41, -2.0, 1.0
    v_fma_f32 v42, v42, -2.0, 1.0
    v_fma_f32 v43, v43, -2.0, 1.0
    v_fma_f32 v44, v44, -2.0, 1.0
    v_fma_f32 v45, v45, -2.0, 1.0
    v_fma_f32 v46, v46, -2.0, 1.0
    v_fma_f32 v47, v47, -2.0, 1.0
    v_cvt_pk_bf16_f32 v228, v40, v41
    v_cvt_pk_bf16_f32 v229, v42, v43
    v_cvt_pk_bf16_f32 v230, v44, v45
    v_cvt_pk_bf16_f32 v231, v46, v47
    ds_write_b128 v248, v[228:231] offset:1024
    v_add_f32 v48, v208, v80
    v_add_f32 v49, v209, v81
    v_add_f32 v50, v210, v82
    v_add_f32 v51, v211, v83
    v_add_f32 v52, v212, v84
    v_add_f32 v53, v213, v85
    v_add_f32 v54, v214, v86
    v_add_f32 v55, v215, v87
    v_exp_f32 v48, v48
    v_exp_f32 v49, v49
    v_exp_f32 v50, v50
    v_exp_f32 v51, v51
    v_exp_f32 v52, v52
    v_exp_f32 v53, v53
    v_exp_f32 v54, v54
    v_exp_f32 v55, v55
    v_add_f32 v48, 1.0, v48
    v_add_f32 v49, 1.0, v49
    v_add_f32 v50, 1.0, v50
    v_add_f32 v51, 1.0, v51
    v_add_f32 v52, 1.0, v52
    v_add_f32 v53, 1.0, v53
    v_add_f32 v54, 1.0, v54
    v_add_f32 v55, 1.0, v55
    v_rcp_f32 v48, v48
    v_rcp_f32 v49, v49
    v_rcp_f32 v50, v50
    v_rcp_f32 v51, v51
    v_rcp_f32 v52, v52
    v_rcp_f32 v53, v53
    v_rcp_f32 v54, v54
    v_rcp_f32 v55, v55
    v_fma_f32 v48, v48, -2.0, 1.0
    v_fma_f32 v49, v49, -2.0, 1.0
    v_fma_f32 v50, v50, -2.0, 1.0
    v_fma_f32 v51, v51, -2.0, 1.0
    v_fma_f32 v52, v52, -2.0, 1.0
    v_fma_f32 v53, v53, -2.0, 1.0
    v_fma_f32 v54, v54, -2.0, 1.0
    v_fma_f32 v55, v55, -2.0, 1.0
    v_cvt_pk_bf16_f32 v232, v48, v49
    v_cvt_pk_bf16_f32 v233, v50, v51
    v_cvt_pk_bf16_f32 v234, v52, v53
    v_cvt_pk_bf16_f32 v235, v54, v55
    ds_write_b128 v248, v[232:235] offset:2048
    v_add_f32 v56, v216, v88
    v_add_f32 v57, v217, v89
    v_add_f32 v58, v218, v90
    v_add_f32 v59, v219, v91
    v_add_f32 v60, v220, v92
    v_add_f32 v61, v221, v93
    v_add_f32 v62, v222, v94
    v_add_f32 v63, v223, v95
    ds_read_b128 v[64:67], v246 offset:0
    ds_read_b128 v[68:71], v246 offset:16
    ds_read_b128 v[72:75], v246 offset:64
    ds_read_b128 v[76:79], v246 offset:80
    ds_read_b128 v[80:83], v246 offset:128
    ds_read_b128 v[84:87], v246 offset:144
    ds_read_b128 v[88:91], v246 offset:192
    ds_read_b128 v[92:95], v246 offset:208
    v_add_u32 v246, 1088, v246
    v_exp_f32 v56, v56
    v_exp_f32 v57, v57
    v_exp_f32 v58, v58
    v_exp_f32 v59, v59
    v_exp_f32 v60, v60
    v_exp_f32 v61, v61
    v_exp_f32 v62, v62
    v_exp_f32 v63, v63
    v_add_f32 v56, 1.0, v56
    v_add_f32 v57, 1.0, v57
    v_add_f32 v58, 1.0, v58
    v_add_f32 v59, 1.0, v59
    v_add_f32 v60, 1.0, v60
    v_add_f32 v61, 1.0, v61
    v_add_f32 v62, 1.0, v62
    v_add_f32 v63, 1.0, v63
    v_rcp_f32 v56, v56
    v_rcp_f32 v57, v57
    v_rcp_f32 v58, v58
    v_rcp_f32 v59, v59
    v_rcp_f32 v60, v60
    v_rcp_f32 v61, v61
    v_rcp_f32 v62, v62
    v_rcp_f32 v63, v63
    v_fma_f32 v56, v56, -2.0, 1.0
    v_fma_f32 v57, v57, -2.0, 1.0
    v_fma_f32 v58, v58, -2.0, 1.0
    v_fma_f32 v59, v59, -2.0, 1.0
    v_fma_f32 v60, v60, -2.0, 1.0
    v_fma_f32 v61, v61, -2.0, 1.0
    v_fma_f32 v62, v62, -2.0, 1.0
    v_fma_f32 v63, v63, -2.0, 1.0
    v_cvt_pk_bf16_f32 v236, v56, v57
    v_cvt_pk_bf16_f32 v237, v58, v59
    v_cvt_pk_bf16_f32 v238, v60, v61
    v_cvt_pk_bf16_f32 v239, v62, v63
    ds_write_b128 v248, v[236:239] offset:3072
    s_waitcnt lgkmcnt(0)
    s_barrier
    v_add_f32 v32, v192, v64
    v_add_f32 v33, v193, v65
    v_add_f32 v34, v194, v66
    v_add_f32 v35, v195, v67
    v_add_f32 v36, v196, v68
    v_add_f32 v37, v197, v69
    v_add_f32 v38, v198, v70
    v_add_f32 v39, v199, v71
    v_exp_f32 v32, v32
    v_exp_f32 v33, v33
    v_exp_f32 v34, v34
    v_exp_f32 v35, v35
    v_exp_f32 v36, v36
    v_exp_f32 v37, v37
    v_exp_f32 v38, v38
    v_exp_f32 v39, v39
    v_add_f32 v32, 1.0, v32
    v_add_f32 v33, 1.0, v33
    v_add_f32 v34, 1.0, v34
    v_add_f32 v35, 1.0, v35
    v_add_f32 v36, 1.0, v36
    v_add_f32 v37, 1.0, v37
    v_add_f32 v38, 1.0, v38
    v_add_f32 v39, 1.0, v39
    v_rcp_f32 v32, v32
    v_rcp_f32 v33, v33
    v_rcp_f32 v34, v34
    v_rcp_f32 v35, v35
    v_rcp_f32 v36, v36
    v_rcp_f32 v37, v37
    v_rcp_f32 v38, v38
    v_rcp_f32 v39, v39
    v_fma_f32 v32, v32, -2.0, 1.0
    v_fma_f32 v33, v33, -2.0, 1.0
    v_fma_f32 v34, v34, -2.0, 1.0
    v_fma_f32 v35, v35, -2.0, 1.0
    v_fma_f32 v36, v36, -2.0, 1.0
    v_fma_f32 v37, v37, -2.0, 1.0
    v_fma_f32 v38, v38, -2.0, 1.0
    v_fma_f32 v39, v39, -2.0, 1.0
    v_cvt_pk_bf16_f32 v224, v32, v33
    v_cvt_pk_bf16_f32 v225, v34, v35
    v_cvt_pk_bf16_f32 v226, v36, v37
    v_cvt_pk_bf16_f32 v227, v38, v39
    ds_write_b128 v248, v[224:227] offset:16384
    v_add_f32 v40, v200, v72
    v_add_f32 v41, v201, v73
    v_add_f32 v42, v202, v74
    v_add_f32 v43, v203, v75
    v_add_f32 v44, v204, v76
    v_add_f32 v45, v205, v77
    v_add_f32 v46, v206, v78
    v_add_f32 v47, v207, v79
    v_exp_f32 v40, v40
    v_exp_f32 v41, v41
    v_exp_f32 v42, v42
    v_exp_f32 v43, v43
    v_exp_f32 v44, v44
    v_exp_f32 v45, v45
    v_exp_f32 v46, v46
    v_exp_f32 v47, v47
    v_add_f32 v40, 1.0, v40
    v_add_f32 v41, 1.0, v41
    v_add_f32 v42, 1.0, v42
    v_add_f32 v43, 1.0, v43
    v_add_f32 v44, 1.0, v44
    v_add_f32 v45, 1.0, v45
    v_add_f32 v46, 1.0, v46
    v_add_f32 v47, 1.0, v47
    v_rcp_f32 v40, v40
    v_rcp_f32 v41, v41
    v_rcp_f32 v42, v42
    v_rcp_f32 v43, v43
    v_rcp_f32 v44, v44
    v_rcp_f32 v45, v45
    v_rcp_f32 v46, v46
    v_rcp_f32 v47, v47
    v_fma_f32 v40, v40, -2.0, 1.0
    v_fma_f32 v41, v41, -2.0, 1.0
    v_fma_f32 v42, v42, -2.0, 1.0
    v_fma_f32 v43, v43, -2.0, 1.0
    v_fma_f32 v44, v44, -2.0, 1.0
    v_fma_f32 v45, v45, -2.0, 1.0
    v_fma_f32 v46, v46, -2.0, 1.0
    v_fma_f32 v47, v47, -2.0, 1.0
    v_cvt_pk_bf16_f32 v228, v40, v41
    v_cvt_pk_bf16_f32 v229, v42, v43
    v_cvt_pk_bf16_f32 v230, v44, v45
    v_cvt_pk_bf16_f32 v231, v46, v47
    ds_write_b128 v248, v[228:231] offset:17408
    v_add_f32 v48, v208, v80
    v_add_f32 v49, v209, v81
    v_add_f32 v50, v210, v82
    v_add_f32 v51, v211, v83
    v_add_f32 v52, v212, v84
    v_add_f32 v53, v213, v85
    v_add_f32 v54, v214, v86
    v_add_f32 v55, v215, v87
    v_exp_f32 v48, v48
    v_exp_f32 v49, v49
    v_exp_f32 v50, v50
    v_exp_f32 v51, v51
    v_exp_f32 v52, v52
    v_exp_f32 v53, v53
    v_exp_f32 v54, v54
    v_exp_f32 v55, v55
    v_add_f32 v48, 1.0, v48
    v_add_f32 v49, 1.0, v49
    v_add_f32 v50, 1.0, v50
    v_add_f32 v51, 1.0, v51
    v_add_f32 v52, 1.0, v52
    v_add_f32 v53, 1.0, v53
    v_add_f32 v54, 1.0, v54
    v_add_f32 v55, 1.0, v55
    v_rcp_f32 v48, v48
    v_rcp_f32 v49, v49
    v_rcp_f32 v50, v50
    v_rcp_f32 v51, v51
    v_rcp_f32 v52, v52
    v_rcp_f32 v53, v53
    v_rcp_f32 v54, v54
    v_rcp_f32 v55, v55
    v_fma_f32 v48, v48, -2.0, 1.0
    v_fma_f32 v49, v49, -2.0, 1.0
    v_fma_f32 v50, v50, -2.0, 1.0
    v_fma_f32 v51, v51, -2.0, 1.0
    v_fma_f32 v52, v52, -2.0, 1.0
    v_fma_f32 v53, v53, -2.0, 1.0
    v_fma_f32 v54, v54, -2.0, 1.0
    v_fma_f32 v55, v55, -2.0, 1.0
    v_cvt_pk_bf16_f32 v232, v48, v49
    v_cvt_pk_bf16_f32 v233, v50, v51
    v_cvt_pk_bf16_f32 v234, v52, v53
    v_cvt_pk_bf16_f32 v235, v54, v55
    ds_write_b128 v248, v[232:235] offset:18432
    v_add_f32 v56, v216, v88
    v_add_f32 v57, v217, v89
    v_add_f32 v58, v218, v90
    v_add_f32 v59, v219, v91
    v_add_f32 v60, v220, v92
    v_add_f32 v61, v221, v93
    v_add_f32 v62, v222, v94
    v_add_f32 v63, v223, v95
    ds_read_b128 v[64:67], v246 offset:0
    ds_read_b128 v[68:71], v246 offset:16
    ds_read_b128 v[72:75], v246 offset:64
    ds_read_b128 v[76:79], v246 offset:80
    ds_read_b128 v[80:83], v246 offset:128
    ds_read_b128 v[84:87], v246 offset:144
    ds_read_b128 v[88:91], v246 offset:192
    ds_read_b128 v[92:95], v246 offset:208
    v_add_u32 v246, 1088, v246
    v_exp_f32 v56, v56
    v_exp_f32 v57, v57
    v_exp_f32 v58, v58
    v_exp_f32 v59, v59
    v_exp_f32 v60, v60
    v_exp_f32 v61, v61
    v_exp_f32 v62, v62
    v_exp_f32 v63, v63
    v_add_f32 v56, 1.0, v56
    v_add_f32 v57, 1.0, v57
    v_add_f32 v58, 1.0, v58
    v_add_f32 v59, 1.0, v59
    v_add_f32 v60, 1.0, v60
    v_add_f32 v61, 1.0, v61
    v_add_f32 v62, 1.0, v62
    v_add_f32 v63, 1.0, v63
    v_rcp_f32 v56, v56
    v_rcp_f32 v57, v57
    v_rcp_f32 v58, v58
    v_rcp_f32 v59, v59
    v_rcp_f32 v60, v60
    v_rcp_f32 v61, v61
    v_rcp_f32 v62, v62
    v_rcp_f32 v63, v63
    v_fma_f32 v56, v56, -2.0, 1.0
    v_fma_f32 v57, v57, -2.0, 1.0
    v_fma_f32 v58, v58, -2.0, 1.0
    v_fma_f32 v59, v59, -2.0, 1.0
    v_fma_f32 v60, v60, -2.0, 1.0
    v_fma_f32 v61, v61, -2.0, 1.0
    v_fma_f32 v62, v62, -2.0, 1.0
    v_fma_f32 v63, v63, -2.0, 1.0
    v_cvt_pk_bf16_f32 v236, v56, v57
    v_cvt_pk_bf16_f32 v237, v58, v59
    v_cvt_pk_bf16_f32 v238, v60, v61
    v_cvt_pk_bf16_f32 v239, v62, v63
    ds_write_b128 v248, v[236:239] offset:19456
    s_waitcnt lgkmcnt(0)
    s_barrier
    s_sub_u32 s22, s22, 1
    s_cmp_lg_u32 s22, 0
    s_cbranch_scc1 L_joint_kernel_tloop0
L_joint_kernel_fin:
L_joint_kernel_done:
    s_endpgm
.section .rodata,"a"
.p2align 6
.amdhsa_kernel prep_kernel
  .amdhsa_next_free_vgpr 128
  .amdhsa_next_free_sgpr 102
  .amdhsa_accum_offset 128
  .amdhsa_group_segment_fixed_size 0
  .amdhsa_kernarg_size 80
  .amdhsa_user_sgpr_count 2
  .amdhsa_user_sgpr_kernarg_segment_ptr 1
  .amdhsa_system_sgpr_workgroup_id_x 1
.end_amdhsa_kernel
.p2align 6
.amdhsa_kernel conv1_kernel
  .amdhsa_next_free_vgpr 128
  .amdhsa_next_free_sgpr 102
  .amdhsa_accum_offset 128
  .amdhsa_group_segment_fixed_size 0
  .amdhsa_kernarg_size 80
  .amdhsa_user_sgpr_count 2
  .amdhsa_user_sgpr_kernarg_segment_ptr 1
  .amdhsa_system_sgpr_workgroup_id_x 1
.end_amdhsa_kernel
.p2align 6
.amdhsa_kernel conv2_kernel
  .amdhsa_next_free_vgpr 128
  .amdhsa_next_free_sgpr 102
  .amdhsa_accum_offset 128
  .amdhsa_group_segment_fixed_size 0
  .amdhsa_kernarg_size 80
  .amdhsa_user_sgpr_count 2
  .amdhsa_user_sgpr_kernarg_segment_ptr 1
  .amdhsa_system_sgpr_workgroup_id_x 1
.end_amdhsa_kernel
.p2align 6
.amdhsa_kernel joint_kernel
  .amdhsa_next_free_vgpr 256
  .amdhsa_next_free_sgpr 102
  .amdhsa_accum_offset 256
  .amdhsa_group_segment_fixed_size 0
  .amdhsa_kernarg_size 80
  .amdhsa_user_sgpr_count 2
  .amdhsa_user_sgpr_kernarg_segment_ptr 1
  .amdhsa_system_sgpr_workgroup_id_x 1
.end_amdhsa_kernel
```

```asm
; @launch kernel=prep_kernel grid=(268,1,1) block=(256,1,1) lds=32768
; @launch kernel=conv1_kernel grid=(256,1,1) block=(1024,1,1) lds=162816
; @launch kernel=conv2_kernel grid=(256,1,1) block=(1024,1,1) lds=162816
; @launch kernel=joint_kernel grid=(250,1,1) block=(512,1,1) lds=97152
.amdgcn_target "amdgcn-amd-amdhsa--gfx950"
.text
.globl prep_kernel
.p2align 8
.type prep_kernel,@function
prep_kernel:
    s_cmp_ge_u32 s2, 268
    s_cbranch_scc1 L_prep_kernel_done
    s_getpc_b64 s[62:63]
L_prep_kernel_pc:
    s_and_b32 s3, s2, 8
    s_lshl_b32 s3, s3, 12
    v_lshlrev_b32 v120, 7, v0
    v_add_u32 v120, s3, v120
    v_min_u32 v120, L_joint_kernel_done-L_prep_kernel_pc, v120
    v_mov_b32 v121, s63
    v_add_co_u32 v120, vcc, s62, v120
    v_addc_co_u32 v121, vcc, 0, v121, vcc
    global_load_dword v122, v[120:121], off
    s_cmp_lt_u32 s2, 12
    s_cbranch_scc1 L_prep_kernel_small
    s_sub_u32 s2, s2, 12
    v_readfirstlane_b32 s20, v0
    s_lshr_b32 s20, s20, 6
    s_lshl_b32 s21, s2, 2
    s_add_u32 s20, s20, s21
    v_and_b32 v1, 63, v0
    s_load_dwordx2 s[8:9], s[0:1], 8
    s_load_dwordx2 s[30:31], s[0:1], 72
    s_lshr_b32 s22, s20, 8
    s_bfe_u32 s23, s20, 0x40004
    s_bfe_u32 s24, s20, 0x30001
    s_and_b32 s21, s20, 1
    v_lshrrev_b32 v2, 4, v1
    v_lshlrev_b32 v2, 12, v2
    v_and_b32 v3, 15, v1
    v_lshl_add_u32 v2, v3, 2, v2
    s_lshl_b32 s26, s22, 3
    s_lshr_b32 s27, s23, 3
    s_add_u32 s26, s26, s27
    s_lshl_b32 s26, s26, 17
    s_and_b32 s27, s23, 7
    s_lshl_b32 s27, s27, 14
    s_add_u32 s26, s26, s27
    s_lshl_b32 s27, s24, 6
    s_add_u32 s26, s26, s27
    s_mov_b32 s10, 4063232
    s_mov_b32 s11, 0x00020000
    s_add_u32 s37, s26, 262144
    s_add_u32 s38, s26, 524288
    s_add_u32 s39, s26, 786432
    s_waitcnt lgkmcnt(0)
    buffer_load_dword v16, v2, s[8:11], s26 offen offset:0
    buffer_load_dword v17, v2, s[8:11], s26 offen offset:512
    buffer_load_dword v24, v2, s[8:11], s37 offen offset:0
    buffer_load_dword v25, v2, s[8:11], s37 offen offset:512
    buffer_load_dword v32, v2, s[8:11], s38 offen offset:0
    buffer_load_dword v33, v2, s[8:11], s38 offen offset:512
    buffer_load_dword v40, v2, s[8:11], s39 offen offset:0
    buffer_load_dword v41, v2, s[8:11], s39 offen offset:512
    buffer_load_dword v18, v2, s[8:11], s26 offen offset:1024
    buffer_load_dword v19, v2, s[8:11], s26 offen offset:1536
    buffer_load_dword v26, v2, s[8:11], s37 offen offset:1024
    buffer_load_dword v27, v2, s[8:11], s37 offen offset:1536
    buffer_load_dword v34, v2, s[8:11], s38 offen offset:1024
    buffer_load_dword v35, v2, s[8:11], s38 offen offset:1536
    buffer_load_dword v42, v2, s[8:11], s39 offen offset:1024
    buffer_load_dword v43, v2, s[8:11], s39 offen offset:1536
    buffer_load_dword v20, v2, s[8:11], s26 offen offset:2048
    buffer_load_dword v21, v2, s[8:11], s26 offen offset:2560
    buffer_load_dword v28, v2, s[8:11], s37 offen offset:2048
    buffer_load_dword v29, v2, s[8:11], s37 offen offset:2560
    buffer_load_dword v36, v2, s[8:11], s38 offen offset:2048
    buffer_load_dword v37, v2, s[8:11], s38 offen offset:2560
    buffer_load_dword v44, v2, s[8:11], s39 offen offset:2048
    buffer_load_dword v45, v2, s[8:11], s39 offen offset:2560
    buffer_load_dword v22, v2, s[8:11], s26 offen offset:3072
    buffer_load_dword v23, v2, s[8:11], s26 offen offset:3584
    buffer_load_dword v30, v2, s[8:11], s37 offen offset:3072
    buffer_load_dword v31, v2, s[8:11], s37 offen offset:3584
    buffer_load_dword v38, v2, s[8:11], s38 offen offset:3072
    buffer_load_dword v39, v2, s[8:11], s38 offen offset:3584
    buffer_load_dword v46, v2, s[8:11], s39 offen offset:3072
    buffer_load_dword v47, v2, s[8:11], s39 offen offset:3584
    s_add_u32 s12, s30, 0
    s_addc_u32 s13, s31, 0
    s_mov_b32 s14, 7340032
    s_mov_b32 s15, 0x00020000
    v_lshlrev_b32 v4, 4, v1
    s_lshl_b32 s27, s24, 4
    s_add_u32 s27, s27, s23
    s_mul_i32 s27, s27, 57344
    s_lshl_b32 s28, s22, 11
    s_add_u32 s27, s27, s28
    s_lshl_b32 s28, s21, 10
    s_add_u32 s27, s27, s28
    s_cmp_eq_u32 s21, 0
    s_mov_b32 s32, 0x07060302
    s_cselect_b32 s32, 0x05040100, s32
    s_mov_b32 s33, 0x03020c0c
    s_cselect_b32 s33, 0x01000c0c, s33
    s_mov_b32 s35, 0x3d2aaaab
    s_mov_b32 s36, 0x3c638e39
    s_waitcnt vmcnt(24)
    v_perm_b32 v72, v17, v16, s32
    v_perm_b32 v48, v41, v40, s32
    v_perm_b32 v76, v76, v40, s33
    v_perm_b32 v84, v84, v41, s33
    v_perm_b32 v77, v77, v32, s33
    v_perm_b32 v85, v85, v33, s33
    v_perm_b32 v78, v78, v24, s33
    v_perm_b32 v86, v86, v25, s33
    v_perm_b32 v79, v79, v16, s33
    v_perm_b32 v87, v87, v17, s33
    v_add_f32 v80, v76, v78
    v_add_f32 v88, v84, v86
    v_add_f32 v81, v77, v79
    v_add_f32 v89, v85, v87
    v_fma_f32 v82, v78, 4.0, v76
    v_fma_f32 v90, v86, 4.0, v84
    v_fma_f32 v83, v79, 4.0, v77
    v_fma_f32 v91, v87, 4.0, v85
    v_add_f32 v77, v80, v81
    v_add_f32 v85, v88, v89
    v_sub_f32 v78, v80, v81
    v_sub_f32 v86, v88, v89
    v_fma_f32 v79, v83, 2.0, v82
    v_fma_f32 v87, v91, 2.0, v90
    v_fma_f32 v82, v83, -2.0, v82
    v_fma_f32 v90, v91, -2.0, v90
    v_fmamk_f32 v80, v76, 0x41700000, v82
    v_fmamk_f32 v88, v84, 0x41700000, v90
    v_fmamk_f32 v80, v81, 0x41200000, v80
    v_fmamk_f32 v88, v89, 0x41200000, v88
    v_mul_f32 v77, 0.5, v77
    v_mul_f32 v85, 0.5, v85
    v_mul_f32 v78, 0.5, v78
    v_mul_f32 v86, 0.5, v86
    v_mul_f32 v79, s35, v79
    v_mul_f32 v87, s35, v87
    v_mul_f32 v82, s35, v82
    v_mul_f32 v90, s35, v90
    v_mul_f32 v80, s36, v80
    v_mul_f32 v88, s36, v88
    v_cvt_pk_bf16_f32 v52, v77, v85
    v_cvt_pk_bf16_f32 v56, v78, v86
    v_cvt_pk_bf16_f32 v60, v79, v87
    v_cvt_pk_bf16_f32 v64, v82, v90
    v_cvt_pk_bf16_f32 v68, v80, v88
    s_waitcnt vmcnt(16)
    v_perm_b32 v73, v19, v18, s32
    v_perm_b32 v49, v43, v42, s32
    v_perm_b32 v76, v76, v42, s33
    v_perm_b32 v84, v84, v43, s33
    v_perm_b32 v77, v77, v34, s33
    v_perm_b32 v85, v85, v35, s33
    v_perm_b32 v78, v78, v26, s33
    v_perm_b32 v86, v86, v27, s33
    v_perm_b32 v79, v79, v18, s33
    v_perm_b32 v87, v87, v19, s33
    v_add_f32 v80, v76, v78
    v_add_f32 v88, v84, v86
    v_add_f32 v81, v77, v79
    v_add_f32 v89, v85, v87
    v_fma_f32 v82, v78, 4.0, v76
    v_fma_f32 v90, v86, 4.0, v84
    v_fma_f32 v83, v79, 4.0, v77
    v_fma_f32 v91, v87, 4.0, v85
    v_add_f32 v77, v80, v81
    v_add_f32 v85, v88, v89
    v_sub_f32 v78, v80, v81
    v_sub_f32 v86, v88, v89
    v_fma_f32 v79, v83, 2.0, v82
    v_fma_f32 v87, v91, 2.0, v90
    v_fma_f32 v82, v83, -2.0, v82
    v_fma_f32 v90, v91, -2.0, v90
    v_fmamk_f32 v80, v76, 0x41700000, v82
    v_fmamk_f32 v88, v84, 0x41700000, v90
    v_fmamk_f32 v80, v81, 0x41200000, v80
    v_fmamk_f32 v88, v89, 0x41200000, v88
    v_mul_f32 v77, 0.5, v77
    v_mul_f32 v85, 0.5, v85
    v_mul_f32 v78, 0.5, v78
    v_mul_f32 v86, 0.5, v86
    v_mul_f32 v79, s35, v79
    v_mul_f32 v87, s35, v87
    v_mul_f32 v82, s35, v82
    v_mul_f32 v90, s35, v90
    v_mul_f32 v80, s36, v80
    v_mul_f32 v88, s36, v88
    v_cvt_pk_bf16_f32 v53, v77, v85
    v_cvt_pk_bf16_f32 v57, v78, v86
    v_cvt_pk_bf16_f32 v61, v79, v87
    v_cvt_pk_bf16_f32 v65, v82, v90
    v_cvt_pk_bf16_f32 v69, v80, v88
    s_waitcnt vmcnt(8)
    v_perm_b32 v74, v21, v20, s32
    v_perm_b32 v50, v45, v44, s32
    v_perm_b32 v76, v76, v44, s33
    v_perm_b32 v84, v84, v45, s33
    v_perm_b32 v77, v77, v36, s33
    v_perm_b32 v85, v85, v37, s33
    v_perm_b32 v78, v78, v28, s33
    v_perm_b32 v86, v86, v29, s33
    v_perm_b32 v79, v79, v20, s33
    v_perm_b32 v87, v87, v21, s33
    v_add_f32 v80, v76, v78
    v_add_f32 v88, v84, v86
    v_add_f32 v81, v77, v79
    v_add_f32 v89, v85, v87
    v_fma_f32 v82, v78, 4.0, v76
    v_fma_f32 v90, v86, 4.0, v84
    v_fma_f32 v83, v79, 4.0, v77
    v_fma_f32 v91, v87, 4.0, v85
    v_add_f32 v77, v80, v81
    v_add_f32 v85, v88, v89
    v_sub_f32 v78, v80, v81
    v_sub_f32 v86, v88, v89
    v_fma_f32 v79, v83, 2.0, v82
    v_fma_f32 v87, v91, 2.0, v90
    v_fma_f32 v82, v83, -2.0, v82
    v_fma_f32 v90, v91, -2.0, v90
    v_fmamk_f32 v80, v76, 0x41700000, v82
    v_fmamk_f32 v88, v84, 0x41700000, v90
    v_fmamk_f32 v80, v81, 0x41200000, v80
    v_fmamk_f32 v88, v89, 0x41200000, v88
    v_mul_f32 v77, 0.5, v77
    v_mul_f32 v85, 0.5, v85
    v_mul_f32 v78, 0.5, v78
    v_mul_f32 v86, 0.5, v86
    v_mul_f32 v79, s35, v79
    v_mul_f32 v87, s35, v87
    v_mul_f32 v82, s35, v82
    v_mul_f32 v90, s35, v90
    v_mul_f32 v80, s36, v80
    v_mul_f32 v88, s36, v88
    v_cvt_pk_bf16_f32 v54, v77, v85
    v_cvt_pk_bf16_f32 v58, v78, v86
    v_cvt_pk_bf16_f32 v62, v79, v87
    v_cvt_pk_bf16_f32 v66, v82, v90
    v_cvt_pk_bf16_f32 v70, v80, v88
    s_waitcnt vmcnt(0)
    v_perm_b32 v75, v23, v22, s32
    v_perm_b32 v51, v47, v46, s32
    v_perm_b32 v76, v76, v46, s33
    v_perm_b32 v84, v84, v47, s33
    v_perm_b32 v77, v77, v38, s33
    v_perm_b32 v85, v85, v39, s33
    v_perm_b32 v78, v78, v30, s33
    v_perm_b32 v86, v86, v31, s33
    v_perm_b32 v79, v79, v22, s33
    v_perm_b32 v87, v87, v23, s33
    v_add_f32 v80, v76, v78
    v_add_f32 v88, v84, v86
    v_add_f32 v81, v77, v79
    v_add_f32 v89, v85, v87
    v_fma_f32 v82, v78, 4.0, v76
    v_fma_f32 v90, v86, 4.0, v84
    v_fma_f32 v83, v79, 4.0, v77
    v_fma_f32 v91, v87, 4.0, v85
    v_add_f32 v77, v80, v81
    v_add_f32 v85, v88, v89
    v_sub_f32 v78, v80, v81
    v_sub_f32 v86, v88, v89
    v_fma_f32 v79, v83, 2.0, v82
    v_fma_f32 v87, v91, 2.0, v90
    v_fma_f32 v82, v83, -2.0, v82
    v_fma_f32 v90, v91, -2.0, v90
    v_fmamk_f32 v80, v76, 0x41700000, v82
    v_fmamk_f32 v88, v84, 0x41700000, v90
    v_fmamk_f32 v80, v81, 0x41200000, v80
    v_fmamk_f32 v88, v89, 0x41200000, v88
    v_mul_f32 v77, 0.5, v77
    v_mul_f32 v85, 0.5, v85
    v_mul_f32 v78, 0.5, v78
    v_mul_f32 v86, 0.5, v86
    v_mul_f32 v79, s35, v79
    v_mul_f32 v87, s35, v87
    v_mul_f32 v82, s35, v82
    v_mul_f32 v90, s35, v90
    v_mul_f32 v80, s36, v80
    v_mul_f32 v88, s36, v88
    v_cvt_pk_bf16_f32 v55, v77, v85
    v_cvt_pk_bf16_f32 v59, v78, v86
    v_cvt_pk_bf16_f32 v63, v79, v87
    v_cvt_pk_bf16_f32 v67, v82, v90
    v_cvt_pk_bf16_f32 v71, v80, v88
    s_add_u32 s28, s27, 49152
    buffer_store_dwordx4 v[72:75], v4, s[12:15], s28 offen sc1
    s_add_u32 s28, s27, 0
    buffer_store_dwordx4 v[48:51], v4, s[12:15], s28 offen sc1
    s_add_u32 s28, s27, 8192
    buffer_store_dwordx4 v[52:55], v4, s[12:15], s28 offen sc1
    s_add_u32 s28, s27, 16384
    buffer_store_dwordx4 v[56:59], v4, s[12:15], s28 offen sc1
    s_add_u32 s28, s27, 24576
    buffer_store_dwordx4 v[60:63], v4, s[12:15], s28 offen sc1
    s_add_u32 s28, s27, 32768
    buffer_store_dwordx4 v[64:67], v4, s[12:15], s28 offen sc1
    s_add_u32 s28, s27, 40960
    buffer_store_dwordx4 v[68:71], v4, s[12:15], s28 offen sc1
L_prep_kernel_done:
    s_endpgm
L_prep_kernel_small:
    s_load_dwordx4 s[4:7], s[0:1], 24
    s_load_dwordx4 s[36:39], s[0:1], 40
    s_load_dwordx2 s[30:31], s[0:1], 72
    v_readfirstlane_b32 s20, v0
    s_lshr_b32 s20, s20, 6
    s_lshr_b32 s21, s2, 2
    s_and_b32 s22, s2, 3
    v_and_b32 v1, 63, v0
    v_lshrrev_b32 v2, 5, v1
    v_and_b32 v3, 31, v1
    v_lshlrev_b32 v5, 12, v2
    v_lshl_add_u32 v5, v3, 2, v5
    s_lshl_b32 s23, s20, 15
    s_lshl_b32 s24, s22, 7
    s_add_u32 s23, s23, s24
    s_mov_b32 s32, 0x05040100
    s_mov_b32 s33, 0x07060302
    s_waitcnt lgkmcnt(0)
    s_cmp_eq_u32 s21, 1
    s_cselect_b32 s8, s38, s6
    s_cselect_b32 s9, s39, s7
    s_cmp_eq_u32 s21, 2
    s_cselect_b32 s8, s36, s8
    s_cselect_b32 s9, s37, s9
    s_mov_b32 s10, 131072
    s_mov_b32 s11, 0x00020000
    buffer_load_dword v16, v5, s[8:11], s23 offen offset:0
    buffer_load_dword v17, v5, s[8:11], s23 offen offset:512
    buffer_load_dword v18, v5, s[8:11], s23 offen offset:1024
    buffer_load_dword v19, v5, s[8:11], s23 offen offset:1536
    buffer_load_dword v20, v5, s[8:11], s23 offen offset:2048
    buffer_load_dword v21, v5, s[8:11], s23 offen offset:2560
    buffer_load_dword v22, v5, s[8:11], s23 offen offset:3072
    buffer_load_dword v23, v5, s[8:11], s23 offen offset:3584
    s_add_u32 s23, s23, 8192
    buffer_load_dword v24, v5, s[8:11], s23 offen offset:0
    buffer_load_dword v25, v5, s[8:11], s23 offen offset:512
    buffer_load_dword v26, v5, s[8:11], s23 offen offset:1024
    buffer_load_dword v27, v5, s[8:11], s23 offen offset:1536
    buffer_load_dword v28, v5, s[8:11], s23 offen offset:2048
    buffer_load_dword v29, v5, s[8:11], s23 offen offset:2560
    buffer_load_dword v30, v5, s[8:11], s23 offen offset:3072
    buffer_load_dword v31, v5, s[8:11], s23 offen offset:3584
    s_add_u32 s23, s23, 8192
    buffer_load_dword v32, v5, s[8:11], s23 offen offset:0
    buffer_load_dword v33, v5, s[8:11], s23 offen offset:512
    buffer_load_dword v34, v5, s[8:11], s23 offen offset:1024
    buffer_load_dword v35, v5, s[8:11], s23 offen offset:1536
    buffer_load_dword v36, v5, s[8:11], s23 offen offset:2048
    buffer_load_dword v37, v5, s[8:11], s23 offen offset:2560
    buffer_load_dword v38, v5, s[8:11], s23 offen offset:3072
    buffer_load_dword v39, v5, s[8:11], s23 offen offset:3584
    s_add_u32 s23, s23, 8192
    buffer_load_dword v40, v5, s[8:11], s23 offen offset:0
    buffer_load_dword v41, v5, s[8:11], s23 offen offset:512
    buffer_load_dword v42, v5, s[8:11], s23 offen offset:1024
    buffer_load_dword v43, v5, s[8:11], s23 offen offset:1536
    buffer_load_dword v44, v5, s[8:11], s23 offen offset:2048
    buffer_load_dword v45, v5, s[8:11], s23 offen offset:2560
    buffer_load_dword v46, v5, s[8:11], s23 offen offset:3072
    buffer_load_dword v47, v5, s[8:11], s23 offen offset:3584
    s_mov_b32 s16, s4
    s_mov_b32 s17, s5
    s_mov_b32 s18, 8192
    s_mov_b32 s19, 0x00020000
    v_lshlrev_b32 v6, 9, v3
    v_lshl_add_u32 v6, v2, 4, v6
    s_lshl_b32 s24, s20, 7
    buffer_load_dwordx4 v[80:83], v6, s[16:19], s24 offen offset:0
    buffer_load_dwordx4 v[84:87], v6, s[16:19], s24 offen offset:32
    buffer_load_dwordx4 v[88:91], v6, s[16:19], s24 offen offset:64
    buffer_load_dwordx4 v[92:95], v6, s[16:19], s24 offen offset:96
    s_lshl_b32 s24, s21, 17
    s_add_u32 s24, s24, 44040192
    s_add_u32 s12, s30, s24
    s_addc_u32 s13, s31, 0
    s_mov_b32 s14, 131072
    s_mov_b32 s15, 0x00020000
    s_waitcnt vmcnt(0)
    v_perm_b32 v48, v17, v16, s32
    v_perm_b32 v49, v19, v18, s32
    v_perm_b32 v50, v21, v20, s32
    v_perm_b32 v51, v23, v22, s32
    v_perm_b32 v52, v17, v16, s33
    v_perm_b32 v53, v19, v18, s33
    v_perm_b32 v54, v21, v20, s33
    v_perm_b32 v55, v23, v22, s33
    v_perm_b32 v56, v25, v24, s32
    v_perm_b32 v57, v27, v26, s32
    v_perm_b32 v58, v29, v28, s32
    v_perm_b32 v59, v31, v30, s32
    v_perm_b32 v60, v25, v24, s33
    v_perm_b32 v61, v27, v26, s33
    v_perm_b32 v62, v29, v28, s33
    v_perm_b32 v63, v31, v30, s33
    v_perm_b32 v64, v33, v32, s32
    v_perm_b32 v65, v35, v34, s32
    v_perm_b32 v66, v37, v36, s32
    v_perm_b32 v67, v39, v38, s32
    v_perm_b32 v68, v33, v32, s33
    v_perm_b32 v69, v35, v34, s33
    v_perm_b32 v70, v37, v36, s33
    v_perm_b32 v71, v39, v38, s33
    v_perm_b32 v72, v41, v40, s32
    v_perm_b32 v73, v43, v42, s32
    v_perm_b32 v74, v45, v44, s32
    v_perm_b32 v75, v47, v46, s32
    v_perm_b32 v76, v41, v40, s33
    v_perm_b32 v77, v43, v42, s33
    v_perm_b32 v78, v45, v44, s33
    v_perm_b32 v79, v47, v46, s33
    s_cmp_eq_u32 s21, 2
    s_cbranch_scc1 L_prep_kernel_ge
    v_lshlrev_b32 v4, 4, v1
    s_lshl_b32 s24, s22, 15
    s_lshl_b32 s25, s20, 13
    s_add_u32 s24, s24, s25
    s_add_u32 s25, s24, 4096
    buffer_store_dwordx4 v[48:51], v4, s[12:15], s24 offen offset:0 sc1
    buffer_store_dwordx4 v[52:55], v4, s[12:15], s24 offen offset:1024 sc1
    buffer_store_dwordx4 v[56:59], v4, s[12:15], s24 offen offset:2048 sc1
    buffer_store_dwordx4 v[60:63], v4, s[12:15], s24 offen offset:3072 sc1
    buffer_store_dwordx4 v[64:67], v4, s[12:15], s25 offen offset:0 sc1
    buffer_store_dwordx4 v[68:71], v4, s[12:15], s25 offen offset:1024 sc1
    buffer_store_dwordx4 v[72:75], v4, s[12:15], s25 offen offset:2048 sc1
    buffer_store_dwordx4 v[76:79], v4, s[12:15], s25 offen offset:3072 sc1
    s_endpgm
L_prep_kernel_ge:
    v_mfma_f32_32x32x16_bf16 v[96:111], v[48:51], v[80:83], 0
    v_mfma_f32_32x32x16_bf16 v[112:127], v[52:55], v[80:83], 0
    v_mfma_f32_32x32x16_bf16 v[96:111], v[56:59], v[84:87], v[96:111]
    v_mfma_f32_32x32x16_bf16 v[112:127], v[60:63], v[84:87], v[112:127]
    v_mfma_f32_32x32x16_bf16 v[96:111], v[64:67], v[88:91], v[96:111]
    v_mfma_f32_32x32x16_bf16 v[112:127], v[68:71], v[88:91], v[112:127]
    v_mfma_f32_32x32x16_bf16 v[96:111], v[72:75], v[92:95], v[96:111]
    v_mfma_f32_32x32x16_bf16 v[112:127], v[76:79], v[92:95], v[112:127]
    v_lshlrev_b32 v4, 4, v1
    s_lshl_b32 s24, s20, 13
    v_add_u32 v7, s24, v4
    s_nop 15
    ds_write_b128 v7, v[96:99] offset:0
    ds_write_b128 v7, v[100:103] offset:1024
    ds_write_b128 v7, v[104:107] offset:2048
    ds_write_b128 v7, v[108:111] offset:3072
    ds_write_b128 v7, v[112:115] offset:4096
    ds_write_b128 v7, v[116:119] offset:5120
    ds_write_b128 v7, v[120:123] offset:6144
    ds_write_b128 v7, v[124:127] offset:7168
    s_waitcnt lgkmcnt(0)
    s_barrier
    s_lshl_b32 s24, s20, 10
    v_add_u32 v7, s24, v4
    ds_read_b128 v[16:19], v7 offset:0
    ds_read_b128 v[20:23], v7 offset:4096
    ds_read_b128 v[24:27], v7 offset:8192
    ds_read_b128 v[28:31], v7 offset:12288
    ds_read_b128 v[32:35], v7 offset:16384
    ds_read_b128 v[36:39], v7 offset:20480
    ds_read_b128 v[40:43], v7 offset:24576
    ds_read_b128 v[44:47], v7 offset:28672
    s_mov_b32 s14, 16384
    v_lshlrev_b32 v8, 10, v3
    v_lshl_add_u32 v8, v2, 5, v8
    s_lshl_b32 s24, s22, 8
    s_lshl_b32 s25, s20, 6
    s_add_u32 s24, s24, s25
    s_mov_b32 s34, 0xffff0000
    s_mov_b32 s35, 0x4038aa3b
    s_waitcnt lgkmcnt(0)
    v_add_f32 v16, v16, v24
    v_add_f32 v16, v16, v32
    v_add_f32 v16, v16, v40
    v_add_f32 v17, v17, v25
    v_add_f32 v17, v17, v33
    v_add_f32 v17, v17, v41
    v_add_f32 v18, v18, v26
    v_add_f32 v18, v18, v34
    v_add_f32 v18, v18, v42
    v_add_f32 v19, v19, v27
    v_add_f32 v19, v19, v35
    v_add_f32 v19, v19, v43
    v_add_f32 v20, v20, v28
    v_add_f32 v20, v20, v36
    v_add_f32 v20, v20, v44
    v_add_f32 v21, v21, v29
    v_add_f32 v21, v21, v37
    v_add_f32 v21, v21, v45
    v_add_f32 v22, v22, v30
    v_add_f32 v22, v22, v38
    v_add_f32 v22, v22, v46
    v_add_f32 v23, v23, v31
    v_add_f32 v23, v23, v39
    v_add_f32 v23, v23, v47
    v_cvt_pk_bf16_f32 v48, v16, v20
    v_cvt_pk_bf16_f32 v49, v17, v21
    v_cvt_pk_bf16_f32 v50, v18, v22
    v_cvt_pk_bf16_f32 v51, v19, v23
    v_lshlrev_b32 v56, 16, v48
    v_and_b32 v57, s34, v48
    v_lshlrev_b32 v58, 16, v49
    v_and_b32 v59, s34, v49
    v_lshlrev_b32 v60, 16, v50
    v_and_b32 v61, s34, v50
    v_lshlrev_b32 v62, 16, v51
    v_and_b32 v63, s34, v51
    v_mul_f32 v56, s35, v56
    v_mul_f32 v57, s35, v57
    v_mul_f32 v58, s35, v58
    v_mul_f32 v59, s35, v59
    v_mul_f32 v60, s35, v60
    v_mul_f32 v61, s35, v61
    v_mul_f32 v62, s35, v62
    v_mul_f32 v63, s35, v63
    buffer_store_dwordx4 v[56:59], v8, s[12:15], s24 offen sc1
    buffer_store_dwordx4 v[60:63], v8, s[12:15], s24 offen offset:16 sc1
    v_exp_f32 v64, v56
    v_exp_f32 v65, v57
    v_exp_f32 v66, v58
    v_exp_f32 v67, v59
    v_exp_f32 v68, v60
    v_exp_f32 v69, v61
    v_exp_f32 v70, v62
    v_exp_f32 v71, v63
    v_max3_f32 v72, |v56|, |v57|, |v58|
    v_max3_f32 v72, |v59|, |v60|, v72
    v_max3_f32 v72, |v61|, |v62|, v72
    v_max_f32 v72, |v63|, v72
    s_add_u32 s12, s12, 16384
    s_addc_u32 s13, s13, 0
    v_cmp_lt_f32 vcc, 0x42f00000, v72
    buffer_store_dwordx4 v[64:67], v8, s[12:15], s24 offen sc1
    buffer_store_dwordx4 v[68:71], v8, s[12:15], s24 offen offset:16 sc1
    s_add_u32 s12, s12, 16384
    s_addc_u32 s13, s13, 0
    s_or_b32 s26, vcc_lo, vcc_hi
    s_lshr_b32 s24, s24, 4
    v_mov_b32 v73, s26
    v_mov_b32 v74, 0
    buffer_store_dword v73, v74, s[12:15], s24 offen sc1
    s_endpgm
.globl conv1_kernel
.p2align 8
.type conv1_kernel,@function
conv1_kernel:
    s_cmp_ge_u32 s2, 256
    s_cbranch_scc1 L_conv1_kernel_done
    s_load_dwordx2 s[4:5], s[0:1], 0
    s_load_dwordx2 s[30:31], s[0:1], 72
    v_readfirstlane_b32 s20, v0
    s_lshr_b32 s20, s20, 6
    s_and_b32 s36, s2, 0
    s_lshl_b32 s36, s36, 3
    s_bfe_u32 s37, s2, 196611
    s_or_b32 s29, s36, s37
    s_bfe_u32 s36, s2, 196608
    s_lshl_b32 s36, s36, 2
    s_lshr_b32 s37, s2, 6
    s_or_b32 s36, s36, s37
    s_mov_b32 s33, 0
    s_and_b32 s34, s36, 15
    s_lshr_b32 s35, s36, 4
    s_mul_i32 s21, s34, 500
    s_and_b32 s32, s20, 3
    v_and_b32 v127, 63, v0
    v_lshrrev_b32 v5, 2, v127
    v_and_b32 v6, 3, v127
    s_and_b32 s42, s20, 7
    v_lshlrev_b32 v7, 15, v5
    v_lshl_add_u32 v7, v6, 4, v7
    s_lshl_b32 s41, s21, 10
    s_sub_u32 s41, s41, 7680
    s_lshl_b32 s37, s42, 12
    s_add_u32 s37, s37, s41
    v_add_u32 v7, s37, v7
    s_mul_i32 s36, s35, 8192000
    s_mov_b32 s10, 8192000
    s_mov_b32 s11, 0x00020000
    s_mov_b32 s25, 0xffff0000
    s_waitcnt lgkmcnt(0)
    s_add_u32 s8, s4, s36
    s_addc_u32 s9, s5, 0
    s_cmp_ge_u32 s20, 8
    s_cbranch_scc1 L_conv1_kernel_helper
    s_add_u32 s37, s41, 524288
    v_lshl_add_u32 v108, v127, 4, s37
    v_add_u32 v109, 1024, v108
    v_add_u32 v110, 2048, v108
    s_lshl_b32 s36, s29, 4
    s_lshl_b32 s37, s33, 3
    s_add_u32 s36, s36, s37
    s_mul_i32 s36, s36, 57344
    s_add_u32 s36, s36, 0
    s_add_u32 s12, s30, s36
    s_addc_u32 s13, s31, 0
    s_mov_b32 s14, 917504
    s_mov_b32 s15, 0x00020000
    s_mul_i32 s36, s35, 4194304
    s_add_u32 s36, s36, 18874368
    s_add_u32 s16, s30, s36
    s_addc_u32 s17, s31, 0
    s_mov_b32 s18, 4194304
    s_mov_b32 s19, 0x00020000
    v_and_b32 v10, 15, v127
    v_lshrrev_b32 v11, 4, v127
    v_add_u32 v8, 0, v10
    v_and_b32 v16, 4, v8
    v_lshrrev_b32 v16, 1, v16
    v_xor_b32 v16, v11, v16
    v_lshlrev_b32 v16, 4, v16
    v_lshl_add_u32 v8, v8, 6, v16
    v_add_u32 v9, 1, v10
    v_and_b32 v16, 4, v9
    v_lshrrev_b32 v16, 1, v16
    v_xor_b32 v16, v11, v16
    v_lshlrev_b32 v16, 4, v16
    v_lshl_add_u32 v9, v9, 6, v16
    s_lshr_b32 s38, s32, 1
    s_and_b32 s39, s32, 1
    s_add_u32 s40, s38, 4
    s_lshl_b32 s43, s39, 10
    s_cmp_lt_u32 s20, 4
    s_cselect_b32 s40, s20, s40
    s_cselect_b32 s36, 0, s43
    s_lshl_b32 s37, s40, 13
    s_add_u32 s37, s37, s36
    v_lshl_add_u32 v125, v127, 4, s37
    s_mul_i32 s37, s40, 16384
    v_add_u32 v120, s37, v8
    v_add_u32 v121, s37, v9
    s_lshl_b32 s37, s40, 10
    s_add_u32 s37, s37, 115712
    v_lshl_add_u32 v16, v11, 4, s37
    v_cmp_eq_u32 vcc, 15, v10
    v_mov_b32 v17, 8192
    v_mov_b32 v18, 4294959104
    v_mov_b32 v19, 64
    v_cndmask_b32 v122, v121, v16, vcc
    v_cndmask_b32 v123, v17, v19, vcc
    v_cndmask_b32 v124, v18, v19, vcc
    v_lshl_add_u32 v126, v127, 4, s37
    s_mov_b32 s44, 0x3f800000
    s_mov_b32 s45, 0x00000000
    s_mov_b32 s46, 0x00000000
    s_cmp_eq_u32 s40, 1
    s_cselect_b32 s45, 0x3f800000, s45
    s_cselect_b32 s46, 0x3f800000, s46
    s_cmp_eq_u32 s40, 2
    s_cselect_b32 s45, 0xbf800000, s45
    s_cselect_b32 s46, 0x3f800000, s46
    s_cmp_eq_u32 s40, 3
    s_cselect_b32 s45, 0x40000000, s45
    s_cselect_b32 s46, 0x40800000, s46
    s_cmp_eq_u32 s40, 4
    s_cselect_b32 s45, 0xc0000000, s45
    s_cselect_b32 s46, 0x40800000, s46
    s_cmp_eq_u32 s40, 5
    s_cselect_b32 s44, 0x41800000, s44
    s_cselect_b32 s45, 0x41000000, s45
    s_cselect_b32 s46, 0x40800000, s46
    s_cmp_ge_u32 s20, 4
    s_cbranch_scc1 L_conv1_kernel_m2
    v_mov_b32 v0, 0
    v_mov_b32 v1, 0
    v_mov_b32 v2, 0
    v_mov_b32 v3, 0
    v_mov_b32 v4, 0
    v_mov_b32 v5, 0
    v_mov_b32 v6, 0
    v_mov_b32 v7, 0
    v_mov_b32 v8, 0
    v_mov_b32 v9, 0
    v_mov_b32 v10, 0
    v_mov_b32 v11, 0
    v_mov_b32 v12, 0
    v_mov_b32 v13, 0
    v_mov_b32 v14, 0
    v_mov_b32 v15, 0
    v_mov_b32 v16, 0
    v_mov_b32 v17, 0
    v_mov_b32 v18, 0
    v_mov_b32 v19, 0
    v_mov_b32 v20, 0
    v_mov_b32 v21, 0
    v_mov_b32 v22, 0
    v_mov_b32 v23, 0
    v_mov_b32 v24, 0
    v_mov_b32 v25, 0
    v_mov_b32 v26, 0
    v_mov_b32 v27, 0
    v_mov_b32 v28, 0
    v_mov_b32 v29, 0
    v_mov_b32 v30, 0
    v_mov_b32 v31, 0
    v_mov_b32 v32, 0
    v_mov_b32 v33, 0
    v_mov_b32 v34, 0
    v_mov_b32 v35, 0
    v_mov_b32 v36, 0
    v_mov_b32 v37, 0
    v_mov_b32 v38, 0
    v_mov_b32 v39, 0
    v_mov_b32 v40, 0
    v_mov_b32 v41, 0
    v_mov_b32 v42, 0
    v_mov_b32 v43, 0
    v_mov_b32 v44, 0
    v_mov_b32 v45, 0
    v_mov_b32 v46, 0
    v_mov_b32 v47, 0
    v_mov_b32 v48, 0
    v_mov_b32 v49, 0
    v_mov_b32 v50, 0
    v_mov_b32 v51, 0
    v_mov_b32 v52, 0
    v_mov_b32 v53, 0
    v_mov_b32 v54, 0
    v_mov_b32 v55, 0
    v_mov_b32 v56, 0
    v_mov_b32 v57, 0
    v_mov_b32 v58, 0
    v_mov_b32 v59, 0
    v_mov_b32 v60, 0
    v_mov_b32 v61, 0
    v_mov_b32 v62, 0
    v_mov_b32 v63, 0
    s_barrier
    buffer_load_dwordx4 v[96:99], v108, s[8:11], 0 offen
    buffer_load_dwordx4 v[100:103], v109, s[8:11], 0 offen
    buffer_load_dwordx4 v[104:107], v110, s[8:11], 0 offen
    s_mov_b32 s23, 0
    s_mov_b32 s26, 4096
    buffer_load_dwordx4 v[64:67], v125, s[12:15], s23 offen offset:0
    buffer_load_dwordx4 v[68:71], v125, s[12:15], s23 offen offset:1024
    buffer_load_dwordx4 v[72:75], v125, s[12:15], s23 offen offset:2048
    buffer_load_dwordx4 v[76:79], v125, s[12:15], s23 offen offset:3072
    buffer_load_dwordx4 v[80:83], v125, s[12:15], s26 offen offset:0
    buffer_load_dwordx4 v[84:87], v125, s[12:15], s26 offen offset:1024
    buffer_load_dwordx4 v[88:91], v125, s[12:15], s26 offen offset:2048
    buffer_load_dwordx4 v[92:95], v125, s[12:15], s26 offen offset:3072
    s_mov_b32 s23, 57344
    s_mov_b32 s26, 61440
    s_waitcnt vmcnt(8)
    v_lshlrev_b32 v108, 16, v96
    v_and_b32 v111, s25, v96
    v_lshlrev_b32 v109, 16, v100
    v_and_b32 v112, s25, v100
    v_lshlrev_b32 v110, 16, v104
    v_and_b32 v113, s25, v104
    v_mul_f32 v114, s44, v108
    v_mul_f32 v115, s44, v111
    v_fmac_f32 v114, s45, v109
    v_fmac_f32 v115, s45, v112
    v_fmac_f32 v114, s46, v110
    v_fmac_f32 v115, s46, v113
    v_cvt_pk_bf16_f32 v96, v114, v115
    v_lshlrev_b32 v108, 16, v97
    v_and_b32 v111, s25, v97
    v_lshlrev_b32 v109, 16, v101
    v_and_b32 v112, s25, v101
    v_lshlrev_b32 v110, 16, v105
    v_and_b32 v113, s25, v105
    v_mul_f32 v114, s44, v108
    v_mul_f32 v115, s44, v111
    v_fmac_f32 v114, s45, v109
    v_fmac_f32 v115, s45, v112
    v_fmac_f32 v114, s46, v110
    v_fmac_f32 v115, s46, v113
    v_cvt_pk_bf16_f32 v97, v114, v115
    v_lshlrev_b32 v108, 16, v98
    v_and_b32 v111, s25, v98
    v_lshlrev_b32 v109, 16, v102
    v_and_b32 v112, s25, v102
    v_lshlrev_b32 v110, 16, v106
    v_and_b32 v113, s25, v106
    v_mul_f32 v114, s44, v108
    v_mul_f32 v115, s44, v111
    v_fmac_f32 v114, s45, v109
    v_fmac_f32 v115, s45, v112
    v_fmac_f32 v114, s46, v110
    v_fmac_f32 v115, s46, v113
    v_cvt_pk_bf16_f32 v98, v114, v115
    v_lshlrev_b32 v108, 16, v99
    v_and_b32 v111, s25, v99
    v_lshlrev_b32 v109, 16, v103
    v_and_b32 v112, s25, v103
    v_lshlrev_b32 v110, 16, v107
    v_and_b32 v113, s25, v107
    v_mul_f32 v114, s44, v108
    v_mul_f32 v115, s44, v111
    v_fmac_f32 v114, s45, v109
    v_fmac_f32 v115, s45, v112
    v_fmac_f32 v114, s46, v110
    v_fmac_f32 v115, s46, v113
    v_cvt_pk_bf16_f32 v99, v114, v115
    ds_write_b128 v126, v[96:99]
    s_waitcnt lgkmcnt(0)
    s_barrier
    s_mov_b32 s22, 8
    s_setprio 2
L_conv1_kernel_mloop1:
    ds_read_b128 v[96:99], v120 offset:0
    ds_read_b128 v[100:103], v120 offset:1024
    ds_read_b128 v[104:107], v120 offset:2048
    ds_read_b128 v[108:111], v120 offset:3072
    ds_read_b128 v[112:115], v120 offset:4096
    ds_read_b128 v[116:119], v120 offset:5120
    s_waitcnt vmcnt(6) lgkmcnt(5)
    v_mfma_f32_16x16x32_bf16 v[0:3], v[64:67], v[96:99], v[0:3]
    v_mfma_f32_16x16x32_bf16 v[32:35], v[68:71], v[96:99], v[32:35]
    ds_read_b128 v[96:99], v120 offset:6144
    s_waitcnt vmcnt(4) lgkmcnt(5)
    v_mfma_f32_16x16x32_bf16 v[4:7], v[64:67], v[100:103], v[4:7]
    v_mfma_f32_16x16x32_bf16 v[36:39], v[68:71], v[100:103], v[36:39]
    v_mfma_f32_16x16x32_bf16 v[0:3], v[72:75], v[100:103], v[0:3]
    v_mfma_f32_16x16x32_bf16 v[32:35], v[76:79], v[100:103], v[32:35]
    ds_read_b128 v[100:103], v120 offset:7168
    s_waitcnt vmcnt(2) lgkmcnt(5)
    v_mfma_f32_16x16x32_bf16 v[8:11], v[64:67], v[104:107], v[8:11]
    v_mfma_f32_16x16x32_bf16 v[40:43], v[68:71], v[104:107], v[40:43]
    v_mfma_f32_16x16x32_bf16 v[4:7], v[72:75], v[104:107], v[4:7]
    v_mfma_f32_16x16x32_bf16 v[36:39], v[76:79], v[104:107], v[36:39]
    v_mfma_f32_16x16x32_bf16 v[0:3], v[80:83], v[104:107], v[0:3]
    v_mfma_f32_16x16x32_bf16 v[32:35], v[84:87], v[104:107], v[32:35]
    ds_read_b128 v[104:107], v122 offset:0
    v_add_u32 v122, v123, v122
    s_waitcnt vmcnt(0) lgkmcnt(5)
    v_mfma_f32_16x16x32_bf16 v[12:15], v[64:67], v[108:111], v[12:15]
    v_mfma_f32_16x16x32_bf16 v[44:47], v[68:71], v[108:111], v[44:47]
    v_mfma_f32_16x16x32_bf16 v[8:11], v[72:75], v[108:111], v[8:11]
    v_mfma_f32_16x16x32_bf16 v[40:43], v[76:79], v[108:111], v[40:43]
    v_mfma_f32_16x16x32_bf16 v[4:7], v[80:83], v[108:111], v[4:7]
    v_mfma_f32_16x16x32_bf16 v[36:39], v[84:87], v[108:111], v[36:39]
    v_mfma_f32_16x16x32_bf16 v[0:3], v[88:91], v[108:111], v[0:3]
    v_mfma_f32_16x16x32_bf16 v[32:35], v[92:95], v[108:111], v[32:35]
    ds_read_b128 v[108:111], v121 offset:1024
    s_waitcnt lgkmcnt(5)
    v_mfma_f32_16x16x32_bf16 v[16:19], v[64:67], v[112:115], v[16:19]
    v_mfma_f32_16x16x32_bf16 v[48:51], v[68:71], v[112:115], v[48:51]
    v_mfma_f32_16x16x32_bf16 v[12:15], v[72:75], v[112:115], v[12:15]
    v_mfma_f32_16x16x32_bf16 v[44:47], v[76:79], v[112:115], v[44:47]
    v_mfma_f32_16x16x32_bf16 v[8:11], v[80:83], v[112:115], v[8:11]
    v_mfma_f32_16x16x32_bf16 v[40:43], v[84:87], v[112:115], v[40:43]
    v_mfma_f32_16x16x32_bf16 v[4:7], v[88:91], v[112:115], v[4:7]
    v_mfma_f32_16x16x32_bf16 v[36:39], v[92:95], v[112:115], v[36:39]
    ds_read_b128 v[112:115], v121 offset:2048
    s_waitcnt lgkmcnt(5)
    v_mfma_f32_16x16x32_bf16 v[20:23], v[64:67], v[116:119], v[20:23]
    v_mfma_f32_16x16x32_bf16 v[52:55], v[68:71], v[116:119], v[52:55]
    v_mfma_f32_16x16x32_bf16 v[16:19], v[72:75], v[116:119], v[16:19]
    v_mfma_f32_16x16x32_bf16 v[48:51], v[76:79], v[116:119], v[48:51]
    v_mfma_f32_16x16x32_bf16 v[12:15], v[80:83], v[116:119], v[12:15]
    v_mfma_f32_16x16x32_bf16 v[44:47], v[84:87], v[116:119], v[44:47]
    v_mfma_f32_16x16x32_bf16 v[8:11], v[88:91], v[116:119], v[8:11]
    v_mfma_f32_16x16x32_bf16 v[40:43], v[92:95], v[116:119], v[40:43]
    s_waitcnt lgkmcnt(4)
    v_mfma_f32_16x16x32_bf16 v[24:27], v[64:67], v[96:99], v[24:27]
    v_mfma_f32_16x16x32_bf16 v[56:59], v[68:71], v[96:99], v[56:59]
    v_mfma_f32_16x16x32_bf16 v[20:23], v[72:75], v[96:99], v[20:23]
    v_mfma_f32_16x16x32_bf16 v[52:55], v[76:79], v[96:99], v[52:55]
    v_mfma_f32_16x16x32_bf16 v[16:19], v[80:83], v[96:99], v[16:19]
    v_mfma_f32_16x16x32_bf16 v[48:51], v[84:87], v[96:99], v[48:51]
    v_mfma_f32_16x16x32_bf16 v[12:15], v[88:91], v[96:99], v[12:15]
    v_mfma_f32_16x16x32_bf16 v[44:47], v[92:95], v[96:99], v[44:47]
    s_waitcnt lgkmcnt(3)
    v_mfma_f32_16x16x32_bf16 v[28:31], v[64:67], v[100:103], v[28:31]
    v_mfma_f32_16x16x32_bf16 v[60:63], v[68:71], v[100:103], v[60:63]
    v_mfma_f32_16x16x32_bf16 v[24:27], v[72:75], v[100:103], v[24:27]
    v_mfma_f32_16x16x32_bf16 v[56:59], v[76:79], v[100:103], v[56:59]
    v_mfma_f32_16x16x32_bf16 v[20:23], v[80:83], v[100:103], v[20:23]
    v_mfma_f32_16x16x32_bf16 v[52:55], v[84:87], v[100:103], v[52:55]
    v_mfma_f32_16x16x32_bf16 v[16:19], v[88:91], v[100:103], v[16:19]
    v_mfma_f32_16x16x32_bf16 v[48:51], v[92:95], v[100:103], v[48:51]
    buffer_load_dwordx4 v[64:67], v125, s[12:15], s23 offen offset:0
    buffer_load_dwordx4 v[68:71], v125, s[12:15], s23 offen offset:1024
    s_waitcnt lgkmcnt(2)
    v_mfma_f32_16x16x32_bf16 v[28:31], v[72:75], v[104:107], v[28:31]
    v_mfma_f32_16x16x32_bf16 v[60:63], v[76:79], v[104:107], v[60:63]
    v_mfma_f32_16x16x32_bf16 v[24:27], v[80:83], v[104:107], v[24:27]
    v_mfma_f32_16x16x32_bf16 v[56:59], v[84:87], v[104:107], v[56:59]
    v_mfma_f32_16x16x32_bf16 v[20:23], v[88:91], v[104:107], v[20:23]
    v_mfma_f32_16x16x32_bf16 v[52:55], v[92:95], v[104:107], v[52:55]
    buffer_load_dwordx4 v[72:75], v125, s[12:15], s23 offen offset:2048
    buffer_load_dwordx4 v[76:79], v125, s[12:15], s23 offen offset:3072
    s_waitcnt lgkmcnt(1)
    v_mfma_f32_16x16x32_bf16 v[28:31], v[80:83], v[108:111], v[28:31]
    v_mfma_f32_16x16x32_bf16 v[60:63], v[84:87], v[108:111], v[60:63]
    v_mfma_f32_16x16x32_bf16 v[24:27], v[88:91], v[108:111], v[24:27]
    v_mfma_f32_16x16x32_bf16 v[56:59], v[92:95], v[108:111], v[56:59]
    buffer_load_dwordx4 v[80:83], v125, s[12:15], s26 offen offset:0
    buffer_load_dwordx4 v[84:87], v125, s[12:15], s26 offen offset:1024
    s_waitcnt lgkmcnt(0)
    v_mfma_f32_16x16x32_bf16 v[28:31], v[88:91], v[112:115], v[28:31]
    v_mfma_f32_16x16x32_bf16 v[60:63], v[92:95], v[112:115], v[60:63]
    buffer_load_dwordx4 v[88:91], v125, s[12:15], s26 offen offset:2048
    buffer_load_dwordx4 v[92:95], v125, s[12:15], s26 offen offset:3072
    s_add_u32 s23, s23, 57344
    s_add_u32 s26, s26, 57344
    s_barrier
    s_sub_u32 s22, s22, 1
    s_cmp_eq_u32 s22, 0
    s_cbranch_scc1 L_conv1_kernel_mlast1
    ds_read_b128 v[96:99], v120 offset:8192
    ds_read_b128 v[100:103], v120 offset:9216
    ds_read_b128 v[104:107], v120 offset:10240
    ds_read_b128 v[108:111], v120 offset:11264
    ds_read_b128 v[112:115], v120 offset:12288
    ds_read_b128 v[116:119], v120 offset:13312
    s_waitcnt vmcnt(6) lgkmcnt(5)
    v_mfma_f32_16x16x32_bf16 v[0:3], v[64:67], v[96:99], v[0:3]
    v_mfma_f32_16x16x32_bf16 v[32:35], v[68:71], v[96:99], v[32:35]
    ds_read_b128 v[96:99], v120 offset:14336
    s_waitcnt vmcnt(4) lgkmcnt(5)
    v_mfma_f32_16x16x32_bf16 v[4:7], v[64:67], v[100:103], v[4:7]
    v_mfma_f32_16x16x32_bf16 v[36:39], v[68:71], v[100:103], v[36:39]
    v_mfma_f32_16x16x32_bf16 v[0:3], v[72:75], v[100:103], v[0:3]
    v_mfma_f32_16x16x32_bf16 v[32:35], v[76:79], v[100:103], v[32:35]
    ds_read_b128 v[100:103], v120 offset:15360
    s_waitcnt vmcnt(2) lgkmcnt(5)
    v_mfma_f32_16x16x32_bf16 v[8:11], v[64:67], v[104:107], v[8:11]
    v_mfma_f32_16x16x32_bf16 v[40:43], v[68:71], v[104:107], v[40:43]
    v_mfma_f32_16x16x32_bf16 v[4:7], v[72:75], v[104:107], v[4:7]
    v_mfma_f32_16x16x32_bf16 v[36:39], v[76:79], v[104:107], v[36:39]
    v_mfma_f32_16x16x32_bf16 v[0:3], v[80:83], v[104:107], v[0:3]
    v_mfma_f32_16x16x32_bf16 v[32:35], v[84:87], v[104:107], v[32:35]
    ds_read_b128 v[104:107], v122 offset:0
    v_add_u32 v122, v124, v122
    s_waitcnt vmcnt(0) lgkmcnt(5)
    v_mfma_f32_16x16x32_bf16 v[12:15], v[64:67], v[108:111], v[12:15]
    v_mfma_f32_16x16x32_bf16 v[44:47], v[68:71], v[108:111], v[44:47]
    v_mfma_f32_16x16x32_bf16 v[8:11], v[72:75], v[108:111], v[8:11]
    v_mfma_f32_16x16x32_bf16 v[40:43], v[76:79], v[108:111], v[40:43]
    v_mfma_f32_16x16x32_bf16 v[4:7], v[80:83], v[108:111], v[4:7]
    v_mfma_f32_16x16x32_bf16 v[36:39], v[84:87], v[108:111], v[36:39]
    v_mfma_f32_16x16x32_bf16 v[0:3], v[88:91], v[108:111], v[0:3]
    v_mfma_f32_16x16x32_bf16 v[32:35], v[92:95], v[108:111], v[32:35]
    ds_read_b128 v[108:111], v121 offset:9216
    s_waitcnt lgkmcnt(5)
    v_mfma_f32_16x16x32_bf16 v[16:19], v[64:67], v[112:115], v[16:19]
    v_mfma_f32_16x16x32_bf16 v[48:51], v[68:71], v[112:115], v[48:51]
    v_mfma_f32_16x16x32_bf16 v[12:15], v[72:75], v[112:115], v[12:15]
    v_mfma_f32_16x16x32_bf16 v[44:47], v[76:79], v[112:115], v[44:47]
    v_mfma_f32_16x16x32_bf16 v[8:11], v[80:83], v[112:115], v[8:11]
    v_mfma_f32_16x16x32_bf16 v[40:43], v[84:87], v[112:115], v[40:43]
    v_mfma_f32_16x16x32_bf16 v[4:7], v[88:91], v[112:115], v[4:7]
    v_mfma_f32_16x16x32_bf16 v[36:39], v[92:95], v[112:115], v[36:39]
    ds_read_b128 v[112:115], v121 offset:10240
    s_waitcnt lgkmcnt(5)
    v_mfma_f32_16x16x32_bf16 v[20:23], v[64:67], v[116:119], v[20:23]
    v_mfma_f32_16x16x32_bf16 v[52:55], v[68:71], v[116:119], v[52:55]
    v_mfma_f32_16x16x32_bf16 v[16:19], v[72:75], v[116:119], v[16:19]
    v_mfma_f32_16x16x32_bf16 v[48:51], v[76:79], v[116:119], v[48:51]
    v_mfma_f32_16x16x32_bf16 v[12:15], v[80:83], v[116:119], v[12:15]
    v_mfma_f32_16x16x32_bf16 v[44:47], v[84:87], v[116:119], v[44:47]
    v_mfma_f32_16x16x32_bf16 v[8:11], v[88:91], v[116:119], v[8:11]
    v_mfma_f32_16x16x32_bf16 v[40:43], v[92:95], v[116:119], v[40:43]
    s_waitcnt lgkmcnt(4)
    v_mfma_f32_16x16x32_bf16 v[24:27], v[64:67], v[96:99], v[24:27]
    v_mfma_f32_16x16x32_bf16 v[56:59], v[68:71], v[96:99], v[56:59]
    v_mfma_f32_16x16x32_bf16 v[20:23], v[72:75], v[96:99], v[20:23]
    v_mfma_f32_16x16x32_bf16 v[52:55], v[76:79], v[96:99], v[52:55]
    v_mfma_f32_16x16x32_bf16 v[16:19], v[80:83], v[96:99], v[16:19]
    v_mfma_f32_16x16x32_bf16 v[48:51], v[84:87], v[96:99], v[48:51]
    v_mfma_f32_16x16x32_bf16 v[12:15], v[88:91], v[96:99], v[12:15]
    v_mfma_f32_16x16x32_bf16 v[44:47], v[92:95], v[96:99], v[44:47]
    s_waitcnt lgkmcnt(3)
    v_mfma_f32_16x16x32_bf16 v[28:31], v[64:67], v[100:103], v[28:31]
    v_mfma_f32_16x16x32_bf16 v[60:63], v[68:71], v[100:103], v[60:63]
    v_mfma_f32_16x16x32_bf16 v[24:27], v[72:75], v[100:103], v[24:27]
    v_mfma_f32_16x16x32_bf16 v[56:59], v[76:79], v[100:103], v[56:59]
    v_mfma_f32_16x16x32_bf16 v[20:23], v[80:83], v[100:103], v[20:23]
    v_mfma_f32_16x16x32_bf16 v[52:55], v[84:87], v[100:103], v[52:55]
    v_mfma_f32_16x16x32_bf16 v[16:19], v[88:91], v[100:103], v[16:19]
    v_mfma_f32_16x16x32_bf16 v[48:51], v[92:95], v[100:103], v[48:51]
    buffer_load_dwordx4 v[64:67], v125, s[12:15], s23 offen offset:0
    buffer_load_dwordx4 v[68:71], v125, s[12:15], s23 offen offset:1024
    s_waitcnt lgkmcnt(2)
    v_mfma_f32_16x16x32_bf16 v[28:31], v[72:75], v[104:107], v[28:31]
    v_mfma_f32_16x16x32_bf16 v[60:63], v[76:79], v[104:107], v[60:63]
    v_mfma_f32_16x16x32_bf16 v[24:27], v[80:83], v[104:107], v[24:27]
    v_mfma_f32_16x16x32_bf16 v[56:59], v[84:87], v[104:107], v[56:59]
    v_mfma_f32_16x16x32_bf16 v[20:23], v[88:91], v[104:107], v[20:23]
    v_mfma_f32_16x16x32_bf16 v[52:55], v[92:95], v[104:107], v[52:55]
    buffer_load_dwordx4 v[72:75], v125, s[12:15], s23 offen offset:2048
    buffer_load_dwordx4 v[76:79], v125, s[12:15], s23 offen offset:3072
    s_waitcnt lgkmcnt(1)
    v_mfma_f32_16x16x32_bf16 v[28:31], v[80:83], v[108:111], v[28:31]
    v_mfma_f32_16x16x32_bf16 v[60:63], v[84:87], v[108:111], v[60:63]
    v_mfma_f32_16x16x32_bf16 v[24:27], v[88:91], v[108:111], v[24:27]
    v_mfma_f32_16x16x32_bf16 v[56:59], v[92:95], v[108:111], v[56:59]
    buffer_load_dwordx4 v[80:83], v125, s[12:15], s26 offen offset:0
    buffer_load_dwordx4 v[84:87], v125, s[12:15], s26 offen offset:1024
    s_waitcnt lgkmcnt(0)
    v_mfma_f32_16x16x32_bf16 v[28:31], v[88:91], v[112:115], v[28:31]
    v_mfma_f32_16x16x32_bf16 v[60:63], v[92:95], v[112:115], v[60:63]
    buffer_load_dwordx4 v[88:91], v125, s[12:15], s26 offen offset:2048
    buffer_load_dwordx4 v[92:95], v125, s[12:15], s26 offen offset:3072
    s_add_u32 s23, s23, 57344
    s_add_u32 s26, s26, 57344
    s_barrier
    s_branch L_conv1_kernel_mloop1
L_conv1_kernel_mlast1:
    v_and_b32 v125, 15, v127
    v_and_b32 v126, 7, v127
    v_lshlrev_b32 v126, 4, v126
    v_lshl_add_u32 v125, v125, 7, v126
    v_lshrrev_b32 v126, 4, v127
    v_lshl_add_u32 v125, v126, 11, v125
    s_lshl_b32 s36, s20, 14
    s_add_u32 s37, s36, 8192
    v_add_u32 v126, s37, v125
    v_add_u32 v125, s36, v125
    ds_read_b128 v[96:99], v120 offset:8192
    ds_read_b128 v[100:103], v120 offset:9216
    ds_read_b128 v[104:107], v120 offset:10240
    ds_read_b128 v[108:111], v120 offset:11264
    ds_read_b128 v[112:115], v120 offset:12288
    ds_read_b128 v[116:119], v120 offset:13312
    s_waitcnt vmcnt(6) lgkmcnt(5)
    v_mfma_f32_16x16x32_bf16 v[0:3], v[64:67], v[96:99], v[0:3]
    v_mfma_f32_16x16x32_bf16 v[32:35], v[68:71], v[96:99], v[32:35]
    ds_read_b128 v[96:99], v120 offset:14336
    s_waitcnt vmcnt(4) lgkmcnt(5)
    v_mfma_f32_16x16x32_bf16 v[4:7], v[64:67], v[100:103], v[4:7]
    v_mfma_f32_16x16x32_bf16 v[36:39], v[68:71], v[100:103], v[36:39]
    v_mfma_f32_16x16x32_bf16 v[0:3], v[72:75], v[100:103], v[0:3]
    v_mfma_f32_16x16x32_bf16 v[32:35], v[76:79], v[100:103], v[32:35]
    ds_read_b128 v[100:103], v120 offset:15360
    s_waitcnt vmcnt(2) lgkmcnt(5)
    v_mfma_f32_16x16x32_bf16 v[8:11], v[64:67], v[104:107], v[8:11]
    v_mfma_f32_16x16x32_bf16 v[40:43], v[68:71], v[104:107], v[40:43]
    v_mfma_f32_16x16x32_bf16 v[4:7], v[72:75], v[104:107], v[4:7]
    v_mfma_f32_16x16x32_bf16 v[36:39], v[76:79], v[104:107], v[36:39]
    v_mfma_f32_16x16x32_bf16 v[0:3], v[80:83], v[104:107], v[0:3]
    v_mfma_f32_16x16x32_bf16 v[32:35], v[84:87], v[104:107], v[32:35]
    ds_read_b128 v[104:107], v122 offset:0
    s_waitcnt vmcnt(0) lgkmcnt(5)
    v_mfma_f32_16x16x32_bf16 v[12:15], v[64:67], v[108:111], v[12:15]
    v_mfma_f32_16x16x32_bf16 v[44:47], v[68:71], v[108:111], v[44:47]
    v_mfma_f32_16x16x32_bf16 v[8:11], v[72:75], v[108:111], v[8:11]
    v_mfma_f32_16x16x32_bf16 v[40:43], v[76:79], v[108:111], v[40:43]
    v_mfma_f32_16x16x32_bf16 v[4:7], v[80:83], v[108:111], v[4:7]
    v_mfma_f32_16x16x32_bf16 v[36:39], v[84:87], v[108:111], v[36:39]
    v_mfma_f32_16x16x32_bf16 v[0:3], v[88:91], v[108:111], v[0:3]
    v_mfma_f32_16x16x32_bf16 v[32:35], v[92:95], v[108:111], v[32:35]
    ds_read_b128 v[108:111], v121 offset:9216
    s_waitcnt lgkmcnt(5)
    v_mfma_f32_16x16x32_bf16 v[16:19], v[64:67], v[112:115], v[16:19]
    v_mfma_f32_16x16x32_bf16 v[48:51], v[68:71], v[112:115], v[48:51]
    v_mfma_f32_16x16x32_bf16 v[12:15], v[72:75], v[112:115], v[12:15]
    v_mfma_f32_16x16x32_bf16 v[44:47], v[76:79], v[112:115], v[44:47]
    v_mfma_f32_16x16x32_bf16 v[8:11], v[80:83], v[112:115], v[8:11]
    v_mfma_f32_16x16x32_bf16 v[40:43], v[84:87], v[112:115], v[40:43]
    v_mfma_f32_16x16x32_bf16 v[4:7], v[88:91], v[112:115], v[4:7]
    v_mfma_f32_16x16x32_bf16 v[36:39], v[92:95], v[112:115], v[36:39]
    ds_read_b128 v[112:115], v121 offset:10240
    v_xor_b32 v123, 0, v125
    ds_write_b128 v123, v[0:3]
    s_waitcnt lgkmcnt(6)
    v_mfma_f32_16x16x32_bf16 v[20:23], v[64:67], v[116:119], v[20:23]
    v_mfma_f32_16x16x32_bf16 v[52:55], v[68:71], v[116:119], v[52:55]
    v_mfma_f32_16x16x32_bf16 v[16:19], v[72:75], v[116:119], v[16:19]
    v_mfma_f32_16x16x32_bf16 v[48:51], v[76:79], v[116:119], v[48:51]
    v_mfma_f32_16x16x32_bf16 v[12:15], v[80:83], v[116:119], v[12:15]
    v_mfma_f32_16x16x32_bf16 v[44:47], v[84:87], v[116:119], v[44:47]
    v_mfma_f32_16x16x32_bf16 v[8:11], v[88:91], v[116:119], v[8:11]
    v_mfma_f32_16x16x32_bf16 v[40:43], v[92:95], v[116:119], v[40:43]
    v_xor_b32 v124, 16, v125
    ds_write_b128 v124, v[4:7]
    s_waitcnt lgkmcnt(2)
    v_mfma_f32_16x16x32_bf16 v[24:27], v[64:67], v[96:99], v[24:27]
    v_mfma_f32_16x16x32_bf16 v[56:59], v[68:71], v[96:99], v[56:59]
    v_mfma_f32_16x16x32_bf16 v[20:23], v[72:75], v[96:99], v[20:23]
    v_mfma_f32_16x16x32_bf16 v[52:55], v[76:79], v[96:99], v[52:55]
    v_mfma_f32_16x16x32_bf16 v[16:19], v[80:83], v[96:99], v[16:19]
    v_mfma_f32_16x16x32_bf16 v[48:51], v[84:87], v[96:99], v[48:51]
    v_mfma_f32_16x16x32_bf16 v[12:15], v[88:91], v[96:99], v[12:15]
    v_mfma_f32_16x16x32_bf16 v[44:47], v[92:95], v[96:99], v[44:47]
    v_xor_b32 v123, 32, v125
    ds_write_b128 v123, v[8:11]
    v_xor_b32 v124, 0, v126
    ds_write_b128 v124, v[32:35]
    v_mfma_f32_16x16x32_bf16 v[28:31], v[64:67], v[100:103], v[28:31]
    v_mfma_f32_16x16x32_bf16 v[60:63], v[68:71], v[100:103], v[60:63]
    v_mfma_f32_16x16x32_bf16 v[24:27], v[72:75], v[100:103], v[24:27]
    v_mfma_f32_16x16x32_bf16 v[56:59], v[76:79], v[100:103], v[56:59]
    v_mfma_f32_16x16x32_bf16 v[20:23], v[80:83], v[100:103], v[20:23]
    v_mfma_f32_16x16x32_bf16 v[52:55], v[84:87], v[100:103], v[52:55]
    v_mfma_f32_16x16x32_bf16 v[16:19], v[88:91], v[100:103], v[16:19]
    v_mfma_f32_16x16x32_bf16 v[48:51], v[92:95], v[100:103], v[48:51]
    v_xor_b32 v123, 16, v126
    ds_write_b128 v123, v[36:39]
    v_xor_b32 v124, 32, v126
    ds_write_b128 v124, v[40:43]
    v_mfma_f32_16x16x32_bf16 v[28:31], v[72:75], v[104:107], v[28:31]
    v_mfma_f32_16x16x32_bf16 v[60:63], v[76:79], v[104:107], v[60:63]
    v_mfma_f32_16x16x32_bf16 v[24:27], v[80:83], v[104:107], v[24:27]
    v_mfma_f32_16x16x32_bf16 v[56:59], v[84:87], v[104:107], v[56:59]
    v_mfma_f32_16x16x32_bf16 v[20:23], v[88:91], v[104:107], v[20:23]
    v_mfma_f32_16x16x32_bf16 v[52:55], v[92:95], v[104:107], v[52:55]
    v_xor_b32 v124, 48, v125
    ds_write_b128 v124, v[12:15]
    v_xor_b32 v123, 48, v126
    ds_write_b128 v123, v[44:47]
    v_mfma_f32_16x16x32_bf16 v[28:31], v[80:83], v[108:111], v[28:31]
    v_mfma_f32_16x16x32_bf16 v[60:63], v[84:87], v[108:111], v[60:63]
    v_mfma_f32_16x16x32_bf16 v[24:27], v[88:91], v[108:111], v[24:27]
    v_mfma_f32_16x16x32_bf16 v[56:59], v[92:95], v[108:111], v[56:59]
    v_xor_b32 v123, 64, v125
    ds_write_b128 v123, v[16:19]
    v_xor_b32 v124, 64, v126
    ds_write_b128 v124, v[48:51]
    v_mfma_f32_16x16x32_bf16 v[28:31], v[88:91], v[112:115], v[28:31]
    v_mfma_f32_16x16x32_bf16 v[60:63], v[92:95], v[112:115], v[60:63]
    v_xor_b32 v124, 80, v125
    ds_write_b128 v124, v[20:23]
    v_xor_b32 v123, 80, v126
    ds_write_b128 v123, v[52:55]
    s_nop 7
    v_xor_b32 v123, 96, v125
    ds_write_b128 v123, v[24:27]
    v_xor_b32 v124, 96, v126
    ds_write_b128 v124, v[56:59]
    v_xor_b32 v124, 112, v125
    ds_write_b128 v124, v[28:31]
    v_xor_b32 v123, 112, v126
    s_waitcnt lgkmcnt(8)
    ds_write_b128 v123, v[60:63]
    s_setprio 0
    s_branch L_conv1_kernel_epi
L_conv1_kernel_m2:
    s_mul_i32 s37, s38, 2176
    s_add_u32 s37, s37, 98304
    v_add_u32 v116, s37, v8
    v_add_u32 v118, s37, v9
    v_add_u32 v117, 104832, v8
    s_cmp_eq_u32 s38, 0
    s_cbranch_scc1 L_conv1_kernel_hh0
    v_add_u32 v117, 98304, v9
L_conv1_kernel_hh0:
    s_lshl_b32 s37, s38, 12
    s_add_u32 s37, s37, s43
    s_add_u32 s37, s37, 49152
    v_lshl_add_u32 v119, v127, 4, s37
    v_mov_b32 v0, 0
    v_mov_b32 v1, 0
    v_mov_b32 v2, 0
    v_mov_b32 v3, 0
    v_mov_b32 v4, 0
    v_mov_b32 v5, 0
    v_mov_b32 v6, 0
    v_mov_b32 v7, 0
    v_mov_b32 v8, 0
    v_mov_b32 v9, 0
    v_mov_b32 v10, 0
    v_mov_b32 v11, 0
    v_mov_b32 v12, 0
    v_mov_b32 v13, 0
    v_mov_b32 v14, 0
    v_mov_b32 v15, 0
    v_mov_b32 v16, 0
    v_mov_b32 v17, 0
    v_mov_b32 v18, 0
    v_mov_b32 v19, 0
    v_mov_b32 v20, 0
    v_mov_b32 v21, 0
    v_mov_b32 v22, 0
    v_mov_b32 v23, 0
    v_mov_b32 v24, 0
    v_mov_b32 v25, 0
    v_mov_b32 v26, 0
    v_mov_b32 v27, 0
    v_mov_b32 v28, 0
    v_mov_b32 v29, 0
    v_mov_b32 v30, 0
    v_mov_b32 v31, 0
    v_mov_b32 v32, 0
    v_mov_b32 v33, 0
    v_mov_b32 v34, 0
    v_mov_b32 v35, 0
    v_mov_b32 v36, 0
    v_mov_b32 v37, 0
    v_mov_b32 v38, 0
    v_mov_b32 v39, 0
    v_mov_b32 v40, 0
    v_mov_b32 v41, 0
    v_mov_b32 v42, 0
    v_mov_b32 v43, 0
    v_mov_b32 v44, 0
    v_mov_b32 v45, 0
    v_mov_b32 v46, 0
    v_mov_b32 v47, 0
    v_mov_b32 v48, 0
    v_mov_b32 v49, 0
    v_mov_b32 v50, 0
    v_mov_b32 v51, 0
    v_mov_b32 v52, 0
    v_mov_b32 v53, 0
    v_mov_b32 v54, 0
    v_mov_b32 v55, 0
    v_mov_b32 v56, 0
    v_mov_b32 v57, 0
    v_mov_b32 v58, 0
    v_mov_b32 v59, 0
    v_mov_b32 v60, 0
    v_mov_b32 v61, 0
    v_mov_b32 v62, 0
    v_mov_b32 v63, 0
    s_barrier
    buffer_load_dwordx4 v[96:99], v108, s[8:11], 0 offen
    buffer_load_dwordx4 v[100:103], v109, s[8:11], 0 offen
    buffer_load_dwordx4 v[104:107], v110, s[8:11], 0 offen
    s_mov_b32 s23, 0
    s_mov_b32 s26, 4096
    buffer_load_dwordx4 v[64:67], v125, s[12:15], s23 offen offset:0
    buffer_load_dwordx4 v[68:71], v125, s[12:15], s23 offen offset:2048
    buffer_load_dwordx4 v[80:83], v119, s[12:15], s23 offen offset:0
    buffer_load_dwordx4 v[72:75], v125, s[12:15], s26 offen offset:0
    buffer_load_dwordx4 v[84:87], v119, s[12:15], s23 offen offset:2048
    buffer_load_dwordx4 v[76:79], v125, s[12:15], s26 offen offset:2048
    s_mov_b32 s23, 57344
    s_mov_b32 s26, 61440
    s_waitcnt vmcnt(6)
    v_lshlrev_b32 v108, 16, v96
    v_and_b32 v111, s25, v96
    v_lshlrev_b32 v109, 16, v100
    v_and_b32 v112, s25, v100
    v_lshlrev_b32 v110, 16, v104
    v_and_b32 v113, s25, v104
    v_mul_f32 v114, s44, v108
    v_mul_f32 v115, s44, v111
    v_fmac_f32 v114, s45, v109
    v_fmac_f32 v115, s45, v112
    v_fmac_f32 v114, s46, v110
    v_fmac_f32 v115, s46, v113
    v_cvt_pk_bf16_f32 v96, v114, v115
    v_lshlrev_b32 v108, 16, v97
    v_and_b32 v111, s25, v97
    v_lshlrev_b32 v109, 16, v101
    v_and_b32 v112, s25, v101
    v_lshlrev_b32 v110, 16, v105
    v_and_b32 v113, s25, v105
    v_mul_f32 v114, s44, v108
    v_mul_f32 v115, s44, v111
    v_fmac_f32 v114, s45, v109
    v_fmac_f32 v115, s45, v112
    v_fmac_f32 v114, s46, v110
    v_fmac_f32 v115, s46, v113
    v_cvt_pk_bf16_f32 v97, v114, v115
    v_lshlrev_b32 v108, 16, v98
    v_and_b32 v111, s25, v98
    v_lshlrev_b32 v109, 16, v102
    v_and_b32 v112, s25, v102
    v_lshlrev_b32 v110, 16, v106
    v_and_b32 v113, s25, v106
    v_mul_f32 v114, s44, v108
    v_mul_f32 v115, s44, v111
    v_fmac_f32 v114, s45, v109
    v_fmac_f32 v115, s45, v112
    v_fmac_f32 v114, s46, v110
    v_fmac_f32 v115, s46, v113
    v_cvt_pk_bf16_f32 v98, v114, v115
    v_lshlrev_b32 v108, 16, v99
    v_and_b32 v111, s25, v99
    v_lshlrev_b32 v109, 16, v103
    v_and_b32 v112, s25, v103
    v_lshlrev_b32 v110, 16, v107
    v_and_b32 v113, s25, v107
    v_mul_f32 v114, s44, v108
    v_mul_f32 v115, s44, v111
    v_fmac_f32 v114, s45, v109
    v_fmac_f32 v115, s45, v112
    v_fmac_f32 v114, s46, v110
    v_fmac_f32 v115, s46, v113
    v_cvt_pk_bf16_f32 v99, v114, v115
    ds_write_b128 v126, v[96:99]
    v_and_b32 v126, 15, v127
    v_lshlrev_b32 v126, 2, v126
    v_add_u32 v126, 99328, v126
    ds_write_b32 v126, v0
    ds_write_b32 v126, v0 offset:8704
    s_waitcnt lgkmcnt(0)
    s_barrier
    s_mov_b32 s22, 8
    s_setprio 2
L_conv1_kernel_mloop2:
    ds_read_b128 v[88:91], v120 offset:0
    ds_read_b128 v[92:95], v120 offset:1024
    ds_read_b128 v[96:99], v116 offset:0
    ds_read_b128 v[100:103], v120 offset:2048
    ds_read_b128 v[104:107], v116 offset:1088
    ds_read_b128 v[108:111], v120 offset:3072
    ds_read_b128 v[112:115], v116 offset:2176
    s_waitcnt vmcnt(5) lgkmcnt(6)
    v_mfma_f32_16x16x32_bf16 v[0:3], v[64:67], v[88:91], v[0:3]
    ds_read_b128 v[88:91], v120 offset:4096
    s_waitcnt vmcnt(4) lgkmcnt(6)
    v_mfma_f32_16x16x32_bf16 v[4:7], v[64:67], v[92:95], v[4:7]
    v_mfma_f32_16x16x32_bf16 v[0:3], v[68:71], v[92:95], v[0:3]
    ds_read_b128 v[92:95], v116 offset:3264
    s_waitcnt vmcnt(3) lgkmcnt(6)
    v_mfma_f32_16x16x32_bf16 v[32:35], v[80:83], v[96:99], v[32:35]
    ds_read_b128 v[96:99], v120 offset:5120
    s_waitcnt vmcnt(2) lgkmcnt(6)
    v_mfma_f32_16x16x32_bf16 v[8:11], v[64:67], v[100:103], v[8:11]
    v_mfma_f32_16x16x32_bf16 v[4:7], v[68:71], v[100:103], v[4:7]
    v_mfma_f32_16x16x32_bf16 v[0:3], v[72:75], v[100:103], v[0:3]
    ds_read_b128 v[100:103], v116 offset:4352
    s_waitcnt vmcnt(1) lgkmcnt(6)
    v_mfma_f32_16x16x32_bf16 v[36:39], v[80:83], v[104:107], v[36:39]
    v_mfma_f32_16x16x32_bf16 v[32:35], v[84:87], v[104:107], v[32:35]
    ds_read_b128 v[104:107], v120 offset:6144
    s_waitcnt vmcnt(0) lgkmcnt(6)
    v_mfma_f32_16x16x32_bf16 v[12:15], v[64:67], v[108:111], v[12:15]
    v_mfma_f32_16x16x32_bf16 v[8:11], v[68:71], v[108:111], v[8:11]
    v_mfma_f32_16x16x32_bf16 v[4:7], v[72:75], v[108:111], v[4:7]
    v_mfma_f32_16x16x32_bf16 v[0:3], v[76:79], v[108:111], v[0:3]
    ds_read_b128 v[108:111], v116 offset:5440
    s_waitcnt lgkmcnt(6)
    v_mfma_f32_16x16x32_bf16 v[40:43], v[80:83], v[112:115], v[40:43]
    v_mfma_f32_16x16x32_bf16 v[36:39], v[84:87], v[112:115], v[36:39]
    ds_read_b128 v[112:115], v120 offset:7168
    s_waitcnt lgkmcnt(6)
    v_mfma_f32_16x16x32_bf16 v[16:19], v[64:67], v[88:91], v[16:19]
    v_mfma_f32_16x16x32_bf16 v[12:15], v[68:71], v[88:91], v[12:15]
    v_mfma_f32_16x16x32_bf16 v[8:11], v[72:75], v[88:91], v[8:11]
    v_mfma_f32_16x16x32_bf16 v[4:7], v[76:79], v[88:91], v[4:7]
    ds_read_b128 v[88:91], v117 offset:0
    s_waitcnt lgkmcnt(6)
    v_mfma_f32_16x16x32_bf16 v[44:47], v[80:83], v[92:95], v[44:47]
    v_mfma_f32_16x16x32_bf16 v[40:43], v[84:87], v[92:95], v[40:43]
    ds_read_b128 v[92:95], v122 offset:0
    v_add_u32 v122, v123, v122
    s_waitcnt lgkmcnt(6)
    v_mfma_f32_16x16x32_bf16 v[20:23], v[64:67], v[96:99], v[20:23]
    v_mfma_f32_16x16x32_bf16 v[16:19], v[68:71], v[96:99], v[16:19]
    v_mfma_f32_16x16x32_bf16 v[12:15], v[72:75], v[96:99], v[12:15]
    v_mfma_f32_16x16x32_bf16 v[8:11], v[76:79], v[96:99], v[8:11]
    ds_read_b128 v[96:99], v117 offset:1088
    s_waitcnt lgkmcnt(6)
    v_mfma_f32_16x16x32_bf16 v[48:51], v[80:83], v[100:103], v[48:51]
    v_mfma_f32_16x16x32_bf16 v[44:47], v[84:87], v[100:103], v[44:47]
    ds_read_b128 v[100:103], v121 offset:1024
    s_waitcnt lgkmcnt(6)
    v_mfma_f32_16x16x32_bf16 v[24:27], v[64:67], v[104:107], v[24:27]
    v_mfma_f32_16x16x32_bf16 v[20:23], v[68:71], v[104:107], v[20:23]
    v_mfma_f32_16x16x32_bf16 v[16:19], v[72:75], v[104:107], v[16:19]
    v_mfma_f32_16x16x32_bf16 v[12:15], v[76:79], v[104:107], v[12:15]
    ds_read_b128 v[104:107], v118 offset:0
    s_waitcnt lgkmcnt(6)
    v_mfma_f32_16x16x32_bf16 v[52:55], v[80:83], v[108:111], v[52:55]
    v_mfma_f32_16x16x32_bf16 v[48:51], v[84:87], v[108:111], v[48:51]
    ds_read_b128 v[108:111], v121 offset:2048
    s_waitcnt lgkmcnt(6)
    v_mfma_f32_16x16x32_bf16 v[28:31], v[64:67], v[112:115], v[28:31]
    v_mfma_f32_16x16x32_bf16 v[24:27], v[68:71], v[112:115], v[24:27]
    v_mfma_f32_16x16x32_bf16 v[20:23], v[72:75], v[112:115], v[20:23]
    v_mfma_f32_16x16x32_bf16 v[16:19], v[76:79], v[112:115], v[16:19]
    buffer_load_dwordx4 v[64:67], v125, s[12:15], s23 offen offset:0
    s_waitcnt lgkmcnt(5)
    v_mfma_f32_16x16x32_bf16 v[56:59], v[80:83], v[88:91], v[56:59]
    v_mfma_f32_16x16x32_bf16 v[52:55], v[84:87], v[88:91], v[52:55]
    s_waitcnt lgkmcnt(0)
    s_barrier
    v_mfma_f32_16x16x32_bf16 v[28:31], v[68:71], v[92:95], v[28:31]
    v_mfma_f32_16x16x32_bf16 v[24:27], v[72:75], v[92:95], v[24:27]
    v_mfma_f32_16x16x32_bf16 v[20:23], v[76:79], v[92:95], v[20:23]
    buffer_load_dwordx4 v[68:71], v125, s[12:15], s23 offen offset:2048
    v_mfma_f32_16x16x32_bf16 v[60:63], v[80:83], v[96:99], v[60:63]
    v_mfma_f32_16x16x32_bf16 v[56:59], v[84:87], v[96:99], v[56:59]
    buffer_load_dwordx4 v[80:83], v119, s[12:15], s23 offen offset:0
    v_mfma_f32_16x16x32_bf16 v[28:31], v[72:75], v[100:103], v[28:31]
    v_mfma_f32_16x16x32_bf16 v[24:27], v[76:79], v[100:103], v[24:27]
    buffer_load_dwordx4 v[72:75], v125, s[12:15], s26 offen offset:0
    v_mfma_f32_16x16x32_bf16 v[60:63], v[84:87], v[104:107], v[60:63]
    buffer_load_dwordx4 v[84:87], v119, s[12:15], s23 offen offset:2048
    v_mfma_f32_16x16x32_bf16 v[28:31], v[76:79], v[108:111], v[28:31]
    buffer_load_dwordx4 v[76:79], v125, s[12:15], s26 offen offset:2048
    s_add_u32 s23, s23, 57344
    s_add_u32 s26, s26, 57344
    s_sub_u32 s22, s22, 1
    s_cmp_eq_u32 s22, 0
    s_cbranch_scc1 L_conv1_kernel_mlast2
    ds_read_b128 v[88:91], v120 offset:8192
    ds_read_b128 v[92:95], v120 offset:9216
    ds_read_b128 v[96:99], v116 offset:8704
    ds_read_b128 v[100:103], v120 offset:10240
    ds_read_b128 v[104:107], v116 offset:9792
    ds_read_b128 v[108:111], v120 offset:11264
    ds_read_b128 v[112:115], v116 offset:10880
    s_waitcnt vmcnt(5) lgkmcnt(6)
    v_mfma_f32_16x16x32_bf16 v[0:3], v[64:67], v[88:91], v[0:3]
    ds_read_b128 v[88:91], v120 offset:12288
    s_waitcnt vmcnt(4) lgkmcnt(6)
    v_mfma_f32_16x16x32_bf16 v[4:7], v[64:67], v[92:95], v[4:7]
    v_mfma_f32_16x16x32_bf16 v[0:3], v[68:71], v[92:95], v[0:3]
    ds_read_b128 v[92:95], v116 offset:11968
    s_waitcnt vmcnt(3) lgkmcnt(6)
    v_mfma_f32_16x16x32_bf16 v[32:35], v[80:83], v[96:99], v[32:35]
    ds_read_b128 v[96:99], v120 offset:13312
    s_waitcnt vmcnt(2) lgkmcnt(6)
    v_mfma_f32_16x16x32_bf16 v[8:11], v[64:67], v[100:103], v[8:11]
    v_mfma_f32_16x16x32_bf16 v[4:7], v[68:71], v[100:103], v[4:7]
    v_mfma_f32_16x16x32_bf16 v[0:3], v[72:75], v[100:103], v[0:3]
    ds_read_b128 v[100:103], v116 offset:13056
    s_waitcnt vmcnt(1) lgkmcnt(6)
    v_mfma_f32_16x16x32_bf16 v[36:39], v[80:83], v[104:107], v[36:39]
    v_mfma_f32_16x16x32_bf16 v[32:35], v[84:87], v[104:107], v[32:35]
    ds_read_b128 v[104:107], v120 offset:14336
    s_waitcnt vmcnt(0) lgkmcnt(6)
    v_mfma_f32_16x16x32_bf16 v[12:15], v[64:67], v[108:111], v[12:15]
    v_mfma_f32_16x16x32_bf16 v[8:11], v[68:71], v[108:111], v[8:11]
    v_mfma_f32_16x16x32_bf16 v[4:7], v[72:75], v[108:111], v[4:7]
    v_mfma_f32_16x16x32_bf16 v[0:3], v[76:79], v[108:111], v[0:3]
    ds_read_b128 v[108:111], v116 offset:14144
    s_waitcnt lgkmcnt(6)
    v_mfma_f32_16x16x32_bf16 v[40:43], v[80:83], v[112:115], v[40:43]
    v_mfma_f32_16x16x32_bf16 v[36:39], v[84:87], v[112:115], v[36:39]
    ds_read_b128 v[112:115], v120 offset:15360
    s_waitcnt lgkmcnt(6)
    v_mfma_f32_16x16x32_bf16 v[16:19], v[64:67], v[88:91], v[16:19]
    v_mfma_f32_16x16x32_bf16 v[12:15], v[68:71], v[88:91], v[12:15]
    v_mfma_f32_16x16x32_bf16 v[8:11], v[72:75], v[88:91], v[8:11]
    v_mfma_f32_16x16x32_bf16 v[4:7], v[76:79], v[88:91], v[4:7]
    ds_read_b128 v[88:91], v117 offset:8704
    s_waitcnt lgkmcnt(6)
    v_mfma_f32_16x16x32_bf16 v[44:47], v[80:83], v[92:95], v[44:47]
    v_mfma_f32_16x16x32_bf16 v[40:43], v[84:87], v[92:95], v[40:43]
    ds_read_b128 v[92:95], v122 offset:0
    v_add_u32 v122, v124, v122
    s_waitcnt lgkmcnt(6)
    v_mfma_f32_16x16x32_bf16 v[20:23], v[64:67], v[96:99], v[20:23]
    v_mfma_f32_16x16x32_bf16 v[16:19], v[68:71], v[96:99], v[16:19]
    v_mfma_f32_16x16x32_bf16 v[12:15], v[72:75], v[96:99], v[12:15]
    v_mfma_f32_16x16x32_bf16 v[8:11], v[76:79], v[96:99], v[8:11]
    ds_read_b128 v[96:99], v117 offset:9792
    s_waitcnt lgkmcnt(6)
    v_mfma_f32_16x16x32_bf16 v[48:51], v[80:83], v[100:103], v[48:51]
    v_mfma_f32_16x16x32_bf16 v[44:47], v[84:87], v[100:103], v[44:47]
    ds_read_b128 v[100:103], v121 offset:9216
    s_waitcnt lgkmcnt(6)
    v_mfma_f32_16x16x32_bf16 v[24:27], v[64:67], v[104:107], v[24:27]
    v_mfma_f32_16x16x32_bf16 v[20:23], v[68:71], v[104:107], v[20:23]
    v_mfma_f32_16x16x32_bf16 v[16:19], v[72:75], v[104:107], v[16:19]
    v_mfma_f32_16x16x32_bf16 v[12:15], v[76:79], v[104:107], v[12:15]
    ds_read_b128 v[104:107], v118 offset:8704
    s_waitcnt lgkmcnt(6)
    v_mfma_f32_16x16x32_bf16 v[52:55], v[80:83], v[108:111], v[52:55]
    v_mfma_f32_16x16x32_bf16 v[48:51], v[84:87], v[108:111], v[48:51]
    ds_read_b128 v[108:111], v121 offset:10240
    s_waitcnt lgkmcnt(6)
    v_mfma_f32_16x16x32_bf16 v[28:31], v[64:67], v[112:115], v[28:31]
    v_mfma_f32_16x16x32_bf16 v[24:27], v[68:71], v[112:115], v[24:27]
    v_mfma_f32_16x16x32_bf16 v[20:23], v[72:75], v[112:115], v[20:23]
    v_mfma_f32_16x16x32_bf16 v[16:19], v[76:79], v[112:115], v[16:19]
    buffer_load_dwordx4 v[64:67], v125, s[12:15], s23 offen offset:0
    s_waitcnt lgkmcnt(5)
    v_mfma_f32_16x16x32_bf16 v[56:59], v[80:83], v[88:91], v[56:59]
    v_mfma_f32_16x16x32_bf16 v[52:55], v[84:87], v[88:91], v[52:55]
    s_waitcnt lgkmcnt(0)
    s_barrier
    v_mfma_f32_16x16x32_bf16 v[28:31], v[68:71], v[92:95], v[28:31]
    v_mfma_f32_16x16x32_bf16 v[24:27], v[72:75], v[92:95], v[24:27]
    v_mfma_f32_16x16x32_bf16 v[20:23], v[76:79], v[92:95], v[20:23]
    buffer_load_dwordx4 v[68:71], v125, s[12:15], s23 offen offset:2048
    v_mfma_f32_16x16x32_bf16 v[60:63], v[80:83], v[96:99], v[60:63]
    v_mfma_f32_16x16x32_bf16 v[56:59], v[84:87], v[96:99], v[56:59]
    buffer_load_dwordx4 v[80:83], v119, s[12:15], s23 offen offset:0
    v_mfma_f32_16x16x32_bf16 v[28:31], v[72:75], v[100:103], v[28:31]
    v_mfma_f32_16x16x32_bf16 v[24:27], v[76:79], v[100:103], v[24:27]
    buffer_load_dwordx4 v[72:75], v125, s[12:15], s26 offen offset:0
    v_mfma_f32_16x16x32_bf16 v[60:63], v[84:87], v[104:107], v[60:63]
    buffer_load_dwordx4 v[84:87], v119, s[12:15], s23 offen offset:2048
    v_mfma_f32_16x16x32_bf16 v[28:31], v[76:79], v[108:111], v[28:31]
    buffer_load_dwordx4 v[76:79], v125, s[12:15], s26 offen offset:2048
    s_add_u32 s23, s23, 57344
    s_add_u32 s26, s26, 57344
    s_branch L_conv1_kernel_mloop2
L_conv1_kernel_mlast2:
    v_and_b32 v125, 15, v127
    v_and_b32 v126, 7, v127
    v_lshlrev_b32 v126, 4, v126
    v_lshl_add_u32 v125, v125, 7, v126
    v_lshrrev_b32 v126, 4, v127
    v_lshl_add_u32 v125, v126, 11, v125
    s_mov_b32 s36, 65536
    s_cmp_eq_u32 s32, 1
    s_cselect_b32 s36, 121856, s36
    s_cmp_eq_u32 s32, 2
    s_cselect_b32 s36, 81920, s36
    s_cmp_eq_u32 s32, 3
    s_cselect_b32 s36, 130048, s36
    s_mov_b32 s37, 98304
    s_cmp_eq_u32 s32, 1
    s_cselect_b32 s37, 138240, s37
    s_cmp_eq_u32 s32, 2
    s_cselect_b32 s37, 146432, s37
    s_cmp_eq_u32 s32, 3
    s_cselect_b32 s37, 154624, s37
    v_add_u32 v126, s37, v125
    v_add_u32 v125, s36, v125
    ds_read_b128 v[88:91], v120 offset:8192
    ds_read_b128 v[92:95], v120 offset:9216
    ds_read_b128 v[96:99], v116 offset:8704
    ds_read_b128 v[100:103], v120 offset:10240
    ds_read_b128 v[104:107], v116 offset:9792
    ds_read_b128 v[108:111], v120 offset:11264
    ds_read_b128 v[112:115], v116 offset:10880
    s_waitcnt vmcnt(5) lgkmcnt(6)
    v_mfma_f32_16x16x32_bf16 v[0:3], v[64:67], v[88:91], v[0:3]
    ds_read_b128 v[88:91], v120 offset:12288
    s_waitcnt vmcnt(4) lgkmcnt(6)
    v_mfma_f32_16x16x32_bf16 v[4:7], v[64:67], v[92:95], v[4:7]
    v_mfma_f32_16x16x32_bf16 v[0:3], v[68:71], v[92:95], v[0:3]
    ds_read_b128 v[92:95], v116 offset:11968
    s_waitcnt vmcnt(3) lgkmcnt(6)
    v_mfma_f32_16x16x32_bf16 v[32:35], v[80:83], v[96:99], v[32:35]
    ds_read_b128 v[96:99], v120 offset:13312
    s_waitcnt vmcnt(2) lgkmcnt(6)
    v_mfma_f32_16x16x32_bf16 v[8:11], v[64:67], v[100:103], v[8:11]
    v_mfma_f32_16x16x32_bf16 v[4:7], v[68:71], v[100:103], v[4:7]
    v_mfma_f32_16x16x32_bf16 v[0:3], v[72:75], v[100:103], v[0:3]
    ds_read_b128 v[100:103], v116 offset:13056
    s_waitcnt vmcnt(1) lgkmcnt(6)
    v_mfma_f32_16x16x32_bf16 v[36:39], v[80:83], v[104:107], v[36:39]
    v_mfma_f32_16x16x32_bf16 v[32:35], v[84:87], v[104:107], v[32:35]
    ds_read_b128 v[104:107], v120 offset:14336
    s_waitcnt vmcnt(0) lgkmcnt(6)
    v_mfma_f32_16x16x32_bf16 v[12:15], v[64:67], v[108:111], v[12:15]
    v_mfma_f32_16x16x32_bf16 v[8:11], v[68:71], v[108:111], v[8:11]
    v_mfma_f32_16x16x32_bf16 v[4:7], v[72:75], v[108:111], v[4:7]
    v_mfma_f32_16x16x32_bf16 v[0:3], v[76:79], v[108:111], v[0:3]
    ds_read_b128 v[108:111], v116 offset:14144
    s_waitcnt lgkmcnt(6)
    v_mfma_f32_16x16x32_bf16 v[40:43], v[80:83], v[112:115], v[40:43]
    v_mfma_f32_16x16x32_bf16 v[36:39], v[84:87], v[112:115], v[36:39]
    ds_read_b128 v[112:115], v120 offset:15360
    s_waitcnt lgkmcnt(6)
    v_mfma_f32_16x16x32_bf16 v[16:19], v[64:67], v[88:91], v[16:19]
    v_mfma_f32_16x16x32_bf16 v[12:15], v[68:71], v[88:91], v[12:15]
    v_mfma_f32_16x16x32_bf16 v[8:11], v[72:75], v[88:91], v[8:11]
    v_mfma_f32_16x16x32_bf16 v[4:7], v[76:79], v[88:91], v[4:7]
    ds_read_b128 v[88:91], v117 offset:8704
    v_xor_b32 v124, 0, v126
    ds_write_b128 v124, v[32:35]
    s_waitcnt lgkmcnt(7)
    v_mfma_f32_16x16x32_bf16 v[44:47], v[80:83], v[92:95], v[44:47]
    v_mfma_f32_16x16x32_bf16 v[40:43], v[84:87], v[92:95], v[40:43]
    ds_read_b128 v[92:95], v122 offset:0
    v_xor_b32 v123, 0, v125
    ds_write_b128 v123, v[0:3]
    s_waitcnt lgkmcnt(8)
    v_mfma_f32_16x16x32_bf16 v[20:23], v[64:67], v[96:99], v[20:23]
    v_mfma_f32_16x16x32_bf16 v[16:19], v[68:71], v[96:99], v[16:19]
    v_mfma_f32_16x16x32_bf16 v[12:15], v[72:75], v[96:99], v[12:15]
    v_mfma_f32_16x16x32_bf16 v[8:11], v[76:79], v[96:99], v[8:11]
    ds_read_b128 v[96:99], v117 offset:9792
    v_xor_b32 v123, 16, v126
    ds_write_b128 v123, v[36:39]
    s_waitcnt lgkmcnt(9)
    v_mfma_f32_16x16x32_bf16 v[48:51], v[80:83], v[100:103], v[48:51]
    v_mfma_f32_16x16x32_bf16 v[44:47], v[84:87], v[100:103], v[44:47]
    ds_read_b128 v[100:103], v121 offset:9216
    v_xor_b32 v124, 16, v125
    ds_write_b128 v124, v[4:7]
    s_waitcnt lgkmcnt(10)
    v_mfma_f32_16x16x32_bf16 v[24:27], v[64:67], v[104:107], v[24:27]
    v_mfma_f32_16x16x32_bf16 v[20:23], v[68:71], v[104:107], v[20:23]
    v_mfma_f32_16x16x32_bf16 v[16:19], v[72:75], v[104:107], v[16:19]
    v_mfma_f32_16x16x32_bf16 v[12:15], v[76:79], v[104:107], v[12:15]
    ds_read_b128 v[104:107], v118 offset:8704
    v_xor_b32 v124, 32, v126
    ds_write_b128 v124, v[40:43]
    s_waitcnt lgkmcnt(11)
    v_mfma_f32_16x16x32_bf16 v[52:55], v[80:83], v[108:111], v[52:55]
    v_mfma_f32_16x16x32_bf16 v[48:51], v[84:87], v[108:111], v[48:51]
    ds_read_b128 v[108:111], v121 offset:10240
    v_xor_b32 v123, 32, v125
    ds_write_b128 v123, v[8:11]
    s_waitcnt lgkmcnt(12)
    v_mfma_f32_16x16x32_bf16 v[28:31], v[64:67], v[112:115], v[28:31]
    v_mfma_f32_16x16x32_bf16 v[24:27], v[68:71], v[112:115], v[24:27]
    v_mfma_f32_16x16x32_bf16 v[20:23], v[72:75], v[112:115], v[20:23]
    v_mfma_f32_16x16x32_bf16 v[16:19], v[76:79], v[112:115], v[16:19]
    v_xor_b32 v123, 48, v126
    ds_write_b128 v123, v[44:47]
    s_waitcnt lgkmcnt(12)
    v_mfma_f32_16x16x32_bf16 v[56:59], v[80:83], v[88:91], v[56:59]
    v_mfma_f32_16x16x32_bf16 v[52:55], v[84:87], v[88:91], v[52:55]
    v_xor_b32 v124, 48, v125
    ds_write_b128 v124, v[12:15]
    s_waitcnt lgkmcnt(11)
    v_mfma_f32_16x16x32_bf16 v[28:31], v[68:71], v[92:95], v[28:31]
    v_mfma_f32_16x16x32_bf16 v[24:27], v[72:75], v[92:95], v[24:27]
    v_mfma_f32_16x16x32_bf16 v[20:23], v[76:79], v[92:95], v[20:23]
    v_xor_b32 v124, 64, v126
    ds_write_b128 v124, v[48:51]
    s_waitcnt lgkmcnt(10)
    v_mfma_f32_16x16x32_bf16 v[60:63], v[80:83], v[96:99], v[60:63]
    v_mfma_f32_16x16x32_bf16 v[56:59], v[84:87], v[96:99], v[56:59]
    v_xor_b32 v123, 64, v125
    ds_write_b128 v123, v[16:19]
    s_waitcnt lgkmcnt(9)
    v_mfma_f32_16x16x32_bf16 v[28:31], v[72:75], v[100:103], v[28:31]
    v_mfma_f32_16x16x32_bf16 v[24:27], v[76:79], v[100:103], v[24:27]
    v_xor_b32 v123, 80, v126
    ds_write_b128 v123, v[52:55]
    s_waitcnt lgkmcnt(8)
    v_mfma_f32_16x16x32_bf16 v[60:63], v[84:87], v[104:107], v[60:63]
    v_xor_b32 v124, 80, v125
    ds_write_b128 v124, v[20:23]
    s_waitcnt lgkmcnt(7)
    v_mfma_f32_16x16x32_bf16 v[28:31], v[76:79], v[108:111], v[28:31]
    v_xor_b32 v124, 96, v126
    ds_write_b128 v124, v[56:59]
    s_nop 7
    v_xor_b32 v123, 96, v125
    ds_write_b128 v123, v[24:27]
    v_xor_b32 v123, 112, v126
    ds_write_b128 v123, v[60:63]
    v_xor_b32 v124, 112, v125
    ds_write_b128 v124, v[28:31]
    s_setprio 0
    s_branch L_conv1_kernel_epi
L_conv1_kernel_helper:
    s_setprio 3
    v_add_u32 v92, 0, v7
    v_add_u32 v93, 1024, v7
    v_add_u32 v94, 2048, v7
    v_add_u32 v95, 3072, v7
    v_and_b32 v76, 4, v5
    v_lshrrev_b32 v76, 1, v76
    v_xor_b32 v76, v6, v76
    v_lshlrev_b32 v76, 4, v76
    v_lshl_add_u32 v76, v5, 6, v76
    s_mov_b32 s24, 0
    s_mov_b32 s27, 524288
    buffer_load_dwordx4 v[0:3], v92, s[8:11], s24 offen offset:0
    buffer_load_dwordx4 v[16:19], v92, s[8:11], s24 offen offset:64
    v_add_u32 v92, 128, v92
    buffer_load_dwordx4 v[4:7], v93, s[8:11], s24 offen offset:0
    buffer_load_dwordx4 v[20:23], v93, s[8:11], s24 offen offset:64
    v_add_u32 v93, 128, v93
    buffer_load_dwordx4 v[8:11], v94, s[8:11], s24 offen offset:0
    buffer_load_dwordx4 v[24:27], v94, s[8:11], s24 offen offset:64
    v_add_u32 v94, 128, v94
    buffer_load_dwordx4 v[12:15], v95, s[8:11], s24 offen offset:0
    buffer_load_dwordx4 v[28:31], v95, s[8:11], s24 offen offset:64
    v_add_u32 v95, 128, v95
    s_barrier
    s_mul_i32 s36, s42, 1024
    v_add_u32 v96, s36, v76
    v_add_u32 v97, 65536, v96
    s_mul_i32 s36, s42, 1088
    s_add_u32 s36, s36, 98304
    v_add_u32 v98, s36, v76
    s_waitcnt vmcnt(0)
    s_mov_b32 s28, 0
    s_mov_b32 s22, 4
    s_cmp_ge_u32 s20, 12
    s_cbranch_scc1 L_conv1_kernel_h2
    ds_write_b128 v96, v[0:3] offset:0
    ds_write_b128 v98, v[12:15] offset:0
    v_lshlrev_b32 v76, 16, v0
    v_and_b32 v84, s25, v0
    v_lshlrev_b32 v77, 16, v4
    v_and_b32 v85, s25, v4
    v_lshlrev_b32 v78, 16, v8
    v_and_b32 v86, s25, v8
    v_lshlrev_b32 v79, 16, v12
    v_and_b32 v87, s25, v12
    v_add_f32 v80, v76, v78
    v_add_f32 v88, v84, v86
    v_add_f32 v81, v77, v79
    v_add_f32 v89, v85, v87
    v_fma_f32 v82, v78, 4.0, v76
    v_fma_f32 v90, v86, 4.0, v84
    v_fma_f32 v83, v79, 4.0, v77
    v_fma_f32 v91, v87, 4.0, v85
    v_add_f32 v77, v80, v81
    v_add_f32 v85, v88, v89
    v_sub_f32 v78, v80, v81
    v_sub_f32 v86, v88, v89
    v_fma_f32 v79, v83, 2.0, v82
    v_fma_f32 v87, v91, 2.0, v90
    v_fma_f32 v82, v83, -2.0, v82
    v_fma_f32 v90, v91, -2.0, v90
    v_fmamk_f32 v80, v76, 0x41700000, v82
    v_fmamk_f32 v88, v84, 0x41700000, v90
    v_fmamk_f32 v80, v81, 0x41200000, v80
    v_fmamk_f32 v88, v89, 0x41200000, v88
    v_cvt_pk_bf16_f32 v4, v77, v85
    v_cvt_pk_bf16_f32 v8, v78, v86
    v_cvt_pk_bf16_f32 v64, v79, v87
    v_cvt_pk_bf16_f32 v68, v82, v90
    v_cvt_pk_bf16_f32 v72, v80, v88
    v_lshlrev_b32 v76, 16, v1
    v_and_b32 v84, s25, v1
    v_lshlrev_b32 v77, 16, v5
    v_and_b32 v85, s25, v5
    v_lshlrev_b32 v78, 16, v9
    v_and_b32 v86, s25, v9
    v_lshlrev_b32 v79, 16, v13
    v_and_b32 v87, s25, v13
    v_add_f32 v80, v76, v78
    v_add_f32 v88, v84, v86
    v_add_f32 v81, v77, v79
    v_add_f32 v89, v85, v87
    v_fma_f32 v82, v78, 4.0, v76
    v_fma_f32 v90, v86, 4.0, v84
    v_fma_f32 v83, v79, 4.0, v77
    v_fma_f32 v91, v87, 4.0, v85
    v_add_f32 v77, v80, v81
    v_add_f32 v85, v88, v89
    v_sub_f32 v78, v80, v81
    v_sub_f32 v86, v88, v89
    v_fma_f32 v79, v83, 2.0, v82
    v_fma_f32 v87, v91, 2.0, v90
    v_fma_f32 v82, v83, -2.0, v82
    v_fma_f32 v90, v91, -2.0, v90
    v_fmamk_f32 v80, v76, 0x41700000, v82
    v_fmamk_f32 v88, v84, 0x41700000, v90
    v_fmamk_f32 v80, v81, 0x41200000, v80
    v_fmamk_f32 v88, v89, 0x41200000, v88
    v_cvt_pk_bf16_f32 v5, v77, v85
    v_cvt_pk_bf16_f32 v9, v78, v86
    v_cvt_pk_bf16_f32 v65, v79, v87
    v_cvt_pk_bf16_f32 v69, v82, v90
    v_cvt_pk_bf16_f32 v73, v80, v88
    v_lshlrev_b32 v76, 16, v2
    v_and_b32 v84, s25, v2
    v_lshlrev_b32 v77, 16, v6
    v_and_b32 v85, s25, v6
    v_lshlrev_b32 v78, 16, v10
    v_and_b32 v86, s25, v10
    v_lshlrev_b32 v79, 16, v14
    v_and_b32 v87, s25, v14
    v_add_f32 v80, v76, v78
    v_add_f32 v88, v84, v86
    v_add_f32 v81, v77, v79
    v_add_f32 v89, v85, v87
    v_fma_f32 v82, v78, 4.0, v76
    v_fma_f32 v90, v86, 4.0, v84
    v_fma_f32 v83, v79, 4.0, v77
    v_fma_f32 v91, v87, 4.0, v85
    v_add_f32 v77, v80, v81
    v_add_f32 v85, v88, v89
    v_sub_f32 v78, v80, v81
    v_sub_f32 v86, v88, v89
    v_fma_f32 v79, v83, 2.0, v82
    v_fma_f32 v87, v91, 2.0, v90
    v_fma_f32 v82, v83, -2.0, v82
    v_fma_f32 v90, v91, -2.0, v90
    v_fmamk_f32 v80, v76, 0x41700000, v82
    v_fmamk_f32 v88, v84, 0x41700000, v90
    v_fmamk_f32 v80, v81, 0x41200000, v80
    v_fmamk_f32 v88, v89, 0x41200000, v88
    v_cvt_pk_bf16_f32 v6, v77, v85
    v_cvt_pk_bf16_f32 v10, v78, v86
    v_cvt_pk_bf16_f32 v66, v79, v87
    v_cvt_pk_bf16_f32 v70, v82, v90
    v_cvt_pk_bf16_f32 v74, v80, v88
    v_lshlrev_b32 v76, 16, v3
    v_and_b32 v84, s25, v3
    v_lshlrev_b32 v77, 16, v7
    v_and_b32 v85, s25, v7
    v_lshlrev_b32 v78, 16, v11
    v_and_b32 v86, s25, v11
    v_lshlrev_b32 v79, 16, v15
    v_and_b32 v87, s25, v15
    v_add_f32 v80, v76, v78
    v_add_f32 v88, v84, v86
    v_add_f32 v81, v77, v79
    v_add_f32 v89, v85, v87
    v_fma_f32 v82, v78, 4.0, v76
    v_fma_f32 v90, v86, 4.0, v84
    v_fma_f32 v83, v79, 4.0, v77
    v_fma_f32 v91, v87, 4.0, v85
    v_add_f32 v77, v80, v81
    v_add_f32 v85, v88, v89
    v_sub_f32 v78, v80, v81
    v_sub_f32 v86, v88, v89
    v_fma_f32 v79, v83, 2.0, v82
    v_fma_f32 v87, v91, 2.0, v90
    v_fma_f32 v82, v83, -2.0, v82
    v_fma_f32 v90, v91, -2.0, v90
    v_fmamk_f32 v80, v76, 0x41700000, v82
    v_fmamk_f32 v88, v84, 0x41700000, v90
    v_fmamk_f32 v80, v81, 0x41200000, v80
    v_fmamk_f32 v88, v89, 0x41200000, v88
    v_cvt_pk_bf16_f32 v7, v77, v85
    v_cvt_pk_bf16_f32 v11, v78, v86
    v_cvt_pk_bf16_f32 v67, v79, v87
    v_cvt_pk_bf16_f32 v71, v82, v90
    v_cvt_pk_bf16_f32 v75, v80, v88
    ds_write_b128 v96, v[64:67] offset:49152
    ds_write_b128 v97, v[68:71] offset:0
    ds_write_b128 v97, v[72:75] offset:16384
    ds_write_b128 v96, v[4:7] offset:16384
    ds_write_b128 v96, v[8:11] offset:32768
    s_waitcnt vmcnt(0)
    buffer_load_dwordx4 v[32:35], v92, s[8:11], s24 offen offset:0
    buffer_load_dwordx4 v[48:51], v92, s[8:11], s24 offen offset:64
    v_add_u32 v92, 128, v92
    buffer_load_dwordx4 v[36:39], v93, s[8:11], s24 offen offset:0
    buffer_load_dwordx4 v[52:55], v93, s[8:11], s24 offen offset:64
    v_add_u32 v93, 128, v93
    s_waitcnt lgkmcnt(0)
    s_barrier
    s_setprio 1
L_conv1_kernel_hloop1:
    s_cmp_lt_u32 s28, 13
    s_cselect_b32 s24, 0, 2130706432
    v_lshlrev_b32 v76, 16, v16
    v_and_b32 v84, s25, v16
    v_lshlrev_b32 v77, 16, v20
    v_and_b32 v85, s25, v20
    v_lshlrev_b32 v78, 16, v24
    v_and_b32 v86, s25, v24
    v_lshlrev_b32 v79, 16, v28
    v_and_b32 v87, s25, v28
    v_add_f32 v80, v76, v78
    v_add_f32 v88, v84, v86
    v_add_f32 v81, v77, v79
    v_add_f32 v89, v85, v87
    v_fma_f32 v82, v78, 4.0, v76
    buffer_load_dwordx4 v[40:43], v94, s[8:11], s24 offen offset:0
    buffer_load_dwordx4 v[56:59], v94, s[8:11], s24 offen offset:64
    v_add_u32 v94, 128, v94
    v_fma_f32 v90, v86, 4.0, v84
    v_fma_f32 v83, v79, 4.0, v77
    v_fma_f32 v91, v87, 4.0, v85
    v_add_f32 v77, v80, v81
    v_add_f32 v85, v88, v89
    v_sub_f32 v78, v80, v81
    v_sub_f32 v86, v88, v89
    v_fma_f32 v79, v83, 2.0, v82
    v_fma_f32 v87, v91, 2.0, v90
    v_fma_f32 v82, v83, -2.0, v82
    v_fma_f32 v90, v91, -2.0, v90
    v_fmamk_f32 v80, v76, 0x41700000, v82
    v_fmamk_f32 v88, v84, 0x41700000, v90
    v_fmamk_f32 v80, v81, 0x41200000, v80
    v_fmamk_f32 v88, v89, 0x41200000, v88
    v_cvt_pk_bf16_f32 v20, v77, v85
    v_cvt_pk_bf16_f32 v24, v78, v86
    v_cvt_pk_bf16_f32 v64, v79, v87
    v_cvt_pk_bf16_f32 v68, v82, v90
    v_cvt_pk_bf16_f32 v72, v80, v88
    v_lshlrev_b32 v76, 16, v17
    v_and_b32 v84, s25, v17
    v_lshlrev_b32 v77, 16, v21
    v_and_b32 v85, s25, v21
    v_lshlrev_b32 v78, 16, v25
    v_and_b32 v86, s25, v25
    v_lshlrev_b32 v79, 16, v29
    v_and_b32 v87, s25, v29
    v_add_f32 v80, v76, v78
    v_add_f32 v88, v84, v86
    v_add_f32 v81, v77, v79
    v_add_f32 v89, v85, v87
    v_fma_f32 v82, v78, 4.0, v76
    v_fma_f32 v90, v86, 4.0, v84
    v_fma_f32 v83, v79, 4.0, v77
    v_fma_f32 v91, v87, 4.0, v85
    v_add_f32 v77, v80, v81
    v_add_f32 v85, v88, v89
    v_sub_f32 v78, v80, v81
    v_sub_f32 v86, v88, v89
    v_fma_f32 v79, v83, 2.0, v82
    v_fma_f32 v87, v91, 2.0, v90
    v_fma_f32 v82, v83, -2.0, v82
    v_fma_f32 v90, v91, -2.0, v90
    v_fmamk_f32 v80, v76, 0x41700000, v82
    v_fmamk_f32 v88, v84, 0x41700000, v90
    v_fmamk_f32 v80, v81, 0x41200000, v80
    v_fmamk_f32 v88, v89, 0x41200000, v88
    v_cvt_pk_bf16_f32 v21, v77, v85
    v_cvt_pk_bf16_f32 v25, v78, v86
    v_cvt_pk_bf16_f32 v65, v79, v87
    v_cvt_pk_bf16_f32 v69, v82, v90
    v_cvt_pk_bf16_f32 v73, v80, v88
    buffer_load_dwordx4 v[44:47], v95, s[8:11], s24 offen offset:0
    buffer_load_dwordx4 v[60:63], v95, s[8:11], s24 offen offset:64
    v_add_u32 v95, 128, v95
    v_lshlrev_b32 v76, 16, v18
    v_and_b32 v84, s25, v18
    v_lshlrev_b32 v77, 16, v22
    v_and_b32 v85, s25, v22
    v_lshlrev_b32 v78, 16, v26
    v_and_b32 v86, s25, v26
    v_lshlrev_b32 v79, 16, v30
    v_and_b32 v87, s25, v30
    v_add_f32 v80, v76, v78
    v_add_f32 v88, v84, v86
    v_add_f32 v81, v77, v79
    v_add_f32 v89, v85, v87
    v_fma_f32 v82, v78, 4.0, v76
    v_fma_f32 v90, v86, 4.0, v84
    v_fma_f32 v83, v79, 4.0, v77
    v_fma_f32 v91, v87, 4.0, v85
    v_add_f32 v77, v80, v81
    v_add_f32 v85, v88, v89
    v_sub_f32 v78, v80, v81
    v_sub_f32 v86, v88, v89
    v_fma_f32 v79, v83, 2.0, v82
    v_fma_f32 v87, v91, 2.0, v90
    v_fma_f32 v82, v83, -2.0, v82
    v_fma_f32 v90, v91, -2.0, v90
    v_fmamk_f32 v80, v76, 0x41700000, v82
    v_fmamk_f32 v88, v84, 0x41700000, v90
    v_fmamk_f32 v80, v81, 0x41200000, v80
    v_fmamk_f32 v88, v89, 0x41200000, v88
    v_cvt_pk_bf16_f32 v22, v77, v85
    v_cvt_pk_bf16_f32 v26, v78, v86
    v_cvt_pk_bf16_f32 v66, v79, v87
    v_cvt_pk_bf16_f32 v70, v82, v90
    v_cvt_pk_bf16_f32 v74, v80, v88
    v_lshlrev_b32 v76, 16, v19
    v_and_b32 v84, s25, v19
    v_lshlrev_b32 v77, 16, v23
    v_and_b32 v85, s25, v23
    v_lshlrev_b32 v78, 16, v27
    v_and_b32 v86, s25, v27
    v_lshlrev_b32 v79, 16, v31
    v_and_b32 v87, s25, v31
    v_add_f32 v80, v76, v78
    v_add_f32 v88, v84, v86
    v_add_f32 v81, v77, v79
    v_add_f32 v89, v85, v87
    v_fma_f32 v82, v78, 4.0, v76
    v_fma_f32 v90, v86, 4.0, v84
    v_fma_f32 v83, v79, 4.0, v77
    v_fma_f32 v91, v87, 4.0, v85
    v_add_f32 v77, v80, v81
    v_add_f32 v85, v88, v89
    v_sub_f32 v78, v80, v81
    v_sub_f32 v86, v88, v89
    v_fma_f32 v79, v83, 2.0, v82
    v_fma_f32 v87, v91, 2.0, v90
    v_fma_f32 v82, v83, -2.0, v82
    v_fma_f32 v90, v91, -2.0, v90
    v_fmamk_f32 v80, v76, 0x41700000, v82
    v_fmamk_f32 v88, v84, 0x41700000, v90
    v_fmamk_f32 v80, v81, 0x41200000, v80
    v_fmamk_f32 v88, v89, 0x41200000, v88
    v_cvt_pk_bf16_f32 v23, v77, v85
    v_cvt_pk_bf16_f32 v27, v78, v86
    v_cvt_pk_bf16_f32 v67, v79, v87
    v_cvt_pk_bf16_f32 v71, v82, v90
    v_cvt_pk_bf16_f32 v75, v80, v88
    ds_write_b128 v96, v[64:67] offset:57344
    ds_write_b128 v97, v[68:71] offset:8192
    ds_write_b128 v97, v[72:75] offset:24576
    ds_write_b128 v96, v[16:19] offset:8192
    ds_write_b128 v96, v[20:23] offset:24576
    ds_write_b128 v96, v[24:27] offset:40960
    ds_write_b128 v98, v[28:31] offset:8704
    s_add_u32 s28, s28, 1
    s_waitcnt lgkmcnt(0)
    s_barrier
    s_cmp_lt_u32 s28, 13
    s_cselect_b32 s24, 0, 2130706432
    s_waitcnt vmcnt(0)
    v_lshlrev_b32 v76, 16, v32
    v_and_b32 v84, s25, v32
    v_lshlrev_b32 v77, 16, v36
    v_and_b32 v85, s25, v36
    v_lshlrev_b32 v78, 16, v40
    v_and_b32 v86, s25, v40
    v_lshlrev_b32 v79, 16, v44
    v_and_b32 v87, s25, v44
    v_add_f32 v80, v76, v78
    v_add_f32 v88, v84, v86
    v_add_f32 v81, v77, v79
    v_add_f32 v89, v85, v87
    v_fma_f32 v82, v78, 4.0, v76
    v_fma_f32 v90, v86, 4.0, v84
    v_fma_f32 v83, v79, 4.0, v77
    v_fma_f32 v91, v87, 4.0, v85
    v_add_f32 v77, v80, v81
    v_add_f32 v85, v88, v89
    v_sub_f32 v78, v80, v81
    v_sub_f32 v86, v88, v89
    v_fma_f32 v79, v83, 2.0, v82
    v_fma_f32 v87, v91, 2.0, v90
    v_fma_f32 v82, v83, -2.0, v82
    v_fma_f32 v90, v91, -2.0, v90
    v_fmamk_f32 v80, v76, 0x41700000, v82
    v_fmamk_f32 v88, v84, 0x41700000, v90
    v_fmamk_f32 v80, v81, 0x41200000, v80
    v_fmamk_f32 v88, v89, 0x41200000, v88
    v_cvt_pk_bf16_f32 v36, v77, v85
    v_cvt_pk_bf16_f32 v40, v78, v86
    v_cvt_pk_bf16_f32 v64, v79, v87
    v_cvt_pk_bf16_f32 v68, v82, v90
    v_cvt_pk_bf16_f32 v72, v80, v88
    v_lshlrev_b32 v76, 16, v33
    v_and_b32 v84, s25, v33
    v_lshlrev_b32 v77, 16, v37
    v_and_b32 v85, s25, v37
    v_lshlrev_b32 v78, 16, v41
    v_and_b32 v86, s25, v41
    buffer_load_dwordx4 v[0:3], v92, s[8:11], s24 offen offset:0
    buffer_load_dwordx4 v[16:19], v92, s[8:11], s24 offen offset:64
    v_add_u32 v92, 128, v92
    v_lshlrev_b32 v79, 16, v45
    v_and_b32 v87, s25, v45
    v_add_f32 v80, v76, v78
    v_add_f32 v88, v84, v86
    v_add_f32 v81, v77, v79
    v_add_f32 v89, v85, v87
    v_fma_f32 v82, v78, 4.0, v76
    v_fma_f32 v90, v86, 4.0, v84
    v_fma_f32 v83, v79, 4.0, v77
    v_fma_f32 v91, v87, 4.0, v85
    v_add_f32 v77, v80, v81
    v_add_f32 v85, v88, v89
    v_sub_f32 v78, v80, v81
    v_sub_f32 v86, v88, v89
    v_fma_f32 v79, v83, 2.0, v82
    v_fma_f32 v87, v91, 2.0, v90
    v_fma_f32 v82, v83, -2.0, v82
    v_fma_f32 v90, v91, -2.0, v90
    v_fmamk_f32 v80, v76, 0x41700000, v82
    v_fmamk_f32 v88, v84, 0x41700000, v90
    v_fmamk_f32 v80, v81, 0x41200000, v80
    v_fmamk_f32 v88, v89, 0x41200000, v88
    v_cvt_pk_bf16_f32 v37, v77, v85
    v_cvt_pk_bf16_f32 v41, v78, v86
    v_cvt_pk_bf16_f32 v65, v79, v87
    v_cvt_pk_bf16_f32 v69, v82, v90
    v_cvt_pk_bf16_f32 v73, v80, v88
    v_lshlrev_b32 v76, 16, v34
    v_and_b32 v84, s25, v34
    v_lshlrev_b32 v77, 16, v38
    v_and_b32 v85, s25, v38
    v_lshlrev_b32 v78, 16, v42
    v_and_b32 v86, s25, v42
    v_lshlrev_b32 v79, 16, v46
    v_and_b32 v87, s25, v46
    v_add_f32 v80, v76, v78
    v_add_f32 v88, v84, v86
    v_add_f32 v81, v77, v79
    v_add_f32 v89, v85, v87
    v_fma_f32 v82, v78, 4.0, v76
    v_fma_f32 v90, v86, 4.0, v84
    v_fma_f32 v83, v79, 4.0, v77
    v_fma_f32 v91, v87, 4.0, v85
    v_add_f32 v77, v80, v81
    v_add_f32 v85, v88, v89
    v_sub_f32 v78, v80, v81
    v_sub_f32 v86, v88, v89
    v_fma_f32 v79, v83, 2.0, v82
    v_fma_f32 v87, v91, 2.0, v90
    v_fma_f32 v82, v83, -2.0, v82
    v_fma_f32 v90, v91, -2.0, v90
    v_fmamk_f32 v80, v76, 0x41700000, v82
    v_fmamk_f32 v88, v84, 0x41700000, v90
    buffer_load_dwordx4 v[4:7], v93, s[8:11], s24 offen offset:0
    buffer_load_dwordx4 v[20:23], v93, s[8:11], s24 offen offset:64
    v_add_u32 v93, 128, v93
    v_fmamk_f32 v80, v81, 0x41200000, v80
    v_fmamk_f32 v88, v89, 0x41200000, v88
    v_cvt_pk_bf16_f32 v38, v77, v85
    v_cvt_pk_bf16_f32 v42, v78, v86
    v_cvt_pk_bf16_f32 v66, v79, v87
    v_cvt_pk_bf16_f32 v70, v82, v90
    v_cvt_pk_bf16_f32 v74, v80, v88
    v_lshlrev_b32 v76, 16, v35
    v_and_b32 v84, s25, v35
    v_lshlrev_b32 v77, 16, v39
    v_and_b32 v85, s25, v39
    v_lshlrev_b32 v78, 16, v43
    v_and_b32 v86, s25, v43
    v_lshlrev_b32 v79, 16, v47
    v_and_b32 v87, s25, v47
    v_add_f32 v80, v76, v78
    v_add_f32 v88, v84, v86
    v_add_f32 v81, v77, v79
    v_add_f32 v89, v85, v87
    v_fma_f32 v82, v78, 4.0, v76
    v_fma_f32 v90, v86, 4.0, v84
    v_fma_f32 v83, v79, 4.0, v77
    v_fma_f32 v91, v87, 4.0, v85
    v_add_f32 v77, v80, v81
    v_add_f32 v85, v88, v89
    v_sub_f32 v78, v80, v81
    v_sub_f32 v86, v88, v89
    v_fma_f32 v79, v83, 2.0, v82
    v_fma_f32 v87, v91, 2.0, v90
    v_fma_f32 v82, v83, -2.0, v82
    v_fma_f32 v90, v91, -2.0, v90
    v_fmamk_f32 v80, v76, 0x41700000, v82
    v_fmamk_f32 v88, v84, 0x41700000, v90
    v_fmamk_f32 v80, v81, 0x41200000, v80
    v_fmamk_f32 v88, v89, 0x41200000, v88
    v_cvt_pk_bf16_f32 v39, v77, v85
    v_cvt_pk_bf16_f32 v43, v78, v86
    v_cvt_pk_bf16_f32 v67, v79, v87
    v_cvt_pk_bf16_f32 v71, v82, v90
    v_cvt_pk_bf16_f32 v75, v80, v88
    ds_write_b128 v96, v[64:67] offset:49152
    ds_write_b128 v97, v[68:71] offset:0
    ds_write_b128 v97, v[72:75] offset:16384
    ds_write_b128 v96, v[32:35] offset:0
    ds_write_b128 v96, v[36:39] offset:16384
    ds_write_b128 v96, v[40:43] offset:32768
    ds_write_b128 v98, v[44:47] offset:0
    s_add_u32 s28, s28, 1
    s_waitcnt lgkmcnt(0)
    s_barrier
    s_cmp_lt_u32 s28, 13
    s_cselect_b32 s24, 0, 2130706432
    v_lshlrev_b32 v76, 16, v48
    v_and_b32 v84, s25, v48
    v_lshlrev_b32 v77, 16, v52
    v_and_b32 v85, s25, v52
    v_lshlrev_b32 v78, 16, v56
    v_and_b32 v86, s25, v56
    v_lshlrev_b32 v79, 16, v60
    v_and_b32 v87, s25, v60
    v_add_f32 v80, v76, v78
    v_add_f32 v88, v84, v86
    v_add_f32 v81, v77, v79
    v_add_f32 v89, v85, v87
    v_fma_f32 v82, v78, 4.0, v76
    buffer_load_dwordx4 v[8:11], v94, s[8:11], s24 offen offset:0
    buffer_load_dwordx4 v[24:27], v94, s[8:11], s24 offen offset:64
    v_add_u32 v94, 128, v94
    v_fma_f32 v90, v86, 4.0, v84
    v_fma_f32 v83, v79, 4.0, v77
    v_fma_f32 v91, v87, 4.0, v85
    v_add_f32 v77, v80, v81
    v_add_f32 v85, v88, v89
    v_sub_f32 v78, v80, v81
    v_sub_f32 v86, v88, v89
    v_fma_f32 v79, v83, 2.0, v82
    v_fma_f32 v87, v91, 2.0, v90
    v_fma_f32 v82, v83, -2.0, v82
    v_fma_f32 v90, v91, -2.0, v90
    v_fmamk_f32 v80, v76, 0x41700000, v82
    v_fmamk_f32 v88, v84, 0x41700000, v90
    v_fmamk_f32 v80, v81, 0x41200000, v80
    v_fmamk_f32 v88, v89, 0x41200000, v88
    v_cvt_pk_bf16_f32 v52, v77, v85
    v_cvt_pk_bf16_f32 v56, v78, v86
    v_cvt_pk_bf16_f32 v64, v79, v87
    v_cvt_pk_bf16_f32 v68, v82, v90
    v_cvt_pk_bf16_f32 v72, v80, v88
    v_lshlrev_b32 v76, 16, v49
    v_and_b32 v84, s25, v49
    v_lshlrev_b32 v77, 16, v53
    v_and_b32 v85, s25, v53
    v_lshlrev_b32 v78, 16, v57
    v_and_b32 v86, s25, v57
    v_lshlrev_b32 v79, 16, v61
    v_and_b32 v87, s25, v61
    v_add_f32 v80, v76, v78
    v_add_f32 v88, v84, v86
    v_add_f32 v81, v77, v79
    v_add_f32 v89, v85, v87
    v_fma_f32 v82, v78, 4.0, v76
    v_fma_f32 v90, v86, 4.0, v84
    v_fma_f32 v83, v79, 4.0, v77
    v_fma_f32 v91, v87, 4.0, v85
    v_add_f32 v77, v80, v81
    v_add_f32 v85, v88, v89
    v_sub_f32 v78, v80, v81
    v_sub_f32 v86, v88, v89
    v_fma_f32 v79, v83, 2.0, v82
    v_fma_f32 v87, v91, 2.0, v90
    v_fma_f32 v82, v83, -2.0, v82
    v_fma_f32 v90, v91, -2.0, v90
    v_fmamk_f32 v80, v76, 0x41700000, v82
    v_fmamk_f32 v88, v84, 0x41700000, v90
    v_fmamk_f32 v80, v81, 0x41200000, v80
    v_fmamk_f32 v88, v89, 0x41200000, v88
    v_cvt_pk_bf16_f32 v53, v77, v85
    v_cvt_pk_bf16_f32 v57, v78, v86
    v_cvt_pk_bf16_f32 v65, v79, v87
    v_cvt_pk_bf16_f32 v69, v82, v90
    v_cvt_pk_bf16_f32 v73, v80, v88
    buffer_load_dwordx4 v[12:15], v95, s[8:11], s24 offen offset:0
    buffer_load_dwordx4 v[28:31], v95, s[8:11], s24 offen offset:64
    v_add_u32 v95, 128, v95
    v_lshlrev_b32 v76, 16, v50
    v_and_b32 v84, s25, v50
    v_lshlrev_b32 v77, 16, v54
    v_and_b32 v85, s25, v54
    v_lshlrev_b32 v78, 16, v58
    v_and_b32 v86, s25, v58
    v_lshlrev_b32 v79, 16, v62
    v_and_b32 v87, s25, v62
    v_add_f32 v80, v76, v78
    v_add_f32 v88, v84, v86
    v_add_f32 v81, v77, v79
    v_add_f32 v89, v85, v87
    v_fma_f32 v82, v78, 4.0, v76
    v_fma_f32 v90, v86, 4.0, v84
    v_fma_f32 v83, v79, 4.0, v77
    v_fma_f32 v91, v87, 4.0, v85
    v_add_f32 v77, v80, v81
    v_add_f32 v85, v88, v89
    v_sub_f32 v78, v80, v81
    v_sub_f32 v86, v88, v89
    v_fma_f32 v79, v83, 2.0, v82
    v_fma_f32 v87, v91, 2.0, v90
    v_fma_f32 v82, v83, -2.0, v82
    v_fma_f32 v90, v91, -2.0, v90
    v_fmamk_f32 v80, v76, 0x41700000, v82
    v_fmamk_f32 v88, v84, 0x41700000, v90
    v_fmamk_f32 v80, v81, 0x41200000, v80
    v_fmamk_f32 v88, v89, 0x41200000, v88
    v_cvt_pk_bf16_f32 v54, v77, v85
    v_cvt_pk_bf16_f32 v58, v78, v86
    v_cvt_pk_bf16_f32 v66, v79, v87
    v_cvt_pk_bf16_f32 v70, v82, v90
    v_cvt_pk_bf16_f32 v74, v80, v88
    v_lshlrev_b32 v76, 16, v51
    v_and_b32 v84, s25, v51
    v_lshlrev_b32 v77, 16, v55
    v_and_b32 v85, s25, v55
    v_lshlrev_b32 v78, 16, v59
    v_and_b32 v86, s25, v59
    v_lshlrev_b32 v79, 16, v63
    v_and_b32 v87, s25, v63
    v_add_f32 v80, v76, v78
    v_add_f32 v88, v84, v86
    v_add_f32 v81, v77, v79
    v_add_f32 v89, v85, v87
    v_fma_f32 v82, v78, 4.0, v76
    v_fma_f32 v90, v86, 4.0, v84
    v_fma_f32 v83, v79, 4.0, v77
    v_fma_f32 v91, v87, 4.0, v85
    v_add_f32 v77, v80, v81
    v_add_f32 v85, v88, v89
    v_sub_f32 v78, v80, v81
    v_sub_f32 v86, v88, v89
    v_fma_f32 v79, v83, 2.0, v82
    v_fma_f32 v87, v91, 2.0, v90
    v_fma_f32 v82, v83, -2.0, v82
    v_fma_f32 v90, v91, -2.0, v90
    v_fmamk_f32 v80, v76, 0x41700000, v82
    v_fmamk_f32 v88, v84, 0x41700000, v90
    v_fmamk_f32 v80, v81, 0x41200000, v80
    v_fmamk_f32 v88, v89, 0x41200000, v88
    v_cvt_pk_bf16_f32 v55, v77, v85
    v_cvt_pk_bf16_f32 v59, v78, v86
    v_cvt_pk_bf16_f32 v67, v79, v87
    v_cvt_pk_bf16_f32 v71, v82, v90
    v_cvt_pk_bf16_f32 v75, v80, v88
    ds_write_b128 v96, v[64:67] offset:57344
    ds_write_b128 v97, v[68:71] offset:8192
    ds_write_b128 v97, v[72:75] offset:24576
    ds_write_b128 v96, v[48:51] offset:8192
    ds_write_b128 v96, v[52:55] offset:24576
    ds_write_b128 v96, v[56:59] offset:40960
    ds_write_b128 v98, v[60:63] offset:8704
    s_add_u32 s28, s28, 1
    s_waitcnt lgkmcnt(0)
    s_barrier
    s_cmp_eq_u32 s22, 1
    s_cbranch_scc1 L_conv1_kernel_hlast1
    s_cmp_lt_u32 s28, 13
    s_cselect_b32 s24, 0, 2130706432
    s_waitcnt vmcnt(0)
    v_lshlrev_b32 v76, 16, v0
    v_and_b32 v84, s25, v0
    v_lshlrev_b32 v77, 16, v4
    v_and_b32 v85, s25, v4
    v_lshlrev_b32 v78, 16, v8
    v_and_b32 v86, s25, v8
    v_lshlrev_b32 v79, 16, v12
    v_and_b32 v87, s25, v12
    v_add_f32 v80, v76, v78
    v_add_f32 v88, v84, v86
    v_add_f32 v81, v77, v79
    v_add_f32 v89, v85, v87
    v_fma_f32 v82, v78, 4.0, v76
    v_fma_f32 v90, v86, 4.0, v84
    v_fma_f32 v83, v79, 4.0, v77
    v_fma_f32 v91, v87, 4.0, v85
    v_add_f32 v77, v80, v81
    v_add_f32 v85, v88, v89
    v_sub_f32 v78, v80, v81
    v_sub_f32 v86, v88, v89
    v_fma_f32 v79, v83, 2.0, v82
    v_fma_f32 v87, v91, 2.0, v90
    v_fma_f32 v82, v83, -2.0, v82
    v_fma_f32 v90, v91, -2.0, v90
    v_fmamk_f32 v80, v76, 0x41700000, v82
    v_fmamk_f32 v88, v84, 0x41700000, v90
    v_fmamk_f32 v80, v81, 0x41200000, v80
    v_fmamk_f32 v88, v89, 0x41200000, v88
    v_cvt_pk_bf16_f32 v4, v77, v85
    v_cvt_pk_bf16_f32 v8, v78, v86
    v_cvt_pk_bf16_f32 v64, v79, v87
    v_cvt_pk_bf16_f32 v68, v82, v90
    v_cvt_pk_bf16_f32 v72, v80, v88
    v_lshlrev_b32 v76, 16, v1
    v_and_b32 v84, s25, v1
    v_lshlrev_b32 v77, 16, v5
    v_and_b32 v85, s25, v5
    v_lshlrev_b32 v78, 16, v9
    v_and_b32 v86, s25, v9
    buffer_load_dwordx4 v[32:35], v92, s[8:11], s24 offen offset:0
    buffer_load_dwordx4 v[48:51], v92, s[8:11], s24 offen offset:64
    v_add_u32 v92, 128, v92
    v_lshlrev_b32 v79, 16, v13
    v_and_b32 v87, s25, v13
    v_add_f32 v80, v76, v78
    v_add_f32 v88, v84, v86
    v_add_f32 v81, v77, v79
    v_add_f32 v89, v85, v87
    v_fma_f32 v82, v78, 4.0, v76
    v_fma_f32 v90, v86, 4.0, v84
    v_fma_f32 v83, v79, 4.0, v77
    v_fma_f32 v91, v87, 4.0, v85
    v_add_f32 v77, v80, v81
    v_add_f32 v85, v88, v89
    v_sub_f32 v78, v80, v81
    v_sub_f32 v86, v88, v89
    v_fma_f32 v79, v83, 2.0, v82
    v_fma_f32 v87, v91, 2.0, v90
    v_fma_f32 v82, v83, -2.0, v82
    v_fma_f32 v90, v91, -2.0, v90
    v_fmamk_f32 v80, v76, 0x41700000, v82
    v_fmamk_f32 v88, v84, 0x41700000, v90
    v_fmamk_f32 v80, v81, 0x41200000, v80
    v_fmamk_f32 v88, v89, 0x41200000, v88
    v_cvt_pk_bf16_f32 v5, v77, v85
    v_cvt_pk_bf16_f32 v9, v78, v86
    v_cvt_pk_bf16_f32 v65, v79, v87
    v_cvt_pk_bf16_f32 v69, v82, v90
    v_cvt_pk_bf16_f32 v73, v80, v88
    v_lshlrev_b32 v76, 16, v2
    v_and_b32 v84, s25, v2
    v_lshlrev_b32 v77, 16, v6
    v_and_b32 v85, s25, v6
    v_lshlrev_b32 v78, 16, v10
    v_and_b32 v86, s25, v10
    v_lshlrev_b32 v79, 16, v14
    v_and_b32 v87, s25, v14
    v_add_f32 v80, v76, v78
    v_add_f32 v88, v84, v86
    v_add_f32 v81, v77, v79
    v_add_f32 v89, v85, v87
    v_fma_f32 v82, v78, 4.0, v76
    v_fma_f32 v90, v86, 4.0, v84
    v_fma_f32 v83, v79, 4.0, v77
    v_fma_f32 v91, v87, 4.0, v85
    v_add_f32 v77, v80, v81
    v_add_f32 v85, v88, v89
    v_sub_f32 v78, v80, v81
    v_sub_f32 v86, v88, v89
    v_fma_f32 v79, v83, 2.0, v82
    v_fma_f32 v87, v91, 2.0, v90
    v_fma_f32 v82, v83, -2.0, v82
    v_fma_f32 v90, v91, -2.0, v90
    v_fmamk_f32 v80, v76, 0x41700000, v82
    v_fmamk_f32 v88, v84, 0x41700000, v90
    buffer_load_dwordx4 v[36:39], v93, s[8:11], s24 offen offset:0
    buffer_load_dwordx4 v[52:55], v93, s[8:11], s24 offen offset:64
    v_add_u32 v93, 128, v93
    v_fmamk_f32 v80, v81, 0x41200000, v80
    v_fmamk_f32 v88, v89, 0x41200000, v88
    v_cvt_pk_bf16_f32 v6, v77, v85
    v_cvt_pk_bf16_f32 v10, v78, v86
    v_cvt_pk_bf16_f32 v66, v79, v87
    v_cvt_pk_bf16_f32 v70, v82, v90
    v_cvt_pk_bf16_f32 v74, v80, v88
    v_lshlrev_b32 v76, 16, v3
    v_and_b32 v84, s25, v3
    v_lshlrev_b32 v77, 16, v7
    v_and_b32 v85, s25, v7
    v_lshlrev_b32 v78, 16, v11
    v_and_b32 v86, s25, v11
    v_lshlrev_b32 v79, 16, v15
    v_and_b32 v87, s25, v15
    v_add_f32 v80, v76, v78
    v_add_f32 v88, v84, v86
    v_add_f32 v81, v77, v79
    v_add_f32 v89, v85, v87
    v_fma_f32 v82, v78, 4.0, v76
    v_fma_f32 v90, v86, 4.0, v84
    v_fma_f32 v83, v79, 4.0, v77
    v_fma_f32 v91, v87, 4.0, v85
    v_add_f32 v77, v80, v81
    v_add_f32 v85, v88, v89
    v_sub_f32 v78, v80, v81
    v_sub_f32 v86, v88, v89
    v_fma_f32 v79, v83, 2.0, v82
    v_fma_f32 v87, v91, 2.0, v90
    v_fma_f32 v82, v83, -2.0, v82
    v_fma_f32 v90, v91, -2.0, v90
    v_fmamk_f32 v80, v76, 0x41700000, v82
    v_fmamk_f32 v88, v84, 0x41700000, v90
    v_fmamk_f32 v80, v81, 0x41200000, v80
    v_fmamk_f32 v88, v89, 0x41200000, v88
    v_cvt_pk_bf16_f32 v7, v77, v85
    v_cvt_pk_bf16_f32 v11, v78, v86
    v_cvt_pk_bf16_f32 v67, v79, v87
    v_cvt_pk_bf16_f32 v71, v82, v90
    v_cvt_pk_bf16_f32 v75, v80, v88
    ds_write_b128 v96, v[64:67] offset:49152
    ds_write_b128 v97, v[68:71] offset:0
    ds_write_b128 v97, v[72:75] offset:16384
    ds_write_b128 v96, v[0:3] offset:0
    ds_write_b128 v96, v[4:7] offset:16384
    ds_write_b128 v96, v[8:11] offset:32768
    ds_write_b128 v98, v[12:15] offset:0
    s_add_u32 s28, s28, 1
    s_waitcnt lgkmcnt(0)
    s_barrier
    s_sub_u32 s22, s22, 1
    s_branch L_conv1_kernel_hloop1
L_conv1_kernel_hlast1:
    s_branch L_conv1_kernel_end
L_conv1_kernel_h2:
    ds_write_b128 v96, v[0:3] offset:0
    ds_write_b128 v98, v[12:15] offset:0
    v_lshlrev_b32 v76, 16, v0
    v_and_b32 v84, s25, v0
    v_lshlrev_b32 v77, 16, v4
    v_and_b32 v85, s25, v4
    v_lshlrev_b32 v78, 16, v8
    v_and_b32 v86, s25, v8
    v_lshlrev_b32 v79, 16, v12
    v_and_b32 v87, s25, v12
    v_add_f32 v80, v76, v78
    v_add_f32 v88, v84, v86
    v_add_f32 v81, v77, v79
    v_add_f32 v89, v85, v87
    v_fma_f32 v82, v78, 4.0, v76
    v_fma_f32 v90, v86, 4.0, v84
    v_fma_f32 v83, v79, 4.0, v77
    v_fma_f32 v91, v87, 4.0, v85
    v_add_f32 v77, v80, v81
    v_add_f32 v85, v88, v89
    v_sub_f32 v78, v80, v81
    v_sub_f32 v86, v88, v89
    v_fma_f32 v79, v83, 2.0, v82
    v_fma_f32 v87, v91, 2.0, v90
    v_fma_f32 v82, v83, -2.0, v82
    v_fma_f32 v90, v91, -2.0, v90
    v_fmamk_f32 v80, v76, 0x41700000, v82
    v_fmamk_f32 v88, v84, 0x41700000, v90
    v_fmamk_f32 v80, v81, 0x41200000, v80
    v_fmamk_f32 v88, v89, 0x41200000, v88
    v_cvt_pk_bf16_f32 v4, v77, v85
    v_cvt_pk_bf16_f32 v8, v78, v86
    v_cvt_pk_bf16_f32 v64, v79, v87
    v_cvt_pk_bf16_f32 v68, v82, v90
    v_cvt_pk_bf16_f32 v72, v80, v88
    v_lshlrev_b32 v76, 16, v1
    v_and_b32 v84, s25, v1
    v_lshlrev_b32 v77, 16, v5
    v_and_b32 v85, s25, v5
    v_lshlrev_b32 v78, 16, v9
    v_and_b32 v86, s25, v9
    v_lshlrev_b32 v79, 16, v13
    v_and_b32 v87, s25, v13
    v_add_f32 v80, v76, v78
    v_add_f32 v88, v84, v86
    v_add_f32 v81, v77, v79
    v_add_f32 v89, v85, v87
    v_fma_f32 v82, v78, 4.0, v76
    v_fma_f32 v90, v86, 4.0, v84
    v_fma_f32 v83, v79, 4.0, v77
    v_fma_f32 v91, v87, 4.0, v85
    v_add_f32 v77, v80, v81
    v_add_f32 v85, v88, v89
    v_sub_f32 v78, v80, v81
    v_sub_f32 v86, v88, v89
    v_fma_f32 v79, v83, 2.0, v82
    v_fma_f32 v87, v91, 2.0, v90
    v_fma_f32 v82, v83, -2.0, v82
    v_fma_f32 v90, v91, -2.0, v90
    v_fmamk_f32 v80, v76, 0x41700000, v82
    v_fmamk_f32 v88, v84, 0x41700000, v90
    v_fmamk_f32 v80, v81, 0x41200000, v80
    v_fmamk_f32 v88, v89, 0x41200000, v88
    v_cvt_pk_bf16_f32 v5, v77, v85
    v_cvt_pk_bf16_f32 v9, v78, v86
    v_cvt_pk_bf16_f32 v65, v79, v87
    v_cvt_pk_bf16_f32 v69, v82, v90
    v_cvt_pk_bf16_f32 v73, v80, v88
    v_lshlrev_b32 v76, 16, v2
    v_and_b32 v84, s25, v2
    v_lshlrev_b32 v77, 16, v6
    v_and_b32 v85, s25, v6
    v_lshlrev_b32 v78, 16, v10
    v_and_b32 v86, s25, v10
    v_lshlrev_b32 v79, 16, v14
    v_and_b32 v87, s25, v14
    v_add_f32 v80, v76, v78
    v_add_f32 v88, v84, v86
    v_add_f32 v81, v77, v79
    v_add_f32 v89, v85, v87
    v_fma_f32 v82, v78, 4.0, v76
    v_fma_f32 v90, v86, 4.0, v84
    v_fma_f32 v83, v79, 4.0, v77
    v_fma_f32 v91, v87, 4.0, v85
    v_add_f32 v77, v80, v81
    v_add_f32 v85, v88, v89
    v_sub_f32 v78, v80, v81
    v_sub_f32 v86, v88, v89
    v_fma_f32 v79, v83, 2.0, v82
    v_fma_f32 v87, v91, 2.0, v90
    v_fma_f32 v82, v83, -2.0, v82
    v_fma_f32 v90, v91, -2.0, v90
    v_fmamk_f32 v80, v76, 0x41700000, v82
    v_fmamk_f32 v88, v84, 0x41700000, v90
    v_fmamk_f32 v80, v81, 0x41200000, v80
    v_fmamk_f32 v88, v89, 0x41200000, v88
    v_cvt_pk_bf16_f32 v6, v77, v85
    v_cvt_pk_bf16_f32 v10, v78, v86
    v_cvt_pk_bf16_f32 v66, v79, v87
    v_cvt_pk_bf16_f32 v70, v82, v90
    v_cvt_pk_bf16_f32 v74, v80, v88
    v_lshlrev_b32 v76, 16, v3
    v_and_b32 v84, s25, v3
    v_lshlrev_b32 v77, 16, v7
    v_and_b32 v85, s25, v7
    v_lshlrev_b32 v78, 16, v11
    v_and_b32 v86, s25, v11
    v_lshlrev_b32 v79, 16, v15
    v_and_b32 v87, s25, v15
    v_add_f32 v80, v76, v78
    v_add_f32 v88, v84, v86
    v_add_f32 v81, v77, v79
    v_add_f32 v89, v85, v87
    v_fma_f32 v82, v78, 4.0, v76
    v_fma_f32 v90, v86, 4.0, v84
    v_fma_f32 v83, v79, 4.0, v77
    v_fma_f32 v91, v87, 4.0, v85
    v_add_f32 v77, v80, v81
    v_add_f32 v85, v88, v89
    v_sub_f32 v78, v80, v81
    v_sub_f32 v86, v88, v89
    v_fma_f32 v79, v83, 2.0, v82
    v_fma_f32 v87, v91, 2.0, v90
    v_fma_f32 v82, v83, -2.0, v82
    v_fma_f32 v90, v91, -2.0, v90
    v_fmamk_f32 v80, v76, 0x41700000, v82
    v_fmamk_f32 v88, v84, 0x41700000, v90
    v_fmamk_f32 v80, v81, 0x41200000, v80
    v_fmamk_f32 v88, v89, 0x41200000, v88
    v_cvt_pk_bf16_f32 v7, v77, v85
    v_cvt_pk_bf16_f32 v11, v78, v86
    v_cvt_pk_bf16_f32 v67, v79, v87
    v_cvt_pk_bf16_f32 v71, v82, v90
    v_cvt_pk_bf16_f32 v75, v80, v88
    ds_write_b128 v96, v[64:67] offset:49152
    ds_write_b128 v97, v[68:71] offset:0
    ds_write_b128 v97, v[72:75] offset:16384
    ds_write_b128 v96, v[4:7] offset:16384
    ds_write_b128 v96, v[8:11] offset:32768
    s_waitcnt vmcnt(0)
    buffer_load_dwordx4 v[32:35], v92, s[8:11], s24 offen offset:0
    buffer_load_dwordx4 v[48:51], v92, s[8:11], s24 offen offset:64
    v_add_u32 v92, 128, v92
    buffer_load_dwordx4 v[36:39], v93, s[8:11], s24 offen offset:0
    buffer_load_dwordx4 v[52:55], v93, s[8:11], s24 offen offset:64
    v_add_u32 v93, 128, v93
    buffer_load_dwordx4 v[40:43], v94, s[8:11], s24 offen offset:0
    buffer_load_dwordx4 v[56:59], v94, s[8:11], s24 offen offset:64
    v_add_u32 v94, 128, v94
    buffer_load_dwordx4 v[44:47], v95, s[8:11], s24 offen offset:0
    buffer_load_dwordx4 v[60:63], v95, s[8:11], s24 offen offset:64
    v_add_u32 v95, 128, v95
    s_waitcnt lgkmcnt(0)
    s_barrier
    s_setprio 0
    v_lshlrev_b32 v76, 16, v16
    v_and_b32 v84, s25, v16
    v_lshlrev_b32 v77, 16, v20
    v_and_b32 v85, s25, v20
    v_lshlrev_b32 v78, 16, v24
    v_and_b32 v86, s25, v24
    v_lshlrev_b32 v79, 16, v28
    v_and_b32 v87, s25, v28
    v_add_f32 v80, v76, v78
    v_add_f32 v88, v84, v86
    v_add_f32 v81, v77, v79
    v_add_f32 v89, v85, v87
    v_fma_f32 v82, v78, 4.0, v76
    v_fma_f32 v90, v86, 4.0, v84
    v_fma_f32 v83, v79, 4.0, v77
    v_fma_f32 v91, v87, 4.0, v85
    v_add_f32 v77, v80, v81
    v_add_f32 v85, v88, v89
    v_sub_f32 v78, v80, v81
    v_sub_f32 v86, v88, v89
    v_fma_f32 v79, v83, 2.0, v82
    v_fma_f32 v87, v91, 2.0, v90
    v_fma_f32 v82, v83, -2.0, v82
    v_fma_f32 v90, v91, -2.0, v90
    v_fmamk_f32 v80, v76, 0x41700000, v82
    v_fmamk_f32 v88, v84, 0x41700000, v90
    v_fmamk_f32 v80, v81, 0x41200000, v80
    v_fmamk_f32 v88, v89, 0x41200000, v88
    v_cvt_pk_bf16_f32 v20, v77, v85
    v_cvt_pk_bf16_f32 v24, v78, v86
    v_cvt_pk_bf16_f32 v64, v79, v87
    v_cvt_pk_bf16_f32 v68, v82, v90
    v_cvt_pk_bf16_f32 v72, v80, v88
    v_lshlrev_b32 v76, 16, v17
    v_and_b32 v84, s25, v17
    v_lshlrev_b32 v77, 16, v21
    v_and_b32 v85, s25, v21
    v_lshlrev_b32 v78, 16, v25
    v_and_b32 v86, s25, v25
    v_lshlrev_b32 v79, 16, v29
    v_and_b32 v87, s25, v29
    v_add_f32 v80, v76, v78
    v_add_f32 v88, v84, v86
    v_add_f32 v81, v77, v79
    v_add_f32 v89, v85, v87
    v_fma_f32 v82, v78, 4.0, v76
    v_fma_f32 v90, v86, 4.0, v84
    v_fma_f32 v83, v79, 4.0, v77
    v_fma_f32 v91, v87, 4.0, v85
    v_add_f32 v77, v80, v81
    v_add_f32 v85, v88, v89
    v_sub_f32 v78, v80, v81
    v_sub_f32 v86, v88, v89
    v_fma_f32 v79, v83, 2.0, v82
    v_fma_f32 v87, v91, 2.0, v90
    v_fma_f32 v82, v83, -2.0, v82
    v_fma_f32 v90, v91, -2.0, v90
    v_fmamk_f32 v80, v76, 0x41700000, v82
    v_fmamk_f32 v88, v84, 0x41700000, v90
    v_fmamk_f32 v80, v81, 0x41200000, v80
    v_fmamk_f32 v88, v89, 0x41200000, v88
    v_cvt_pk_bf16_f32 v21, v77, v85
    v_cvt_pk_bf16_f32 v25, v78, v86
    v_cvt_pk_bf16_f32 v65, v79, v87
    v_cvt_pk_bf16_f32 v69, v82, v90
    v_cvt_pk_bf16_f32 v73, v80, v88
    v_lshlrev_b32 v76, 16, v18
    v_and_b32 v84, s25, v18
    v_lshlrev_b32 v77, 16, v22
    v_and_b32 v85, s25, v22
    v_lshlrev_b32 v78, 16, v26
    v_and_b32 v86, s25, v26
    v_lshlrev_b32 v79, 16, v30
    v_and_b32 v87, s25, v30
    v_add_f32 v80, v76, v78
    v_add_f32 v88, v84, v86
    v_add_f32 v81, v77, v79
    v_add_f32 v89, v85, v87
    v_fma_f32 v82, v78, 4.0, v76
    v_fma_f32 v90, v86, 4.0, v84
    v_fma_f32 v83, v79, 4.0, v77
    v_fma_f32 v91, v87, 4.0, v85
    v_add_f32 v77, v80, v81
    v_add_f32 v85, v88, v89
    v_sub_f32 v78, v80, v81
    v_sub_f32 v86, v88, v89
    v_fma_f32 v79, v83, 2.0, v82
    v_fma_f32 v87, v91, 2.0, v90
    v_fma_f32 v82, v83, -2.0, v82
    v_fma_f32 v90, v91, -2.0, v90
    v_fmamk_f32 v80, v76, 0x41700000, v82
    v_fmamk_f32 v88, v84, 0x41700000, v90
    v_fmamk_f32 v80, v81, 0x41200000, v80
    v_fmamk_f32 v88, v89, 0x41200000, v88
    v_cvt_pk_bf16_f32 v22, v77, v85
    v_cvt_pk_bf16_f32 v26, v78, v86
    v_cvt_pk_bf16_f32 v66, v79, v87
    v_cvt_pk_bf16_f32 v70, v82, v90
    v_cvt_pk_bf16_f32 v74, v80, v88
    v_lshlrev_b32 v76, 16, v19
    v_and_b32 v84, s25, v19
    v_lshlrev_b32 v77, 16, v23
    v_and_b32 v85, s25, v23
    v_lshlrev_b32 v78, 16, v27
    v_and_b32 v86, s25, v27
    v_lshlrev_b32 v79, 16, v31
    v_and_b32 v87, s25, v31
    v_add_f32 v80, v76, v78
    v_add_f32 v88, v84, v86
    v_add_f32 v81, v77, v79
    v_add_f32 v89, v85, v87
    v_fma_f32 v82, v78, 4.0, v76
    v_fma_f32 v90, v86, 4.0, v84
    v_fma_f32 v83, v79, 4.0, v77
    v_fma_f32 v91, v87, 4.0, v85
    v_add_f32 v77, v80, v81
    v_add_f32 v85, v88, v89
    v_sub_f32 v78, v80, v81
    v_sub_f32 v86, v88, v89
    v_fma_f32 v79, v83, 2.0, v82
    v_fma_f32 v87, v91, 2.0, v90
    v_fma_f32 v82, v83, -2.0, v82
    v_fma_f32 v90, v91, -2.0, v90
    v_fmamk_f32 v80, v76, 0x41700000, v82
    v_fmamk_f32 v88, v84, 0x41700000, v90
    v_fmamk_f32 v80, v81, 0x41200000, v80
    v_fmamk_f32 v88, v89, 0x41200000, v88
    v_cvt_pk_bf16_f32 v23, v77, v85
    v_cvt_pk_bf16_f32 v27, v78, v86
    v_cvt_pk_bf16_f32 v67, v79, v87
    v_cvt_pk_bf16_f32 v71, v82, v90
    v_cvt_pk_bf16_f32 v75, v80, v88
L_conv1_kernel_hloop2:
    s_cmp_lt_u32 s28, 12
    s_cselect_b32 s24, 0, 2130706432
    ds_write_b128 v96, v[64:67] offset:57344
    ds_write_b128 v97, v[68:71] offset:8192
    ds_write_b128 v97, v[72:75] offset:24576
    ds_write_b128 v96, v[16:19] offset:8192
    ds_write_b128 v96, v[20:23] offset:24576
    ds_write_b128 v96, v[24:27] offset:40960
    ds_write_b128 v98, v[28:31] offset:8704
    s_waitcnt vmcnt(0)
    v_lshlrev_b32 v76, 16, v32
    v_and_b32 v84, s25, v32
    v_lshlrev_b32 v77, 16, v36
    v_and_b32 v85, s25, v36
    v_lshlrev_b32 v78, 16, v40
    v_and_b32 v86, s25, v40
    v_lshlrev_b32 v79, 16, v44
    v_and_b32 v87, s25, v44
    v_add_f32 v80, v76, v78
    v_add_f32 v88, v84, v86
    v_add_f32 v81, v77, v79
    v_add_f32 v89, v85, v87
    v_fma_f32 v82, v78, 4.0, v76
    v_fma_f32 v90, v86, 4.0, v84
    v_fma_f32 v83, v79, 4.0, v77
    v_fma_f32 v91, v87, 4.0, v85
    v_add_f32 v77, v80, v81
    v_add_f32 v85, v88, v89
    v_sub_f32 v78, v80, v81
    v_sub_f32 v86, v88, v89
    v_fma_f32 v79, v83, 2.0, v82
    v_fma_f32 v87, v91, 2.0, v90
    v_fma_f32 v82, v83, -2.0, v82
    v_fma_f32 v90, v91, -2.0, v90
    v_fmamk_f32 v80, v76, 0x41700000, v82
    v_fmamk_f32 v88, v84, 0x41700000, v90
    buffer_load_dwordx4 v[0:3], v92, s[8:11], s24 offen offset:0
    buffer_load_dwordx4 v[16:19], v92, s[8:11], s24 offen offset:64
    v_add_u32 v92, 128, v92
    v_fmamk_f32 v80, v81, 0x41200000, v80
    v_fmamk_f32 v88, v89, 0x41200000, v88
    v_cvt_pk_bf16_f32 v36, v77, v85
    v_cvt_pk_bf16_f32 v40, v78, v86
    v_cvt_pk_bf16_f32 v64, v79, v87
    v_cvt_pk_bf16_f32 v68, v82, v90
    v_cvt_pk_bf16_f32 v72, v80, v88
    v_lshlrev_b32 v76, 16, v33
    v_and_b32 v84, s25, v33
    v_lshlrev_b32 v77, 16, v37
    v_and_b32 v85, s25, v37
    v_lshlrev_b32 v78, 16, v41
    v_and_b32 v86, s25, v41
    v_lshlrev_b32 v79, 16, v45
    v_and_b32 v87, s25, v45
    v_add_f32 v80, v76, v78
    v_add_f32 v88, v84, v86
    v_add_f32 v81, v77, v79
    v_add_f32 v89, v85, v87
    v_fma_f32 v82, v78, 4.0, v76
    v_fma_f32 v90, v86, 4.0, v84
    v_fma_f32 v83, v79, 4.0, v77
    v_fma_f32 v91, v87, 4.0, v85
    v_add_f32 v77, v80, v81
    v_add_f32 v85, v88, v89
    v_sub_f32 v78, v80, v81
    v_sub_f32 v86, v88, v89
    v_fma_f32 v79, v83, 2.0, v82
    v_fma_f32 v87, v91, 2.0, v90
    v_fma_f32 v82, v83, -2.0, v82
    v_fma_f32 v90, v91, -2.0, v90
    v_fmamk_f32 v80, v76, 0x41700000, v82
    v_fmamk_f32 v88, v84, 0x41700000, v90
    v_fmamk_f32 v80, v81, 0x41200000, v80
    v_fmamk_f32 v88, v89, 0x41200000, v88
    v_cvt_pk_bf16_f32 v37, v77, v85
    v_cvt_pk_bf16_f32 v41, v78, v86
    v_cvt_pk_bf16_f32 v65, v79, v87
    v_cvt_pk_bf16_f32 v69, v82, v90
    v_cvt_pk_bf16_f32 v73, v80, v88
    v_lshlrev_b32 v76, 16, v34
    v_and_b32 v84, s25, v34
    v_lshlrev_b32 v77, 16, v38
    v_and_b32 v85, s25, v38
    v_lshlrev_b32 v78, 16, v42
    v_and_b32 v86, s25, v42
    v_lshlrev_b32 v79, 16, v46
    v_and_b32 v87, s25, v46
    v_add_f32 v80, v76, v78
    v_add_f32 v88, v84, v86
    v_add_f32 v81, v77, v79
    v_add_f32 v89, v85, v87
    v_fma_f32 v82, v78, 4.0, v76
    buffer_load_dwordx4 v[4:7], v93, s[8:11], s24 offen offset:0
    buffer_load_dwordx4 v[20:23], v93, s[8:11], s24 offen offset:64
    v_add_u32 v93, 128, v93
    v_fma_f32 v90, v86, 4.0, v84
    v_fma_f32 v83, v79, 4.0, v77
    v_fma_f32 v91, v87, 4.0, v85
    v_add_f32 v77, v80, v81
    v_add_f32 v85, v88, v89
    v_sub_f32 v78, v80, v81
    v_sub_f32 v86, v88, v89
    v_fma_f32 v79, v83, 2.0, v82
    v_fma_f32 v87, v91, 2.0, v90
    v_fma_f32 v82, v83, -2.0, v82
    v_fma_f32 v90, v91, -2.0, v90
    v_fmamk_f32 v80, v76, 0x41700000, v82
    v_fmamk_f32 v88, v84, 0x41700000, v90
    v_fmamk_f32 v80, v81, 0x41200000, v80
    v_fmamk_f32 v88, v89, 0x41200000, v88
    v_cvt_pk_bf16_f32 v38, v77, v85
    v_cvt_pk_bf16_f32 v42, v78, v86
    v_cvt_pk_bf16_f32 v66, v79, v87
    v_cvt_pk_bf16_f32 v70, v82, v90
    v_cvt_pk_bf16_f32 v74, v80, v88
    v_lshlrev_b32 v76, 16, v35
    v_and_b32 v84, s25, v35
    v_lshlrev_b32 v77, 16, v39
    v_and_b32 v85, s25, v39
    v_lshlrev_b32 v78, 16, v43
    v_and_b32 v86, s25, v43
    v_lshlrev_b32 v79, 16, v47
    v_and_b32 v87, s25, v47
    v_add_f32 v80, v76, v78
    v_add_f32 v88, v84, v86
    v_add_f32 v81, v77, v79
    v_add_f32 v89, v85, v87
    v_fma_f32 v82, v78, 4.0, v76
    v_fma_f32 v90, v86, 4.0, v84
    v_fma_f32 v83, v79, 4.0, v77
    v_fma_f32 v91, v87, 4.0, v85
    v_add_f32 v77, v80, v81
    v_add_f32 v85, v88, v89
    v_sub_f32 v78, v80, v81
    v_sub_f32 v86, v88, v89
    v_fma_f32 v79, v83, 2.0, v82
    v_fma_f32 v87, v91, 2.0, v90
    v_fma_f32 v82, v83, -2.0, v82
    v_fma_f32 v90, v91, -2.0, v90
    v_fmamk_f32 v80, v76, 0x41700000, v82
    v_fmamk_f32 v88, v84, 0x41700000, v90
    v_fmamk_f32 v80, v81, 0x41200000, v80
    v_fmamk_f32 v88, v89, 0x41200000, v88
    v_cvt_pk_bf16_f32 v39, v77, v85
    v_cvt_pk_bf16_f32 v43, v78, v86
    v_cvt_pk_bf16_f32 v67, v79, v87
    v_cvt_pk_bf16_f32 v71, v82, v90
    v_cvt_pk_bf16_f32 v75, v80, v88
    s_add_u32 s28, s28, 1
    s_waitcnt lgkmcnt(0)
    s_barrier
    s_cmp_lt_u32 s28, 12
    s_cselect_b32 s24, 0, 2130706432
    ds_write_b128 v96, v[64:67] offset:49152
    ds_write_b128 v97, v[68:71] offset:0
    ds_write_b128 v97, v[72:75] offset:16384
    ds_write_b128 v96, v[32:35] offset:0
    ds_write_b128 v96, v[36:39] offset:16384
    ds_write_b128 v96, v[40:43] offset:32768
    ds_write_b128 v98, v[44:47] offset:0
    v_lshlrev_b32 v76, 16, v48
    v_and_b32 v84, s25, v48
    buffer_load_dwordx4 v[8:11], v94, s[8:11], s24 offen offset:0
    buffer_load_dwordx4 v[24:27], v94, s[8:11], s24 offen offset:64
    v_add_u32 v94, 128, v94
    v_lshlrev_b32 v77, 16, v52
    v_and_b32 v85, s25, v52
    v_lshlrev_b32 v78, 16, v56
    v_and_b32 v86, s25, v56
    v_lshlrev_b32 v79, 16, v60
    v_and_b32 v87, s25, v60
    v_add_f32 v80, v76, v78
    v_add_f32 v88, v84, v86
    v_add_f32 v81, v77, v79
    v_add_f32 v89, v85, v87
    v_fma_f32 v82, v78, 4.0, v76
    v_fma_f32 v90, v86, 4.0, v84
    v_fma_f32 v83, v79, 4.0, v77
    v_fma_f32 v91, v87, 4.0, v85
    v_add_f32 v77, v80, v81
    v_add_f32 v85, v88, v89
    v_sub_f32 v78, v80, v81
    buffer_load_dwordx4 v[12:15], v95, s[8:11], s24 offen offset:0
    buffer_load_dwordx4 v[28:31], v95, s[8:11], s24 offen offset:64
    v_add_u32 v95, 128, v95
    v_sub_f32 v86, v88, v89
    v_fma_f32 v79, v83, 2.0, v82
    v_fma_f32 v87, v91, 2.0, v90
    v_fma_f32 v82, v83, -2.0, v82
    v_fma_f32 v90, v91, -2.0, v90
    v_fmamk_f32 v80, v76, 0x41700000, v82
    v_fmamk_f32 v88, v84, 0x41700000, v90
    v_fmamk_f32 v80, v81, 0x41200000, v80
    v_fmamk_f32 v88, v89, 0x41200000, v88
    v_cvt_pk_bf16_f32 v52, v77, v85
    v_cvt_pk_bf16_f32 v56, v78, v86
    v_cvt_pk_bf16_f32 v64, v79, v87
    v_cvt_pk_bf16_f32 v68, v82, v90
    v_cvt_pk_bf16_f32 v72, v80, v88
    v_lshlrev_b32 v76, 16, v49
    v_and_b32 v84, s25, v49
    v_lshlrev_b32 v77, 16, v53
    v_and_b32 v85, s25, v53
    v_lshlrev_b32 v78, 16, v57
    v_and_b32 v86, s25, v57
    v_lshlrev_b32 v79, 16, v61
    v_and_b32 v87, s25, v61
    v_add_f32 v80, v76, v78
    v_add_f32 v88, v84, v86
    v_add_f32 v81, v77, v79
    v_add_f32 v89, v85, v87
    v_fma_f32 v82, v78, 4.0, v76
    v_fma_f32 v90, v86, 4.0, v84
    v_fma_f32 v83, v79, 4.0, v77
    v_fma_f32 v91, v87, 4.0, v85
    v_add_f32 v77, v80, v81
    v_add_f32 v85, v88, v89
    v_sub_f32 v78, v80, v81
    v_sub_f32 v86, v88, v89
    v_fma_f32 v79, v83, 2.0, v82
    v_fma_f32 v87, v91, 2.0, v90
    v_fma_f32 v82, v83, -2.0, v82
    v_fma_f32 v90, v91, -2.0, v90
    v_fmamk_f32 v80, v76, 0x41700000, v82
    v_fmamk_f32 v88, v84, 0x41700000, v90
    v_fmamk_f32 v80, v81, 0x41200000, v80
    v_fmamk_f32 v88, v89, 0x41200000, v88
    v_cvt_pk_bf16_f32 v53, v77, v85
    v_cvt_pk_bf16_f32 v57, v78, v86
    v_cvt_pk_bf16_f32 v65, v79, v87
    v_cvt_pk_bf16_f32 v69, v82, v90
    v_cvt_pk_bf16_f32 v73, v80, v88
    v_lshlrev_b32 v76, 16, v50
    v_and_b32 v84, s25, v50
    v_lshlrev_b32 v77, 16, v54
    v_and_b32 v85, s25, v54
    v_lshlrev_b32 v78, 16, v58
    v_and_b32 v86, s25, v58
    v_lshlrev_b32 v79, 16, v62
    v_and_b32 v87, s25, v62
    v_add_f32 v80, v76, v78
    v_add_f32 v88, v84, v86
    v_add_f32 v81, v77, v79
    v_add_f32 v89, v85, v87
    v_fma_f32 v82, v78, 4.0, v76
    v_fma_f32 v90, v86, 4.0, v84
    v_fma_f32 v83, v79, 4.0, v77
    v_fma_f32 v91, v87, 4.0, v85
    v_add_f32 v77, v80, v81
    v_add_f32 v85, v88, v89
    v_sub_f32 v78, v80, v81
    v_sub_f32 v86, v88, v89
    v_fma_f32 v79, v83, 2.0, v82
    v_fma_f32 v87, v91, 2.0, v90
    v_fma_f32 v82, v83, -2.0, v82
    v_fma_f32 v90, v91, -2.0, v90
    v_fmamk_f32 v80, v76, 0x41700000, v82
    v_fmamk_f32 v88, v84, 0x41700000, v90
    v_fmamk_f32 v80, v81, 0x41200000, v80
    v_fmamk_f32 v88, v89, 0x41200000, v88
    v_cvt_pk_bf16_f32 v54, v77, v85
    v_cvt_pk_bf16_f32 v58, v78, v86
    v_cvt_pk_bf16_f32 v66, v79, v87
    v_cvt_pk_bf16_f32 v70, v82, v90
    v_cvt_pk_bf16_f32 v74, v80, v88
    v_lshlrev_b32 v76, 16, v51
    v_and_b32 v84, s25, v51
    v_lshlrev_b32 v77, 16, v55
    v_and_b32 v85, s25, v55
    v_lshlrev_b32 v78, 16, v59
    v_and_b32 v86, s25, v59
    v_lshlrev_b32 v79, 16, v63
    v_and_b32 v87, s25, v63
    v_add_f32 v80, v76, v78
    v_add_f32 v88, v84, v86
    v_add_f32 v81, v77, v79
    v_add_f32 v89, v85, v87
    v_fma_f32 v82, v78, 4.0, v76
    v_fma_f32 v90, v86, 4.0, v84
    v_fma_f32 v83, v79, 4.0, v77
    v_fma_f32 v91, v87, 4.0, v85
    v_add_f32 v77, v80, v81
    v_add_f32 v85, v88, v89
    v_sub_f32 v78, v80, v81
    v_sub_f32 v86, v88, v89
    v_fma_f32 v79, v83, 2.0, v82
    v_fma_f32 v87, v91, 2.0, v90
    v_fma_f32 v82, v83, -2.0, v82
    v_fma_f32 v90, v91, -2.0, v90
    v_fmamk_f32 v80, v76, 0x41700000, v82
    v_fmamk_f32 v88, v84, 0x41700000, v90
    v_fmamk_f32 v80, v81, 0x41200000, v80
    v_fmamk_f32 v88, v89, 0x41200000, v88
    v_cvt_pk_bf16_f32 v55, v77, v85
    v_cvt_pk_bf16_f32 v59, v78, v86
    v_cvt_pk_bf16_f32 v67, v79, v87
    v_cvt_pk_bf16_f32 v71, v82, v90
    v_cvt_pk_bf16_f32 v75, v80, v88
    s_add_u32 s28, s28, 1
    s_waitcnt lgkmcnt(0)
    s_barrier
    s_cmp_eq_u32 s22, 1
    s_cbranch_scc1 L_conv1_kernel_hlast2
    s_cmp_lt_u32 s28, 12
    s_cselect_b32 s24, 0, 2130706432
    ds_write_b128 v96, v[64:67] offset:57344
    ds_write_b128 v97, v[68:71] offset:8192
    ds_write_b128 v97, v[72:75] offset:24576
    ds_write_b128 v96, v[48:51] offset:8192
    ds_write_b128 v96, v[52:55] offset:24576
    ds_write_b128 v96, v[56:59] offset:40960
    ds_write_b128 v98, v[60:63] offset:8704
    s_waitcnt vmcnt(0)
    v_lshlrev_b32 v76, 16, v0
    v_and_b32 v84, s25, v0
    v_lshlrev_b32 v77, 16, v4
    v_and_b32 v85, s25, v4
    v_lshlrev_b32 v78, 16, v8
    v_and_b32 v86, s25, v8
    v_lshlrev_b32 v79, 16, v12
    v_and_b32 v87, s25, v12
    v_add_f32 v80, v76, v78
    v_add_f32 v88, v84, v86
    v_add_f32 v81, v77, v79
    v_add_f32 v89, v85, v87
    v_fma_f32 v82, v78, 4.0, v76
    v_fma_f32 v90, v86, 4.0, v84
    v_fma_f32 v83, v79, 4.0, v77
    v_fma_f32 v91, v87, 4.0, v85
    v_add_f32 v77, v80, v81
    v_add_f32 v85, v88, v89
    v_sub_f32 v78, v80, v81
    v_sub_f32 v86, v88, v89
    v_fma_f32 v79, v83, 2.0, v82
    v_fma_f32 v87, v91, 2.0, v90
    v_fma_f32 v82, v83, -2.0, v82
    v_fma_f32 v90, v91, -2.0, v90
    v_fmamk_f32 v80, v76, 0x41700000, v82
    v_fmamk_f32 v88, v84, 0x41700000, v90
    buffer_load_dwordx4 v[32:35], v92, s[8:11], s24 offen offset:0
    buffer_load_dwordx4 v[48:51], v92, s[8:11], s24 offen offset:64
    v_add_u32 v92, 128, v92
    v_fmamk_f32 v80, v81, 0x41200000, v80
    v_fmamk_f32 v88, v89, 0x41200000, v88
    v_cvt_pk_bf16_f32 v4, v77, v85
    v_cvt_pk_bf16_f32 v8, v78, v86
    v_cvt_pk_bf16_f32 v64, v79, v87
    v_cvt_pk_bf16_f32 v68, v82, v90
    v_cvt_pk_bf16_f32 v72, v80, v88
    v_lshlrev_b32 v76, 16, v1
    v_and_b32 v84, s25, v1
    v_lshlrev_b32 v77, 16, v5
    v_and_b32 v85, s25, v5
    v_lshlrev_b32 v78, 16, v9
    v_and_b32 v86, s25, v9
    v_lshlrev_b32 v79, 16, v13
    v_and_b32 v87, s25, v13
    v_add_f32 v80, v76, v78
    v_add_f32 v88, v84, v86
    v_add_f32 v81, v77, v79
    v_add_f32 v89, v85, v87
    v_fma_f32 v82, v78, 4.0, v76
    v_fma_f32 v90, v86, 4.0, v84
    v_fma_f32 v83, v79, 4.0, v77
    v_fma_f32 v91, v87, 4.0, v85
    v_add_f32 v77, v80, v81
    v_add_f32 v85, v88, v89
    v_sub_f32 v78, v80, v81
    v_sub_f32 v86, v88, v89
    v_fma_f32 v79, v83, 2.0, v82
    v_fma_f32 v87, v91, 2.0, v90
    v_fma_f32 v82, v83, -2.0, v82
    v_fma_f32 v90, v91, -2.0, v90
    v_fmamk_f32 v80, v76, 0x41700000, v82
    v_fmamk_f32 v88, v84, 0x41700000, v90
    v_fmamk_f32 v80, v81, 0x41200000, v80
    v_fmamk_f32 v88, v89, 0x41200000, v88
    v_cvt_pk_bf16_f32 v5, v77, v85
    v_cvt_pk_bf16_f32 v9, v78, v86
    v_cvt_pk_bf16_f32 v65, v79, v87
    v_cvt_pk_bf16_f32 v69, v82, v90
    v_cvt_pk_bf16_f32 v73, v80, v88
    v_lshlrev_b32 v76, 16, v2
    v_and_b32 v84, s25, v2
    v_lshlrev_b32 v77, 16, v6
    v_and_b32 v85, s25, v6
    v_lshlrev_b32 v78, 16, v10
    v_and_b32 v86, s25, v10
    v_lshlrev_b32 v79, 16, v14
    v_and_b32 v87, s25, v14
    v_add_f32 v80, v76, v78
    v_add_f32 v88, v84, v86
    v_add_f32 v81, v77, v79
    v_add_f32 v89, v85, v87
    v_fma_f32 v82, v78, 4.0, v76
    buffer_load_dwordx4 v[36:39], v93, s[8:11], s24 offen offset:0
    buffer_load_dwordx4 v[52:55], v93, s[8:11], s24 offen offset:64
    v_add_u32 v93, 128, v93
    v_fma_f32 v90, v86, 4.0, v84
    v_fma_f32 v83, v79, 4.0, v77
    v_fma_f32 v91, v87, 4.0, v85
    v_add_f32 v77, v80, v81
    v_add_f32 v85, v88, v89
    v_sub_f32 v78, v80, v81
    v_sub_f32 v86, v88, v89
    v_fma_f32 v79, v83, 2.0, v82
    v_fma_f32 v87, v91, 2.0, v90
    v_fma_f32 v82, v83, -2.0, v82
    v_fma_f32 v90, v91, -2.0, v90
    v_fmamk_f32 v80, v76, 0x41700000, v82
    v_fmamk_f32 v88, v84, 0x41700000, v90
    v_fmamk_f32 v80, v81, 0x41200000, v80
    v_fmamk_f32 v88, v89, 0x41200000, v88
    v_cvt_pk_bf16_f32 v6, v77, v85
    v_cvt_pk_bf16_f32 v10, v78, v86
    v_cvt_pk_bf16_f32 v66, v79, v87
    v_cvt_pk_bf16_f32 v70, v82, v90
    v_cvt_pk_bf16_f32 v74, v80, v88
    v_lshlrev_b32 v76, 16, v3
    v_and_b32 v84, s25, v3
    v_lshlrev_b32 v77, 16, v7
    v_and_b32 v85, s25, v7
    v_lshlrev_b32 v78, 16, v11
    v_and_b32 v86, s25, v11
    v_lshlrev_b32 v79, 16, v15
    v_and_b32 v87, s25, v15
    v_add_f32 v80, v76, v78
    v_add_f32 v88, v84, v86
    v_add_f32 v81, v77, v79
    v_add_f32 v89, v85, v87
    v_fma_f32 v82, v78, 4.0, v76
    v_fma_f32 v90, v86, 4.0, v84
    v_fma_f32 v83, v79, 4.0, v77
    v_fma_f32 v91, v87, 4.0, v85
    v_add_f32 v77, v80, v81
    v_add_f32 v85, v88, v89
    v_sub_f32 v78, v80, v81
    v_sub_f32 v86, v88, v89
    v_fma_f32 v79, v83, 2.0, v82
    v_fma_f32 v87, v91, 2.0, v90
    v_fma_f32 v82, v83, -2.0, v82
    v_fma_f32 v90, v91, -2.0, v90
    v_fmamk_f32 v80, v76, 0x41700000, v82
    v_fmamk_f32 v88, v84, 0x41700000, v90
    v_fmamk_f32 v80, v81, 0x41200000, v80
    v_fmamk_f32 v88, v89, 0x41200000, v88
    v_cvt_pk_bf16_f32 v7, v77, v85
    v_cvt_pk_bf16_f32 v11, v78, v86
    v_cvt_pk_bf16_f32 v67, v79, v87
    v_cvt_pk_bf16_f32 v71, v82, v90
    v_cvt_pk_bf16_f32 v75, v80, v88
    s_add_u32 s28, s28, 1
    s_waitcnt lgkmcnt(0)
    s_barrier
    s_cmp_lt_u32 s28, 12
    s_cselect_b32 s24, 0, 2130706432
    ds_write_b128 v96, v[64:67] offset:49152
    ds_write_b128 v97, v[68:71] offset:0
    ds_write_b128 v97, v[72:75] offset:16384
    ds_write_b128 v96, v[0:3] offset:0
    ds_write_b128 v96, v[4:7] offset:16384
    ds_write_b128 v96, v[8:11] offset:32768
    ds_write_b128 v98, v[12:15] offset:0
    v_lshlrev_b32 v76, 16, v16
    v_and_b32 v84, s25, v16
    buffer_load_dwordx4 v[40:43], v94, s[8:11], s24 offen offset:0
    buffer_load_dwordx4 v[56:59], v94, s[8:11], s24 offen offset:64
    v_add_u32 v94, 128, v94
    v_lshlrev_b32 v77, 16, v20
    v_and_b32 v85, s25, v20
    v_lshlrev_b32 v78, 16, v24
    v_and_b32 v86, s25, v24
    v_lshlrev_b32 v79, 16, v28
    v_and_b32 v87, s25, v28
    v_add_f32 v80, v76, v78
    v_add_f32 v88, v84, v86
    v_add_f32 v81, v77, v79
    v_add_f32 v89, v85, v87
    v_fma_f32 v82, v78, 4.0, v76
    v_fma_f32 v90, v86, 4.0, v84
    v_fma_f32 v83, v79, 4.0, v77
    v_fma_f32 v91, v87, 4.0, v85
    v_add_f32 v77, v80, v81
    v_add_f32 v85, v88, v89
    v_sub_f32 v78, v80, v81
    buffer_load_dwordx4 v[44:47], v95, s[8:11], s24 offen offset:0
    buffer_load_dwordx4 v[60:63], v95, s[8:11], s24 offen offset:64
    v_add_u32 v95, 128, v95
    v_sub_f32 v86, v88, v89
    v_fma_f32 v79, v83, 2.0, v82
    v_fma_f32 v87, v91, 2.0, v90
    v_fma_f32 v82, v83, -2.0, v82
    v_fma_f32 v90, v91, -2.0, v90
    v_fmamk_f32 v80, v76, 0x41700000, v82
    v_fmamk_f32 v88, v84, 0x41700000, v90
    v_fmamk_f32 v80, v81, 0x41200000, v80
    v_fmamk_f32 v88, v89, 0x41200000, v88
    v_cvt_pk_bf16_f32 v20, v77, v85
    v_cvt_pk_bf16_f32 v24, v78, v86
    v_cvt_pk_bf16_f32 v64, v79, v87
    v_cvt_pk_bf16_f32 v68, v82, v90
    v_cvt_pk_bf16_f32 v72, v80, v88
    v_lshlrev_b32 v76, 16, v17
    v_and_b32 v84, s25, v17
    v_lshlrev_b32 v77, 16, v21
    v_and_b32 v85, s25, v21
    v_lshlrev_b32 v78, 16, v25
    v_and_b32 v86, s25, v25
    v_lshlrev_b32 v79, 16, v29
    v_and_b32 v87, s25, v29
    v_add_f32 v80, v76, v78
    v_add_f32 v88, v84, v86
    v_add_f32 v81, v77, v79
    v_add_f32 v89, v85, v87
    v_fma_f32 v82, v78, 4.0, v76
    v_fma_f32 v90, v86, 4.0, v84
    v_fma_f32 v83, v79, 4.0, v77
    v_fma_f32 v91, v87, 4.0, v85
    v_add_f32 v77, v80, v81
    v_add_f32 v85, v88, v89
    v_sub_f32 v78, v80, v81
    v_sub_f32 v86, v88, v89
    v_fma_f32 v79, v83, 2.0, v82
    v_fma_f32 v87, v91, 2.0, v90
    v_fma_f32 v82, v83, -2.0, v82
    v_fma_f32 v90, v91, -2.0, v90
    v_fmamk_f32 v80, v76, 0x41700000, v82
    v_fmamk_f32 v88, v84, 0x41700000, v90
    v_fmamk_f32 v80, v81, 0x41200000, v80
    v_fmamk_f32 v88, v89, 0x41200000, v88
    v_cvt_pk_bf16_f32 v21, v77, v85
    v_cvt_pk_bf16_f32 v25, v78, v86
    v_cvt_pk_bf16_f32 v65, v79, v87
    v_cvt_pk_bf16_f32 v69, v82, v90
    v_cvt_pk_bf16_f32 v73, v80, v88
    v_lshlrev_b32 v76, 16, v18
    v_and_b32 v84, s25, v18
    v_lshlrev_b32 v77, 16, v22
    v_and_b32 v85, s25, v22
    v_lshlrev_b32 v78, 16, v26
    v_and_b32 v86, s25, v26
    v_lshlrev_b32 v79, 16, v30
    v_and_b32 v87, s25, v30
    v_add_f32 v80, v76, v78
    v_add_f32 v88, v84, v86
    v_add_f32 v81, v77, v79
    v_add_f32 v89, v85, v87
    v_fma_f32 v82, v78, 4.0, v76
    v_fma_f32 v90, v86, 4.0, v84
    v_fma_f32 v83, v79, 4.0, v77
    v_fma_f32 v91, v87, 4.0, v85
    v_add_f32 v77, v80, v81
    v_add_f32 v85, v88, v89
    v_sub_f32 v78, v80, v81
    v_sub_f32 v86, v88, v89
    v_fma_f32 v79, v83, 2.0, v82
    v_fma_f32 v87, v91, 2.0, v90
    v_fma_f32 v82, v83, -2.0, v82
    v_fma_f32 v90, v91, -2.0, v90
    v_fmamk_f32 v80, v76, 0x41700000, v82
    v_fmamk_f32 v88, v84, 0x41700000, v90
    v_fmamk_f32 v80, v81, 0x41200000, v80
    v_fmamk_f32 v88, v89, 0x41200000, v88
    v_cvt_pk_bf16_f32 v22, v77, v85
    v_cvt_pk_bf16_f32 v26, v78, v86
    v_cvt_pk_bf16_f32 v66, v79, v87
    v_cvt_pk_bf16_f32 v70, v82, v90
    v_cvt_pk_bf16_f32 v74, v80, v88
    v_lshlrev_b32 v76, 16, v19
    v_and_b32 v84, s25, v19
    v_lshlrev_b32 v77, 16, v23
    v_and_b32 v85, s25, v23
    v_lshlrev_b32 v78, 16, v27
    v_and_b32 v86, s25, v27
    v_lshlrev_b32 v79, 16, v31
    v_and_b32 v87, s25, v31
    v_add_f32 v80, v76, v78
    v_add_f32 v88, v84, v86
    v_add_f32 v81, v77, v79
    v_add_f32 v89, v85, v87
    v_fma_f32 v82, v78, 4.0, v76
    v_fma_f32 v90, v86, 4.0, v84
    v_fma_f32 v83, v79, 4.0, v77
    v_fma_f32 v91, v87, 4.0, v85
    v_add_f32 v77, v80, v81
    v_add_f32 v85, v88, v89
    v_sub_f32 v78, v80, v81
    v_sub_f32 v86, v88, v89
    v_fma_f32 v79, v83, 2.0, v82
    v_fma_f32 v87, v91, 2.0, v90
    v_fma_f32 v82, v83, -2.0, v82
    v_fma_f32 v90, v91, -2.0, v90
    v_fmamk_f32 v80, v76, 0x41700000, v82
    v_fmamk_f32 v88, v84, 0x41700000, v90
    v_fmamk_f32 v80, v81, 0x41200000, v80
    v_fmamk_f32 v88, v89, 0x41200000, v88
    v_cvt_pk_bf16_f32 v23, v77, v85
    v_cvt_pk_bf16_f32 v27, v78, v86
    v_cvt_pk_bf16_f32 v67, v79, v87
    v_cvt_pk_bf16_f32 v71, v82, v90
    v_cvt_pk_bf16_f32 v75, v80, v88
    s_add_u32 s28, s28, 1
    s_waitcnt lgkmcnt(0)
    s_barrier
    s_sub_u32 s22, s22, 1
    s_branch L_conv1_kernel_hloop2
L_conv1_kernel_hlast2:
    s_waitcnt vmcnt(0)
    s_mov_b32 s58, s20
    s_lshl_b32 s20, s2, 2
    s_add_u32 s20, s20, s32
    v_mov_b32 v1, v127
    s_load_dwordx2 s[8:9], s[0:1], 16
    s_lshr_b32 s22, s20, 8
    s_bfe_u32 s23, s20, 0x40004
    s_bfe_u32 s24, s20, 0x30001
    s_and_b32 s21, s20, 1
    v_lshrrev_b32 v2, 4, v1
    v_lshlrev_b32 v2, 12, v2
    v_and_b32 v3, 15, v1
    v_lshl_add_u32 v2, v3, 2, v2
    s_lshl_b32 s26, s22, 3
    s_lshr_b32 s27, s23, 3
    s_add_u32 s26, s26, s27
    s_lshl_b32 s26, s26, 17
    s_and_b32 s27, s23, 7
    s_lshl_b32 s27, s27, 14
    s_add_u32 s26, s26, s27
    s_lshl_b32 s27, s24, 6
    s_add_u32 s26, s26, s27
    s_mov_b32 s10, 4063232
    s_mov_b32 s11, 0x00020000
    s_add_u32 s37, s26, 262144
    s_add_u32 s38, s26, 524288
    s_add_u32 s39, s26, 786432
    s_waitcnt lgkmcnt(0)
    buffer_load_dword v16, v2, s[8:11], s26 offen offset:0
    buffer_load_dword v17, v2, s[8:11], s26 offen offset:512
    buffer_load_dword v24, v2, s[8:11], s37 offen offset:0
    buffer_load_dword v25, v2, s[8:11], s37 offen offset:512
    buffer_load_dword v32, v2, s[8:11], s38 offen offset:0
    buffer_load_dword v33, v2, s[8:11], s38 offen offset:512
    buffer_load_dword v40, v2, s[8:11], s39 offen offset:0
    buffer_load_dword v41, v2, s[8:11], s39 offen offset:512
    buffer_load_dword v18, v2, s[8:11], s26 offen offset:1024
    buffer_load_dword v19, v2, s[8:11], s26 offen offset:1536
    buffer_load_dword v26, v2, s[8:11], s37 offen offset:1024
    buffer_load_dword v27, v2, s[8:11], s37 offen offset:1536
    buffer_load_dword v34, v2, s[8:11], s38 offen offset:1024
    buffer_load_dword v35, v2, s[8:11], s38 offen offset:1536
    buffer_load_dword v42, v2, s[8:11], s39 offen offset:1024
    buffer_load_dword v43, v2, s[8:11], s39 offen offset:1536
    buffer_load_dword v20, v2, s[8:11], s26 offen offset:2048
    buffer_load_dword v21, v2, s[8:11], s26 offen offset:2560
    buffer_load_dword v28, v2, s[8:11], s37 offen offset:2048
    buffer_load_dword v29, v2, s[8:11], s37 offen offset:2560
    buffer_load_dword v36, v2, s[8:11], s38 offen offset:2048
    buffer_load_dword v37, v2, s[8:11], s38 offen offset:2560
    buffer_load_dword v44, v2, s[8:11], s39 offen offset:2048
    buffer_load_dword v45, v2, s[8:11], s39 offen offset:2560
    buffer_load_dword v22, v2, s[8:11], s26 offen offset:3072
    buffer_load_dword v23, v2, s[8:11], s26 offen offset:3584
    buffer_load_dword v30, v2, s[8:11], s37 offen offset:3072
    buffer_load_dword v31, v2, s[8:11], s37 offen offset:3584
    buffer_load_dword v38, v2, s[8:11], s38 offen offset:3072
    buffer_load_dword v39, v2, s[8:11], s38 offen offset:3584
    buffer_load_dword v46, v2, s[8:11], s39 offen offset:3072
    buffer_load_dword v47, v2, s[8:11], s39 offen offset:3584
    s_add_u32 s12, s30, 9437184
    s_addc_u32 s13, s31, 0
    s_mov_b32 s14, 7340032
    s_mov_b32 s15, 0x00020000
    v_lshlrev_b32 v4, 4, v1
    s_lshl_b32 s27, s24, 4
    s_add_u32 s27, s27, s23
    s_mul_i32 s27, s27, 57344
    s_lshl_b32 s28, s22, 11
    s_add_u32 s27, s27, s28
    s_lshl_b32 s28, s21, 10
    s_add_u32 s27, s27, s28
    s_cmp_eq_u32 s21, 0
    s_mov_b32 s32, 0x07060302
    s_cselect_b32 s32, 0x05040100, s32
    s_mov_b32 s33, 0x03020c0c
    s_cselect_b32 s33, 0x01000c0c, s33
    s_mov_b32 s35, 0x3d2aaaab
    s_mov_b32 s36, 0x3c638e39
    s_mov_b32 s25, 0xffff0000
    ds_write_b128 v96, v[64:67] offset:57344
    ds_write_b128 v97, v[68:71] offset:8192
    ds_write_b128 v97, v[72:75] offset:24576
    ds_write_b128 v96, v[48:51] offset:8192
    ds_write_b128 v96, v[52:55] offset:24576
    ds_write_b128 v96, v[56:59] offset:40960
    ds_write_b128 v98, v[60:63] offset:8704
    s_waitcnt lgkmcnt(0)
    s_barrier
    s_waitcnt vmcnt(24)
    v_perm_b32 v72, v17, v16, s32
    v_perm_b32 v48, v41, v40, s32
    v_perm_b32 v76, v76, v40, s33
    v_perm_b32 v84, v84, v41, s33
    v_perm_b32 v77, v77, v32, s33
    v_perm_b32 v85, v85, v33, s33
    v_perm_b32 v78, v78, v24, s33
    v_perm_b32 v86, v86, v25, s33
    v_perm_b32 v79, v79, v16, s33
    v_perm_b32 v87, v87, v17, s33
    v_add_f32 v80, v76, v78
    v_add_f32 v88, v84, v86
    v_add_f32 v81, v77, v79
    v_add_f32 v89, v85, v87
    v_fma_f32 v82, v78, 4.0, v76
    v_fma_f32 v90, v86, 4.0, v84
    v_fma_f32 v83, v79, 4.0, v77
    v_fma_f32 v91, v87, 4.0, v85
    v_add_f32 v77, v80, v81
    v_add_f32 v85, v88, v89
    v_sub_f32 v78, v80, v81
    v_sub_f32 v86, v88, v89
    v_fma_f32 v79, v83, 2.0, v82
    v_fma_f32 v87, v91, 2.0, v90
    v_fma_f32 v82, v83, -2.0, v82
    v_fma_f32 v90, v91, -2.0, v90
    v_fmamk_f32 v80, v76, 0x41700000, v82
    v_fmamk_f32 v88, v84, 0x41700000, v90
    v_fmamk_f32 v80, v81, 0x41200000, v80
    v_fmamk_f32 v88, v89, 0x41200000, v88
    v_mul_f32 v77, 0.5, v77
    v_mul_f32 v85, 0.5, v85
    v_mul_f32 v78, 0.5, v78
    v_mul_f32 v86, 0.5, v86
    v_mul_f32 v79, s35, v79
    v_mul_f32 v87, s35, v87
    v_mul_f32 v82, s35, v82
    v_mul_f32 v90, s35, v90
    v_mul_f32 v80, s36, v80
    v_mul_f32 v88, s36, v88
    v_cvt_pk_bf16_f32 v52, v77, v85
    v_cvt_pk_bf16_f32 v56, v78, v86
    v_cvt_pk_bf16_f32 v60, v79, v87
    v_cvt_pk_bf16_f32 v64, v82, v90
    v_cvt_pk_bf16_f32 v68, v80, v88
    s_waitcnt vmcnt(16)
    v_perm_b32 v73, v19, v18, s32
    v_perm_b32 v49, v43, v42, s32
    v_perm_b32 v76, v76, v42, s33
    v_perm_b32 v84, v84, v43, s33
    v_perm_b32 v77, v77, v34, s33
    v_perm_b32 v85, v85, v35, s33
    v_perm_b32 v78, v78, v26, s33
    v_perm_b32 v86, v86, v27, s33
    v_perm_b32 v79, v79, v18, s33
    v_perm_b32 v87, v87, v19, s33
    v_add_f32 v80, v76, v78
    v_add_f32 v88, v84, v86
    v_add_f32 v81, v77, v79
    v_add_f32 v89, v85, v87
    v_fma_f32 v82, v78, 4.0, v76
    v_fma_f32 v90, v86, 4.0, v84
    v_fma_f32 v83, v79, 4.0, v77
    v_fma_f32 v91, v87, 4.0, v85
    v_add_f32 v77, v80, v81
    v_add_f32 v85, v88, v89
    v_sub_f32 v78, v80, v81
    v_sub_f32 v86, v88, v89
    v_fma_f32 v79, v83, 2.0, v82
    v_fma_f32 v87, v91, 2.0, v90
    v_fma_f32 v82, v83, -2.0, v82
    v_fma_f32 v90, v91, -2.0, v90
    v_fmamk_f32 v80, v76, 0x41700000, v82
    v_fmamk_f32 v88, v84, 0x41700000, v90
    v_fmamk_f32 v80, v81, 0x41200000, v80
    v_fmamk_f32 v88, v89, 0x41200000, v88
    v_mul_f32 v77, 0.5, v77
    v_mul_f32 v85, 0.5, v85
    v_mul_f32 v78, 0.5, v78
    v_mul_f32 v86, 0.5, v86
    v_mul_f32 v79, s35, v79
    v_mul_f32 v87, s35, v87
    v_mul_f32 v82, s35, v82
    v_mul_f32 v90, s35, v90
    v_mul_f32 v80, s36, v80
    v_mul_f32 v88, s36, v88
    v_cvt_pk_bf16_f32 v53, v77, v85
    v_cvt_pk_bf16_f32 v57, v78, v86
    v_cvt_pk_bf16_f32 v61, v79, v87
    v_cvt_pk_bf16_f32 v65, v82, v90
    v_cvt_pk_bf16_f32 v69, v80, v88
    s_waitcnt vmcnt(8)
    v_perm_b32 v74, v21, v20, s32
    v_perm_b32 v50, v45, v44, s32
    v_perm_b32 v76, v76, v44, s33
    v_perm_b32 v84, v84, v45, s33
    v_perm_b32 v77, v77, v36, s33
    v_perm_b32 v85, v85, v37, s33
    v_perm_b32 v78, v78, v28, s33
    v_perm_b32 v86, v86, v29, s33
    v_perm_b32 v79, v79, v20, s33
    v_perm_b32 v87, v87, v21, s33
    v_add_f32 v80, v76, v78
    v_add_f32 v88, v84, v86
    v_add_f32 v81, v77, v79
    v_add_f32 v89, v85, v87
    v_fma_f32 v82, v78, 4.0, v76
    v_fma_f32 v90, v86, 4.0, v84
    v_fma_f32 v83, v79, 4.0, v77
    v_fma_f32 v91, v87, 4.0, v85
    v_add_f32 v77, v80, v81
    v_add_f32 v85, v88, v89
    v_sub_f32 v78, v80, v81
    v_sub_f32 v86, v88, v89
    v_fma_f32 v79, v83, 2.0, v82
    v_fma_f32 v87, v91, 2.0, v90
    v_fma_f32 v82, v83, -2.0, v82
    v_fma_f32 v90, v91, -2.0, v90
    v_fmamk_f32 v80, v76, 0x41700000, v82
    v_fmamk_f32 v88, v84, 0x41700000, v90
    v_fmamk_f32 v80, v81, 0x41200000, v80
    v_fmamk_f32 v88, v89, 0x41200000, v88
    v_mul_f32 v77, 0.5, v77
    v_mul_f32 v85, 0.5, v85
    v_mul_f32 v78, 0.5, v78
    v_mul_f32 v86, 0.5, v86
    v_mul_f32 v79, s35, v79
    v_mul_f32 v87, s35, v87
    v_mul_f32 v82, s35, v82
    v_mul_f32 v90, s35, v90
    v_mul_f32 v80, s36, v80
    v_mul_f32 v88, s36, v88
    v_cvt_pk_bf16_f32 v54, v77, v85
    v_cvt_pk_bf16_f32 v58, v78, v86
    v_cvt_pk_bf16_f32 v62, v79, v87
    v_cvt_pk_bf16_f32 v66, v82, v90
    v_cvt_pk_bf16_f32 v70, v80, v88
    s_waitcnt vmcnt(0)
    v_perm_b32 v75, v23, v22, s32
    v_perm_b32 v51, v47, v46, s32
    v_perm_b32 v76, v76, v46, s33
    v_perm_b32 v84, v84, v47, s33
    v_perm_b32 v77, v77, v38, s33
    v_perm_b32 v85, v85, v39, s33
    v_perm_b32 v78, v78, v30, s33
    v_perm_b32 v86, v86, v31, s33
    v_perm_b32 v79, v79, v22, s33
    v_perm_b32 v87, v87, v23, s33
    v_add_f32 v80, v76, v78
    v_add_f32 v88, v84, v86
    v_add_f32 v81, v77, v79
    v_add_f32 v89, v85, v87
    v_fma_f32 v82, v78, 4.0, v76
    v_fma_f32 v90, v86, 4.0, v84
    v_fma_f32 v83, v79, 4.0, v77
    v_fma_f32 v91, v87, 4.0, v85
    v_add_f32 v77, v80, v81
    v_add_f32 v85, v88, v89
    v_sub_f32 v78, v80, v81
    v_sub_f32 v86, v88, v89
    v_fma_f32 v79, v83, 2.0, v82
    v_fma_f32 v87, v91, 2.0, v90
    v_fma_f32 v82, v83, -2.0, v82
    v_fma_f32 v90, v91, -2.0, v90
    v_fmamk_f32 v80, v76, 0x41700000, v82
    v_fmamk_f32 v88, v84, 0x41700000, v90
    v_fmamk_f32 v80, v81, 0x41200000, v80
    v_fmamk_f32 v88, v89, 0x41200000, v88
    v_mul_f32 v77, 0.5, v77
    v_mul_f32 v85, 0.5, v85
    v_mul_f32 v78, 0.5, v78
    v_mul_f32 v86, 0.5, v86
    v_mul_f32 v79, s35, v79
    v_mul_f32 v87, s35, v87
    v_mul_f32 v82, s35, v82
    v_mul_f32 v90, s35, v90
    v_mul_f32 v80, s36, v80
    v_mul_f32 v88, s36, v88
    v_cvt_pk_bf16_f32 v55, v77, v85
    v_cvt_pk_bf16_f32 v59, v78, v86
    v_cvt_pk_bf16_f32 v63, v79, v87
    v_cvt_pk_bf16_f32 v67, v82, v90
    v_cvt_pk_bf16_f32 v71, v80, v88
    s_add_u32 s28, s27, 49152
    buffer_store_dwordx4 v[72:75], v4, s[12:15], s28 offen sc1
    s_add_u32 s28, s27, 0
    buffer_store_dwordx4 v[48:51], v4, s[12:15], s28 offen sc1
    s_add_u32 s28, s27, 8192
    buffer_store_dwordx4 v[52:55], v4, s[12:15], s28 offen sc1
    s_add_u32 s28, s27, 16384
    buffer_store_dwordx4 v[56:59], v4, s[12:15], s28 offen sc1
    s_add_u32 s28, s27, 24576
    buffer_store_dwordx4 v[60:63], v4, s[12:15], s28 offen sc1
    s_add_u32 s28, s27, 32768
    buffer_store_dwordx4 v[64:67], v4, s[12:15], s28 offen sc1
    s_add_u32 s28, s27, 40960
    buffer_store_dwordx4 v[68:71], v4, s[12:15], s28 offen sc1
    s_mov_b32 s20, s58
    s_branch L_conv1_kernel_end
L_conv1_kernel_epi:
    v_and_b32 v108, 15, v127
    v_lshrrev_b32 v109, 4, v127
    v_lshrrev_b32 v110, 3, v108
    s_lshl_b32 s36, s20, 1
    v_add_u32 v110, s36, v110
    v_xor_b32 v111, v110, v108
    v_and_b32 v111, 7, v111
    v_lshlrev_b32 v111, 4, v111
    v_lshl_add_u32 v111, v110, 7, v111
    v_lshl_add_u32 v120, v109, 11, v111
    v_add_u32 v121, 65536, v120
    v_add_u32 v125, 131072, v120
    s_lshl_b32 s36, s20, 9
    s_add_u32 s36, s36, 115712
    v_lshl_add_u32 v123, v109, 7, s36
    s_lshl_b32 s36, s20, 4
    v_add_u32 v108, s36, v108
    v_lshlrev_b32 v110, 6, v108
    v_lshl_add_u32 v110, v109, 4, v110
    s_mul_i32 s36, s29, 524288
    s_lshl_b32 s37, s21, 4
    s_add_u32 s36, s36, s37
    v_add_u32 v110, s36, v110
    v_mov_b32 v111, 2130706432
    v_cmp_gt_u32 vcc, 125, v108
    s_mov_b32 s4, 0xbeaaaaab
    s_mov_b32 s5, s4
    s_mov_b32 s6, 0x3e800000
    s_mov_b32 s7, s6
    s_mov_b32 s8, 0xc0a00000
    s_mov_b32 s9, s8
    s_mov_b32 s10, 0xc0638e39
    s_mov_b32 s11, s10
    s_mov_b32 s12, 0xbf638e39
    s_mov_b32 s13, s12
    s_mov_b32 s14, 0xbe638e39
    s_mov_b32 s15, s14
    s_mov_b32 s22, 0xbd638e39
    s_mov_b32 s23, s22
    s_mov_b32 s24, 0x3ff1c71c
    s_mov_b32 s25, s24
    s_mov_b32 s26, 0xbf2aaaab
    s_mov_b32 s27, s26
    s_mov_b32 s32, 0x3ecccccd
    s_mov_b32 s33, s32
    s_mov_b32 s34, 0xbd888889
    s_mov_b32 s35, s34
    s_mov_b32 s38, 0xbe4ccccd
    s_mov_b32 s39, s38
    s_mov_b32 s40, 0xbdd2d3e8
    s_mov_b32 s41, s40
    s_mov_b32 s42, 0x3f800000
    s_mov_b32 s43, s42
    s_waitcnt lgkmcnt(0)
    s_barrier
    v_cndmask_b32 v122, v111, v110, vcc
    ds_read_b128 v[0:3], v120 offset:0
    ds_read_b128 v[4:7], v120 offset:16384
    ds_read_b128 v[8:11], v120 offset:32768
    ds_read_b128 v[12:15], v120 offset:49152
    ds_read_b128 v[16:19], v121 offset:0
    ds_read_b128 v[20:23], v121 offset:16384
    ds_read_b128 v[24:27], v121 offset:32768
    ds_read_b128 v[28:31], v125 offset:15360
    ds_read_b128 v[32:35], v120 offset:8192
    ds_read_b128 v[36:39], v120 offset:24576
    ds_read_b128 v[40:43], v120 offset:40960
    ds_read_b128 v[44:47], v120 offset:57344
    ds_read_b128 v[48:51], v121 offset:56320
    ds_read_b128 v[52:55], v121 offset:64512
    ds_read_b128 v[56:59], v125 offset:7168
    s_waitcnt lgkmcnt(7)
    ds_read_b128 v[60:63], v125 offset:23552
    s_waitcnt lgkmcnt(8)
    v_pk_add_f32 v[88:89], v[24:25], v[28:29]
    v_pk_add_f32 v[90:91], v[26:27], v[30:31]
    v_pk_add_f32 v[24:25], v[4:5], v[8:9]
    v_pk_add_f32 v[26:27], v[6:7], v[10:11]
    v_pk_add_f32 v[4:5], v[4:5], v[8:9] neg_lo:[0,1] neg_hi:[0,1]
    v_pk_add_f32 v[6:7], v[6:7], v[10:11] neg_lo:[0,1] neg_hi:[0,1]
    v_pk_add_f32 v[72:73], v[12:13], v[16:17]
    v_pk_add_f32 v[74:75], v[14:15], v[18:19]
    v_pk_add_f32 v[12:13], v[12:13], v[16:17] neg_lo:[0,1] neg_hi:[0,1]
    v_pk_add_f32 v[14:15], v[14:15], v[18:19] neg_lo:[0,1] neg_hi:[0,1]
    v_pk_fma_f32 v[72:73], v[24:25], s[4:5], v[72:73]
    v_pk_fma_f32 v[74:75], v[26:27], s[4:5], v[74:75]
    v_pk_fma_f32 v[20:21], v[0:1], s[10:11], v[20:21]
    v_pk_fma_f32 v[22:23], v[2:3], s[10:11], v[22:23]
    v_pk_fma_f32 v[72:73], v[0:1], s[6:7], v[72:73]
    v_pk_fma_f32 v[74:75], v[2:3], s[6:7], v[74:75]
    v_pk_add_f32 v[24:25], v[24:25], v[0:1] neg_lo:[0,1] neg_hi:[0,1]
    v_pk_add_f32 v[26:27], v[26:27], v[2:3] neg_lo:[0,1] neg_hi:[0,1]
    v_pk_fma_f32 v[72:73], v[88:89], s[8:9], v[72:73]
    v_pk_fma_f32 v[74:75], v[90:91], s[8:9], v[74:75]
    v_pk_add_f32 v[24:25], v[24:25], v[88:89] neg_lo:[0,1] neg_hi:[0,1]
    v_pk_add_f32 v[26:27], v[26:27], v[90:91] neg_lo:[0,1] neg_hi:[0,1]
    v_pk_fma_f32 v[20:21], v[88:89], s[22:23], v[20:21]
    v_pk_fma_f32 v[22:23], v[90:91], s[22:23], v[22:23]
    v_pk_add_f32 v[8:9], v[24:25], v[72:73] neg_lo:[0,1] neg_hi:[0,1]
    v_pk_add_f32 v[10:11], v[26:27], v[74:75] neg_lo:[0,1] neg_hi:[0,1]
    v_pk_fma_f32 v[20:21], v[72:73], s[14:15], v[20:21]
    v_pk_fma_f32 v[22:23], v[74:75], s[14:15], v[22:23]
    v_pk_mul_f32 v[80:81], v[12:13], s[32:33]
    v_pk_mul_f32 v[82:83], v[14:15], s[32:33]
    v_pk_fma_f32 v[20:21], v[8:9], s[12:13], v[20:21]
    v_pk_fma_f32 v[22:23], v[10:11], s[12:13], v[22:23]
    v_pk_fma_f32 v[80:81], v[4:5], s[34:35], v[80:81]
    v_pk_fma_f32 v[82:83], v[6:7], s[34:35], v[82:83]
    v_pk_fma_f32 v[64:65], v[4:5], s[24:25], v[20:21] neg_lo:[0,0,1] neg_hi:[0,0,1]
    v_pk_fma_f32 v[66:67], v[6:7], s[24:25], v[22:23] neg_lo:[0,0,1] neg_hi:[0,0,1]
    v_pk_fma_f32 v[64:65], v[12:13], s[26:27], v[64:65]
    v_pk_fma_f32 v[66:67], v[14:15], s[26:27], v[66:67]
    v_pk_fma_f32 v[80:81], v[64:65], s[38:39], v[80:81]
    v_pk_fma_f32 v[82:83], v[66:67], s[38:39], v[82:83]
    v_pk_add_f32 v[4:5], v[4:5], v[64:65] neg_lo:[0,1] neg_hi:[0,1]
    v_pk_add_f32 v[6:7], v[6:7], v[66:67] neg_lo:[0,1] neg_hi:[0,1]
    v_pk_add_f32 v[4:5], v[4:5], v[80:81] neg_lo:[0,1] neg_hi:[0,1]
    v_pk_add_f32 v[6:7], v[6:7], v[82:83] neg_lo:[0,1] neg_hi:[0,1]
    s_waitcnt lgkmcnt(0)
    v_pk_add_f32 v[92:93], v[56:57], v[60:61]
    v_pk_add_f32 v[94:95], v[58:59], v[62:63]
    v_pk_add_f32 v[56:57], v[36:37], v[40:41]
    v_pk_add_f32 v[58:59], v[38:39], v[42:43]
    v_pk_add_f32 v[36:37], v[36:37], v[40:41] neg_lo:[0,1] neg_hi:[0,1]
    v_pk_add_f32 v[38:39], v[38:39], v[42:43] neg_lo:[0,1] neg_hi:[0,1]
    v_pk_add_f32 v[76:77], v[44:45], v[48:49]
    v_pk_add_f32 v[78:79], v[46:47], v[50:51]
    v_pk_add_f32 v[44:45], v[44:45], v[48:49] neg_lo:[0,1] neg_hi:[0,1]
    v_pk_add_f32 v[46:47], v[46:47], v[50:51] neg_lo:[0,1] neg_hi:[0,1]
    v_pk_fma_f32 v[76:77], v[56:57], s[4:5], v[76:77]
    v_pk_fma_f32 v[78:79], v[58:59], s[4:5], v[78:79]
    v_pk_fma_f32 v[52:53], v[32:33], s[10:11], v[52:53]
    v_pk_fma_f32 v[54:55], v[34:35], s[10:11], v[54:55]
    v_pk_fma_f32 v[76:77], v[32:33], s[6:7], v[76:77]
    v_pk_fma_f32 v[78:79], v[34:35], s[6:7], v[78:79]
    v_pk_add_f32 v[56:57], v[56:57], v[32:33] neg_lo:[0,1] neg_hi:[0,1]
    v_pk_add_f32 v[58:59], v[58:59], v[34:35] neg_lo:[0,1] neg_hi:[0,1]
    v_pk_fma_f32 v[76:77], v[92:93], s[8:9], v[76:77]
    v_pk_fma_f32 v[78:79], v[94:95], s[8:9], v[78:79]
    v_pk_add_f32 v[56:57], v[56:57], v[92:93] neg_lo:[0,1] neg_hi:[0,1]
    v_pk_add_f32 v[58:59], v[58:59], v[94:95] neg_lo:[0,1] neg_hi:[0,1]
    v_pk_fma_f32 v[52:53], v[92:93], s[22:23], v[52:53]
    v_pk_fma_f32 v[54:55], v[94:95], s[22:23], v[54:55]
    v_pk_add_f32 v[40:41], v[56:57], v[76:77] neg_lo:[0,1] neg_hi:[0,1]
    v_pk_add_f32 v[42:43], v[58:59], v[78:79] neg_lo:[0,1] neg_hi:[0,1]
    v_pk_fma_f32 v[52:53], v[76:77], s[14:15], v[52:53]
    v_pk_fma_f32 v[54:55], v[78:79], s[14:15], v[54:55]
    v_pk_mul_f32 v[84:85], v[44:45], s[32:33]
    v_pk_mul_f32 v[86:87], v[46:47], s[32:33]
    v_pk_fma_f32 v[52:53], v[40:41], s[12:13], v[52:53]
    v_pk_fma_f32 v[54:55], v[42:43], s[12:13], v[54:55]
    v_pk_fma_f32 v[84:85], v[36:37], s[34:35], v[84:85]
    v_pk_fma_f32 v[86:87], v[38:39], s[34:35], v[86:87]
    v_pk_fma_f32 v[68:69], v[36:37], s[24:25], v[52:53] neg_lo:[0,0,1] neg_hi:[0,0,1]
    v_pk_fma_f32 v[70:71], v[38:39], s[24:25], v[54:55] neg_lo:[0,0,1] neg_hi:[0,0,1]
    v_pk_fma_f32 v[68:69], v[44:45], s[26:27], v[68:69]
    v_pk_fma_f32 v[70:71], v[46:47], s[26:27], v[70:71]
    v_pk_fma_f32 v[84:85], v[68:69], s[38:39], v[84:85]
    v_pk_fma_f32 v[86:87], v[70:71], s[38:39], v[86:87]
    v_pk_add_f32 v[36:37], v[36:37], v[68:69] neg_lo:[0,1] neg_hi:[0,1]
    v_pk_add_f32 v[38:39], v[38:39], v[70:71] neg_lo:[0,1] neg_hi:[0,1]
    v_pk_add_f32 v[36:37], v[36:37], v[84:85] neg_lo:[0,1] neg_hi:[0,1]
    v_pk_add_f32 v[38:39], v[38:39], v[86:87] neg_lo:[0,1] neg_hi:[0,1]
    s_mov_b32 s36, 0x00010001
    s_mov_b32 s37, 0x00010001
    s_mov_b64 exec, s[36:37]
    ds_write_b128 v123, v[0:3] offset:0
    ds_write_b128 v123, v[32:35] offset:16
    ds_write_b128 v123, v[4:7] offset:32
    ds_write_b128 v123, v[36:39] offset:48
    ds_write_b128 v123, v[8:11] offset:64
    ds_write_b128 v123, v[40:43] offset:80
    s_mov_b64 exec, -1
    v_mov_b32 v44, 0xc0135761
    v_mov_b32 v45, v44
    v_pk_mul_f32 v[16:17], v[64:65], v[64:65]
    v_pk_mul_f32 v[18:19], v[66:67], v[66:67]
    v_pk_mul_f32 v[20:21], v[68:69], v[68:69]
    v_pk_mul_f32 v[22:23], v[70:71], v[70:71]
    v_pk_fma_f32 v[16:17], v[16:17], s[40:41], v[44:45]
    v_pk_fma_f32 v[18:19], v[18:19], s[40:41], v[44:45]
    v_pk_fma_f32 v[20:21], v[20:21], s[40:41], v[44:45]
    v_pk_fma_f32 v[22:23], v[22:23], s[40:41], v[44:45]
    v_pk_mul_f32 v[16:17], v[16:17], v[64:65]
    v_pk_mul_f32 v[18:19], v[18:19], v[66:67]
    v_pk_mul_f32 v[20:21], v[20:21], v[68:69]
    v_pk_mul_f32 v[22:23], v[22:23], v[70:71]
    v_exp_f32 v16, v16
    v_exp_f32 v17, v17
    v_exp_f32 v18, v18
    v_exp_f32 v19, v19
    v_exp_f32 v20, v20
    v_exp_f32 v21, v21
    v_exp_f32 v22, v22
    v_exp_f32 v23, v23
    v_pk_add_f32 v[16:17], v[16:17], s[42:43]
    v_pk_add_f32 v[18:19], v[18:19], s[42:43]
    v_pk_add_f32 v[20:21], v[20:21], s[42:43]
    v_pk_add_f32 v[22:23], v[22:23], s[42:43]
    v_rcp_f32 v16, v16
    v_rcp_f32 v17, v17
    v_rcp_f32 v18, v18
    v_rcp_f32 v19, v19
    v_rcp_f32 v20, v20
    v_rcp_f32 v21, v21
    v_rcp_f32 v22, v22
    v_rcp_f32 v23, v23
    v_pk_mul_f32 v[64:65], v[64:65], v[16:17]
    v_pk_mul_f32 v[66:67], v[66:67], v[18:19]
    v_pk_mul_f32 v[68:69], v[68:69], v[20:21]
    v_pk_mul_f32 v[70:71], v[70:71], v[22:23]
    v_cvt_pk_bf16_f32 v48, v64, v68
    v_cvt_pk_bf16_f32 v49, v65, v69
    v_cvt_pk_bf16_f32 v50, v66, v70
    v_cvt_pk_bf16_f32 v51, v67, v71
    s_mov_b32 s44, 393280
    buffer_store_dwordx4 v[48:51], v122, s[16:19], s44 offen sc1
    s_waitcnt lgkmcnt(0)
    s_barrier
    ds_read_b128 v[96:99], v123 offset:512
    ds_read_b128 v[100:103], v123 offset:528
    ds_read_b128 v[104:107], v123 offset:544
    ds_read_b128 v[108:111], v123 offset:560
    ds_read_b128 v[112:115], v123 offset:576
    ds_read_b128 v[116:119], v123 offset:592
    s_waitcnt lgkmcnt(4)
    v_mov_b32_dpp v96, v0 row_shl:1 row_mask:0xf bank_mask:0xf
    v_mov_b32_dpp v97, v1 row_shl:1 row_mask:0xf bank_mask:0xf
    v_mov_b32_dpp v98, v2 row_shl:1 row_mask:0xf bank_mask:0xf
    v_mov_b32_dpp v99, v3 row_shl:1 row_mask:0xf bank_mask:0xf
    v_mov_b32_dpp v100, v32 row_shl:1 row_mask:0xf bank_mask:0xf
    v_mov_b32_dpp v101, v33 row_shl:1 row_mask:0xf bank_mask:0xf
    v_mov_b32_dpp v102, v34 row_shl:1 row_mask:0xf bank_mask:0xf
    v_mov_b32_dpp v103, v35 row_shl:1 row_mask:0xf bank_mask:0xf
    v_pk_add_f32 v[72:73], v[72:73], v[96:97]
    v_pk_add_f32 v[74:75], v[74:75], v[98:99]
    v_pk_add_f32 v[76:77], v[76:77], v[100:101]
    v_pk_add_f32 v[78:79], v[78:79], v[102:103]
    v_pk_mul_f32 v[24:25], v[72:73], v[72:73]
    v_pk_mul_f32 v[26:27], v[74:75], v[74:75]
    v_pk_mul_f32 v[28:29], v[76:77], v[76:77]
    v_pk_mul_f32 v[30:31], v[78:79], v[78:79]
    v_pk_fma_f32 v[24:25], v[24:25], s[40:41], v[44:45]
    v_pk_fma_f32 v[26:27], v[26:27], s[40:41], v[44:45]
    v_pk_fma_f32 v[28:29], v[28:29], s[40:41], v[44:45]
    v_pk_fma_f32 v[30:31], v[30:31], s[40:41], v[44:45]
    v_pk_mul_f32 v[24:25], v[24:25], v[72:73]
    v_pk_mul_f32 v[26:27], v[26:27], v[74:75]
    v_pk_mul_f32 v[28:29], v[28:29], v[76:77]
    v_pk_mul_f32 v[30:31], v[30:31], v[78:79]
    v_exp_f32 v24, v24
    v_exp_f32 v25, v25
    v_exp_f32 v26, v26
    v_exp_f32 v27, v27
    v_exp_f32 v28, v28
    v_exp_f32 v29, v29
    v_exp_f32 v30, v30
    v_exp_f32 v31, v31
    v_pk_add_f32 v[24:25], v[24:25], s[42:43]
    v_pk_add_f32 v[26:27], v[26:27], s[42:43]
    v_pk_add_f32 v[28:29], v[28:29], s[42:43]
    v_pk_add_f32 v[30:31], v[30:31], s[42:43]
    v_rcp_f32 v24, v24
    v_rcp_f32 v25, v25
    v_rcp_f32 v26, v26
    v_rcp_f32 v27, v27
    v_rcp_f32 v28, v28
    v_rcp_f32 v29, v29
    v_rcp_f32 v30, v30
    v_rcp_f32 v31, v31
    v_pk_mul_f32 v[72:73], v[72:73], v[24:25]
    v_pk_mul_f32 v[74:75], v[74:75], v[26:27]
    v_pk_mul_f32 v[76:77], v[76:77], v[28:29]
    v_pk_mul_f32 v[78:79], v[78:79], v[30:31]
    v_cvt_pk_bf16_f32 v52, v72, v76
    v_cvt_pk_bf16_f32 v53, v73, v77
    v_cvt_pk_bf16_f32 v54, v74, v78
    v_cvt_pk_bf16_f32 v55, v75, v79
    s_mov_b32 s44, 128
    buffer_store_dwordx4 v[52:55], v122, s[16:19], s44 offen sc1
    s_waitcnt lgkmcnt(2)
    v_mov_b32_dpp v104, v4 row_shl:1 row_mask:0xf bank_mask:0xf
    v_mov_b32_dpp v105, v5 row_shl:1 row_mask:0xf bank_mask:0xf
    v_mov_b32_dpp v106, v6 row_shl:1 row_mask:0xf bank_mask:0xf
    v_mov_b32_dpp v107, v7 row_shl:1 row_mask:0xf bank_mask:0xf
    v_mov_b32_dpp v108, v36 row_shl:1 row_mask:0xf bank_mask:0xf
    v_mov_b32_dpp v109, v37 row_shl:1 row_mask:0xf bank_mask:0xf
    v_mov_b32_dpp v110, v38 row_shl:1 row_mask:0xf bank_mask:0xf
    v_mov_b32_dpp v111, v39 row_shl:1 row_mask:0xf bank_mask:0xf
    v_pk_add_f32 v[80:81], v[80:81], v[104:105]
    v_pk_add_f32 v[82:83], v[82:83], v[106:107]
    v_pk_add_f32 v[84:85], v[84:85], v[108:109]
    v_pk_add_f32 v[86:87], v[86:87], v[110:111]
    v_pk_mul_f32 v[16:17], v[80:81], v[80:81]
    v_pk_mul_f32 v[18:19], v[82:83], v[82:83]
    v_pk_mul_f32 v[20:21], v[84:85], v[84:85]
    v_pk_mul_f32 v[22:23], v[86:87], v[86:87]
    v_pk_fma_f32 v[16:17], v[16:17], s[40:41], v[44:45]
    v_pk_fma_f32 v[18:19], v[18:19], s[40:41], v[44:45]
    v_pk_fma_f32 v[20:21], v[20:21], s[40:41], v[44:45]
    v_pk_fma_f32 v[22:23], v[22:23], s[40:41], v[44:45]
    v_pk_mul_f32 v[16:17], v[16:17], v[80:81]
    v_pk_mul_f32 v[18:19], v[18:19], v[82:83]
    v_pk_mul_f32 v[20:21], v[20:21], v[84:85]
    v_pk_mul_f32 v[22:23], v[22:23], v[86:87]
    v_exp_f32 v16, v16
    v_exp_f32 v17, v17
    v_exp_f32 v18, v18
    v_exp_f32 v19, v19
    v_exp_f32 v20, v20
    v_exp_f32 v21, v21
    v_exp_f32 v22, v22
    v_exp_f32 v23, v23
    v_pk_add_f32 v[16:17], v[16:17], s[42:43]
    v_pk_add_f32 v[18:19], v[18:19], s[42:43]
    v_pk_add_f32 v[20:21], v[20:21], s[42:43]
    v_pk_add_f32 v[22:23], v[22:23], s[42:43]
    v_rcp_f32 v16, v16
    v_rcp_f32 v17, v17
    v_rcp_f32 v18, v18
    v_rcp_f32 v19, v19
    v_rcp_f32 v20, v20
    v_rcp_f32 v21, v21
    v_rcp_f32 v22, v22
    v_rcp_f32 v23, v23
    v_pk_mul_f32 v[80:81], v[80:81], v[16:17]
    v_pk_mul_f32 v[82:83], v[82:83], v[18:19]
    v_pk_mul_f32 v[84:85], v[84:85], v[20:21]
    v_pk_mul_f32 v[86:87], v[86:87], v[22:23]
    v_cvt_pk_bf16_f32 v56, v80, v84
    v_cvt_pk_bf16_f32 v57, v81, v85
    v_cvt_pk_bf16_f32 v58, v82, v86
    v_cvt_pk_bf16_f32 v59, v83, v87
    s_mov_b32 s44, 131200
    buffer_store_dwordx4 v[56:59], v122, s[16:19], s44 offen sc1
    s_waitcnt lgkmcnt(0)
    v_mov_b32_dpp v112, v8 row_shl:1 row_mask:0xf bank_mask:0xf
    v_mov_b32_dpp v113, v9 row_shl:1 row_mask:0xf bank_mask:0xf
    v_mov_b32_dpp v114, v10 row_shl:1 row_mask:0xf bank_mask:0xf
    v_mov_b32_dpp v115, v11 row_shl:1 row_mask:0xf bank_mask:0xf
    v_mov_b32_dpp v116, v40 row_shl:1 row_mask:0xf bank_mask:0xf
    v_mov_b32_dpp v117, v41 row_shl:1 row_mask:0xf bank_mask:0xf
    v_mov_b32_dpp v118, v42 row_shl:1 row_mask:0xf bank_mask:0xf
    v_mov_b32_dpp v119, v43 row_shl:1 row_mask:0xf bank_mask:0xf
    v_pk_add_f32 v[88:89], v[88:89], v[112:113]
    v_pk_add_f32 v[90:91], v[90:91], v[114:115]
    v_pk_add_f32 v[92:93], v[92:93], v[116:117]
    v_pk_add_f32 v[94:95], v[94:95], v[118:119]
    v_pk_mul_f32 v[24:25], v[88:89], v[88:89]
    v_pk_mul_f32 v[26:27], v[90:91], v[90:91]
    v_pk_mul_f32 v[28:29], v[92:93], v[92:93]
    v_pk_mul_f32 v[30:31], v[94:95], v[94:95]
    v_pk_fma_f32 v[24:25], v[24:25], s[40:41], v[44:45]
    v_pk_fma_f32 v[26:27], v[26:27], s[40:41], v[44:45]
    v_pk_fma_f32 v[28:29], v[28:29], s[40:41], v[44:45]
    v_pk_fma_f32 v[30:31], v[30:31], s[40:41], v[44:45]
    v_pk_mul_f32 v[24:25], v[24:25], v[88:89]
    v_pk_mul_f32 v[26:27], v[26:27], v[90:91]
    v_pk_mul_f32 v[28:29], v[28:29], v[92:93]
    v_pk_mul_f32 v[30:31], v[30:31], v[94:95]
    v_exp_f32 v24, v24
    v_exp_f32 v25, v25
    v_exp_f32 v26, v26
    v_exp_f32 v27, v27
    v_exp_f32 v28, v28
    v_exp_f32 v29, v29
    v_exp_f32 v30, v30
    v_exp_f32 v31, v31
    v_pk_add_f32 v[24:25], v[24:25], s[42:43]
    v_pk_add_f32 v[26:27], v[26:27], s[42:43]
    v_pk_add_f32 v[28:29], v[28:29], s[42:43]
    v_pk_add_f32 v[30:31], v[30:31], s[42:43]
    v_rcp_f32 v24, v24
    v_rcp_f32 v25, v25
    v_rcp_f32 v26, v26
    v_rcp_f32 v27, v27
    v_rcp_f32 v28, v28
    v_rcp_f32 v29, v29
    v_rcp_f32 v30, v30
    v_rcp_f32 v31, v31
    v_pk_mul_f32 v[88:89], v[88:89], v[24:25]
    v_pk_mul_f32 v[90:91], v[90:91], v[26:27]
    v_pk_mul_f32 v[92:93], v[92:93], v[28:29]
    v_pk_mul_f32 v[94:95], v[94:95], v[30:31]
    v_cvt_pk_bf16_f32 v60, v88, v92
    v_cvt_pk_bf16_f32 v61, v89, v93
    v_cvt_pk_bf16_f32 v62, v90, v94
    v_cvt_pk_bf16_f32 v63, v91, v95
    s_mov_b32 s44, 262272
    buffer_store_dwordx4 v[60:63], v122, s[16:19], s44 offen sc1
L_conv1_kernel_end:
L_conv1_kernel_done:
    s_endpgm
.globl conv2_kernel
.p2align 8
.type conv2_kernel,@function
conv2_kernel:
    s_cmp_ge_u32 s2, 256
    s_cbranch_scc1 L_conv2_kernel_done
    s_load_dwordx2 s[4:5], s[0:1], 72
    s_load_dwordx2 s[30:31], s[0:1], 72
    v_readfirstlane_b32 s20, v0
    s_lshr_b32 s20, s20, 6
    s_and_b32 s36, s2, 0
    s_lshl_b32 s36, s36, 3
    s_bfe_u32 s37, s2, 196611
    s_or_b32 s29, s36, s37
    s_bfe_u32 s36, s2, 196608
    s_lshl_b32 s36, s36, 2
    s_lshr_b32 s37, s2, 6
    s_or_b32 s36, s36, s37
    s_lshr_b32 s33, s36, 4
    s_and_b32 s34, s36, 7
    s_bfe_u32 s35, s36, 0x10003
    s_mul_i32 s21, s34, 500
    s_and_b32 s32, s20, 3
    v_and_b32 v127, 63, v0
    v_lshrrev_b32 v5, 2, v127
    v_and_b32 v6, 3, v127
    s_and_b32 s42, s20, 7
    s_lshr_b32 s41, s21, 2
    s_sub_u32 s41, s41, 1
    s_add_u32 s37, s41, s42
    v_lshl_add_u32 v7, v5, 3, s37
    s_mul_i32 s36, s35, 4194304
    s_add_u32 s36, s36, 18874368
    s_mov_b32 s10, 4194304
    s_mov_b32 s11, 0x00020000
    s_mov_b32 s25, 0xffff0000
    s_waitcnt lgkmcnt(0)
    s_add_u32 s8, s4, s36
    s_addc_u32 s9, s5, 0
    s_cmp_ge_u32 s20, 8
    s_cbranch_scc1 L_conv2_kernel_helper
    s_add_u32 s37, s41, 128
    v_mov_b32 v16, s37
    v_mul_u32_u24 v17, 524288, v5
    v_lshl_add_u32 v17, v6, 4, v17
    s_add_u32 s37, s33, 4294967289
    v_lshl_add_u32 v18, v16, 3, s37
    v_cmp_gt_u32 vcc, 8000, v18
    s_mul_i32 s37, s33, 131072
    s_add_u32 s37, s37, 0
    v_lshl_add_u32 v108, v16, 7, s37
    v_add_u32 v108, v108, v17
    v_mov_b32 v18, 2130706432
    v_cndmask_b32 v108, v18, v108, vcc
    s_add_u32 s37, s33, 4294967291
    v_lshl_add_u32 v18, v16, 3, s37
    v_cmp_gt_u32 vcc, 8000, v18
    s_mul_i32 s37, s33, 131072
    s_add_u32 s37, s37, 262144
    v_lshl_add_u32 v109, v16, 7, s37
    v_add_u32 v109, v109, v17
    v_mov_b32 v18, 2130706432
    v_cndmask_b32 v109, v18, v109, vcc
    s_add_u32 s37, s33, 4294967293
    v_lshl_add_u32 v18, v16, 3, s37
    v_cmp_gt_u32 vcc, 8000, v18
    s_mul_i32 s37, s33, 131072
    s_add_u32 s37, s37, 64
    v_lshl_add_u32 v110, v16, 7, s37
    v_add_u32 v110, v110, v17
    v_mov_b32 v18, 2130706432
    v_cndmask_b32 v110, v18, v110, vcc
    s_lshl_b32 s36, s29, 4
    s_lshl_b32 s37, s33, 3
    s_add_u32 s36, s36, s37
    s_mul_i32 s36, s36, 57344
    s_add_u32 s36, s36, 9437184
    s_add_u32 s12, s30, s36
    s_addc_u32 s13, s31, 0
    s_mov_b32 s14, 458752
    s_mov_b32 s15, 0x00020000
    s_mul_i32 s36, s35, 2097152
    s_add_u32 s36, s36, 27262976
    s_mul_i32 s37, s33, 8388608
    s_add_u32 s36, s36, s37
    s_add_u32 s16, s30, s36
    s_addc_u32 s17, s31, 0
    s_mov_b32 s18, 2097152
    s_mov_b32 s19, 0x00020000
    v_and_b32 v10, 15, v127
    v_lshrrev_b32 v11, 4, v127
    v_add_u32 v8, 0, v10
    v_and_b32 v16, 4, v8
    v_lshrrev_b32 v16, 1, v16
    v_xor_b32 v16, v11, v16
    v_lshlrev_b32 v16, 4, v16
    v_lshl_add_u32 v8, v8, 6, v16
    v_add_u32 v9, 1, v10
    v_and_b32 v16, 4, v9
    v_lshrrev_b32 v16, 1, v16
    v_xor_b32 v16, v11, v16
    v_lshlrev_b32 v16, 4, v16
    v_lshl_add_u32 v9, v9, 6, v16
    s_lshr_b32 s38, s32, 1
    s_and_b32 s39, s32, 1
    s_add_u32 s40, s38, 4
    s_lshl_b32 s43, s39, 10
    s_cmp_lt_u32 s20, 4
    s_cselect_b32 s40, s20, s40
    s_cselect_b32 s36, 0, s43
    s_lshl_b32 s37, s40, 13
    s_add_u32 s37, s37, s36
    v_lshl_add_u32 v125, v127, 4, s37
    s_mul_i32 s37, s40, 16384
    v_add_u32 v120, s37, v8
    v_add_u32 v121, s37, v9
    s_lshl_b32 s37, s40, 10
    s_add_u32 s37, s37, 115712
    v_lshl_add_u32 v16, v11, 4, s37
    v_cmp_eq_u32 vcc, 15, v10
    v_mov_b32 v17, 8192
    v_mov_b32 v18, 4294959104
    v_mov_b32 v19, 64
    v_cndmask_b32 v122, v121, v16, vcc
    v_cndmask_b32 v123, v17, v19, vcc
    v_cndmask_b32 v124, v18, v19, vcc
    v_lshl_add_u32 v126, v127, 4, s37
    s_mov_b32 s44, 0x3f800000
    s_mov_b32 s45, 0x00000000
    s_mov_b32 s46, 0x00000000
    s_cmp_eq_u32 s40, 1
    s_cselect_b32 s45, 0x3f800000, s45
    s_cselect_b32 s46, 0x3f800000, s46
    s_cmp_eq_u32 s40, 2
    s_cselect_b32 s45, 0xbf800000, s45
    s_cselect_b32 s46, 0x3f800000, s46
    s_cmp_eq_u32 s40, 3
    s_cselect_b32 s45, 0x40000000, s45
    s_cselect_b32 s46, 0x40800000, s46
    s_cmp_eq_u32 s40, 4
    s_cselect_b32 s45, 0xc0000000, s45
    s_cselect_b32 s46, 0x40800000, s46
    s_cmp_eq_u32 s40, 5
    s_cselect_b32 s44, 0x41800000, s44
    s_cselect_b32 s45, 0x41000000, s45
    s_cselect_b32 s46, 0x40800000, s46
    s_cmp_ge_u32 s20, 4
    s_cbranch_scc1 L_conv2_kernel_m2
    v_mov_b32 v0, 0
    v_mov_b32 v1, 0
    v_mov_b32 v2, 0
    v_mov_b32 v3, 0
    v_mov_b32 v4, 0
    v_mov_b32 v5, 0
    v_mov_b32 v6, 0
    v_mov_b32 v7, 0
    v_mov_b32 v8, 0
    v_mov_b32 v9, 0
    v_mov_b32 v10, 0
    v_mov_b32 v11, 0
    v_mov_b32 v12, 0
    v_mov_b32 v13, 0
    v_mov_b32 v14, 0
    v_mov_b32 v15, 0
    v_mov_b32 v16, 0
    v_mov_b32 v17, 0
    v_mov_b32 v18, 0
    v_mov_b32 v19, 0
    v_mov_b32 v20, 0
    v_mov_b32 v21, 0
    v_mov_b32 v22, 0
    v_mov_b32 v23, 0
    v_mov_b32 v24, 0
    v_mov_b32 v25, 0
    v_mov_b32 v26, 0
    v_mov_b32 v27, 0
    v_mov_b32 v28, 0
    v_mov_b32 v29, 0
    v_mov_b32 v30, 0
    v_mov_b32 v31, 0
    v_mov_b32 v32, 0
    v_mov_b32 v33, 0
    v_mov_b32 v34, 0
    v_mov_b32 v35, 0
    v_mov_b32 v36, 0
    v_mov_b32 v37, 0
    v_mov_b32 v38, 0
    v_mov_b32 v39, 0
    v_mov_b32 v40, 0
    v_mov_b32 v41, 0
    v_mov_b32 v42, 0
    v_mov_b32 v43, 0
    v_mov_b32 v44, 0
    v_mov_b32 v45, 0
    v_mov_b32 v46, 0
    v_mov_b32 v47, 0
    v_mov_b32 v48, 0
    v_mov_b32 v49, 0
    v_mov_b32 v50, 0
    v_mov_b32 v51, 0
    v_mov_b32 v52, 0
    v_mov_b32 v53, 0
    v_mov_b32 v54, 0
    v_mov_b32 v55, 0
    v_mov_b32 v56, 0
    v_mov_b32 v57, 0
    v_mov_b32 v58, 0
    v_mov_b32 v59, 0
    v_mov_b32 v60, 0
    v_mov_b32 v61, 0
    v_mov_b32 v62, 0
    v_mov_b32 v63, 0
    s_barrier
    buffer_load_dwordx4 v[96:99], v108, s[8:11], 0 offen
    buffer_load_dwordx4 v[100:103], v109, s[8:11], 0 offen
    buffer_load_dwordx4 v[104:107], v110, s[8:11], 0 offen
    s_mov_b32 s23, 0
    s_mov_b32 s26, 4096
    buffer_load_dwordx4 v[64:67], v125, s[12:15], s23 offen offset:0
    buffer_load_dwordx4 v[68:71], v125, s[12:15], s23 offen offset:1024
    buffer_load_dwordx4 v[72:75], v125, s[12:15], s23 offen offset:2048
    buffer_load_dwordx4 v[76:79], v125, s[12:15], s23 offen offset:3072
    buffer_load_dwordx4 v[80:83], v125, s[12:15], s26 offen offset:0
    buffer_load_dwordx4 v[84:87], v125, s[12:15], s26 offen offset:1024
    buffer_load_dwordx4 v[88:91], v125, s[12:15], s26 offen offset:2048
    buffer_load_dwordx4 v[92:95], v125, s[12:15], s26 offen offset:3072
    s_mov_b32 s23, 57344
    s_mov_b32 s26, 61440
    s_waitcnt vmcnt(8)
    v_lshlrev_b32 v108, 16, v96
    v_and_b32 v111, s25, v96
    v_lshlrev_b32 v109, 16, v100
    v_and_b32 v112, s25, v100
    v_lshlrev_b32 v110, 16, v104
    v_and_b32 v113, s25, v104
    v_mul_f32 v114, s44, v108
    v_mul_f32 v115, s44, v111
    v_fmac_f32 v114, s45, v109
    v_fmac_f32 v115, s45, v112
    v_fmac_f32 v114, s46, v110
    v_fmac_f32 v115, s46, v113
    v_cvt_pk_bf16_f32 v96, v114, v115
    v_lshlrev_b32 v108, 16, v97
    v_and_b32 v111, s25, v97
    v_lshlrev_b32 v109, 16, v101
    v_and_b32 v112, s25, v101
    v_lshlrev_b32 v110, 16, v105
    v_and_b32 v113, s25, v105
    v_mul_f32 v114, s44, v108
    v_mul_f32 v115, s44, v111
    v_fmac_f32 v114, s45, v109
    v_fmac_f32 v115, s45, v112
    v_fmac_f32 v114, s46, v110
    v_fmac_f32 v115, s46, v113
    v_cvt_pk_bf16_f32 v97, v114, v115
    v_lshlrev_b32 v108, 16, v98
    v_and_b32 v111, s25, v98
    v_lshlrev_b32 v109, 16, v102
    v_and_b32 v112, s25, v102
    v_lshlrev_b32 v110, 16, v106
    v_and_b32 v113, s25, v106
    v_mul_f32 v114, s44, v108
    v_mul_f32 v115, s44, v111
    v_fmac_f32 v114, s45, v109
    v_fmac_f32 v115, s45, v112
    v_fmac_f32 v114, s46, v110
    v_fmac_f32 v115, s46, v113
    v_cvt_pk_bf16_f32 v98, v114, v115
    v_lshlrev_b32 v108, 16, v99
    v_and_b32 v111, s25, v99
    v_lshlrev_b32 v109, 16, v103
    v_and_b32 v112, s25, v103
    v_lshlrev_b32 v110, 16, v107
    v_and_b32 v113, s25, v107
    v_mul_f32 v114, s44, v108
    v_mul_f32 v115, s44, v111
    v_fmac_f32 v114, s45, v109
    v_fmac_f32 v115, s45, v112
    v_fmac_f32 v114, s46, v110
    v_fmac_f32 v115, s46, v113
    v_cvt_pk_bf16_f32 v99, v114, v115
    ds_write_b128 v126, v[96:99]
    s_waitcnt lgkmcnt(0)
    s_barrier
    s_mov_b32 s22, 4
    s_setprio 2
L_conv2_kernel_mloop1:
    ds_read_b128 v[96:99], v120 offset:0
    ds_read_b128 v[100:103], v120 offset:1024
    ds_read_b128 v[104:107], v120 offset:2048
    ds_read_b128 v[108:111], v120 offset:3072
    ds_read_b128 v[112:115], v120 offset:4096
    ds_read_b128 v[116:119], v120 offset:5120
    s_waitcnt vmcnt(6) lgkmcnt(5)
    v_mfma_f32_16x16x32_bf16 v[0:3], v[64:67], v[96:99], v[0:3]
    v_mfma_f32_16x16x32_bf16 v[32:35], v[68:71], v[96:99], v[32:35]
    ds_read_b128 v[96:99], v120 offset:6144
    s_waitcnt vmcnt(4) lgkmcnt(5)
    v_mfma_f32_16x16x32_bf16 v[4:7], v[64:67], v[100:103], v[4:7]
    v_mfma_f32_16x16x32_bf16 v[36:39], v[68:71], v[100:103], v[36:39]
    v_mfma_f32_16x16x32_bf16 v[0:3], v[72:75], v[100:103], v[0:3]
    v_mfma_f32_16x16x32_bf16 v[32:35], v[76:79], v[100:103], v[32:35]
    ds_read_b128 v[100:103], v120 offset:7168
    s_waitcnt vmcnt(2) lgkmcnt(5)
    v_mfma_f32_16x16x32_bf16 v[8:11], v[64:67], v[104:107], v[8:11]
    v_mfma_f32_16x16x32_bf16 v[40:43], v[68:71], v[104:107], v[40:43]
    v_mfma_f32_16x16x32_bf16 v[4:7], v[72:75], v[104:107], v[4:7]
    v_mfma_f32_16x16x32_bf16 v[36:39], v[76:79], v[104:107], v[36:39]
    v_mfma_f32_16x16x32_bf16 v[0:3], v[80:83], v[104:107], v[0:3]
    v_mfma_f32_16x16x32_bf16 v[32:35], v[84:87], v[104:107], v[32:35]
    ds_read_b128 v[104:107], v122 offset:0
    v_add_u32 v122, v123, v122
    s_waitcnt vmcnt(0) lgkmcnt(5)
    v_mfma_f32_16x16x32_bf16 v[12:15], v[64:67], v[108:111], v[12:15]
    v_mfma_f32_16x16x32_bf16 v[44:47], v[68:71], v[108:111], v[44:47]
    v_mfma_f32_16x16x32_bf16 v[8:11], v[72:75], v[108:111], v[8:11]
    v_mfma_f32_16x16x32_bf16 v[40:43], v[76:79], v[108:111], v[40:43]
    v_mfma_f32_16x16x32_bf16 v[4:7], v[80:83], v[108:111], v[4:7]
    v_mfma_f32_16x16x32_bf16 v[36:39], v[84:87], v[108:111], v[36:39]
    v_mfma_f32_16x16x32_bf16 v[0:3], v[88:91], v[108:111], v[0:3]
    v_mfma_f32_16x16x32_bf16 v[32:35], v[92:95], v[108:111], v[32:35]
    ds_read_b128 v[108:111], v121 offset:1024
    s_waitcnt lgkmcnt(5)
    v_mfma_f32_16x16x32_bf16 v[16:19], v[64:67], v[112:115], v[16:19]
    v_mfma_f32_16x16x32_bf16 v[48:51], v[68:71], v[112:115], v[48:51]
    v_mfma_f32_16x16x32_bf16 v[12:15], v[72:75], v[112:115], v[12:15]
    v_mfma_f32_16x16x32_bf16 v[44:47], v[76:79], v[112:115], v[44:47]
    v_mfma_f32_16x16x32_bf16 v[8:11], v[80:83], v[112:115], v[8:11]
    v_mfma_f32_16x16x32_bf16 v[40:43], v[84:87], v[112:115], v[40:43]
    v_mfma_f32_16x16x32_bf16 v[4:7], v[88:91], v[112:115], v[4:7]
    v_mfma_f32_16x16x32_bf16 v[36:39], v[92:95], v[112:115], v[36:39]
    ds_read_b128 v[112:115], v121 offset:2048
    s_waitcnt lgkmcnt(5)
    v_mfma_f32_16x16x32_bf16 v[20:23], v[64:67], v[116:119], v[20:23]
    v_mfma_f32_16x16x32_bf16 v[52:55], v[68:71], v[116:119], v[52:55]
    v_mfma_f32_16x16x32_bf16 v[16:19], v[72:75], v[116:119], v[16:19]
    v_mfma_f32_16x16x32_bf16 v[48:51], v[76:79], v[116:119], v[48:51]
    v_mfma_f32_16x16x32_bf16 v[12:15], v[80:83], v[116:119], v[12:15]
    v_mfma_f32_16x16x32_bf16 v[44:47], v[84:87], v[116:119], v[44:47]
    v_mfma_f32_16x16x32_bf16 v[8:11], v[88:91], v[116:119], v[8:11]
    v_mfma_f32_16x16x32_bf16 v[40:43], v[92:95], v[116:119], v[40:43]
    s_waitcnt lgkmcnt(4)
    v_mfma_f32_16x16x32_bf16 v[24:27], v[64:67], v[96:99], v[24:27]
    v_mfma_f32_16x16x32_bf16 v[56:59], v[68:71], v[96:99], v[56:59]
    v_mfma_f32_16x16x32_bf16 v[20:23], v[72:75], v[96:99], v[20:23]
    v_mfma_f32_16x16x32_bf16 v[52:55], v[76:79], v[96:99], v[52:55]
    v_mfma_f32_16x16x32_bf16 v[16:19], v[80:83], v[96:99], v[16:19]
    v_mfma_f32_16x16x32_bf16 v[48:51], v[84:87], v[96:99], v[48:51]
    v_mfma_f32_16x16x32_bf16 v[12:15], v[88:91], v[96:99], v[12:15]
    v_mfma_f32_16x16x32_bf16 v[44:47], v[92:95], v[96:99], v[44:47]
    s_waitcnt lgkmcnt(3)
    v_mfma_f32_16x16x32_bf16 v[28:31], v[64:67], v[100:103], v[28:31]
    v_mfma_f32_16x16x32_bf16 v[60:63], v[68:71], v[100:103], v[60:63]
    v_mfma_f32_16x16x32_bf16 v[24:27], v[72:75], v[100:103], v[24:27]
    v_mfma_f32_16x16x32_bf16 v[56:59], v[76:79], v[100:103], v[56:59]
    v_mfma_f32_16x16x32_bf16 v[20:23], v[80:83], v[100:103], v[20:23]
    v_mfma_f32_16x16x32_bf16 v[52:55], v[84:87], v[100:103], v[52:55]
    v_mfma_f32_16x16x32_bf16 v[16:19], v[88:91], v[100:103], v[16:19]
    v_mfma_f32_16x16x32_bf16 v[48:51], v[92:95], v[100:103], v[48:51]
    buffer_load_dwordx4 v[64:67], v125, s[12:15], s23 offen offset:0
    buffer_load_dwordx4 v[68:71], v125, s[12:15], s23 offen offset:1024
    s_waitcnt lgkmcnt(2)
    v_mfma_f32_16x16x32_bf16 v[28:31], v[72:75], v[104:107], v[28:31]
    v_mfma_f32_16x16x32_bf16 v[60:63], v[76:79], v[104:107], v[60:63]
    v_mfma_f32_16x16x32_bf16 v[24:27], v[80:83], v[104:107], v[24:27]
    v_mfma_f32_16x16x32_bf16 v[56:59], v[84:87], v[104:107], v[56:59]
    v_mfma_f32_16x16x32_bf16 v[20:23], v[88:91], v[104:107], v[20:23]
    v_mfma_f32_16x16x32_bf16 v[52:55], v[92:95], v[104:107], v[52:55]
    buffer_load_dwordx4 v[72:75], v125, s[12:15], s23 offen offset:2048
    buffer_load_dwordx4 v[76:79], v125, s[12:15], s23 offen offset:3072
    s_waitcnt lgkmcnt(1)
    v_mfma_f32_16x16x32_bf16 v[28:31], v[80:83], v[108:111], v[28:31]
    v_mfma_f32_16x16x32_bf16 v[60:63], v[84:87], v[108:111], v[60:63]
    v_mfma_f32_16x16x32_bf16 v[24:27], v[88:91], v[108:111], v[24:27]
    v_mfma_f32_16x16x32_bf16 v[56:59], v[92:95], v[108:111], v[56:59]
    buffer_load_dwordx4 v[80:83], v125, s[12:15], s26 offen offset:0
    buffer_load_dwordx4 v[84:87], v125, s[12:15], s26 offen offset:1024
    s_waitcnt lgkmcnt(0)
    v_mfma_f32_16x16x32_bf16 v[28:31], v[88:91], v[112:115], v[28:31]
    v_mfma_f32_16x16x32_bf16 v[60:63], v[92:95], v[112:115], v[60:63]
    buffer_load_dwordx4 v[88:91], v125, s[12:15], s26 offen offset:2048
    buffer_load_dwordx4 v[92:95], v125, s[12:15], s26 offen offset:3072
    s_add_u32 s23, s23, 57344
    s_add_u32 s26, s26, 57344
    s_barrier
    s_sub_u32 s22, s22, 1
    s_cmp_eq_u32 s22, 0
    s_cbranch_scc1 L_conv2_kernel_mlast1
    ds_read_b128 v[96:99], v120 offset:8192
    ds_read_b128 v[100:103], v120 offset:9216
    ds_read_b128 v[104:107], v120 offset:10240
    ds_read_b128 v[108:111], v120 offset:11264
    ds_read_b128 v[112:115], v120 offset:12288
    ds_read_b128 v[116:119], v120 offset:13312
    s_waitcnt vmcnt(6) lgkmcnt(5)
    v_mfma_f32_16x16x32_bf16 v[0:3], v[64:67], v[96:99], v[0:3]
    v_mfma_f32_16x16x32_bf16 v[32:35], v[68:71], v[96:99], v[32:35]
    ds_read_b128 v[96:99], v120 offset:14336
    s_waitcnt vmcnt(4) lgkmcnt(5)
    v_mfma_f32_16x16x32_bf16 v[4:7], v[64:67], v[100:103], v[4:7]
    v_mfma_f32_16x16x32_bf16 v[36:39], v[68:71], v[100:103], v[36:39]
    v_mfma_f32_16x16x32_bf16 v[0:3], v[72:75], v[100:103], v[0:3]
    v_mfma_f32_16x16x32_bf16 v[32:35], v[76:79], v[100:103], v[32:35]
    ds_read_b128 v[100:103], v120 offset:15360
    s_waitcnt vmcnt(2) lgkmcnt(5)
    v_mfma_f32_16x16x32_bf16 v[8:11], v[64:67], v[104:107], v[8:11]
    v_mfma_f32_16x16x32_bf16 v[40:43], v[68:71], v[104:107], v[40:43]
    v_mfma_f32_16x16x32_bf16 v[4:7], v[72:75], v[104:107], v[4:7]
    v_mfma_f32_16x16x32_bf16 v[36:39], v[76:79], v[104:107], v[36:39]
    v_mfma_f32_16x16x32_bf16 v[0:3], v[80:83], v[104:107], v[0:3]
    v_mfma_f32_16x16x32_bf16 v[32:35], v[84:87], v[104:107], v[32:35]
    ds_read_b128 v[104:107], v122 offset:0
    v_add_u32 v122, v124, v122
    s_waitcnt vmcnt(0) lgkmcnt(5)
    v_mfma_f32_16x16x32_bf16 v[12:15], v[64:67], v[108:111], v[12:15]
    v_mfma_f32_16x16x32_bf16 v[44:47], v[68:71], v[108:111], v[44:47]
    v_mfma_f32_16x16x32_bf16 v[8:11], v[72:75], v[108:111], v[8:11]
    v_mfma_f32_16x16x32_bf16 v[40:43], v[76:79], v[108:111], v[40:43]
    v_mfma_f32_16x16x32_bf16 v[4:7], v[80:83], v[108:111], v[4:7]
    v_mfma_f32_16x16x32_bf16 v[36:39], v[84:87], v[108:111], v[36:39]
    v_mfma_f32_16x16x32_bf16 v[0:3], v[88:91], v[108:111], v[0:3]
    v_mfma_f32_16x16x32_bf16 v[32:35], v[92:95], v[108:111], v[32:35]
    ds_read_b128 v[108:111], v121 offset:9216
    s_waitcnt lgkmcnt(5)
    v_mfma_f32_16x16x32_bf16 v[16:19], v[64:67], v[112:115], v[16:19]
    v_mfma_f32_16x16x32_bf16 v[48:51], v[68:71], v[112:115], v[48:51]
    v_mfma_f32_16x16x32_bf16 v[12:15], v[72:75], v[112:115], v[12:15]
    v_mfma_f32_16x16x32_bf16 v[44:47], v[76:79], v[112:115], v[44:47]
    v_mfma_f32_16x16x32_bf16 v[8:11], v[80:83], v[112:115], v[8:11]
    v_mfma_f32_16x16x32_bf16 v[40:43], v[84:87], v[112:115], v[40:43]
    v_mfma_f32_16x16x32_bf16 v[4:7], v[88:91], v[112:115], v[4:7]
    v_mfma_f32_16x16x32_bf16 v[36:39], v[92:95], v[112:115], v[36:39]
    ds_read_b128 v[112:115], v121 offset:10240
    s_waitcnt lgkmcnt(5)
    v_mfma_f32_16x16x32_bf16 v[20:23], v[64:67], v[116:119], v[20:23]
    v_mfma_f32_16x16x32_bf16 v[52:55], v[68:71], v[116:119], v[52:55]
    v_mfma_f32_16x16x32_bf16 v[16:19], v[72:75], v[116:119], v[16:19]
    v_mfma_f32_16x16x32_bf16 v[48:51], v[76:79], v[116:119], v[48:51]
    v_mfma_f32_16x16x32_bf16 v[12:15], v[80:83], v[116:119], v[12:15]
    v_mfma_f32_16x16x32_bf16 v[44:47], v[84:87], v[116:119], v[44:47]
    v_mfma_f32_16x16x32_bf16 v[8:11], v[88:91], v[116:119], v[8:11]
    v_mfma_f32_16x16x32_bf16 v[40:43], v[92:95], v[116:119], v[40:43]
    s_waitcnt lgkmcnt(4)
    v_mfma_f32_16x16x32_bf16 v[24:27], v[64:67], v[96:99], v[24:27]
    v_mfma_f32_16x16x32_bf16 v[56:59], v[68:71], v[96:99], v[56:59]
    v_mfma_f32_16x16x32_bf16 v[20:23], v[72:75], v[96:99], v[20:23]
    v_mfma_f32_16x16x32_bf16 v[52:55], v[76:79], v[96:99], v[52:55]
    v_mfma_f32_16x16x32_bf16 v[16:19], v[80:83], v[96:99], v[16:19]
    v_mfma_f32_16x16x32_bf16 v[48:51], v[84:87], v[96:99], v[48:51]
    v_mfma_f32_16x16x32_bf16 v[12:15], v[88:91], v[96:99], v[12:15]
    v_mfma_f32_16x16x32_bf16 v[44:47], v[92:95], v[96:99], v[44:47]
    s_waitcnt lgkmcnt(3)
    v_mfma_f32_16x16x32_bf16 v[28:31], v[64:67], v[100:103], v[28:31]
    v_mfma_f32_16x16x32_bf16 v[60:63], v[68:71], v[100:103], v[60:63]
    v_mfma_f32_16x16x32_bf16 v[24:27], v[72:75], v[100:103], v[24:27]
    v_mfma_f32_16x16x32_bf16 v[56:59], v[76:79], v[100:103], v[56:59]
    v_mfma_f32_16x16x32_bf16 v[20:23], v[80:83], v[100:103], v[20:23]
    v_mfma_f32_16x16x32_bf16 v[52:55], v[84:87], v[100:103], v[52:55]
    v_mfma_f32_16x16x32_bf16 v[16:19], v[88:91], v[100:103], v[16:19]
    v_mfma_f32_16x16x32_bf16 v[48:51], v[92:95], v[100:103], v[48:51]
    buffer_load_dwordx4 v[64:67], v125, s[12:15], s23 offen offset:0
    buffer_load_dwordx4 v[68:71], v125, s[12:15], s23 offen offset:1024
    s_waitcnt lgkmcnt(2)
    v_mfma_f32_16x16x32_bf16 v[28:31], v[72:75], v[104:107], v[28:31]
    v_mfma_f32_16x16x32_bf16 v[60:63], v[76:79], v[104:107], v[60:63]
    v_mfma_f32_16x16x32_bf16 v[24:27], v[80:83], v[104:107], v[24:27]
    v_mfma_f32_16x16x32_bf16 v[56:59], v[84:87], v[104:107], v[56:59]
    v_mfma_f32_16x16x32_bf16 v[20:23], v[88:91], v[104:107], v[20:23]
    v_mfma_f32_16x16x32_bf16 v[52:55], v[92:95], v[104:107], v[52:55]
    buffer_load_dwordx4 v[72:75], v125, s[12:15], s23 offen offset:2048
    buffer_load_dwordx4 v[76:79], v125, s[12:15], s23 offen offset:3072
    s_waitcnt lgkmcnt(1)
    v_mfma_f32_16x16x32_bf16 v[28:31], v[80:83], v[108:111], v[28:31]
    v_mfma_f32_16x16x32_bf16 v[60:63], v[84:87], v[108:111], v[60:63]
    v_mfma_f32_16x16x32_bf16 v[24:27], v[88:91], v[108:111], v[24:27]
    v_mfma_f32_16x16x32_bf16 v[56:59], v[92:95], v[108:111], v[56:59]
    buffer_load_dwordx4 v[80:83], v125, s[12:15], s26 offen offset:0
    buffer_load_dwordx4 v[84:87], v125, s[12:15], s26 offen offset:1024
    s_waitcnt lgkmcnt(0)
    v_mfma_f32_16x16x32_bf16 v[28:31], v[88:91], v[112:115], v[28:31]
    v_mfma_f32_16x16x32_bf16 v[60:63], v[92:95], v[112:115], v[60:63]
    buffer_load_dwordx4 v[88:91], v125, s[12:15], s26 offen offset:2048
    buffer_load_dwordx4 v[92:95], v125, s[12:15], s26 offen offset:3072
    s_add_u32 s23, s23, 57344
    s_add_u32 s26, s26, 57344
    s_barrier
    s_branch L_conv2_kernel_mloop1
L_conv2_kernel_mlast1:
    v_and_b32 v125, 15, v127
    v_and_b32 v126, 7, v127
    v_lshlrev_b32 v126, 4, v126
    v_lshl_add_u32 v125, v125, 7, v126
    v_lshrrev_b32 v126, 4, v127
    v_lshl_add_u32 v125, v126, 11, v125
    s_lshl_b32 s36, s20, 14
    s_add_u32 s37, s36, 8192
    v_add_u32 v126, s37, v125
    v_add_u32 v125, s36, v125
    ds_read_b128 v[96:99], v120 offset:8192
    ds_read_b128 v[100:103], v120 offset:9216
    ds_read_b128 v[104:107], v120 offset:10240
    ds_read_b128 v[108:111], v120 offset:11264
    ds_read_b128 v[112:115], v120 offset:12288
    ds_read_b128 v[116:119], v120 offset:13312
    s_waitcnt vmcnt(6) lgkmcnt(5)
    v_mfma_f32_16x16x32_bf16 v[0:3], v[64:67], v[96:99], v[0:3]
    v_mfma_f32_16x16x32_bf16 v[32:35], v[68:71], v[96:99], v[32:35]
    ds_read_b128 v[96:99], v120 offset:14336
    s_waitcnt vmcnt(4) lgkmcnt(5)
    v_mfma_f32_16x16x32_bf16 v[4:7], v[64:67], v[100:103], v[4:7]
    v_mfma_f32_16x16x32_bf16 v[36:39], v[68:71], v[100:103], v[36:39]
    v_mfma_f32_16x16x32_bf16 v[0:3], v[72:75], v[100:103], v[0:3]
    v_mfma_f32_16x16x32_bf16 v[32:35], v[76:79], v[100:103], v[32:35]
    ds_read_b128 v[100:103], v120 offset:15360
    s_waitcnt vmcnt(2) lgkmcnt(5)
    v_mfma_f32_16x16x32_bf16 v[8:11], v[64:67], v[104:107], v[8:11]
    v_mfma_f32_16x16x32_bf16 v[40:43], v[68:71], v[104:107], v[40:43]
    v_mfma_f32_16x16x32_bf16 v[4:7], v[72:75], v[104:107], v[4:7]
    v_mfma_f32_16x16x32_bf16 v[36:39], v[76:79], v[104:107], v[36:39]
    v_mfma_f32_16x16x32_bf16 v[0:3], v[80:83], v[104:107], v[0:3]
    v_mfma_f32_16x16x32_bf16 v[32:35], v[84:87], v[104:107], v[32:35]
    ds_read_b128 v[104:107], v122 offset:0
    s_waitcnt vmcnt(0) lgkmcnt(5)
    v_mfma_f32_16x16x32_bf16 v[12:15], v[64:67], v[108:111], v[12:15]
    v_mfma_f32_16x16x32_bf16 v[44:47], v[68:71], v[108:111], v[44:47]
    v_mfma_f32_16x16x32_bf16 v[8:11], v[72:75], v[108:111], v[8:11]
    v_mfma_f32_16x16x32_bf16 v[40:43], v[76:79], v[108:111], v[40:43]
    v_mfma_f32_16x16x32_bf16 v[4:7], v[80:83], v[108:111], v[4:7]
    v_mfma_f32_16x16x32_bf16 v[36:39], v[84:87], v[108:111], v[36:39]
    v_mfma_f32_16x16x32_bf16 v[0:3], v[88:91], v[108:111], v[0:3]
    v_mfma_f32_16x16x32_bf16 v[32:35], v[92:95], v[108:111], v[32:35]
    ds_read_b128 v[108:111], v121 offset:9216
    s_waitcnt lgkmcnt(5)
    v_mfma_f32_16x16x32_bf16 v[16:19], v[64:67], v[112:115], v[16:19]
    v_mfma_f32_16x16x32_bf16 v[48:51], v[68:71], v[112:115], v[48:51]
    v_mfma_f32_16x16x32_bf16 v[12:15], v[72:75], v[112:115], v[12:15]
    v_mfma_f32_16x16x32_bf16 v[44:47], v[76:79], v[112:115], v[44:47]
    v_mfma_f32_16x16x32_bf16 v[8:11], v[80:83], v[112:115], v[8:11]
    v_mfma_f32_16x16x32_bf16 v[40:43], v[84:87], v[112:115], v[40:43]
    v_mfma_f32_16x16x32_bf16 v[4:7], v[88:91], v[112:115], v[4:7]
    v_mfma_f32_16x16x32_bf16 v[36:39], v[92:95], v[112:115], v[36:39]
    ds_read_b128 v[112:115], v121 offset:10240
    v_xor_b32 v123, 0, v125
    ds_write_b128 v123, v[0:3]
    s_waitcnt lgkmcnt(6)
    v_mfma_f32_16x16x32_bf16 v[20:23], v[64:67], v[116:119], v[20:23]
    v_mfma_f32_16x16x32_bf16 v[52:55], v[68:71], v[116:119], v[52:55]
    v_mfma_f32_16x16x32_bf16 v[16:19], v[72:75], v[116:119], v[16:19]
    v_mfma_f32_16x16x32_bf16 v[48:51], v[76:79], v[116:119], v[48:51]
    v_mfma_f32_16x16x32_bf16 v[12:15], v[80:83], v[116:119], v[12:15]
    v_mfma_f32_16x16x32_bf16 v[44:47], v[84:87], v[116:119], v[44:47]
    v_mfma_f32_16x16x32_bf16 v[8:11], v[88:91], v[116:119], v[8:11]
    v_mfma_f32_16x16x32_bf16 v[40:43], v[92:95], v[116:119], v[40:43]
    v_xor_b32 v124, 16, v125
    ds_write_b128 v124, v[4:7]
    s_waitcnt lgkmcnt(2)
    v_mfma_f32_16x16x32_bf16 v[24:27], v[64:67], v[96:99], v[24:27]
    v_mfma_f32_16x16x32_bf16 v[56:59], v[68:71], v[96:99], v[56:59]
    v_mfma_f32_16x16x32_bf16 v[20:23], v[72:75], v[96:99], v[20:23]
    v_mfma_f32_16x16x32_bf16 v[52:55], v[76:79], v[96:99], v[52:55]
    v_mfma_f32_16x16x32_bf16 v[16:19], v[80:83], v[96:99], v[16:19]
    v_mfma_f32_16x16x32_bf16 v[48:51], v[84:87], v[96:99], v[48:51]
    v_mfma_f32_16x16x32_bf16 v[12:15], v[88:91], v[96:99], v[12:15]
    v_mfma_f32_16x16x32_bf16 v[44:47], v[92:95], v[96:99], v[44:47]
    v_xor_b32 v123, 32, v125
    ds_write_b128 v123, v[8:11]
    v_xor_b32 v124, 0, v126
    ds_write_b128 v124, v[32:35]
    v_mfma_f32_16x16x32_bf16 v[28:31], v[64:67], v[100:103], v[28:31]
    v_mfma_f32_16x16x32_bf16 v[60:63], v[68:71], v[100:103], v[60:63]
    v_mfma_f32_16x16x32_bf16 v[24:27], v[72:75], v[100:103], v[24:27]
    v_mfma_f32_16x16x32_bf16 v[56:59], v[76:79], v[100:103], v[56:59]
    v_mfma_f32_16x16x32_bf16 v[20:23], v[80:83], v[100:103], v[20:23]
    v_mfma_f32_16x16x32_bf16 v[52:55], v[84:87], v[100:103], v[52:55]
    v_mfma_f32_16x16x32_bf16 v[16:19], v[88:91], v[100:103], v[16:19]
    v_mfma_f32_16x16x32_bf16 v[48:51], v[92:95], v[100:103], v[48:51]
    v_xor_b32 v123, 16, v126
    ds_write_b128 v123, v[36:39]
    v_xor_b32 v124, 32, v126
    ds_write_b128 v124, v[40:43]
    v_mfma_f32_16x16x32_bf16 v[28:31], v[72:75], v[104:107], v[28:31]
    v_mfma_f32_16x16x32_bf16 v[60:63], v[76:79], v[104:107], v[60:63]
    v_mfma_f32_16x16x32_bf16 v[24:27], v[80:83], v[104:107], v[24:27]
    v_mfma_f32_16x16x32_bf16 v[56:59], v[84:87], v[104:107], v[56:59]
    v_mfma_f32_16x16x32_bf16 v[20:23], v[88:91], v[104:107], v[20:23]
    v_mfma_f32_16x16x32_bf16 v[52:55], v[92:95], v[104:107], v[52:55]
    v_xor_b32 v124, 48, v125
    ds_write_b128 v124, v[12:15]
    v_xor_b32 v123, 48, v126
    ds_write_b128 v123, v[44:47]
    v_mfma_f32_16x16x32_bf16 v[28:31], v[80:83], v[108:111], v[28:31]
    v_mfma_f32_16x16x32_bf16 v[60:63], v[84:87], v[108:111], v[60:63]
    v_mfma_f32_16x16x32_bf16 v[24:27], v[88:91], v[108:111], v[24:27]
    v_mfma_f32_16x16x32_bf16 v[56:59], v[92:95], v[108:111], v[56:59]
    v_xor_b32 v123, 64, v125
    ds_write_b128 v123, v[16:19]
    v_xor_b32 v124, 64, v126
    ds_write_b128 v124, v[48:51]
    v_mfma_f32_16x16x32_bf16 v[28:31], v[88:91], v[112:115], v[28:31]
    v_mfma_f32_16x16x32_bf16 v[60:63], v[92:95], v[112:115], v[60:63]
    v_xor_b32 v124, 80, v125
    ds_write_b128 v124, v[20:23]
    v_xor_b32 v123, 80, v126
    ds_write_b128 v123, v[52:55]
    s_nop 7
    v_xor_b32 v123, 96, v125
    ds_write_b128 v123, v[24:27]
    v_xor_b32 v124, 96, v126
    ds_write_b128 v124, v[56:59]
    v_xor_b32 v124, 112, v125
    ds_write_b128 v124, v[28:31]
    v_xor_b32 v123, 112, v126
    s_waitcnt lgkmcnt(8)
    ds_write_b128 v123, v[60:63]
    s_setprio 0
    s_branch L_conv2_kernel_epi
L_conv2_kernel_m2:
    s_mul_i32 s37, s38, 2176
    s_add_u32 s37, s37, 98304
    v_add_u32 v116, s37, v8
    v_add_u32 v118, s37, v9
    v_add_u32 v117, 104832, v8
    s_cmp_eq_u32 s38, 0
    s_cbranch_scc1 L_conv2_kernel_hh0
    v_add_u32 v117, 98304, v9
L_conv2_kernel_hh0:
    s_lshl_b32 s37, s38, 12
    s_add_u32 s37, s37, s43
    s_add_u32 s37, s37, 49152
    v_lshl_add_u32 v119, v127, 4, s37
    v_mov_b32 v0, 0
    v_mov_b32 v1, 0
    v_mov_b32 v2, 0
    v_mov_b32 v3, 0
    v_mov_b32 v4, 0
    v_mov_b32 v5, 0
    v_mov_b32 v6, 0
    v_mov_b32 v7, 0
    v_mov_b32 v8, 0
    v_mov_b32 v9, 0
    v_mov_b32 v10, 0
    v_mov_b32 v11, 0
    v_mov_b32 v12, 0
    v_mov_b32 v13, 0
    v_mov_b32 v14, 0
    v_mov_b32 v15, 0
    v_mov_b32 v16, 0
    v_mov_b32 v17, 0
    v_mov_b32 v18, 0
    v_mov_b32 v19, 0
    v_mov_b32 v20, 0
    v_mov_b32 v21, 0
    v_mov_b32 v22, 0
    v_mov_b32 v23, 0
    v_mov_b32 v24, 0
    v_mov_b32 v25, 0
    v_mov_b32 v26, 0
    v_mov_b32 v27, 0
    v_mov_b32 v28, 0
    v_mov_b32 v29, 0
    v_mov_b32 v30, 0
    v_mov_b32 v31, 0
    v_mov_b32 v32, 0
    v_mov_b32 v33, 0
    v_mov_b32 v34, 0
    v_mov_b32 v35, 0
    v_mov_b32 v36, 0
    v_mov_b32 v37, 0
    v_mov_b32 v38, 0
    v_mov_b32 v39, 0
    v_mov_b32 v40, 0
    v_mov_b32 v41, 0
    v_mov_b32 v42, 0
    v_mov_b32 v43, 0
    v_mov_b32 v44, 0
    v_mov_b32 v45, 0
    v_mov_b32 v46, 0
    v_mov_b32 v47, 0
    v_mov_b32 v48, 0
    v_mov_b32 v49, 0
    v_mov_b32 v50, 0
    v_mov_b32 v51, 0
    v_mov_b32 v52, 0
    v_mov_b32 v53, 0
    v_mov_b32 v54, 0
    v_mov_b32 v55, 0
    v_mov_b32 v56, 0
    v_mov_b32 v57, 0
    v_mov_b32 v58, 0
    v_mov_b32 v59, 0
    v_mov_b32 v60, 0
    v_mov_b32 v61, 0
    v_mov_b32 v62, 0
    v_mov_b32 v63, 0
    s_barrier
    buffer_load_dwordx4 v[96:99], v108, s[8:11], 0 offen
    buffer_load_dwordx4 v[100:103], v109, s[8:11], 0 offen
    buffer_load_dwordx4 v[104:107], v110, s[8:11], 0 offen
    s_mov_b32 s23, 0
    s_mov_b32 s26, 4096
    buffer_load_dwordx4 v[64:67], v125, s[12:15], s23 offen offset:0
    buffer_load_dwordx4 v[68:71], v125, s[12:15], s23 offen offset:2048
    buffer_load_dwordx4 v[80:83], v119, s[12:15], s23 offen offset:0
    buffer_load_dwordx4 v[72:75], v125, s[12:15], s26 offen offset:0
    buffer_load_dwordx4 v[84:87], v119, s[12:15], s23 offen offset:2048
    buffer_load_dwordx4 v[76:79], v125, s[12:15], s26 offen offset:2048
    s_mov_b32 s23, 57344
    s_mov_b32 s26, 61440
    s_waitcnt vmcnt(6)
    v_lshlrev_b32 v108, 16, v96
    v_and_b32 v111, s25, v96
    v_lshlrev_b32 v109, 16, v100
    v_and_b32 v112, s25, v100
    v_lshlrev_b32 v110, 16, v104
    v_and_b32 v113, s25, v104
    v_mul_f32 v114, s44, v108
    v_mul_f32 v115, s44, v111
    v_fmac_f32 v114, s45, v109
    v_fmac_f32 v115, s45, v112
    v_fmac_f32 v114, s46, v110
    v_fmac_f32 v115, s46, v113
    v_cvt_pk_bf16_f32 v96, v114, v115
    v_lshlrev_b32 v108, 16, v97
    v_and_b32 v111, s25, v97
    v_lshlrev_b32 v109, 16, v101
    v_and_b32 v112, s25, v101
    v_lshlrev_b32 v110, 16, v105
    v_and_b32 v113, s25, v105
    v_mul_f32 v114, s44, v108
    v_mul_f32 v115, s44, v111
    v_fmac_f32 v114, s45, v109
    v_fmac_f32 v115, s45, v112
    v_fmac_f32 v114, s46, v110
    v_fmac_f32 v115, s46, v113
    v_cvt_pk_bf16_f32 v97, v114, v115
    v_lshlrev_b32 v108, 16, v98
    v_and_b32 v111, s25, v98
    v_lshlrev_b32 v109, 16, v102
    v_and_b32 v112, s25, v102
    v_lshlrev_b32 v110, 16, v106
    v_and_b32 v113, s25, v106
    v_mul_f32 v114, s44, v108
    v_mul_f32 v115, s44, v111
    v_fmac_f32 v114, s45, v109
    v_fmac_f32 v115, s45, v112
    v_fmac_f32 v114, s46, v110
    v_fmac_f32 v115, s46, v113
    v_cvt_pk_bf16_f32 v98, v114, v115
    v_lshlrev_b32 v108, 16, v99
    v_and_b32 v111, s25, v99
    v_lshlrev_b32 v109, 16, v103
    v_and_b32 v112, s25, v103
    v_lshlrev_b32 v110, 16, v107
    v_and_b32 v113, s25, v107
    v_mul_f32 v114, s44, v108
    v_mul_f32 v115, s44, v111
    v_fmac_f32 v114, s45, v109
    v_fmac_f32 v115, s45, v112
    v_fmac_f32 v114, s46, v110
    v_fmac_f32 v115, s46, v113
    v_cvt_pk_bf16_f32 v99, v114, v115
    ds_write_b128 v126, v[96:99]
    v_and_b32 v126, 15, v127
    v_lshlrev_b32 v126, 2, v126
    v_add_u32 v126, 99328, v126
    ds_write_b32 v126, v0
    ds_write_b32 v126, v0 offset:8704
    s_waitcnt lgkmcnt(0)
    s_barrier
    s_mov_b32 s22, 4
    s_setprio 2
L_conv2_kernel_mloop2:
    ds_read_b128 v[88:91], v120 offset:0
    ds_read_b128 v[92:95], v120 offset:1024
    ds_read_b128 v[96:99], v116 offset:0
    ds_read_b128 v[100:103], v120 offset:2048
    ds_read_b128 v[104:107], v116 offset:1088
    ds_read_b128 v[108:111], v120 offset:3072
    ds_read_b128 v[112:115], v116 offset:2176
    s_waitcnt vmcnt(5) lgkmcnt(6)
    v_mfma_f32_16x16x32_bf16 v[0:3], v[64:67], v[88:91], v[0:3]
    ds_read_b128 v[88:91], v120 offset:4096
    s_waitcnt vmcnt(4) lgkmcnt(6)
    v_mfma_f32_16x16x32_bf16 v[4:7], v[64:67], v[92:95], v[4:7]
    v_mfma_f32_16x16x32_bf16 v[0:3], v[68:71], v[92:95], v[0:3]
    ds_read_b128 v[92:95], v116 offset:3264
    s_waitcnt vmcnt(3) lgkmcnt(6)
    v_mfma_f32_16x16x32_bf16 v[32:35], v[80:83], v[96:99], v[32:35]
    ds_read_b128 v[96:99], v120 offset:5120
    s_waitcnt vmcnt(2) lgkmcnt(6)
    v_mfma_f32_16x16x32_bf16 v[8:11], v[64:67], v[100:103], v[8:11]
    v_mfma_f32_16x16x32_bf16 v[4:7], v[68:71], v[100:103], v[4:7]
    v_mfma_f32_16x16x32_bf16 v[0:3], v[72:75], v[100:103], v[0:3]
    ds_read_b128 v[100:103], v116 offset:4352
    s_waitcnt vmcnt(1) lgkmcnt(6)
    v_mfma_f32_16x16x32_bf16 v[36:39], v[80:83], v[104:107], v[36:39]
    v_mfma_f32_16x16x32_bf16 v[32:35], v[84:87], v[104:107], v[32:35]
    ds_read_b128 v[104:107], v120 offset:6144
    s_waitcnt vmcnt(0) lgkmcnt(6)
    v_mfma_f32_16x16x32_bf16 v[12:15], v[64:67], v[108:111], v[12:15]
    v_mfma_f32_16x16x32_bf16 v[8:11], v[68:71], v[108:111], v[8:11]
    v_mfma_f32_16x16x32_bf16 v[4:7], v[72:75], v[108:111], v[4:7]
    v_mfma_f32_16x16x32_bf16 v[0:3], v[76:79], v[108:111], v[0:3]
    ds_read_b128 v[108:111], v116 offset:5440
    s_waitcnt lgkmcnt(6)
    v_mfma_f32_16x16x32_bf16 v[40:43], v[80:83], v[112:115], v[40:43]
    v_mfma_f32_16x16x32_bf16 v[36:39], v[84:87], v[112:115], v[36:39]
    ds_read_b128 v[112:115], v120 offset:7168
    s_waitcnt lgkmcnt(6)
    v_mfma_f32_16x16x32_bf16 v[16:19], v[64:67], v[88:91], v[16:19]
    v_mfma_f32_16x16x32_bf16 v[12:15], v[68:71], v[88:91], v[12:15]
    v_mfma_f32_16x16x32_bf16 v[8:11], v[72:75], v[88:91], v[8:11]
    v_mfma_f32_16x16x32_bf16 v[4:7], v[76:79], v[88:91], v[4:7]
    ds_read_b128 v[88:91], v117 offset:0
    s_waitcnt lgkmcnt(6)
    v_mfma_f32_16x16x32_bf16 v[44:47], v[80:83], v[92:95], v[44:47]
    v_mfma_f32_16x16x32_bf16 v[40:43], v[84:87], v[92:95], v[40:43]
    ds_read_b128 v[92:95], v122 offset:0
    v_add_u32 v122, v123, v122
    s_waitcnt lgkmcnt(6)
    v_mfma_f32_16x16x32_bf16 v[20:23], v[64:67], v[96:99], v[20:23]
    v_mfma_f32_16x16x32_bf16 v[16:19], v[68:71], v[96:99], v[16:19]
    v_mfma_f32_16x16x32_bf16 v[12:15], v[72:75], v[96:99], v[12:15]
    v_mfma_f32_16x16x32_bf16 v[8:11], v[76:79], v[96:99], v[8:11]
    ds_read_b128 v[96:99], v117 offset:1088
    s_waitcnt lgkmcnt(6)
    v_mfma_f32_16x16x32_bf16 v[48:51], v[80:83], v[100:103], v[48:51]
    v_mfma_f32_16x16x32_bf16 v[44:47], v[84:87], v[100:103], v[44:47]
    ds_read_b128 v[100:103], v121 offset:1024
    s_waitcnt lgkmcnt(6)
    v_mfma_f32_16x16x32_bf16 v[24:27], v[64:67], v[104:107], v[24:27]
    v_mfma_f32_16x16x32_bf16 v[20:23], v[68:71], v[104:107], v[20:23]
    v_mfma_f32_16x16x32_bf16 v[16:19], v[72:75], v[104:107], v[16:19]
    v_mfma_f32_16x16x32_bf16 v[12:15], v[76:79], v[104:107], v[12:15]
    ds_read_b128 v[104:107], v118 offset:0
    s_waitcnt lgkmcnt(6)
    v_mfma_f32_16x16x32_bf16 v[52:55], v[80:83], v[108:111], v[52:55]
    v_mfma_f32_16x16x32_bf16 v[48:51], v[84:87], v[108:111], v[48:51]
    ds_read_b128 v[108:111], v121 offset:2048
    s_waitcnt lgkmcnt(6)
    v_mfma_f32_16x16x32_bf16 v[28:31], v[64:67], v[112:115], v[28:31]
    v_mfma_f32_16x16x32_bf16 v[24:27], v[68:71], v[112:115], v[24:27]
    v_mfma_f32_16x16x32_bf16 v[20:23], v[72:75], v[112:115], v[20:23]
    v_mfma_f32_16x16x32_bf16 v[16:19], v[76:79], v[112:115], v[16:19]
    buffer_load_dwordx4 v[64:67], v125, s[12:15], s23 offen offset:0
    s_waitcnt lgkmcnt(5)
    v_mfma_f32_16x16x32_bf16 v[56:59], v[80:83], v[88:91], v[56:59]
    v_mfma_f32_16x16x32_bf16 v[52:55], v[84:87], v[88:91], v[52:55]
    s_waitcnt lgkmcnt(0)
    s_barrier
    v_mfma_f32_16x16x32_bf16 v[28:31], v[68:71], v[92:95], v[28:31]
    v_mfma_f32_16x16x32_bf16 v[24:27], v[72:75], v[92:95], v[24:27]
    v_mfma_f32_16x16x32_bf16 v[20:23], v[76:79], v[92:95], v[20:23]
    buffer_load_dwordx4 v[68:71], v125, s[12:15], s23 offen offset:2048
    v_mfma_f32_16x16x32_bf16 v[60:63], v[80:83], v[96:99], v[60:63]
    v_mfma_f32_16x16x32_bf16 v[56:59], v[84:87], v[96:99], v[56:59]
    buffer_load_dwordx4 v[80:83], v119, s[12:15], s23 offen offset:0
    v_mfma_f32_16x16x32_bf16 v[28:31], v[72:75], v[100:103], v[28:31]
    v_mfma_f32_16x16x32_bf16 v[24:27], v[76:79], v[100:103], v[24:27]
    buffer_load_dwordx4 v[72:75], v125, s[12:15], s26 offen offset:0
    v_mfma_f32_16x16x32_bf16 v[60:63], v[84:87], v[104:107], v[60:63]
    buffer_load_dwordx4 v[84:87], v119, s[12:15], s23 offen offset:2048
    v_mfma_f32_16x16x32_bf16 v[28:31], v[76:79], v[108:111], v[28:31]
    buffer_load_dwordx4 v[76:79], v125, s[12:15], s26 offen offset:2048
    s_add_u32 s23, s23, 57344
    s_add_u32 s26, s26, 57344
    s_sub_u32 s22, s22, 1
    s_cmp_eq_u32 s22, 0
    s_cbranch_scc1 L_conv2_kernel_mlast2
    ds_read_b128 v[88:91], v120 offset:8192
    ds_read_b128 v[92:95], v120 offset:9216
    ds_read_b128 v[96:99], v116 offset:8704
    ds_read_b128 v[100:103], v120 offset:10240
    ds_read_b128 v[104:107], v116 offset:9792
    ds_read_b128 v[108:111], v120 offset:11264
    ds_read_b128 v[112:115], v116 offset:10880
    s_waitcnt vmcnt(5) lgkmcnt(6)
    v_mfma_f32_16x16x32_bf16 v[0:3], v[64:67], v[88:91], v[0:3]
    ds_read_b128 v[88:91], v120 offset:12288
    s_waitcnt vmcnt(4) lgkmcnt(6)
    v_mfma_f32_16x16x32_bf16 v[4:7], v[64:67], v[92:95], v[4:7]
    v_mfma_f32_16x16x32_bf16 v[0:3], v[68:71], v[92:95], v[0:3]
    ds_read_b128 v[92:95], v116 offset:11968
    s_waitcnt vmcnt(3) lgkmcnt(6)
    v_mfma_f32_16x16x32_bf16 v[32:35], v[80:83], v[96:99], v[32:35]
    ds_read_b128 v[96:99], v120 offset:13312
    s_waitcnt vmcnt(2) lgkmcnt(6)
    v_mfma_f32_16x16x32_bf16 v[8:11], v[64:67], v[100:103], v[8:11]
    v_mfma_f32_16x16x32_bf16 v[4:7], v[68:71], v[100:103], v[4:7]
    v_mfma_f32_16x16x32_bf16 v[0:3], v[72:75], v[100:103], v[0:3]
    ds_read_b128 v[100:103], v116 offset:13056
    s_waitcnt vmcnt(1) lgkmcnt(6)
    v_mfma_f32_16x16x32_bf16 v[36:39], v[80:83], v[104:107], v[36:39]
    v_mfma_f32_16x16x32_bf16 v[32:35], v[84:87], v[104:107], v[32:35]
    ds_read_b128 v[104:107], v120 offset:14336
    s_waitcnt vmcnt(0) lgkmcnt(6)
    v_mfma_f32_16x16x32_bf16 v[12:15], v[64:67], v[108:111], v[12:15]
    v_mfma_f32_16x16x32_bf16 v[8:11], v[68:71], v[108:111], v[8:11]
    v_mfma_f32_16x16x32_bf16 v[4:7], v[72:75], v[108:111], v[4:7]
    v_mfma_f32_16x16x32_bf16 v[0:3], v[76:79], v[108:111], v[0:3]
    ds_read_b128 v[108:111], v116 offset:14144
    s_waitcnt lgkmcnt(6)
    v_mfma_f32_16x16x32_bf16 v[40:43], v[80:83], v[112:115], v[40:43]
    v_mfma_f32_16x16x32_bf16 v[36:39], v[84:87], v[112:115], v[36:39]
    ds_read_b128 v[112:115], v120 offset:15360
    s_waitcnt lgkmcnt(6)
    v_mfma_f32_16x16x32_bf16 v[16:19], v[64:67], v[88:91], v[16:19]
    v_mfma_f32_16x16x32_bf16 v[12:15], v[68:71], v[88:91], v[12:15]
    v_mfma_f32_16x16x32_bf16 v[8:11], v[72:75], v[88:91], v[8:11]
    v_mfma_f32_16x16x32_bf16 v[4:7], v[76:79], v[88:91], v[4:7]
    ds_read_b128 v[88:91], v117 offset:8704
    s_waitcnt lgkmcnt(6)
    v_mfma_f32_16x16x32_bf16 v[44:47], v[80:83], v[92:95], v[44:47]
    v_mfma_f32_16x16x32_bf16 v[40:43], v[84:87], v[92:95], v[40:43]
    ds_read_b128 v[92:95], v122 offset:0
    v_add_u32 v122, v124, v122
    s_waitcnt lgkmcnt(6)
    v_mfma_f32_16x16x32_bf16 v[20:23], v[64:67], v[96:99], v[20:23]
    v_mfma_f32_16x16x32_bf16 v[16:19], v[68:71], v[96:99], v[16:19]
    v_mfma_f32_16x16x32_bf16 v[12:15], v[72:75], v[96:99], v[12:15]
    v_mfma_f32_16x16x32_bf16 v[8:11], v[76:79], v[96:99], v[8:11]
    ds_read_b128 v[96:99], v117 offset:9792
    s_waitcnt lgkmcnt(6)
    v_mfma_f32_16x16x32_bf16 v[48:51], v[80:83], v[100:103], v[48:51]
    v_mfma_f32_16x16x32_bf16 v[44:47], v[84:87], v[100:103], v[44:47]
    ds_read_b128 v[100:103], v121 offset:9216
    s_waitcnt lgkmcnt(6)
    v_mfma_f32_16x16x32_bf16 v[24:27], v[64:67], v[104:107], v[24:27]
    v_mfma_f32_16x16x32_bf16 v[20:23], v[68:71], v[104:107], v[20:23]
    v_mfma_f32_16x16x32_bf16 v[16:19], v[72:75], v[104:107], v[16:19]
    v_mfma_f32_16x16x32_bf16 v[12:15], v[76:79], v[104:107], v[12:15]
    ds_read_b128 v[104:107], v118 offset:8704
    s_waitcnt lgkmcnt(6)
    v_mfma_f32_16x16x32_bf16 v[52:55], v[80:83], v[108:111], v[52:55]
    v_mfma_f32_16x16x32_bf16 v[48:51], v[84:87], v[108:111], v[48:51]
    ds_read_b128 v[108:111], v121 offset:10240
    s_waitcnt lgkmcnt(6)
    v_mfma_f32_16x16x32_bf16 v[28:31], v[64:67], v[112:115], v[28:31]
    v_mfma_f32_16x16x32_bf16 v[24:27], v[68:71], v[112:115], v[24:27]
    v_mfma_f32_16x16x32_bf16 v[20:23], v[72:75], v[112:115], v[20:23]
    v_mfma_f32_16x16x32_bf16 v[16:19], v[76:79], v[112:115], v[16:19]
    buffer_load_dwordx4 v[64:67], v125, s[12:15], s23 offen offset:0
    s_waitcnt lgkmcnt(5)
    v_mfma_f32_16x16x32_bf16 v[56:59], v[80:83], v[88:91], v[56:59]
    v_mfma_f32_16x16x32_bf16 v[52:55], v[84:87], v[88:91], v[52:55]
    s_waitcnt lgkmcnt(0)
    s_barrier
    v_mfma_f32_16x16x32_bf16 v[28:31], v[68:71], v[92:95], v[28:31]
    v_mfma_f32_16x16x32_bf16 v[24:27], v[72:75], v[92:95], v[24:27]
    v_mfma_f32_16x16x32_bf16 v[20:23], v[76:79], v[92:95], v[20:23]
    buffer_load_dwordx4 v[68:71], v125, s[12:15], s23 offen offset:2048
    v_mfma_f32_16x16x32_bf16 v[60:63], v[80:83], v[96:99], v[60:63]
    v_mfma_f32_16x16x32_bf16 v[56:59], v[84:87], v[96:99], v[56:59]
    buffer_load_dwordx4 v[80:83], v119, s[12:15], s23 offen offset:0
    v_mfma_f32_16x16x32_bf16 v[28:31], v[72:75], v[100:103], v[28:31]
    v_mfma_f32_16x16x32_bf16 v[24:27], v[76:79], v[100:103], v[24:27]
    buffer_load_dwordx4 v[72:75], v125, s[12:15], s26 offen offset:0
    v_mfma_f32_16x16x32_bf16 v[60:63], v[84:87], v[104:107], v[60:63]
    buffer_load_dwordx4 v[84:87], v119, s[12:15], s23 offen offset:2048
    v_mfma_f32_16x16x32_bf16 v[28:31], v[76:79], v[108:111], v[28:31]
    buffer_load_dwordx4 v[76:79], v125, s[12:15], s26 offen offset:2048
    s_add_u32 s23, s23, 57344
    s_add_u32 s26, s26, 57344
    s_branch L_conv2_kernel_mloop2
L_conv2_kernel_mlast2:
    v_and_b32 v125, 15, v127
    v_and_b32 v126, 7, v127
    v_lshlrev_b32 v126, 4, v126
    v_lshl_add_u32 v125, v125, 7, v126
    v_lshrrev_b32 v126, 4, v127
    v_lshl_add_u32 v125, v126, 11, v125
    s_mov_b32 s36, 65536
    s_cmp_eq_u32 s32, 1
    s_cselect_b32 s36, 121856, s36
    s_cmp_eq_u32 s32, 2
    s_cselect_b32 s36, 81920, s36
    s_cmp_eq_u32 s32, 3
    s_cselect_b32 s36, 130048, s36
    s_mov_b32 s37, 98304
    s_cmp_eq_u32 s32, 1
    s_cselect_b32 s37, 138240, s37
    s_cmp_eq_u32 s32, 2
    s_cselect_b32 s37, 146432, s37
    s_cmp_eq_u32 s32, 3
    s_cselect_b32 s37, 154624, s37
    v_add_u32 v126, s37, v125
    v_add_u32 v125, s36, v125
    ds_read_b128 v[88:91], v120 offset:8192
    ds_read_b128 v[92:95], v120 offset:9216
    ds_read_b128 v[96:99], v116 offset:8704
    ds_read_b128 v[100:103], v120 offset:10240
    ds_read_b128 v[104:107], v116 offset:9792
    ds_read_b128 v[108:111], v120 offset:11264
    ds_read_b128 v[112:115], v116 offset:10880
    s_waitcnt vmcnt(5) lgkmcnt(6)
    v_mfma_f32_16x16x32_bf16 v[0:3], v[64:67], v[88:91], v[0:3]
    ds_read_b128 v[88:91], v120 offset:12288
    s_waitcnt vmcnt(4) lgkmcnt(6)
    v_mfma_f32_16x16x32_bf16 v[4:7], v[64:67], v[92:95], v[4:7]
    v_mfma_f32_16x16x32_bf16 v[0:3], v[68:71], v[92:95], v[0:3]
    ds_read_b128 v[92:95], v116 offset:11968
    s_waitcnt vmcnt(3) lgkmcnt(6)
    v_mfma_f32_16x16x32_bf16 v[32:35], v[80:83], v[96:99], v[32:35]
    ds_read_b128 v[96:99], v120 offset:13312
    s_waitcnt vmcnt(2) lgkmcnt(6)
    v_mfma_f32_16x16x32_bf16 v[8:11], v[64:67], v[100:103], v[8:11]
    v_mfma_f32_16x16x32_bf16 v[4:7], v[68:71], v[100:103], v[4:7]
    v_mfma_f32_16x16x32_bf16 v[0:3], v[72:75], v[100:103], v[0:3]
    ds_read_b128 v[100:103], v116 offset:13056
    s_waitcnt vmcnt(1) lgkmcnt(6)
    v_mfma_f32_16x16x32_bf16 v[36:39], v[80:83], v[104:107], v[36:39]
    v_mfma_f32_16x16x32_bf16 v[32:35], v[84:87], v[104:107], v[32:35]
    ds_read_b128 v[104:107], v120 offset:14336
    s_waitcnt vmcnt(0) lgkmcnt(6)
    v_mfma_f32_16x16x32_bf16 v[12:15], v[64:67], v[108:111], v[12:15]
    v_mfma_f32_16x16x32_bf16 v[8:11], v[68:71], v[108:111], v[8:11]
    v_mfma_f32_16x16x32_bf16 v[4:7], v[72:75], v[108:111], v[4:7]
    v_mfma_f32_16x16x32_bf16 v[0:3], v[76:79], v[108:111], v[0:3]
    ds_read_b128 v[108:111], v116 offset:14144
    s_waitcnt lgkmcnt(6)
    v_mfma_f32_16x16x32_bf16 v[40:43], v[80:83], v[112:115], v[40:43]
    v_mfma_f32_16x16x32_bf16 v[36:39], v[84:87], v[112:115], v[36:39]
    ds_read_b128 v[112:115], v120 offset:15360
    s_waitcnt lgkmcnt(6)
    v_mfma_f32_16x16x32_bf16 v[16:19], v[64:67], v[88:91], v[16:19]
    v_mfma_f32_16x16x32_bf16 v[12:15], v[68:71], v[88:91], v[12:15]
    v_mfma_f32_16x16x32_bf16 v[8:11], v[72:75], v[88:91], v[8:11]
    v_mfma_f32_16x16x32_bf16 v[4:7], v[76:79], v[88:91], v[4:7]
    ds_read_b128 v[88:91], v117 offset:8704
    v_xor_b32 v124, 0, v126
    ds_write_b128 v124, v[32:35]
    s_waitcnt lgkmcnt(7)
    v_mfma_f32_16x16x32_bf16 v[44:47], v[80:83], v[92:95], v[44:47]
    v_mfma_f32_16x16x32_bf16 v[40:43], v[84:87], v[92:95], v[40:43]
    ds_read_b128 v[92:95], v122 offset:0
    v_xor_b32 v123, 0, v125
    ds_write_b128 v123, v[0:3]
    s_waitcnt lgkmcnt(8)
    v_mfma_f32_16x16x32_bf16 v[20:23], v[64:67], v[96:99], v[20:23]
    v_mfma_f32_16x16x32_bf16 v[16:19], v[68:71], v[96:99], v[16:19]
    v_mfma_f32_16x16x32_bf16 v[12:15], v[72:75], v[96:99], v[12:15]
    v_mfma_f32_16x16x32_bf16 v[8:11], v[76:79], v[96:99], v[8:11]
    ds_read_b128 v[96:99], v117 offset:9792
    v_xor_b32 v123, 16, v126
    ds_write_b128 v123, v[36:39]
    s_waitcnt lgkmcnt(9)
    v_mfma_f32_16x16x32_bf16 v[48:51], v[80:83], v[100:103], v[48:51]
    v_mfma_f32_16x16x32_bf16 v[44:47], v[84:87], v[100:103], v[44:47]
    ds_read_b128 v[100:103], v121 offset:9216
    v_xor_b32 v124, 16, v125
    ds_write_b128 v124, v[4:7]
    s_waitcnt lgkmcnt(10)
    v_mfma_f32_16x16x32_bf16 v[24:27], v[64:67], v[104:107], v[24:27]
    v_mfma_f32_16x16x32_bf16 v[20:23], v[68:71], v[104:107], v[20:23]
    v_mfma_f32_16x16x32_bf16 v[16:19], v[72:75], v[104:107], v[16:19]
    v_mfma_f32_16x16x32_bf16 v[12:15], v[76:79], v[104:107], v[12:15]
    ds_read_b128 v[104:107], v118 offset:8704
    v_xor_b32 v124, 32, v126
    ds_write_b128 v124, v[40:43]
    s_waitcnt lgkmcnt(11)
    v_mfma_f32_16x16x32_bf16 v[52:55], v[80:83], v[108:111], v[52:55]
    v_mfma_f32_16x16x32_bf16 v[48:51], v[84:87], v[108:111], v[48:51]
    ds_read_b128 v[108:111], v121 offset:10240
    v_xor_b32 v123, 32, v125
    ds_write_b128 v123, v[8:11]
    s_waitcnt lgkmcnt(12)
    v_mfma_f32_16x16x32_bf16 v[28:31], v[64:67], v[112:115], v[28:31]
    v_mfma_f32_16x16x32_bf16 v[24:27], v[68:71], v[112:115], v[24:27]
    v_mfma_f32_16x16x32_bf16 v[20:23], v[72:75], v[112:115], v[20:23]
    v_mfma_f32_16x16x32_bf16 v[16:19], v[76:79], v[112:115], v[16:19]
    v_xor_b32 v123, 48, v126
    ds_write_b128 v123, v[44:47]
    s_waitcnt lgkmcnt(12)
    v_mfma_f32_16x16x32_bf16 v[56:59], v[80:83], v[88:91], v[56:59]
    v_mfma_f32_16x16x32_bf16 v[52:55], v[84:87], v[88:91], v[52:55]
    v_xor_b32 v124, 48, v125
    ds_write_b128 v124, v[12:15]
    s_waitcnt lgkmcnt(11)
    v_mfma_f32_16x16x32_bf16 v[28:31], v[68:71], v[92:95], v[28:31]
    v_mfma_f32_16x16x32_bf16 v[24:27], v[72:75], v[92:95], v[24:27]
    v_mfma_f32_16x16x32_bf16 v[20:23], v[76:79], v[92:95], v[20:23]
    v_xor_b32 v124, 64, v126
    ds_write_b128 v124, v[48:51]
    s_waitcnt lgkmcnt(10)
    v_mfma_f32_16x16x32_bf16 v[60:63], v[80:83], v[96:99], v[60:63]
    v_mfma_f32_16x16x32_bf16 v[56:59], v[84:87], v[96:99], v[56:59]
    v_xor_b32 v123, 64, v125
    ds_write_b128 v123, v[16:19]
    s_waitcnt lgkmcnt(9)
    v_mfma_f32_16x16x32_bf16 v[28:31], v[72:75], v[100:103], v[28:31]
    v_mfma_f32_16x16x32_bf16 v[24:27], v[76:79], v[100:103], v[24:27]
    v_xor_b32 v123, 80, v126
    ds_write_b128 v123, v[52:55]
    s_waitcnt lgkmcnt(8)
    v_mfma_f32_16x16x32_bf16 v[60:63], v[84:87], v[104:107], v[60:63]
    v_xor_b32 v124, 80, v125
    ds_write_b128 v124, v[20:23]
    s_waitcnt lgkmcnt(7)
    v_mfma_f32_16x16x32_bf16 v[28:31], v[76:79], v[108:111], v[28:31]
    v_xor_b32 v124, 96, v126
    ds_write_b128 v124, v[56:59]
    s_nop 7
    v_xor_b32 v123, 96, v125
    ds_write_b128 v123, v[24:27]
    v_xor_b32 v123, 112, v126
    ds_write_b128 v123, v[60:63]
    v_xor_b32 v124, 112, v125
    ds_write_b128 v124, v[28:31]
    s_setprio 0
    s_branch L_conv2_kernel_epi
L_conv2_kernel_helper:
    s_setprio 3
    v_lshlrev_b32 v8, 4, v6
    s_add_u32 s37, s33, 4294967289
    v_lshl_add_u32 v9, v7, 3, s37
    v_cmp_gt_u32 vcc, 8000, v9
    s_mul_i32 s37, s33, 131072
    s_add_u32 s37, s37, 0
    v_lshl_add_u32 v92, v7, 7, s37
    v_add_u32 v92, v92, v8
    v_mov_b32 v9, 2130706432
    v_cndmask_b32 v92, v9, v92, vcc
    s_add_u32 s37, s33, 4294967291
    v_lshl_add_u32 v9, v7, 3, s37
    v_cmp_gt_u32 vcc, 8000, v9
    s_mul_i32 s37, s33, 131072
    s_add_u32 s37, s37, 262144
    v_lshl_add_u32 v93, v7, 7, s37
    v_add_u32 v93, v93, v8
    v_mov_b32 v9, 2130706432
    v_cndmask_b32 v93, v9, v93, vcc
    s_add_u32 s37, s33, 4294967293
    v_lshl_add_u32 v9, v7, 3, s37
    v_cmp_gt_u32 vcc, 8000, v9
    s_mul_i32 s37, s33, 131072
    s_add_u32 s37, s37, 64
    v_lshl_add_u32 v94, v7, 7, s37
    v_add_u32 v94, v94, v8
    v_mov_b32 v9, 2130706432
    v_cndmask_b32 v94, v9, v94, vcc
    s_add_u32 s37, s33, 4294967295
    v_lshl_add_u32 v9, v7, 3, s37
    v_cmp_gt_u32 vcc, 8000, v9
    s_mul_i32 s37, s33, 131072
    s_add_u32 s37, s37, 262208
    v_lshl_add_u32 v95, v7, 7, s37
    v_add_u32 v95, v95, v8
    v_mov_b32 v9, 2130706432
    v_cndmask_b32 v95, v9, v95, vcc
    v_and_b32 v76, 4, v5
    v_lshrrev_b32 v76, 1, v76
    v_xor_b32 v76, v6, v76
    v_lshlrev_b32 v76, 4, v76
    v_lshl_add_u32 v76, v5, 6, v76
    s_mov_b32 s24, 0
    s_mov_b32 s27, 524288
    buffer_load_dwordx4 v[0:3], v92, s[8:11], s24 offen
    buffer_load_dwordx4 v[8:11], v94, s[8:11], s24 offen
    buffer_load_dwordx4 v[4:7], v93, s[8:11], s24 offen
    buffer_load_dwordx4 v[12:15], v95, s[8:11], s24 offen
    buffer_load_dwordx4 v[16:19], v92, s[8:11], s27 offen
    buffer_load_dwordx4 v[24:27], v94, s[8:11], s27 offen
    buffer_load_dwordx4 v[20:23], v93, s[8:11], s27 offen
    buffer_load_dwordx4 v[28:31], v95, s[8:11], s27 offen
    s_barrier
    s_mul_i32 s36, s42, 1024
    v_add_u32 v96, s36, v76
    v_add_u32 v97, 65536, v96
    s_mul_i32 s36, s42, 1088
    s_add_u32 s36, s36, 98304
    v_add_u32 v98, s36, v76
    s_waitcnt vmcnt(0)
    s_mov_b32 s28, 0
    s_mov_b32 s22, 2
    s_cmp_ge_u32 s20, 12
    s_cbranch_scc1 L_conv2_kernel_h2
    ds_write_b128 v96, v[0:3] offset:0
    ds_write_b128 v98, v[12:15] offset:0
    v_lshlrev_b32 v76, 16, v0
    v_and_b32 v84, s25, v0
    v_lshlrev_b32 v77, 16, v4
    v_and_b32 v85, s25, v4
    v_lshlrev_b32 v78, 16, v8
    v_and_b32 v86, s25, v8
    v_lshlrev_b32 v79, 16, v12
    v_and_b32 v87, s25, v12
    v_add_f32 v80, v76, v78
    v_add_f32 v88, v84, v86
    v_add_f32 v81, v77, v79
    v_add_f32 v89, v85, v87
    v_fma_f32 v82, v78, 4.0, v76
    v_fma_f32 v90, v86, 4.0, v84
    v_fma_f32 v83, v79, 4.0, v77
    v_fma_f32 v91, v87, 4.0, v85
    v_add_f32 v77, v80, v81
    v_add_f32 v85, v88, v89
    v_sub_f32 v78, v80, v81
    v_sub_f32 v86, v88, v89
    v_fma_f32 v79, v83, 2.0, v82
    v_fma_f32 v87, v91, 2.0, v90
    v_fma_f32 v82, v83, -2.0, v82
    v_fma_f32 v90, v91, -2.0, v90
    v_fmamk_f32 v80, v76, 0x41700000, v82
    v_fmamk_f32 v88, v84, 0x41700000, v90
    v_fmamk_f32 v80, v81, 0x41200000, v80
    v_fmamk_f32 v88, v89, 0x41200000, v88
    v_cvt_pk_bf16_f32 v4, v77, v85
    v_cvt_pk_bf16_f32 v8, v78, v86
    v_cvt_pk_bf16_f32 v64, v79, v87
    v_cvt_pk_bf16_f32 v68, v82, v90
    v_cvt_pk_bf16_f32 v72, v80, v88
    v_lshlrev_b32 v76, 16, v1
    v_and_b32 v84, s25, v1
    v_lshlrev_b32 v77, 16, v5
    v_and_b32 v85, s25, v5
    v_lshlrev_b32 v78, 16, v9
    v_and_b32 v86, s25, v9
    v_lshlrev_b32 v79, 16, v13
    v_and_b32 v87, s25, v13
    v_add_f32 v80, v76, v78
    v_add_f32 v88, v84, v86
    v_add_f32 v81, v77, v79
    v_add_f32 v89, v85, v87
    v_fma_f32 v82, v78, 4.0, v76
    v_fma_f32 v90, v86, 4.0, v84
    v_fma_f32 v83, v79, 4.0, v77
    v_fma_f32 v91, v87, 4.0, v85
    v_add_f32 v77, v80, v81
    v_add_f32 v85, v88, v89
    v_sub_f32 v78, v80, v81
    v_sub_f32 v86, v88, v89
    v_fma_f32 v79, v83, 2.0, v82
    v_fma_f32 v87, v91, 2.0, v90
    v_fma_f32 v82, v83, -2.0, v82
    v_fma_f32 v90, v91, -2.0, v90
    v_fmamk_f32 v80, v76, 0x41700000, v82
    v_fmamk_f32 v88, v84, 0x41700000, v90
    v_fmamk_f32 v80, v81, 0x41200000, v80
    v_fmamk_f32 v88, v89, 0x41200000, v88
    v_cvt_pk_bf16_f32 v5, v77, v85
    v_cvt_pk_bf16_f32 v9, v78, v86
    v_cvt_pk_bf16_f32 v65, v79, v87
    v_cvt_pk_bf16_f32 v69, v82, v90
    v_cvt_pk_bf16_f32 v73, v80, v88
    v_lshlrev_b32 v76, 16, v2
    v_and_b32 v84, s25, v2
    v_lshlrev_b32 v77, 16, v6
    v_and_b32 v85, s25, v6
    v_lshlrev_b32 v78, 16, v10
    v_and_b32 v86, s25, v10
    v_lshlrev_b32 v79, 16, v14
    v_and_b32 v87, s25, v14
    v_add_f32 v80, v76, v78
    v_add_f32 v88, v84, v86
    v_add_f32 v81, v77, v79
    v_add_f32 v89, v85, v87
    v_fma_f32 v82, v78, 4.0, v76
    v_fma_f32 v90, v86, 4.0, v84
    v_fma_f32 v83, v79, 4.0, v77
    v_fma_f32 v91, v87, 4.0, v85
    v_add_f32 v77, v80, v81
    v_add_f32 v85, v88, v89
    v_sub_f32 v78, v80, v81
    v_sub_f32 v86, v88, v89
    v_fma_f32 v79, v83, 2.0, v82
    v_fma_f32 v87, v91, 2.0, v90
    v_fma_f32 v82, v83, -2.0, v82
    v_fma_f32 v90, v91, -2.0, v90
    v_fmamk_f32 v80, v76, 0x41700000, v82
    v_fmamk_f32 v88, v84, 0x41700000, v90
    v_fmamk_f32 v80, v81, 0x41200000, v80
    v_fmamk_f32 v88, v89, 0x41200000, v88
    v_cvt_pk_bf16_f32 v6, v77, v85
    v_cvt_pk_bf16_f32 v10, v78, v86
    v_cvt_pk_bf16_f32 v66, v79, v87
    v_cvt_pk_bf16_f32 v70, v82, v90
    v_cvt_pk_bf16_f32 v74, v80, v88
    v_lshlrev_b32 v76, 16, v3
    v_and_b32 v84, s25, v3
    v_lshlrev_b32 v77, 16, v7
    v_and_b32 v85, s25, v7
    v_lshlrev_b32 v78, 16, v11
    v_and_b32 v86, s25, v11
    v_lshlrev_b32 v79, 16, v15
    v_and_b32 v87, s25, v15
    v_add_f32 v80, v76, v78
    v_add_f32 v88, v84, v86
    v_add_f32 v81, v77, v79
    v_add_f32 v89, v85, v87
    v_fma_f32 v82, v78, 4.0, v76
    v_fma_f32 v90, v86, 4.0, v84
    v_fma_f32 v83, v79, 4.0, v77
    v_fma_f32 v91, v87, 4.0, v85
    v_add_f32 v77, v80, v81
    v_add_f32 v85, v88, v89
    v_sub_f32 v78, v80, v81
    v_sub_f32 v86, v88, v89
    v_fma_f32 v79, v83, 2.0, v82
    v_fma_f32 v87, v91, 2.0, v90
    v_fma_f32 v82, v83, -2.0, v82
    v_fma_f32 v90, v91, -2.0, v90
    v_fmamk_f32 v80, v76, 0x41700000, v82
    v_fmamk_f32 v88, v84, 0x41700000, v90
    v_fmamk_f32 v80, v81, 0x41200000, v80
    v_fmamk_f32 v88, v89, 0x41200000, v88
    v_cvt_pk_bf16_f32 v7, v77, v85
    v_cvt_pk_bf16_f32 v11, v78, v86
    v_cvt_pk_bf16_f32 v67, v79, v87
    v_cvt_pk_bf16_f32 v71, v82, v90
    v_cvt_pk_bf16_f32 v75, v80, v88
    ds_write_b128 v96, v[64:67] offset:49152
    ds_write_b128 v97, v[68:71] offset:0
    ds_write_b128 v97, v[72:75] offset:16384
    ds_write_b128 v96, v[4:7] offset:16384
    ds_write_b128 v96, v[8:11] offset:32768
    s_waitcnt vmcnt(0)
    s_mov_b32 s24, 1048576
    s_mov_b32 s27, 1572864
    buffer_load_dwordx4 v[32:35], v92, s[8:11], s24 offen
    buffer_load_dwordx4 v[40:43], v94, s[8:11], s24 offen
    buffer_load_dwordx4 v[36:39], v93, s[8:11], s24 offen
    buffer_load_dwordx4 v[44:47], v95, s[8:11], s24 offen
    s_waitcnt lgkmcnt(0)
    s_barrier
    s_setprio 1
L_conv2_kernel_hloop1:
    v_lshlrev_b32 v76, 16, v16
    v_and_b32 v84, s25, v16
    v_lshlrev_b32 v77, 16, v20
    v_and_b32 v85, s25, v20
    v_lshlrev_b32 v78, 16, v24
    v_and_b32 v86, s25, v24
    v_lshlrev_b32 v79, 16, v28
    v_and_b32 v87, s25, v28
    v_add_f32 v80, v76, v78
    v_add_f32 v88, v84, v86
    v_add_f32 v81, v77, v79
    v_add_f32 v89, v85, v87
    v_fma_f32 v82, v78, 4.0, v76
    buffer_load_dwordx4 v[48:51], v92, s[8:11], s27 offen
    buffer_load_dwordx4 v[56:59], v94, s[8:11], s27 offen
    v_fma_f32 v90, v86, 4.0, v84
    v_fma_f32 v83, v79, 4.0, v77
    v_fma_f32 v91, v87, 4.0, v85
    v_add_f32 v77, v80, v81
    v_add_f32 v85, v88, v89
    v_sub_f32 v78, v80, v81
    v_sub_f32 v86, v88, v89
    v_fma_f32 v79, v83, 2.0, v82
    v_fma_f32 v87, v91, 2.0, v90
    v_fma_f32 v82, v83, -2.0, v82
    v_fma_f32 v90, v91, -2.0, v90
    v_fmamk_f32 v80, v76, 0x41700000, v82
    v_fmamk_f32 v88, v84, 0x41700000, v90
    v_fmamk_f32 v80, v81, 0x41200000, v80
    v_fmamk_f32 v88, v89, 0x41200000, v88
    v_cvt_pk_bf16_f32 v20, v77, v85
    v_cvt_pk_bf16_f32 v24, v78, v86
    v_cvt_pk_bf16_f32 v64, v79, v87
    v_cvt_pk_bf16_f32 v68, v82, v90
    v_cvt_pk_bf16_f32 v72, v80, v88
    v_lshlrev_b32 v76, 16, v17
    v_and_b32 v84, s25, v17
    v_lshlrev_b32 v77, 16, v21
    v_and_b32 v85, s25, v21
    v_lshlrev_b32 v78, 16, v25
    v_and_b32 v86, s25, v25
    v_lshlrev_b32 v79, 16, v29
    v_and_b32 v87, s25, v29
    v_add_f32 v80, v76, v78
    v_add_f32 v88, v84, v86
    v_add_f32 v81, v77, v79
    v_add_f32 v89, v85, v87
    v_fma_f32 v82, v78, 4.0, v76
    v_fma_f32 v90, v86, 4.0, v84
    v_fma_f32 v83, v79, 4.0, v77
    v_fma_f32 v91, v87, 4.0, v85
    v_add_f32 v77, v80, v81
    v_add_f32 v85, v88, v89
    v_sub_f32 v78, v80, v81
    v_sub_f32 v86, v88, v89
    v_fma_f32 v79, v83, 2.0, v82
    v_fma_f32 v87, v91, 2.0, v90
    v_fma_f32 v82, v83, -2.0, v82
    v_fma_f32 v90, v91, -2.0, v90
    v_fmamk_f32 v80, v76, 0x41700000, v82
    v_fmamk_f32 v88, v84, 0x41700000, v90
    v_fmamk_f32 v80, v81, 0x41200000, v80
    v_fmamk_f32 v88, v89, 0x41200000, v88
    v_cvt_pk_bf16_f32 v21, v77, v85
    v_cvt_pk_bf16_f32 v25, v78, v86
    v_cvt_pk_bf16_f32 v65, v79, v87
    v_cvt_pk_bf16_f32 v69, v82, v90
    v_cvt_pk_bf16_f32 v73, v80, v88
    buffer_load_dwordx4 v[52:55], v93, s[8:11], s27 offen
    buffer_load_dwordx4 v[60:63], v95, s[8:11], s27 offen
    v_lshlrev_b32 v76, 16, v18
    v_and_b32 v84, s25, v18
    v_lshlrev_b32 v77, 16, v22
    v_and_b32 v85, s25, v22
    v_lshlrev_b32 v78, 16, v26
    v_and_b32 v86, s25, v26
    v_lshlrev_b32 v79, 16, v30
    v_and_b32 v87, s25, v30
    v_add_f32 v80, v76, v78
    v_add_f32 v88, v84, v86
    v_add_f32 v81, v77, v79
    v_add_f32 v89, v85, v87
    v_fma_f32 v82, v78, 4.0, v76
    v_fma_f32 v90, v86, 4.0, v84
    v_fma_f32 v83, v79, 4.0, v77
    v_fma_f32 v91, v87, 4.0, v85
    v_add_f32 v77, v80, v81
    v_add_f32 v85, v88, v89
    v_sub_f32 v78, v80, v81
    v_sub_f32 v86, v88, v89
    v_fma_f32 v79, v83, 2.0, v82
    v_fma_f32 v87, v91, 2.0, v90
    v_fma_f32 v82, v83, -2.0, v82
    v_fma_f32 v90, v91, -2.0, v90
    v_fmamk_f32 v80, v76, 0x41700000, v82
    v_fmamk_f32 v88, v84, 0x41700000, v90
    v_fmamk_f32 v80, v81, 0x41200000, v80
    v_fmamk_f32 v88, v89, 0x41200000, v88
    v_cvt_pk_bf16_f32 v22, v77, v85
    v_cvt_pk_bf16_f32 v26, v78, v86
    v_cvt_pk_bf16_f32 v66, v79, v87
    v_cvt_pk_bf16_f32 v70, v82, v90
    v_cvt_pk_bf16_f32 v74, v80, v88
    v_lshlrev_b32 v76, 16, v19
    v_and_b32 v84, s25, v19
    v_lshlrev_b32 v77, 16, v23
    v_and_b32 v85, s25, v23
    v_lshlrev_b32 v78, 16, v27
    v_and_b32 v86, s25, v27
    v_lshlrev_b32 v79, 16, v31
    v_and_b32 v87, s25, v31
    v_add_f32 v80, v76, v78
    v_add_f32 v88, v84, v86
    v_add_f32 v81, v77, v79
    v_add_f32 v89, v85, v87
    v_fma_f32 v82, v78, 4.0, v76
    v_fma_f32 v90, v86, 4.0, v84
    v_fma_f32 v83, v79, 4.0, v77
    v_fma_f32 v91, v87, 4.0, v85
    v_add_f32 v77, v80, v81
    v_add_f32 v85, v88, v89
    v_sub_f32 v78, v80, v81
    v_sub_f32 v86, v88, v89
    v_fma_f32 v79, v83, 2.0, v82
    v_fma_f32 v87, v91, 2.0, v90
    v_fma_f32 v82, v83, -2.0, v82
    v_fma_f32 v90, v91, -2.0, v90
    v_fmamk_f32 v80, v76, 0x41700000, v82
    v_fmamk_f32 v88, v84, 0x41700000, v90
    v_fmamk_f32 v80, v81, 0x41200000, v80
    v_fmamk_f32 v88, v89, 0x41200000, v88
    v_cvt_pk_bf16_f32 v23, v77, v85
    v_cvt_pk_bf16_f32 v27, v78, v86
    v_cvt_pk_bf16_f32 v67, v79, v87
    v_cvt_pk_bf16_f32 v71, v82, v90
    v_cvt_pk_bf16_f32 v75, v80, v88
    ds_write_b128 v96, v[64:67] offset:57344
    ds_write_b128 v97, v[68:71] offset:8192
    ds_write_b128 v97, v[72:75] offset:24576
    ds_write_b128 v96, v[16:19] offset:8192
    ds_write_b128 v96, v[20:23] offset:24576
    ds_write_b128 v96, v[24:27] offset:40960
    ds_write_b128 v98, v[28:31] offset:8704
    s_add_u32 s28, s28, 1
    s_waitcnt lgkmcnt(0)
    s_barrier
    s_add_u32 s24, s24, 1048576
    s_add_u32 s27, s27, 1048576
    s_waitcnt vmcnt(0)
    v_lshlrev_b32 v76, 16, v32
    v_and_b32 v84, s25, v32
    v_lshlrev_b32 v77, 16, v36
    v_and_b32 v85, s25, v36
    v_lshlrev_b32 v78, 16, v40
    v_and_b32 v86, s25, v40
    v_lshlrev_b32 v79, 16, v44
    v_and_b32 v87, s25, v44
    v_add_f32 v80, v76, v78
    v_add_f32 v88, v84, v86
    v_add_f32 v81, v77, v79
    v_add_f32 v89, v85, v87
    v_fma_f32 v82, v78, 4.0, v76
    v_fma_f32 v90, v86, 4.0, v84
    v_fma_f32 v83, v79, 4.0, v77
    v_fma_f32 v91, v87, 4.0, v85
    v_add_f32 v77, v80, v81
    v_add_f32 v85, v88, v89
    v_sub_f32 v78, v80, v81
    v_sub_f32 v86, v88, v89
    v_fma_f32 v79, v83, 2.0, v82
    v_fma_f32 v87, v91, 2.0, v90
    v_fma_f32 v82, v83, -2.0, v82
    v_fma_f32 v90, v91, -2.0, v90
    v_fmamk_f32 v80, v76, 0x41700000, v82
    v_fmamk_f32 v88, v84, 0x41700000, v90
    v_fmamk_f32 v80, v81, 0x41200000, v80
    v_fmamk_f32 v88, v89, 0x41200000, v88
    v_cvt_pk_bf16_f32 v36, v77, v85
    v_cvt_pk_bf16_f32 v40, v78, v86
    v_cvt_pk_bf16_f32 v64, v79, v87
    v_cvt_pk_bf16_f32 v68, v82, v90
    v_cvt_pk_bf16_f32 v72, v80, v88
    v_lshlrev_b32 v76, 16, v33
    v_and_b32 v84, s25, v33
    v_lshlrev_b32 v77, 16, v37
    v_and_b32 v85, s25, v37
    v_lshlrev_b32 v78, 16, v41
    v_and_b32 v86, s25, v41
    buffer_load_dwordx4 v[0:3], v92, s[8:11], s24 offen
    buffer_load_dwordx4 v[8:11], v94, s[8:11], s24 offen
    v_lshlrev_b32 v79, 16, v45
    v_and_b32 v87, s25, v45
    v_add_f32 v80, v76, v78
    v_add_f32 v88, v84, v86
    v_add_f32 v81, v77, v79
    v_add_f32 v89, v85, v87
    v_fma_f32 v82, v78, 4.0, v76
    v_fma_f32 v90, v86, 4.0, v84
    v_fma_f32 v83, v79, 4.0, v77
    v_fma_f32 v91, v87, 4.0, v85
    v_add_f32 v77, v80, v81
    v_add_f32 v85, v88, v89
    v_sub_f32 v78, v80, v81
    v_sub_f32 v86, v88, v89
    v_fma_f32 v79, v83, 2.0, v82
    v_fma_f32 v87, v91, 2.0, v90
    v_fma_f32 v82, v83, -2.0, v82
    v_fma_f32 v90, v91, -2.0, v90
    v_fmamk_f32 v80, v76, 0x41700000, v82
    v_fmamk_f32 v88, v84, 0x41700000, v90
    v_fmamk_f32 v80, v81, 0x41200000, v80
    v_fmamk_f32 v88, v89, 0x41200000, v88
    v_cvt_pk_bf16_f32 v37, v77, v85
    v_cvt_pk_bf16_f32 v41, v78, v86
    v_cvt_pk_bf16_f32 v65, v79, v87
    v_cvt_pk_bf16_f32 v69, v82, v90
    v_cvt_pk_bf16_f32 v73, v80, v88
    v_lshlrev_b32 v76, 16, v34
    v_and_b32 v84, s25, v34
    v_lshlrev_b32 v77, 16, v38
    v_and_b32 v85, s25, v38
    v_lshlrev_b32 v78, 16, v42
    v_and_b32 v86, s25, v42
    v_lshlrev_b32 v79, 16, v46
    v_and_b32 v87, s25, v46
    v_add_f32 v80, v76, v78
    v_add_f32 v88, v84, v86
    v_add_f32 v81, v77, v79
    v_add_f32 v89, v85, v87
    v_fma_f32 v82, v78, 4.0, v76
    v_fma_f32 v90, v86, 4.0, v84
    v_fma_f32 v83, v79, 4.0, v77
    v_fma_f32 v91, v87, 4.0, v85
    v_add_f32 v77, v80, v81
    v_add_f32 v85, v88, v89
    v_sub_f32 v78, v80, v81
    v_sub_f32 v86, v88, v89
    v_fma_f32 v79, v83, 2.0, v82
    v_fma_f32 v87, v91, 2.0, v90
    v_fma_f32 v82, v83, -2.0, v82
    v_fma_f32 v90, v91, -2.0, v90
    v_fmamk_f32 v80, v76, 0x41700000, v82
    v_fmamk_f32 v88, v84, 0x41700000, v90
    buffer_load_dwordx4 v[4:7], v93, s[8:11], s24 offen
    buffer_load_dwordx4 v[12:15], v95, s[8:11], s24 offen
    v_fmamk_f32 v80, v81, 0x41200000, v80
    v_fmamk_f32 v88, v89, 0x41200000, v88
    v_cvt_pk_bf16_f32 v38, v77, v85
    v_cvt_pk_bf16_f32 v42, v78, v86
    v_cvt_pk_bf16_f32 v66, v79, v87
    v_cvt_pk_bf16_f32 v70, v82, v90
    v_cvt_pk_bf16_f32 v74, v80, v88
    v_lshlrev_b32 v76, 16, v35
    v_and_b32 v84, s25, v35
    v_lshlrev_b32 v77, 16, v39
    v_and_b32 v85, s25, v39
    v_lshlrev_b32 v78, 16, v43
    v_and_b32 v86, s25, v43
    v_lshlrev_b32 v79, 16, v47
    v_and_b32 v87, s25, v47
    v_add_f32 v80, v76, v78
    v_add_f32 v88, v84, v86
    v_add_f32 v81, v77, v79
    v_add_f32 v89, v85, v87
    v_fma_f32 v82, v78, 4.0, v76
    v_fma_f32 v90, v86, 4.0, v84
    v_fma_f32 v83, v79, 4.0, v77
    v_fma_f32 v91, v87, 4.0, v85
    v_add_f32 v77, v80, v81
    v_add_f32 v85, v88, v89
    v_sub_f32 v78, v80, v81
    v_sub_f32 v86, v88, v89
    v_fma_f32 v79, v83, 2.0, v82
    v_fma_f32 v87, v91, 2.0, v90
    v_fma_f32 v82, v83, -2.0, v82
    v_fma_f32 v90, v91, -2.0, v90
    v_fmamk_f32 v80, v76, 0x41700000, v82
    v_fmamk_f32 v88, v84, 0x41700000, v90
    v_fmamk_f32 v80, v81, 0x41200000, v80
    v_fmamk_f32 v88, v89, 0x41200000, v88
    v_cvt_pk_bf16_f32 v39, v77, v85
    v_cvt_pk_bf16_f32 v43, v78, v86
    v_cvt_pk_bf16_f32 v67, v79, v87
    v_cvt_pk_bf16_f32 v71, v82, v90
    v_cvt_pk_bf16_f32 v75, v80, v88
    ds_write_b128 v96, v[64:67] offset:49152
    ds_write_b128 v97, v[68:71] offset:0
    ds_write_b128 v97, v[72:75] offset:16384
    ds_write_b128 v96, v[32:35] offset:0
    ds_write_b128 v96, v[36:39] offset:16384
    ds_write_b128 v96, v[40:43] offset:32768
    ds_write_b128 v98, v[44:47] offset:0
    s_add_u32 s28, s28, 1
    s_waitcnt lgkmcnt(0)
    s_barrier
    v_lshlrev_b32 v76, 16, v48
    v_and_b32 v84, s25, v48
    v_lshlrev_b32 v77, 16, v52
    v_and_b32 v85, s25, v52
    v_lshlrev_b32 v78, 16, v56
    v_and_b32 v86, s25, v56
    v_lshlrev_b32 v79, 16, v60
    v_and_b32 v87, s25, v60
    v_add_f32 v80, v76, v78
    v_add_f32 v88, v84, v86
    v_add_f32 v81, v77, v79
    v_add_f32 v89, v85, v87
    v_fma_f32 v82, v78, 4.0, v76
    buffer_load_dwordx4 v[16:19], v92, s[8:11], s27 offen
    buffer_load_dwordx4 v[24:27], v94, s[8:11], s27 offen
    v_fma_f32 v90, v86, 4.0, v84
    v_fma_f32 v83, v79, 4.0, v77
    v_fma_f32 v91, v87, 4.0, v85
    v_add_f32 v77, v80, v81
    v_add_f32 v85, v88, v89
    v_sub_f32 v78, v80, v81
    v_sub_f32 v86, v88, v89
    v_fma_f32 v79, v83, 2.0, v82
    v_fma_f32 v87, v91, 2.0, v90
    v_fma_f32 v82, v83, -2.0, v82
    v_fma_f32 v90, v91, -2.0, v90
    v_fmamk_f32 v80, v76, 0x41700000, v82
    v_fmamk_f32 v88, v84, 0x41700000, v90
    v_fmamk_f32 v80, v81, 0x41200000, v80
    v_fmamk_f32 v88, v89, 0x41200000, v88
    v_cvt_pk_bf16_f32 v52, v77, v85
    v_cvt_pk_bf16_f32 v56, v78, v86
    v_cvt_pk_bf16_f32 v64, v79, v87
    v_cvt_pk_bf16_f32 v68, v82, v90
    v_cvt_pk_bf16_f32 v72, v80, v88
    v_lshlrev_b32 v76, 16, v49
    v_and_b32 v84, s25, v49
    v_lshlrev_b32 v77, 16, v53
    v_and_b32 v85, s25, v53
    v_lshlrev_b32 v78, 16, v57
    v_and_b32 v86, s25, v57
    v_lshlrev_b32 v79, 16, v61
    v_and_b32 v87, s25, v61
    v_add_f32 v80, v76, v78
    v_add_f32 v88, v84, v86
    v_add_f32 v81, v77, v79
    v_add_f32 v89, v85, v87
    v_fma_f32 v82, v78, 4.0, v76
    v_fma_f32 v90, v86, 4.0, v84
    v_fma_f32 v83, v79, 4.0, v77
    v_fma_f32 v91, v87, 4.0, v85
    v_add_f32 v77, v80, v81
    v_add_f32 v85, v88, v89
    v_sub_f32 v78, v80, v81
    v_sub_f32 v86, v88, v89
    v_fma_f32 v79, v83, 2.0, v82
    v_fma_f32 v87, v91, 2.0, v90
    v_fma_f32 v82, v83, -2.0, v82
    v_fma_f32 v90, v91, -2.0, v90
    v_fmamk_f32 v80, v76, 0x41700000, v82
    v_fmamk_f32 v88, v84, 0x41700000, v90
    v_fmamk_f32 v80, v81, 0x41200000, v80
    v_fmamk_f32 v88, v89, 0x41200000, v88
    v_cvt_pk_bf16_f32 v53, v77, v85
    v_cvt_pk_bf16_f32 v57, v78, v86
    v_cvt_pk_bf16_f32 v65, v79, v87
    v_cvt_pk_bf16_f32 v69, v82, v90
    v_cvt_pk_bf16_f32 v73, v80, v88
    buffer_load_dwordx4 v[20:23], v93, s[8:11], s27 offen
    buffer_load_dwordx4 v[28:31], v95, s[8:11], s27 offen
    v_lshlrev_b32 v76, 16, v50
    v_and_b32 v84, s25, v50
    v_lshlrev_b32 v77, 16, v54
    v_and_b32 v85, s25, v54
    v_lshlrev_b32 v78, 16, v58
    v_and_b32 v86, s25, v58
    v_lshlrev_b32 v79, 16, v62
    v_and_b32 v87, s25, v62
    v_add_f32 v80, v76, v78
    v_add_f32 v88, v84, v86
    v_add_f32 v81, v77, v79
    v_add_f32 v89, v85, v87
    v_fma_f32 v82, v78, 4.0, v76
    v_fma_f32 v90, v86, 4.0, v84
    v_fma_f32 v83, v79, 4.0, v77
    v_fma_f32 v91, v87, 4.0, v85
    v_add_f32 v77, v80, v81
    v_add_f32 v85, v88, v89
    v_sub_f32 v78, v80, v81
    v_sub_f32 v86, v88, v89
    v_fma_f32 v79, v83, 2.0, v82
    v_fma_f32 v87, v91, 2.0, v90
    v_fma_f32 v82, v83, -2.0, v82
    v_fma_f32 v90, v91, -2.0, v90
    v_fmamk_f32 v80, v76, 0x41700000, v82
    v_fmamk_f32 v88, v84, 0x41700000, v90
    v_fmamk_f32 v80, v81, 0x41200000, v80
    v_fmamk_f32 v88, v89, 0x41200000, v88
    v_cvt_pk_bf16_f32 v54, v77, v85
    v_cvt_pk_bf16_f32 v58, v78, v86
    v_cvt_pk_bf16_f32 v66, v79, v87
    v_cvt_pk_bf16_f32 v70, v82, v90
    v_cvt_pk_bf16_f32 v74, v80, v88
    v_lshlrev_b32 v76, 16, v51
    v_and_b32 v84, s25, v51
    v_lshlrev_b32 v77, 16, v55
    v_and_b32 v85, s25, v55
    v_lshlrev_b32 v78, 16, v59
    v_and_b32 v86, s25, v59
    v_lshlrev_b32 v79, 16, v63
    v_and_b32 v87, s25, v63
    v_add_f32 v80, v76, v78
    v_add_f32 v88, v84, v86
    v_add_f32 v81, v77, v79
    v_add_f32 v89, v85, v87
    v_fma_f32 v82, v78, 4.0, v76
    v_fma_f32 v90, v86, 4.0, v84
    v_fma_f32 v83, v79, 4.0, v77
    v_fma_f32 v91, v87, 4.0, v85
    v_add_f32 v77, v80, v81
    v_add_f32 v85, v88, v89
    v_sub_f32 v78, v80, v81
    v_sub_f32 v86, v88, v89
    v_fma_f32 v79, v83, 2.0, v82
    v_fma_f32 v87, v91, 2.0, v90
    v_fma_f32 v82, v83, -2.0, v82
    v_fma_f32 v90, v91, -2.0, v90
    v_fmamk_f32 v80, v76, 0x41700000, v82
    v_fmamk_f32 v88, v84, 0x41700000, v90
    v_fmamk_f32 v80, v81, 0x41200000, v80
    v_fmamk_f32 v88, v89, 0x41200000, v88
    v_cvt_pk_bf16_f32 v55, v77, v85
    v_cvt_pk_bf16_f32 v59, v78, v86
    v_cvt_pk_bf16_f32 v67, v79, v87
    v_cvt_pk_bf16_f32 v71, v82, v90
    v_cvt_pk_bf16_f32 v75, v80, v88
    ds_write_b128 v96, v[64:67] offset:57344
    ds_write_b128 v97, v[68:71] offset:8192
    ds_write_b128 v97, v[72:75] offset:24576
    ds_write_b128 v96, v[48:51] offset:8192
    ds_write_b128 v96, v[52:55] offset:24576
    ds_write_b128 v96, v[56:59] offset:40960
    ds_write_b128 v98, v[60:63] offset:8704
    s_add_u32 s28, s28, 1
    s_waitcnt lgkmcnt(0)
    s_barrier
    s_cmp_eq_u32 s22, 1
    s_cbranch_scc1 L_conv2_kernel_hlast1
    s_add_u32 s24, s24, 1048576
    s_add_u32 s27, s27, 1048576
    s_waitcnt vmcnt(0)
    v_lshlrev_b32 v76, 16, v0
    v_and_b32 v84, s25, v0
    v_lshlrev_b32 v77, 16, v4
    v_and_b32 v85, s25, v4
    v_lshlrev_b32 v78, 16, v8
    v_and_b32 v86, s25, v8
    v_lshlrev_b32 v79, 16, v12
    v_and_b32 v87, s25, v12
    v_add_f32 v80, v76, v78
    v_add_f32 v88, v84, v86
    v_add_f32 v81, v77, v79
    v_add_f32 v89, v85, v87
    v_fma_f32 v82, v78, 4.0, v76
    v_fma_f32 v90, v86, 4.0, v84
    v_fma_f32 v83, v79, 4.0, v77
    v_fma_f32 v91, v87, 4.0, v85
    v_add_f32 v77, v80, v81
    v_add_f32 v85, v88, v89
    v_sub_f32 v78, v80, v81
    v_sub_f32 v86, v88, v89
    v_fma_f32 v79, v83, 2.0, v82
    v_fma_f32 v87, v91, 2.0, v90
    v_fma_f32 v82, v83, -2.0, v82
    v_fma_f32 v90, v91, -2.0, v90
    v_fmamk_f32 v80, v76, 0x41700000, v82
    v_fmamk_f32 v88, v84, 0x41700000, v90
    v_fmamk_f32 v80, v81, 0x41200000, v80
    v_fmamk_f32 v88, v89, 0x41200000, v88
    v_cvt_pk_bf16_f32 v4, v77, v85
    v_cvt_pk_bf16_f32 v8, v78, v86
    v_cvt_pk_bf16_f32 v64, v79, v87
    v_cvt_pk_bf16_f32 v68, v82, v90
    v_cvt_pk_bf16_f32 v72, v80, v88
    v_lshlrev_b32 v76, 16, v1
    v_and_b32 v84, s25, v1
    v_lshlrev_b32 v77, 16, v5
    v_and_b32 v85, s25, v5
    v_lshlrev_b32 v78, 16, v9
    v_and_b32 v86, s25, v9
    buffer_load_dwordx4 v[32:35], v92, s[8:11], s24 offen
    buffer_load_dwordx4 v[40:43], v94, s[8:11], s24 offen
    v_lshlrev_b32 v79, 16, v13
    v_and_b32 v87, s25, v13
    v_add_f32 v80, v76, v78
    v_add_f32 v88, v84, v86
    v_add_f32 v81, v77, v79
    v_add_f32 v89, v85, v87
    v_fma_f32 v82, v78, 4.0, v76
    v_fma_f32 v90, v86, 4.0, v84
    v_fma_f32 v83, v79, 4.0, v77
    v_fma_f32 v91, v87, 4.0, v85
    v_add_f32 v77, v80, v81
    v_add_f32 v85, v88, v89
    v_sub_f32 v78, v80, v81
    v_sub_f32 v86, v88, v89
    v_fma_f32 v79, v83, 2.0, v82
    v_fma_f32 v87, v91, 2.0, v90
    v_fma_f32 v82, v83, -2.0, v82
    v_fma_f32 v90, v91, -2.0, v90
    v_fmamk_f32 v80, v76, 0x41700000, v82
    v_fmamk_f32 v88, v84, 0x41700000, v90
    v_fmamk_f32 v80, v81, 0x41200000, v80
    v_fmamk_f32 v88, v89, 0x41200000, v88
    v_cvt_pk_bf16_f32 v5, v77, v85
    v_cvt_pk_bf16_f32 v9, v78, v86
    v_cvt_pk_bf16_f32 v65, v79, v87
    v_cvt_pk_bf16_f32 v69, v82, v90
    v_cvt_pk_bf16_f32 v73, v80, v88
    v_lshlrev_b32 v76, 16, v2
    v_and_b32 v84, s25, v2
    v_lshlrev_b32 v77, 16, v6
    v_and_b32 v85, s25, v6
    v_lshlrev_b32 v78, 16, v10
    v_and_b32 v86, s25, v10
    v_lshlrev_b32 v79, 16, v14
    v_and_b32 v87, s25, v14
    v_add_f32 v80, v76, v78
    v_add_f32 v88, v84, v86
    v_add_f32 v81, v77, v79
    v_add_f32 v89, v85, v87
    v_fma_f32 v82, v78, 4.0, v76
    v_fma_f32 v90, v86, 4.0, v84
    v_fma_f32 v83, v79, 4.0, v77
    v_fma_f32 v91, v87, 4.0, v85
    v_add_f32 v77, v80, v81
    v_add_f32 v85, v88, v89
    v_sub_f32 v78, v80, v81
    v_sub_f32 v86, v88, v89
    v_fma_f32 v79, v83, 2.0, v82
    v_fma_f32 v87, v91, 2.0, v90
    v_fma_f32 v82, v83, -2.0, v82
    v_fma_f32 v90, v91, -2.0, v90
    v_fmamk_f32 v80, v76, 0x41700000, v82
    v_fmamk_f32 v88, v84, 0x41700000, v90
    buffer_load_dwordx4 v[36:39], v93, s[8:11], s24 offen
    buffer_load_dwordx4 v[44:47], v95, s[8:11], s24 offen
    v_fmamk_f32 v80, v81, 0x41200000, v80
    v_fmamk_f32 v88, v89, 0x41200000, v88
    v_cvt_pk_bf16_f32 v6, v77, v85
    v_cvt_pk_bf16_f32 v10, v78, v86
    v_cvt_pk_bf16_f32 v66, v79, v87
    v_cvt_pk_bf16_f32 v70, v82, v90
    v_cvt_pk_bf16_f32 v74, v80, v88
    v_lshlrev_b32 v76, 16, v3
    v_and_b32 v84, s25, v3
    v_lshlrev_b32 v77, 16, v7
    v_and_b32 v85, s25, v7
    v_lshlrev_b32 v78, 16, v11
    v_and_b32 v86, s25, v11
    v_lshlrev_b32 v79, 16, v15
    v_and_b32 v87, s25, v15
    v_add_f32 v80, v76, v78
    v_add_f32 v88, v84, v86
    v_add_f32 v81, v77, v79
    v_add_f32 v89, v85, v87
    v_fma_f32 v82, v78, 4.0, v76
    v_fma_f32 v90, v86, 4.0, v84
    v_fma_f32 v83, v79, 4.0, v77
    v_fma_f32 v91, v87, 4.0, v85
    v_add_f32 v77, v80, v81
    v_add_f32 v85, v88, v89
    v_sub_f32 v78, v80, v81
    v_sub_f32 v86, v88, v89
    v_fma_f32 v79, v83, 2.0, v82
    v_fma_f32 v87, v91, 2.0, v90
    v_fma_f32 v82, v83, -2.0, v82
    v_fma_f32 v90, v91, -2.0, v90
    v_fmamk_f32 v80, v76, 0x41700000, v82
    v_fmamk_f32 v88, v84, 0x41700000, v90
    v_fmamk_f32 v80, v81, 0x41200000, v80
    v_fmamk_f32 v88, v89, 0x41200000, v88
    v_cvt_pk_bf16_f32 v7, v77, v85
    v_cvt_pk_bf16_f32 v11, v78, v86
    v_cvt_pk_bf16_f32 v67, v79, v87
    v_cvt_pk_bf16_f32 v71, v82, v90
    v_cvt_pk_bf16_f32 v75, v80, v88
    ds_write_b128 v96, v[64:67] offset:49152
    ds_write_b128 v97, v[68:71] offset:0
    ds_write_b128 v97, v[72:75] offset:16384
    ds_write_b128 v96, v[0:3] offset:0
    ds_write_b128 v96, v[4:7] offset:16384
    ds_write_b128 v96, v[8:11] offset:32768
    ds_write_b128 v98, v[12:15] offset:0
    s_add_u32 s28, s28, 1
    s_waitcnt lgkmcnt(0)
    s_barrier
    s_sub_u32 s22, s22, 1
    s_branch L_conv2_kernel_hloop1
L_conv2_kernel_hlast1:
    s_branch L_conv2_kernel_end
L_conv2_kernel_h2:
    ds_write_b128 v96, v[0:3] offset:0
    ds_write_b128 v98, v[12:15] offset:0
    v_lshlrev_b32 v76, 16, v0
    v_and_b32 v84, s25, v0
    v_lshlrev_b32 v77, 16, v4
    v_and_b32 v85, s25, v4
    v_lshlrev_b32 v78, 16, v8
    v_and_b32 v86, s25, v8
    v_lshlrev_b32 v79, 16, v12
    v_and_b32 v87, s25, v12
    v_add_f32 v80, v76, v78
    v_add_f32 v88, v84, v86
    v_add_f32 v81, v77, v79
    v_add_f32 v89, v85, v87
    v_fma_f32 v82, v78, 4.0, v76
    v_fma_f32 v90, v86, 4.0, v84
    v_fma_f32 v83, v79, 4.0, v77
    v_fma_f32 v91, v87, 4.0, v85
    v_add_f32 v77, v80, v81
    v_add_f32 v85, v88, v89
    v_sub_f32 v78, v80, v81
    v_sub_f32 v86, v88, v89
    v_fma_f32 v79, v83, 2.0, v82
    v_fma_f32 v87, v91, 2.0, v90
    v_fma_f32 v82, v83, -2.0, v82
    v_fma_f32 v90, v91, -2.0, v90
    v_fmamk_f32 v80, v76, 0x41700000, v82
    v_fmamk_f32 v88, v84, 0x41700000, v90
    v_fmamk_f32 v80, v81, 0x41200000, v80
    v_fmamk_f32 v88, v89, 0x41200000, v88
    v_cvt_pk_bf16_f32 v4, v77, v85
    v_cvt_pk_bf16_f32 v8, v78, v86
    v_cvt_pk_bf16_f32 v64, v79, v87
    v_cvt_pk_bf16_f32 v68, v82, v90
    v_cvt_pk_bf16_f32 v72, v80, v88
    v_lshlrev_b32 v76, 16, v1
    v_and_b32 v84, s25, v1
    v_lshlrev_b32 v77, 16, v5
    v_and_b32 v85, s25, v5
    v_lshlrev_b32 v78, 16, v9
    v_and_b32 v86, s25, v9
    v_lshlrev_b32 v79, 16, v13
    v_and_b32 v87, s25, v13
    v_add_f32 v80, v76, v78
    v_add_f32 v88, v84, v86
    v_add_f32 v81, v77, v79
    v_add_f32 v89, v85, v87
    v_fma_f32 v82, v78, 4.0, v76
    v_fma_f32 v90, v86, 4.0, v84
    v_fma_f32 v83, v79, 4.0, v77
    v_fma_f32 v91, v87, 4.0, v85
    v_add_f32 v77, v80, v81
    v_add_f32 v85, v88, v89
    v_sub_f32 v78, v80, v81
    v_sub_f32 v86, v88, v89
    v_fma_f32 v79, v83, 2.0, v82
    v_fma_f32 v87, v91, 2.0, v90
    v_fma_f32 v82, v83, -2.0, v82
    v_fma_f32 v90, v91, -2.0, v90
    v_fmamk_f32 v80, v76, 0x41700000, v82
    v_fmamk_f32 v88, v84, 0x41700000, v90
    v_fmamk_f32 v80, v81, 0x41200000, v80
    v_fmamk_f32 v88, v89, 0x41200000, v88
    v_cvt_pk_bf16_f32 v5, v77, v85
    v_cvt_pk_bf16_f32 v9, v78, v86
    v_cvt_pk_bf16_f32 v65, v79, v87
    v_cvt_pk_bf16_f32 v69, v82, v90
    v_cvt_pk_bf16_f32 v73, v80, v88
    v_lshlrev_b32 v76, 16, v2
    v_and_b32 v84, s25, v2
    v_lshlrev_b32 v77, 16, v6
    v_and_b32 v85, s25, v6
    v_lshlrev_b32 v78, 16, v10
    v_and_b32 v86, s25, v10
    v_lshlrev_b32 v79, 16, v14
    v_and_b32 v87, s25, v14
    v_add_f32 v80, v76, v78
    v_add_f32 v88, v84, v86
    v_add_f32 v81, v77, v79
    v_add_f32 v89, v85, v87
    v_fma_f32 v82, v78, 4.0, v76
    v_fma_f32 v90, v86, 4.0, v84
    v_fma_f32 v83, v79, 4.0, v77
    v_fma_f32 v91, v87, 4.0, v85
    v_add_f32 v77, v80, v81
    v_add_f32 v85, v88, v89
    v_sub_f32 v78, v80, v81
    v_sub_f32 v86, v88, v89
    v_fma_f32 v79, v83, 2.0, v82
    v_fma_f32 v87, v91, 2.0, v90
    v_fma_f32 v82, v83, -2.0, v82
    v_fma_f32 v90, v91, -2.0, v90
    v_fmamk_f32 v80, v76, 0x41700000, v82
    v_fmamk_f32 v88, v84, 0x41700000, v90
    v_fmamk_f32 v80, v81, 0x41200000, v80
    v_fmamk_f32 v88, v89, 0x41200000, v88
    v_cvt_pk_bf16_f32 v6, v77, v85
    v_cvt_pk_bf16_f32 v10, v78, v86
    v_cvt_pk_bf16_f32 v66, v79, v87
    v_cvt_pk_bf16_f32 v70, v82, v90
    v_cvt_pk_bf16_f32 v74, v80, v88
    v_lshlrev_b32 v76, 16, v3
    v_and_b32 v84, s25, v3
    v_lshlrev_b32 v77, 16, v7
    v_and_b32 v85, s25, v7
    v_lshlrev_b32 v78, 16, v11
    v_and_b32 v86, s25, v11
    v_lshlrev_b32 v79, 16, v15
    v_and_b32 v87, s25, v15
    v_add_f32 v80, v76, v78
    v_add_f32 v88, v84, v86
    v_add_f32 v81, v77, v79
    v_add_f32 v89, v85, v87
    v_fma_f32 v82, v78, 4.0, v76
    v_fma_f32 v90, v86, 4.0, v84
    v_fma_f32 v83, v79, 4.0, v77
    v_fma_f32 v91, v87, 4.0, v85
    v_add_f32 v77, v80, v81
    v_add_f32 v85, v88, v89
    v_sub_f32 v78, v80, v81
    v_sub_f32 v86, v88, v89
    v_fma_f32 v79, v83, 2.0, v82
    v_fma_f32 v87, v91, 2.0, v90
    v_fma_f32 v82, v83, -2.0, v82
    v_fma_f32 v90, v91, -2.0, v90
    v_fmamk_f32 v80, v76, 0x41700000, v82
    v_fmamk_f32 v88, v84, 0x41700000, v90
    v_fmamk_f32 v80, v81, 0x41200000, v80
    v_fmamk_f32 v88, v89, 0x41200000, v88
    v_cvt_pk_bf16_f32 v7, v77, v85
    v_cvt_pk_bf16_f32 v11, v78, v86
    v_cvt_pk_bf16_f32 v67, v79, v87
    v_cvt_pk_bf16_f32 v71, v82, v90
    v_cvt_pk_bf16_f32 v75, v80, v88
    ds_write_b128 v96, v[64:67] offset:49152
    ds_write_b128 v97, v[68:71] offset:0
    ds_write_b128 v97, v[72:75] offset:16384
    ds_write_b128 v96, v[4:7] offset:16384
    ds_write_b128 v96, v[8:11] offset:32768
    s_waitcnt vmcnt(0)
    s_mov_b32 s24, 1048576
    s_mov_b32 s27, 1572864
    buffer_load_dwordx4 v[32:35], v92, s[8:11], s24 offen
    buffer_load_dwordx4 v[40:43], v94, s[8:11], s24 offen
    buffer_load_dwordx4 v[36:39], v93, s[8:11], s24 offen
    buffer_load_dwordx4 v[44:47], v95, s[8:11], s24 offen
    buffer_load_dwordx4 v[48:51], v92, s[8:11], s27 offen
    buffer_load_dwordx4 v[56:59], v94, s[8:11], s27 offen
    buffer_load_dwordx4 v[52:55], v93, s[8:11], s27 offen
    buffer_load_dwordx4 v[60:63], v95, s[8:11], s27 offen
    s_waitcnt lgkmcnt(0)
    s_barrier
    s_setprio 0
    v_lshlrev_b32 v76, 16, v16
    v_and_b32 v84, s25, v16
    v_lshlrev_b32 v77, 16, v20
    v_and_b32 v85, s25, v20
    v_lshlrev_b32 v78, 16, v24
    v_and_b32 v86, s25, v24
    v_lshlrev_b32 v79, 16, v28
    v_and_b32 v87, s25, v28
    v_add_f32 v80, v76, v78
    v_add_f32 v88, v84, v86
    v_add_f32 v81, v77, v79
    v_add_f32 v89, v85, v87
    v_fma_f32 v82, v78, 4.0, v76
    v_fma_f32 v90, v86, 4.0, v84
    v_fma_f32 v83, v79, 4.0, v77
    v_fma_f32 v91, v87, 4.0, v85
    v_add_f32 v77, v80, v81
    v_add_f32 v85, v88, v89
    v_sub_f32 v78, v80, v81
    v_sub_f32 v86, v88, v89
    v_fma_f32 v79, v83, 2.0, v82
    v_fma_f32 v87, v91, 2.0, v90
    v_fma_f32 v82, v83, -2.0, v82
    v_fma_f32 v90, v91, -2.0, v90
    v_fmamk_f32 v80, v76, 0x41700000, v82
    v_fmamk_f32 v88, v84, 0x41700000, v90
    v_fmamk_f32 v80, v81, 0x41200000, v80
    v_fmamk_f32 v88, v89, 0x41200000, v88
    v_cvt_pk_bf16_f32 v20, v77, v85
    v_cvt_pk_bf16_f32 v24, v78, v86
    v_cvt_pk_bf16_f32 v64, v79, v87
    v_cvt_pk_bf16_f32 v68, v82, v90
    v_cvt_pk_bf16_f32 v72, v80, v88
    v_lshlrev_b32 v76, 16, v17
    v_and_b32 v84, s25, v17
    v_lshlrev_b32 v77, 16, v21
    v_and_b32 v85, s25, v21
    v_lshlrev_b32 v78, 16, v25
    v_and_b32 v86, s25, v25
    v_lshlrev_b32 v79, 16, v29
    v_and_b32 v87, s25, v29
    v_add_f32 v80, v76, v78
    v_add_f32 v88, v84, v86
    v_add_f32 v81, v77, v79
    v_add_f32 v89, v85, v87
    v_fma_f32 v82, v78, 4.0, v76
    v_fma_f32 v90, v86, 4.0, v84
    v_fma_f32 v83, v79, 4.0, v77
    v_fma_f32 v91, v87, 4.0, v85
    v_add_f32 v77, v80, v81
    v_add_f32 v85, v88, v89
    v_sub_f32 v78, v80, v81
    v_sub_f32 v86, v88, v89
    v_fma_f32 v79, v83, 2.0, v82
    v_fma_f32 v87, v91, 2.0, v90
    v_fma_f32 v82, v83, -2.0, v82
    v_fma_f32 v90, v91, -2.0, v90
    v_fmamk_f32 v80, v76, 0x41700000, v82
    v_fmamk_f32 v88, v84, 0x41700000, v90
    v_fmamk_f32 v80, v81, 0x41200000, v80
    v_fmamk_f32 v88, v89, 0x41200000, v88
    v_cvt_pk_bf16_f32 v21, v77, v85
    v_cvt_pk_bf16_f32 v25, v78, v86
    v_cvt_pk_bf16_f32 v65, v79, v87
    v_cvt_pk_bf16_f32 v69, v82, v90
    v_cvt_pk_bf16_f32 v73, v80, v88
    v_lshlrev_b32 v76, 16, v18
    v_and_b32 v84, s25, v18
    v_lshlrev_b32 v77, 16, v22
    v_and_b32 v85, s25, v22
    v_lshlrev_b32 v78, 16, v26
    v_and_b32 v86, s25, v26
    v_lshlrev_b32 v79, 16, v30
    v_and_b32 v87, s25, v30
    v_add_f32 v80, v76, v78
    v_add_f32 v88, v84, v86
    v_add_f32 v81, v77, v79
    v_add_f32 v89, v85, v87
    v_fma_f32 v82, v78, 4.0, v76
    v_fma_f32 v90, v86, 4.0, v84
    v_fma_f32 v83, v79, 4.0, v77
    v_fma_f32 v91, v87, 4.0, v85
    v_add_f32 v77, v80, v81
    v_add_f32 v85, v88, v89
    v_sub_f32 v78, v80, v81
    v_sub_f32 v86, v88, v89
    v_fma_f32 v79, v83, 2.0, v82
    v_fma_f32 v87, v91, 2.0, v90
    v_fma_f32 v82, v83, -2.0, v82
    v_fma_f32 v90, v91, -2.0, v90
    v_fmamk_f32 v80, v76, 0x41700000, v82
    v_fmamk_f32 v88, v84, 0x41700000, v90
    v_fmamk_f32 v80, v81, 0x41200000, v80
    v_fmamk_f32 v88, v89, 0x41200000, v88
    v_cvt_pk_bf16_f32 v22, v77, v85
    v_cvt_pk_bf16_f32 v26, v78, v86
    v_cvt_pk_bf16_f32 v66, v79, v87
    v_cvt_pk_bf16_f32 v70, v82, v90
    v_cvt_pk_bf16_f32 v74, v80, v88
    v_lshlrev_b32 v76, 16, v19
    v_and_b32 v84, s25, v19
    v_lshlrev_b32 v77, 16, v23
    v_and_b32 v85, s25, v23
    v_lshlrev_b32 v78, 16, v27
    v_and_b32 v86, s25, v27
    v_lshlrev_b32 v79, 16, v31
    v_and_b32 v87, s25, v31
    v_add_f32 v80, v76, v78
    v_add_f32 v88, v84, v86
    v_add_f32 v81, v77, v79
    v_add_f32 v89, v85, v87
    v_fma_f32 v82, v78, 4.0, v76
    v_fma_f32 v90, v86, 4.0, v84
    v_fma_f32 v83, v79, 4.0, v77
    v_fma_f32 v91, v87, 4.0, v85
    v_add_f32 v77, v80, v81
    v_add_f32 v85, v88, v89
    v_sub_f32 v78, v80, v81
    v_sub_f32 v86, v88, v89
    v_fma_f32 v79, v83, 2.0, v82
    v_fma_f32 v87, v91, 2.0, v90
    v_fma_f32 v82, v83, -2.0, v82
    v_fma_f32 v90, v91, -2.0, v90
    v_fmamk_f32 v80, v76, 0x41700000, v82
    v_fmamk_f32 v88, v84, 0x41700000, v90
    v_fmamk_f32 v80, v81, 0x41200000, v80
    v_fmamk_f32 v88, v89, 0x41200000, v88
    v_cvt_pk_bf16_f32 v23, v77, v85
    v_cvt_pk_bf16_f32 v27, v78, v86
    v_cvt_pk_bf16_f32 v67, v79, v87
    v_cvt_pk_bf16_f32 v71, v82, v90
    v_cvt_pk_bf16_f32 v75, v80, v88
L_conv2_kernel_hloop2:
    s_add_u32 s24, s24, 1048576
    s_add_u32 s27, s27, 1048576
    ds_write_b128 v96, v[64:67] offset:57344
    ds_write_b128 v97, v[68:71] offset:8192
    ds_write_b128 v97, v[72:75] offset:24576
    ds_write_b128 v96, v[16:19] offset:8192
    ds_write_b128 v96, v[20:23] offset:24576
    ds_write_b128 v96, v[24:27] offset:40960
    ds_write_b128 v98, v[28:31] offset:8704
    s_waitcnt vmcnt(0)
    v_lshlrev_b32 v76, 16, v32
    v_and_b32 v84, s25, v32
    v_lshlrev_b32 v77, 16, v36
    v_and_b32 v85, s25, v36
    v_lshlrev_b32 v78, 16, v40
    v_and_b32 v86, s25, v40
    v_lshlrev_b32 v79, 16, v44
    v_and_b32 v87, s25, v44
    v_add_f32 v80, v76, v78
    v_add_f32 v88, v84, v86
    v_add_f32 v81, v77, v79
    v_add_f32 v89, v85, v87
    v_fma_f32 v82, v78, 4.0, v76
    v_fma_f32 v90, v86, 4.0, v84
    v_fma_f32 v83, v79, 4.0, v77
    v_fma_f32 v91, v87, 4.0, v85
    v_add_f32 v77, v80, v81
    v_add_f32 v85, v88, v89
    v_sub_f32 v78, v80, v81
    v_sub_f32 v86, v88, v89
    v_fma_f32 v79, v83, 2.0, v82
    v_fma_f32 v87, v91, 2.0, v90
    v_fma_f32 v82, v83, -2.0, v82
    v_fma_f32 v90, v91, -2.0, v90
    v_fmamk_f32 v80, v76, 0x41700000, v82
    v_fmamk_f32 v88, v84, 0x41700000, v90
    buffer_load_dwordx4 v[0:3], v92, s[8:11], s24 offen
    buffer_load_dwordx4 v[8:11], v94, s[8:11], s24 offen
    v_fmamk_f32 v80, v81, 0x41200000, v80
    v_fmamk_f32 v88, v89, 0x41200000, v88
    v_cvt_pk_bf16_f32 v36, v77, v85
    v_cvt_pk_bf16_f32 v40, v78, v86
    v_cvt_pk_bf16_f32 v64, v79, v87
    v_cvt_pk_bf16_f32 v68, v82, v90
    v_cvt_pk_bf16_f32 v72, v80, v88
    v_lshlrev_b32 v76, 16, v33
    v_and_b32 v84, s25, v33
    v_lshlrev_b32 v77, 16, v37
    v_and_b32 v85, s25, v37
    v_lshlrev_b32 v78, 16, v41
    v_and_b32 v86, s25, v41
    v_lshlrev_b32 v79, 16, v45
    v_and_b32 v87, s25, v45
    v_add_f32 v80, v76, v78
    v_add_f32 v88, v84, v86
    v_add_f32 v81, v77, v79
    v_add_f32 v89, v85, v87
    v_fma_f32 v82, v78, 4.0, v76
    v_fma_f32 v90, v86, 4.0, v84
    v_fma_f32 v83, v79, 4.0, v77
    v_fma_f32 v91, v87, 4.0, v85
    v_add_f32 v77, v80, v81
    v_add_f32 v85, v88, v89
    v_sub_f32 v78, v80, v81
    v_sub_f32 v86, v88, v89
    v_fma_f32 v79, v83, 2.0, v82
    v_fma_f32 v87, v91, 2.0, v90
    v_fma_f32 v82, v83, -2.0, v82
    v_fma_f32 v90, v91, -2.0, v90
    v_fmamk_f32 v80, v76, 0x41700000, v82
    v_fmamk_f32 v88, v84, 0x41700000, v90
    v_fmamk_f32 v80, v81, 0x41200000, v80
    v_fmamk_f32 v88, v89, 0x41200000, v88
    v_cvt_pk_bf16_f32 v37, v77, v85
    v_cvt_pk_bf16_f32 v41, v78, v86
    v_cvt_pk_bf16_f32 v65, v79, v87
    v_cvt_pk_bf16_f32 v69, v82, v90
    v_cvt_pk_bf16_f32 v73, v80, v88
    v_lshlrev_b32 v76, 16, v34
    v_and_b32 v84, s25, v34
    v_lshlrev_b32 v77, 16, v38
    v_and_b32 v85, s25, v38
    v_lshlrev_b32 v78, 16, v42
    v_and_b32 v86, s25, v42
    v_lshlrev_b32 v79, 16, v46
    v_and_b32 v87, s25, v46
    v_add_f32 v80, v76, v78
    v_add_f32 v88, v84, v86
    v_add_f32 v81, v77, v79
    v_add_f32 v89, v85, v87
    v_fma_f32 v82, v78, 4.0, v76
    buffer_load_dwordx4 v[4:7], v93, s[8:11], s24 offen
    buffer_load_dwordx4 v[12:15], v95, s[8:11], s24 offen
    v_fma_f32 v90, v86, 4.0, v84
    v_fma_f32 v83, v79, 4.0, v77
    v_fma_f32 v91, v87, 4.0, v85
    v_add_f32 v77, v80, v81
    v_add_f32 v85, v88, v89
    v_sub_f32 v78, v80, v81
    v_sub_f32 v86, v88, v89
    v_fma_f32 v79, v83, 2.0, v82
    v_fma_f32 v87, v91, 2.0, v90
    v_fma_f32 v82, v83, -2.0, v82
    v_fma_f32 v90, v91, -2.0, v90
    v_fmamk_f32 v80, v76, 0x41700000, v82
    v_fmamk_f32 v88, v84, 0x41700000, v90
    v_fmamk_f32 v80, v81, 0x41200000, v80
    v_fmamk_f32 v88, v89, 0x41200000, v88
    v_cvt_pk_bf16_f32 v38, v77, v85
    v_cvt_pk_bf16_f32 v42, v78, v86
    v_cvt_pk_bf16_f32 v66, v79, v87
    v_cvt_pk_bf16_f32 v70, v82, v90
    v_cvt_pk_bf16_f32 v74, v80, v88
    v_lshlrev_b32 v76, 16, v35
    v_and_b32 v84, s25, v35
    v_lshlrev_b32 v77, 16, v39
    v_and_b32 v85, s25, v39
    v_lshlrev_b32 v78, 16, v43
    v_and_b32 v86, s25, v43
    v_lshlrev_b32 v79, 16, v47
    v_and_b32 v87, s25, v47
    v_add_f32 v80, v76, v78
    v_add_f32 v88, v84, v86
    v_add_f32 v81, v77, v79
    v_add_f32 v89, v85, v87
    v_fma_f32 v82, v78, 4.0, v76
    v_fma_f32 v90, v86, 4.0, v84
    v_fma_f32 v83, v79, 4.0, v77
    v_fma_f32 v91, v87, 4.0, v85
    v_add_f32 v77, v80, v81
    v_add_f32 v85, v88, v89
    v_sub_f32 v78, v80, v81
    v_sub_f32 v86, v88, v89
    v_fma_f32 v79, v83, 2.0, v82
    v_fma_f32 v87, v91, 2.0, v90
    v_fma_f32 v82, v83, -2.0, v82
    v_fma_f32 v90, v91, -2.0, v90
    v_fmamk_f32 v80, v76, 0x41700000, v82
    v_fmamk_f32 v88, v84, 0x41700000, v90
    v_fmamk_f32 v80, v81, 0x41200000, v80
    v_fmamk_f32 v88, v89, 0x41200000, v88
    v_cvt_pk_bf16_f32 v39, v77, v85
    v_cvt_pk_bf16_f32 v43, v78, v86
    v_cvt_pk_bf16_f32 v67, v79, v87
    v_cvt_pk_bf16_f32 v71, v82, v90
    v_cvt_pk_bf16_f32 v75, v80, v88
    s_add_u32 s28, s28, 1
    s_waitcnt lgkmcnt(0)
    s_barrier
    ds_write_b128 v96, v[64:67] offset:49152
    ds_write_b128 v97, v[68:71] offset:0
    ds_write_b128 v97, v[72:75] offset:16384
    ds_write_b128 v96, v[32:35] offset:0
    ds_write_b128 v96, v[36:39] offset:16384
    ds_write_b128 v96, v[40:43] offset:32768
    ds_write_b128 v98, v[44:47] offset:0
    v_lshlrev_b32 v76, 16, v48
    v_and_b32 v84, s25, v48
    buffer_load_dwordx4 v[16:19], v92, s[8:11], s27 offen
    buffer_load_dwordx4 v[24:27], v94, s[8:11], s27 offen
    v_lshlrev_b32 v77, 16, v52
    v_and_b32 v85, s25, v52
    v_lshlrev_b32 v78, 16, v56
    v_and_b32 v86, s25, v56
    v_lshlrev_b32 v79, 16, v60
    v_and_b32 v87, s25, v60
    v_add_f32 v80, v76, v78
    v_add_f32 v88, v84, v86
    v_add_f32 v81, v77, v79
    v_add_f32 v89, v85, v87
    v_fma_f32 v82, v78, 4.0, v76
    v_fma_f32 v90, v86, 4.0, v84
    v_fma_f32 v83, v79, 4.0, v77
    v_fma_f32 v91, v87, 4.0, v85
    v_add_f32 v77, v80, v81
    v_add_f32 v85, v88, v89
    v_sub_f32 v78, v80, v81
    buffer_load_dwordx4 v[20:23], v93, s[8:11], s27 offen
    buffer_load_dwordx4 v[28:31], v95, s[8:11], s27 offen
    v_sub_f32 v86, v88, v89
    v_fma_f32 v79, v83, 2.0, v82
    v_fma_f32 v87, v91, 2.0, v90
    v_fma_f32 v82, v83, -2.0, v82
    v_fma_f32 v90, v91, -2.0, v90
    v_fmamk_f32 v80, v76, 0x41700000, v82
    v_fmamk_f32 v88, v84, 0x41700000, v90
    v_fmamk_f32 v80, v81, 0x41200000, v80
    v_fmamk_f32 v88, v89, 0x41200000, v88
    v_cvt_pk_bf16_f32 v52, v77, v85
    v_cvt_pk_bf16_f32 v56, v78, v86
    v_cvt_pk_bf16_f32 v64, v79, v87
    v_cvt_pk_bf16_f32 v68, v82, v90
    v_cvt_pk_bf16_f32 v72, v80, v88
    v_lshlrev_b32 v76, 16, v49
    v_and_b32 v84, s25, v49
    v_lshlrev_b32 v77, 16, v53
    v_and_b32 v85, s25, v53
    v_lshlrev_b32 v78, 16, v57
    v_and_b32 v86, s25, v57
    v_lshlrev_b32 v79, 16, v61
    v_and_b32 v87, s25, v61
    v_add_f32 v80, v76, v78
    v_add_f32 v88, v84, v86
    v_add_f32 v81, v77, v79
    v_add_f32 v89, v85, v87
    v_fma_f32 v82, v78, 4.0, v76
    v_fma_f32 v90, v86, 4.0, v84
    v_fma_f32 v83, v79, 4.0, v77
    v_fma_f32 v91, v87, 4.0, v85
    v_add_f32 v77, v80, v81
    v_add_f32 v85, v88, v89
    v_sub_f32 v78, v80, v81
    v_sub_f32 v86, v88, v89
    v_fma_f32 v79, v83, 2.0, v82
    v_fma_f32 v87, v91, 2.0, v90
    v_fma_f32 v82, v83, -2.0, v82
    v_fma_f32 v90, v91, -2.0, v90
    v_fmamk_f32 v80, v76, 0x41700000, v82
    v_fmamk_f32 v88, v84, 0x41700000, v90
    v_fmamk_f32 v80, v81, 0x41200000, v80
    v_fmamk_f32 v88, v89, 0x41200000, v88
    v_cvt_pk_bf16_f32 v53, v77, v85
    v_cvt_pk_bf16_f32 v57, v78, v86
    v_cvt_pk_bf16_f32 v65, v79, v87
    v_cvt_pk_bf16_f32 v69, v82, v90
    v_cvt_pk_bf16_f32 v73, v80, v88
    v_lshlrev_b32 v76, 16, v50
    v_and_b32 v84, s25, v50
    v_lshlrev_b32 v77, 16, v54
    v_and_b32 v85, s25, v54
    v_lshlrev_b32 v78, 16, v58
    v_and_b32 v86, s25, v58
    v_lshlrev_b32 v79, 16, v62
    v_and_b32 v87, s25, v62
    v_add_f32 v80, v76, v78
    v_add_f32 v88, v84, v86
    v_add_f32 v81, v77, v79
    v_add_f32 v89, v85, v87
    v_fma_f32 v82, v78, 4.0, v76
    v_fma_f32 v90, v86, 4.0, v84
    v_fma_f32 v83, v79, 4.0, v77
    v_fma_f32 v91, v87, 4.0, v85
    v_add_f32 v77, v80, v81
    v_add_f32 v85, v88, v89
    v_sub_f32 v78, v80, v81
    v_sub_f32 v86, v88, v89
    v_fma_f32 v79, v83, 2.0, v82
    v_fma_f32 v87, v91, 2.0, v90
    v_fma_f32 v82, v83, -2.0, v82
    v_fma_f32 v90, v91, -2.0, v90
    v_fmamk_f32 v80, v76, 0x41700000, v82
    v_fmamk_f32 v88, v84, 0x41700000, v90
    v_fmamk_f32 v80, v81, 0x41200000, v80
    v_fmamk_f32 v88, v89, 0x41200000, v88
    v_cvt_pk_bf16_f32 v54, v77, v85
    v_cvt_pk_bf16_f32 v58, v78, v86
    v_cvt_pk_bf16_f32 v66, v79, v87
    v_cvt_pk_bf16_f32 v70, v82, v90
    v_cvt_pk_bf16_f32 v74, v80, v88
    v_lshlrev_b32 v76, 16, v51
    v_and_b32 v84, s25, v51
    v_lshlrev_b32 v77, 16, v55
    v_and_b32 v85, s25, v55
    v_lshlrev_b32 v78, 16, v59
    v_and_b32 v86, s25, v59
    v_lshlrev_b32 v79, 16, v63
    v_and_b32 v87, s25, v63
    v_add_f32 v80, v76, v78
    v_add_f32 v88, v84, v86
    v_add_f32 v81, v77, v79
    v_add_f32 v89, v85, v87
    v_fma_f32 v82, v78, 4.0, v76
    v_fma_f32 v90, v86, 4.0, v84
    v_fma_f32 v83, v79, 4.0, v77
    v_fma_f32 v91, v87, 4.0, v85
    v_add_f32 v77, v80, v81
    v_add_f32 v85, v88, v89
    v_sub_f32 v78, v80, v81
    v_sub_f32 v86, v88, v89
    v_fma_f32 v79, v83, 2.0, v82
    v_fma_f32 v87, v91, 2.0, v90
    v_fma_f32 v82, v83, -2.0, v82
    v_fma_f32 v90, v91, -2.0, v90
    v_fmamk_f32 v80, v76, 0x41700000, v82
    v_fmamk_f32 v88, v84, 0x41700000, v90
    v_fmamk_f32 v80, v81, 0x41200000, v80
    v_fmamk_f32 v88, v89, 0x41200000, v88
    v_cvt_pk_bf16_f32 v55, v77, v85
    v_cvt_pk_bf16_f32 v59, v78, v86
    v_cvt_pk_bf16_f32 v67, v79, v87
    v_cvt_pk_bf16_f32 v71, v82, v90
    v_cvt_pk_bf16_f32 v75, v80, v88
    s_add_u32 s28, s28, 1
    s_waitcnt lgkmcnt(0)
    s_barrier
    s_cmp_eq_u32 s22, 1
    s_cbranch_scc1 L_conv2_kernel_hlast2
    s_add_u32 s24, s24, 1048576
    s_add_u32 s27, s27, 1048576
    ds_write_b128 v96, v[64:67] offset:57344
    ds_write_b128 v97, v[68:71] offset:8192
    ds_write_b128 v97, v[72:75] offset:24576
    ds_write_b128 v96, v[48:51] offset:8192
    ds_write_b128 v96, v[52:55] offset:24576
    ds_write_b128 v96, v[56:59] offset:40960
    ds_write_b128 v98, v[60:63] offset:8704
    s_waitcnt vmcnt(0)
    v_lshlrev_b32 v76, 16, v0
    v_and_b32 v84, s25, v0
    v_lshlrev_b32 v77, 16, v4
    v_and_b32 v85, s25, v4
    v_lshlrev_b32 v78, 16, v8
    v_and_b32 v86, s25, v8
    v_lshlrev_b32 v79, 16, v12
    v_and_b32 v87, s25, v12
    v_add_f32 v80, v76, v78
    v_add_f32 v88, v84, v86
    v_add_f32 v81, v77, v79
    v_add_f32 v89, v85, v87
    v_fma_f32 v82, v78, 4.0, v76
    v_fma_f32 v90, v86, 4.0, v84
    v_fma_f32 v83, v79, 4.0, v77
    v_fma_f32 v91, v87, 4.0, v85
    v_add_f32 v77, v80, v81
    v_add_f32 v85, v88, v89
    v_sub_f32 v78, v80, v81
    v_sub_f32 v86, v88, v89
    v_fma_f32 v79, v83, 2.0, v82
    v_fma_f32 v87, v91, 2.0, v90
    v_fma_f32 v82, v83, -2.0, v82
    v_fma_f32 v90, v91, -2.0, v90
    v_fmamk_f32 v80, v76, 0x41700000, v82
    v_fmamk_f32 v88, v84, 0x41700000, v90
    buffer_load_dwordx4 v[32:35], v92, s[8:11], s24 offen
    buffer_load_dwordx4 v[40:43], v94, s[8:11], s24 offen
    v_fmamk_f32 v80, v81, 0x41200000, v80
    v_fmamk_f32 v88, v89, 0x41200000, v88
    v_cvt_pk_bf16_f32 v4, v77, v85
    v_cvt_pk_bf16_f32 v8, v78, v86
    v_cvt_pk_bf16_f32 v64, v79, v87
    v_cvt_pk_bf16_f32 v68, v82, v90
    v_cvt_pk_bf16_f32 v72, v80, v88
    v_lshlrev_b32 v76, 16, v1
    v_and_b32 v84, s25, v1
    v_lshlrev_b32 v77, 16, v5
    v_and_b32 v85, s25, v5
    v_lshlrev_b32 v78, 16, v9
    v_and_b32 v86, s25, v9
    v_lshlrev_b32 v79, 16, v13
    v_and_b32 v87, s25, v13
    v_add_f32 v80, v76, v78
    v_add_f32 v88, v84, v86
    v_add_f32 v81, v77, v79
    v_add_f32 v89, v85, v87
    v_fma_f32 v82, v78, 4.0, v76
    v_fma_f32 v90, v86, 4.0, v84
    v_fma_f32 v83, v79, 4.0, v77
    v_fma_f32 v91, v87, 4.0, v85
    v_add_f32 v77, v80, v81
    v_add_f32 v85, v88, v89
    v_sub_f32 v78, v80, v81
    v_sub_f32 v86, v88, v89
    v_fma_f32 v79, v83, 2.0, v82
    v_fma_f32 v87, v91, 2.0, v90
    v_fma_f32 v82, v83, -2.0, v82
    v_fma_f32 v90, v91, -2.0, v90
    v_fmamk_f32 v80, v76, 0x41700000, v82
    v_fmamk_f32 v88, v84, 0x41700000, v90
    v_fmamk_f32 v80, v81, 0x41200000, v80
    v_fmamk_f32 v88, v89, 0x41200000, v88
    v_cvt_pk_bf16_f32 v5, v77, v85
    v_cvt_pk_bf16_f32 v9, v78, v86
    v_cvt_pk_bf16_f32 v65, v79, v87
    v_cvt_pk_bf16_f32 v69, v82, v90
    v_cvt_pk_bf16_f32 v73, v80, v88
    v_lshlrev_b32 v76, 16, v2
    v_and_b32 v84, s25, v2
    v_lshlrev_b32 v77, 16, v6
    v_and_b32 v85, s25, v6
    v_lshlrev_b32 v78, 16, v10
    v_and_b32 v86, s25, v10
    v_lshlrev_b32 v79, 16, v14
    v_and_b32 v87, s25, v14
    v_add_f32 v80, v76, v78
    v_add_f32 v88, v84, v86
    v_add_f32 v81, v77, v79
    v_add_f32 v89, v85, v87
    v_fma_f32 v82, v78, 4.0, v76
    buffer_load_dwordx4 v[36:39], v93, s[8:11], s24 offen
    buffer_load_dwordx4 v[44:47], v95, s[8:11], s24 offen
    v_fma_f32 v90, v86, 4.0, v84
    v_fma_f32 v83, v79, 4.0, v77
    v_fma_f32 v91, v87, 4.0, v85
    v_add_f32 v77, v80, v81
    v_add_f32 v85, v88, v89
    v_sub_f32 v78, v80, v81
    v_sub_f32 v86, v88, v89
    v_fma_f32 v79, v83, 2.0, v82
    v_fma_f32 v87, v91, 2.0, v90
    v_fma_f32 v82, v83, -2.0, v82
    v_fma_f32 v90, v91, -2.0, v90
    v_fmamk_f32 v80, v76, 0x41700000, v82
    v_fmamk_f32 v88, v84, 0x41700000, v90
    v_fmamk_f32 v80, v81, 0x41200000, v80
    v_fmamk_f32 v88, v89, 0x41200000, v88
    v_cvt_pk_bf16_f32 v6, v77, v85
    v_cvt_pk_bf16_f32 v10, v78, v86
    v_cvt_pk_bf16_f32 v66, v79, v87
    v_cvt_pk_bf16_f32 v70, v82, v90
    v_cvt_pk_bf16_f32 v74, v80, v88
    v_lshlrev_b32 v76, 16, v3
    v_and_b32 v84, s25, v3
    v_lshlrev_b32 v77, 16, v7
    v_and_b32 v85, s25, v7
    v_lshlrev_b32 v78, 16, v11
    v_and_b32 v86, s25, v11
    v_lshlrev_b32 v79, 16, v15
    v_and_b32 v87, s25, v15
    v_add_f32 v80, v76, v78
    v_add_f32 v88, v84, v86
    v_add_f32 v81, v77, v79
    v_add_f32 v89, v85, v87
    v_fma_f32 v82, v78, 4.0, v76
    v_fma_f32 v90, v86, 4.0, v84
    v_fma_f32 v83, v79, 4.0, v77
    v_fma_f32 v91, v87, 4.0, v85
    v_add_f32 v77, v80, v81
    v_add_f32 v85, v88, v89
    v_sub_f32 v78, v80, v81
    v_sub_f32 v86, v88, v89
    v_fma_f32 v79, v83, 2.0, v82
    v_fma_f32 v87, v91, 2.0, v90
    v_fma_f32 v82, v83, -2.0, v82
    v_fma_f32 v90, v91, -2.0, v90
    v_fmamk_f32 v80, v76, 0x41700000, v82
    v_fmamk_f32 v88, v84, 0x41700000, v90
    v_fmamk_f32 v80, v81, 0x41200000, v80
    v_fmamk_f32 v88, v89, 0x41200000, v88
    v_cvt_pk_bf16_f32 v7, v77, v85
    v_cvt_pk_bf16_f32 v11, v78, v86
    v_cvt_pk_bf16_f32 v67, v79, v87
    v_cvt_pk_bf16_f32 v71, v82, v90
    v_cvt_pk_bf16_f32 v75, v80, v88
    s_add_u32 s28, s28, 1
    s_waitcnt lgkmcnt(0)
    s_barrier
    ds_write_b128 v96, v[64:67] offset:49152
    ds_write_b128 v97, v[68:71] offset:0
    ds_write_b128 v97, v[72:75] offset:16384
    ds_write_b128 v96, v[0:3] offset:0
    ds_write_b128 v96, v[4:7] offset:16384
    ds_write_b128 v96, v[8:11] offset:32768
    ds_write_b128 v98, v[12:15] offset:0
    v_lshlrev_b32 v76, 16, v16
    v_and_b32 v84, s25, v16
    buffer_load_dwordx4 v[48:51], v92, s[8:11], s27 offen
    buffer_load_dwordx4 v[56:59], v94, s[8:11], s27 offen
    v_lshlrev_b32 v77, 16, v20
    v_and_b32 v85, s25, v20
    v_lshlrev_b32 v78, 16, v24
    v_and_b32 v86, s25, v24
    v_lshlrev_b32 v79, 16, v28
    v_and_b32 v87, s25, v28
    v_add_f32 v80, v76, v78
    v_add_f32 v88, v84, v86
    v_add_f32 v81, v77, v79
    v_add_f32 v89, v85, v87
    v_fma_f32 v82, v78, 4.0, v76
    v_fma_f32 v90, v86, 4.0, v84
    v_fma_f32 v83, v79, 4.0, v77
    v_fma_f32 v91, v87, 4.0, v85
    v_add_f32 v77, v80, v81
    v_add_f32 v85, v88, v89
    v_sub_f32 v78, v80, v81
    buffer_load_dwordx4 v[52:55], v93, s[8:11], s27 offen
    buffer_load_dwordx4 v[60:63], v95, s[8:11], s27 offen
    v_sub_f32 v86, v88, v89
    v_fma_f32 v79, v83, 2.0, v82
    v_fma_f32 v87, v91, 2.0, v90
    v_fma_f32 v82, v83, -2.0, v82
    v_fma_f32 v90, v91, -2.0, v90
    v_fmamk_f32 v80, v76, 0x41700000, v82
    v_fmamk_f32 v88, v84, 0x41700000, v90
    v_fmamk_f32 v80, v81, 0x41200000, v80
    v_fmamk_f32 v88, v89, 0x41200000, v88
    v_cvt_pk_bf16_f32 v20, v77, v85
    v_cvt_pk_bf16_f32 v24, v78, v86
    v_cvt_pk_bf16_f32 v64, v79, v87
    v_cvt_pk_bf16_f32 v68, v82, v90
    v_cvt_pk_bf16_f32 v72, v80, v88
    v_lshlrev_b32 v76, 16, v17
    v_and_b32 v84, s25, v17
    v_lshlrev_b32 v77, 16, v21
    v_and_b32 v85, s25, v21
    v_lshlrev_b32 v78, 16, v25
    v_and_b32 v86, s25, v25
    v_lshlrev_b32 v79, 16, v29
    v_and_b32 v87, s25, v29
    v_add_f32 v80, v76, v78
    v_add_f32 v88, v84, v86
    v_add_f32 v81, v77, v79
    v_add_f32 v89, v85, v87
    v_fma_f32 v82, v78, 4.0, v76
    v_fma_f32 v90, v86, 4.0, v84
    v_fma_f32 v83, v79, 4.0, v77
    v_fma_f32 v91, v87, 4.0, v85
    v_add_f32 v77, v80, v81
    v_add_f32 v85, v88, v89
    v_sub_f32 v78, v80, v81
    v_sub_f32 v86, v88, v89
    v_fma_f32 v79, v83, 2.0, v82
    v_fma_f32 v87, v91, 2.0, v90
    v_fma_f32 v82, v83, -2.0, v82
    v_fma_f32 v90, v91, -2.0, v90
    v_fmamk_f32 v80, v76, 0x41700000, v82
    v_fmamk_f32 v88, v84, 0x41700000, v90
    v_fmamk_f32 v80, v81, 0x41200000, v80
    v_fmamk_f32 v88, v89, 0x41200000, v88
    v_cvt_pk_bf16_f32 v21, v77, v85
    v_cvt_pk_bf16_f32 v25, v78, v86
    v_cvt_pk_bf16_f32 v65, v79, v87
    v_cvt_pk_bf16_f32 v69, v82, v90
    v_cvt_pk_bf16_f32 v73, v80, v88
    v_lshlrev_b32 v76, 16, v18
    v_and_b32 v84, s25, v18
    v_lshlrev_b32 v77, 16, v22
    v_and_b32 v85, s25, v22
    v_lshlrev_b32 v78, 16, v26
    v_and_b32 v86, s25, v26
    v_lshlrev_b32 v79, 16, v30
    v_and_b32 v87, s25, v30
    v_add_f32 v80, v76, v78
    v_add_f32 v88, v84, v86
    v_add_f32 v81, v77, v79
    v_add_f32 v89, v85, v87
    v_fma_f32 v82, v78, 4.0, v76
    v_fma_f32 v90, v86, 4.0, v84
    v_fma_f32 v83, v79, 4.0, v77
    v_fma_f32 v91, v87, 4.0, v85
    v_add_f32 v77, v80, v81
    v_add_f32 v85, v88, v89
    v_sub_f32 v78, v80, v81
    v_sub_f32 v86, v88, v89
    v_fma_f32 v79, v83, 2.0, v82
    v_fma_f32 v87, v91, 2.0, v90
    v_fma_f32 v82, v83, -2.0, v82
    v_fma_f32 v90, v91, -2.0, v90
    v_fmamk_f32 v80, v76, 0x41700000, v82
    v_fmamk_f32 v88, v84, 0x41700000, v90
    v_fmamk_f32 v80, v81, 0x41200000, v80
    v_fmamk_f32 v88, v89, 0x41200000, v88
    v_cvt_pk_bf16_f32 v22, v77, v85
    v_cvt_pk_bf16_f32 v26, v78, v86
    v_cvt_pk_bf16_f32 v66, v79, v87
    v_cvt_pk_bf16_f32 v70, v82, v90
    v_cvt_pk_bf16_f32 v74, v80, v88
    v_lshlrev_b32 v76, 16, v19
    v_and_b32 v84, s25, v19
    v_lshlrev_b32 v77, 16, v23
    v_and_b32 v85, s25, v23
    v_lshlrev_b32 v78, 16, v27
    v_and_b32 v86, s25, v27
    v_lshlrev_b32 v79, 16, v31
    v_and_b32 v87, s25, v31
    v_add_f32 v80, v76, v78
    v_add_f32 v88, v84, v86
    v_add_f32 v81, v77, v79
    v_add_f32 v89, v85, v87
    v_fma_f32 v82, v78, 4.0, v76
    v_fma_f32 v90, v86, 4.0, v84
    v_fma_f32 v83, v79, 4.0, v77
    v_fma_f32 v91, v87, 4.0, v85
    v_add_f32 v77, v80, v81
    v_add_f32 v85, v88, v89
    v_sub_f32 v78, v80, v81
    v_sub_f32 v86, v88, v89
    v_fma_f32 v79, v83, 2.0, v82
    v_fma_f32 v87, v91, 2.0, v90
    v_fma_f32 v82, v83, -2.0, v82
    v_fma_f32 v90, v91, -2.0, v90
    v_fmamk_f32 v80, v76, 0x41700000, v82
    v_fmamk_f32 v88, v84, 0x41700000, v90
    v_fmamk_f32 v80, v81, 0x41200000, v80
    v_fmamk_f32 v88, v89, 0x41200000, v88
    v_cvt_pk_bf16_f32 v23, v77, v85
    v_cvt_pk_bf16_f32 v27, v78, v86
    v_cvt_pk_bf16_f32 v67, v79, v87
    v_cvt_pk_bf16_f32 v71, v82, v90
    v_cvt_pk_bf16_f32 v75, v80, v88
    s_add_u32 s28, s28, 1
    s_waitcnt lgkmcnt(0)
    s_barrier
    s_sub_u32 s22, s22, 1
    s_branch L_conv2_kernel_hloop2
L_conv2_kernel_hlast2:
    s_mov_b32 s25, 0xffff0000
    ds_write_b128 v96, v[64:67] offset:57344
    ds_write_b128 v97, v[68:71] offset:8192
    ds_write_b128 v97, v[72:75] offset:24576
    ds_write_b128 v96, v[48:51] offset:8192
    ds_write_b128 v96, v[52:55] offset:24576
    ds_write_b128 v96, v[56:59] offset:40960
    ds_write_b128 v98, v[60:63] offset:8704
    s_waitcnt lgkmcnt(0)
    s_barrier
    s_branch L_conv2_kernel_end
L_conv2_kernel_epi:
    v_and_b32 v108, 15, v127
    v_lshrrev_b32 v109, 4, v127
    v_lshrrev_b32 v110, 3, v108
    s_lshl_b32 s36, s20, 1
    v_add_u32 v110, s36, v110
    v_xor_b32 v111, v110, v108
    v_and_b32 v111, 7, v111
    v_lshlrev_b32 v111, 4, v111
    v_lshl_add_u32 v111, v110, 7, v111
    v_lshl_add_u32 v120, v109, 11, v111
    v_add_u32 v121, 65536, v120
    v_add_u32 v125, 131072, v120
    s_lshl_b32 s36, s20, 9
    s_add_u32 s36, s36, 115712
    v_lshl_add_u32 v123, v109, 7, s36
    s_lshl_b32 s36, s20, 4
    v_add_u32 v108, s36, v108
    v_lshlrev_b32 v110, 6, v108
    v_lshl_add_u32 v110, v109, 4, v110
    s_mul_i32 s36, s29, 262144
    s_lshl_b32 s37, s21, 4
    s_add_u32 s36, s36, s37
    v_add_u32 v110, s36, v110
    v_mov_b32 v111, 2130706432
    v_cmp_gt_u32 vcc, 125, v108
    s_mov_b32 s4, 0xbeaaaaab
    s_mov_b32 s5, s4
    s_mov_b32 s6, 0x3e800000
    s_mov_b32 s7, s6
    s_mov_b32 s8, 0xc0a00000
    s_mov_b32 s9, s8
    s_mov_b32 s10, 0xc0638e39
    s_mov_b32 s11, s10
    s_mov_b32 s12, 0xbf638e39
    s_mov_b32 s13, s12
    s_mov_b32 s14, 0xbe638e39
    s_mov_b32 s15, s14
    s_mov_b32 s22, 0xbd638e39
    s_mov_b32 s23, s22
    s_mov_b32 s24, 0x3ff1c71c
    s_mov_b32 s25, s24
    s_mov_b32 s26, 0xbf2aaaab
    s_mov_b32 s27, s26
    s_mov_b32 s32, 0x3ecccccd
    s_mov_b32 s33, s32
    s_mov_b32 s34, 0xbd888889
    s_mov_b32 s35, s34
    s_mov_b32 s38, 0xbe4ccccd
    s_mov_b32 s39, s38
    s_mov_b32 s40, 0xbdd2d3e8
    s_mov_b32 s41, s40
    s_mov_b32 s42, 0x3f800000
    s_mov_b32 s43, s42
    s_waitcnt lgkmcnt(0)
    s_barrier
    v_cndmask_b32 v122, v111, v110, vcc
    ds_read_b128 v[0:3], v120 offset:0
    ds_read_b128 v[4:7], v120 offset:16384
    ds_read_b128 v[8:11], v120 offset:32768
    ds_read_b128 v[12:15], v120 offset:49152
    ds_read_b128 v[16:19], v121 offset:0
    ds_read_b128 v[20:23], v121 offset:16384
    ds_read_b128 v[24:27], v121 offset:32768
    ds_read_b128 v[28:31], v125 offset:15360
    ds_read_b128 v[32:35], v120 offset:8192
    ds_read_b128 v[36:39], v120 offset:24576
    ds_read_b128 v[40:43], v120 offset:40960
    ds_read_b128 v[44:47], v120 offset:57344
    ds_read_b128 v[48:51], v121 offset:56320
    ds_read_b128 v[52:55], v121 offset:64512
    ds_read_b128 v[56:59], v125 offset:7168
    s_waitcnt lgkmcnt(7)
    ds_read_b128 v[60:63], v125 offset:23552
    s_waitcnt lgkmcnt(8)
    v_pk_add_f32 v[88:89], v[24:25], v[28:29]
    v_pk_add_f32 v[90:91], v[26:27], v[30:31]
    v_pk_add_f32 v[24:25], v[4:5], v[8:9]
    v_pk_add_f32 v[26:27], v[6:7], v[10:11]
    v_pk_add_f32 v[4:5], v[4:5], v[8:9] neg_lo:[0,1] neg_hi:[0,1]
    v_pk_add_f32 v[6:7], v[6:7], v[10:11] neg_lo:[0,1] neg_hi:[0,1]
    v_pk_add_f32 v[72:73], v[12:13], v[16:17]
    v_pk_add_f32 v[74:75], v[14:15], v[18:19]
    v_pk_add_f32 v[12:13], v[12:13], v[16:17] neg_lo:[0,1] neg_hi:[0,1]
    v_pk_add_f32 v[14:15], v[14:15], v[18:19] neg_lo:[0,1] neg_hi:[0,1]
    v_pk_fma_f32 v[72:73], v[24:25], s[4:5], v[72:73]
    v_pk_fma_f32 v[74:75], v[26:27], s[4:5], v[74:75]
    v_pk_fma_f32 v[20:21], v[0:1], s[10:11], v[20:21]
    v_pk_fma_f32 v[22:23], v[2:3], s[10:11], v[22:23]
    v_pk_fma_f32 v[72:73], v[0:1], s[6:7], v[72:73]
    v_pk_fma_f32 v[74:75], v[2:3], s[6:7], v[74:75]
    v_pk_add_f32 v[24:25], v[24:25], v[0:1] neg_lo:[0,1] neg_hi:[0,1]
    v_pk_add_f32 v[26:27], v[26:27], v[2:3] neg_lo:[0,1] neg_hi:[0,1]
    v_pk_fma_f32 v[72:73], v[88:89], s[8:9], v[72:73]
    v_pk_fma_f32 v[74:75], v[90:91], s[8:9], v[74:75]
    v_pk_add_f32 v[24:25], v[24:25], v[88:89] neg_lo:[0,1] neg_hi:[0,1]
    v_pk_add_f32 v[26:27], v[26:27], v[90:91] neg_lo:[0,1] neg_hi:[0,1]
    v_pk_fma_f32 v[20:21], v[88:89], s[22:23], v[20:21]
    v_pk_fma_f32 v[22:23], v[90:91], s[22:23], v[22:23]
    v_pk_add_f32 v[8:9], v[24:25], v[72:73] neg_lo:[0,1] neg_hi:[0,1]
    v_pk_add_f32 v[10:11], v[26:27], v[74:75] neg_lo:[0,1] neg_hi:[0,1]
    v_pk_fma_f32 v[20:21], v[72:73], s[14:15], v[20:21]
    v_pk_fma_f32 v[22:23], v[74:75], s[14:15], v[22:23]
    v_pk_mul_f32 v[80:81], v[12:13], s[32:33]
    v_pk_mul_f32 v[82:83], v[14:15], s[32:33]
    v_pk_fma_f32 v[20:21], v[8:9], s[12:13], v[20:21]
    v_pk_fma_f32 v[22:23], v[10:11], s[12:13], v[22:23]
    v_pk_fma_f32 v[80:81], v[4:5], s[34:35], v[80:81]
    v_pk_fma_f32 v[82:83], v[6:7], s[34:35], v[82:83]
    v_pk_fma_f32 v[64:65], v[4:5], s[24:25], v[20:21] neg_lo:[0,0,1] neg_hi:[0,0,1]
    v_pk_fma_f32 v[66:67], v[6:7], s[24:25], v[22:23] neg_lo:[0,0,1] neg_hi:[0,0,1]
    v_pk_fma_f32 v[64:65], v[12:13], s[26:27], v[64:65]
    v_pk_fma_f32 v[66:67], v[14:15], s[26:27], v[66:67]
    v_pk_fma_f32 v[80:81], v[64:65], s[38:39], v[80:81]
    v_pk_fma_f32 v[82:83], v[66:67], s[38:39], v[82:83]
    v_pk_add_f32 v[4:5], v[4:5], v[64:65] neg_lo:[0,1] neg_hi:[0,1]
    v_pk_add_f32 v[6:7], v[6:7], v[66:67] neg_lo:[0,1] neg_hi:[0,1]
    v_pk_add_f32 v[4:5], v[4:5], v[80:81] neg_lo:[0,1] neg_hi:[0,1]
    v_pk_add_f32 v[6:7], v[6:7], v[82:83] neg_lo:[0,1] neg_hi:[0,1]
    s_waitcnt lgkmcnt(0)
    v_pk_add_f32 v[92:93], v[56:57], v[60:61]
    v_pk_add_f32 v[94:95], v[58:59], v[62:63]
    v_pk_add_f32 v[56:57], v[36:37], v[40:41]
    v_pk_add_f32 v[58:59], v[38:39], v[42:43]
    v_pk_add_f32 v[36:37], v[36:37], v[40:41] neg_lo:[0,1] neg_hi:[0,1]
    v_pk_add_f32 v[38:39], v[38:39], v[42:43] neg_lo:[0,1] neg_hi:[0,1]
    v_pk_add_f32 v[76:77], v[44:45], v[48:49]
    v_pk_add_f32 v[78:79], v[46:47], v[50:51]
    v_pk_add_f32 v[44:45], v[44:45], v[48:49] neg_lo:[0,1] neg_hi:[0,1]
    v_pk_add_f32 v[46:47], v[46:47], v[50:51] neg_lo:[0,1] neg_hi:[0,1]
    v_pk_fma_f32 v[76:77], v[56:57], s[4:5], v[76:77]
    v_pk_fma_f32 v[78:79], v[58:59], s[4:5], v[78:79]
    v_pk_fma_f32 v[52:53], v[32:33], s[10:11], v[52:53]
    v_pk_fma_f32 v[54:55], v[34:35], s[10:11], v[54:55]
    v_pk_fma_f32 v[76:77], v[32:33], s[6:7], v[76:77]
    v_pk_fma_f32 v[78:79], v[34:35], s[6:7], v[78:79]
    v_pk_add_f32 v[56:57], v[56:57], v[32:33] neg_lo:[0,1] neg_hi:[0,1]
    v_pk_add_f32 v[58:59], v[58:59], v[34:35] neg_lo:[0,1] neg_hi:[0,1]
    v_pk_fma_f32 v[76:77], v[92:93], s[8:9], v[76:77]
    v_pk_fma_f32 v[78:79], v[94:95], s[8:9], v[78:79]
    v_pk_add_f32 v[56:57], v[56:57], v[92:93] neg_lo:[0,1] neg_hi:[0,1]
    v_pk_add_f32 v[58:59], v[58:59], v[94:95] neg_lo:[0,1] neg_hi:[0,1]
    v_pk_fma_f32 v[52:53], v[92:93], s[22:23], v[52:53]
    v_pk_fma_f32 v[54:55], v[94:95], s[22:23], v[54:55]
    v_pk_add_f32 v[40:41], v[56:57], v[76:77] neg_lo:[0,1] neg_hi:[0,1]
    v_pk_add_f32 v[42:43], v[58:59], v[78:79] neg_lo:[0,1] neg_hi:[0,1]
    v_pk_fma_f32 v[52:53], v[76:77], s[14:15], v[52:53]
    v_pk_fma_f32 v[54:55], v[78:79], s[14:15], v[54:55]
    v_pk_mul_f32 v[84:85], v[44:45], s[32:33]
    v_pk_mul_f32 v[86:87], v[46:47], s[32:33]
    v_pk_fma_f32 v[52:53], v[40:41], s[12:13], v[52:53]
    v_pk_fma_f32 v[54:55], v[42:43], s[12:13], v[54:55]
    v_pk_fma_f32 v[84:85], v[36:37], s[34:35], v[84:85]
    v_pk_fma_f32 v[86:87], v[38:39], s[34:35], v[86:87]
    v_pk_fma_f32 v[68:69], v[36:37], s[24:25], v[52:53] neg_lo:[0,0,1] neg_hi:[0,0,1]
    v_pk_fma_f32 v[70:71], v[38:39], s[24:25], v[54:55] neg_lo:[0,0,1] neg_hi:[0,0,1]
    v_pk_fma_f32 v[68:69], v[44:45], s[26:27], v[68:69]
    v_pk_fma_f32 v[70:71], v[46:47], s[26:27], v[70:71]
    v_pk_fma_f32 v[84:85], v[68:69], s[38:39], v[84:85]
    v_pk_fma_f32 v[86:87], v[70:71], s[38:39], v[86:87]
    v_pk_add_f32 v[36:37], v[36:37], v[68:69] neg_lo:[0,1] neg_hi:[0,1]
    v_pk_add_f32 v[38:39], v[38:39], v[70:71] neg_lo:[0,1] neg_hi:[0,1]
    v_pk_add_f32 v[36:37], v[36:37], v[84:85] neg_lo:[0,1] neg_hi:[0,1]
    v_pk_add_f32 v[38:39], v[38:39], v[86:87] neg_lo:[0,1] neg_hi:[0,1]
    s_mov_b32 s36, 0x00010001
    s_mov_b32 s37, 0x00010001
    s_mov_b64 exec, s[36:37]
    ds_write_b128 v123, v[0:3] offset:0
    ds_write_b128 v123, v[32:35] offset:16
    ds_write_b128 v123, v[4:7] offset:32
    ds_write_b128 v123, v[36:39] offset:48
    ds_write_b128 v123, v[8:11] offset:64
    ds_write_b128 v123, v[40:43] offset:80
    s_mov_b64 exec, -1
    v_mov_b32 v44, 0xc0135761
    v_mov_b32 v45, v44
    v_cvt_pk_bf16_f32 v48, v64, v68
    v_cvt_pk_bf16_f32 v49, v65, v69
    v_cvt_pk_bf16_f32 v50, v66, v70
    v_cvt_pk_bf16_f32 v51, v67, v71
    s_mov_b32 s44, 0
    buffer_store_dwordx4 v[48:51], v122, s[16:19], s44 offen sc1
    s_waitcnt lgkmcnt(0)
    s_barrier
    ds_read_b128 v[96:99], v123 offset:512
    ds_read_b128 v[100:103], v123 offset:528
    ds_read_b128 v[104:107], v123 offset:544
    ds_read_b128 v[108:111], v123 offset:560
    ds_read_b128 v[112:115], v123 offset:576
    ds_read_b128 v[116:119], v123 offset:592
    s_waitcnt lgkmcnt(4)
    v_mov_b32_dpp v96, v0 row_shl:1 row_mask:0xf bank_mask:0xf
    v_mov_b32_dpp v97, v1 row_shl:1 row_mask:0xf bank_mask:0xf
    v_mov_b32_dpp v98, v2 row_shl:1 row_mask:0xf bank_mask:0xf
    v_mov_b32_dpp v99, v3 row_shl:1 row_mask:0xf bank_mask:0xf
    v_mov_b32_dpp v100, v32 row_shl:1 row_mask:0xf bank_mask:0xf
    v_mov_b32_dpp v101, v33 row_shl:1 row_mask:0xf bank_mask:0xf
    v_mov_b32_dpp v102, v34 row_shl:1 row_mask:0xf bank_mask:0xf
    v_mov_b32_dpp v103, v35 row_shl:1 row_mask:0xf bank_mask:0xf
    v_pk_add_f32 v[72:73], v[72:73], v[96:97]
    v_pk_add_f32 v[74:75], v[74:75], v[98:99]
    v_pk_add_f32 v[76:77], v[76:77], v[100:101]
    v_pk_add_f32 v[78:79], v[78:79], v[102:103]
    v_cvt_pk_bf16_f32 v52, v72, v76
    v_cvt_pk_bf16_f32 v53, v73, v77
    v_cvt_pk_bf16_f32 v54, v74, v78
    v_cvt_pk_bf16_f32 v55, v75, v79
    s_mov_b32 s44, 65536
    buffer_store_dwordx4 v[52:55], v122, s[16:19], s44 offen sc1
    s_waitcnt lgkmcnt(2)
    v_mov_b32_dpp v104, v4 row_shl:1 row_mask:0xf bank_mask:0xf
    v_mov_b32_dpp v105, v5 row_shl:1 row_mask:0xf bank_mask:0xf
    v_mov_b32_dpp v106, v6 row_shl:1 row_mask:0xf bank_mask:0xf
    v_mov_b32_dpp v107, v7 row_shl:1 row_mask:0xf bank_mask:0xf
    v_mov_b32_dpp v108, v36 row_shl:1 row_mask:0xf bank_mask:0xf
    v_mov_b32_dpp v109, v37 row_shl:1 row_mask:0xf bank_mask:0xf
    v_mov_b32_dpp v110, v38 row_shl:1 row_mask:0xf bank_mask:0xf
    v_mov_b32_dpp v111, v39 row_shl:1 row_mask:0xf bank_mask:0xf
    v_pk_add_f32 v[80:81], v[80:81], v[104:105]
    v_pk_add_f32 v[82:83], v[82:83], v[106:107]
    v_pk_add_f32 v[84:85], v[84:85], v[108:109]
    v_pk_add_f32 v[86:87], v[86:87], v[110:111]
    v_cvt_pk_bf16_f32 v56, v80, v84
    v_cvt_pk_bf16_f32 v57, v81, v85
    v_cvt_pk_bf16_f32 v58, v82, v86
    v_cvt_pk_bf16_f32 v59, v83, v87
    s_mov_b32 s44, 131072
    buffer_store_dwordx4 v[56:59], v122, s[16:19], s44 offen sc1
    s_waitcnt lgkmcnt(0)
    v_mov_b32_dpp v112, v8 row_shl:1 row_mask:0xf bank_mask:0xf
    v_mov_b32_dpp v113, v9 row_shl:1 row_mask:0xf bank_mask:0xf
    v_mov_b32_dpp v114, v10 row_shl:1 row_mask:0xf bank_mask:0xf
    v_mov_b32_dpp v115, v11 row_shl:1 row_mask:0xf bank_mask:0xf
    v_mov_b32_dpp v116, v40 row_shl:1 row_mask:0xf bank_mask:0xf
    v_mov_b32_dpp v117, v41 row_shl:1 row_mask:0xf bank_mask:0xf
    v_mov_b32_dpp v118, v42 row_shl:1 row_mask:0xf bank_mask:0xf
    v_mov_b32_dpp v119, v43 row_shl:1 row_mask:0xf bank_mask:0xf
    v_pk_add_f32 v[88:89], v[88:89], v[112:113]
    v_pk_add_f32 v[90:91], v[90:91], v[114:115]
    v_pk_add_f32 v[92:93], v[92:93], v[116:117]
    v_pk_add_f32 v[94:95], v[94:95], v[118:119]
    v_cvt_pk_bf16_f32 v60, v88, v92
    v_cvt_pk_bf16_f32 v61, v89, v93
    v_cvt_pk_bf16_f32 v62, v90, v94
    v_cvt_pk_bf16_f32 v63, v91, v95
    s_mov_b32 s44, 196608
    buffer_store_dwordx4 v[60:63], v122, s[16:19], s44 offen sc1
L_conv2_kernel_end:
L_conv2_kernel_done:
    s_endpgm
.globl joint_kernel
.p2align 8
.type joint_kernel,@function
joint_kernel:
    s_cmp_ge_u32 s2, 250
    s_cbranch_scc1 L_joint_kernel_done
    s_load_dwordx2 s[28:29], s[0:1], 56
    s_load_dwordx2 s[30:31], s[0:1], 72
    v_readfirstlane_b32 s20, v0
    s_lshr_b32 s20, s20, 6
    s_and_b32 s21, s20, 3
    v_and_b32 v255, 63, v0
    v_lshlrev_b32 v254, 4, v255
    s_cmp_ge_u32 s20, 4
    s_mov_b32 s33, 44171264
    s_cselect_b32 s33, 44040192, s33
    s_lshl_b32 s36, s21, 15
    s_add_u32 s33, s33, s36
    s_mov_b32 s14, 32768
    s_mov_b32 s15, 0x00020000
    s_lshl_b32 s35, s2, 9
    s_cmp_ge_u32 s2, 125
    s_cselect_b32 s36, 2033152, 0
    s_add_u32 s35, s35, s36
    s_mov_b32 s10, 12582912
    s_mov_b32 s11, 0x00020000
    s_waitcnt lgkmcnt(0)
    s_add_u32 s12, s30, s33
    s_addc_u32 s13, s31, 0
    s_cmp_ge_u32 s20, 4
    s_cbranch_scc1 L_joint_kernel_T
    s_add_u32 s8, s30, 27262976
    s_addc_u32 s9, s31, 0
    v_lshrrev_b32 v252, 5, v255
    v_and_b32 v251, 0x1ff, v254
    v_mul_u32_u24 v253, 65536, v252
    v_add_u32 v251, v253, v251
    s_mul_i32 s36, s20, 524288
    s_add_u32 s36, s36, s35
    s_add_u32 s37, s36, 8388608
    buffer_load_dwordx4 v[128:131], v251, s[8:11], s36 offen
    buffer_load_dwordx4 v[144:147], v251, s[8:11], s37 offen
    s_add_u32 s36, s36, 131072
    s_add_u32 s37, s36, 8388608
    buffer_load_dwordx4 v[132:135], v251, s[8:11], s36 offen
    buffer_load_dwordx4 v[148:151], v251, s[8:11], s37 offen
    s_add_u32 s36, s36, 131072
    s_add_u32 s37, s36, 8388608
    buffer_load_dwordx4 v[136:139], v251, s[8:11], s36 offen
    buffer_load_dwordx4 v[152:155], v251, s[8:11], s37 offen
    s_add_u32 s36, s36, 131072
    s_add_u32 s37, s36, 8388608
    buffer_load_dwordx4 v[140:143], v251, s[8:11], s36 offen
    buffer_load_dwordx4 v[156:159], v251, s[8:11], s37 offen
    s_cmp_ge_u32 s2, 125
    s_cselect_b32 s34, 8192, 0
    s_add_u32 s34, s34, 44302336
    s_add_u32 s40, s30, s34
    s_addc_u32 s41, s31, 0
    s_mov_b32 s42, 24576
    s_mov_b32 s43, 0x00020000
    s_lshl_b32 s38, s20, 11
    s_add_u32 s38, s38, 16384
    buffer_load_dwordx4 v[192:195], v254, s[40:43], s38 offen offset:0
    buffer_load_dwordx4 v[196:199], v254, s[40:43], s38 offen offset:1024
    s_barrier
    s_lshl_b32 s35, s2, 17
    s_add_u32 s16, s28, s35
    s_addc_u32 s17, s29, 0
    s_mov_b32 s18, 131072
    s_mov_b32 s19, 0x00020000
    s_mov_b32 s44, 0xbdd2d3e8
    v_mov_b32 v253, 0xc0135761
    v_bfe_u32 v251, v255, 2, 3
    v_lshl_add_u32 v252, v251, 2, v252
    v_mul_u32_u24 v252, 528, v252
    v_and_b32 v251, 0x30, v254
    s_lshl_b32 s36, s20, 7
    v_add3_u32 v252, v252, v251, s36
    s_mov_b32 s45, 0xffff0000
    s_mov_b32 s46, s44
    s_mov_b32 s47, s44
    s_mov_b32 s48, 1.0
    s_mov_b32 s49, 1.0
    v_mov_b32 v248, v253
    v_mov_b32 v249, v253
    s_mov_b32 s22, 2
L_joint_kernel_floop:
    s_waitcnt vmcnt(8)
    v_lshlrev_b32 v168, 16, v128
    v_and_b32 v169, s45, v128
    v_lshlrev_b32 v232, 16, v144
    v_and_b32 v233, s45, v144
    v_lshlrev_b32 v170, 16, v129
    v_and_b32 v171, s45, v129
    v_lshlrev_b32 v234, 16, v145
    v_and_b32 v235, s45, v145
    v_lshlrev_b32 v172, 16, v130
    v_and_b32 v173, s45, v130
    v_lshlrev_b32 v236, 16, v146
    v_and_b32 v237, s45, v146
    v_lshlrev_b32 v174, 16, v131
    v_and_b32 v175, s45, v131
    v_lshlrev_b32 v238, 16, v147
    v_and_b32 v239, s45, v147
    v_pk_add_f32 v[168:169], v[168:169], v[232:233]
    v_pk_add_f32 v[170:171], v[170:171], v[234:235]
    v_pk_add_f32 v[172:173], v[172:173], v[236:237]
    v_pk_add_f32 v[174:175], v[174:175], v[238:239]
    v_pk_mul_f32 v[232:233], v[168:169], v[168:169]
    v_pk_mul_f32 v[234:235], v[170:171], v[170:171]
    v_pk_mul_f32 v[236:237], v[172:173], v[172:173]
    v_pk_mul_f32 v[238:239], v[174:175], v[174:175]
    v_pk_fma_f32 v[232:233], v[232:233], s[46:47], v[248:249]
    v_pk_fma_f32 v[234:235], v[234:235], s[46:47], v[248:249]
    v_pk_fma_f32 v[236:237], v[236:237], s[46:47], v[248:249]
    v_pk_fma_f32 v[238:239], v[238:239], s[46:47], v[248:249]
    v_pk_mul_f32 v[232:233], v[232:233], v[168:169]
    v_pk_mul_f32 v[234:235], v[234:235], v[170:171]
    v_pk_mul_f32 v[236:237], v[236:237], v[172:173]
    v_pk_mul_f32 v[238:239], v[238:239], v[174:175]
    v_exp_f32 v232, v232
    v_exp_f32 v233, v233
    v_exp_f32 v234, v234
    v_exp_f32 v235, v235
    v_exp_f32 v236, v236
    v_exp_f32 v237, v237
    v_exp_f32 v238, v238
    v_exp_f32 v239, v239
    v_pk_add_f32 v[232:233], v[232:233], s[48:49]
    v_pk_add_f32 v[234:235], v[234:235], s[48:49]
    v_pk_add_f32 v[236:237], v[236:237], s[48:49]
    v_pk_add_f32 v[238:239], v[238:239], s[48:49]
    v_rcp_f32 v232, v232
    v_rcp_f32 v233, v233
    v_rcp_f32 v234, v234
    v_rcp_f32 v235, v235
    v_rcp_f32 v236, v236
    v_rcp_f32 v237, v237
    v_rcp_f32 v238, v238
    v_rcp_f32 v239, v239
    v_pk_mul_f32 v[168:169], v[168:169], v[232:233]
    v_pk_mul_f32 v[170:171], v[170:171], v[234:235]
    v_pk_mul_f32 v[172:173], v[172:173], v[236:237]
    v_pk_mul_f32 v[174:175], v[174:175], v[238:239]
    v_cvt_pk_bf16_f32 v240, v168, v169
    v_cvt_pk_bf16_f32 v241, v170, v171
    v_cvt_pk_bf16_f32 v242, v172, v173
    v_cvt_pk_bf16_f32 v243, v174, v175
    ds_write_b128 v252, v[240:243] offset:32768
    s_waitcnt vmcnt(6)
    v_lshlrev_b32 v168, 16, v132
    v_and_b32 v169, s45, v132
    v_lshlrev_b32 v232, 16, v148
    v_and_b32 v233, s45, v148
    v_lshlrev_b32 v170, 16, v133
    v_and_b32 v171, s45, v133
    v_lshlrev_b32 v234, 16, v149
    v_and_b32 v235, s45, v149
    v_lshlrev_b32 v172, 16, v134
    v_and_b32 v173, s45, v134
    v_lshlrev_b32 v236, 16, v150
    v_and_b32 v237, s45, v150
    v_lshlrev_b32 v174, 16, v135
    v_and_b32 v175, s45, v135
    v_lshlrev_b32 v238, 16, v151
    v_and_b32 v239, s45, v151
    v_pk_add_f32 v[168:169], v[168:169], v[232:233]
    v_pk_add_f32 v[170:171], v[170:171], v[234:235]
    v_pk_add_f32 v[172:173], v[172:173], v[236:237]
    v_pk_add_f32 v[174:175], v[174:175], v[238:239]
    v_pk_mul_f32 v[232:233], v[168:169], v[168:169]
    v_pk_mul_f32 v[234:235], v[170:171], v[170:171]
    v_pk_mul_f32 v[236:237], v[172:173], v[172:173]
    v_pk_mul_f32 v[238:239], v[174:175], v[174:175]
    v_pk_fma_f32 v[232:233], v[232:233], s[46:47], v[248:249]
    v_pk_fma_f32 v[234:235], v[234:235], s[46:47], v[248:249]
    v_pk_fma_f32 v[236:237], v[236:237], s[46:47], v[248:249]
    v_pk_fma_f32 v[238:239], v[238:239], s[46:47], v[248:249]
    v_pk_mul_f32 v[232:233], v[232:233], v[168:169]
    v_pk_mul_f32 v[234:235], v[234:235], v[170:171]
    v_pk_mul_f32 v[236:237], v[236:237], v[172:173]
    v_pk_mul_f32 v[238:239], v[238:239], v[174:175]
    v_exp_f32 v232, v232
    v_exp_f32 v233, v233
    v_exp_f32 v234, v234
    v_exp_f32 v235, v235
    v_exp_f32 v236, v236
    v_exp_f32 v237, v237
    v_exp_f32 v238, v238
    v_exp_f32 v239, v239
    v_pk_add_f32 v[232:233], v[232:233], s[48:49]
    v_pk_add_f32 v[234:235], v[234:235], s[48:49]
    v_pk_add_f32 v[236:237], v[236:237], s[48:49]
    v_pk_add_f32 v[238:239], v[238:239], s[48:49]
    v_rcp_f32 v232, v232
    v_rcp_f32 v233, v233
    v_rcp_f32 v234, v234
    v_rcp_f32 v235, v235
    v_rcp_f32 v236, v236
    v_rcp_f32 v237, v237
    v_rcp_f32 v238, v238
    v_rcp_f32 v239, v239
    v_pk_mul_f32 v[168:169], v[168:169], v[232:233]
    v_pk_mul_f32 v[170:171], v[170:171], v[234:235]
    v_pk_mul_f32 v[172:173], v[172:173], v[236:237]
    v_pk_mul_f32 v[174:175], v[174:175], v[238:239]
    v_cvt_pk_bf16_f32 v244, v168, v169
    v_cvt_pk_bf16_f32 v245, v170, v171
    v_cvt_pk_bf16_f32 v246, v172, v173
    v_cvt_pk_bf16_f32 v247, v174, v175
    ds_write_b128 v252, v[244:247] offset:33824
    s_waitcnt vmcnt(0)
    v_pk_mov_b32 v[128:129], v[136:137], v[136:137] op_sel:[0,1]
    v_pk_mov_b32 v[144:145], v[152:153], v[152:153] op_sel:[0,1]
    v_pk_mov_b32 v[130:131], v[138:139], v[138:139] op_sel:[0,1]
    v_pk_mov_b32 v[146:147], v[154:155], v[154:155] op_sel:[0,1]
    v_pk_mov_b32 v[132:133], v[140:141], v[140:141] op_sel:[0,1]
    v_pk_mov_b32 v[148:149], v[156:157], v[156:157] op_sel:[0,1]
    v_pk_mov_b32 v[134:135], v[142:143], v[142:143] op_sel:[0,1]
    v_pk_mov_b32 v[150:151], v[158:159], v[158:159] op_sel:[0,1]
    v_add_u32 v252, 64, v252
    s_sub_u32 s22, s22, 1
    s_cmp_lg_u32 s22, 0
    s_cbranch_scc1 L_joint_kernel_floop
    s_mul_i32 s36, s20, 2080
    s_add_u32 s36, s36, 88832
    v_add_u32 v251, s36, v254
    ds_write_b128 v251, v[192:195] offset:0
    ds_write_b128 v251, v[196:199] offset:1040
    s_waitcnt lgkmcnt(0)
    s_barrier
    s_mov_b32 s36, 0
    buffer_load_dwordx4 v[0:3], v254, s[12:15], s36 offen offset:0
    buffer_load_dwordx4 v[4:7], v254, s[12:15], s36 offen offset:1024
    buffer_load_dwordx4 v[8:11], v254, s[12:15], s36 offen offset:2048
    buffer_load_dwordx4 v[12:15], v254, s[12:15], s36 offen offset:3072
    s_mov_b32 s36, 4096
    buffer_load_dwordx4 v[16:19], v254, s[12:15], s36 offen offset:0
    buffer_load_dwordx4 v[20:23], v254, s[12:15], s36 offen offset:1024
    buffer_load_dwordx4 v[24:27], v254, s[12:15], s36 offen offset:2048
    buffer_load_dwordx4 v[28:31], v254, s[12:15], s36 offen offset:3072
    s_mov_b32 s36, 8192
    buffer_load_dwordx4 v[32:35], v254, s[12:15], s36 offen offset:0
    buffer_load_dwordx4 v[36:39], v254, s[12:15], s36 offen offset:1024
    buffer_load_dwordx4 v[40:43], v254, s[12:15], s36 offen offset:2048
    buffer_load_dwordx4 v[44:47], v254, s[12:15], s36 offen offset:3072
    s_mov_b32 s36, 12288
    buffer_load_dwordx4 v[48:51], v254, s[12:15], s36 offen offset:0
    buffer_load_dwordx4 v[52:55], v254, s[12:15], s36 offen offset:1024
    buffer_load_dwordx4 v[56:59], v254, s[12:15], s36 offen offset:2048
    buffer_load_dwordx4 v[60:63], v254, s[12:15], s36 offen offset:3072
    s_mov_b32 s36, 16384
    buffer_load_dwordx4 v[64:67], v254, s[12:15], s36 offen offset:0
    buffer_load_dwordx4 v[68:71], v254, s[12:15], s36 offen offset:1024
    buffer_load_dwordx4 v[72:75], v254, s[12:15], s36 offen offset:2048
    buffer_load_dwordx4 v[76:79], v254, s[12:15], s36 offen offset:3072
    s_mov_b32 s36, 20480
    buffer_load_dwordx4 v[80:83], v254, s[12:15], s36 offen offset:0
    buffer_load_dwordx4 v[84:87], v254, s[12:15], s36 offen offset:1024
    buffer_load_dwordx4 v[88:91], v254, s[12:15], s36 offen offset:2048
    buffer_load_dwordx4 v[92:95], v254, s[12:15], s36 offen offset:3072
    s_mov_b32 s36, 24576
    buffer_load_dwordx4 v[96:99], v254, s[12:15], s36 offen offset:0
    buffer_load_dwordx4 v[100:103], v254, s[12:15], s36 offen offset:1024
    buffer_load_dwordx4 v[104:107], v254, s[12:15], s36 offen offset:2048
    buffer_load_dwordx4 v[108:111], v254, s[12:15], s36 offen offset:3072
    s_mov_b32 s36, 28672
    buffer_load_dwordx4 v[112:115], v254, s[12:15], s36 offen offset:0
    buffer_load_dwordx4 v[116:119], v254, s[12:15], s36 offen offset:1024
    buffer_load_dwordx4 v[120:123], v254, s[12:15], s36 offen offset:2048
    buffer_load_dwordx4 v[124:127], v254, s[12:15], s36 offen offset:3072
    v_lshrrev_b32 v250, 5, v255
    v_lshlrev_b32 v250, 11, v250
    v_and_b32 v249, 31, v255
    v_lshl_add_u32 v250, v249, 2, v250
    s_lshl_b32 s36, s21, 7
    v_add_u32 v250, s36, v250
    s_mov_b32 s44, 0
    s_mov_b32 s45, 4096
    s_mov_b32 s46, 8192
    s_mov_b32 s47, 12288
    s_barrier
    ds_read_b128 v[192:195], v254 offset:0
    ds_read_b128 v[196:199], v254 offset:1024
    ds_read_b128 v[200:203], v254 offset:2048
    ds_read_b128 v[204:207], v254 offset:3072
    s_waitcnt vmcnt(30) lgkmcnt(3)
    v_mfma_f32_32x32x16_bf16 v[128:143], v[192:195], v[0:3], 0
    ds_read_b128 v[208:211], v254 offset:4096
    v_mfma_f32_32x32x16_bf16 v[144:159], v[192:195], v[4:7], 0
    s_waitcnt vmcnt(28) lgkmcnt(3)
    v_mfma_f32_32x32x16_bf16 v[128:143], v[196:199], v[8:11], v[128:143]
    ds_read_b128 v[212:215], v254 offset:5120
    v_mfma_f32_32x32x16_bf16 v[144:159], v[196:199], v[12:15], v[144:159]
    s_waitcnt vmcnt(26) lgkmcnt(3)
    v_mfma_f32_32x32x16_bf16 v[128:143], v[200:203], v[16:19], v[128:143]
    ds_read_b128 v[216:219], v254 offset:6144
    v_mfma_f32_32x32x16_bf16 v[144:159], v[200:203], v[20:23], v[144:159]
    s_waitcnt vmcnt(24) lgkmcnt(3)
    v_mfma_f32_32x32x16_bf16 v[128:143], v[204:207], v[24:27], v[128:143]
    ds_read_b128 v[220:223], v254 offset:7168
    v_mfma_f32_32x32x16_bf16 v[144:159], v[204:207], v[28:31], v[144:159]
    s_waitcnt vmcnt(22) lgkmcnt(3)
    v_mfma_f32_32x32x16_bf16 v[128:143], v[208:211], v[32:35], v[128:143]
    ds_read_b128 v[192:195], v254 offset:8192
    v_mfma_f32_32x32x16_bf16 v[144:159], v[208:211], v[36:39], v[144:159]
    s_waitcnt vmcnt(20) lgkmcnt(3)
    v_mfma_f32_32x32x16_bf16 v[128:143], v[212:215], v[40:43], v[128:143]
    ds_read_b128 v[196:199], v254 offset:9216
    v_mfma_f32_32x32x16_bf16 v[144:159], v[212:215], v[44:47], v[144:159]
    s_waitcnt vmcnt(18) lgkmcnt(3)
    v_mfma_f32_32x32x16_bf16 v[128:143], v[216:219], v[48:51], v[128:143]
    ds_read_b128 v[200:203], v254 offset:10240
    v_mfma_f32_32x32x16_bf16 v[144:159], v[216:219], v[52:55], v[144:159]
    s_waitcnt vmcnt(16) lgkmcnt(3)
    v_mfma_f32_32x32x16_bf16 v[128:143], v[220:223], v[56:59], v[128:143]
    ds_read_b128 v[204:207], v254 offset:11264
    v_mfma_f32_32x32x16_bf16 v[144:159], v[220:223], v[60:63], v[144:159]
    s_waitcnt vmcnt(14) lgkmcnt(3)
    v_mfma_f32_32x32x16_bf16 v[128:143], v[192:195], v[64:67], v[128:143]
    ds_read_b128 v[208:211], v254 offset:12288
    v_mfma_f32_32x32x16_bf16 v[144:159], v[192:195], v[68:71], v[144:159]
    s_waitcnt vmcnt(12) lgkmcnt(3)
    v_mfma_f32_32x32x16_bf16 v[128:143], v[196:199], v[72:75], v[128:143]
    ds_read_b128 v[212:215], v254 offset:13312
    v_mfma_f32_32x32x16_bf16 v[144:159], v[196:199], v[76:79], v[144:159]
    s_waitcnt vmcnt(10) lgkmcnt(3)
    v_mfma_f32_32x32x16_bf16 v[128:143], v[200:203], v[80:83], v[128:143]
    ds_read_b128 v[216:219], v254 offset:14336
    v_mfma_f32_32x32x16_bf16 v[144:159], v[200:203], v[84:87], v[144:159]
    s_waitcnt vmcnt(8) lgkmcnt(3)
    v_mfma_f32_32x32x16_bf16 v[128:143], v[204:207], v[88:91], v[128:143]
    ds_read_b128 v[220:223], v254 offset:15360
    v_mfma_f32_32x32x16_bf16 v[144:159], v[204:207], v[92:95], v[144:159]
    s_waitcnt lgkmcnt(0)
    s_barrier
    s_waitcnt vmcnt(6)
    v_mfma_f32_32x32x16_bf16 v[128:143], v[208:211], v[96:99], v[128:143]
    ds_read_b128 v[192:195], v254 offset:16384
    v_mfma_f32_32x32x16_bf16 v[144:159], v[208:211], v[100:103], v[144:159]
    s_waitcnt vmcnt(4)
    v_mfma_f32_32x32x16_bf16 v[128:143], v[212:215], v[104:107], v[128:143]
    ds_read_b128 v[196:199], v254 offset:17408
    v_mfma_f32_32x32x16_bf16 v[144:159], v[212:215], v[108:111], v[144:159]
    s_waitcnt vmcnt(2)
    v_mfma_f32_32x32x16_bf16 v[128:143], v[216:219], v[112:115], v[128:143]
    ds_read_b128 v[200:203], v254 offset:18432
    v_mfma_f32_32x32x16_bf16 v[144:159], v[216:219], v[116:119], v[144:159]
    s_waitcnt vmcnt(0)
    v_mfma_f32_32x32x16_bf16 v[128:143], v[220:223], v[120:123], v[128:143]
    ds_read_b128 v[204:207], v254 offset:19456
    v_mfma_f32_32x32x16_bf16 v[144:159], v[220:223], v[124:127], v[144:159]
    s_mov_b32 s22, 4
    s_nop 0
L_joint_kernel_oloop:
    s_waitcnt lgkmcnt(3)
    s_nop 0
    v_mfma_f32_32x32x16_bf16 v[160:175], v[192:195], v[0:3], 0
    ds_read_b128 v[208:211], v254 offset:20480
    v_mfma_f32_32x32x16_bf16 v[176:191], v[192:195], v[4:7], 0
    s_waitcnt lgkmcnt(3)
    s_nop 0
    v_mfma_f32_32x32x16_bf16 v[160:175], v[196:199], v[8:11], v[160:175]
    ds_read_b128 v[212:215], v254 offset:21504
    v_mfma_f32_32x32x16_bf16 v[176:191], v[196:199], v[12:15], v[176:191]
    s_waitcnt lgkmcnt(3)
    s_nop 0
    v_mfma_f32_32x32x16_bf16 v[160:175], v[200:203], v[16:19], v[160:175]
    ds_read_b128 v[216:219], v254 offset:22528
    v_mfma_f32_32x32x16_bf16 v[176:191], v[200:203], v[20:23], v[176:191]
    s_waitcnt lgkmcnt(3)
    s_nop 0
    v_mfma_f32_32x32x16_bf16 v[160:175], v[204:207], v[24:27], v[160:175]
    ds_read_b128 v[220:223], v254 offset:23552
    v_mfma_f32_32x32x16_bf16 v[176:191], v[204:207], v[28:31], v[176:191]
    s_waitcnt lgkmcnt(3)
    s_nop 0
    v_mfma_f32_32x32x16_bf16 v[160:175], v[208:211], v[32:35], v[160:175]
    ds_read_b128 v[192:195], v254 offset:24576
    v_cvt_pk_bf16_f32 v224, v128, v144
    buffer_store_dword v224, v250, s[16:19], s44 offen offset:0 nt
    v_mfma_f32_32x32x16_bf16 v[176:191], v[208:211], v[36:39], v[176:191]
    v_cvt_pk_bf16_f32 v225, v129, v145
    buffer_store_dword v225, v250, s[16:19], s44 offen offset:512 nt
    s_waitcnt lgkmcnt(3)
    s_nop 0
    v_mfma_f32_32x32x16_bf16 v[160:175], v[212:215], v[40:43], v[160:175]
    ds_read_b128 v[196:199], v254 offset:25600
    v_cvt_pk_bf16_f32 v226, v130, v146
    buffer_store_dword v226, v250, s[16:19], s44 offen offset:1024 nt
    v_mfma_f32_32x32x16_bf16 v[176:191], v[212:215], v[44:47], v[176:191]
    v_cvt_pk_bf16_f32 v227, v131, v147
    buffer_store_dword v227, v250, s[16:19], s44 offen offset:1536 nt
    s_waitcnt lgkmcnt(3)
    s_nop 0
    v_mfma_f32_32x32x16_bf16 v[160:175], v[216:219], v[48:51], v[160:175]
    ds_read_b128 v[200:203], v254 offset:26624
    v_cvt_pk_bf16_f32 v228, v132, v148
    buffer_store_dword v228, v250, s[16:19], s45 offen offset:0 nt
    v_mfma_f32_32x32x16_bf16 v[176:191], v[216:219], v[52:55], v[176:191]
    v_cvt_pk_bf16_f32 v229, v133, v149
    buffer_store_dword v229, v250, s[16:19], s45 offen offset:512 nt
    s_waitcnt lgkmcnt(3)
    s_nop 0
    v_mfma_f32_32x32x16_bf16 v[160:175], v[220:223], v[56:59], v[160:175]
    ds_read_b128 v[204:207], v254 offset:27648
    v_cvt_pk_bf16_f32 v230, v134, v150
    buffer_store_dword v230, v250, s[16:19], s45 offen offset:1024 nt
    v_mfma_f32_32x32x16_bf16 v[176:191], v[220:223], v[60:63], v[176:191]
    v_cvt_pk_bf16_f32 v231, v135, v151
    buffer_store_dword v231, v250, s[16:19], s45 offen offset:1536 nt
    s_waitcnt lgkmcnt(3)
    s_nop 0
    v_mfma_f32_32x32x16_bf16 v[160:175], v[192:195], v[64:67], v[160:175]
    ds_read_b128 v[208:211], v254 offset:28672
    v_cvt_pk_bf16_f32 v232, v136, v152
    buffer_store_dword v232, v250, s[16:19], s46 offen offset:0 nt
    v_mfma_f32_32x32x16_bf16 v[176:191], v[192:195], v[68:71], v[176:191]
    v_cvt_pk_bf16_f32 v233, v137, v153
    buffer_store_dword v233, v250, s[16:19], s46 offen offset:512 nt
    s_waitcnt lgkmcnt(3)
    s_nop 0
    v_mfma_f32_32x32x16_bf16 v[160:175], v[196:199], v[72:75], v[160:175]
    ds_read_b128 v[212:215], v254 offset:29696
    v_cvt_pk_bf16_f32 v234, v138, v154
    buffer_store_dword v234, v250, s[16:19], s46 offen offset:1024 nt
    v_mfma_f32_32x32x16_bf16 v[176:191], v[196:199], v[76:79], v[176:191]
    v_cvt_pk_bf16_f32 v235, v139, v155
    buffer_store_dword v235, v250, s[16:19], s46 offen offset:1536 nt
    s_waitcnt lgkmcnt(3)
    s_nop 0
    v_mfma_f32_32x32x16_bf16 v[160:175], v[200:203], v[80:83], v[160:175]
    ds_read_b128 v[216:219], v254 offset:30720
    v_cvt_pk_bf16_f32 v236, v140, v156
    v_mfma_f32_32x32x16_bf16 v[176:191], v[200:203], v[84:87], v[176:191]
    buffer_store_dword v236, v250, s[16:19], s47 offen offset:0 nt
    s_waitcnt lgkmcnt(3)
    s_nop 0
    v_mfma_f32_32x32x16_bf16 v[160:175], v[204:207], v[88:91], v[160:175]
    ds_read_b128 v[220:223], v254 offset:31744
    v_cvt_pk_bf16_f32 v237, v141, v157
    v_mfma_f32_32x32x16_bf16 v[176:191], v[204:207], v[92:95], v[176:191]
    buffer_store_dword v237, v250, s[16:19], s47 offen offset:512 nt
    s_waitcnt lgkmcnt(0)
    s_barrier
    v_mfma_f32_32x32x16_bf16 v[160:175], v[208:211], v[96:99], v[160:175]
    ds_read_b128 v[192:195], v254 offset:0
    v_cvt_pk_bf16_f32 v238, v142, v158
    v_mfma_f32_32x32x16_bf16 v[176:191], v[208:211], v[100:103], v[176:191]
    buffer_store_dword v238, v250, s[16:19], s47 offen offset:1024 nt
    v_mfma_f32_32x32x16_bf16 v[160:175], v[212:215], v[104:107], v[160:175]
    ds_read_b128 v[196:199], v254 offset:1024
    v_cvt_pk_bf16_f32 v239, v143, v159
    v_mfma_f32_32x32x16_bf16 v[176:191], v[212:215], v[108:111], v[176:191]
    buffer_store_dword v239, v250, s[16:19], s47 offen offset:1536 nt
    v_mfma_f32_32x32x16_bf16 v[160:175], v[216:219], v[112:115], v[160:175]
    ds_read_b128 v[200:203], v254 offset:2048
    v_add_u32 v250, 16384, v250
    v_mfma_f32_32x32x16_bf16 v[176:191], v[216:219], v[116:119], v[176:191]
    v_mfma_f32_32x32x16_bf16 v[160:175], v[220:223], v[120:123], v[160:175]
    ds_read_b128 v[204:207], v254 offset:3072
    v_mfma_f32_32x32x16_bf16 v[176:191], v[220:223], v[124:127], v[176:191]
    s_sub_u32 s22, s22, 1
    s_cmp_eq_u32 s22, 0
    s_cbranch_scc1 L_joint_kernel_oend
    s_waitcnt lgkmcnt(3)
    v_mfma_f32_32x32x16_bf16 v[128:143], v[192:195], v[0:3], 0
    ds_read_b128 v[208:211], v254 offset:4096
    v_mfma_f32_32x32x16_bf16 v[144:159], v[192:195], v[4:7], 0
    s_waitcnt lgkmcnt(3)
    s_nop 0
    v_mfma_f32_32x32x16_bf16 v[128:143], v[196:199], v[8:11], v[128:143]
    ds_read_b128 v[212:215], v254 offset:5120
    v_mfma_f32_32x32x16_bf16 v[144:159], v[196:199], v[12:15], v[144:159]
    s_waitcnt lgkmcnt(3)
    s_nop 0
    v_mfma_f32_32x32x16_bf16 v[128:143], v[200:203], v[16:19], v[128:143]
    ds_read_b128 v[216:219], v254 offset:6144
    v_mfma_f32_32x32x16_bf16 v[144:159], v[200:203], v[20:23], v[144:159]
    s_waitcnt lgkmcnt(3)
    s_nop 0
    v_mfma_f32_32x32x16_bf16 v[128:143], v[204:207], v[24:27], v[128:143]
    ds_read_b128 v[220:223], v254 offset:7168
    v_mfma_f32_32x32x16_bf16 v[144:159], v[204:207], v[28:31], v[144:159]
    s_waitcnt lgkmcnt(3)
    s_nop 0
    v_mfma_f32_32x32x16_bf16 v[128:143], v[208:211], v[32:35], v[128:143]
    ds_read_b128 v[192:195], v254 offset:8192
    v_cvt_pk_bf16_f32 v224, v160, v176
    buffer_store_dword v224, v250, s[16:19], s44 offen offset:0 nt
    v_mfma_f32_32x32x16_bf16 v[144:159], v[208:211], v[36:39], v[144:159]
    v_cvt_pk_bf16_f32 v225, v161, v177
    buffer_store_dword v225, v250, s[16:19], s44 offen offset:512 nt
    s_waitcnt lgkmcnt(3)
    s_nop 0
    v_mfma_f32_32x32x16_bf16 v[128:143], v[212:215], v[40:43], v[128:143]
    ds_read_b128 v[196:199], v254 offset:9216
    v_cvt_pk_bf16_f32 v226, v162, v178
    buffer_store_dword v226, v250, s[16:19], s44 offen offset:1024 nt
    v_mfma_f32_32x32x16_bf16 v[144:159], v[212:215], v[44:47], v[144:159]
    v_cvt_pk_bf16_f32 v227, v163, v179
    buffer_store_dword v227, v250, s[16:19], s44 offen offset:1536 nt
    s_waitcnt lgkmcnt(3)
    s_nop 0
    v_mfma_f32_32x32x16_bf16 v[128:143], v[216:219], v[48:51], v[128:143]
    ds_read_b128 v[200:203], v254 offset:10240
    v_cvt_pk_bf16_f32 v228, v164, v180
    buffer_store_dword v228, v250, s[16:19], s45 offen offset:0 nt
    v_mfma_f32_32x32x16_bf16 v[144:159], v[216:219], v[52:55], v[144:159]
    v_cvt_pk_bf16_f32 v229, v165, v181
    buffer_store_dword v229, v250, s[16:19], s45 offen offset:512 nt
    s_waitcnt lgkmcnt(3)
    s_nop 0
    v_mfma_f32_32x32x16_bf16 v[128:143], v[220:223], v[56:59], v[128:143]
    ds_read_b128 v[204:207], v254 offset:11264
    v_cvt_pk_bf16_f32 v230, v166, v182
    buffer_store_dword v230, v250, s[16:19], s45 offen offset:1024 nt
    v_mfma_f32_32x32x16_bf16 v[144:159], v[220:223], v[60:63], v[144:159]
    v_cvt_pk_bf16_f32 v231, v167, v183
    buffer_store_dword v231, v250, s[16:19], s45 offen offset:1536 nt
    s_waitcnt lgkmcnt(3)
    s_nop 0
    v_mfma_f32_32x32x16_bf16 v[128:143], v[192:195], v[64:67], v[128:143]
    ds_read_b128 v[208:211], v254 offset:12288
    v_cvt_pk_bf16_f32 v232, v168, v184
    buffer_store_dword v232, v250, s[16:19], s46 offen offset:0 nt
    v_mfma_f32_32x32x16_bf16 v[144:159], v[192:195], v[68:71], v[144:159]
    v_cvt_pk_bf16_f32 v233, v169, v185
    buffer_store_dword v233, v250, s[16:19], s46 offen offset:512 nt
    s_waitcnt lgkmcnt(3)
    s_nop 0
    v_mfma_f32_32x32x16_bf16 v[128:143], v[196:199], v[72:75], v[128:143]
    ds_read_b128 v[212:215], v254 offset:13312
    v_cvt_pk_bf16_f32 v234, v170, v186
    buffer_store_dword v234, v250, s[16:19], s46 offen offset:1024 nt
    v_mfma_f32_32x32x16_bf16 v[144:159], v[196:199], v[76:79], v[144:159]
    v_cvt_pk_bf16_f32 v235, v171, v187
    buffer_store_dword v235, v250, s[16:19], s46 offen offset:1536 nt
    s_waitcnt lgkmcnt(3)
    s_nop 0
    v_mfma_f32_32x32x16_bf16 v[128:143], v[200:203], v[80:83], v[128:143]
    ds_read_b128 v[216:219], v254 offset:14336
    v_cvt_pk_bf16_f32 v236, v172, v188
    v_mfma_f32_32x32x16_bf16 v[144:159], v[200:203], v[84:87], v[144:159]
    buffer_store_dword v236, v250, s[16:19], s47 offen offset:0 nt
    s_waitcnt lgkmcnt(3)
    s_nop 0
    v_mfma_f32_32x32x16_bf16 v[128:143], v[204:207], v[88:91], v[128:143]
    ds_read_b128 v[220:223], v254 offset:15360
    v_cvt_pk_bf16_f32 v237, v173, v189
    v_mfma_f32_32x32x16_bf16 v[144:159], v[204:207], v[92:95], v[144:159]
    buffer_store_dword v237, v250, s[16:19], s47 offen offset:512 nt
    s_waitcnt lgkmcnt(0)
    s_barrier
    v_mfma_f32_32x32x16_bf16 v[128:143], v[208:211], v[96:99], v[128:143]
    ds_read_b128 v[192:195], v254 offset:16384
    v_cvt_pk_bf16_f32 v238, v174, v190
    v_mfma_f32_32x32x16_bf16 v[144:159], v[208:211], v[100:103], v[144:159]
    buffer_store_dword v238, v250, s[16:19], s47 offen offset:1024 nt
    v_mfma_f32_32x32x16_bf16 v[128:143], v[212:215], v[104:107], v[128:143]
    ds_read_b128 v[196:199], v254 offset:17408
    v_cvt_pk_bf16_f32 v239, v175, v191
    v_mfma_f32_32x32x16_bf16 v[144:159], v[212:215], v[108:111], v[144:159]
    buffer_store_dword v239, v250, s[16:19], s47 offen offset:1536 nt
    v_mfma_f32_32x32x16_bf16 v[128:143], v[216:219], v[112:115], v[128:143]
    ds_read_b128 v[200:203], v254 offset:18432
    v_add_u32 v250, 16384, v250
    v_mfma_f32_32x32x16_bf16 v[144:159], v[216:219], v[116:119], v[144:159]
    v_mfma_f32_32x32x16_bf16 v[128:143], v[220:223], v[120:123], v[128:143]
    ds_read_b128 v[204:207], v254 offset:19456
    v_mfma_f32_32x32x16_bf16 v[144:159], v[220:223], v[124:127], v[144:159]
    s_waitcnt vmcnt(24)
    s_branch L_joint_kernel_oloop
L_joint_kernel_oend:
    s_nop 15
    v_cvt_pk_bf16_f32 v224, v160, v176
    buffer_store_dword v224, v250, s[16:19], s44 offen offset:0 nt
    v_cvt_pk_bf16_f32 v225, v161, v177
    buffer_store_dword v225, v250, s[16:19], s44 offen offset:512 nt
    v_cvt_pk_bf16_f32 v226, v162, v178
    buffer_store_dword v226, v250, s[16:19], s44 offen offset:1024 nt
    v_cvt_pk_bf16_f32 v227, v163, v179
    buffer_store_dword v227, v250, s[16:19], s44 offen offset:1536 nt
    v_cvt_pk_bf16_f32 v228, v164, v180
    buffer_store_dword v228, v250, s[16:19], s45 offen offset:0 nt
    v_cvt_pk_bf16_f32 v229, v165, v181
    buffer_store_dword v229, v250, s[16:19], s45 offen offset:512 nt
    v_cvt_pk_bf16_f32 v230, v166, v182
    buffer_store_dword v230, v250, s[16:19], s45 offen offset:1024 nt
    v_cvt_pk_bf16_f32 v231, v167, v183
    buffer_store_dword v231, v250, s[16:19], s45 offen offset:1536 nt
    v_cvt_pk_bf16_f32 v232, v168, v184
    buffer_store_dword v232, v250, s[16:19], s46 offen offset:0 nt
    v_cvt_pk_bf16_f32 v233, v169, v185
    buffer_store_dword v233, v250, s[16:19], s46 offen offset:512 nt
    v_cvt_pk_bf16_f32 v234, v170, v186
    buffer_store_dword v234, v250, s[16:19], s46 offen offset:1024 nt
    v_cvt_pk_bf16_f32 v235, v171, v187
    buffer_store_dword v235, v250, s[16:19], s46 offen offset:1536 nt
    v_cvt_pk_bf16_f32 v236, v172, v188
    buffer_store_dword v236, v250, s[16:19], s47 offen offset:0 nt
    v_cvt_pk_bf16_f32 v237, v173, v189
    buffer_store_dword v237, v250, s[16:19], s47 offen offset:512 nt
    v_cvt_pk_bf16_f32 v238, v174, v190
    buffer_store_dword v238, v250, s[16:19], s47 offen offset:1024 nt
    v_cvt_pk_bf16_f32 v239, v175, v191
    buffer_store_dword v239, v250, s[16:19], s47 offen offset:1536 nt
    v_add_u32 v250, 16384, v250
    s_branch L_joint_kernel_fin
L_joint_kernel_T:
    s_setprio 3
    s_add_u32 s36, s30, 44335104
    s_addc_u32 s37, s31, 0
    s_load_dwordx16 s[44:59], s[36:37], 0
    s_cmp_ge_u32 s2, 125
    s_cselect_b32 s34, 8192, 0
    s_add_u32 s34, s34, 44302336
    s_add_u32 s40, s30, s34
    s_addc_u32 s41, s31, 0
    s_mov_b32 s42, 24576
    s_mov_b32 s43, 0x00020000
    v_and_b32 v248, 31, v255
    v_lshrrev_b32 v246, 5, v255
    v_mul_u32_u24 v250, 528, v248
    v_lshl_add_u32 v250, v246, 4, v250
    v_lshlrev_b32 v246, 5, v246
    v_and_b32 v249, 7, v255
    v_lshl_add_u32 v249, v249, 10, v246
    s_lshl_b32 s38, s21, 8
    s_add_u32 s39, s38, 16384
    v_and_b32 v245, 7, v255
    v_mul_u32_u24 v245, 1040, v245
    s_add_u32 s36, s38, 88832
    v_add3_u32 v245, v245, v246, s36
    s_mul_i32 s36, s21, 9792
    s_add_u32 s36, s36, 49664
    v_add_u32 v246, s36, v246
    v_mul_u32_u24 v247, 272, v248
    v_add_u32 v247, v247, v246
    v_lshrrev_b32 v248, 3, v248
    v_mul_u32_u24 v248, 272, v248
    v_add_u32 v246, v248, v246
    s_lshl_b32 s36, s21, 12
    v_add_u32 v248, s36, v254
    s_barrier
    s_mov_b32 s36, 0
    buffer_load_dwordx4 v[0:3], v254, s[12:15], s36 offen offset:0
    buffer_load_dwordx4 v[4:7], v254, s[12:15], s36 offen offset:1024
    buffer_load_dwordx4 v[8:11], v254, s[12:15], s36 offen offset:2048
    buffer_load_dwordx4 v[12:15], v254, s[12:15], s36 offen offset:3072
    s_mov_b32 s36, 4096
    buffer_load_dwordx4 v[16:19], v254, s[12:15], s36 offen offset:0
    buffer_load_dwordx4 v[20:23], v254, s[12:15], s36 offen offset:1024
    buffer_load_dwordx4 v[24:27], v254, s[12:15], s36 offen offset:2048
    buffer_load_dwordx4 v[28:31], v254, s[12:15], s36 offen offset:3072
    s_mov_b32 s36, 8192
    buffer_load_dwordx4 v[32:35], v254, s[12:15], s36 offen offset:0
    buffer_load_dwordx4 v[36:39], v254, s[12:15], s36 offen offset:1024
    buffer_load_dwordx4 v[40:43], v254, s[12:15], s36 offen offset:2048
    buffer_load_dwordx4 v[44:47], v254, s[12:15], s36 offen offset:3072
    s_mov_b32 s36, 12288
    buffer_load_dwordx4 v[48:51], v254, s[12:15], s36 offen offset:0
    buffer_load_dwordx4 v[52:55], v254, s[12:15], s36 offen offset:1024
    buffer_load_dwordx4 v[56:59], v254, s[12:15], s36 offen offset:2048
    buffer_load_dwordx4 v[60:63], v254, s[12:15], s36 offen offset:3072
    s_mov_b32 s36, 16384
    buffer_load_dwordx4 v[64:67], v254, s[12:15], s36 offen offset:0
    buffer_load_dwordx4 v[68:71], v254, s[12:15], s36 offen offset:1024
    buffer_load_dwordx4 v[72:75], v254, s[12:15], s36 offen offset:2048
    buffer_load_dwordx4 v[76:79], v254, s[12:15], s36 offen offset:3072
    s_mov_b32 s36, 20480
    buffer_load_dwordx4 v[80:83], v254, s[12:15], s36 offen offset:0
    buffer_load_dwordx4 v[84:87], v254, s[12:15], s36 offen offset:1024
    buffer_load_dwordx4 v[88:91], v254, s[12:15], s36 offen offset:2048
    buffer_load_dwordx4 v[92:95], v254, s[12:15], s36 offen offset:3072
    s_mov_b32 s36, 24576
    buffer_load_dwordx4 v[96:99], v254, s[12:15], s36 offen offset:0
    buffer_load_dwordx4 v[100:103], v254, s[12:15], s36 offen offset:1024
    buffer_load_dwordx4 v[104:107], v254, s[12:15], s36 offen offset:2048
    buffer_load_dwordx4 v[108:111], v254, s[12:15], s36 offen offset:3072
    s_mov_b32 s36, 28672
    buffer_load_dwordx4 v[112:115], v254, s[12:15], s36 offen offset:0
    buffer_load_dwordx4 v[116:119], v254, s[12:15], s36 offen offset:1024
    buffer_load_dwordx4 v[120:123], v254, s[12:15], s36 offen offset:2048
    buffer_load_dwordx4 v[124:127], v254, s[12:15], s36 offen offset:3072
    s_waitcnt lgkmcnt(0)
    s_setprio 0
    s_or_b32 s44, s44, s45
    s_or_b32 s44, s44, s46
    s_or_b32 s44, s44, s47
    s_or_b32 s44, s44, s48
    s_or_b32 s44, s44, s49
    s_or_b32 s44, s44, s50
    s_or_b32 s44, s44, s51
    s_or_b32 s44, s44, s52
    s_or_b32 s44, s44, s53
    s_or_b32 s44, s44, s54
    s_or_b32 s44, s44, s55
    s_or_b32 s44, s44, s56
    s_or_b32 s44, s44, s57
    s_or_b32 s44, s44, s58
    s_or_b32 s44, s44, s59
    s_barrier
    ds_read_b128 v[160:163], v250 offset:32768
    ds_read_b128 v[164:167], v250 offset:32800
    ds_read_b128 v[168:171], v250 offset:32832
    ds_read_b128 v[172:175], v250 offset:32864
    ds_read_b128 v[176:179], v250 offset:32896
    ds_read_b128 v[180:183], v250 offset:32928
    ds_read_b128 v[184:187], v250 offset:32960
    ds_read_b128 v[188:191], v250 offset:32992
    s_waitcnt vmcnt(30) lgkmcnt(7)
    v_mfma_f32_32x32x16_bf16 v[128:143], v[0:3], v[160:163], 0
    v_mfma_f32_32x32x16_bf16 v[144:159], v[4:7], v[160:163], 0
    ds_read_b128 v[160:163], v250 offset:33024
    s_waitcnt vmcnt(28) lgkmcnt(7)
    v_mfma_f32_32x32x16_bf16 v[128:143], v[8:11], v[164:167], v[128:143]
    v_mfma_f32_32x32x16_bf16 v[144:159], v[12:15], v[164:167], v[144:159]
    ds_read_b128 v[164:167], v250 offset:33056
    s_waitcnt vmcnt(26) lgkmcnt(7)
    v_mfma_f32_32x32x16_bf16 v[128:143], v[16:19], v[168:171], v[128:143]
    v_mfma_f32_32x32x16_bf16 v[144:159], v[20:23], v[168:171], v[144:159]
    ds_read_b128 v[168:171], v250 offset:33088
    s_waitcnt vmcnt(24) lgkmcnt(7)
    v_mfma_f32_32x32x16_bf16 v[128:143], v[24:27], v[172:175], v[128:143]
    v_mfma_f32_32x32x16_bf16 v[144:159], v[28:31], v[172:175], v[144:159]
    ds_read_b128 v[172:175], v250 offset:33120
    s_waitcnt vmcnt(22) lgkmcnt(7)
    v_mfma_f32_32x32x16_bf16 v[128:143], v[32:35], v[176:179], v[128:143]
    v_mfma_f32_32x32x16_bf16 v[144:159], v[36:39], v[176:179], v[144:159]
    ds_read_b128 v[176:179], v250 offset:33152
    s_waitcnt vmcnt(20) lgkmcnt(7)
    v_mfma_f32_32x32x16_bf16 v[128:143], v[40:43], v[180:183], v[128:143]
    v_mfma_f32_32x32x16_bf16 v[144:159], v[44:47], v[180:183], v[144:159]
    ds_read_b128 v[180:183], v250 offset:33184
    s_waitcnt vmcnt(18) lgkmcnt(7)
    v_mfma_f32_32x32x16_bf16 v[128:143], v[48:51], v[184:187], v[128:143]
    v_mfma_f32_32x32x16_bf16 v[144:159], v[52:55], v[184:187], v[144:159]
    ds_read_b128 v[184:187], v250 offset:33216
    s_waitcnt vmcnt(16) lgkmcnt(7)
    v_mfma_f32_32x32x16_bf16 v[128:143], v[56:59], v[188:191], v[128:143]
    v_mfma_f32_32x32x16_bf16 v[144:159], v[60:63], v[188:191], v[144:159]
    ds_read_b128 v[188:191], v250 offset:33248
    s_waitcnt vmcnt(14) lgkmcnt(7)
    v_mfma_f32_32x32x16_bf16 v[128:143], v[64:67], v[160:163], v[128:143]
    v_mfma_f32_32x32x16_bf16 v[144:159], v[68:71], v[160:163], v[144:159]
    ds_read_b128 v[192:195], v245 offset:0
    s_waitcnt vmcnt(12) lgkmcnt(7)
    v_mfma_f32_32x32x16_bf16 v[128:143], v[72:75], v[164:167], v[128:143]
    v_mfma_f32_32x32x16_bf16 v[144:159], v[76:79], v[164:167], v[144:159]
    ds_read_b128 v[196:199], v245 offset:16
    s_waitcnt vmcnt(10) lgkmcnt(7)
    v_mfma_f32_32x32x16_bf16 v[128:143], v[80:83], v[168:171], v[128:143]
    v_mfma_f32_32x32x16_bf16 v[144:159], v[84:87], v[168:171], v[144:159]
    ds_read_b128 v[200:203], v245 offset:64
    s_waitcnt vmcnt(8) lgkmcnt(7)
    v_mfma_f32_32x32x16_bf16 v[128:143], v[88:91], v[172:175], v[128:143]
    v_mfma_f32_32x32x16_bf16 v[144:159], v[92:95], v[172:175], v[144:159]
    ds_read_b128 v[204:207], v245 offset:80
    s_waitcnt vmcnt(6) lgkmcnt(7)
    v_mfma_f32_32x32x16_bf16 v[128:143], v[96:99], v[176:179], v[128:143]
    v_mfma_f32_32x32x16_bf16 v[144:159], v[100:103], v[176:179], v[144:159]
    ds_read_b128 v[208:211], v245 offset:128
    s_waitcnt vmcnt(4) lgkmcnt(7)
    v_mfma_f32_32x32x16_bf16 v[128:143], v[104:107], v[180:183], v[128:143]
    v_mfma_f32_32x32x16_bf16 v[144:159], v[108:111], v[180:183], v[144:159]
    ds_read_b128 v[212:215], v245 offset:144
    s_waitcnt vmcnt(2) lgkmcnt(7)
    v_mfma_f32_32x32x16_bf16 v[128:143], v[112:115], v[184:187], v[128:143]
    v_mfma_f32_32x32x16_bf16 v[144:159], v[116:119], v[184:187], v[144:159]
    ds_read_b128 v[216:219], v245 offset:192
    s_waitcnt vmcnt(0) lgkmcnt(7)
    v_mfma_f32_32x32x16_bf16 v[128:143], v[120:123], v[188:191], v[128:143]
    v_mfma_f32_32x32x16_bf16 v[144:159], v[124:127], v[188:191], v[144:159]
    ds_read_b128 v[220:223], v245 offset:208
    s_mov_b32 s46, 0xffff0000
    s_mov_b32 s45, 0x4038aa3b
    s_nop 10
    s_mov_b32 s48, s45
    s_mov_b32 s49, s45
    v_mov_b32 v96, 0
    s_waitcnt lgkmcnt(0)
    v_cvt_pk_bf16_f32 v224, v128, v144
    v_cvt_pk_bf16_f32 v225, v129, v145
    v_cvt_pk_bf16_f32 v226, v130, v146
    v_cvt_pk_bf16_f32 v227, v131, v147
    v_lshlrev_b32 v0, 16, v224
    v_and_b32 v1, s46, v224
    v_lshlrev_b32 v2, 16, v225
    v_and_b32 v3, s46, v225
    v_lshlrev_b32 v4, 16, v226
    v_and_b32 v5, s46, v226
    v_lshlrev_b32 v6, 16, v227
    v_and_b32 v7, s46, v227
    v_pk_mul_f32 v[0:1], v[0:1], s[48:49]
    v_pk_mul_f32 v[2:3], v[2:3], s[48:49]
    v_pk_mul_f32 v[4:5], v[4:5], s[48:49]
    v_pk_mul_f32 v[6:7], v[6:7], s[48:49]
    v_exp_f32 v32, v0
    v_exp_f32 v33, v1
    v_exp_f32 v34, v2
    v_exp_f32 v35, v3
    v_max3_f32 v96, |v0|, |v1|, v96
    v_max3_f32 v96, |v2|, |v3|, v96
    ds_write_b128 v247, v[32:35] offset:0
    v_exp_f32 v36, v4
    v_exp_f32 v37, v5
    v_exp_f32 v38, v6
    v_exp_f32 v39, v7
    v_max3_f32 v96, |v4|, |v5|, v96
    v_max3_f32 v96, |v6|, |v7|, v96
    ds_write_b128 v247, v[36:39] offset:16
    v_cvt_pk_bf16_f32 v228, v132, v148
    v_cvt_pk_bf16_f32 v229, v133, v149
    v_cvt_pk_bf16_f32 v230, v134, v150
    v_cvt_pk_bf16_f32 v231, v135, v151
    v_lshlrev_b32 v8, 16, v228
    v_and_b32 v9, s46, v228
    v_lshlrev_b32 v10, 16, v229
    v_and_b32 v11, s46, v229
    v_lshlrev_b32 v12, 16, v230
    v_and_b32 v13, s46, v230
    v_lshlrev_b32 v14, 16, v231
    v_and_b32 v15, s46, v231
    v_pk_mul_f32 v[8:9], v[8:9], s[48:49]
    v_pk_mul_f32 v[10:11], v[10:11], s[48:49]
    v_pk_mul_f32 v[12:13], v[12:13], s[48:49]
    v_pk_mul_f32 v[14:15], v[14:15], s[48:49]
    v_exp_f32 v40, v8
    v_exp_f32 v41, v9
    v_exp_f32 v42, v10
    v_exp_f32 v43, v11
    v_max3_f32 v96, |v8|, |v9|, v96
    v_max3_f32 v96, |v10|, |v11|, v96
    ds_write_b128 v247, v[40:43] offset:64
    v_exp_f32 v44, v12
    v_exp_f32 v45, v13
    v_exp_f32 v46, v14
    v_exp_f32 v47, v15
    v_max3_f32 v96, |v12|, |v13|, v96
    v_max3_f32 v96, |v14|, |v15|, v96
    ds_write_b128 v247, v[44:47] offset:80
    v_cvt_pk_bf16_f32 v232, v136, v152
    v_cvt_pk_bf16_f32 v233, v137, v153
    v_cvt_pk_bf16_f32 v234, v138, v154
    v_cvt_pk_bf16_f32 v235, v139, v155
    v_lshlrev_b32 v16, 16, v232
    v_and_b32 v17, s46, v232
    v_lshlrev_b32 v18, 16, v233
    v_and_b32 v19, s46, v233
    v_lshlrev_b32 v20, 16, v234
    v_and_b32 v21, s46, v234
    v_lshlrev_b32 v22, 16, v235
    v_and_b32 v23, s46, v235
    v_pk_mul_f32 v[16:17], v[16:17], s[48:49]
    v_pk_mul_f32 v[18:19], v[18:19], s[48:49]
    v_pk_mul_f32 v[20:21], v[20:21], s[48:49]
    v_pk_mul_f32 v[22:23], v[22:23], s[48:49]
    v_exp_f32 v48, v16
    v_exp_f32 v49, v17
    v_exp_f32 v50, v18
    v_exp_f32 v51, v19
    v_max3_f32 v96, |v16|, |v17|, v96
    v_max3_f32 v96, |v18|, |v19|, v96
    ds_write_b128 v247, v[48:51] offset:128
    v_exp_f32 v52, v20
    v_exp_f32 v53, v21
    v_exp_f32 v54, v22
    v_exp_f32 v55, v23
    v_max3_f32 v96, |v20|, |v21|, v96
    v_max3_f32 v96, |v22|, |v23|, v96
    ds_write_b128 v247, v[52:55] offset:144
    v_cvt_pk_bf16_f32 v236, v140, v156
    v_cvt_pk_bf16_f32 v237, v141, v157
    v_cvt_pk_bf16_f32 v238, v142, v158
    v_cvt_pk_bf16_f32 v239, v143, v159
    v_lshlrev_b32 v24, 16, v236
    v_and_b32 v25, s46, v236
    v_lshlrev_b32 v26, 16, v237
    v_and_b32 v27, s46, v237
    v_lshlrev_b32 v28, 16, v238
    v_and_b32 v29, s46, v238
    v_lshlrev_b32 v30, 16, v239
    v_and_b32 v31, s46, v239
    v_pk_mul_f32 v[24:25], v[24:25], s[48:49]
    v_pk_mul_f32 v[26:27], v[26:27], s[48:49]
    v_pk_mul_f32 v[28:29], v[28:29], s[48:49]
    v_pk_mul_f32 v[30:31], v[30:31], s[48:49]
    v_exp_f32 v56, v24
    v_exp_f32 v57, v25
    v_exp_f32 v58, v26
    v_exp_f32 v59, v27
    v_max3_f32 v96, |v24|, |v25|, v96
    v_max3_f32 v96, |v26|, |v27|, v96
    ds_write_b128 v247, v[56:59] offset:192
    v_exp_f32 v60, v28
    v_exp_f32 v61, v29
    v_exp_f32 v62, v30
    v_exp_f32 v63, v31
    v_max3_f32 v96, |v28|, |v29|, v96
    v_max3_f32 v96, |v30|, |v31|, v96
    ds_write_b128 v247, v[60:63] offset:208
    v_cmp_lt_f32 vcc, 0x42f00000, v96
    s_mov_b32 s22, 4
    s_or_b32 s44, s44, vcc_lo
    s_or_b32 s44, s44, vcc_hi
    s_cmp_lg_u32 s44, 0
    s_cbranch_scc1 L_joint_kernel_tslow
    s_waitcnt lgkmcnt(4)
    ds_read_b128 v[64:67], v246 offset:0
    ds_read_b128 v[68:71], v246 offset:16
    ds_read_b128 v[72:75], v246 offset:64
    ds_read_b128 v[76:79], v246 offset:80
    ds_read_b128 v[80:83], v246 offset:128
    ds_read_b128 v[84:87], v246 offset:144
    ds_read_b128 v[88:91], v246 offset:192
    ds_read_b128 v[92:95], v246 offset:208
    v_add_u32 v246, 1088, v246
    s_waitcnt vmcnt(0) lgkmcnt(0)
L_joint_kernel_tloop1:
    v_fma_f32 v32, v192, v64, 1.0
    v_fma_f32 v33, v193, v65, 1.0
    v_fma_f32 v34, v194, v66, 1.0
    v_fma_f32 v35, v195, v67, 1.0
    v_fma_f32 v36, v196, v68, 1.0
    v_fma_f32 v37, v197, v69, 1.0
    v_fma_f32 v38, v198, v70, 1.0
    v_fma_f32 v39, v199, v71, 1.0
    v_rcp_f32 v32, v32
    v_rcp_f32 v33, v33
    v_rcp_f32 v34, v34
    v_rcp_f32 v35, v35
    v_rcp_f32 v36, v36
    v_rcp_f32 v37, v37
    v_rcp_f32 v38, v38
    v_rcp_f32 v39, v39
    v_fma_f32 v32, v32, -2.0, 1.0
    v_fma_f32 v33, v33, -2.0, 1.0
    v_fma_f32 v34, v34, -2.0, 1.0
    v_fma_f32 v35, v35, -2.0, 1.0
    v_fma_f32 v36, v36, -2.0, 1.0
    v_fma_f32 v37, v37, -2.0, 1.0
    v_fma_f32 v38, v38, -2.0, 1.0
    v_fma_f32 v39, v39, -2.0, 1.0
    v_cvt_pk_bf16_f32 v224, v32, v33
    v_cvt_pk_bf16_f32 v225, v34, v35
    v_cvt_pk_bf16_f32 v226, v36, v37
    v_cvt_pk_bf16_f32 v227, v38, v39
    ds_write_b128 v248, v[224:227] offset:0
    v_fma_f32 v40, v200, v72, 1.0
    v_fma_f32 v41, v201, v73, 1.0
    v_fma_f32 v42, v202, v74, 1.0
    v_fma_f32 v43, v203, v75, 1.0
    v_fma_f32 v44, v204, v76, 1.0
    v_fma_f32 v45, v205, v77, 1.0
    v_fma_f32 v46, v206, v78, 1.0
    v_fma_f32 v47, v207, v79, 1.0
    v_rcp_f32 v40, v40
    v_rcp_f32 v41, v41
    v_rcp_f32 v42, v42
    v_rcp_f32 v43, v43
    v_rcp_f32 v44, v44
    v_rcp_f32 v45, v45
    v_rcp_f32 v46, v46
    v_rcp_f32 v47, v47
    v_fma_f32 v40, v40, -2.0, 1.0
    v_fma_f32 v41, v41, -2.0, 1.0
    v_fma_f32 v42, v42, -2.0, 1.0
    v_fma_f32 v43, v43, -2.0, 1.0
    v_fma_f32 v44, v44, -2.0, 1.0
    v_fma_f32 v45, v45, -2.0, 1.0
    v_fma_f32 v46, v46, -2.0, 1.0
    v_fma_f32 v47, v47, -2.0, 1.0
    v_cvt_pk_bf16_f32 v228, v40, v41
    v_cvt_pk_bf16_f32 v229, v42, v43
    v_cvt_pk_bf16_f32 v230, v44, v45
    v_cvt_pk_bf16_f32 v231, v46, v47
    ds_write_b128 v248, v[228:231] offset:1024
    v_fma_f32 v48, v208, v80, 1.0
    v_fma_f32 v49, v209, v81, 1.0
    v_fma_f32 v50, v210, v82, 1.0
    v_fma_f32 v51, v211, v83, 1.0
    v_fma_f32 v52, v212, v84, 1.0
    v_fma_f32 v53, v213, v85, 1.0
    v_fma_f32 v54, v214, v86, 1.0
    v_fma_f32 v55, v215, v87, 1.0
    v_rcp_f32 v48, v48
    v_rcp_f32 v49, v49
    v_rcp_f32 v50, v50
    v_rcp_f32 v51, v51
    v_rcp_f32 v52, v52
    v_rcp_f32 v53, v53
    v_rcp_f32 v54, v54
    v_rcp_f32 v55, v55
    v_fma_f32 v48, v48, -2.0, 1.0
    v_fma_f32 v49, v49, -2.0, 1.0
    v_fma_f32 v50, v50, -2.0, 1.0
    v_fma_f32 v51, v51, -2.0, 1.0
    v_fma_f32 v52, v52, -2.0, 1.0
    v_fma_f32 v53, v53, -2.0, 1.0
    v_fma_f32 v54, v54, -2.0, 1.0
    v_fma_f32 v55, v55, -2.0, 1.0
    v_cvt_pk_bf16_f32 v232, v48, v49
    v_cvt_pk_bf16_f32 v233, v50, v51
    v_cvt_pk_bf16_f32 v234, v52, v53
    v_cvt_pk_bf16_f32 v235, v54, v55
    ds_write_b128 v248, v[232:235] offset:2048
    v_fma_f32 v56, v216, v88, 1.0
    v_fma_f32 v57, v217, v89, 1.0
    v_fma_f32 v58, v218, v90, 1.0
    v_fma_f32 v59, v219, v91, 1.0
    v_fma_f32 v60, v220, v92, 1.0
    v_fma_f32 v61, v221, v93, 1.0
    v_fma_f32 v62, v222, v94, 1.0
    v_fma_f32 v63, v223, v95, 1.0
    ds_read_b128 v[64:67], v246 offset:0
    ds_read_b128 v[68:71], v246 offset:16
    ds_read_b128 v[72:75], v246 offset:64
    ds_read_b128 v[76:79], v246 offset:80
    ds_read_b128 v[80:83], v246 offset:128
    ds_read_b128 v[84:87], v246 offset:144
    ds_read_b128 v[88:91], v246 offset:192
    ds_read_b128 v[92:95], v246 offset:208
    v_add_u32 v246, 1088, v246
    v_rcp_f32 v56, v56
    v_rcp_f32 v57, v57
    v_rcp_f32 v58, v58
    v_rcp_f32 v59, v59
    v_rcp_f32 v60, v60
    v_rcp_f32 v61, v61
    v_rcp_f32 v62, v62
    v_rcp_f32 v63, v63
    v_fma_f32 v56, v56, -2.0, 1.0
    v_fma_f32 v57, v57, -2.0, 1.0
    v_fma_f32 v58, v58, -2.0, 1.0
    v_fma_f32 v59, v59, -2.0, 1.0
    v_fma_f32 v60, v60, -2.0, 1.0
    v_fma_f32 v61, v61, -2.0, 1.0
    v_fma_f32 v62, v62, -2.0, 1.0
    v_fma_f32 v63, v63, -2.0, 1.0
    v_cvt_pk_bf16_f32 v236, v56, v57
    v_cvt_pk_bf16_f32 v237, v58, v59
    v_cvt_pk_bf16_f32 v238, v60, v61
    v_cvt_pk_bf16_f32 v239, v62, v63
    ds_write_b128 v248, v[236:239] offset:3072
    s_waitcnt lgkmcnt(0)
    s_barrier
    v_fma_f32 v32, v192, v64, 1.0
    v_fma_f32 v33, v193, v65, 1.0
    v_fma_f32 v34, v194, v66, 1.0
    v_fma_f32 v35, v195, v67, 1.0
    v_fma_f32 v36, v196, v68, 1.0
    v_fma_f32 v37, v197, v69, 1.0
    v_fma_f32 v38, v198, v70, 1.0
    v_fma_f32 v39, v199, v71, 1.0
    v_rcp_f32 v32, v32
    v_rcp_f32 v33, v33
    v_rcp_f32 v34, v34
    v_rcp_f32 v35, v35
    v_rcp_f32 v36, v36
    v_rcp_f32 v37, v37
    v_rcp_f32 v38, v38
    v_rcp_f32 v39, v39
    v_fma_f32 v32, v32, -2.0, 1.0
    v_fma_f32 v33, v33, -2.0, 1.0
    v_fma_f32 v34, v34, -2.0, 1.0
    v_fma_f32 v35, v35, -2.0, 1.0
    v_fma_f32 v36, v36, -2.0, 1.0
    v_fma_f32 v37, v37, -2.0, 1.0
    v_fma_f32 v38, v38, -2.0, 1.0
    v_fma_f32 v39, v39, -2.0, 1.0
    v_cvt_pk_bf16_f32 v224, v32, v33
    v_cvt_pk_bf16_f32 v225, v34, v35
    v_cvt_pk_bf16_f32 v226, v36, v37
    v_cvt_pk_bf16_f32 v227, v38, v39
    ds_write_b128 v248, v[224:227] offset:16384
    v_fma_f32 v40, v200, v72, 1.0
    v_fma_f32 v41, v201, v73, 1.0
    v_fma_f32 v42, v202, v74, 1.0
    v_fma_f32 v43, v203, v75, 1.0
    v_fma_f32 v44, v204, v76, 1.0
    v_fma_f32 v45, v205, v77, 1.0
    v_fma_f32 v46, v206, v78, 1.0
    v_fma_f32 v47, v207, v79, 1.0
    v_rcp_f32 v40, v40
    v_rcp_f32 v41, v41
    v_rcp_f32 v42, v42
    v_rcp_f32 v43, v43
    v_rcp_f32 v44, v44
    v_rcp_f32 v45, v45
    v_rcp_f32 v46, v46
    v_rcp_f32 v47, v47
    v_fma_f32 v40, v40, -2.0, 1.0
    v_fma_f32 v41, v41, -2.0, 1.0
    v_fma_f32 v42, v42, -2.0, 1.0
    v_fma_f32 v43, v43, -2.0, 1.0
    v_fma_f32 v44, v44, -2.0, 1.0
    v_fma_f32 v45, v45, -2.0, 1.0
    v_fma_f32 v46, v46, -2.0, 1.0
    v_fma_f32 v47, v47, -2.0, 1.0
    v_cvt_pk_bf16_f32 v228, v40, v41
    v_cvt_pk_bf16_f32 v229, v42, v43
    v_cvt_pk_bf16_f32 v230, v44, v45
    v_cvt_pk_bf16_f32 v231, v46, v47
    ds_write_b128 v248, v[228:231] offset:17408
    v_fma_f32 v48, v208, v80, 1.0
    v_fma_f32 v49, v209, v81, 1.0
    v_fma_f32 v50, v210, v82, 1.0
    v_fma_f32 v51, v211, v83, 1.0
    v_fma_f32 v52, v212, v84, 1.0
    v_fma_f32 v53, v213, v85, 1.0
    v_fma_f32 v54, v214, v86, 1.0
    v_fma_f32 v55, v215, v87, 1.0
    v_rcp_f32 v48, v48
    v_rcp_f32 v49, v49
    v_rcp_f32 v50, v50
    v_rcp_f32 v51, v51
    v_rcp_f32 v52, v52
    v_rcp_f32 v53, v53
    v_rcp_f32 v54, v54
    v_rcp_f32 v55, v55
    v_fma_f32 v48, v48, -2.0, 1.0
    v_fma_f32 v49, v49, -2.0, 1.0
    v_fma_f32 v50, v50, -2.0, 1.0
    v_fma_f32 v51, v51, -2.0, 1.0
    v_fma_f32 v52, v52, -2.0, 1.0
    v_fma_f32 v53, v53, -2.0, 1.0
    v_fma_f32 v54, v54, -2.0, 1.0
    v_fma_f32 v55, v55, -2.0, 1.0
    v_cvt_pk_bf16_f32 v232, v48, v49
    v_cvt_pk_bf16_f32 v233, v50, v51
    v_cvt_pk_bf16_f32 v234, v52, v53
    v_cvt_pk_bf16_f32 v235, v54, v55
    ds_write_b128 v248, v[232:235] offset:18432
    v_fma_f32 v56, v216, v88, 1.0
    v_fma_f32 v57, v217, v89, 1.0
    v_fma_f32 v58, v218, v90, 1.0
    v_fma_f32 v59, v219, v91, 1.0
    v_fma_f32 v60, v220, v92, 1.0
    v_fma_f32 v61, v221, v93, 1.0
    v_fma_f32 v62, v222, v94, 1.0
    v_fma_f32 v63, v223, v95, 1.0
    ds_read_b128 v[64:67], v246 offset:0
    ds_read_b128 v[68:71], v246 offset:16
    ds_read_b128 v[72:75], v246 offset:64
    ds_read_b128 v[76:79], v246 offset:80
    ds_read_b128 v[80:83], v246 offset:128
    ds_read_b128 v[84:87], v246 offset:144
    ds_read_b128 v[88:91], v246 offset:192
    ds_read_b128 v[92:95], v246 offset:208
    v_add_u32 v246, 1088, v246
    v_rcp_f32 v56, v56
    v_rcp_f32 v57, v57
    v_rcp_f32 v58, v58
    v_rcp_f32 v59, v59
    v_rcp_f32 v60, v60
    v_rcp_f32 v61, v61
    v_rcp_f32 v62, v62
    v_rcp_f32 v63, v63
    v_fma_f32 v56, v56, -2.0, 1.0
    v_fma_f32 v57, v57, -2.0, 1.0
    v_fma_f32 v58, v58, -2.0, 1.0
    v_fma_f32 v59, v59, -2.0, 1.0
    v_fma_f32 v60, v60, -2.0, 1.0
    v_fma_f32 v61, v61, -2.0, 1.0
    v_fma_f32 v62, v62, -2.0, 1.0
    v_fma_f32 v63, v63, -2.0, 1.0
    v_cvt_pk_bf16_f32 v236, v56, v57
    v_cvt_pk_bf16_f32 v237, v58, v59
    v_cvt_pk_bf16_f32 v238, v60, v61
    v_cvt_pk_bf16_f32 v239, v62, v63
    ds_write_b128 v248, v[236:239] offset:19456
    s_waitcnt lgkmcnt(0)
    s_barrier
    s_sub_u32 s22, s22, 1
    s_cmp_lg_u32 s22, 0
    s_cbranch_scc1 L_joint_kernel_tloop1
    s_branch L_joint_kernel_fin
L_joint_kernel_tslow:
    s_waitcnt vmcnt(0)
    buffer_load_dwordx4 v[192:195], v249, s[40:43], s38 offen offset:0
    buffer_load_dwordx4 v[196:199], v249, s[40:43], s38 offen offset:16
    buffer_load_dwordx4 v[200:203], v249, s[40:43], s38 offen offset:64
    buffer_load_dwordx4 v[204:207], v249, s[40:43], s38 offen offset:80
    buffer_load_dwordx4 v[208:211], v249, s[40:43], s38 offen offset:128
    buffer_load_dwordx4 v[212:215], v249, s[40:43], s38 offen offset:144
    buffer_load_dwordx4 v[216:219], v249, s[40:43], s38 offen offset:192
    buffer_load_dwordx4 v[220:223], v249, s[40:43], s38 offen offset:208
    s_waitcnt lgkmcnt(0)
    ds_write_b128 v247, v[0:3] offset:0
    ds_write_b128 v247, v[4:7] offset:16
    ds_write_b128 v247, v[8:11] offset:64
    ds_write_b128 v247, v[12:15] offset:80
    ds_write_b128 v247, v[16:19] offset:128
    ds_write_b128 v247, v[20:23] offset:144
    ds_write_b128 v247, v[24:27] offset:192
    ds_write_b128 v247, v[28:31] offset:208
    s_waitcnt lgkmcnt(4)
    ds_read_b128 v[64:67], v246 offset:0
    ds_read_b128 v[68:71], v246 offset:16
    ds_read_b128 v[72:75], v246 offset:64
    ds_read_b128 v[76:79], v246 offset:80
    ds_read_b128 v[80:83], v246 offset:128
    ds_read_b128 v[84:87], v246 offset:144
    ds_read_b128 v[88:91], v246 offset:192
    ds_read_b128 v[92:95], v246 offset:208
    v_add_u32 v246, 1088, v246
    s_waitcnt vmcnt(0) lgkmcnt(0)
L_joint_kernel_tloop0:
    v_add_f32 v32, v192, v64
    v_add_f32 v33, v193, v65
    v_add_f32 v34, v194, v66
    v_add_f32 v35, v195, v67
    v_add_f32 v36, v196, v68
    v_add_f32 v37, v197, v69
    v_add_f32 v38, v198, v70
    v_add_f32 v39, v199, v71
    v_exp_f32 v32, v32
    v_exp_f32 v33, v33
    v_exp_f32 v34, v34
    v_exp_f32 v35, v35
    v_exp_f32 v36, v36
    v_exp_f32 v37, v37
    v_exp_f32 v38, v38
    v_exp_f32 v39, v39
    v_add_f32 v32, 1.0, v32
    v_add_f32 v33, 1.0, v33
    v_add_f32 v34, 1.0, v34
    v_add_f32 v35, 1.0, v35
    v_add_f32 v36, 1.0, v36
    v_add_f32 v37, 1.0, v37
    v_add_f32 v38, 1.0, v38
    v_add_f32 v39, 1.0, v39
    v_rcp_f32 v32, v32
    v_rcp_f32 v33, v33
    v_rcp_f32 v34, v34
    v_rcp_f32 v35, v35
    v_rcp_f32 v36, v36
    v_rcp_f32 v37, v37
    v_rcp_f32 v38, v38
    v_rcp_f32 v39, v39
    v_fma_f32 v32, v32, -2.0, 1.0
    v_fma_f32 v33, v33, -2.0, 1.0
    v_fma_f32 v34, v34, -2.0, 1.0
    v_fma_f32 v35, v35, -2.0, 1.0
    v_fma_f32 v36, v36, -2.0, 1.0
    v_fma_f32 v37, v37, -2.0, 1.0
    v_fma_f32 v38, v38, -2.0, 1.0
    v_fma_f32 v39, v39, -2.0, 1.0
    v_cvt_pk_bf16_f32 v224, v32, v33
    v_cvt_pk_bf16_f32 v225, v34, v35
    v_cvt_pk_bf16_f32 v226, v36, v37
    v_cvt_pk_bf16_f32 v227, v38, v39
    ds_write_b128 v248, v[224:227] offset:0
    v_add_f32 v40, v200, v72
    v_add_f32 v41, v201, v73
    v_add_f32 v42, v202, v74
    v_add_f32 v43, v203, v75
    v_add_f32 v44, v204, v76
    v_add_f32 v45, v205, v77
    v_add_f32 v46, v206, v78
    v_add_f32 v47, v207, v79
    v_exp_f32 v40, v40
    v_exp_f32 v41, v41
    v_exp_f32 v42, v42
    v_exp_f32 v43, v43
    v_exp_f32 v44, v44
    v_exp_f32 v45, v45
    v_exp_f32 v46, v46
    v_exp_f32 v47, v47
    v_add_f32 v40, 1.0, v40
    v_add_f32 v41, 1.0, v41
    v_add_f32 v42, 1.0, v42
    v_add_f32 v43, 1.0, v43
    v_add_f32 v44, 1.0, v44
    v_add_f32 v45, 1.0, v45
    v_add_f32 v46, 1.0, v46
    v_add_f32 v47, 1.0, v47
    v_rcp_f32 v40, v40
    v_rcp_f32 v41, v41
    v_rcp_f32 v42, v42
    v_rcp_f32 v43, v43
    v_rcp_f32 v44, v44
    v_rcp_f32 v45, v45
    v_rcp_f32 v46, v46
    v_rcp_f32 v47, v47
    v_fma_f32 v40, v40, -2.0, 1.0
    v_fma_f32 v41, v41, -2.0, 1.0
    v_fma_f32 v42, v42, -2.0, 1.0
    v_fma_f32 v43, v43, -2.0, 1.0
    v_fma_f32 v44, v44, -2.0, 1.0
    v_fma_f32 v45, v45, -2.0, 1.0
    v_fma_f32 v46, v46, -2.0, 1.0
    v_fma_f32 v47, v47, -2.0, 1.0
    v_cvt_pk_bf16_f32 v228, v40, v41
    v_cvt_pk_bf16_f32 v229, v42, v43
    v_cvt_pk_bf16_f32 v230, v44, v45
    v_cvt_pk_bf16_f32 v231, v46, v47
    ds_write_b128 v248, v[228:231] offset:1024
    v_add_f32 v48, v208, v80
    v_add_f32 v49, v209, v81
    v_add_f32 v50, v210, v82
    v_add_f32 v51, v211, v83
    v_add_f32 v52, v212, v84
    v_add_f32 v53, v213, v85
    v_add_f32 v54, v214, v86
    v_add_f32 v55, v215, v87
    v_exp_f32 v48, v48
    v_exp_f32 v49, v49
    v_exp_f32 v50, v50
    v_exp_f32 v51, v51
    v_exp_f32 v52, v52
    v_exp_f32 v53, v53
    v_exp_f32 v54, v54
    v_exp_f32 v55, v55
    v_add_f32 v48, 1.0, v48
    v_add_f32 v49, 1.0, v49
    v_add_f32 v50, 1.0, v50
    v_add_f32 v51, 1.0, v51
    v_add_f32 v52, 1.0, v52
    v_add_f32 v53, 1.0, v53
    v_add_f32 v54, 1.0, v54
    v_add_f32 v55, 1.0, v55
    v_rcp_f32 v48, v48
    v_rcp_f32 v49, v49
    v_rcp_f32 v50, v50
    v_rcp_f32 v51, v51
    v_rcp_f32 v52, v52
    v_rcp_f32 v53, v53
    v_rcp_f32 v54, v54
    v_rcp_f32 v55, v55
    v_fma_f32 v48, v48, -2.0, 1.0
    v_fma_f32 v49, v49, -2.0, 1.0
    v_fma_f32 v50, v50, -2.0, 1.0
    v_fma_f32 v51, v51, -2.0, 1.0
    v_fma_f32 v52, v52, -2.0, 1.0
    v_fma_f32 v53, v53, -2.0, 1.0
    v_fma_f32 v54, v54, -2.0, 1.0
    v_fma_f32 v55, v55, -2.0, 1.0
    v_cvt_pk_bf16_f32 v232, v48, v49
    v_cvt_pk_bf16_f32 v233, v50, v51
    v_cvt_pk_bf16_f32 v234, v52, v53
    v_cvt_pk_bf16_f32 v235, v54, v55
    ds_write_b128 v248, v[232:235] offset:2048
    v_add_f32 v56, v216, v88
    v_add_f32 v57, v217, v89
    v_add_f32 v58, v218, v90
    v_add_f32 v59, v219, v91
    v_add_f32 v60, v220, v92
    v_add_f32 v61, v221, v93
    v_add_f32 v62, v222, v94
    v_add_f32 v63, v223, v95
    ds_read_b128 v[64:67], v246 offset:0
    ds_read_b128 v[68:71], v246 offset:16
    ds_read_b128 v[72:75], v246 offset:64
    ds_read_b128 v[76:79], v246 offset:80
    ds_read_b128 v[80:83], v246 offset:128
    ds_read_b128 v[84:87], v246 offset:144
    ds_read_b128 v[88:91], v246 offset:192
    ds_read_b128 v[92:95], v246 offset:208
    v_add_u32 v246, 1088, v246
    v_exp_f32 v56, v56
    v_exp_f32 v57, v57
    v_exp_f32 v58, v58
    v_exp_f32 v59, v59
    v_exp_f32 v60, v60
    v_exp_f32 v61, v61
    v_exp_f32 v62, v62
    v_exp_f32 v63, v63
    v_add_f32 v56, 1.0, v56
    v_add_f32 v57, 1.0, v57
    v_add_f32 v58, 1.0, v58
    v_add_f32 v59, 1.0, v59
    v_add_f32 v60, 1.0, v60
    v_add_f32 v61, 1.0, v61
    v_add_f32 v62, 1.0, v62
    v_add_f32 v63, 1.0, v63
    v_rcp_f32 v56, v56
    v_rcp_f32 v57, v57
    v_rcp_f32 v58, v58
    v_rcp_f32 v59, v59
    v_rcp_f32 v60, v60
    v_rcp_f32 v61, v61
    v_rcp_f32 v62, v62
    v_rcp_f32 v63, v63
    v_fma_f32 v56, v56, -2.0, 1.0
    v_fma_f32 v57, v57, -2.0, 1.0
    v_fma_f32 v58, v58, -2.0, 1.0
    v_fma_f32 v59, v59, -2.0, 1.0
    v_fma_f32 v60, v60, -2.0, 1.0
    v_fma_f32 v61, v61, -2.0, 1.0
    v_fma_f32 v62, v62, -2.0, 1.0
    v_fma_f32 v63, v63, -2.0, 1.0
    v_cvt_pk_bf16_f32 v236, v56, v57
    v_cvt_pk_bf16_f32 v237, v58, v59
    v_cvt_pk_bf16_f32 v238, v60, v61
    v_cvt_pk_bf16_f32 v239, v62, v63
    ds_write_b128 v248, v[236:239] offset:3072
    s_waitcnt lgkmcnt(0)
    s_barrier
    v_add_f32 v32, v192, v64
    v_add_f32 v33, v193, v65
    v_add_f32 v34, v194, v66
    v_add_f32 v35, v195, v67
    v_add_f32 v36, v196, v68
    v_add_f32 v37, v197, v69
    v_add_f32 v38, v198, v70
    v_add_f32 v39, v199, v71
    v_exp_f32 v32, v32
    v_exp_f32 v33, v33
    v_exp_f32 v34, v34
    v_exp_f32 v35, v35
    v_exp_f32 v36, v36
    v_exp_f32 v37, v37
    v_exp_f32 v38, v38
    v_exp_f32 v39, v39
    v_add_f32 v32, 1.0, v32
    v_add_f32 v33, 1.0, v33
    v_add_f32 v34, 1.0, v34
    v_add_f32 v35, 1.0, v35
    v_add_f32 v36, 1.0, v36
    v_add_f32 v37, 1.0, v37
    v_add_f32 v38, 1.0, v38
    v_add_f32 v39, 1.0, v39
    v_rcp_f32 v32, v32
    v_rcp_f32 v33, v33
    v_rcp_f32 v34, v34
    v_rcp_f32 v35, v35
    v_rcp_f32 v36, v36
    v_rcp_f32 v37, v37
    v_rcp_f32 v38, v38
    v_rcp_f32 v39, v39
    v_fma_f32 v32, v32, -2.0, 1.0
    v_fma_f32 v33, v33, -2.0, 1.0
    v_fma_f32 v34, v34, -2.0, 1.0
    v_fma_f32 v35, v35, -2.0, 1.0
    v_fma_f32 v36, v36, -2.0, 1.0
    v_fma_f32 v37, v37, -2.0, 1.0
    v_fma_f32 v38, v38, -2.0, 1.0
    v_fma_f32 v39, v39, -2.0, 1.0
    v_cvt_pk_bf16_f32 v224, v32, v33
    v_cvt_pk_bf16_f32 v225, v34, v35
    v_cvt_pk_bf16_f32 v226, v36, v37
    v_cvt_pk_bf16_f32 v227, v38, v39
    ds_write_b128 v248, v[224:227] offset:16384
    v_add_f32 v40, v200, v72
    v_add_f32 v41, v201, v73
    v_add_f32 v42, v202, v74
    v_add_f32 v43, v203, v75
    v_add_f32 v44, v204, v76
    v_add_f32 v45, v205, v77
    v_add_f32 v46, v206, v78
    v_add_f32 v47, v207, v79
    v_exp_f32 v40, v40
    v_exp_f32 v41, v41
    v_exp_f32 v42, v42
    v_exp_f32 v43, v43
    v_exp_f32 v44, v44
    v_exp_f32 v45, v45
    v_exp_f32 v46, v46
    v_exp_f32 v47, v47
    v_add_f32 v40, 1.0, v40
    v_add_f32 v41, 1.0, v41
    v_add_f32 v42, 1.0, v42
    v_add_f32 v43, 1.0, v43
    v_add_f32 v44, 1.0, v44
    v_add_f32 v45, 1.0, v45
    v_add_f32 v46, 1.0, v46
    v_add_f32 v47, 1.0, v47
    v_rcp_f32 v40, v40
    v_rcp_f32 v41, v41
    v_rcp_f32 v42, v42
    v_rcp_f32 v43, v43
    v_rcp_f32 v44, v44
    v_rcp_f32 v45, v45
    v_rcp_f32 v46, v46
    v_rcp_f32 v47, v47
    v_fma_f32 v40, v40, -2.0, 1.0
    v_fma_f32 v41, v41, -2.0, 1.0
    v_fma_f32 v42, v42, -2.0, 1.0
    v_fma_f32 v43, v43, -2.0, 1.0
    v_fma_f32 v44, v44, -2.0, 1.0
    v_fma_f32 v45, v45, -2.0, 1.0
    v_fma_f32 v46, v46, -2.0, 1.0
    v_fma_f32 v47, v47, -2.0, 1.0
    v_cvt_pk_bf16_f32 v228, v40, v41
    v_cvt_pk_bf16_f32 v229, v42, v43
    v_cvt_pk_bf16_f32 v230, v44, v45
    v_cvt_pk_bf16_f32 v231, v46, v47
    ds_write_b128 v248, v[228:231] offset:17408
    v_add_f32 v48, v208, v80
    v_add_f32 v49, v209, v81
    v_add_f32 v50, v210, v82
    v_add_f32 v51, v211, v83
    v_add_f32 v52, v212, v84
    v_add_f32 v53, v213, v85
    v_add_f32 v54, v214, v86
    v_add_f32 v55, v215, v87
    v_exp_f32 v48, v48
    v_exp_f32 v49, v49
    v_exp_f32 v50, v50
    v_exp_f32 v51, v51
    v_exp_f32 v52, v52
    v_exp_f32 v53, v53
    v_exp_f32 v54, v54
    v_exp_f32 v55, v55
    v_add_f32 v48, 1.0, v48
    v_add_f32 v49, 1.0, v49
    v_add_f32 v50, 1.0, v50
    v_add_f32 v51, 1.0, v51
    v_add_f32 v52, 1.0, v52
    v_add_f32 v53, 1.0, v53
    v_add_f32 v54, 1.0, v54
    v_add_f32 v55, 1.0, v55
    v_rcp_f32 v48, v48
    v_rcp_f32 v49, v49
    v_rcp_f32 v50, v50
    v_rcp_f32 v51, v51
    v_rcp_f32 v52, v52
    v_rcp_f32 v53, v53
    v_rcp_f32 v54, v54
    v_rcp_f32 v55, v55
    v_fma_f32 v48, v48, -2.0, 1.0
    v_fma_f32 v49, v49, -2.0, 1.0
    v_fma_f32 v50, v50, -2.0, 1.0
    v_fma_f32 v51, v51, -2.0, 1.0
    v_fma_f32 v52, v52, -2.0, 1.0
    v_fma_f32 v53, v53, -2.0, 1.0
    v_fma_f32 v54, v54, -2.0, 1.0
    v_fma_f32 v55, v55, -2.0, 1.0
    v_cvt_pk_bf16_f32 v232, v48, v49
    v_cvt_pk_bf16_f32 v233, v50, v51
    v_cvt_pk_bf16_f32 v234, v52, v53
    v_cvt_pk_bf16_f32 v235, v54, v55
    ds_write_b128 v248, v[232:235] offset:18432
    v_add_f32 v56, v216, v88
    v_add_f32 v57, v217, v89
    v_add_f32 v58, v218, v90
    v_add_f32 v59, v219, v91
    v_add_f32 v60, v220, v92
    v_add_f32 v61, v221, v93
    v_add_f32 v62, v222, v94
    v_add_f32 v63, v223, v95
    ds_read_b128 v[64:67], v246 offset:0
    ds_read_b128 v[68:71], v246 offset:16
    ds_read_b128 v[72:75], v246 offset:64
    ds_read_b128 v[76:79], v246 offset:80
    ds_read_b128 v[80:83], v246 offset:128
    ds_read_b128 v[84:87], v246 offset:144
    ds_read_b128 v[88:91], v246 offset:192
    ds_read_b128 v[92:95], v246 offset:208
    v_add_u32 v246, 1088, v246
    v_exp_f32 v56, v56
    v_exp_f32 v57, v57
    v_exp_f32 v58, v58
    v_exp_f32 v59, v59
    v_exp_f32 v60, v60
    v_exp_f32 v61, v61
    v_exp_f32 v62, v62
    v_exp_f32 v63, v63
    v_add_f32 v56, 1.0, v56
    v_add_f32 v57, 1.0, v57
    v_add_f32 v58, 1.0, v58
    v_add_f32 v59, 1.0, v59
    v_add_f32 v60, 1.0, v60
    v_add_f32 v61, 1.0, v61
    v_add_f32 v62, 1.0, v62
    v_add_f32 v63, 1.0, v63
    v_rcp_f32 v56, v56
    v_rcp_f32 v57, v57
    v_rcp_f32 v58, v58
    v_rcp_f32 v59, v59
    v_rcp_f32 v60, v60
    v_rcp_f32 v61, v61
    v_rcp_f32 v62, v62
    v_rcp_f32 v63, v63
    v_fma_f32 v56, v56, -2.0, 1.0
    v_fma_f32 v57, v57, -2.0, 1.0
    v_fma_f32 v58, v58, -2.0, 1.0
    v_fma_f32 v59, v59, -2.0, 1.0
    v_fma_f32 v60, v60, -2.0, 1.0
    v_fma_f32 v61, v61, -2.0, 1.0
    v_fma_f32 v62, v62, -2.0, 1.0
    v_fma_f32 v63, v63, -2.0, 1.0
    v_cvt_pk_bf16_f32 v236, v56, v57
    v_cvt_pk_bf16_f32 v237, v58, v59
    v_cvt_pk_bf16_f32 v238, v60, v61
    v_cvt_pk_bf16_f32 v239, v62, v63
    ds_write_b128 v248, v[236:239] offset:19456
    s_waitcnt lgkmcnt(0)
    s_barrier
    s_sub_u32 s22, s22, 1
    s_cmp_lg_u32 s22, 0
    s_cbranch_scc1 L_joint_kernel_tloop0
L_joint_kernel_fin:
L_joint_kernel_done:
    s_endpgm
.section .rodata,"a"
.p2align 6
.amdhsa_kernel prep_kernel
  .amdhsa_next_free_vgpr 128
  .amdhsa_next_free_sgpr 102
  .amdhsa_accum_offset 128
  .amdhsa_group_segment_fixed_size 0
  .amdhsa_kernarg_size 80
  .amdhsa_user_sgpr_count 2
  .amdhsa_user_sgpr_kernarg_segment_ptr 1
  .amdhsa_system_sgpr_workgroup_id_x 1
.end_amdhsa_kernel
.p2align 6
.amdhsa_kernel conv1_kernel
  .amdhsa_next_free_vgpr 128
  .amdhsa_next_free_sgpr 102
  .amdhsa_accum_offset 128
  .amdhsa_group_segment_fixed_size 0
  .amdhsa_kernarg_size 80
  .amdhsa_user_sgpr_count 2
  .amdhsa_user_sgpr_kernarg_segment_ptr 1
  .amdhsa_system_sgpr_workgroup_id_x 1
.end_amdhsa_kernel
.p2align 6
.amdhsa_kernel conv2_kernel
  .amdhsa_next_free_vgpr 128
  .amdhsa_next_free_sgpr 102
  .amdhsa_accum_offset 128
  .amdhsa_group_segment_fixed_size 0
  .amdhsa_kernarg_size 80
  .amdhsa_user_sgpr_count 2
  .amdhsa_user_sgpr_kernarg_segment_ptr 1
  .amdhsa_system_sgpr_workgroup_id_x 1
.end_amdhsa_kernel
.p2align 6
.amdhsa_kernel joint_kernel
  .amdhsa_next_free_vgpr 256
  .amdhsa_next_free_sgpr 102
  .amdhsa_accum_offset 256
  .amdhsa_group_segment_fixed_size 0
  .amdhsa_kernarg_size 80
  .amdhsa_user_sgpr_count 2
  .amdhsa_user_sgpr_kernarg_segment_ptr 1
  .amdhsa_system_sgpr_workgroup_id_x 1
.end_amdhsa_kernel
```

```asm
; @launch kernel=prep_kernel grid=(268,1,1) block=(256,1,1) lds=4096
; @launch kernel=conv1_kernel grid=(256,1,1) block=(1024,1,1) lds=162816
; @launch kernel=conv2_kernel grid=(256,1,1) block=(1024,1,1) lds=162816
; @launch kernel=joint_kernel grid=(250,1,1) block=(1024,1,1) lds=99472
.amdgcn_target "amdgcn-amd-amdhsa--gfx950"
.text
.globl prep_kernel
.p2align 8
.type prep_kernel,@function
prep_kernel:
    s_cmp_ge_u32 s2, 268
    s_cbranch_scc1 L_prep_kernel_done
    s_getpc_b64 s[62:63]
L_prep_kernel_pc:
    s_and_b32 s3, s2, 8
    s_lshl_b32 s3, s3, 12
    v_lshlrev_b32 v120, 7, v0
    v_add_u32 v120, s3, v120
    v_min_u32 v120, L_joint_kernel_done-L_prep_kernel_pc, v120
    v_mov_b32 v121, s63
    v_add_co_u32 v120, vcc, s62, v120
    v_addc_co_u32 v121, vcc, 0, v121, vcc
    global_load_dword v122, v[120:121], off
    s_load_dwordx16 s[44:59], s[0:1], 0
    s_mov_b32 s3, s2
    s_sub_u32 s2, s2, 12
    v_readfirstlane_b32 s40, v0
    s_lshr_b32 s40, s40, 6
    s_lshl_b32 s21, s2, 2
    s_add_u32 s20, s40, s21
    v_and_b32 v1, 63, v0
    s_load_dwordx2 s[8:9], s[0:1], 8
    s_load_dwordx2 s[30:31], s[0:1], 72
    s_lshr_b32 s22, s20, 8
    s_bfe_u32 s23, s20, 0x40004
    s_bfe_u32 s24, s20, 0x30001
    s_and_b32 s21, s20, 1
    v_lshrrev_b32 v2, 4, v1
    v_lshlrev_b32 v2, 12, v2
    v_and_b32 v3, 15, v1
    v_lshl_add_u32 v2, v3, 2, v2
    s_lshl_b32 s26, s22, 3
    s_lshr_b32 s27, s23, 3
    s_add_u32 s26, s26, s27
    s_lshl_b32 s26, s26, 17
    s_and_b32 s27, s23, 7
    s_lshl_b32 s27, s27, 14
    s_add_u32 s26, s26, s27
    s_lshl_b32 s27, s24, 6
    s_add_u32 s26, s26, s27
    s_mov_b32 s10, 4063232
    s_mov_b32 s11, 0x00020000
    s_lshr_b32 s41, s3, 2
    s_and_b32 s42, s3, 3
    s_lshl_b32 s42, s42, 1
    s_and_b32 s43, s40, 1
    s_add_u32 s42, s42, s43
    s_lshr_b32 s43, s40, 1
    s_lshl_b32 s4, s43, 16
    s_lshl_b32 s5, s42, 6
    s_add_u32 s4, s4, s5
    s_cmp_lt_u32 s3, 12
    s_cselect_b32 s26, s4, s26
    s_cselect_b32 s10, 131072, s10
    s_mov_b32 s5, 262144
    s_cselect_b32 s5, 16384, s5
    s_add_u32 s37, s26, s5
    s_add_u32 s38, s37, s5
    s_add_u32 s39, s38, s5
    s_waitcnt lgkmcnt(0)
    s_cmp_eq_u32 s41, 0
    s_cselect_b32 s8, s52, s8
    s_cselect_b32 s9, s53, s9
    s_cmp_eq_u32 s41, 1
    s_cselect_b32 s8, s56, s8
    s_cselect_b32 s9, s57, s9
    s_cmp_eq_u32 s41, 2
    s_cselect_b32 s8, s54, s8
    s_cselect_b32 s9, s55, s9
    buffer_load_dword v16, v2, s[8:11], s26 offen offset:0
    buffer_load_dword v17, v2, s[8:11], s26 offen offset:512
    buffer_load_dword v24, v2, s[8:11], s37 offen offset:0
    buffer_load_dword v25, v2, s[8:11], s37 offen offset:512
    buffer_load_dword v32, v2, s[8:11], s38 offen offset:0
    buffer_load_dword v33, v2, s[8:11], s38 offen offset:512
    buffer_load_dword v40, v2, s[8:11], s39 offen offset:0
    buffer_load_dword v41, v2, s[8:11], s39 offen offset:512
    buffer_load_dword v18, v2, s[8:11], s26 offen offset:1024
    buffer_load_dword v19, v2, s[8:11], s26 offen offset:1536
    buffer_load_dword v26, v2, s[8:11], s37 offen offset:1024
    buffer_load_dword v27, v2, s[8:11], s37 offen offset:1536
    buffer_load_dword v34, v2, s[8:11], s38 offen offset:1024
    buffer_load_dword v35, v2, s[8:11], s38 offen offset:1536
    buffer_load_dword v42, v2, s[8:11], s39 offen offset:1024
    buffer_load_dword v43, v2, s[8:11], s39 offen offset:1536
    buffer_load_dword v20, v2, s[8:11], s26 offen offset:2048
    buffer_load_dword v21, v2, s[8:11], s26 offen offset:2560
    buffer_load_dword v28, v2, s[8:11], s37 offen offset:2048
    buffer_load_dword v29, v2, s[8:11], s37 offen offset:2560
    buffer_load_dword v36, v2, s[8:11], s38 offen offset:2048
    buffer_load_dword v37, v2, s[8:11], s38 offen offset:2560
    buffer_load_dword v44, v2, s[8:11], s39 offen offset:2048
    buffer_load_dword v45, v2, s[8:11], s39 offen offset:2560
    buffer_load_dword v22, v2, s[8:11], s26 offen offset:3072
    buffer_load_dword v23, v2, s[8:11], s26 offen offset:3584
    buffer_load_dword v30, v2, s[8:11], s37 offen offset:3072
    buffer_load_dword v31, v2, s[8:11], s37 offen offset:3584
    buffer_load_dword v38, v2, s[8:11], s38 offen offset:3072
    buffer_load_dword v39, v2, s[8:11], s38 offen offset:3584
    buffer_load_dword v46, v2, s[8:11], s39 offen offset:3072
    buffer_load_dword v47, v2, s[8:11], s39 offen offset:3584
    s_cmp_lt_u32 s3, 12
    s_cbranch_scc1 L_prep_kernel_small
    s_add_u32 s12, s30, 0
    s_addc_u32 s13, s31, 0
    s_mov_b32 s14, 7340032
    s_mov_b32 s15, 0x00020000
    v_lshlrev_b32 v4, 4, v1
    s_lshl_b32 s27, s24, 4
    s_add_u32 s27, s27, s23
    s_mul_i32 s27, s27, 57344
    s_lshl_b32 s28, s22, 11
    s_add_u32 s27, s27, s28
    s_lshl_b32 s28, s21, 10
    s_add_u32 s27, s27, s28
    s_cmp_eq_u32 s21, 0
    s_mov_b32 s32, 0x07060302
    s_cselect_b32 s32, 0x05040100, s32
    s_mov_b32 s33, 0x03020c0c
    s_cselect_b32 s33, 0x01000c0c, s33
    s_mov_b32 s35, 0x3d2aaaab
    s_mov_b32 s36, 0x3c638e39
    s_waitcnt vmcnt(24)
    v_perm_b32 v72, v17, v16, s32
    v_perm_b32 v48, v41, v40, s32
    v_perm_b32 v76, v76, v40, s33
    v_perm_b32 v84, v84, v41, s33
    v_perm_b32 v77, v77, v32, s33
    v_perm_b32 v85, v85, v33, s33
    v_perm_b32 v78, v78, v24, s33
    v_perm_b32 v86, v86, v25, s33
    v_perm_b32 v79, v79, v16, s33
    v_perm_b32 v87, v87, v17, s33
    v_add_f32 v80, v76, v78
    v_add_f32 v88, v84, v86
    v_add_f32 v81, v77, v79
    v_add_f32 v89, v85, v87
    v_fma_f32 v82, v78, 4.0, v76
    v_fma_f32 v90, v86, 4.0, v84
    v_fma_f32 v83, v79, 4.0, v77
    v_fma_f32 v91, v87, 4.0, v85
    v_add_f32 v77, v80, v81
    v_add_f32 v85, v88, v89
    v_sub_f32 v78, v80, v81
    v_sub_f32 v86, v88, v89
    v_fma_f32 v79, v83, 2.0, v82
    v_fma_f32 v87, v91, 2.0, v90
    v_fma_f32 v82, v83, -2.0, v82
    v_fma_f32 v90, v91, -2.0, v90
    v_fmamk_f32 v80, v76, 0x41700000, v82
    v_fmamk_f32 v88, v84, 0x41700000, v90
    v_fmamk_f32 v80, v81, 0x41200000, v80
    v_fmamk_f32 v88, v89, 0x41200000, v88
    v_mul_f32 v77, 0.5, v77
    v_mul_f32 v85, 0.5, v85
    v_mul_f32 v78, 0.5, v78
    v_mul_f32 v86, 0.5, v86
    v_mul_f32 v79, s35, v79
    v_mul_f32 v87, s35, v87
    v_mul_f32 v82, s35, v82
    v_mul_f32 v90, s35, v90
    v_mul_f32 v80, s36, v80
    v_mul_f32 v88, s36, v88
    v_cvt_pk_bf16_f32 v52, v77, v85
    v_cvt_pk_bf16_f32 v56, v78, v86
    v_cvt_pk_bf16_f32 v60, v79, v87
    v_cvt_pk_bf16_f32 v64, v82, v90
    v_cvt_pk_bf16_f32 v68, v80, v88
    s_waitcnt vmcnt(16)
    v_perm_b32 v73, v19, v18, s32
    v_perm_b32 v49, v43, v42, s32
    v_perm_b32 v76, v76, v42, s33
    v_perm_b32 v84, v84, v43, s33
    v_perm_b32 v77, v77, v34, s33
    v_perm_b32 v85, v85, v35, s33
    v_perm_b32 v78, v78, v26, s33
    v_perm_b32 v86, v86, v27, s33
    v_perm_b32 v79, v79, v18, s33
    v_perm_b32 v87, v87, v19, s33
    v_add_f32 v80, v76, v78
    v_add_f32 v88, v84, v86
    v_add_f32 v81, v77, v79
    v_add_f32 v89, v85, v87
    v_fma_f32 v82, v78, 4.0, v76
    v_fma_f32 v90, v86, 4.0, v84
    v_fma_f32 v83, v79, 4.0, v77
    v_fma_f32 v91, v87, 4.0, v85
    v_add_f32 v77, v80, v81
    v_add_f32 v85, v88, v89
    v_sub_f32 v78, v80, v81
    v_sub_f32 v86, v88, v89
    v_fma_f32 v79, v83, 2.0, v82
    v_fma_f32 v87, v91, 2.0, v90
    v_fma_f32 v82, v83, -2.0, v82
    v_fma_f32 v90, v91, -2.0, v90
    v_fmamk_f32 v80, v76, 0x41700000, v82
    v_fmamk_f32 v88, v84, 0x41700000, v90
    v_fmamk_f32 v80, v81, 0x41200000, v80
    v_fmamk_f32 v88, v89, 0x41200000, v88
    v_mul_f32 v77, 0.5, v77
    v_mul_f32 v85, 0.5, v85
    v_mul_f32 v78, 0.5, v78
    v_mul_f32 v86, 0.5, v86
    v_mul_f32 v79, s35, v79
    v_mul_f32 v87, s35, v87
    v_mul_f32 v82, s35, v82
    v_mul_f32 v90, s35, v90
    v_mul_f32 v80, s36, v80
    v_mul_f32 v88, s36, v88
    v_cvt_pk_bf16_f32 v53, v77, v85
    v_cvt_pk_bf16_f32 v57, v78, v86
    v_cvt_pk_bf16_f32 v61, v79, v87
    v_cvt_pk_bf16_f32 v65, v82, v90
    v_cvt_pk_bf16_f32 v69, v80, v88
    s_waitcnt vmcnt(8)
    v_perm_b32 v74, v21, v20, s32
    v_perm_b32 v50, v45, v44, s32
    v_perm_b32 v76, v76, v44, s33
    v_perm_b32 v84, v84, v45, s33
    v_perm_b32 v77, v77, v36, s33
    v_perm_b32 v85, v85, v37, s33
    v_perm_b32 v78, v78, v28, s33
    v_perm_b32 v86, v86, v29, s33
    v_perm_b32 v79, v79, v20, s33
    v_perm_b32 v87, v87, v21, s33
    v_add_f32 v80, v76, v78
    v_add_f32 v88, v84, v86
    v_add_f32 v81, v77, v79
    v_add_f32 v89, v85, v87
    v_fma_f32 v82, v78, 4.0, v76
    v_fma_f32 v90, v86, 4.0, v84
    v_fma_f32 v83, v79, 4.0, v77
    v_fma_f32 v91, v87, 4.0, v85
    v_add_f32 v77, v80, v81
    v_add_f32 v85, v88, v89
    v_sub_f32 v78, v80, v81
    v_sub_f32 v86, v88, v89
    v_fma_f32 v79, v83, 2.0, v82
    v_fma_f32 v87, v91, 2.0, v90
    v_fma_f32 v82, v83, -2.0, v82
    v_fma_f32 v90, v91, -2.0, v90
    v_fmamk_f32 v80, v76, 0x41700000, v82
    v_fmamk_f32 v88, v84, 0x41700000, v90
    v_fmamk_f32 v80, v81, 0x41200000, v80
    v_fmamk_f32 v88, v89, 0x41200000, v88
    v_mul_f32 v77, 0.5, v77
    v_mul_f32 v85, 0.5, v85
    v_mul_f32 v78, 0.5, v78
    v_mul_f32 v86, 0.5, v86
    v_mul_f32 v79, s35, v79
    v_mul_f32 v87, s35, v87
    v_mul_f32 v82, s35, v82
    v_mul_f32 v90, s35, v90
    v_mul_f32 v80, s36, v80
    v_mul_f32 v88, s36, v88
    v_cvt_pk_bf16_f32 v54, v77, v85
    v_cvt_pk_bf16_f32 v58, v78, v86
    v_cvt_pk_bf16_f32 v62, v79, v87
    v_cvt_pk_bf16_f32 v66, v82, v90
    v_cvt_pk_bf16_f32 v70, v80, v88
    s_waitcnt vmcnt(0)
    v_perm_b32 v75, v23, v22, s32
    v_perm_b32 v51, v47, v46, s32
    v_perm_b32 v76, v76, v46, s33
    v_perm_b32 v84, v84, v47, s33
    v_perm_b32 v77, v77, v38, s33
    v_perm_b32 v85, v85, v39, s33
    v_perm_b32 v78, v78, v30, s33
    v_perm_b32 v86, v86, v31, s33
    v_perm_b32 v79, v79, v22, s33
    v_perm_b32 v87, v87, v23, s33
    v_add_f32 v80, v76, v78
    v_add_f32 v88, v84, v86
    v_add_f32 v81, v77, v79
    v_add_f32 v89, v85, v87
    v_fma_f32 v82, v78, 4.0, v76
    v_fma_f32 v90, v86, 4.0, v84
    v_fma_f32 v83, v79, 4.0, v77
    v_fma_f32 v91, v87, 4.0, v85
    v_add_f32 v77, v80, v81
    v_add_f32 v85, v88, v89
    v_sub_f32 v78, v80, v81
    v_sub_f32 v86, v88, v89
    v_fma_f32 v79, v83, 2.0, v82
    v_fma_f32 v87, v91, 2.0, v90
    v_fma_f32 v82, v83, -2.0, v82
    v_fma_f32 v90, v91, -2.0, v90
    v_fmamk_f32 v80, v76, 0x41700000, v82
    v_fmamk_f32 v88, v84, 0x41700000, v90
    v_fmamk_f32 v80, v81, 0x41200000, v80
    v_fmamk_f32 v88, v89, 0x41200000, v88
    v_mul_f32 v77, 0.5, v77
    v_mul_f32 v85, 0.5, v85
    v_mul_f32 v78, 0.5, v78
    v_mul_f32 v86, 0.5, v86
    v_mul_f32 v79, s35, v79
    v_mul_f32 v87, s35, v87
    v_mul_f32 v82, s35, v82
    v_mul_f32 v90, s35, v90
    v_mul_f32 v80, s36, v80
    v_mul_f32 v88, s36, v88
    v_cvt_pk_bf16_f32 v55, v77, v85
    v_cvt_pk_bf16_f32 v59, v78, v86
    v_cvt_pk_bf16_f32 v63, v79, v87
    v_cvt_pk_bf16_f32 v67, v82, v90
    v_cvt_pk_bf16_f32 v71, v80, v88
    s_add_u32 s28, s27, 49152
    buffer_store_dwordx4 v[72:75], v4, s[12:15], s28 offen sc1
    s_add_u32 s28, s27, 0
    buffer_store_dwordx4 v[48:51], v4, s[12:15], s28 offen sc1
    s_add_u32 s28, s27, 8192
    buffer_store_dwordx4 v[52:55], v4, s[12:15], s28 offen sc1
    s_add_u32 s28, s27, 16384
    buffer_store_dwordx4 v[56:59], v4, s[12:15], s28 offen sc1
    s_add_u32 s28, s27, 24576
    buffer_store_dwordx4 v[60:63], v4, s[12:15], s28 offen sc1
    s_add_u32 s28, s27, 32768
    buffer_store_dwordx4 v[64:67], v4, s[12:15], s28 offen sc1
    s_add_u32 s28, s27, 40960
    buffer_store_dwordx4 v[68:71], v4, s[12:15], s28 offen sc1
L_prep_kernel_done:
    s_endpgm
L_prep_kernel_small:
    s_mov_b32 s16, s50
    s_mov_b32 s17, s51
    s_mov_b32 s18, 8192
    s_mov_b32 s19, 0x00020000
    v_lshrrev_b32 v2, 4, v1
    v_lshlrev_b32 v6, 9, v3
    v_lshl_add_u32 v6, v2, 4, v6
    s_lshl_b32 s24, s43, 8
    s_cmp_eq_u32 s41, 2
    s_cselect_b32 s24, s24, 0x100000
    buffer_load_dwordx4 v[80:83], v6, s[16:19], s24 offen offset:0
    buffer_load_dwordx4 v[84:87], v6, s[16:19], s24 offen offset:64
    buffer_load_dwordx4 v[88:91], v6, s[16:19], s24 offen offset:128
    buffer_load_dwordx4 v[92:95], v6, s[16:19], s24 offen offset:192
    s_lshl_b32 s24, s41, 17
    s_add_u32 s24, s24, 44040192
    s_add_u32 s12, s30, s24
    s_addc_u32 s13, s31, 0
    s_mov_b32 s14, 131072
    s_mov_b32 s15, 0x00020000
    s_mov_b32 s32, 0x05040100
    s_mov_b32 s33, 0x07060302
    v_lshlrev_b32 v4, 4, v1
    s_lshl_b32 s24, s42, 14
    s_lshl_b32 s25, s43, 13
    s_add_u32 s24, s24, s25
    s_add_u32 s25, s24, 4096
    s_waitcnt vmcnt(4)
    v_perm_b32 v48, v17, v16, s32
    v_perm_b32 v49, v19, v18, s32
    v_perm_b32 v50, v21, v20, s32
    v_perm_b32 v51, v23, v22, s32
    v_perm_b32 v52, v17, v16, s33
    v_perm_b32 v53, v19, v18, s33
    v_perm_b32 v54, v21, v20, s33
    v_perm_b32 v55, v23, v22, s33
    v_perm_b32 v56, v25, v24, s32
    v_perm_b32 v57, v27, v26, s32
    v_perm_b32 v58, v29, v28, s32
    v_perm_b32 v59, v31, v30, s32
    v_perm_b32 v60, v25, v24, s33
    v_perm_b32 v61, v27, v26, s33
    v_perm_b32 v62, v29, v28, s33
    v_perm_b32 v63, v31, v30, s33
    v_perm_b32 v64, v33, v32, s32
    v_perm_b32 v65, v35, v34, s32
    v_perm_b32 v66, v37, v36, s32
    v_perm_b32 v67, v39, v38, s32
    v_perm_b32 v68, v33, v32, s33
    v_perm_b32 v69, v35, v34, s33
    v_perm_b32 v70, v37, v36, s33
    v_perm_b32 v71, v39, v38, s33
    v_perm_b32 v72, v41, v40, s32
    v_perm_b32 v73, v43, v42, s32
    v_perm_b32 v74, v45, v44, s32
    v_perm_b32 v75, v47, v46, s32
    v_perm_b32 v76, v41, v40, s33
    v_perm_b32 v77, v43, v42, s33
    v_perm_b32 v78, v45, v44, s33
    v_perm_b32 v79, v47, v46, s33
    s_cmp_eq_u32 s41, 2
    s_cbranch_scc1 L_prep_kernel_ge
    buffer_store_dwordx4 v[48:51], v4, s[12:15], s24 offen offset:0 sc1
    buffer_store_dwordx4 v[52:55], v4, s[12:15], s24 offen offset:1024 sc1
    buffer_store_dwordx4 v[56:59], v4, s[12:15], s24 offen offset:2048 sc1
    buffer_store_dwordx4 v[60:63], v4, s[12:15], s24 offen offset:3072 sc1
    buffer_store_dwordx4 v[64:67], v4, s[12:15], s25 offen offset:0 sc1
    buffer_store_dwordx4 v[68:71], v4, s[12:15], s25 offen offset:1024 sc1
    buffer_store_dwordx4 v[72:75], v4, s[12:15], s25 offen offset:2048 sc1
    buffer_store_dwordx4 v[76:79], v4, s[12:15], s25 offen offset:3072 sc1
    s_endpgm
L_prep_kernel_ge:
    s_waitcnt vmcnt(0)
    v_mfma_f32_16x16x32_bf16 v[96:99], v[48:51], v[80:83], 0
    v_mfma_f32_16x16x32_bf16 v[100:103], v[52:55], v[80:83], 0
    v_mfma_f32_16x16x32_bf16 v[96:99], v[56:59], v[84:87], v[96:99]
    v_mfma_f32_16x16x32_bf16 v[100:103], v[60:63], v[84:87], v[100:103]
    v_mfma_f32_16x16x32_bf16 v[96:99], v[64:67], v[88:91], v[96:99]
    v_mfma_f32_16x16x32_bf16 v[100:103], v[68:71], v[88:91], v[100:103]
    v_mfma_f32_16x16x32_bf16 v[96:99], v[72:75], v[92:95], v[96:99]
    v_mfma_f32_16x16x32_bf16 v[100:103], v[76:79], v[92:95], v[100:103]
    s_and_b32 s24, s40, 1
    s_lshl_b32 s24, s24, 11
    v_add_u32 v7, s24, v4
    s_mov_b32 s14, 16384
    v_lshlrev_b32 v8, 10, v3
    v_lshl_add_u32 v8, v2, 5, v8
    s_lshl_b32 s24, s42, 7
    s_mov_b32 s34, 0xffff0000
    s_mov_b32 s35, 0x4038aa3b
    s_cmp_eq_u32 s43, 0
    s_cbranch_scc1 L_prep_kernel_ge0
    ds_write_b128 v7, v[96:99]
    ds_write_b128 v7, v[100:103] offset:1024
    s_waitcnt lgkmcnt(0)
    s_barrier
    s_endpgm
L_prep_kernel_ge0:
    s_barrier
    ds_read_b128 v[16:19], v7
    ds_read_b128 v[20:23], v7 offset:1024
    s_waitcnt lgkmcnt(0)
    v_add_f32 v16, v16, v96
    v_add_f32 v17, v17, v97
    v_add_f32 v18, v18, v98
    v_add_f32 v19, v19, v99
    v_add_f32 v20, v20, v100
    v_add_f32 v21, v21, v101
    v_add_f32 v22, v22, v102
    v_add_f32 v23, v23, v103
    v_cvt_pk_bf16_f32 v48, v16, v20
    v_cvt_pk_bf16_f32 v49, v17, v21
    v_cvt_pk_bf16_f32 v50, v18, v22
    v_cvt_pk_bf16_f32 v51, v19, v23
    v_lshlrev_b32 v56, 16, v48
    v_and_b32 v57, s34, v48
    v_lshlrev_b32 v58, 16, v49
    v_and_b32 v59, s34, v49
    v_lshlrev_b32 v60, 16, v50
    v_and_b32 v61, s34, v50
    v_lshlrev_b32 v62, 16, v51
    v_and_b32 v63, s34, v51
    v_mul_f32 v56, s35, v56
    v_mul_f32 v57, s35, v57
    v_mul_f32 v58, s35, v58
    v_mul_f32 v59, s35, v59
    v_mul_f32 v60, s35, v60
    v_mul_f32 v61, s35, v61
    v_mul_f32 v62, s35, v62
    v_mul_f32 v63, s35, v63
    buffer_store_dwordx4 v[56:59], v8, s[12:15], s24 offen sc1
    buffer_store_dwordx4 v[60:63], v8, s[12:15], s24 offen offset:16 sc1
    v_exp_f32 v64, v56
    v_exp_f32 v65, v57
    v_exp_f32 v66, v58
    v_exp_f32 v67, v59
    v_exp_f32 v68, v60
    v_exp_f32 v69, v61
    v_exp_f32 v70, v62
    v_exp_f32 v71, v63
    v_max3_f32 v72, |v56|, |v57|, |v58|
    v_max3_f32 v72, |v59|, |v60|, v72
    v_max3_f32 v72, |v61|, |v62|, v72
    v_max_f32 v72, |v63|, v72
    s_add_u32 s12, s12, 16384
    s_addc_u32 s13, s13, 0
    v_cmp_lt_f32 vcc, 0x42f00000, v72
    buffer_store_dwordx4 v[64:67], v8, s[12:15], s24 offen sc1
    buffer_store_dwordx4 v[68:71], v8, s[12:15], s24 offen offset:16 sc1
    s_add_u32 s12, s12, 16384
    s_addc_u32 s13, s13, 0
    s_or_b32 s26, vcc_lo, vcc_hi
    s_lshl_b32 s24, s42, 2
    v_mov_b32 v73, s26
    v_mov_b32 v74, 0
    buffer_store_dword v73, v74, s[12:15], s24 offen sc1
    s_endpgm
.globl conv1_kernel
.p2align 8
.type conv1_kernel,@function
conv1_kernel:
    s_cmp_ge_u32 s2, 256
    s_cbranch_scc1 L_conv1_kernel_done
    s_load_dwordx2 s[4:5], s[0:1], 0
    s_load_dwordx2 s[30:31], s[0:1], 72
    v_readfirstlane_b32 s20, v0
    s_lshr_b32 s20, s20, 6
    s_and_b32 s36, s2, 0
    s_lshl_b32 s36, s36, 3
    s_bfe_u32 s37, s2, 196611
    s_or_b32 s29, s36, s37
    s_bfe_u32 s36, s2, 196608
    s_lshl_b32 s36, s36, 2
    s_lshr_b32 s37, s2, 6
    s_or_b32 s36, s36, s37
    s_mov_b32 s33, 0
    s_and_b32 s34, s36, 15
    s_lshr_b32 s35, s36, 4
    s_mul_i32 s21, s34, 500
    s_and_b32 s32, s20, 3
    v_and_b32 v127, 63, v0
    v_lshrrev_b32 v5, 2, v127
    v_and_b32 v6, 3, v127
    s_and_b32 s42, s20, 7
    v_lshlrev_b32 v7, 15, v5
    v_lshl_add_u32 v7, v6, 4, v7
    s_lshl_b32 s41, s21, 10
    s_sub_u32 s41, s41, 7680
    s_lshl_b32 s37, s42, 12
    s_add_u32 s37, s37, s41
    v_add_u32 v7, s37, v7
    s_mul_i32 s36, s35, 8192000
    s_mov_b32 s10, 8192000
    s_mov_b32 s11, 0x00020000
    s_mov_b32 s25, 0xffff0000
    s_waitcnt lgkmcnt(0)
    s_add_u32 s8, s4, s36
    s_addc_u32 s9, s5, 0
    s_cmp_ge_u32 s20, 8
    s_cbranch_scc1 L_conv1_kernel_helper
    s_add_u32 s37, s41, 524288
    v_lshl_add_u32 v108, v127, 4, s37
    v_add_u32 v109, 1024, v108
    v_add_u32 v110, 2048, v108
    s_lshl_b32 s36, s29, 4
    s_lshl_b32 s37, s33, 3
    s_add_u32 s36, s36, s37
    s_mul_i32 s36, s36, 57344
    s_add_u32 s36, s36, 0
    s_add_u32 s12, s30, s36
    s_addc_u32 s13, s31, 0
    s_mov_b32 s14, 917504
    s_mov_b32 s15, 0x00020000
    s_mul_i32 s36, s35, 4194304
    s_add_u32 s36, s36, 18874368
    s_add_u32 s16, s30, s36
    s_addc_u32 s17, s31, 0
    s_mov_b32 s18, 4194304
    s_mov_b32 s19, 0x00020000
    v_and_b32 v10, 15, v127
    v_lshrrev_b32 v11, 4, v127
    v_add_u32 v8, 0, v10
    v_and_b32 v16, 4, v8
    v_lshrrev_b32 v16, 1, v16
    v_xor_b32 v16, v11, v16
    v_lshlrev_b32 v16, 4, v16
    v_lshl_add_u32 v8, v8, 6, v16
    v_add_u32 v9, 1, v10
    v_and_b32 v16, 4, v9
    v_lshrrev_b32 v16, 1, v16
    v_xor_b32 v16, v11, v16
    v_lshlrev_b32 v16, 4, v16
    v_lshl_add_u32 v9, v9, 6, v16
    s_lshr_b32 s38, s32, 1
    s_and_b32 s39, s32, 1
    s_add_u32 s40, s38, 4
    s_lshl_b32 s43, s39, 10
    s_cmp_lt_u32 s20, 4
    s_cselect_b32 s40, s20, s40
    s_cselect_b32 s36, 0, s43
    s_lshl_b32 s37, s40, 13
    s_add_u32 s37, s37, s36
    v_lshl_add_u32 v125, v127, 4, s37
    s_mul_i32 s37, s40, 16384
    v_add_u32 v120, s37, v8
    v_add_u32 v121, s37, v9
    s_lshl_b32 s37, s40, 10
    s_add_u32 s37, s37, 115712
    v_lshl_add_u32 v16, v11, 4, s37
    v_cmp_eq_u32 vcc, 15, v10
    v_mov_b32 v17, 8192
    v_mov_b32 v18, 4294959104
    v_mov_b32 v19, 64
    v_cndmask_b32 v122, v121, v16, vcc
    v_cndmask_b32 v123, v17, v19, vcc
    v_cndmask_b32 v124, v18, v19, vcc
    v_lshl_add_u32 v126, v127, 4, s37
    s_mov_b32 s44, 0x3f800000
    s_mov_b32 s45, 0x00000000
    s_mov_b32 s46, 0x00000000
    s_cmp_eq_u32 s40, 1
    s_cselect_b32 s45, 0x3f800000, s45
    s_cselect_b32 s46, 0x3f800000, s46
    s_cmp_eq_u32 s40, 2
    s_cselect_b32 s45, 0xbf800000, s45
    s_cselect_b32 s46, 0x3f800000, s46
    s_cmp_eq_u32 s40, 3
    s_cselect_b32 s45, 0x40000000, s45
    s_cselect_b32 s46, 0x40800000, s46
    s_cmp_eq_u32 s40, 4
    s_cselect_b32 s45, 0xc0000000, s45
    s_cselect_b32 s46, 0x40800000, s46
    s_cmp_eq_u32 s40, 5
    s_cselect_b32 s44, 0x41800000, s44
    s_cselect_b32 s45, 0x41000000, s45
    s_cselect_b32 s46, 0x40800000, s46
    s_cmp_ge_u32 s20, 4
    s_cbranch_scc1 L_conv1_kernel_m2
    v_mov_b32 v0, 0
    v_mov_b32 v1, 0
    v_mov_b32 v2, 0
    v_mov_b32 v3, 0
    v_mov_b32 v4, 0
    v_mov_b32 v5, 0
    v_mov_b32 v6, 0
    v_mov_b32 v7, 0
    v_mov_b32 v8, 0
    v_mov_b32 v9, 0
    v_mov_b32 v10, 0
    v_mov_b32 v11, 0
    v_mov_b32 v12, 0
    v_mov_b32 v13, 0
    v_mov_b32 v14, 0
    v_mov_b32 v15, 0
    v_mov_b32 v16, 0
    v_mov_b32 v17, 0
    v_mov_b32 v18, 0
    v_mov_b32 v19, 0
    v_mov_b32 v20, 0
    v_mov_b32 v21, 0
    v_mov_b32 v22, 0
    v_mov_b32 v23, 0
    v_mov_b32 v24, 0
    v_mov_b32 v25, 0
    v_mov_b32 v26, 0
    v_mov_b32 v27, 0
    v_mov_b32 v28, 0
    v_mov_b32 v29, 0
    v_mov_b32 v30, 0
    v_mov_b32 v31, 0
    v_mov_b32 v32, 0
    v_mov_b32 v33, 0
    v_mov_b32 v34, 0
    v_mov_b32 v35, 0
    v_mov_b32 v36, 0
    v_mov_b32 v37, 0
    v_mov_b32 v38, 0
    v_mov_b32 v39, 0
    v_mov_b32 v40, 0
    v_mov_b32 v41, 0
    v_mov_b32 v42, 0
    v_mov_b32 v43, 0
    v_mov_b32 v44, 0
    v_mov_b32 v45, 0
    v_mov_b32 v46, 0
    v_mov_b32 v47, 0
    v_mov_b32 v48, 0
    v_mov_b32 v49, 0
    v_mov_b32 v50, 0
    v_mov_b32 v51, 0
    v_mov_b32 v52, 0
    v_mov_b32 v53, 0
    v_mov_b32 v54, 0
    v_mov_b32 v55, 0
    v_mov_b32 v56, 0
    v_mov_b32 v57, 0
    v_mov_b32 v58, 0
    v_mov_b32 v59, 0
    v_mov_b32 v60, 0
    v_mov_b32 v61, 0
    v_mov_b32 v62, 0
    v_mov_b32 v63, 0
    s_barrier
    buffer_load_dwordx4 v[96:99], v108, s[8:11], 0 offen
    buffer_load_dwordx4 v[100:103], v109, s[8:11], 0 offen
    buffer_load_dwordx4 v[104:107], v110, s[8:11], 0 offen
    s_mov_b32 s23, 0
    s_mov_b32 s26, 4096
    buffer_load_dwordx4 v[64:67], v125, s[12:15], s23 offen offset:0
    buffer_load_dwordx4 v[68:71], v125, s[12:15], s23 offen offset:1024
    buffer_load_dwordx4 v[72:75], v125, s[12:15], s23 offen offset:2048
    buffer_load_dwordx4 v[76:79], v125, s[12:15], s23 offen offset:3072
    buffer_load_dwordx4 v[80:83], v125, s[12:15], s26 offen offset:0
    buffer_load_dwordx4 v[84:87], v125, s[12:15], s26 offen offset:1024
    buffer_load_dwordx4 v[88:91], v125, s[12:15], s26 offen offset:2048
    buffer_load_dwordx4 v[92:95], v125, s[12:15], s26 offen offset:3072
    s_mov_b32 s23, 57344
    s_mov_b32 s26, 61440
    s_waitcnt vmcnt(8)
    v_lshlrev_b32 v108, 16, v96
    v_and_b32 v111, s25, v96
    v_lshlrev_b32 v109, 16, v100
    v_and_b32 v112, s25, v100
    v_lshlrev_b32 v110, 16, v104
    v_and_b32 v113, s25, v104
    v_mul_f32 v114, s44, v108
    v_mul_f32 v115, s44, v111
    v_fmac_f32 v114, s45, v109
    v_fmac_f32 v115, s45, v112
    v_fmac_f32 v114, s46, v110
    v_fmac_f32 v115, s46, v113
    v_cvt_pk_bf16_f32 v96, v114, v115
    v_lshlrev_b32 v108, 16, v97
    v_and_b32 v111, s25, v97
    v_lshlrev_b32 v109, 16, v101
    v_and_b32 v112, s25, v101
    v_lshlrev_b32 v110, 16, v105
    v_and_b32 v113, s25, v105
    v_mul_f32 v114, s44, v108
    v_mul_f32 v115, s44, v111
    v_fmac_f32 v114, s45, v109
    v_fmac_f32 v115, s45, v112
    v_fmac_f32 v114, s46, v110
    v_fmac_f32 v115, s46, v113
    v_cvt_pk_bf16_f32 v97, v114, v115
    v_lshlrev_b32 v108, 16, v98
    v_and_b32 v111, s25, v98
    v_lshlrev_b32 v109, 16, v102
    v_and_b32 v112, s25, v102
    v_lshlrev_b32 v110, 16, v106
    v_and_b32 v113, s25, v106
    v_mul_f32 v114, s44, v108
    v_mul_f32 v115, s44, v111
    v_fmac_f32 v114, s45, v109
    v_fmac_f32 v115, s45, v112
    v_fmac_f32 v114, s46, v110
    v_fmac_f32 v115, s46, v113
    v_cvt_pk_bf16_f32 v98, v114, v115
    v_lshlrev_b32 v108, 16, v99
    v_and_b32 v111, s25, v99
    v_lshlrev_b32 v109, 16, v103
    v_and_b32 v112, s25, v103
    v_lshlrev_b32 v110, 16, v107
    v_and_b32 v113, s25, v107
    v_mul_f32 v114, s44, v108
    v_mul_f32 v115, s44, v111
    v_fmac_f32 v114, s45, v109
    v_fmac_f32 v115, s45, v112
    v_fmac_f32 v114, s46, v110
    v_fmac_f32 v115, s46, v113
    v_cvt_pk_bf16_f32 v99, v114, v115
    ds_write_b128 v126, v[96:99]
    s_waitcnt lgkmcnt(0)
    s_barrier
    s_mov_b32 s22, 8
    s_setprio 2
L_conv1_kernel_mloop1:
    ds_read_b128 v[96:99], v120 offset:0
    ds_read_b128 v[100:103], v120 offset:1024
    ds_read_b128 v[104:107], v120 offset:2048
    ds_read_b128 v[108:111], v120 offset:3072
    ds_read_b128 v[112:115], v120 offset:4096
    ds_read_b128 v[116:119], v120 offset:5120
    s_waitcnt vmcnt(6) lgkmcnt(5)
    v_mfma_f32_16x16x32_bf16 v[0:3], v[64:67], v[96:99], v[0:3]
    v_mfma_f32_16x16x32_bf16 v[32:35], v[68:71], v[96:99], v[32:35]
    ds_read_b128 v[96:99], v120 offset:6144
    s_waitcnt vmcnt(4) lgkmcnt(5)
    v_mfma_f32_16x16x32_bf16 v[4:7], v[64:67], v[100:103], v[4:7]
    v_mfma_f32_16x16x32_bf16 v[36:39], v[68:71], v[100:103], v[36:39]
    v_mfma_f32_16x16x32_bf16 v[0:3], v[72:75], v[100:103], v[0:3]
    v_mfma_f32_16x16x32_bf16 v[32:35], v[76:79], v[100:103], v[32:35]
    ds_read_b128 v[100:103], v120 offset:7168
    s_waitcnt vmcnt(2) lgkmcnt(5)
    v_mfma_f32_16x16x32_bf16 v[8:11], v[64:67], v[104:107], v[8:11]
    v_mfma_f32_16x16x32_bf16 v[40:43], v[68:71], v[104:107], v[40:43]
    v_mfma_f32_16x16x32_bf16 v[4:7], v[72:75], v[104:107], v[4:7]
    v_mfma_f32_16x16x32_bf16 v[36:39], v[76:79], v[104:107], v[36:39]
    v_mfma_f32_16x16x32_bf16 v[0:3], v[80:83], v[104:107], v[0:3]
    v_mfma_f32_16x16x32_bf16 v[32:35], v[84:87], v[104:107], v[32:35]
    ds_read_b128 v[104:107], v122 offset:0
    v_add_u32 v122, v123, v122
    s_waitcnt vmcnt(0) lgkmcnt(5)
    v_mfma_f32_16x16x32_bf16 v[12:15], v[64:67], v[108:111], v[12:15]
    v_mfma_f32_16x16x32_bf16 v[44:47], v[68:71], v[108:111], v[44:47]
    v_mfma_f32_16x16x32_bf16 v[8:11], v[72:75], v[108:111], v[8:11]
    v_mfma_f32_16x16x32_bf16 v[40:43], v[76:79], v[108:111], v[40:43]
    v_mfma_f32_16x16x32_bf16 v[4:7], v[80:83], v[108:111], v[4:7]
    v_mfma_f32_16x16x32_bf16 v[36:39], v[84:87], v[108:111], v[36:39]
    v_mfma_f32_16x16x32_bf16 v[0:3], v[88:91], v[108:111], v[0:3]
    v_mfma_f32_16x16x32_bf16 v[32:35], v[92:95], v[108:111], v[32:35]
    ds_read_b128 v[108:111], v121 offset:1024
    s_waitcnt lgkmcnt(5)
    v_mfma_f32_16x16x32_bf16 v[16:19], v[64:67], v[112:115], v[16:19]
    v_mfma_f32_16x16x32_bf16 v[48:51], v[68:71], v[112:115], v[48:51]
    v_mfma_f32_16x16x32_bf16 v[12:15], v[72:75], v[112:115], v[12:15]
    v_mfma_f32_16x16x32_bf16 v[44:47], v[76:79], v[112:115], v[44:47]
    v_mfma_f32_16x16x32_bf16 v[8:11], v[80:83], v[112:115], v[8:11]
    v_mfma_f32_16x16x32_bf16 v[40:43], v[84:87], v[112:115], v[40:43]
    v_mfma_f32_16x16x32_bf16 v[4:7], v[88:91], v[112:115], v[4:7]
    v_mfma_f32_16x16x32_bf16 v[36:39], v[92:95], v[112:115], v[36:39]
    ds_read_b128 v[112:115], v121 offset:2048
    s_waitcnt lgkmcnt(5)
    v_mfma_f32_16x16x32_bf16 v[20:23], v[64:67], v[116:119], v[20:23]
    v_mfma_f32_16x16x32_bf16 v[52:55], v[68:71], v[116:119], v[52:55]
    v_mfma_f32_16x16x32_bf16 v[16:19], v[72:75], v[116:119], v[16:19]
    v_mfma_f32_16x16x32_bf16 v[48:51], v[76:79], v[116:119], v[48:51]
    v_mfma_f32_16x16x32_bf16 v[12:15], v[80:83], v[116:119], v[12:15]
    v_mfma_f32_16x16x32_bf16 v[44:47], v[84:87], v[116:119], v[44:47]
    v_mfma_f32_16x16x32_bf16 v[8:11], v[88:91], v[116:119], v[8:11]
    v_mfma_f32_16x16x32_bf16 v[40:43], v[92:95], v[116:119], v[40:43]
    s_waitcnt lgkmcnt(4)
    v_mfma_f32_16x16x32_bf16 v[24:27], v[64:67], v[96:99], v[24:27]
    v_mfma_f32_16x16x32_bf16 v[56:59], v[68:71], v[96:99], v[56:59]
    v_mfma_f32_16x16x32_bf16 v[20:23], v[72:75], v[96:99], v[20:23]
    v_mfma_f32_16x16x32_bf16 v[52:55], v[76:79], v[96:99], v[52:55]
    v_mfma_f32_16x16x32_bf16 v[16:19], v[80:83], v[96:99], v[16:19]
    v_mfma_f32_16x16x32_bf16 v[48:51], v[84:87], v[96:99], v[48:51]
    v_mfma_f32_16x16x32_bf16 v[12:15], v[88:91], v[96:99], v[12:15]
    v_mfma_f32_16x16x32_bf16 v[44:47], v[92:95], v[96:99], v[44:47]
    s_waitcnt lgkmcnt(3)
    v_mfma_f32_16x16x32_bf16 v[28:31], v[64:67], v[100:103], v[28:31]
    v_mfma_f32_16x16x32_bf16 v[60:63], v[68:71], v[100:103], v[60:63]
    v_mfma_f32_16x16x32_bf16 v[24:27], v[72:75], v[100:103], v[24:27]
    v_mfma_f32_16x16x32_bf16 v[56:59], v[76:79], v[100:103], v[56:59]
    v_mfma_f32_16x16x32_bf16 v[20:23], v[80:83], v[100:103], v[20:23]
    v_mfma_f32_16x16x32_bf16 v[52:55], v[84:87], v[100:103], v[52:55]
    v_mfma_f32_16x16x32_bf16 v[16:19], v[88:91], v[100:103], v[16:19]
    v_mfma_f32_16x16x32_bf16 v[48:51], v[92:95], v[100:103], v[48:51]
    buffer_load_dwordx4 v[64:67], v125, s[12:15], s23 offen offset:0
    buffer_load_dwordx4 v[68:71], v125, s[12:15], s23 offen offset:1024
    s_waitcnt lgkmcnt(2)
    v_mfma_f32_16x16x32_bf16 v[28:31], v[72:75], v[104:107], v[28:31]
    v_mfma_f32_16x16x32_bf16 v[60:63], v[76:79], v[104:107], v[60:63]
    v_mfma_f32_16x16x32_bf16 v[24:27], v[80:83], v[104:107], v[24:27]
    v_mfma_f32_16x16x32_bf16 v[56:59], v[84:87], v[104:107], v[56:59]
    v_mfma_f32_16x16x32_bf16 v[20:23], v[88:91], v[104:107], v[20:23]
    v_mfma_f32_16x16x32_bf16 v[52:55], v[92:95], v[104:107], v[52:55]
    buffer_load_dwordx4 v[72:75], v125, s[12:15], s23 offen offset:2048
    buffer_load_dwordx4 v[76:79], v125, s[12:15], s23 offen offset:3072
    s_waitcnt lgkmcnt(1)
    v_mfma_f32_16x16x32_bf16 v[28:31], v[80:83], v[108:111], v[28:31]
    v_mfma_f32_16x16x32_bf16 v[60:63], v[84:87], v[108:111], v[60:63]
    v_mfma_f32_16x16x32_bf16 v[24:27], v[88:91], v[108:111], v[24:27]
    v_mfma_f32_16x16x32_bf16 v[56:59], v[92:95], v[108:111], v[56:59]
    buffer_load_dwordx4 v[80:83], v125, s[12:15], s26 offen offset:0
    buffer_load_dwordx4 v[84:87], v125, s[12:15], s26 offen offset:1024
    s_waitcnt lgkmcnt(0)
    v_mfma_f32_16x16x32_bf16 v[28:31], v[88:91], v[112:115], v[28:31]
    v_mfma_f32_16x16x32_bf16 v[60:63], v[92:95], v[112:115], v[60:63]
    buffer_load_dwordx4 v[88:91], v125, s[12:15], s26 offen offset:2048
    buffer_load_dwordx4 v[92:95], v125, s[12:15], s26 offen offset:3072
    s_add_u32 s23, s23, 57344
    s_add_u32 s26, s26, 57344
    s_barrier
    s_sub_u32 s22, s22, 1
    s_cmp_eq_u32 s22, 0
    s_cbranch_scc1 L_conv1_kernel_mlast1
    ds_read_b128 v[96:99], v120 offset:8192
    ds_read_b128 v[100:103], v120 offset:9216
    ds_read_b128 v[104:107], v120 offset:10240
    ds_read_b128 v[108:111], v120 offset:11264
    ds_read_b128 v[112:115], v120 offset:12288
    ds_read_b128 v[116:119], v120 offset:13312
    s_waitcnt vmcnt(6) lgkmcnt(5)
    v_mfma_f32_16x16x32_bf16 v[0:3], v[64:67], v[96:99], v[0:3]
    v_mfma_f32_16x16x32_bf16 v[32:35], v[68:71], v[96:99], v[32:35]
    ds_read_b128 v[96:99], v120 offset:14336
    s_waitcnt vmcnt(4) lgkmcnt(5)
    v_mfma_f32_16x16x32_bf16 v[4:7], v[64:67], v[100:103], v[4:7]
    v_mfma_f32_16x16x32_bf16 v[36:39], v[68:71], v[100:103], v[36:39]
    v_mfma_f32_16x16x32_bf16 v[0:3], v[72:75], v[100:103], v[0:3]
    v_mfma_f32_16x16x32_bf16 v[32:35], v[76:79], v[100:103], v[32:35]
    ds_read_b128 v[100:103], v120 offset:15360
    s_waitcnt vmcnt(2) lgkmcnt(5)
    v_mfma_f32_16x16x32_bf16 v[8:11], v[64:67], v[104:107], v[8:11]
    v_mfma_f32_16x16x32_bf16 v[40:43], v[68:71], v[104:107], v[40:43]
    v_mfma_f32_16x16x32_bf16 v[4:7], v[72:75], v[104:107], v[4:7]
    v_mfma_f32_16x16x32_bf16 v[36:39], v[76:79], v[104:107], v[36:39]
    v_mfma_f32_16x16x32_bf16 v[0:3], v[80:83], v[104:107], v[0:3]
    v_mfma_f32_16x16x32_bf16 v[32:35], v[84:87], v[104:107], v[32:35]
    ds_read_b128 v[104:107], v122 offset:0
    v_add_u32 v122, v124, v122
    s_waitcnt vmcnt(0) lgkmcnt(5)
    v_mfma_f32_16x16x32_bf16 v[12:15], v[64:67], v[108:111], v[12:15]
    v_mfma_f32_16x16x32_bf16 v[44:47], v[68:71], v[108:111], v[44:47]
    v_mfma_f32_16x16x32_bf16 v[8:11], v[72:75], v[108:111], v[8:11]
    v_mfma_f32_16x16x32_bf16 v[40:43], v[76:79], v[108:111], v[40:43]
    v_mfma_f32_16x16x32_bf16 v[4:7], v[80:83], v[108:111], v[4:7]
    v_mfma_f32_16x16x32_bf16 v[36:39], v[84:87], v[108:111], v[36:39]
    v_mfma_f32_16x16x32_bf16 v[0:3], v[88:91], v[108:111], v[0:3]
    v_mfma_f32_16x16x32_bf16 v[32:35], v[92:95], v[108:111], v[32:35]
    ds_read_b128 v[108:111], v121 offset:9216
    s_waitcnt lgkmcnt(5)
    v_mfma_f32_16x16x32_bf16 v[16:19], v[64:67], v[112:115], v[16:19]
    v_mfma_f32_16x16x32_bf16 v[48:51], v[68:71], v[112:115], v[48:51]
    v_mfma_f32_16x16x32_bf16 v[12:15], v[72:75], v[112:115], v[12:15]
    v_mfma_f32_16x16x32_bf16 v[44:47], v[76:79], v[112:115], v[44:47]
    v_mfma_f32_16x16x32_bf16 v[8:11], v[80:83], v[112:115], v[8:11]
    v_mfma_f32_16x16x32_bf16 v[40:43], v[84:87], v[112:115], v[40:43]
    v_mfma_f32_16x16x32_bf16 v[4:7], v[88:91], v[112:115], v[4:7]
    v_mfma_f32_16x16x32_bf16 v[36:39], v[92:95], v[112:115], v[36:39]
    ds_read_b128 v[112:115], v121 offset:10240
    s_waitcnt lgkmcnt(5)
    v_mfma_f32_16x16x32_bf16 v[20:23], v[64:67], v[116:119], v[20:23]
    v_mfma_f32_16x16x32_bf16 v[52:55], v[68:71], v[116:119], v[52:55]
    v_mfma_f32_16x16x32_bf16 v[16:19], v[72:75], v[116:119], v[16:19]
    v_mfma_f32_16x16x32_bf16 v[48:51], v[76:79], v[116:119], v[48:51]
    v_mfma_f32_16x16x32_bf16 v[12:15], v[80:83], v[116:119], v[12:15]
    v_mfma_f32_16x16x32_bf16 v[44:47], v[84:87], v[116:119], v[44:47]
    v_mfma_f32_16x16x32_bf16 v[8:11], v[88:91], v[116:119], v[8:11]
    v_mfma_f32_16x16x32_bf16 v[40:43], v[92:95], v[116:119], v[40:43]
    s_waitcnt lgkmcnt(4)
    v_mfma_f32_16x16x32_bf16 v[24:27], v[64:67], v[96:99], v[24:27]
    v_mfma_f32_16x16x32_bf16 v[56:59], v[68:71], v[96:99], v[56:59]
    v_mfma_f32_16x16x32_bf16 v[20:23], v[72:75], v[96:99], v[20:23]
    v_mfma_f32_16x16x32_bf16 v[52:55], v[76:79], v[96:99], v[52:55]
    v_mfma_f32_16x16x32_bf16 v[16:19], v[80:83], v[96:99], v[16:19]
    v_mfma_f32_16x16x32_bf16 v[48:51], v[84:87], v[96:99], v[48:51]
    v_mfma_f32_16x16x32_bf16 v[12:15], v[88:91], v[96:99], v[12:15]
    v_mfma_f32_16x16x32_bf16 v[44:47], v[92:95], v[96:99], v[44:47]
    s_waitcnt lgkmcnt(3)
    v_mfma_f32_16x16x32_bf16 v[28:31], v[64:67], v[100:103], v[28:31]
    v_mfma_f32_16x16x32_bf16 v[60:63], v[68:71], v[100:103], v[60:63]
    v_mfma_f32_16x16x32_bf16 v[24:27], v[72:75], v[100:103], v[24:27]
    v_mfma_f32_16x16x32_bf16 v[56:59], v[76:79], v[100:103], v[56:59]
    v_mfma_f32_16x16x32_bf16 v[20:23], v[80:83], v[100:103], v[20:23]
    v_mfma_f32_16x16x32_bf16 v[52:55], v[84:87], v[100:103], v[52:55]
    v_mfma_f32_16x16x32_bf16 v[16:19], v[88:91], v[100:103], v[16:19]
    v_mfma_f32_16x16x32_bf16 v[48:51], v[92:95], v[100:103], v[48:51]
    buffer_load_dwordx4 v[64:67], v125, s[12:15], s23 offen offset:0
    buffer_load_dwordx4 v[68:71], v125, s[12:15], s23 offen offset:1024
    s_waitcnt lgkmcnt(2)
    v_mfma_f32_16x16x32_bf16 v[28:31], v[72:75], v[104:107], v[28:31]
    v_mfma_f32_16x16x32_bf16 v[60:63], v[76:79], v[104:107], v[60:63]
    v_mfma_f32_16x16x32_bf16 v[24:27], v[80:83], v[104:107], v[24:27]
    v_mfma_f32_16x16x32_bf16 v[56:59], v[84:87], v[104:107], v[56:59]
    v_mfma_f32_16x16x32_bf16 v[20:23], v[88:91], v[104:107], v[20:23]
    v_mfma_f32_16x16x32_bf16 v[52:55], v[92:95], v[104:107], v[52:55]
    buffer_load_dwordx4 v[72:75], v125, s[12:15], s23 offen offset:2048
    buffer_load_dwordx4 v[76:79], v125, s[12:15], s23 offen offset:3072
    s_waitcnt lgkmcnt(1)
    v_mfma_f32_16x16x32_bf16 v[28:31], v[80:83], v[108:111], v[28:31]
    v_mfma_f32_16x16x32_bf16 v[60:63], v[84:87], v[108:111], v[60:63]
    v_mfma_f32_16x16x32_bf16 v[24:27], v[88:91], v[108:111], v[24:27]
    v_mfma_f32_16x16x32_bf16 v[56:59], v[92:95], v[108:111], v[56:59]
    buffer_load_dwordx4 v[80:83], v125, s[12:15], s26 offen offset:0
    buffer_load_dwordx4 v[84:87], v125, s[12:15], s26 offen offset:1024
    s_waitcnt lgkmcnt(0)
    v_mfma_f32_16x16x32_bf16 v[28:31], v[88:91], v[112:115], v[28:31]
    v_mfma_f32_16x16x32_bf16 v[60:63], v[92:95], v[112:115], v[60:63]
    buffer_load_dwordx4 v[88:91], v125, s[12:15], s26 offen offset:2048
    buffer_load_dwordx4 v[92:95], v125, s[12:15], s26 offen offset:3072
    s_add_u32 s23, s23, 57344
    s_add_u32 s26, s26, 57344
    s_barrier
    s_branch L_conv1_kernel_mloop1
L_conv1_kernel_mlast1:
    v_and_b32 v125, 15, v127
    v_and_b32 v126, 7, v127
    v_lshlrev_b32 v126, 4, v126
    v_lshl_add_u32 v125, v125, 7, v126
    v_lshrrev_b32 v126, 4, v127
    v_lshl_add_u32 v125, v126, 11, v125
    s_lshl_b32 s36, s20, 14
    s_add_u32 s37, s36, 8192
    v_add_u32 v126, s37, v125
    v_add_u32 v125, s36, v125
    ds_read_b128 v[96:99], v120 offset:8192
    ds_read_b128 v[100:103], v120 offset:9216
    ds_read_b128 v[104:107], v120 offset:10240
    ds_read_b128 v[108:111], v120 offset:11264
    ds_read_b128 v[112:115], v120 offset:12288
    ds_read_b128 v[116:119], v120 offset:13312
    s_waitcnt vmcnt(6) lgkmcnt(5)
    v_mfma_f32_16x16x32_bf16 v[0:3], v[64:67], v[96:99], v[0:3]
    v_mfma_f32_16x16x32_bf16 v[32:35], v[68:71], v[96:99], v[32:35]
    ds_read_b128 v[96:99], v120 offset:14336
    s_waitcnt vmcnt(4) lgkmcnt(5)
    v_mfma_f32_16x16x32_bf16 v[4:7], v[64:67], v[100:103], v[4:7]
    v_mfma_f32_16x16x32_bf16 v[36:39], v[68:71], v[100:103], v[36:39]
    v_mfma_f32_16x16x32_bf16 v[0:3], v[72:75], v[100:103], v[0:3]
    v_mfma_f32_16x16x32_bf16 v[32:35], v[76:79], v[100:103], v[32:35]
    ds_read_b128 v[100:103], v120 offset:15360
    s_waitcnt vmcnt(2) lgkmcnt(5)
    v_mfma_f32_16x16x32_bf16 v[8:11], v[64:67], v[104:107], v[8:11]
    v_mfma_f32_16x16x32_bf16 v[40:43], v[68:71], v[104:107], v[40:43]
    v_mfma_f32_16x16x32_bf16 v[4:7], v[72:75], v[104:107], v[4:7]
    v_mfma_f32_16x16x32_bf16 v[36:39], v[76:79], v[104:107], v[36:39]
    v_mfma_f32_16x16x32_bf16 v[0:3], v[80:83], v[104:107], v[0:3]
    v_mfma_f32_16x16x32_bf16 v[32:35], v[84:87], v[104:107], v[32:35]
    ds_read_b128 v[104:107], v122 offset:0
    s_waitcnt vmcnt(0) lgkmcnt(5)
    v_mfma_f32_16x16x32_bf16 v[12:15], v[64:67], v[108:111], v[12:15]
    v_mfma_f32_16x16x32_bf16 v[44:47], v[68:71], v[108:111], v[44:47]
    v_mfma_f32_16x16x32_bf16 v[8:11], v[72:75], v[108:111], v[8:11]
    v_mfma_f32_16x16x32_bf16 v[40:43], v[76:79], v[108:111], v[40:43]
    v_mfma_f32_16x16x32_bf16 v[4:7], v[80:83], v[108:111], v[4:7]
    v_mfma_f32_16x16x32_bf16 v[36:39], v[84:87], v[108:111], v[36:39]
    v_mfma_f32_16x16x32_bf16 v[0:3], v[88:91], v[108:111], v[0:3]
    v_mfma_f32_16x16x32_bf16 v[32:35], v[92:95], v[108:111], v[32:35]
    ds_read_b128 v[108:111], v121 offset:9216
    s_waitcnt lgkmcnt(5)
    v_mfma_f32_16x16x32_bf16 v[16:19], v[64:67], v[112:115], v[16:19]
    v_mfma_f32_16x16x32_bf16 v[48:51], v[68:71], v[112:115], v[48:51]
    v_mfma_f32_16x16x32_bf16 v[12:15], v[72:75], v[112:115], v[12:15]
    v_mfma_f32_16x16x32_bf16 v[44:47], v[76:79], v[112:115], v[44:47]
    v_mfma_f32_16x16x32_bf16 v[8:11], v[80:83], v[112:115], v[8:11]
    v_mfma_f32_16x16x32_bf16 v[40:43], v[84:87], v[112:115], v[40:43]
    v_mfma_f32_16x16x32_bf16 v[4:7], v[88:91], v[112:115], v[4:7]
    v_mfma_f32_16x16x32_bf16 v[36:39], v[92:95], v[112:115], v[36:39]
    ds_read_b128 v[112:115], v121 offset:10240
    v_xor_b32 v123, 0, v125
    ds_write_b128 v123, v[0:3]
    s_waitcnt lgkmcnt(6)
    v_mfma_f32_16x16x32_bf16 v[20:23], v[64:67], v[116:119], v[20:23]
    v_mfma_f32_16x16x32_bf16 v[52:55], v[68:71], v[116:119], v[52:55]
    v_mfma_f32_16x16x32_bf16 v[16:19], v[72:75], v[116:119], v[16:19]
    v_mfma_f32_16x16x32_bf16 v[48:51], v[76:79], v[116:119], v[48:51]
    v_mfma_f32_16x16x32_bf16 v[12:15], v[80:83], v[116:119], v[12:15]
    v_mfma_f32_16x16x32_bf16 v[44:47], v[84:87], v[116:119], v[44:47]
    v_mfma_f32_16x16x32_bf16 v[8:11], v[88:91], v[116:119], v[8:11]
    v_mfma_f32_16x16x32_bf16 v[40:43], v[92:95], v[116:119], v[40:43]
    v_xor_b32 v124, 16, v125
    ds_write_b128 v124, v[4:7]
    s_waitcnt lgkmcnt(2)
    v_mfma_f32_16x16x32_bf16 v[24:27], v[64:67], v[96:99], v[24:27]
    v_mfma_f32_16x16x32_bf16 v[56:59], v[68:71], v[96:99], v[56:59]
    v_mfma_f32_16x16x32_bf16 v[20:23], v[72:75], v[96:99], v[20:23]
    v_mfma_f32_16x16x32_bf16 v[52:55], v[76:79], v[96:99], v[52:55]
    v_mfma_f32_16x16x32_bf16 v[16:19], v[80:83], v[96:99], v[16:19]
    v_mfma_f32_16x16x32_bf16 v[48:51], v[84:87], v[96:99], v[48:51]
    v_mfma_f32_16x16x32_bf16 v[12:15], v[88:91], v[96:99], v[12:15]
    v_mfma_f32_16x16x32_bf16 v[44:47], v[92:95], v[96:99], v[44:47]
    v_xor_b32 v123, 32, v125
    ds_write_b128 v123, v[8:11]
    v_xor_b32 v124, 0, v126
    ds_write_b128 v124, v[32:35]
    v_mfma_f32_16x16x32_bf16 v[28:31], v[64:67], v[100:103], v[28:31]
    v_mfma_f32_16x16x32_bf16 v[60:63], v[68:71], v[100:103], v[60:63]
    v_mfma_f32_16x16x32_bf16 v[24:27], v[72:75], v[100:103], v[24:27]
    v_mfma_f32_16x16x32_bf16 v[56:59], v[76:79], v[100:103], v[56:59]
    v_mfma_f32_16x16x32_bf16 v[20:23], v[80:83], v[100:103], v[20:23]
    v_mfma_f32_16x16x32_bf16 v[52:55], v[84:87], v[100:103], v[52:55]
    v_mfma_f32_16x16x32_bf16 v[16:19], v[88:91], v[100:103], v[16:19]
    v_mfma_f32_16x16x32_bf16 v[48:51], v[92:95], v[100:103], v[48:51]
    v_xor_b32 v123, 16, v126
    ds_write_b128 v123, v[36:39]
    v_xor_b32 v124, 32, v126
    ds_write_b128 v124, v[40:43]
    v_mfma_f32_16x16x32_bf16 v[28:31], v[72:75], v[104:107], v[28:31]
    v_mfma_f32_16x16x32_bf16 v[60:63], v[76:79], v[104:107], v[60:63]
    v_mfma_f32_16x16x32_bf16 v[24:27], v[80:83], v[104:107], v[24:27]
    v_mfma_f32_16x16x32_bf16 v[56:59], v[84:87], v[104:107], v[56:59]
    v_mfma_f32_16x16x32_bf16 v[20:23], v[88:91], v[104:107], v[20:23]
    v_mfma_f32_16x16x32_bf16 v[52:55], v[92:95], v[104:107], v[52:55]
    v_xor_b32 v124, 48, v125
    ds_write_b128 v124, v[12:15]
    v_xor_b32 v123, 48, v126
    ds_write_b128 v123, v[44:47]
    v_mfma_f32_16x16x32_bf16 v[28:31], v[80:83], v[108:111], v[28:31]
    v_mfma_f32_16x16x32_bf16 v[60:63], v[84:87], v[108:111], v[60:63]
    v_mfma_f32_16x16x32_bf16 v[24:27], v[88:91], v[108:111], v[24:27]
    v_mfma_f32_16x16x32_bf16 v[56:59], v[92:95], v[108:111], v[56:59]
    v_xor_b32 v123, 64, v125
    ds_write_b128 v123, v[16:19]
    v_xor_b32 v124, 64, v126
    ds_write_b128 v124, v[48:51]
    v_mfma_f32_16x16x32_bf16 v[28:31], v[88:91], v[112:115], v[28:31]
    v_mfma_f32_16x16x32_bf16 v[60:63], v[92:95], v[112:115], v[60:63]
    v_xor_b32 v124, 80, v125
    ds_write_b128 v124, v[20:23]
    v_xor_b32 v123, 80, v126
    ds_write_b128 v123, v[52:55]
    s_nop 7
    v_xor_b32 v123, 96, v125
    ds_write_b128 v123, v[24:27]
    v_xor_b32 v124, 96, v126
    ds_write_b128 v124, v[56:59]
    v_xor_b32 v124, 112, v125
    ds_write_b128 v124, v[28:31]
    v_xor_b32 v123, 112, v126
    s_waitcnt lgkmcnt(8)
    ds_write_b128 v123, v[60:63]
    s_setprio 0
    s_branch L_conv1_kernel_epi
L_conv1_kernel_m2:
    s_mul_i32 s37, s38, 2176
    s_add_u32 s37, s37, 98304
    v_add_u32 v116, s37, v8
    v_add_u32 v118, s37, v9
    v_add_u32 v117, 104832, v8
    s_cmp_eq_u32 s38, 0
    s_cbranch_scc1 L_conv1_kernel_hh0
    v_add_u32 v117, 98304, v9
L_conv1_kernel_hh0:
    s_lshl_b32 s37, s38, 12
    s_add_u32 s37, s37, s43
    s_add_u32 s37, s37, 49152
    v_lshl_add_u32 v119, v127, 4, s37
    v_mov_b32 v0, 0
    v_mov_b32 v1, 0
    v_mov_b32 v2, 0
    v_mov_b32 v3, 0
    v_mov_b32 v4, 0
    v_mov_b32 v5, 0
    v_mov_b32 v6, 0
    v_mov_b32 v7, 0
    v_mov_b32 v8, 0
    v_mov_b32 v9, 0
    v_mov_b32 v10, 0
    v_mov_b32 v11, 0
    v_mov_b32 v12, 0
    v_mov_b32 v13, 0
    v_mov_b32 v14, 0
    v_mov_b32 v15, 0
    v_mov_b32 v16, 0
    v_mov_b32 v17, 0
    v_mov_b32 v18, 0
    v_mov_b32 v19, 0
    v_mov_b32 v20, 0
    v_mov_b32 v21, 0
    v_mov_b32 v22, 0
    v_mov_b32 v23, 0
    v_mov_b32 v24, 0
    v_mov_b32 v25, 0
    v_mov_b32 v26, 0
    v_mov_b32 v27, 0
    v_mov_b32 v28, 0
    v_mov_b32 v29, 0
    v_mov_b32 v30, 0
    v_mov_b32 v31, 0
    v_mov_b32 v32, 0
    v_mov_b32 v33, 0
    v_mov_b32 v34, 0
    v_mov_b32 v35, 0
    v_mov_b32 v36, 0
    v_mov_b32 v37, 0
    v_mov_b32 v38, 0
    v_mov_b32 v39, 0
    v_mov_b32 v40, 0
    v_mov_b32 v41, 0
    v_mov_b32 v42, 0
    v_mov_b32 v43, 0
    v_mov_b32 v44, 0
    v_mov_b32 v45, 0
    v_mov_b32 v46, 0
    v_mov_b32 v47, 0
    v_mov_b32 v48, 0
    v_mov_b32 v49, 0
    v_mov_b32 v50, 0
    v_mov_b32 v51, 0
    v_mov_b32 v52, 0
    v_mov_b32 v53, 0
    v_mov_b32 v54, 0
    v_mov_b32 v55, 0
    v_mov_b32 v56, 0
    v_mov_b32 v57, 0
    v_mov_b32 v58, 0
    v_mov_b32 v59, 0
    v_mov_b32 v60, 0
    v_mov_b32 v61, 0
    v_mov_b32 v62, 0
    v_mov_b32 v63, 0
    s_barrier
    buffer_load_dwordx4 v[96:99], v108, s[8:11], 0 offen
    buffer_load_dwordx4 v[100:103], v109, s[8:11], 0 offen
    buffer_load_dwordx4 v[104:107], v110, s[8:11], 0 offen
    s_mov_b32 s23, 0
    s_mov_b32 s26, 4096
    buffer_load_dwordx4 v[64:67], v125, s[12:15], s23 offen offset:0
    buffer_load_dwordx4 v[68:71], v125, s[12:15], s23 offen offset:2048
    buffer_load_dwordx4 v[80:83], v119, s[12:15], s23 offen offset:0
    buffer_load_dwordx4 v[72:75], v125, s[12:15], s26 offen offset:0
    buffer_load_dwordx4 v[84:87], v119, s[12:15], s23 offen offset:2048
    buffer_load_dwordx4 v[76:79], v125, s[12:15], s26 offen offset:2048
    s_mov_b32 s23, 57344
    s_mov_b32 s26, 61440
    s_waitcnt vmcnt(6)
    v_lshlrev_b32 v108, 16, v96
    v_and_b32 v111, s25, v96
    v_lshlrev_b32 v109, 16, v100
    v_and_b32 v112, s25, v100
    v_lshlrev_b32 v110, 16, v104
    v_and_b32 v113, s25, v104
    v_mul_f32 v114, s44, v108
    v_mul_f32 v115, s44, v111
    v_fmac_f32 v114, s45, v109
    v_fmac_f32 v115, s45, v112
    v_fmac_f32 v114, s46, v110
    v_fmac_f32 v115, s46, v113
    v_cvt_pk_bf16_f32 v96, v114, v115
    v_lshlrev_b32 v108, 16, v97
    v_and_b32 v111, s25, v97
    v_lshlrev_b32 v109, 16, v101
    v_and_b32 v112, s25, v101
    v_lshlrev_b32 v110, 16, v105
    v_and_b32 v113, s25, v105
    v_mul_f32 v114, s44, v108
    v_mul_f32 v115, s44, v111
    v_fmac_f32 v114, s45, v109
    v_fmac_f32 v115, s45, v112
    v_fmac_f32 v114, s46, v110
    v_fmac_f32 v115, s46, v113
    v_cvt_pk_bf16_f32 v97, v114, v115
    v_lshlrev_b32 v108, 16, v98
    v_and_b32 v111, s25, v98
    v_lshlrev_b32 v109, 16, v102
    v_and_b32 v112, s25, v102
    v_lshlrev_b32 v110, 16, v106
    v_and_b32 v113, s25, v106
    v_mul_f32 v114, s44, v108
    v_mul_f32 v115, s44, v111
    v_fmac_f32 v114, s45, v109
    v_fmac_f32 v115, s45, v112
    v_fmac_f32 v114, s46, v110
    v_fmac_f32 v115, s46, v113
    v_cvt_pk_bf16_f32 v98, v114, v115
    v_lshlrev_b32 v108, 16, v99
    v_and_b32 v111, s25, v99
    v_lshlrev_b32 v109, 16, v103
    v_and_b32 v112, s25, v103
    v_lshlrev_b32 v110, 16, v107
    v_and_b32 v113, s25, v107
    v_mul_f32 v114, s44, v108
    v_mul_f32 v115, s44, v111
    v_fmac_f32 v114, s45, v109
    v_fmac_f32 v115, s45, v112
    v_fmac_f32 v114, s46, v110
    v_fmac_f32 v115, s46, v113
    v_cvt_pk_bf16_f32 v99, v114, v115
    ds_write_b128 v126, v[96:99]
    v_and_b32 v126, 15, v127
    v_lshlrev_b32 v126, 2, v126
    v_add_u32 v126, 99328, v126
    ds_write_b32 v126, v0
    ds_write_b32 v126, v0 offset:8704
    s_waitcnt lgkmcnt(0)
    s_barrier
    s_mov_b32 s22, 8
    s_setprio 2
L_conv1_kernel_mloop2:
    ds_read_b128 v[88:91], v120 offset:0
    ds_read_b128 v[92:95], v120 offset:1024
    ds_read_b128 v[96:99], v116 offset:0
    ds_read_b128 v[100:103], v120 offset:2048
    ds_read_b128 v[104:107], v116 offset:1088
    ds_read_b128 v[108:111], v120 offset:3072
    ds_read_b128 v[112:115], v116 offset:2176
    s_waitcnt vmcnt(5) lgkmcnt(6)
    v_mfma_f32_16x16x32_bf16 v[0:3], v[64:67], v[88:91], v[0:3]
    ds_read_b128 v[88:91], v120 offset:4096
    s_waitcnt vmcnt(4) lgkmcnt(6)
    v_mfma_f32_16x16x32_bf16 v[4:7], v[64:67], v[92:95], v[4:7]
    v_mfma_f32_16x16x32_bf16 v[0:3], v[68:71], v[92:95], v[0:3]
    ds_read_b128 v[92:95], v116 offset:3264
    s_waitcnt vmcnt(3) lgkmcnt(6)
    v_mfma_f32_16x16x32_bf16 v[32:35], v[80:83], v[96:99], v[32:35]
    ds_read_b128 v[96:99], v120 offset:5120
    s_waitcnt vmcnt(2) lgkmcnt(6)
    v_mfma_f32_16x16x32_bf16 v[8:11], v[64:67], v[100:103], v[8:11]
    v_mfma_f32_16x16x32_bf16 v[4:7], v[68:71], v[100:103], v[4:7]
    v_mfma_f32_16x16x32_bf16 v[0:3], v[72:75], v[100:103], v[0:3]
    ds_read_b128 v[100:103], v116 offset:4352
    s_waitcnt vmcnt(1) lgkmcnt(6)
    v_mfma_f32_16x16x32_bf16 v[36:39], v[80:83], v[104:107], v[36:39]
    v_mfma_f32_16x16x32_bf16 v[32:35], v[84:87], v[104:107], v[32:35]
    ds_read_b128 v[104:107], v120 offset:6144
    s_waitcnt vmcnt(0) lgkmcnt(6)
    v_mfma_f32_16x16x32_bf16 v[12:15], v[64:67], v[108:111], v[12:15]
    v_mfma_f32_16x16x32_bf16 v[8:11], v[68:71], v[108:111], v[8:11]
    v_mfma_f32_16x16x32_bf16 v[4:7], v[72:75], v[108:111], v[4:7]
    v_mfma_f32_16x16x32_bf16 v[0:3], v[76:79], v[108:111], v[0:3]
    ds_read_b128 v[108:111], v116 offset:5440
    s_waitcnt lgkmcnt(6)
    v_mfma_f32_16x16x32_bf16 v[40:43], v[80:83], v[112:115], v[40:43]
    v_mfma_f32_16x16x32_bf16 v[36:39], v[84:87], v[112:115], v[36:39]
    ds_read_b128 v[112:115], v120 offset:7168
    s_waitcnt lgkmcnt(6)
    v_mfma_f32_16x16x32_bf16 v[16:19], v[64:67], v[88:91], v[16:19]
    v_mfma_f32_16x16x32_bf16 v[12:15], v[68:71], v[88:91], v[12:15]
    v_mfma_f32_16x16x32_bf16 v[8:11], v[72:75], v[88:91], v[8:11]
    v_mfma_f32_16x16x32_bf16 v[4:7], v[76:79], v[88:91], v[4:7]
    ds_read_b128 v[88:91], v117 offset:0
    s_waitcnt lgkmcnt(6)
    v_mfma_f32_16x16x32_bf16 v[44:47], v[80:83], v[92:95], v[44:47]
    v_mfma_f32_16x16x32_bf16 v[40:43], v[84:87], v[92:95], v[40:43]
    ds_read_b128 v[92:95], v122 offset:0
    v_add_u32 v122, v123, v122
    s_waitcnt lgkmcnt(6)
    v_mfma_f32_16x16x32_bf16 v[20:23], v[64:67], v[96:99], v[20:23]
    v_mfma_f32_16x16x32_bf16 v[16:19], v[68:71], v[96:99], v[16:19]
    v_mfma_f32_16x16x32_bf16 v[12:15], v[72:75], v[96:99], v[12:15]
    v_mfma_f32_16x16x32_bf16 v[8:11], v[76:79], v[96:99], v[8:11]
    ds_read_b128 v[96:99], v117 offset:1088
    s_waitcnt lgkmcnt(6)
    v_mfma_f32_16x16x32_bf16 v[48:51], v[80:83], v[100:103], v[48:51]
    v_mfma_f32_16x16x32_bf16 v[44:47], v[84:87], v[100:103], v[44:47]
    ds_read_b128 v[100:103], v121 offset:1024
    s_waitcnt lgkmcnt(6)
    v_mfma_f32_16x16x32_bf16 v[24:27], v[64:67], v[104:107], v[24:27]
    v_mfma_f32_16x16x32_bf16 v[20:23], v[68:71], v[104:107], v[20:23]
    v_mfma_f32_16x16x32_bf16 v[16:19], v[72:75], v[104:107], v[16:19]
    v_mfma_f32_16x16x32_bf16 v[12:15], v[76:79], v[104:107], v[12:15]
    ds_read_b128 v[104:107], v118 offset:0
    s_waitcnt lgkmcnt(6)
    v_mfma_f32_16x16x32_bf16 v[52:55], v[80:83], v[108:111], v[52:55]
    v_mfma_f32_16x16x32_bf16 v[48:51], v[84:87], v[108:111], v[48:51]
    ds_read_b128 v[108:111], v121 offset:2048
    s_waitcnt lgkmcnt(6)
    v_mfma_f32_16x16x32_bf16 v[28:31], v[64:67], v[112:115], v[28:31]
    v_mfma_f32_16x16x32_bf16 v[24:27], v[68:71], v[112:115], v[24:27]
    v_mfma_f32_16x16x32_bf16 v[20:23], v[72:75], v[112:115], v[20:23]
    v_mfma_f32_16x16x32_bf16 v[16:19], v[76:79], v[112:115], v[16:19]
    buffer_load_dwordx4 v[64:67], v125, s[12:15], s23 offen offset:0
    s_waitcnt lgkmcnt(5)
    v_mfma_f32_16x16x32_bf16 v[56:59], v[80:83], v[88:91], v[56:59]
    v_mfma_f32_16x16x32_bf16 v[52:55], v[84:87], v[88:91], v[52:55]
    s_waitcnt lgkmcnt(0)
    s_barrier
    v_mfma_f32_16x16x32_bf16 v[28:31], v[68:71], v[92:95], v[28:31]
    v_mfma_f32_16x16x32_bf16 v[24:27], v[72:75], v[92:95], v[24:27]
    v_mfma_f32_16x16x32_bf16 v[20:23], v[76:79], v[92:95], v[20:23]
    buffer_load_dwordx4 v[68:71], v125, s[12:15], s23 offen offset:2048
    v_mfma_f32_16x16x32_bf16 v[60:63], v[80:83], v[96:99], v[60:63]
    v_mfma_f32_16x16x32_bf16 v[56:59], v[84:87], v[96:99], v[56:59]
    buffer_load_dwordx4 v[80:83], v119, s[12:15], s23 offen offset:0
    v_mfma_f32_16x16x32_bf16 v[28:31], v[72:75], v[100:103], v[28:31]
    v_mfma_f32_16x16x32_bf16 v[24:27], v[76:79], v[100:103], v[24:27]
    buffer_load_dwordx4 v[72:75], v125, s[12:15], s26 offen offset:0
    v_mfma_f32_16x16x32_bf16 v[60:63], v[84:87], v[104:107], v[60:63]
    buffer_load_dwordx4 v[84:87], v119, s[12:15], s23 offen offset:2048
    v_mfma_f32_16x16x32_bf16 v[28:31], v[76:79], v[108:111], v[28:31]
    buffer_load_dwordx4 v[76:79], v125, s[12:15], s26 offen offset:2048
    s_add_u32 s23, s23, 57344
    s_add_u32 s26, s26, 57344
    s_sub_u32 s22, s22, 1
    s_cmp_eq_u32 s22, 0
    s_cbranch_scc1 L_conv1_kernel_mlast2
    ds_read_b128 v[88:91], v120 offset:8192
    ds_read_b128 v[92:95], v120 offset:9216
    ds_read_b128 v[96:99], v116 offset:8704
    ds_read_b128 v[100:103], v120 offset:10240
    ds_read_b128 v[104:107], v116 offset:9792
    ds_read_b128 v[108:111], v120 offset:11264
    ds_read_b128 v[112:115], v116 offset:10880
    s_waitcnt vmcnt(5) lgkmcnt(6)
    v_mfma_f32_16x16x32_bf16 v[0:3], v[64:67], v[88:91], v[0:3]
    ds_read_b128 v[88:91], v120 offset:12288
    s_waitcnt vmcnt(4) lgkmcnt(6)
    v_mfma_f32_16x16x32_bf16 v[4:7], v[64:67], v[92:95], v[4:7]
    v_mfma_f32_16x16x32_bf16 v[0:3], v[68:71], v[92:95], v[0:3]
    ds_read_b128 v[92:95], v116 offset:11968
    s_waitcnt vmcnt(3) lgkmcnt(6)
    v_mfma_f32_16x16x32_bf16 v[32:35], v[80:83], v[96:99], v[32:35]
    ds_read_b128 v[96:99], v120 offset:13312
    s_waitcnt vmcnt(2) lgkmcnt(6)
    v_mfma_f32_16x16x32_bf16 v[8:11], v[64:67], v[100:103], v[8:11]
    v_mfma_f32_16x16x32_bf16 v[4:7], v[68:71], v[100:103], v[4:7]
    v_mfma_f32_16x16x32_bf16 v[0:3], v[72:75], v[100:103], v[0:3]
    ds_read_b128 v[100:103], v116 offset:13056
    s_waitcnt vmcnt(1) lgkmcnt(6)
    v_mfma_f32_16x16x32_bf16 v[36:39], v[80:83], v[104:107], v[36:39]
    v_mfma_f32_16x16x32_bf16 v[32:35], v[84:87], v[104:107], v[32:35]
    ds_read_b128 v[104:107], v120 offset:14336
    s_waitcnt vmcnt(0) lgkmcnt(6)
    v_mfma_f32_16x16x32_bf16 v[12:15], v[64:67], v[108:111], v[12:15]
    v_mfma_f32_16x16x32_bf16 v[8:11], v[68:71], v[108:111], v[8:11]
    v_mfma_f32_16x16x32_bf16 v[4:7], v[72:75], v[108:111], v[4:7]
    v_mfma_f32_16x16x32_bf16 v[0:3], v[76:79], v[108:111], v[0:3]
    ds_read_b128 v[108:111], v116 offset:14144
    s_waitcnt lgkmcnt(6)
    v_mfma_f32_16x16x32_bf16 v[40:43], v[80:83], v[112:115], v[40:43]
    v_mfma_f32_16x16x32_bf16 v[36:39], v[84:87], v[112:115], v[36:39]
    ds_read_b128 v[112:115], v120 offset:15360
    s_waitcnt lgkmcnt(6)
    v_mfma_f32_16x16x32_bf16 v[16:19], v[64:67], v[88:91], v[16:19]
    v_mfma_f32_16x16x32_bf16 v[12:15], v[68:71], v[88:91], v[12:15]
    v_mfma_f32_16x16x32_bf16 v[8:11], v[72:75], v[88:91], v[8:11]
    v_mfma_f32_16x16x32_bf16 v[4:7], v[76:79], v[88:91], v[4:7]
    ds_read_b128 v[88:91], v117 offset:8704
    s_waitcnt lgkmcnt(6)
    v_mfma_f32_16x16x32_bf16 v[44:47], v[80:83], v[92:95], v[44:47]
    v_mfma_f32_16x16x32_bf16 v[40:43], v[84:87], v[92:95], v[40:43]
    ds_read_b128 v[92:95], v122 offset:0
    v_add_u32 v122, v124, v122
    s_waitcnt lgkmcnt(6)
    v_mfma_f32_16x16x32_bf16 v[20:23], v[64:67], v[96:99], v[20:23]
    v_mfma_f32_16x16x32_bf16 v[16:19], v[68:71], v[96:99], v[16:19]
    v_mfma_f32_16x16x32_bf16 v[12:15], v[72:75], v[96:99], v[12:15]
    v_mfma_f32_16x16x32_bf16 v[8:11], v[76:79], v[96:99], v[8:11]
    ds_read_b128 v[96:99], v117 offset:9792
    s_waitcnt lgkmcnt(6)
    v_mfma_f32_16x16x32_bf16 v[48:51], v[80:83], v[100:103], v[48:51]
    v_mfma_f32_16x16x32_bf16 v[44:47], v[84:87], v[100:103], v[44:47]
    ds_read_b128 v[100:103], v121 offset:9216
    s_waitcnt lgkmcnt(6)
    v_mfma_f32_16x16x32_bf16 v[24:27], v[64:67], v[104:107], v[24:27]
    v_mfma_f32_16x16x32_bf16 v[20:23], v[68:71], v[104:107], v[20:23]
    v_mfma_f32_16x16x32_bf16 v[16:19], v[72:75], v[104:107], v[16:19]
    v_mfma_f32_16x16x32_bf16 v[12:15], v[76:79], v[104:107], v[12:15]
    ds_read_b128 v[104:107], v118 offset:8704
    s_waitcnt lgkmcnt(6)
    v_mfma_f32_16x16x32_bf16 v[52:55], v[80:83], v[108:111], v[52:55]
    v_mfma_f32_16x16x32_bf16 v[48:51], v[84:87], v[108:111], v[48:51]
    ds_read_b128 v[108:111], v121 offset:10240
    s_waitcnt lgkmcnt(6)
    v_mfma_f32_16x16x32_bf16 v[28:31], v[64:67], v[112:115], v[28:31]
    v_mfma_f32_16x16x32_bf16 v[24:27], v[68:71], v[112:115], v[24:27]
    v_mfma_f32_16x16x32_bf16 v[20:23], v[72:75], v[112:115], v[20:23]
    v_mfma_f32_16x16x32_bf16 v[16:19], v[76:79], v[112:115], v[16:19]
    buffer_load_dwordx4 v[64:67], v125, s[12:15], s23 offen offset:0
    s_waitcnt lgkmcnt(5)
    v_mfma_f32_16x16x32_bf16 v[56:59], v[80:83], v[88:91], v[56:59]
    v_mfma_f32_16x16x32_bf16 v[52:55], v[84:87], v[88:91], v[52:55]
    s_waitcnt lgkmcnt(0)
    s_barrier
    v_mfma_f32_16x16x32_bf16 v[28:31], v[68:71], v[92:95], v[28:31]
    v_mfma_f32_16x16x32_bf16 v[24:27], v[72:75], v[92:95], v[24:27]
    v_mfma_f32_16x16x32_bf16 v[20:23], v[76:79], v[92:95], v[20:23]
    buffer_load_dwordx4 v[68:71], v125, s[12:15], s23 offen offset:2048
    v_mfma_f32_16x16x32_bf16 v[60:63], v[80:83], v[96:99], v[60:63]
    v_mfma_f32_16x16x32_bf16 v[56:59], v[84:87], v[96:99], v[56:59]
    buffer_load_dwordx4 v[80:83], v119, s[12:15], s23 offen offset:0
    v_mfma_f32_16x16x32_bf16 v[28:31], v[72:75], v[100:103], v[28:31]
    v_mfma_f32_16x16x32_bf16 v[24:27], v[76:79], v[100:103], v[24:27]
    buffer_load_dwordx4 v[72:75], v125, s[12:15], s26 offen offset:0
    v_mfma_f32_16x16x32_bf16 v[60:63], v[84:87], v[104:107], v[60:63]
    buffer_load_dwordx4 v[84:87], v119, s[12:15], s23 offen offset:2048
    v_mfma_f32_16x16x32_bf16 v[28:31], v[76:79], v[108:111], v[28:31]
    buffer_load_dwordx4 v[76:79], v125, s[12:15], s26 offen offset:2048
    s_add_u32 s23, s23, 57344
    s_add_u32 s26, s26, 57344
    s_branch L_conv1_kernel_mloop2
L_conv1_kernel_mlast2:
    v_and_b32 v125, 15, v127
    v_and_b32 v126, 7, v127
    v_lshlrev_b32 v126, 4, v126
    v_lshl_add_u32 v125, v125, 7, v126
    v_lshrrev_b32 v126, 4, v127
    v_lshl_add_u32 v125, v126, 11, v125
    s_mov_b32 s36, 65536
    s_cmp_eq_u32 s32, 1
    s_cselect_b32 s36, 121856, s36
    s_cmp_eq_u32 s32, 2
    s_cselect_b32 s36, 81920, s36
    s_cmp_eq_u32 s32, 3
    s_cselect_b32 s36, 130048, s36
    s_mov_b32 s37, 98304
    s_cmp_eq_u32 s32, 1
    s_cselect_b32 s37, 138240, s37
    s_cmp_eq_u32 s32, 2
    s_cselect_b32 s37, 146432, s37
    s_cmp_eq_u32 s32, 3
    s_cselect_b32 s37, 154624, s37
    v_add_u32 v126, s37, v125
    v_add_u32 v125, s36, v125
    ds_read_b128 v[88:91], v120 offset:8192
    ds_read_b128 v[92:95], v120 offset:9216
    ds_read_b128 v[96:99], v116 offset:8704
    ds_read_b128 v[100:103], v120 offset:10240
    ds_read_b128 v[104:107], v116 offset:9792
    ds_read_b128 v[108:111], v120 offset:11264
    ds_read_b128 v[112:115], v116 offset:10880
    s_waitcnt vmcnt(5) lgkmcnt(6)
    v_mfma_f32_16x16x32_bf16 v[0:3], v[64:67], v[88:91], v[0:3]
    ds_read_b128 v[88:91], v120 offset:12288
    s_waitcnt vmcnt(4) lgkmcnt(6)
    v_mfma_f32_16x16x32_bf16 v[4:7], v[64:67], v[92:95], v[4:7]
    v_mfma_f32_16x16x32_bf16 v[0:3], v[68:71], v[92:95], v[0:3]
    ds_read_b128 v[92:95], v116 offset:11968
    s_waitcnt vmcnt(3) lgkmcnt(6)
    v_mfma_f32_16x16x32_bf16 v[32:35], v[80:83], v[96:99], v[32:35]
    ds_read_b128 v[96:99], v120 offset:13312
    s_waitcnt vmcnt(2) lgkmcnt(6)
    v_mfma_f32_16x16x32_bf16 v[8:11], v[64:67], v[100:103], v[8:11]
    v_mfma_f32_16x16x32_bf16 v[4:7], v[68:71], v[100:103], v[4:7]
    v_mfma_f32_16x16x32_bf16 v[0:3], v[72:75], v[100:103], v[0:3]
    ds_read_b128 v[100:103], v116 offset:13056
    s_waitcnt vmcnt(1) lgkmcnt(6)
    v_mfma_f32_16x16x32_bf16 v[36:39], v[80:83], v[104:107], v[36:39]
    v_mfma_f32_16x16x32_bf16 v[32:35], v[84:87], v[104:107], v[32:35]
    ds_read_b128 v[104:107], v120 offset:14336
    s_waitcnt vmcnt(0) lgkmcnt(6)
    v_mfma_f32_16x16x32_bf16 v[12:15], v[64:67], v[108:111], v[12:15]
    v_mfma_f32_16x16x32_bf16 v[8:11], v[68:71], v[108:111], v[8:11]
    v_mfma_f32_16x16x32_bf16 v[4:7], v[72:75], v[108:111], v[4:7]
    v_mfma_f32_16x16x32_bf16 v[0:3], v[76:79], v[108:111], v[0:3]
    ds_read_b128 v[108:111], v116 offset:14144
    s_waitcnt lgkmcnt(6)
    v_mfma_f32_16x16x32_bf16 v[40:43], v[80:83], v[112:115], v[40:43]
    v_mfma_f32_16x16x32_bf16 v[36:39], v[84:87], v[112:115], v[36:39]
    ds_read_b128 v[112:115], v120 offset:15360
    s_waitcnt lgkmcnt(6)
    v_mfma_f32_16x16x32_bf16 v[16:19], v[64:67], v[88:91], v[16:19]
    v_mfma_f32_16x16x32_bf16 v[12:15], v[68:71], v[88:91], v[12:15]
    v_mfma_f32_16x16x32_bf16 v[8:11], v[72:75], v[88:91], v[8:11]
    v_mfma_f32_16x16x32_bf16 v[4:7], v[76:79], v[88:91], v[4:7]
    ds_read_b128 v[88:91], v117 offset:8704
    v_xor_b32 v124, 0, v126
    ds_write_b128 v124, v[32:35]
    s_waitcnt lgkmcnt(7)
    v_mfma_f32_16x16x32_bf16 v[44:47], v[80:83], v[92:95], v[44:47]
    v_mfma_f32_16x16x32_bf16 v[40:43], v[84:87], v[92:95], v[40:43]
    ds_read_b128 v[92:95], v122 offset:0
    v_xor_b32 v123, 0, v125
    ds_write_b128 v123, v[0:3]
    s_waitcnt lgkmcnt(8)
    v_mfma_f32_16x16x32_bf16 v[20:23], v[64:67], v[96:99], v[20:23]
    v_mfma_f32_16x16x32_bf16 v[16:19], v[68:71], v[96:99], v[16:19]
    v_mfma_f32_16x16x32_bf16 v[12:15], v[72:75], v[96:99], v[12:15]
    v_mfma_f32_16x16x32_bf16 v[8:11], v[76:79], v[96:99], v[8:11]
    ds_read_b128 v[96:99], v117 offset:9792
    v_xor_b32 v123, 16, v126
    ds_write_b128 v123, v[36:39]
    s_waitcnt lgkmcnt(9)
    v_mfma_f32_16x16x32_bf16 v[48:51], v[80:83], v[100:103], v[48:51]
    v_mfma_f32_16x16x32_bf16 v[44:47], v[84:87], v[100:103], v[44:47]
    ds_read_b128 v[100:103], v121 offset:9216
    v_xor_b32 v124, 16, v125
    ds_write_b128 v124, v[4:7]
    s_waitcnt lgkmcnt(10)
    v_mfma_f32_16x16x32_bf16 v[24:27], v[64:67], v[104:107], v[24:27]
    v_mfma_f32_16x16x32_bf16 v[20:23], v[68:71], v[104:107], v[20:23]
    v_mfma_f32_16x16x32_bf16 v[16:19], v[72:75], v[104:107], v[16:19]
    v_mfma_f32_16x16x32_bf16 v[12:15], v[76:79], v[104:107], v[12:15]
    ds_read_b128 v[104:107], v118 offset:8704
    v_xor_b32 v124, 32, v126
    ds_write_b128 v124, v[40:43]
    s_waitcnt lgkmcnt(11)
    v_mfma_f32_16x16x32_bf16 v[52:55], v[80:83], v[108:111], v[52:55]
    v_mfma_f32_16x16x32_bf16 v[48:51], v[84:87], v[108:111], v[48:51]
    ds_read_b128 v[108:111], v121 offset:10240
    v_xor_b32 v123, 32, v125
    ds_write_b128 v123, v[8:11]
    s_waitcnt lgkmcnt(12)
    v_mfma_f32_16x16x32_bf16 v[28:31], v[64:67], v[112:115], v[28:31]
    v_mfma_f32_16x16x32_bf16 v[24:27], v[68:71], v[112:115], v[24:27]
    v_mfma_f32_16x16x32_bf16 v[20:23], v[72:75], v[112:115], v[20:23]
    v_mfma_f32_16x16x32_bf16 v[16:19], v[76:79], v[112:115], v[16:19]
    v_xor_b32 v123, 48, v126
    ds_write_b128 v123, v[44:47]
    s_waitcnt lgkmcnt(12)
    v_mfma_f32_16x16x32_bf16 v[56:59], v[80:83], v[88:91], v[56:59]
    v_mfma_f32_16x16x32_bf16 v[52:55], v[84:87], v[88:91], v[52:55]
    v_xor_b32 v124, 48, v125
    ds_write_b128 v124, v[12:15]
    s_waitcnt lgkmcnt(11)
    v_mfma_f32_16x16x32_bf16 v[28:31], v[68:71], v[92:95], v[28:31]
    v_mfma_f32_16x16x32_bf16 v[24:27], v[72:75], v[92:95], v[24:27]
    v_mfma_f32_16x16x32_bf16 v[20:23], v[76:79], v[92:95], v[20:23]
    v_xor_b32 v124, 64, v126
    ds_write_b128 v124, v[48:51]
    s_waitcnt lgkmcnt(10)
    v_mfma_f32_16x16x32_bf16 v[60:63], v[80:83], v[96:99], v[60:63]
    v_mfma_f32_16x16x32_bf16 v[56:59], v[84:87], v[96:99], v[56:59]
    v_xor_b32 v123, 64, v125
    ds_write_b128 v123, v[16:19]
    s_waitcnt lgkmcnt(9)
    v_mfma_f32_16x16x32_bf16 v[28:31], v[72:75], v[100:103], v[28:31]
    v_mfma_f32_16x16x32_bf16 v[24:27], v[76:79], v[100:103], v[24:27]
    v_xor_b32 v123, 80, v126
    ds_write_b128 v123, v[52:55]
    s_waitcnt lgkmcnt(8)
    v_mfma_f32_16x16x32_bf16 v[60:63], v[84:87], v[104:107], v[60:63]
    v_xor_b32 v124, 80, v125
    ds_write_b128 v124, v[20:23]
    s_waitcnt lgkmcnt(7)
    v_mfma_f32_16x16x32_bf16 v[28:31], v[76:79], v[108:111], v[28:31]
    v_xor_b32 v124, 96, v126
    ds_write_b128 v124, v[56:59]
    s_nop 7
    v_xor_b32 v123, 96, v125
    ds_write_b128 v123, v[24:27]
    v_xor_b32 v123, 112, v126
    ds_write_b128 v123, v[60:63]
    v_xor_b32 v124, 112, v125
    ds_write_b128 v124, v[28:31]
    s_setprio 0
    s_branch L_conv1_kernel_epi
L_conv1_kernel_helper:
    s_setprio 3
    v_add_u32 v92, 0, v7
    v_add_u32 v93, 1024, v7
    v_add_u32 v94, 2048, v7
    v_add_u32 v95, 3072, v7
    v_and_b32 v76, 4, v5
    v_lshrrev_b32 v76, 1, v76
    v_xor_b32 v76, v6, v76
    v_lshlrev_b32 v76, 4, v76
    v_lshl_add_u32 v76, v5, 6, v76
    s_mov_b32 s24, 0
    s_mov_b32 s27, 524288
    buffer_load_dwordx4 v[0:3], v92, s[8:11], s24 offen offset:0
    buffer_load_dwordx4 v[16:19], v92, s[8:11], s24 offen offset:64
    v_add_u32 v92, 128, v92
    buffer_load_dwordx4 v[4:7], v93, s[8:11], s24 offen offset:0
    buffer_load_dwordx4 v[20:23], v93, s[8:11], s24 offen offset:64
    v_add_u32 v93, 128, v93
    buffer_load_dwordx4 v[8:11], v94, s[8:11], s24 offen offset:0
    buffer_load_dwordx4 v[24:27], v94, s[8:11], s24 offen offset:64
    v_add_u32 v94, 128, v94
    buffer_load_dwordx4 v[12:15], v95, s[8:11], s24 offen offset:0
    buffer_load_dwordx4 v[28:31], v95, s[8:11], s24 offen offset:64
    v_add_u32 v95, 128, v95
    s_barrier
    s_mul_i32 s36, s42, 1024
    v_add_u32 v96, s36, v76
    v_add_u32 v97, 65536, v96
    s_mul_i32 s36, s42, 1088
    s_add_u32 s36, s36, 98304
    v_add_u32 v98, s36, v76
    s_waitcnt vmcnt(0)
    s_mov_b32 s28, 0
    s_mov_b32 s22, 4
    s_cmp_ge_u32 s20, 12
    s_cbranch_scc1 L_conv1_kernel_h2
    ds_write_b128 v96, v[0:3] offset:0
    ds_write_b128 v98, v[12:15] offset:0
    v_lshlrev_b32 v76, 16, v0
    v_and_b32 v84, s25, v0
    v_lshlrev_b32 v77, 16, v4
    v_and_b32 v85, s25, v4
    v_lshlrev_b32 v78, 16, v8
    v_and_b32 v86, s25, v8
    v_lshlrev_b32 v79, 16, v12
    v_and_b32 v87, s25, v12
    v_add_f32 v80, v76, v78
    v_add_f32 v88, v84, v86
    v_add_f32 v81, v77, v79
    v_add_f32 v89, v85, v87
    v_fma_f32 v82, v78, 4.0, v76
    v_fma_f32 v90, v86, 4.0, v84
    v_fma_f32 v83, v79, 4.0, v77
    v_fma_f32 v91, v87, 4.0, v85
    v_add_f32 v77, v80, v81
    v_add_f32 v85, v88, v89
    v_sub_f32 v78, v80, v81
    v_sub_f32 v86, v88, v89
    v_fma_f32 v79, v83, 2.0, v82
    v_fma_f32 v87, v91, 2.0, v90
    v_fma_f32 v82, v83, -2.0, v82
    v_fma_f32 v90, v91, -2.0, v90
    v_fmamk_f32 v80, v76, 0x41700000, v82
    v_fmamk_f32 v88, v84, 0x41700000, v90
    v_fmamk_f32 v80, v81, 0x41200000, v80
    v_fmamk_f32 v88, v89, 0x41200000, v88
    v_cvt_pk_bf16_f32 v4, v77, v85
    v_cvt_pk_bf16_f32 v8, v78, v86
    v_cvt_pk_bf16_f32 v64, v79, v87
    v_cvt_pk_bf16_f32 v68, v82, v90
    v_cvt_pk_bf16_f32 v72, v80, v88
    v_lshlrev_b32 v76, 16, v1
    v_and_b32 v84, s25, v1
    v_lshlrev_b32 v77, 16, v5
    v_and_b32 v85, s25, v5
    v_lshlrev_b32 v78, 16, v9
    v_and_b32 v86, s25, v9
    v_lshlrev_b32 v79, 16, v13
    v_and_b32 v87, s25, v13
    v_add_f32 v80, v76, v78
    v_add_f32 v88, v84, v86
    v_add_f32 v81, v77, v79
    v_add_f32 v89, v85, v87
    v_fma_f32 v82, v78, 4.0, v76
    v_fma_f32 v90, v86, 4.0, v84
    v_fma_f32 v83, v79, 4.0, v77
    v_fma_f32 v91, v87, 4.0, v85
    v_add_f32 v77, v80, v81
    v_add_f32 v85, v88, v89
    v_sub_f32 v78, v80, v81
    v_sub_f32 v86, v88, v89
    v_fma_f32 v79, v83, 2.0, v82
    v_fma_f32 v87, v91, 2.0, v90
    v_fma_f32 v82, v83, -2.0, v82
    v_fma_f32 v90, v91, -2.0, v90
    v_fmamk_f32 v80, v76, 0x41700000, v82
    v_fmamk_f32 v88, v84, 0x41700000, v90
    v_fmamk_f32 v80, v81, 0x41200000, v80
    v_fmamk_f32 v88, v89, 0x41200000, v88
    v_cvt_pk_bf16_f32 v5, v77, v85
    v_cvt_pk_bf16_f32 v9, v78, v86
    v_cvt_pk_bf16_f32 v65, v79, v87
    v_cvt_pk_bf16_f32 v69, v82, v90
    v_cvt_pk_bf16_f32 v73, v80, v88
    v_lshlrev_b32 v76, 16, v2
    v_and_b32 v84, s25, v2
    v_lshlrev_b32 v77, 16, v6
    v_and_b32 v85, s25, v6
    v_lshlrev_b32 v78, 16, v10
    v_and_b32 v86, s25, v10
    v_lshlrev_b32 v79, 16, v14
    v_and_b32 v87, s25, v14
    v_add_f32 v80, v76, v78
    v_add_f32 v88, v84, v86
    v_add_f32 v81, v77, v79
    v_add_f32 v89, v85, v87
    v_fma_f32 v82, v78, 4.0, v76
    v_fma_f32 v90, v86, 4.0, v84
    v_fma_f32 v83, v79, 4.0, v77
    v_fma_f32 v91, v87, 4.0, v85
    v_add_f32 v77, v80, v81
    v_add_f32 v85, v88, v89
    v_sub_f32 v78, v80, v81
    v_sub_f32 v86, v88, v89
    v_fma_f32 v79, v83, 2.0, v82
    v_fma_f32 v87, v91, 2.0, v90
    v_fma_f32 v82, v83, -2.0, v82
    v_fma_f32 v90, v91, -2.0, v90
    v_fmamk_f32 v80, v76, 0x41700000, v82
    v_fmamk_f32 v88, v84, 0x41700000, v90
    v_fmamk_f32 v80, v81, 0x41200000, v80
    v_fmamk_f32 v88, v89, 0x41200000, v88
    v_cvt_pk_bf16_f32 v6, v77, v85
    v_cvt_pk_bf16_f32 v10, v78, v86
    v_cvt_pk_bf16_f32 v66, v79, v87
    v_cvt_pk_bf16_f32 v70, v82, v90
    v_cvt_pk_bf16_f32 v74, v80, v88
    v_lshlrev_b32 v76, 16, v3
    v_and_b32 v84, s25, v3
    v_lshlrev_b32 v77, 16, v7
    v_and_b32 v85, s25, v7
    v_lshlrev_b32 v78, 16, v11
    v_and_b32 v86, s25, v11
    v_lshlrev_b32 v79, 16, v15
    v_and_b32 v87, s25, v15
    v_add_f32 v80, v76, v78
    v_add_f32 v88, v84, v86
    v_add_f32 v81, v77, v79
    v_add_f32 v89, v85, v87
    v_fma_f32 v82, v78, 4.0, v76
    v_fma_f32 v90, v86, 4.0, v84
    v_fma_f32 v83, v79, 4.0, v77
    v_fma_f32 v91, v87, 4.0, v85
    v_add_f32 v77, v80, v81
    v_add_f32 v85, v88, v89
    v_sub_f32 v78, v80, v81
    v_sub_f32 v86, v88, v89
    v_fma_f32 v79, v83, 2.0, v82
    v_fma_f32 v87, v91, 2.0, v90
    v_fma_f32 v82, v83, -2.0, v82
    v_fma_f32 v90, v91, -2.0, v90
    v_fmamk_f32 v80, v76, 0x41700000, v82
    v_fmamk_f32 v88, v84, 0x41700000, v90
    v_fmamk_f32 v80, v81, 0x41200000, v80
    v_fmamk_f32 v88, v89, 0x41200000, v88
    v_cvt_pk_bf16_f32 v7, v77, v85
    v_cvt_pk_bf16_f32 v11, v78, v86
    v_cvt_pk_bf16_f32 v67, v79, v87
    v_cvt_pk_bf16_f32 v71, v82, v90
    v_cvt_pk_bf16_f32 v75, v80, v88
    ds_write_b128 v96, v[64:67] offset:49152
    ds_write_b128 v97, v[68:71] offset:0
    ds_write_b128 v97, v[72:75] offset:16384
    ds_write_b128 v96, v[4:7] offset:16384
    ds_write_b128 v96, v[8:11] offset:32768
    s_waitcnt vmcnt(0)
    buffer_load_dwordx4 v[32:35], v92, s[8:11], s24 offen offset:0
    buffer_load_dwordx4 v[48:51], v92, s[8:11], s24 offen offset:64
    v_add_u32 v92, 128, v92
    buffer_load_dwordx4 v[36:39], v93, s[8:11], s24 offen offset:0
    buffer_load_dwordx4 v[52:55], v93, s[8:11], s24 offen offset:64
    v_add_u32 v93, 128, v93
    s_waitcnt lgkmcnt(0)
    s_barrier
    s_setprio 1
L_conv1_kernel_hloop1:
    s_cmp_lt_u32 s28, 13
    s_cselect_b32 s24, 0, 2130706432
    v_lshlrev_b32 v76, 16, v16
    v_and_b32 v84, s25, v16
    v_lshlrev_b32 v77, 16, v20
    v_and_b32 v85, s25, v20
    v_lshlrev_b32 v78, 16, v24
    v_and_b32 v86, s25, v24
    v_lshlrev_b32 v79, 16, v28
    v_and_b32 v87, s25, v28
    v_add_f32 v80, v76, v78
    v_add_f32 v88, v84, v86
    v_add_f32 v81, v77, v79
    v_add_f32 v89, v85, v87
    v_fma_f32 v82, v78, 4.0, v76
    buffer_load_dwordx4 v[40:43], v94, s[8:11], s24 offen offset:0
    buffer_load_dwordx4 v[56:59], v94, s[8:11], s24 offen offset:64
    v_add_u32 v94, 128, v94
    v_fma_f32 v90, v86, 4.0, v84
    v_fma_f32 v83, v79, 4.0, v77
    v_fma_f32 v91, v87, 4.0, v85
    v_add_f32 v77, v80, v81
    v_add_f32 v85, v88, v89
    v_sub_f32 v78, v80, v81
    v_sub_f32 v86, v88, v89
    v_fma_f32 v79, v83, 2.0, v82
    v_fma_f32 v87, v91, 2.0, v90
    v_fma_f32 v82, v83, -2.0, v82
    v_fma_f32 v90, v91, -2.0, v90
    v_fmamk_f32 v80, v76, 0x41700000, v82
    v_fmamk_f32 v88, v84, 0x41700000, v90
    v_fmamk_f32 v80, v81, 0x41200000, v80
    v_fmamk_f32 v88, v89, 0x41200000, v88
    v_cvt_pk_bf16_f32 v20, v77, v85
    v_cvt_pk_bf16_f32 v24, v78, v86
    v_cvt_pk_bf16_f32 v64, v79, v87
    v_cvt_pk_bf16_f32 v68, v82, v90
    v_cvt_pk_bf16_f32 v72, v80, v88
    v_lshlrev_b32 v76, 16, v17
    v_and_b32 v84, s25, v17
    v_lshlrev_b32 v77, 16, v21
    v_and_b32 v85, s25, v21
    v_lshlrev_b32 v78, 16, v25
    v_and_b32 v86, s25, v25
    v_lshlrev_b32 v79, 16, v29
    v_and_b32 v87, s25, v29
    v_add_f32 v80, v76, v78
    v_add_f32 v88, v84, v86
    v_add_f32 v81, v77, v79
    v_add_f32 v89, v85, v87
    v_fma_f32 v82, v78, 4.0, v76
    v_fma_f32 v90, v86, 4.0, v84
    v_fma_f32 v83, v79, 4.0, v77
    v_fma_f32 v91, v87, 4.0, v85
    v_add_f32 v77, v80, v81
    v_add_f32 v85, v88, v89
    v_sub_f32 v78, v80, v81
    v_sub_f32 v86, v88, v89
    v_fma_f32 v79, v83, 2.0, v82
    v_fma_f32 v87, v91, 2.0, v90
    v_fma_f32 v82, v83, -2.0, v82
    v_fma_f32 v90, v91, -2.0, v90
    v_fmamk_f32 v80, v76, 0x41700000, v82
    v_fmamk_f32 v88, v84, 0x41700000, v90
    v_fmamk_f32 v80, v81, 0x41200000, v80
    v_fmamk_f32 v88, v89, 0x41200000, v88
    v_cvt_pk_bf16_f32 v21, v77, v85
    v_cvt_pk_bf16_f32 v25, v78, v86
    v_cvt_pk_bf16_f32 v65, v79, v87
    v_cvt_pk_bf16_f32 v69, v82, v90
    v_cvt_pk_bf16_f32 v73, v80, v88
    buffer_load_dwordx4 v[44:47], v95, s[8:11], s24 offen offset:0
    buffer_load_dwordx4 v[60:63], v95, s[8:11], s24 offen offset:64
    v_add_u32 v95, 128, v95
    v_lshlrev_b32 v76, 16, v18
    v_and_b32 v84, s25, v18
    v_lshlrev_b32 v77, 16, v22
    v_and_b32 v85, s25, v22
    v_lshlrev_b32 v78, 16, v26
    v_and_b32 v86, s25, v26
    v_lshlrev_b32 v79, 16, v30
    v_and_b32 v87, s25, v30
    v_add_f32 v80, v76, v78
    v_add_f32 v88, v84, v86
    v_add_f32 v81, v77, v79
    v_add_f32 v89, v85, v87
    v_fma_f32 v82, v78, 4.0, v76
    v_fma_f32 v90, v86, 4.0, v84
    v_fma_f32 v83, v79, 4.0, v77
    v_fma_f32 v91, v87, 4.0, v85
    v_add_f32 v77, v80, v81
    v_add_f32 v85, v88, v89
    v_sub_f32 v78, v80, v81
    v_sub_f32 v86, v88, v89
    v_fma_f32 v79, v83, 2.0, v82
    v_fma_f32 v87, v91, 2.0, v90
    v_fma_f32 v82, v83, -2.0, v82
    v_fma_f32 v90, v91, -2.0, v90
    v_fmamk_f32 v80, v76, 0x41700000, v82
    v_fmamk_f32 v88, v84, 0x41700000, v90
    v_fmamk_f32 v80, v81, 0x41200000, v80
    v_fmamk_f32 v88, v89, 0x41200000, v88
    v_cvt_pk_bf16_f32 v22, v77, v85
    v_cvt_pk_bf16_f32 v26, v78, v86
    v_cvt_pk_bf16_f32 v66, v79, v87
    v_cvt_pk_bf16_f32 v70, v82, v90
    v_cvt_pk_bf16_f32 v74, v80, v88
    v_lshlrev_b32 v76, 16, v19
    v_and_b32 v84, s25, v19
    v_lshlrev_b32 v77, 16, v23
    v_and_b32 v85, s25, v23
    v_lshlrev_b32 v78, 16, v27
    v_and_b32 v86, s25, v27
    v_lshlrev_b32 v79, 16, v31
    v_and_b32 v87, s25, v31
    v_add_f32 v80, v76, v78
    v_add_f32 v88, v84, v86
    v_add_f32 v81, v77, v79
    v_add_f32 v89, v85, v87
    v_fma_f32 v82, v78, 4.0, v76
    v_fma_f32 v90, v86, 4.0, v84
    v_fma_f32 v83, v79, 4.0, v77
    v_fma_f32 v91, v87, 4.0, v85
    v_add_f32 v77, v80, v81
    v_add_f32 v85, v88, v89
    v_sub_f32 v78, v80, v81
    v_sub_f32 v86, v88, v89
    v_fma_f32 v79, v83, 2.0, v82
    v_fma_f32 v87, v91, 2.0, v90
    v_fma_f32 v82, v83, -2.0, v82
    v_fma_f32 v90, v91, -2.0, v90
    v_fmamk_f32 v80, v76, 0x41700000, v82
    v_fmamk_f32 v88, v84, 0x41700000, v90
    v_fmamk_f32 v80, v81, 0x41200000, v80
    v_fmamk_f32 v88, v89, 0x41200000, v88
    v_cvt_pk_bf16_f32 v23, v77, v85
    v_cvt_pk_bf16_f32 v27, v78, v86
    v_cvt_pk_bf16_f32 v67, v79, v87
    v_cvt_pk_bf16_f32 v71, v82, v90
    v_cvt_pk_bf16_f32 v75, v80, v88
    ds_write_b128 v96, v[64:67] offset:57344
    ds_write_b128 v97, v[68:71] offset:8192
    ds_write_b128 v97, v[72:75] offset:24576
    ds_write_b128 v96, v[16:19] offset:8192
    ds_write_b128 v96, v[20:23] offset:24576
    ds_write_b128 v96, v[24:27] offset:40960
    ds_write_b128 v98, v[28:31] offset:8704
    s_add_u32 s28, s28, 1
    s_waitcnt lgkmcnt(0)
    s_barrier
    s_cmp_lt_u32 s28, 13
    s_cselect_b32 s24, 0, 2130706432
    s_waitcnt vmcnt(0)
    v_lshlrev_b32 v76, 16, v32
    v_and_b32 v84, s25, v32
    v_lshlrev_b32 v77, 16, v36
    v_and_b32 v85, s25, v36
    v_lshlrev_b32 v78, 16, v40
    v_and_b32 v86, s25, v40
    v_lshlrev_b32 v79, 16, v44
    v_and_b32 v87, s25, v44
    v_add_f32 v80, v76, v78
    v_add_f32 v88, v84, v86
    v_add_f32 v81, v77, v79
    v_add_f32 v89, v85, v87
    v_fma_f32 v82, v78, 4.0, v76
    v_fma_f32 v90, v86, 4.0, v84
    v_fma_f32 v83, v79, 4.0, v77
    v_fma_f32 v91, v87, 4.0, v85
    v_add_f32 v77, v80, v81
    v_add_f32 v85, v88, v89
    v_sub_f32 v78, v80, v81
    v_sub_f32 v86, v88, v89
    v_fma_f32 v79, v83, 2.0, v82
    v_fma_f32 v87, v91, 2.0, v90
    v_fma_f32 v82, v83, -2.0, v82
    v_fma_f32 v90, v91, -2.0, v90
    v_fmamk_f32 v80, v76, 0x41700000, v82
    v_fmamk_f32 v88, v84, 0x41700000, v90
    v_fmamk_f32 v80, v81, 0x41200000, v80
    v_fmamk_f32 v88, v89, 0x41200000, v88
    v_cvt_pk_bf16_f32 v36, v77, v85
    v_cvt_pk_bf16_f32 v40, v78, v86
    v_cvt_pk_bf16_f32 v64, v79, v87
    v_cvt_pk_bf16_f32 v68, v82, v90
    v_cvt_pk_bf16_f32 v72, v80, v88
    v_lshlrev_b32 v76, 16, v33
    v_and_b32 v84, s25, v33
    v_lshlrev_b32 v77, 16, v37
    v_and_b32 v85, s25, v37
    v_lshlrev_b32 v78, 16, v41
    v_and_b32 v86, s25, v41
    buffer_load_dwordx4 v[0:3], v92, s[8:11], s24 offen offset:0
    buffer_load_dwordx4 v[16:19], v92, s[8:11], s24 offen offset:64
    v_add_u32 v92, 128, v92
    v_lshlrev_b32 v79, 16, v45
    v_and_b32 v87, s25, v45
    v_add_f32 v80, v76, v78
    v_add_f32 v88, v84, v86
    v_add_f32 v81, v77, v79
    v_add_f32 v89, v85, v87
    v_fma_f32 v82, v78, 4.0, v76
    v_fma_f32 v90, v86, 4.0, v84
    v_fma_f32 v83, v79, 4.0, v77
    v_fma_f32 v91, v87, 4.0, v85
    v_add_f32 v77, v80, v81
    v_add_f32 v85, v88, v89
    v_sub_f32 v78, v80, v81
    v_sub_f32 v86, v88, v89
    v_fma_f32 v79, v83, 2.0, v82
    v_fma_f32 v87, v91, 2.0, v90
    v_fma_f32 v82, v83, -2.0, v82
    v_fma_f32 v90, v91, -2.0, v90
    v_fmamk_f32 v80, v76, 0x41700000, v82
    v_fmamk_f32 v88, v84, 0x41700000, v90
    v_fmamk_f32 v80, v81, 0x41200000, v80
    v_fmamk_f32 v88, v89, 0x41200000, v88
    v_cvt_pk_bf16_f32 v37, v77, v85
    v_cvt_pk_bf16_f32 v41, v78, v86
    v_cvt_pk_bf16_f32 v65, v79, v87
    v_cvt_pk_bf16_f32 v69, v82, v90
    v_cvt_pk_bf16_f32 v73, v80, v88
    v_lshlrev_b32 v76, 16, v34
    v_and_b32 v84, s25, v34
    v_lshlrev_b32 v77, 16, v38
    v_and_b32 v85, s25, v38
    v_lshlrev_b32 v78, 16, v42
    v_and_b32 v86, s25, v42
    v_lshlrev_b32 v79, 16, v46
    v_and_b32 v87, s25, v46
    v_add_f32 v80, v76, v78
    v_add_f32 v88, v84, v86
    v_add_f32 v81, v77, v79
    v_add_f32 v89, v85, v87
    v_fma_f32 v82, v78, 4.0, v76
    v_fma_f32 v90, v86, 4.0, v84
    v_fma_f32 v83, v79, 4.0, v77
    v_fma_f32 v91, v87, 4.0, v85
    v_add_f32 v77, v80, v81
    v_add_f32 v85, v88, v89
    v_sub_f32 v78, v80, v81
    v_sub_f32 v86, v88, v89
    v_fma_f32 v79, v83, 2.0, v82
    v_fma_f32 v87, v91, 2.0, v90
    v_fma_f32 v82, v83, -2.0, v82
    v_fma_f32 v90, v91, -2.0, v90
    v_fmamk_f32 v80, v76, 0x41700000, v82
    v_fmamk_f32 v88, v84, 0x41700000, v90
    buffer_load_dwordx4 v[4:7], v93, s[8:11], s24 offen offset:0
    buffer_load_dwordx4 v[20:23], v93, s[8:11], s24 offen offset:64
    v_add_u32 v93, 128, v93
    v_fmamk_f32 v80, v81, 0x41200000, v80
    v_fmamk_f32 v88, v89, 0x41200000, v88
    v_cvt_pk_bf16_f32 v38, v77, v85
    v_cvt_pk_bf16_f32 v42, v78, v86
    v_cvt_pk_bf16_f32 v66, v79, v87
    v_cvt_pk_bf16_f32 v70, v82, v90
    v_cvt_pk_bf16_f32 v74, v80, v88
    v_lshlrev_b32 v76, 16, v35
    v_and_b32 v84, s25, v35
    v_lshlrev_b32 v77, 16, v39
    v_and_b32 v85, s25, v39
    v_lshlrev_b32 v78, 16, v43
    v_and_b32 v86, s25, v43
    v_lshlrev_b32 v79, 16, v47
    v_and_b32 v87, s25, v47
    v_add_f32 v80, v76, v78
    v_add_f32 v88, v84, v86
    v_add_f32 v81, v77, v79
    v_add_f32 v89, v85, v87
    v_fma_f32 v82, v78, 4.0, v76
    v_fma_f32 v90, v86, 4.0, v84
    v_fma_f32 v83, v79, 4.0, v77
    v_fma_f32 v91, v87, 4.0, v85
    v_add_f32 v77, v80, v81
    v_add_f32 v85, v88, v89
    v_sub_f32 v78, v80, v81
    v_sub_f32 v86, v88, v89
    v_fma_f32 v79, v83, 2.0, v82
    v_fma_f32 v87, v91, 2.0, v90
    v_fma_f32 v82, v83, -2.0, v82
    v_fma_f32 v90, v91, -2.0, v90
    v_fmamk_f32 v80, v76, 0x41700000, v82
    v_fmamk_f32 v88, v84, 0x41700000, v90
    v_fmamk_f32 v80, v81, 0x41200000, v80
    v_fmamk_f32 v88, v89, 0x41200000, v88
    v_cvt_pk_bf16_f32 v39, v77, v85
    v_cvt_pk_bf16_f32 v43, v78, v86
    v_cvt_pk_bf16_f32 v67, v79, v87
    v_cvt_pk_bf16_f32 v71, v82, v90
    v_cvt_pk_bf16_f32 v75, v80, v88
    ds_write_b128 v96, v[64:67] offset:49152
    ds_write_b128 v97, v[68:71] offset:0
    ds_write_b128 v97, v[72:75] offset:16384
    ds_write_b128 v96, v[32:35] offset:0
    ds_write_b128 v96, v[36:39] offset:16384
    ds_write_b128 v96, v[40:43] offset:32768
    ds_write_b128 v98, v[44:47] offset:0
    s_add_u32 s28, s28, 1
    s_waitcnt lgkmcnt(0)
    s_barrier
    s_cmp_lt_u32 s28, 13
    s_cselect_b32 s24, 0, 2130706432
    v_lshlrev_b32 v76, 16, v48
    v_and_b32 v84, s25, v48
    v_lshlrev_b32 v77, 16, v52
    v_and_b32 v85, s25, v52
    v_lshlrev_b32 v78, 16, v56
    v_and_b32 v86, s25, v56
    v_lshlrev_b32 v79, 16, v60
    v_and_b32 v87, s25, v60
    v_add_f32 v80, v76, v78
    v_add_f32 v88, v84, v86
    v_add_f32 v81, v77, v79
    v_add_f32 v89, v85, v87
    v_fma_f32 v82, v78, 4.0, v76
    buffer_load_dwordx4 v[8:11], v94, s[8:11], s24 offen offset:0
    buffer_load_dwordx4 v[24:27], v94, s[8:11], s24 offen offset:64
    v_add_u32 v94, 128, v94
    v_fma_f32 v90, v86, 4.0, v84
    v_fma_f32 v83, v79, 4.0, v77
    v_fma_f32 v91, v87, 4.0, v85
    v_add_f32 v77, v80, v81
    v_add_f32 v85, v88, v89
    v_sub_f32 v78, v80, v81
    v_sub_f32 v86, v88, v89
    v_fma_f32 v79, v83, 2.0, v82
    v_fma_f32 v87, v91, 2.0, v90
    v_fma_f32 v82, v83, -2.0, v82
    v_fma_f32 v90, v91, -2.0, v90
    v_fmamk_f32 v80, v76, 0x41700000, v82
    v_fmamk_f32 v88, v84, 0x41700000, v90
    v_fmamk_f32 v80, v81, 0x41200000, v80
    v_fmamk_f32 v88, v89, 0x41200000, v88
    v_cvt_pk_bf16_f32 v52, v77, v85
    v_cvt_pk_bf16_f32 v56, v78, v86
    v_cvt_pk_bf16_f32 v64, v79, v87
    v_cvt_pk_bf16_f32 v68, v82, v90
    v_cvt_pk_bf16_f32 v72, v80, v88
    v_lshlrev_b32 v76, 16, v49
    v_and_b32 v84, s25, v49
    v_lshlrev_b32 v77, 16, v53
    v_and_b32 v85, s25, v53
    v_lshlrev_b32 v78, 16, v57
    v_and_b32 v86, s25, v57
    v_lshlrev_b32 v79, 16, v61
    v_and_b32 v87, s25, v61
    v_add_f32 v80, v76, v78
    v_add_f32 v88, v84, v86
    v_add_f32 v81, v77, v79
    v_add_f32 v89, v85, v87
    v_fma_f32 v82, v78, 4.0, v76
    v_fma_f32 v90, v86, 4.0, v84
    v_fma_f32 v83, v79, 4.0, v77
    v_fma_f32 v91, v87, 4.0, v85
    v_add_f32 v77, v80, v81
    v_add_f32 v85, v88, v89
    v_sub_f32 v78, v80, v81
    v_sub_f32 v86, v88, v89
    v_fma_f32 v79, v83, 2.0, v82
    v_fma_f32 v87, v91, 2.0, v90
    v_fma_f32 v82, v83, -2.0, v82
    v_fma_f32 v90, v91, -2.0, v90
    v_fmamk_f32 v80, v76, 0x41700000, v82
    v_fmamk_f32 v88, v84, 0x41700000, v90
    v_fmamk_f32 v80, v81, 0x41200000, v80
    v_fmamk_f32 v88, v89, 0x41200000, v88
    v_cvt_pk_bf16_f32 v53, v77, v85
    v_cvt_pk_bf16_f32 v57, v78, v86
    v_cvt_pk_bf16_f32 v65, v79, v87
    v_cvt_pk_bf16_f32 v69, v82, v90
    v_cvt_pk_bf16_f32 v73, v80, v88
    buffer_load_dwordx4 v[12:15], v95, s[8:11], s24 offen offset:0
    buffer_load_dwordx4 v[28:31], v95, s[8:11], s24 offen offset:64
    v_add_u32 v95, 128, v95
    v_lshlrev_b32 v76, 16, v50
    v_and_b32 v84, s25, v50
    v_lshlrev_b32 v77, 16, v54
    v_and_b32 v85, s25, v54
    v_lshlrev_b32 v78, 16, v58
    v_and_b32 v86, s25, v58
    v_lshlrev_b32 v79, 16, v62
    v_and_b32 v87, s25, v62
    v_add_f32 v80, v76, v78
    v_add_f32 v88, v84, v86
    v_add_f32 v81, v77, v79
    v_add_f32 v89, v85, v87
    v_fma_f32 v82, v78, 4.0, v76
    v_fma_f32 v90, v86, 4.0, v84
    v_fma_f32 v83, v79, 4.0, v77
    v_fma_f32 v91, v87, 4.0, v85
    v_add_f32 v77, v80, v81
    v_add_f32 v85, v88, v89
    v_sub_f32 v78, v80, v81
    v_sub_f32 v86, v88, v89
    v_fma_f32 v79, v83, 2.0, v82
    v_fma_f32 v87, v91, 2.0, v90
    v_fma_f32 v82, v83, -2.0, v82
    v_fma_f32 v90, v91, -2.0, v90
    v_fmamk_f32 v80, v76, 0x41700000, v82
    v_fmamk_f32 v88, v84, 0x41700000, v90
    v_fmamk_f32 v80, v81, 0x41200000, v80
    v_fmamk_f32 v88, v89, 0x41200000, v88
    v_cvt_pk_bf16_f32 v54, v77, v85
    v_cvt_pk_bf16_f32 v58, v78, v86
    v_cvt_pk_bf16_f32 v66, v79, v87
    v_cvt_pk_bf16_f32 v70, v82, v90
    v_cvt_pk_bf16_f32 v74, v80, v88
    v_lshlrev_b32 v76, 16, v51
    v_and_b32 v84, s25, v51
    v_lshlrev_b32 v77, 16, v55
    v_and_b32 v85, s25, v55
    v_lshlrev_b32 v78, 16, v59
    v_and_b32 v86, s25, v59
    v_lshlrev_b32 v79, 16, v63
    v_and_b32 v87, s25, v63
    v_add_f32 v80, v76, v78
    v_add_f32 v88, v84, v86
    v_add_f32 v81, v77, v79
    v_add_f32 v89, v85, v87
    v_fma_f32 v82, v78, 4.0, v76
    v_fma_f32 v90, v86, 4.0, v84
    v_fma_f32 v83, v79, 4.0, v77
    v_fma_f32 v91, v87, 4.0, v85
    v_add_f32 v77, v80, v81
    v_add_f32 v85, v88, v89
    v_sub_f32 v78, v80, v81
    v_sub_f32 v86, v88, v89
    v_fma_f32 v79, v83, 2.0, v82
    v_fma_f32 v87, v91, 2.0, v90
    v_fma_f32 v82, v83, -2.0, v82
    v_fma_f32 v90, v91, -2.0, v90
    v_fmamk_f32 v80, v76, 0x41700000, v82
    v_fmamk_f32 v88, v84, 0x41700000, v90
    v_fmamk_f32 v80, v81, 0x41200000, v80
    v_fmamk_f32 v88, v89, 0x41200000, v88
    v_cvt_pk_bf16_f32 v55, v77, v85
    v_cvt_pk_bf16_f32 v59, v78, v86
    v_cvt_pk_bf16_f32 v67, v79, v87
    v_cvt_pk_bf16_f32 v71, v82, v90
    v_cvt_pk_bf16_f32 v75, v80, v88
    ds_write_b128 v96, v[64:67] offset:57344
    ds_write_b128 v97, v[68:71] offset:8192
    ds_write_b128 v97, v[72:75] offset:24576
    ds_write_b128 v96, v[48:51] offset:8192
    ds_write_b128 v96, v[52:55] offset:24576
    ds_write_b128 v96, v[56:59] offset:40960
    ds_write_b128 v98, v[60:63] offset:8704
    s_add_u32 s28, s28, 1
    s_waitcnt lgkmcnt(0)
    s_barrier
    s_cmp_eq_u32 s22, 1
    s_cbranch_scc1 L_conv1_kernel_hlast1
    s_cmp_lt_u32 s28, 13
    s_cselect_b32 s24, 0, 2130706432
    s_waitcnt vmcnt(0)
    v_lshlrev_b32 v76, 16, v0
    v_and_b32 v84, s25, v0
    v_lshlrev_b32 v77, 16, v4
    v_and_b32 v85, s25, v4
    v_lshlrev_b32 v78, 16, v8
    v_and_b32 v86, s25, v8
    v_lshlrev_b32 v79, 16, v12
    v_and_b32 v87, s25, v12
    v_add_f32 v80, v76, v78
    v_add_f32 v88, v84, v86
    v_add_f32 v81, v77, v79
    v_add_f32 v89, v85, v87
    v_fma_f32 v82, v78, 4.0, v76
    v_fma_f32 v90, v86, 4.0, v84
    v_fma_f32 v83, v79, 4.0, v77
    v_fma_f32 v91, v87, 4.0, v85
    v_add_f32 v77, v80, v81
    v_add_f32 v85, v88, v89
    v_sub_f32 v78, v80, v81
    v_sub_f32 v86, v88, v89
    v_fma_f32 v79, v83, 2.0, v82
    v_fma_f32 v87, v91, 2.0, v90
    v_fma_f32 v82, v83, -2.0, v82
    v_fma_f32 v90, v91, -2.0, v90
    v_fmamk_f32 v80, v76, 0x41700000, v82
    v_fmamk_f32 v88, v84, 0x41700000, v90
    v_fmamk_f32 v80, v81, 0x41200000, v80
    v_fmamk_f32 v88, v89, 0x41200000, v88
    v_cvt_pk_bf16_f32 v4, v77, v85
    v_cvt_pk_bf16_f32 v8, v78, v86
    v_cvt_pk_bf16_f32 v64, v79, v87
    v_cvt_pk_bf16_f32 v68, v82, v90
    v_cvt_pk_bf16_f32 v72, v80, v88
    v_lshlrev_b32 v76, 16, v1
    v_and_b32 v84, s25, v1
    v_lshlrev_b32 v77, 16, v5
    v_and_b32 v85, s25, v5
    v_lshlrev_b32 v78, 16, v9
    v_and_b32 v86, s25, v9
    buffer_load_dwordx4 v[32:35], v92, s[8:11], s24 offen offset:0
    buffer_load_dwordx4 v[48:51], v92, s[8:11], s24 offen offset:64
    v_add_u32 v92, 128, v92
    v_lshlrev_b32 v79, 16, v13
    v_and_b32 v87, s25, v13
    v_add_f32 v80, v76, v78
    v_add_f32 v88, v84, v86
    v_add_f32 v81, v77, v79
    v_add_f32 v89, v85, v87
    v_fma_f32 v82, v78, 4.0, v76
    v_fma_f32 v90, v86, 4.0, v84
    v_fma_f32 v83, v79, 4.0, v77
    v_fma_f32 v91, v87, 4.0, v85
    v_add_f32 v77, v80, v81
    v_add_f32 v85, v88, v89
    v_sub_f32 v78, v80, v81
    v_sub_f32 v86, v88, v89
    v_fma_f32 v79, v83, 2.0, v82
    v_fma_f32 v87, v91, 2.0, v90
    v_fma_f32 v82, v83, -2.0, v82
    v_fma_f32 v90, v91, -2.0, v90
    v_fmamk_f32 v80, v76, 0x41700000, v82
    v_fmamk_f32 v88, v84, 0x41700000, v90
    v_fmamk_f32 v80, v81, 0x41200000, v80
    v_fmamk_f32 v88, v89, 0x41200000, v88
    v_cvt_pk_bf16_f32 v5, v77, v85
    v_cvt_pk_bf16_f32 v9, v78, v86
    v_cvt_pk_bf16_f32 v65, v79, v87
    v_cvt_pk_bf16_f32 v69, v82, v90
    v_cvt_pk_bf16_f32 v73, v80, v88
    v_lshlrev_b32 v76, 16, v2
    v_and_b32 v84, s25, v2
    v_lshlrev_b32 v77, 16, v6
    v_and_b32 v85, s25, v6
    v_lshlrev_b32 v78, 16, v10
    v_and_b32 v86, s25, v10
    v_lshlrev_b32 v79, 16, v14
    v_and_b32 v87, s25, v14
    v_add_f32 v80, v76, v78
    v_add_f32 v88, v84, v86
    v_add_f32 v81, v77, v79
    v_add_f32 v89, v85, v87
    v_fma_f32 v82, v78, 4.0, v76
    v_fma_f32 v90, v86, 4.0, v84
    v_fma_f32 v83, v79, 4.0, v77
    v_fma_f32 v91, v87, 4.0, v85
    v_add_f32 v77, v80, v81
    v_add_f32 v85, v88, v89
    v_sub_f32 v78, v80, v81
    v_sub_f32 v86, v88, v89
    v_fma_f32 v79, v83, 2.0, v82
    v_fma_f32 v87, v91, 2.0, v90
    v_fma_f32 v82, v83, -2.0, v82
    v_fma_f32 v90, v91, -2.0, v90
    v_fmamk_f32 v80, v76, 0x41700000, v82
    v_fmamk_f32 v88, v84, 0x41700000, v90
    buffer_load_dwordx4 v[36:39], v93, s[8:11], s24 offen offset:0
    buffer_load_dwordx4 v[52:55], v93, s[8:11], s24 offen offset:64
    v_add_u32 v93, 128, v93
    v_fmamk_f32 v80, v81, 0x41200000, v80
    v_fmamk_f32 v88, v89, 0x41200000, v88
    v_cvt_pk_bf16_f32 v6, v77, v85
    v_cvt_pk_bf16_f32 v10, v78, v86
    v_cvt_pk_bf16_f32 v66, v79, v87
    v_cvt_pk_bf16_f32 v70, v82, v90
    v_cvt_pk_bf16_f32 v74, v80, v88
    v_lshlrev_b32 v76, 16, v3
    v_and_b32 v84, s25, v3
    v_lshlrev_b32 v77, 16, v7
    v_and_b32 v85, s25, v7
    v_lshlrev_b32 v78, 16, v11
    v_and_b32 v86, s25, v11
    v_lshlrev_b32 v79, 16, v15
    v_and_b32 v87, s25, v15
    v_add_f32 v80, v76, v78
    v_add_f32 v88, v84, v86
    v_add_f32 v81, v77, v79
    v_add_f32 v89, v85, v87
    v_fma_f32 v82, v78, 4.0, v76
    v_fma_f32 v90, v86, 4.0, v84
    v_fma_f32 v83, v79, 4.0, v77
    v_fma_f32 v91, v87, 4.0, v85
    v_add_f32 v77, v80, v81
    v_add_f32 v85, v88, v89
    v_sub_f32 v78, v80, v81
    v_sub_f32 v86, v88, v89
    v_fma_f32 v79, v83, 2.0, v82
    v_fma_f32 v87, v91, 2.0, v90
    v_fma_f32 v82, v83, -2.0, v82
    v_fma_f32 v90, v91, -2.0, v90
    v_fmamk_f32 v80, v76, 0x41700000, v82
    v_fmamk_f32 v88, v84, 0x41700000, v90
    v_fmamk_f32 v80, v81, 0x41200000, v80
    v_fmamk_f32 v88, v89, 0x41200000, v88
    v_cvt_pk_bf16_f32 v7, v77, v85
    v_cvt_pk_bf16_f32 v11, v78, v86
    v_cvt_pk_bf16_f32 v67, v79, v87
    v_cvt_pk_bf16_f32 v71, v82, v90
    v_cvt_pk_bf16_f32 v75, v80, v88
    ds_write_b128 v96, v[64:67] offset:49152
    ds_write_b128 v97, v[68:71] offset:0
    ds_write_b128 v97, v[72:75] offset:16384
    ds_write_b128 v96, v[0:3] offset:0
    ds_write_b128 v96, v[4:7] offset:16384
    ds_write_b128 v96, v[8:11] offset:32768
    ds_write_b128 v98, v[12:15] offset:0
    s_add_u32 s28, s28, 1
    s_waitcnt lgkmcnt(0)
    s_barrier
    s_sub_u32 s22, s22, 1
    s_branch L_conv1_kernel_hloop1
L_conv1_kernel_hlast1:
    s_branch L_conv1_kernel_end
L_conv1_kernel_h2:
    ds_write_b128 v96, v[0:3] offset:0
    ds_write_b128 v98, v[12:15] offset:0
    v_lshlrev_b32 v76, 16, v0
    v_and_b32 v84, s25, v0
    v_lshlrev_b32 v77, 16, v4
    v_and_b32 v85, s25, v4
    v_lshlrev_b32 v78, 16, v8
    v_and_b32 v86, s25, v8
    v_lshlrev_b32 v79, 16, v12
    v_and_b32 v87, s25, v12
    v_add_f32 v80, v76, v78
    v_add_f32 v88, v84, v86
    v_add_f32 v81, v77, v79
    v_add_f32 v89, v85, v87
    v_fma_f32 v82, v78, 4.0, v76
    v_fma_f32 v90, v86, 4.0, v84
    v_fma_f32 v83, v79, 4.0, v77
    v_fma_f32 v91, v87, 4.0, v85
    v_add_f32 v77, v80, v81
    v_add_f32 v85, v88, v89
    v_sub_f32 v78, v80, v81
    v_sub_f32 v86, v88, v89
    v_fma_f32 v79, v83, 2.0, v82
    v_fma_f32 v87, v91, 2.0, v90
    v_fma_f32 v82, v83, -2.0, v82
    v_fma_f32 v90, v91, -2.0, v90
    v_fmamk_f32 v80, v76, 0x41700000, v82
    v_fmamk_f32 v88, v84, 0x41700000, v90
    v_fmamk_f32 v80, v81, 0x41200000, v80
    v_fmamk_f32 v88, v89, 0x41200000, v88
    v_cvt_pk_bf16_f32 v4, v77, v85
    v_cvt_pk_bf16_f32 v8, v78, v86
    v_cvt_pk_bf16_f32 v64, v79, v87
    v_cvt_pk_bf16_f32 v68, v82, v90
    v_cvt_pk_bf16_f32 v72, v80, v88
    v_lshlrev_b32 v76, 16, v1
    v_and_b32 v84, s25, v1
    v_lshlrev_b32 v77, 16, v5
    v_and_b32 v85, s25, v5
    v_lshlrev_b32 v78, 16, v9
    v_and_b32 v86, s25, v9
    v_lshlrev_b32 v79, 16, v13
    v_and_b32 v87, s25, v13
    v_add_f32 v80, v76, v78
    v_add_f32 v88, v84, v86
    v_add_f32 v81, v77, v79
    v_add_f32 v89, v85, v87
    v_fma_f32 v82, v78, 4.0, v76
    v_fma_f32 v90, v86, 4.0, v84
    v_fma_f32 v83, v79, 4.0, v77
    v_fma_f32 v91, v87, 4.0, v85
    v_add_f32 v77, v80, v81
    v_add_f32 v85, v88, v89
    v_sub_f32 v78, v80, v81
    v_sub_f32 v86, v88, v89
    v_fma_f32 v79, v83, 2.0, v82
    v_fma_f32 v87, v91, 2.0, v90
    v_fma_f32 v82, v83, -2.0, v82
    v_fma_f32 v90, v91, -2.0, v90
    v_fmamk_f32 v80, v76, 0x41700000, v82
    v_fmamk_f32 v88, v84, 0x41700000, v90
    v_fmamk_f32 v80, v81, 0x41200000, v80
    v_fmamk_f32 v88, v89, 0x41200000, v88
    v_cvt_pk_bf16_f32 v5, v77, v85
    v_cvt_pk_bf16_f32 v9, v78, v86
    v_cvt_pk_bf16_f32 v65, v79, v87
    v_cvt_pk_bf16_f32 v69, v82, v90
    v_cvt_pk_bf16_f32 v73, v80, v88
    v_lshlrev_b32 v76, 16, v2
    v_and_b32 v84, s25, v2
    v_lshlrev_b32 v77, 16, v6
    v_and_b32 v85, s25, v6
    v_lshlrev_b32 v78, 16, v10
    v_and_b32 v86, s25, v10
    v_lshlrev_b32 v79, 16, v14
    v_and_b32 v87, s25, v14
    v_add_f32 v80, v76, v78
    v_add_f32 v88, v84, v86
    v_add_f32 v81, v77, v79
    v_add_f32 v89, v85, v87
    v_fma_f32 v82, v78, 4.0, v76
    v_fma_f32 v90, v86, 4.0, v84
    v_fma_f32 v83, v79, 4.0, v77
    v_fma_f32 v91, v87, 4.0, v85
    v_add_f32 v77, v80, v81
    v_add_f32 v85, v88, v89
    v_sub_f32 v78, v80, v81
    v_sub_f32 v86, v88, v89
    v_fma_f32 v79, v83, 2.0, v82
    v_fma_f32 v87, v91, 2.0, v90
    v_fma_f32 v82, v83, -2.0, v82
    v_fma_f32 v90, v91, -2.0, v90
    v_fmamk_f32 v80, v76, 0x41700000, v82
    v_fmamk_f32 v88, v84, 0x41700000, v90
    v_fmamk_f32 v80, v81, 0x41200000, v80
    v_fmamk_f32 v88, v89, 0x41200000, v88
    v_cvt_pk_bf16_f32 v6, v77, v85
    v_cvt_pk_bf16_f32 v10, v78, v86
    v_cvt_pk_bf16_f32 v66, v79, v87
    v_cvt_pk_bf16_f32 v70, v82, v90
    v_cvt_pk_bf16_f32 v74, v80, v88
    v_lshlrev_b32 v76, 16, v3
    v_and_b32 v84, s25, v3
    v_lshlrev_b32 v77, 16, v7
    v_and_b32 v85, s25, v7
    v_lshlrev_b32 v78, 16, v11
    v_and_b32 v86, s25, v11
    v_lshlrev_b32 v79, 16, v15
    v_and_b32 v87, s25, v15
    v_add_f32 v80, v76, v78
    v_add_f32 v88, v84, v86
    v_add_f32 v81, v77, v79
    v_add_f32 v89, v85, v87
    v_fma_f32 v82, v78, 4.0, v76
    v_fma_f32 v90, v86, 4.0, v84
    v_fma_f32 v83, v79, 4.0, v77
    v_fma_f32 v91, v87, 4.0, v85
    v_add_f32 v77, v80, v81
    v_add_f32 v85, v88, v89
    v_sub_f32 v78, v80, v81
    v_sub_f32 v86, v88, v89
    v_fma_f32 v79, v83, 2.0, v82
    v_fma_f32 v87, v91, 2.0, v90
    v_fma_f32 v82, v83, -2.0, v82
    v_fma_f32 v90, v91, -2.0, v90
    v_fmamk_f32 v80, v76, 0x41700000, v82
    v_fmamk_f32 v88, v84, 0x41700000, v90
    v_fmamk_f32 v80, v81, 0x41200000, v80
    v_fmamk_f32 v88, v89, 0x41200000, v88
    v_cvt_pk_bf16_f32 v7, v77, v85
    v_cvt_pk_bf16_f32 v11, v78, v86
    v_cvt_pk_bf16_f32 v67, v79, v87
    v_cvt_pk_bf16_f32 v71, v82, v90
    v_cvt_pk_bf16_f32 v75, v80, v88
    ds_write_b128 v96, v[64:67] offset:49152
    ds_write_b128 v97, v[68:71] offset:0
    ds_write_b128 v97, v[72:75] offset:16384
    ds_write_b128 v96, v[4:7] offset:16384
    ds_write_b128 v96, v[8:11] offset:32768
    s_waitcnt vmcnt(0)
    buffer_load_dwordx4 v[32:35], v92, s[8:11], s24 offen offset:0
    buffer_load_dwordx4 v[48:51], v92, s[8:11], s24 offen offset:64
    v_add_u32 v92, 128, v92
    buffer_load_dwordx4 v[36:39], v93, s[8:11], s24 offen offset:0
    buffer_load_dwordx4 v[52:55], v93, s[8:11], s24 offen offset:64
    v_add_u32 v93, 128, v93
    buffer_load_dwordx4 v[40:43], v94, s[8:11], s24 offen offset:0
    buffer_load_dwordx4 v[56:59], v94, s[8:11], s24 offen offset:64
    v_add_u32 v94, 128, v94
    buffer_load_dwordx4 v[44:47], v95, s[8:11], s24 offen offset:0
    buffer_load_dwordx4 v[60:63], v95, s[8:11], s24 offen offset:64
    v_add_u32 v95, 128, v95
    s_waitcnt lgkmcnt(0)
    s_barrier
    s_setprio 0
    v_lshlrev_b32 v76, 16, v16
    v_and_b32 v84, s25, v16
    v_lshlrev_b32 v77, 16, v20
    v_and_b32 v85, s25, v20
    v_lshlrev_b32 v78, 16, v24
    v_and_b32 v86, s25, v24
    v_lshlrev_b32 v79, 16, v28
    v_and_b32 v87, s25, v28
    v_add_f32 v80, v76, v78
    v_add_f32 v88, v84, v86
    v_add_f32 v81, v77, v79
    v_add_f32 v89, v85, v87
    v_fma_f32 v82, v78, 4.0, v76
    v_fma_f32 v90, v86, 4.0, v84
    v_fma_f32 v83, v79, 4.0, v77
    v_fma_f32 v91, v87, 4.0, v85
    v_add_f32 v77, v80, v81
    v_add_f32 v85, v88, v89
    v_sub_f32 v78, v80, v81
    v_sub_f32 v86, v88, v89
    v_fma_f32 v79, v83, 2.0, v82
    v_fma_f32 v87, v91, 2.0, v90
    v_fma_f32 v82, v83, -2.0, v82
    v_fma_f32 v90, v91, -2.0, v90
    v_fmamk_f32 v80, v76, 0x41700000, v82
    v_fmamk_f32 v88, v84, 0x41700000, v90
    v_fmamk_f32 v80, v81, 0x41200000, v80
    v_fmamk_f32 v88, v89, 0x41200000, v88
    v_cvt_pk_bf16_f32 v20, v77, v85
    v_cvt_pk_bf16_f32 v24, v78, v86
    v_cvt_pk_bf16_f32 v64, v79, v87
    v_cvt_pk_bf16_f32 v68, v82, v90
    v_cvt_pk_bf16_f32 v72, v80, v88
    v_lshlrev_b32 v76, 16, v17
    v_and_b32 v84, s25, v17
    v_lshlrev_b32 v77, 16, v21
    v_and_b32 v85, s25, v21
    v_lshlrev_b32 v78, 16, v25
    v_and_b32 v86, s25, v25
    v_lshlrev_b32 v79, 16, v29
    v_and_b32 v87, s25, v29
    v_add_f32 v80, v76, v78
    v_add_f32 v88, v84, v86
    v_add_f32 v81, v77, v79
    v_add_f32 v89, v85, v87
    v_fma_f32 v82, v78, 4.0, v76
    v_fma_f32 v90, v86, 4.0, v84
    v_fma_f32 v83, v79, 4.0, v77
    v_fma_f32 v91, v87, 4.0, v85
    v_add_f32 v77, v80, v81
    v_add_f32 v85, v88, v89
    v_sub_f32 v78, v80, v81
    v_sub_f32 v86, v88, v89
    v_fma_f32 v79, v83, 2.0, v82
    v_fma_f32 v87, v91, 2.0, v90
    v_fma_f32 v82, v83, -2.0, v82
    v_fma_f32 v90, v91, -2.0, v90
    v_fmamk_f32 v80, v76, 0x41700000, v82
    v_fmamk_f32 v88, v84, 0x41700000, v90
    v_fmamk_f32 v80, v81, 0x41200000, v80
    v_fmamk_f32 v88, v89, 0x41200000, v88
    v_cvt_pk_bf16_f32 v21, v77, v85
    v_cvt_pk_bf16_f32 v25, v78, v86
    v_cvt_pk_bf16_f32 v65, v79, v87
    v_cvt_pk_bf16_f32 v69, v82, v90
    v_cvt_pk_bf16_f32 v73, v80, v88
    v_lshlrev_b32 v76, 16, v18
    v_and_b32 v84, s25, v18
    v_lshlrev_b32 v77, 16, v22
    v_and_b32 v85, s25, v22
    v_lshlrev_b32 v78, 16, v26
    v_and_b32 v86, s25, v26
    v_lshlrev_b32 v79, 16, v30
    v_and_b32 v87, s25, v30
    v_add_f32 v80, v76, v78
    v_add_f32 v88, v84, v86
    v_add_f32 v81, v77, v79
    v_add_f32 v89, v85, v87
    v_fma_f32 v82, v78, 4.0, v76
    v_fma_f32 v90, v86, 4.0, v84
    v_fma_f32 v83, v79, 4.0, v77
    v_fma_f32 v91, v87, 4.0, v85
    v_add_f32 v77, v80, v81
    v_add_f32 v85, v88, v89
    v_sub_f32 v78, v80, v81
    v_sub_f32 v86, v88, v89
    v_fma_f32 v79, v83, 2.0, v82
    v_fma_f32 v87, v91, 2.0, v90
    v_fma_f32 v82, v83, -2.0, v82
    v_fma_f32 v90, v91, -2.0, v90
    v_fmamk_f32 v80, v76, 0x41700000, v82
    v_fmamk_f32 v88, v84, 0x41700000, v90
    v_fmamk_f32 v80, v81, 0x41200000, v80
    v_fmamk_f32 v88, v89, 0x41200000, v88
    v_cvt_pk_bf16_f32 v22, v77, v85
    v_cvt_pk_bf16_f32 v26, v78, v86
    v_cvt_pk_bf16_f32 v66, v79, v87
    v_cvt_pk_bf16_f32 v70, v82, v90
    v_cvt_pk_bf16_f32 v74, v80, v88
    v_lshlrev_b32 v76, 16, v19
    v_and_b32 v84, s25, v19
    v_lshlrev_b32 v77, 16, v23
    v_and_b32 v85, s25, v23
    v_lshlrev_b32 v78, 16, v27
    v_and_b32 v86, s25, v27
    v_lshlrev_b32 v79, 16, v31
    v_and_b32 v87, s25, v31
    v_add_f32 v80, v76, v78
    v_add_f32 v88, v84, v86
    v_add_f32 v81, v77, v79
    v_add_f32 v89, v85, v87
    v_fma_f32 v82, v78, 4.0, v76
    v_fma_f32 v90, v86, 4.0, v84
    v_fma_f32 v83, v79, 4.0, v77
    v_fma_f32 v91, v87, 4.0, v85
    v_add_f32 v77, v80, v81
    v_add_f32 v85, v88, v89
    v_sub_f32 v78, v80, v81
    v_sub_f32 v86, v88, v89
    v_fma_f32 v79, v83, 2.0, v82
    v_fma_f32 v87, v91, 2.0, v90
    v_fma_f32 v82, v83, -2.0, v82
    v_fma_f32 v90, v91, -2.0, v90
    v_fmamk_f32 v80, v76, 0x41700000, v82
    v_fmamk_f32 v88, v84, 0x41700000, v90
    v_fmamk_f32 v80, v81, 0x41200000, v80
    v_fmamk_f32 v88, v89, 0x41200000, v88
    v_cvt_pk_bf16_f32 v23, v77, v85
    v_cvt_pk_bf16_f32 v27, v78, v86
    v_cvt_pk_bf16_f32 v67, v79, v87
    v_cvt_pk_bf16_f32 v71, v82, v90
    v_cvt_pk_bf16_f32 v75, v80, v88
L_conv1_kernel_hloop2:
    s_cmp_lt_u32 s28, 12
    s_cselect_b32 s24, 0, 2130706432
    ds_write_b128 v96, v[64:67] offset:57344
    ds_write_b128 v97, v[68:71] offset:8192
    ds_write_b128 v97, v[72:75] offset:24576
    ds_write_b128 v96, v[16:19] offset:8192
    ds_write_b128 v96, v[20:23] offset:24576
    ds_write_b128 v96, v[24:27] offset:40960
    ds_write_b128 v98, v[28:31] offset:8704
    s_waitcnt vmcnt(0)
    v_lshlrev_b32 v76, 16, v32
    v_and_b32 v84, s25, v32
    v_lshlrev_b32 v77, 16, v36
    v_and_b32 v85, s25, v36
    v_lshlrev_b32 v78, 16, v40
    v_and_b32 v86, s25, v40
    v_lshlrev_b32 v79, 16, v44
    v_and_b32 v87, s25, v44
    v_add_f32 v80, v76, v78
    v_add_f32 v88, v84, v86
    v_add_f32 v81, v77, v79
    v_add_f32 v89, v85, v87
    v_fma_f32 v82, v78, 4.0, v76
    v_fma_f32 v90, v86, 4.0, v84
    v_fma_f32 v83, v79, 4.0, v77
    v_fma_f32 v91, v87, 4.0, v85
    v_add_f32 v77, v80, v81
    v_add_f32 v85, v88, v89
    v_sub_f32 v78, v80, v81
    v_sub_f32 v86, v88, v89
    v_fma_f32 v79, v83, 2.0, v82
    v_fma_f32 v87, v91, 2.0, v90
    v_fma_f32 v82, v83, -2.0, v82
    v_fma_f32 v90, v91, -2.0, v90
    v_fmamk_f32 v80, v76, 0x41700000, v82
    v_fmamk_f32 v88, v84, 0x41700000, v90
    buffer_load_dwordx4 v[0:3], v92, s[8:11], s24 offen offset:0
    buffer_load_dwordx4 v[16:19], v92, s[8:11], s24 offen offset:64
    v_add_u32 v92, 128, v92
    v_fmamk_f32 v80, v81, 0x41200000, v80
    v_fmamk_f32 v88, v89, 0x41200000, v88
    v_cvt_pk_bf16_f32 v36, v77, v85
    v_cvt_pk_bf16_f32 v40, v78, v86
    v_cvt_pk_bf16_f32 v64, v79, v87
    v_cvt_pk_bf16_f32 v68, v82, v90
    v_cvt_pk_bf16_f32 v72, v80, v88
    v_lshlrev_b32 v76, 16, v33
    v_and_b32 v84, s25, v33
    v_lshlrev_b32 v77, 16, v37
    v_and_b32 v85, s25, v37
    v_lshlrev_b32 v78, 16, v41
    v_and_b32 v86, s25, v41
    v_lshlrev_b32 v79, 16, v45
    v_and_b32 v87, s25, v45
    v_add_f32 v80, v76, v78
    v_add_f32 v88, v84, v86
    v_add_f32 v81, v77, v79
    v_add_f32 v89, v85, v87
    v_fma_f32 v82, v78, 4.0, v76
    v_fma_f32 v90, v86, 4.0, v84
    v_fma_f32 v83, v79, 4.0, v77
    v_fma_f32 v91, v87, 4.0, v85
    v_add_f32 v77, v80, v81
    v_add_f32 v85, v88, v89
    v_sub_f32 v78, v80, v81
    v_sub_f32 v86, v88, v89
    v_fma_f32 v79, v83, 2.0, v82
    v_fma_f32 v87, v91, 2.0, v90
    v_fma_f32 v82, v83, -2.0, v82
    v_fma_f32 v90, v91, -2.0, v90
    v_fmamk_f32 v80, v76, 0x41700000, v82
    v_fmamk_f32 v88, v84, 0x41700000, v90
    v_fmamk_f32 v80, v81, 0x41200000, v80
    v_fmamk_f32 v88, v89, 0x41200000, v88
    v_cvt_pk_bf16_f32 v37, v77, v85
    v_cvt_pk_bf16_f32 v41, v78, v86
    v_cvt_pk_bf16_f32 v65, v79, v87
    v_cvt_pk_bf16_f32 v69, v82, v90
    v_cvt_pk_bf16_f32 v73, v80, v88
    v_lshlrev_b32 v76, 16, v34
    v_and_b32 v84, s25, v34
    v_lshlrev_b32 v77, 16, v38
    v_and_b32 v85, s25, v38
    v_lshlrev_b32 v78, 16, v42
    v_and_b32 v86, s25, v42
    v_lshlrev_b32 v79, 16, v46
    v_and_b32 v87, s25, v46
    v_add_f32 v80, v76, v78
    v_add_f32 v88, v84, v86
    v_add_f32 v81, v77, v79
    v_add_f32 v89, v85, v87
    v_fma_f32 v82, v78, 4.0, v76
    buffer_load_dwordx4 v[4:7], v93, s[8:11], s24 offen offset:0
    buffer_load_dwordx4 v[20:23], v93, s[8:11], s24 offen offset:64
    v_add_u32 v93, 128, v93
    v_fma_f32 v90, v86, 4.0, v84
    v_fma_f32 v83, v79, 4.0, v77
    v_fma_f32 v91, v87, 4.0, v85
    v_add_f32 v77, v80, v81
    v_add_f32 v85, v88, v89
    v_sub_f32 v78, v80, v81
    v_sub_f32 v86, v88, v89
    v_fma_f32 v79, v83, 2.0, v82
    v_fma_f32 v87, v91, 2.0, v90
    v_fma_f32 v82, v83, -2.0, v82
    v_fma_f32 v90, v91, -2.0, v90
    v_fmamk_f32 v80, v76, 0x41700000, v82
    v_fmamk_f32 v88, v84, 0x41700000, v90
    v_fmamk_f32 v80, v81, 0x41200000, v80
    v_fmamk_f32 v88, v89, 0x41200000, v88
    v_cvt_pk_bf16_f32 v38, v77, v85
    v_cvt_pk_bf16_f32 v42, v78, v86
    v_cvt_pk_bf16_f32 v66, v79, v87
    v_cvt_pk_bf16_f32 v70, v82, v90
    v_cvt_pk_bf16_f32 v74, v80, v88
    v_lshlrev_b32 v76, 16, v35
    v_and_b32 v84, s25, v35
    v_lshlrev_b32 v77, 16, v39
    v_and_b32 v85, s25, v39
    v_lshlrev_b32 v78, 16, v43
    v_and_b32 v86, s25, v43
    v_lshlrev_b32 v79, 16, v47
    v_and_b32 v87, s25, v47
    v_add_f32 v80, v76, v78
    v_add_f32 v88, v84, v86
    v_add_f32 v81, v77, v79
    v_add_f32 v89, v85, v87
    v_fma_f32 v82, v78, 4.0, v76
    v_fma_f32 v90, v86, 4.0, v84
    v_fma_f32 v83, v79, 4.0, v77
    v_fma_f32 v91, v87, 4.0, v85
    v_add_f32 v77, v80, v81
    v_add_f32 v85, v88, v89
    v_sub_f32 v78, v80, v81
    v_sub_f32 v86, v88, v89
    v_fma_f32 v79, v83, 2.0, v82
    v_fma_f32 v87, v91, 2.0, v90
    v_fma_f32 v82, v83, -2.0, v82
    v_fma_f32 v90, v91, -2.0, v90
    v_fmamk_f32 v80, v76, 0x41700000, v82
    v_fmamk_f32 v88, v84, 0x41700000, v90
    v_fmamk_f32 v80, v81, 0x41200000, v80
    v_fmamk_f32 v88, v89, 0x41200000, v88
    v_cvt_pk_bf16_f32 v39, v77, v85
    v_cvt_pk_bf16_f32 v43, v78, v86
    v_cvt_pk_bf16_f32 v67, v79, v87
    v_cvt_pk_bf16_f32 v71, v82, v90
    v_cvt_pk_bf16_f32 v75, v80, v88
    s_add_u32 s28, s28, 1
    s_waitcnt lgkmcnt(0)
    s_barrier
    s_cmp_lt_u32 s28, 12
    s_cselect_b32 s24, 0, 2130706432
    ds_write_b128 v96, v[64:67] offset:49152
    ds_write_b128 v97, v[68:71] offset:0
    ds_write_b128 v97, v[72:75] offset:16384
    ds_write_b128 v96, v[32:35] offset:0
    ds_write_b128 v96, v[36:39] offset:16384
    ds_write_b128 v96, v[40:43] offset:32768
    ds_write_b128 v98, v[44:47] offset:0
    v_lshlrev_b32 v76, 16, v48
    v_and_b32 v84, s25, v48
    buffer_load_dwordx4 v[8:11], v94, s[8:11], s24 offen offset:0
    buffer_load_dwordx4 v[24:27], v94, s[8:11], s24 offen offset:64
    v_add_u32 v94, 128, v94
    v_lshlrev_b32 v77, 16, v52
    v_and_b32 v85, s25, v52
    v_lshlrev_b32 v78, 16, v56
    v_and_b32 v86, s25, v56
    v_lshlrev_b32 v79, 16, v60
    v_and_b32 v87, s25, v60
    v_add_f32 v80, v76, v78
    v_add_f32 v88, v84, v86
    v_add_f32 v81, v77, v79
    v_add_f32 v89, v85, v87
    v_fma_f32 v82, v78, 4.0, v76
    v_fma_f32 v90, v86, 4.0, v84
    v_fma_f32 v83, v79, 4.0, v77
    v_fma_f32 v91, v87, 4.0, v85
    v_add_f32 v77, v80, v81
    v_add_f32 v85, v88, v89
    v_sub_f32 v78, v80, v81
    buffer_load_dwordx4 v[12:15], v95, s[8:11], s24 offen offset:0
    buffer_load_dwordx4 v[28:31], v95, s[8:11], s24 offen offset:64
    v_add_u32 v95, 128, v95
    v_sub_f32 v86, v88, v89
    v_fma_f32 v79, v83, 2.0, v82
    v_fma_f32 v87, v91, 2.0, v90
    v_fma_f32 v82, v83, -2.0, v82
    v_fma_f32 v90, v91, -2.0, v90
    v_fmamk_f32 v80, v76, 0x41700000, v82
    v_fmamk_f32 v88, v84, 0x41700000, v90
    v_fmamk_f32 v80, v81, 0x41200000, v80
    v_fmamk_f32 v88, v89, 0x41200000, v88
    v_cvt_pk_bf16_f32 v52, v77, v85
    v_cvt_pk_bf16_f32 v56, v78, v86
    v_cvt_pk_bf16_f32 v64, v79, v87
    v_cvt_pk_bf16_f32 v68, v82, v90
    v_cvt_pk_bf16_f32 v72, v80, v88
    v_lshlrev_b32 v76, 16, v49
    v_and_b32 v84, s25, v49
    v_lshlrev_b32 v77, 16, v53
    v_and_b32 v85, s25, v53
    v_lshlrev_b32 v78, 16, v57
    v_and_b32 v86, s25, v57
    v_lshlrev_b32 v79, 16, v61
    v_and_b32 v87, s25, v61
    v_add_f32 v80, v76, v78
    v_add_f32 v88, v84, v86
    v_add_f32 v81, v77, v79
    v_add_f32 v89, v85, v87
    v_fma_f32 v82, v78, 4.0, v76
    v_fma_f32 v90, v86, 4.0, v84
    v_fma_f32 v83, v79, 4.0, v77
    v_fma_f32 v91, v87, 4.0, v85
    v_add_f32 v77, v80, v81
    v_add_f32 v85, v88, v89
    v_sub_f32 v78, v80, v81
    v_sub_f32 v86, v88, v89
    v_fma_f32 v79, v83, 2.0, v82
    v_fma_f32 v87, v91, 2.0, v90
    v_fma_f32 v82, v83, -2.0, v82
    v_fma_f32 v90, v91, -2.0, v90
    v_fmamk_f32 v80, v76, 0x41700000, v82
    v_fmamk_f32 v88, v84, 0x41700000, v90
    v_fmamk_f32 v80, v81, 0x41200000, v80
    v_fmamk_f32 v88, v89, 0x41200000, v88
    v_cvt_pk_bf16_f32 v53, v77, v85
    v_cvt_pk_bf16_f32 v57, v78, v86
    v_cvt_pk_bf16_f32 v65, v79, v87
    v_cvt_pk_bf16_f32 v69, v82, v90
    v_cvt_pk_bf16_f32 v73, v80, v88
    v_lshlrev_b32 v76, 16, v50
    v_and_b32 v84, s25, v50
    v_lshlrev_b32 v77, 16, v54
    v_and_b32 v85, s25, v54
    v_lshlrev_b32 v78, 16, v58
    v_and_b32 v86, s25, v58
    v_lshlrev_b32 v79, 16, v62
    v_and_b32 v87, s25, v62
    v_add_f32 v80, v76, v78
    v_add_f32 v88, v84, v86
    v_add_f32 v81, v77, v79
    v_add_f32 v89, v85, v87
    v_fma_f32 v82, v78, 4.0, v76
    v_fma_f32 v90, v86, 4.0, v84
    v_fma_f32 v83, v79, 4.0, v77
    v_fma_f32 v91, v87, 4.0, v85
    v_add_f32 v77, v80, v81
    v_add_f32 v85, v88, v89
    v_sub_f32 v78, v80, v81
    v_sub_f32 v86, v88, v89
    v_fma_f32 v79, v83, 2.0, v82
    v_fma_f32 v87, v91, 2.0, v90
    v_fma_f32 v82, v83, -2.0, v82
    v_fma_f32 v90, v91, -2.0, v90
    v_fmamk_f32 v80, v76, 0x41700000, v82
    v_fmamk_f32 v88, v84, 0x41700000, v90
    v_fmamk_f32 v80, v81, 0x41200000, v80
    v_fmamk_f32 v88, v89, 0x41200000, v88
    v_cvt_pk_bf16_f32 v54, v77, v85
    v_cvt_pk_bf16_f32 v58, v78, v86
    v_cvt_pk_bf16_f32 v66, v79, v87
    v_cvt_pk_bf16_f32 v70, v82, v90
    v_cvt_pk_bf16_f32 v74, v80, v88
    v_lshlrev_b32 v76, 16, v51
    v_and_b32 v84, s25, v51
    v_lshlrev_b32 v77, 16, v55
    v_and_b32 v85, s25, v55
    v_lshlrev_b32 v78, 16, v59
    v_and_b32 v86, s25, v59
    v_lshlrev_b32 v79, 16, v63
    v_and_b32 v87, s25, v63
    v_add_f32 v80, v76, v78
    v_add_f32 v88, v84, v86
    v_add_f32 v81, v77, v79
    v_add_f32 v89, v85, v87
    v_fma_f32 v82, v78, 4.0, v76
    v_fma_f32 v90, v86, 4.0, v84
    v_fma_f32 v83, v79, 4.0, v77
    v_fma_f32 v91, v87, 4.0, v85
    v_add_f32 v77, v80, v81
    v_add_f32 v85, v88, v89
    v_sub_f32 v78, v80, v81
    v_sub_f32 v86, v88, v89
    v_fma_f32 v79, v83, 2.0, v82
    v_fma_f32 v87, v91, 2.0, v90
    v_fma_f32 v82, v83, -2.0, v82
    v_fma_f32 v90, v91, -2.0, v90
    v_fmamk_f32 v80, v76, 0x41700000, v82
    v_fmamk_f32 v88, v84, 0x41700000, v90
    v_fmamk_f32 v80, v81, 0x41200000, v80
    v_fmamk_f32 v88, v89, 0x41200000, v88
    v_cvt_pk_bf16_f32 v55, v77, v85
    v_cvt_pk_bf16_f32 v59, v78, v86
    v_cvt_pk_bf16_f32 v67, v79, v87
    v_cvt_pk_bf16_f32 v71, v82, v90
    v_cvt_pk_bf16_f32 v75, v80, v88
    s_add_u32 s28, s28, 1
    s_waitcnt lgkmcnt(0)
    s_barrier
    s_cmp_eq_u32 s22, 1
    s_cbranch_scc1 L_conv1_kernel_hlast2
    s_cmp_lt_u32 s28, 12
    s_cselect_b32 s24, 0, 2130706432
    ds_write_b128 v96, v[64:67] offset:57344
    ds_write_b128 v97, v[68:71] offset:8192
    ds_write_b128 v97, v[72:75] offset:24576
    ds_write_b128 v96, v[48:51] offset:8192
    ds_write_b128 v96, v[52:55] offset:24576
    ds_write_b128 v96, v[56:59] offset:40960
    ds_write_b128 v98, v[60:63] offset:8704
    s_waitcnt vmcnt(0)
    v_lshlrev_b32 v76, 16, v0
    v_and_b32 v84, s25, v0
    v_lshlrev_b32 v77, 16, v4
    v_and_b32 v85, s25, v4
    v_lshlrev_b32 v78, 16, v8
    v_and_b32 v86, s25, v8
    v_lshlrev_b32 v79, 16, v12
    v_and_b32 v87, s25, v12
    v_add_f32 v80, v76, v78
    v_add_f32 v88, v84, v86
    v_add_f32 v81, v77, v79
    v_add_f32 v89, v85, v87
    v_fma_f32 v82, v78, 4.0, v76
    v_fma_f32 v90, v86, 4.0, v84
    v_fma_f32 v83, v79, 4.0, v77
    v_fma_f32 v91, v87, 4.0, v85
    v_add_f32 v77, v80, v81
    v_add_f32 v85, v88, v89
    v_sub_f32 v78, v80, v81
    v_sub_f32 v86, v88, v89
    v_fma_f32 v79, v83, 2.0, v82
    v_fma_f32 v87, v91, 2.0, v90
    v_fma_f32 v82, v83, -2.0, v82
    v_fma_f32 v90, v91, -2.0, v90
    v_fmamk_f32 v80, v76, 0x41700000, v82
    v_fmamk_f32 v88, v84, 0x41700000, v90
    buffer_load_dwordx4 v[32:35], v92, s[8:11], s24 offen offset:0
    buffer_load_dwordx4 v[48:51], v92, s[8:11], s24 offen offset:64
    v_add_u32 v92, 128, v92
    v_fmamk_f32 v80, v81, 0x41200000, v80
    v_fmamk_f32 v88, v89, 0x41200000, v88
    v_cvt_pk_bf16_f32 v4, v77, v85
    v_cvt_pk_bf16_f32 v8, v78, v86
    v_cvt_pk_bf16_f32 v64, v79, v87
    v_cvt_pk_bf16_f32 v68, v82, v90
    v_cvt_pk_bf16_f32 v72, v80, v88
    v_lshlrev_b32 v76, 16, v1
    v_and_b32 v84, s25, v1
    v_lshlrev_b32 v77, 16, v5
    v_and_b32 v85, s25, v5
    v_lshlrev_b32 v78, 16, v9
    v_and_b32 v86, s25, v9
    v_lshlrev_b32 v79, 16, v13
    v_and_b32 v87, s25, v13
    v_add_f32 v80, v76, v78
    v_add_f32 v88, v84, v86
    v_add_f32 v81, v77, v79
    v_add_f32 v89, v85, v87
    v_fma_f32 v82, v78, 4.0, v76
    v_fma_f32 v90, v86, 4.0, v84
    v_fma_f32 v83, v79, 4.0, v77
    v_fma_f32 v91, v87, 4.0, v85
    v_add_f32 v77, v80, v81
    v_add_f32 v85, v88, v89
    v_sub_f32 v78, v80, v81
    v_sub_f32 v86, v88, v89
    v_fma_f32 v79, v83, 2.0, v82
    v_fma_f32 v87, v91, 2.0, v90
    v_fma_f32 v82, v83, -2.0, v82
    v_fma_f32 v90, v91, -2.0, v90
    v_fmamk_f32 v80, v76, 0x41700000, v82
    v_fmamk_f32 v88, v84, 0x41700000, v90
    v_fmamk_f32 v80, v81, 0x41200000, v80
    v_fmamk_f32 v88, v89, 0x41200000, v88
    v_cvt_pk_bf16_f32 v5, v77, v85
    v_cvt_pk_bf16_f32 v9, v78, v86
    v_cvt_pk_bf16_f32 v65, v79, v87
    v_cvt_pk_bf16_f32 v69, v82, v90
    v_cvt_pk_bf16_f32 v73, v80, v88
    v_lshlrev_b32 v76, 16, v2
    v_and_b32 v84, s25, v2
    v_lshlrev_b32 v77, 16, v6
    v_and_b32 v85, s25, v6
    v_lshlrev_b32 v78, 16, v10
    v_and_b32 v86, s25, v10
    v_lshlrev_b32 v79, 16, v14
    v_and_b32 v87, s25, v14
    v_add_f32 v80, v76, v78
    v_add_f32 v88, v84, v86
    v_add_f32 v81, v77, v79
    v_add_f32 v89, v85, v87
    v_fma_f32 v82, v78, 4.0, v76
    buffer_load_dwordx4 v[36:39], v93, s[8:11], s24 offen offset:0
    buffer_load_dwordx4 v[52:55], v93, s[8:11], s24 offen offset:64
    v_add_u32 v93, 128, v93
    v_fma_f32 v90, v86, 4.0, v84
    v_fma_f32 v83, v79, 4.0, v77
    v_fma_f32 v91, v87, 4.0, v85
    v_add_f32 v77, v80, v81
    v_add_f32 v85, v88, v89
    v_sub_f32 v78, v80, v81
    v_sub_f32 v86, v88, v89
    v_fma_f32 v79, v83, 2.0, v82
    v_fma_f32 v87, v91, 2.0, v90
    v_fma_f32 v82, v83, -2.0, v82
    v_fma_f32 v90, v91, -2.0, v90
    v_fmamk_f32 v80, v76, 0x41700000, v82
    v_fmamk_f32 v88, v84, 0x41700000, v90
    v_fmamk_f32 v80, v81, 0x41200000, v80
    v_fmamk_f32 v88, v89, 0x41200000, v88
    v_cvt_pk_bf16_f32 v6, v77, v85
    v_cvt_pk_bf16_f32 v10, v78, v86
    v_cvt_pk_bf16_f32 v66, v79, v87
    v_cvt_pk_bf16_f32 v70, v82, v90
    v_cvt_pk_bf16_f32 v74, v80, v88
    v_lshlrev_b32 v76, 16, v3
    v_and_b32 v84, s25, v3
    v_lshlrev_b32 v77, 16, v7
    v_and_b32 v85, s25, v7
    v_lshlrev_b32 v78, 16, v11
    v_and_b32 v86, s25, v11
    v_lshlrev_b32 v79, 16, v15
    v_and_b32 v87, s25, v15
    v_add_f32 v80, v76, v78
    v_add_f32 v88, v84, v86
    v_add_f32 v81, v77, v79
    v_add_f32 v89, v85, v87
    v_fma_f32 v82, v78, 4.0, v76
    v_fma_f32 v90, v86, 4.0, v84
    v_fma_f32 v83, v79, 4.0, v77
    v_fma_f32 v91, v87, 4.0, v85
    v_add_f32 v77, v80, v81
    v_add_f32 v85, v88, v89
    v_sub_f32 v78, v80, v81
    v_sub_f32 v86, v88, v89
    v_fma_f32 v79, v83, 2.0, v82
    v_fma_f32 v87, v91, 2.0, v90
    v_fma_f32 v82, v83, -2.0, v82
    v_fma_f32 v90, v91, -2.0, v90
    v_fmamk_f32 v80, v76, 0x41700000, v82
    v_fmamk_f32 v88, v84, 0x41700000, v90
    v_fmamk_f32 v80, v81, 0x41200000, v80
    v_fmamk_f32 v88, v89, 0x41200000, v88
    v_cvt_pk_bf16_f32 v7, v77, v85
    v_cvt_pk_bf16_f32 v11, v78, v86
    v_cvt_pk_bf16_f32 v67, v79, v87
    v_cvt_pk_bf16_f32 v71, v82, v90
    v_cvt_pk_bf16_f32 v75, v80, v88
    s_add_u32 s28, s28, 1
    s_waitcnt lgkmcnt(0)
    s_barrier
    s_cmp_lt_u32 s28, 12
    s_cselect_b32 s24, 0, 2130706432
    ds_write_b128 v96, v[64:67] offset:49152
    ds_write_b128 v97, v[68:71] offset:0
    ds_write_b128 v97, v[72:75] offset:16384
    ds_write_b128 v96, v[0:3] offset:0
    ds_write_b128 v96, v[4:7] offset:16384
    ds_write_b128 v96, v[8:11] offset:32768
    ds_write_b128 v98, v[12:15] offset:0
    v_lshlrev_b32 v76, 16, v16
    v_and_b32 v84, s25, v16
    buffer_load_dwordx4 v[40:43], v94, s[8:11], s24 offen offset:0
    buffer_load_dwordx4 v[56:59], v94, s[8:11], s24 offen offset:64
    v_add_u32 v94, 128, v94
    v_lshlrev_b32 v77, 16, v20
    v_and_b32 v85, s25, v20
    v_lshlrev_b32 v78, 16, v24
    v_and_b32 v86, s25, v24
    v_lshlrev_b32 v79, 16, v28
    v_and_b32 v87, s25, v28
    v_add_f32 v80, v76, v78
    v_add_f32 v88, v84, v86
    v_add_f32 v81, v77, v79
    v_add_f32 v89, v85, v87
    v_fma_f32 v82, v78, 4.0, v76
    v_fma_f32 v90, v86, 4.0, v84
    v_fma_f32 v83, v79, 4.0, v77
    v_fma_f32 v91, v87, 4.0, v85
    v_add_f32 v77, v80, v81
    v_add_f32 v85, v88, v89
    v_sub_f32 v78, v80, v81
    buffer_load_dwordx4 v[44:47], v95, s[8:11], s24 offen offset:0
    buffer_load_dwordx4 v[60:63], v95, s[8:11], s24 offen offset:64
    v_add_u32 v95, 128, v95
    v_sub_f32 v86, v88, v89
    v_fma_f32 v79, v83, 2.0, v82
    v_fma_f32 v87, v91, 2.0, v90
    v_fma_f32 v82, v83, -2.0, v82
    v_fma_f32 v90, v91, -2.0, v90
    v_fmamk_f32 v80, v76, 0x41700000, v82
    v_fmamk_f32 v88, v84, 0x41700000, v90
    v_fmamk_f32 v80, v81, 0x41200000, v80
    v_fmamk_f32 v88, v89, 0x41200000, v88
    v_cvt_pk_bf16_f32 v20, v77, v85
    v_cvt_pk_bf16_f32 v24, v78, v86
    v_cvt_pk_bf16_f32 v64, v79, v87
    v_cvt_pk_bf16_f32 v68, v82, v90
    v_cvt_pk_bf16_f32 v72, v80, v88
    v_lshlrev_b32 v76, 16, v17
    v_and_b32 v84, s25, v17
    v_lshlrev_b32 v77, 16, v21
    v_and_b32 v85, s25, v21
    v_lshlrev_b32 v78, 16, v25
    v_and_b32 v86, s25, v25
    v_lshlrev_b32 v79, 16, v29
    v_and_b32 v87, s25, v29
    v_add_f32 v80, v76, v78
    v_add_f32 v88, v84, v86
    v_add_f32 v81, v77, v79
    v_add_f32 v89, v85, v87
    v_fma_f32 v82, v78, 4.0, v76
    v_fma_f32 v90, v86, 4.0, v84
    v_fma_f32 v83, v79, 4.0, v77
    v_fma_f32 v91, v87, 4.0, v85
    v_add_f32 v77, v80, v81
    v_add_f32 v85, v88, v89
    v_sub_f32 v78, v80, v81
    v_sub_f32 v86, v88, v89
    v_fma_f32 v79, v83, 2.0, v82
    v_fma_f32 v87, v91, 2.0, v90
    v_fma_f32 v82, v83, -2.0, v82
    v_fma_f32 v90, v91, -2.0, v90
    v_fmamk_f32 v80, v76, 0x41700000, v82
    v_fmamk_f32 v88, v84, 0x41700000, v90
    v_fmamk_f32 v80, v81, 0x41200000, v80
    v_fmamk_f32 v88, v89, 0x41200000, v88
    v_cvt_pk_bf16_f32 v21, v77, v85
    v_cvt_pk_bf16_f32 v25, v78, v86
    v_cvt_pk_bf16_f32 v65, v79, v87
    v_cvt_pk_bf16_f32 v69, v82, v90
    v_cvt_pk_bf16_f32 v73, v80, v88
    v_lshlrev_b32 v76, 16, v18
    v_and_b32 v84, s25, v18
    v_lshlrev_b32 v77, 16, v22
    v_and_b32 v85, s25, v22
    v_lshlrev_b32 v78, 16, v26
    v_and_b32 v86, s25, v26
    v_lshlrev_b32 v79, 16, v30
    v_and_b32 v87, s25, v30
    v_add_f32 v80, v76, v78
    v_add_f32 v88, v84, v86
    v_add_f32 v81, v77, v79
    v_add_f32 v89, v85, v87
    v_fma_f32 v82, v78, 4.0, v76
    v_fma_f32 v90, v86, 4.0, v84
    v_fma_f32 v83, v79, 4.0, v77
    v_fma_f32 v91, v87, 4.0, v85
    v_add_f32 v77, v80, v81
    v_add_f32 v85, v88, v89
    v_sub_f32 v78, v80, v81
    v_sub_f32 v86, v88, v89
    v_fma_f32 v79, v83, 2.0, v82
    v_fma_f32 v87, v91, 2.0, v90
    v_fma_f32 v82, v83, -2.0, v82
    v_fma_f32 v90, v91, -2.0, v90
    v_fmamk_f32 v80, v76, 0x41700000, v82
    v_fmamk_f32 v88, v84, 0x41700000, v90
    v_fmamk_f32 v80, v81, 0x41200000, v80
    v_fmamk_f32 v88, v89, 0x41200000, v88
    v_cvt_pk_bf16_f32 v22, v77, v85
    v_cvt_pk_bf16_f32 v26, v78, v86
    v_cvt_pk_bf16_f32 v66, v79, v87
    v_cvt_pk_bf16_f32 v70, v82, v90
    v_cvt_pk_bf16_f32 v74, v80, v88
    v_lshlrev_b32 v76, 16, v19
    v_and_b32 v84, s25, v19
    v_lshlrev_b32 v77, 16, v23
    v_and_b32 v85, s25, v23
    v_lshlrev_b32 v78, 16, v27
    v_and_b32 v86, s25, v27
    v_lshlrev_b32 v79, 16, v31
    v_and_b32 v87, s25, v31
    v_add_f32 v80, v76, v78
    v_add_f32 v88, v84, v86
    v_add_f32 v81, v77, v79
    v_add_f32 v89, v85, v87
    v_fma_f32 v82, v78, 4.0, v76
    v_fma_f32 v90, v86, 4.0, v84
    v_fma_f32 v83, v79, 4.0, v77
    v_fma_f32 v91, v87, 4.0, v85
    v_add_f32 v77, v80, v81
    v_add_f32 v85, v88, v89
    v_sub_f32 v78, v80, v81
    v_sub_f32 v86, v88, v89
    v_fma_f32 v79, v83, 2.0, v82
    v_fma_f32 v87, v91, 2.0, v90
    v_fma_f32 v82, v83, -2.0, v82
    v_fma_f32 v90, v91, -2.0, v90
    v_fmamk_f32 v80, v76, 0x41700000, v82
    v_fmamk_f32 v88, v84, 0x41700000, v90
    v_fmamk_f32 v80, v81, 0x41200000, v80
    v_fmamk_f32 v88, v89, 0x41200000, v88
    v_cvt_pk_bf16_f32 v23, v77, v85
    v_cvt_pk_bf16_f32 v27, v78, v86
    v_cvt_pk_bf16_f32 v67, v79, v87
    v_cvt_pk_bf16_f32 v71, v82, v90
    v_cvt_pk_bf16_f32 v75, v80, v88
    s_add_u32 s28, s28, 1
    s_waitcnt lgkmcnt(0)
    s_barrier
    s_sub_u32 s22, s22, 1
    s_branch L_conv1_kernel_hloop2
L_conv1_kernel_hlast2:
    s_waitcnt vmcnt(0)
    s_mov_b32 s58, s20
    s_lshl_b32 s20, s2, 2
    s_add_u32 s20, s20, s32
    v_mov_b32 v1, v127
    s_load_dwordx2 s[8:9], s[0:1], 16
    s_lshr_b32 s22, s20, 8
    s_bfe_u32 s23, s20, 0x40004
    s_bfe_u32 s24, s20, 0x30001
    s_and_b32 s21, s20, 1
    v_lshrrev_b32 v2, 4, v1
    v_lshlrev_b32 v2, 12, v2
    v_and_b32 v3, 15, v1
    v_lshl_add_u32 v2, v3, 2, v2
    s_lshl_b32 s26, s22, 3
    s_lshr_b32 s27, s23, 3
    s_add_u32 s26, s26, s27
    s_lshl_b32 s26, s26, 17
    s_and_b32 s27, s23, 7
    s_lshl_b32 s27, s27, 14
    s_add_u32 s26, s26, s27
    s_lshl_b32 s27, s24, 6
    s_add_u32 s26, s26, s27
    s_mov_b32 s10, 4063232
    s_mov_b32 s11, 0x00020000
    s_add_u32 s37, s26, 262144
    s_add_u32 s38, s26, 524288
    s_add_u32 s39, s26, 786432
    s_waitcnt lgkmcnt(0)
    buffer_load_dword v16, v2, s[8:11], s26 offen offset:0
    buffer_load_dword v17, v2, s[8:11], s26 offen offset:512
    buffer_load_dword v24, v2, s[8:11], s37 offen offset:0
    buffer_load_dword v25, v2, s[8:11], s37 offen offset:512
    buffer_load_dword v32, v2, s[8:11], s38 offen offset:0
    buffer_load_dword v33, v2, s[8:11], s38 offen offset:512
    buffer_load_dword v40, v2, s[8:11], s39 offen offset:0
    buffer_load_dword v41, v2, s[8:11], s39 offen offset:512
    buffer_load_dword v18, v2, s[8:11], s26 offen offset:1024
    buffer_load_dword v19, v2, s[8:11], s26 offen offset:1536
    buffer_load_dword v26, v2, s[8:11], s37 offen offset:1024
    buffer_load_dword v27, v2, s[8:11], s37 offen offset:1536
    buffer_load_dword v34, v2, s[8:11], s38 offen offset:1024
    buffer_load_dword v35, v2, s[8:11], s38 offen offset:1536
    buffer_load_dword v42, v2, s[8:11], s39 offen offset:1024
    buffer_load_dword v43, v2, s[8:11], s39 offen offset:1536
    buffer_load_dword v20, v2, s[8:11], s26 offen offset:2048
    buffer_load_dword v21, v2, s[8:11], s26 offen offset:2560
    buffer_load_dword v28, v2, s[8:11], s37 offen offset:2048
    buffer_load_dword v29, v2, s[8:11], s37 offen offset:2560
    buffer_load_dword v36, v2, s[8:11], s38 offen offset:2048
    buffer_load_dword v37, v2, s[8:11], s38 offen offset:2560
    buffer_load_dword v44, v2, s[8:11], s39 offen offset:2048
    buffer_load_dword v45, v2, s[8:11], s39 offen offset:2560
    buffer_load_dword v22, v2, s[8:11], s26 offen offset:3072
    buffer_load_dword v23, v2, s[8:11], s26 offen offset:3584
    buffer_load_dword v30, v2, s[8:11], s37 offen offset:3072
    buffer_load_dword v31, v2, s[8:11], s37 offen offset:3584
    buffer_load_dword v38, v2, s[8:11], s38 offen offset:3072
    buffer_load_dword v39, v2, s[8:11], s38 offen offset:3584
    buffer_load_dword v46, v2, s[8:11], s39 offen offset:3072
    buffer_load_dword v47, v2, s[8:11], s39 offen offset:3584
    s_add_u32 s12, s30, 9437184
    s_addc_u32 s13, s31, 0
    s_mov_b32 s14, 7340032
    s_mov_b32 s15, 0x00020000
    v_lshlrev_b32 v4, 4, v1
    s_lshl_b32 s27, s24, 4
    s_add_u32 s27, s27, s23
    s_mul_i32 s27, s27, 57344
    s_lshl_b32 s28, s22, 11
    s_add_u32 s27, s27, s28
    s_lshl_b32 s28, s21, 10
    s_add_u32 s27, s27, s28
    s_cmp_eq_u32 s21, 0
    s_mov_b32 s32, 0x07060302
    s_cselect_b32 s32, 0x05040100, s32
    s_mov_b32 s33, 0x03020c0c
    s_cselect_b32 s33, 0x01000c0c, s33
    s_mov_b32 s35, 0x3d2aaaab
    s_mov_b32 s36, 0x3c638e39
    s_mov_b32 s25, 0xffff0000
    ds_write_b128 v96, v[64:67] offset:57344
    ds_write_b128 v97, v[68:71] offset:8192
    ds_write_b128 v97, v[72:75] offset:24576
    ds_write_b128 v96, v[48:51] offset:8192
    ds_write_b128 v96, v[52:55] offset:24576
    ds_write_b128 v96, v[56:59] offset:40960
    ds_write_b128 v98, v[60:63] offset:8704
    s_waitcnt lgkmcnt(0)
    s_barrier
    s_waitcnt vmcnt(24)
    v_perm_b32 v72, v17, v16, s32
    v_perm_b32 v48, v41, v40, s32
    v_perm_b32 v76, v76, v40, s33
    v_perm_b32 v84, v84, v41, s33
    v_perm_b32 v77, v77, v32, s33
    v_perm_b32 v85, v85, v33, s33
    v_perm_b32 v78, v78, v24, s33
    v_perm_b32 v86, v86, v25, s33
    v_perm_b32 v79, v79, v16, s33
    v_perm_b32 v87, v87, v17, s33
    v_add_f32 v80, v76, v78
    v_add_f32 v88, v84, v86
    v_add_f32 v81, v77, v79
    v_add_f32 v89, v85, v87
    v_fma_f32 v82, v78, 4.0, v76
    v_fma_f32 v90, v86, 4.0, v84
    v_fma_f32 v83, v79, 4.0, v77
    v_fma_f32 v91, v87, 4.0, v85
    v_add_f32 v77, v80, v81
    v_add_f32 v85, v88, v89
    v_sub_f32 v78, v80, v81
    v_sub_f32 v86, v88, v89
    v_fma_f32 v79, v83, 2.0, v82
    v_fma_f32 v87, v91, 2.0, v90
    v_fma_f32 v82, v83, -2.0, v82
    v_fma_f32 v90, v91, -2.0, v90
    v_fmamk_f32 v80, v76, 0x41700000, v82
    v_fmamk_f32 v88, v84, 0x41700000, v90
    v_fmamk_f32 v80, v81, 0x41200000, v80
    v_fmamk_f32 v88, v89, 0x41200000, v88
    v_mul_f32 v77, 0.5, v77
    v_mul_f32 v85, 0.5, v85
    v_mul_f32 v78, 0.5, v78
    v_mul_f32 v86, 0.5, v86
    v_mul_f32 v79, s35, v79
    v_mul_f32 v87, s35, v87
    v_mul_f32 v82, s35, v82
    v_mul_f32 v90, s35, v90
    v_mul_f32 v80, s36, v80
    v_mul_f32 v88, s36, v88
    v_cvt_pk_bf16_f32 v52, v77, v85
    v_cvt_pk_bf16_f32 v56, v78, v86
    v_cvt_pk_bf16_f32 v60, v79, v87
    v_cvt_pk_bf16_f32 v64, v82, v90
    v_cvt_pk_bf16_f32 v68, v80, v88
    s_waitcnt vmcnt(16)
    v_perm_b32 v73, v19, v18, s32
    v_perm_b32 v49, v43, v42, s32
    v_perm_b32 v76, v76, v42, s33
    v_perm_b32 v84, v84, v43, s33
    v_perm_b32 v77, v77, v34, s33
    v_perm_b32 v85, v85, v35, s33
    v_perm_b32 v78, v78, v26, s33
    v_perm_b32 v86, v86, v27, s33
    v_perm_b32 v79, v79, v18, s33
    v_perm_b32 v87, v87, v19, s33
    v_add_f32 v80, v76, v78
    v_add_f32 v88, v84, v86
    v_add_f32 v81, v77, v79
    v_add_f32 v89, v85, v87
    v_fma_f32 v82, v78, 4.0, v76
    v_fma_f32 v90, v86, 4.0, v84
    v_fma_f32 v83, v79, 4.0, v77
    v_fma_f32 v91, v87, 4.0, v85
    v_add_f32 v77, v80, v81
    v_add_f32 v85, v88, v89
    v_sub_f32 v78, v80, v81
    v_sub_f32 v86, v88, v89
    v_fma_f32 v79, v83, 2.0, v82
    v_fma_f32 v87, v91, 2.0, v90
    v_fma_f32 v82, v83, -2.0, v82
    v_fma_f32 v90, v91, -2.0, v90
    v_fmamk_f32 v80, v76, 0x41700000, v82
    v_fmamk_f32 v88, v84, 0x41700000, v90
    v_fmamk_f32 v80, v81, 0x41200000, v80
    v_fmamk_f32 v88, v89, 0x41200000, v88
    v_mul_f32 v77, 0.5, v77
    v_mul_f32 v85, 0.5, v85
    v_mul_f32 v78, 0.5, v78
    v_mul_f32 v86, 0.5, v86
    v_mul_f32 v79, s35, v79
    v_mul_f32 v87, s35, v87
    v_mul_f32 v82, s35, v82
    v_mul_f32 v90, s35, v90
    v_mul_f32 v80, s36, v80
    v_mul_f32 v88, s36, v88
    v_cvt_pk_bf16_f32 v53, v77, v85
    v_cvt_pk_bf16_f32 v57, v78, v86
    v_cvt_pk_bf16_f32 v61, v79, v87
    v_cvt_pk_bf16_f32 v65, v82, v90
    v_cvt_pk_bf16_f32 v69, v80, v88
    s_waitcnt vmcnt(8)
    v_perm_b32 v74, v21, v20, s32
    v_perm_b32 v50, v45, v44, s32
    v_perm_b32 v76, v76, v44, s33
    v_perm_b32 v84, v84, v45, s33
    v_perm_b32 v77, v77, v36, s33
    v_perm_b32 v85, v85, v37, s33
    v_perm_b32 v78, v78, v28, s33
    v_perm_b32 v86, v86, v29, s33
    v_perm_b32 v79, v79, v20, s33
    v_perm_b32 v87, v87, v21, s33
    v_add_f32 v80, v76, v78
    v_add_f32 v88, v84, v86
    v_add_f32 v81, v77, v79
    v_add_f32 v89, v85, v87
    v_fma_f32 v82, v78, 4.0, v76
    v_fma_f32 v90, v86, 4.0, v84
    v_fma_f32 v83, v79, 4.0, v77
    v_fma_f32 v91, v87, 4.0, v85
    v_add_f32 v77, v80, v81
    v_add_f32 v85, v88, v89
    v_sub_f32 v78, v80, v81
    v_sub_f32 v86, v88, v89
    v_fma_f32 v79, v83, 2.0, v82
    v_fma_f32 v87, v91, 2.0, v90
    v_fma_f32 v82, v83, -2.0, v82
    v_fma_f32 v90, v91, -2.0, v90
    v_fmamk_f32 v80, v76, 0x41700000, v82
    v_fmamk_f32 v88, v84, 0x41700000, v90
    v_fmamk_f32 v80, v81, 0x41200000, v80
    v_fmamk_f32 v88, v89, 0x41200000, v88
    v_mul_f32 v77, 0.5, v77
    v_mul_f32 v85, 0.5, v85
    v_mul_f32 v78, 0.5, v78
    v_mul_f32 v86, 0.5, v86
    v_mul_f32 v79, s35, v79
    v_mul_f32 v87, s35, v87
    v_mul_f32 v82, s35, v82
    v_mul_f32 v90, s35, v90
    v_mul_f32 v80, s36, v80
    v_mul_f32 v88, s36, v88
    v_cvt_pk_bf16_f32 v54, v77, v85
    v_cvt_pk_bf16_f32 v58, v78, v86
    v_cvt_pk_bf16_f32 v62, v79, v87
    v_cvt_pk_bf16_f32 v66, v82, v90
    v_cvt_pk_bf16_f32 v70, v80, v88
    s_waitcnt vmcnt(0)
    v_perm_b32 v75, v23, v22, s32
    v_perm_b32 v51, v47, v46, s32
    v_perm_b32 v76, v76, v46, s33
    v_perm_b32 v84, v84, v47, s33
    v_perm_b32 v77, v77, v38, s33
    v_perm_b32 v85, v85, v39, s33
    v_perm_b32 v78, v78, v30, s33
    v_perm_b32 v86, v86, v31, s33
    v_perm_b32 v79, v79, v22, s33
    v_perm_b32 v87, v87, v23, s33
    v_add_f32 v80, v76, v78
    v_add_f32 v88, v84, v86
    v_add_f32 v81, v77, v79
    v_add_f32 v89, v85, v87
    v_fma_f32 v82, v78, 4.0, v76
    v_fma_f32 v90, v86, 4.0, v84
    v_fma_f32 v83, v79, 4.0, v77
    v_fma_f32 v91, v87, 4.0, v85
    v_add_f32 v77, v80, v81
    v_add_f32 v85, v88, v89
    v_sub_f32 v78, v80, v81
    v_sub_f32 v86, v88, v89
    v_fma_f32 v79, v83, 2.0, v82
    v_fma_f32 v87, v91, 2.0, v90
    v_fma_f32 v82, v83, -2.0, v82
    v_fma_f32 v90, v91, -2.0, v90
    v_fmamk_f32 v80, v76, 0x41700000, v82
    v_fmamk_f32 v88, v84, 0x41700000, v90
    v_fmamk_f32 v80, v81, 0x41200000, v80
    v_fmamk_f32 v88, v89, 0x41200000, v88
    v_mul_f32 v77, 0.5, v77
    v_mul_f32 v85, 0.5, v85
    v_mul_f32 v78, 0.5, v78
    v_mul_f32 v86, 0.5, v86
    v_mul_f32 v79, s35, v79
    v_mul_f32 v87, s35, v87
    v_mul_f32 v82, s35, v82
    v_mul_f32 v90, s35, v90
    v_mul_f32 v80, s36, v80
    v_mul_f32 v88, s36, v88
    v_cvt_pk_bf16_f32 v55, v77, v85
    v_cvt_pk_bf16_f32 v59, v78, v86
    v_cvt_pk_bf16_f32 v63, v79, v87
    v_cvt_pk_bf16_f32 v67, v82, v90
    v_cvt_pk_bf16_f32 v71, v80, v88
    s_add_u32 s28, s27, 49152
    buffer_store_dwordx4 v[72:75], v4, s[12:15], s28 offen sc1
    s_add_u32 s28, s27, 0
    buffer_store_dwordx4 v[48:51], v4, s[12:15], s28 offen sc1
    s_add_u32 s28, s27, 8192
    buffer_store_dwordx4 v[52:55], v4, s[12:15], s28 offen sc1
    s_add_u32 s28, s27, 16384
    buffer_store_dwordx4 v[56:59], v4, s[12:15], s28 offen sc1
    s_add_u32 s28, s27, 24576
    buffer_store_dwordx4 v[60:63], v4, s[12:15], s28 offen sc1
    s_add_u32 s28, s27, 32768
    buffer_store_dwordx4 v[64:67], v4, s[12:15], s28 offen sc1
    s_add_u32 s28, s27, 40960
    buffer_store_dwordx4 v[68:71], v4, s[12:15], s28 offen sc1
    s_mov_b32 s20, s58
    s_branch L_conv1_kernel_end
L_conv1_kernel_epi:
    v_and_b32 v108, 15, v127
    v_lshrrev_b32 v109, 4, v127
    v_lshrrev_b32 v110, 3, v108
    s_lshl_b32 s36, s20, 1
    v_add_u32 v110, s36, v110
    v_xor_b32 v111, v110, v108
    v_and_b32 v111, 7, v111
    v_lshlrev_b32 v111, 4, v111
    v_lshl_add_u32 v111, v110, 7, v111
    v_lshl_add_u32 v120, v109, 11, v111
    v_add_u32 v121, 65536, v120
    v_add_u32 v125, 131072, v120
    s_lshl_b32 s36, s20, 9
    s_add_u32 s36, s36, 115712
    v_lshl_add_u32 v123, v109, 7, s36
    s_lshl_b32 s36, s20, 4
    v_add_u32 v108, s36, v108
    v_lshlrev_b32 v110, 6, v108
    v_lshl_add_u32 v110, v109, 4, v110
    s_mul_i32 s36, s29, 524288
    s_lshl_b32 s37, s21, 4
    s_add_u32 s36, s36, s37
    v_add_u32 v110, s36, v110
    v_mov_b32 v111, 2130706432
    v_cmp_gt_u32 vcc, 125, v108
    s_mov_b32 s4, 0xbeaaaaab
    s_mov_b32 s5, s4
    s_mov_b32 s6, 0x3e800000
    s_mov_b32 s7, s6
    s_mov_b32 s8, 0xc0a00000
    s_mov_b32 s9, s8
    s_mov_b32 s10, 0xc0638e39
    s_mov_b32 s11, s10
    s_mov_b32 s12, 0xbf638e39
    s_mov_b32 s13, s12
    s_mov_b32 s14, 0xbe638e39
    s_mov_b32 s15, s14
    s_mov_b32 s22, 0xbd638e39
    s_mov_b32 s23, s22
    s_mov_b32 s24, 0x3ff1c71c
    s_mov_b32 s25, s24
    s_mov_b32 s26, 0xbf2aaaab
    s_mov_b32 s27, s26
    s_mov_b32 s32, 0x3ecccccd
    s_mov_b32 s33, s32
    s_mov_b32 s34, 0xbd888889
    s_mov_b32 s35, s34
    s_mov_b32 s38, 0xbe4ccccd
    s_mov_b32 s39, s38
    s_mov_b32 s40, 0xbdd2d3e8
    s_mov_b32 s41, s40
    s_mov_b32 s42, 0x3f800000
    s_mov_b32 s43, s42
    s_waitcnt lgkmcnt(0)
    s_barrier
    v_cndmask_b32 v122, v111, v110, vcc
    ds_read_b128 v[0:3], v120 offset:0
    ds_read_b128 v[4:7], v120 offset:16384
    ds_read_b128 v[8:11], v120 offset:32768
    ds_read_b128 v[12:15], v120 offset:49152
    ds_read_b128 v[16:19], v121 offset:0
    ds_read_b128 v[20:23], v121 offset:16384
    ds_read_b128 v[24:27], v121 offset:32768
    ds_read_b128 v[28:31], v125 offset:15360
    ds_read_b128 v[32:35], v120 offset:8192
    ds_read_b128 v[36:39], v120 offset:24576
    ds_read_b128 v[40:43], v120 offset:40960
    ds_read_b128 v[44:47], v120 offset:57344
    ds_read_b128 v[48:51], v121 offset:56320
    ds_read_b128 v[52:55], v121 offset:64512
    ds_read_b128 v[56:59], v125 offset:7168
    s_waitcnt lgkmcnt(7)
    ds_read_b128 v[60:63], v125 offset:23552
    s_waitcnt lgkmcnt(8)
    v_pk_add_f32 v[88:89], v[24:25], v[28:29]
    v_pk_add_f32 v[90:91], v[26:27], v[30:31]
    v_pk_add_f32 v[24:25], v[4:5], v[8:9]
    v_pk_add_f32 v[26:27], v[6:7], v[10:11]
    v_pk_add_f32 v[4:5], v[4:5], v[8:9] neg_lo:[0,1] neg_hi:[0,1]
    v_pk_add_f32 v[6:7], v[6:7], v[10:11] neg_lo:[0,1] neg_hi:[0,1]
    v_pk_add_f32 v[72:73], v[12:13], v[16:17]
    v_pk_add_f32 v[74:75], v[14:15], v[18:19]
    v_pk_add_f32 v[12:13], v[12:13], v[16:17] neg_lo:[0,1] neg_hi:[0,1]
    v_pk_add_f32 v[14:15], v[14:15], v[18:19] neg_lo:[0,1] neg_hi:[0,1]
    v_pk_fma_f32 v[72:73], v[24:25], s[4:5], v[72:73]
    v_pk_fma_f32 v[74:75], v[26:27], s[4:5], v[74:75]
    v_pk_fma_f32 v[20:21], v[0:1], s[10:11], v[20:21]
    v_pk_fma_f32 v[22:23], v[2:3], s[10:11], v[22:23]
    v_pk_fma_f32 v[72:73], v[0:1], s[6:7], v[72:73]
    v_pk_fma_f32 v[74:75], v[2:3], s[6:7], v[74:75]
    v_pk_add_f32 v[24:25], v[24:25], v[0:1] neg_lo:[0,1] neg_hi:[0,1]
    v_pk_add_f32 v[26:27], v[26:27], v[2:3] neg_lo:[0,1] neg_hi:[0,1]
    v_pk_fma_f32 v[72:73], v[88:89], s[8:9], v[72:73]
    v_pk_fma_f32 v[74:75], v[90:91], s[8:9], v[74:75]
    v_pk_add_f32 v[24:25], v[24:25], v[88:89] neg_lo:[0,1] neg_hi:[0,1]
    v_pk_add_f32 v[26:27], v[26:27], v[90:91] neg_lo:[0,1] neg_hi:[0,1]
    v_pk_fma_f32 v[20:21], v[88:89], s[22:23], v[20:21]
    v_pk_fma_f32 v[22:23], v[90:91], s[22:23], v[22:23]
    v_pk_add_f32 v[8:9], v[24:25], v[72:73] neg_lo:[0,1] neg_hi:[0,1]
    v_pk_add_f32 v[10:11], v[26:27], v[74:75] neg_lo:[0,1] neg_hi:[0,1]
    v_pk_fma_f32 v[20:21], v[72:73], s[14:15], v[20:21]
    v_pk_fma_f32 v[22:23], v[74:75], s[14:15], v[22:23]
    v_pk_mul_f32 v[80:81], v[12:13], s[32:33]
    v_pk_mul_f32 v[82:83], v[14:15], s[32:33]
    v_pk_fma_f32 v[20:21], v[8:9], s[12:13], v[20:21]
    v_pk_fma_f32 v[22:23], v[10:11], s[12:13], v[22:23]
    v_pk_fma_f32 v[80:81], v[4:5], s[34:35], v[80:81]
    v_pk_fma_f32 v[82:83], v[6:7], s[34:35], v[82:83]
    v_pk_fma_f32 v[64:65], v[4:5], s[24:25], v[20:21] neg_lo:[0,0,1] neg_hi:[0,0,1]
    v_pk_fma_f32 v[66:67], v[6:7], s[24:25], v[22:23] neg_lo:[0,0,1] neg_hi:[0,0,1]
    v_pk_fma_f32 v[64:65], v[12:13], s[26:27], v[64:65]
    v_pk_fma_f32 v[66:67], v[14:15], s[26:27], v[66:67]
    v_pk_fma_f32 v[80:81], v[64:65], s[38:39], v[80:81]
    v_pk_fma_f32 v[82:83], v[66:67], s[38:39], v[82:83]
    v_pk_add_f32 v[4:5], v[4:5], v[64:65] neg_lo:[0,1] neg_hi:[0,1]
    v_pk_add_f32 v[6:7], v[6:7], v[66:67] neg_lo:[0,1] neg_hi:[0,1]
    v_pk_add_f32 v[4:5], v[4:5], v[80:81] neg_lo:[0,1] neg_hi:[0,1]
    v_pk_add_f32 v[6:7], v[6:7], v[82:83] neg_lo:[0,1] neg_hi:[0,1]
    s_waitcnt lgkmcnt(0)
    v_pk_add_f32 v[92:93], v[56:57], v[60:61]
    v_pk_add_f32 v[94:95], v[58:59], v[62:63]
    v_pk_add_f32 v[56:57], v[36:37], v[40:41]
    v_pk_add_f32 v[58:59], v[38:39], v[42:43]
    v_pk_add_f32 v[36:37], v[36:37], v[40:41] neg_lo:[0,1] neg_hi:[0,1]
    v_pk_add_f32 v[38:39], v[38:39], v[42:43] neg_lo:[0,1] neg_hi:[0,1]
    v_pk_add_f32 v[76:77], v[44:45], v[48:49]
    v_pk_add_f32 v[78:79], v[46:47], v[50:51]
    v_pk_add_f32 v[44:45], v[44:45], v[48:49] neg_lo:[0,1] neg_hi:[0,1]
    v_pk_add_f32 v[46:47], v[46:47], v[50:51] neg_lo:[0,1] neg_hi:[0,1]
    v_pk_fma_f32 v[76:77], v[56:57], s[4:5], v[76:77]
    v_pk_fma_f32 v[78:79], v[58:59], s[4:5], v[78:79]
    v_pk_fma_f32 v[52:53], v[32:33], s[10:11], v[52:53]
    v_pk_fma_f32 v[54:55], v[34:35], s[10:11], v[54:55]
    v_pk_fma_f32 v[76:77], v[32:33], s[6:7], v[76:77]
    v_pk_fma_f32 v[78:79], v[34:35], s[6:7], v[78:79]
    v_pk_add_f32 v[56:57], v[56:57], v[32:33] neg_lo:[0,1] neg_hi:[0,1]
    v_pk_add_f32 v[58:59], v[58:59], v[34:35] neg_lo:[0,1] neg_hi:[0,1]
    v_pk_fma_f32 v[76:77], v[92:93], s[8:9], v[76:77]
    v_pk_fma_f32 v[78:79], v[94:95], s[8:9], v[78:79]
    v_pk_add_f32 v[56:57], v[56:57], v[92:93] neg_lo:[0,1] neg_hi:[0,1]
    v_pk_add_f32 v[58:59], v[58:59], v[94:95] neg_lo:[0,1] neg_hi:[0,1]
    v_pk_fma_f32 v[52:53], v[92:93], s[22:23], v[52:53]
    v_pk_fma_f32 v[54:55], v[94:95], s[22:23], v[54:55]
    v_pk_add_f32 v[40:41], v[56:57], v[76:77] neg_lo:[0,1] neg_hi:[0,1]
    v_pk_add_f32 v[42:43], v[58:59], v[78:79] neg_lo:[0,1] neg_hi:[0,1]
    v_pk_fma_f32 v[52:53], v[76:77], s[14:15], v[52:53]
    v_pk_fma_f32 v[54:55], v[78:79], s[14:15], v[54:55]
    v_pk_mul_f32 v[84:85], v[44:45], s[32:33]
    v_pk_mul_f32 v[86:87], v[46:47], s[32:33]
    v_pk_fma_f32 v[52:53], v[40:41], s[12:13], v[52:53]
    v_pk_fma_f32 v[54:55], v[42:43], s[12:13], v[54:55]
    v_pk_fma_f32 v[84:85], v[36:37], s[34:35], v[84:85]
    v_pk_fma_f32 v[86:87], v[38:39], s[34:35], v[86:87]
    v_pk_fma_f32 v[68:69], v[36:37], s[24:25], v[52:53] neg_lo:[0,0,1] neg_hi:[0,0,1]
    v_pk_fma_f32 v[70:71], v[38:39], s[24:25], v[54:55] neg_lo:[0,0,1] neg_hi:[0,0,1]
    v_pk_fma_f32 v[68:69], v[44:45], s[26:27], v[68:69]
    v_pk_fma_f32 v[70:71], v[46:47], s[26:27], v[70:71]
    v_pk_fma_f32 v[84:85], v[68:69], s[38:39], v[84:85]
    v_pk_fma_f32 v[86:87], v[70:71], s[38:39], v[86:87]
    v_pk_add_f32 v[36:37], v[36:37], v[68:69] neg_lo:[0,1] neg_hi:[0,1]
    v_pk_add_f32 v[38:39], v[38:39], v[70:71] neg_lo:[0,1] neg_hi:[0,1]
    v_pk_add_f32 v[36:37], v[36:37], v[84:85] neg_lo:[0,1] neg_hi:[0,1]
    v_pk_add_f32 v[38:39], v[38:39], v[86:87] neg_lo:[0,1] neg_hi:[0,1]
    s_mov_b32 s36, 0x00010001
    s_mov_b32 s37, 0x00010001
    s_mov_b64 exec, s[36:37]
    ds_write_b128 v123, v[0:3] offset:0
    ds_write_b128 v123, v[32:35] offset:16
    ds_write_b128 v123, v[4:7] offset:32
    ds_write_b128 v123, v[36:39] offset:48
    ds_write_b128 v123, v[8:11] offset:64
    ds_write_b128 v123, v[40:43] offset:80
    s_mov_b64 exec, -1
    v_mov_b32 v44, 0xc0135761
    v_mov_b32 v45, v44
    v_pk_mul_f32 v[16:17], v[64:65], v[64:65]
    v_pk_mul_f32 v[18:19], v[66:67], v[66:67]
    v_pk_mul_f32 v[20:21], v[68:69], v[68:69]
    v_pk_mul_f32 v[22:23], v[70:71], v[70:71]
    v_pk_fma_f32 v[16:17], v[16:17], s[40:41], v[44:45]
    v_pk_fma_f32 v[18:19], v[18:19], s[40:41], v[44:45]
    v_pk_fma_f32 v[20:21], v[20:21], s[40:41], v[44:45]
    v_pk_fma_f32 v[22:23], v[22:23], s[40:41], v[44:45]
    v_pk_mul_f32 v[16:17], v[16:17], v[64:65]
    v_pk_mul_f32 v[18:19], v[18:19], v[66:67]
    v_pk_mul_f32 v[20:21], v[20:21], v[68:69]
    v_pk_mul_f32 v[22:23], v[22:23], v[70:71]
    v_exp_f32 v16, v16
    v_exp_f32 v17, v17
    v_exp_f32 v18, v18
    v_exp_f32 v19, v19
    v_exp_f32 v20, v20
    v_exp_f32 v21, v21
    v_exp_f32 v22, v22
    v_exp_f32 v23, v23
    v_pk_add_f32 v[16:17], v[16:17], s[42:43]
    v_pk_add_f32 v[18:19], v[18:19], s[42:43]
    v_pk_add_f32 v[20:21], v[20:21], s[42:43]
    v_pk_add_f32 v[22:23], v[22:23], s[42:43]
    v_rcp_f32 v16, v16
    v_rcp_f32 v17, v17
    v_rcp_f32 v18, v18
    v_rcp_f32 v19, v19
    v_rcp_f32 v20, v20
    v_rcp_f32 v21, v21
    v_rcp_f32 v22, v22
    v_rcp_f32 v23, v23
    v_pk_mul_f32 v[64:65], v[64:65], v[16:17]
    v_pk_mul_f32 v[66:67], v[66:67], v[18:19]
    v_pk_mul_f32 v[68:69], v[68:69], v[20:21]
    v_pk_mul_f32 v[70:71], v[70:71], v[22:23]
    v_cvt_pk_bf16_f32 v48, v64, v68
    v_cvt_pk_bf16_f32 v49, v65, v69
    v_cvt_pk_bf16_f32 v50, v66, v70
    v_cvt_pk_bf16_f32 v51, v67, v71
    s_mov_b32 s44, 393280
    buffer_store_dwordx4 v[48:51], v122, s[16:19], s44 offen sc1
    s_waitcnt lgkmcnt(0)
    s_barrier
    ds_read_b128 v[96:99], v123 offset:512
    ds_read_b128 v[100:103], v123 offset:528
    ds_read_b128 v[104:107], v123 offset:544
    ds_read_b128 v[108:111], v123 offset:560
    ds_read_b128 v[112:115], v123 offset:576
    ds_read_b128 v[116:119], v123 offset:592
    s_waitcnt lgkmcnt(4)
    v_mov_b32_dpp v96, v0 row_shl:1 row_mask:0xf bank_mask:0xf
    v_mov_b32_dpp v97, v1 row_shl:1 row_mask:0xf bank_mask:0xf
    v_mov_b32_dpp v98, v2 row_shl:1 row_mask:0xf bank_mask:0xf
    v_mov_b32_dpp v99, v3 row_shl:1 row_mask:0xf bank_mask:0xf
    v_mov_b32_dpp v100, v32 row_shl:1 row_mask:0xf bank_mask:0xf
    v_mov_b32_dpp v101, v33 row_shl:1 row_mask:0xf bank_mask:0xf
    v_mov_b32_dpp v102, v34 row_shl:1 row_mask:0xf bank_mask:0xf
    v_mov_b32_dpp v103, v35 row_shl:1 row_mask:0xf bank_mask:0xf
    v_pk_add_f32 v[72:73], v[72:73], v[96:97]
    v_pk_add_f32 v[74:75], v[74:75], v[98:99]
    v_pk_add_f32 v[76:77], v[76:77], v[100:101]
    v_pk_add_f32 v[78:79], v[78:79], v[102:103]
    v_pk_mul_f32 v[24:25], v[72:73], v[72:73]
    v_pk_mul_f32 v[26:27], v[74:75], v[74:75]
    v_pk_mul_f32 v[28:29], v[76:77], v[76:77]
    v_pk_mul_f32 v[30:31], v[78:79], v[78:79]
    v_pk_fma_f32 v[24:25], v[24:25], s[40:41], v[44:45]
    v_pk_fma_f32 v[26:27], v[26:27], s[40:41], v[44:45]
    v_pk_fma_f32 v[28:29], v[28:29], s[40:41], v[44:45]
    v_pk_fma_f32 v[30:31], v[30:31], s[40:41], v[44:45]
    v_pk_mul_f32 v[24:25], v[24:25], v[72:73]
    v_pk_mul_f32 v[26:27], v[26:27], v[74:75]
    v_pk_mul_f32 v[28:29], v[28:29], v[76:77]
    v_pk_mul_f32 v[30:31], v[30:31], v[78:79]
    v_exp_f32 v24, v24
    v_exp_f32 v25, v25
    v_exp_f32 v26, v26
    v_exp_f32 v27, v27
    v_exp_f32 v28, v28
    v_exp_f32 v29, v29
    v_exp_f32 v30, v30
    v_exp_f32 v31, v31
    v_pk_add_f32 v[24:25], v[24:25], s[42:43]
    v_pk_add_f32 v[26:27], v[26:27], s[42:43]
    v_pk_add_f32 v[28:29], v[28:29], s[42:43]
    v_pk_add_f32 v[30:31], v[30:31], s[42:43]
    v_rcp_f32 v24, v24
    v_rcp_f32 v25, v25
    v_rcp_f32 v26, v26
    v_rcp_f32 v27, v27
    v_rcp_f32 v28, v28
    v_rcp_f32 v29, v29
    v_rcp_f32 v30, v30
    v_rcp_f32 v31, v31
    v_pk_mul_f32 v[72:73], v[72:73], v[24:25]
    v_pk_mul_f32 v[74:75], v[74:75], v[26:27]
    v_pk_mul_f32 v[76:77], v[76:77], v[28:29]
    v_pk_mul_f32 v[78:79], v[78:79], v[30:31]
    v_cvt_pk_bf16_f32 v52, v72, v76
    v_cvt_pk_bf16_f32 v53, v73, v77
    v_cvt_pk_bf16_f32 v54, v74, v78
    v_cvt_pk_bf16_f32 v55, v75, v79
    s_mov_b32 s44, 128
    buffer_store_dwordx4 v[52:55], v122, s[16:19], s44 offen sc1
    s_waitcnt lgkmcnt(2)
    v_mov_b32_dpp v104, v4 row_shl:1 row_mask:0xf bank_mask:0xf
    v_mov_b32_dpp v105, v5 row_shl:1 row_mask:0xf bank_mask:0xf
    v_mov_b32_dpp v106, v6 row_shl:1 row_mask:0xf bank_mask:0xf
    v_mov_b32_dpp v107, v7 row_shl:1 row_mask:0xf bank_mask:0xf
    v_mov_b32_dpp v108, v36 row_shl:1 row_mask:0xf bank_mask:0xf
    v_mov_b32_dpp v109, v37 row_shl:1 row_mask:0xf bank_mask:0xf
    v_mov_b32_dpp v110, v38 row_shl:1 row_mask:0xf bank_mask:0xf
    v_mov_b32_dpp v111, v39 row_shl:1 row_mask:0xf bank_mask:0xf
    v_pk_add_f32 v[80:81], v[80:81], v[104:105]
    v_pk_add_f32 v[82:83], v[82:83], v[106:107]
    v_pk_add_f32 v[84:85], v[84:85], v[108:109]
    v_pk_add_f32 v[86:87], v[86:87], v[110:111]
    v_pk_mul_f32 v[16:17], v[80:81], v[80:81]
    v_pk_mul_f32 v[18:19], v[82:83], v[82:83]
    v_pk_mul_f32 v[20:21], v[84:85], v[84:85]
    v_pk_mul_f32 v[22:23], v[86:87], v[86:87]
    v_pk_fma_f32 v[16:17], v[16:17], s[40:41], v[44:45]
    v_pk_fma_f32 v[18:19], v[18:19], s[40:41], v[44:45]
    v_pk_fma_f32 v[20:21], v[20:21], s[40:41], v[44:45]
    v_pk_fma_f32 v[22:23], v[22:23], s[40:41], v[44:45]
    v_pk_mul_f32 v[16:17], v[16:17], v[80:81]
    v_pk_mul_f32 v[18:19], v[18:19], v[82:83]
    v_pk_mul_f32 v[20:21], v[20:21], v[84:85]
    v_pk_mul_f32 v[22:23], v[22:23], v[86:87]
    v_exp_f32 v16, v16
    v_exp_f32 v17, v17
    v_exp_f32 v18, v18
    v_exp_f32 v19, v19
    v_exp_f32 v20, v20
    v_exp_f32 v21, v21
    v_exp_f32 v22, v22
    v_exp_f32 v23, v23
    v_pk_add_f32 v[16:17], v[16:17], s[42:43]
    v_pk_add_f32 v[18:19], v[18:19], s[42:43]
    v_pk_add_f32 v[20:21], v[20:21], s[42:43]
    v_pk_add_f32 v[22:23], v[22:23], s[42:43]
    v_rcp_f32 v16, v16
    v_rcp_f32 v17, v17
    v_rcp_f32 v18, v18
    v_rcp_f32 v19, v19
    v_rcp_f32 v20, v20
    v_rcp_f32 v21, v21
    v_rcp_f32 v22, v22
    v_rcp_f32 v23, v23
    v_pk_mul_f32 v[80:81], v[80:81], v[16:17]
    v_pk_mul_f32 v[82:83], v[82:83], v[18:19]
    v_pk_mul_f32 v[84:85], v[84:85], v[20:21]
    v_pk_mul_f32 v[86:87], v[86:87], v[22:23]
    v_cvt_pk_bf16_f32 v56, v80, v84
    v_cvt_pk_bf16_f32 v57, v81, v85
    v_cvt_pk_bf16_f32 v58, v82, v86
    v_cvt_pk_bf16_f32 v59, v83, v87
    s_mov_b32 s44, 131200
    buffer_store_dwordx4 v[56:59], v122, s[16:19], s44 offen sc1
    s_waitcnt lgkmcnt(0)
    v_mov_b32_dpp v112, v8 row_shl:1 row_mask:0xf bank_mask:0xf
    v_mov_b32_dpp v113, v9 row_shl:1 row_mask:0xf bank_mask:0xf
    v_mov_b32_dpp v114, v10 row_shl:1 row_mask:0xf bank_mask:0xf
    v_mov_b32_dpp v115, v11 row_shl:1 row_mask:0xf bank_mask:0xf
    v_mov_b32_dpp v116, v40 row_shl:1 row_mask:0xf bank_mask:0xf
    v_mov_b32_dpp v117, v41 row_shl:1 row_mask:0xf bank_mask:0xf
    v_mov_b32_dpp v118, v42 row_shl:1 row_mask:0xf bank_mask:0xf
    v_mov_b32_dpp v119, v43 row_shl:1 row_mask:0xf bank_mask:0xf
    v_pk_add_f32 v[88:89], v[88:89], v[112:113]
    v_pk_add_f32 v[90:91], v[90:91], v[114:115]
    v_pk_add_f32 v[92:93], v[92:93], v[116:117]
    v_pk_add_f32 v[94:95], v[94:95], v[118:119]
    v_pk_mul_f32 v[24:25], v[88:89], v[88:89]
    v_pk_mul_f32 v[26:27], v[90:91], v[90:91]
    v_pk_mul_f32 v[28:29], v[92:93], v[92:93]
    v_pk_mul_f32 v[30:31], v[94:95], v[94:95]
    v_pk_fma_f32 v[24:25], v[24:25], s[40:41], v[44:45]
    v_pk_fma_f32 v[26:27], v[26:27], s[40:41], v[44:45]
    v_pk_fma_f32 v[28:29], v[28:29], s[40:41], v[44:45]
    v_pk_fma_f32 v[30:31], v[30:31], s[40:41], v[44:45]
    v_pk_mul_f32 v[24:25], v[24:25], v[88:89]
    v_pk_mul_f32 v[26:27], v[26:27], v[90:91]
    v_pk_mul_f32 v[28:29], v[28:29], v[92:93]
    v_pk_mul_f32 v[30:31], v[30:31], v[94:95]
    v_exp_f32 v24, v24
    v_exp_f32 v25, v25
    v_exp_f32 v26, v26
    v_exp_f32 v27, v27
    v_exp_f32 v28, v28
    v_exp_f32 v29, v29
    v_exp_f32 v30, v30
    v_exp_f32 v31, v31
    v_pk_add_f32 v[24:25], v[24:25], s[42:43]
    v_pk_add_f32 v[26:27], v[26:27], s[42:43]
    v_pk_add_f32 v[28:29], v[28:29], s[42:43]
    v_pk_add_f32 v[30:31], v[30:31], s[42:43]
    v_rcp_f32 v24, v24
    v_rcp_f32 v25, v25
    v_rcp_f32 v26, v26
    v_rcp_f32 v27, v27
    v_rcp_f32 v28, v28
    v_rcp_f32 v29, v29
    v_rcp_f32 v30, v30
    v_rcp_f32 v31, v31
    v_pk_mul_f32 v[88:89], v[88:89], v[24:25]
    v_pk_mul_f32 v[90:91], v[90:91], v[26:27]
    v_pk_mul_f32 v[92:93], v[92:93], v[28:29]
    v_pk_mul_f32 v[94:95], v[94:95], v[30:31]
    v_cvt_pk_bf16_f32 v60, v88, v92
    v_cvt_pk_bf16_f32 v61, v89, v93
    v_cvt_pk_bf16_f32 v62, v90, v94
    v_cvt_pk_bf16_f32 v63, v91, v95
    s_mov_b32 s44, 262272
    buffer_store_dwordx4 v[60:63], v122, s[16:19], s44 offen sc1
L_conv1_kernel_end:
L_conv1_kernel_done:
    s_endpgm
.globl conv2_kernel
.p2align 8
.type conv2_kernel,@function
conv2_kernel:
    s_cmp_ge_u32 s2, 256
    s_cbranch_scc1 L_conv2_kernel_done
    s_load_dwordx2 s[4:5], s[0:1], 72
    s_load_dwordx2 s[30:31], s[0:1], 72
    v_readfirstlane_b32 s20, v0
    s_lshr_b32 s20, s20, 6
    s_and_b32 s36, s2, 0
    s_lshl_b32 s36, s36, 3
    s_bfe_u32 s37, s2, 196611
    s_or_b32 s29, s36, s37
    s_bfe_u32 s36, s2, 196608
    s_lshl_b32 s36, s36, 2
    s_lshr_b32 s37, s2, 6
    s_or_b32 s36, s36, s37
    s_lshr_b32 s33, s36, 4
    s_and_b32 s34, s36, 7
    s_bfe_u32 s35, s36, 0x10003
    s_mul_i32 s21, s34, 500
    s_and_b32 s32, s20, 3
    v_and_b32 v127, 63, v0
    v_lshrrev_b32 v5, 2, v127
    v_and_b32 v6, 3, v127
    s_and_b32 s42, s20, 7
    s_lshr_b32 s41, s21, 2
    s_sub_u32 s41, s41, 1
    s_add_u32 s37, s41, s42
    v_lshl_add_u32 v7, v5, 3, s37
    s_mul_i32 s36, s35, 4194304
    s_add_u32 s36, s36, 18874368
    s_mov_b32 s10, 4194304
    s_mov_b32 s11, 0x00020000
    s_mov_b32 s25, 0xffff0000
    s_waitcnt lgkmcnt(0)
    s_add_u32 s8, s4, s36
    s_addc_u32 s9, s5, 0
    s_cmp_ge_u32 s20, 8
    s_cbranch_scc1 L_conv2_kernel_helper
    s_add_u32 s37, s41, 128
    v_mov_b32 v16, s37
    v_mul_u32_u24 v17, 524288, v5
    v_lshl_add_u32 v17, v6, 4, v17
    s_add_u32 s37, s33, 4294967289
    v_lshl_add_u32 v18, v16, 3, s37
    v_cmp_gt_u32 vcc, 8000, v18
    s_mul_i32 s37, s33, 131072
    s_add_u32 s37, s37, 0
    v_lshl_add_u32 v108, v16, 7, s37
    v_add_u32 v108, v108, v17
    v_mov_b32 v18, 2130706432
    v_cndmask_b32 v108, v18, v108, vcc
    s_add_u32 s37, s33, 4294967291
    v_lshl_add_u32 v18, v16, 3, s37
    v_cmp_gt_u32 vcc, 8000, v18
    s_mul_i32 s37, s33, 131072
    s_add_u32 s37, s37, 262144
    v_lshl_add_u32 v109, v16, 7, s37
    v_add_u32 v109, v109, v17
    v_mov_b32 v18, 2130706432
    v_cndmask_b32 v109, v18, v109, vcc
    s_add_u32 s37, s33, 4294967293
    v_lshl_add_u32 v18, v16, 3, s37
    v_cmp_gt_u32 vcc, 8000, v18
    s_mul_i32 s37, s33, 131072
    s_add_u32 s37, s37, 64
    v_lshl_add_u32 v110, v16, 7, s37
    v_add_u32 v110, v110, v17
    v_mov_b32 v18, 2130706432
    v_cndmask_b32 v110, v18, v110, vcc
    s_lshl_b32 s36, s29, 4
    s_lshl_b32 s37, s33, 3
    s_add_u32 s36, s36, s37
    s_mul_i32 s36, s36, 57344
    s_add_u32 s36, s36, 9437184
    s_add_u32 s12, s30, s36
    s_addc_u32 s13, s31, 0
    s_mov_b32 s14, 458752
    s_mov_b32 s15, 0x00020000
    s_mul_i32 s36, s35, 2097152
    s_add_u32 s36, s36, 27262976
    s_mul_i32 s37, s33, 8388608
    s_add_u32 s36, s36, s37
    s_add_u32 s16, s30, s36
    s_addc_u32 s17, s31, 0
    s_mov_b32 s18, 2097152
    s_mov_b32 s19, 0x00020000
    v_and_b32 v10, 15, v127
    v_lshrrev_b32 v11, 4, v127
    v_add_u32 v8, 0, v10
    v_and_b32 v16, 4, v8
    v_lshrrev_b32 v16, 1, v16
    v_xor_b32 v16, v11, v16
    v_lshlrev_b32 v16, 4, v16
    v_lshl_add_u32 v8, v8, 6, v16
    v_add_u32 v9, 1, v10
    v_and_b32 v16, 4, v9
    v_lshrrev_b32 v16, 1, v16
    v_xor_b32 v16, v11, v16
    v_lshlrev_b32 v16, 4, v16
    v_lshl_add_u32 v9, v9, 6, v16
    s_lshr_b32 s38, s32, 1
    s_and_b32 s39, s32, 1
    s_add_u32 s40, s38, 4
    s_lshl_b32 s43, s39, 10
    s_cmp_lt_u32 s20, 4
    s_cselect_b32 s40, s20, s40
    s_cselect_b32 s36, 0, s43
    s_lshl_b32 s37, s40, 13
    s_add_u32 s37, s37, s36
    v_lshl_add_u32 v125, v127, 4, s37
    s_mul_i32 s37, s40, 16384
    v_add_u32 v120, s37, v8
    v_add_u32 v121, s37, v9
    s_lshl_b32 s37, s40, 10
    s_add_u32 s37, s37, 115712
    v_lshl_add_u32 v16, v11, 4, s37
    v_cmp_eq_u32 vcc, 15, v10
    v_mov_b32 v17, 8192
    v_mov_b32 v18, 4294959104
    v_mov_b32 v19, 64
    v_cndmask_b32 v122, v121, v16, vcc
    v_cndmask_b32 v123, v17, v19, vcc
    v_cndmask_b32 v124, v18, v19, vcc
    v_lshl_add_u32 v126, v127, 4, s37
    s_mov_b32 s44, 0x3f800000
    s_mov_b32 s45, 0x00000000
    s_mov_b32 s46, 0x00000000
    s_cmp_eq_u32 s40, 1
    s_cselect_b32 s45, 0x3f800000, s45
    s_cselect_b32 s46, 0x3f800000, s46
    s_cmp_eq_u32 s40, 2
    s_cselect_b32 s45, 0xbf800000, s45
    s_cselect_b32 s46, 0x3f800000, s46
    s_cmp_eq_u32 s40, 3
    s_cselect_b32 s45, 0x40000000, s45
    s_cselect_b32 s46, 0x40800000, s46
    s_cmp_eq_u32 s40, 4
    s_cselect_b32 s45, 0xc0000000, s45
    s_cselect_b32 s46, 0x40800000, s46
    s_cmp_eq_u32 s40, 5
    s_cselect_b32 s44, 0x41800000, s44
    s_cselect_b32 s45, 0x41000000, s45
    s_cselect_b32 s46, 0x40800000, s46
    s_cmp_ge_u32 s20, 4
    s_cbranch_scc1 L_conv2_kernel_m2
    v_mov_b32 v0, 0
    v_mov_b32 v1, 0
    v_mov_b32 v2, 0
    v_mov_b32 v3, 0
    v_mov_b32 v4, 0
    v_mov_b32 v5, 0
    v_mov_b32 v6, 0
    v_mov_b32 v7, 0
    v_mov_b32 v8, 0
    v_mov_b32 v9, 0
    v_mov_b32 v10, 0
    v_mov_b32 v11, 0
    v_mov_b32 v12, 0
    v_mov_b32 v13, 0
    v_mov_b32 v14, 0
    v_mov_b32 v15, 0
    v_mov_b32 v16, 0
    v_mov_b32 v17, 0
    v_mov_b32 v18, 0
    v_mov_b32 v19, 0
    v_mov_b32 v20, 0
    v_mov_b32 v21, 0
    v_mov_b32 v22, 0
    v_mov_b32 v23, 0
    v_mov_b32 v24, 0
    v_mov_b32 v25, 0
    v_mov_b32 v26, 0
    v_mov_b32 v27, 0
    v_mov_b32 v28, 0
    v_mov_b32 v29, 0
    v_mov_b32 v30, 0
    v_mov_b32 v31, 0
    v_mov_b32 v32, 0
    v_mov_b32 v33, 0
    v_mov_b32 v34, 0
    v_mov_b32 v35, 0
    v_mov_b32 v36, 0
    v_mov_b32 v37, 0
    v_mov_b32 v38, 0
    v_mov_b32 v39, 0
    v_mov_b32 v40, 0
    v_mov_b32 v41, 0
    v_mov_b32 v42, 0
    v_mov_b32 v43, 0
    v_mov_b32 v44, 0
    v_mov_b32 v45, 0
    v_mov_b32 v46, 0
    v_mov_b32 v47, 0
    v_mov_b32 v48, 0
    v_mov_b32 v49, 0
    v_mov_b32 v50, 0
    v_mov_b32 v51, 0
    v_mov_b32 v52, 0
    v_mov_b32 v53, 0
    v_mov_b32 v54, 0
    v_mov_b32 v55, 0
    v_mov_b32 v56, 0
    v_mov_b32 v57, 0
    v_mov_b32 v58, 0
    v_mov_b32 v59, 0
    v_mov_b32 v60, 0
    v_mov_b32 v61, 0
    v_mov_b32 v62, 0
    v_mov_b32 v63, 0
    s_barrier
    buffer_load_dwordx4 v[96:99], v108, s[8:11], 0 offen
    buffer_load_dwordx4 v[100:103], v109, s[8:11], 0 offen
    buffer_load_dwordx4 v[104:107], v110, s[8:11], 0 offen
    s_mov_b32 s23, 0
    s_mov_b32 s26, 4096
    buffer_load_dwordx4 v[64:67], v125, s[12:15], s23 offen offset:0
    buffer_load_dwordx4 v[68:71], v125, s[12:15], s23 offen offset:1024
    buffer_load_dwordx4 v[72:75], v125, s[12:15], s23 offen offset:2048
    buffer_load_dwordx4 v[76:79], v125, s[12:15], s23 offen offset:3072
    buffer_load_dwordx4 v[80:83], v125, s[12:15], s26 offen offset:0
    buffer_load_dwordx4 v[84:87], v125, s[12:15], s26 offen offset:1024
    buffer_load_dwordx4 v[88:91], v125, s[12:15], s26 offen offset:2048
    buffer_load_dwordx4 v[92:95], v125, s[12:15], s26 offen offset:3072
    s_mov_b32 s23, 57344
    s_mov_b32 s26, 61440
    s_waitcnt vmcnt(8)
    v_lshlrev_b32 v108, 16, v96
    v_and_b32 v111, s25, v96
    v_lshlrev_b32 v109, 16, v100
    v_and_b32 v112, s25, v100
    v_lshlrev_b32 v110, 16, v104
    v_and_b32 v113, s25, v104
    v_mul_f32 v114, s44, v108
    v_mul_f32 v115, s44, v111
    v_fmac_f32 v114, s45, v109
    v_fmac_f32 v115, s45, v112
    v_fmac_f32 v114, s46, v110
    v_fmac_f32 v115, s46, v113
    v_cvt_pk_bf16_f32 v96, v114, v115
    v_lshlrev_b32 v108, 16, v97
    v_and_b32 v111, s25, v97
    v_lshlrev_b32 v109, 16, v101
    v_and_b32 v112, s25, v101
    v_lshlrev_b32 v110, 16, v105
    v_and_b32 v113, s25, v105
    v_mul_f32 v114, s44, v108
    v_mul_f32 v115, s44, v111
    v_fmac_f32 v114, s45, v109
    v_fmac_f32 v115, s45, v112
    v_fmac_f32 v114, s46, v110
    v_fmac_f32 v115, s46, v113
    v_cvt_pk_bf16_f32 v97, v114, v115
    v_lshlrev_b32 v108, 16, v98
    v_and_b32 v111, s25, v98
    v_lshlrev_b32 v109, 16, v102
    v_and_b32 v112, s25, v102
    v_lshlrev_b32 v110, 16, v106
    v_and_b32 v113, s25, v106
    v_mul_f32 v114, s44, v108
    v_mul_f32 v115, s44, v111
    v_fmac_f32 v114, s45, v109
    v_fmac_f32 v115, s45, v112
    v_fmac_f32 v114, s46, v110
    v_fmac_f32 v115, s46, v113
    v_cvt_pk_bf16_f32 v98, v114, v115
    v_lshlrev_b32 v108, 16, v99
    v_and_b32 v111, s25, v99
    v_lshlrev_b32 v109, 16, v103
    v_and_b32 v112, s25, v103
    v_lshlrev_b32 v110, 16, v107
    v_and_b32 v113, s25, v107
    v_mul_f32 v114, s44, v108
    v_mul_f32 v115, s44, v111
    v_fmac_f32 v114, s45, v109
    v_fmac_f32 v115, s45, v112
    v_fmac_f32 v114, s46, v110
    v_fmac_f32 v115, s46, v113
    v_cvt_pk_bf16_f32 v99, v114, v115
    ds_write_b128 v126, v[96:99]
    s_waitcnt lgkmcnt(0)
    s_barrier
    s_mov_b32 s22, 4
    s_setprio 2
L_conv2_kernel_mloop1:
    ds_read_b128 v[96:99], v120 offset:0
    ds_read_b128 v[100:103], v120 offset:1024
    ds_read_b128 v[104:107], v120 offset:2048
    ds_read_b128 v[108:111], v120 offset:3072
    ds_read_b128 v[112:115], v120 offset:4096
    ds_read_b128 v[116:119], v120 offset:5120
    s_waitcnt vmcnt(6) lgkmcnt(5)
    v_mfma_f32_16x16x32_bf16 v[0:3], v[64:67], v[96:99], v[0:3]
    v_mfma_f32_16x16x32_bf16 v[32:35], v[68:71], v[96:99], v[32:35]
    ds_read_b128 v[96:99], v120 offset:6144
    s_waitcnt vmcnt(4) lgkmcnt(5)
    v_mfma_f32_16x16x32_bf16 v[4:7], v[64:67], v[100:103], v[4:7]
    v_mfma_f32_16x16x32_bf16 v[36:39], v[68:71], v[100:103], v[36:39]
    v_mfma_f32_16x16x32_bf16 v[0:3], v[72:75], v[100:103], v[0:3]
    v_mfma_f32_16x16x32_bf16 v[32:35], v[76:79], v[100:103], v[32:35]
    ds_read_b128 v[100:103], v120 offset:7168
    s_waitcnt vmcnt(2) lgkmcnt(5)
    v_mfma_f32_16x16x32_bf16 v[8:11], v[64:67], v[104:107], v[8:11]
    v_mfma_f32_16x16x32_bf16 v[40:43], v[68:71], v[104:107], v[40:43]
    v_mfma_f32_16x16x32_bf16 v[4:7], v[72:75], v[104:107], v[4:7]
    v_mfma_f32_16x16x32_bf16 v[36:39], v[76:79], v[104:107], v[36:39]
    v_mfma_f32_16x16x32_bf16 v[0:3], v[80:83], v[104:107], v[0:3]
    v_mfma_f32_16x16x32_bf16 v[32:35], v[84:87], v[104:107], v[32:35]
    ds_read_b128 v[104:107], v122 offset:0
    v_add_u32 v122, v123, v122
    s_waitcnt vmcnt(0) lgkmcnt(5)
    v_mfma_f32_16x16x32_bf16 v[12:15], v[64:67], v[108:111], v[12:15]
    v_mfma_f32_16x16x32_bf16 v[44:47], v[68:71], v[108:111], v[44:47]
    v_mfma_f32_16x16x32_bf16 v[8:11], v[72:75], v[108:111], v[8:11]
    v_mfma_f32_16x16x32_bf16 v[40:43], v[76:79], v[108:111], v[40:43]
    v_mfma_f32_16x16x32_bf16 v[4:7], v[80:83], v[108:111], v[4:7]
    v_mfma_f32_16x16x32_bf16 v[36:39], v[84:87], v[108:111], v[36:39]
    v_mfma_f32_16x16x32_bf16 v[0:3], v[88:91], v[108:111], v[0:3]
    v_mfma_f32_16x16x32_bf16 v[32:35], v[92:95], v[108:111], v[32:35]
    ds_read_b128 v[108:111], v121 offset:1024
    s_waitcnt lgkmcnt(5)
    v_mfma_f32_16x16x32_bf16 v[16:19], v[64:67], v[112:115], v[16:19]
    v_mfma_f32_16x16x32_bf16 v[48:51], v[68:71], v[112:115], v[48:51]
    v_mfma_f32_16x16x32_bf16 v[12:15], v[72:75], v[112:115], v[12:15]
    v_mfma_f32_16x16x32_bf16 v[44:47], v[76:79], v[112:115], v[44:47]
    v_mfma_f32_16x16x32_bf16 v[8:11], v[80:83], v[112:115], v[8:11]
    v_mfma_f32_16x16x32_bf16 v[40:43], v[84:87], v[112:115], v[40:43]
    v_mfma_f32_16x16x32_bf16 v[4:7], v[88:91], v[112:115], v[4:7]
    v_mfma_f32_16x16x32_bf16 v[36:39], v[92:95], v[112:115], v[36:39]
    ds_read_b128 v[112:115], v121 offset:2048
    s_waitcnt lgkmcnt(5)
    v_mfma_f32_16x16x32_bf16 v[20:23], v[64:67], v[116:119], v[20:23]
    v_mfma_f32_16x16x32_bf16 v[52:55], v[68:71], v[116:119], v[52:55]
    v_mfma_f32_16x16x32_bf16 v[16:19], v[72:75], v[116:119], v[16:19]
    v_mfma_f32_16x16x32_bf16 v[48:51], v[76:79], v[116:119], v[48:51]
    v_mfma_f32_16x16x32_bf16 v[12:15], v[80:83], v[116:119], v[12:15]
    v_mfma_f32_16x16x32_bf16 v[44:47], v[84:87], v[116:119], v[44:47]
    v_mfma_f32_16x16x32_bf16 v[8:11], v[88:91], v[116:119], v[8:11]
    v_mfma_f32_16x16x32_bf16 v[40:43], v[92:95], v[116:119], v[40:43]
    s_waitcnt lgkmcnt(4)
    v_mfma_f32_16x16x32_bf16 v[24:27], v[64:67], v[96:99], v[24:27]
    v_mfma_f32_16x16x32_bf16 v[56:59], v[68:71], v[96:99], v[56:59]
    v_mfma_f32_16x16x32_bf16 v[20:23], v[72:75], v[96:99], v[20:23]
    v_mfma_f32_16x16x32_bf16 v[52:55], v[76:79], v[96:99], v[52:55]
    v_mfma_f32_16x16x32_bf16 v[16:19], v[80:83], v[96:99], v[16:19]
    v_mfma_f32_16x16x32_bf16 v[48:51], v[84:87], v[96:99], v[48:51]
    v_mfma_f32_16x16x32_bf16 v[12:15], v[88:91], v[96:99], v[12:15]
    v_mfma_f32_16x16x32_bf16 v[44:47], v[92:95], v[96:99], v[44:47]
    s_waitcnt lgkmcnt(3)
    v_mfma_f32_16x16x32_bf16 v[28:31], v[64:67], v[100:103], v[28:31]
    v_mfma_f32_16x16x32_bf16 v[60:63], v[68:71], v[100:103], v[60:63]
    v_mfma_f32_16x16x32_bf16 v[24:27], v[72:75], v[100:103], v[24:27]
    v_mfma_f32_16x16x32_bf16 v[56:59], v[76:79], v[100:103], v[56:59]
    v_mfma_f32_16x16x32_bf16 v[20:23], v[80:83], v[100:103], v[20:23]
    v_mfma_f32_16x16x32_bf16 v[52:55], v[84:87], v[100:103], v[52:55]
    v_mfma_f32_16x16x32_bf16 v[16:19], v[88:91], v[100:103], v[16:19]
    v_mfma_f32_16x16x32_bf16 v[48:51], v[92:95], v[100:103], v[48:51]
    buffer_load_dwordx4 v[64:67], v125, s[12:15], s23 offen offset:0
    buffer_load_dwordx4 v[68:71], v125, s[12:15], s23 offen offset:1024
    s_waitcnt lgkmcnt(2)
    v_mfma_f32_16x16x32_bf16 v[28:31], v[72:75], v[104:107], v[28:31]
    v_mfma_f32_16x16x32_bf16 v[60:63], v[76:79], v[104:107], v[60:63]
    v_mfma_f32_16x16x32_bf16 v[24:27], v[80:83], v[104:107], v[24:27]
    v_mfma_f32_16x16x32_bf16 v[56:59], v[84:87], v[104:107], v[56:59]
    v_mfma_f32_16x16x32_bf16 v[20:23], v[88:91], v[104:107], v[20:23]
    v_mfma_f32_16x16x32_bf16 v[52:55], v[92:95], v[104:107], v[52:55]
    buffer_load_dwordx4 v[72:75], v125, s[12:15], s23 offen offset:2048
    buffer_load_dwordx4 v[76:79], v125, s[12:15], s23 offen offset:3072
    s_waitcnt lgkmcnt(1)
    v_mfma_f32_16x16x32_bf16 v[28:31], v[80:83], v[108:111], v[28:31]
    v_mfma_f32_16x16x32_bf16 v[60:63], v[84:87], v[108:111], v[60:63]
    v_mfma_f32_16x16x32_bf16 v[24:27], v[88:91], v[108:111], v[24:27]
    v_mfma_f32_16x16x32_bf16 v[56:59], v[92:95], v[108:111], v[56:59]
    buffer_load_dwordx4 v[80:83], v125, s[12:15], s26 offen offset:0
    buffer_load_dwordx4 v[84:87], v125, s[12:15], s26 offen offset:1024
    s_waitcnt lgkmcnt(0)
    v_mfma_f32_16x16x32_bf16 v[28:31], v[88:91], v[112:115], v[28:31]
    v_mfma_f32_16x16x32_bf16 v[60:63], v[92:95], v[112:115], v[60:63]
    buffer_load_dwordx4 v[88:91], v125, s[12:15], s26 offen offset:2048
    buffer_load_dwordx4 v[92:95], v125, s[12:15], s26 offen offset:3072
    s_add_u32 s23, s23, 57344
    s_add_u32 s26, s26, 57344
    s_barrier
    s_sub_u32 s22, s22, 1
    s_cmp_eq_u32 s22, 0
    s_cbranch_scc1 L_conv2_kernel_mlast1
    ds_read_b128 v[96:99], v120 offset:8192
    ds_read_b128 v[100:103], v120 offset:9216
    ds_read_b128 v[104:107], v120 offset:10240
    ds_read_b128 v[108:111], v120 offset:11264
    ds_read_b128 v[112:115], v120 offset:12288
    ds_read_b128 v[116:119], v120 offset:13312
    s_waitcnt vmcnt(6) lgkmcnt(5)
    v_mfma_f32_16x16x32_bf16 v[0:3], v[64:67], v[96:99], v[0:3]
    v_mfma_f32_16x16x32_bf16 v[32:35], v[68:71], v[96:99], v[32:35]
    ds_read_b128 v[96:99], v120 offset:14336
    s_waitcnt vmcnt(4) lgkmcnt(5)
    v_mfma_f32_16x16x32_bf16 v[4:7], v[64:67], v[100:103], v[4:7]
    v_mfma_f32_16x16x32_bf16 v[36:39], v[68:71], v[100:103], v[36:39]
    v_mfma_f32_16x16x32_bf16 v[0:3], v[72:75], v[100:103], v[0:3]
    v_mfma_f32_16x16x32_bf16 v[32:35], v[76:79], v[100:103], v[32:35]
    ds_read_b128 v[100:103], v120 offset:15360
    s_waitcnt vmcnt(2) lgkmcnt(5)
    v_mfma_f32_16x16x32_bf16 v[8:11], v[64:67], v[104:107], v[8:11]
    v_mfma_f32_16x16x32_bf16 v[40:43], v[68:71], v[104:107], v[40:43]
    v_mfma_f32_16x16x32_bf16 v[4:7], v[72:75], v[104:107], v[4:7]
    v_mfma_f32_16x16x32_bf16 v[36:39], v[76:79], v[104:107], v[36:39]
    v_mfma_f32_16x16x32_bf16 v[0:3], v[80:83], v[104:107], v[0:3]
    v_mfma_f32_16x16x32_bf16 v[32:35], v[84:87], v[104:107], v[32:35]
    ds_read_b128 v[104:107], v122 offset:0
    v_add_u32 v122, v124, v122
    s_waitcnt vmcnt(0) lgkmcnt(5)
    v_mfma_f32_16x16x32_bf16 v[12:15], v[64:67], v[108:111], v[12:15]
    v_mfma_f32_16x16x32_bf16 v[44:47], v[68:71], v[108:111], v[44:47]
    v_mfma_f32_16x16x32_bf16 v[8:11], v[72:75], v[108:111], v[8:11]
    v_mfma_f32_16x16x32_bf16 v[40:43], v[76:79], v[108:111], v[40:43]
    v_mfma_f32_16x16x32_bf16 v[4:7], v[80:83], v[108:111], v[4:7]
    v_mfma_f32_16x16x32_bf16 v[36:39], v[84:87], v[108:111], v[36:39]
    v_mfma_f32_16x16x32_bf16 v[0:3], v[88:91], v[108:111], v[0:3]
    v_mfma_f32_16x16x32_bf16 v[32:35], v[92:95], v[108:111], v[32:35]
    ds_read_b128 v[108:111], v121 offset:9216
    s_waitcnt lgkmcnt(5)
    v_mfma_f32_16x16x32_bf16 v[16:19], v[64:67], v[112:115], v[16:19]
    v_mfma_f32_16x16x32_bf16 v[48:51], v[68:71], v[112:115], v[48:51]
    v_mfma_f32_16x16x32_bf16 v[12:15], v[72:75], v[112:115], v[12:15]
    v_mfma_f32_16x16x32_bf16 v[44:47], v[76:79], v[112:115], v[44:47]
    v_mfma_f32_16x16x32_bf16 v[8:11], v[80:83], v[112:115], v[8:11]
    v_mfma_f32_16x16x32_bf16 v[40:43], v[84:87], v[112:115], v[40:43]
    v_mfma_f32_16x16x32_bf16 v[4:7], v[88:91], v[112:115], v[4:7]
    v_mfma_f32_16x16x32_bf16 v[36:39], v[92:95], v[112:115], v[36:39]
    ds_read_b128 v[112:115], v121 offset:10240
    s_waitcnt lgkmcnt(5)
    v_mfma_f32_16x16x32_bf16 v[20:23], v[64:67], v[116:119], v[20:23]
    v_mfma_f32_16x16x32_bf16 v[52:55], v[68:71], v[116:119], v[52:55]
    v_mfma_f32_16x16x32_bf16 v[16:19], v[72:75], v[116:119], v[16:19]
    v_mfma_f32_16x16x32_bf16 v[48:51], v[76:79], v[116:119], v[48:51]
    v_mfma_f32_16x16x32_bf16 v[12:15], v[80:83], v[116:119], v[12:15]
    v_mfma_f32_16x16x32_bf16 v[44:47], v[84:87], v[116:119], v[44:47]
    v_mfma_f32_16x16x32_bf16 v[8:11], v[88:91], v[116:119], v[8:11]
    v_mfma_f32_16x16x32_bf16 v[40:43], v[92:95], v[116:119], v[40:43]
    s_waitcnt lgkmcnt(4)
    v_mfma_f32_16x16x32_bf16 v[24:27], v[64:67], v[96:99], v[24:27]
    v_mfma_f32_16x16x32_bf16 v[56:59], v[68:71], v[96:99], v[56:59]
    v_mfma_f32_16x16x32_bf16 v[20:23], v[72:75], v[96:99], v[20:23]
    v_mfma_f32_16x16x32_bf16 v[52:55], v[76:79], v[96:99], v[52:55]
    v_mfma_f32_16x16x32_bf16 v[16:19], v[80:83], v[96:99], v[16:19]
    v_mfma_f32_16x16x32_bf16 v[48:51], v[84:87], v[96:99], v[48:51]
    v_mfma_f32_16x16x32_bf16 v[12:15], v[88:91], v[96:99], v[12:15]
    v_mfma_f32_16x16x32_bf16 v[44:47], v[92:95], v[96:99], v[44:47]
    s_waitcnt lgkmcnt(3)
    v_mfma_f32_16x16x32_bf16 v[28:31], v[64:67], v[100:103], v[28:31]
    v_mfma_f32_16x16x32_bf16 v[60:63], v[68:71], v[100:103], v[60:63]
    v_mfma_f32_16x16x32_bf16 v[24:27], v[72:75], v[100:103], v[24:27]
    v_mfma_f32_16x16x32_bf16 v[56:59], v[76:79], v[100:103], v[56:59]
    v_mfma_f32_16x16x32_bf16 v[20:23], v[80:83], v[100:103], v[20:23]
    v_mfma_f32_16x16x32_bf16 v[52:55], v[84:87], v[100:103], v[52:55]
    v_mfma_f32_16x16x32_bf16 v[16:19], v[88:91], v[100:103], v[16:19]
    v_mfma_f32_16x16x32_bf16 v[48:51], v[92:95], v[100:103], v[48:51]
    buffer_load_dwordx4 v[64:67], v125, s[12:15], s23 offen offset:0
    buffer_load_dwordx4 v[68:71], v125, s[12:15], s23 offen offset:1024
    s_waitcnt lgkmcnt(2)
    v_mfma_f32_16x16x32_bf16 v[28:31], v[72:75], v[104:107], v[28:31]
    v_mfma_f32_16x16x32_bf16 v[60:63], v[76:79], v[104:107], v[60:63]
    v_mfma_f32_16x16x32_bf16 v[24:27], v[80:83], v[104:107], v[24:27]
    v_mfma_f32_16x16x32_bf16 v[56:59], v[84:87], v[104:107], v[56:59]
    v_mfma_f32_16x16x32_bf16 v[20:23], v[88:91], v[104:107], v[20:23]
    v_mfma_f32_16x16x32_bf16 v[52:55], v[92:95], v[104:107], v[52:55]
    buffer_load_dwordx4 v[72:75], v125, s[12:15], s23 offen offset:2048
    buffer_load_dwordx4 v[76:79], v125, s[12:15], s23 offen offset:3072
    s_waitcnt lgkmcnt(1)
    v_mfma_f32_16x16x32_bf16 v[28:31], v[80:83], v[108:111], v[28:31]
    v_mfma_f32_16x16x32_bf16 v[60:63], v[84:87], v[108:111], v[60:63]
    v_mfma_f32_16x16x32_bf16 v[24:27], v[88:91], v[108:111], v[24:27]
    v_mfma_f32_16x16x32_bf16 v[56:59], v[92:95], v[108:111], v[56:59]
    buffer_load_dwordx4 v[80:83], v125, s[12:15], s26 offen offset:0
    buffer_load_dwordx4 v[84:87], v125, s[12:15], s26 offen offset:1024
    s_waitcnt lgkmcnt(0)
    v_mfma_f32_16x16x32_bf16 v[28:31], v[88:91], v[112:115], v[28:31]
    v_mfma_f32_16x16x32_bf16 v[60:63], v[92:95], v[112:115], v[60:63]
    buffer_load_dwordx4 v[88:91], v125, s[12:15], s26 offen offset:2048
    buffer_load_dwordx4 v[92:95], v125, s[12:15], s26 offen offset:3072
    s_add_u32 s23, s23, 57344
    s_add_u32 s26, s26, 57344
    s_barrier
    s_branch L_conv2_kernel_mloop1
L_conv2_kernel_mlast1:
    v_and_b32 v125, 15, v127
    v_and_b32 v126, 7, v127
    v_lshlrev_b32 v126, 4, v126
    v_lshl_add_u32 v125, v125, 7, v126
    v_lshrrev_b32 v126, 4, v127
    v_lshl_add_u32 v125, v126, 11, v125
    s_lshl_b32 s36, s20, 14
    s_add_u32 s37, s36, 8192
    v_add_u32 v126, s37, v125
    v_add_u32 v125, s36, v125
    ds_read_b128 v[96:99], v120 offset:8192
    ds_read_b128 v[100:103], v120 offset:9216
    ds_read_b128 v[104:107], v120 offset:10240
    ds_read_b128 v[108:111], v120 offset:11264
    ds_read_b128 v[112:115], v120 offset:12288
    ds_read_b128 v[116:119], v120 offset:13312
    s_waitcnt vmcnt(6) lgkmcnt(5)
    v_mfma_f32_16x16x32_bf16 v[0:3], v[64:67], v[96:99], v[0:3]
    v_mfma_f32_16x16x32_bf16 v[32:35], v[68:71], v[96:99], v[32:35]
    ds_read_b128 v[96:99], v120 offset:14336
    s_waitcnt vmcnt(4) lgkmcnt(5)
    v_mfma_f32_16x16x32_bf16 v[4:7], v[64:67], v[100:103], v[4:7]
    v_mfma_f32_16x16x32_bf16 v[36:39], v[68:71], v[100:103], v[36:39]
    v_mfma_f32_16x16x32_bf16 v[0:3], v[72:75], v[100:103], v[0:3]
    v_mfma_f32_16x16x32_bf16 v[32:35], v[76:79], v[100:103], v[32:35]
    ds_read_b128 v[100:103], v120 offset:15360
    s_waitcnt vmcnt(2) lgkmcnt(5)
    v_mfma_f32_16x16x32_bf16 v[8:11], v[64:67], v[104:107], v[8:11]
    v_mfma_f32_16x16x32_bf16 v[40:43], v[68:71], v[104:107], v[40:43]
    v_mfma_f32_16x16x32_bf16 v[4:7], v[72:75], v[104:107], v[4:7]
    v_mfma_f32_16x16x32_bf16 v[36:39], v[76:79], v[104:107], v[36:39]
    v_mfma_f32_16x16x32_bf16 v[0:3], v[80:83], v[104:107], v[0:3]
    v_mfma_f32_16x16x32_bf16 v[32:35], v[84:87], v[104:107], v[32:35]
    ds_read_b128 v[104:107], v122 offset:0
    s_waitcnt vmcnt(0) lgkmcnt(5)
    v_mfma_f32_16x16x32_bf16 v[12:15], v[64:67], v[108:111], v[12:15]
    v_mfma_f32_16x16x32_bf16 v[44:47], v[68:71], v[108:111], v[44:47]
    v_mfma_f32_16x16x32_bf16 v[8:11], v[72:75], v[108:111], v[8:11]
    v_mfma_f32_16x16x32_bf16 v[40:43], v[76:79], v[108:111], v[40:43]
    v_mfma_f32_16x16x32_bf16 v[4:7], v[80:83], v[108:111], v[4:7]
    v_mfma_f32_16x16x32_bf16 v[36:39], v[84:87], v[108:111], v[36:39]
    v_mfma_f32_16x16x32_bf16 v[0:3], v[88:91], v[108:111], v[0:3]
    v_mfma_f32_16x16x32_bf16 v[32:35], v[92:95], v[108:111], v[32:35]
    ds_read_b128 v[108:111], v121 offset:9216
    s_waitcnt lgkmcnt(5)
    v_mfma_f32_16x16x32_bf16 v[16:19], v[64:67], v[112:115], v[16:19]
    v_mfma_f32_16x16x32_bf16 v[48:51], v[68:71], v[112:115], v[48:51]
    v_mfma_f32_16x16x32_bf16 v[12:15], v[72:75], v[112:115], v[12:15]
    v_mfma_f32_16x16x32_bf16 v[44:47], v[76:79], v[112:115], v[44:47]
    v_mfma_f32_16x16x32_bf16 v[8:11], v[80:83], v[112:115], v[8:11]
    v_mfma_f32_16x16x32_bf16 v[40:43], v[84:87], v[112:115], v[40:43]
    v_mfma_f32_16x16x32_bf16 v[4:7], v[88:91], v[112:115], v[4:7]
    v_mfma_f32_16x16x32_bf16 v[36:39], v[92:95], v[112:115], v[36:39]
    ds_read_b128 v[112:115], v121 offset:10240
    v_xor_b32 v123, 0, v125
    ds_write_b128 v123, v[0:3]
    s_waitcnt lgkmcnt(6)
    v_mfma_f32_16x16x32_bf16 v[20:23], v[64:67], v[116:119], v[20:23]
    v_mfma_f32_16x16x32_bf16 v[52:55], v[68:71], v[116:119], v[52:55]
    v_mfma_f32_16x16x32_bf16 v[16:19], v[72:75], v[116:119], v[16:19]
    v_mfma_f32_16x16x32_bf16 v[48:51], v[76:79], v[116:119], v[48:51]
    v_mfma_f32_16x16x32_bf16 v[12:15], v[80:83], v[116:119], v[12:15]
    v_mfma_f32_16x16x32_bf16 v[44:47], v[84:87], v[116:119], v[44:47]
    v_mfma_f32_16x16x32_bf16 v[8:11], v[88:91], v[116:119], v[8:11]
    v_mfma_f32_16x16x32_bf16 v[40:43], v[92:95], v[116:119], v[40:43]
    v_xor_b32 v124, 16, v125
    ds_write_b128 v124, v[4:7]
    s_waitcnt lgkmcnt(2)
    v_mfma_f32_16x16x32_bf16 v[24:27], v[64:67], v[96:99], v[24:27]
    v_mfma_f32_16x16x32_bf16 v[56:59], v[68:71], v[96:99], v[56:59]
    v_mfma_f32_16x16x32_bf16 v[20:23], v[72:75], v[96:99], v[20:23]
    v_mfma_f32_16x16x32_bf16 v[52:55], v[76:79], v[96:99], v[52:55]
    v_mfma_f32_16x16x32_bf16 v[16:19], v[80:83], v[96:99], v[16:19]
    v_mfma_f32_16x16x32_bf16 v[48:51], v[84:87], v[96:99], v[48:51]
    v_mfma_f32_16x16x32_bf16 v[12:15], v[88:91], v[96:99], v[12:15]
    v_mfma_f32_16x16x32_bf16 v[44:47], v[92:95], v[96:99], v[44:47]
    v_xor_b32 v123, 32, v125
    ds_write_b128 v123, v[8:11]
    v_xor_b32 v124, 0, v126
    ds_write_b128 v124, v[32:35]
    v_mfma_f32_16x16x32_bf16 v[28:31], v[64:67], v[100:103], v[28:31]
    v_mfma_f32_16x16x32_bf16 v[60:63], v[68:71], v[100:103], v[60:63]
    v_mfma_f32_16x16x32_bf16 v[24:27], v[72:75], v[100:103], v[24:27]
    v_mfma_f32_16x16x32_bf16 v[56:59], v[76:79], v[100:103], v[56:59]
    v_mfma_f32_16x16x32_bf16 v[20:23], v[80:83], v[100:103], v[20:23]
    v_mfma_f32_16x16x32_bf16 v[52:55], v[84:87], v[100:103], v[52:55]
    v_mfma_f32_16x16x32_bf16 v[16:19], v[88:91], v[100:103], v[16:19]
    v_mfma_f32_16x16x32_bf16 v[48:51], v[92:95], v[100:103], v[48:51]
    v_xor_b32 v123, 16, v126
    ds_write_b128 v123, v[36:39]
    v_xor_b32 v124, 32, v126
    ds_write_b128 v124, v[40:43]
    v_mfma_f32_16x16x32_bf16 v[28:31], v[72:75], v[104:107], v[28:31]
    v_mfma_f32_16x16x32_bf16 v[60:63], v[76:79], v[104:107], v[60:63]
    v_mfma_f32_16x16x32_bf16 v[24:27], v[80:83], v[104:107], v[24:27]
    v_mfma_f32_16x16x32_bf16 v[56:59], v[84:87], v[104:107], v[56:59]
    v_mfma_f32_16x16x32_bf16 v[20:23], v[88:91], v[104:107], v[20:23]
    v_mfma_f32_16x16x32_bf16 v[52:55], v[92:95], v[104:107], v[52:55]
    v_xor_b32 v124, 48, v125
    ds_write_b128 v124, v[12:15]
    v_xor_b32 v123, 48, v126
    ds_write_b128 v123, v[44:47]
    v_mfma_f32_16x16x32_bf16 v[28:31], v[80:83], v[108:111], v[28:31]
    v_mfma_f32_16x16x32_bf16 v[60:63], v[84:87], v[108:111], v[60:63]
    v_mfma_f32_16x16x32_bf16 v[24:27], v[88:91], v[108:111], v[24:27]
    v_mfma_f32_16x16x32_bf16 v[56:59], v[92:95], v[108:111], v[56:59]
    v_xor_b32 v123, 64, v125
    ds_write_b128 v123, v[16:19]
    v_xor_b32 v124, 64, v126
    ds_write_b128 v124, v[48:51]
    v_mfma_f32_16x16x32_bf16 v[28:31], v[88:91], v[112:115], v[28:31]
    v_mfma_f32_16x16x32_bf16 v[60:63], v[92:95], v[112:115], v[60:63]
    v_xor_b32 v124, 80, v125
    ds_write_b128 v124, v[20:23]
    v_xor_b32 v123, 80, v126
    ds_write_b128 v123, v[52:55]
    s_nop 7
    v_xor_b32 v123, 96, v125
    ds_write_b128 v123, v[24:27]
    v_xor_b32 v124, 96, v126
    ds_write_b128 v124, v[56:59]
    v_xor_b32 v124, 112, v125
    ds_write_b128 v124, v[28:31]
    v_xor_b32 v123, 112, v126
    s_waitcnt lgkmcnt(8)
    ds_write_b128 v123, v[60:63]
    s_setprio 0
    s_branch L_conv2_kernel_epi
L_conv2_kernel_m2:
    s_mul_i32 s37, s38, 2176
    s_add_u32 s37, s37, 98304
    v_add_u32 v116, s37, v8
    v_add_u32 v118, s37, v9
    v_add_u32 v117, 104832, v8
    s_cmp_eq_u32 s38, 0
    s_cbranch_scc1 L_conv2_kernel_hh0
    v_add_u32 v117, 98304, v9
L_conv2_kernel_hh0:
    s_lshl_b32 s37, s38, 12
    s_add_u32 s37, s37, s43
    s_add_u32 s37, s37, 49152
    v_lshl_add_u32 v119, v127, 4, s37
    v_mov_b32 v0, 0
    v_mov_b32 v1, 0
    v_mov_b32 v2, 0
    v_mov_b32 v3, 0
    v_mov_b32 v4, 0
    v_mov_b32 v5, 0
    v_mov_b32 v6, 0
    v_mov_b32 v7, 0
    v_mov_b32 v8, 0
    v_mov_b32 v9, 0
    v_mov_b32 v10, 0
    v_mov_b32 v11, 0
    v_mov_b32 v12, 0
    v_mov_b32 v13, 0
    v_mov_b32 v14, 0
    v_mov_b32 v15, 0
    v_mov_b32 v16, 0
    v_mov_b32 v17, 0
    v_mov_b32 v18, 0
    v_mov_b32 v19, 0
    v_mov_b32 v20, 0
    v_mov_b32 v21, 0
    v_mov_b32 v22, 0
    v_mov_b32 v23, 0
    v_mov_b32 v24, 0
    v_mov_b32 v25, 0
    v_mov_b32 v26, 0
    v_mov_b32 v27, 0
    v_mov_b32 v28, 0
    v_mov_b32 v29, 0
    v_mov_b32 v30, 0
    v_mov_b32 v31, 0
    v_mov_b32 v32, 0
    v_mov_b32 v33, 0
    v_mov_b32 v34, 0
    v_mov_b32 v35, 0
    v_mov_b32 v36, 0
    v_mov_b32 v37, 0
    v_mov_b32 v38, 0
    v_mov_b32 v39, 0
    v_mov_b32 v40, 0
    v_mov_b32 v41, 0
    v_mov_b32 v42, 0
    v_mov_b32 v43, 0
    v_mov_b32 v44, 0
    v_mov_b32 v45, 0
    v_mov_b32 v46, 0
    v_mov_b32 v47, 0
    v_mov_b32 v48, 0
    v_mov_b32 v49, 0
    v_mov_b32 v50, 0
    v_mov_b32 v51, 0
    v_mov_b32 v52, 0
    v_mov_b32 v53, 0
    v_mov_b32 v54, 0
    v_mov_b32 v55, 0
    v_mov_b32 v56, 0
    v_mov_b32 v57, 0
    v_mov_b32 v58, 0
    v_mov_b32 v59, 0
    v_mov_b32 v60, 0
    v_mov_b32 v61, 0
    v_mov_b32 v62, 0
    v_mov_b32 v63, 0
    s_barrier
    buffer_load_dwordx4 v[96:99], v108, s[8:11], 0 offen
    buffer_load_dwordx4 v[100:103], v109, s[8:11], 0 offen
    buffer_load_dwordx4 v[104:107], v110, s[8:11], 0 offen
    s_mov_b32 s23, 0
    s_mov_b32 s26, 4096
    buffer_load_dwordx4 v[64:67], v125, s[12:15], s23 offen offset:0
    buffer_load_dwordx4 v[68:71], v125, s[12:15], s23 offen offset:2048
    buffer_load_dwordx4 v[80:83], v119, s[12:15], s23 offen offset:0
    buffer_load_dwordx4 v[72:75], v125, s[12:15], s26 offen offset:0
    buffer_load_dwordx4 v[84:87], v119, s[12:15], s23 offen offset:2048
    buffer_load_dwordx4 v[76:79], v125, s[12:15], s26 offen offset:2048
    s_mov_b32 s23, 57344
    s_mov_b32 s26, 61440
    s_waitcnt vmcnt(6)
    v_lshlrev_b32 v108, 16, v96
    v_and_b32 v111, s25, v96
    v_lshlrev_b32 v109, 16, v100
    v_and_b32 v112, s25, v100
    v_lshlrev_b32 v110, 16, v104
    v_and_b32 v113, s25, v104
    v_mul_f32 v114, s44, v108
    v_mul_f32 v115, s44, v111
    v_fmac_f32 v114, s45, v109
    v_fmac_f32 v115, s45, v112
    v_fmac_f32 v114, s46, v110
    v_fmac_f32 v115, s46, v113
    v_cvt_pk_bf16_f32 v96, v114, v115
    v_lshlrev_b32 v108, 16, v97
    v_and_b32 v111, s25, v97
    v_lshlrev_b32 v109, 16, v101
    v_and_b32 v112, s25, v101
    v_lshlrev_b32 v110, 16, v105
    v_and_b32 v113, s25, v105
    v_mul_f32 v114, s44, v108
    v_mul_f32 v115, s44, v111
    v_fmac_f32 v114, s45, v109
    v_fmac_f32 v115, s45, v112
    v_fmac_f32 v114, s46, v110
    v_fmac_f32 v115, s46, v113
    v_cvt_pk_bf16_f32 v97, v114, v115
    v_lshlrev_b32 v108, 16, v98
    v_and_b32 v111, s25, v98
    v_lshlrev_b32 v109, 16, v102
    v_and_b32 v112, s25, v102
    v_lshlrev_b32 v110, 16, v106
    v_and_b32 v113, s25, v106
    v_mul_f32 v114, s44, v108
    v_mul_f32 v115, s44, v111
    v_fmac_f32 v114, s45, v109
    v_fmac_f32 v115, s45, v112
    v_fmac_f32 v114, s46, v110
    v_fmac_f32 v115, s46, v113
    v_cvt_pk_bf16_f32 v98, v114, v115
    v_lshlrev_b32 v108, 16, v99
    v_and_b32 v111, s25, v99
    v_lshlrev_b32 v109, 16, v103
    v_and_b32 v112, s25, v103
    v_lshlrev_b32 v110, 16, v107
    v_and_b32 v113, s25, v107
    v_mul_f32 v114, s44, v108
    v_mul_f32 v115, s44, v111
    v_fmac_f32 v114, s45, v109
    v_fmac_f32 v115, s45, v112
    v_fmac_f32 v114, s46, v110
    v_fmac_f32 v115, s46, v113
    v_cvt_pk_bf16_f32 v99, v114, v115
    ds_write_b128 v126, v[96:99]
    v_and_b32 v126, 15, v127
    v_lshlrev_b32 v126, 2, v126
    v_add_u32 v126, 99328, v126
    ds_write_b32 v126, v0
    ds_write_b32 v126, v0 offset:8704
    s_waitcnt lgkmcnt(0)
    s_barrier
    s_mov_b32 s22, 4
    s_setprio 2
L_conv2_kernel_mloop2:
    ds_read_b128 v[88:91], v120 offset:0
    ds_read_b128 v[92:95], v120 offset:1024
    ds_read_b128 v[96:99], v116 offset:0
    ds_read_b128 v[100:103], v120 offset:2048
    ds_read_b128 v[104:107], v116 offset:1088
    ds_read_b128 v[108:111], v120 offset:3072
    ds_read_b128 v[112:115], v116 offset:2176
    s_waitcnt vmcnt(5) lgkmcnt(6)
    v_mfma_f32_16x16x32_bf16 v[0:3], v[64:67], v[88:91], v[0:3]
    ds_read_b128 v[88:91], v120 offset:4096
    s_waitcnt vmcnt(4) lgkmcnt(6)
    v_mfma_f32_16x16x32_bf16 v[4:7], v[64:67], v[92:95], v[4:7]
    v_mfma_f32_16x16x32_bf16 v[0:3], v[68:71], v[92:95], v[0:3]
    ds_read_b128 v[92:95], v116 offset:3264
    s_waitcnt vmcnt(3) lgkmcnt(6)
    v_mfma_f32_16x16x32_bf16 v[32:35], v[80:83], v[96:99], v[32:35]
    ds_read_b128 v[96:99], v120 offset:5120
    s_waitcnt vmcnt(2) lgkmcnt(6)
    v_mfma_f32_16x16x32_bf16 v[8:11], v[64:67], v[100:103], v[8:11]
    v_mfma_f32_16x16x32_bf16 v[4:7], v[68:71], v[100:103], v[4:7]
    v_mfma_f32_16x16x32_bf16 v[0:3], v[72:75], v[100:103], v[0:3]
    ds_read_b128 v[100:103], v116 offset:4352
    s_waitcnt vmcnt(1) lgkmcnt(6)
    v_mfma_f32_16x16x32_bf16 v[36:39], v[80:83], v[104:107], v[36:39]
    v_mfma_f32_16x16x32_bf16 v[32:35], v[84:87], v[104:107], v[32:35]
    ds_read_b128 v[104:107], v120 offset:6144
    s_waitcnt vmcnt(0) lgkmcnt(6)
    v_mfma_f32_16x16x32_bf16 v[12:15], v[64:67], v[108:111], v[12:15]
    v_mfma_f32_16x16x32_bf16 v[8:11], v[68:71], v[108:111], v[8:11]
    v_mfma_f32_16x16x32_bf16 v[4:7], v[72:75], v[108:111], v[4:7]
    v_mfma_f32_16x16x32_bf16 v[0:3], v[76:79], v[108:111], v[0:3]
    ds_read_b128 v[108:111], v116 offset:5440
    s_waitcnt lgkmcnt(6)
    v_mfma_f32_16x16x32_bf16 v[40:43], v[80:83], v[112:115], v[40:43]
    v_mfma_f32_16x16x32_bf16 v[36:39], v[84:87], v[112:115], v[36:39]
    ds_read_b128 v[112:115], v120 offset:7168
    s_waitcnt lgkmcnt(6)
    v_mfma_f32_16x16x32_bf16 v[16:19], v[64:67], v[88:91], v[16:19]
    v_mfma_f32_16x16x32_bf16 v[12:15], v[68:71], v[88:91], v[12:15]
    v_mfma_f32_16x16x32_bf16 v[8:11], v[72:75], v[88:91], v[8:11]
    v_mfma_f32_16x16x32_bf16 v[4:7], v[76:79], v[88:91], v[4:7]
    ds_read_b128 v[88:91], v117 offset:0
    s_waitcnt lgkmcnt(6)
    v_mfma_f32_16x16x32_bf16 v[44:47], v[80:83], v[92:95], v[44:47]
    v_mfma_f32_16x16x32_bf16 v[40:43], v[84:87], v[92:95], v[40:43]
    ds_read_b128 v[92:95], v122 offset:0
    v_add_u32 v122, v123, v122
    s_waitcnt lgkmcnt(6)
    v_mfma_f32_16x16x32_bf16 v[20:23], v[64:67], v[96:99], v[20:23]
    v_mfma_f32_16x16x32_bf16 v[16:19], v[68:71], v[96:99], v[16:19]
    v_mfma_f32_16x16x32_bf16 v[12:15], v[72:75], v[96:99], v[12:15]
    v_mfma_f32_16x16x32_bf16 v[8:11], v[76:79], v[96:99], v[8:11]
    ds_read_b128 v[96:99], v117 offset:1088
    s_waitcnt lgkmcnt(6)
    v_mfma_f32_16x16x32_bf16 v[48:51], v[80:83], v[100:103], v[48:51]
    v_mfma_f32_16x16x32_bf16 v[44:47], v[84:87], v[100:103], v[44:47]
    ds_read_b128 v[100:103], v121 offset:1024
    s_waitcnt lgkmcnt(6)
    v_mfma_f32_16x16x32_bf16 v[24:27], v[64:67], v[104:107], v[24:27]
    v_mfma_f32_16x16x32_bf16 v[20:23], v[68:71], v[104:107], v[20:23]
    v_mfma_f32_16x16x32_bf16 v[16:19], v[72:75], v[104:107], v[16:19]
    v_mfma_f32_16x16x32_bf16 v[12:15], v[76:79], v[104:107], v[12:15]
    ds_read_b128 v[104:107], v118 offset:0
    s_waitcnt lgkmcnt(6)
    v_mfma_f32_16x16x32_bf16 v[52:55], v[80:83], v[108:111], v[52:55]
    v_mfma_f32_16x16x32_bf16 v[48:51], v[84:87], v[108:111], v[48:51]
    ds_read_b128 v[108:111], v121 offset:2048
    s_waitcnt lgkmcnt(6)
    v_mfma_f32_16x16x32_bf16 v[28:31], v[64:67], v[112:115], v[28:31]
    v_mfma_f32_16x16x32_bf16 v[24:27], v[68:71], v[112:115], v[24:27]
    v_mfma_f32_16x16x32_bf16 v[20:23], v[72:75], v[112:115], v[20:23]
    v_mfma_f32_16x16x32_bf16 v[16:19], v[76:79], v[112:115], v[16:19]
    buffer_load_dwordx4 v[64:67], v125, s[12:15], s23 offen offset:0
    s_waitcnt lgkmcnt(5)
    v_mfma_f32_16x16x32_bf16 v[56:59], v[80:83], v[88:91], v[56:59]
    v_mfma_f32_16x16x32_bf16 v[52:55], v[84:87], v[88:91], v[52:55]
    s_waitcnt lgkmcnt(0)
    s_barrier
    v_mfma_f32_16x16x32_bf16 v[28:31], v[68:71], v[92:95], v[28:31]
    v_mfma_f32_16x16x32_bf16 v[24:27], v[72:75], v[92:95], v[24:27]
    v_mfma_f32_16x16x32_bf16 v[20:23], v[76:79], v[92:95], v[20:23]
    buffer_load_dwordx4 v[68:71], v125, s[12:15], s23 offen offset:2048
    v_mfma_f32_16x16x32_bf16 v[60:63], v[80:83], v[96:99], v[60:63]
    v_mfma_f32_16x16x32_bf16 v[56:59], v[84:87], v[96:99], v[56:59]
    buffer_load_dwordx4 v[80:83], v119, s[12:15], s23 offen offset:0
    v_mfma_f32_16x16x32_bf16 v[28:31], v[72:75], v[100:103], v[28:31]
    v_mfma_f32_16x16x32_bf16 v[24:27], v[76:79], v[100:103], v[24:27]
    buffer_load_dwordx4 v[72:75], v125, s[12:15], s26 offen offset:0
    v_mfma_f32_16x16x32_bf16 v[60:63], v[84:87], v[104:107], v[60:63]
    buffer_load_dwordx4 v[84:87], v119, s[12:15], s23 offen offset:2048
    v_mfma_f32_16x16x32_bf16 v[28:31], v[76:79], v[108:111], v[28:31]
    buffer_load_dwordx4 v[76:79], v125, s[12:15], s26 offen offset:2048
    s_add_u32 s23, s23, 57344
    s_add_u32 s26, s26, 57344
    s_sub_u32 s22, s22, 1
    s_cmp_eq_u32 s22, 0
    s_cbranch_scc1 L_conv2_kernel_mlast2
    ds_read_b128 v[88:91], v120 offset:8192
    ds_read_b128 v[92:95], v120 offset:9216
    ds_read_b128 v[96:99], v116 offset:8704
    ds_read_b128 v[100:103], v120 offset:10240
    ds_read_b128 v[104:107], v116 offset:9792
    ds_read_b128 v[108:111], v120 offset:11264
    ds_read_b128 v[112:115], v116 offset:10880
    s_waitcnt vmcnt(5) lgkmcnt(6)
    v_mfma_f32_16x16x32_bf16 v[0:3], v[64:67], v[88:91], v[0:3]
    ds_read_b128 v[88:91], v120 offset:12288
    s_waitcnt vmcnt(4) lgkmcnt(6)
    v_mfma_f32_16x16x32_bf16 v[4:7], v[64:67], v[92:95], v[4:7]
    v_mfma_f32_16x16x32_bf16 v[0:3], v[68:71], v[92:95], v[0:3]
    ds_read_b128 v[92:95], v116 offset:11968
    s_waitcnt vmcnt(3) lgkmcnt(6)
    v_mfma_f32_16x16x32_bf16 v[32:35], v[80:83], v[96:99], v[32:35]
    ds_read_b128 v[96:99], v120 offset:13312
    s_waitcnt vmcnt(2) lgkmcnt(6)
    v_mfma_f32_16x16x32_bf16 v[8:11], v[64:67], v[100:103], v[8:11]
    v_mfma_f32_16x16x32_bf16 v[4:7], v[68:71], v[100:103], v[4:7]
    v_mfma_f32_16x16x32_bf16 v[0:3], v[72:75], v[100:103], v[0:3]
    ds_read_b128 v[100:103], v116 offset:13056
    s_waitcnt vmcnt(1) lgkmcnt(6)
    v_mfma_f32_16x16x32_bf16 v[36:39], v[80:83], v[104:107], v[36:39]
    v_mfma_f32_16x16x32_bf16 v[32:35], v[84:87], v[104:107], v[32:35]
    ds_read_b128 v[104:107], v120 offset:14336
    s_waitcnt vmcnt(0) lgkmcnt(6)
    v_mfma_f32_16x16x32_bf16 v[12:15], v[64:67], v[108:111], v[12:15]
    v_mfma_f32_16x16x32_bf16 v[8:11], v[68:71], v[108:111], v[8:11]
    v_mfma_f32_16x16x32_bf16 v[4:7], v[72:75], v[108:111], v[4:7]
    v_mfma_f32_16x16x32_bf16 v[0:3], v[76:79], v[108:111], v[0:3]
    ds_read_b128 v[108:111], v116 offset:14144
    s_waitcnt lgkmcnt(6)
    v_mfma_f32_16x16x32_bf16 v[40:43], v[80:83], v[112:115], v[40:43]
    v_mfma_f32_16x16x32_bf16 v[36:39], v[84:87], v[112:115], v[36:39]
    ds_read_b128 v[112:115], v120 offset:15360
    s_waitcnt lgkmcnt(6)
    v_mfma_f32_16x16x32_bf16 v[16:19], v[64:67], v[88:91], v[16:19]
    v_mfma_f32_16x16x32_bf16 v[12:15], v[68:71], v[88:91], v[12:15]
    v_mfma_f32_16x16x32_bf16 v[8:11], v[72:75], v[88:91], v[8:11]
    v_mfma_f32_16x16x32_bf16 v[4:7], v[76:79], v[88:91], v[4:7]
    ds_read_b128 v[88:91], v117 offset:8704
    s_waitcnt lgkmcnt(6)
    v_mfma_f32_16x16x32_bf16 v[44:47], v[80:83], v[92:95], v[44:47]
    v_mfma_f32_16x16x32_bf16 v[40:43], v[84:87], v[92:95], v[40:43]
    ds_read_b128 v[92:95], v122 offset:0
    v_add_u32 v122, v124, v122
    s_waitcnt lgkmcnt(6)
    v_mfma_f32_16x16x32_bf16 v[20:23], v[64:67], v[96:99], v[20:23]
    v_mfma_f32_16x16x32_bf16 v[16:19], v[68:71], v[96:99], v[16:19]
    v_mfma_f32_16x16x32_bf16 v[12:15], v[72:75], v[96:99], v[12:15]
    v_mfma_f32_16x16x32_bf16 v[8:11], v[76:79], v[96:99], v[8:11]
    ds_read_b128 v[96:99], v117 offset:9792
    s_waitcnt lgkmcnt(6)
    v_mfma_f32_16x16x32_bf16 v[48:51], v[80:83], v[100:103], v[48:51]
    v_mfma_f32_16x16x32_bf16 v[44:47], v[84:87], v[100:103], v[44:47]
    ds_read_b128 v[100:103], v121 offset:9216
    s_waitcnt lgkmcnt(6)
    v_mfma_f32_16x16x32_bf16 v[24:27], v[64:67], v[104:107], v[24:27]
    v_mfma_f32_16x16x32_bf16 v[20:23], v[68:71], v[104:107], v[20:23]
    v_mfma_f32_16x16x32_bf16 v[16:19], v[72:75], v[104:107], v[16:19]
    v_mfma_f32_16x16x32_bf16 v[12:15], v[76:79], v[104:107], v[12:15]
    ds_read_b128 v[104:107], v118 offset:8704
    s_waitcnt lgkmcnt(6)
    v_mfma_f32_16x16x32_bf16 v[52:55], v[80:83], v[108:111], v[52:55]
    v_mfma_f32_16x16x32_bf16 v[48:51], v[84:87], v[108:111], v[48:51]
    ds_read_b128 v[108:111], v121 offset:10240
    s_waitcnt lgkmcnt(6)
    v_mfma_f32_16x16x32_bf16 v[28:31], v[64:67], v[112:115], v[28:31]
    v_mfma_f32_16x16x32_bf16 v[24:27], v[68:71], v[112:115], v[24:27]
    v_mfma_f32_16x16x32_bf16 v[20:23], v[72:75], v[112:115], v[20:23]
    v_mfma_f32_16x16x32_bf16 v[16:19], v[76:79], v[112:115], v[16:19]
    buffer_load_dwordx4 v[64:67], v125, s[12:15], s23 offen offset:0
    s_waitcnt lgkmcnt(5)
    v_mfma_f32_16x16x32_bf16 v[56:59], v[80:83], v[88:91], v[56:59]
    v_mfma_f32_16x16x32_bf16 v[52:55], v[84:87], v[88:91], v[52:55]
    s_waitcnt lgkmcnt(0)
    s_barrier
    v_mfma_f32_16x16x32_bf16 v[28:31], v[68:71], v[92:95], v[28:31]
    v_mfma_f32_16x16x32_bf16 v[24:27], v[72:75], v[92:95], v[24:27]
    v_mfma_f32_16x16x32_bf16 v[20:23], v[76:79], v[92:95], v[20:23]
    buffer_load_dwordx4 v[68:71], v125, s[12:15], s23 offen offset:2048
    v_mfma_f32_16x16x32_bf16 v[60:63], v[80:83], v[96:99], v[60:63]
    v_mfma_f32_16x16x32_bf16 v[56:59], v[84:87], v[96:99], v[56:59]
    buffer_load_dwordx4 v[80:83], v119, s[12:15], s23 offen offset:0
    v_mfma_f32_16x16x32_bf16 v[28:31], v[72:75], v[100:103], v[28:31]
    v_mfma_f32_16x16x32_bf16 v[24:27], v[76:79], v[100:103], v[24:27]
    buffer_load_dwordx4 v[72:75], v125, s[12:15], s26 offen offset:0
    v_mfma_f32_16x16x32_bf16 v[60:63], v[84:87], v[104:107], v[60:63]
    buffer_load_dwordx4 v[84:87], v119, s[12:15], s23 offen offset:2048
    v_mfma_f32_16x16x32_bf16 v[28:31], v[76:79], v[108:111], v[28:31]
    buffer_load_dwordx4 v[76:79], v125, s[12:15], s26 offen offset:2048
    s_add_u32 s23, s23, 57344
    s_add_u32 s26, s26, 57344
    s_branch L_conv2_kernel_mloop2
L_conv2_kernel_mlast2:
    v_and_b32 v125, 15, v127
    v_and_b32 v126, 7, v127
    v_lshlrev_b32 v126, 4, v126
    v_lshl_add_u32 v125, v125, 7, v126
    v_lshrrev_b32 v126, 4, v127
    v_lshl_add_u32 v125, v126, 11, v125
    s_mov_b32 s36, 65536
    s_cmp_eq_u32 s32, 1
    s_cselect_b32 s36, 121856, s36
    s_cmp_eq_u32 s32, 2
    s_cselect_b32 s36, 81920, s36
    s_cmp_eq_u32 s32, 3
    s_cselect_b32 s36, 130048, s36
    s_mov_b32 s37, 98304
    s_cmp_eq_u32 s32, 1
    s_cselect_b32 s37, 138240, s37
    s_cmp_eq_u32 s32, 2
    s_cselect_b32 s37, 146432, s37
    s_cmp_eq_u32 s32, 3
    s_cselect_b32 s37, 154624, s37
    v_add_u32 v126, s37, v125
    v_add_u32 v125, s36, v125
    ds_read_b128 v[88:91], v120 offset:8192
    ds_read_b128 v[92:95], v120 offset:9216
    ds_read_b128 v[96:99], v116 offset:8704
    ds_read_b128 v[100:103], v120 offset:10240
    ds_read_b128 v[104:107], v116 offset:9792
    ds_read_b128 v[108:111], v120 offset:11264
    ds_read_b128 v[112:115], v116 offset:10880
    s_waitcnt vmcnt(5) lgkmcnt(6)
    v_mfma_f32_16x16x32_bf16 v[0:3], v[64:67], v[88:91], v[0:3]
    ds_read_b128 v[88:91], v120 offset:12288
    s_waitcnt vmcnt(4) lgkmcnt(6)
    v_mfma_f32_16x16x32_bf16 v[4:7], v[64:67], v[92:95], v[4:7]
    v_mfma_f32_16x16x32_bf16 v[0:3], v[68:71], v[92:95], v[0:3]
    ds_read_b128 v[92:95], v116 offset:11968
    s_waitcnt vmcnt(3) lgkmcnt(6)
    v_mfma_f32_16x16x32_bf16 v[32:35], v[80:83], v[96:99], v[32:35]
    ds_read_b128 v[96:99], v120 offset:13312
    s_waitcnt vmcnt(2) lgkmcnt(6)
    v_mfma_f32_16x16x32_bf16 v[8:11], v[64:67], v[100:103], v[8:11]
    v_mfma_f32_16x16x32_bf16 v[4:7], v[68:71], v[100:103], v[4:7]
    v_mfma_f32_16x16x32_bf16 v[0:3], v[72:75], v[100:103], v[0:3]
    ds_read_b128 v[100:103], v116 offset:13056
    s_waitcnt vmcnt(1) lgkmcnt(6)
    v_mfma_f32_16x16x32_bf16 v[36:39], v[80:83], v[104:107], v[36:39]
    v_mfma_f32_16x16x32_bf16 v[32:35], v[84:87], v[104:107], v[32:35]
    ds_read_b128 v[104:107], v120 offset:14336
    s_waitcnt vmcnt(0) lgkmcnt(6)
    v_mfma_f32_16x16x32_bf16 v[12:15], v[64:67], v[108:111], v[12:15]
    v_mfma_f32_16x16x32_bf16 v[8:11], v[68:71], v[108:111], v[8:11]
    v_mfma_f32_16x16x32_bf16 v[4:7], v[72:75], v[108:111], v[4:7]
    v_mfma_f32_16x16x32_bf16 v[0:3], v[76:79], v[108:111], v[0:3]
    ds_read_b128 v[108:111], v116 offset:14144
    s_waitcnt lgkmcnt(6)
    v_mfma_f32_16x16x32_bf16 v[40:43], v[80:83], v[112:115], v[40:43]
    v_mfma_f32_16x16x32_bf16 v[36:39], v[84:87], v[112:115], v[36:39]
    ds_read_b128 v[112:115], v120 offset:15360
    s_waitcnt lgkmcnt(6)
    v_mfma_f32_16x16x32_bf16 v[16:19], v[64:67], v[88:91], v[16:19]
    v_mfma_f32_16x16x32_bf16 v[12:15], v[68:71], v[88:91], v[12:15]
    v_mfma_f32_16x16x32_bf16 v[8:11], v[72:75], v[88:91], v[8:11]
    v_mfma_f32_16x16x32_bf16 v[4:7], v[76:79], v[88:91], v[4:7]
    ds_read_b128 v[88:91], v117 offset:8704
    v_xor_b32 v124, 0, v126
    ds_write_b128 v124, v[32:35]
    s_waitcnt lgkmcnt(7)
    v_mfma_f32_16x16x32_bf16 v[44:47], v[80:83], v[92:95], v[44:47]
    v_mfma_f32_16x16x32_bf16 v[40:43], v[84:87], v[92:95], v[40:43]
    ds_read_b128 v[92:95], v122 offset:0
    v_xor_b32 v123, 0, v125
    ds_write_b128 v123, v[0:3]
    s_waitcnt lgkmcnt(8)
    v_mfma_f32_16x16x32_bf16 v[20:23], v[64:67], v[96:99], v[20:23]
    v_mfma_f32_16x16x32_bf16 v[16:19], v[68:71], v[96:99], v[16:19]
    v_mfma_f32_16x16x32_bf16 v[12:15], v[72:75], v[96:99], v[12:15]
    v_mfma_f32_16x16x32_bf16 v[8:11], v[76:79], v[96:99], v[8:11]
    ds_read_b128 v[96:99], v117 offset:9792
    v_xor_b32 v123, 16, v126
    ds_write_b128 v123, v[36:39]
    s_waitcnt lgkmcnt(9)
    v_mfma_f32_16x16x32_bf16 v[48:51], v[80:83], v[100:103], v[48:51]
    v_mfma_f32_16x16x32_bf16 v[44:47], v[84:87], v[100:103], v[44:47]
    ds_read_b128 v[100:103], v121 offset:9216
    v_xor_b32 v124, 16, v125
    ds_write_b128 v124, v[4:7]
    s_waitcnt lgkmcnt(10)
    v_mfma_f32_16x16x32_bf16 v[24:27], v[64:67], v[104:107], v[24:27]
    v_mfma_f32_16x16x32_bf16 v[20:23], v[68:71], v[104:107], v[20:23]
    v_mfma_f32_16x16x32_bf16 v[16:19], v[72:75], v[104:107], v[16:19]
    v_mfma_f32_16x16x32_bf16 v[12:15], v[76:79], v[104:107], v[12:15]
    ds_read_b128 v[104:107], v118 offset:8704
    v_xor_b32 v124, 32, v126
    ds_write_b128 v124, v[40:43]
    s_waitcnt lgkmcnt(11)
    v_mfma_f32_16x16x32_bf16 v[52:55], v[80:83], v[108:111], v[52:55]
    v_mfma_f32_16x16x32_bf16 v[48:51], v[84:87], v[108:111], v[48:51]
    ds_read_b128 v[108:111], v121 offset:10240
    v_xor_b32 v123, 32, v125
    ds_write_b128 v123, v[8:11]
    s_waitcnt lgkmcnt(12)
    v_mfma_f32_16x16x32_bf16 v[28:31], v[64:67], v[112:115], v[28:31]
    v_mfma_f32_16x16x32_bf16 v[24:27], v[68:71], v[112:115], v[24:27]
    v_mfma_f32_16x16x32_bf16 v[20:23], v[72:75], v[112:115], v[20:23]
    v_mfma_f32_16x16x32_bf16 v[16:19], v[76:79], v[112:115], v[16:19]
    v_xor_b32 v123, 48, v126
    ds_write_b128 v123, v[44:47]
    s_waitcnt lgkmcnt(12)
    v_mfma_f32_16x16x32_bf16 v[56:59], v[80:83], v[88:91], v[56:59]
    v_mfma_f32_16x16x32_bf16 v[52:55], v[84:87], v[88:91], v[52:55]
    v_xor_b32 v124, 48, v125
    ds_write_b128 v124, v[12:15]
    s_waitcnt lgkmcnt(11)
    v_mfma_f32_16x16x32_bf16 v[28:31], v[68:71], v[92:95], v[28:31]
    v_mfma_f32_16x16x32_bf16 v[24:27], v[72:75], v[92:95], v[24:27]
    v_mfma_f32_16x16x32_bf16 v[20:23], v[76:79], v[92:95], v[20:23]
    v_xor_b32 v124, 64, v126
    ds_write_b128 v124, v[48:51]
    s_waitcnt lgkmcnt(10)
    v_mfma_f32_16x16x32_bf16 v[60:63], v[80:83], v[96:99], v[60:63]
    v_mfma_f32_16x16x32_bf16 v[56:59], v[84:87], v[96:99], v[56:59]
    v_xor_b32 v123, 64, v125
    ds_write_b128 v123, v[16:19]
    s_waitcnt lgkmcnt(9)
    v_mfma_f32_16x16x32_bf16 v[28:31], v[72:75], v[100:103], v[28:31]
    v_mfma_f32_16x16x32_bf16 v[24:27], v[76:79], v[100:103], v[24:27]
    v_xor_b32 v123, 80, v126
    ds_write_b128 v123, v[52:55]
    s_waitcnt lgkmcnt(8)
    v_mfma_f32_16x16x32_bf16 v[60:63], v[84:87], v[104:107], v[60:63]
    v_xor_b32 v124, 80, v125
    ds_write_b128 v124, v[20:23]
    s_waitcnt lgkmcnt(7)
    v_mfma_f32_16x16x32_bf16 v[28:31], v[76:79], v[108:111], v[28:31]
    v_xor_b32 v124, 96, v126
    ds_write_b128 v124, v[56:59]
    s_nop 7
    v_xor_b32 v123, 96, v125
    ds_write_b128 v123, v[24:27]
    v_xor_b32 v123, 112, v126
    ds_write_b128 v123, v[60:63]
    v_xor_b32 v124, 112, v125
    ds_write_b128 v124, v[28:31]
    s_setprio 0
    s_branch L_conv2_kernel_epi
L_conv2_kernel_helper:
    s_setprio 3
    v_lshlrev_b32 v8, 4, v6
    s_add_u32 s37, s33, 4294967289
    v_lshl_add_u32 v9, v7, 3, s37
    v_cmp_gt_u32 vcc, 8000, v9
    s_mul_i32 s37, s33, 131072
    s_add_u32 s37, s37, 0
    v_lshl_add_u32 v92, v7, 7, s37
    v_add_u32 v92, v92, v8
    v_mov_b32 v9, 2130706432
    v_cndmask_b32 v92, v9, v92, vcc
    s_add_u32 s37, s33, 4294967291
    v_lshl_add_u32 v9, v7, 3, s37
    v_cmp_gt_u32 vcc, 8000, v9
    s_mul_i32 s37, s33, 131072
    s_add_u32 s37, s37, 262144
    v_lshl_add_u32 v93, v7, 7, s37
    v_add_u32 v93, v93, v8
    v_mov_b32 v9, 2130706432
    v_cndmask_b32 v93, v9, v93, vcc
    s_add_u32 s37, s33, 4294967293
    v_lshl_add_u32 v9, v7, 3, s37
    v_cmp_gt_u32 vcc, 8000, v9
    s_mul_i32 s37, s33, 131072
    s_add_u32 s37, s37, 64
    v_lshl_add_u32 v94, v7, 7, s37
    v_add_u32 v94, v94, v8
    v_mov_b32 v9, 2130706432
    v_cndmask_b32 v94, v9, v94, vcc
    s_add_u32 s37, s33, 4294967295
    v_lshl_add_u32 v9, v7, 3, s37
    v_cmp_gt_u32 vcc, 8000, v9
    s_mul_i32 s37, s33, 131072
    s_add_u32 s37, s37, 262208
    v_lshl_add_u32 v95, v7, 7, s37
    v_add_u32 v95, v95, v8
    v_mov_b32 v9, 2130706432
    v_cndmask_b32 v95, v9, v95, vcc
    v_and_b32 v76, 4, v5
    v_lshrrev_b32 v76, 1, v76
    v_xor_b32 v76, v6, v76
    v_lshlrev_b32 v76, 4, v76
    v_lshl_add_u32 v76, v5, 6, v76
    s_mov_b32 s24, 0
    s_mov_b32 s27, 524288
    buffer_load_dwordx4 v[0:3], v92, s[8:11], s24 offen
    buffer_load_dwordx4 v[8:11], v94, s[8:11], s24 offen
    buffer_load_dwordx4 v[4:7], v93, s[8:11], s24 offen
    buffer_load_dwordx4 v[12:15], v95, s[8:11], s24 offen
    buffer_load_dwordx4 v[16:19], v92, s[8:11], s27 offen
    buffer_load_dwordx4 v[24:27], v94, s[8:11], s27 offen
    buffer_load_dwordx4 v[20:23], v93, s[8:11], s27 offen
    buffer_load_dwordx4 v[28:31], v95, s[8:11], s27 offen
    s_barrier
    s_mul_i32 s36, s42, 1024
    v_add_u32 v96, s36, v76
    v_add_u32 v97, 65536, v96
    s_mul_i32 s36, s42, 1088
    s_add_u32 s36, s36, 98304
    v_add_u32 v98, s36, v76
    s_waitcnt vmcnt(0)
    s_mov_b32 s28, 0
    s_mov_b32 s22, 2
    s_cmp_ge_u32 s20, 12
    s_cbranch_scc1 L_conv2_kernel_h2
    ds_write_b128 v96, v[0:3] offset:0
    ds_write_b128 v98, v[12:15] offset:0
    v_lshlrev_b32 v76, 16, v0
    v_and_b32 v84, s25, v0
    v_lshlrev_b32 v77, 16, v4
    v_and_b32 v85, s25, v4
    v_lshlrev_b32 v78, 16, v8
    v_and_b32 v86, s25, v8
    v_lshlrev_b32 v79, 16, v12
    v_and_b32 v87, s25, v12
    v_add_f32 v80, v76, v78
    v_add_f32 v88, v84, v86
    v_add_f32 v81, v77, v79
    v_add_f32 v89, v85, v87
    v_fma_f32 v82, v78, 4.0, v76
    v_fma_f32 v90, v86, 4.0, v84
    v_fma_f32 v83, v79, 4.0, v77
    v_fma_f32 v91, v87, 4.0, v85
    v_add_f32 v77, v80, v81
    v_add_f32 v85, v88, v89
    v_sub_f32 v78, v80, v81
    v_sub_f32 v86, v88, v89
    v_fma_f32 v79, v83, 2.0, v82
    v_fma_f32 v87, v91, 2.0, v90
    v_fma_f32 v82, v83, -2.0, v82
    v_fma_f32 v90, v91, -2.0, v90
    v_fmamk_f32 v80, v76, 0x41700000, v82
    v_fmamk_f32 v88, v84, 0x41700000, v90
    v_fmamk_f32 v80, v81, 0x41200000, v80
    v_fmamk_f32 v88, v89, 0x41200000, v88
    v_cvt_pk_bf16_f32 v4, v77, v85
    v_cvt_pk_bf16_f32 v8, v78, v86
    v_cvt_pk_bf16_f32 v64, v79, v87
    v_cvt_pk_bf16_f32 v68, v82, v90
    v_cvt_pk_bf16_f32 v72, v80, v88
    v_lshlrev_b32 v76, 16, v1
    v_and_b32 v84, s25, v1
    v_lshlrev_b32 v77, 16, v5
    v_and_b32 v85, s25, v5
    v_lshlrev_b32 v78, 16, v9
    v_and_b32 v86, s25, v9
    v_lshlrev_b32 v79, 16, v13
    v_and_b32 v87, s25, v13
    v_add_f32 v80, v76, v78
    v_add_f32 v88, v84, v86
    v_add_f32 v81, v77, v79
    v_add_f32 v89, v85, v87
    v_fma_f32 v82, v78, 4.0, v76
    v_fma_f32 v90, v86, 4.0, v84
    v_fma_f32 v83, v79, 4.0, v77
    v_fma_f32 v91, v87, 4.0, v85
    v_add_f32 v77, v80, v81
    v_add_f32 v85, v88, v89
    v_sub_f32 v78, v80, v81
    v_sub_f32 v86, v88, v89
    v_fma_f32 v79, v83, 2.0, v82
    v_fma_f32 v87, v91, 2.0, v90
    v_fma_f32 v82, v83, -2.0, v82
    v_fma_f32 v90, v91, -2.0, v90
    v_fmamk_f32 v80, v76, 0x41700000, v82
    v_fmamk_f32 v88, v84, 0x41700000, v90
    v_fmamk_f32 v80, v81, 0x41200000, v80
    v_fmamk_f32 v88, v89, 0x41200000, v88
    v_cvt_pk_bf16_f32 v5, v77, v85
    v_cvt_pk_bf16_f32 v9, v78, v86
    v_cvt_pk_bf16_f32 v65, v79, v87
    v_cvt_pk_bf16_f32 v69, v82, v90
    v_cvt_pk_bf16_f32 v73, v80, v88
    v_lshlrev_b32 v76, 16, v2
    v_and_b32 v84, s25, v2
    v_lshlrev_b32 v77, 16, v6
    v_and_b32 v85, s25, v6
    v_lshlrev_b32 v78, 16, v10
    v_and_b32 v86, s25, v10
    v_lshlrev_b32 v79, 16, v14
    v_and_b32 v87, s25, v14
    v_add_f32 v80, v76, v78
    v_add_f32 v88, v84, v86
    v_add_f32 v81, v77, v79
    v_add_f32 v89, v85, v87
    v_fma_f32 v82, v78, 4.0, v76
    v_fma_f32 v90, v86, 4.0, v84
    v_fma_f32 v83, v79, 4.0, v77
    v_fma_f32 v91, v87, 4.0, v85
    v_add_f32 v77, v80, v81
    v_add_f32 v85, v88, v89
    v_sub_f32 v78, v80, v81
    v_sub_f32 v86, v88, v89
    v_fma_f32 v79, v83, 2.0, v82
    v_fma_f32 v87, v91, 2.0, v90
    v_fma_f32 v82, v83, -2.0, v82
    v_fma_f32 v90, v91, -2.0, v90
    v_fmamk_f32 v80, v76, 0x41700000, v82
    v_fmamk_f32 v88, v84, 0x41700000, v90
    v_fmamk_f32 v80, v81, 0x41200000, v80
    v_fmamk_f32 v88, v89, 0x41200000, v88
    v_cvt_pk_bf16_f32 v6, v77, v85
    v_cvt_pk_bf16_f32 v10, v78, v86
    v_cvt_pk_bf16_f32 v66, v79, v87
    v_cvt_pk_bf16_f32 v70, v82, v90
    v_cvt_pk_bf16_f32 v74, v80, v88
    v_lshlrev_b32 v76, 16, v3
    v_and_b32 v84, s25, v3
    v_lshlrev_b32 v77, 16, v7
    v_and_b32 v85, s25, v7
    v_lshlrev_b32 v78, 16, v11
    v_and_b32 v86, s25, v11
    v_lshlrev_b32 v79, 16, v15
    v_and_b32 v87, s25, v15
    v_add_f32 v80, v76, v78
    v_add_f32 v88, v84, v86
    v_add_f32 v81, v77, v79
    v_add_f32 v89, v85, v87
    v_fma_f32 v82, v78, 4.0, v76
    v_fma_f32 v90, v86, 4.0, v84
    v_fma_f32 v83, v79, 4.0, v77
    v_fma_f32 v91, v87, 4.0, v85
    v_add_f32 v77, v80, v81
    v_add_f32 v85, v88, v89
    v_sub_f32 v78, v80, v81
    v_sub_f32 v86, v88, v89
    v_fma_f32 v79, v83, 2.0, v82
    v_fma_f32 v87, v91, 2.0, v90
    v_fma_f32 v82, v83, -2.0, v82
    v_fma_f32 v90, v91, -2.0, v90
    v_fmamk_f32 v80, v76, 0x41700000, v82
    v_fmamk_f32 v88, v84, 0x41700000, v90
    v_fmamk_f32 v80, v81, 0x41200000, v80
    v_fmamk_f32 v88, v89, 0x41200000, v88
    v_cvt_pk_bf16_f32 v7, v77, v85
    v_cvt_pk_bf16_f32 v11, v78, v86
    v_cvt_pk_bf16_f32 v67, v79, v87
    v_cvt_pk_bf16_f32 v71, v82, v90
    v_cvt_pk_bf16_f32 v75, v80, v88
    ds_write_b128 v96, v[64:67] offset:49152
    ds_write_b128 v97, v[68:71] offset:0
    ds_write_b128 v97, v[72:75] offset:16384
    ds_write_b128 v96, v[4:7] offset:16384
    ds_write_b128 v96, v[8:11] offset:32768
    s_waitcnt vmcnt(0)
    s_mov_b32 s24, 1048576
    s_mov_b32 s27, 1572864
    buffer_load_dwordx4 v[32:35], v92, s[8:11], s24 offen
    buffer_load_dwordx4 v[40:43], v94, s[8:11], s24 offen
    buffer_load_dwordx4 v[36:39], v93, s[8:11], s24 offen
    buffer_load_dwordx4 v[44:47], v95, s[8:11], s24 offen
    s_waitcnt lgkmcnt(0)
    s_barrier
    s_setprio 1
L_conv2_kernel_hloop1:
    v_lshlrev_b32 v76, 16, v16
    v_and_b32 v84, s25, v16
    v_lshlrev_b32 v77, 16, v20
    v_and_b32 v85, s25, v20
    v_lshlrev_b32 v78, 16, v24
    v_and_b32 v86, s25, v24
    v_lshlrev_b32 v79, 16, v28
    v_and_b32 v87, s25, v28
    v_add_f32 v80, v76, v78
    v_add_f32 v88, v84, v86
    v_add_f32 v81, v77, v79
    v_add_f32 v89, v85, v87
    v_fma_f32 v82, v78, 4.0, v76
    buffer_load_dwordx4 v[48:51], v92, s[8:11], s27 offen
    buffer_load_dwordx4 v[56:59], v94, s[8:11], s27 offen
    v_fma_f32 v90, v86, 4.0, v84
    v_fma_f32 v83, v79, 4.0, v77
    v_fma_f32 v91, v87, 4.0, v85
    v_add_f32 v77, v80, v81
    v_add_f32 v85, v88, v89
    v_sub_f32 v78, v80, v81
    v_sub_f32 v86, v88, v89
    v_fma_f32 v79, v83, 2.0, v82
    v_fma_f32 v87, v91, 2.0, v90
    v_fma_f32 v82, v83, -2.0, v82
    v_fma_f32 v90, v91, -2.0, v90
    v_fmamk_f32 v80, v76, 0x41700000, v82
    v_fmamk_f32 v88, v84, 0x41700000, v90
    v_fmamk_f32 v80, v81, 0x41200000, v80
    v_fmamk_f32 v88, v89, 0x41200000, v88
    v_cvt_pk_bf16_f32 v20, v77, v85
    v_cvt_pk_bf16_f32 v24, v78, v86
    v_cvt_pk_bf16_f32 v64, v79, v87
    v_cvt_pk_bf16_f32 v68, v82, v90
    v_cvt_pk_bf16_f32 v72, v80, v88
    v_lshlrev_b32 v76, 16, v17
    v_and_b32 v84, s25, v17
    v_lshlrev_b32 v77, 16, v21
    v_and_b32 v85, s25, v21
    v_lshlrev_b32 v78, 16, v25
    v_and_b32 v86, s25, v25
    v_lshlrev_b32 v79, 16, v29
    v_and_b32 v87, s25, v29
    v_add_f32 v80, v76, v78
    v_add_f32 v88, v84, v86
    v_add_f32 v81, v77, v79
    v_add_f32 v89, v85, v87
    v_fma_f32 v82, v78, 4.0, v76
    v_fma_f32 v90, v86, 4.0, v84
    v_fma_f32 v83, v79, 4.0, v77
    v_fma_f32 v91, v87, 4.0, v85
    v_add_f32 v77, v80, v81
    v_add_f32 v85, v88, v89
    v_sub_f32 v78, v80, v81
    v_sub_f32 v86, v88, v89
    v_fma_f32 v79, v83, 2.0, v82
    v_fma_f32 v87, v91, 2.0, v90
    v_fma_f32 v82, v83, -2.0, v82
    v_fma_f32 v90, v91, -2.0, v90
    v_fmamk_f32 v80, v76, 0x41700000, v82
    v_fmamk_f32 v88, v84, 0x41700000, v90
    v_fmamk_f32 v80, v81, 0x41200000, v80
    v_fmamk_f32 v88, v89, 0x41200000, v88
    v_cvt_pk_bf16_f32 v21, v77, v85
    v_cvt_pk_bf16_f32 v25, v78, v86
    v_cvt_pk_bf16_f32 v65, v79, v87
    v_cvt_pk_bf16_f32 v69, v82, v90
    v_cvt_pk_bf16_f32 v73, v80, v88
    buffer_load_dwordx4 v[52:55], v93, s[8:11], s27 offen
    buffer_load_dwordx4 v[60:63], v95, s[8:11], s27 offen
    v_lshlrev_b32 v76, 16, v18
    v_and_b32 v84, s25, v18
    v_lshlrev_b32 v77, 16, v22
    v_and_b32 v85, s25, v22
    v_lshlrev_b32 v78, 16, v26
    v_and_b32 v86, s25, v26
    v_lshlrev_b32 v79, 16, v30
    v_and_b32 v87, s25, v30
    v_add_f32 v80, v76, v78
    v_add_f32 v88, v84, v86
    v_add_f32 v81, v77, v79
    v_add_f32 v89, v85, v87
    v_fma_f32 v82, v78, 4.0, v76
    v_fma_f32 v90, v86, 4.0, v84
    v_fma_f32 v83, v79, 4.0, v77
    v_fma_f32 v91, v87, 4.0, v85
    v_add_f32 v77, v80, v81
    v_add_f32 v85, v88, v89
    v_sub_f32 v78, v80, v81
    v_sub_f32 v86, v88, v89
    v_fma_f32 v79, v83, 2.0, v82
    v_fma_f32 v87, v91, 2.0, v90
    v_fma_f32 v82, v83, -2.0, v82
    v_fma_f32 v90, v91, -2.0, v90
    v_fmamk_f32 v80, v76, 0x41700000, v82
    v_fmamk_f32 v88, v84, 0x41700000, v90
    v_fmamk_f32 v80, v81, 0x41200000, v80
    v_fmamk_f32 v88, v89, 0x41200000, v88
    v_cvt_pk_bf16_f32 v22, v77, v85
    v_cvt_pk_bf16_f32 v26, v78, v86
    v_cvt_pk_bf16_f32 v66, v79, v87
    v_cvt_pk_bf16_f32 v70, v82, v90
    v_cvt_pk_bf16_f32 v74, v80, v88
    v_lshlrev_b32 v76, 16, v19
    v_and_b32 v84, s25, v19
    v_lshlrev_b32 v77, 16, v23
    v_and_b32 v85, s25, v23
    v_lshlrev_b32 v78, 16, v27
    v_and_b32 v86, s25, v27
    v_lshlrev_b32 v79, 16, v31
    v_and_b32 v87, s25, v31
    v_add_f32 v80, v76, v78
    v_add_f32 v88, v84, v86
    v_add_f32 v81, v77, v79
    v_add_f32 v89, v85, v87
    v_fma_f32 v82, v78, 4.0, v76
    v_fma_f32 v90, v86, 4.0, v84
    v_fma_f32 v83, v79, 4.0, v77
    v_fma_f32 v91, v87, 4.0, v85
    v_add_f32 v77, v80, v81
    v_add_f32 v85, v88, v89
    v_sub_f32 v78, v80, v81
    v_sub_f32 v86, v88, v89
    v_fma_f32 v79, v83, 2.0, v82
    v_fma_f32 v87, v91, 2.0, v90
    v_fma_f32 v82, v83, -2.0, v82
    v_fma_f32 v90, v91, -2.0, v90
    v_fmamk_f32 v80, v76, 0x41700000, v82
    v_fmamk_f32 v88, v84, 0x41700000, v90
    v_fmamk_f32 v80, v81, 0x41200000, v80
    v_fmamk_f32 v88, v89, 0x41200000, v88
    v_cvt_pk_bf16_f32 v23, v77, v85
    v_cvt_pk_bf16_f32 v27, v78, v86
    v_cvt_pk_bf16_f32 v67, v79, v87
    v_cvt_pk_bf16_f32 v71, v82, v90
    v_cvt_pk_bf16_f32 v75, v80, v88
    ds_write_b128 v96, v[64:67] offset:57344
    ds_write_b128 v97, v[68:71] offset:8192
    ds_write_b128 v97, v[72:75] offset:24576
    ds_write_b128 v96, v[16:19] offset:8192
    ds_write_b128 v96, v[20:23] offset:24576
    ds_write_b128 v96, v[24:27] offset:40960
    ds_write_b128 v98, v[28:31] offset:8704
    s_add_u32 s28, s28, 1
    s_waitcnt lgkmcnt(0)
    s_barrier
    s_add_u32 s24, s24, 1048576
    s_add_u32 s27, s27, 1048576
    s_waitcnt vmcnt(0)
    v_lshlrev_b32 v76, 16, v32
    v_and_b32 v84, s25, v32
    v_lshlrev_b32 v77, 16, v36
    v_and_b32 v85, s25, v36
    v_lshlrev_b32 v78, 16, v40
    v_and_b32 v86, s25, v40
    v_lshlrev_b32 v79, 16, v44
    v_and_b32 v87, s25, v44
    v_add_f32 v80, v76, v78
    v_add_f32 v88, v84, v86
    v_add_f32 v81, v77, v79
    v_add_f32 v89, v85, v87
    v_fma_f32 v82, v78, 4.0, v76
    v_fma_f32 v90, v86, 4.0, v84
    v_fma_f32 v83, v79, 4.0, v77
    v_fma_f32 v91, v87, 4.0, v85
    v_add_f32 v77, v80, v81
    v_add_f32 v85, v88, v89
    v_sub_f32 v78, v80, v81
    v_sub_f32 v86, v88, v89
    v_fma_f32 v79, v83, 2.0, v82
    v_fma_f32 v87, v91, 2.0, v90
    v_fma_f32 v82, v83, -2.0, v82
    v_fma_f32 v90, v91, -2.0, v90
    v_fmamk_f32 v80, v76, 0x41700000, v82
    v_fmamk_f32 v88, v84, 0x41700000, v90
    v_fmamk_f32 v80, v81, 0x41200000, v80
    v_fmamk_f32 v88, v89, 0x41200000, v88
    v_cvt_pk_bf16_f32 v36, v77, v85
    v_cvt_pk_bf16_f32 v40, v78, v86
    v_cvt_pk_bf16_f32 v64, v79, v87
    v_cvt_pk_bf16_f32 v68, v82, v90
    v_cvt_pk_bf16_f32 v72, v80, v88
    v_lshlrev_b32 v76, 16, v33
    v_and_b32 v84, s25, v33
    v_lshlrev_b32 v77, 16, v37
    v_and_b32 v85, s25, v37
    v_lshlrev_b32 v78, 16, v41
    v_and_b32 v86, s25, v41
    buffer_load_dwordx4 v[0:3], v92, s[8:11], s24 offen
    buffer_load_dwordx4 v[8:11], v94, s[8:11], s24 offen
    v_lshlrev_b32 v79, 16, v45
    v_and_b32 v87, s25, v45
    v_add_f32 v80, v76, v78
    v_add_f32 v88, v84, v86
    v_add_f32 v81, v77, v79
    v_add_f32 v89, v85, v87
    v_fma_f32 v82, v78, 4.0, v76
    v_fma_f32 v90, v86, 4.0, v84
    v_fma_f32 v83, v79, 4.0, v77
    v_fma_f32 v91, v87, 4.0, v85
    v_add_f32 v77, v80, v81
    v_add_f32 v85, v88, v89
    v_sub_f32 v78, v80, v81
    v_sub_f32 v86, v88, v89
    v_fma_f32 v79, v83, 2.0, v82
    v_fma_f32 v87, v91, 2.0, v90
    v_fma_f32 v82, v83, -2.0, v82
    v_fma_f32 v90, v91, -2.0, v90
    v_fmamk_f32 v80, v76, 0x41700000, v82
    v_fmamk_f32 v88, v84, 0x41700000, v90
    v_fmamk_f32 v80, v81, 0x41200000, v80
    v_fmamk_f32 v88, v89, 0x41200000, v88
    v_cvt_pk_bf16_f32 v37, v77, v85
    v_cvt_pk_bf16_f32 v41, v78, v86
    v_cvt_pk_bf16_f32 v65, v79, v87
    v_cvt_pk_bf16_f32 v69, v82, v90
    v_cvt_pk_bf16_f32 v73, v80, v88
    v_lshlrev_b32 v76, 16, v34
    v_and_b32 v84, s25, v34
    v_lshlrev_b32 v77, 16, v38
    v_and_b32 v85, s25, v38
    v_lshlrev_b32 v78, 16, v42
    v_and_b32 v86, s25, v42
    v_lshlrev_b32 v79, 16, v46
    v_and_b32 v87, s25, v46
    v_add_f32 v80, v76, v78
    v_add_f32 v88, v84, v86
    v_add_f32 v81, v77, v79
    v_add_f32 v89, v85, v87
    v_fma_f32 v82, v78, 4.0, v76
    v_fma_f32 v90, v86, 4.0, v84
    v_fma_f32 v83, v79, 4.0, v77
    v_fma_f32 v91, v87, 4.0, v85
    v_add_f32 v77, v80, v81
    v_add_f32 v85, v88, v89
    v_sub_f32 v78, v80, v81
    v_sub_f32 v86, v88, v89
    v_fma_f32 v79, v83, 2.0, v82
    v_fma_f32 v87, v91, 2.0, v90
    v_fma_f32 v82, v83, -2.0, v82
    v_fma_f32 v90, v91, -2.0, v90
    v_fmamk_f32 v80, v76, 0x41700000, v82
    v_fmamk_f32 v88, v84, 0x41700000, v90
    buffer_load_dwordx4 v[4:7], v93, s[8:11], s24 offen
    buffer_load_dwordx4 v[12:15], v95, s[8:11], s24 offen
    v_fmamk_f32 v80, v81, 0x41200000, v80
    v_fmamk_f32 v88, v89, 0x41200000, v88
    v_cvt_pk_bf16_f32 v38, v77, v85
    v_cvt_pk_bf16_f32 v42, v78, v86
    v_cvt_pk_bf16_f32 v66, v79, v87
    v_cvt_pk_bf16_f32 v70, v82, v90
    v_cvt_pk_bf16_f32 v74, v80, v88
    v_lshlrev_b32 v76, 16, v35
    v_and_b32 v84, s25, v35
    v_lshlrev_b32 v77, 16, v39
    v_and_b32 v85, s25, v39
    v_lshlrev_b32 v78, 16, v43
    v_and_b32 v86, s25, v43
    v_lshlrev_b32 v79, 16, v47
    v_and_b32 v87, s25, v47
    v_add_f32 v80, v76, v78
    v_add_f32 v88, v84, v86
    v_add_f32 v81, v77, v79
    v_add_f32 v89, v85, v87
    v_fma_f32 v82, v78, 4.0, v76
    v_fma_f32 v90, v86, 4.0, v84
    v_fma_f32 v83, v79, 4.0, v77
    v_fma_f32 v91, v87, 4.0, v85
    v_add_f32 v77, v80, v81
    v_add_f32 v85, v88, v89
    v_sub_f32 v78, v80, v81
    v_sub_f32 v86, v88, v89
    v_fma_f32 v79, v83, 2.0, v82
    v_fma_f32 v87, v91, 2.0, v90
    v_fma_f32 v82, v83, -2.0, v82
    v_fma_f32 v90, v91, -2.0, v90
    v_fmamk_f32 v80, v76, 0x41700000, v82
    v_fmamk_f32 v88, v84, 0x41700000, v90
    v_fmamk_f32 v80, v81, 0x41200000, v80
    v_fmamk_f32 v88, v89, 0x41200000, v88
    v_cvt_pk_bf16_f32 v39, v77, v85
    v_cvt_pk_bf16_f32 v43, v78, v86
    v_cvt_pk_bf16_f32 v67, v79, v87
    v_cvt_pk_bf16_f32 v71, v82, v90
    v_cvt_pk_bf16_f32 v75, v80, v88
    ds_write_b128 v96, v[64:67] offset:49152
    ds_write_b128 v97, v[68:71] offset:0
    ds_write_b128 v97, v[72:75] offset:16384
    ds_write_b128 v96, v[32:35] offset:0
    ds_write_b128 v96, v[36:39] offset:16384
    ds_write_b128 v96, v[40:43] offset:32768
    ds_write_b128 v98, v[44:47] offset:0
    s_add_u32 s28, s28, 1
    s_waitcnt lgkmcnt(0)
    s_barrier
    v_lshlrev_b32 v76, 16, v48
    v_and_b32 v84, s25, v48
    v_lshlrev_b32 v77, 16, v52
    v_and_b32 v85, s25, v52
    v_lshlrev_b32 v78, 16, v56
    v_and_b32 v86, s25, v56
    v_lshlrev_b32 v79, 16, v60
    v_and_b32 v87, s25, v60
    v_add_f32 v80, v76, v78
    v_add_f32 v88, v84, v86
    v_add_f32 v81, v77, v79
    v_add_f32 v89, v85, v87
    v_fma_f32 v82, v78, 4.0, v76
    buffer_load_dwordx4 v[16:19], v92, s[8:11], s27 offen
    buffer_load_dwordx4 v[24:27], v94, s[8:11], s27 offen
    v_fma_f32 v90, v86, 4.0, v84
    v_fma_f32 v83, v79, 4.0, v77
    v_fma_f32 v91, v87, 4.0, v85
    v_add_f32 v77, v80, v81
    v_add_f32 v85, v88, v89
    v_sub_f32 v78, v80, v81
    v_sub_f32 v86, v88, v89
    v_fma_f32 v79, v83, 2.0, v82
    v_fma_f32 v87, v91, 2.0, v90
    v_fma_f32 v82, v83, -2.0, v82
    v_fma_f32 v90, v91, -2.0, v90
    v_fmamk_f32 v80, v76, 0x41700000, v82
    v_fmamk_f32 v88, v84, 0x41700000, v90
    v_fmamk_f32 v80, v81, 0x41200000, v80
    v_fmamk_f32 v88, v89, 0x41200000, v88
    v_cvt_pk_bf16_f32 v52, v77, v85
    v_cvt_pk_bf16_f32 v56, v78, v86
    v_cvt_pk_bf16_f32 v64, v79, v87
    v_cvt_pk_bf16_f32 v68, v82, v90
    v_cvt_pk_bf16_f32 v72, v80, v88
    v_lshlrev_b32 v76, 16, v49
    v_and_b32 v84, s25, v49
    v_lshlrev_b32 v77, 16, v53
    v_and_b32 v85, s25, v53
    v_lshlrev_b32 v78, 16, v57
    v_and_b32 v86, s25, v57
    v_lshlrev_b32 v79, 16, v61
    v_and_b32 v87, s25, v61
    v_add_f32 v80, v76, v78
    v_add_f32 v88, v84, v86
    v_add_f32 v81, v77, v79
    v_add_f32 v89, v85, v87
    v_fma_f32 v82, v78, 4.0, v76
    v_fma_f32 v90, v86, 4.0, v84
    v_fma_f32 v83, v79, 4.0, v77
    v_fma_f32 v91, v87, 4.0, v85
    v_add_f32 v77, v80, v81
    v_add_f32 v85, v88, v89
    v_sub_f32 v78, v80, v81
    v_sub_f32 v86, v88, v89
    v_fma_f32 v79, v83, 2.0, v82
    v_fma_f32 v87, v91, 2.0, v90
    v_fma_f32 v82, v83, -2.0, v82
    v_fma_f32 v90, v91, -2.0, v90
    v_fmamk_f32 v80, v76, 0x41700000, v82
    v_fmamk_f32 v88, v84, 0x41700000, v90
    v_fmamk_f32 v80, v81, 0x41200000, v80
    v_fmamk_f32 v88, v89, 0x41200000, v88
    v_cvt_pk_bf16_f32 v53, v77, v85
    v_cvt_pk_bf16_f32 v57, v78, v86
    v_cvt_pk_bf16_f32 v65, v79, v87
    v_cvt_pk_bf16_f32 v69, v82, v90
    v_cvt_pk_bf16_f32 v73, v80, v88
    buffer_load_dwordx4 v[20:23], v93, s[8:11], s27 offen
    buffer_load_dwordx4 v[28:31], v95, s[8:11], s27 offen
    v_lshlrev_b32 v76, 16, v50
    v_and_b32 v84, s25, v50
    v_lshlrev_b32 v77, 16, v54
    v_and_b32 v85, s25, v54
    v_lshlrev_b32 v78, 16, v58
    v_and_b32 v86, s25, v58
    v_lshlrev_b32 v79, 16, v62
    v_and_b32 v87, s25, v62
    v_add_f32 v80, v76, v78
    v_add_f32 v88, v84, v86
    v_add_f32 v81, v77, v79
    v_add_f32 v89, v85, v87
    v_fma_f32 v82, v78, 4.0, v76
    v_fma_f32 v90, v86, 4.0, v84
    v_fma_f32 v83, v79, 4.0, v77
    v_fma_f32 v91, v87, 4.0, v85
    v_add_f32 v77, v80, v81
    v_add_f32 v85, v88, v89
    v_sub_f32 v78, v80, v81
    v_sub_f32 v86, v88, v89
    v_fma_f32 v79, v83, 2.0, v82
    v_fma_f32 v87, v91, 2.0, v90
    v_fma_f32 v82, v83, -2.0, v82
    v_fma_f32 v90, v91, -2.0, v90
    v_fmamk_f32 v80, v76, 0x41700000, v82
    v_fmamk_f32 v88, v84, 0x41700000, v90
    v_fmamk_f32 v80, v81, 0x41200000, v80
    v_fmamk_f32 v88, v89, 0x41200000, v88
    v_cvt_pk_bf16_f32 v54, v77, v85
    v_cvt_pk_bf16_f32 v58, v78, v86
    v_cvt_pk_bf16_f32 v66, v79, v87
    v_cvt_pk_bf16_f32 v70, v82, v90
    v_cvt_pk_bf16_f32 v74, v80, v88
    v_lshlrev_b32 v76, 16, v51
    v_and_b32 v84, s25, v51
    v_lshlrev_b32 v77, 16, v55
    v_and_b32 v85, s25, v55
    v_lshlrev_b32 v78, 16, v59
    v_and_b32 v86, s25, v59
    v_lshlrev_b32 v79, 16, v63
    v_and_b32 v87, s25, v63
    v_add_f32 v80, v76, v78
    v_add_f32 v88, v84, v86
    v_add_f32 v81, v77, v79
    v_add_f32 v89, v85, v87
    v_fma_f32 v82, v78, 4.0, v76
    v_fma_f32 v90, v86, 4.0, v84
    v_fma_f32 v83, v79, 4.0, v77
    v_fma_f32 v91, v87, 4.0, v85
    v_add_f32 v77, v80, v81
    v_add_f32 v85, v88, v89
    v_sub_f32 v78, v80, v81
    v_sub_f32 v86, v88, v89
    v_fma_f32 v79, v83, 2.0, v82
    v_fma_f32 v87, v91, 2.0, v90
    v_fma_f32 v82, v83, -2.0, v82
    v_fma_f32 v90, v91, -2.0, v90
    v_fmamk_f32 v80, v76, 0x41700000, v82
    v_fmamk_f32 v88, v84, 0x41700000, v90
    v_fmamk_f32 v80, v81, 0x41200000, v80
    v_fmamk_f32 v88, v89, 0x41200000, v88
    v_cvt_pk_bf16_f32 v55, v77, v85
    v_cvt_pk_bf16_f32 v59, v78, v86
    v_cvt_pk_bf16_f32 v67, v79, v87
    v_cvt_pk_bf16_f32 v71, v82, v90
    v_cvt_pk_bf16_f32 v75, v80, v88
    ds_write_b128 v96, v[64:67] offset:57344
    ds_write_b128 v97, v[68:71] offset:8192
    ds_write_b128 v97, v[72:75] offset:24576
    ds_write_b128 v96, v[48:51] offset:8192
    ds_write_b128 v96, v[52:55] offset:24576
    ds_write_b128 v96, v[56:59] offset:40960
    ds_write_b128 v98, v[60:63] offset:8704
    s_add_u32 s28, s28, 1
    s_waitcnt lgkmcnt(0)
    s_barrier
    s_cmp_eq_u32 s22, 1
    s_cbranch_scc1 L_conv2_kernel_hlast1
    s_add_u32 s24, s24, 1048576
    s_add_u32 s27, s27, 1048576
    s_waitcnt vmcnt(0)
    v_lshlrev_b32 v76, 16, v0
    v_and_b32 v84, s25, v0
    v_lshlrev_b32 v77, 16, v4
    v_and_b32 v85, s25, v4
    v_lshlrev_b32 v78, 16, v8
    v_and_b32 v86, s25, v8
    v_lshlrev_b32 v79, 16, v12
    v_and_b32 v87, s25, v12
    v_add_f32 v80, v76, v78
    v_add_f32 v88, v84, v86
    v_add_f32 v81, v77, v79
    v_add_f32 v89, v85, v87
    v_fma_f32 v82, v78, 4.0, v76
    v_fma_f32 v90, v86, 4.0, v84
    v_fma_f32 v83, v79, 4.0, v77
    v_fma_f32 v91, v87, 4.0, v85
    v_add_f32 v77, v80, v81
    v_add_f32 v85, v88, v89
    v_sub_f32 v78, v80, v81
    v_sub_f32 v86, v88, v89
    v_fma_f32 v79, v83, 2.0, v82
    v_fma_f32 v87, v91, 2.0, v90
    v_fma_f32 v82, v83, -2.0, v82
    v_fma_f32 v90, v91, -2.0, v90
    v_fmamk_f32 v80, v76, 0x41700000, v82
    v_fmamk_f32 v88, v84, 0x41700000, v90
    v_fmamk_f32 v80, v81, 0x41200000, v80
    v_fmamk_f32 v88, v89, 0x41200000, v88
    v_cvt_pk_bf16_f32 v4, v77, v85
    v_cvt_pk_bf16_f32 v8, v78, v86
    v_cvt_pk_bf16_f32 v64, v79, v87
    v_cvt_pk_bf16_f32 v68, v82, v90
    v_cvt_pk_bf16_f32 v72, v80, v88
    v_lshlrev_b32 v76, 16, v1
    v_and_b32 v84, s25, v1
    v_lshlrev_b32 v77, 16, v5
    v_and_b32 v85, s25, v5
    v_lshlrev_b32 v78, 16, v9
    v_and_b32 v86, s25, v9
    buffer_load_dwordx4 v[32:35], v92, s[8:11], s24 offen
    buffer_load_dwordx4 v[40:43], v94, s[8:11], s24 offen
    v_lshlrev_b32 v79, 16, v13
    v_and_b32 v87, s25, v13
    v_add_f32 v80, v76, v78
    v_add_f32 v88, v84, v86
    v_add_f32 v81, v77, v79
    v_add_f32 v89, v85, v87
    v_fma_f32 v82, v78, 4.0, v76
    v_fma_f32 v90, v86, 4.0, v84
    v_fma_f32 v83, v79, 4.0, v77
    v_fma_f32 v91, v87, 4.0, v85
    v_add_f32 v77, v80, v81
    v_add_f32 v85, v88, v89
    v_sub_f32 v78, v80, v81
    v_sub_f32 v86, v88, v89
    v_fma_f32 v79, v83, 2.0, v82
    v_fma_f32 v87, v91, 2.0, v90
    v_fma_f32 v82, v83, -2.0, v82
    v_fma_f32 v90, v91, -2.0, v90
    v_fmamk_f32 v80, v76, 0x41700000, v82
    v_fmamk_f32 v88, v84, 0x41700000, v90
    v_fmamk_f32 v80, v81, 0x41200000, v80
    v_fmamk_f32 v88, v89, 0x41200000, v88
    v_cvt_pk_bf16_f32 v5, v77, v85
    v_cvt_pk_bf16_f32 v9, v78, v86
    v_cvt_pk_bf16_f32 v65, v79, v87
    v_cvt_pk_bf16_f32 v69, v82, v90
    v_cvt_pk_bf16_f32 v73, v80, v88
    v_lshlrev_b32 v76, 16, v2
    v_and_b32 v84, s25, v2
    v_lshlrev_b32 v77, 16, v6
    v_and_b32 v85, s25, v6
    v_lshlrev_b32 v78, 16, v10
    v_and_b32 v86, s25, v10
    v_lshlrev_b32 v79, 16, v14
    v_and_b32 v87, s25, v14
    v_add_f32 v80, v76, v78
    v_add_f32 v88, v84, v86
    v_add_f32 v81, v77, v79
    v_add_f32 v89, v85, v87
    v_fma_f32 v82, v78, 4.0, v76
    v_fma_f32 v90, v86, 4.0, v84
    v_fma_f32 v83, v79, 4.0, v77
    v_fma_f32 v91, v87, 4.0, v85
    v_add_f32 v77, v80, v81
    v_add_f32 v85, v88, v89
    v_sub_f32 v78, v80, v81
    v_sub_f32 v86, v88, v89
    v_fma_f32 v79, v83, 2.0, v82
    v_fma_f32 v87, v91, 2.0, v90
    v_fma_f32 v82, v83, -2.0, v82
    v_fma_f32 v90, v91, -2.0, v90
    v_fmamk_f32 v80, v76, 0x41700000, v82
    v_fmamk_f32 v88, v84, 0x41700000, v90
    buffer_load_dwordx4 v[36:39], v93, s[8:11], s24 offen
    buffer_load_dwordx4 v[44:47], v95, s[8:11], s24 offen
    v_fmamk_f32 v80, v81, 0x41200000, v80
    v_fmamk_f32 v88, v89, 0x41200000, v88
    v_cvt_pk_bf16_f32 v6, v77, v85
    v_cvt_pk_bf16_f32 v10, v78, v86
    v_cvt_pk_bf16_f32 v66, v79, v87
    v_cvt_pk_bf16_f32 v70, v82, v90
    v_cvt_pk_bf16_f32 v74, v80, v88
    v_lshlrev_b32 v76, 16, v3
    v_and_b32 v84, s25, v3
    v_lshlrev_b32 v77, 16, v7
    v_and_b32 v85, s25, v7
    v_lshlrev_b32 v78, 16, v11
    v_and_b32 v86, s25, v11
    v_lshlrev_b32 v79, 16, v15
    v_and_b32 v87, s25, v15
    v_add_f32 v80, v76, v78
    v_add_f32 v88, v84, v86
    v_add_f32 v81, v77, v79
    v_add_f32 v89, v85, v87
    v_fma_f32 v82, v78, 4.0, v76
    v_fma_f32 v90, v86, 4.0, v84
    v_fma_f32 v83, v79, 4.0, v77
    v_fma_f32 v91, v87, 4.0, v85
    v_add_f32 v77, v80, v81
    v_add_f32 v85, v88, v89
    v_sub_f32 v78, v80, v81
    v_sub_f32 v86, v88, v89
    v_fma_f32 v79, v83, 2.0, v82
    v_fma_f32 v87, v91, 2.0, v90
    v_fma_f32 v82, v83, -2.0, v82
    v_fma_f32 v90, v91, -2.0, v90
    v_fmamk_f32 v80, v76, 0x41700000, v82
    v_fmamk_f32 v88, v84, 0x41700000, v90
    v_fmamk_f32 v80, v81, 0x41200000, v80
    v_fmamk_f32 v88, v89, 0x41200000, v88
    v_cvt_pk_bf16_f32 v7, v77, v85
    v_cvt_pk_bf16_f32 v11, v78, v86
    v_cvt_pk_bf16_f32 v67, v79, v87
    v_cvt_pk_bf16_f32 v71, v82, v90
    v_cvt_pk_bf16_f32 v75, v80, v88
    ds_write_b128 v96, v[64:67] offset:49152
    ds_write_b128 v97, v[68:71] offset:0
    ds_write_b128 v97, v[72:75] offset:16384
    ds_write_b128 v96, v[0:3] offset:0
    ds_write_b128 v96, v[4:7] offset:16384
    ds_write_b128 v96, v[8:11] offset:32768
    ds_write_b128 v98, v[12:15] offset:0
    s_add_u32 s28, s28, 1
    s_waitcnt lgkmcnt(0)
    s_barrier
    s_sub_u32 s22, s22, 1
    s_branch L_conv2_kernel_hloop1
L_conv2_kernel_hlast1:
    s_branch L_conv2_kernel_end
L_conv2_kernel_h2:
    ds_write_b128 v96, v[0:3] offset:0
    ds_write_b128 v98, v[12:15] offset:0
    v_lshlrev_b32 v76, 16, v0
    v_and_b32 v84, s25, v0
    v_lshlrev_b32 v77, 16, v4
    v_and_b32 v85, s25, v4
    v_lshlrev_b32 v78, 16, v8
    v_and_b32 v86, s25, v8
    v_lshlrev_b32 v79, 16, v12
    v_and_b32 v87, s25, v12
    v_add_f32 v80, v76, v78
    v_add_f32 v88, v84, v86
    v_add_f32 v81, v77, v79
    v_add_f32 v89, v85, v87
    v_fma_f32 v82, v78, 4.0, v76
    v_fma_f32 v90, v86, 4.0, v84
    v_fma_f32 v83, v79, 4.0, v77
    v_fma_f32 v91, v87, 4.0, v85
    v_add_f32 v77, v80, v81
    v_add_f32 v85, v88, v89
    v_sub_f32 v78, v80, v81
    v_sub_f32 v86, v88, v89
    v_fma_f32 v79, v83, 2.0, v82
    v_fma_f32 v87, v91, 2.0, v90
    v_fma_f32 v82, v83, -2.0, v82
    v_fma_f32 v90, v91, -2.0, v90
    v_fmamk_f32 v80, v76, 0x41700000, v82
    v_fmamk_f32 v88, v84, 0x41700000, v90
    v_fmamk_f32 v80, v81, 0x41200000, v80
    v_fmamk_f32 v88, v89, 0x41200000, v88
    v_cvt_pk_bf16_f32 v4, v77, v85
    v_cvt_pk_bf16_f32 v8, v78, v86
    v_cvt_pk_bf16_f32 v64, v79, v87
    v_cvt_pk_bf16_f32 v68, v82, v90
    v_cvt_pk_bf16_f32 v72, v80, v88
    v_lshlrev_b32 v76, 16, v1
    v_and_b32 v84, s25, v1
    v_lshlrev_b32 v77, 16, v5
    v_and_b32 v85, s25, v5
    v_lshlrev_b32 v78, 16, v9
    v_and_b32 v86, s25, v9
    v_lshlrev_b32 v79, 16, v13
    v_and_b32 v87, s25, v13
    v_add_f32 v80, v76, v78
    v_add_f32 v88, v84, v86
    v_add_f32 v81, v77, v79
    v_add_f32 v89, v85, v87
    v_fma_f32 v82, v78, 4.0, v76
    v_fma_f32 v90, v86, 4.0, v84
    v_fma_f32 v83, v79, 4.0, v77
    v_fma_f32 v91, v87, 4.0, v85
    v_add_f32 v77, v80, v81
    v_add_f32 v85, v88, v89
    v_sub_f32 v78, v80, v81
    v_sub_f32 v86, v88, v89
    v_fma_f32 v79, v83, 2.0, v82
    v_fma_f32 v87, v91, 2.0, v90
    v_fma_f32 v82, v83, -2.0, v82
    v_fma_f32 v90, v91, -2.0, v90
    v_fmamk_f32 v80, v76, 0x41700000, v82
    v_fmamk_f32 v88, v84, 0x41700000, v90
    v_fmamk_f32 v80, v81, 0x41200000, v80
    v_fmamk_f32 v88, v89, 0x41200000, v88
    v_cvt_pk_bf16_f32 v5, v77, v85
    v_cvt_pk_bf16_f32 v9, v78, v86
    v_cvt_pk_bf16_f32 v65, v79, v87
    v_cvt_pk_bf16_f32 v69, v82, v90
    v_cvt_pk_bf16_f32 v73, v80, v88
    v_lshlrev_b32 v76, 16, v2
    v_and_b32 v84, s25, v2
    v_lshlrev_b32 v77, 16, v6
    v_and_b32 v85, s25, v6
    v_lshlrev_b32 v78, 16, v10
    v_and_b32 v86, s25, v10
    v_lshlrev_b32 v79, 16, v14
    v_and_b32 v87, s25, v14
    v_add_f32 v80, v76, v78
    v_add_f32 v88, v84, v86
    v_add_f32 v81, v77, v79
    v_add_f32 v89, v85, v87
    v_fma_f32 v82, v78, 4.0, v76
    v_fma_f32 v90, v86, 4.0, v84
    v_fma_f32 v83, v79, 4.0, v77
    v_fma_f32 v91, v87, 4.0, v85
    v_add_f32 v77, v80, v81
    v_add_f32 v85, v88, v89
    v_sub_f32 v78, v80, v81
    v_sub_f32 v86, v88, v89
    v_fma_f32 v79, v83, 2.0, v82
    v_fma_f32 v87, v91, 2.0, v90
    v_fma_f32 v82, v83, -2.0, v82
    v_fma_f32 v90, v91, -2.0, v90
    v_fmamk_f32 v80, v76, 0x41700000, v82
    v_fmamk_f32 v88, v84, 0x41700000, v90
    v_fmamk_f32 v80, v81, 0x41200000, v80
    v_fmamk_f32 v88, v89, 0x41200000, v88
    v_cvt_pk_bf16_f32 v6, v77, v85
    v_cvt_pk_bf16_f32 v10, v78, v86
    v_cvt_pk_bf16_f32 v66, v79, v87
    v_cvt_pk_bf16_f32 v70, v82, v90
    v_cvt_pk_bf16_f32 v74, v80, v88
    v_lshlrev_b32 v76, 16, v3
    v_and_b32 v84, s25, v3
    v_lshlrev_b32 v77, 16, v7
    v_and_b32 v85, s25, v7
    v_lshlrev_b32 v78, 16, v11
    v_and_b32 v86, s25, v11
    v_lshlrev_b32 v79, 16, v15
    v_and_b32 v87, s25, v15
    v_add_f32 v80, v76, v78
    v_add_f32 v88, v84, v86
    v_add_f32 v81, v77, v79
    v_add_f32 v89, v85, v87
    v_fma_f32 v82, v78, 4.0, v76
    v_fma_f32 v90, v86, 4.0, v84
    v_fma_f32 v83, v79, 4.0, v77
    v_fma_f32 v91, v87, 4.0, v85
    v_add_f32 v77, v80, v81
    v_add_f32 v85, v88, v89
    v_sub_f32 v78, v80, v81
    v_sub_f32 v86, v88, v89
    v_fma_f32 v79, v83, 2.0, v82
    v_fma_f32 v87, v91, 2.0, v90
    v_fma_f32 v82, v83, -2.0, v82
    v_fma_f32 v90, v91, -2.0, v90
    v_fmamk_f32 v80, v76, 0x41700000, v82
    v_fmamk_f32 v88, v84, 0x41700000, v90
    v_fmamk_f32 v80, v81, 0x41200000, v80
    v_fmamk_f32 v88, v89, 0x41200000, v88
    v_cvt_pk_bf16_f32 v7, v77, v85
    v_cvt_pk_bf16_f32 v11, v78, v86
    v_cvt_pk_bf16_f32 v67, v79, v87
    v_cvt_pk_bf16_f32 v71, v82, v90
    v_cvt_pk_bf16_f32 v75, v80, v88
    ds_write_b128 v96, v[64:67] offset:49152
    ds_write_b128 v97, v[68:71] offset:0
    ds_write_b128 v97, v[72:75] offset:16384
    ds_write_b128 v96, v[4:7] offset:16384
    ds_write_b128 v96, v[8:11] offset:32768
    s_waitcnt vmcnt(0)
    s_mov_b32 s24, 1048576
    s_mov_b32 s27, 1572864
    buffer_load_dwordx4 v[32:35], v92, s[8:11], s24 offen
    buffer_load_dwordx4 v[40:43], v94, s[8:11], s24 offen
    buffer_load_dwordx4 v[36:39], v93, s[8:11], s24 offen
    buffer_load_dwordx4 v[44:47], v95, s[8:11], s24 offen
    buffer_load_dwordx4 v[48:51], v92, s[8:11], s27 offen
    buffer_load_dwordx4 v[56:59], v94, s[8:11], s27 offen
    buffer_load_dwordx4 v[52:55], v93, s[8:11], s27 offen
    buffer_load_dwordx4 v[60:63], v95, s[8:11], s27 offen
    s_waitcnt lgkmcnt(0)
    s_barrier
    s_setprio 0
    v_lshlrev_b32 v76, 16, v16
    v_and_b32 v84, s25, v16
    v_lshlrev_b32 v77, 16, v20
    v_and_b32 v85, s25, v20
    v_lshlrev_b32 v78, 16, v24
    v_and_b32 v86, s25, v24
    v_lshlrev_b32 v79, 16, v28
    v_and_b32 v87, s25, v28
    v_add_f32 v80, v76, v78
    v_add_f32 v88, v84, v86
    v_add_f32 v81, v77, v79
    v_add_f32 v89, v85, v87
    v_fma_f32 v82, v78, 4.0, v76
    v_fma_f32 v90, v86, 4.0, v84
    v_fma_f32 v83, v79, 4.0, v77
    v_fma_f32 v91, v87, 4.0, v85
    v_add_f32 v77, v80, v81
    v_add_f32 v85, v88, v89
    v_sub_f32 v78, v80, v81
    v_sub_f32 v86, v88, v89
    v_fma_f32 v79, v83, 2.0, v82
    v_fma_f32 v87, v91, 2.0, v90
    v_fma_f32 v82, v83, -2.0, v82
    v_fma_f32 v90, v91, -2.0, v90
    v_fmamk_f32 v80, v76, 0x41700000, v82
    v_fmamk_f32 v88, v84, 0x41700000, v90
    v_fmamk_f32 v80, v81, 0x41200000, v80
    v_fmamk_f32 v88, v89, 0x41200000, v88
    v_cvt_pk_bf16_f32 v20, v77, v85
    v_cvt_pk_bf16_f32 v24, v78, v86
    v_cvt_pk_bf16_f32 v64, v79, v87
    v_cvt_pk_bf16_f32 v68, v82, v90
    v_cvt_pk_bf16_f32 v72, v80, v88
    v_lshlrev_b32 v76, 16, v17
    v_and_b32 v84, s25, v17
    v_lshlrev_b32 v77, 16, v21
    v_and_b32 v85, s25, v21
    v_lshlrev_b32 v78, 16, v25
    v_and_b32 v86, s25, v25
    v_lshlrev_b32 v79, 16, v29
    v_and_b32 v87, s25, v29
    v_add_f32 v80, v76, v78
    v_add_f32 v88, v84, v86
    v_add_f32 v81, v77, v79
    v_add_f32 v89, v85, v87
    v_fma_f32 v82, v78, 4.0, v76
    v_fma_f32 v90, v86, 4.0, v84
    v_fma_f32 v83, v79, 4.0, v77
    v_fma_f32 v91, v87, 4.0, v85
    v_add_f32 v77, v80, v81
    v_add_f32 v85, v88, v89
    v_sub_f32 v78, v80, v81
    v_sub_f32 v86, v88, v89
    v_fma_f32 v79, v83, 2.0, v82
    v_fma_f32 v87, v91, 2.0, v90
    v_fma_f32 v82, v83, -2.0, v82
    v_fma_f32 v90, v91, -2.0, v90
    v_fmamk_f32 v80, v76, 0x41700000, v82
    v_fmamk_f32 v88, v84, 0x41700000, v90
    v_fmamk_f32 v80, v81, 0x41200000, v80
    v_fmamk_f32 v88, v89, 0x41200000, v88
    v_cvt_pk_bf16_f32 v21, v77, v85
    v_cvt_pk_bf16_f32 v25, v78, v86
    v_cvt_pk_bf16_f32 v65, v79, v87
    v_cvt_pk_bf16_f32 v69, v82, v90
    v_cvt_pk_bf16_f32 v73, v80, v88
    v_lshlrev_b32 v76, 16, v18
    v_and_b32 v84, s25, v18
    v_lshlrev_b32 v77, 16, v22
    v_and_b32 v85, s25, v22
    v_lshlrev_b32 v78, 16, v26
    v_and_b32 v86, s25, v26
    v_lshlrev_b32 v79, 16, v30
    v_and_b32 v87, s25, v30
    v_add_f32 v80, v76, v78
    v_add_f32 v88, v84, v86
    v_add_f32 v81, v77, v79
    v_add_f32 v89, v85, v87
    v_fma_f32 v82, v78, 4.0, v76
    v_fma_f32 v90, v86, 4.0, v84
    v_fma_f32 v83, v79, 4.0, v77
    v_fma_f32 v91, v87, 4.0, v85
    v_add_f32 v77, v80, v81
    v_add_f32 v85, v88, v89
    v_sub_f32 v78, v80, v81
    v_sub_f32 v86, v88, v89
    v_fma_f32 v79, v83, 2.0, v82
    v_fma_f32 v87, v91, 2.0, v90
    v_fma_f32 v82, v83, -2.0, v82
    v_fma_f32 v90, v91, -2.0, v90
    v_fmamk_f32 v80, v76, 0x41700000, v82
    v_fmamk_f32 v88, v84, 0x41700000, v90
    v_fmamk_f32 v80, v81, 0x41200000, v80
    v_fmamk_f32 v88, v89, 0x41200000, v88
    v_cvt_pk_bf16_f32 v22, v77, v85
    v_cvt_pk_bf16_f32 v26, v78, v86
    v_cvt_pk_bf16_f32 v66, v79, v87
    v_cvt_pk_bf16_f32 v70, v82, v90
    v_cvt_pk_bf16_f32 v74, v80, v88
    v_lshlrev_b32 v76, 16, v19
    v_and_b32 v84, s25, v19
    v_lshlrev_b32 v77, 16, v23
    v_and_b32 v85, s25, v23
    v_lshlrev_b32 v78, 16, v27
    v_and_b32 v86, s25, v27
    v_lshlrev_b32 v79, 16, v31
    v_and_b32 v87, s25, v31
    v_add_f32 v80, v76, v78
    v_add_f32 v88, v84, v86
    v_add_f32 v81, v77, v79
    v_add_f32 v89, v85, v87
    v_fma_f32 v82, v78, 4.0, v76
    v_fma_f32 v90, v86, 4.0, v84
    v_fma_f32 v83, v79, 4.0, v77
    v_fma_f32 v91, v87, 4.0, v85
    v_add_f32 v77, v80, v81
    v_add_f32 v85, v88, v89
    v_sub_f32 v78, v80, v81
    v_sub_f32 v86, v88, v89
    v_fma_f32 v79, v83, 2.0, v82
    v_fma_f32 v87, v91, 2.0, v90
    v_fma_f32 v82, v83, -2.0, v82
    v_fma_f32 v90, v91, -2.0, v90
    v_fmamk_f32 v80, v76, 0x41700000, v82
    v_fmamk_f32 v88, v84, 0x41700000, v90
    v_fmamk_f32 v80, v81, 0x41200000, v80
    v_fmamk_f32 v88, v89, 0x41200000, v88
    v_cvt_pk_bf16_f32 v23, v77, v85
    v_cvt_pk_bf16_f32 v27, v78, v86
    v_cvt_pk_bf16_f32 v67, v79, v87
    v_cvt_pk_bf16_f32 v71, v82, v90
    v_cvt_pk_bf16_f32 v75, v80, v88
L_conv2_kernel_hloop2:
    s_add_u32 s24, s24, 1048576
    s_add_u32 s27, s27, 1048576
    ds_write_b128 v96, v[64:67] offset:57344
    ds_write_b128 v97, v[68:71] offset:8192
    ds_write_b128 v97, v[72:75] offset:24576
    ds_write_b128 v96, v[16:19] offset:8192
    ds_write_b128 v96, v[20:23] offset:24576
    ds_write_b128 v96, v[24:27] offset:40960
    ds_write_b128 v98, v[28:31] offset:8704
    s_waitcnt vmcnt(0)
    v_lshlrev_b32 v76, 16, v32
    v_and_b32 v84, s25, v32
    v_lshlrev_b32 v77, 16, v36
    v_and_b32 v85, s25, v36
    v_lshlrev_b32 v78, 16, v40
    v_and_b32 v86, s25, v40
    v_lshlrev_b32 v79, 16, v44
    v_and_b32 v87, s25, v44
    v_add_f32 v80, v76, v78
    v_add_f32 v88, v84, v86
    v_add_f32 v81, v77, v79
    v_add_f32 v89, v85, v87
    v_fma_f32 v82, v78, 4.0, v76
    v_fma_f32 v90, v86, 4.0, v84
    v_fma_f32 v83, v79, 4.0, v77
    v_fma_f32 v91, v87, 4.0, v85
    v_add_f32 v77, v80, v81
    v_add_f32 v85, v88, v89
    v_sub_f32 v78, v80, v81
    v_sub_f32 v86, v88, v89
    v_fma_f32 v79, v83, 2.0, v82
    v_fma_f32 v87, v91, 2.0, v90
    v_fma_f32 v82, v83, -2.0, v82
    v_fma_f32 v90, v91, -2.0, v90
    v_fmamk_f32 v80, v76, 0x41700000, v82
    v_fmamk_f32 v88, v84, 0x41700000, v90
    buffer_load_dwordx4 v[0:3], v92, s[8:11], s24 offen
    buffer_load_dwordx4 v[8:11], v94, s[8:11], s24 offen
    v_fmamk_f32 v80, v81, 0x41200000, v80
    v_fmamk_f32 v88, v89, 0x41200000, v88
    v_cvt_pk_bf16_f32 v36, v77, v85
    v_cvt_pk_bf16_f32 v40, v78, v86
    v_cvt_pk_bf16_f32 v64, v79, v87
    v_cvt_pk_bf16_f32 v68, v82, v90
    v_cvt_pk_bf16_f32 v72, v80, v88
    v_lshlrev_b32 v76, 16, v33
    v_and_b32 v84, s25, v33
    v_lshlrev_b32 v77, 16, v37
    v_and_b32 v85, s25, v37
    v_lshlrev_b32 v78, 16, v41
    v_and_b32 v86, s25, v41
    v_lshlrev_b32 v79, 16, v45
    v_and_b32 v87, s25, v45
    v_add_f32 v80, v76, v78
    v_add_f32 v88, v84, v86
    v_add_f32 v81, v77, v79
    v_add_f32 v89, v85, v87
    v_fma_f32 v82, v78, 4.0, v76
    v_fma_f32 v90, v86, 4.0, v84
    v_fma_f32 v83, v79, 4.0, v77
    v_fma_f32 v91, v87, 4.0, v85
    v_add_f32 v77, v80, v81
    v_add_f32 v85, v88, v89
    v_sub_f32 v78, v80, v81
    v_sub_f32 v86, v88, v89
    v_fma_f32 v79, v83, 2.0, v82
    v_fma_f32 v87, v91, 2.0, v90
    v_fma_f32 v82, v83, -2.0, v82
    v_fma_f32 v90, v91, -2.0, v90
    v_fmamk_f32 v80, v76, 0x41700000, v82
    v_fmamk_f32 v88, v84, 0x41700000, v90
    v_fmamk_f32 v80, v81, 0x41200000, v80
    v_fmamk_f32 v88, v89, 0x41200000, v88
    v_cvt_pk_bf16_f32 v37, v77, v85
    v_cvt_pk_bf16_f32 v41, v78, v86
    v_cvt_pk_bf16_f32 v65, v79, v87
    v_cvt_pk_bf16_f32 v69, v82, v90
    v_cvt_pk_bf16_f32 v73, v80, v88
    v_lshlrev_b32 v76, 16, v34
    v_and_b32 v84, s25, v34
    v_lshlrev_b32 v77, 16, v38
    v_and_b32 v85, s25, v38
    v_lshlrev_b32 v78, 16, v42
    v_and_b32 v86, s25, v42
    v_lshlrev_b32 v79, 16, v46
    v_and_b32 v87, s25, v46
    v_add_f32 v80, v76, v78
    v_add_f32 v88, v84, v86
    v_add_f32 v81, v77, v79
    v_add_f32 v89, v85, v87
    v_fma_f32 v82, v78, 4.0, v76
    buffer_load_dwordx4 v[4:7], v93, s[8:11], s24 offen
    buffer_load_dwordx4 v[12:15], v95, s[8:11], s24 offen
    v_fma_f32 v90, v86, 4.0, v84
    v_fma_f32 v83, v79, 4.0, v77
    v_fma_f32 v91, v87, 4.0, v85
    v_add_f32 v77, v80, v81
    v_add_f32 v85, v88, v89
    v_sub_f32 v78, v80, v81
    v_sub_f32 v86, v88, v89
    v_fma_f32 v79, v83, 2.0, v82
    v_fma_f32 v87, v91, 2.0, v90
    v_fma_f32 v82, v83, -2.0, v82
    v_fma_f32 v90, v91, -2.0, v90
    v_fmamk_f32 v80, v76, 0x41700000, v82
    v_fmamk_f32 v88, v84, 0x41700000, v90
    v_fmamk_f32 v80, v81, 0x41200000, v80
    v_fmamk_f32 v88, v89, 0x41200000, v88
    v_cvt_pk_bf16_f32 v38, v77, v85
    v_cvt_pk_bf16_f32 v42, v78, v86
    v_cvt_pk_bf16_f32 v66, v79, v87
    v_cvt_pk_bf16_f32 v70, v82, v90
    v_cvt_pk_bf16_f32 v74, v80, v88
    v_lshlrev_b32 v76, 16, v35
    v_and_b32 v84, s25, v35
    v_lshlrev_b32 v77, 16, v39
    v_and_b32 v85, s25, v39
    v_lshlrev_b32 v78, 16, v43
    v_and_b32 v86, s25, v43
    v_lshlrev_b32 v79, 16, v47
    v_and_b32 v87, s25, v47
    v_add_f32 v80, v76, v78
    v_add_f32 v88, v84, v86
    v_add_f32 v81, v77, v79
    v_add_f32 v89, v85, v87
    v_fma_f32 v82, v78, 4.0, v76
    v_fma_f32 v90, v86, 4.0, v84
    v_fma_f32 v83, v79, 4.0, v77
    v_fma_f32 v91, v87, 4.0, v85
    v_add_f32 v77, v80, v81
    v_add_f32 v85, v88, v89
    v_sub_f32 v78, v80, v81
    v_sub_f32 v86, v88, v89
    v_fma_f32 v79, v83, 2.0, v82
    v_fma_f32 v87, v91, 2.0, v90
    v_fma_f32 v82, v83, -2.0, v82
    v_fma_f32 v90, v91, -2.0, v90
    v_fmamk_f32 v80, v76, 0x41700000, v82
    v_fmamk_f32 v88, v84, 0x41700000, v90
    v_fmamk_f32 v80, v81, 0x41200000, v80
    v_fmamk_f32 v88, v89, 0x41200000, v88
    v_cvt_pk_bf16_f32 v39, v77, v85
    v_cvt_pk_bf16_f32 v43, v78, v86
    v_cvt_pk_bf16_f32 v67, v79, v87
    v_cvt_pk_bf16_f32 v71, v82, v90
    v_cvt_pk_bf16_f32 v75, v80, v88
    s_add_u32 s28, s28, 1
    s_waitcnt lgkmcnt(0)
    s_barrier
    ds_write_b128 v96, v[64:67] offset:49152
    ds_write_b128 v97, v[68:71] offset:0
    ds_write_b128 v97, v[72:75] offset:16384
    ds_write_b128 v96, v[32:35] offset:0
    ds_write_b128 v96, v[36:39] offset:16384
    ds_write_b128 v96, v[40:43] offset:32768
    ds_write_b128 v98, v[44:47] offset:0
    v_lshlrev_b32 v76, 16, v48
    v_and_b32 v84, s25, v48
    buffer_load_dwordx4 v[16:19], v92, s[8:11], s27 offen
    buffer_load_dwordx4 v[24:27], v94, s[8:11], s27 offen
    v_lshlrev_b32 v77, 16, v52
    v_and_b32 v85, s25, v52
    v_lshlrev_b32 v78, 16, v56
    v_and_b32 v86, s25, v56
    v_lshlrev_b32 v79, 16, v60
    v_and_b32 v87, s25, v60
    v_add_f32 v80, v76, v78
    v_add_f32 v88, v84, v86
    v_add_f32 v81, v77, v79
    v_add_f32 v89, v85, v87
    v_fma_f32 v82, v78, 4.0, v76
    v_fma_f32 v90, v86, 4.0, v84
    v_fma_f32 v83, v79, 4.0, v77
    v_fma_f32 v91, v87, 4.0, v85
    v_add_f32 v77, v80, v81
    v_add_f32 v85, v88, v89
    v_sub_f32 v78, v80, v81
    buffer_load_dwordx4 v[20:23], v93, s[8:11], s27 offen
    buffer_load_dwordx4 v[28:31], v95, s[8:11], s27 offen
    v_sub_f32 v86, v88, v89
    v_fma_f32 v79, v83, 2.0, v82
    v_fma_f32 v87, v91, 2.0, v90
    v_fma_f32 v82, v83, -2.0, v82
    v_fma_f32 v90, v91, -2.0, v90
    v_fmamk_f32 v80, v76, 0x41700000, v82
    v_fmamk_f32 v88, v84, 0x41700000, v90
    v_fmamk_f32 v80, v81, 0x41200000, v80
    v_fmamk_f32 v88, v89, 0x41200000, v88
    v_cvt_pk_bf16_f32 v52, v77, v85
    v_cvt_pk_bf16_f32 v56, v78, v86
    v_cvt_pk_bf16_f32 v64, v79, v87
    v_cvt_pk_bf16_f32 v68, v82, v90
    v_cvt_pk_bf16_f32 v72, v80, v88
    v_lshlrev_b32 v76, 16, v49
    v_and_b32 v84, s25, v49
    v_lshlrev_b32 v77, 16, v53
    v_and_b32 v85, s25, v53
    v_lshlrev_b32 v78, 16, v57
    v_and_b32 v86, s25, v57
    v_lshlrev_b32 v79, 16, v61
    v_and_b32 v87, s25, v61
    v_add_f32 v80, v76, v78
    v_add_f32 v88, v84, v86
    v_add_f32 v81, v77, v79
    v_add_f32 v89, v85, v87
    v_fma_f32 v82, v78, 4.0, v76
    v_fma_f32 v90, v86, 4.0, v84
    v_fma_f32 v83, v79, 4.0, v77
    v_fma_f32 v91, v87, 4.0, v85
    v_add_f32 v77, v80, v81
    v_add_f32 v85, v88, v89
    v_sub_f32 v78, v80, v81
    v_sub_f32 v86, v88, v89
    v_fma_f32 v79, v83, 2.0, v82
    v_fma_f32 v87, v91, 2.0, v90
    v_fma_f32 v82, v83, -2.0, v82
    v_fma_f32 v90, v91, -2.0, v90
    v_fmamk_f32 v80, v76, 0x41700000, v82
    v_fmamk_f32 v88, v84, 0x41700000, v90
    v_fmamk_f32 v80, v81, 0x41200000, v80
    v_fmamk_f32 v88, v89, 0x41200000, v88
    v_cvt_pk_bf16_f32 v53, v77, v85
    v_cvt_pk_bf16_f32 v57, v78, v86
    v_cvt_pk_bf16_f32 v65, v79, v87
    v_cvt_pk_bf16_f32 v69, v82, v90
    v_cvt_pk_bf16_f32 v73, v80, v88
    v_lshlrev_b32 v76, 16, v50
    v_and_b32 v84, s25, v50
    v_lshlrev_b32 v77, 16, v54
    v_and_b32 v85, s25, v54
    v_lshlrev_b32 v78, 16, v58
    v_and_b32 v86, s25, v58
    v_lshlrev_b32 v79, 16, v62
    v_and_b32 v87, s25, v62
    v_add_f32 v80, v76, v78
    v_add_f32 v88, v84, v86
    v_add_f32 v81, v77, v79
    v_add_f32 v89, v85, v87
    v_fma_f32 v82, v78, 4.0, v76
    v_fma_f32 v90, v86, 4.0, v84
    v_fma_f32 v83, v79, 4.0, v77
    v_fma_f32 v91, v87, 4.0, v85
    v_add_f32 v77, v80, v81
    v_add_f32 v85, v88, v89
    v_sub_f32 v78, v80, v81
    v_sub_f32 v86, v88, v89
    v_fma_f32 v79, v83, 2.0, v82
    v_fma_f32 v87, v91, 2.0, v90
    v_fma_f32 v82, v83, -2.0, v82
    v_fma_f32 v90, v91, -2.0, v90
    v_fmamk_f32 v80, v76, 0x41700000, v82
    v_fmamk_f32 v88, v84, 0x41700000, v90
    v_fmamk_f32 v80, v81, 0x41200000, v80
    v_fmamk_f32 v88, v89, 0x41200000, v88
    v_cvt_pk_bf16_f32 v54, v77, v85
    v_cvt_pk_bf16_f32 v58, v78, v86
    v_cvt_pk_bf16_f32 v66, v79, v87
    v_cvt_pk_bf16_f32 v70, v82, v90
    v_cvt_pk_bf16_f32 v74, v80, v88
    v_lshlrev_b32 v76, 16, v51
    v_and_b32 v84, s25, v51
    v_lshlrev_b32 v77, 16, v55
    v_and_b32 v85, s25, v55
    v_lshlrev_b32 v78, 16, v59
    v_and_b32 v86, s25, v59
    v_lshlrev_b32 v79, 16, v63
    v_and_b32 v87, s25, v63
    v_add_f32 v80, v76, v78
    v_add_f32 v88, v84, v86
    v_add_f32 v81, v77, v79
    v_add_f32 v89, v85, v87
    v_fma_f32 v82, v78, 4.0, v76
    v_fma_f32 v90, v86, 4.0, v84
    v_fma_f32 v83, v79, 4.0, v77
    v_fma_f32 v91, v87, 4.0, v85
    v_add_f32 v77, v80, v81
    v_add_f32 v85, v88, v89
    v_sub_f32 v78, v80, v81
    v_sub_f32 v86, v88, v89
    v_fma_f32 v79, v83, 2.0, v82
    v_fma_f32 v87, v91, 2.0, v90
    v_fma_f32 v82, v83, -2.0, v82
    v_fma_f32 v90, v91, -2.0, v90
    v_fmamk_f32 v80, v76, 0x41700000, v82
    v_fmamk_f32 v88, v84, 0x41700000, v90
    v_fmamk_f32 v80, v81, 0x41200000, v80
    v_fmamk_f32 v88, v89, 0x41200000, v88
    v_cvt_pk_bf16_f32 v55, v77, v85
    v_cvt_pk_bf16_f32 v59, v78, v86
    v_cvt_pk_bf16_f32 v67, v79, v87
    v_cvt_pk_bf16_f32 v71, v82, v90
    v_cvt_pk_bf16_f32 v75, v80, v88
    s_add_u32 s28, s28, 1
    s_waitcnt lgkmcnt(0)
    s_barrier
    s_cmp_eq_u32 s22, 1
    s_cbranch_scc1 L_conv2_kernel_hlast2
    s_add_u32 s24, s24, 1048576
    s_add_u32 s27, s27, 1048576
    ds_write_b128 v96, v[64:67] offset:57344
    ds_write_b128 v97, v[68:71] offset:8192
    ds_write_b128 v97, v[72:75] offset:24576
    ds_write_b128 v96, v[48:51] offset:8192
    ds_write_b128 v96, v[52:55] offset:24576
    ds_write_b128 v96, v[56:59] offset:40960
    ds_write_b128 v98, v[60:63] offset:8704
    s_waitcnt vmcnt(0)
    v_lshlrev_b32 v76, 16, v0
    v_and_b32 v84, s25, v0
    v_lshlrev_b32 v77, 16, v4
    v_and_b32 v85, s25, v4
    v_lshlrev_b32 v78, 16, v8
    v_and_b32 v86, s25, v8
    v_lshlrev_b32 v79, 16, v12
    v_and_b32 v87, s25, v12
    v_add_f32 v80, v76, v78
    v_add_f32 v88, v84, v86
    v_add_f32 v81, v77, v79
    v_add_f32 v89, v85, v87
    v_fma_f32 v82, v78, 4.0, v76
    v_fma_f32 v90, v86, 4.0, v84
    v_fma_f32 v83, v79, 4.0, v77
    v_fma_f32 v91, v87, 4.0, v85
    v_add_f32 v77, v80, v81
    v_add_f32 v85, v88, v89
    v_sub_f32 v78, v80, v81
    v_sub_f32 v86, v88, v89
    v_fma_f32 v79, v83, 2.0, v82
    v_fma_f32 v87, v91, 2.0, v90
    v_fma_f32 v82, v83, -2.0, v82
    v_fma_f32 v90, v91, -2.0, v90
    v_fmamk_f32 v80, v76, 0x41700000, v82
    v_fmamk_f32 v88, v84, 0x41700000, v90
    buffer_load_dwordx4 v[32:35], v92, s[8:11], s24 offen
    buffer_load_dwordx4 v[40:43], v94, s[8:11], s24 offen
    v_fmamk_f32 v80, v81, 0x41200000, v80
    v_fmamk_f32 v88, v89, 0x41200000, v88
    v_cvt_pk_bf16_f32 v4, v77, v85
    v_cvt_pk_bf16_f32 v8, v78, v86
    v_cvt_pk_bf16_f32 v64, v79, v87
    v_cvt_pk_bf16_f32 v68, v82, v90
    v_cvt_pk_bf16_f32 v72, v80, v88
    v_lshlrev_b32 v76, 16, v1
    v_and_b32 v84, s25, v1
    v_lshlrev_b32 v77, 16, v5
    v_and_b32 v85, s25, v5
    v_lshlrev_b32 v78, 16, v9
    v_and_b32 v86, s25, v9
    v_lshlrev_b32 v79, 16, v13
    v_and_b32 v87, s25, v13
    v_add_f32 v80, v76, v78
    v_add_f32 v88, v84, v86
    v_add_f32 v81, v77, v79
    v_add_f32 v89, v85, v87
    v_fma_f32 v82, v78, 4.0, v76
    v_fma_f32 v90, v86, 4.0, v84
    v_fma_f32 v83, v79, 4.0, v77
    v_fma_f32 v91, v87, 4.0, v85
    v_add_f32 v77, v80, v81
    v_add_f32 v85, v88, v89
    v_sub_f32 v78, v80, v81
    v_sub_f32 v86, v88, v89
    v_fma_f32 v79, v83, 2.0, v82
    v_fma_f32 v87, v91, 2.0, v90
    v_fma_f32 v82, v83, -2.0, v82
    v_fma_f32 v90, v91, -2.0, v90
    v_fmamk_f32 v80, v76, 0x41700000, v82
    v_fmamk_f32 v88, v84, 0x41700000, v90
    v_fmamk_f32 v80, v81, 0x41200000, v80
    v_fmamk_f32 v88, v89, 0x41200000, v88
    v_cvt_pk_bf16_f32 v5, v77, v85
    v_cvt_pk_bf16_f32 v9, v78, v86
    v_cvt_pk_bf16_f32 v65, v79, v87
    v_cvt_pk_bf16_f32 v69, v82, v90
    v_cvt_pk_bf16_f32 v73, v80, v88
    v_lshlrev_b32 v76, 16, v2
    v_and_b32 v84, s25, v2
    v_lshlrev_b32 v77, 16, v6
    v_and_b32 v85, s25, v6
    v_lshlrev_b32 v78, 16, v10
    v_and_b32 v86, s25, v10
    v_lshlrev_b32 v79, 16, v14
    v_and_b32 v87, s25, v14
    v_add_f32 v80, v76, v78
    v_add_f32 v88, v84, v86
    v_add_f32 v81, v77, v79
    v_add_f32 v89, v85, v87
    v_fma_f32 v82, v78, 4.0, v76
    buffer_load_dwordx4 v[36:39], v93, s[8:11], s24 offen
    buffer_load_dwordx4 v[44:47], v95, s[8:11], s24 offen
    v_fma_f32 v90, v86, 4.0, v84
    v_fma_f32 v83, v79, 4.0, v77
    v_fma_f32 v91, v87, 4.0, v85
    v_add_f32 v77, v80, v81
    v_add_f32 v85, v88, v89
    v_sub_f32 v78, v80, v81
    v_sub_f32 v86, v88, v89
    v_fma_f32 v79, v83, 2.0, v82
    v_fma_f32 v87, v91, 2.0, v90
    v_fma_f32 v82, v83, -2.0, v82
    v_fma_f32 v90, v91, -2.0, v90
    v_fmamk_f32 v80, v76, 0x41700000, v82
    v_fmamk_f32 v88, v84, 0x41700000, v90
    v_fmamk_f32 v80, v81, 0x41200000, v80
    v_fmamk_f32 v88, v89, 0x41200000, v88
    v_cvt_pk_bf16_f32 v6, v77, v85
    v_cvt_pk_bf16_f32 v10, v78, v86
    v_cvt_pk_bf16_f32 v66, v79, v87
    v_cvt_pk_bf16_f32 v70, v82, v90
    v_cvt_pk_bf16_f32 v74, v80, v88
    v_lshlrev_b32 v76, 16, v3
    v_and_b32 v84, s25, v3
    v_lshlrev_b32 v77, 16, v7
    v_and_b32 v85, s25, v7
    v_lshlrev_b32 v78, 16, v11
    v_and_b32 v86, s25, v11
    v_lshlrev_b32 v79, 16, v15
    v_and_b32 v87, s25, v15
    v_add_f32 v80, v76, v78
    v_add_f32 v88, v84, v86
    v_add_f32 v81, v77, v79
    v_add_f32 v89, v85, v87
    v_fma_f32 v82, v78, 4.0, v76
    v_fma_f32 v90, v86, 4.0, v84
    v_fma_f32 v83, v79, 4.0, v77
    v_fma_f32 v91, v87, 4.0, v85
    v_add_f32 v77, v80, v81
    v_add_f32 v85, v88, v89
    v_sub_f32 v78, v80, v81
    v_sub_f32 v86, v88, v89
    v_fma_f32 v79, v83, 2.0, v82
    v_fma_f32 v87, v91, 2.0, v90
    v_fma_f32 v82, v83, -2.0, v82
    v_fma_f32 v90, v91, -2.0, v90
    v_fmamk_f32 v80, v76, 0x41700000, v82
    v_fmamk_f32 v88, v84, 0x41700000, v90
    v_fmamk_f32 v80, v81, 0x41200000, v80
    v_fmamk_f32 v88, v89, 0x41200000, v88
    v_cvt_pk_bf16_f32 v7, v77, v85
    v_cvt_pk_bf16_f32 v11, v78, v86
    v_cvt_pk_bf16_f32 v67, v79, v87
    v_cvt_pk_bf16_f32 v71, v82, v90
    v_cvt_pk_bf16_f32 v75, v80, v88
    s_add_u32 s28, s28, 1
    s_waitcnt lgkmcnt(0)
    s_barrier
    ds_write_b128 v96, v[64:67] offset:49152
    ds_write_b128 v97, v[68:71] offset:0
    ds_write_b128 v97, v[72:75] offset:16384
    ds_write_b128 v96, v[0:3] offset:0
    ds_write_b128 v96, v[4:7] offset:16384
    ds_write_b128 v96, v[8:11] offset:32768
    ds_write_b128 v98, v[12:15] offset:0
    v_lshlrev_b32 v76, 16, v16
    v_and_b32 v84, s25, v16
    buffer_load_dwordx4 v[48:51], v92, s[8:11], s27 offen
    buffer_load_dwordx4 v[56:59], v94, s[8:11], s27 offen
    v_lshlrev_b32 v77, 16, v20
    v_and_b32 v85, s25, v20
    v_lshlrev_b32 v78, 16, v24
    v_and_b32 v86, s25, v24
    v_lshlrev_b32 v79, 16, v28
    v_and_b32 v87, s25, v28
    v_add_f32 v80, v76, v78
    v_add_f32 v88, v84, v86
    v_add_f32 v81, v77, v79
    v_add_f32 v89, v85, v87
    v_fma_f32 v82, v78, 4.0, v76
    v_fma_f32 v90, v86, 4.0, v84
    v_fma_f32 v83, v79, 4.0, v77
    v_fma_f32 v91, v87, 4.0, v85
    v_add_f32 v77, v80, v81
    v_add_f32 v85, v88, v89
    v_sub_f32 v78, v80, v81
    buffer_load_dwordx4 v[52:55], v93, s[8:11], s27 offen
    buffer_load_dwordx4 v[60:63], v95, s[8:11], s27 offen
    v_sub_f32 v86, v88, v89
    v_fma_f32 v79, v83, 2.0, v82
    v_fma_f32 v87, v91, 2.0, v90
    v_fma_f32 v82, v83, -2.0, v82
    v_fma_f32 v90, v91, -2.0, v90
    v_fmamk_f32 v80, v76, 0x41700000, v82
    v_fmamk_f32 v88, v84, 0x41700000, v90
    v_fmamk_f32 v80, v81, 0x41200000, v80
    v_fmamk_f32 v88, v89, 0x41200000, v88
    v_cvt_pk_bf16_f32 v20, v77, v85
    v_cvt_pk_bf16_f32 v24, v78, v86
    v_cvt_pk_bf16_f32 v64, v79, v87
    v_cvt_pk_bf16_f32 v68, v82, v90
    v_cvt_pk_bf16_f32 v72, v80, v88
    v_lshlrev_b32 v76, 16, v17
    v_and_b32 v84, s25, v17
    v_lshlrev_b32 v77, 16, v21
    v_and_b32 v85, s25, v21
    v_lshlrev_b32 v78, 16, v25
    v_and_b32 v86, s25, v25
    v_lshlrev_b32 v79, 16, v29
    v_and_b32 v87, s25, v29
    v_add_f32 v80, v76, v78
    v_add_f32 v88, v84, v86
    v_add_f32 v81, v77, v79
    v_add_f32 v89, v85, v87
    v_fma_f32 v82, v78, 4.0, v76
    v_fma_f32 v90, v86, 4.0, v84
    v_fma_f32 v83, v79, 4.0, v77
    v_fma_f32 v91, v87, 4.0, v85
    v_add_f32 v77, v80, v81
    v_add_f32 v85, v88, v89
    v_sub_f32 v78, v80, v81
    v_sub_f32 v86, v88, v89
    v_fma_f32 v79, v83, 2.0, v82
    v_fma_f32 v87, v91, 2.0, v90
    v_fma_f32 v82, v83, -2.0, v82
    v_fma_f32 v90, v91, -2.0, v90
    v_fmamk_f32 v80, v76, 0x41700000, v82
    v_fmamk_f32 v88, v84, 0x41700000, v90
    v_fmamk_f32 v80, v81, 0x41200000, v80
    v_fmamk_f32 v88, v89, 0x41200000, v88
    v_cvt_pk_bf16_f32 v21, v77, v85
    v_cvt_pk_bf16_f32 v25, v78, v86
    v_cvt_pk_bf16_f32 v65, v79, v87
    v_cvt_pk_bf16_f32 v69, v82, v90
    v_cvt_pk_bf16_f32 v73, v80, v88
    v_lshlrev_b32 v76, 16, v18
    v_and_b32 v84, s25, v18
    v_lshlrev_b32 v77, 16, v22
    v_and_b32 v85, s25, v22
    v_lshlrev_b32 v78, 16, v26
    v_and_b32 v86, s25, v26
    v_lshlrev_b32 v79, 16, v30
    v_and_b32 v87, s25, v30
    v_add_f32 v80, v76, v78
    v_add_f32 v88, v84, v86
    v_add_f32 v81, v77, v79
    v_add_f32 v89, v85, v87
    v_fma_f32 v82, v78, 4.0, v76
    v_fma_f32 v90, v86, 4.0, v84
    v_fma_f32 v83, v79, 4.0, v77
    v_fma_f32 v91, v87, 4.0, v85
    v_add_f32 v77, v80, v81
    v_add_f32 v85, v88, v89
    v_sub_f32 v78, v80, v81
    v_sub_f32 v86, v88, v89
    v_fma_f32 v79, v83, 2.0, v82
    v_fma_f32 v87, v91, 2.0, v90
    v_fma_f32 v82, v83, -2.0, v82
    v_fma_f32 v90, v91, -2.0, v90
    v_fmamk_f32 v80, v76, 0x41700000, v82
    v_fmamk_f32 v88, v84, 0x41700000, v90
    v_fmamk_f32 v80, v81, 0x41200000, v80
    v_fmamk_f32 v88, v89, 0x41200000, v88
    v_cvt_pk_bf16_f32 v22, v77, v85
    v_cvt_pk_bf16_f32 v26, v78, v86
    v_cvt_pk_bf16_f32 v66, v79, v87
    v_cvt_pk_bf16_f32 v70, v82, v90
    v_cvt_pk_bf16_f32 v74, v80, v88
    v_lshlrev_b32 v76, 16, v19
    v_and_b32 v84, s25, v19
    v_lshlrev_b32 v77, 16, v23
    v_and_b32 v85, s25, v23
    v_lshlrev_b32 v78, 16, v27
    v_and_b32 v86, s25, v27
    v_lshlrev_b32 v79, 16, v31
    v_and_b32 v87, s25, v31
    v_add_f32 v80, v76, v78
    v_add_f32 v88, v84, v86
    v_add_f32 v81, v77, v79
    v_add_f32 v89, v85, v87
    v_fma_f32 v82, v78, 4.0, v76
    v_fma_f32 v90, v86, 4.0, v84
    v_fma_f32 v83, v79, 4.0, v77
    v_fma_f32 v91, v87, 4.0, v85
    v_add_f32 v77, v80, v81
    v_add_f32 v85, v88, v89
    v_sub_f32 v78, v80, v81
    v_sub_f32 v86, v88, v89
    v_fma_f32 v79, v83, 2.0, v82
    v_fma_f32 v87, v91, 2.0, v90
    v_fma_f32 v82, v83, -2.0, v82
    v_fma_f32 v90, v91, -2.0, v90
    v_fmamk_f32 v80, v76, 0x41700000, v82
    v_fmamk_f32 v88, v84, 0x41700000, v90
    v_fmamk_f32 v80, v81, 0x41200000, v80
    v_fmamk_f32 v88, v89, 0x41200000, v88
    v_cvt_pk_bf16_f32 v23, v77, v85
    v_cvt_pk_bf16_f32 v27, v78, v86
    v_cvt_pk_bf16_f32 v67, v79, v87
    v_cvt_pk_bf16_f32 v71, v82, v90
    v_cvt_pk_bf16_f32 v75, v80, v88
    s_add_u32 s28, s28, 1
    s_waitcnt lgkmcnt(0)
    s_barrier
    s_sub_u32 s22, s22, 1
    s_branch L_conv2_kernel_hloop2
L_conv2_kernel_hlast2:
    s_mov_b32 s25, 0xffff0000
    ds_write_b128 v96, v[64:67] offset:57344
    ds_write_b128 v97, v[68:71] offset:8192
    ds_write_b128 v97, v[72:75] offset:24576
    ds_write_b128 v96, v[48:51] offset:8192
    ds_write_b128 v96, v[52:55] offset:24576
    ds_write_b128 v96, v[56:59] offset:40960
    ds_write_b128 v98, v[60:63] offset:8704
    s_waitcnt lgkmcnt(0)
    s_barrier
    s_branch L_conv2_kernel_end
L_conv2_kernel_epi:
    v_and_b32 v108, 15, v127
    v_lshrrev_b32 v109, 4, v127
    v_lshrrev_b32 v110, 3, v108
    s_lshl_b32 s36, s20, 1
    v_add_u32 v110, s36, v110
    v_xor_b32 v111, v110, v108
    v_and_b32 v111, 7, v111
    v_lshlrev_b32 v111, 4, v111
    v_lshl_add_u32 v111, v110, 7, v111
    v_lshl_add_u32 v120, v109, 11, v111
    v_add_u32 v121, 65536, v120
    v_add_u32 v125, 131072, v120
    s_lshl_b32 s36, s20, 9
    s_add_u32 s36, s36, 115712
    v_lshl_add_u32 v123, v109, 7, s36
    s_lshl_b32 s36, s20, 4
    v_add_u32 v108, s36, v108
    v_lshlrev_b32 v110, 6, v108
    v_lshl_add_u32 v110, v109, 4, v110
    s_mul_i32 s36, s29, 262144
    s_lshl_b32 s37, s21, 4
    s_add_u32 s36, s36, s37
    v_add_u32 v110, s36, v110
    v_mov_b32 v111, 2130706432
    v_cmp_gt_u32 vcc, 125, v108
    s_mov_b32 s4, 0xbeaaaaab
    s_mov_b32 s5, s4
    s_mov_b32 s6, 0x3e800000
    s_mov_b32 s7, s6
    s_mov_b32 s8, 0xc0a00000
    s_mov_b32 s9, s8
    s_mov_b32 s10, 0xc0638e39
    s_mov_b32 s11, s10
    s_mov_b32 s12, 0xbf638e39
    s_mov_b32 s13, s12
    s_mov_b32 s14, 0xbe638e39
    s_mov_b32 s15, s14
    s_mov_b32 s22, 0xbd638e39
    s_mov_b32 s23, s22
    s_mov_b32 s24, 0x3ff1c71c
    s_mov_b32 s25, s24
    s_mov_b32 s26, 0xbf2aaaab
    s_mov_b32 s27, s26
    s_mov_b32 s32, 0x3ecccccd
    s_mov_b32 s33, s32
    s_mov_b32 s34, 0xbd888889
    s_mov_b32 s35, s34
    s_mov_b32 s38, 0xbe4ccccd
    s_mov_b32 s39, s38
    s_mov_b32 s40, 0xbdd2d3e8
    s_mov_b32 s41, s40
    s_mov_b32 s42, 0x3f800000
    s_mov_b32 s43, s42
    s_waitcnt lgkmcnt(0)
    s_barrier
    v_cndmask_b32 v122, v111, v110, vcc
    ds_read_b128 v[0:3], v120 offset:0
    ds_read_b128 v[4:7], v120 offset:16384
    ds_read_b128 v[8:11], v120 offset:32768
    ds_read_b128 v[12:15], v120 offset:49152
    ds_read_b128 v[16:19], v121 offset:0
    ds_read_b128 v[20:23], v121 offset:16384
    ds_read_b128 v[24:27], v121 offset:32768
    ds_read_b128 v[28:31], v125 offset:15360
    ds_read_b128 v[32:35], v120 offset:8192
    ds_read_b128 v[36:39], v120 offset:24576
    ds_read_b128 v[40:43], v120 offset:40960
    ds_read_b128 v[44:47], v120 offset:57344
    ds_read_b128 v[48:51], v121 offset:56320
    ds_read_b128 v[52:55], v121 offset:64512
    ds_read_b128 v[56:59], v125 offset:7168
    s_waitcnt lgkmcnt(7)
    ds_read_b128 v[60:63], v125 offset:23552
    s_waitcnt lgkmcnt(8)
    v_pk_add_f32 v[88:89], v[24:25], v[28:29]
    v_pk_add_f32 v[90:91], v[26:27], v[30:31]
    v_pk_add_f32 v[24:25], v[4:5], v[8:9]
    v_pk_add_f32 v[26:27], v[6:7], v[10:11]
    v_pk_add_f32 v[4:5], v[4:5], v[8:9] neg_lo:[0,1] neg_hi:[0,1]
    v_pk_add_f32 v[6:7], v[6:7], v[10:11] neg_lo:[0,1] neg_hi:[0,1]
    v_pk_add_f32 v[72:73], v[12:13], v[16:17]
    v_pk_add_f32 v[74:75], v[14:15], v[18:19]
    v_pk_add_f32 v[12:13], v[12:13], v[16:17] neg_lo:[0,1] neg_hi:[0,1]
    v_pk_add_f32 v[14:15], v[14:15], v[18:19] neg_lo:[0,1] neg_hi:[0,1]
    v_pk_fma_f32 v[72:73], v[24:25], s[4:5], v[72:73]
    v_pk_fma_f32 v[74:75], v[26:27], s[4:5], v[74:75]
    v_pk_fma_f32 v[20:21], v[0:1], s[10:11], v[20:21]
    v_pk_fma_f32 v[22:23], v[2:3], s[10:11], v[22:23]
    v_pk_fma_f32 v[72:73], v[0:1], s[6:7], v[72:73]
    v_pk_fma_f32 v[74:75], v[2:3], s[6:7], v[74:75]
    v_pk_add_f32 v[24:25], v[24:25], v[0:1] neg_lo:[0,1] neg_hi:[0,1]
    v_pk_add_f32 v[26:27], v[26:27], v[2:3] neg_lo:[0,1] neg_hi:[0,1]
    v_pk_fma_f32 v[72:73], v[88:89], s[8:9], v[72:73]
    v_pk_fma_f32 v[74:75], v[90:91], s[8:9], v[74:75]
    v_pk_add_f32 v[24:25], v[24:25], v[88:89] neg_lo:[0,1] neg_hi:[0,1]
    v_pk_add_f32 v[26:27], v[26:27], v[90:91] neg_lo:[0,1] neg_hi:[0,1]
    v_pk_fma_f32 v[20:21], v[88:89], s[22:23], v[20:21]
    v_pk_fma_f32 v[22:23], v[90:91], s[22:23], v[22:23]
    v_pk_add_f32 v[8:9], v[24:25], v[72:73] neg_lo:[0,1] neg_hi:[0,1]
    v_pk_add_f32 v[10:11], v[26:27], v[74:75] neg_lo:[0,1] neg_hi:[0,1]
    v_pk_fma_f32 v[20:21], v[72:73], s[14:15], v[20:21]
    v_pk_fma_f32 v[22:23], v[74:75], s[14:15], v[22:23]
    v_pk_mul_f32 v[80:81], v[12:13], s[32:33]
    v_pk_mul_f32 v[82:83], v[14:15], s[32:33]
    v_pk_fma_f32 v[20:21], v[8:9], s[12:13], v[20:21]
    v_pk_fma_f32 v[22:23], v[10:11], s[12:13], v[22:23]
    v_pk_fma_f32 v[80:81], v[4:5], s[34:35], v[80:81]
    v_pk_fma_f32 v[82:83], v[6:7], s[34:35], v[82:83]
    v_pk_fma_f32 v[64:65], v[4:5], s[24:25], v[20:21] neg_lo:[0,0,1] neg_hi:[0,0,1]
    v_pk_fma_f32 v[66:67], v[6:7], s[24:25], v[22:23] neg_lo:[0,0,1] neg_hi:[0,0,1]
    v_pk_fma_f32 v[64:65], v[12:13], s[26:27], v[64:65]
    v_pk_fma_f32 v[66:67], v[14:15], s[26:27], v[66:67]
    v_pk_fma_f32 v[80:81], v[64:65], s[38:39], v[80:81]
    v_pk_fma_f32 v[82:83], v[66:67], s[38:39], v[82:83]
    v_pk_add_f32 v[4:5], v[4:5], v[64:65] neg_lo:[0,1] neg_hi:[0,1]
    v_pk_add_f32 v[6:7], v[6:7], v[66:67] neg_lo:[0,1] neg_hi:[0,1]
    v_pk_add_f32 v[4:5], v[4:5], v[80:81] neg_lo:[0,1] neg_hi:[0,1]
    v_pk_add_f32 v[6:7], v[6:7], v[82:83] neg_lo:[0,1] neg_hi:[0,1]
    s_waitcnt lgkmcnt(0)
    v_pk_add_f32 v[92:93], v[56:57], v[60:61]
    v_pk_add_f32 v[94:95], v[58:59], v[62:63]
    v_pk_add_f32 v[56:57], v[36:37], v[40:41]
    v_pk_add_f32 v[58:59], v[38:39], v[42:43]
    v_pk_add_f32 v[36:37], v[36:37], v[40:41] neg_lo:[0,1] neg_hi:[0,1]
    v_pk_add_f32 v[38:39], v[38:39], v[42:43] neg_lo:[0,1] neg_hi:[0,1]
    v_pk_add_f32 v[76:77], v[44:45], v[48:49]
    v_pk_add_f32 v[78:79], v[46:47], v[50:51]
    v_pk_add_f32 v[44:45], v[44:45], v[48:49] neg_lo:[0,1] neg_hi:[0,1]
    v_pk_add_f32 v[46:47], v[46:47], v[50:51] neg_lo:[0,1] neg_hi:[0,1]
    v_pk_fma_f32 v[76:77], v[56:57], s[4:5], v[76:77]
    v_pk_fma_f32 v[78:79], v[58:59], s[4:5], v[78:79]
    v_pk_fma_f32 v[52:53], v[32:33], s[10:11], v[52:53]
    v_pk_fma_f32 v[54:55], v[34:35], s[10:11], v[54:55]
    v_pk_fma_f32 v[76:77], v[32:33], s[6:7], v[76:77]
    v_pk_fma_f32 v[78:79], v[34:35], s[6:7], v[78:79]
    v_pk_add_f32 v[56:57], v[56:57], v[32:33] neg_lo:[0,1] neg_hi:[0,1]
    v_pk_add_f32 v[58:59], v[58:59], v[34:35] neg_lo:[0,1] neg_hi:[0,1]
    v_pk_fma_f32 v[76:77], v[92:93], s[8:9], v[76:77]
    v_pk_fma_f32 v[78:79], v[94:95], s[8:9], v[78:79]
    v_pk_add_f32 v[56:57], v[56:57], v[92:93] neg_lo:[0,1] neg_hi:[0,1]
    v_pk_add_f32 v[58:59], v[58:59], v[94:95] neg_lo:[0,1] neg_hi:[0,1]
    v_pk_fma_f32 v[52:53], v[92:93], s[22:23], v[52:53]
    v_pk_fma_f32 v[54:55], v[94:95], s[22:23], v[54:55]
    v_pk_add_f32 v[40:41], v[56:57], v[76:77] neg_lo:[0,1] neg_hi:[0,1]
    v_pk_add_f32 v[42:43], v[58:59], v[78:79] neg_lo:[0,1] neg_hi:[0,1]
    v_pk_fma_f32 v[52:53], v[76:77], s[14:15], v[52:53]
    v_pk_fma_f32 v[54:55], v[78:79], s[14:15], v[54:55]
    v_pk_mul_f32 v[84:85], v[44:45], s[32:33]
    v_pk_mul_f32 v[86:87], v[46:47], s[32:33]
    v_pk_fma_f32 v[52:53], v[40:41], s[12:13], v[52:53]
    v_pk_fma_f32 v[54:55], v[42:43], s[12:13], v[54:55]
    v_pk_fma_f32 v[84:85], v[36:37], s[34:35], v[84:85]
    v_pk_fma_f32 v[86:87], v[38:39], s[34:35], v[86:87]
    v_pk_fma_f32 v[68:69], v[36:37], s[24:25], v[52:53] neg_lo:[0,0,1] neg_hi:[0,0,1]
    v_pk_fma_f32 v[70:71], v[38:39], s[24:25], v[54:55] neg_lo:[0,0,1] neg_hi:[0,0,1]
    v_pk_fma_f32 v[68:69], v[44:45], s[26:27], v[68:69]
    v_pk_fma_f32 v[70:71], v[46:47], s[26:27], v[70:71]
    v_pk_fma_f32 v[84:85], v[68:69], s[38:39], v[84:85]
    v_pk_fma_f32 v[86:87], v[70:71], s[38:39], v[86:87]
    v_pk_add_f32 v[36:37], v[36:37], v[68:69] neg_lo:[0,1] neg_hi:[0,1]
    v_pk_add_f32 v[38:39], v[38:39], v[70:71] neg_lo:[0,1] neg_hi:[0,1]
    v_pk_add_f32 v[36:37], v[36:37], v[84:85] neg_lo:[0,1] neg_hi:[0,1]
    v_pk_add_f32 v[38:39], v[38:39], v[86:87] neg_lo:[0,1] neg_hi:[0,1]
    s_mov_b32 s36, 0x00010001
    s_mov_b32 s37, 0x00010001
    s_mov_b64 exec, s[36:37]
    ds_write_b128 v123, v[0:3] offset:0
    ds_write_b128 v123, v[32:35] offset:16
    ds_write_b128 v123, v[4:7] offset:32
    ds_write_b128 v123, v[36:39] offset:48
    ds_write_b128 v123, v[8:11] offset:64
    ds_write_b128 v123, v[40:43] offset:80
    s_mov_b64 exec, -1
    v_mov_b32 v44, 0xc0135761
    v_mov_b32 v45, v44
    v_cvt_pk_bf16_f32 v48, v64, v68
    v_cvt_pk_bf16_f32 v49, v65, v69
    v_cvt_pk_bf16_f32 v50, v66, v70
    v_cvt_pk_bf16_f32 v51, v67, v71
    s_mov_b32 s44, 0
    buffer_store_dwordx4 v[48:51], v122, s[16:19], s44 offen sc1
    s_waitcnt lgkmcnt(0)
    s_barrier
    ds_read_b128 v[96:99], v123 offset:512
    ds_read_b128 v[100:103], v123 offset:528
    ds_read_b128 v[104:107], v123 offset:544
    ds_read_b128 v[108:111], v123 offset:560
    ds_read_b128 v[112:115], v123 offset:576
    ds_read_b128 v[116:119], v123 offset:592
    s_waitcnt lgkmcnt(4)
    v_mov_b32_dpp v96, v0 row_shl:1 row_mask:0xf bank_mask:0xf
    v_mov_b32_dpp v97, v1 row_shl:1 row_mask:0xf bank_mask:0xf
    v_mov_b32_dpp v98, v2 row_shl:1 row_mask:0xf bank_mask:0xf
    v_mov_b32_dpp v99, v3 row_shl:1 row_mask:0xf bank_mask:0xf
    v_mov_b32_dpp v100, v32 row_shl:1 row_mask:0xf bank_mask:0xf
    v_mov_b32_dpp v101, v33 row_shl:1 row_mask:0xf bank_mask:0xf
    v_mov_b32_dpp v102, v34 row_shl:1 row_mask:0xf bank_mask:0xf
    v_mov_b32_dpp v103, v35 row_shl:1 row_mask:0xf bank_mask:0xf
    v_pk_add_f32 v[72:73], v[72:73], v[96:97]
    v_pk_add_f32 v[74:75], v[74:75], v[98:99]
    v_pk_add_f32 v[76:77], v[76:77], v[100:101]
    v_pk_add_f32 v[78:79], v[78:79], v[102:103]
    v_cvt_pk_bf16_f32 v52, v72, v76
    v_cvt_pk_bf16_f32 v53, v73, v77
    v_cvt_pk_bf16_f32 v54, v74, v78
    v_cvt_pk_bf16_f32 v55, v75, v79
    s_mov_b32 s44, 65536
    buffer_store_dwordx4 v[52:55], v122, s[16:19], s44 offen sc1
    s_waitcnt lgkmcnt(2)
    v_mov_b32_dpp v104, v4 row_shl:1 row_mask:0xf bank_mask:0xf
    v_mov_b32_dpp v105, v5 row_shl:1 row_mask:0xf bank_mask:0xf
    v_mov_b32_dpp v106, v6 row_shl:1 row_mask:0xf bank_mask:0xf
    v_mov_b32_dpp v107, v7 row_shl:1 row_mask:0xf bank_mask:0xf
    v_mov_b32_dpp v108, v36 row_shl:1 row_mask:0xf bank_mask:0xf
    v_mov_b32_dpp v109, v37 row_shl:1 row_mask:0xf bank_mask:0xf
    v_mov_b32_dpp v110, v38 row_shl:1 row_mask:0xf bank_mask:0xf
    v_mov_b32_dpp v111, v39 row_shl:1 row_mask:0xf bank_mask:0xf
    v_pk_add_f32 v[80:81], v[80:81], v[104:105]
    v_pk_add_f32 v[82:83], v[82:83], v[106:107]
    v_pk_add_f32 v[84:85], v[84:85], v[108:109]
    v_pk_add_f32 v[86:87], v[86:87], v[110:111]
    v_cvt_pk_bf16_f32 v56, v80, v84
    v_cvt_pk_bf16_f32 v57, v81, v85
    v_cvt_pk_bf16_f32 v58, v82, v86
    v_cvt_pk_bf16_f32 v59, v83, v87
    s_mov_b32 s44, 131072
    buffer_store_dwordx4 v[56:59], v122, s[16:19], s44 offen sc1
    s_waitcnt lgkmcnt(0)
    v_mov_b32_dpp v112, v8 row_shl:1 row_mask:0xf bank_mask:0xf
    v_mov_b32_dpp v113, v9 row_shl:1 row_mask:0xf bank_mask:0xf
    v_mov_b32_dpp v114, v10 row_shl:1 row_mask:0xf bank_mask:0xf
    v_mov_b32_dpp v115, v11 row_shl:1 row_mask:0xf bank_mask:0xf
    v_mov_b32_dpp v116, v40 row_shl:1 row_mask:0xf bank_mask:0xf
    v_mov_b32_dpp v117, v41 row_shl:1 row_mask:0xf bank_mask:0xf
    v_mov_b32_dpp v118, v42 row_shl:1 row_mask:0xf bank_mask:0xf
    v_mov_b32_dpp v119, v43 row_shl:1 row_mask:0xf bank_mask:0xf
    v_pk_add_f32 v[88:89], v[88:89], v[112:113]
    v_pk_add_f32 v[90:91], v[90:91], v[114:115]
    v_pk_add_f32 v[92:93], v[92:93], v[116:117]
    v_pk_add_f32 v[94:95], v[94:95], v[118:119]
    v_cvt_pk_bf16_f32 v60, v88, v92
    v_cvt_pk_bf16_f32 v61, v89, v93
    v_cvt_pk_bf16_f32 v62, v90, v94
    v_cvt_pk_bf16_f32 v63, v91, v95
    s_mov_b32 s44, 196608
    buffer_store_dwordx4 v[60:63], v122, s[16:19], s44 offen sc1
L_conv2_kernel_end:
L_conv2_kernel_done:
    s_endpgm
.globl joint_kernel
.p2align 8
.type joint_kernel,@function
joint_kernel:
    s_cmp_ge_u32 s2, 250
    s_cbranch_scc1 L_joint_kernel_done
    s_load_dwordx2 s[28:29], s[0:1], 56
    s_load_dwordx2 s[30:31], s[0:1], 72
    v_readfirstlane_b32 s20, v0
    s_lshr_b32 s20, s20, 6
    s_and_b32 s21, s20, 7
    v_and_b32 v127, 63, v0
    v_lshlrev_b32 v126, 4, v127
    s_cmp_ge_u32 s20, 8
    s_mov_b32 s33, 44171264
    s_cselect_b32 s33, 44040192, s33
    s_lshl_b32 s36, s21, 14
    s_add_u32 s33, s33, s36
    s_mov_b32 s14, 16384
    s_mov_b32 s15, 0x00020000
    s_lshl_b32 s35, s2, 9
    s_cmp_ge_u32 s2, 125
    s_cselect_b32 s36, 2033152, 0
    s_cselect_b32 s34, 8192, 0
    s_add_u32 s35, s35, s36
    s_add_u32 s34, s34, 44302336
    s_mov_b32 s10, 12582912
    s_mov_b32 s11, 0x00020000
    s_mov_b32 s42, 24576
    s_mov_b32 s43, 0x00020000
    s_waitcnt lgkmcnt(0)
    s_add_u32 s12, s30, s33
    s_addc_u32 s13, s31, 0
    s_add_u32 s40, s30, s34
    s_addc_u32 s41, s31, 0
    s_cmp_ge_u32 s20, 8
    s_cbranch_scc1 L_joint_kernel_T
    s_add_u32 s8, s30, 27262976
    s_addc_u32 s9, s31, 0
    v_mov_b32 v0, 99456
    v_mov_b32 v2, 0
    v_mov_b32 v3, 0
    ds_write_b64 v0, v[2:3]
    v_lshrrev_b32 v124, 5, v127
    v_and_b32 v123, 0x1ff, v126
    v_mul_u32_u24 v125, 65536, v124
    v_add_u32 v123, v125, v123
    s_mul_i32 s36, s21, 262144
    s_add_u32 s36, s36, s35
    s_add_u32 s37, s36, 8388608
    buffer_load_dwordx4 v[64:67], v123, s[8:11], s36 offen
    buffer_load_dwordx4 v[72:75], v123, s[8:11], s37 offen
    s_add_u32 s36, s36, 131072
    s_add_u32 s37, s36, 8388608
    buffer_load_dwordx4 v[68:71], v123, s[8:11], s36 offen
    buffer_load_dwordx4 v[76:79], v123, s[8:11], s37 offen
    s_lshl_b32 s38, s21, 10
    s_add_u32 s38, s38, 16384
    buffer_load_dwordx4 v[80:83], v126, s[40:43], s38 offen
    s_waitcnt lgkmcnt(0)
    s_barrier
    s_lshl_b32 s35, s2, 17
    s_add_u32 s16, s28, s35
    s_addc_u32 s17, s29, 0
    s_mov_b32 s18, 131072
    s_mov_b32 s19, 0x00020000
    s_mov_b32 s46, 0xbdd2d3e8
    s_mov_b32 s47, s46
    v_mov_b32 v120, 0xc0135761
    v_mov_b32 v121, v120
    s_mov_b32 s48, 1.0
    s_mov_b32 s49, 1.0
    v_bfe_u32 v123, v127, 2, 3
    v_lshl_add_u32 v124, v123, 2, v124
    v_mul_u32_u24 v124, 528, v124
    v_and_b32 v123, 0x30, v126
    s_lshl_b32 s36, s21, 6
    v_add3_u32 v124, v124, v123, s36
    s_mov_b32 s45, 0xffff0000
    s_mul_i32 s36, s21, 1040
    s_add_u32 s36, s36, 91136
    v_add_u32 v123, s36, v126
    s_mov_b32 s22, 2
    s_waitcnt vmcnt(3)
L_joint_kernel_floop:
    v_lshlrev_b32 v88, 16, v64
    v_and_b32 v89, s45, v64
    v_lshlrev_b32 v96, 16, v72
    v_and_b32 v97, s45, v72
    v_lshlrev_b32 v90, 16, v65
    v_and_b32 v91, s45, v65
    v_lshlrev_b32 v98, 16, v73
    v_and_b32 v99, s45, v73
    v_lshlrev_b32 v92, 16, v66
    v_and_b32 v93, s45, v66
    v_lshlrev_b32 v100, 16, v74
    v_and_b32 v101, s45, v74
    v_lshlrev_b32 v94, 16, v67
    v_and_b32 v95, s45, v67
    v_lshlrev_b32 v102, 16, v75
    v_and_b32 v103, s45, v75
    v_pk_add_f32 v[88:89], v[88:89], v[96:97]
    v_pk_add_f32 v[90:91], v[90:91], v[98:99]
    v_pk_add_f32 v[92:93], v[92:93], v[100:101]
    v_pk_add_f32 v[94:95], v[94:95], v[102:103]
    v_pk_mul_f32 v[96:97], v[88:89], v[88:89]
    v_pk_mul_f32 v[98:99], v[90:91], v[90:91]
    v_pk_mul_f32 v[100:101], v[92:93], v[92:93]
    v_pk_mul_f32 v[102:103], v[94:95], v[94:95]
    v_pk_fma_f32 v[96:97], v[96:97], s[46:47], v[120:121]
    v_pk_fma_f32 v[98:99], v[98:99], s[46:47], v[120:121]
    v_pk_fma_f32 v[100:101], v[100:101], s[46:47], v[120:121]
    v_pk_fma_f32 v[102:103], v[102:103], s[46:47], v[120:121]
    v_pk_mul_f32 v[96:97], v[96:97], v[88:89]
    v_pk_mul_f32 v[98:99], v[98:99], v[90:91]
    v_pk_mul_f32 v[100:101], v[100:101], v[92:93]
    v_pk_mul_f32 v[102:103], v[102:103], v[94:95]
    v_exp_f32 v96, v96
    v_exp_f32 v97, v97
    v_exp_f32 v98, v98
    v_exp_f32 v99, v99
    v_exp_f32 v100, v100
    v_exp_f32 v101, v101
    v_exp_f32 v102, v102
    v_exp_f32 v103, v103
    v_pk_add_f32 v[96:97], v[96:97], s[48:49]
    v_pk_add_f32 v[98:99], v[98:99], s[48:49]
    v_pk_add_f32 v[100:101], v[100:101], s[48:49]
    v_pk_add_f32 v[102:103], v[102:103], s[48:49]
    v_rcp_f32 v96, v96
    v_rcp_f32 v97, v97
    v_rcp_f32 v98, v98
    v_rcp_f32 v99, v99
    v_rcp_f32 v100, v100
    v_rcp_f32 v101, v101
    v_rcp_f32 v102, v102
    v_rcp_f32 v103, v103
    v_pk_mul_f32 v[88:89], v[88:89], v[96:97]
    v_pk_mul_f32 v[90:91], v[90:91], v[98:99]
    v_pk_mul_f32 v[92:93], v[92:93], v[100:101]
    v_pk_mul_f32 v[94:95], v[94:95], v[102:103]
    v_cvt_pk_bf16_f32 v104, v88, v89
    v_cvt_pk_bf16_f32 v105, v90, v91
    v_cvt_pk_bf16_f32 v106, v92, v93
    v_cvt_pk_bf16_f32 v107, v94, v95
    ds_write_b128 v124, v[104:107] offset:32768
    s_waitcnt vmcnt(0)
    v_pk_mov_b32 v[64:65], v[68:69], v[68:69] op_sel:[0,1]
    v_pk_mov_b32 v[72:73], v[76:77], v[76:77] op_sel:[0,1]
    v_pk_mov_b32 v[66:67], v[70:71], v[70:71] op_sel:[0,1]
    v_pk_mov_b32 v[74:75], v[78:79], v[78:79] op_sel:[0,1]
    v_add_u32 v124, 1056, v124
    s_sub_u32 s22, s22, 1
    s_cmp_lg_u32 s22, 0
    s_cbranch_scc1 L_joint_kernel_floop
    ds_write_b128 v123, v[80:83]
    s_waitcnt lgkmcnt(0)
    v_mov_b32 v120, 99456
    v_mov_b32 v121, 1
    s_mov_b64 exec, 1
    ds_add_u32 v120, v121 offset:0
    s_mov_b64 exec, -1
L_joint_kernel_ow:
    ds_read_b32 v121, v120 offset:4
    s_waitcnt lgkmcnt(0)
    v_readfirstlane_b32 s37, v121
    s_cmp_ge_u32 s37, 8
    s_cbranch_scc1 L_joint_kernel_ow_d
    s_sleep 1
    s_branch L_joint_kernel_ow
L_joint_kernel_ow_d:
    s_mov_b32 s36, 0
    buffer_load_dwordx4 v[0:3], v126, s[12:15], s36 offen offset:0
    buffer_load_dwordx4 v[4:7], v126, s[12:15], s36 offen offset:1024
    buffer_load_dwordx4 v[8:11], v126, s[12:15], s36 offen offset:2048
    buffer_load_dwordx4 v[12:15], v126, s[12:15], s36 offen offset:3072
    s_mov_b32 s36, 4096
    buffer_load_dwordx4 v[16:19], v126, s[12:15], s36 offen offset:0
    buffer_load_dwordx4 v[20:23], v126, s[12:15], s36 offen offset:1024
    buffer_load_dwordx4 v[24:27], v126, s[12:15], s36 offen offset:2048
    buffer_load_dwordx4 v[28:31], v126, s[12:15], s36 offen offset:3072
    s_mov_b32 s36, 8192
    buffer_load_dwordx4 v[32:35], v126, s[12:15], s36 offen offset:0
    buffer_load_dwordx4 v[36:39], v126, s[12:15], s36 offen offset:1024
    buffer_load_dwordx4 v[40:43], v126, s[12:15], s36 offen offset:2048
    buffer_load_dwordx4 v[44:47], v126, s[12:15], s36 offen offset:3072
    s_mov_b32 s36, 12288
    buffer_load_dwordx4 v[48:51], v126, s[12:15], s36 offen offset:0
    buffer_load_dwordx4 v[52:55], v126, s[12:15], s36 offen offset:1024
    buffer_load_dwordx4 v[56:59], v126, s[12:15], s36 offen offset:2048
    buffer_load_dwordx4 v[60:63], v126, s[12:15], s36 offen offset:3072
    v_lshrrev_b32 v125, 4, v127
    v_lshlrev_b32 v125, 11, v125
    v_and_b32 v124, 15, v127
    v_lshl_add_u32 v125, v124, 2, v125
    s_lshl_b32 s36, s21, 6
    v_add_u32 v125, s36, v125
    s_mov_b32 s44, 8192
    s_setprio 1
    s_barrier
    ds_read_b128 v[96:99], v126 offset:0
    ds_read_b128 v[100:103], v126 offset:1024
    ds_read_b128 v[104:107], v126 offset:2048
    ds_read_b128 v[108:111], v126 offset:3072
    s_waitcnt vmcnt(14) lgkmcnt(3)
    v_mfma_f32_16x16x32_bf16 v[64:67], v[96:99], v[0:3], 0
    v_mfma_f32_16x16x32_bf16 v[68:71], v[96:99], v[4:7], 0
    ds_read_b128 v[96:99], v126 offset:4096
    s_waitcnt lgkmcnt(3)
    v_mfma_f32_16x16x32_bf16 v[72:75], v[100:103], v[0:3], 0
    v_mfma_f32_16x16x32_bf16 v[76:79], v[100:103], v[4:7], 0
    ds_read_b128 v[100:103], v126 offset:5120
    s_waitcnt vmcnt(12) lgkmcnt(3)
    v_mfma_f32_16x16x32_bf16 v[64:67], v[104:107], v[8:11], v[64:67]
    v_mfma_f32_16x16x32_bf16 v[68:71], v[104:107], v[12:15], v[68:71]
    ds_read_b128 v[104:107], v126 offset:6144
    s_waitcnt lgkmcnt(3)
    v_mfma_f32_16x16x32_bf16 v[72:75], v[108:111], v[8:11], v[72:75]
    v_mfma_f32_16x16x32_bf16 v[76:79], v[108:111], v[12:15], v[76:79]
    ds_read_b128 v[108:111], v126 offset:7168
    s_waitcnt vmcnt(10) lgkmcnt(3)
    v_mfma_f32_16x16x32_bf16 v[64:67], v[96:99], v[16:19], v[64:67]
    v_mfma_f32_16x16x32_bf16 v[68:71], v[96:99], v[20:23], v[68:71]
    ds_read_b128 v[96:99], v126 offset:8192
    s_waitcnt lgkmcnt(3)
    v_mfma_f32_16x16x32_bf16 v[72:75], v[100:103], v[16:19], v[72:75]
    v_mfma_f32_16x16x32_bf16 v[76:79], v[100:103], v[20:23], v[76:79]
    ds_read_b128 v[100:103], v126 offset:9216
    s_waitcnt vmcnt(8) lgkmcnt(3)
    v_mfma_f32_16x16x32_bf16 v[64:67], v[104:107], v[24:27], v[64:67]
    v_mfma_f32_16x16x32_bf16 v[68:71], v[104:107], v[28:31], v[68:71]
    ds_read_b128 v[104:107], v126 offset:10240
    s_waitcnt lgkmcnt(3)
    v_mfma_f32_16x16x32_bf16 v[72:75], v[108:111], v[24:27], v[72:75]
    v_mfma_f32_16x16x32_bf16 v[76:79], v[108:111], v[28:31], v[76:79]
    ds_read_b128 v[108:111], v126 offset:11264
    s_waitcnt vmcnt(6) lgkmcnt(3)
    v_mfma_f32_16x16x32_bf16 v[64:67], v[96:99], v[32:35], v[64:67]
    v_mfma_f32_16x16x32_bf16 v[68:71], v[96:99], v[36:39], v[68:71]
    ds_read_b128 v[96:99], v126 offset:12288
    s_waitcnt lgkmcnt(3)
    v_mfma_f32_16x16x32_bf16 v[72:75], v[100:103], v[32:35], v[72:75]
    v_mfma_f32_16x16x32_bf16 v[76:79], v[100:103], v[36:39], v[76:79]
    ds_read_b128 v[100:103], v126 offset:13312
    s_waitcnt vmcnt(4) lgkmcnt(3)
    v_mfma_f32_16x16x32_bf16 v[64:67], v[104:107], v[40:43], v[64:67]
    v_mfma_f32_16x16x32_bf16 v[68:71], v[104:107], v[44:47], v[68:71]
    ds_read_b128 v[104:107], v126 offset:14336
    s_waitcnt lgkmcnt(3)
    v_mfma_f32_16x16x32_bf16 v[72:75], v[108:111], v[40:43], v[72:75]
    v_mfma_f32_16x16x32_bf16 v[76:79], v[108:111], v[44:47], v[76:79]
    ds_read_b128 v[108:111], v126 offset:15360
    s_waitcnt vmcnt(2) lgkmcnt(3)
    v_mfma_f32_16x16x32_bf16 v[64:67], v[96:99], v[48:51], v[64:67]
    v_mfma_f32_16x16x32_bf16 v[68:71], v[96:99], v[52:55], v[68:71]
    s_waitcnt lgkmcnt(0)
    s_barrier
    ds_read_b128 v[96:99], v126 offset:16384
    v_mfma_f32_16x16x32_bf16 v[72:75], v[100:103], v[48:51], v[72:75]
    v_mfma_f32_16x16x32_bf16 v[76:79], v[100:103], v[52:55], v[76:79]
    ds_read_b128 v[100:103], v126 offset:17408
    s_waitcnt vmcnt(0)
    v_mfma_f32_16x16x32_bf16 v[64:67], v[104:107], v[56:59], v[64:67]
    v_mfma_f32_16x16x32_bf16 v[68:71], v[104:107], v[60:63], v[68:71]
    ds_read_b128 v[104:107], v126 offset:18432
    v_mfma_f32_16x16x32_bf16 v[72:75], v[108:111], v[56:59], v[72:75]
    v_mfma_f32_16x16x32_bf16 v[76:79], v[108:111], v[60:63], v[76:79]
    ds_read_b128 v[108:111], v126 offset:19456
    s_mov_b32 s22, 4
L_joint_kernel_oloop:
    s_waitcnt lgkmcnt(3)
    v_mfma_f32_16x16x32_bf16 v[80:83], v[96:99], v[0:3], 0
    v_mfma_f32_16x16x32_bf16 v[84:87], v[96:99], v[4:7], 0
    ds_read_b128 v[96:99], v126 offset:20480
    s_waitcnt lgkmcnt(3)
    v_mfma_f32_16x16x32_bf16 v[88:91], v[100:103], v[0:3], 0
    v_mfma_f32_16x16x32_bf16 v[92:95], v[100:103], v[4:7], 0
    ds_read_b128 v[100:103], v126 offset:21504
    s_waitcnt lgkmcnt(3)
    v_mfma_f32_16x16x32_bf16 v[80:83], v[104:107], v[8:11], v[80:83]
    v_mfma_f32_16x16x32_bf16 v[84:87], v[104:107], v[12:15], v[84:87]
    ds_read_b128 v[104:107], v126 offset:22528
    s_waitcnt lgkmcnt(3)
    v_mfma_f32_16x16x32_bf16 v[88:91], v[108:111], v[8:11], v[88:91]
    v_cvt_pk_bf16_f32 v112, v64, v68
    v_mfma_f32_16x16x32_bf16 v[92:95], v[108:111], v[12:15], v[92:95]
    buffer_store_dword v112, v125, s[16:19], 0 offen offset:0 nt
    ds_read_b128 v[108:111], v126 offset:23552
    s_waitcnt lgkmcnt(3)
    v_mfma_f32_16x16x32_bf16 v[80:83], v[96:99], v[16:19], v[80:83]
    v_cvt_pk_bf16_f32 v113, v65, v69
    v_mfma_f32_16x16x32_bf16 v[84:87], v[96:99], v[20:23], v[84:87]
    buffer_store_dword v113, v125, s[16:19], 0 offen offset:512 nt
    ds_read_b128 v[96:99], v126 offset:24576
    s_waitcnt lgkmcnt(3)
    v_mfma_f32_16x16x32_bf16 v[88:91], v[100:103], v[16:19], v[88:91]
    v_cvt_pk_bf16_f32 v114, v66, v70
    v_mfma_f32_16x16x32_bf16 v[92:95], v[100:103], v[20:23], v[92:95]
    buffer_store_dword v114, v125, s[16:19], 0 offen offset:1024 nt
    ds_read_b128 v[100:103], v126 offset:25600
    s_waitcnt lgkmcnt(3)
    v_mfma_f32_16x16x32_bf16 v[80:83], v[104:107], v[24:27], v[80:83]
    v_cvt_pk_bf16_f32 v115, v67, v71
    v_mfma_f32_16x16x32_bf16 v[84:87], v[104:107], v[28:31], v[84:87]
    buffer_store_dword v115, v125, s[16:19], 0 offen offset:1536 nt
    ds_read_b128 v[104:107], v126 offset:26624
    s_waitcnt lgkmcnt(3)
    v_mfma_f32_16x16x32_bf16 v[88:91], v[108:111], v[24:27], v[88:91]
    v_cvt_pk_bf16_f32 v116, v72, v76
    v_mfma_f32_16x16x32_bf16 v[92:95], v[108:111], v[28:31], v[92:95]
    buffer_store_dword v116, v125, s[16:19], s44 offen offset:0 nt
    ds_read_b128 v[108:111], v126 offset:27648
    s_waitcnt lgkmcnt(3)
    v_mfma_f32_16x16x32_bf16 v[80:83], v[96:99], v[32:35], v[80:83]
    v_cvt_pk_bf16_f32 v117, v73, v77
    v_mfma_f32_16x16x32_bf16 v[84:87], v[96:99], v[36:39], v[84:87]
    buffer_store_dword v117, v125, s[16:19], s44 offen offset:512 nt
    ds_read_b128 v[96:99], v126 offset:28672
    s_waitcnt lgkmcnt(3)
    v_mfma_f32_16x16x32_bf16 v[88:91], v[100:103], v[32:35], v[88:91]
    v_cvt_pk_bf16_f32 v118, v74, v78
    v_mfma_f32_16x16x32_bf16 v[92:95], v[100:103], v[36:39], v[92:95]
    buffer_store_dword v118, v125, s[16:19], s44 offen offset:1024 nt
    ds_read_b128 v[100:103], v126 offset:29696
    s_waitcnt lgkmcnt(3)
    v_mfma_f32_16x16x32_bf16 v[80:83], v[104:107], v[40:43], v[80:83]
    v_cvt_pk_bf16_f32 v119, v75, v79
    v_mfma_f32_16x16x32_bf16 v[84:87], v[104:107], v[44:47], v[84:87]
    buffer_store_dword v119, v125, s[16:19], s44 offen offset:1536 nt
    ds_read_b128 v[104:107], v126 offset:30720
    s_waitcnt lgkmcnt(3)
    v_mfma_f32_16x16x32_bf16 v[88:91], v[108:111], v[40:43], v[88:91]
    v_add_u32 v125, 16384, v125
    v_mfma_f32_16x16x32_bf16 v[92:95], v[108:111], v[44:47], v[92:95]
    ds_read_b128 v[108:111], v126 offset:31744
    s_waitcnt lgkmcnt(3)
    v_mfma_f32_16x16x32_bf16 v[80:83], v[96:99], v[48:51], v[80:83]
    v_mfma_f32_16x16x32_bf16 v[84:87], v[96:99], v[52:55], v[84:87]
    s_waitcnt lgkmcnt(0)
    s_barrier
    ds_read_b128 v[96:99], v126 offset:0
    v_mfma_f32_16x16x32_bf16 v[88:91], v[100:103], v[48:51], v[88:91]
    v_mfma_f32_16x16x32_bf16 v[92:95], v[100:103], v[52:55], v[92:95]
    ds_read_b128 v[100:103], v126 offset:1024
    v_mfma_f32_16x16x32_bf16 v[80:83], v[104:107], v[56:59], v[80:83]
    v_mfma_f32_16x16x32_bf16 v[84:87], v[104:107], v[60:63], v[84:87]
    ds_read_b128 v[104:107], v126 offset:2048
    v_mfma_f32_16x16x32_bf16 v[88:91], v[108:111], v[56:59], v[88:91]
    v_mfma_f32_16x16x32_bf16 v[92:95], v[108:111], v[60:63], v[92:95]
    ds_read_b128 v[108:111], v126 offset:3072
    s_sub_u32 s22, s22, 1
    s_cmp_eq_u32 s22, 0
    s_cbranch_scc1 L_joint_kernel_oend
    s_waitcnt lgkmcnt(3)
    v_mfma_f32_16x16x32_bf16 v[64:67], v[96:99], v[0:3], 0
    v_mfma_f32_16x16x32_bf16 v[68:71], v[96:99], v[4:7], 0
    ds_read_b128 v[96:99], v126 offset:4096
    s_waitcnt lgkmcnt(3)
    v_mfma_f32_16x16x32_bf16 v[72:75], v[100:103], v[0:3], 0
    v_mfma_f32_16x16x32_bf16 v[76:79], v[100:103], v[4:7], 0
    ds_read_b128 v[100:103], v126 offset:5120
    s_waitcnt lgkmcnt(3)
    v_mfma_f32_16x16x32_bf16 v[64:67], v[104:107], v[8:11], v[64:67]
    v_mfma_f32_16x16x32_bf16 v[68:71], v[104:107], v[12:15], v[68:71]
    ds_read_b128 v[104:107], v126 offset:6144
    s_waitcnt lgkmcnt(3)
    v_mfma_f32_16x16x32_bf16 v[72:75], v[108:111], v[8:11], v[72:75]
    v_cvt_pk_bf16_f32 v112, v80, v84
    v_mfma_f32_16x16x32_bf16 v[76:79], v[108:111], v[12:15], v[76:79]
    buffer_store_dword v112, v125, s[16:19], 0 offen offset:0 nt
    ds_read_b128 v[108:111], v126 offset:7168
    s_waitcnt lgkmcnt(3)
    v_mfma_f32_16x16x32_bf16 v[64:67], v[96:99], v[16:19], v[64:67]
    v_cvt_pk_bf16_f32 v113, v81, v85
    v_mfma_f32_16x16x32_bf16 v[68:71], v[96:99], v[20:23], v[68:71]
    buffer_store_dword v113, v125, s[16:19], 0 offen offset:512 nt
    ds_read_b128 v[96:99], v126 offset:8192
    s_waitcnt lgkmcnt(3)
    v_mfma_f32_16x16x32_bf16 v[72:75], v[100:103], v[16:19], v[72:75]
    v_cvt_pk_bf16_f32 v114, v82, v86
    v_mfma_f32_16x16x32_bf16 v[76:79], v[100:103], v[20:23], v[76:79]
    buffer_store_dword v114, v125, s[16:19], 0 offen offset:1024 nt
    ds_read_b128 v[100:103], v126 offset:9216
    s_waitcnt lgkmcnt(3)
    v_mfma_f32_16x16x32_bf16 v[64:67], v[104:107], v[24:27], v[64:67]
    v_cvt_pk_bf16_f32 v115, v83, v87
    v_mfma_f32_16x16x32_bf16 v[68:71], v[104:107], v[28:31], v[68:71]
    buffer_store_dword v115, v125, s[16:19], 0 offen offset:1536 nt
    ds_read_b128 v[104:107], v126 offset:10240
    s_waitcnt lgkmcnt(3)
    v_mfma_f32_16x16x32_bf16 v[72:75], v[108:111], v[24:27], v[72:75]
    v_cvt_pk_bf16_f32 v116, v88, v92
    v_mfma_f32_16x16x32_bf16 v[76:79], v[108:111], v[28:31], v[76:79]
    buffer_store_dword v116, v125, s[16:19], s44 offen offset:0 nt
    ds_read_b128 v[108:111], v126 offset:11264
    s_waitcnt lgkmcnt(3)
    v_mfma_f32_16x16x32_bf16 v[64:67], v[96:99], v[32:35], v[64:67]
    v_cvt_pk_bf16_f32 v117, v89, v93
    v_mfma_f32_16x16x32_bf16 v[68:71], v[96:99], v[36:39], v[68:71]
    buffer_store_dword v117, v125, s[16:19], s44 offen offset:512 nt
    ds_read_b128 v[96:99], v126 offset:12288
    s_waitcnt lgkmcnt(3)
    v_mfma_f32_16x16x32_bf16 v[72:75], v[100:103], v[32:35], v[72:75]
    v_cvt_pk_bf16_f32 v118, v90, v94
    v_mfma_f32_16x16x32_bf16 v[76:79], v[100:103], v[36:39], v[76:79]
    buffer_store_dword v118, v125, s[16:19], s44 offen offset:1024 nt
    ds_read_b128 v[100:103], v126 offset:13312
    s_waitcnt lgkmcnt(3)
    v_mfma_f32_16x16x32_bf16 v[64:67], v[104:107], v[40:43], v[64:67]
    v_cvt_pk_bf16_f32 v119, v91, v95
    v_mfma_f32_16x16x32_bf16 v[68:71], v[104:107], v[44:47], v[68:71]
    buffer_store_dword v119, v125, s[16:19], s44 offen offset:1536 nt
    ds_read_b128 v[104:107], v126 offset:14336
    s_waitcnt lgkmcnt(3)
    v_mfma_f32_16x16x32_bf16 v[72:75], v[108:111], v[40:43], v[72:75]
    v_add_u32 v125, 16384, v125
    v_mfma_f32_16x16x32_bf16 v[76:79], v[108:111], v[44:47], v[76:79]
    ds_read_b128 v[108:111], v126 offset:15360
    s_waitcnt lgkmcnt(3)
    v_mfma_f32_16x16x32_bf16 v[64:67], v[96:99], v[48:51], v[64:67]
    v_mfma_f32_16x16x32_bf16 v[68:71], v[96:99], v[52:55], v[68:71]
    s_waitcnt lgkmcnt(0)
    s_barrier
    ds_read_b128 v[96:99], v126 offset:16384
    v_mfma_f32_16x16x32_bf16 v[72:75], v[100:103], v[48:51], v[72:75]
    v_mfma_f32_16x16x32_bf16 v[76:79], v[100:103], v[52:55], v[76:79]
    ds_read_b128 v[100:103], v126 offset:17408
    v_mfma_f32_16x16x32_bf16 v[64:67], v[104:107], v[56:59], v[64:67]
    v_mfma_f32_16x16x32_bf16 v[68:71], v[104:107], v[60:63], v[68:71]
    ds_read_b128 v[104:107], v126 offset:18432
    v_mfma_f32_16x16x32_bf16 v[72:75], v[108:111], v[56:59], v[72:75]
    v_mfma_f32_16x16x32_bf16 v[76:79], v[108:111], v[60:63], v[76:79]
    ds_read_b128 v[108:111], v126 offset:19456
    s_waitcnt vmcnt(32)
    s_branch L_joint_kernel_oloop
L_joint_kernel_oend:
    s_nop 7
    v_cvt_pk_bf16_f32 v112, v80, v84
    buffer_store_dword v112, v125, s[16:19], 0 offen offset:0 nt
    v_cvt_pk_bf16_f32 v113, v81, v85
    buffer_store_dword v113, v125, s[16:19], 0 offen offset:512 nt
    v_cvt_pk_bf16_f32 v114, v82, v86
    buffer_store_dword v114, v125, s[16:19], 0 offen offset:1024 nt
    v_cvt_pk_bf16_f32 v115, v83, v87
    buffer_store_dword v115, v125, s[16:19], 0 offen offset:1536 nt
    v_cvt_pk_bf16_f32 v116, v88, v92
    buffer_store_dword v116, v125, s[16:19], s44 offen offset:0 nt
    v_cvt_pk_bf16_f32 v117, v89, v93
    buffer_store_dword v117, v125, s[16:19], s44 offen offset:512 nt
    v_cvt_pk_bf16_f32 v118, v90, v94
    buffer_store_dword v118, v125, s[16:19], s44 offen offset:1024 nt
    v_cvt_pk_bf16_f32 v119, v91, v95
    buffer_store_dword v119, v125, s[16:19], s44 offen offset:1536 nt
    v_add_u32 v125, 16384, v125
    s_branch L_joint_kernel_fin
L_joint_kernel_T:
    s_setprio 3
    s_lshl_b32 s36, s21, 2
    s_add_u32 s36, s36, 44335104
    s_add_u32 s36, s30, s36
    s_addc_u32 s37, s31, 0
    s_load_dword s44, s[36:37], 0
    v_and_b32 v123, 15, v127
    v_lshrrev_b32 v121, 4, v127
    v_mul_u32_u24 v125, 528, v123
    v_lshl_add_u32 v125, v121, 4, v125
    v_lshlrev_b32 v121, 5, v121
    v_and_b32 v120, 7, v127
    v_lshl_add_u32 v124, v120, 10, v121
    s_lshl_b32 s38, s21, 7
    v_mul_u32_u24 v120, 1040, v120
    s_add_u32 s36, s38, 91136
    v_add3_u32 v120, v120, v121, s36
    s_mul_i32 s36, s21, 5184
    s_add_u32 s36, s36, 49664
    v_add_u32 v121, s36, v121
    v_mul_u32_u24 v122, 144, v123
    v_add_u32 v122, v122, v121
    v_lshrrev_b32 v123, 3, v123
    v_mul_u32_u24 v123, 144, v123
    v_add_u32 v121, v123, v121
    s_lshl_b32 s36, s21, 11
    v_add_u32 v123, s36, v126
    s_barrier
    s_mov_b32 s36, 0
    buffer_load_dwordx4 v[0:3], v126, s[12:15], s36 offen offset:0
    buffer_load_dwordx4 v[4:7], v126, s[12:15], s36 offen offset:1024
    buffer_load_dwordx4 v[8:11], v126, s[12:15], s36 offen offset:2048
    buffer_load_dwordx4 v[12:15], v126, s[12:15], s36 offen offset:3072
    s_mov_b32 s36, 4096
    buffer_load_dwordx4 v[16:19], v126, s[12:15], s36 offen offset:0
    buffer_load_dwordx4 v[20:23], v126, s[12:15], s36 offen offset:1024
    buffer_load_dwordx4 v[24:27], v126, s[12:15], s36 offen offset:2048
    buffer_load_dwordx4 v[28:31], v126, s[12:15], s36 offen offset:3072
    s_mov_b32 s36, 8192
    buffer_load_dwordx4 v[32:35], v126, s[12:15], s36 offen offset:0
    buffer_load_dwordx4 v[36:39], v126, s[12:15], s36 offen offset:1024
    buffer_load_dwordx4 v[40:43], v126, s[12:15], s36 offen offset:2048
    buffer_load_dwordx4 v[44:47], v126, s[12:15], s36 offen offset:3072
    s_mov_b32 s36, 12288
    buffer_load_dwordx4 v[48:51], v126, s[12:15], s36 offen offset:0
    buffer_load_dwordx4 v[52:55], v126, s[12:15], s36 offen offset:1024
    buffer_load_dwordx4 v[56:59], v126, s[12:15], s36 offen offset:2048
    buffer_load_dwordx4 v[60:63], v126, s[12:15], s36 offen offset:3072
    v_mov_b32 v64, 99456
    v_mov_b32 v65, 1
    s_mov_b64 exec, 1
    ds_add_u32 v64, v65 offset:4
    s_mov_b64 exec, -1
L_joint_kernel_tw:
    ds_read_b32 v65, v64 offset:0
    s_waitcnt lgkmcnt(0)
    v_readfirstlane_b32 s37, v65
    s_cmp_ge_u32 s37, 8
    s_cbranch_scc1 L_joint_kernel_tw_d
    s_sleep 1
    s_branch L_joint_kernel_tw
L_joint_kernel_tw_d:
    ds_read_b128 v[80:83], v125 offset:32768
    ds_read_b128 v[84:87], v125 offset:41216
    ds_read_b128 v[88:91], v125 offset:32832
    ds_read_b128 v[92:95], v125 offset:41280
    ds_read_b128 v[96:99], v125 offset:32896
    ds_read_b128 v[100:103], v125 offset:41344
    ds_read_b128 v[104:107], v125 offset:32960
    ds_read_b128 v[108:111], v125 offset:41408
    s_setprio 0
    s_waitcnt vmcnt(14) lgkmcnt(7)
    v_mfma_f32_16x16x32_bf16 v[64:67], v[0:3], v[80:83], 0
    v_mfma_f32_16x16x32_bf16 v[68:71], v[4:7], v[80:83], 0
    ds_read_b128 v[80:83], v125 offset:33024
    s_waitcnt lgkmcnt(7)
    v_mfma_f32_16x16x32_bf16 v[72:75], v[0:3], v[84:87], 0
    v_mfma_f32_16x16x32_bf16 v[76:79], v[4:7], v[84:87], 0
    ds_read_b128 v[84:87], v125 offset:41472
    s_waitcnt vmcnt(12) lgkmcnt(7)
    v_mfma_f32_16x16x32_bf16 v[64:67], v[8:11], v[88:91], v[64:67]
    v_mfma_f32_16x16x32_bf16 v[68:71], v[12:15], v[88:91], v[68:71]
    ds_read_b128 v[88:91], v125 offset:33088
    s_waitcnt lgkmcnt(7)
    v_mfma_f32_16x16x32_bf16 v[72:75], v[8:11], v[92:95], v[72:75]
    v_mfma_f32_16x16x32_bf16 v[76:79], v[12:15], v[92:95], v[76:79]
    ds_read_b128 v[92:95], v125 offset:41536
    s_waitcnt vmcnt(10) lgkmcnt(7)
    v_mfma_f32_16x16x32_bf16 v[64:67], v[16:19], v[96:99], v[64:67]
    v_mfma_f32_16x16x32_bf16 v[68:71], v[20:23], v[96:99], v[68:71]
    ds_read_b128 v[96:99], v125 offset:33152
    s_waitcnt lgkmcnt(7)
    v_mfma_f32_16x16x32_bf16 v[72:75], v[16:19], v[100:103], v[72:75]
    v_mfma_f32_16x16x32_bf16 v[76:79], v[20:23], v[100:103], v[76:79]
    ds_read_b128 v[100:103], v125 offset:41600
    s_waitcnt vmcnt(8) lgkmcnt(7)
    v_mfma_f32_16x16x32_bf16 v[64:67], v[24:27], v[104:107], v[64:67]
    v_mfma_f32_16x16x32_bf16 v[68:71], v[28:31], v[104:107], v[68:71]
    ds_read_b128 v[104:107], v125 offset:33216
    s_waitcnt lgkmcnt(7)
    v_mfma_f32_16x16x32_bf16 v[72:75], v[24:27], v[108:111], v[72:75]
    v_mfma_f32_16x16x32_bf16 v[76:79], v[28:31], v[108:111], v[76:79]
    ds_read_b128 v[108:111], v125 offset:41664
    s_waitcnt vmcnt(6) lgkmcnt(7)
    v_mfma_f32_16x16x32_bf16 v[64:67], v[32:35], v[80:83], v[64:67]
    v_mfma_f32_16x16x32_bf16 v[68:71], v[36:39], v[80:83], v[68:71]
    ds_read_b128 v[112:115], v120 offset:0
    s_waitcnt lgkmcnt(7)
    v_mfma_f32_16x16x32_bf16 v[72:75], v[32:35], v[84:87], v[72:75]
    v_mfma_f32_16x16x32_bf16 v[76:79], v[36:39], v[84:87], v[76:79]
    ds_read_b128 v[116:119], v120 offset:16
    s_waitcnt vmcnt(4) lgkmcnt(7)
    v_mfma_f32_16x16x32_bf16 v[64:67], v[40:43], v[88:91], v[64:67]
    v_mfma_f32_16x16x32_bf16 v[68:71], v[44:47], v[88:91], v[68:71]
    s_waitcnt lgkmcnt(6)
    v_mfma_f32_16x16x32_bf16 v[72:75], v[40:43], v[92:95], v[72:75]
    v_mfma_f32_16x16x32_bf16 v[76:79], v[44:47], v[92:95], v[76:79]
    s_waitcnt vmcnt(2) lgkmcnt(5)
    v_mfma_f32_16x16x32_bf16 v[64:67], v[48:51], v[96:99], v[64:67]
    v_mfma_f32_16x16x32_bf16 v[68:71], v[52:55], v[96:99], v[68:71]
    s_waitcnt lgkmcnt(4)
    v_mfma_f32_16x16x32_bf16 v[72:75], v[48:51], v[100:103], v[72:75]
    v_mfma_f32_16x16x32_bf16 v[76:79], v[52:55], v[100:103], v[76:79]
    s_waitcnt vmcnt(0) lgkmcnt(3)
    v_mfma_f32_16x16x32_bf16 v[64:67], v[56:59], v[104:107], v[64:67]
    v_mfma_f32_16x16x32_bf16 v[68:71], v[60:63], v[104:107], v[68:71]
    s_waitcnt lgkmcnt(2)
    v_mfma_f32_16x16x32_bf16 v[72:75], v[56:59], v[108:111], v[72:75]
    v_mfma_f32_16x16x32_bf16 v[76:79], v[60:63], v[108:111], v[76:79]
    s_mov_b32 s46, 0xffff0000
    s_mov_b32 s48, 0x4038aa3b
    s_mov_b32 s49, s48
    s_nop 3
    v_mov_b32 v28, 0
    s_waitcnt lgkmcnt(0)
    v_cvt_pk_bf16_f32 v24, v64, v68
    v_cvt_pk_bf16_f32 v25, v65, v69
    v_cvt_pk_bf16_f32 v26, v66, v70
    v_cvt_pk_bf16_f32 v27, v67, v71
    v_lshlrev_b32 v80, 16, v24
    v_and_b32 v81, s46, v24
    v_lshlrev_b32 v82, 16, v25
    v_and_b32 v83, s46, v25
    v_lshlrev_b32 v84, 16, v26
    v_and_b32 v85, s46, v26
    v_lshlrev_b32 v86, 16, v27
    v_and_b32 v87, s46, v27
    v_pk_mul_f32 v[80:81], v[80:81], s[48:49]
    v_pk_mul_f32 v[82:83], v[82:83], s[48:49]
    v_pk_mul_f32 v[84:85], v[84:85], s[48:49]
    v_pk_mul_f32 v[86:87], v[86:87], s[48:49]
    v_exp_f32 v96, v80
    v_exp_f32 v97, v81
    v_exp_f32 v98, v82
    v_exp_f32 v99, v83
    v_max3_f32 v28, |v80|, |v81|, v28
    v_max3_f32 v28, |v82|, |v83|, v28
    ds_write_b128 v122, v[96:99] offset:0
    v_exp_f32 v100, v84
    v_exp_f32 v101, v85
    v_exp_f32 v102, v86
    v_exp_f32 v103, v87
    v_max3_f32 v28, |v84|, |v85|, v28
    v_max3_f32 v28, |v86|, |v87|, v28
    ds_write_b128 v122, v[100:103] offset:16
    v_cvt_pk_bf16_f32 v24, v72, v76
    v_cvt_pk_bf16_f32 v25, v73, v77
    v_cvt_pk_bf16_f32 v26, v74, v78
    v_cvt_pk_bf16_f32 v27, v75, v79
    v_lshlrev_b32 v88, 16, v24
    v_and_b32 v89, s46, v24
    v_lshlrev_b32 v90, 16, v25
    v_and_b32 v91, s46, v25
    v_lshlrev_b32 v92, 16, v26
    v_and_b32 v93, s46, v26
    v_lshlrev_b32 v94, 16, v27
    v_and_b32 v95, s46, v27
    v_pk_mul_f32 v[88:89], v[88:89], s[48:49]
    v_pk_mul_f32 v[90:91], v[90:91], s[48:49]
    v_pk_mul_f32 v[92:93], v[92:93], s[48:49]
    v_pk_mul_f32 v[94:95], v[94:95], s[48:49]
    v_exp_f32 v104, v88
    v_exp_f32 v105, v89
    v_exp_f32 v106, v90
    v_exp_f32 v107, v91
    v_max3_f32 v28, |v88|, |v89|, v28
    v_max3_f32 v28, |v90|, |v91|, v28
    ds_write_b128 v122, v[104:107] offset:2304
    v_exp_f32 v108, v92
    v_exp_f32 v109, v93
    v_exp_f32 v110, v94
    v_exp_f32 v111, v95
    v_max3_f32 v28, |v92|, |v93|, v28
    v_max3_f32 v28, |v94|, |v95|, v28
    ds_write_b128 v122, v[108:111] offset:2320
    v_cmp_lt_f32 vcc, 0x42f00000, v28
    s_mov_b32 s22, 4
    s_or_b32 s44, s44, vcc_lo
    s_or_b32 s44, s44, vcc_hi
    s_cmp_lg_u32 s44, 0
    s_cbranch_scc1 L_joint_kernel_tslow
    ds_read_b128 v[32:35], v121 offset:0
    ds_read_b128 v[36:39], v121 offset:16
    ds_read_b128 v[40:43], v121 offset:288
    ds_read_b128 v[44:47], v121 offset:304
    v_add_u32 v121, 576, v121
    s_waitcnt vmcnt(0) lgkmcnt(0)
L_joint_kernel_tloop1:
    v_fma_f32 v48, v112, v32, 1.0
    v_fma_f32 v49, v113, v33, 1.0
    v_fma_f32 v50, v114, v34, 1.0
    v_fma_f32 v51, v115, v35, 1.0
    v_fma_f32 v52, v116, v36, 1.0
    v_fma_f32 v53, v117, v37, 1.0
    v_fma_f32 v54, v118, v38, 1.0
    v_fma_f32 v55, v119, v39, 1.0
    v_fma_f32 v56, v112, v40, 1.0
    v_fma_f32 v57, v113, v41, 1.0
    v_fma_f32 v58, v114, v42, 1.0
    v_fma_f32 v59, v115, v43, 1.0
    v_fma_f32 v60, v116, v44, 1.0
    v_fma_f32 v61, v117, v45, 1.0
    v_fma_f32 v62, v118, v46, 1.0
    v_fma_f32 v63, v119, v47, 1.0
    ds_read_b128 v[32:35], v121 offset:0
    ds_read_b128 v[36:39], v121 offset:16
    ds_read_b128 v[40:43], v121 offset:288
    ds_read_b128 v[44:47], v121 offset:304
    v_add_u32 v121, 576, v121
    v_rcp_f32 v48, v48
    v_rcp_f32 v49, v49
    v_rcp_f32 v50, v50
    v_rcp_f32 v51, v51
    v_rcp_f32 v52, v52
    v_rcp_f32 v53, v53
    v_rcp_f32 v54, v54
    v_rcp_f32 v55, v55
    v_fma_f32 v48, v48, -2.0, 1.0
    v_fma_f32 v49, v49, -2.0, 1.0
    v_fma_f32 v50, v50, -2.0, 1.0
    v_fma_f32 v51, v51, -2.0, 1.0
    v_fma_f32 v52, v52, -2.0, 1.0
    v_fma_f32 v53, v53, -2.0, 1.0
    v_fma_f32 v54, v54, -2.0, 1.0
    v_fma_f32 v55, v55, -2.0, 1.0
    v_cvt_pk_bf16_f32 v64, v48, v49
    v_cvt_pk_bf16_f32 v65, v50, v51
    v_cvt_pk_bf16_f32 v66, v52, v53
    v_cvt_pk_bf16_f32 v67, v54, v55
    ds_write_b128 v123, v[64:67] offset:0
    v_rcp_f32 v56, v56
    v_rcp_f32 v57, v57
    v_rcp_f32 v58, v58
    v_rcp_f32 v59, v59
    v_rcp_f32 v60, v60
    v_rcp_f32 v61, v61
    v_rcp_f32 v62, v62
    v_rcp_f32 v63, v63
    v_fma_f32 v56, v56, -2.0, 1.0
    v_fma_f32 v57, v57, -2.0, 1.0
    v_fma_f32 v58, v58, -2.0, 1.0
    v_fma_f32 v59, v59, -2.0, 1.0
    v_fma_f32 v60, v60, -2.0, 1.0
    v_fma_f32 v61, v61, -2.0, 1.0
    v_fma_f32 v62, v62, -2.0, 1.0
    v_fma_f32 v63, v63, -2.0, 1.0
    v_cvt_pk_bf16_f32 v68, v56, v57
    v_cvt_pk_bf16_f32 v69, v58, v59
    v_cvt_pk_bf16_f32 v70, v60, v61
    v_cvt_pk_bf16_f32 v71, v62, v63
    ds_write_b128 v123, v[68:71] offset:1024
    s_waitcnt lgkmcnt(0)
    s_barrier
    v_fma_f32 v48, v112, v32, 1.0
    v_fma_f32 v49, v113, v33, 1.0
    v_fma_f32 v50, v114, v34, 1.0
    v_fma_f32 v51, v115, v35, 1.0
    v_fma_f32 v52, v116, v36, 1.0
    v_fma_f32 v53, v117, v37, 1.0
    v_fma_f32 v54, v118, v38, 1.0
    v_fma_f32 v55, v119, v39, 1.0
    v_fma_f32 v56, v112, v40, 1.0
    v_fma_f32 v57, v113, v41, 1.0
    v_fma_f32 v58, v114, v42, 1.0
    v_fma_f32 v59, v115, v43, 1.0
    v_fma_f32 v60, v116, v44, 1.0
    v_fma_f32 v61, v117, v45, 1.0
    v_fma_f32 v62, v118, v46, 1.0
    v_fma_f32 v63, v119, v47, 1.0
    ds_read_b128 v[32:35], v121 offset:0
    ds_read_b128 v[36:39], v121 offset:16
    ds_read_b128 v[40:43], v121 offset:288
    ds_read_b128 v[44:47], v121 offset:304
    v_add_u32 v121, 576, v121
    v_rcp_f32 v48, v48
    v_rcp_f32 v49, v49
    v_rcp_f32 v50, v50
    v_rcp_f32 v51, v51
    v_rcp_f32 v52, v52
    v_rcp_f32 v53, v53
    v_rcp_f32 v54, v54
    v_rcp_f32 v55, v55
    v_fma_f32 v48, v48, -2.0, 1.0
    v_fma_f32 v49, v49, -2.0, 1.0
    v_fma_f32 v50, v50, -2.0, 1.0
    v_fma_f32 v51, v51, -2.0, 1.0
    v_fma_f32 v52, v52, -2.0, 1.0
    v_fma_f32 v53, v53, -2.0, 1.0
    v_fma_f32 v54, v54, -2.0, 1.0
    v_fma_f32 v55, v55, -2.0, 1.0
    v_cvt_pk_bf16_f32 v64, v48, v49
    v_cvt_pk_bf16_f32 v65, v50, v51
    v_cvt_pk_bf16_f32 v66, v52, v53
    v_cvt_pk_bf16_f32 v67, v54, v55
    ds_write_b128 v123, v[64:67] offset:16384
    v_rcp_f32 v56, v56
    v_rcp_f32 v57, v57
    v_rcp_f32 v58, v58
    v_rcp_f32 v59, v59
    v_rcp_f32 v60, v60
    v_rcp_f32 v61, v61
    v_rcp_f32 v62, v62
    v_rcp_f32 v63, v63
    v_fma_f32 v56, v56, -2.0, 1.0
    v_fma_f32 v57, v57, -2.0, 1.0
    v_fma_f32 v58, v58, -2.0, 1.0
    v_fma_f32 v59, v59, -2.0, 1.0
    v_fma_f32 v60, v60, -2.0, 1.0
    v_fma_f32 v61, v61, -2.0, 1.0
    v_fma_f32 v62, v62, -2.0, 1.0
    v_fma_f32 v63, v63, -2.0, 1.0
    v_cvt_pk_bf16_f32 v68, v56, v57
    v_cvt_pk_bf16_f32 v69, v58, v59
    v_cvt_pk_bf16_f32 v70, v60, v61
    v_cvt_pk_bf16_f32 v71, v62, v63
    ds_write_b128 v123, v[68:71] offset:17408
    s_waitcnt lgkmcnt(0)
    s_barrier
    s_sub_u32 s22, s22, 1
    s_cmp_lg_u32 s22, 0
    s_cbranch_scc1 L_joint_kernel_tloop1
    s_branch L_joint_kernel_fin
L_joint_kernel_tslow:
    buffer_load_dwordx4 v[112:115], v124, s[40:43], s38 offen offset:0
    buffer_load_dwordx4 v[116:119], v124, s[40:43], s38 offen offset:16
    ds_write_b128 v122, v[80:83] offset:0
    ds_write_b128 v122, v[84:87] offset:16
    ds_write_b128 v122, v[88:91] offset:2304
    ds_write_b128 v122, v[92:95] offset:2320
    ds_read_b128 v[32:35], v121 offset:0
    ds_read_b128 v[36:39], v121 offset:16
    ds_read_b128 v[40:43], v121 offset:288
    ds_read_b128 v[44:47], v121 offset:304
    v_add_u32 v121, 576, v121
    s_waitcnt vmcnt(0) lgkmcnt(0)
L_joint_kernel_tloop0:
    v_add_f32 v48, v112, v32
    v_add_f32 v49, v113, v33
    v_add_f32 v50, v114, v34
    v_add_f32 v51, v115, v35
    v_add_f32 v52, v116, v36
    v_add_f32 v53, v117, v37
    v_add_f32 v54, v118, v38
    v_add_f32 v55, v119, v39
    v_add_f32 v56, v112, v40
    v_add_f32 v57, v113, v41
    v_add_f32 v58, v114, v42
    v_add_f32 v59, v115, v43
    v_add_f32 v60, v116, v44
    v_add_f32 v61, v117, v45
    v_add_f32 v62, v118, v46
    v_add_f32 v63, v119, v47
    ds_read_b128 v[32:35], v121 offset:0
    ds_read_b128 v[36:39], v121 offset:16
    ds_read_b128 v[40:43], v121 offset:288
    ds_read_b128 v[44:47], v121 offset:304
    v_add_u32 v121, 576, v121
    v_exp_f32 v48, v48
    v_exp_f32 v49, v49
    v_exp_f32 v50, v50
    v_exp_f32 v51, v51
    v_exp_f32 v52, v52
    v_exp_f32 v53, v53
    v_exp_f32 v54, v54
    v_exp_f32 v55, v55
    v_add_f32 v48, 1.0, v48
    v_add_f32 v49, 1.0, v49
    v_add_f32 v50, 1.0, v50
    v_add_f32 v51, 1.0, v51
    v_add_f32 v52, 1.0, v52
    v_add_f32 v53, 1.0, v53
    v_add_f32 v54, 1.0, v54
    v_add_f32 v55, 1.0, v55
    v_rcp_f32 v48, v48
    v_rcp_f32 v49, v49
    v_rcp_f32 v50, v50
    v_rcp_f32 v51, v51
    v_rcp_f32 v52, v52
    v_rcp_f32 v53, v53
    v_rcp_f32 v54, v54
    v_rcp_f32 v55, v55
    v_fma_f32 v48, v48, -2.0, 1.0
    v_fma_f32 v49, v49, -2.0, 1.0
    v_fma_f32 v50, v50, -2.0, 1.0
    v_fma_f32 v51, v51, -2.0, 1.0
    v_fma_f32 v52, v52, -2.0, 1.0
    v_fma_f32 v53, v53, -2.0, 1.0
    v_fma_f32 v54, v54, -2.0, 1.0
    v_fma_f32 v55, v55, -2.0, 1.0
    v_cvt_pk_bf16_f32 v64, v48, v49
    v_cvt_pk_bf16_f32 v65, v50, v51
    v_cvt_pk_bf16_f32 v66, v52, v53
    v_cvt_pk_bf16_f32 v67, v54, v55
    ds_write_b128 v123, v[64:67] offset:0
    v_exp_f32 v56, v56
    v_exp_f32 v57, v57
    v_exp_f32 v58, v58
    v_exp_f32 v59, v59
    v_exp_f32 v60, v60
    v_exp_f32 v61, v61
    v_exp_f32 v62, v62
    v_exp_f32 v63, v63
    v_add_f32 v56, 1.0, v56
    v_add_f32 v57, 1.0, v57
    v_add_f32 v58, 1.0, v58
    v_add_f32 v59, 1.0, v59
    v_add_f32 v60, 1.0, v60
    v_add_f32 v61, 1.0, v61
    v_add_f32 v62, 1.0, v62
    v_add_f32 v63, 1.0, v63
    v_rcp_f32 v56, v56
    v_rcp_f32 v57, v57
    v_rcp_f32 v58, v58
    v_rcp_f32 v59, v59
    v_rcp_f32 v60, v60
    v_rcp_f32 v61, v61
    v_rcp_f32 v62, v62
    v_rcp_f32 v63, v63
    v_fma_f32 v56, v56, -2.0, 1.0
    v_fma_f32 v57, v57, -2.0, 1.0
    v_fma_f32 v58, v58, -2.0, 1.0
    v_fma_f32 v59, v59, -2.0, 1.0
    v_fma_f32 v60, v60, -2.0, 1.0
    v_fma_f32 v61, v61, -2.0, 1.0
    v_fma_f32 v62, v62, -2.0, 1.0
    v_fma_f32 v63, v63, -2.0, 1.0
    v_cvt_pk_bf16_f32 v68, v56, v57
    v_cvt_pk_bf16_f32 v69, v58, v59
    v_cvt_pk_bf16_f32 v70, v60, v61
    v_cvt_pk_bf16_f32 v71, v62, v63
    ds_write_b128 v123, v[68:71] offset:1024
    s_waitcnt lgkmcnt(0)
    s_barrier
    v_add_f32 v48, v112, v32
    v_add_f32 v49, v113, v33
    v_add_f32 v50, v114, v34
    v_add_f32 v51, v115, v35
    v_add_f32 v52, v116, v36
    v_add_f32 v53, v117, v37
    v_add_f32 v54, v118, v38
    v_add_f32 v55, v119, v39
    v_add_f32 v56, v112, v40
    v_add_f32 v57, v113, v41
    v_add_f32 v58, v114, v42
    v_add_f32 v59, v115, v43
    v_add_f32 v60, v116, v44
    v_add_f32 v61, v117, v45
    v_add_f32 v62, v118, v46
    v_add_f32 v63, v119, v47
    ds_read_b128 v[32:35], v121 offset:0
    ds_read_b128 v[36:39], v121 offset:16
    ds_read_b128 v[40:43], v121 offset:288
    ds_read_b128 v[44:47], v121 offset:304
    v_add_u32 v121, 576, v121
    v_exp_f32 v48, v48
    v_exp_f32 v49, v49
    v_exp_f32 v50, v50
    v_exp_f32 v51, v51
    v_exp_f32 v52, v52
    v_exp_f32 v53, v53
    v_exp_f32 v54, v54
    v_exp_f32 v55, v55
    v_add_f32 v48, 1.0, v48
    v_add_f32 v49, 1.0, v49
    v_add_f32 v50, 1.0, v50
    v_add_f32 v51, 1.0, v51
    v_add_f32 v52, 1.0, v52
    v_add_f32 v53, 1.0, v53
    v_add_f32 v54, 1.0, v54
    v_add_f32 v55, 1.0, v55
    v_rcp_f32 v48, v48
    v_rcp_f32 v49, v49
    v_rcp_f32 v50, v50
    v_rcp_f32 v51, v51
    v_rcp_f32 v52, v52
    v_rcp_f32 v53, v53
    v_rcp_f32 v54, v54
    v_rcp_f32 v55, v55
    v_fma_f32 v48, v48, -2.0, 1.0
    v_fma_f32 v49, v49, -2.0, 1.0
    v_fma_f32 v50, v50, -2.0, 1.0
    v_fma_f32 v51, v51, -2.0, 1.0
    v_fma_f32 v52, v52, -2.0, 1.0
    v_fma_f32 v53, v53, -2.0, 1.0
    v_fma_f32 v54, v54, -2.0, 1.0
    v_fma_f32 v55, v55, -2.0, 1.0
    v_cvt_pk_bf16_f32 v64, v48, v49
    v_cvt_pk_bf16_f32 v65, v50, v51
    v_cvt_pk_bf16_f32 v66, v52, v53
    v_cvt_pk_bf16_f32 v67, v54, v55
    ds_write_b128 v123, v[64:67] offset:16384
    v_exp_f32 v56, v56
    v_exp_f32 v57, v57
    v_exp_f32 v58, v58
    v_exp_f32 v59, v59
    v_exp_f32 v60, v60
    v_exp_f32 v61, v61
    v_exp_f32 v62, v62
    v_exp_f32 v63, v63
    v_add_f32 v56, 1.0, v56
    v_add_f32 v57, 1.0, v57
    v_add_f32 v58, 1.0, v58
    v_add_f32 v59, 1.0, v59
    v_add_f32 v60, 1.0, v60
    v_add_f32 v61, 1.0, v61
    v_add_f32 v62, 1.0, v62
    v_add_f32 v63, 1.0, v63
    v_rcp_f32 v56, v56
    v_rcp_f32 v57, v57
    v_rcp_f32 v58, v58
    v_rcp_f32 v59, v59
    v_rcp_f32 v60, v60
    v_rcp_f32 v61, v61
    v_rcp_f32 v62, v62
    v_rcp_f32 v63, v63
    v_fma_f32 v56, v56, -2.0, 1.0
    v_fma_f32 v57, v57, -2.0, 1.0
    v_fma_f32 v58, v58, -2.0, 1.0
    v_fma_f32 v59, v59, -2.0, 1.0
    v_fma_f32 v60, v60, -2.0, 1.0
    v_fma_f32 v61, v61, -2.0, 1.0
    v_fma_f32 v62, v62, -2.0, 1.0
    v_fma_f32 v63, v63, -2.0, 1.0
    v_cvt_pk_bf16_f32 v68, v56, v57
    v_cvt_pk_bf16_f32 v69, v58, v59
    v_cvt_pk_bf16_f32 v70, v60, v61
    v_cvt_pk_bf16_f32 v71, v62, v63
    ds_write_b128 v123, v[68:71] offset:17408
    s_waitcnt lgkmcnt(0)
    s_barrier
    s_sub_u32 s22, s22, 1
    s_cmp_lg_u32 s22, 0
    s_cbranch_scc1 L_joint_kernel_tloop0
L_joint_kernel_fin:
L_joint_kernel_done:
    s_endpgm
.section .rodata,"a"
.p2align 6
.amdhsa_kernel prep_kernel
  .amdhsa_next_free_vgpr 128
  .amdhsa_next_free_sgpr 102
  .amdhsa_accum_offset 128
  .amdhsa_group_segment_fixed_size 0
  .amdhsa_kernarg_size 80
  .amdhsa_user_sgpr_count 2
  .amdhsa_user_sgpr_kernarg_segment_ptr 1
  .amdhsa_system_sgpr_workgroup_id_x 1
.end_amdhsa_kernel
.p2align 6
.amdhsa_kernel conv1_kernel
  .amdhsa_next_free_vgpr 128
  .amdhsa_next_free_sgpr 102
  .amdhsa_accum_offset 128
  .amdhsa_group_segment_fixed_size 0
  .amdhsa_kernarg_size 80
  .amdhsa_user_sgpr_count 2
  .amdhsa_user_sgpr_kernarg_segment_ptr 1
  .amdhsa_system_sgpr_workgroup_id_x 1
.end_amdhsa_kernel
.p2align 6
.amdhsa_kernel conv2_kernel
  .amdhsa_next_free_vgpr 128
  .amdhsa_next_free_sgpr 102
  .amdhsa_accum_offset 128
  .amdhsa_group_segment_fixed_size 0
  .amdhsa_kernarg_size 80
  .amdhsa_user_sgpr_count 2
  .amdhsa_user_sgpr_kernarg_segment_ptr 1
  .amdhsa_system_sgpr_workgroup_id_x 1
.end_amdhsa_kernel
.p2align 6
.amdhsa_kernel joint_kernel
  .amdhsa_next_free_vgpr 128
  .amdhsa_next_free_sgpr 102
  .amdhsa_accum_offset 128
  .amdhsa_group_segment_fixed_size 0
  .amdhsa_kernarg_size 80
  .amdhsa_user_sgpr_count 2
  .amdhsa_user_sgpr_kernarg_segment_ptr 1
  .amdhsa_system_sgpr_workgroup_id_x 1
.end_amdhsa_kernel
```

```asm
; @launch kernel=prep_kernel grid=(268,1,1) block=(256,1,1) lds=4096
; @launch kernel=conv1_kernel grid=(256,1,1) block=(1024,1,1) lds=162816
; @launch kernel=conv2_kernel grid=(256,1,1) block=(1024,1,1) lds=162816
; @launch kernel=joint_kernel grid=(250,1,1) block=(1024,1,1) lds=99472
.amdgcn_target "amdgcn-amd-amdhsa--gfx950"
.text
.globl prep_kernel
.p2align 8
.type prep_kernel,@function
prep_kernel:
    s_cmp_ge_u32 s2, 268
    s_cbranch_scc1 L_prep_kernel_done
    s_mov_b32 s3, s2
    s_load_dwordx16 s[44:59], s[0:1], 0
    s_sub_u32 s2, s2, 12
    v_readfirstlane_b32 s40, v0
    s_lshr_b32 s40, s40, 6
    s_lshl_b32 s21, s2, 2
    s_add_u32 s20, s40, s21
    v_and_b32 v1, 63, v0
    s_load_dwordx2 s[8:9], s[0:1], 8
    s_load_dwordx2 s[30:31], s[0:1], 72
    s_lshr_b32 s22, s20, 8
    s_bfe_u32 s23, s20, 0x40004
    s_bfe_u32 s24, s20, 0x30001
    s_and_b32 s21, s20, 1
    v_lshrrev_b32 v2, 4, v1
    v_lshlrev_b32 v2, 12, v2
    v_and_b32 v3, 15, v1
    v_lshl_add_u32 v2, v3, 2, v2
    s_lshl_b32 s26, s22, 3
    s_lshr_b32 s27, s23, 3
    s_add_u32 s26, s26, s27
    s_lshl_b32 s26, s26, 17
    s_and_b32 s27, s23, 7
    s_lshl_b32 s27, s27, 14
    s_add_u32 s26, s26, s27
    s_lshl_b32 s27, s24, 6
    s_add_u32 s26, s26, s27
    s_mov_b32 s10, 4063232
    s_mov_b32 s11, 0x00020000
    s_lshr_b32 s41, s3, 2
    s_and_b32 s42, s3, 3
    s_lshl_b32 s42, s42, 1
    s_and_b32 s43, s40, 1
    s_add_u32 s42, s42, s43
    s_lshr_b32 s43, s40, 1
    s_lshl_b32 s4, s43, 16
    s_lshl_b32 s5, s42, 6
    s_add_u32 s4, s4, s5
    s_cmp_lt_u32 s3, 12
    s_cselect_b32 s26, s4, s26
    s_cselect_b32 s10, 131072, s10
    s_mov_b32 s5, 262144
    s_cselect_b32 s5, 16384, s5
    s_add_u32 s37, s26, s5
    s_add_u32 s38, s37, s5
    s_add_u32 s39, s38, s5
    s_waitcnt lgkmcnt(0)
    s_cmp_eq_u32 s41, 0
    s_cselect_b32 s8, s52, s8
    s_cselect_b32 s9, s53, s9
    s_cmp_eq_u32 s41, 1
    s_cselect_b32 s8, s56, s8
    s_cselect_b32 s9, s57, s9
    s_cmp_eq_u32 s41, 2
    s_cselect_b32 s8, s54, s8
    s_cselect_b32 s9, s55, s9
    buffer_load_dword v16, v2, s[8:11], s26 offen offset:0
    buffer_load_dword v17, v2, s[8:11], s26 offen offset:512
    buffer_load_dword v24, v2, s[8:11], s37 offen offset:0
    buffer_load_dword v25, v2, s[8:11], s37 offen offset:512
    buffer_load_dword v32, v2, s[8:11], s38 offen offset:0
    buffer_load_dword v33, v2, s[8:11], s38 offen offset:512
    buffer_load_dword v40, v2, s[8:11], s39 offen offset:0
    buffer_load_dword v41, v2, s[8:11], s39 offen offset:512
    buffer_load_dword v18, v2, s[8:11], s26 offen offset:1024
    buffer_load_dword v19, v2, s[8:11], s26 offen offset:1536
    buffer_load_dword v26, v2, s[8:11], s37 offen offset:1024
    buffer_load_dword v27, v2, s[8:11], s37 offen offset:1536
    buffer_load_dword v34, v2, s[8:11], s38 offen offset:1024
    buffer_load_dword v35, v2, s[8:11], s38 offen offset:1536
    buffer_load_dword v42, v2, s[8:11], s39 offen offset:1024
    buffer_load_dword v43, v2, s[8:11], s39 offen offset:1536
    buffer_load_dword v20, v2, s[8:11], s26 offen offset:2048
    buffer_load_dword v21, v2, s[8:11], s26 offen offset:2560
    buffer_load_dword v28, v2, s[8:11], s37 offen offset:2048
    buffer_load_dword v29, v2, s[8:11], s37 offen offset:2560
    buffer_load_dword v36, v2, s[8:11], s38 offen offset:2048
    buffer_load_dword v37, v2, s[8:11], s38 offen offset:2560
    buffer_load_dword v44, v2, s[8:11], s39 offen offset:2048
    buffer_load_dword v45, v2, s[8:11], s39 offen offset:2560
    buffer_load_dword v22, v2, s[8:11], s26 offen offset:3072
    buffer_load_dword v23, v2, s[8:11], s26 offen offset:3584
    buffer_load_dword v30, v2, s[8:11], s37 offen offset:3072
    buffer_load_dword v31, v2, s[8:11], s37 offen offset:3584
    buffer_load_dword v38, v2, s[8:11], s38 offen offset:3072
    buffer_load_dword v39, v2, s[8:11], s38 offen offset:3584
    buffer_load_dword v46, v2, s[8:11], s39 offen offset:3072
    buffer_load_dword v47, v2, s[8:11], s39 offen offset:3584
    s_cmp_lt_u32 s3, 12
    s_cbranch_scc1 L_prep_kernel_small
    s_add_u32 s12, s30, 0
    s_addc_u32 s13, s31, 0
    s_mov_b32 s14, 7340032
    s_mov_b32 s15, 0x00020000
    v_lshlrev_b32 v4, 4, v1
    s_lshl_b32 s27, s24, 4
    s_add_u32 s27, s27, s23
    s_mul_i32 s27, s27, 57344
    s_lshl_b32 s28, s22, 11
    s_add_u32 s27, s27, s28
    s_lshl_b32 s28, s21, 10
    s_add_u32 s27, s27, s28
    s_cmp_eq_u32 s21, 0
    s_mov_b32 s32, 0x07060302
    s_cselect_b32 s32, 0x05040100, s32
    s_mov_b32 s33, 0x03020c0c
    s_cselect_b32 s33, 0x01000c0c, s33
    s_mov_b32 s35, 0x3d2aaaab
    s_mov_b32 s36, 0x3c638e39
    s_waitcnt vmcnt(24)
    v_perm_b32 v72, v17, v16, s32
    v_perm_b32 v48, v41, v40, s32
    v_perm_b32 v76, v76, v40, s33
    v_perm_b32 v84, v84, v41, s33
    v_perm_b32 v77, v77, v32, s33
    v_perm_b32 v85, v85, v33, s33
    v_perm_b32 v78, v78, v24, s33
    v_perm_b32 v86, v86, v25, s33
    v_perm_b32 v79, v79, v16, s33
    v_perm_b32 v87, v87, v17, s33
    v_add_f32 v80, v76, v78
    v_add_f32 v88, v84, v86
    v_add_f32 v81, v77, v79
    v_add_f32 v89, v85, v87
    v_fma_f32 v82, v78, 4.0, v76
    v_fma_f32 v90, v86, 4.0, v84
    v_fma_f32 v83, v79, 4.0, v77
    v_fma_f32 v91, v87, 4.0, v85
    v_add_f32 v77, v80, v81
    v_add_f32 v85, v88, v89
    v_sub_f32 v78, v80, v81
    v_sub_f32 v86, v88, v89
    v_fma_f32 v79, v83, 2.0, v82
    v_fma_f32 v87, v91, 2.0, v90
    v_fma_f32 v82, v83, -2.0, v82
    v_fma_f32 v90, v91, -2.0, v90
    v_fmamk_f32 v80, v76, 0x41700000, v82
    v_fmamk_f32 v88, v84, 0x41700000, v90
    v_fmamk_f32 v80, v81, 0x41200000, v80
    v_fmamk_f32 v88, v89, 0x41200000, v88
    v_mul_f32 v77, 0.5, v77
    v_mul_f32 v85, 0.5, v85
    v_mul_f32 v78, 0.5, v78
    v_mul_f32 v86, 0.5, v86
    v_mul_f32 v79, s35, v79
    v_mul_f32 v87, s35, v87
    v_mul_f32 v82, s35, v82
    v_mul_f32 v90, s35, v90
    v_mul_f32 v80, s36, v80
    v_mul_f32 v88, s36, v88
    v_cvt_pk_bf16_f32 v52, v77, v85
    v_cvt_pk_bf16_f32 v56, v78, v86
    v_cvt_pk_bf16_f32 v60, v79, v87
    v_cvt_pk_bf16_f32 v64, v82, v90
    v_cvt_pk_bf16_f32 v68, v80, v88
    s_waitcnt vmcnt(16)
    v_perm_b32 v73, v19, v18, s32
    v_perm_b32 v49, v43, v42, s32
    v_perm_b32 v76, v76, v42, s33
    v_perm_b32 v84, v84, v43, s33
    v_perm_b32 v77, v77, v34, s33
    v_perm_b32 v85, v85, v35, s33
    v_perm_b32 v78, v78, v26, s33
    v_perm_b32 v86, v86, v27, s33
    v_perm_b32 v79, v79, v18, s33
    v_perm_b32 v87, v87, v19, s33
    v_add_f32 v80, v76, v78
    v_add_f32 v88, v84, v86
    v_add_f32 v81, v77, v79
    v_add_f32 v89, v85, v87
    v_fma_f32 v82, v78, 4.0, v76
    v_fma_f32 v90, v86, 4.0, v84
    v_fma_f32 v83, v79, 4.0, v77
    v_fma_f32 v91, v87, 4.0, v85
    v_add_f32 v77, v80, v81
    v_add_f32 v85, v88, v89
    v_sub_f32 v78, v80, v81
    v_sub_f32 v86, v88, v89
    v_fma_f32 v79, v83, 2.0, v82
    v_fma_f32 v87, v91, 2.0, v90
    v_fma_f32 v82, v83, -2.0, v82
    v_fma_f32 v90, v91, -2.0, v90
    v_fmamk_f32 v80, v76, 0x41700000, v82
    v_fmamk_f32 v88, v84, 0x41700000, v90
    v_fmamk_f32 v80, v81, 0x41200000, v80
    v_fmamk_f32 v88, v89, 0x41200000, v88
    v_mul_f32 v77, 0.5, v77
    v_mul_f32 v85, 0.5, v85
    v_mul_f32 v78, 0.5, v78
    v_mul_f32 v86, 0.5, v86
    v_mul_f32 v79, s35, v79
    v_mul_f32 v87, s35, v87
    v_mul_f32 v82, s35, v82
    v_mul_f32 v90, s35, v90
    v_mul_f32 v80, s36, v80
    v_mul_f32 v88, s36, v88
    v_cvt_pk_bf16_f32 v53, v77, v85
    v_cvt_pk_bf16_f32 v57, v78, v86
    v_cvt_pk_bf16_f32 v61, v79, v87
    v_cvt_pk_bf16_f32 v65, v82, v90
    v_cvt_pk_bf16_f32 v69, v80, v88
    s_waitcnt vmcnt(8)
    v_perm_b32 v74, v21, v20, s32
    v_perm_b32 v50, v45, v44, s32
    v_perm_b32 v76, v76, v44, s33
    v_perm_b32 v84, v84, v45, s33
    v_perm_b32 v77, v77, v36, s33
    v_perm_b32 v85, v85, v37, s33
    v_perm_b32 v78, v78, v28, s33
    v_perm_b32 v86, v86, v29, s33
    v_perm_b32 v79, v79, v20, s33
    v_perm_b32 v87, v87, v21, s33
    v_add_f32 v80, v76, v78
    v_add_f32 v88, v84, v86
    v_add_f32 v81, v77, v79
    v_add_f32 v89, v85, v87
    v_fma_f32 v82, v78, 4.0, v76
    v_fma_f32 v90, v86, 4.0, v84
    v_fma_f32 v83, v79, 4.0, v77
    v_fma_f32 v91, v87, 4.0, v85
    v_add_f32 v77, v80, v81
    v_add_f32 v85, v88, v89
    v_sub_f32 v78, v80, v81
    v_sub_f32 v86, v88, v89
    v_fma_f32 v79, v83, 2.0, v82
    v_fma_f32 v87, v91, 2.0, v90
    v_fma_f32 v82, v83, -2.0, v82
    v_fma_f32 v90, v91, -2.0, v90
    v_fmamk_f32 v80, v76, 0x41700000, v82
    v_fmamk_f32 v88, v84, 0x41700000, v90
    v_fmamk_f32 v80, v81, 0x41200000, v80
    v_fmamk_f32 v88, v89, 0x41200000, v88
    v_mul_f32 v77, 0.5, v77
    v_mul_f32 v85, 0.5, v85
    v_mul_f32 v78, 0.5, v78
    v_mul_f32 v86, 0.5, v86
    v_mul_f32 v79, s35, v79
    v_mul_f32 v87, s35, v87
    v_mul_f32 v82, s35, v82
    v_mul_f32 v90, s35, v90
    v_mul_f32 v80, s36, v80
    v_mul_f32 v88, s36, v88
    v_cvt_pk_bf16_f32 v54, v77, v85
    v_cvt_pk_bf16_f32 v58, v78, v86
    v_cvt_pk_bf16_f32 v62, v79, v87
    v_cvt_pk_bf16_f32 v66, v82, v90
    v_cvt_pk_bf16_f32 v70, v80, v88
    s_waitcnt vmcnt(0)
    s_cmp_ge_u32 s3, 44
    s_cbranch_scc1 L_prep_kernel_ncw
    s_getpc_b64 s[62:63]
L_prep_kernel_pc:
    s_and_b32 s64, s3, 8
    s_lshl_b32 s64, s64, 12
    v_lshlrev_b32 v120, 7, v0
    v_add_u32 v120, s64, v120
    v_min_u32 v120, L_joint_kernel_done-L_prep_kernel_pc, v120
    v_mov_b32 v121, s63
    v_add_co_u32 v120, vcc, s62, v120
    v_addc_co_u32 v121, vcc, 0, v121, vcc
    global_load_dword v122, v[120:121], off
L_prep_kernel_ncw:
    v_perm_b32 v75, v23, v22, s32
    v_perm_b32 v51, v47, v46, s32
    v_perm_b32 v76, v76, v46, s33
    v_perm_b32 v84, v84, v47, s33
    v_perm_b32 v77, v77, v38, s33
    v_perm_b32 v85, v85, v39, s33
    v_perm_b32 v78, v78, v30, s33
    v_perm_b32 v86, v86, v31, s33
    v_perm_b32 v79, v79, v22, s33
    v_perm_b32 v87, v87, v23, s33
    v_add_f32 v80, v76, v78
    v_add_f32 v88, v84, v86
    v_add_f32 v81, v77, v79
    v_add_f32 v89, v85, v87
    v_fma_f32 v82, v78, 4.0, v76
    v_fma_f32 v90, v86, 4.0, v84
    v_fma_f32 v83, v79, 4.0, v77
    v_fma_f32 v91, v87, 4.0, v85
    v_add_f32 v77, v80, v81
    v_add_f32 v85, v88, v89
    v_sub_f32 v78, v80, v81
    v_sub_f32 v86, v88, v89
    v_fma_f32 v79, v83, 2.0, v82
    v_fma_f32 v87, v91, 2.0, v90
    v_fma_f32 v82, v83, -2.0, v82
    v_fma_f32 v90, v91, -2.0, v90
    v_fmamk_f32 v80, v76, 0x41700000, v82
    v_fmamk_f32 v88, v84, 0x41700000, v90
    v_fmamk_f32 v80, v81, 0x41200000, v80
    v_fmamk_f32 v88, v89, 0x41200000, v88
    v_mul_f32 v77, 0.5, v77
    v_mul_f32 v85, 0.5, v85
    v_mul_f32 v78, 0.5, v78
    v_mul_f32 v86, 0.5, v86
    v_mul_f32 v79, s35, v79
    v_mul_f32 v87, s35, v87
    v_mul_f32 v82, s35, v82
    v_mul_f32 v90, s35, v90
    v_mul_f32 v80, s36, v80
    v_mul_f32 v88, s36, v88
    v_cvt_pk_bf16_f32 v55, v77, v85
    v_cvt_pk_bf16_f32 v59, v78, v86
    v_cvt_pk_bf16_f32 v63, v79, v87
    v_cvt_pk_bf16_f32 v67, v82, v90
    v_cvt_pk_bf16_f32 v71, v80, v88
    s_add_u32 s28, s27, 49152
    buffer_store_dwordx4 v[72:75], v4, s[12:15], s28 offen sc1
    s_add_u32 s28, s27, 0
    buffer_store_dwordx4 v[48:51], v4, s[12:15], s28 offen sc1
    s_add_u32 s28, s27, 8192
    buffer_store_dwordx4 v[52:55], v4, s[12:15], s28 offen sc1
    s_add_u32 s28, s27, 16384
    buffer_store_dwordx4 v[56:59], v4, s[12:15], s28 offen sc1
    s_add_u32 s28, s27, 24576
    buffer_store_dwordx4 v[60:63], v4, s[12:15], s28 offen sc1
    s_add_u32 s28, s27, 32768
    buffer_store_dwordx4 v[64:67], v4, s[12:15], s28 offen sc1
    s_add_u32 s28, s27, 40960
    buffer_store_dwordx4 v[68:71], v4, s[12:15], s28 offen sc1
L_prep_kernel_done:
    s_endpgm
L_prep_kernel_small:
    s_mov_b32 s16, s50
    s_mov_b32 s17, s51
    s_mov_b32 s18, 8192
    s_mov_b32 s19, 0x00020000
    v_lshrrev_b32 v2, 4, v1
    v_lshlrev_b32 v6, 9, v3
    v_lshl_add_u32 v6, v2, 4, v6
    s_lshl_b32 s24, s43, 8
    s_cmp_eq_u32 s41, 2
    s_cselect_b32 s24, s24, 0x100000
    buffer_load_dwordx4 v[80:83], v6, s[16:19], s24 offen offset:0
    buffer_load_dwordx4 v[84:87], v6, s[16:19], s24 offen offset:64
    buffer_load_dwordx4 v[88:91], v6, s[16:19], s24 offen offset:128
    buffer_load_dwordx4 v[92:95], v6, s[16:19], s24 offen offset:192
    s_lshl_b32 s24, s41, 17
    s_add_u32 s24, s24, 44040192
    s_add_u32 s12, s30, s24
    s_addc_u32 s13, s31, 0
    s_mov_b32 s14, 131072
    s_mov_b32 s15, 0x00020000
    s_mov_b32 s32, 0x05040100
    s_mov_b32 s33, 0x07060302
    v_lshlrev_b32 v4, 4, v1
    s_lshl_b32 s24, s42, 14
    s_lshl_b32 s25, s43, 13
    s_add_u32 s24, s24, s25
    s_add_u32 s25, s24, 4096
    s_waitcnt vmcnt(4)
    v_perm_b32 v48, v17, v16, s32
    v_perm_b32 v49, v19, v18, s32
    v_perm_b32 v50, v21, v20, s32
    v_perm_b32 v51, v23, v22, s32
    v_perm_b32 v52, v17, v16, s33
    v_perm_b32 v53, v19, v18, s33
    v_perm_b32 v54, v21, v20, s33
    v_perm_b32 v55, v23, v22, s33
    v_perm_b32 v56, v25, v24, s32
    v_perm_b32 v57, v27, v26, s32
    v_perm_b32 v58, v29, v28, s32
    v_perm_b32 v59, v31, v30, s32
    v_perm_b32 v60, v25, v24, s33
    v_perm_b32 v61, v27, v26, s33
    v_perm_b32 v62, v29, v28, s33
    v_perm_b32 v63, v31, v30, s33
    v_perm_b32 v64, v33, v32, s32
    v_perm_b32 v65, v35, v34, s32
    v_perm_b32 v66, v37, v36, s32
    v_perm_b32 v67, v39, v38, s32
    v_perm_b32 v68, v33, v32, s33
    v_perm_b32 v69, v35, v34, s33
    v_perm_b32 v70, v37, v36, s33
    v_perm_b32 v71, v39, v38, s33
    v_perm_b32 v72, v41, v40, s32
    v_perm_b32 v73, v43, v42, s32
    v_perm_b32 v74, v45, v44, s32
    v_perm_b32 v75, v47, v46, s32
    v_perm_b32 v76, v41, v40, s33
    v_perm_b32 v77, v43, v42, s33
    v_perm_b32 v78, v45, v44, s33
    v_perm_b32 v79, v47, v46, s33
    s_cmp_eq_u32 s41, 2
    s_cbranch_scc1 L_prep_kernel_ge
    buffer_store_dwordx4 v[48:51], v4, s[12:15], s24 offen offset:0 sc1
    buffer_store_dwordx4 v[52:55], v4, s[12:15], s24 offen offset:1024 sc1
    buffer_store_dwordx4 v[56:59], v4, s[12:15], s24 offen offset:2048 sc1
    buffer_store_dwordx4 v[60:63], v4, s[12:15], s24 offen offset:3072 sc1
    buffer_store_dwordx4 v[64:67], v4, s[12:15], s25 offen offset:0 sc1
    buffer_store_dwordx4 v[68:71], v4, s[12:15], s25 offen offset:1024 sc1
    buffer_store_dwordx4 v[72:75], v4, s[12:15], s25 offen offset:2048 sc1
    buffer_store_dwordx4 v[76:79], v4, s[12:15], s25 offen offset:3072 sc1
    s_endpgm
L_prep_kernel_ge:
    s_waitcnt vmcnt(0)
    v_mfma_f32_16x16x32_bf16 v[96:99], v[48:51], v[80:83], 0
    v_mfma_f32_16x16x32_bf16 v[100:103], v[52:55], v[80:83], 0
    v_mfma_f32_16x16x32_bf16 v[96:99], v[56:59], v[84:87], v[96:99]
    v_mfma_f32_16x16x32_bf16 v[100:103], v[60:63], v[84:87], v[100:103]
    v_mfma_f32_16x16x32_bf16 v[96:99], v[64:67], v[88:91], v[96:99]
    v_mfma_f32_16x16x32_bf16 v[100:103], v[68:71], v[88:91], v[100:103]
    v_mfma_f32_16x16x32_bf16 v[96:99], v[72:75], v[92:95], v[96:99]
    v_mfma_f32_16x16x32_bf16 v[100:103], v[76:79], v[92:95], v[100:103]
    s_and_b32 s24, s40, 1
    s_lshl_b32 s24, s24, 11
    v_add_u32 v7, s24, v4
    s_mov_b32 s14, 16384
    v_lshlrev_b32 v8, 10, v3
    v_lshl_add_u32 v8, v2, 5, v8
    s_lshl_b32 s24, s42, 7
    s_mov_b32 s34, 0xffff0000
    s_mov_b32 s35, 0x4038aa3b
    s_cmp_eq_u32 s43, 0
    s_cbranch_scc1 L_prep_kernel_ge0
    ds_write_b128 v7, v[96:99]
    ds_write_b128 v7, v[100:103] offset:1024
    s_waitcnt lgkmcnt(0)
    s_barrier
    s_endpgm
L_prep_kernel_ge0:
    s_barrier
    ds_read_b128 v[16:19], v7
    ds_read_b128 v[20:23], v7 offset:1024
    s_waitcnt lgkmcnt(0)
    v_add_f32 v16, v16, v96
    v_add_f32 v17, v17, v97
    v_add_f32 v18, v18, v98
    v_add_f32 v19, v19, v99
    v_add_f32 v20, v20, v100
    v_add_f32 v21, v21, v101
    v_add_f32 v22, v22, v102
    v_add_f32 v23, v23, v103
    v_cvt_pk_bf16_f32 v48, v16, v20
    v_cvt_pk_bf16_f32 v49, v17, v21
    v_cvt_pk_bf16_f32 v50, v18, v22
    v_cvt_pk_bf16_f32 v51, v19, v23
    v_lshlrev_b32 v56, 16, v48
    v_and_b32 v57, s34, v48
    v_lshlrev_b32 v58, 16, v49
    v_and_b32 v59, s34, v49
    v_lshlrev_b32 v60, 16, v50
    v_and_b32 v61, s34, v50
    v_lshlrev_b32 v62, 16, v51
    v_and_b32 v63, s34, v51
    v_mul_f32 v56, s35, v56
    v_mul_f32 v57, s35, v57
    v_mul_f32 v58, s35, v58
    v_mul_f32 v59, s35, v59
    v_mul_f32 v60, s35, v60
    v_mul_f32 v61, s35, v61
    v_mul_f32 v62, s35, v62
    v_mul_f32 v63, s35, v63
    buffer_store_dwordx4 v[56:59], v8, s[12:15], s24 offen sc1
    buffer_store_dwordx4 v[60:63], v8, s[12:15], s24 offen offset:16 sc1
    v_exp_f32 v64, v56
    v_exp_f32 v65, v57
    v_exp_f32 v66, v58
    v_exp_f32 v67, v59
    v_exp_f32 v68, v60
    v_exp_f32 v69, v61
    v_exp_f32 v70, v62
    v_exp_f32 v71, v63
    v_max3_f32 v72, |v56|, |v57|, |v58|
    v_max3_f32 v72, |v59|, |v60|, v72
    v_max3_f32 v72, |v61|, |v62|, v72
    v_max_f32 v72, |v63|, v72
    s_add_u32 s12, s12, 16384
    s_addc_u32 s13, s13, 0
    v_cmp_lt_f32 vcc, 0x42f00000, v72
    buffer_store_dwordx4 v[64:67], v8, s[12:15], s24 offen sc1
    buffer_store_dwordx4 v[68:71], v8, s[12:15], s24 offen offset:16 sc1
    s_add_u32 s12, s12, 16384
    s_addc_u32 s13, s13, 0
    s_or_b32 s26, vcc_lo, vcc_hi
    s_lshl_b32 s24, s42, 2
    v_mov_b32 v73, s26
    v_mov_b32 v74, 0
    buffer_store_dword v73, v74, s[12:15], s24 offen sc1
    s_endpgm
.globl conv1_kernel
.p2align 8
.type conv1_kernel,@function
conv1_kernel:
    s_cmp_ge_u32 s2, 256
    s_cbranch_scc1 L_conv1_kernel_done
    s_load_dwordx2 s[4:5], s[0:1], 0
    s_load_dwordx2 s[30:31], s[0:1], 72
    v_readfirstlane_b32 s20, v0
    s_lshr_b32 s20, s20, 6
    s_and_b32 s36, s2, 0
    s_lshl_b32 s36, s36, 3
    s_bfe_u32 s37, s2, 196611
    s_or_b32 s29, s36, s37
    s_bfe_u32 s36, s2, 196608
    s_lshl_b32 s36, s36, 2
    s_lshr_b32 s37, s2, 6
    s_or_b32 s36, s36, s37
    s_mov_b32 s33, 0
    s_and_b32 s34, s36, 15
    s_lshr_b32 s35, s36, 4
    s_mul_i32 s21, s34, 500
    s_and_b32 s32, s20, 3
    v_and_b32 v127, 63, v0
    v_lshrrev_b32 v5, 2, v127
    v_and_b32 v6, 3, v127
    s_and_b32 s42, s20, 7
    v_lshlrev_b32 v7, 15, v5
    v_lshl_add_u32 v7, v6, 4, v7
    s_lshl_b32 s41, s21, 10
    s_sub_u32 s41, s41, 7680
    s_lshl_b32 s37, s42, 12
    s_add_u32 s37, s37, s41
    v_add_u32 v7, s37, v7
    s_mul_i32 s36, s35, 8192000
    s_mov_b32 s10, 8192000
    s_mov_b32 s11, 0x00020000
    s_mov_b32 s25, 0xffff0000
    s_waitcnt lgkmcnt(0)
    s_add_u32 s8, s4, s36
    s_addc_u32 s9, s5, 0
    s_cmp_ge_u32 s20, 8
    s_cbranch_scc1 L_conv1_kernel_helper
    s_add_u32 s37, s41, 524288
    v_lshl_add_u32 v108, v127, 4, s37
    v_add_u32 v109, 1024, v108
    v_add_u32 v110, 2048, v108
    s_lshl_b32 s36, s29, 4
    s_lshl_b32 s37, s33, 3
    s_add_u32 s36, s36, s37
    s_mul_i32 s36, s36, 57344
    s_add_u32 s36, s36, 0
    s_add_u32 s12, s30, s36
    s_addc_u32 s13, s31, 0
    s_mov_b32 s14, 917504
    s_mov_b32 s15, 0x00020000
    s_mul_i32 s36, s35, 4194304
    s_add_u32 s36, s36, 18874368
    s_add_u32 s16, s30, s36
    s_addc_u32 s17, s31, 0
    s_mov_b32 s18, 4194304
    s_mov_b32 s19, 0x00020000
    v_and_b32 v10, 15, v127
    v_lshrrev_b32 v11, 4, v127
    v_add_u32 v8, 0, v10
    v_and_b32 v16, 4, v8
    v_lshrrev_b32 v16, 1, v16
    v_xor_b32 v16, v11, v16
    v_lshlrev_b32 v16, 4, v16
    v_lshl_add_u32 v8, v8, 6, v16
    v_add_u32 v9, 1, v10
    v_and_b32 v16, 4, v9
    v_lshrrev_b32 v16, 1, v16
    v_xor_b32 v16, v11, v16
    v_lshlrev_b32 v16, 4, v16
    v_lshl_add_u32 v9, v9, 6, v16
    s_lshr_b32 s38, s32, 1
    s_and_b32 s39, s32, 1
    s_add_u32 s40, s38, 4
    s_lshl_b32 s43, s39, 10
    s_cmp_lt_u32 s20, 4
    s_cselect_b32 s40, s20, s40
    s_cselect_b32 s36, 0, s43
    s_lshl_b32 s37, s40, 13
    s_add_u32 s37, s37, s36
    v_lshl_add_u32 v125, v127, 4, s37
    s_mul_i32 s37, s40, 16384
    v_add_u32 v120, s37, v8
    v_add_u32 v121, s37, v9
    s_lshl_b32 s37, s40, 10
    s_add_u32 s37, s37, 115712
    v_lshl_add_u32 v16, v11, 4, s37
    v_cmp_eq_u32 vcc, 15, v10
    v_mov_b32 v17, 8192
    v_mov_b32 v18, 4294959104
    v_mov_b32 v19, 64
    v_cndmask_b32 v122, v121, v16, vcc
    v_cndmask_b32 v123, v17, v19, vcc
    v_cndmask_b32 v124, v18, v19, vcc
    v_lshl_add_u32 v126, v127, 4, s37
    s_mov_b32 s44, 0x3f800000
    s_mov_b32 s45, 0x00000000
    s_mov_b32 s46, 0x00000000
    s_cmp_eq_u32 s40, 1
    s_cselect_b32 s45, 0x3f800000, s45
    s_cselect_b32 s46, 0x3f800000, s46
    s_cmp_eq_u32 s40, 2
    s_cselect_b32 s45, 0xbf800000, s45
    s_cselect_b32 s46, 0x3f800000, s46
    s_cmp_eq_u32 s40, 3
    s_cselect_b32 s45, 0x40000000, s45
    s_cselect_b32 s46, 0x40800000, s46
    s_cmp_eq_u32 s40, 4
    s_cselect_b32 s45, 0xc0000000, s45
    s_cselect_b32 s46, 0x40800000, s46
    s_cmp_eq_u32 s40, 5
    s_cselect_b32 s44, 0x41800000, s44
    s_cselect_b32 s45, 0x41000000, s45
    s_cselect_b32 s46, 0x40800000, s46
    s_cmp_ge_u32 s20, 4
    s_cbranch_scc1 L_conv1_kernel_m2
    v_mov_b32 v0, 0
    v_mov_b32 v1, 0
    v_mov_b32 v2, 0
    v_mov_b32 v3, 0
    v_mov_b32 v4, 0
    v_mov_b32 v5, 0
    v_mov_b32 v6, 0
    v_mov_b32 v7, 0
    v_mov_b32 v8, 0
    v_mov_b32 v9, 0
    v_mov_b32 v10, 0
    v_mov_b32 v11, 0
    v_mov_b32 v12, 0
    v_mov_b32 v13, 0
    v_mov_b32 v14, 0
    v_mov_b32 v15, 0
    v_mov_b32 v16, 0
    v_mov_b32 v17, 0
    v_mov_b32 v18, 0
    v_mov_b32 v19, 0
    v_mov_b32 v20, 0
    v_mov_b32 v21, 0
    v_mov_b32 v22, 0
    v_mov_b32 v23, 0
    v_mov_b32 v24, 0
    v_mov_b32 v25, 0
    v_mov_b32 v26, 0
    v_mov_b32 v27, 0
    v_mov_b32 v28, 0
    v_mov_b32 v29, 0
    v_mov_b32 v30, 0
    v_mov_b32 v31, 0
    v_mov_b32 v32, 0
    v_mov_b32 v33, 0
    v_mov_b32 v34, 0
    v_mov_b32 v35, 0
    v_mov_b32 v36, 0
    v_mov_b32 v37, 0
    v_mov_b32 v38, 0
    v_mov_b32 v39, 0
    v_mov_b32 v40, 0
    v_mov_b32 v41, 0
    v_mov_b32 v42, 0
    v_mov_b32 v43, 0
    v_mov_b32 v44, 0
    v_mov_b32 v45, 0
    v_mov_b32 v46, 0
    v_mov_b32 v47, 0
    v_mov_b32 v48, 0
    v_mov_b32 v49, 0
    v_mov_b32 v50, 0
    v_mov_b32 v51, 0
    v_mov_b32 v52, 0
    v_mov_b32 v53, 0
    v_mov_b32 v54, 0
    v_mov_b32 v55, 0
    v_mov_b32 v56, 0
    v_mov_b32 v57, 0
    v_mov_b32 v58, 0
    v_mov_b32 v59, 0
    v_mov_b32 v60, 0
    v_mov_b32 v61, 0
    v_mov_b32 v62, 0
    v_mov_b32 v63, 0
    s_barrier
    buffer_load_dwordx4 v[96:99], v108, s[8:11], 0 offen
    buffer_load_dwordx4 v[100:103], v109, s[8:11], 0 offen
    buffer_load_dwordx4 v[104:107], v110, s[8:11], 0 offen
    s_mov_b32 s23, 0
    s_mov_b32 s26, 4096
    buffer_load_dwordx4 v[64:67], v125, s[12:15], s23 offen offset:0
    buffer_load_dwordx4 v[68:71], v125, s[12:15], s23 offen offset:1024
    buffer_load_dwordx4 v[72:75], v125, s[12:15], s23 offen offset:2048
    buffer_load_dwordx4 v[76:79], v125, s[12:15], s23 offen offset:3072
    buffer_load_dwordx4 v[80:83], v125, s[12:15], s26 offen offset:0
    buffer_load_dwordx4 v[84:87], v125, s[12:15], s26 offen offset:1024
    buffer_load_dwordx4 v[88:91], v125, s[12:15], s26 offen offset:2048
    buffer_load_dwordx4 v[92:95], v125, s[12:15], s26 offen offset:3072
    s_mov_b32 s23, 57344
    s_mov_b32 s26, 61440
    s_waitcnt vmcnt(8)
    v_lshlrev_b32 v108, 16, v96
    v_and_b32 v111, s25, v96
    v_lshlrev_b32 v109, 16, v100
    v_and_b32 v112, s25, v100
    v_lshlrev_b32 v110, 16, v104
    v_and_b32 v113, s25, v104
    v_mul_f32 v114, s44, v108
    v_mul_f32 v115, s44, v111
    v_fmac_f32 v114, s45, v109
    v_fmac_f32 v115, s45, v112
    v_fmac_f32 v114, s46, v110
    v_fmac_f32 v115, s46, v113
    v_cvt_pk_bf16_f32 v96, v114, v115
    v_lshlrev_b32 v108, 16, v97
    v_and_b32 v111, s25, v97
    v_lshlrev_b32 v109, 16, v101
    v_and_b32 v112, s25, v101
    v_lshlrev_b32 v110, 16, v105
    v_and_b32 v113, s25, v105
    v_mul_f32 v114, s44, v108
    v_mul_f32 v115, s44, v111
    v_fmac_f32 v114, s45, v109
    v_fmac_f32 v115, s45, v112
    v_fmac_f32 v114, s46, v110
    v_fmac_f32 v115, s46, v113
    v_cvt_pk_bf16_f32 v97, v114, v115
    v_lshlrev_b32 v108, 16, v98
    v_and_b32 v111, s25, v98
    v_lshlrev_b32 v109, 16, v102
    v_and_b32 v112, s25, v102
    v_lshlrev_b32 v110, 16, v106
    v_and_b32 v113, s25, v106
    v_mul_f32 v114, s44, v108
    v_mul_f32 v115, s44, v111
    v_fmac_f32 v114, s45, v109
    v_fmac_f32 v115, s45, v112
    v_fmac_f32 v114, s46, v110
    v_fmac_f32 v115, s46, v113
    v_cvt_pk_bf16_f32 v98, v114, v115
    v_lshlrev_b32 v108, 16, v99
    v_and_b32 v111, s25, v99
    v_lshlrev_b32 v109, 16, v103
    v_and_b32 v112, s25, v103
    v_lshlrev_b32 v110, 16, v107
    v_and_b32 v113, s25, v107
    v_mul_f32 v114, s44, v108
    v_mul_f32 v115, s44, v111
    v_fmac_f32 v114, s45, v109
    v_fmac_f32 v115, s45, v112
    v_fmac_f32 v114, s46, v110
    v_fmac_f32 v115, s46, v113
    v_cvt_pk_bf16_f32 v99, v114, v115
    ds_write_b128 v126, v[96:99]
    s_waitcnt lgkmcnt(0)
    s_barrier
    s_mov_b32 s22, 8
    s_setprio 2
L_conv1_kernel_mloop1:
    ds_read_b128 v[96:99], v120 offset:0
    ds_read_b128 v[100:103], v120 offset:1024
    ds_read_b128 v[104:107], v120 offset:2048
    ds_read_b128 v[108:111], v120 offset:3072
    ds_read_b128 v[112:115], v120 offset:4096
    ds_read_b128 v[116:119], v120 offset:5120
    s_waitcnt vmcnt(6) lgkmcnt(5)
    v_mfma_f32_16x16x32_bf16 v[0:3], v[64:67], v[96:99], v[0:3]
    v_mfma_f32_16x16x32_bf16 v[32:35], v[68:71], v[96:99], v[32:35]
    ds_read_b128 v[96:99], v120 offset:6144
    s_waitcnt vmcnt(4) lgkmcnt(5)
    v_mfma_f32_16x16x32_bf16 v[4:7], v[64:67], v[100:103], v[4:7]
    v_mfma_f32_16x16x32_bf16 v[36:39], v[68:71], v[100:103], v[36:39]
    v_mfma_f32_16x16x32_bf16 v[0:3], v[72:75], v[100:103], v[0:3]
    v_mfma_f32_16x16x32_bf16 v[32:35], v[76:79], v[100:103], v[32:35]
    ds_read_b128 v[100:103], v120 offset:7168
    s_waitcnt vmcnt(2) lgkmcnt(5)
    v_mfma_f32_16x16x32_bf16 v[8:11], v[64:67], v[104:107], v[8:11]
    v_mfma_f32_16x16x32_bf16 v[40:43], v[68:71], v[104:107], v[40:43]
    v_mfma_f32_16x16x32_bf16 v[4:7], v[72:75], v[104:107], v[4:7]
    v_mfma_f32_16x16x32_bf16 v[36:39], v[76:79], v[104:107], v[36:39]
    v_mfma_f32_16x16x32_bf16 v[0:3], v[80:83], v[104:107], v[0:3]
    v_mfma_f32_16x16x32_bf16 v[32:35], v[84:87], v[104:107], v[32:35]
    ds_read_b128 v[104:107], v122 offset:0
    v_add_u32 v122, v123, v122
    s_waitcnt vmcnt(0) lgkmcnt(5)
    v_mfma_f32_16x16x32_bf16 v[12:15], v[64:67], v[108:111], v[12:15]
    v_mfma_f32_16x16x32_bf16 v[44:47], v[68:71], v[108:111], v[44:47]
    v_mfma_f32_16x16x32_bf16 v[8:11], v[72:75], v[108:111], v[8:11]
    v_mfma_f32_16x16x32_bf16 v[40:43], v[76:79], v[108:111], v[40:43]
    v_mfma_f32_16x16x32_bf16 v[4:7], v[80:83], v[108:111], v[4:7]
    v_mfma_f32_16x16x32_bf16 v[36:39], v[84:87], v[108:111], v[36:39]
    v_mfma_f32_16x16x32_bf16 v[0:3], v[88:91], v[108:111], v[0:3]
    v_mfma_f32_16x16x32_bf16 v[32:35], v[92:95], v[108:111], v[32:35]
    ds_read_b128 v[108:111], v121 offset:1024
    s_waitcnt lgkmcnt(5)
    v_mfma_f32_16x16x32_bf16 v[16:19], v[64:67], v[112:115], v[16:19]
    v_mfma_f32_16x16x32_bf16 v[48:51], v[68:71], v[112:115], v[48:51]
    v_mfma_f32_16x16x32_bf16 v[12:15], v[72:75], v[112:115], v[12:15]
    v_mfma_f32_16x16x32_bf16 v[44:47], v[76:79], v[112:115], v[44:47]
    v_mfma_f32_16x16x32_bf16 v[8:11], v[80:83], v[112:115], v[8:11]
    v_mfma_f32_16x16x32_bf16 v[40:43], v[84:87], v[112:115], v[40:43]
    v_mfma_f32_16x16x32_bf16 v[4:7], v[88:91], v[112:115], v[4:7]
    v_mfma_f32_16x16x32_bf16 v[36:39], v[92:95], v[112:115], v[36:39]
    ds_read_b128 v[112:115], v121 offset:2048
    s_waitcnt lgkmcnt(5)
    v_mfma_f32_16x16x32_bf16 v[20:23], v[64:67], v[116:119], v[20:23]
    v_mfma_f32_16x16x32_bf16 v[52:55], v[68:71], v[116:119], v[52:55]
    v_mfma_f32_16x16x32_bf16 v[16:19], v[72:75], v[116:119], v[16:19]
    v_mfma_f32_16x16x32_bf16 v[48:51], v[76:79], v[116:119], v[48:51]
    v_mfma_f32_16x16x32_bf16 v[12:15], v[80:83], v[116:119], v[12:15]
    v_mfma_f32_16x16x32_bf16 v[44:47], v[84:87], v[116:119], v[44:47]
    v_mfma_f32_16x16x32_bf16 v[8:11], v[88:91], v[116:119], v[8:11]
    v_mfma_f32_16x16x32_bf16 v[40:43], v[92:95], v[116:119], v[40:43]
    s_waitcnt lgkmcnt(4)
    v_mfma_f32_16x16x32_bf16 v[24:27], v[64:67], v[96:99], v[24:27]
    v_mfma_f32_16x16x32_bf16 v[56:59], v[68:71], v[96:99], v[56:59]
    v_mfma_f32_16x16x32_bf16 v[20:23], v[72:75], v[96:99], v[20:23]
    v_mfma_f32_16x16x32_bf16 v[52:55], v[76:79], v[96:99], v[52:55]
    v_mfma_f32_16x16x32_bf16 v[16:19], v[80:83], v[96:99], v[16:19]
    v_mfma_f32_16x16x32_bf16 v[48:51], v[84:87], v[96:99], v[48:51]
    v_mfma_f32_16x16x32_bf16 v[12:15], v[88:91], v[96:99], v[12:15]
    v_mfma_f32_16x16x32_bf16 v[44:47], v[92:95], v[96:99], v[44:47]
    s_waitcnt lgkmcnt(3)
    v_mfma_f32_16x16x32_bf16 v[28:31], v[64:67], v[100:103], v[28:31]
    v_mfma_f32_16x16x32_bf16 v[60:63], v[68:71], v[100:103], v[60:63]
    v_mfma_f32_16x16x32_bf16 v[24:27], v[72:75], v[100:103], v[24:27]
    v_mfma_f32_16x16x32_bf16 v[56:59], v[76:79], v[100:103], v[56:59]
    v_mfma_f32_16x16x32_bf16 v[20:23], v[80:83], v[100:103], v[20:23]
    v_mfma_f32_16x16x32_bf16 v[52:55], v[84:87], v[100:103], v[52:55]
    v_mfma_f32_16x16x32_bf16 v[16:19], v[88:91], v[100:103], v[16:19]
    v_mfma_f32_16x16x32_bf16 v[48:51], v[92:95], v[100:103], v[48:51]
    buffer_load_dwordx4 v[64:67], v125, s[12:15], s23 offen offset:0
    buffer_load_dwordx4 v[68:71], v125, s[12:15], s23 offen offset:1024
    s_waitcnt lgkmcnt(2)
    v_mfma_f32_16x16x32_bf16 v[28:31], v[72:75], v[104:107], v[28:31]
    v_mfma_f32_16x16x32_bf16 v[60:63], v[76:79], v[104:107], v[60:63]
    v_mfma_f32_16x16x32_bf16 v[24:27], v[80:83], v[104:107], v[24:27]
    v_mfma_f32_16x16x32_bf16 v[56:59], v[84:87], v[104:107], v[56:59]
    v_mfma_f32_16x16x32_bf16 v[20:23], v[88:91], v[104:107], v[20:23]
    v_mfma_f32_16x16x32_bf16 v[52:55], v[92:95], v[104:107], v[52:55]
    buffer_load_dwordx4 v[72:75], v125, s[12:15], s23 offen offset:2048
    buffer_load_dwordx4 v[76:79], v125, s[12:15], s23 offen offset:3072
    s_waitcnt lgkmcnt(1)
    v_mfma_f32_16x16x32_bf16 v[28:31], v[80:83], v[108:111], v[28:31]
    v_mfma_f32_16x16x32_bf16 v[60:63], v[84:87], v[108:111], v[60:63]
    v_mfma_f32_16x16x32_bf16 v[24:27], v[88:91], v[108:111], v[24:27]
    v_mfma_f32_16x16x32_bf16 v[56:59], v[92:95], v[108:111], v[56:59]
    buffer_load_dwordx4 v[80:83], v125, s[12:15], s26 offen offset:0
    buffer_load_dwordx4 v[84:87], v125, s[12:15], s26 offen offset:1024
    s_waitcnt lgkmcnt(0)
    v_mfma_f32_16x16x32_bf16 v[28:31], v[88:91], v[112:115], v[28:31]
    v_mfma_f32_16x16x32_bf16 v[60:63], v[92:95], v[112:115], v[60:63]
    buffer_load_dwordx4 v[88:91], v125, s[12:15], s26 offen offset:2048
    buffer_load_dwordx4 v[92:95], v125, s[12:15], s26 offen offset:3072
    s_add_u32 s23, s23, 57344
    s_add_u32 s26, s26, 57344
    s_barrier
    s_sub_u32 s22, s22, 1
    s_cmp_eq_u32 s22, 0
    s_cbranch_scc1 L_conv1_kernel_mlast1
    ds_read_b128 v[96:99], v120 offset:8192
    ds_read_b128 v[100:103], v120 offset:9216
    ds_read_b128 v[104:107], v120 offset:10240
    ds_read_b128 v[108:111], v120 offset:11264
    ds_read_b128 v[112:115], v120 offset:12288
    ds_read_b128 v[116:119], v120 offset:13312
    s_waitcnt vmcnt(6) lgkmcnt(5)
    v_mfma_f32_16x16x32_bf16 v[0:3], v[64:67], v[96:99], v[0:3]
    v_mfma_f32_16x16x32_bf16 v[32:35], v[68:71], v[96:99], v[32:35]
    ds_read_b128 v[96:99], v120 offset:14336
    s_waitcnt vmcnt(4) lgkmcnt(5)
    v_mfma_f32_16x16x32_bf16 v[4:7], v[64:67], v[100:103], v[4:7]
    v_mfma_f32_16x16x32_bf16 v[36:39], v[68:71], v[100:103], v[36:39]
    v_mfma_f32_16x16x32_bf16 v[0:3], v[72:75], v[100:103], v[0:3]
    v_mfma_f32_16x16x32_bf16 v[32:35], v[76:79], v[100:103], v[32:35]
    ds_read_b128 v[100:103], v120 offset:15360
    s_waitcnt vmcnt(2) lgkmcnt(5)
    v_mfma_f32_16x16x32_bf16 v[8:11], v[64:67], v[104:107], v[8:11]
    v_mfma_f32_16x16x32_bf16 v[40:43], v[68:71], v[104:107], v[40:43]
    v_mfma_f32_16x16x32_bf16 v[4:7], v[72:75], v[104:107], v[4:7]
    v_mfma_f32_16x16x32_bf16 v[36:39], v[76:79], v[104:107], v[36:39]
    v_mfma_f32_16x16x32_bf16 v[0:3], v[80:83], v[104:107], v[0:3]
    v_mfma_f32_16x16x32_bf16 v[32:35], v[84:87], v[104:107], v[32:35]
    ds_read_b128 v[104:107], v122 offset:0
    v_add_u32 v122, v124, v122
    s_waitcnt vmcnt(0) lgkmcnt(5)
    v_mfma_f32_16x16x32_bf16 v[12:15], v[64:67], v[108:111], v[12:15]
    v_mfma_f32_16x16x32_bf16 v[44:47], v[68:71], v[108:111], v[44:47]
    v_mfma_f32_16x16x32_bf16 v[8:11], v[72:75], v[108:111], v[8:11]
    v_mfma_f32_16x16x32_bf16 v[40:43], v[76:79], v[108:111], v[40:43]
    v_mfma_f32_16x16x32_bf16 v[4:7], v[80:83], v[108:111], v[4:7]
    v_mfma_f32_16x16x32_bf16 v[36:39], v[84:87], v[108:111], v[36:39]
    v_mfma_f32_16x16x32_bf16 v[0:3], v[88:91], v[108:111], v[0:3]
    v_mfma_f32_16x16x32_bf16 v[32:35], v[92:95], v[108:111], v[32:35]
    ds_read_b128 v[108:111], v121 offset:9216
    s_waitcnt lgkmcnt(5)
    v_mfma_f32_16x16x32_bf16 v[16:19], v[64:67], v[112:115], v[16:19]
    v_mfma_f32_16x16x32_bf16 v[48:51], v[68:71], v[112:115], v[48:51]
    v_mfma_f32_16x16x32_bf16 v[12:15], v[72:75], v[112:115], v[12:15]
    v_mfma_f32_16x16x32_bf16 v[44:47], v[76:79], v[112:115], v[44:47]
    v_mfma_f32_16x16x32_bf16 v[8:11], v[80:83], v[112:115], v[8:11]
    v_mfma_f32_16x16x32_bf16 v[40:43], v[84:87], v[112:115], v[40:43]
    v_mfma_f32_16x16x32_bf16 v[4:7], v[88:91], v[112:115], v[4:7]
    v_mfma_f32_16x16x32_bf16 v[36:39], v[92:95], v[112:115], v[36:39]
    ds_read_b128 v[112:115], v121 offset:10240
    s_waitcnt lgkmcnt(5)
    v_mfma_f32_16x16x32_bf16 v[20:23], v[64:67], v[116:119], v[20:23]
    v_mfma_f32_16x16x32_bf16 v[52:55], v[68:71], v[116:119], v[52:55]
    v_mfma_f32_16x16x32_bf16 v[16:19], v[72:75], v[116:119], v[16:19]
    v_mfma_f32_16x16x32_bf16 v[48:51], v[76:79], v[116:119], v[48:51]
    v_mfma_f32_16x16x32_bf16 v[12:15], v[80:83], v[116:119], v[12:15]
    v_mfma_f32_16x16x32_bf16 v[44:47], v[84:87], v[116:119], v[44:47]
    v_mfma_f32_16x16x32_bf16 v[8:11], v[88:91], v[116:119], v[8:11]
    v_mfma_f32_16x16x32_bf16 v[40:43], v[92:95], v[116:119], v[40:43]
    s_waitcnt lgkmcnt(4)
    v_mfma_f32_16x16x32_bf16 v[24:27], v[64:67], v[96:99], v[24:27]
    v_mfma_f32_16x16x32_bf16 v[56:59], v[68:71], v[96:99], v[56:59]
    v_mfma_f32_16x16x32_bf16 v[20:23], v[72:75], v[96:99], v[20:23]
    v_mfma_f32_16x16x32_bf16 v[52:55], v[76:79], v[96:99], v[52:55]
    v_mfma_f32_16x16x32_bf16 v[16:19], v[80:83], v[96:99], v[16:19]
    v_mfma_f32_16x16x32_bf16 v[48:51], v[84:87], v[96:99], v[48:51]
    v_mfma_f32_16x16x32_bf16 v[12:15], v[88:91], v[96:99], v[12:15]
    v_mfma_f32_16x16x32_bf16 v[44:47], v[92:95], v[96:99], v[44:47]
    s_waitcnt lgkmcnt(3)
    v_mfma_f32_16x16x32_bf16 v[28:31], v[64:67], v[100:103], v[28:31]
    v_mfma_f32_16x16x32_bf16 v[60:63], v[68:71], v[100:103], v[60:63]
    v_mfma_f32_16x16x32_bf16 v[24:27], v[72:75], v[100:103], v[24:27]
    v_mfma_f32_16x16x32_bf16 v[56:59], v[76:79], v[100:103], v[56:59]
    v_mfma_f32_16x16x32_bf16 v[20:23], v[80:83], v[100:103], v[20:23]
    v_mfma_f32_16x16x32_bf16 v[52:55], v[84:87], v[100:103], v[52:55]
    v_mfma_f32_16x16x32_bf16 v[16:19], v[88:91], v[100:103], v[16:19]
    v_mfma_f32_16x16x32_bf16 v[48:51], v[92:95], v[100:103], v[48:51]
    buffer_load_dwordx4 v[64:67], v125, s[12:15], s23 offen offset:0
    buffer_load_dwordx4 v[68:71], v125, s[12:15], s23 offen offset:1024
    s_waitcnt lgkmcnt(2)
    v_mfma_f32_16x16x32_bf16 v[28:31], v[72:75], v[104:107], v[28:31]
    v_mfma_f32_16x16x32_bf16 v[60:63], v[76:79], v[104:107], v[60:63]
    v_mfma_f32_16x16x32_bf16 v[24:27], v[80:83], v[104:107], v[24:27]
    v_mfma_f32_16x16x32_bf16 v[56:59], v[84:87], v[104:107], v[56:59]
    v_mfma_f32_16x16x32_bf16 v[20:23], v[88:91], v[104:107], v[20:23]
    v_mfma_f32_16x16x32_bf16 v[52:55], v[92:95], v[104:107], v[52:55]
    buffer_load_dwordx4 v[72:75], v125, s[12:15], s23 offen offset:2048
    buffer_load_dwordx4 v[76:79], v125, s[12:15], s23 offen offset:3072
    s_waitcnt lgkmcnt(1)
    v_mfma_f32_16x16x32_bf16 v[28:31], v[80:83], v[108:111], v[28:31]
    v_mfma_f32_16x16x32_bf16 v[60:63], v[84:87], v[108:111], v[60:63]
    v_mfma_f32_16x16x32_bf16 v[24:27], v[88:91], v[108:111], v[24:27]
    v_mfma_f32_16x16x32_bf16 v[56:59], v[92:95], v[108:111], v[56:59]
    buffer_load_dwordx4 v[80:83], v125, s[12:15], s26 offen offset:0
    buffer_load_dwordx4 v[84:87], v125, s[12:15], s26 offen offset:1024
    s_waitcnt lgkmcnt(0)
    v_mfma_f32_16x16x32_bf16 v[28:31], v[88:91], v[112:115], v[28:31]
    v_mfma_f32_16x16x32_bf16 v[60:63], v[92:95], v[112:115], v[60:63]
    buffer_load_dwordx4 v[88:91], v125, s[12:15], s26 offen offset:2048
    buffer_load_dwordx4 v[92:95], v125, s[12:15], s26 offen offset:3072
    s_add_u32 s23, s23, 57344
    s_add_u32 s26, s26, 57344
    s_barrier
    s_branch L_conv1_kernel_mloop1
L_conv1_kernel_mlast1:
    v_and_b32 v125, 15, v127
    v_and_b32 v126, 7, v127
    v_lshlrev_b32 v126, 4, v126
    v_lshl_add_u32 v125, v125, 7, v126
    v_lshrrev_b32 v126, 4, v127
    v_lshl_add_u32 v125, v126, 11, v125
    s_lshl_b32 s36, s20, 14
    s_add_u32 s37, s36, 8192
    v_add_u32 v126, s37, v125
    v_add_u32 v125, s36, v125
    ds_read_b128 v[96:99], v120 offset:8192
    ds_read_b128 v[100:103], v120 offset:9216
    ds_read_b128 v[104:107], v120 offset:10240
    ds_read_b128 v[108:111], v120 offset:11264
    ds_read_b128 v[112:115], v120 offset:12288
    ds_read_b128 v[116:119], v120 offset:13312
    s_waitcnt vmcnt(6) lgkmcnt(5)
    v_mfma_f32_16x16x32_bf16 v[0:3], v[64:67], v[96:99], v[0:3]
    v_mfma_f32_16x16x32_bf16 v[32:35], v[68:71], v[96:99], v[32:35]
    ds_read_b128 v[96:99], v120 offset:14336
    s_waitcnt vmcnt(4) lgkmcnt(5)
    v_mfma_f32_16x16x32_bf16 v[4:7], v[64:67], v[100:103], v[4:7]
    v_mfma_f32_16x16x32_bf16 v[36:39], v[68:71], v[100:103], v[36:39]
    v_mfma_f32_16x16x32_bf16 v[0:3], v[72:75], v[100:103], v[0:3]
    v_mfma_f32_16x16x32_bf16 v[32:35], v[76:79], v[100:103], v[32:35]
    ds_read_b128 v[100:103], v120 offset:15360
    s_waitcnt vmcnt(2) lgkmcnt(5)
    v_mfma_f32_16x16x32_bf16 v[8:11], v[64:67], v[104:107], v[8:11]
    v_mfma_f32_16x16x32_bf16 v[40:43], v[68:71], v[104:107], v[40:43]
    v_mfma_f32_16x16x32_bf16 v[4:7], v[72:75], v[104:107], v[4:7]
    v_mfma_f32_16x16x32_bf16 v[36:39], v[76:79], v[104:107], v[36:39]
    v_mfma_f32_16x16x32_bf16 v[0:3], v[80:83], v[104:107], v[0:3]
    v_mfma_f32_16x16x32_bf16 v[32:35], v[84:87], v[104:107], v[32:35]
    ds_read_b128 v[104:107], v122 offset:0
    s_waitcnt vmcnt(0) lgkmcnt(5)
    v_mfma_f32_16x16x32_bf16 v[12:15], v[64:67], v[108:111], v[12:15]
    v_mfma_f32_16x16x32_bf16 v[44:47], v[68:71], v[108:111], v[44:47]
    v_mfma_f32_16x16x32_bf16 v[8:11], v[72:75], v[108:111], v[8:11]
    v_mfma_f32_16x16x32_bf16 v[40:43], v[76:79], v[108:111], v[40:43]
    v_mfma_f32_16x16x32_bf16 v[4:7], v[80:83], v[108:111], v[4:7]
    v_mfma_f32_16x16x32_bf16 v[36:39], v[84:87], v[108:111], v[36:39]
    v_mfma_f32_16x16x32_bf16 v[0:3], v[88:91], v[108:111], v[0:3]
    v_mfma_f32_16x16x32_bf16 v[32:35], v[92:95], v[108:111], v[32:35]
    ds_read_b128 v[108:111], v121 offset:9216
    s_waitcnt lgkmcnt(5)
    v_mfma_f32_16x16x32_bf16 v[16:19], v[64:67], v[112:115], v[16:19]
    v_mfma_f32_16x16x32_bf16 v[48:51], v[68:71], v[112:115], v[48:51]
    v_mfma_f32_16x16x32_bf16 v[12:15], v[72:75], v[112:115], v[12:15]
    v_mfma_f32_16x16x32_bf16 v[44:47], v[76:79], v[112:115], v[44:47]
    v_mfma_f32_16x16x32_bf16 v[8:11], v[80:83], v[112:115], v[8:11]
    v_mfma_f32_16x16x32_bf16 v[40:43], v[84:87], v[112:115], v[40:43]
    v_mfma_f32_16x16x32_bf16 v[4:7], v[88:91], v[112:115], v[4:7]
    v_mfma_f32_16x16x32_bf16 v[36:39], v[92:95], v[112:115], v[36:39]
    ds_read_b128 v[112:115], v121 offset:10240
    v_xor_b32 v123, 0, v125
    ds_write_b128 v123, v[0:3]
    s_waitcnt lgkmcnt(6)
    v_mfma_f32_16x16x32_bf16 v[20:23], v[64:67], v[116:119], v[20:23]
    v_mfma_f32_16x16x32_bf16 v[52:55], v[68:71], v[116:119], v[52:55]
    v_mfma_f32_16x16x32_bf16 v[16:19], v[72:75], v[116:119], v[16:19]
    v_mfma_f32_16x16x32_bf16 v[48:51], v[76:79], v[116:119], v[48:51]
    v_mfma_f32_16x16x32_bf16 v[12:15], v[80:83], v[116:119], v[12:15]
    v_mfma_f32_16x16x32_bf16 v[44:47], v[84:87], v[116:119], v[44:47]
    v_mfma_f32_16x16x32_bf16 v[8:11], v[88:91], v[116:119], v[8:11]
    v_mfma_f32_16x16x32_bf16 v[40:43], v[92:95], v[116:119], v[40:43]
    v_xor_b32 v124, 16, v125
    ds_write_b128 v124, v[4:7]
    s_waitcnt lgkmcnt(2)
    v_mfma_f32_16x16x32_bf16 v[24:27], v[64:67], v[96:99], v[24:27]
    v_mfma_f32_16x16x32_bf16 v[56:59], v[68:71], v[96:99], v[56:59]
    v_mfma_f32_16x16x32_bf16 v[20:23], v[72:75], v[96:99], v[20:23]
    v_mfma_f32_16x16x32_bf16 v[52:55], v[76:79], v[96:99], v[52:55]
    v_mfma_f32_16x16x32_bf16 v[16:19], v[80:83], v[96:99], v[16:19]
    v_mfma_f32_16x16x32_bf16 v[48:51], v[84:87], v[96:99], v[48:51]
    v_mfma_f32_16x16x32_bf16 v[12:15], v[88:91], v[96:99], v[12:15]
    v_mfma_f32_16x16x32_bf16 v[44:47], v[92:95], v[96:99], v[44:47]
    v_xor_b32 v123, 32, v125
    ds_write_b128 v123, v[8:11]
    v_xor_b32 v124, 0, v126
    ds_write_b128 v124, v[32:35]
    v_mfma_f32_16x16x32_bf16 v[28:31], v[64:67], v[100:103], v[28:31]
    v_mfma_f32_16x16x32_bf16 v[60:63], v[68:71], v[100:103], v[60:63]
    v_mfma_f32_16x16x32_bf16 v[24:27], v[72:75], v[100:103], v[24:27]
    v_mfma_f32_16x16x32_bf16 v[56:59], v[76:79], v[100:103], v[56:59]
    v_mfma_f32_16x16x32_bf16 v[20:23], v[80:83], v[100:103], v[20:23]
    v_mfma_f32_16x16x32_bf16 v[52:55], v[84:87], v[100:103], v[52:55]
    v_mfma_f32_16x16x32_bf16 v[16:19], v[88:91], v[100:103], v[16:19]
    v_mfma_f32_16x16x32_bf16 v[48:51], v[92:95], v[100:103], v[48:51]
    v_xor_b32 v123, 16, v126
    ds_write_b128 v123, v[36:39]
    v_xor_b32 v124, 32, v126
    ds_write_b128 v124, v[40:43]
    v_mfma_f32_16x16x32_bf16 v[28:31], v[72:75], v[104:107], v[28:31]
    v_mfma_f32_16x16x32_bf16 v[60:63], v[76:79], v[104:107], v[60:63]
    v_mfma_f32_16x16x32_bf16 v[24:27], v[80:83], v[104:107], v[24:27]
    v_mfma_f32_16x16x32_bf16 v[56:59], v[84:87], v[104:107], v[56:59]
    v_mfma_f32_16x16x32_bf16 v[20:23], v[88:91], v[104:107], v[20:23]
    v_mfma_f32_16x16x32_bf16 v[52:55], v[92:95], v[104:107], v[52:55]
    v_xor_b32 v124, 48, v125
    ds_write_b128 v124, v[12:15]
    v_xor_b32 v123, 48, v126
    ds_write_b128 v123, v[44:47]
    v_mfma_f32_16x16x32_bf16 v[28:31], v[80:83], v[108:111], v[28:31]
    v_mfma_f32_16x16x32_bf16 v[60:63], v[84:87], v[108:111], v[60:63]
    v_mfma_f32_16x16x32_bf16 v[24:27], v[88:91], v[108:111], v[24:27]
    v_mfma_f32_16x16x32_bf16 v[56:59], v[92:95], v[108:111], v[56:59]
    v_xor_b32 v123, 64, v125
    ds_write_b128 v123, v[16:19]
    v_xor_b32 v124, 64, v126
    ds_write_b128 v124, v[48:51]
    v_mfma_f32_16x16x32_bf16 v[28:31], v[88:91], v[112:115], v[28:31]
    v_mfma_f32_16x16x32_bf16 v[60:63], v[92:95], v[112:115], v[60:63]
    v_xor_b32 v124, 80, v125
    ds_write_b128 v124, v[20:23]
    v_xor_b32 v123, 80, v126
    ds_write_b128 v123, v[52:55]
    s_nop 7
    v_xor_b32 v123, 96, v125
    ds_write_b128 v123, v[24:27]
    v_xor_b32 v124, 96, v126
    ds_write_b128 v124, v[56:59]
    v_xor_b32 v124, 112, v125
    ds_write_b128 v124, v[28:31]
    v_xor_b32 v123, 112, v126
    s_waitcnt lgkmcnt(8)
    ds_write_b128 v123, v[60:63]
    s_setprio 0
    s_branch L_conv1_kernel_epi
L_conv1_kernel_m2:
    s_mul_i32 s37, s38, 2176
    s_add_u32 s37, s37, 98304
    v_add_u32 v116, s37, v8
    v_add_u32 v118, s37, v9
    v_add_u32 v117, 104832, v8
    s_cmp_eq_u32 s38, 0
    s_cbranch_scc1 L_conv1_kernel_hh0
    v_add_u32 v117, 98304, v9
L_conv1_kernel_hh0:
    s_lshl_b32 s37, s38, 12
    s_add_u32 s37, s37, s43
    s_add_u32 s37, s37, 49152
    v_lshl_add_u32 v119, v127, 4, s37
    v_mov_b32 v0, 0
    v_mov_b32 v1, 0
    v_mov_b32 v2, 0
    v_mov_b32 v3, 0
    v_mov_b32 v4, 0
    v_mov_b32 v5, 0
    v_mov_b32 v6, 0
    v_mov_b32 v7, 0
    v_mov_b32 v8, 0
    v_mov_b32 v9, 0
    v_mov_b32 v10, 0
    v_mov_b32 v11, 0
    v_mov_b32 v12, 0
    v_mov_b32 v13, 0
    v_mov_b32 v14, 0
    v_mov_b32 v15, 0
    v_mov_b32 v16, 0
    v_mov_b32 v17, 0
    v_mov_b32 v18, 0
    v_mov_b32 v19, 0
    v_mov_b32 v20, 0
    v_mov_b32 v21, 0
    v_mov_b32 v22, 0
    v_mov_b32 v23, 0
    v_mov_b32 v24, 0
    v_mov_b32 v25, 0
    v_mov_b32 v26, 0
    v_mov_b32 v27, 0
    v_mov_b32 v28, 0
    v_mov_b32 v29, 0
    v_mov_b32 v30, 0
    v_mov_b32 v31, 0
    v_mov_b32 v32, 0
    v_mov_b32 v33, 0
    v_mov_b32 v34, 0
    v_mov_b32 v35, 0
    v_mov_b32 v36, 0
    v_mov_b32 v37, 0
    v_mov_b32 v38, 0
    v_mov_b32 v39, 0
    v_mov_b32 v40, 0
    v_mov_b32 v41, 0
    v_mov_b32 v42, 0
    v_mov_b32 v43, 0
    v_mov_b32 v44, 0
    v_mov_b32 v45, 0
    v_mov_b32 v46, 0
    v_mov_b32 v47, 0
    v_mov_b32 v48, 0
    v_mov_b32 v49, 0
    v_mov_b32 v50, 0
    v_mov_b32 v51, 0
    v_mov_b32 v52, 0
    v_mov_b32 v53, 0
    v_mov_b32 v54, 0
    v_mov_b32 v55, 0
    v_mov_b32 v56, 0
    v_mov_b32 v57, 0
    v_mov_b32 v58, 0
    v_mov_b32 v59, 0
    v_mov_b32 v60, 0
    v_mov_b32 v61, 0
    v_mov_b32 v62, 0
    v_mov_b32 v63, 0
    s_barrier
    buffer_load_dwordx4 v[96:99], v108, s[8:11], 0 offen
    buffer_load_dwordx4 v[100:103], v109, s[8:11], 0 offen
    buffer_load_dwordx4 v[104:107], v110, s[8:11], 0 offen
    s_mov_b32 s23, 0
    s_mov_b32 s26, 4096
    buffer_load_dwordx4 v[64:67], v125, s[12:15], s23 offen offset:0
    buffer_load_dwordx4 v[68:71], v125, s[12:15], s23 offen offset:2048
    buffer_load_dwordx4 v[80:83], v119, s[12:15], s23 offen offset:0
    buffer_load_dwordx4 v[72:75], v125, s[12:15], s26 offen offset:0
    buffer_load_dwordx4 v[84:87], v119, s[12:15], s23 offen offset:2048
    buffer_load_dwordx4 v[76:79], v125, s[12:15], s26 offen offset:2048
    s_mov_b32 s23, 57344
    s_mov_b32 s26, 61440
    s_waitcnt vmcnt(6)
    v_lshlrev_b32 v108, 16, v96
    v_and_b32 v111, s25, v96
    v_lshlrev_b32 v109, 16, v100
    v_and_b32 v112, s25, v100
    v_lshlrev_b32 v110, 16, v104
    v_and_b32 v113, s25, v104
    v_mul_f32 v114, s44, v108
    v_mul_f32 v115, s44, v111
    v_fmac_f32 v114, s45, v109
    v_fmac_f32 v115, s45, v112
    v_fmac_f32 v114, s46, v110
    v_fmac_f32 v115, s46, v113
    v_cvt_pk_bf16_f32 v96, v114, v115
    v_lshlrev_b32 v108, 16, v97
    v_and_b32 v111, s25, v97
    v_lshlrev_b32 v109, 16, v101
    v_and_b32 v112, s25, v101
    v_lshlrev_b32 v110, 16, v105
    v_and_b32 v113, s25, v105
    v_mul_f32 v114, s44, v108
    v_mul_f32 v115, s44, v111
    v_fmac_f32 v114, s45, v109
    v_fmac_f32 v115, s45, v112
    v_fmac_f32 v114, s46, v110
    v_fmac_f32 v115, s46, v113
    v_cvt_pk_bf16_f32 v97, v114, v115
    v_lshlrev_b32 v108, 16, v98
    v_and_b32 v111, s25, v98
    v_lshlrev_b32 v109, 16, v102
    v_and_b32 v112, s25, v102
    v_lshlrev_b32 v110, 16, v106
    v_and_b32 v113, s25, v106
    v_mul_f32 v114, s44, v108
    v_mul_f32 v115, s44, v111
    v_fmac_f32 v114, s45, v109
    v_fmac_f32 v115, s45, v112
    v_fmac_f32 v114, s46, v110
    v_fmac_f32 v115, s46, v113
    v_cvt_pk_bf16_f32 v98, v114, v115
    v_lshlrev_b32 v108, 16, v99
    v_and_b32 v111, s25, v99
    v_lshlrev_b32 v109, 16, v103
    v_and_b32 v112, s25, v103
    v_lshlrev_b32 v110, 16, v107
    v_and_b32 v113, s25, v107
    v_mul_f32 v114, s44, v108
    v_mul_f32 v115, s44, v111
    v_fmac_f32 v114, s45, v109
    v_fmac_f32 v115, s45, v112
    v_fmac_f32 v114, s46, v110
    v_fmac_f32 v115, s46, v113
    v_cvt_pk_bf16_f32 v99, v114, v115
    ds_write_b128 v126, v[96:99]
    v_and_b32 v126, 15, v127
    v_lshlrev_b32 v126, 2, v126
    v_add_u32 v126, 99328, v126
    ds_write_b32 v126, v0
    ds_write_b32 v126, v0 offset:8704
    s_waitcnt lgkmcnt(0)
    s_barrier
    s_mov_b32 s22, 8
    s_setprio 2
L_conv1_kernel_mloop2:
    ds_read_b128 v[88:91], v120 offset:0
    ds_read_b128 v[92:95], v120 offset:1024
    ds_read_b128 v[96:99], v116 offset:0
    ds_read_b128 v[100:103], v120 offset:2048
    ds_read_b128 v[104:107], v116 offset:1088
    ds_read_b128 v[108:111], v120 offset:3072
    ds_read_b128 v[112:115], v116 offset:2176
    s_waitcnt vmcnt(5) lgkmcnt(6)
    v_mfma_f32_16x16x32_bf16 v[0:3], v[64:67], v[88:91], v[0:3]
    ds_read_b128 v[88:91], v120 offset:4096
    s_waitcnt vmcnt(4) lgkmcnt(6)
    v_mfma_f32_16x16x32_bf16 v[4:7], v[64:67], v[92:95], v[4:7]
    v_mfma_f32_16x16x32_bf16 v[0:3], v[68:71], v[92:95], v[0:3]
    ds_read_b128 v[92:95], v116 offset:3264
    s_waitcnt vmcnt(3) lgkmcnt(6)
    v_mfma_f32_16x16x32_bf16 v[32:35], v[80:83], v[96:99], v[32:35]
    ds_read_b128 v[96:99], v120 offset:5120
    s_waitcnt vmcnt(2) lgkmcnt(6)
    v_mfma_f32_16x16x32_bf16 v[8:11], v[64:67], v[100:103], v[8:11]
    v_mfma_f32_16x16x32_bf16 v[4:7], v[68:71], v[100:103], v[4:7]
    v_mfma_f32_16x16x32_bf16 v[0:3], v[72:75], v[100:103], v[0:3]
    ds_read_b128 v[100:103], v116 offset:4352
    s_waitcnt vmcnt(1) lgkmcnt(6)
    v_mfma_f32_16x16x32_bf16 v[36:39], v[80:83], v[104:107], v[36:39]
    v_mfma_f32_16x16x32_bf16 v[32:35], v[84:87], v[104:107], v[32:35]
    ds_read_b128 v[104:107], v120 offset:6144
    s_waitcnt vmcnt(0) lgkmcnt(6)
    v_mfma_f32_16x16x32_bf16 v[12:15], v[64:67], v[108:111], v[12:15]
    v_mfma_f32_16x16x32_bf16 v[8:11], v[68:71], v[108:111], v[8:11]
    v_mfma_f32_16x16x32_bf16 v[4:7], v[72:75], v[108:111], v[4:7]
    v_mfma_f32_16x16x32_bf16 v[0:3], v[76:79], v[108:111], v[0:3]
    ds_read_b128 v[108:111], v116 offset:5440
    s_waitcnt lgkmcnt(6)
    v_mfma_f32_16x16x32_bf16 v[40:43], v[80:83], v[112:115], v[40:43]
    v_mfma_f32_16x16x32_bf16 v[36:39], v[84:87], v[112:115], v[36:39]
    ds_read_b128 v[112:115], v120 offset:7168
    s_waitcnt lgkmcnt(6)
    v_mfma_f32_16x16x32_bf16 v[16:19], v[64:67], v[88:91], v[16:19]
    v_mfma_f32_16x16x32_bf16 v[12:15], v[68:71], v[88:91], v[12:15]
    v_mfma_f32_16x16x32_bf16 v[8:11], v[72:75], v[88:91], v[8:11]
    v_mfma_f32_16x16x32_bf16 v[4:7], v[76:79], v[88:91], v[4:7]
    ds_read_b128 v[88:91], v117 offset:0
    s_waitcnt lgkmcnt(6)
    v_mfma_f32_16x16x32_bf16 v[44:47], v[80:83], v[92:95], v[44:47]
    v_mfma_f32_16x16x32_bf16 v[40:43], v[84:87], v[92:95], v[40:43]
    ds_read_b128 v[92:95], v122 offset:0
    v_add_u32 v122, v123, v122
    s_waitcnt lgkmcnt(6)
    v_mfma_f32_16x16x32_bf16 v[20:23], v[64:67], v[96:99], v[20:23]
    v_mfma_f32_16x16x32_bf16 v[16:19], v[68:71], v[96:99], v[16:19]
    v_mfma_f32_16x16x32_bf16 v[12:15], v[72:75], v[96:99], v[12:15]
    v_mfma_f32_16x16x32_bf16 v[8:11], v[76:79], v[96:99], v[8:11]
    ds_read_b128 v[96:99], v117 offset:1088
    s_waitcnt lgkmcnt(6)
    v_mfma_f32_16x16x32_bf16 v[48:51], v[80:83], v[100:103], v[48:51]
    v_mfma_f32_16x16x32_bf16 v[44:47], v[84:87], v[100:103], v[44:47]
    ds_read_b128 v[100:103], v121 offset:1024
    s_waitcnt lgkmcnt(6)
    v_mfma_f32_16x16x32_bf16 v[24:27], v[64:67], v[104:107], v[24:27]
    v_mfma_f32_16x16x32_bf16 v[20:23], v[68:71], v[104:107], v[20:23]
    v_mfma_f32_16x16x32_bf16 v[16:19], v[72:75], v[104:107], v[16:19]
    v_mfma_f32_16x16x32_bf16 v[12:15], v[76:79], v[104:107], v[12:15]
    ds_read_b128 v[104:107], v118 offset:0
    s_waitcnt lgkmcnt(6)
    v_mfma_f32_16x16x32_bf16 v[52:55], v[80:83], v[108:111], v[52:55]
    v_mfma_f32_16x16x32_bf16 v[48:51], v[84:87], v[108:111], v[48:51]
    ds_read_b128 v[108:111], v121 offset:2048
    s_waitcnt lgkmcnt(6)
    v_mfma_f32_16x16x32_bf16 v[28:31], v[64:67], v[112:115], v[28:31]
    v_mfma_f32_16x16x32_bf16 v[24:27], v[68:71], v[112:115], v[24:27]
    v_mfma_f32_16x16x32_bf16 v[20:23], v[72:75], v[112:115], v[20:23]
    v_mfma_f32_16x16x32_bf16 v[16:19], v[76:79], v[112:115], v[16:19]
    buffer_load_dwordx4 v[64:67], v125, s[12:15], s23 offen offset:0
    s_waitcnt lgkmcnt(5)
    v_mfma_f32_16x16x32_bf16 v[56:59], v[80:83], v[88:91], v[56:59]
    v_mfma_f32_16x16x32_bf16 v[52:55], v[84:87], v[88:91], v[52:55]
    s_waitcnt lgkmcnt(0)
    s_barrier
    v_mfma_f32_16x16x32_bf16 v[28:31], v[68:71], v[92:95], v[28:31]
    v_mfma_f32_16x16x32_bf16 v[24:27], v[72:75], v[92:95], v[24:27]
    v_mfma_f32_16x16x32_bf16 v[20:23], v[76:79], v[92:95], v[20:23]
    buffer_load_dwordx4 v[68:71], v125, s[12:15], s23 offen offset:2048
    v_mfma_f32_16x16x32_bf16 v[60:63], v[80:83], v[96:99], v[60:63]
    v_mfma_f32_16x16x32_bf16 v[56:59], v[84:87], v[96:99], v[56:59]
    buffer_load_dwordx4 v[80:83], v119, s[12:15], s23 offen offset:0
    v_mfma_f32_16x16x32_bf16 v[28:31], v[72:75], v[100:103], v[28:31]
    v_mfma_f32_16x16x32_bf16 v[24:27], v[76:79], v[100:103], v[24:27]
    buffer_load_dwordx4 v[72:75], v125, s[12:15], s26 offen offset:0
    v_mfma_f32_16x16x32_bf16 v[60:63], v[84:87], v[104:107], v[60:63]
    buffer_load_dwordx4 v[84:87], v119, s[12:15], s23 offen offset:2048
    v_mfma_f32_16x16x32_bf16 v[28:31], v[76:79], v[108:111], v[28:31]
    buffer_load_dwordx4 v[76:79], v125, s[12:15], s26 offen offset:2048
    s_add_u32 s23, s23, 57344
    s_add_u32 s26, s26, 57344
    s_sub_u32 s22, s22, 1
    s_cmp_eq_u32 s22, 0
    s_cbranch_scc1 L_conv1_kernel_mlast2
    ds_read_b128 v[88:91], v120 offset:8192
    ds_read_b128 v[92:95], v120 offset:9216
    ds_read_b128 v[96:99], v116 offset:8704
    ds_read_b128 v[100:103], v120 offset:10240
    ds_read_b128 v[104:107], v116 offset:9792
    ds_read_b128 v[108:111], v120 offset:11264
    ds_read_b128 v[112:115], v116 offset:10880
    s_waitcnt vmcnt(5) lgkmcnt(6)
    v_mfma_f32_16x16x32_bf16 v[0:3], v[64:67], v[88:91], v[0:3]
    ds_read_b128 v[88:91], v120 offset:12288
    s_waitcnt vmcnt(4) lgkmcnt(6)
    v_mfma_f32_16x16x32_bf16 v[4:7], v[64:67], v[92:95], v[4:7]
    v_mfma_f32_16x16x32_bf16 v[0:3], v[68:71], v[92:95], v[0:3]
    ds_read_b128 v[92:95], v116 offset:11968
    s_waitcnt vmcnt(3) lgkmcnt(6)
    v_mfma_f32_16x16x32_bf16 v[32:35], v[80:83], v[96:99], v[32:35]
    ds_read_b128 v[96:99], v120 offset:13312
    s_waitcnt vmcnt(2) lgkmcnt(6)
    v_mfma_f32_16x16x32_bf16 v[8:11], v[64:67], v[100:103], v[8:11]
    v_mfma_f32_16x16x32_bf16 v[4:7], v[68:71], v[100:103], v[4:7]
    v_mfma_f32_16x16x32_bf16 v[0:3], v[72:75], v[100:103], v[0:3]
    ds_read_b128 v[100:103], v116 offset:13056
    s_waitcnt vmcnt(1) lgkmcnt(6)
    v_mfma_f32_16x16x32_bf16 v[36:39], v[80:83], v[104:107], v[36:39]
    v_mfma_f32_16x16x32_bf16 v[32:35], v[84:87], v[104:107], v[32:35]
    ds_read_b128 v[104:107], v120 offset:14336
    s_waitcnt vmcnt(0) lgkmcnt(6)
    v_mfma_f32_16x16x32_bf16 v[12:15], v[64:67], v[108:111], v[12:15]
    v_mfma_f32_16x16x32_bf16 v[8:11], v[68:71], v[108:111], v[8:11]
    v_mfma_f32_16x16x32_bf16 v[4:7], v[72:75], v[108:111], v[4:7]
    v_mfma_f32_16x16x32_bf16 v[0:3], v[76:79], v[108:111], v[0:3]
    ds_read_b128 v[108:111], v116 offset:14144
    s_waitcnt lgkmcnt(6)
    v_mfma_f32_16x16x32_bf16 v[40:43], v[80:83], v[112:115], v[40:43]
    v_mfma_f32_16x16x32_bf16 v[36:39], v[84:87], v[112:115], v[36:39]
    ds_read_b128 v[112:115], v120 offset:15360
    s_waitcnt lgkmcnt(6)
    v_mfma_f32_16x16x32_bf16 v[16:19], v[64:67], v[88:91], v[16:19]
    v_mfma_f32_16x16x32_bf16 v[12:15], v[68:71], v[88:91], v[12:15]
    v_mfma_f32_16x16x32_bf16 v[8:11], v[72:75], v[88:91], v[8:11]
    v_mfma_f32_16x16x32_bf16 v[4:7], v[76:79], v[88:91], v[4:7]
    ds_read_b128 v[88:91], v117 offset:8704
    s_waitcnt lgkmcnt(6)
    v_mfma_f32_16x16x32_bf16 v[44:47], v[80:83], v[92:95], v[44:47]
    v_mfma_f32_16x16x32_bf16 v[40:43], v[84:87], v[92:95], v[40:43]
    ds_read_b128 v[92:95], v122 offset:0
    v_add_u32 v122, v124, v122
    s_waitcnt lgkmcnt(6)
    v_mfma_f32_16x16x32_bf16 v[20:23], v[64:67], v[96:99], v[20:23]
    v_mfma_f32_16x16x32_bf16 v[16:19], v[68:71], v[96:99], v[16:19]
    v_mfma_f32_16x16x32_bf16 v[12:15], v[72:75], v[96:99], v[12:15]
    v_mfma_f32_16x16x32_bf16 v[8:11], v[76:79], v[96:99], v[8:11]
    ds_read_b128 v[96:99], v117 offset:9792
    s_waitcnt lgkmcnt(6)
    v_mfma_f32_16x16x32_bf16 v[48:51], v[80:83], v[100:103], v[48:51]
    v_mfma_f32_16x16x32_bf16 v[44:47], v[84:87], v[100:103], v[44:47]
    ds_read_b128 v[100:103], v121 offset:9216
    s_waitcnt lgkmcnt(6)
    v_mfma_f32_16x16x32_bf16 v[24:27], v[64:67], v[104:107], v[24:27]
    v_mfma_f32_16x16x32_bf16 v[20:23], v[68:71], v[104:107], v[20:23]
    v_mfma_f32_16x16x32_bf16 v[16:19], v[72:75], v[104:107], v[16:19]
    v_mfma_f32_16x16x32_bf16 v[12:15], v[76:79], v[104:107], v[12:15]
    ds_read_b128 v[104:107], v118 offset:8704
    s_waitcnt lgkmcnt(6)
    v_mfma_f32_16x16x32_bf16 v[52:55], v[80:83], v[108:111], v[52:55]
    v_mfma_f32_16x16x32_bf16 v[48:51], v[84:87], v[108:111], v[48:51]
    ds_read_b128 v[108:111], v121 offset:10240
    s_waitcnt lgkmcnt(6)
    v_mfma_f32_16x16x32_bf16 v[28:31], v[64:67], v[112:115], v[28:31]
    v_mfma_f32_16x16x32_bf16 v[24:27], v[68:71], v[112:115], v[24:27]
    v_mfma_f32_16x16x32_bf16 v[20:23], v[72:75], v[112:115], v[20:23]
    v_mfma_f32_16x16x32_bf16 v[16:19], v[76:79], v[112:115], v[16:19]
    buffer_load_dwordx4 v[64:67], v125, s[12:15], s23 offen offset:0
    s_waitcnt lgkmcnt(5)
    v_mfma_f32_16x16x32_bf16 v[56:59], v[80:83], v[88:91], v[56:59]
    v_mfma_f32_16x16x32_bf16 v[52:55], v[84:87], v[88:91], v[52:55]
    s_waitcnt lgkmcnt(0)
    s_barrier
    v_mfma_f32_16x16x32_bf16 v[28:31], v[68:71], v[92:95], v[28:31]
    v_mfma_f32_16x16x32_bf16 v[24:27], v[72:75], v[92:95], v[24:27]
    v_mfma_f32_16x16x32_bf16 v[20:23], v[76:79], v[92:95], v[20:23]
    buffer_load_dwordx4 v[68:71], v125, s[12:15], s23 offen offset:2048
    v_mfma_f32_16x16x32_bf16 v[60:63], v[80:83], v[96:99], v[60:63]
    v_mfma_f32_16x16x32_bf16 v[56:59], v[84:87], v[96:99], v[56:59]
    buffer_load_dwordx4 v[80:83], v119, s[12:15], s23 offen offset:0
    v_mfma_f32_16x16x32_bf16 v[28:31], v[72:75], v[100:103], v[28:31]
    v_mfma_f32_16x16x32_bf16 v[24:27], v[76:79], v[100:103], v[24:27]
    buffer_load_dwordx4 v[72:75], v125, s[12:15], s26 offen offset:0
    v_mfma_f32_16x16x32_bf16 v[60:63], v[84:87], v[104:107], v[60:63]
    buffer_load_dwordx4 v[84:87], v119, s[12:15], s23 offen offset:2048
    v_mfma_f32_16x16x32_bf16 v[28:31], v[76:79], v[108:111], v[28:31]
    buffer_load_dwordx4 v[76:79], v125, s[12:15], s26 offen offset:2048
    s_add_u32 s23, s23, 57344
    s_add_u32 s26, s26, 57344
    s_branch L_conv1_kernel_mloop2
L_conv1_kernel_mlast2:
    v_and_b32 v125, 15, v127
    v_and_b32 v126, 7, v127
    v_lshlrev_b32 v126, 4, v126
    v_lshl_add_u32 v125, v125, 7, v126
    v_lshrrev_b32 v126, 4, v127
    v_lshl_add_u32 v125, v126, 11, v125
    s_mov_b32 s36, 65536
    s_cmp_eq_u32 s32, 1
    s_cselect_b32 s36, 121856, s36
    s_cmp_eq_u32 s32, 2
    s_cselect_b32 s36, 81920, s36
    s_cmp_eq_u32 s32, 3
    s_cselect_b32 s36, 130048, s36
    s_mov_b32 s37, 98304
    s_cmp_eq_u32 s32, 1
    s_cselect_b32 s37, 138240, s37
    s_cmp_eq_u32 s32, 2
    s_cselect_b32 s37, 146432, s37
    s_cmp_eq_u32 s32, 3
    s_cselect_b32 s37, 154624, s37
    v_add_u32 v126, s37, v125
    v_add_u32 v125, s36, v125
    ds_read_b128 v[88:91], v120 offset:8192
    ds_read_b128 v[92:95], v120 offset:9216
    ds_read_b128 v[96:99], v116 offset:8704
    ds_read_b128 v[100:103], v120 offset:10240
    ds_read_b128 v[104:107], v116 offset:9792
    ds_read_b128 v[108:111], v120 offset:11264
    ds_read_b128 v[112:115], v116 offset:10880
    s_waitcnt vmcnt(5) lgkmcnt(6)
    v_mfma_f32_16x16x32_bf16 v[0:3], v[64:67], v[88:91], v[0:3]
    ds_read_b128 v[88:91], v120 offset:12288
    s_waitcnt vmcnt(4) lgkmcnt(6)
    v_mfma_f32_16x16x32_bf16 v[4:7], v[64:67], v[92:95], v[4:7]
    v_mfma_f32_16x16x32_bf16 v[0:3], v[68:71], v[92:95], v[0:3]
    ds_read_b128 v[92:95], v116 offset:11968
    s_waitcnt vmcnt(3) lgkmcnt(6)
    v_mfma_f32_16x16x32_bf16 v[32:35], v[80:83], v[96:99], v[32:35]
    ds_read_b128 v[96:99], v120 offset:13312
    s_waitcnt vmcnt(2) lgkmcnt(6)
    v_mfma_f32_16x16x32_bf16 v[8:11], v[64:67], v[100:103], v[8:11]
    v_mfma_f32_16x16x32_bf16 v[4:7], v[68:71], v[100:103], v[4:7]
    v_mfma_f32_16x16x32_bf16 v[0:3], v[72:75], v[100:103], v[0:3]
    ds_read_b128 v[100:103], v116 offset:13056
    s_waitcnt vmcnt(1) lgkmcnt(6)
    v_mfma_f32_16x16x32_bf16 v[36:39], v[80:83], v[104:107], v[36:39]
    v_mfma_f32_16x16x32_bf16 v[32:35], v[84:87], v[104:107], v[32:35]
    ds_read_b128 v[104:107], v120 offset:14336
    s_waitcnt vmcnt(0) lgkmcnt(6)
    v_mfma_f32_16x16x32_bf16 v[12:15], v[64:67], v[108:111], v[12:15]
    v_mfma_f32_16x16x32_bf16 v[8:11], v[68:71], v[108:111], v[8:11]
    v_mfma_f32_16x16x32_bf16 v[4:7], v[72:75], v[108:111], v[4:7]
    v_mfma_f32_16x16x32_bf16 v[0:3], v[76:79], v[108:111], v[0:3]
    ds_read_b128 v[108:111], v116 offset:14144
    s_waitcnt lgkmcnt(6)
    v_mfma_f32_16x16x32_bf16 v[40:43], v[80:83], v[112:115], v[40:43]
    v_mfma_f32_16x16x32_bf16 v[36:39], v[84:87], v[112:115], v[36:39]
    ds_read_b128 v[112:115], v120 offset:15360
    s_waitcnt lgkmcnt(6)
    v_mfma_f32_16x16x32_bf16 v[16:19], v[64:67], v[88:91], v[16:19]
    v_mfma_f32_16x16x32_bf16 v[12:15], v[68:71], v[88:91], v[12:15]
    v_mfma_f32_16x16x32_bf16 v[8:11], v[72:75], v[88:91], v[8:11]
    v_mfma_f32_16x16x32_bf16 v[4:7], v[76:79], v[88:91], v[4:7]
    ds_read_b128 v[88:91], v117 offset:8704
    v_xor_b32 v124, 0, v126
    ds_write_b128 v124, v[32:35]
    s_waitcnt lgkmcnt(7)
    v_mfma_f32_16x16x32_bf16 v[44:47], v[80:83], v[92:95], v[44:47]
    v_mfma_f32_16x16x32_bf16 v[40:43], v[84:87], v[92:95], v[40:43]
    ds_read_b128 v[92:95], v122 offset:0
    v_xor_b32 v123, 0, v125
    ds_write_b128 v123, v[0:3]
    s_waitcnt lgkmcnt(8)
    v_mfma_f32_16x16x32_bf16 v[20:23], v[64:67], v[96:99], v[20:23]
    v_mfma_f32_16x16x32_bf16 v[16:19], v[68:71], v[96:99], v[16:19]
    v_mfma_f32_16x16x32_bf16 v[12:15], v[72:75], v[96:99], v[12:15]
    v_mfma_f32_16x16x32_bf16 v[8:11], v[76:79], v[96:99], v[8:11]
    ds_read_b128 v[96:99], v117 offset:9792
    v_xor_b32 v123, 16, v126
    ds_write_b128 v123, v[36:39]
    s_waitcnt lgkmcnt(9)
    v_mfma_f32_16x16x32_bf16 v[48:51], v[80:83], v[100:103], v[48:51]
    v_mfma_f32_16x16x32_bf16 v[44:47], v[84:87], v[100:103], v[44:47]
    ds_read_b128 v[100:103], v121 offset:9216
    v_xor_b32 v124, 16, v125
    ds_write_b128 v124, v[4:7]
    s_waitcnt lgkmcnt(10)
    v_mfma_f32_16x16x32_bf16 v[24:27], v[64:67], v[104:107], v[24:27]
    v_mfma_f32_16x16x32_bf16 v[20:23], v[68:71], v[104:107], v[20:23]
    v_mfma_f32_16x16x32_bf16 v[16:19], v[72:75], v[104:107], v[16:19]
    v_mfma_f32_16x16x32_bf16 v[12:15], v[76:79], v[104:107], v[12:15]
    ds_read_b128 v[104:107], v118 offset:8704
    v_xor_b32 v124, 32, v126
    ds_write_b128 v124, v[40:43]
    s_waitcnt lgkmcnt(11)
    v_mfma_f32_16x16x32_bf16 v[52:55], v[80:83], v[108:111], v[52:55]
    v_mfma_f32_16x16x32_bf16 v[48:51], v[84:87], v[108:111], v[48:51]
    ds_read_b128 v[108:111], v121 offset:10240
    v_xor_b32 v123, 32, v125
    ds_write_b128 v123, v[8:11]
    s_waitcnt lgkmcnt(12)
    v_mfma_f32_16x16x32_bf16 v[28:31], v[64:67], v[112:115], v[28:31]
    v_mfma_f32_16x16x32_bf16 v[24:27], v[68:71], v[112:115], v[24:27]
    v_mfma_f32_16x16x32_bf16 v[20:23], v[72:75], v[112:115], v[20:23]
    v_mfma_f32_16x16x32_bf16 v[16:19], v[76:79], v[112:115], v[16:19]
    v_xor_b32 v123, 48, v126
    ds_write_b128 v123, v[44:47]
    s_waitcnt lgkmcnt(12)
    v_mfma_f32_16x16x32_bf16 v[56:59], v[80:83], v[88:91], v[56:59]
    v_mfma_f32_16x16x32_bf16 v[52:55], v[84:87], v[88:91], v[52:55]
    v_xor_b32 v124, 48, v125
    ds_write_b128 v124, v[12:15]
    s_waitcnt lgkmcnt(11)
    v_mfma_f32_16x16x32_bf16 v[28:31], v[68:71], v[92:95], v[28:31]
    v_mfma_f32_16x16x32_bf16 v[24:27], v[72:75], v[92:95], v[24:27]
    v_mfma_f32_16x16x32_bf16 v[20:23], v[76:79], v[92:95], v[20:23]
    v_xor_b32 v124, 64, v126
    ds_write_b128 v124, v[48:51]
    s_waitcnt lgkmcnt(10)
    v_mfma_f32_16x16x32_bf16 v[60:63], v[80:83], v[96:99], v[60:63]
    v_mfma_f32_16x16x32_bf16 v[56:59], v[84:87], v[96:99], v[56:59]
    v_xor_b32 v123, 64, v125
    ds_write_b128 v123, v[16:19]
    s_waitcnt lgkmcnt(9)
    v_mfma_f32_16x16x32_bf16 v[28:31], v[72:75], v[100:103], v[28:31]
    v_mfma_f32_16x16x32_bf16 v[24:27], v[76:79], v[100:103], v[24:27]
    v_xor_b32 v123, 80, v126
    ds_write_b128 v123, v[52:55]
    s_waitcnt lgkmcnt(8)
    v_mfma_f32_16x16x32_bf16 v[60:63], v[84:87], v[104:107], v[60:63]
    v_xor_b32 v124, 80, v125
    ds_write_b128 v124, v[20:23]
    s_waitcnt lgkmcnt(7)
    v_mfma_f32_16x16x32_bf16 v[28:31], v[76:79], v[108:111], v[28:31]
    v_xor_b32 v124, 96, v126
    ds_write_b128 v124, v[56:59]
    s_nop 7
    v_xor_b32 v123, 96, v125
    ds_write_b128 v123, v[24:27]
    v_xor_b32 v123, 112, v126
    ds_write_b128 v123, v[60:63]
    v_xor_b32 v124, 112, v125
    ds_write_b128 v124, v[28:31]
    s_setprio 0
    s_branch L_conv1_kernel_epi
L_conv1_kernel_helper:
    s_setprio 3
    v_add_u32 v92, 0, v7
    v_add_u32 v93, 1024, v7
    v_add_u32 v94, 2048, v7
    v_add_u32 v95, 3072, v7
    v_and_b32 v76, 4, v5
    v_lshrrev_b32 v76, 1, v76
    v_xor_b32 v76, v6, v76
    v_lshlrev_b32 v76, 4, v76
    v_lshl_add_u32 v76, v5, 6, v76
    s_mov_b32 s24, 0
    s_mov_b32 s27, 524288
    buffer_load_dwordx4 v[0:3], v92, s[8:11], s24 offen offset:0
    buffer_load_dwordx4 v[16:19], v92, s[8:11], s24 offen offset:64
    v_add_u32 v92, 128, v92
    buffer_load_dwordx4 v[4:7], v93, s[8:11], s24 offen offset:0
    buffer_load_dwordx4 v[20:23], v93, s[8:11], s24 offen offset:64
    v_add_u32 v93, 128, v93
    buffer_load_dwordx4 v[8:11], v94, s[8:11], s24 offen offset:0
    buffer_load_dwordx4 v[24:27], v94, s[8:11], s24 offen offset:64
    v_add_u32 v94, 128, v94
    buffer_load_dwordx4 v[12:15], v95, s[8:11], s24 offen offset:0
    buffer_load_dwordx4 v[28:31], v95, s[8:11], s24 offen offset:64
    v_add_u32 v95, 128, v95
    s_barrier
    s_mul_i32 s36, s42, 1024
    v_add_u32 v96, s36, v76
    v_add_u32 v97, 65536, v96
    s_mul_i32 s36, s42, 1088
    s_add_u32 s36, s36, 98304
    v_add_u32 v98, s36, v76
    s_waitcnt vmcnt(0)
    s_mov_b32 s28, 0
    s_mov_b32 s22, 4
    s_cmp_ge_u32 s20, 12
    s_cbranch_scc1 L_conv1_kernel_h2
    ds_write_b128 v96, v[0:3] offset:0
    ds_write_b128 v98, v[12:15] offset:0
    v_lshlrev_b32 v76, 16, v0
    v_and_b32 v84, s25, v0
    v_lshlrev_b32 v77, 16, v4
    v_and_b32 v85, s25, v4
    v_lshlrev_b32 v78, 16, v8
    v_and_b32 v86, s25, v8
    v_lshlrev_b32 v79, 16, v12
    v_and_b32 v87, s25, v12
    v_add_f32 v80, v76, v78
    v_add_f32 v88, v84, v86
    v_add_f32 v81, v77, v79
    v_add_f32 v89, v85, v87
    v_fma_f32 v82, v78, 4.0, v76
    v_fma_f32 v90, v86, 4.0, v84
    v_fma_f32 v83, v79, 4.0, v77
    v_fma_f32 v91, v87, 4.0, v85
    v_add_f32 v77, v80, v81
    v_add_f32 v85, v88, v89
    v_sub_f32 v78, v80, v81
    v_sub_f32 v86, v88, v89
    v_fma_f32 v79, v83, 2.0, v82
    v_fma_f32 v87, v91, 2.0, v90
    v_fma_f32 v82, v83, -2.0, v82
    v_fma_f32 v90, v91, -2.0, v90
    v_fmamk_f32 v80, v76, 0x41700000, v82
    v_fmamk_f32 v88, v84, 0x41700000, v90
    v_fmamk_f32 v80, v81, 0x41200000, v80
    v_fmamk_f32 v88, v89, 0x41200000, v88
    v_cvt_pk_bf16_f32 v4, v77, v85
    v_cvt_pk_bf16_f32 v8, v78, v86
    v_cvt_pk_bf16_f32 v64, v79, v87
    v_cvt_pk_bf16_f32 v68, v82, v90
    v_cvt_pk_bf16_f32 v72, v80, v88
    v_lshlrev_b32 v76, 16, v1
    v_and_b32 v84, s25, v1
    v_lshlrev_b32 v77, 16, v5
    v_and_b32 v85, s25, v5
    v_lshlrev_b32 v78, 16, v9
    v_and_b32 v86, s25, v9
    v_lshlrev_b32 v79, 16, v13
    v_and_b32 v87, s25, v13
    v_add_f32 v80, v76, v78
    v_add_f32 v88, v84, v86
    v_add_f32 v81, v77, v79
    v_add_f32 v89, v85, v87
    v_fma_f32 v82, v78, 4.0, v76
    v_fma_f32 v90, v86, 4.0, v84
    v_fma_f32 v83, v79, 4.0, v77
    v_fma_f32 v91, v87, 4.0, v85
    v_add_f32 v77, v80, v81
    v_add_f32 v85, v88, v89
    v_sub_f32 v78, v80, v81
    v_sub_f32 v86, v88, v89
    v_fma_f32 v79, v83, 2.0, v82
    v_fma_f32 v87, v91, 2.0, v90
    v_fma_f32 v82, v83, -2.0, v82
    v_fma_f32 v90, v91, -2.0, v90
    v_fmamk_f32 v80, v76, 0x41700000, v82
    v_fmamk_f32 v88, v84, 0x41700000, v90
    v_fmamk_f32 v80, v81, 0x41200000, v80
    v_fmamk_f32 v88, v89, 0x41200000, v88
    v_cvt_pk_bf16_f32 v5, v77, v85
    v_cvt_pk_bf16_f32 v9, v78, v86
    v_cvt_pk_bf16_f32 v65, v79, v87
    v_cvt_pk_bf16_f32 v69, v82, v90
    v_cvt_pk_bf16_f32 v73, v80, v88
    v_lshlrev_b32 v76, 16, v2
    v_and_b32 v84, s25, v2
    v_lshlrev_b32 v77, 16, v6
    v_and_b32 v85, s25, v6
    v_lshlrev_b32 v78, 16, v10
    v_and_b32 v86, s25, v10
    v_lshlrev_b32 v79, 16, v14
    v_and_b32 v87, s25, v14
    v_add_f32 v80, v76, v78
    v_add_f32 v88, v84, v86
    v_add_f32 v81, v77, v79
    v_add_f32 v89, v85, v87
    v_fma_f32 v82, v78, 4.0, v76
    v_fma_f32 v90, v86, 4.0, v84
    v_fma_f32 v83, v79, 4.0, v77
    v_fma_f32 v91, v87, 4.0, v85
    v_add_f32 v77, v80, v81
    v_add_f32 v85, v88, v89
    v_sub_f32 v78, v80, v81
    v_sub_f32 v86, v88, v89
    v_fma_f32 v79, v83, 2.0, v82
    v_fma_f32 v87, v91, 2.0, v90
    v_fma_f32 v82, v83, -2.0, v82
    v_fma_f32 v90, v91, -2.0, v90
    v_fmamk_f32 v80, v76, 0x41700000, v82
    v_fmamk_f32 v88, v84, 0x41700000, v90
    v_fmamk_f32 v80, v81, 0x41200000, v80
    v_fmamk_f32 v88, v89, 0x41200000, v88
    v_cvt_pk_bf16_f32 v6, v77, v85
    v_cvt_pk_bf16_f32 v10, v78, v86
    v_cvt_pk_bf16_f32 v66, v79, v87
    v_cvt_pk_bf16_f32 v70, v82, v90
    v_cvt_pk_bf16_f32 v74, v80, v88
    v_lshlrev_b32 v76, 16, v3
    v_and_b32 v84, s25, v3
    v_lshlrev_b32 v77, 16, v7
    v_and_b32 v85, s25, v7
    v_lshlrev_b32 v78, 16, v11
    v_and_b32 v86, s25, v11
    v_lshlrev_b32 v79, 16, v15
    v_and_b32 v87, s25, v15
    v_add_f32 v80, v76, v78
    v_add_f32 v88, v84, v86
    v_add_f32 v81, v77, v79
    v_add_f32 v89, v85, v87
    v_fma_f32 v82, v78, 4.0, v76
    v_fma_f32 v90, v86, 4.0, v84
    v_fma_f32 v83, v79, 4.0, v77
    v_fma_f32 v91, v87, 4.0, v85
    v_add_f32 v77, v80, v81
    v_add_f32 v85, v88, v89
    v_sub_f32 v78, v80, v81
    v_sub_f32 v86, v88, v89
    v_fma_f32 v79, v83, 2.0, v82
    v_fma_f32 v87, v91, 2.0, v90
    v_fma_f32 v82, v83, -2.0, v82
    v_fma_f32 v90, v91, -2.0, v90
    v_fmamk_f32 v80, v76, 0x41700000, v82
    v_fmamk_f32 v88, v84, 0x41700000, v90
    v_fmamk_f32 v80, v81, 0x41200000, v80
    v_fmamk_f32 v88, v89, 0x41200000, v88
    v_cvt_pk_bf16_f32 v7, v77, v85
    v_cvt_pk_bf16_f32 v11, v78, v86
    v_cvt_pk_bf16_f32 v67, v79, v87
    v_cvt_pk_bf16_f32 v71, v82, v90
    v_cvt_pk_bf16_f32 v75, v80, v88
    ds_write_b128 v96, v[64:67] offset:49152
    ds_write_b128 v97, v[68:71] offset:0
    ds_write_b128 v97, v[72:75] offset:16384
    ds_write_b128 v96, v[4:7] offset:16384
    ds_write_b128 v96, v[8:11] offset:32768
    s_waitcnt vmcnt(0)
    buffer_load_dwordx4 v[32:35], v92, s[8:11], s24 offen offset:0
    buffer_load_dwordx4 v[48:51], v92, s[8:11], s24 offen offset:64
    v_add_u32 v92, 128, v92
    buffer_load_dwordx4 v[36:39], v93, s[8:11], s24 offen offset:0
    buffer_load_dwordx4 v[52:55], v93, s[8:11], s24 offen offset:64
    v_add_u32 v93, 128, v93
    s_waitcnt lgkmcnt(0)
    s_barrier
    s_setprio 1
L_conv1_kernel_hloop1:
    s_cmp_lt_u32 s28, 13
    s_cselect_b32 s24, 0, 2130706432
    v_lshlrev_b32 v76, 16, v16
    v_and_b32 v84, s25, v16
    v_lshlrev_b32 v77, 16, v20
    v_and_b32 v85, s25, v20
    v_lshlrev_b32 v78, 16, v24
    v_and_b32 v86, s25, v24
    v_lshlrev_b32 v79, 16, v28
    v_and_b32 v87, s25, v28
    v_add_f32 v80, v76, v78
    v_add_f32 v88, v84, v86
    v_add_f32 v81, v77, v79
    v_add_f32 v89, v85, v87
    v_fma_f32 v82, v78, 4.0, v76
    buffer_load_dwordx4 v[40:43], v94, s[8:11], s24 offen offset:0
    buffer_load_dwordx4 v[56:59], v94, s[8:11], s24 offen offset:64
    v_add_u32 v94, 128, v94
    v_fma_f32 v90, v86, 4.0, v84
    v_fma_f32 v83, v79, 4.0, v77
    v_fma_f32 v91, v87, 4.0, v85
    v_add_f32 v77, v80, v81
    v_add_f32 v85, v88, v89
    v_sub_f32 v78, v80, v81
    v_sub_f32 v86, v88, v89
    v_fma_f32 v79, v83, 2.0, v82
    v_fma_f32 v87, v91, 2.0, v90
    v_fma_f32 v82, v83, -2.0, v82
    v_fma_f32 v90, v91, -2.0, v90
    v_fmamk_f32 v80, v76, 0x41700000, v82
    v_fmamk_f32 v88, v84, 0x41700000, v90
    v_fmamk_f32 v80, v81, 0x41200000, v80
    v_fmamk_f32 v88, v89, 0x41200000, v88
    v_cvt_pk_bf16_f32 v20, v77, v85
    v_cvt_pk_bf16_f32 v24, v78, v86
    v_cvt_pk_bf16_f32 v64, v79, v87
    v_cvt_pk_bf16_f32 v68, v82, v90
    v_cvt_pk_bf16_f32 v72, v80, v88
    v_lshlrev_b32 v76, 16, v17
    v_and_b32 v84, s25, v17
    v_lshlrev_b32 v77, 16, v21
    v_and_b32 v85, s25, v21
    v_lshlrev_b32 v78, 16, v25
    v_and_b32 v86, s25, v25
    v_lshlrev_b32 v79, 16, v29
    v_and_b32 v87, s25, v29
    v_add_f32 v80, v76, v78
    v_add_f32 v88, v84, v86
    v_add_f32 v81, v77, v79
    v_add_f32 v89, v85, v87
    v_fma_f32 v82, v78, 4.0, v76
    v_fma_f32 v90, v86, 4.0, v84
    v_fma_f32 v83, v79, 4.0, v77
    v_fma_f32 v91, v87, 4.0, v85
    v_add_f32 v77, v80, v81
    v_add_f32 v85, v88, v89
    v_sub_f32 v78, v80, v81
    v_sub_f32 v86, v88, v89
    v_fma_f32 v79, v83, 2.0, v82
    v_fma_f32 v87, v91, 2.0, v90
    v_fma_f32 v82, v83, -2.0, v82
    v_fma_f32 v90, v91, -2.0, v90
    v_fmamk_f32 v80, v76, 0x41700000, v82
    v_fmamk_f32 v88, v84, 0x41700000, v90
    v_fmamk_f32 v80, v81, 0x41200000, v80
    v_fmamk_f32 v88, v89, 0x41200000, v88
    v_cvt_pk_bf16_f32 v21, v77, v85
    v_cvt_pk_bf16_f32 v25, v78, v86
    v_cvt_pk_bf16_f32 v65, v79, v87
    v_cvt_pk_bf16_f32 v69, v82, v90
    v_cvt_pk_bf16_f32 v73, v80, v88
    buffer_load_dwordx4 v[44:47], v95, s[8:11], s24 offen offset:0
    buffer_load_dwordx4 v[60:63], v95, s[8:11], s24 offen offset:64
    v_add_u32 v95, 128, v95
    v_lshlrev_b32 v76, 16, v18
    v_and_b32 v84, s25, v18
    v_lshlrev_b32 v77, 16, v22
    v_and_b32 v85, s25, v22
    v_lshlrev_b32 v78, 16, v26
    v_and_b32 v86, s25, v26
    v_lshlrev_b32 v79, 16, v30
    v_and_b32 v87, s25, v30
    v_add_f32 v80, v76, v78
    v_add_f32 v88, v84, v86
    v_add_f32 v81, v77, v79
    v_add_f32 v89, v85, v87
    v_fma_f32 v82, v78, 4.0, v76
    v_fma_f32 v90, v86, 4.0, v84
    v_fma_f32 v83, v79, 4.0, v77
    v_fma_f32 v91, v87, 4.0, v85
    v_add_f32 v77, v80, v81
    v_add_f32 v85, v88, v89
    v_sub_f32 v78, v80, v81
    v_sub_f32 v86, v88, v89
    v_fma_f32 v79, v83, 2.0, v82
    v_fma_f32 v87, v91, 2.0, v90
    v_fma_f32 v82, v83, -2.0, v82
    v_fma_f32 v90, v91, -2.0, v90
    v_fmamk_f32 v80, v76, 0x41700000, v82
    v_fmamk_f32 v88, v84, 0x41700000, v90
    v_fmamk_f32 v80, v81, 0x41200000, v80
    v_fmamk_f32 v88, v89, 0x41200000, v88
    v_cvt_pk_bf16_f32 v22, v77, v85
    v_cvt_pk_bf16_f32 v26, v78, v86
    v_cvt_pk_bf16_f32 v66, v79, v87
    v_cvt_pk_bf16_f32 v70, v82, v90
    v_cvt_pk_bf16_f32 v74, v80, v88
    v_lshlrev_b32 v76, 16, v19
    v_and_b32 v84, s25, v19
    v_lshlrev_b32 v77, 16, v23
    v_and_b32 v85, s25, v23
    v_lshlrev_b32 v78, 16, v27
    v_and_b32 v86, s25, v27
    v_lshlrev_b32 v79, 16, v31
    v_and_b32 v87, s25, v31
    v_add_f32 v80, v76, v78
    v_add_f32 v88, v84, v86
    v_add_f32 v81, v77, v79
    v_add_f32 v89, v85, v87
    v_fma_f32 v82, v78, 4.0, v76
    v_fma_f32 v90, v86, 4.0, v84
    v_fma_f32 v83, v79, 4.0, v77
    v_fma_f32 v91, v87, 4.0, v85
    v_add_f32 v77, v80, v81
    v_add_f32 v85, v88, v89
    v_sub_f32 v78, v80, v81
    v_sub_f32 v86, v88, v89
    v_fma_f32 v79, v83, 2.0, v82
    v_fma_f32 v87, v91, 2.0, v90
    v_fma_f32 v82, v83, -2.0, v82
    v_fma_f32 v90, v91, -2.0, v90
    v_fmamk_f32 v80, v76, 0x41700000, v82
    v_fmamk_f32 v88, v84, 0x41700000, v90
    v_fmamk_f32 v80, v81, 0x41200000, v80
    v_fmamk_f32 v88, v89, 0x41200000, v88
    v_cvt_pk_bf16_f32 v23, v77, v85
    v_cvt_pk_bf16_f32 v27, v78, v86
    v_cvt_pk_bf16_f32 v67, v79, v87
    v_cvt_pk_bf16_f32 v71, v82, v90
    v_cvt_pk_bf16_f32 v75, v80, v88
    ds_write_b128 v96, v[64:67] offset:57344
    ds_write_b128 v97, v[68:71] offset:8192
    ds_write_b128 v97, v[72:75] offset:24576
    ds_write_b128 v96, v[16:19] offset:8192
    ds_write_b128 v96, v[20:23] offset:24576
    ds_write_b128 v96, v[24:27] offset:40960
    ds_write_b128 v98, v[28:31] offset:8704
    s_add_u32 s28, s28, 1
    s_waitcnt lgkmcnt(0)
    s_barrier
    s_cmp_lt_u32 s28, 13
    s_cselect_b32 s24, 0, 2130706432
    s_waitcnt vmcnt(0)
    v_lshlrev_b32 v76, 16, v32
    v_and_b32 v84, s25, v32
    v_lshlrev_b32 v77, 16, v36
    v_and_b32 v85, s25, v36
    v_lshlrev_b32 v78, 16, v40
    v_and_b32 v86, s25, v40
    v_lshlrev_b32 v79, 16, v44
    v_and_b32 v87, s25, v44
    v_add_f32 v80, v76, v78
    v_add_f32 v88, v84, v86
    v_add_f32 v81, v77, v79
    v_add_f32 v89, v85, v87
    v_fma_f32 v82, v78, 4.0, v76
    v_fma_f32 v90, v86, 4.0, v84
    v_fma_f32 v83, v79, 4.0, v77
    v_fma_f32 v91, v87, 4.0, v85
    v_add_f32 v77, v80, v81
    v_add_f32 v85, v88, v89
    v_sub_f32 v78, v80, v81
    v_sub_f32 v86, v88, v89
    v_fma_f32 v79, v83, 2.0, v82
    v_fma_f32 v87, v91, 2.0, v90
    v_fma_f32 v82, v83, -2.0, v82
    v_fma_f32 v90, v91, -2.0, v90
    v_fmamk_f32 v80, v76, 0x41700000, v82
    v_fmamk_f32 v88, v84, 0x41700000, v90
    v_fmamk_f32 v80, v81, 0x41200000, v80
    v_fmamk_f32 v88, v89, 0x41200000, v88
    v_cvt_pk_bf16_f32 v36, v77, v85
    v_cvt_pk_bf16_f32 v40, v78, v86
    v_cvt_pk_bf16_f32 v64, v79, v87
    v_cvt_pk_bf16_f32 v68, v82, v90
    v_cvt_pk_bf16_f32 v72, v80, v88
    v_lshlrev_b32 v76, 16, v33
    v_and_b32 v84, s25, v33
    v_lshlrev_b32 v77, 16, v37
    v_and_b32 v85, s25, v37
    v_lshlrev_b32 v78, 16, v41
    v_and_b32 v86, s25, v41
    buffer_load_dwordx4 v[0:3], v92, s[8:11], s24 offen offset:0
    buffer_load_dwordx4 v[16:19], v92, s[8:11], s24 offen offset:64
    v_add_u32 v92, 128, v92
    v_lshlrev_b32 v79, 16, v45
    v_and_b32 v87, s25, v45
    v_add_f32 v80, v76, v78
    v_add_f32 v88, v84, v86
    v_add_f32 v81, v77, v79
    v_add_f32 v89, v85, v87
    v_fma_f32 v82, v78, 4.0, v76
    v_fma_f32 v90, v86, 4.0, v84
    v_fma_f32 v83, v79, 4.0, v77
    v_fma_f32 v91, v87, 4.0, v85
    v_add_f32 v77, v80, v81
    v_add_f32 v85, v88, v89
    v_sub_f32 v78, v80, v81
    v_sub_f32 v86, v88, v89
    v_fma_f32 v79, v83, 2.0, v82
    v_fma_f32 v87, v91, 2.0, v90
    v_fma_f32 v82, v83, -2.0, v82
    v_fma_f32 v90, v91, -2.0, v90
    v_fmamk_f32 v80, v76, 0x41700000, v82
    v_fmamk_f32 v88, v84, 0x41700000, v90
    v_fmamk_f32 v80, v81, 0x41200000, v80
    v_fmamk_f32 v88, v89, 0x41200000, v88
    v_cvt_pk_bf16_f32 v37, v77, v85
    v_cvt_pk_bf16_f32 v41, v78, v86
    v_cvt_pk_bf16_f32 v65, v79, v87
    v_cvt_pk_bf16_f32 v69, v82, v90
    v_cvt_pk_bf16_f32 v73, v80, v88
    v_lshlrev_b32 v76, 16, v34
    v_and_b32 v84, s25, v34
    v_lshlrev_b32 v77, 16, v38
    v_and_b32 v85, s25, v38
    v_lshlrev_b32 v78, 16, v42
    v_and_b32 v86, s25, v42
    v_lshlrev_b32 v79, 16, v46
    v_and_b32 v87, s25, v46
    v_add_f32 v80, v76, v78
    v_add_f32 v88, v84, v86
    v_add_f32 v81, v77, v79
    v_add_f32 v89, v85, v87
    v_fma_f32 v82, v78, 4.0, v76
    v_fma_f32 v90, v86, 4.0, v84
    v_fma_f32 v83, v79, 4.0, v77
    v_fma_f32 v91, v87, 4.0, v85
    v_add_f32 v77, v80, v81
    v_add_f32 v85, v88, v89
    v_sub_f32 v78, v80, v81
    v_sub_f32 v86, v88, v89
    v_fma_f32 v79, v83, 2.0, v82
    v_fma_f32 v87, v91, 2.0, v90
    v_fma_f32 v82, v83, -2.0, v82
    v_fma_f32 v90, v91, -2.0, v90
    v_fmamk_f32 v80, v76, 0x41700000, v82
    v_fmamk_f32 v88, v84, 0x41700000, v90
    buffer_load_dwordx4 v[4:7], v93, s[8:11], s24 offen offset:0
    buffer_load_dwordx4 v[20:23], v93, s[8:11], s24 offen offset:64
    v_add_u32 v93, 128, v93
    v_fmamk_f32 v80, v81, 0x41200000, v80
    v_fmamk_f32 v88, v89, 0x41200000, v88
    v_cvt_pk_bf16_f32 v38, v77, v85
    v_cvt_pk_bf16_f32 v42, v78, v86
    v_cvt_pk_bf16_f32 v66, v79, v87
    v_cvt_pk_bf16_f32 v70, v82, v90
    v_cvt_pk_bf16_f32 v74, v80, v88
    v_lshlrev_b32 v76, 16, v35
    v_and_b32 v84, s25, v35
    v_lshlrev_b32 v77, 16, v39
    v_and_b32 v85, s25, v39
    v_lshlrev_b32 v78, 16, v43
    v_and_b32 v86, s25, v43
    v_lshlrev_b32 v79, 16, v47
    v_and_b32 v87, s25, v47
    v_add_f32 v80, v76, v78
    v_add_f32 v88, v84, v86
    v_add_f32 v81, v77, v79
    v_add_f32 v89, v85, v87
    v_fma_f32 v82, v78, 4.0, v76
    v_fma_f32 v90, v86, 4.0, v84
    v_fma_f32 v83, v79, 4.0, v77
    v_fma_f32 v91, v87, 4.0, v85
    v_add_f32 v77, v80, v81
    v_add_f32 v85, v88, v89
    v_sub_f32 v78, v80, v81
    v_sub_f32 v86, v88, v89
    v_fma_f32 v79, v83, 2.0, v82
    v_fma_f32 v87, v91, 2.0, v90
    v_fma_f32 v82, v83, -2.0, v82
    v_fma_f32 v90, v91, -2.0, v90
    v_fmamk_f32 v80, v76, 0x41700000, v82
    v_fmamk_f32 v88, v84, 0x41700000, v90
    v_fmamk_f32 v80, v81, 0x41200000, v80
    v_fmamk_f32 v88, v89, 0x41200000, v88
    v_cvt_pk_bf16_f32 v39, v77, v85
    v_cvt_pk_bf16_f32 v43, v78, v86
    v_cvt_pk_bf16_f32 v67, v79, v87
    v_cvt_pk_bf16_f32 v71, v82, v90
    v_cvt_pk_bf16_f32 v75, v80, v88
    ds_write_b128 v96, v[64:67] offset:49152
    ds_write_b128 v97, v[68:71] offset:0
    ds_write_b128 v97, v[72:75] offset:16384
    ds_write_b128 v96, v[32:35] offset:0
    ds_write_b128 v96, v[36:39] offset:16384
    ds_write_b128 v96, v[40:43] offset:32768
    ds_write_b128 v98, v[44:47] offset:0
    s_add_u32 s28, s28, 1
    s_waitcnt lgkmcnt(0)
    s_barrier
    s_cmp_lt_u32 s28, 13
    s_cselect_b32 s24, 0, 2130706432
    v_lshlrev_b32 v76, 16, v48
    v_and_b32 v84, s25, v48
    v_lshlrev_b32 v77, 16, v52
    v_and_b32 v85, s25, v52
    v_lshlrev_b32 v78, 16, v56
    v_and_b32 v86, s25, v56
    v_lshlrev_b32 v79, 16, v60
    v_and_b32 v87, s25, v60
    v_add_f32 v80, v76, v78
    v_add_f32 v88, v84, v86
    v_add_f32 v81, v77, v79
    v_add_f32 v89, v85, v87
    v_fma_f32 v82, v78, 4.0, v76
    buffer_load_dwordx4 v[8:11], v94, s[8:11], s24 offen offset:0
    buffer_load_dwordx4 v[24:27], v94, s[8:11], s24 offen offset:64
    v_add_u32 v94, 128, v94
    v_fma_f32 v90, v86, 4.0, v84
    v_fma_f32 v83, v79, 4.0, v77
    v_fma_f32 v91, v87, 4.0, v85
    v_add_f32 v77, v80, v81
    v_add_f32 v85, v88, v89
    v_sub_f32 v78, v80, v81
    v_sub_f32 v86, v88, v89
    v_fma_f32 v79, v83, 2.0, v82
    v_fma_f32 v87, v91, 2.0, v90
    v_fma_f32 v82, v83, -2.0, v82
    v_fma_f32 v90, v91, -2.0, v90
    v_fmamk_f32 v80, v76, 0x41700000, v82
    v_fmamk_f32 v88, v84, 0x41700000, v90
    v_fmamk_f32 v80, v81, 0x41200000, v80
    v_fmamk_f32 v88, v89, 0x41200000, v88
    v_cvt_pk_bf16_f32 v52, v77, v85
    v_cvt_pk_bf16_f32 v56, v78, v86
    v_cvt_pk_bf16_f32 v64, v79, v87
    v_cvt_pk_bf16_f32 v68, v82, v90
    v_cvt_pk_bf16_f32 v72, v80, v88
    v_lshlrev_b32 v76, 16, v49
    v_and_b32 v84, s25, v49
    v_lshlrev_b32 v77, 16, v53
    v_and_b32 v85, s25, v53
    v_lshlrev_b32 v78, 16, v57
    v_and_b32 v86, s25, v57
    v_lshlrev_b32 v79, 16, v61
    v_and_b32 v87, s25, v61
    v_add_f32 v80, v76, v78
    v_add_f32 v88, v84, v86
    v_add_f32 v81, v77, v79
    v_add_f32 v89, v85, v87
    v_fma_f32 v82, v78, 4.0, v76
    v_fma_f32 v90, v86, 4.0, v84
    v_fma_f32 v83, v79, 4.0, v77
    v_fma_f32 v91, v87, 4.0, v85
    v_add_f32 v77, v80, v81
    v_add_f32 v85, v88, v89
    v_sub_f32 v78, v80, v81
    v_sub_f32 v86, v88, v89
    v_fma_f32 v79, v83, 2.0, v82
    v_fma_f32 v87, v91, 2.0, v90
    v_fma_f32 v82, v83, -2.0, v82
    v_fma_f32 v90, v91, -2.0, v90
    v_fmamk_f32 v80, v76, 0x41700000, v82
    v_fmamk_f32 v88, v84, 0x41700000, v90
    v_fmamk_f32 v80, v81, 0x41200000, v80
    v_fmamk_f32 v88, v89, 0x41200000, v88
    v_cvt_pk_bf16_f32 v53, v77, v85
    v_cvt_pk_bf16_f32 v57, v78, v86
    v_cvt_pk_bf16_f32 v65, v79, v87
    v_cvt_pk_bf16_f32 v69, v82, v90
    v_cvt_pk_bf16_f32 v73, v80, v88
    buffer_load_dwordx4 v[12:15], v95, s[8:11], s24 offen offset:0
    buffer_load_dwordx4 v[28:31], v95, s[8:11], s24 offen offset:64
    v_add_u32 v95, 128, v95
    v_lshlrev_b32 v76, 16, v50
    v_and_b32 v84, s25, v50
    v_lshlrev_b32 v77, 16, v54
    v_and_b32 v85, s25, v54
    v_lshlrev_b32 v78, 16, v58
    v_and_b32 v86, s25, v58
    v_lshlrev_b32 v79, 16, v62
    v_and_b32 v87, s25, v62
    v_add_f32 v80, v76, v78
    v_add_f32 v88, v84, v86
    v_add_f32 v81, v77, v79
    v_add_f32 v89, v85, v87
    v_fma_f32 v82, v78, 4.0, v76
    v_fma_f32 v90, v86, 4.0, v84
    v_fma_f32 v83, v79, 4.0, v77
    v_fma_f32 v91, v87, 4.0, v85
    v_add_f32 v77, v80, v81
    v_add_f32 v85, v88, v89
    v_sub_f32 v78, v80, v81
    v_sub_f32 v86, v88, v89
    v_fma_f32 v79, v83, 2.0, v82
    v_fma_f32 v87, v91, 2.0, v90
    v_fma_f32 v82, v83, -2.0, v82
    v_fma_f32 v90, v91, -2.0, v90
    v_fmamk_f32 v80, v76, 0x41700000, v82
    v_fmamk_f32 v88, v84, 0x41700000, v90
    v_fmamk_f32 v80, v81, 0x41200000, v80
    v_fmamk_f32 v88, v89, 0x41200000, v88
    v_cvt_pk_bf16_f32 v54, v77, v85
    v_cvt_pk_bf16_f32 v58, v78, v86
    v_cvt_pk_bf16_f32 v66, v79, v87
    v_cvt_pk_bf16_f32 v70, v82, v90
    v_cvt_pk_bf16_f32 v74, v80, v88
    v_lshlrev_b32 v76, 16, v51
    v_and_b32 v84, s25, v51
    v_lshlrev_b32 v77, 16, v55
    v_and_b32 v85, s25, v55
    v_lshlrev_b32 v78, 16, v59
    v_and_b32 v86, s25, v59
    v_lshlrev_b32 v79, 16, v63
    v_and_b32 v87, s25, v63
    v_add_f32 v80, v76, v78
    v_add_f32 v88, v84, v86
    v_add_f32 v81, v77, v79
    v_add_f32 v89, v85, v87
    v_fma_f32 v82, v78, 4.0, v76
    v_fma_f32 v90, v86, 4.0, v84
    v_fma_f32 v83, v79, 4.0, v77
    v_fma_f32 v91, v87, 4.0, v85
    v_add_f32 v77, v80, v81
    v_add_f32 v85, v88, v89
    v_sub_f32 v78, v80, v81
    v_sub_f32 v86, v88, v89
    v_fma_f32 v79, v83, 2.0, v82
    v_fma_f32 v87, v91, 2.0, v90
    v_fma_f32 v82, v83, -2.0, v82
    v_fma_f32 v90, v91, -2.0, v90
    v_fmamk_f32 v80, v76, 0x41700000, v82
    v_fmamk_f32 v88, v84, 0x41700000, v90
    v_fmamk_f32 v80, v81, 0x41200000, v80
    v_fmamk_f32 v88, v89, 0x41200000, v88
    v_cvt_pk_bf16_f32 v55, v77, v85
    v_cvt_pk_bf16_f32 v59, v78, v86
    v_cvt_pk_bf16_f32 v67, v79, v87
    v_cvt_pk_bf16_f32 v71, v82, v90
    v_cvt_pk_bf16_f32 v75, v80, v88
    ds_write_b128 v96, v[64:67] offset:57344
    ds_write_b128 v97, v[68:71] offset:8192
    ds_write_b128 v97, v[72:75] offset:24576
    ds_write_b128 v96, v[48:51] offset:8192
    ds_write_b128 v96, v[52:55] offset:24576
    ds_write_b128 v96, v[56:59] offset:40960
    ds_write_b128 v98, v[60:63] offset:8704
    s_add_u32 s28, s28, 1
    s_waitcnt lgkmcnt(0)
    s_barrier
    s_cmp_eq_u32 s22, 1
    s_cbranch_scc1 L_conv1_kernel_hlast1
    s_cmp_lt_u32 s28, 13
    s_cselect_b32 s24, 0, 2130706432
    s_waitcnt vmcnt(0)
    v_lshlrev_b32 v76, 16, v0
    v_and_b32 v84, s25, v0
    v_lshlrev_b32 v77, 16, v4
    v_and_b32 v85, s25, v4
    v_lshlrev_b32 v78, 16, v8
    v_and_b32 v86, s25, v8
    v_lshlrev_b32 v79, 16, v12
    v_and_b32 v87, s25, v12
    v_add_f32 v80, v76, v78
    v_add_f32 v88, v84, v86
    v_add_f32 v81, v77, v79
    v_add_f32 v89, v85, v87
    v_fma_f32 v82, v78, 4.0, v76
    v_fma_f32 v90, v86, 4.0, v84
    v_fma_f32 v83, v79, 4.0, v77
    v_fma_f32 v91, v87, 4.0, v85
    v_add_f32 v77, v80, v81
    v_add_f32 v85, v88, v89
    v_sub_f32 v78, v80, v81
    v_sub_f32 v86, v88, v89
    v_fma_f32 v79, v83, 2.0, v82
    v_fma_f32 v87, v91, 2.0, v90
    v_fma_f32 v82, v83, -2.0, v82
    v_fma_f32 v90, v91, -2.0, v90
    v_fmamk_f32 v80, v76, 0x41700000, v82
    v_fmamk_f32 v88, v84, 0x41700000, v90
    v_fmamk_f32 v80, v81, 0x41200000, v80
    v_fmamk_f32 v88, v89, 0x41200000, v88
    v_cvt_pk_bf16_f32 v4, v77, v85
    v_cvt_pk_bf16_f32 v8, v78, v86
    v_cvt_pk_bf16_f32 v64, v79, v87
    v_cvt_pk_bf16_f32 v68, v82, v90
    v_cvt_pk_bf16_f32 v72, v80, v88
    v_lshlrev_b32 v76, 16, v1
    v_and_b32 v84, s25, v1
    v_lshlrev_b32 v77, 16, v5
    v_and_b32 v85, s25, v5
    v_lshlrev_b32 v78, 16, v9
    v_and_b32 v86, s25, v9
    buffer_load_dwordx4 v[32:35], v92, s[8:11], s24 offen offset:0
    buffer_load_dwordx4 v[48:51], v92, s[8:11], s24 offen offset:64
    v_add_u32 v92, 128, v92
    v_lshlrev_b32 v79, 16, v13
    v_and_b32 v87, s25, v13
    v_add_f32 v80, v76, v78
    v_add_f32 v88, v84, v86
    v_add_f32 v81, v77, v79
    v_add_f32 v89, v85, v87
    v_fma_f32 v82, v78, 4.0, v76
    v_fma_f32 v90, v86, 4.0, v84
    v_fma_f32 v83, v79, 4.0, v77
    v_fma_f32 v91, v87, 4.0, v85
    v_add_f32 v77, v80, v81
    v_add_f32 v85, v88, v89
    v_sub_f32 v78, v80, v81
    v_sub_f32 v86, v88, v89
    v_fma_f32 v79, v83, 2.0, v82
    v_fma_f32 v87, v91, 2.0, v90
    v_fma_f32 v82, v83, -2.0, v82
    v_fma_f32 v90, v91, -2.0, v90
    v_fmamk_f32 v80, v76, 0x41700000, v82
    v_fmamk_f32 v88, v84, 0x41700000, v90
    v_fmamk_f32 v80, v81, 0x41200000, v80
    v_fmamk_f32 v88, v89, 0x41200000, v88
    v_cvt_pk_bf16_f32 v5, v77, v85
    v_cvt_pk_bf16_f32 v9, v78, v86
    v_cvt_pk_bf16_f32 v65, v79, v87
    v_cvt_pk_bf16_f32 v69, v82, v90
    v_cvt_pk_bf16_f32 v73, v80, v88
    v_lshlrev_b32 v76, 16, v2
    v_and_b32 v84, s25, v2
    v_lshlrev_b32 v77, 16, v6
    v_and_b32 v85, s25, v6
    v_lshlrev_b32 v78, 16, v10
    v_and_b32 v86, s25, v10
    v_lshlrev_b32 v79, 16, v14
    v_and_b32 v87, s25, v14
    v_add_f32 v80, v76, v78
    v_add_f32 v88, v84, v86
    v_add_f32 v81, v77, v79
    v_add_f32 v89, v85, v87
    v_fma_f32 v82, v78, 4.0, v76
    v_fma_f32 v90, v86, 4.0, v84
    v_fma_f32 v83, v79, 4.0, v77
    v_fma_f32 v91, v87, 4.0, v85
    v_add_f32 v77, v80, v81
    v_add_f32 v85, v88, v89
    v_sub_f32 v78, v80, v81
    v_sub_f32 v86, v88, v89
    v_fma_f32 v79, v83, 2.0, v82
    v_fma_f32 v87, v91, 2.0, v90
    v_fma_f32 v82, v83, -2.0, v82
    v_fma_f32 v90, v91, -2.0, v90
    v_fmamk_f32 v80, v76, 0x41700000, v82
    v_fmamk_f32 v88, v84, 0x41700000, v90
    buffer_load_dwordx4 v[36:39], v93, s[8:11], s24 offen offset:0
    buffer_load_dwordx4 v[52:55], v93, s[8:11], s24 offen offset:64
    v_add_u32 v93, 128, v93
    v_fmamk_f32 v80, v81, 0x41200000, v80
    v_fmamk_f32 v88, v89, 0x41200000, v88
    v_cvt_pk_bf16_f32 v6, v77, v85
    v_cvt_pk_bf16_f32 v10, v78, v86
    v_cvt_pk_bf16_f32 v66, v79, v87
    v_cvt_pk_bf16_f32 v70, v82, v90
    v_cvt_pk_bf16_f32 v74, v80, v88
    v_lshlrev_b32 v76, 16, v3
    v_and_b32 v84, s25, v3
    v_lshlrev_b32 v77, 16, v7
    v_and_b32 v85, s25, v7
    v_lshlrev_b32 v78, 16, v11
    v_and_b32 v86, s25, v11
    v_lshlrev_b32 v79, 16, v15
    v_and_b32 v87, s25, v15
    v_add_f32 v80, v76, v78
    v_add_f32 v88, v84, v86
    v_add_f32 v81, v77, v79
    v_add_f32 v89, v85, v87
    v_fma_f32 v82, v78, 4.0, v76
    v_fma_f32 v90, v86, 4.0, v84
    v_fma_f32 v83, v79, 4.0, v77
    v_fma_f32 v91, v87, 4.0, v85
    v_add_f32 v77, v80, v81
    v_add_f32 v85, v88, v89
    v_sub_f32 v78, v80, v81
    v_sub_f32 v86, v88, v89
    v_fma_f32 v79, v83, 2.0, v82
    v_fma_f32 v87, v91, 2.0, v90
    v_fma_f32 v82, v83, -2.0, v82
    v_fma_f32 v90, v91, -2.0, v90
    v_fmamk_f32 v80, v76, 0x41700000, v82
    v_fmamk_f32 v88, v84, 0x41700000, v90
    v_fmamk_f32 v80, v81, 0x41200000, v80
    v_fmamk_f32 v88, v89, 0x41200000, v88
    v_cvt_pk_bf16_f32 v7, v77, v85
    v_cvt_pk_bf16_f32 v11, v78, v86
    v_cvt_pk_bf16_f32 v67, v79, v87
    v_cvt_pk_bf16_f32 v71, v82, v90
    v_cvt_pk_bf16_f32 v75, v80, v88
    ds_write_b128 v96, v[64:67] offset:49152
    ds_write_b128 v97, v[68:71] offset:0
    ds_write_b128 v97, v[72:75] offset:16384
    ds_write_b128 v96, v[0:3] offset:0
    ds_write_b128 v96, v[4:7] offset:16384
    ds_write_b128 v96, v[8:11] offset:32768
    ds_write_b128 v98, v[12:15] offset:0
    s_add_u32 s28, s28, 1
    s_waitcnt lgkmcnt(0)
    s_barrier
    s_sub_u32 s22, s22, 1
    s_branch L_conv1_kernel_hloop1
L_conv1_kernel_hlast1:
    s_branch L_conv1_kernel_end
L_conv1_kernel_h2:
    ds_write_b128 v96, v[0:3] offset:0
    ds_write_b128 v98, v[12:15] offset:0
    v_lshlrev_b32 v76, 16, v0
    v_and_b32 v84, s25, v0
    v_lshlrev_b32 v77, 16, v4
    v_and_b32 v85, s25, v4
    v_lshlrev_b32 v78, 16, v8
    v_and_b32 v86, s25, v8
    v_lshlrev_b32 v79, 16, v12
    v_and_b32 v87, s25, v12
    v_add_f32 v80, v76, v78
    v_add_f32 v88, v84, v86
    v_add_f32 v81, v77, v79
    v_add_f32 v89, v85, v87
    v_fma_f32 v82, v78, 4.0, v76
    v_fma_f32 v90, v86, 4.0, v84
    v_fma_f32 v83, v79, 4.0, v77
    v_fma_f32 v91, v87, 4.0, v85
    v_add_f32 v77, v80, v81
    v_add_f32 v85, v88, v89
    v_sub_f32 v78, v80, v81
    v_sub_f32 v86, v88, v89
    v_fma_f32 v79, v83, 2.0, v82
    v_fma_f32 v87, v91, 2.0, v90
    v_fma_f32 v82, v83, -2.0, v82
    v_fma_f32 v90, v91, -2.0, v90
    v_fmamk_f32 v80, v76, 0x41700000, v82
    v_fmamk_f32 v88, v84, 0x41700000, v90
    v_fmamk_f32 v80, v81, 0x41200000, v80
    v_fmamk_f32 v88, v89, 0x41200000, v88
    v_cvt_pk_bf16_f32 v4, v77, v85
    v_cvt_pk_bf16_f32 v8, v78, v86
    v_cvt_pk_bf16_f32 v64, v79, v87
    v_cvt_pk_bf16_f32 v68, v82, v90
    v_cvt_pk_bf16_f32 v72, v80, v88
    v_lshlrev_b32 v76, 16, v1
    v_and_b32 v84, s25, v1
    v_lshlrev_b32 v77, 16, v5
    v_and_b32 v85, s25, v5
    v_lshlrev_b32 v78, 16, v9
    v_and_b32 v86, s25, v9
    v_lshlrev_b32 v79, 16, v13
    v_and_b32 v87, s25, v13
    v_add_f32 v80, v76, v78
    v_add_f32 v88, v84, v86
    v_add_f32 v81, v77, v79
    v_add_f32 v89, v85, v87
    v_fma_f32 v82, v78, 4.0, v76
    v_fma_f32 v90, v86, 4.0, v84
    v_fma_f32 v83, v79, 4.0, v77
    v_fma_f32 v91, v87, 4.0, v85
    v_add_f32 v77, v80, v81
    v_add_f32 v85, v88, v89
    v_sub_f32 v78, v80, v81
    v_sub_f32 v86, v88, v89
    v_fma_f32 v79, v83, 2.0, v82
    v_fma_f32 v87, v91, 2.0, v90
    v_fma_f32 v82, v83, -2.0, v82
    v_fma_f32 v90, v91, -2.0, v90
    v_fmamk_f32 v80, v76, 0x41700000, v82
    v_fmamk_f32 v88, v84, 0x41700000, v90
    v_fmamk_f32 v80, v81, 0x41200000, v80
    v_fmamk_f32 v88, v89, 0x41200000, v88
    v_cvt_pk_bf16_f32 v5, v77, v85
    v_cvt_pk_bf16_f32 v9, v78, v86
    v_cvt_pk_bf16_f32 v65, v79, v87
    v_cvt_pk_bf16_f32 v69, v82, v90
    v_cvt_pk_bf16_f32 v73, v80, v88
    v_lshlrev_b32 v76, 16, v2
    v_and_b32 v84, s25, v2
    v_lshlrev_b32 v77, 16, v6
    v_and_b32 v85, s25, v6
    v_lshlrev_b32 v78, 16, v10
    v_and_b32 v86, s25, v10
    v_lshlrev_b32 v79, 16, v14
    v_and_b32 v87, s25, v14
    v_add_f32 v80, v76, v78
    v_add_f32 v88, v84, v86
    v_add_f32 v81, v77, v79
    v_add_f32 v89, v85, v87
    v_fma_f32 v82, v78, 4.0, v76
    v_fma_f32 v90, v86, 4.0, v84
    v_fma_f32 v83, v79, 4.0, v77
    v_fma_f32 v91, v87, 4.0, v85
    v_add_f32 v77, v80, v81
    v_add_f32 v85, v88, v89
    v_sub_f32 v78, v80, v81
    v_sub_f32 v86, v88, v89
    v_fma_f32 v79, v83, 2.0, v82
    v_fma_f32 v87, v91, 2.0, v90
    v_fma_f32 v82, v83, -2.0, v82
    v_fma_f32 v90, v91, -2.0, v90
    v_fmamk_f32 v80, v76, 0x41700000, v82
    v_fmamk_f32 v88, v84, 0x41700000, v90
    v_fmamk_f32 v80, v81, 0x41200000, v80
    v_fmamk_f32 v88, v89, 0x41200000, v88
    v_cvt_pk_bf16_f32 v6, v77, v85
    v_cvt_pk_bf16_f32 v10, v78, v86
    v_cvt_pk_bf16_f32 v66, v79, v87
    v_cvt_pk_bf16_f32 v70, v82, v90
    v_cvt_pk_bf16_f32 v74, v80, v88
    v_lshlrev_b32 v76, 16, v3
    v_and_b32 v84, s25, v3
    v_lshlrev_b32 v77, 16, v7
    v_and_b32 v85, s25, v7
    v_lshlrev_b32 v78, 16, v11
    v_and_b32 v86, s25, v11
    v_lshlrev_b32 v79, 16, v15
    v_and_b32 v87, s25, v15
    v_add_f32 v80, v76, v78
    v_add_f32 v88, v84, v86
    v_add_f32 v81, v77, v79
    v_add_f32 v89, v85, v87
    v_fma_f32 v82, v78, 4.0, v76
    v_fma_f32 v90, v86, 4.0, v84
    v_fma_f32 v83, v79, 4.0, v77
    v_fma_f32 v91, v87, 4.0, v85
    v_add_f32 v77, v80, v81
    v_add_f32 v85, v88, v89
    v_sub_f32 v78, v80, v81
    v_sub_f32 v86, v88, v89
    v_fma_f32 v79, v83, 2.0, v82
    v_fma_f32 v87, v91, 2.0, v90
    v_fma_f32 v82, v83, -2.0, v82
    v_fma_f32 v90, v91, -2.0, v90
    v_fmamk_f32 v80, v76, 0x41700000, v82
    v_fmamk_f32 v88, v84, 0x41700000, v90
    v_fmamk_f32 v80, v81, 0x41200000, v80
    v_fmamk_f32 v88, v89, 0x41200000, v88
    v_cvt_pk_bf16_f32 v7, v77, v85
    v_cvt_pk_bf16_f32 v11, v78, v86
    v_cvt_pk_bf16_f32 v67, v79, v87
    v_cvt_pk_bf16_f32 v71, v82, v90
    v_cvt_pk_bf16_f32 v75, v80, v88
    ds_write_b128 v96, v[64:67] offset:49152
    ds_write_b128 v97, v[68:71] offset:0
    ds_write_b128 v97, v[72:75] offset:16384
    ds_write_b128 v96, v[4:7] offset:16384
    ds_write_b128 v96, v[8:11] offset:32768
    s_waitcnt vmcnt(0)
    buffer_load_dwordx4 v[32:35], v92, s[8:11], s24 offen offset:0
    buffer_load_dwordx4 v[48:51], v92, s[8:11], s24 offen offset:64
    v_add_u32 v92, 128, v92
    buffer_load_dwordx4 v[36:39], v93, s[8:11], s24 offen offset:0
    buffer_load_dwordx4 v[52:55], v93, s[8:11], s24 offen offset:64
    v_add_u32 v93, 128, v93
    buffer_load_dwordx4 v[40:43], v94, s[8:11], s24 offen offset:0
    buffer_load_dwordx4 v[56:59], v94, s[8:11], s24 offen offset:64
    v_add_u32 v94, 128, v94
    buffer_load_dwordx4 v[44:47], v95, s[8:11], s24 offen offset:0
    buffer_load_dwordx4 v[60:63], v95, s[8:11], s24 offen offset:64
    v_add_u32 v95, 128, v95
    s_waitcnt lgkmcnt(0)
    s_barrier
    s_setprio 0
    v_lshlrev_b32 v76, 16, v16
    v_and_b32 v84, s25, v16
    v_lshlrev_b32 v77, 16, v20
    v_and_b32 v85, s25, v20
    v_lshlrev_b32 v78, 16, v24
    v_and_b32 v86, s25, v24
    v_lshlrev_b32 v79, 16, v28
    v_and_b32 v87, s25, v28
    v_add_f32 v80, v76, v78
    v_add_f32 v88, v84, v86
    v_add_f32 v81, v77, v79
    v_add_f32 v89, v85, v87
    v_fma_f32 v82, v78, 4.0, v76
    v_fma_f32 v90, v86, 4.0, v84
    v_fma_f32 v83, v79, 4.0, v77
    v_fma_f32 v91, v87, 4.0, v85
    v_add_f32 v77, v80, v81
    v_add_f32 v85, v88, v89
    v_sub_f32 v78, v80, v81
    v_sub_f32 v86, v88, v89
    v_fma_f32 v79, v83, 2.0, v82
    v_fma_f32 v87, v91, 2.0, v90
    v_fma_f32 v82, v83, -2.0, v82
    v_fma_f32 v90, v91, -2.0, v90
    v_fmamk_f32 v80, v76, 0x41700000, v82
    v_fmamk_f32 v88, v84, 0x41700000, v90
    v_fmamk_f32 v80, v81, 0x41200000, v80
    v_fmamk_f32 v88, v89, 0x41200000, v88
    v_cvt_pk_bf16_f32 v20, v77, v85
    v_cvt_pk_bf16_f32 v24, v78, v86
    v_cvt_pk_bf16_f32 v64, v79, v87
    v_cvt_pk_bf16_f32 v68, v82, v90
    v_cvt_pk_bf16_f32 v72, v80, v88
    v_lshlrev_b32 v76, 16, v17
    v_and_b32 v84, s25, v17
    v_lshlrev_b32 v77, 16, v21
    v_and_b32 v85, s25, v21
    v_lshlrev_b32 v78, 16, v25
    v_and_b32 v86, s25, v25
    v_lshlrev_b32 v79, 16, v29
    v_and_b32 v87, s25, v29
    v_add_f32 v80, v76, v78
    v_add_f32 v88, v84, v86
    v_add_f32 v81, v77, v79
    v_add_f32 v89, v85, v87
    v_fma_f32 v82, v78, 4.0, v76
    v_fma_f32 v90, v86, 4.0, v84
    v_fma_f32 v83, v79, 4.0, v77
    v_fma_f32 v91, v87, 4.0, v85
    v_add_f32 v77, v80, v81
    v_add_f32 v85, v88, v89
    v_sub_f32 v78, v80, v81
    v_sub_f32 v86, v88, v89
    v_fma_f32 v79, v83, 2.0, v82
    v_fma_f32 v87, v91, 2.0, v90
    v_fma_f32 v82, v83, -2.0, v82
    v_fma_f32 v90, v91, -2.0, v90
    v_fmamk_f32 v80, v76, 0x41700000, v82
    v_fmamk_f32 v88, v84, 0x41700000, v90
    v_fmamk_f32 v80, v81, 0x41200000, v80
    v_fmamk_f32 v88, v89, 0x41200000, v88
    v_cvt_pk_bf16_f32 v21, v77, v85
    v_cvt_pk_bf16_f32 v25, v78, v86
    v_cvt_pk_bf16_f32 v65, v79, v87
    v_cvt_pk_bf16_f32 v69, v82, v90
    v_cvt_pk_bf16_f32 v73, v80, v88
    v_lshlrev_b32 v76, 16, v18
    v_and_b32 v84, s25, v18
    v_lshlrev_b32 v77, 16, v22
    v_and_b32 v85, s25, v22
    v_lshlrev_b32 v78, 16, v26
    v_and_b32 v86, s25, v26
    v_lshlrev_b32 v79, 16, v30
    v_and_b32 v87, s25, v30
    v_add_f32 v80, v76, v78
    v_add_f32 v88, v84, v86
    v_add_f32 v81, v77, v79
    v_add_f32 v89, v85, v87
    v_fma_f32 v82, v78, 4.0, v76
    v_fma_f32 v90, v86, 4.0, v84
    v_fma_f32 v83, v79, 4.0, v77
    v_fma_f32 v91, v87, 4.0, v85
    v_add_f32 v77, v80, v81
    v_add_f32 v85, v88, v89
    v_sub_f32 v78, v80, v81
    v_sub_f32 v86, v88, v89
    v_fma_f32 v79, v83, 2.0, v82
    v_fma_f32 v87, v91, 2.0, v90
    v_fma_f32 v82, v83, -2.0, v82
    v_fma_f32 v90, v91, -2.0, v90
    v_fmamk_f32 v80, v76, 0x41700000, v82
    v_fmamk_f32 v88, v84, 0x41700000, v90
    v_fmamk_f32 v80, v81, 0x41200000, v80
    v_fmamk_f32 v88, v89, 0x41200000, v88
    v_cvt_pk_bf16_f32 v22, v77, v85
    v_cvt_pk_bf16_f32 v26, v78, v86
    v_cvt_pk_bf16_f32 v66, v79, v87
    v_cvt_pk_bf16_f32 v70, v82, v90
    v_cvt_pk_bf16_f32 v74, v80, v88
    v_lshlrev_b32 v76, 16, v19
    v_and_b32 v84, s25, v19
    v_lshlrev_b32 v77, 16, v23
    v_and_b32 v85, s25, v23
    v_lshlrev_b32 v78, 16, v27
    v_and_b32 v86, s25, v27
    v_lshlrev_b32 v79, 16, v31
    v_and_b32 v87, s25, v31
    v_add_f32 v80, v76, v78
    v_add_f32 v88, v84, v86
    v_add_f32 v81, v77, v79
    v_add_f32 v89, v85, v87
    v_fma_f32 v82, v78, 4.0, v76
    v_fma_f32 v90, v86, 4.0, v84
    v_fma_f32 v83, v79, 4.0, v77
    v_fma_f32 v91, v87, 4.0, v85
    v_add_f32 v77, v80, v81
    v_add_f32 v85, v88, v89
    v_sub_f32 v78, v80, v81
    v_sub_f32 v86, v88, v89
    v_fma_f32 v79, v83, 2.0, v82
    v_fma_f32 v87, v91, 2.0, v90
    v_fma_f32 v82, v83, -2.0, v82
    v_fma_f32 v90, v91, -2.0, v90
    v_fmamk_f32 v80, v76, 0x41700000, v82
    v_fmamk_f32 v88, v84, 0x41700000, v90
    v_fmamk_f32 v80, v81, 0x41200000, v80
    v_fmamk_f32 v88, v89, 0x41200000, v88
    v_cvt_pk_bf16_f32 v23, v77, v85
    v_cvt_pk_bf16_f32 v27, v78, v86
    v_cvt_pk_bf16_f32 v67, v79, v87
    v_cvt_pk_bf16_f32 v71, v82, v90
    v_cvt_pk_bf16_f32 v75, v80, v88
L_conv1_kernel_hloop2:
    s_cmp_lt_u32 s28, 12
    s_cselect_b32 s24, 0, 2130706432
    ds_write_b128 v96, v[64:67] offset:57344
    ds_write_b128 v97, v[68:71] offset:8192
    ds_write_b128 v97, v[72:75] offset:24576
    ds_write_b128 v96, v[16:19] offset:8192
    ds_write_b128 v96, v[20:23] offset:24576
    ds_write_b128 v96, v[24:27] offset:40960
    ds_write_b128 v98, v[28:31] offset:8704
    s_waitcnt vmcnt(0)
    v_lshlrev_b32 v76, 16, v32
    v_and_b32 v84, s25, v32
    v_lshlrev_b32 v77, 16, v36
    v_and_b32 v85, s25, v36
    v_lshlrev_b32 v78, 16, v40
    v_and_b32 v86, s25, v40
    v_lshlrev_b32 v79, 16, v44
    v_and_b32 v87, s25, v44
    v_add_f32 v80, v76, v78
    v_add_f32 v88, v84, v86
    v_add_f32 v81, v77, v79
    v_add_f32 v89, v85, v87
    v_fma_f32 v82, v78, 4.0, v76
    v_fma_f32 v90, v86, 4.0, v84
    v_fma_f32 v83, v79, 4.0, v77
    v_fma_f32 v91, v87, 4.0, v85
    v_add_f32 v77, v80, v81
    v_add_f32 v85, v88, v89
    v_sub_f32 v78, v80, v81
    v_sub_f32 v86, v88, v89
    v_fma_f32 v79, v83, 2.0, v82
    v_fma_f32 v87, v91, 2.0, v90
    v_fma_f32 v82, v83, -2.0, v82
    v_fma_f32 v90, v91, -2.0, v90
    v_fmamk_f32 v80, v76, 0x41700000, v82
    v_fmamk_f32 v88, v84, 0x41700000, v90
    buffer_load_dwordx4 v[0:3], v92, s[8:11], s24 offen offset:0
    buffer_load_dwordx4 v[16:19], v92, s[8:11], s24 offen offset:64
    v_add_u32 v92, 128, v92
    v_fmamk_f32 v80, v81, 0x41200000, v80
    v_fmamk_f32 v88, v89, 0x41200000, v88
    v_cvt_pk_bf16_f32 v36, v77, v85
    v_cvt_pk_bf16_f32 v40, v78, v86
    v_cvt_pk_bf16_f32 v64, v79, v87
    v_cvt_pk_bf16_f32 v68, v82, v90
    v_cvt_pk_bf16_f32 v72, v80, v88
    v_lshlrev_b32 v76, 16, v33
    v_and_b32 v84, s25, v33
    v_lshlrev_b32 v77, 16, v37
    v_and_b32 v85, s25, v37
    v_lshlrev_b32 v78, 16, v41
    v_and_b32 v86, s25, v41
    v_lshlrev_b32 v79, 16, v45
    v_and_b32 v87, s25, v45
    v_add_f32 v80, v76, v78
    v_add_f32 v88, v84, v86
    v_add_f32 v81, v77, v79
    v_add_f32 v89, v85, v87
    v_fma_f32 v82, v78, 4.0, v76
    v_fma_f32 v90, v86, 4.0, v84
    v_fma_f32 v83, v79, 4.0, v77
    v_fma_f32 v91, v87, 4.0, v85
    v_add_f32 v77, v80, v81
    v_add_f32 v85, v88, v89
    v_sub_f32 v78, v80, v81
    v_sub_f32 v86, v88, v89
    v_fma_f32 v79, v83, 2.0, v82
    v_fma_f32 v87, v91, 2.0, v90
    v_fma_f32 v82, v83, -2.0, v82
    v_fma_f32 v90, v91, -2.0, v90
    v_fmamk_f32 v80, v76, 0x41700000, v82
    v_fmamk_f32 v88, v84, 0x41700000, v90
    v_fmamk_f32 v80, v81, 0x41200000, v80
    v_fmamk_f32 v88, v89, 0x41200000, v88
    v_cvt_pk_bf16_f32 v37, v77, v85
    v_cvt_pk_bf16_f32 v41, v78, v86
    v_cvt_pk_bf16_f32 v65, v79, v87
    v_cvt_pk_bf16_f32 v69, v82, v90
    v_cvt_pk_bf16_f32 v73, v80, v88
    v_lshlrev_b32 v76, 16, v34
    v_and_b32 v84, s25, v34
    v_lshlrev_b32 v77, 16, v38
    v_and_b32 v85, s25, v38
    v_lshlrev_b32 v78, 16, v42
    v_and_b32 v86, s25, v42
    v_lshlrev_b32 v79, 16, v46
    v_and_b32 v87, s25, v46
    v_add_f32 v80, v76, v78
    v_add_f32 v88, v84, v86
    v_add_f32 v81, v77, v79
    v_add_f32 v89, v85, v87
    v_fma_f32 v82, v78, 4.0, v76
    buffer_load_dwordx4 v[4:7], v93, s[8:11], s24 offen offset:0
    buffer_load_dwordx4 v[20:23], v93, s[8:11], s24 offen offset:64
    v_add_u32 v93, 128, v93
    v_fma_f32 v90, v86, 4.0, v84
    v_fma_f32 v83, v79, 4.0, v77
    v_fma_f32 v91, v87, 4.0, v85
    v_add_f32 v77, v80, v81
    v_add_f32 v85, v88, v89
    v_sub_f32 v78, v80, v81
    v_sub_f32 v86, v88, v89
    v_fma_f32 v79, v83, 2.0, v82
    v_fma_f32 v87, v91, 2.0, v90
    v_fma_f32 v82, v83, -2.0, v82
    v_fma_f32 v90, v91, -2.0, v90
    v_fmamk_f32 v80, v76, 0x41700000, v82
    v_fmamk_f32 v88, v84, 0x41700000, v90
    v_fmamk_f32 v80, v81, 0x41200000, v80
    v_fmamk_f32 v88, v89, 0x41200000, v88
    v_cvt_pk_bf16_f32 v38, v77, v85
    v_cvt_pk_bf16_f32 v42, v78, v86
    v_cvt_pk_bf16_f32 v66, v79, v87
    v_cvt_pk_bf16_f32 v70, v82, v90
    v_cvt_pk_bf16_f32 v74, v80, v88
    v_lshlrev_b32 v76, 16, v35
    v_and_b32 v84, s25, v35
    v_lshlrev_b32 v77, 16, v39
    v_and_b32 v85, s25, v39
    v_lshlrev_b32 v78, 16, v43
    v_and_b32 v86, s25, v43
    v_lshlrev_b32 v79, 16, v47
    v_and_b32 v87, s25, v47
    v_add_f32 v80, v76, v78
    v_add_f32 v88, v84, v86
    v_add_f32 v81, v77, v79
    v_add_f32 v89, v85, v87
    v_fma_f32 v82, v78, 4.0, v76
    v_fma_f32 v90, v86, 4.0, v84
    v_fma_f32 v83, v79, 4.0, v77
    v_fma_f32 v91, v87, 4.0, v85
    v_add_f32 v77, v80, v81
    v_add_f32 v85, v88, v89
    v_sub_f32 v78, v80, v81
    v_sub_f32 v86, v88, v89
    v_fma_f32 v79, v83, 2.0, v82
    v_fma_f32 v87, v91, 2.0, v90
    v_fma_f32 v82, v83, -2.0, v82
    v_fma_f32 v90, v91, -2.0, v90
    v_fmamk_f32 v80, v76, 0x41700000, v82
    v_fmamk_f32 v88, v84, 0x41700000, v90
    v_fmamk_f32 v80, v81, 0x41200000, v80
    v_fmamk_f32 v88, v89, 0x41200000, v88
    v_cvt_pk_bf16_f32 v39, v77, v85
    v_cvt_pk_bf16_f32 v43, v78, v86
    v_cvt_pk_bf16_f32 v67, v79, v87
    v_cvt_pk_bf16_f32 v71, v82, v90
    v_cvt_pk_bf16_f32 v75, v80, v88
    s_add_u32 s28, s28, 1
    s_waitcnt lgkmcnt(0)
    s_barrier
    s_cmp_lt_u32 s28, 12
    s_cselect_b32 s24, 0, 2130706432
    ds_write_b128 v96, v[64:67] offset:49152
    ds_write_b128 v97, v[68:71] offset:0
    ds_write_b128 v97, v[72:75] offset:16384
    ds_write_b128 v96, v[32:35] offset:0
    ds_write_b128 v96, v[36:39] offset:16384
    ds_write_b128 v96, v[40:43] offset:32768
    ds_write_b128 v98, v[44:47] offset:0
    v_lshlrev_b32 v76, 16, v48
    v_and_b32 v84, s25, v48
    buffer_load_dwordx4 v[8:11], v94, s[8:11], s24 offen offset:0
    buffer_load_dwordx4 v[24:27], v94, s[8:11], s24 offen offset:64
    v_add_u32 v94, 128, v94
    v_lshlrev_b32 v77, 16, v52
    v_and_b32 v85, s25, v52
    v_lshlrev_b32 v78, 16, v56
    v_and_b32 v86, s25, v56
    v_lshlrev_b32 v79, 16, v60
    v_and_b32 v87, s25, v60
    v_add_f32 v80, v76, v78
    v_add_f32 v88, v84, v86
    v_add_f32 v81, v77, v79
    v_add_f32 v89, v85, v87
    v_fma_f32 v82, v78, 4.0, v76
    v_fma_f32 v90, v86, 4.0, v84
    v_fma_f32 v83, v79, 4.0, v77
    v_fma_f32 v91, v87, 4.0, v85
    v_add_f32 v77, v80, v81
    v_add_f32 v85, v88, v89
    v_sub_f32 v78, v80, v81
    buffer_load_dwordx4 v[12:15], v95, s[8:11], s24 offen offset:0
    buffer_load_dwordx4 v[28:31], v95, s[8:11], s24 offen offset:64
    v_add_u32 v95, 128, v95
    v_sub_f32 v86, v88, v89
    v_fma_f32 v79, v83, 2.0, v82
    v_fma_f32 v87, v91, 2.0, v90
    v_fma_f32 v82, v83, -2.0, v82
    v_fma_f32 v90, v91, -2.0, v90
    v_fmamk_f32 v80, v76, 0x41700000, v82
    v_fmamk_f32 v88, v84, 0x41700000, v90
    v_fmamk_f32 v80, v81, 0x41200000, v80
    v_fmamk_f32 v88, v89, 0x41200000, v88
    v_cvt_pk_bf16_f32 v52, v77, v85
    v_cvt_pk_bf16_f32 v56, v78, v86
    v_cvt_pk_bf16_f32 v64, v79, v87
    v_cvt_pk_bf16_f32 v68, v82, v90
    v_cvt_pk_bf16_f32 v72, v80, v88
    v_lshlrev_b32 v76, 16, v49
    v_and_b32 v84, s25, v49
    v_lshlrev_b32 v77, 16, v53
    v_and_b32 v85, s25, v53
    v_lshlrev_b32 v78, 16, v57
    v_and_b32 v86, s25, v57
    v_lshlrev_b32 v79, 16, v61
    v_and_b32 v87, s25, v61
    v_add_f32 v80, v76, v78
    v_add_f32 v88, v84, v86
    v_add_f32 v81, v77, v79
    v_add_f32 v89, v85, v87
    v_fma_f32 v82, v78, 4.0, v76
    v_fma_f32 v90, v86, 4.0, v84
    v_fma_f32 v83, v79, 4.0, v77
    v_fma_f32 v91, v87, 4.0, v85
    v_add_f32 v77, v80, v81
    v_add_f32 v85, v88, v89
    v_sub_f32 v78, v80, v81
    v_sub_f32 v86, v88, v89
    v_fma_f32 v79, v83, 2.0, v82
    v_fma_f32 v87, v91, 2.0, v90
    v_fma_f32 v82, v83, -2.0, v82
    v_fma_f32 v90, v91, -2.0, v90
    v_fmamk_f32 v80, v76, 0x41700000, v82
    v_fmamk_f32 v88, v84, 0x41700000, v90
    v_fmamk_f32 v80, v81, 0x41200000, v80
    v_fmamk_f32 v88, v89, 0x41200000, v88
    v_cvt_pk_bf16_f32 v53, v77, v85
    v_cvt_pk_bf16_f32 v57, v78, v86
    v_cvt_pk_bf16_f32 v65, v79, v87
    v_cvt_pk_bf16_f32 v69, v82, v90
    v_cvt_pk_bf16_f32 v73, v80, v88
    v_lshlrev_b32 v76, 16, v50
    v_and_b32 v84, s25, v50
    v_lshlrev_b32 v77, 16, v54
    v_and_b32 v85, s25, v54
    v_lshlrev_b32 v78, 16, v58
    v_and_b32 v86, s25, v58
    v_lshlrev_b32 v79, 16, v62
    v_and_b32 v87, s25, v62
    v_add_f32 v80, v76, v78
    v_add_f32 v88, v84, v86
    v_add_f32 v81, v77, v79
    v_add_f32 v89, v85, v87
    v_fma_f32 v82, v78, 4.0, v76
    v_fma_f32 v90, v86, 4.0, v84
    v_fma_f32 v83, v79, 4.0, v77
    v_fma_f32 v91, v87, 4.0, v85
    v_add_f32 v77, v80, v81
    v_add_f32 v85, v88, v89
    v_sub_f32 v78, v80, v81
    v_sub_f32 v86, v88, v89
    v_fma_f32 v79, v83, 2.0, v82
    v_fma_f32 v87, v91, 2.0, v90
    v_fma_f32 v82, v83, -2.0, v82
    v_fma_f32 v90, v91, -2.0, v90
    v_fmamk_f32 v80, v76, 0x41700000, v82
    v_fmamk_f32 v88, v84, 0x41700000, v90
    v_fmamk_f32 v80, v81, 0x41200000, v80
    v_fmamk_f32 v88, v89, 0x41200000, v88
    v_cvt_pk_bf16_f32 v54, v77, v85
    v_cvt_pk_bf16_f32 v58, v78, v86
    v_cvt_pk_bf16_f32 v66, v79, v87
    v_cvt_pk_bf16_f32 v70, v82, v90
    v_cvt_pk_bf16_f32 v74, v80, v88
    v_lshlrev_b32 v76, 16, v51
    v_and_b32 v84, s25, v51
    v_lshlrev_b32 v77, 16, v55
    v_and_b32 v85, s25, v55
    v_lshlrev_b32 v78, 16, v59
    v_and_b32 v86, s25, v59
    v_lshlrev_b32 v79, 16, v63
    v_and_b32 v87, s25, v63
    v_add_f32 v80, v76, v78
    v_add_f32 v88, v84, v86
    v_add_f32 v81, v77, v79
    v_add_f32 v89, v85, v87
    v_fma_f32 v82, v78, 4.0, v76
    v_fma_f32 v90, v86, 4.0, v84
    v_fma_f32 v83, v79, 4.0, v77
    v_fma_f32 v91, v87, 4.0, v85
    v_add_f32 v77, v80, v81
    v_add_f32 v85, v88, v89
    v_sub_f32 v78, v80, v81
    v_sub_f32 v86, v88, v89
    v_fma_f32 v79, v83, 2.0, v82
    v_fma_f32 v87, v91, 2.0, v90
    v_fma_f32 v82, v83, -2.0, v82
    v_fma_f32 v90, v91, -2.0, v90
    v_fmamk_f32 v80, v76, 0x41700000, v82
    v_fmamk_f32 v88, v84, 0x41700000, v90
    v_fmamk_f32 v80, v81, 0x41200000, v80
    v_fmamk_f32 v88, v89, 0x41200000, v88
    v_cvt_pk_bf16_f32 v55, v77, v85
    v_cvt_pk_bf16_f32 v59, v78, v86
    v_cvt_pk_bf16_f32 v67, v79, v87
    v_cvt_pk_bf16_f32 v71, v82, v90
    v_cvt_pk_bf16_f32 v75, v80, v88
    s_add_u32 s28, s28, 1
    s_waitcnt lgkmcnt(0)
    s_barrier
    s_cmp_eq_u32 s22, 1
    s_cbranch_scc1 L_conv1_kernel_hlast2
    s_cmp_lt_u32 s28, 12
    s_cselect_b32 s24, 0, 2130706432
    ds_write_b128 v96, v[64:67] offset:57344
    ds_write_b128 v97, v[68:71] offset:8192
    ds_write_b128 v97, v[72:75] offset:24576
    ds_write_b128 v96, v[48:51] offset:8192
    ds_write_b128 v96, v[52:55] offset:24576
    ds_write_b128 v96, v[56:59] offset:40960
    ds_write_b128 v98, v[60:63] offset:8704
    s_waitcnt vmcnt(0)
    v_lshlrev_b32 v76, 16, v0
    v_and_b32 v84, s25, v0
    v_lshlrev_b32 v77, 16, v4
    v_and_b32 v85, s25, v4
    v_lshlrev_b32 v78, 16, v8
    v_and_b32 v86, s25, v8
    v_lshlrev_b32 v79, 16, v12
    v_and_b32 v87, s25, v12
    v_add_f32 v80, v76, v78
    v_add_f32 v88, v84, v86
    v_add_f32 v81, v77, v79
    v_add_f32 v89, v85, v87
    v_fma_f32 v82, v78, 4.0, v76
    v_fma_f32 v90, v86, 4.0, v84
    v_fma_f32 v83, v79, 4.0, v77
    v_fma_f32 v91, v87, 4.0, v85
    v_add_f32 v77, v80, v81
    v_add_f32 v85, v88, v89
    v_sub_f32 v78, v80, v81
    v_sub_f32 v86, v88, v89
    v_fma_f32 v79, v83, 2.0, v82
    v_fma_f32 v87, v91, 2.0, v90
    v_fma_f32 v82, v83, -2.0, v82
    v_fma_f32 v90, v91, -2.0, v90
    v_fmamk_f32 v80, v76, 0x41700000, v82
    v_fmamk_f32 v88, v84, 0x41700000, v90
    buffer_load_dwordx4 v[32:35], v92, s[8:11], s24 offen offset:0
    buffer_load_dwordx4 v[48:51], v92, s[8:11], s24 offen offset:64
    v_add_u32 v92, 128, v92
    v_fmamk_f32 v80, v81, 0x41200000, v80
    v_fmamk_f32 v88, v89, 0x41200000, v88
    v_cvt_pk_bf16_f32 v4, v77, v85
    v_cvt_pk_bf16_f32 v8, v78, v86
    v_cvt_pk_bf16_f32 v64, v79, v87
    v_cvt_pk_bf16_f32 v68, v82, v90
    v_cvt_pk_bf16_f32 v72, v80, v88
    v_lshlrev_b32 v76, 16, v1
    v_and_b32 v84, s25, v1
    v_lshlrev_b32 v77, 16, v5
    v_and_b32 v85, s25, v5
    v_lshlrev_b32 v78, 16, v9
    v_and_b32 v86, s25, v9
    v_lshlrev_b32 v79, 16, v13
    v_and_b32 v87, s25, v13
    v_add_f32 v80, v76, v78
    v_add_f32 v88, v84, v86
    v_add_f32 v81, v77, v79
    v_add_f32 v89, v85, v87
    v_fma_f32 v82, v78, 4.0, v76
    v_fma_f32 v90, v86, 4.0, v84
    v_fma_f32 v83, v79, 4.0, v77
    v_fma_f32 v91, v87, 4.0, v85
    v_add_f32 v77, v80, v81
    v_add_f32 v85, v88, v89
    v_sub_f32 v78, v80, v81
    v_sub_f32 v86, v88, v89
    v_fma_f32 v79, v83, 2.0, v82
    v_fma_f32 v87, v91, 2.0, v90
    v_fma_f32 v82, v83, -2.0, v82
    v_fma_f32 v90, v91, -2.0, v90
    v_fmamk_f32 v80, v76, 0x41700000, v82
    v_fmamk_f32 v88, v84, 0x41700000, v90
    v_fmamk_f32 v80, v81, 0x41200000, v80
    v_fmamk_f32 v88, v89, 0x41200000, v88
    v_cvt_pk_bf16_f32 v5, v77, v85
    v_cvt_pk_bf16_f32 v9, v78, v86
    v_cvt_pk_bf16_f32 v65, v79, v87
    v_cvt_pk_bf16_f32 v69, v82, v90
    v_cvt_pk_bf16_f32 v73, v80, v88
    v_lshlrev_b32 v76, 16, v2
    v_and_b32 v84, s25, v2
    v_lshlrev_b32 v77, 16, v6
    v_and_b32 v85, s25, v6
    v_lshlrev_b32 v78, 16, v10
    v_and_b32 v86, s25, v10
    v_lshlrev_b32 v79, 16, v14
    v_and_b32 v87, s25, v14
    v_add_f32 v80, v76, v78
    v_add_f32 v88, v84, v86
    v_add_f32 v81, v77, v79
    v_add_f32 v89, v85, v87
    v_fma_f32 v82, v78, 4.0, v76
    buffer_load_dwordx4 v[36:39], v93, s[8:11], s24 offen offset:0
    buffer_load_dwordx4 v[52:55], v93, s[8:11], s24 offen offset:64
    v_add_u32 v93, 128, v93
    v_fma_f32 v90, v86, 4.0, v84
    v_fma_f32 v83, v79, 4.0, v77
    v_fma_f32 v91, v87, 4.0, v85
    v_add_f32 v77, v80, v81
    v_add_f32 v85, v88, v89
    v_sub_f32 v78, v80, v81
    v_sub_f32 v86, v88, v89
    v_fma_f32 v79, v83, 2.0, v82
    v_fma_f32 v87, v91, 2.0, v90
    v_fma_f32 v82, v83, -2.0, v82
    v_fma_f32 v90, v91, -2.0, v90
    v_fmamk_f32 v80, v76, 0x41700000, v82
    v_fmamk_f32 v88, v84, 0x41700000, v90
    v_fmamk_f32 v80, v81, 0x41200000, v80
    v_fmamk_f32 v88, v89, 0x41200000, v88
    v_cvt_pk_bf16_f32 v6, v77, v85
    v_cvt_pk_bf16_f32 v10, v78, v86
    v_cvt_pk_bf16_f32 v66, v79, v87
    v_cvt_pk_bf16_f32 v70, v82, v90
    v_cvt_pk_bf16_f32 v74, v80, v88
    v_lshlrev_b32 v76, 16, v3
    v_and_b32 v84, s25, v3
    v_lshlrev_b32 v77, 16, v7
    v_and_b32 v85, s25, v7
    v_lshlrev_b32 v78, 16, v11
    v_and_b32 v86, s25, v11
    v_lshlrev_b32 v79, 16, v15
    v_and_b32 v87, s25, v15
    v_add_f32 v80, v76, v78
    v_add_f32 v88, v84, v86
    v_add_f32 v81, v77, v79
    v_add_f32 v89, v85, v87
    v_fma_f32 v82, v78, 4.0, v76
    v_fma_f32 v90, v86, 4.0, v84
    v_fma_f32 v83, v79, 4.0, v77
    v_fma_f32 v91, v87, 4.0, v85
    v_add_f32 v77, v80, v81
    v_add_f32 v85, v88, v89
    v_sub_f32 v78, v80, v81
    v_sub_f32 v86, v88, v89
    v_fma_f32 v79, v83, 2.0, v82
    v_fma_f32 v87, v91, 2.0, v90
    v_fma_f32 v82, v83, -2.0, v82
    v_fma_f32 v90, v91, -2.0, v90
    v_fmamk_f32 v80, v76, 0x41700000, v82
    v_fmamk_f32 v88, v84, 0x41700000, v90
    v_fmamk_f32 v80, v81, 0x41200000, v80
    v_fmamk_f32 v88, v89, 0x41200000, v88
    v_cvt_pk_bf16_f32 v7, v77, v85
    v_cvt_pk_bf16_f32 v11, v78, v86
    v_cvt_pk_bf16_f32 v67, v79, v87
    v_cvt_pk_bf16_f32 v71, v82, v90
    v_cvt_pk_bf16_f32 v75, v80, v88
    s_add_u32 s28, s28, 1
    s_waitcnt lgkmcnt(0)
    s_barrier
    s_cmp_lt_u32 s28, 12
    s_cselect_b32 s24, 0, 2130706432
    ds_write_b128 v96, v[64:67] offset:49152
    ds_write_b128 v97, v[68:71] offset:0
    ds_write_b128 v97, v[72:75] offset:16384
    ds_write_b128 v96, v[0:3] offset:0
    ds_write_b128 v96, v[4:7] offset:16384
    ds_write_b128 v96, v[8:11] offset:32768
    ds_write_b128 v98, v[12:15] offset:0
    v_lshlrev_b32 v76, 16, v16
    v_and_b32 v84, s25, v16
    buffer_load_dwordx4 v[40:43], v94, s[8:11], s24 offen offset:0
    buffer_load_dwordx4 v[56:59], v94, s[8:11], s24 offen offset:64
    v_add_u32 v94, 128, v94
    v_lshlrev_b32 v77, 16, v20
    v_and_b32 v85, s25, v20
    v_lshlrev_b32 v78, 16, v24
    v_and_b32 v86, s25, v24
    v_lshlrev_b32 v79, 16, v28
    v_and_b32 v87, s25, v28
    v_add_f32 v80, v76, v78
    v_add_f32 v88, v84, v86
    v_add_f32 v81, v77, v79
    v_add_f32 v89, v85, v87
    v_fma_f32 v82, v78, 4.0, v76
    v_fma_f32 v90, v86, 4.0, v84
    v_fma_f32 v83, v79, 4.0, v77
    v_fma_f32 v91, v87, 4.0, v85
    v_add_f32 v77, v80, v81
    v_add_f32 v85, v88, v89
    v_sub_f32 v78, v80, v81
    buffer_load_dwordx4 v[44:47], v95, s[8:11], s24 offen offset:0
    buffer_load_dwordx4 v[60:63], v95, s[8:11], s24 offen offset:64
    v_add_u32 v95, 128, v95
    v_sub_f32 v86, v88, v89
    v_fma_f32 v79, v83, 2.0, v82
    v_fma_f32 v87, v91, 2.0, v90
    v_fma_f32 v82, v83, -2.0, v82
    v_fma_f32 v90, v91, -2.0, v90
    v_fmamk_f32 v80, v76, 0x41700000, v82
    v_fmamk_f32 v88, v84, 0x41700000, v90
    v_fmamk_f32 v80, v81, 0x41200000, v80
    v_fmamk_f32 v88, v89, 0x41200000, v88
    v_cvt_pk_bf16_f32 v20, v77, v85
    v_cvt_pk_bf16_f32 v24, v78, v86
    v_cvt_pk_bf16_f32 v64, v79, v87
    v_cvt_pk_bf16_f32 v68, v82, v90
    v_cvt_pk_bf16_f32 v72, v80, v88
    v_lshlrev_b32 v76, 16, v17
    v_and_b32 v84, s25, v17
    v_lshlrev_b32 v77, 16, v21
    v_and_b32 v85, s25, v21
    v_lshlrev_b32 v78, 16, v25
    v_and_b32 v86, s25, v25
    v_lshlrev_b32 v79, 16, v29
    v_and_b32 v87, s25, v29
    v_add_f32 v80, v76, v78
    v_add_f32 v88, v84, v86
    v_add_f32 v81, v77, v79
    v_add_f32 v89, v85, v87
    v_fma_f32 v82, v78, 4.0, v76
    v_fma_f32 v90, v86, 4.0, v84
    v_fma_f32 v83, v79, 4.0, v77
    v_fma_f32 v91, v87, 4.0, v85
    v_add_f32 v77, v80, v81
    v_add_f32 v85, v88, v89
    v_sub_f32 v78, v80, v81
    v_sub_f32 v86, v88, v89
    v_fma_f32 v79, v83, 2.0, v82
    v_fma_f32 v87, v91, 2.0, v90
    v_fma_f32 v82, v83, -2.0, v82
    v_fma_f32 v90, v91, -2.0, v90
    v_fmamk_f32 v80, v76, 0x41700000, v82
    v_fmamk_f32 v88, v84, 0x41700000, v90
    v_fmamk_f32 v80, v81, 0x41200000, v80
    v_fmamk_f32 v88, v89, 0x41200000, v88
    v_cvt_pk_bf16_f32 v21, v77, v85
    v_cvt_pk_bf16_f32 v25, v78, v86
    v_cvt_pk_bf16_f32 v65, v79, v87
    v_cvt_pk_bf16_f32 v69, v82, v90
    v_cvt_pk_bf16_f32 v73, v80, v88
    v_lshlrev_b32 v76, 16, v18
    v_and_b32 v84, s25, v18
    v_lshlrev_b32 v77, 16, v22
    v_and_b32 v85, s25, v22
    v_lshlrev_b32 v78, 16, v26
    v_and_b32 v86, s25, v26
    v_lshlrev_b32 v79, 16, v30
    v_and_b32 v87, s25, v30
    v_add_f32 v80, v76, v78
    v_add_f32 v88, v84, v86
    v_add_f32 v81, v77, v79
    v_add_f32 v89, v85, v87
    v_fma_f32 v82, v78, 4.0, v76
    v_fma_f32 v90, v86, 4.0, v84
    v_fma_f32 v83, v79, 4.0, v77
    v_fma_f32 v91, v87, 4.0, v85
    v_add_f32 v77, v80, v81
    v_add_f32 v85, v88, v89
    v_sub_f32 v78, v80, v81
    v_sub_f32 v86, v88, v89
    v_fma_f32 v79, v83, 2.0, v82
    v_fma_f32 v87, v91, 2.0, v90
    v_fma_f32 v82, v83, -2.0, v82
    v_fma_f32 v90, v91, -2.0, v90
    v_fmamk_f32 v80, v76, 0x41700000, v82
    v_fmamk_f32 v88, v84, 0x41700000, v90
    v_fmamk_f32 v80, v81, 0x41200000, v80
    v_fmamk_f32 v88, v89, 0x41200000, v88
    v_cvt_pk_bf16_f32 v22, v77, v85
    v_cvt_pk_bf16_f32 v26, v78, v86
    v_cvt_pk_bf16_f32 v66, v79, v87
    v_cvt_pk_bf16_f32 v70, v82, v90
    v_cvt_pk_bf16_f32 v74, v80, v88
    v_lshlrev_b32 v76, 16, v19
    v_and_b32 v84, s25, v19
    v_lshlrev_b32 v77, 16, v23
    v_and_b32 v85, s25, v23
    v_lshlrev_b32 v78, 16, v27
    v_and_b32 v86, s25, v27
    v_lshlrev_b32 v79, 16, v31
    v_and_b32 v87, s25, v31
    v_add_f32 v80, v76, v78
    v_add_f32 v88, v84, v86
    v_add_f32 v81, v77, v79
    v_add_f32 v89, v85, v87
    v_fma_f32 v82, v78, 4.0, v76
    v_fma_f32 v90, v86, 4.0, v84
    v_fma_f32 v83, v79, 4.0, v77
    v_fma_f32 v91, v87, 4.0, v85
    v_add_f32 v77, v80, v81
    v_add_f32 v85, v88, v89
    v_sub_f32 v78, v80, v81
    v_sub_f32 v86, v88, v89
    v_fma_f32 v79, v83, 2.0, v82
    v_fma_f32 v87, v91, 2.0, v90
    v_fma_f32 v82, v83, -2.0, v82
    v_fma_f32 v90, v91, -2.0, v90
    v_fmamk_f32 v80, v76, 0x41700000, v82
    v_fmamk_f32 v88, v84, 0x41700000, v90
    v_fmamk_f32 v80, v81, 0x41200000, v80
    v_fmamk_f32 v88, v89, 0x41200000, v88
    v_cvt_pk_bf16_f32 v23, v77, v85
    v_cvt_pk_bf16_f32 v27, v78, v86
    v_cvt_pk_bf16_f32 v67, v79, v87
    v_cvt_pk_bf16_f32 v71, v82, v90
    v_cvt_pk_bf16_f32 v75, v80, v88
    s_add_u32 s28, s28, 1
    s_waitcnt lgkmcnt(0)
    s_barrier
    s_sub_u32 s22, s22, 1
    s_branch L_conv1_kernel_hloop2
L_conv1_kernel_hlast2:
    s_waitcnt vmcnt(0)
    s_mov_b32 s58, s20
    s_lshl_b32 s20, s2, 2
    s_add_u32 s20, s20, s32
    v_mov_b32 v1, v127
    s_load_dwordx2 s[8:9], s[0:1], 16
    s_lshr_b32 s22, s20, 8
    s_bfe_u32 s23, s20, 0x40004
    s_bfe_u32 s24, s20, 0x30001
    s_and_b32 s21, s20, 1
    v_lshrrev_b32 v2, 4, v1
    v_lshlrev_b32 v2, 12, v2
    v_and_b32 v3, 15, v1
    v_lshl_add_u32 v2, v3, 2, v2
    s_lshl_b32 s26, s22, 3
    s_lshr_b32 s27, s23, 3
    s_add_u32 s26, s26, s27
    s_lshl_b32 s26, s26, 17
    s_and_b32 s27, s23, 7
    s_lshl_b32 s27, s27, 14
    s_add_u32 s26, s26, s27
    s_lshl_b32 s27, s24, 6
    s_add_u32 s26, s26, s27
    s_mov_b32 s10, 4063232
    s_mov_b32 s11, 0x00020000
    s_add_u32 s37, s26, 262144
    s_add_u32 s38, s26, 524288
    s_add_u32 s39, s26, 786432
    s_waitcnt lgkmcnt(0)
    buffer_load_dword v16, v2, s[8:11], s26 offen offset:0
    buffer_load_dword v17, v2, s[8:11], s26 offen offset:512
    buffer_load_dword v24, v2, s[8:11], s37 offen offset:0
    buffer_load_dword v25, v2, s[8:11], s37 offen offset:512
    buffer_load_dword v32, v2, s[8:11], s38 offen offset:0
    buffer_load_dword v33, v2, s[8:11], s38 offen offset:512
    buffer_load_dword v40, v2, s[8:11], s39 offen offset:0
    buffer_load_dword v41, v2, s[8:11], s39 offen offset:512
    buffer_load_dword v18, v2, s[8:11], s26 offen offset:1024
    buffer_load_dword v19, v2, s[8:11], s26 offen offset:1536
    buffer_load_dword v26, v2, s[8:11], s37 offen offset:1024
    buffer_load_dword v27, v2, s[8:11], s37 offen offset:1536
    buffer_load_dword v34, v2, s[8:11], s38 offen offset:1024
    buffer_load_dword v35, v2, s[8:11], s38 offen offset:1536
    buffer_load_dword v42, v2, s[8:11], s39 offen offset:1024
    buffer_load_dword v43, v2, s[8:11], s39 offen offset:1536
    buffer_load_dword v20, v2, s[8:11], s26 offen offset:2048
    buffer_load_dword v21, v2, s[8:11], s26 offen offset:2560
    buffer_load_dword v28, v2, s[8:11], s37 offen offset:2048
    buffer_load_dword v29, v2, s[8:11], s37 offen offset:2560
    buffer_load_dword v36, v2, s[8:11], s38 offen offset:2048
    buffer_load_dword v37, v2, s[8:11], s38 offen offset:2560
    buffer_load_dword v44, v2, s[8:11], s39 offen offset:2048
    buffer_load_dword v45, v2, s[8:11], s39 offen offset:2560
    buffer_load_dword v22, v2, s[8:11], s26 offen offset:3072
    buffer_load_dword v23, v2, s[8:11], s26 offen offset:3584
    buffer_load_dword v30, v2, s[8:11], s37 offen offset:3072
    buffer_load_dword v31, v2, s[8:11], s37 offen offset:3584
    buffer_load_dword v38, v2, s[8:11], s38 offen offset:3072
    buffer_load_dword v39, v2, s[8:11], s38 offen offset:3584
    buffer_load_dword v46, v2, s[8:11], s39 offen offset:3072
    buffer_load_dword v47, v2, s[8:11], s39 offen offset:3584
    s_add_u32 s12, s30, 9437184
    s_addc_u32 s13, s31, 0
    s_mov_b32 s14, 7340032
    s_mov_b32 s15, 0x00020000
    v_lshlrev_b32 v4, 4, v1
    s_lshl_b32 s27, s24, 4
    s_add_u32 s27, s27, s23
    s_mul_i32 s27, s27, 57344
    s_lshl_b32 s28, s22, 11
    s_add_u32 s27, s27, s28
    s_lshl_b32 s28, s21, 10
    s_add_u32 s27, s27, s28
    s_cmp_eq_u32 s21, 0
    s_mov_b32 s32, 0x07060302
    s_cselect_b32 s32, 0x05040100, s32
    s_mov_b32 s33, 0x03020c0c
    s_cselect_b32 s33, 0x01000c0c, s33
    s_mov_b32 s35, 0x3d2aaaab
    s_mov_b32 s36, 0x3c638e39
    s_mov_b32 s25, 0xffff0000
    ds_write_b128 v96, v[64:67] offset:57344
    ds_write_b128 v97, v[68:71] offset:8192
    ds_write_b128 v97, v[72:75] offset:24576
    ds_write_b128 v96, v[48:51] offset:8192
    ds_write_b128 v96, v[52:55] offset:24576
    ds_write_b128 v96, v[56:59] offset:40960
    ds_write_b128 v98, v[60:63] offset:8704
    s_waitcnt lgkmcnt(0)
    s_barrier
    s_waitcnt vmcnt(24)
    v_perm_b32 v72, v17, v16, s32
    v_perm_b32 v48, v41, v40, s32
    v_perm_b32 v76, v76, v40, s33
    v_perm_b32 v84, v84, v41, s33
    v_perm_b32 v77, v77, v32, s33
    v_perm_b32 v85, v85, v33, s33
    v_perm_b32 v78, v78, v24, s33
    v_perm_b32 v86, v86, v25, s33
    v_perm_b32 v79, v79, v16, s33
    v_perm_b32 v87, v87, v17, s33
    v_add_f32 v80, v76, v78
    v_add_f32 v88, v84, v86
    v_add_f32 v81, v77, v79
    v_add_f32 v89, v85, v87
    v_fma_f32 v82, v78, 4.0, v76
    v_fma_f32 v90, v86, 4.0, v84
    v_fma_f32 v83, v79, 4.0, v77
    v_fma_f32 v91, v87, 4.0, v85
    v_add_f32 v77, v80, v81
    v_add_f32 v85, v88, v89
    v_sub_f32 v78, v80, v81
    v_sub_f32 v86, v88, v89
    v_fma_f32 v79, v83, 2.0, v82
    v_fma_f32 v87, v91, 2.0, v90
    v_fma_f32 v82, v83, -2.0, v82
    v_fma_f32 v90, v91, -2.0, v90
    v_fmamk_f32 v80, v76, 0x41700000, v82
    v_fmamk_f32 v88, v84, 0x41700000, v90
    v_fmamk_f32 v80, v81, 0x41200000, v80
    v_fmamk_f32 v88, v89, 0x41200000, v88
    v_mul_f32 v77, 0.5, v77
    v_mul_f32 v85, 0.5, v85
    v_mul_f32 v78, 0.5, v78
    v_mul_f32 v86, 0.5, v86
    v_mul_f32 v79, s35, v79
    v_mul_f32 v87, s35, v87
    v_mul_f32 v82, s35, v82
    v_mul_f32 v90, s35, v90
    v_mul_f32 v80, s36, v80
    v_mul_f32 v88, s36, v88
    v_cvt_pk_bf16_f32 v52, v77, v85
    v_cvt_pk_bf16_f32 v56, v78, v86
    v_cvt_pk_bf16_f32 v60, v79, v87
    v_cvt_pk_bf16_f32 v64, v82, v90
    v_cvt_pk_bf16_f32 v68, v80, v88
    s_waitcnt vmcnt(16)
    v_perm_b32 v73, v19, v18, s32
    v_perm_b32 v49, v43, v42, s32
    v_perm_b32 v76, v76, v42, s33
    v_perm_b32 v84, v84, v43, s33
    v_perm_b32 v77, v77, v34, s33
    v_perm_b32 v85, v85, v35, s33
    v_perm_b32 v78, v78, v26, s33
    v_perm_b32 v86, v86, v27, s33
    v_perm_b32 v79, v79, v18, s33
    v_perm_b32 v87, v87, v19, s33
    v_add_f32 v80, v76, v78
    v_add_f32 v88, v84, v86
    v_add_f32 v81, v77, v79
    v_add_f32 v89, v85, v87
    v_fma_f32 v82, v78, 4.0, v76
    v_fma_f32 v90, v86, 4.0, v84
    v_fma_f32 v83, v79, 4.0, v77
    v_fma_f32 v91, v87, 4.0, v85
    v_add_f32 v77, v80, v81
    v_add_f32 v85, v88, v89
    v_sub_f32 v78, v80, v81
    v_sub_f32 v86, v88, v89
    v_fma_f32 v79, v83, 2.0, v82
    v_fma_f32 v87, v91, 2.0, v90
    v_fma_f32 v82, v83, -2.0, v82
    v_fma_f32 v90, v91, -2.0, v90
    v_fmamk_f32 v80, v76, 0x41700000, v82
    v_fmamk_f32 v88, v84, 0x41700000, v90
    v_fmamk_f32 v80, v81, 0x41200000, v80
    v_fmamk_f32 v88, v89, 0x41200000, v88
    v_mul_f32 v77, 0.5, v77
    v_mul_f32 v85, 0.5, v85
    v_mul_f32 v78, 0.5, v78
    v_mul_f32 v86, 0.5, v86
    v_mul_f32 v79, s35, v79
    v_mul_f32 v87, s35, v87
    v_mul_f32 v82, s35, v82
    v_mul_f32 v90, s35, v90
    v_mul_f32 v80, s36, v80
    v_mul_f32 v88, s36, v88
    v_cvt_pk_bf16_f32 v53, v77, v85
    v_cvt_pk_bf16_f32 v57, v78, v86
    v_cvt_pk_bf16_f32 v61, v79, v87
    v_cvt_pk_bf16_f32 v65, v82, v90
    v_cvt_pk_bf16_f32 v69, v80, v88
    s_waitcnt vmcnt(8)
    v_perm_b32 v74, v21, v20, s32
    v_perm_b32 v50, v45, v44, s32
    v_perm_b32 v76, v76, v44, s33
    v_perm_b32 v84, v84, v45, s33
    v_perm_b32 v77, v77, v36, s33
    v_perm_b32 v85, v85, v37, s33
    v_perm_b32 v78, v78, v28, s33
    v_perm_b32 v86, v86, v29, s33
    v_perm_b32 v79, v79, v20, s33
    v_perm_b32 v87, v87, v21, s33
    v_add_f32 v80, v76, v78
    v_add_f32 v88, v84, v86
    v_add_f32 v81, v77, v79
    v_add_f32 v89, v85, v87
    v_fma_f32 v82, v78, 4.0, v76
    v_fma_f32 v90, v86, 4.0, v84
    v_fma_f32 v83, v79, 4.0, v77
    v_fma_f32 v91, v87, 4.0, v85
    v_add_f32 v77, v80, v81
    v_add_f32 v85, v88, v89
    v_sub_f32 v78, v80, v81
    v_sub_f32 v86, v88, v89
    v_fma_f32 v79, v83, 2.0, v82
    v_fma_f32 v87, v91, 2.0, v90
    v_fma_f32 v82, v83, -2.0, v82
    v_fma_f32 v90, v91, -2.0, v90
    v_fmamk_f32 v80, v76, 0x41700000, v82
    v_fmamk_f32 v88, v84, 0x41700000, v90
    v_fmamk_f32 v80, v81, 0x41200000, v80
    v_fmamk_f32 v88, v89, 0x41200000, v88
    v_mul_f32 v77, 0.5, v77
    v_mul_f32 v85, 0.5, v85
    v_mul_f32 v78, 0.5, v78
    v_mul_f32 v86, 0.5, v86
    v_mul_f32 v79, s35, v79
    v_mul_f32 v87, s35, v87
    v_mul_f32 v82, s35, v82
    v_mul_f32 v90, s35, v90
    v_mul_f32 v80, s36, v80
    v_mul_f32 v88, s36, v88
    v_cvt_pk_bf16_f32 v54, v77, v85
    v_cvt_pk_bf16_f32 v58, v78, v86
    v_cvt_pk_bf16_f32 v62, v79, v87
    v_cvt_pk_bf16_f32 v66, v82, v90
    v_cvt_pk_bf16_f32 v70, v80, v88
    s_waitcnt vmcnt(0)
    v_perm_b32 v75, v23, v22, s32
    v_perm_b32 v51, v47, v46, s32
    v_perm_b32 v76, v76, v46, s33
    v_perm_b32 v84, v84, v47, s33
    v_perm_b32 v77, v77, v38, s33
    v_perm_b32 v85, v85, v39, s33
    v_perm_b32 v78, v78, v30, s33
    v_perm_b32 v86, v86, v31, s33
    v_perm_b32 v79, v79, v22, s33
    v_perm_b32 v87, v87, v23, s33
    v_add_f32 v80, v76, v78
    v_add_f32 v88, v84, v86
    v_add_f32 v81, v77, v79
    v_add_f32 v89, v85, v87
    v_fma_f32 v82, v78, 4.0, v76
    v_fma_f32 v90, v86, 4.0, v84
    v_fma_f32 v83, v79, 4.0, v77
    v_fma_f32 v91, v87, 4.0, v85
    v_add_f32 v77, v80, v81
    v_add_f32 v85, v88, v89
    v_sub_f32 v78, v80, v81
    v_sub_f32 v86, v88, v89
    v_fma_f32 v79, v83, 2.0, v82
    v_fma_f32 v87, v91, 2.0, v90
    v_fma_f32 v82, v83, -2.0, v82
    v_fma_f32 v90, v91, -2.0, v90
    v_fmamk_f32 v80, v76, 0x41700000, v82
    v_fmamk_f32 v88, v84, 0x41700000, v90
    v_fmamk_f32 v80, v81, 0x41200000, v80
    v_fmamk_f32 v88, v89, 0x41200000, v88
    v_mul_f32 v77, 0.5, v77
    v_mul_f32 v85, 0.5, v85
    v_mul_f32 v78, 0.5, v78
    v_mul_f32 v86, 0.5, v86
    v_mul_f32 v79, s35, v79
    v_mul_f32 v87, s35, v87
    v_mul_f32 v82, s35, v82
    v_mul_f32 v90, s35, v90
    v_mul_f32 v80, s36, v80
    v_mul_f32 v88, s36, v88
    v_cvt_pk_bf16_f32 v55, v77, v85
    v_cvt_pk_bf16_f32 v59, v78, v86
    v_cvt_pk_bf16_f32 v63, v79, v87
    v_cvt_pk_bf16_f32 v67, v82, v90
    v_cvt_pk_bf16_f32 v71, v80, v88
    s_add_u32 s28, s27, 49152
    buffer_store_dwordx4 v[72:75], v4, s[12:15], s28 offen sc1
    s_add_u32 s28, s27, 0
    buffer_store_dwordx4 v[48:51], v4, s[12:15], s28 offen sc1
    s_add_u32 s28, s27, 8192
    buffer_store_dwordx4 v[52:55], v4, s[12:15], s28 offen sc1
    s_add_u32 s28, s27, 16384
    buffer_store_dwordx4 v[56:59], v4, s[12:15], s28 offen sc1
    s_add_u32 s28, s27, 24576
    buffer_store_dwordx4 v[60:63], v4, s[12:15], s28 offen sc1
    s_add_u32 s28, s27, 32768
    buffer_store_dwordx4 v[64:67], v4, s[12:15], s28 offen sc1
    s_add_u32 s28, s27, 40960
    buffer_store_dwordx4 v[68:71], v4, s[12:15], s28 offen sc1
    s_mov_b32 s20, s58
    s_branch L_conv1_kernel_end
L_conv1_kernel_epi:
    v_and_b32 v108, 15, v127
    v_lshrrev_b32 v109, 4, v127
    v_lshrrev_b32 v110, 3, v108
    s_lshl_b32 s36, s20, 1
    v_add_u32 v110, s36, v110
    v_xor_b32 v111, v110, v108
    v_and_b32 v111, 7, v111
    v_lshlrev_b32 v111, 4, v111
    v_lshl_add_u32 v111, v110, 7, v111
    v_lshl_add_u32 v120, v109, 11, v111
    v_add_u32 v121, 65536, v120
    v_add_u32 v125, 131072, v120
    s_lshl_b32 s36, s20, 9
    s_add_u32 s36, s36, 115712
    v_lshl_add_u32 v123, v109, 7, s36
    s_lshl_b32 s36, s20, 4
    v_add_u32 v108, s36, v108
    v_lshlrev_b32 v110, 6, v108
    v_lshl_add_u32 v110, v109, 4, v110
    s_mul_i32 s36, s29, 524288
    s_lshl_b32 s37, s21, 4
    s_add_u32 s36, s36, s37
    v_add_u32 v110, s36, v110
    v_mov_b32 v111, 2130706432
    v_cmp_gt_u32 vcc, 125, v108
    s_mov_b32 s4, 0xbeaaaaab
    s_mov_b32 s5, s4
    s_mov_b32 s6, 0x3e800000
    s_mov_b32 s7, s6
    s_mov_b32 s8, 0xc0a00000
    s_mov_b32 s9, s8
    s_mov_b32 s10, 0xc0638e39
    s_mov_b32 s11, s10
    s_mov_b32 s12, 0xbf638e39
    s_mov_b32 s13, s12
    s_mov_b32 s14, 0xbe638e39
    s_mov_b32 s15, s14
    s_mov_b32 s22, 0xbd638e39
    s_mov_b32 s23, s22
    s_mov_b32 s24, 0x3ff1c71c
    s_mov_b32 s25, s24
    s_mov_b32 s26, 0xbf2aaaab
    s_mov_b32 s27, s26
    s_mov_b32 s32, 0x3ecccccd
    s_mov_b32 s33, s32
    s_mov_b32 s34, 0xbd888889
    s_mov_b32 s35, s34
    s_mov_b32 s38, 0xbe4ccccd
    s_mov_b32 s39, s38
    s_mov_b32 s40, 0xbdd2d3e8
    s_mov_b32 s41, s40
    s_mov_b32 s42, 0x3f800000
    s_mov_b32 s43, s42
    s_waitcnt lgkmcnt(0)
    s_barrier
    v_cndmask_b32 v122, v111, v110, vcc
    ds_read_b128 v[0:3], v120 offset:0
    ds_read_b128 v[4:7], v120 offset:16384
    ds_read_b128 v[8:11], v120 offset:32768
    ds_read_b128 v[12:15], v120 offset:49152
    ds_read_b128 v[16:19], v121 offset:0
    ds_read_b128 v[20:23], v121 offset:16384
    ds_read_b128 v[24:27], v121 offset:32768
    ds_read_b128 v[28:31], v125 offset:15360
    ds_read_b128 v[32:35], v120 offset:8192
    ds_read_b128 v[36:39], v120 offset:24576
    ds_read_b128 v[40:43], v120 offset:40960
    ds_read_b128 v[44:47], v120 offset:57344
    ds_read_b128 v[48:51], v121 offset:56320
    ds_read_b128 v[52:55], v121 offset:64512
    ds_read_b128 v[56:59], v125 offset:7168
    s_waitcnt lgkmcnt(7)
    ds_read_b128 v[60:63], v125 offset:23552
    s_waitcnt lgkmcnt(8)
    v_pk_add_f32 v[88:89], v[24:25], v[28:29]
    v_pk_add_f32 v[90:91], v[26:27], v[30:31]
    v_pk_add_f32 v[24:25], v[4:5], v[8:9]
    v_pk_add_f32 v[26:27], v[6:7], v[10:11]
    v_pk_add_f32 v[4:5], v[4:5], v[8:9] neg_lo:[0,1] neg_hi:[0,1]
    v_pk_add_f32 v[6:7], v[6:7], v[10:11] neg_lo:[0,1] neg_hi:[0,1]
    v_pk_add_f32 v[72:73], v[12:13], v[16:17]
    v_pk_add_f32 v[74:75], v[14:15], v[18:19]
    v_pk_add_f32 v[12:13], v[12:13], v[16:17] neg_lo:[0,1] neg_hi:[0,1]
    v_pk_add_f32 v[14:15], v[14:15], v[18:19] neg_lo:[0,1] neg_hi:[0,1]
    v_pk_fma_f32 v[72:73], v[24:25], s[4:5], v[72:73]
    v_pk_fma_f32 v[74:75], v[26:27], s[4:5], v[74:75]
    v_pk_fma_f32 v[20:21], v[0:1], s[10:11], v[20:21]
    v_pk_fma_f32 v[22:23], v[2:3], s[10:11], v[22:23]
    v_pk_fma_f32 v[72:73], v[0:1], s[6:7], v[72:73]
    v_pk_fma_f32 v[74:75], v[2:3], s[6:7], v[74:75]
    v_pk_add_f32 v[24:25], v[24:25], v[0:1] neg_lo:[0,1] neg_hi:[0,1]
    v_pk_add_f32 v[26:27], v[26:27], v[2:3] neg_lo:[0,1] neg_hi:[0,1]
    v_pk_fma_f32 v[72:73], v[88:89], s[8:9], v[72:73]
    v_pk_fma_f32 v[74:75], v[90:91], s[8:9], v[74:75]
    v_pk_add_f32 v[24:25], v[24:25], v[88:89] neg_lo:[0,1] neg_hi:[0,1]
    v_pk_add_f32 v[26:27], v[26:27], v[90:91] neg_lo:[0,1] neg_hi:[0,1]
    v_pk_fma_f32 v[20:21], v[88:89], s[22:23], v[20:21]
    v_pk_fma_f32 v[22:23], v[90:91], s[22:23], v[22:23]
    v_pk_add_f32 v[8:9], v[24:25], v[72:73] neg_lo:[0,1] neg_hi:[0,1]
    v_pk_add_f32 v[10:11], v[26:27], v[74:75] neg_lo:[0,1] neg_hi:[0,1]
    v_pk_fma_f32 v[20:21], v[72:73], s[14:15], v[20:21]
    v_pk_fma_f32 v[22:23], v[74:75], s[14:15], v[22:23]
    v_pk_mul_f32 v[80:81], v[12:13], s[32:33]
    v_pk_mul_f32 v[82:83], v[14:15], s[32:33]
    v_pk_fma_f32 v[20:21], v[8:9], s[12:13], v[20:21]
    v_pk_fma_f32 v[22:23], v[10:11], s[12:13], v[22:23]
    v_pk_fma_f32 v[80:81], v[4:5], s[34:35], v[80:81]
    v_pk_fma_f32 v[82:83], v[6:7], s[34:35], v[82:83]
    v_pk_fma_f32 v[64:65], v[4:5], s[24:25], v[20:21] neg_lo:[0,0,1] neg_hi:[0,0,1]
    v_pk_fma_f32 v[66:67], v[6:7], s[24:25], v[22:23] neg_lo:[0,0,1] neg_hi:[0,0,1]
    v_pk_fma_f32 v[64:65], v[12:13], s[26:27], v[64:65]
    v_pk_fma_f32 v[66:67], v[14:15], s[26:27], v[66:67]
    v_pk_fma_f32 v[80:81], v[64:65], s[38:39], v[80:81]
    v_pk_fma_f32 v[82:83], v[66:67], s[38:39], v[82:83]
    v_pk_add_f32 v[4:5], v[4:5], v[64:65] neg_lo:[0,1] neg_hi:[0,1]
    v_pk_add_f32 v[6:7], v[6:7], v[66:67] neg_lo:[0,1] neg_hi:[0,1]
    v_pk_add_f32 v[4:5], v[4:5], v[80:81] neg_lo:[0,1] neg_hi:[0,1]
    v_pk_add_f32 v[6:7], v[6:7], v[82:83] neg_lo:[0,1] neg_hi:[0,1]
    s_waitcnt lgkmcnt(0)
    v_pk_add_f32 v[92:93], v[56:57], v[60:61]
    v_pk_add_f32 v[94:95], v[58:59], v[62:63]
    v_pk_add_f32 v[56:57], v[36:37], v[40:41]
    v_pk_add_f32 v[58:59], v[38:39], v[42:43]
    v_pk_add_f32 v[36:37], v[36:37], v[40:41] neg_lo:[0,1] neg_hi:[0,1]
    v_pk_add_f32 v[38:39], v[38:39], v[42:43] neg_lo:[0,1] neg_hi:[0,1]
    v_pk_add_f32 v[76:77], v[44:45], v[48:49]
    v_pk_add_f32 v[78:79], v[46:47], v[50:51]
    v_pk_add_f32 v[44:45], v[44:45], v[48:49] neg_lo:[0,1] neg_hi:[0,1]
    v_pk_add_f32 v[46:47], v[46:47], v[50:51] neg_lo:[0,1] neg_hi:[0,1]
    v_pk_fma_f32 v[76:77], v[56:57], s[4:5], v[76:77]
    v_pk_fma_f32 v[78:79], v[58:59], s[4:5], v[78:79]
    v_pk_fma_f32 v[52:53], v[32:33], s[10:11], v[52:53]
    v_pk_fma_f32 v[54:55], v[34:35], s[10:11], v[54:55]
    v_pk_fma_f32 v[76:77], v[32:33], s[6:7], v[76:77]
    v_pk_fma_f32 v[78:79], v[34:35], s[6:7], v[78:79]
    v_pk_add_f32 v[56:57], v[56:57], v[32:33] neg_lo:[0,1] neg_hi:[0,1]
    v_pk_add_f32 v[58:59], v[58:59], v[34:35] neg_lo:[0,1] neg_hi:[0,1]
    v_pk_fma_f32 v[76:77], v[92:93], s[8:9], v[76:77]
    v_pk_fma_f32 v[78:79], v[94:95], s[8:9], v[78:79]
    v_pk_add_f32 v[56:57], v[56:57], v[92:93] neg_lo:[0,1] neg_hi:[0,1]
    v_pk_add_f32 v[58:59], v[58:59], v[94:95] neg_lo:[0,1] neg_hi:[0,1]
    v_pk_fma_f32 v[52:53], v[92:93], s[22:23], v[52:53]
    v_pk_fma_f32 v[54:55], v[94:95], s[22:23], v[54:55]
    v_pk_add_f32 v[40:41], v[56:57], v[76:77] neg_lo:[0,1] neg_hi:[0,1]
    v_pk_add_f32 v[42:43], v[58:59], v[78:79] neg_lo:[0,1] neg_hi:[0,1]
    v_pk_fma_f32 v[52:53], v[76:77], s[14:15], v[52:53]
    v_pk_fma_f32 v[54:55], v[78:79], s[14:15], v[54:55]
    v_pk_mul_f32 v[84:85], v[44:45], s[32:33]
    v_pk_mul_f32 v[86:87], v[46:47], s[32:33]
    v_pk_fma_f32 v[52:53], v[40:41], s[12:13], v[52:53]
    v_pk_fma_f32 v[54:55], v[42:43], s[12:13], v[54:55]
    v_pk_fma_f32 v[84:85], v[36:37], s[34:35], v[84:85]
    v_pk_fma_f32 v[86:87], v[38:39], s[34:35], v[86:87]
    v_pk_fma_f32 v[68:69], v[36:37], s[24:25], v[52:53] neg_lo:[0,0,1] neg_hi:[0,0,1]
    v_pk_fma_f32 v[70:71], v[38:39], s[24:25], v[54:55] neg_lo:[0,0,1] neg_hi:[0,0,1]
    v_pk_fma_f32 v[68:69], v[44:45], s[26:27], v[68:69]
    v_pk_fma_f32 v[70:71], v[46:47], s[26:27], v[70:71]
    v_pk_fma_f32 v[84:85], v[68:69], s[38:39], v[84:85]
    v_pk_fma_f32 v[86:87], v[70:71], s[38:39], v[86:87]
    v_pk_add_f32 v[36:37], v[36:37], v[68:69] neg_lo:[0,1] neg_hi:[0,1]
    v_pk_add_f32 v[38:39], v[38:39], v[70:71] neg_lo:[0,1] neg_hi:[0,1]
    v_pk_add_f32 v[36:37], v[36:37], v[84:85] neg_lo:[0,1] neg_hi:[0,1]
    v_pk_add_f32 v[38:39], v[38:39], v[86:87] neg_lo:[0,1] neg_hi:[0,1]
    s_mov_b32 s36, 0x00010001
    s_mov_b32 s37, 0x00010001
    s_mov_b64 exec, s[36:37]
    ds_write_b128 v123, v[0:3] offset:0
    ds_write_b128 v123, v[32:35] offset:16
    ds_write_b128 v123, v[4:7] offset:32
    ds_write_b128 v123, v[36:39] offset:48
    ds_write_b128 v123, v[8:11] offset:64
    ds_write_b128 v123, v[40:43] offset:80
    s_mov_b64 exec, -1
    v_mov_b32 v44, 0xc0135761
    v_mov_b32 v45, v44
    v_pk_mul_f32 v[16:17], v[64:65], v[64:65]
    v_pk_mul_f32 v[18:19], v[66:67], v[66:67]
    v_pk_mul_f32 v[20:21], v[68:69], v[68:69]
    v_pk_mul_f32 v[22:23], v[70:71], v[70:71]
    v_pk_fma_f32 v[16:17], v[16:17], s[40:41], v[44:45]
    v_pk_fma_f32 v[18:19], v[18:19], s[40:41], v[44:45]
    v_pk_fma_f32 v[20:21], v[20:21], s[40:41], v[44:45]
    v_pk_fma_f32 v[22:23], v[22:23], s[40:41], v[44:45]
    v_pk_mul_f32 v[16:17], v[16:17], v[64:65]
    v_pk_mul_f32 v[18:19], v[18:19], v[66:67]
    v_pk_mul_f32 v[20:21], v[20:21], v[68:69]
    v_pk_mul_f32 v[22:23], v[22:23], v[70:71]
    v_exp_f32 v16, v16
    v_exp_f32 v17, v17
    v_exp_f32 v18, v18
    v_exp_f32 v19, v19
    v_exp_f32 v20, v20
    v_exp_f32 v21, v21
    v_exp_f32 v22, v22
    v_exp_f32 v23, v23
    v_pk_add_f32 v[16:17], v[16:17], s[42:43]
    v_pk_add_f32 v[18:19], v[18:19], s[42:43]
    v_pk_add_f32 v[20:21], v[20:21], s[42:43]
    v_pk_add_f32 v[22:23], v[22:23], s[42:43]
    v_rcp_f32 v16, v16
    v_rcp_f32 v17, v17
    v_rcp_f32 v18, v18
    v_rcp_f32 v19, v19
    v_rcp_f32 v20, v20
    v_rcp_f32 v21, v21
    v_rcp_f32 v22, v22
    v_rcp_f32 v23, v23
    v_pk_mul_f32 v[64:65], v[64:65], v[16:17]
    v_pk_mul_f32 v[66:67], v[66:67], v[18:19]
    v_pk_mul_f32 v[68:69], v[68:69], v[20:21]
    v_pk_mul_f32 v[70:71], v[70:71], v[22:23]
    v_cvt_pk_bf16_f32 v48, v64, v68
    v_cvt_pk_bf16_f32 v49, v65, v69
    v_cvt_pk_bf16_f32 v50, v66, v70
    v_cvt_pk_bf16_f32 v51, v67, v71
    s_mov_b32 s44, 393280
    buffer_store_dwordx4 v[48:51], v122, s[16:19], s44 offen sc1
    s_waitcnt lgkmcnt(0)
    s_barrier
    ds_read_b128 v[96:99], v123 offset:512
    ds_read_b128 v[100:103], v123 offset:528
    ds_read_b128 v[104:107], v123 offset:544
    ds_read_b128 v[108:111], v123 offset:560
    ds_read_b128 v[112:115], v123 offset:576
    ds_read_b128 v[116:119], v123 offset:592
    s_waitcnt lgkmcnt(4)
    v_mov_b32_dpp v96, v0 row_shl:1 row_mask:0xf bank_mask:0xf
    v_mov_b32_dpp v97, v1 row_shl:1 row_mask:0xf bank_mask:0xf
    v_mov_b32_dpp v98, v2 row_shl:1 row_mask:0xf bank_mask:0xf
    v_mov_b32_dpp v99, v3 row_shl:1 row_mask:0xf bank_mask:0xf
    v_mov_b32_dpp v100, v32 row_shl:1 row_mask:0xf bank_mask:0xf
    v_mov_b32_dpp v101, v33 row_shl:1 row_mask:0xf bank_mask:0xf
    v_mov_b32_dpp v102, v34 row_shl:1 row_mask:0xf bank_mask:0xf
    v_mov_b32_dpp v103, v35 row_shl:1 row_mask:0xf bank_mask:0xf
    v_pk_add_f32 v[72:73], v[72:73], v[96:97]
    v_pk_add_f32 v[74:75], v[74:75], v[98:99]
    v_pk_add_f32 v[76:77], v[76:77], v[100:101]
    v_pk_add_f32 v[78:79], v[78:79], v[102:103]
    v_pk_mul_f32 v[24:25], v[72:73], v[72:73]
    v_pk_mul_f32 v[26:27], v[74:75], v[74:75]
    v_pk_mul_f32 v[28:29], v[76:77], v[76:77]
    v_pk_mul_f32 v[30:31], v[78:79], v[78:79]
    v_pk_fma_f32 v[24:25], v[24:25], s[40:41], v[44:45]
    v_pk_fma_f32 v[26:27], v[26:27], s[40:41], v[44:45]
    v_pk_fma_f32 v[28:29], v[28:29], s[40:41], v[44:45]
    v_pk_fma_f32 v[30:31], v[30:31], s[40:41], v[44:45]
    v_pk_mul_f32 v[24:25], v[24:25], v[72:73]
    v_pk_mul_f32 v[26:27], v[26:27], v[74:75]
    v_pk_mul_f32 v[28:29], v[28:29], v[76:77]
    v_pk_mul_f32 v[30:31], v[30:31], v[78:79]
    v_exp_f32 v24, v24
    v_exp_f32 v25, v25
    v_exp_f32 v26, v26
    v_exp_f32 v27, v27
    v_exp_f32 v28, v28
    v_exp_f32 v29, v29
    v_exp_f32 v30, v30
    v_exp_f32 v31, v31
    v_pk_add_f32 v[24:25], v[24:25], s[42:43]
    v_pk_add_f32 v[26:27], v[26:27], s[42:43]
    v_pk_add_f32 v[28:29], v[28:29], s[42:43]
    v_pk_add_f32 v[30:31], v[30:31], s[42:43]
    v_rcp_f32 v24, v24
    v_rcp_f32 v25, v25
    v_rcp_f32 v26, v26
    v_rcp_f32 v27, v27
    v_rcp_f32 v28, v28
    v_rcp_f32 v29, v29
    v_rcp_f32 v30, v30
    v_rcp_f32 v31, v31
    v_pk_mul_f32 v[72:73], v[72:73], v[24:25]
    v_pk_mul_f32 v[74:75], v[74:75], v[26:27]
    v_pk_mul_f32 v[76:77], v[76:77], v[28:29]
    v_pk_mul_f32 v[78:79], v[78:79], v[30:31]
    v_cvt_pk_bf16_f32 v52, v72, v76
    v_cvt_pk_bf16_f32 v53, v73, v77
    v_cvt_pk_bf16_f32 v54, v74, v78
    v_cvt_pk_bf16_f32 v55, v75, v79
    s_mov_b32 s44, 128
    buffer_store_dwordx4 v[52:55], v122, s[16:19], s44 offen sc1
    s_waitcnt lgkmcnt(2)
    v_mov_b32_dpp v104, v4 row_shl:1 row_mask:0xf bank_mask:0xf
    v_mov_b32_dpp v105, v5 row_shl:1 row_mask:0xf bank_mask:0xf
    v_mov_b32_dpp v106, v6 row_shl:1 row_mask:0xf bank_mask:0xf
    v_mov_b32_dpp v107, v7 row_shl:1 row_mask:0xf bank_mask:0xf
    v_mov_b32_dpp v108, v36 row_shl:1 row_mask:0xf bank_mask:0xf
    v_mov_b32_dpp v109, v37 row_shl:1 row_mask:0xf bank_mask:0xf
    v_mov_b32_dpp v110, v38 row_shl:1 row_mask:0xf bank_mask:0xf
    v_mov_b32_dpp v111, v39 row_shl:1 row_mask:0xf bank_mask:0xf
    v_pk_add_f32 v[80:81], v[80:81], v[104:105]
    v_pk_add_f32 v[82:83], v[82:83], v[106:107]
    v_pk_add_f32 v[84:85], v[84:85], v[108:109]
    v_pk_add_f32 v[86:87], v[86:87], v[110:111]
    v_pk_mul_f32 v[16:17], v[80:81], v[80:81]
    v_pk_mul_f32 v[18:19], v[82:83], v[82:83]
    v_pk_mul_f32 v[20:21], v[84:85], v[84:85]
    v_pk_mul_f32 v[22:23], v[86:87], v[86:87]
    v_pk_fma_f32 v[16:17], v[16:17], s[40:41], v[44:45]
    v_pk_fma_f32 v[18:19], v[18:19], s[40:41], v[44:45]
    v_pk_fma_f32 v[20:21], v[20:21], s[40:41], v[44:45]
    v_pk_fma_f32 v[22:23], v[22:23], s[40:41], v[44:45]
    v_pk_mul_f32 v[16:17], v[16:17], v[80:81]
    v_pk_mul_f32 v[18:19], v[18:19], v[82:83]
    v_pk_mul_f32 v[20:21], v[20:21], v[84:85]
    v_pk_mul_f32 v[22:23], v[22:23], v[86:87]
    v_exp_f32 v16, v16
    v_exp_f32 v17, v17
    v_exp_f32 v18, v18
    v_exp_f32 v19, v19
    v_exp_f32 v20, v20
    v_exp_f32 v21, v21
    v_exp_f32 v22, v22
    v_exp_f32 v23, v23
    v_pk_add_f32 v[16:17], v[16:17], s[42:43]
    v_pk_add_f32 v[18:19], v[18:19], s[42:43]
    v_pk_add_f32 v[20:21], v[20:21], s[42:43]
    v_pk_add_f32 v[22:23], v[22:23], s[42:43]
    v_rcp_f32 v16, v16
    v_rcp_f32 v17, v17
    v_rcp_f32 v18, v18
    v_rcp_f32 v19, v19
    v_rcp_f32 v20, v20
    v_rcp_f32 v21, v21
    v_rcp_f32 v22, v22
    v_rcp_f32 v23, v23
    v_pk_mul_f32 v[80:81], v[80:81], v[16:17]
    v_pk_mul_f32 v[82:83], v[82:83], v[18:19]
    v_pk_mul_f32 v[84:85], v[84:85], v[20:21]
    v_pk_mul_f32 v[86:87], v[86:87], v[22:23]
    v_cvt_pk_bf16_f32 v56, v80, v84
    v_cvt_pk_bf16_f32 v57, v81, v85
    v_cvt_pk_bf16_f32 v58, v82, v86
    v_cvt_pk_bf16_f32 v59, v83, v87
    s_mov_b32 s44, 131200
    buffer_store_dwordx4 v[56:59], v122, s[16:19], s44 offen sc1
    s_waitcnt lgkmcnt(0)
    v_mov_b32_dpp v112, v8 row_shl:1 row_mask:0xf bank_mask:0xf
    v_mov_b32_dpp v113, v9 row_shl:1 row_mask:0xf bank_mask:0xf
    v_mov_b32_dpp v114, v10 row_shl:1 row_mask:0xf bank_mask:0xf
    v_mov_b32_dpp v115, v11 row_shl:1 row_mask:0xf bank_mask:0xf
    v_mov_b32_dpp v116, v40 row_shl:1 row_mask:0xf bank_mask:0xf
    v_mov_b32_dpp v117, v41 row_shl:1 row_mask:0xf bank_mask:0xf
    v_mov_b32_dpp v118, v42 row_shl:1 row_mask:0xf bank_mask:0xf
    v_mov_b32_dpp v119, v43 row_shl:1 row_mask:0xf bank_mask:0xf
    v_pk_add_f32 v[88:89], v[88:89], v[112:113]
    v_pk_add_f32 v[90:91], v[90:91], v[114:115]
    v_pk_add_f32 v[92:93], v[92:93], v[116:117]
    v_pk_add_f32 v[94:95], v[94:95], v[118:119]
    v_pk_mul_f32 v[24:25], v[88:89], v[88:89]
    v_pk_mul_f32 v[26:27], v[90:91], v[90:91]
    v_pk_mul_f32 v[28:29], v[92:93], v[92:93]
    v_pk_mul_f32 v[30:31], v[94:95], v[94:95]
    v_pk_fma_f32 v[24:25], v[24:25], s[40:41], v[44:45]
    v_pk_fma_f32 v[26:27], v[26:27], s[40:41], v[44:45]
    v_pk_fma_f32 v[28:29], v[28:29], s[40:41], v[44:45]
    v_pk_fma_f32 v[30:31], v[30:31], s[40:41], v[44:45]
    v_pk_mul_f32 v[24:25], v[24:25], v[88:89]
    v_pk_mul_f32 v[26:27], v[26:27], v[90:91]
    v_pk_mul_f32 v[28:29], v[28:29], v[92:93]
    v_pk_mul_f32 v[30:31], v[30:31], v[94:95]
    v_exp_f32 v24, v24
    v_exp_f32 v25, v25
    v_exp_f32 v26, v26
    v_exp_f32 v27, v27
    v_exp_f32 v28, v28
    v_exp_f32 v29, v29
    v_exp_f32 v30, v30
    v_exp_f32 v31, v31
    v_pk_add_f32 v[24:25], v[24:25], s[42:43]
    v_pk_add_f32 v[26:27], v[26:27], s[42:43]
    v_pk_add_f32 v[28:29], v[28:29], s[42:43]
    v_pk_add_f32 v[30:31], v[30:31], s[42:43]
    v_rcp_f32 v24, v24
    v_rcp_f32 v25, v25
    v_rcp_f32 v26, v26
    v_rcp_f32 v27, v27
    v_rcp_f32 v28, v28
    v_rcp_f32 v29, v29
    v_rcp_f32 v30, v30
    v_rcp_f32 v31, v31
    v_pk_mul_f32 v[88:89], v[88:89], v[24:25]
    v_pk_mul_f32 v[90:91], v[90:91], v[26:27]
    v_pk_mul_f32 v[92:93], v[92:93], v[28:29]
    v_pk_mul_f32 v[94:95], v[94:95], v[30:31]
    v_cvt_pk_bf16_f32 v60, v88, v92
    v_cvt_pk_bf16_f32 v61, v89, v93
    v_cvt_pk_bf16_f32 v62, v90, v94
    v_cvt_pk_bf16_f32 v63, v91, v95
    s_mov_b32 s44, 262272
    buffer_store_dwordx4 v[60:63], v122, s[16:19], s44 offen sc1
L_conv1_kernel_end:
L_conv1_kernel_done:
    s_endpgm
.globl conv2_kernel
.p2align 8
.type conv2_kernel,@function
conv2_kernel:
    s_cmp_ge_u32 s2, 256
    s_cbranch_scc1 L_conv2_kernel_done
    s_load_dwordx2 s[4:5], s[0:1], 72
    s_load_dwordx2 s[30:31], s[0:1], 72
    v_readfirstlane_b32 s20, v0
    s_lshr_b32 s20, s20, 6
    s_and_b32 s36, s2, 0
    s_lshl_b32 s36, s36, 3
    s_bfe_u32 s37, s2, 196611
    s_or_b32 s29, s36, s37
    s_bfe_u32 s36, s2, 196608
    s_lshl_b32 s36, s36, 2
    s_lshr_b32 s37, s2, 6
    s_or_b32 s36, s36, s37
    s_lshr_b32 s33, s36, 4
    s_and_b32 s34, s36, 7
    s_bfe_u32 s35, s36, 0x10003
    s_mul_i32 s21, s34, 500
    s_and_b32 s32, s20, 3
    v_and_b32 v127, 63, v0
    v_lshrrev_b32 v5, 2, v127
    v_and_b32 v6, 3, v127
    s_and_b32 s42, s20, 7
    s_lshr_b32 s41, s21, 2
    s_sub_u32 s41, s41, 1
    s_add_u32 s37, s41, s42
    v_lshl_add_u32 v7, v5, 3, s37
    s_mul_i32 s36, s35, 4194304
    s_add_u32 s36, s36, 18874368
    s_mov_b32 s10, 4194304
    s_mov_b32 s11, 0x00020000
    s_mov_b32 s25, 0xffff0000
    s_waitcnt lgkmcnt(0)
    s_add_u32 s8, s4, s36
    s_addc_u32 s9, s5, 0
    s_cmp_ge_u32 s20, 8
    s_cbranch_scc1 L_conv2_kernel_helper
    s_add_u32 s37, s41, 128
    v_mov_b32 v16, s37
    v_mul_u32_u24 v17, 524288, v5
    v_lshl_add_u32 v17, v6, 4, v17
    s_add_u32 s37, s33, 4294967289
    v_lshl_add_u32 v18, v16, 3, s37
    v_cmp_gt_u32 vcc, 8000, v18
    s_mul_i32 s37, s33, 131072
    s_add_u32 s37, s37, 0
    v_lshl_add_u32 v108, v16, 7, s37
    v_add_u32 v108, v108, v17
    v_mov_b32 v18, 2130706432
    v_cndmask_b32 v108, v18, v108, vcc
    s_add_u32 s37, s33, 4294967291
    v_lshl_add_u32 v18, v16, 3, s37
    v_cmp_gt_u32 vcc, 8000, v18
    s_mul_i32 s37, s33, 131072
    s_add_u32 s37, s37, 262144
    v_lshl_add_u32 v109, v16, 7, s37
    v_add_u32 v109, v109, v17
    v_mov_b32 v18, 2130706432
    v_cndmask_b32 v109, v18, v109, vcc
    s_add_u32 s37, s33, 4294967293
    v_lshl_add_u32 v18, v16, 3, s37
    v_cmp_gt_u32 vcc, 8000, v18
    s_mul_i32 s37, s33, 131072
    s_add_u32 s37, s37, 64
    v_lshl_add_u32 v110, v16, 7, s37
    v_add_u32 v110, v110, v17
    v_mov_b32 v18, 2130706432
    v_cndmask_b32 v110, v18, v110, vcc
    s_lshl_b32 s36, s29, 4
    s_lshl_b32 s37, s33, 3
    s_add_u32 s36, s36, s37
    s_mul_i32 s36, s36, 57344
    s_add_u32 s36, s36, 9437184
    s_add_u32 s12, s30, s36
    s_addc_u32 s13, s31, 0
    s_mov_b32 s14, 458752
    s_mov_b32 s15, 0x00020000
    s_mul_i32 s36, s35, 2097152
    s_add_u32 s36, s36, 27262976
    s_mul_i32 s37, s33, 8388608
    s_add_u32 s36, s36, s37
    s_add_u32 s16, s30, s36
    s_addc_u32 s17, s31, 0
    s_mov_b32 s18, 2097152
    s_mov_b32 s19, 0x00020000
    v_and_b32 v10, 15, v127
    v_lshrrev_b32 v11, 4, v127
    v_add_u32 v8, 0, v10
    v_and_b32 v16, 4, v8
    v_lshrrev_b32 v16, 1, v16
    v_xor_b32 v16, v11, v16
    v_lshlrev_b32 v16, 4, v16
    v_lshl_add_u32 v8, v8, 6, v16
    v_add_u32 v9, 1, v10
    v_and_b32 v16, 4, v9
    v_lshrrev_b32 v16, 1, v16
    v_xor_b32 v16, v11, v16
    v_lshlrev_b32 v16, 4, v16
    v_lshl_add_u32 v9, v9, 6, v16
    s_lshr_b32 s38, s32, 1
    s_and_b32 s39, s32, 1
    s_add_u32 s40, s38, 4
    s_lshl_b32 s43, s39, 10
    s_cmp_lt_u32 s20, 4
    s_cselect_b32 s40, s20, s40
    s_cselect_b32 s36, 0, s43
    s_lshl_b32 s37, s40, 13
    s_add_u32 s37, s37, s36
    v_lshl_add_u32 v125, v127, 4, s37
    s_mul_i32 s37, s40, 16384
    v_add_u32 v120, s37, v8
    v_add_u32 v121, s37, v9
    s_lshl_b32 s37, s40, 10
    s_add_u32 s37, s37, 115712
    v_lshl_add_u32 v16, v11, 4, s37
    v_cmp_eq_u32 vcc, 15, v10
    v_mov_b32 v17, 8192
    v_mov_b32 v18, 4294959104
    v_mov_b32 v19, 64
    v_cndmask_b32 v122, v121, v16, vcc
    v_cndmask_b32 v123, v17, v19, vcc
    v_cndmask_b32 v124, v18, v19, vcc
    v_lshl_add_u32 v126, v127, 4, s37
    s_mov_b32 s44, 0x3f800000
    s_mov_b32 s45, 0x00000000
    s_mov_b32 s46, 0x00000000
    s_cmp_eq_u32 s40, 1
    s_cselect_b32 s45, 0x3f800000, s45
    s_cselect_b32 s46, 0x3f800000, s46
    s_cmp_eq_u32 s40, 2
    s_cselect_b32 s45, 0xbf800000, s45
    s_cselect_b32 s46, 0x3f800000, s46
    s_cmp_eq_u32 s40, 3
    s_cselect_b32 s45, 0x40000000, s45
    s_cselect_b32 s46, 0x40800000, s46
    s_cmp_eq_u32 s40, 4
    s_cselect_b32 s45, 0xc0000000, s45
    s_cselect_b32 s46, 0x40800000, s46
    s_cmp_eq_u32 s40, 5
    s_cselect_b32 s44, 0x41800000, s44
    s_cselect_b32 s45, 0x41000000, s45
    s_cselect_b32 s46, 0x40800000, s46
    s_cmp_ge_u32 s20, 4
    s_cbranch_scc1 L_conv2_kernel_m2
    v_mov_b32 v0, 0
    v_mov_b32 v1, 0
    v_mov_b32 v2, 0
    v_mov_b32 v3, 0
    v_mov_b32 v4, 0
    v_mov_b32 v5, 0
    v_mov_b32 v6, 0
    v_mov_b32 v7, 0
    v_mov_b32 v8, 0
    v_mov_b32 v9, 0
    v_mov_b32 v10, 0
    v_mov_b32 v11, 0
    v_mov_b32 v12, 0
    v_mov_b32 v13, 0
    v_mov_b32 v14, 0
    v_mov_b32 v15, 0
    v_mov_b32 v16, 0
    v_mov_b32 v17, 0
    v_mov_b32 v18, 0
    v_mov_b32 v19, 0
    v_mov_b32 v20, 0
    v_mov_b32 v21, 0
    v_mov_b32 v22, 0
    v_mov_b32 v23, 0
    v_mov_b32 v24, 0
    v_mov_b32 v25, 0
    v_mov_b32 v26, 0
    v_mov_b32 v27, 0
    v_mov_b32 v28, 0
    v_mov_b32 v29, 0
    v_mov_b32 v30, 0
    v_mov_b32 v31, 0
    v_mov_b32 v32, 0
    v_mov_b32 v33, 0
    v_mov_b32 v34, 0
    v_mov_b32 v35, 0
    v_mov_b32 v36, 0
    v_mov_b32 v37, 0
    v_mov_b32 v38, 0
    v_mov_b32 v39, 0
    v_mov_b32 v40, 0
    v_mov_b32 v41, 0
    v_mov_b32 v42, 0
    v_mov_b32 v43, 0
    v_mov_b32 v44, 0
    v_mov_b32 v45, 0
    v_mov_b32 v46, 0
    v_mov_b32 v47, 0
    v_mov_b32 v48, 0
    v_mov_b32 v49, 0
    v_mov_b32 v50, 0
    v_mov_b32 v51, 0
    v_mov_b32 v52, 0
    v_mov_b32 v53, 0
    v_mov_b32 v54, 0
    v_mov_b32 v55, 0
    v_mov_b32 v56, 0
    v_mov_b32 v57, 0
    v_mov_b32 v58, 0
    v_mov_b32 v59, 0
    v_mov_b32 v60, 0
    v_mov_b32 v61, 0
    v_mov_b32 v62, 0
    v_mov_b32 v63, 0
    s_barrier
    buffer_load_dwordx4 v[96:99], v108, s[8:11], 0 offen
    buffer_load_dwordx4 v[100:103], v109, s[8:11], 0 offen
    buffer_load_dwordx4 v[104:107], v110, s[8:11], 0 offen
    s_mov_b32 s23, 0
    s_mov_b32 s26, 4096
    buffer_load_dwordx4 v[64:67], v125, s[12:15], s23 offen offset:0
    buffer_load_dwordx4 v[68:71], v125, s[12:15], s23 offen offset:1024
    buffer_load_dwordx4 v[72:75], v125, s[12:15], s23 offen offset:2048
    buffer_load_dwordx4 v[76:79], v125, s[12:15], s23 offen offset:3072
    buffer_load_dwordx4 v[80:83], v125, s[12:15], s26 offen offset:0
    buffer_load_dwordx4 v[84:87], v125, s[12:15], s26 offen offset:1024
    buffer_load_dwordx4 v[88:91], v125, s[12:15], s26 offen offset:2048
    buffer_load_dwordx4 v[92:95], v125, s[12:15], s26 offen offset:3072
    s_mov_b32 s23, 57344
    s_mov_b32 s26, 61440
    s_waitcnt vmcnt(8)
    v_lshlrev_b32 v108, 16, v96
    v_and_b32 v111, s25, v96
    v_lshlrev_b32 v109, 16, v100
    v_and_b32 v112, s25, v100
    v_lshlrev_b32 v110, 16, v104
    v_and_b32 v113, s25, v104
    v_mul_f32 v114, s44, v108
    v_mul_f32 v115, s44, v111
    v_fmac_f32 v114, s45, v109
    v_fmac_f32 v115, s45, v112
    v_fmac_f32 v114, s46, v110
    v_fmac_f32 v115, s46, v113
    v_cvt_pk_bf16_f32 v96, v114, v115
    v_lshlrev_b32 v108, 16, v97
    v_and_b32 v111, s25, v97
    v_lshlrev_b32 v109, 16, v101
    v_and_b32 v112, s25, v101
    v_lshlrev_b32 v110, 16, v105
    v_and_b32 v113, s25, v105
    v_mul_f32 v114, s44, v108
    v_mul_f32 v115, s44, v111
    v_fmac_f32 v114, s45, v109
    v_fmac_f32 v115, s45, v112
    v_fmac_f32 v114, s46, v110
    v_fmac_f32 v115, s46, v113
    v_cvt_pk_bf16_f32 v97, v114, v115
    v_lshlrev_b32 v108, 16, v98
    v_and_b32 v111, s25, v98
    v_lshlrev_b32 v109, 16, v102
    v_and_b32 v112, s25, v102
    v_lshlrev_b32 v110, 16, v106
    v_and_b32 v113, s25, v106
    v_mul_f32 v114, s44, v108
    v_mul_f32 v115, s44, v111
    v_fmac_f32 v114, s45, v109
    v_fmac_f32 v115, s45, v112
    v_fmac_f32 v114, s46, v110
    v_fmac_f32 v115, s46, v113
    v_cvt_pk_bf16_f32 v98, v114, v115
    v_lshlrev_b32 v108, 16, v99
    v_and_b32 v111, s25, v99
    v_lshlrev_b32 v109, 16, v103
    v_and_b32 v112, s25, v103
    v_lshlrev_b32 v110, 16, v107
    v_and_b32 v113, s25, v107
    v_mul_f32 v114, s44, v108
    v_mul_f32 v115, s44, v111
    v_fmac_f32 v114, s45, v109
    v_fmac_f32 v115, s45, v112
    v_fmac_f32 v114, s46, v110
    v_fmac_f32 v115, s46, v113
    v_cvt_pk_bf16_f32 v99, v114, v115
    ds_write_b128 v126, v[96:99]
    s_waitcnt lgkmcnt(0)
    s_barrier
    s_mov_b32 s22, 4
    s_setprio 2
L_conv2_kernel_mloop1:
    ds_read_b128 v[96:99], v120 offset:0
    ds_read_b128 v[100:103], v120 offset:1024
    ds_read_b128 v[104:107], v120 offset:2048
    ds_read_b128 v[108:111], v120 offset:3072
    ds_read_b128 v[112:115], v120 offset:4096
    ds_read_b128 v[116:119], v120 offset:5120
    s_waitcnt vmcnt(6) lgkmcnt(5)
    v_mfma_f32_16x16x32_bf16 v[0:3], v[64:67], v[96:99], v[0:3]
    v_mfma_f32_16x16x32_bf16 v[32:35], v[68:71], v[96:99], v[32:35]
    ds_read_b128 v[96:99], v120 offset:6144
    s_waitcnt vmcnt(4) lgkmcnt(5)
    v_mfma_f32_16x16x32_bf16 v[4:7], v[64:67], v[100:103], v[4:7]
    v_mfma_f32_16x16x32_bf16 v[36:39], v[68:71], v[100:103], v[36:39]
    v_mfma_f32_16x16x32_bf16 v[0:3], v[72:75], v[100:103], v[0:3]
    v_mfma_f32_16x16x32_bf16 v[32:35], v[76:79], v[100:103], v[32:35]
    ds_read_b128 v[100:103], v120 offset:7168
    s_waitcnt vmcnt(2) lgkmcnt(5)
    v_mfma_f32_16x16x32_bf16 v[8:11], v[64:67], v[104:107], v[8:11]
    v_mfma_f32_16x16x32_bf16 v[40:43], v[68:71], v[104:107], v[40:43]
    v_mfma_f32_16x16x32_bf16 v[4:7], v[72:75], v[104:107], v[4:7]
    v_mfma_f32_16x16x32_bf16 v[36:39], v[76:79], v[104:107], v[36:39]
    v_mfma_f32_16x16x32_bf16 v[0:3], v[80:83], v[104:107], v[0:3]
    v_mfma_f32_16x16x32_bf16 v[32:35], v[84:87], v[104:107], v[32:35]
    ds_read_b128 v[104:107], v122 offset:0
    v_add_u32 v122, v123, v122
    s_waitcnt vmcnt(0) lgkmcnt(5)
    v_mfma_f32_16x16x32_bf16 v[12:15], v[64:67], v[108:111], v[12:15]
    v_mfma_f32_16x16x32_bf16 v[44:47], v[68:71], v[108:111], v[44:47]
    v_mfma_f32_16x16x32_bf16 v[8:11], v[72:75], v[108:111], v[8:11]
    v_mfma_f32_16x16x32_bf16 v[40:43], v[76:79], v[108:111], v[40:43]
    v_mfma_f32_16x16x32_bf16 v[4:7], v[80:83], v[108:111], v[4:7]
    v_mfma_f32_16x16x32_bf16 v[36:39], v[84:87], v[108:111], v[36:39]
    v_mfma_f32_16x16x32_bf16 v[0:3], v[88:91], v[108:111], v[0:3]
    v_mfma_f32_16x16x32_bf16 v[32:35], v[92:95], v[108:111], v[32:35]
    ds_read_b128 v[108:111], v121 offset:1024
    s_waitcnt lgkmcnt(5)
    v_mfma_f32_16x16x32_bf16 v[16:19], v[64:67], v[112:115], v[16:19]
    v_mfma_f32_16x16x32_bf16 v[48:51], v[68:71], v[112:115], v[48:51]
    v_mfma_f32_16x16x32_bf16 v[12:15], v[72:75], v[112:115], v[12:15]
    v_mfma_f32_16x16x32_bf16 v[44:47], v[76:79], v[112:115], v[44:47]
    v_mfma_f32_16x16x32_bf16 v[8:11], v[80:83], v[112:115], v[8:11]
    v_mfma_f32_16x16x32_bf16 v[40:43], v[84:87], v[112:115], v[40:43]
    v_mfma_f32_16x16x32_bf16 v[4:7], v[88:91], v[112:115], v[4:7]
    v_mfma_f32_16x16x32_bf16 v[36:39], v[92:95], v[112:115], v[36:39]
    ds_read_b128 v[112:115], v121 offset:2048
    s_waitcnt lgkmcnt(5)
    v_mfma_f32_16x16x32_bf16 v[20:23], v[64:67], v[116:119], v[20:23]
    v_mfma_f32_16x16x32_bf16 v[52:55], v[68:71], v[116:119], v[52:55]
    v_mfma_f32_16x16x32_bf16 v[16:19], v[72:75], v[116:119], v[16:19]
    v_mfma_f32_16x16x32_bf16 v[48:51], v[76:79], v[116:119], v[48:51]
    v_mfma_f32_16x16x32_bf16 v[12:15], v[80:83], v[116:119], v[12:15]
    v_mfma_f32_16x16x32_bf16 v[44:47], v[84:87], v[116:119], v[44:47]
    v_mfma_f32_16x16x32_bf16 v[8:11], v[88:91], v[116:119], v[8:11]
    v_mfma_f32_16x16x32_bf16 v[40:43], v[92:95], v[116:119], v[40:43]
    s_waitcnt lgkmcnt(4)
    v_mfma_f32_16x16x32_bf16 v[24:27], v[64:67], v[96:99], v[24:27]
    v_mfma_f32_16x16x32_bf16 v[56:59], v[68:71], v[96:99], v[56:59]
    v_mfma_f32_16x16x32_bf16 v[20:23], v[72:75], v[96:99], v[20:23]
    v_mfma_f32_16x16x32_bf16 v[52:55], v[76:79], v[96:99], v[52:55]
    v_mfma_f32_16x16x32_bf16 v[16:19], v[80:83], v[96:99], v[16:19]
    v_mfma_f32_16x16x32_bf16 v[48:51], v[84:87], v[96:99], v[48:51]
    v_mfma_f32_16x16x32_bf16 v[12:15], v[88:91], v[96:99], v[12:15]
    v_mfma_f32_16x16x32_bf16 v[44:47], v[92:95], v[96:99], v[44:47]
    s_waitcnt lgkmcnt(3)
    v_mfma_f32_16x16x32_bf16 v[28:31], v[64:67], v[100:103], v[28:31]
    v_mfma_f32_16x16x32_bf16 v[60:63], v[68:71], v[100:103], v[60:63]
    v_mfma_f32_16x16x32_bf16 v[24:27], v[72:75], v[100:103], v[24:27]
    v_mfma_f32_16x16x32_bf16 v[56:59], v[76:79], v[100:103], v[56:59]
    v_mfma_f32_16x16x32_bf16 v[20:23], v[80:83], v[100:103], v[20:23]
    v_mfma_f32_16x16x32_bf16 v[52:55], v[84:87], v[100:103], v[52:55]
    v_mfma_f32_16x16x32_bf16 v[16:19], v[88:91], v[100:103], v[16:19]
    v_mfma_f32_16x16x32_bf16 v[48:51], v[92:95], v[100:103], v[48:51]
    buffer_load_dwordx4 v[64:67], v125, s[12:15], s23 offen offset:0
    buffer_load_dwordx4 v[68:71], v125, s[12:15], s23 offen offset:1024
    s_waitcnt lgkmcnt(2)
    v_mfma_f32_16x16x32_bf16 v[28:31], v[72:75], v[104:107], v[28:31]
    v_mfma_f32_16x16x32_bf16 v[60:63], v[76:79], v[104:107], v[60:63]
    v_mfma_f32_16x16x32_bf16 v[24:27], v[80:83], v[104:107], v[24:27]
    v_mfma_f32_16x16x32_bf16 v[56:59], v[84:87], v[104:107], v[56:59]
    v_mfma_f32_16x16x32_bf16 v[20:23], v[88:91], v[104:107], v[20:23]
    v_mfma_f32_16x16x32_bf16 v[52:55], v[92:95], v[104:107], v[52:55]
    buffer_load_dwordx4 v[72:75], v125, s[12:15], s23 offen offset:2048
    buffer_load_dwordx4 v[76:79], v125, s[12:15], s23 offen offset:3072
    s_waitcnt lgkmcnt(1)
    v_mfma_f32_16x16x32_bf16 v[28:31], v[80:83], v[108:111], v[28:31]
    v_mfma_f32_16x16x32_bf16 v[60:63], v[84:87], v[108:111], v[60:63]
    v_mfma_f32_16x16x32_bf16 v[24:27], v[88:91], v[108:111], v[24:27]
    v_mfma_f32_16x16x32_bf16 v[56:59], v[92:95], v[108:111], v[56:59]
    buffer_load_dwordx4 v[80:83], v125, s[12:15], s26 offen offset:0
    buffer_load_dwordx4 v[84:87], v125, s[12:15], s26 offen offset:1024
    s_waitcnt lgkmcnt(0)
    v_mfma_f32_16x16x32_bf16 v[28:31], v[88:91], v[112:115], v[28:31]
    v_mfma_f32_16x16x32_bf16 v[60:63], v[92:95], v[112:115], v[60:63]
    buffer_load_dwordx4 v[88:91], v125, s[12:15], s26 offen offset:2048
    buffer_load_dwordx4 v[92:95], v125, s[12:15], s26 offen offset:3072
    s_add_u32 s23, s23, 57344
    s_add_u32 s26, s26, 57344
    s_barrier
    s_sub_u32 s22, s22, 1
    s_cmp_eq_u32 s22, 0
    s_cbranch_scc1 L_conv2_kernel_mlast1
    ds_read_b128 v[96:99], v120 offset:8192
    ds_read_b128 v[100:103], v120 offset:9216
    ds_read_b128 v[104:107], v120 offset:10240
    ds_read_b128 v[108:111], v120 offset:11264
    ds_read_b128 v[112:115], v120 offset:12288
    ds_read_b128 v[116:119], v120 offset:13312
    s_waitcnt vmcnt(6) lgkmcnt(5)
    v_mfma_f32_16x16x32_bf16 v[0:3], v[64:67], v[96:99], v[0:3]
    v_mfma_f32_16x16x32_bf16 v[32:35], v[68:71], v[96:99], v[32:35]
    ds_read_b128 v[96:99], v120 offset:14336
    s_waitcnt vmcnt(4) lgkmcnt(5)
    v_mfma_f32_16x16x32_bf16 v[4:7], v[64:67], v[100:103], v[4:7]
    v_mfma_f32_16x16x32_bf16 v[36:39], v[68:71], v[100:103], v[36:39]
    v_mfma_f32_16x16x32_bf16 v[0:3], v[72:75], v[100:103], v[0:3]
    v_mfma_f32_16x16x32_bf16 v[32:35], v[76:79], v[100:103], v[32:35]
    ds_read_b128 v[100:103], v120 offset:15360
    s_waitcnt vmcnt(2) lgkmcnt(5)
    v_mfma_f32_16x16x32_bf16 v[8:11], v[64:67], v[104:107], v[8:11]
    v_mfma_f32_16x16x32_bf16 v[40:43], v[68:71], v[104:107], v[40:43]
    v_mfma_f32_16x16x32_bf16 v[4:7], v[72:75], v[104:107], v[4:7]
    v_mfma_f32_16x16x32_bf16 v[36:39], v[76:79], v[104:107], v[36:39]
    v_mfma_f32_16x16x32_bf16 v[0:3], v[80:83], v[104:107], v[0:3]
    v_mfma_f32_16x16x32_bf16 v[32:35], v[84:87], v[104:107], v[32:35]
    ds_read_b128 v[104:107], v122 offset:0
    v_add_u32 v122, v124, v122
    s_waitcnt vmcnt(0) lgkmcnt(5)
    v_mfma_f32_16x16x32_bf16 v[12:15], v[64:67], v[108:111], v[12:15]
    v_mfma_f32_16x16x32_bf16 v[44:47], v[68:71], v[108:111], v[44:47]
    v_mfma_f32_16x16x32_bf16 v[8:11], v[72:75], v[108:111], v[8:11]
    v_mfma_f32_16x16x32_bf16 v[40:43], v[76:79], v[108:111], v[40:43]
    v_mfma_f32_16x16x32_bf16 v[4:7], v[80:83], v[108:111], v[4:7]
    v_mfma_f32_16x16x32_bf16 v[36:39], v[84:87], v[108:111], v[36:39]
    v_mfma_f32_16x16x32_bf16 v[0:3], v[88:91], v[108:111], v[0:3]
    v_mfma_f32_16x16x32_bf16 v[32:35], v[92:95], v[108:111], v[32:35]
    ds_read_b128 v[108:111], v121 offset:9216
    s_waitcnt lgkmcnt(5)
    v_mfma_f32_16x16x32_bf16 v[16:19], v[64:67], v[112:115], v[16:19]
    v_mfma_f32_16x16x32_bf16 v[48:51], v[68:71], v[112:115], v[48:51]
    v_mfma_f32_16x16x32_bf16 v[12:15], v[72:75], v[112:115], v[12:15]
    v_mfma_f32_16x16x32_bf16 v[44:47], v[76:79], v[112:115], v[44:47]
    v_mfma_f32_16x16x32_bf16 v[8:11], v[80:83], v[112:115], v[8:11]
    v_mfma_f32_16x16x32_bf16 v[40:43], v[84:87], v[112:115], v[40:43]
    v_mfma_f32_16x16x32_bf16 v[4:7], v[88:91], v[112:115], v[4:7]
    v_mfma_f32_16x16x32_bf16 v[36:39], v[92:95], v[112:115], v[36:39]
    ds_read_b128 v[112:115], v121 offset:10240
    s_waitcnt lgkmcnt(5)
    v_mfma_f32_16x16x32_bf16 v[20:23], v[64:67], v[116:119], v[20:23]
    v_mfma_f32_16x16x32_bf16 v[52:55], v[68:71], v[116:119], v[52:55]
    v_mfma_f32_16x16x32_bf16 v[16:19], v[72:75], v[116:119], v[16:19]
    v_mfma_f32_16x16x32_bf16 v[48:51], v[76:79], v[116:119], v[48:51]
    v_mfma_f32_16x16x32_bf16 v[12:15], v[80:83], v[116:119], v[12:15]
    v_mfma_f32_16x16x32_bf16 v[44:47], v[84:87], v[116:119], v[44:47]
    v_mfma_f32_16x16x32_bf16 v[8:11], v[88:91], v[116:119], v[8:11]
    v_mfma_f32_16x16x32_bf16 v[40:43], v[92:95], v[116:119], v[40:43]
    s_waitcnt lgkmcnt(4)
    v_mfma_f32_16x16x32_bf16 v[24:27], v[64:67], v[96:99], v[24:27]
    v_mfma_f32_16x16x32_bf16 v[56:59], v[68:71], v[96:99], v[56:59]
    v_mfma_f32_16x16x32_bf16 v[20:23], v[72:75], v[96:99], v[20:23]
    v_mfma_f32_16x16x32_bf16 v[52:55], v[76:79], v[96:99], v[52:55]
    v_mfma_f32_16x16x32_bf16 v[16:19], v[80:83], v[96:99], v[16:19]
    v_mfma_f32_16x16x32_bf16 v[48:51], v[84:87], v[96:99], v[48:51]
    v_mfma_f32_16x16x32_bf16 v[12:15], v[88:91], v[96:99], v[12:15]
    v_mfma_f32_16x16x32_bf16 v[44:47], v[92:95], v[96:99], v[44:47]
    s_waitcnt lgkmcnt(3)
    v_mfma_f32_16x16x32_bf16 v[28:31], v[64:67], v[100:103], v[28:31]
    v_mfma_f32_16x16x32_bf16 v[60:63], v[68:71], v[100:103], v[60:63]
    v_mfma_f32_16x16x32_bf16 v[24:27], v[72:75], v[100:103], v[24:27]
    v_mfma_f32_16x16x32_bf16 v[56:59], v[76:79], v[100:103], v[56:59]
    v_mfma_f32_16x16x32_bf16 v[20:23], v[80:83], v[100:103], v[20:23]
    v_mfma_f32_16x16x32_bf16 v[52:55], v[84:87], v[100:103], v[52:55]
    v_mfma_f32_16x16x32_bf16 v[16:19], v[88:91], v[100:103], v[16:19]
    v_mfma_f32_16x16x32_bf16 v[48:51], v[92:95], v[100:103], v[48:51]
    buffer_load_dwordx4 v[64:67], v125, s[12:15], s23 offen offset:0
    buffer_load_dwordx4 v[68:71], v125, s[12:15], s23 offen offset:1024
    s_waitcnt lgkmcnt(2)
    v_mfma_f32_16x16x32_bf16 v[28:31], v[72:75], v[104:107], v[28:31]
    v_mfma_f32_16x16x32_bf16 v[60:63], v[76:79], v[104:107], v[60:63]
    v_mfma_f32_16x16x32_bf16 v[24:27], v[80:83], v[104:107], v[24:27]
    v_mfma_f32_16x16x32_bf16 v[56:59], v[84:87], v[104:107], v[56:59]
    v_mfma_f32_16x16x32_bf16 v[20:23], v[88:91], v[104:107], v[20:23]
    v_mfma_f32_16x16x32_bf16 v[52:55], v[92:95], v[104:107], v[52:55]
    buffer_load_dwordx4 v[72:75], v125, s[12:15], s23 offen offset:2048
    buffer_load_dwordx4 v[76:79], v125, s[12:15], s23 offen offset:3072
    s_waitcnt lgkmcnt(1)
    v_mfma_f32_16x16x32_bf16 v[28:31], v[80:83], v[108:111], v[28:31]
    v_mfma_f32_16x16x32_bf16 v[60:63], v[84:87], v[108:111], v[60:63]
    v_mfma_f32_16x16x32_bf16 v[24:27], v[88:91], v[108:111], v[24:27]
    v_mfma_f32_16x16x32_bf16 v[56:59], v[92:95], v[108:111], v[56:59]
    buffer_load_dwordx4 v[80:83], v125, s[12:15], s26 offen offset:0
    buffer_load_dwordx4 v[84:87], v125, s[12:15], s26 offen offset:1024
    s_waitcnt lgkmcnt(0)
    v_mfma_f32_16x16x32_bf16 v[28:31], v[88:91], v[112:115], v[28:31]
    v_mfma_f32_16x16x32_bf16 v[60:63], v[92:95], v[112:115], v[60:63]
    buffer_load_dwordx4 v[88:91], v125, s[12:15], s26 offen offset:2048
    buffer_load_dwordx4 v[92:95], v125, s[12:15], s26 offen offset:3072
    s_add_u32 s23, s23, 57344
    s_add_u32 s26, s26, 57344
    s_barrier
    s_branch L_conv2_kernel_mloop1
L_conv2_kernel_mlast1:
    v_and_b32 v125, 15, v127
    v_and_b32 v126, 7, v127
    v_lshlrev_b32 v126, 4, v126
    v_lshl_add_u32 v125, v125, 7, v126
    v_lshrrev_b32 v126, 4, v127
    v_lshl_add_u32 v125, v126, 11, v125
    s_lshl_b32 s36, s20, 14
    s_add_u32 s37, s36, 8192
    v_add_u32 v126, s37, v125
    v_add_u32 v125, s36, v125
    ds_read_b128 v[96:99], v120 offset:8192
    ds_read_b128 v[100:103], v120 offset:9216
    ds_read_b128 v[104:107], v120 offset:10240
    ds_read_b128 v[108:111], v120 offset:11264
    ds_read_b128 v[112:115], v120 offset:12288
    ds_read_b128 v[116:119], v120 offset:13312
    s_waitcnt vmcnt(6) lgkmcnt(5)
    v_mfma_f32_16x16x32_bf16 v[0:3], v[64:67], v[96:99], v[0:3]
    v_mfma_f32_16x16x32_bf16 v[32:35], v[68:71], v[96:99], v[32:35]
    ds_read_b128 v[96:99], v120 offset:14336
    s_waitcnt vmcnt(4) lgkmcnt(5)
    v_mfma_f32_16x16x32_bf16 v[4:7], v[64:67], v[100:103], v[4:7]
    v_mfma_f32_16x16x32_bf16 v[36:39], v[68:71], v[100:103], v[36:39]
    v_mfma_f32_16x16x32_bf16 v[0:3], v[72:75], v[100:103], v[0:3]
    v_mfma_f32_16x16x32_bf16 v[32:35], v[76:79], v[100:103], v[32:35]
    ds_read_b128 v[100:103], v120 offset:15360
    s_waitcnt vmcnt(2) lgkmcnt(5)
    v_mfma_f32_16x16x32_bf16 v[8:11], v[64:67], v[104:107], v[8:11]
    v_mfma_f32_16x16x32_bf16 v[40:43], v[68:71], v[104:107], v[40:43]
    v_mfma_f32_16x16x32_bf16 v[4:7], v[72:75], v[104:107], v[4:7]
    v_mfma_f32_16x16x32_bf16 v[36:39], v[76:79], v[104:107], v[36:39]
    v_mfma_f32_16x16x32_bf16 v[0:3], v[80:83], v[104:107], v[0:3]
    v_mfma_f32_16x16x32_bf16 v[32:35], v[84:87], v[104:107], v[32:35]
    ds_read_b128 v[104:107], v122 offset:0
    s_waitcnt vmcnt(0) lgkmcnt(5)
    v_mfma_f32_16x16x32_bf16 v[12:15], v[64:67], v[108:111], v[12:15]
    v_mfma_f32_16x16x32_bf16 v[44:47], v[68:71], v[108:111], v[44:47]
    v_mfma_f32_16x16x32_bf16 v[8:11], v[72:75], v[108:111], v[8:11]
    v_mfma_f32_16x16x32_bf16 v[40:43], v[76:79], v[108:111], v[40:43]
    v_mfma_f32_16x16x32_bf16 v[4:7], v[80:83], v[108:111], v[4:7]
    v_mfma_f32_16x16x32_bf16 v[36:39], v[84:87], v[108:111], v[36:39]
    v_mfma_f32_16x16x32_bf16 v[0:3], v[88:91], v[108:111], v[0:3]
    v_mfma_f32_16x16x32_bf16 v[32:35], v[92:95], v[108:111], v[32:35]
    ds_read_b128 v[108:111], v121 offset:9216
    s_waitcnt lgkmcnt(5)
    v_mfma_f32_16x16x32_bf16 v[16:19], v[64:67], v[112:115], v[16:19]
    v_mfma_f32_16x16x32_bf16 v[48:51], v[68:71], v[112:115], v[48:51]
    v_mfma_f32_16x16x32_bf16 v[12:15], v[72:75], v[112:115], v[12:15]
    v_mfma_f32_16x16x32_bf16 v[44:47], v[76:79], v[112:115], v[44:47]
    v_mfma_f32_16x16x32_bf16 v[8:11], v[80:83], v[112:115], v[8:11]
    v_mfma_f32_16x16x32_bf16 v[40:43], v[84:87], v[112:115], v[40:43]
    v_mfma_f32_16x16x32_bf16 v[4:7], v[88:91], v[112:115], v[4:7]
    v_mfma_f32_16x16x32_bf16 v[36:39], v[92:95], v[112:115], v[36:39]
    ds_read_b128 v[112:115], v121 offset:10240
    v_xor_b32 v123, 0, v125
    ds_write_b128 v123, v[0:3]
    s_waitcnt lgkmcnt(6)
    v_mfma_f32_16x16x32_bf16 v[20:23], v[64:67], v[116:119], v[20:23]
    v_mfma_f32_16x16x32_bf16 v[52:55], v[68:71], v[116:119], v[52:55]
    v_mfma_f32_16x16x32_bf16 v[16:19], v[72:75], v[116:119], v[16:19]
    v_mfma_f32_16x16x32_bf16 v[48:51], v[76:79], v[116:119], v[48:51]
    v_mfma_f32_16x16x32_bf16 v[12:15], v[80:83], v[116:119], v[12:15]
    v_mfma_f32_16x16x32_bf16 v[44:47], v[84:87], v[116:119], v[44:47]
    v_mfma_f32_16x16x32_bf16 v[8:11], v[88:91], v[116:119], v[8:11]
    v_mfma_f32_16x16x32_bf16 v[40:43], v[92:95], v[116:119], v[40:43]
    v_xor_b32 v124, 16, v125
    ds_write_b128 v124, v[4:7]
    s_waitcnt lgkmcnt(2)
    v_mfma_f32_16x16x32_bf16 v[24:27], v[64:67], v[96:99], v[24:27]
    v_mfma_f32_16x16x32_bf16 v[56:59], v[68:71], v[96:99], v[56:59]
    v_mfma_f32_16x16x32_bf16 v[20:23], v[72:75], v[96:99], v[20:23]
    v_mfma_f32_16x16x32_bf16 v[52:55], v[76:79], v[96:99], v[52:55]
    v_mfma_f32_16x16x32_bf16 v[16:19], v[80:83], v[96:99], v[16:19]
    v_mfma_f32_16x16x32_bf16 v[48:51], v[84:87], v[96:99], v[48:51]
    v_mfma_f32_16x16x32_bf16 v[12:15], v[88:91], v[96:99], v[12:15]
    v_mfma_f32_16x16x32_bf16 v[44:47], v[92:95], v[96:99], v[44:47]
    v_xor_b32 v123, 32, v125
    ds_write_b128 v123, v[8:11]
    v_xor_b32 v124, 0, v126
    ds_write_b128 v124, v[32:35]
    v_mfma_f32_16x16x32_bf16 v[28:31], v[64:67], v[100:103], v[28:31]
    v_mfma_f32_16x16x32_bf16 v[60:63], v[68:71], v[100:103], v[60:63]
    v_mfma_f32_16x16x32_bf16 v[24:27], v[72:75], v[100:103], v[24:27]
    v_mfma_f32_16x16x32_bf16 v[56:59], v[76:79], v[100:103], v[56:59]
    v_mfma_f32_16x16x32_bf16 v[20:23], v[80:83], v[100:103], v[20:23]
    v_mfma_f32_16x16x32_bf16 v[52:55], v[84:87], v[100:103], v[52:55]
    v_mfma_f32_16x16x32_bf16 v[16:19], v[88:91], v[100:103], v[16:19]
    v_mfma_f32_16x16x32_bf16 v[48:51], v[92:95], v[100:103], v[48:51]
    v_xor_b32 v123, 16, v126
    ds_write_b128 v123, v[36:39]
    v_xor_b32 v124, 32, v126
    ds_write_b128 v124, v[40:43]
    v_mfma_f32_16x16x32_bf16 v[28:31], v[72:75], v[104:107], v[28:31]
    v_mfma_f32_16x16x32_bf16 v[60:63], v[76:79], v[104:107], v[60:63]
    v_mfma_f32_16x16x32_bf16 v[24:27], v[80:83], v[104:107], v[24:27]
    v_mfma_f32_16x16x32_bf16 v[56:59], v[84:87], v[104:107], v[56:59]
    v_mfma_f32_16x16x32_bf16 v[20:23], v[88:91], v[104:107], v[20:23]
    v_mfma_f32_16x16x32_bf16 v[52:55], v[92:95], v[104:107], v[52:55]
    v_xor_b32 v124, 48, v125
    ds_write_b128 v124, v[12:15]
    v_xor_b32 v123, 48, v126
    ds_write_b128 v123, v[44:47]
    v_mfma_f32_16x16x32_bf16 v[28:31], v[80:83], v[108:111], v[28:31]
    v_mfma_f32_16x16x32_bf16 v[60:63], v[84:87], v[108:111], v[60:63]
    v_mfma_f32_16x16x32_bf16 v[24:27], v[88:91], v[108:111], v[24:27]
    v_mfma_f32_16x16x32_bf16 v[56:59], v[92:95], v[108:111], v[56:59]
    v_xor_b32 v123, 64, v125
    ds_write_b128 v123, v[16:19]
    v_xor_b32 v124, 64, v126
    ds_write_b128 v124, v[48:51]
    v_mfma_f32_16x16x32_bf16 v[28:31], v[88:91], v[112:115], v[28:31]
    v_mfma_f32_16x16x32_bf16 v[60:63], v[92:95], v[112:115], v[60:63]
    v_xor_b32 v124, 80, v125
    ds_write_b128 v124, v[20:23]
    v_xor_b32 v123, 80, v126
    ds_write_b128 v123, v[52:55]
    s_nop 7
    v_xor_b32 v123, 96, v125
    ds_write_b128 v123, v[24:27]
    v_xor_b32 v124, 96, v126
    ds_write_b128 v124, v[56:59]
    v_xor_b32 v124, 112, v125
    ds_write_b128 v124, v[28:31]
    v_xor_b32 v123, 112, v126
    s_waitcnt lgkmcnt(8)
    ds_write_b128 v123, v[60:63]
    s_setprio 0
    s_branch L_conv2_kernel_epi
L_conv2_kernel_m2:
    s_mul_i32 s37, s38, 2176
    s_add_u32 s37, s37, 98304
    v_add_u32 v116, s37, v8
    v_add_u32 v118, s37, v9
    v_add_u32 v117, 104832, v8
    s_cmp_eq_u32 s38, 0
    s_cbranch_scc1 L_conv2_kernel_hh0
    v_add_u32 v117, 98304, v9
L_conv2_kernel_hh0:
    s_lshl_b32 s37, s38, 12
    s_add_u32 s37, s37, s43
    s_add_u32 s37, s37, 49152
    v_lshl_add_u32 v119, v127, 4, s37
    v_mov_b32 v0, 0
    v_mov_b32 v1, 0
    v_mov_b32 v2, 0
    v_mov_b32 v3, 0
    v_mov_b32 v4, 0
    v_mov_b32 v5, 0
    v_mov_b32 v6, 0
    v_mov_b32 v7, 0
    v_mov_b32 v8, 0
    v_mov_b32 v9, 0
    v_mov_b32 v10, 0
    v_mov_b32 v11, 0
    v_mov_b32 v12, 0
    v_mov_b32 v13, 0
    v_mov_b32 v14, 0
    v_mov_b32 v15, 0
    v_mov_b32 v16, 0
    v_mov_b32 v17, 0
    v_mov_b32 v18, 0
    v_mov_b32 v19, 0
    v_mov_b32 v20, 0
    v_mov_b32 v21, 0
    v_mov_b32 v22, 0
    v_mov_b32 v23, 0
    v_mov_b32 v24, 0
    v_mov_b32 v25, 0
    v_mov_b32 v26, 0
    v_mov_b32 v27, 0
    v_mov_b32 v28, 0
    v_mov_b32 v29, 0
    v_mov_b32 v30, 0
    v_mov_b32 v31, 0
    v_mov_b32 v32, 0
    v_mov_b32 v33, 0
    v_mov_b32 v34, 0
    v_mov_b32 v35, 0
    v_mov_b32 v36, 0
    v_mov_b32 v37, 0
    v_mov_b32 v38, 0
    v_mov_b32 v39, 0
    v_mov_b32 v40, 0
    v_mov_b32 v41, 0
    v_mov_b32 v42, 0
    v_mov_b32 v43, 0
    v_mov_b32 v44, 0
    v_mov_b32 v45, 0
    v_mov_b32 v46, 0
    v_mov_b32 v47, 0
    v_mov_b32 v48, 0
    v_mov_b32 v49, 0
    v_mov_b32 v50, 0
    v_mov_b32 v51, 0
    v_mov_b32 v52, 0
    v_mov_b32 v53, 0
    v_mov_b32 v54, 0
    v_mov_b32 v55, 0
    v_mov_b32 v56, 0
    v_mov_b32 v57, 0
    v_mov_b32 v58, 0
    v_mov_b32 v59, 0
    v_mov_b32 v60, 0
    v_mov_b32 v61, 0
    v_mov_b32 v62, 0
    v_mov_b32 v63, 0
    s_barrier
    buffer_load_dwordx4 v[96:99], v108, s[8:11], 0 offen
    buffer_load_dwordx4 v[100:103], v109, s[8:11], 0 offen
    buffer_load_dwordx4 v[104:107], v110, s[8:11], 0 offen
    s_mov_b32 s23, 0
    s_mov_b32 s26, 4096
    buffer_load_dwordx4 v[64:67], v125, s[12:15], s23 offen offset:0
    buffer_load_dwordx4 v[68:71], v125, s[12:15], s23 offen offset:2048
    buffer_load_dwordx4 v[80:83], v119, s[12:15], s23 offen offset:0
    buffer_load_dwordx4 v[72:75], v125, s[12:15], s26 offen offset:0
    buffer_load_dwordx4 v[84:87], v119, s[12:15], s23 offen offset:2048
    buffer_load_dwordx4 v[76:79], v125, s[12:15], s26 offen offset:2048
    s_mov_b32 s23, 57344
    s_mov_b32 s26, 61440
    s_waitcnt vmcnt(6)
    v_lshlrev_b32 v108, 16, v96
    v_and_b32 v111, s25, v96
    v_lshlrev_b32 v109, 16, v100
    v_and_b32 v112, s25, v100
    v_lshlrev_b32 v110, 16, v104
    v_and_b32 v113, s25, v104
    v_mul_f32 v114, s44, v108
    v_mul_f32 v115, s44, v111
    v_fmac_f32 v114, s45, v109
    v_fmac_f32 v115, s45, v112
    v_fmac_f32 v114, s46, v110
    v_fmac_f32 v115, s46, v113
    v_cvt_pk_bf16_f32 v96, v114, v115
    v_lshlrev_b32 v108, 16, v97
    v_and_b32 v111, s25, v97
    v_lshlrev_b32 v109, 16, v101
    v_and_b32 v112, s25, v101
    v_lshlrev_b32 v110, 16, v105
    v_and_b32 v113, s25, v105
    v_mul_f32 v114, s44, v108
    v_mul_f32 v115, s44, v111
    v_fmac_f32 v114, s45, v109
    v_fmac_f32 v115, s45, v112
    v_fmac_f32 v114, s46, v110
    v_fmac_f32 v115, s46, v113
    v_cvt_pk_bf16_f32 v97, v114, v115
    v_lshlrev_b32 v108, 16, v98
    v_and_b32 v111, s25, v98
    v_lshlrev_b32 v109, 16, v102
    v_and_b32 v112, s25, v102
    v_lshlrev_b32 v110, 16, v106
    v_and_b32 v113, s25, v106
    v_mul_f32 v114, s44, v108
    v_mul_f32 v115, s44, v111
    v_fmac_f32 v114, s45, v109
    v_fmac_f32 v115, s45, v112
    v_fmac_f32 v114, s46, v110
    v_fmac_f32 v115, s46, v113
    v_cvt_pk_bf16_f32 v98, v114, v115
    v_lshlrev_b32 v108, 16, v99
    v_and_b32 v111, s25, v99
    v_lshlrev_b32 v109, 16, v103
    v_and_b32 v112, s25, v103
    v_lshlrev_b32 v110, 16, v107
    v_and_b32 v113, s25, v107
    v_mul_f32 v114, s44, v108
    v_mul_f32 v115, s44, v111
    v_fmac_f32 v114, s45, v109
    v_fmac_f32 v115, s45, v112
    v_fmac_f32 v114, s46, v110
    v_fmac_f32 v115, s46, v113
    v_cvt_pk_bf16_f32 v99, v114, v115
    ds_write_b128 v126, v[96:99]
    v_and_b32 v126, 15, v127
    v_lshlrev_b32 v126, 2, v126
    v_add_u32 v126, 99328, v126
    ds_write_b32 v126, v0
    ds_write_b32 v126, v0 offset:8704
    s_waitcnt lgkmcnt(0)
    s_barrier
    s_mov_b32 s22, 4
    s_setprio 2
L_conv2_kernel_mloop2:
    ds_read_b128 v[88:91], v120 offset:0
    ds_read_b128 v[92:95], v120 offset:1024
    ds_read_b128 v[96:99], v116 offset:0
    ds_read_b128 v[100:103], v120 offset:2048
    ds_read_b128 v[104:107], v116 offset:1088
    ds_read_b128 v[108:111], v120 offset:3072
    ds_read_b128 v[112:115], v116 offset:2176
    s_waitcnt vmcnt(5) lgkmcnt(6)
    v_mfma_f32_16x16x32_bf16 v[0:3], v[64:67], v[88:91], v[0:3]
    ds_read_b128 v[88:91], v120 offset:4096
    s_waitcnt vmcnt(4) lgkmcnt(6)
    v_mfma_f32_16x16x32_bf16 v[4:7], v[64:67], v[92:95], v[4:7]
    v_mfma_f32_16x16x32_bf16 v[0:3], v[68:71], v[92:95], v[0:3]
    ds_read_b128 v[92:95], v116 offset:3264
    s_waitcnt vmcnt(3) lgkmcnt(6)
    v_mfma_f32_16x16x32_bf16 v[32:35], v[80:83], v[96:99], v[32:35]
    ds_read_b128 v[96:99], v120 offset:5120
    s_waitcnt vmcnt(2) lgkmcnt(6)
    v_mfma_f32_16x16x32_bf16 v[8:11], v[64:67], v[100:103], v[8:11]
    v_mfma_f32_16x16x32_bf16 v[4:7], v[68:71], v[100:103], v[4:7]
    v_mfma_f32_16x16x32_bf16 v[0:3], v[72:75], v[100:103], v[0:3]
    ds_read_b128 v[100:103], v116 offset:4352
    s_waitcnt vmcnt(1) lgkmcnt(6)
    v_mfma_f32_16x16x32_bf16 v[36:39], v[80:83], v[104:107], v[36:39]
    v_mfma_f32_16x16x32_bf16 v[32:35], v[84:87], v[104:107], v[32:35]
    ds_read_b128 v[104:107], v120 offset:6144
    s_waitcnt vmcnt(0) lgkmcnt(6)
    v_mfma_f32_16x16x32_bf16 v[12:15], v[64:67], v[108:111], v[12:15]
    v_mfma_f32_16x16x32_bf16 v[8:11], v[68:71], v[108:111], v[8:11]
    v_mfma_f32_16x16x32_bf16 v[4:7], v[72:75], v[108:111], v[4:7]
    v_mfma_f32_16x16x32_bf16 v[0:3], v[76:79], v[108:111], v[0:3]
    ds_read_b128 v[108:111], v116 offset:5440
    s_waitcnt lgkmcnt(6)
    v_mfma_f32_16x16x32_bf16 v[40:43], v[80:83], v[112:115], v[40:43]
    v_mfma_f32_16x16x32_bf16 v[36:39], v[84:87], v[112:115], v[36:39]
    ds_read_b128 v[112:115], v120 offset:7168
    s_waitcnt lgkmcnt(6)
    v_mfma_f32_16x16x32_bf16 v[16:19], v[64:67], v[88:91], v[16:19]
    v_mfma_f32_16x16x32_bf16 v[12:15], v[68:71], v[88:91], v[12:15]
    v_mfma_f32_16x16x32_bf16 v[8:11], v[72:75], v[88:91], v[8:11]
    v_mfma_f32_16x16x32_bf16 v[4:7], v[76:79], v[88:91], v[4:7]
    ds_read_b128 v[88:91], v117 offset:0
    s_waitcnt lgkmcnt(6)
    v_mfma_f32_16x16x32_bf16 v[44:47], v[80:83], v[92:95], v[44:47]
    v_mfma_f32_16x16x32_bf16 v[40:43], v[84:87], v[92:95], v[40:43]
    ds_read_b128 v[92:95], v122 offset:0
    v_add_u32 v122, v123, v122
    s_waitcnt lgkmcnt(6)
    v_mfma_f32_16x16x32_bf16 v[20:23], v[64:67], v[96:99], v[20:23]
    v_mfma_f32_16x16x32_bf16 v[16:19], v[68:71], v[96:99], v[16:19]
    v_mfma_f32_16x16x32_bf16 v[12:15], v[72:75], v[96:99], v[12:15]
    v_mfma_f32_16x16x32_bf16 v[8:11], v[76:79], v[96:99], v[8:11]
    ds_read_b128 v[96:99], v117 offset:1088
    s_waitcnt lgkmcnt(6)
    v_mfma_f32_16x16x32_bf16 v[48:51], v[80:83], v[100:103], v[48:51]
    v_mfma_f32_16x16x32_bf16 v[44:47], v[84:87], v[100:103], v[44:47]
    ds_read_b128 v[100:103], v121 offset:1024
    s_waitcnt lgkmcnt(6)
    v_mfma_f32_16x16x32_bf16 v[24:27], v[64:67], v[104:107], v[24:27]
    v_mfma_f32_16x16x32_bf16 v[20:23], v[68:71], v[104:107], v[20:23]
    v_mfma_f32_16x16x32_bf16 v[16:19], v[72:75], v[104:107], v[16:19]
    v_mfma_f32_16x16x32_bf16 v[12:15], v[76:79], v[104:107], v[12:15]
    ds_read_b128 v[104:107], v118 offset:0
    s_waitcnt lgkmcnt(6)
    v_mfma_f32_16x16x32_bf16 v[52:55], v[80:83], v[108:111], v[52:55]
    v_mfma_f32_16x16x32_bf16 v[48:51], v[84:87], v[108:111], v[48:51]
    ds_read_b128 v[108:111], v121 offset:2048
    s_waitcnt lgkmcnt(6)
    v_mfma_f32_16x16x32_bf16 v[28:31], v[64:67], v[112:115], v[28:31]
    v_mfma_f32_16x16x32_bf16 v[24:27], v[68:71], v[112:115], v[24:27]
    v_mfma_f32_16x16x32_bf16 v[20:23], v[72:75], v[112:115], v[20:23]
    v_mfma_f32_16x16x32_bf16 v[16:19], v[76:79], v[112:115], v[16:19]
    buffer_load_dwordx4 v[64:67], v125, s[12:15], s23 offen offset:0
    s_waitcnt lgkmcnt(5)
    v_mfma_f32_16x16x32_bf16 v[56:59], v[80:83], v[88:91], v[56:59]
    v_mfma_f32_16x16x32_bf16 v[52:55], v[84:87], v[88:91], v[52:55]
    s_waitcnt lgkmcnt(0)
    s_barrier
    v_mfma_f32_16x16x32_bf16 v[28:31], v[68:71], v[92:95], v[28:31]
    v_mfma_f32_16x16x32_bf16 v[24:27], v[72:75], v[92:95], v[24:27]
    v_mfma_f32_16x16x32_bf16 v[20:23], v[76:79], v[92:95], v[20:23]
    buffer_load_dwordx4 v[68:71], v125, s[12:15], s23 offen offset:2048
    v_mfma_f32_16x16x32_bf16 v[60:63], v[80:83], v[96:99], v[60:63]
    v_mfma_f32_16x16x32_bf16 v[56:59], v[84:87], v[96:99], v[56:59]
    buffer_load_dwordx4 v[80:83], v119, s[12:15], s23 offen offset:0
    v_mfma_f32_16x16x32_bf16 v[28:31], v[72:75], v[100:103], v[28:31]
    v_mfma_f32_16x16x32_bf16 v[24:27], v[76:79], v[100:103], v[24:27]
    buffer_load_dwordx4 v[72:75], v125, s[12:15], s26 offen offset:0
    v_mfma_f32_16x16x32_bf16 v[60:63], v[84:87], v[104:107], v[60:63]
    buffer_load_dwordx4 v[84:87], v119, s[12:15], s23 offen offset:2048
    v_mfma_f32_16x16x32_bf16 v[28:31], v[76:79], v[108:111], v[28:31]
    buffer_load_dwordx4 v[76:79], v125, s[12:15], s26 offen offset:2048
    s_add_u32 s23, s23, 57344
    s_add_u32 s26, s26, 57344
    s_sub_u32 s22, s22, 1
    s_cmp_eq_u32 s22, 0
    s_cbranch_scc1 L_conv2_kernel_mlast2
    ds_read_b128 v[88:91], v120 offset:8192
    ds_read_b128 v[92:95], v120 offset:9216
    ds_read_b128 v[96:99], v116 offset:8704
    ds_read_b128 v[100:103], v120 offset:10240
    ds_read_b128 v[104:107], v116 offset:9792
    ds_read_b128 v[108:111], v120 offset:11264
    ds_read_b128 v[112:115], v116 offset:10880
    s_waitcnt vmcnt(5) lgkmcnt(6)
    v_mfma_f32_16x16x32_bf16 v[0:3], v[64:67], v[88:91], v[0:3]
    ds_read_b128 v[88:91], v120 offset:12288
    s_waitcnt vmcnt(4) lgkmcnt(6)
    v_mfma_f32_16x16x32_bf16 v[4:7], v[64:67], v[92:95], v[4:7]
    v_mfma_f32_16x16x32_bf16 v[0:3], v[68:71], v[92:95], v[0:3]
    ds_read_b128 v[92:95], v116 offset:11968
    s_waitcnt vmcnt(3) lgkmcnt(6)
    v_mfma_f32_16x16x32_bf16 v[32:35], v[80:83], v[96:99], v[32:35]
    ds_read_b128 v[96:99], v120 offset:13312
    s_waitcnt vmcnt(2) lgkmcnt(6)
    v_mfma_f32_16x16x32_bf16 v[8:11], v[64:67], v[100:103], v[8:11]
    v_mfma_f32_16x16x32_bf16 v[4:7], v[68:71], v[100:103], v[4:7]
    v_mfma_f32_16x16x32_bf16 v[0:3], v[72:75], v[100:103], v[0:3]
    ds_read_b128 v[100:103], v116 offset:13056
    s_waitcnt vmcnt(1) lgkmcnt(6)
    v_mfma_f32_16x16x32_bf16 v[36:39], v[80:83], v[104:107], v[36:39]
    v_mfma_f32_16x16x32_bf16 v[32:35], v[84:87], v[104:107], v[32:35]
    ds_read_b128 v[104:107], v120 offset:14336
    s_waitcnt vmcnt(0) lgkmcnt(6)
    v_mfma_f32_16x16x32_bf16 v[12:15], v[64:67], v[108:111], v[12:15]
    v_mfma_f32_16x16x32_bf16 v[8:11], v[68:71], v[108:111], v[8:11]
    v_mfma_f32_16x16x32_bf16 v[4:7], v[72:75], v[108:111], v[4:7]
    v_mfma_f32_16x16x32_bf16 v[0:3], v[76:79], v[108:111], v[0:3]
    ds_read_b128 v[108:111], v116 offset:14144
    s_waitcnt lgkmcnt(6)
    v_mfma_f32_16x16x32_bf16 v[40:43], v[80:83], v[112:115], v[40:43]
    v_mfma_f32_16x16x32_bf16 v[36:39], v[84:87], v[112:115], v[36:39]
    ds_read_b128 v[112:115], v120 offset:15360
    s_waitcnt lgkmcnt(6)
    v_mfma_f32_16x16x32_bf16 v[16:19], v[64:67], v[88:91], v[16:19]
    v_mfma_f32_16x16x32_bf16 v[12:15], v[68:71], v[88:91], v[12:15]
    v_mfma_f32_16x16x32_bf16 v[8:11], v[72:75], v[88:91], v[8:11]
    v_mfma_f32_16x16x32_bf16 v[4:7], v[76:79], v[88:91], v[4:7]
    ds_read_b128 v[88:91], v117 offset:8704
    s_waitcnt lgkmcnt(6)
    v_mfma_f32_16x16x32_bf16 v[44:47], v[80:83], v[92:95], v[44:47]
    v_mfma_f32_16x16x32_bf16 v[40:43], v[84:87], v[92:95], v[40:43]
    ds_read_b128 v[92:95], v122 offset:0
    v_add_u32 v122, v124, v122
    s_waitcnt lgkmcnt(6)
    v_mfma_f32_16x16x32_bf16 v[20:23], v[64:67], v[96:99], v[20:23]
    v_mfma_f32_16x16x32_bf16 v[16:19], v[68:71], v[96:99], v[16:19]
    v_mfma_f32_16x16x32_bf16 v[12:15], v[72:75], v[96:99], v[12:15]
    v_mfma_f32_16x16x32_bf16 v[8:11], v[76:79], v[96:99], v[8:11]
    ds_read_b128 v[96:99], v117 offset:9792
    s_waitcnt lgkmcnt(6)
    v_mfma_f32_16x16x32_bf16 v[48:51], v[80:83], v[100:103], v[48:51]
    v_mfma_f32_16x16x32_bf16 v[44:47], v[84:87], v[100:103], v[44:47]
    ds_read_b128 v[100:103], v121 offset:9216
    s_waitcnt lgkmcnt(6)
    v_mfma_f32_16x16x32_bf16 v[24:27], v[64:67], v[104:107], v[24:27]
    v_mfma_f32_16x16x32_bf16 v[20:23], v[68:71], v[104:107], v[20:23]
    v_mfma_f32_16x16x32_bf16 v[16:19], v[72:75], v[104:107], v[16:19]
    v_mfma_f32_16x16x32_bf16 v[12:15], v[76:79], v[104:107], v[12:15]
    ds_read_b128 v[104:107], v118 offset:8704
    s_waitcnt lgkmcnt(6)
    v_mfma_f32_16x16x32_bf16 v[52:55], v[80:83], v[108:111], v[52:55]
    v_mfma_f32_16x16x32_bf16 v[48:51], v[84:87], v[108:111], v[48:51]
    ds_read_b128 v[108:111], v121 offset:10240
    s_waitcnt lgkmcnt(6)
    v_mfma_f32_16x16x32_bf16 v[28:31], v[64:67], v[112:115], v[28:31]
    v_mfma_f32_16x16x32_bf16 v[24:27], v[68:71], v[112:115], v[24:27]
    v_mfma_f32_16x16x32_bf16 v[20:23], v[72:75], v[112:115], v[20:23]
    v_mfma_f32_16x16x32_bf16 v[16:19], v[76:79], v[112:115], v[16:19]
    buffer_load_dwordx4 v[64:67], v125, s[12:15], s23 offen offset:0
    s_waitcnt lgkmcnt(5)
    v_mfma_f32_16x16x32_bf16 v[56:59], v[80:83], v[88:91], v[56:59]
    v_mfma_f32_16x16x32_bf16 v[52:55], v[84:87], v[88:91], v[52:55]
    s_waitcnt lgkmcnt(0)
    s_barrier
    v_mfma_f32_16x16x32_bf16 v[28:31], v[68:71], v[92:95], v[28:31]
    v_mfma_f32_16x16x32_bf16 v[24:27], v[72:75], v[92:95], v[24:27]
    v_mfma_f32_16x16x32_bf16 v[20:23], v[76:79], v[92:95], v[20:23]
    buffer_load_dwordx4 v[68:71], v125, s[12:15], s23 offen offset:2048
    v_mfma_f32_16x16x32_bf16 v[60:63], v[80:83], v[96:99], v[60:63]
    v_mfma_f32_16x16x32_bf16 v[56:59], v[84:87], v[96:99], v[56:59]
    buffer_load_dwordx4 v[80:83], v119, s[12:15], s23 offen offset:0
    v_mfma_f32_16x16x32_bf16 v[28:31], v[72:75], v[100:103], v[28:31]
    v_mfma_f32_16x16x32_bf16 v[24:27], v[76:79], v[100:103], v[24:27]
    buffer_load_dwordx4 v[72:75], v125, s[12:15], s26 offen offset:0
    v_mfma_f32_16x16x32_bf16 v[60:63], v[84:87], v[104:107], v[60:63]
    buffer_load_dwordx4 v[84:87], v119, s[12:15], s23 offen offset:2048
    v_mfma_f32_16x16x32_bf16 v[28:31], v[76:79], v[108:111], v[28:31]
    buffer_load_dwordx4 v[76:79], v125, s[12:15], s26 offen offset:2048
    s_add_u32 s23, s23, 57344
    s_add_u32 s26, s26, 57344
    s_branch L_conv2_kernel_mloop2
L_conv2_kernel_mlast2:
    v_and_b32 v125, 15, v127
    v_and_b32 v126, 7, v127
    v_lshlrev_b32 v126, 4, v126
    v_lshl_add_u32 v125, v125, 7, v126
    v_lshrrev_b32 v126, 4, v127
    v_lshl_add_u32 v125, v126, 11, v125
    s_mov_b32 s36, 65536
    s_cmp_eq_u32 s32, 1
    s_cselect_b32 s36, 121856, s36
    s_cmp_eq_u32 s32, 2
    s_cselect_b32 s36, 81920, s36
    s_cmp_eq_u32 s32, 3
    s_cselect_b32 s36, 130048, s36
    s_mov_b32 s37, 98304
    s_cmp_eq_u32 s32, 1
    s_cselect_b32 s37, 138240, s37
    s_cmp_eq_u32 s32, 2
    s_cselect_b32 s37, 146432, s37
    s_cmp_eq_u32 s32, 3
    s_cselect_b32 s37, 154624, s37
    v_add_u32 v126, s37, v125
    v_add_u32 v125, s36, v125
    ds_read_b128 v[88:91], v120 offset:8192
    ds_read_b128 v[92:95], v120 offset:9216
    ds_read_b128 v[96:99], v116 offset:8704
    ds_read_b128 v[100:103], v120 offset:10240
    ds_read_b128 v[104:107], v116 offset:9792
    ds_read_b128 v[108:111], v120 offset:11264
    ds_read_b128 v[112:115], v116 offset:10880
    s_waitcnt vmcnt(5) lgkmcnt(6)
    v_mfma_f32_16x16x32_bf16 v[0:3], v[64:67], v[88:91], v[0:3]
    ds_read_b128 v[88:91], v120 offset:12288
    s_waitcnt vmcnt(4) lgkmcnt(6)
    v_mfma_f32_16x16x32_bf16 v[4:7], v[64:67], v[92:95], v[4:7]
    v_mfma_f32_16x16x32_bf16 v[0:3], v[68:71], v[92:95], v[0:3]
    ds_read_b128 v[92:95], v116 offset:11968
    s_waitcnt vmcnt(3) lgkmcnt(6)
    v_mfma_f32_16x16x32_bf16 v[32:35], v[80:83], v[96:99], v[32:35]
    ds_read_b128 v[96:99], v120 offset:13312
    s_waitcnt vmcnt(2) lgkmcnt(6)
    v_mfma_f32_16x16x32_bf16 v[8:11], v[64:67], v[100:103], v[8:11]
    v_mfma_f32_16x16x32_bf16 v[4:7], v[68:71], v[100:103], v[4:7]
    v_mfma_f32_16x16x32_bf16 v[0:3], v[72:75], v[100:103], v[0:3]
    ds_read_b128 v[100:103], v116 offset:13056
    s_waitcnt vmcnt(1) lgkmcnt(6)
    v_mfma_f32_16x16x32_bf16 v[36:39], v[80:83], v[104:107], v[36:39]
    v_mfma_f32_16x16x32_bf16 v[32:35], v[84:87], v[104:107], v[32:35]
    ds_read_b128 v[104:107], v120 offset:14336
    s_waitcnt vmcnt(0) lgkmcnt(6)
    v_mfma_f32_16x16x32_bf16 v[12:15], v[64:67], v[108:111], v[12:15]
    v_mfma_f32_16x16x32_bf16 v[8:11], v[68:71], v[108:111], v[8:11]
    v_mfma_f32_16x16x32_bf16 v[4:7], v[72:75], v[108:111], v[4:7]
    v_mfma_f32_16x16x32_bf16 v[0:3], v[76:79], v[108:111], v[0:3]
    ds_read_b128 v[108:111], v116 offset:14144
    s_waitcnt lgkmcnt(6)
    v_mfma_f32_16x16x32_bf16 v[40:43], v[80:83], v[112:115], v[40:43]
    v_mfma_f32_16x16x32_bf16 v[36:39], v[84:87], v[112:115], v[36:39]
    ds_read_b128 v[112:115], v120 offset:15360
    s_waitcnt lgkmcnt(6)
    v_mfma_f32_16x16x32_bf16 v[16:19], v[64:67], v[88:91], v[16:19]
    v_mfma_f32_16x16x32_bf16 v[12:15], v[68:71], v[88:91], v[12:15]
    v_mfma_f32_16x16x32_bf16 v[8:11], v[72:75], v[88:91], v[8:11]
    v_mfma_f32_16x16x32_bf16 v[4:7], v[76:79], v[88:91], v[4:7]
    ds_read_b128 v[88:91], v117 offset:8704
    v_xor_b32 v124, 0, v126
    ds_write_b128 v124, v[32:35]
    s_waitcnt lgkmcnt(7)
    v_mfma_f32_16x16x32_bf16 v[44:47], v[80:83], v[92:95], v[44:47]
    v_mfma_f32_16x16x32_bf16 v[40:43], v[84:87], v[92:95], v[40:43]
    ds_read_b128 v[92:95], v122 offset:0
    v_xor_b32 v123, 0, v125
    ds_write_b128 v123, v[0:3]
    s_waitcnt lgkmcnt(8)
    v_mfma_f32_16x16x32_bf16 v[20:23], v[64:67], v[96:99], v[20:23]
    v_mfma_f32_16x16x32_bf16 v[16:19], v[68:71], v[96:99], v[16:19]
    v_mfma_f32_16x16x32_bf16 v[12:15], v[72:75], v[96:99], v[12:15]
    v_mfma_f32_16x16x32_bf16 v[8:11], v[76:79], v[96:99], v[8:11]
    ds_read_b128 v[96:99], v117 offset:9792
    v_xor_b32 v123, 16, v126
    ds_write_b128 v123, v[36:39]
    s_waitcnt lgkmcnt(9)
    v_mfma_f32_16x16x32_bf16 v[48:51], v[80:83], v[100:103], v[48:51]
    v_mfma_f32_16x16x32_bf16 v[44:47], v[84:87], v[100:103], v[44:47]
    ds_read_b128 v[100:103], v121 offset:9216
    v_xor_b32 v124, 16, v125
    ds_write_b128 v124, v[4:7]
    s_waitcnt lgkmcnt(10)
    v_mfma_f32_16x16x32_bf16 v[24:27], v[64:67], v[104:107], v[24:27]
    v_mfma_f32_16x16x32_bf16 v[20:23], v[68:71], v[104:107], v[20:23]
    v_mfma_f32_16x16x32_bf16 v[16:19], v[72:75], v[104:107], v[16:19]
    v_mfma_f32_16x16x32_bf16 v[12:15], v[76:79], v[104:107], v[12:15]
    ds_read_b128 v[104:107], v118 offset:8704
    v_xor_b32 v124, 32, v126
    ds_write_b128 v124, v[40:43]
    s_waitcnt lgkmcnt(11)
    v_mfma_f32_16x16x32_bf16 v[52:55], v[80:83], v[108:111], v[52:55]
    v_mfma_f32_16x16x32_bf16 v[48:51], v[84:87], v[108:111], v[48:51]
    ds_read_b128 v[108:111], v121 offset:10240
    v_xor_b32 v123, 32, v125
    ds_write_b128 v123, v[8:11]
    s_waitcnt lgkmcnt(12)
    v_mfma_f32_16x16x32_bf16 v[28:31], v[64:67], v[112:115], v[28:31]
    v_mfma_f32_16x16x32_bf16 v[24:27], v[68:71], v[112:115], v[24:27]
    v_mfma_f32_16x16x32_bf16 v[20:23], v[72:75], v[112:115], v[20:23]
    v_mfma_f32_16x16x32_bf16 v[16:19], v[76:79], v[112:115], v[16:19]
    v_xor_b32 v123, 48, v126
    ds_write_b128 v123, v[44:47]
    s_waitcnt lgkmcnt(12)
    v_mfma_f32_16x16x32_bf16 v[56:59], v[80:83], v[88:91], v[56:59]
    v_mfma_f32_16x16x32_bf16 v[52:55], v[84:87], v[88:91], v[52:55]
    v_xor_b32 v124, 48, v125
    ds_write_b128 v124, v[12:15]
    s_waitcnt lgkmcnt(11)
    v_mfma_f32_16x16x32_bf16 v[28:31], v[68:71], v[92:95], v[28:31]
    v_mfma_f32_16x16x32_bf16 v[24:27], v[72:75], v[92:95], v[24:27]
    v_mfma_f32_16x16x32_bf16 v[20:23], v[76:79], v[92:95], v[20:23]
    v_xor_b32 v124, 64, v126
    ds_write_b128 v124, v[48:51]
    s_waitcnt lgkmcnt(10)
    v_mfma_f32_16x16x32_bf16 v[60:63], v[80:83], v[96:99], v[60:63]
    v_mfma_f32_16x16x32_bf16 v[56:59], v[84:87], v[96:99], v[56:59]
    v_xor_b32 v123, 64, v125
    ds_write_b128 v123, v[16:19]
    s_waitcnt lgkmcnt(9)
    v_mfma_f32_16x16x32_bf16 v[28:31], v[72:75], v[100:103], v[28:31]
    v_mfma_f32_16x16x32_bf16 v[24:27], v[76:79], v[100:103], v[24:27]
    v_xor_b32 v123, 80, v126
    ds_write_b128 v123, v[52:55]
    s_waitcnt lgkmcnt(8)
    v_mfma_f32_16x16x32_bf16 v[60:63], v[84:87], v[104:107], v[60:63]
    v_xor_b32 v124, 80, v125
    ds_write_b128 v124, v[20:23]
    s_waitcnt lgkmcnt(7)
    v_mfma_f32_16x16x32_bf16 v[28:31], v[76:79], v[108:111], v[28:31]
    v_xor_b32 v124, 96, v126
    ds_write_b128 v124, v[56:59]
    s_nop 7
    v_xor_b32 v123, 96, v125
    ds_write_b128 v123, v[24:27]
    v_xor_b32 v123, 112, v126
    ds_write_b128 v123, v[60:63]
    v_xor_b32 v124, 112, v125
    ds_write_b128 v124, v[28:31]
    s_setprio 0
    s_branch L_conv2_kernel_epi
L_conv2_kernel_helper:
    s_setprio 3
    v_lshlrev_b32 v8, 4, v6
    s_add_u32 s37, s33, 4294967289
    v_lshl_add_u32 v9, v7, 3, s37
    v_cmp_gt_u32 vcc, 8000, v9
    s_mul_i32 s37, s33, 131072
    s_add_u32 s37, s37, 0
    v_lshl_add_u32 v92, v7, 7, s37
    v_add_u32 v92, v92, v8
    v_mov_b32 v9, 2130706432
    v_cndmask_b32 v92, v9, v92, vcc
    s_add_u32 s37, s33, 4294967291
    v_lshl_add_u32 v9, v7, 3, s37
    v_cmp_gt_u32 vcc, 8000, v9
    s_mul_i32 s37, s33, 131072
    s_add_u32 s37, s37, 262144
    v_lshl_add_u32 v93, v7, 7, s37
    v_add_u32 v93, v93, v8
    v_mov_b32 v9, 2130706432
    v_cndmask_b32 v93, v9, v93, vcc
    s_add_u32 s37, s33, 4294967293
    v_lshl_add_u32 v9, v7, 3, s37
    v_cmp_gt_u32 vcc, 8000, v9
    s_mul_i32 s37, s33, 131072
    s_add_u32 s37, s37, 64
    v_lshl_add_u32 v94, v7, 7, s37
    v_add_u32 v94, v94, v8
    v_mov_b32 v9, 2130706432
    v_cndmask_b32 v94, v9, v94, vcc
    s_add_u32 s37, s33, 4294967295
    v_lshl_add_u32 v9, v7, 3, s37
    v_cmp_gt_u32 vcc, 8000, v9
    s_mul_i32 s37, s33, 131072
    s_add_u32 s37, s37, 262208
    v_lshl_add_u32 v95, v7, 7, s37
    v_add_u32 v95, v95, v8
    v_mov_b32 v9, 2130706432
    v_cndmask_b32 v95, v9, v95, vcc
    v_and_b32 v76, 4, v5
    v_lshrrev_b32 v76, 1, v76
    v_xor_b32 v76, v6, v76
    v_lshlrev_b32 v76, 4, v76
    v_lshl_add_u32 v76, v5, 6, v76
    s_mov_b32 s24, 0
    s_mov_b32 s27, 524288
    buffer_load_dwordx4 v[0:3], v92, s[8:11], s24 offen
    buffer_load_dwordx4 v[8:11], v94, s[8:11], s24 offen
    buffer_load_dwordx4 v[4:7], v93, s[8:11], s24 offen
    buffer_load_dwordx4 v[12:15], v95, s[8:11], s24 offen
    buffer_load_dwordx4 v[16:19], v92, s[8:11], s27 offen
    buffer_load_dwordx4 v[24:27], v94, s[8:11], s27 offen
    buffer_load_dwordx4 v[20:23], v93, s[8:11], s27 offen
    buffer_load_dwordx4 v[28:31], v95, s[8:11], s27 offen
    s_barrier
    s_mul_i32 s36, s42, 1024
    v_add_u32 v96, s36, v76
    v_add_u32 v97, 65536, v96
    s_mul_i32 s36, s42, 1088
    s_add_u32 s36, s36, 98304
    v_add_u32 v98, s36, v76
    s_waitcnt vmcnt(0)
    s_mov_b32 s28, 0
    s_mov_b32 s22, 2
    s_cmp_ge_u32 s20, 12
    s_cbranch_scc1 L_conv2_kernel_h2
    ds_write_b128 v96, v[0:3] offset:0
    ds_write_b128 v98, v[12:15] offset:0
    v_lshlrev_b32 v76, 16, v0
    v_and_b32 v84, s25, v0
    v_lshlrev_b32 v77, 16, v4
    v_and_b32 v85, s25, v4
    v_lshlrev_b32 v78, 16, v8
    v_and_b32 v86, s25, v8
    v_lshlrev_b32 v79, 16, v12
    v_and_b32 v87, s25, v12
    v_add_f32 v80, v76, v78
    v_add_f32 v88, v84, v86
    v_add_f32 v81, v77, v79
    v_add_f32 v89, v85, v87
    v_fma_f32 v82, v78, 4.0, v76
    v_fma_f32 v90, v86, 4.0, v84
    v_fma_f32 v83, v79, 4.0, v77
    v_fma_f32 v91, v87, 4.0, v85
    v_add_f32 v77, v80, v81
    v_add_f32 v85, v88, v89
    v_sub_f32 v78, v80, v81
    v_sub_f32 v86, v88, v89
    v_fma_f32 v79, v83, 2.0, v82
    v_fma_f32 v87, v91, 2.0, v90
    v_fma_f32 v82, v83, -2.0, v82
    v_fma_f32 v90, v91, -2.0, v90
    v_fmamk_f32 v80, v76, 0x41700000, v82
    v_fmamk_f32 v88, v84, 0x41700000, v90
    v_fmamk_f32 v80, v81, 0x41200000, v80
    v_fmamk_f32 v88, v89, 0x41200000, v88
    v_cvt_pk_bf16_f32 v4, v77, v85
    v_cvt_pk_bf16_f32 v8, v78, v86
    v_cvt_pk_bf16_f32 v64, v79, v87
    v_cvt_pk_bf16_f32 v68, v82, v90
    v_cvt_pk_bf16_f32 v72, v80, v88
    v_lshlrev_b32 v76, 16, v1
    v_and_b32 v84, s25, v1
    v_lshlrev_b32 v77, 16, v5
    v_and_b32 v85, s25, v5
    v_lshlrev_b32 v78, 16, v9
    v_and_b32 v86, s25, v9
    v_lshlrev_b32 v79, 16, v13
    v_and_b32 v87, s25, v13
    v_add_f32 v80, v76, v78
    v_add_f32 v88, v84, v86
    v_add_f32 v81, v77, v79
    v_add_f32 v89, v85, v87
    v_fma_f32 v82, v78, 4.0, v76
    v_fma_f32 v90, v86, 4.0, v84
    v_fma_f32 v83, v79, 4.0, v77
    v_fma_f32 v91, v87, 4.0, v85
    v_add_f32 v77, v80, v81
    v_add_f32 v85, v88, v89
    v_sub_f32 v78, v80, v81
    v_sub_f32 v86, v88, v89
    v_fma_f32 v79, v83, 2.0, v82
    v_fma_f32 v87, v91, 2.0, v90
    v_fma_f32 v82, v83, -2.0, v82
    v_fma_f32 v90, v91, -2.0, v90
    v_fmamk_f32 v80, v76, 0x41700000, v82
    v_fmamk_f32 v88, v84, 0x41700000, v90
    v_fmamk_f32 v80, v81, 0x41200000, v80
    v_fmamk_f32 v88, v89, 0x41200000, v88
    v_cvt_pk_bf16_f32 v5, v77, v85
    v_cvt_pk_bf16_f32 v9, v78, v86
    v_cvt_pk_bf16_f32 v65, v79, v87
    v_cvt_pk_bf16_f32 v69, v82, v90
    v_cvt_pk_bf16_f32 v73, v80, v88
    v_lshlrev_b32 v76, 16, v2
    v_and_b32 v84, s25, v2
    v_lshlrev_b32 v77, 16, v6
    v_and_b32 v85, s25, v6
    v_lshlrev_b32 v78, 16, v10
    v_and_b32 v86, s25, v10
    v_lshlrev_b32 v79, 16, v14
    v_and_b32 v87, s25, v14
    v_add_f32 v80, v76, v78
    v_add_f32 v88, v84, v86
    v_add_f32 v81, v77, v79
    v_add_f32 v89, v85, v87
    v_fma_f32 v82, v78, 4.0, v76
    v_fma_f32 v90, v86, 4.0, v84
    v_fma_f32 v83, v79, 4.0, v77
    v_fma_f32 v91, v87, 4.0, v85
    v_add_f32 v77, v80, v81
    v_add_f32 v85, v88, v89
    v_sub_f32 v78, v80, v81
    v_sub_f32 v86, v88, v89
    v_fma_f32 v79, v83, 2.0, v82
    v_fma_f32 v87, v91, 2.0, v90
    v_fma_f32 v82, v83, -2.0, v82
    v_fma_f32 v90, v91, -2.0, v90
    v_fmamk_f32 v80, v76, 0x41700000, v82
    v_fmamk_f32 v88, v84, 0x41700000, v90
    v_fmamk_f32 v80, v81, 0x41200000, v80
    v_fmamk_f32 v88, v89, 0x41200000, v88
    v_cvt_pk_bf16_f32 v6, v77, v85
    v_cvt_pk_bf16_f32 v10, v78, v86
    v_cvt_pk_bf16_f32 v66, v79, v87
    v_cvt_pk_bf16_f32 v70, v82, v90
    v_cvt_pk_bf16_f32 v74, v80, v88
    v_lshlrev_b32 v76, 16, v3
    v_and_b32 v84, s25, v3
    v_lshlrev_b32 v77, 16, v7
    v_and_b32 v85, s25, v7
    v_lshlrev_b32 v78, 16, v11
    v_and_b32 v86, s25, v11
    v_lshlrev_b32 v79, 16, v15
    v_and_b32 v87, s25, v15
    v_add_f32 v80, v76, v78
    v_add_f32 v88, v84, v86
    v_add_f32 v81, v77, v79
    v_add_f32 v89, v85, v87
    v_fma_f32 v82, v78, 4.0, v76
    v_fma_f32 v90, v86, 4.0, v84
    v_fma_f32 v83, v79, 4.0, v77
    v_fma_f32 v91, v87, 4.0, v85
    v_add_f32 v77, v80, v81
    v_add_f32 v85, v88, v89
    v_sub_f32 v78, v80, v81
    v_sub_f32 v86, v88, v89
    v_fma_f32 v79, v83, 2.0, v82
    v_fma_f32 v87, v91, 2.0, v90
    v_fma_f32 v82, v83, -2.0, v82
    v_fma_f32 v90, v91, -2.0, v90
    v_fmamk_f32 v80, v76, 0x41700000, v82
    v_fmamk_f32 v88, v84, 0x41700000, v90
    v_fmamk_f32 v80, v81, 0x41200000, v80
    v_fmamk_f32 v88, v89, 0x41200000, v88
    v_cvt_pk_bf16_f32 v7, v77, v85
    v_cvt_pk_bf16_f32 v11, v78, v86
    v_cvt_pk_bf16_f32 v67, v79, v87
    v_cvt_pk_bf16_f32 v71, v82, v90
    v_cvt_pk_bf16_f32 v75, v80, v88
    ds_write_b128 v96, v[64:67] offset:49152
    ds_write_b128 v97, v[68:71] offset:0
    ds_write_b128 v97, v[72:75] offset:16384
    ds_write_b128 v96, v[4:7] offset:16384
    ds_write_b128 v96, v[8:11] offset:32768
    s_waitcnt vmcnt(0)
    s_mov_b32 s24, 1048576
    s_mov_b32 s27, 1572864
    buffer_load_dwordx4 v[32:35], v92, s[8:11], s24 offen
    buffer_load_dwordx4 v[40:43], v94, s[8:11], s24 offen
    buffer_load_dwordx4 v[36:39], v93, s[8:11], s24 offen
    buffer_load_dwordx4 v[44:47], v95, s[8:11], s24 offen
    s_waitcnt lgkmcnt(0)
    s_barrier
    s_setprio 1
L_conv2_kernel_hloop1:
    v_lshlrev_b32 v76, 16, v16
    v_and_b32 v84, s25, v16
    v_lshlrev_b32 v77, 16, v20
    v_and_b32 v85, s25, v20
    v_lshlrev_b32 v78, 16, v24
    v_and_b32 v86, s25, v24
    v_lshlrev_b32 v79, 16, v28
    v_and_b32 v87, s25, v28
    v_add_f32 v80, v76, v78
    v_add_f32 v88, v84, v86
    v_add_f32 v81, v77, v79
    v_add_f32 v89, v85, v87
    v_fma_f32 v82, v78, 4.0, v76
    buffer_load_dwordx4 v[48:51], v92, s[8:11], s27 offen
    buffer_load_dwordx4 v[56:59], v94, s[8:11], s27 offen
    v_fma_f32 v90, v86, 4.0, v84
    v_fma_f32 v83, v79, 4.0, v77
    v_fma_f32 v91, v87, 4.0, v85
    v_add_f32 v77, v80, v81
    v_add_f32 v85, v88, v89
    v_sub_f32 v78, v80, v81
    v_sub_f32 v86, v88, v89
    v_fma_f32 v79, v83, 2.0, v82
    v_fma_f32 v87, v91, 2.0, v90
    v_fma_f32 v82, v83, -2.0, v82
    v_fma_f32 v90, v91, -2.0, v90
    v_fmamk_f32 v80, v76, 0x41700000, v82
    v_fmamk_f32 v88, v84, 0x41700000, v90
    v_fmamk_f32 v80, v81, 0x41200000, v80
    v_fmamk_f32 v88, v89, 0x41200000, v88
    v_cvt_pk_bf16_f32 v20, v77, v85
    v_cvt_pk_bf16_f32 v24, v78, v86
    v_cvt_pk_bf16_f32 v64, v79, v87
    v_cvt_pk_bf16_f32 v68, v82, v90
    v_cvt_pk_bf16_f32 v72, v80, v88
    v_lshlrev_b32 v76, 16, v17
    v_and_b32 v84, s25, v17
    v_lshlrev_b32 v77, 16, v21
    v_and_b32 v85, s25, v21
    v_lshlrev_b32 v78, 16, v25
    v_and_b32 v86, s25, v25
    v_lshlrev_b32 v79, 16, v29
    v_and_b32 v87, s25, v29
    v_add_f32 v80, v76, v78
    v_add_f32 v88, v84, v86
    v_add_f32 v81, v77, v79
    v_add_f32 v89, v85, v87
    v_fma_f32 v82, v78, 4.0, v76
    v_fma_f32 v90, v86, 4.0, v84
    v_fma_f32 v83, v79, 4.0, v77
    v_fma_f32 v91, v87, 4.0, v85
    v_add_f32 v77, v80, v81
    v_add_f32 v85, v88, v89
    v_sub_f32 v78, v80, v81
    v_sub_f32 v86, v88, v89
    v_fma_f32 v79, v83, 2.0, v82
    v_fma_f32 v87, v91, 2.0, v90
    v_fma_f32 v82, v83, -2.0, v82
    v_fma_f32 v90, v91, -2.0, v90
    v_fmamk_f32 v80, v76, 0x41700000, v82
    v_fmamk_f32 v88, v84, 0x41700000, v90
    v_fmamk_f32 v80, v81, 0x41200000, v80
    v_fmamk_f32 v88, v89, 0x41200000, v88
    v_cvt_pk_bf16_f32 v21, v77, v85
    v_cvt_pk_bf16_f32 v25, v78, v86
    v_cvt_pk_bf16_f32 v65, v79, v87
    v_cvt_pk_bf16_f32 v69, v82, v90
    v_cvt_pk_bf16_f32 v73, v80, v88
    buffer_load_dwordx4 v[52:55], v93, s[8:11], s27 offen
    buffer_load_dwordx4 v[60:63], v95, s[8:11], s27 offen
    v_lshlrev_b32 v76, 16, v18
    v_and_b32 v84, s25, v18
    v_lshlrev_b32 v77, 16, v22
    v_and_b32 v85, s25, v22
    v_lshlrev_b32 v78, 16, v26
    v_and_b32 v86, s25, v26
    v_lshlrev_b32 v79, 16, v30
    v_and_b32 v87, s25, v30
    v_add_f32 v80, v76, v78
    v_add_f32 v88, v84, v86
    v_add_f32 v81, v77, v79
    v_add_f32 v89, v85, v87
    v_fma_f32 v82, v78, 4.0, v76
    v_fma_f32 v90, v86, 4.0, v84
    v_fma_f32 v83, v79, 4.0, v77
    v_fma_f32 v91, v87, 4.0, v85
    v_add_f32 v77, v80, v81
    v_add_f32 v85, v88, v89
    v_sub_f32 v78, v80, v81
    v_sub_f32 v86, v88, v89
    v_fma_f32 v79, v83, 2.0, v82
    v_fma_f32 v87, v91, 2.0, v90
    v_fma_f32 v82, v83, -2.0, v82
    v_fma_f32 v90, v91, -2.0, v90
    v_fmamk_f32 v80, v76, 0x41700000, v82
    v_fmamk_f32 v88, v84, 0x41700000, v90
    v_fmamk_f32 v80, v81, 0x41200000, v80
    v_fmamk_f32 v88, v89, 0x41200000, v88
    v_cvt_pk_bf16_f32 v22, v77, v85
    v_cvt_pk_bf16_f32 v26, v78, v86
    v_cvt_pk_bf16_f32 v66, v79, v87
    v_cvt_pk_bf16_f32 v70, v82, v90
    v_cvt_pk_bf16_f32 v74, v80, v88
    v_lshlrev_b32 v76, 16, v19
    v_and_b32 v84, s25, v19
    v_lshlrev_b32 v77, 16, v23
    v_and_b32 v85, s25, v23
    v_lshlrev_b32 v78, 16, v27
    v_and_b32 v86, s25, v27
    v_lshlrev_b32 v79, 16, v31
    v_and_b32 v87, s25, v31
    v_add_f32 v80, v76, v78
    v_add_f32 v88, v84, v86
    v_add_f32 v81, v77, v79
    v_add_f32 v89, v85, v87
    v_fma_f32 v82, v78, 4.0, v76
    v_fma_f32 v90, v86, 4.0, v84
    v_fma_f32 v83, v79, 4.0, v77
    v_fma_f32 v91, v87, 4.0, v85
    v_add_f32 v77, v80, v81
    v_add_f32 v85, v88, v89
    v_sub_f32 v78, v80, v81
    v_sub_f32 v86, v88, v89
    v_fma_f32 v79, v83, 2.0, v82
    v_fma_f32 v87, v91, 2.0, v90
    v_fma_f32 v82, v83, -2.0, v82
    v_fma_f32 v90, v91, -2.0, v90
    v_fmamk_f32 v80, v76, 0x41700000, v82
    v_fmamk_f32 v88, v84, 0x41700000, v90
    v_fmamk_f32 v80, v81, 0x41200000, v80
    v_fmamk_f32 v88, v89, 0x41200000, v88
    v_cvt_pk_bf16_f32 v23, v77, v85
    v_cvt_pk_bf16_f32 v27, v78, v86
    v_cvt_pk_bf16_f32 v67, v79, v87
    v_cvt_pk_bf16_f32 v71, v82, v90
    v_cvt_pk_bf16_f32 v75, v80, v88
    ds_write_b128 v96, v[64:67] offset:57344
    ds_write_b128 v97, v[68:71] offset:8192
    ds_write_b128 v97, v[72:75] offset:24576
    ds_write_b128 v96, v[16:19] offset:8192
    ds_write_b128 v96, v[20:23] offset:24576
    ds_write_b128 v96, v[24:27] offset:40960
    ds_write_b128 v98, v[28:31] offset:8704
    s_add_u32 s28, s28, 1
    s_waitcnt lgkmcnt(0)
    s_barrier
    s_add_u32 s24, s24, 1048576
    s_add_u32 s27, s27, 1048576
    s_waitcnt vmcnt(0)
    v_lshlrev_b32 v76, 16, v32
    v_and_b32 v84, s25, v32
    v_lshlrev_b32 v77, 16, v36
    v_and_b32 v85, s25, v36
    v_lshlrev_b32 v78, 16, v40
    v_and_b32 v86, s25, v40
    v_lshlrev_b32 v79, 16, v44
    v_and_b32 v87, s25, v44
    v_add_f32 v80, v76, v78
    v_add_f32 v88, v84, v86
    v_add_f32 v81, v77, v79
    v_add_f32 v89, v85, v87
    v_fma_f32 v82, v78, 4.0, v76
    v_fma_f32 v90, v86, 4.0, v84
    v_fma_f32 v83, v79, 4.0, v77
    v_fma_f32 v91, v87, 4.0, v85
    v_add_f32 v77, v80, v81
    v_add_f32 v85, v88, v89
    v_sub_f32 v78, v80, v81
    v_sub_f32 v86, v88, v89
    v_fma_f32 v79, v83, 2.0, v82
    v_fma_f32 v87, v91, 2.0, v90
    v_fma_f32 v82, v83, -2.0, v82
    v_fma_f32 v90, v91, -2.0, v90
    v_fmamk_f32 v80, v76, 0x41700000, v82
    v_fmamk_f32 v88, v84, 0x41700000, v90
    v_fmamk_f32 v80, v81, 0x41200000, v80
    v_fmamk_f32 v88, v89, 0x41200000, v88
    v_cvt_pk_bf16_f32 v36, v77, v85
    v_cvt_pk_bf16_f32 v40, v78, v86
    v_cvt_pk_bf16_f32 v64, v79, v87
    v_cvt_pk_bf16_f32 v68, v82, v90
    v_cvt_pk_bf16_f32 v72, v80, v88
    v_lshlrev_b32 v76, 16, v33
    v_and_b32 v84, s25, v33
    v_lshlrev_b32 v77, 16, v37
    v_and_b32 v85, s25, v37
    v_lshlrev_b32 v78, 16, v41
    v_and_b32 v86, s25, v41
    buffer_load_dwordx4 v[0:3], v92, s[8:11], s24 offen
    buffer_load_dwordx4 v[8:11], v94, s[8:11], s24 offen
    v_lshlrev_b32 v79, 16, v45
    v_and_b32 v87, s25, v45
    v_add_f32 v80, v76, v78
    v_add_f32 v88, v84, v86
    v_add_f32 v81, v77, v79
    v_add_f32 v89, v85, v87
    v_fma_f32 v82, v78, 4.0, v76
    v_fma_f32 v90, v86, 4.0, v84
    v_fma_f32 v83, v79, 4.0, v77
    v_fma_f32 v91, v87, 4.0, v85
    v_add_f32 v77, v80, v81
    v_add_f32 v85, v88, v89
    v_sub_f32 v78, v80, v81
    v_sub_f32 v86, v88, v89
    v_fma_f32 v79, v83, 2.0, v82
    v_fma_f32 v87, v91, 2.0, v90
    v_fma_f32 v82, v83, -2.0, v82
    v_fma_f32 v90, v91, -2.0, v90
    v_fmamk_f32 v80, v76, 0x41700000, v82
    v_fmamk_f32 v88, v84, 0x41700000, v90
    v_fmamk_f32 v80, v81, 0x41200000, v80
    v_fmamk_f32 v88, v89, 0x41200000, v88
    v_cvt_pk_bf16_f32 v37, v77, v85
    v_cvt_pk_bf16_f32 v41, v78, v86
    v_cvt_pk_bf16_f32 v65, v79, v87
    v_cvt_pk_bf16_f32 v69, v82, v90
    v_cvt_pk_bf16_f32 v73, v80, v88
    v_lshlrev_b32 v76, 16, v34
    v_and_b32 v84, s25, v34
    v_lshlrev_b32 v77, 16, v38
    v_and_b32 v85, s25, v38
    v_lshlrev_b32 v78, 16, v42
    v_and_b32 v86, s25, v42
    v_lshlrev_b32 v79, 16, v46
    v_and_b32 v87, s25, v46
    v_add_f32 v80, v76, v78
    v_add_f32 v88, v84, v86
    v_add_f32 v81, v77, v79
    v_add_f32 v89, v85, v87
    v_fma_f32 v82, v78, 4.0, v76
    v_fma_f32 v90, v86, 4.0, v84
    v_fma_f32 v83, v79, 4.0, v77
    v_fma_f32 v91, v87, 4.0, v85
    v_add_f32 v77, v80, v81
    v_add_f32 v85, v88, v89
    v_sub_f32 v78, v80, v81
    v_sub_f32 v86, v88, v89
    v_fma_f32 v79, v83, 2.0, v82
    v_fma_f32 v87, v91, 2.0, v90
    v_fma_f32 v82, v83, -2.0, v82
    v_fma_f32 v90, v91, -2.0, v90
    v_fmamk_f32 v80, v76, 0x41700000, v82
    v_fmamk_f32 v88, v84, 0x41700000, v90
    buffer_load_dwordx4 v[4:7], v93, s[8:11], s24 offen
    buffer_load_dwordx4 v[12:15], v95, s[8:11], s24 offen
    v_fmamk_f32 v80, v81, 0x41200000, v80
    v_fmamk_f32 v88, v89, 0x41200000, v88
    v_cvt_pk_bf16_f32 v38, v77, v85
    v_cvt_pk_bf16_f32 v42, v78, v86
    v_cvt_pk_bf16_f32 v66, v79, v87
    v_cvt_pk_bf16_f32 v70, v82, v90
    v_cvt_pk_bf16_f32 v74, v80, v88
    v_lshlrev_b32 v76, 16, v35
    v_and_b32 v84, s25, v35
    v_lshlrev_b32 v77, 16, v39
    v_and_b32 v85, s25, v39
    v_lshlrev_b32 v78, 16, v43
    v_and_b32 v86, s25, v43
    v_lshlrev_b32 v79, 16, v47
    v_and_b32 v87, s25, v47
    v_add_f32 v80, v76, v78
    v_add_f32 v88, v84, v86
    v_add_f32 v81, v77, v79
    v_add_f32 v89, v85, v87
    v_fma_f32 v82, v78, 4.0, v76
    v_fma_f32 v90, v86, 4.0, v84
    v_fma_f32 v83, v79, 4.0, v77
    v_fma_f32 v91, v87, 4.0, v85
    v_add_f32 v77, v80, v81
    v_add_f32 v85, v88, v89
    v_sub_f32 v78, v80, v81
    v_sub_f32 v86, v88, v89
    v_fma_f32 v79, v83, 2.0, v82
    v_fma_f32 v87, v91, 2.0, v90
    v_fma_f32 v82, v83, -2.0, v82
    v_fma_f32 v90, v91, -2.0, v90
    v_fmamk_f32 v80, v76, 0x41700000, v82
    v_fmamk_f32 v88, v84, 0x41700000, v90
    v_fmamk_f32 v80, v81, 0x41200000, v80
    v_fmamk_f32 v88, v89, 0x41200000, v88
    v_cvt_pk_bf16_f32 v39, v77, v85
    v_cvt_pk_bf16_f32 v43, v78, v86
    v_cvt_pk_bf16_f32 v67, v79, v87
    v_cvt_pk_bf16_f32 v71, v82, v90
    v_cvt_pk_bf16_f32 v75, v80, v88
    ds_write_b128 v96, v[64:67] offset:49152
    ds_write_b128 v97, v[68:71] offset:0
    ds_write_b128 v97, v[72:75] offset:16384
    ds_write_b128 v96, v[32:35] offset:0
    ds_write_b128 v96, v[36:39] offset:16384
    ds_write_b128 v96, v[40:43] offset:32768
    ds_write_b128 v98, v[44:47] offset:0
    s_add_u32 s28, s28, 1
    s_waitcnt lgkmcnt(0)
    s_barrier
    v_lshlrev_b32 v76, 16, v48
    v_and_b32 v84, s25, v48
    v_lshlrev_b32 v77, 16, v52
    v_and_b32 v85, s25, v52
    v_lshlrev_b32 v78, 16, v56
    v_and_b32 v86, s25, v56
    v_lshlrev_b32 v79, 16, v60
    v_and_b32 v87, s25, v60
    v_add_f32 v80, v76, v78
    v_add_f32 v88, v84, v86
    v_add_f32 v81, v77, v79
    v_add_f32 v89, v85, v87
    v_fma_f32 v82, v78, 4.0, v76
    buffer_load_dwordx4 v[16:19], v92, s[8:11], s27 offen
    buffer_load_dwordx4 v[24:27], v94, s[8:11], s27 offen
    v_fma_f32 v90, v86, 4.0, v84
    v_fma_f32 v83, v79, 4.0, v77
    v_fma_f32 v91, v87, 4.0, v85
    v_add_f32 v77, v80, v81
    v_add_f32 v85, v88, v89
    v_sub_f32 v78, v80, v81
    v_sub_f32 v86, v88, v89
    v_fma_f32 v79, v83, 2.0, v82
    v_fma_f32 v87, v91, 2.0, v90
    v_fma_f32 v82, v83, -2.0, v82
    v_fma_f32 v90, v91, -2.0, v90
    v_fmamk_f32 v80, v76, 0x41700000, v82
    v_fmamk_f32 v88, v84, 0x41700000, v90
    v_fmamk_f32 v80, v81, 0x41200000, v80
    v_fmamk_f32 v88, v89, 0x41200000, v88
    v_cvt_pk_bf16_f32 v52, v77, v85
    v_cvt_pk_bf16_f32 v56, v78, v86
    v_cvt_pk_bf16_f32 v64, v79, v87
    v_cvt_pk_bf16_f32 v68, v82, v90
    v_cvt_pk_bf16_f32 v72, v80, v88
    v_lshlrev_b32 v76, 16, v49
    v_and_b32 v84, s25, v49
    v_lshlrev_b32 v77, 16, v53
    v_and_b32 v85, s25, v53
    v_lshlrev_b32 v78, 16, v57
    v_and_b32 v86, s25, v57
    v_lshlrev_b32 v79, 16, v61
    v_and_b32 v87, s25, v61
    v_add_f32 v80, v76, v78
    v_add_f32 v88, v84, v86
    v_add_f32 v81, v77, v79
    v_add_f32 v89, v85, v87
    v_fma_f32 v82, v78, 4.0, v76
    v_fma_f32 v90, v86, 4.0, v84
    v_fma_f32 v83, v79, 4.0, v77
    v_fma_f32 v91, v87, 4.0, v85
    v_add_f32 v77, v80, v81
    v_add_f32 v85, v88, v89
    v_sub_f32 v78, v80, v81
    v_sub_f32 v86, v88, v89
    v_fma_f32 v79, v83, 2.0, v82
    v_fma_f32 v87, v91, 2.0, v90
    v_fma_f32 v82, v83, -2.0, v82
    v_fma_f32 v90, v91, -2.0, v90
    v_fmamk_f32 v80, v76, 0x41700000, v82
    v_fmamk_f32 v88, v84, 0x41700000, v90
    v_fmamk_f32 v80, v81, 0x41200000, v80
    v_fmamk_f32 v88, v89, 0x41200000, v88
    v_cvt_pk_bf16_f32 v53, v77, v85
    v_cvt_pk_bf16_f32 v57, v78, v86
    v_cvt_pk_bf16_f32 v65, v79, v87
    v_cvt_pk_bf16_f32 v69, v82, v90
    v_cvt_pk_bf16_f32 v73, v80, v88
    buffer_load_dwordx4 v[20:23], v93, s[8:11], s27 offen
    buffer_load_dwordx4 v[28:31], v95, s[8:11], s27 offen
    v_lshlrev_b32 v76, 16, v50
    v_and_b32 v84, s25, v50
    v_lshlrev_b32 v77, 16, v54
    v_and_b32 v85, s25, v54
    v_lshlrev_b32 v78, 16, v58
    v_and_b32 v86, s25, v58
    v_lshlrev_b32 v79, 16, v62
    v_and_b32 v87, s25, v62
    v_add_f32 v80, v76, v78
    v_add_f32 v88, v84, v86
    v_add_f32 v81, v77, v79
    v_add_f32 v89, v85, v87
    v_fma_f32 v82, v78, 4.0, v76
    v_fma_f32 v90, v86, 4.0, v84
    v_fma_f32 v83, v79, 4.0, v77
    v_fma_f32 v91, v87, 4.0, v85
    v_add_f32 v77, v80, v81
    v_add_f32 v85, v88, v89
    v_sub_f32 v78, v80, v81
    v_sub_f32 v86, v88, v89
    v_fma_f32 v79, v83, 2.0, v82
    v_fma_f32 v87, v91, 2.0, v90
    v_fma_f32 v82, v83, -2.0, v82
    v_fma_f32 v90, v91, -2.0, v90
    v_fmamk_f32 v80, v76, 0x41700000, v82
    v_fmamk_f32 v88, v84, 0x41700000, v90
    v_fmamk_f32 v80, v81, 0x41200000, v80
    v_fmamk_f32 v88, v89, 0x41200000, v88
    v_cvt_pk_bf16_f32 v54, v77, v85
    v_cvt_pk_bf16_f32 v58, v78, v86
    v_cvt_pk_bf16_f32 v66, v79, v87
    v_cvt_pk_bf16_f32 v70, v82, v90
    v_cvt_pk_bf16_f32 v74, v80, v88
    v_lshlrev_b32 v76, 16, v51
    v_and_b32 v84, s25, v51
    v_lshlrev_b32 v77, 16, v55
    v_and_b32 v85, s25, v55
    v_lshlrev_b32 v78, 16, v59
    v_and_b32 v86, s25, v59
    v_lshlrev_b32 v79, 16, v63
    v_and_b32 v87, s25, v63
    v_add_f32 v80, v76, v78
    v_add_f32 v88, v84, v86
    v_add_f32 v81, v77, v79
    v_add_f32 v89, v85, v87
    v_fma_f32 v82, v78, 4.0, v76
    v_fma_f32 v90, v86, 4.0, v84
    v_fma_f32 v83, v79, 4.0, v77
    v_fma_f32 v91, v87, 4.0, v85
    v_add_f32 v77, v80, v81
    v_add_f32 v85, v88, v89
    v_sub_f32 v78, v80, v81
    v_sub_f32 v86, v88, v89
    v_fma_f32 v79, v83, 2.0, v82
    v_fma_f32 v87, v91, 2.0, v90
    v_fma_f32 v82, v83, -2.0, v82
    v_fma_f32 v90, v91, -2.0, v90
    v_fmamk_f32 v80, v76, 0x41700000, v82
    v_fmamk_f32 v88, v84, 0x41700000, v90
    v_fmamk_f32 v80, v81, 0x41200000, v80
    v_fmamk_f32 v88, v89, 0x41200000, v88
    v_cvt_pk_bf16_f32 v55, v77, v85
    v_cvt_pk_bf16_f32 v59, v78, v86
    v_cvt_pk_bf16_f32 v67, v79, v87
    v_cvt_pk_bf16_f32 v71, v82, v90
    v_cvt_pk_bf16_f32 v75, v80, v88
    ds_write_b128 v96, v[64:67] offset:57344
    ds_write_b128 v97, v[68:71] offset:8192
    ds_write_b128 v97, v[72:75] offset:24576
    ds_write_b128 v96, v[48:51] offset:8192
    ds_write_b128 v96, v[52:55] offset:24576
    ds_write_b128 v96, v[56:59] offset:40960
    ds_write_b128 v98, v[60:63] offset:8704
    s_add_u32 s28, s28, 1
    s_waitcnt lgkmcnt(0)
    s_barrier
    s_cmp_eq_u32 s22, 1
    s_cbranch_scc1 L_conv2_kernel_hlast1
    s_add_u32 s24, s24, 1048576
    s_add_u32 s27, s27, 1048576
    s_waitcnt vmcnt(0)
    v_lshlrev_b32 v76, 16, v0
    v_and_b32 v84, s25, v0
    v_lshlrev_b32 v77, 16, v4
    v_and_b32 v85, s25, v4
    v_lshlrev_b32 v78, 16, v8
    v_and_b32 v86, s25, v8
    v_lshlrev_b32 v79, 16, v12
    v_and_b32 v87, s25, v12
    v_add_f32 v80, v76, v78
    v_add_f32 v88, v84, v86
    v_add_f32 v81, v77, v79
    v_add_f32 v89, v85, v87
    v_fma_f32 v82, v78, 4.0, v76
    v_fma_f32 v90, v86, 4.0, v84
    v_fma_f32 v83, v79, 4.0, v77
    v_fma_f32 v91, v87, 4.0, v85
    v_add_f32 v77, v80, v81
    v_add_f32 v85, v88, v89
    v_sub_f32 v78, v80, v81
    v_sub_f32 v86, v88, v89
    v_fma_f32 v79, v83, 2.0, v82
    v_fma_f32 v87, v91, 2.0, v90
    v_fma_f32 v82, v83, -2.0, v82
    v_fma_f32 v90, v91, -2.0, v90
    v_fmamk_f32 v80, v76, 0x41700000, v82
    v_fmamk_f32 v88, v84, 0x41700000, v90
    v_fmamk_f32 v80, v81, 0x41200000, v80
    v_fmamk_f32 v88, v89, 0x41200000, v88
    v_cvt_pk_bf16_f32 v4, v77, v85
    v_cvt_pk_bf16_f32 v8, v78, v86
    v_cvt_pk_bf16_f32 v64, v79, v87
    v_cvt_pk_bf16_f32 v68, v82, v90
    v_cvt_pk_bf16_f32 v72, v80, v88
    v_lshlrev_b32 v76, 16, v1
    v_and_b32 v84, s25, v1
    v_lshlrev_b32 v77, 16, v5
    v_and_b32 v85, s25, v5
    v_lshlrev_b32 v78, 16, v9
    v_and_b32 v86, s25, v9
    buffer_load_dwordx4 v[32:35], v92, s[8:11], s24 offen
    buffer_load_dwordx4 v[40:43], v94, s[8:11], s24 offen
    v_lshlrev_b32 v79, 16, v13
    v_and_b32 v87, s25, v13
    v_add_f32 v80, v76, v78
    v_add_f32 v88, v84, v86
    v_add_f32 v81, v77, v79
    v_add_f32 v89, v85, v87
    v_fma_f32 v82, v78, 4.0, v76
    v_fma_f32 v90, v86, 4.0, v84
    v_fma_f32 v83, v79, 4.0, v77
    v_fma_f32 v91, v87, 4.0, v85
    v_add_f32 v77, v80, v81
    v_add_f32 v85, v88, v89
    v_sub_f32 v78, v80, v81
    v_sub_f32 v86, v88, v89
    v_fma_f32 v79, v83, 2.0, v82
    v_fma_f32 v87, v91, 2.0, v90
    v_fma_f32 v82, v83, -2.0, v82
    v_fma_f32 v90, v91, -2.0, v90
    v_fmamk_f32 v80, v76, 0x41700000, v82
    v_fmamk_f32 v88, v84, 0x41700000, v90
    v_fmamk_f32 v80, v81, 0x41200000, v80
    v_fmamk_f32 v88, v89, 0x41200000, v88
    v_cvt_pk_bf16_f32 v5, v77, v85
    v_cvt_pk_bf16_f32 v9, v78, v86
    v_cvt_pk_bf16_f32 v65, v79, v87
    v_cvt_pk_bf16_f32 v69, v82, v90
    v_cvt_pk_bf16_f32 v73, v80, v88
    v_lshlrev_b32 v76, 16, v2
    v_and_b32 v84, s25, v2
    v_lshlrev_b32 v77, 16, v6
    v_and_b32 v85, s25, v6
    v_lshlrev_b32 v78, 16, v10
    v_and_b32 v86, s25, v10
    v_lshlrev_b32 v79, 16, v14
    v_and_b32 v87, s25, v14
    v_add_f32 v80, v76, v78
    v_add_f32 v88, v84, v86
    v_add_f32 v81, v77, v79
    v_add_f32 v89, v85, v87
    v_fma_f32 v82, v78, 4.0, v76
    v_fma_f32 v90, v86, 4.0, v84
    v_fma_f32 v83, v79, 4.0, v77
    v_fma_f32 v91, v87, 4.0, v85
    v_add_f32 v77, v80, v81
    v_add_f32 v85, v88, v89
    v_sub_f32 v78, v80, v81
    v_sub_f32 v86, v88, v89
    v_fma_f32 v79, v83, 2.0, v82
    v_fma_f32 v87, v91, 2.0, v90
    v_fma_f32 v82, v83, -2.0, v82
    v_fma_f32 v90, v91, -2.0, v90
    v_fmamk_f32 v80, v76, 0x41700000, v82
    v_fmamk_f32 v88, v84, 0x41700000, v90
    buffer_load_dwordx4 v[36:39], v93, s[8:11], s24 offen
    buffer_load_dwordx4 v[44:47], v95, s[8:11], s24 offen
    v_fmamk_f32 v80, v81, 0x41200000, v80
    v_fmamk_f32 v88, v89, 0x41200000, v88
    v_cvt_pk_bf16_f32 v6, v77, v85
    v_cvt_pk_bf16_f32 v10, v78, v86
    v_cvt_pk_bf16_f32 v66, v79, v87
    v_cvt_pk_bf16_f32 v70, v82, v90
    v_cvt_pk_bf16_f32 v74, v80, v88
    v_lshlrev_b32 v76, 16, v3
    v_and_b32 v84, s25, v3
    v_lshlrev_b32 v77, 16, v7
    v_and_b32 v85, s25, v7
    v_lshlrev_b32 v78, 16, v11
    v_and_b32 v86, s25, v11
    v_lshlrev_b32 v79, 16, v15
    v_and_b32 v87, s25, v15
    v_add_f32 v80, v76, v78
    v_add_f32 v88, v84, v86
    v_add_f32 v81, v77, v79
    v_add_f32 v89, v85, v87
    v_fma_f32 v82, v78, 4.0, v76
    v_fma_f32 v90, v86, 4.0, v84
    v_fma_f32 v83, v79, 4.0, v77
    v_fma_f32 v91, v87, 4.0, v85
    v_add_f32 v77, v80, v81
    v_add_f32 v85, v88, v89
    v_sub_f32 v78, v80, v81
    v_sub_f32 v86, v88, v89
    v_fma_f32 v79, v83, 2.0, v82
    v_fma_f32 v87, v91, 2.0, v90
    v_fma_f32 v82, v83, -2.0, v82
    v_fma_f32 v90, v91, -2.0, v90
    v_fmamk_f32 v80, v76, 0x41700000, v82
    v_fmamk_f32 v88, v84, 0x41700000, v90
    v_fmamk_f32 v80, v81, 0x41200000, v80
    v_fmamk_f32 v88, v89, 0x41200000, v88
    v_cvt_pk_bf16_f32 v7, v77, v85
    v_cvt_pk_bf16_f32 v11, v78, v86
    v_cvt_pk_bf16_f32 v67, v79, v87
    v_cvt_pk_bf16_f32 v71, v82, v90
    v_cvt_pk_bf16_f32 v75, v80, v88
    ds_write_b128 v96, v[64:67] offset:49152
    ds_write_b128 v97, v[68:71] offset:0
    ds_write_b128 v97, v[72:75] offset:16384
    ds_write_b128 v96, v[0:3] offset:0
    ds_write_b128 v96, v[4:7] offset:16384
    ds_write_b128 v96, v[8:11] offset:32768
    ds_write_b128 v98, v[12:15] offset:0
    s_add_u32 s28, s28, 1
    s_waitcnt lgkmcnt(0)
    s_barrier
    s_sub_u32 s22, s22, 1
    s_branch L_conv2_kernel_hloop1
L_conv2_kernel_hlast1:
    s_branch L_conv2_kernel_end
L_conv2_kernel_h2:
    ds_write_b128 v96, v[0:3] offset:0
    ds_write_b128 v98, v[12:15] offset:0
    v_lshlrev_b32 v76, 16, v0
    v_and_b32 v84, s25, v0
    v_lshlrev_b32 v77, 16, v4
    v_and_b32 v85, s25, v4
    v_lshlrev_b32 v78, 16, v8
    v_and_b32 v86, s25, v8
    v_lshlrev_b32 v79, 16, v12
    v_and_b32 v87, s25, v12
    v_add_f32 v80, v76, v78
    v_add_f32 v88, v84, v86
    v_add_f32 v81, v77, v79
    v_add_f32 v89, v85, v87
    v_fma_f32 v82, v78, 4.0, v76
    v_fma_f32 v90, v86, 4.0, v84
    v_fma_f32 v83, v79, 4.0, v77
    v_fma_f32 v91, v87, 4.0, v85
    v_add_f32 v77, v80, v81
    v_add_f32 v85, v88, v89
    v_sub_f32 v78, v80, v81
    v_sub_f32 v86, v88, v89
    v_fma_f32 v79, v83, 2.0, v82
    v_fma_f32 v87, v91, 2.0, v90
    v_fma_f32 v82, v83, -2.0, v82
    v_fma_f32 v90, v91, -2.0, v90
    v_fmamk_f32 v80, v76, 0x41700000, v82
    v_fmamk_f32 v88, v84, 0x41700000, v90
    v_fmamk_f32 v80, v81, 0x41200000, v80
    v_fmamk_f32 v88, v89, 0x41200000, v88
    v_cvt_pk_bf16_f32 v4, v77, v85
    v_cvt_pk_bf16_f32 v8, v78, v86
    v_cvt_pk_bf16_f32 v64, v79, v87
    v_cvt_pk_bf16_f32 v68, v82, v90
    v_cvt_pk_bf16_f32 v72, v80, v88
    v_lshlrev_b32 v76, 16, v1
    v_and_b32 v84, s25, v1
    v_lshlrev_b32 v77, 16, v5
    v_and_b32 v85, s25, v5
    v_lshlrev_b32 v78, 16, v9
    v_and_b32 v86, s25, v9
    v_lshlrev_b32 v79, 16, v13
    v_and_b32 v87, s25, v13
    v_add_f32 v80, v76, v78
    v_add_f32 v88, v84, v86
    v_add_f32 v81, v77, v79
    v_add_f32 v89, v85, v87
    v_fma_f32 v82, v78, 4.0, v76
    v_fma_f32 v90, v86, 4.0, v84
    v_fma_f32 v83, v79, 4.0, v77
    v_fma_f32 v91, v87, 4.0, v85
    v_add_f32 v77, v80, v81
    v_add_f32 v85, v88, v89
    v_sub_f32 v78, v80, v81
    v_sub_f32 v86, v88, v89
    v_fma_f32 v79, v83, 2.0, v82
    v_fma_f32 v87, v91, 2.0, v90
    v_fma_f32 v82, v83, -2.0, v82
    v_fma_f32 v90, v91, -2.0, v90
    v_fmamk_f32 v80, v76, 0x41700000, v82
    v_fmamk_f32 v88, v84, 0x41700000, v90
    v_fmamk_f32 v80, v81, 0x41200000, v80
    v_fmamk_f32 v88, v89, 0x41200000, v88
    v_cvt_pk_bf16_f32 v5, v77, v85
    v_cvt_pk_bf16_f32 v9, v78, v86
    v_cvt_pk_bf16_f32 v65, v79, v87
    v_cvt_pk_bf16_f32 v69, v82, v90
    v_cvt_pk_bf16_f32 v73, v80, v88
    v_lshlrev_b32 v76, 16, v2
    v_and_b32 v84, s25, v2
    v_lshlrev_b32 v77, 16, v6
    v_and_b32 v85, s25, v6
    v_lshlrev_b32 v78, 16, v10
    v_and_b32 v86, s25, v10
    v_lshlrev_b32 v79, 16, v14
    v_and_b32 v87, s25, v14
    v_add_f32 v80, v76, v78
    v_add_f32 v88, v84, v86
    v_add_f32 v81, v77, v79
    v_add_f32 v89, v85, v87
    v_fma_f32 v82, v78, 4.0, v76
    v_fma_f32 v90, v86, 4.0, v84
    v_fma_f32 v83, v79, 4.0, v77
    v_fma_f32 v91, v87, 4.0, v85
    v_add_f32 v77, v80, v81
    v_add_f32 v85, v88, v89
    v_sub_f32 v78, v80, v81
    v_sub_f32 v86, v88, v89
    v_fma_f32 v79, v83, 2.0, v82
    v_fma_f32 v87, v91, 2.0, v90
    v_fma_f32 v82, v83, -2.0, v82
    v_fma_f32 v90, v91, -2.0, v90
    v_fmamk_f32 v80, v76, 0x41700000, v82
    v_fmamk_f32 v88, v84, 0x41700000, v90
    v_fmamk_f32 v80, v81, 0x41200000, v80
    v_fmamk_f32 v88, v89, 0x41200000, v88
    v_cvt_pk_bf16_f32 v6, v77, v85
    v_cvt_pk_bf16_f32 v10, v78, v86
    v_cvt_pk_bf16_f32 v66, v79, v87
    v_cvt_pk_bf16_f32 v70, v82, v90
    v_cvt_pk_bf16_f32 v74, v80, v88
    v_lshlrev_b32 v76, 16, v3
    v_and_b32 v84, s25, v3
    v_lshlrev_b32 v77, 16, v7
    v_and_b32 v85, s25, v7
    v_lshlrev_b32 v78, 16, v11
    v_and_b32 v86, s25, v11
    v_lshlrev_b32 v79, 16, v15
    v_and_b32 v87, s25, v15
    v_add_f32 v80, v76, v78
    v_add_f32 v88, v84, v86
    v_add_f32 v81, v77, v79
    v_add_f32 v89, v85, v87
    v_fma_f32 v82, v78, 4.0, v76
    v_fma_f32 v90, v86, 4.0, v84
    v_fma_f32 v83, v79, 4.0, v77
    v_fma_f32 v91, v87, 4.0, v85
    v_add_f32 v77, v80, v81
    v_add_f32 v85, v88, v89
    v_sub_f32 v78, v80, v81
    v_sub_f32 v86, v88, v89
    v_fma_f32 v79, v83, 2.0, v82
    v_fma_f32 v87, v91, 2.0, v90
    v_fma_f32 v82, v83, -2.0, v82
    v_fma_f32 v90, v91, -2.0, v90
    v_fmamk_f32 v80, v76, 0x41700000, v82
    v_fmamk_f32 v88, v84, 0x41700000, v90
    v_fmamk_f32 v80, v81, 0x41200000, v80
    v_fmamk_f32 v88, v89, 0x41200000, v88
    v_cvt_pk_bf16_f32 v7, v77, v85
    v_cvt_pk_bf16_f32 v11, v78, v86
    v_cvt_pk_bf16_f32 v67, v79, v87
    v_cvt_pk_bf16_f32 v71, v82, v90
    v_cvt_pk_bf16_f32 v75, v80, v88
    ds_write_b128 v96, v[64:67] offset:49152
    ds_write_b128 v97, v[68:71] offset:0
    ds_write_b128 v97, v[72:75] offset:16384
    ds_write_b128 v96, v[4:7] offset:16384
    ds_write_b128 v96, v[8:11] offset:32768
    s_waitcnt vmcnt(0)
    s_mov_b32 s24, 1048576
    s_mov_b32 s27, 1572864
    buffer_load_dwordx4 v[32:35], v92, s[8:11], s24 offen
    buffer_load_dwordx4 v[40:43], v94, s[8:11], s24 offen
    buffer_load_dwordx4 v[36:39], v93, s[8:11], s24 offen
    buffer_load_dwordx4 v[44:47], v95, s[8:11], s24 offen
    buffer_load_dwordx4 v[48:51], v92, s[8:11], s27 offen
    buffer_load_dwordx4 v[56:59], v94, s[8:11], s27 offen
    buffer_load_dwordx4 v[52:55], v93, s[8:11], s27 offen
    buffer_load_dwordx4 v[60:63], v95, s[8:11], s27 offen
    s_waitcnt lgkmcnt(0)
    s_barrier
    s_setprio 0
    v_lshlrev_b32 v76, 16, v16
    v_and_b32 v84, s25, v16
    v_lshlrev_b32 v77, 16, v20
    v_and_b32 v85, s25, v20
    v_lshlrev_b32 v78, 16, v24
    v_and_b32 v86, s25, v24
    v_lshlrev_b32 v79, 16, v28
    v_and_b32 v87, s25, v28
    v_add_f32 v80, v76, v78
    v_add_f32 v88, v84, v86
    v_add_f32 v81, v77, v79
    v_add_f32 v89, v85, v87
    v_fma_f32 v82, v78, 4.0, v76
    v_fma_f32 v90, v86, 4.0, v84
    v_fma_f32 v83, v79, 4.0, v77
    v_fma_f32 v91, v87, 4.0, v85
    v_add_f32 v77, v80, v81
    v_add_f32 v85, v88, v89
    v_sub_f32 v78, v80, v81
    v_sub_f32 v86, v88, v89
    v_fma_f32 v79, v83, 2.0, v82
    v_fma_f32 v87, v91, 2.0, v90
    v_fma_f32 v82, v83, -2.0, v82
    v_fma_f32 v90, v91, -2.0, v90
    v_fmamk_f32 v80, v76, 0x41700000, v82
    v_fmamk_f32 v88, v84, 0x41700000, v90
    v_fmamk_f32 v80, v81, 0x41200000, v80
    v_fmamk_f32 v88, v89, 0x41200000, v88
    v_cvt_pk_bf16_f32 v20, v77, v85
    v_cvt_pk_bf16_f32 v24, v78, v86
    v_cvt_pk_bf16_f32 v64, v79, v87
    v_cvt_pk_bf16_f32 v68, v82, v90
    v_cvt_pk_bf16_f32 v72, v80, v88
    v_lshlrev_b32 v76, 16, v17
    v_and_b32 v84, s25, v17
    v_lshlrev_b32 v77, 16, v21
    v_and_b32 v85, s25, v21
    v_lshlrev_b32 v78, 16, v25
    v_and_b32 v86, s25, v25
    v_lshlrev_b32 v79, 16, v29
    v_and_b32 v87, s25, v29
    v_add_f32 v80, v76, v78
    v_add_f32 v88, v84, v86
    v_add_f32 v81, v77, v79
    v_add_f32 v89, v85, v87
    v_fma_f32 v82, v78, 4.0, v76
    v_fma_f32 v90, v86, 4.0, v84
    v_fma_f32 v83, v79, 4.0, v77
    v_fma_f32 v91, v87, 4.0, v85
    v_add_f32 v77, v80, v81
    v_add_f32 v85, v88, v89
    v_sub_f32 v78, v80, v81
    v_sub_f32 v86, v88, v89
    v_fma_f32 v79, v83, 2.0, v82
    v_fma_f32 v87, v91, 2.0, v90
    v_fma_f32 v82, v83, -2.0, v82
    v_fma_f32 v90, v91, -2.0, v90
    v_fmamk_f32 v80, v76, 0x41700000, v82
    v_fmamk_f32 v88, v84, 0x41700000, v90
    v_fmamk_f32 v80, v81, 0x41200000, v80
    v_fmamk_f32 v88, v89, 0x41200000, v88
    v_cvt_pk_bf16_f32 v21, v77, v85
    v_cvt_pk_bf16_f32 v25, v78, v86
    v_cvt_pk_bf16_f32 v65, v79, v87
    v_cvt_pk_bf16_f32 v69, v82, v90
    v_cvt_pk_bf16_f32 v73, v80, v88
    v_lshlrev_b32 v76, 16, v18
    v_and_b32 v84, s25, v18
    v_lshlrev_b32 v77, 16, v22
    v_and_b32 v85, s25, v22
    v_lshlrev_b32 v78, 16, v26
    v_and_b32 v86, s25, v26
    v_lshlrev_b32 v79, 16, v30
    v_and_b32 v87, s25, v30
    v_add_f32 v80, v76, v78
    v_add_f32 v88, v84, v86
    v_add_f32 v81, v77, v79
    v_add_f32 v89, v85, v87
    v_fma_f32 v82, v78, 4.0, v76
    v_fma_f32 v90, v86, 4.0, v84
    v_fma_f32 v83, v79, 4.0, v77
    v_fma_f32 v91, v87, 4.0, v85
    v_add_f32 v77, v80, v81
    v_add_f32 v85, v88, v89
    v_sub_f32 v78, v80, v81
    v_sub_f32 v86, v88, v89
    v_fma_f32 v79, v83, 2.0, v82
    v_fma_f32 v87, v91, 2.0, v90
    v_fma_f32 v82, v83, -2.0, v82
    v_fma_f32 v90, v91, -2.0, v90
    v_fmamk_f32 v80, v76, 0x41700000, v82
    v_fmamk_f32 v88, v84, 0x41700000, v90
    v_fmamk_f32 v80, v81, 0x41200000, v80
    v_fmamk_f32 v88, v89, 0x41200000, v88
    v_cvt_pk_bf16_f32 v22, v77, v85
    v_cvt_pk_bf16_f32 v26, v78, v86
    v_cvt_pk_bf16_f32 v66, v79, v87
    v_cvt_pk_bf16_f32 v70, v82, v90
    v_cvt_pk_bf16_f32 v74, v80, v88
    v_lshlrev_b32 v76, 16, v19
    v_and_b32 v84, s25, v19
    v_lshlrev_b32 v77, 16, v23
    v_and_b32 v85, s25, v23
    v_lshlrev_b32 v78, 16, v27
    v_and_b32 v86, s25, v27
    v_lshlrev_b32 v79, 16, v31
    v_and_b32 v87, s25, v31
    v_add_f32 v80, v76, v78
    v_add_f32 v88, v84, v86
    v_add_f32 v81, v77, v79
    v_add_f32 v89, v85, v87
    v_fma_f32 v82, v78, 4.0, v76
    v_fma_f32 v90, v86, 4.0, v84
    v_fma_f32 v83, v79, 4.0, v77
    v_fma_f32 v91, v87, 4.0, v85
    v_add_f32 v77, v80, v81
    v_add_f32 v85, v88, v89
    v_sub_f32 v78, v80, v81
    v_sub_f32 v86, v88, v89
    v_fma_f32 v79, v83, 2.0, v82
    v_fma_f32 v87, v91, 2.0, v90
    v_fma_f32 v82, v83, -2.0, v82
    v_fma_f32 v90, v91, -2.0, v90
    v_fmamk_f32 v80, v76, 0x41700000, v82
    v_fmamk_f32 v88, v84, 0x41700000, v90
    v_fmamk_f32 v80, v81, 0x41200000, v80
    v_fmamk_f32 v88, v89, 0x41200000, v88
    v_cvt_pk_bf16_f32 v23, v77, v85
    v_cvt_pk_bf16_f32 v27, v78, v86
    v_cvt_pk_bf16_f32 v67, v79, v87
    v_cvt_pk_bf16_f32 v71, v82, v90
    v_cvt_pk_bf16_f32 v75, v80, v88
L_conv2_kernel_hloop2:
    s_add_u32 s24, s24, 1048576
    s_add_u32 s27, s27, 1048576
    ds_write_b128 v96, v[64:67] offset:57344
    ds_write_b128 v97, v[68:71] offset:8192
    ds_write_b128 v97, v[72:75] offset:24576
    ds_write_b128 v96, v[16:19] offset:8192
    ds_write_b128 v96, v[20:23] offset:24576
    ds_write_b128 v96, v[24:27] offset:40960
    ds_write_b128 v98, v[28:31] offset:8704
    s_waitcnt vmcnt(0)
    v_lshlrev_b32 v76, 16, v32
    v_and_b32 v84, s25, v32
    v_lshlrev_b32 v77, 16, v36
    v_and_b32 v85, s25, v36
    v_lshlrev_b32 v78, 16, v40
    v_and_b32 v86, s25, v40
    v_lshlrev_b32 v79, 16, v44
    v_and_b32 v87, s25, v44
    v_add_f32 v80, v76, v78
    v_add_f32 v88, v84, v86
    v_add_f32 v81, v77, v79
    v_add_f32 v89, v85, v87
    v_fma_f32 v82, v78, 4.0, v76
    v_fma_f32 v90, v86, 4.0, v84
    v_fma_f32 v83, v79, 4.0, v77
    v_fma_f32 v91, v87, 4.0, v85
    v_add_f32 v77, v80, v81
    v_add_f32 v85, v88, v89
    v_sub_f32 v78, v80, v81
    v_sub_f32 v86, v88, v89
    v_fma_f32 v79, v83, 2.0, v82
    v_fma_f32 v87, v91, 2.0, v90
    v_fma_f32 v82, v83, -2.0, v82
    v_fma_f32 v90, v91, -2.0, v90
    v_fmamk_f32 v80, v76, 0x41700000, v82
    v_fmamk_f32 v88, v84, 0x41700000, v90
    buffer_load_dwordx4 v[0:3], v92, s[8:11], s24 offen
    buffer_load_dwordx4 v[8:11], v94, s[8:11], s24 offen
    v_fmamk_f32 v80, v81, 0x41200000, v80
    v_fmamk_f32 v88, v89, 0x41200000, v88
    v_cvt_pk_bf16_f32 v36, v77, v85
    v_cvt_pk_bf16_f32 v40, v78, v86
    v_cvt_pk_bf16_f32 v64, v79, v87
    v_cvt_pk_bf16_f32 v68, v82, v90
    v_cvt_pk_bf16_f32 v72, v80, v88
    v_lshlrev_b32 v76, 16, v33
    v_and_b32 v84, s25, v33
    v_lshlrev_b32 v77, 16, v37
    v_and_b32 v85, s25, v37
    v_lshlrev_b32 v78, 16, v41
    v_and_b32 v86, s25, v41
    v_lshlrev_b32 v79, 16, v45
    v_and_b32 v87, s25, v45
    v_add_f32 v80, v76, v78
    v_add_f32 v88, v84, v86
    v_add_f32 v81, v77, v79
    v_add_f32 v89, v85, v87
    v_fma_f32 v82, v78, 4.0, v76
    v_fma_f32 v90, v86, 4.0, v84
    v_fma_f32 v83, v79, 4.0, v77
    v_fma_f32 v91, v87, 4.0, v85
    v_add_f32 v77, v80, v81
    v_add_f32 v85, v88, v89
    v_sub_f32 v78, v80, v81
    v_sub_f32 v86, v88, v89
    v_fma_f32 v79, v83, 2.0, v82
    v_fma_f32 v87, v91, 2.0, v90
    v_fma_f32 v82, v83, -2.0, v82
    v_fma_f32 v90, v91, -2.0, v90
    v_fmamk_f32 v80, v76, 0x41700000, v82
    v_fmamk_f32 v88, v84, 0x41700000, v90
    v_fmamk_f32 v80, v81, 0x41200000, v80
    v_fmamk_f32 v88, v89, 0x41200000, v88
    v_cvt_pk_bf16_f32 v37, v77, v85
    v_cvt_pk_bf16_f32 v41, v78, v86
    v_cvt_pk_bf16_f32 v65, v79, v87
    v_cvt_pk_bf16_f32 v69, v82, v90
    v_cvt_pk_bf16_f32 v73, v80, v88
    v_lshlrev_b32 v76, 16, v34
    v_and_b32 v84, s25, v34
    v_lshlrev_b32 v77, 16, v38
    v_and_b32 v85, s25, v38
    v_lshlrev_b32 v78, 16, v42
    v_and_b32 v86, s25, v42
    v_lshlrev_b32 v79, 16, v46
    v_and_b32 v87, s25, v46
    v_add_f32 v80, v76, v78
    v_add_f32 v88, v84, v86
    v_add_f32 v81, v77, v79
    v_add_f32 v89, v85, v87
    v_fma_f32 v82, v78, 4.0, v76
    buffer_load_dwordx4 v[4:7], v93, s[8:11], s24 offen
    buffer_load_dwordx4 v[12:15], v95, s[8:11], s24 offen
    v_fma_f32 v90, v86, 4.0, v84
    v_fma_f32 v83, v79, 4.0, v77
    v_fma_f32 v91, v87, 4.0, v85
    v_add_f32 v77, v80, v81
    v_add_f32 v85, v88, v89
    v_sub_f32 v78, v80, v81
    v_sub_f32 v86, v88, v89
    v_fma_f32 v79, v83, 2.0, v82
    v_fma_f32 v87, v91, 2.0, v90
    v_fma_f32 v82, v83, -2.0, v82
    v_fma_f32 v90, v91, -2.0, v90
    v_fmamk_f32 v80, v76, 0x41700000, v82
    v_fmamk_f32 v88, v84, 0x41700000, v90
    v_fmamk_f32 v80, v81, 0x41200000, v80
    v_fmamk_f32 v88, v89, 0x41200000, v88
    v_cvt_pk_bf16_f32 v38, v77, v85
    v_cvt_pk_bf16_f32 v42, v78, v86
    v_cvt_pk_bf16_f32 v66, v79, v87
    v_cvt_pk_bf16_f32 v70, v82, v90
    v_cvt_pk_bf16_f32 v74, v80, v88
    v_lshlrev_b32 v76, 16, v35
    v_and_b32 v84, s25, v35
    v_lshlrev_b32 v77, 16, v39
    v_and_b32 v85, s25, v39
    v_lshlrev_b32 v78, 16, v43
    v_and_b32 v86, s25, v43
    v_lshlrev_b32 v79, 16, v47
    v_and_b32 v87, s25, v47
    v_add_f32 v80, v76, v78
    v_add_f32 v88, v84, v86
    v_add_f32 v81, v77, v79
    v_add_f32 v89, v85, v87
    v_fma_f32 v82, v78, 4.0, v76
    v_fma_f32 v90, v86, 4.0, v84
    v_fma_f32 v83, v79, 4.0, v77
    v_fma_f32 v91, v87, 4.0, v85
    v_add_f32 v77, v80, v81
    v_add_f32 v85, v88, v89
    v_sub_f32 v78, v80, v81
    v_sub_f32 v86, v88, v89
    v_fma_f32 v79, v83, 2.0, v82
    v_fma_f32 v87, v91, 2.0, v90
    v_fma_f32 v82, v83, -2.0, v82
    v_fma_f32 v90, v91, -2.0, v90
    v_fmamk_f32 v80, v76, 0x41700000, v82
    v_fmamk_f32 v88, v84, 0x41700000, v90
    v_fmamk_f32 v80, v81, 0x41200000, v80
    v_fmamk_f32 v88, v89, 0x41200000, v88
    v_cvt_pk_bf16_f32 v39, v77, v85
    v_cvt_pk_bf16_f32 v43, v78, v86
    v_cvt_pk_bf16_f32 v67, v79, v87
    v_cvt_pk_bf16_f32 v71, v82, v90
    v_cvt_pk_bf16_f32 v75, v80, v88
    s_add_u32 s28, s28, 1
    s_waitcnt lgkmcnt(0)
    s_barrier
    ds_write_b128 v96, v[64:67] offset:49152
    ds_write_b128 v97, v[68:71] offset:0
    ds_write_b128 v97, v[72:75] offset:16384
    ds_write_b128 v96, v[32:35] offset:0
    ds_write_b128 v96, v[36:39] offset:16384
    ds_write_b128 v96, v[40:43] offset:32768
    ds_write_b128 v98, v[44:47] offset:0
    v_lshlrev_b32 v76, 16, v48
    v_and_b32 v84, s25, v48
    buffer_load_dwordx4 v[16:19], v92, s[8:11], s27 offen
    buffer_load_dwordx4 v[24:27], v94, s[8:11], s27 offen
    v_lshlrev_b32 v77, 16, v52
    v_and_b32 v85, s25, v52
    v_lshlrev_b32 v78, 16, v56
    v_and_b32 v86, s25, v56
    v_lshlrev_b32 v79, 16, v60
    v_and_b32 v87, s25, v60
    v_add_f32 v80, v76, v78
    v_add_f32 v88, v84, v86
    v_add_f32 v81, v77, v79
    v_add_f32 v89, v85, v87
    v_fma_f32 v82, v78, 4.0, v76
    v_fma_f32 v90, v86, 4.0, v84
    v_fma_f32 v83, v79, 4.0, v77
    v_fma_f32 v91, v87, 4.0, v85
    v_add_f32 v77, v80, v81
    v_add_f32 v85, v88, v89
    v_sub_f32 v78, v80, v81
    buffer_load_dwordx4 v[20:23], v93, s[8:11], s27 offen
    buffer_load_dwordx4 v[28:31], v95, s[8:11], s27 offen
    v_sub_f32 v86, v88, v89
    v_fma_f32 v79, v83, 2.0, v82
    v_fma_f32 v87, v91, 2.0, v90
    v_fma_f32 v82, v83, -2.0, v82
    v_fma_f32 v90, v91, -2.0, v90
    v_fmamk_f32 v80, v76, 0x41700000, v82
    v_fmamk_f32 v88, v84, 0x41700000, v90
    v_fmamk_f32 v80, v81, 0x41200000, v80
    v_fmamk_f32 v88, v89, 0x41200000, v88
    v_cvt_pk_bf16_f32 v52, v77, v85
    v_cvt_pk_bf16_f32 v56, v78, v86
    v_cvt_pk_bf16_f32 v64, v79, v87
    v_cvt_pk_bf16_f32 v68, v82, v90
    v_cvt_pk_bf16_f32 v72, v80, v88
    v_lshlrev_b32 v76, 16, v49
    v_and_b32 v84, s25, v49
    v_lshlrev_b32 v77, 16, v53
    v_and_b32 v85, s25, v53
    v_lshlrev_b32 v78, 16, v57
    v_and_b32 v86, s25, v57
    v_lshlrev_b32 v79, 16, v61
    v_and_b32 v87, s25, v61
    v_add_f32 v80, v76, v78
    v_add_f32 v88, v84, v86
    v_add_f32 v81, v77, v79
    v_add_f32 v89, v85, v87
    v_fma_f32 v82, v78, 4.0, v76
    v_fma_f32 v90, v86, 4.0, v84
    v_fma_f32 v83, v79, 4.0, v77
    v_fma_f32 v91, v87, 4.0, v85
    v_add_f32 v77, v80, v81
    v_add_f32 v85, v88, v89
    v_sub_f32 v78, v80, v81
    v_sub_f32 v86, v88, v89
    v_fma_f32 v79, v83, 2.0, v82
    v_fma_f32 v87, v91, 2.0, v90
    v_fma_f32 v82, v83, -2.0, v82
    v_fma_f32 v90, v91, -2.0, v90
    v_fmamk_f32 v80, v76, 0x41700000, v82
    v_fmamk_f32 v88, v84, 0x41700000, v90
    v_fmamk_f32 v80, v81, 0x41200000, v80
    v_fmamk_f32 v88, v89, 0x41200000, v88
    v_cvt_pk_bf16_f32 v53, v77, v85
    v_cvt_pk_bf16_f32 v57, v78, v86
    v_cvt_pk_bf16_f32 v65, v79, v87
    v_cvt_pk_bf16_f32 v69, v82, v90
    v_cvt_pk_bf16_f32 v73, v80, v88
    v_lshlrev_b32 v76, 16, v50
    v_and_b32 v84, s25, v50
    v_lshlrev_b32 v77, 16, v54
    v_and_b32 v85, s25, v54
    v_lshlrev_b32 v78, 16, v58
    v_and_b32 v86, s25, v58
    v_lshlrev_b32 v79, 16, v62
    v_and_b32 v87, s25, v62
    v_add_f32 v80, v76, v78
    v_add_f32 v88, v84, v86
    v_add_f32 v81, v77, v79
    v_add_f32 v89, v85, v87
    v_fma_f32 v82, v78, 4.0, v76
    v_fma_f32 v90, v86, 4.0, v84
    v_fma_f32 v83, v79, 4.0, v77
    v_fma_f32 v91, v87, 4.0, v85
    v_add_f32 v77, v80, v81
    v_add_f32 v85, v88, v89
    v_sub_f32 v78, v80, v81
    v_sub_f32 v86, v88, v89
    v_fma_f32 v79, v83, 2.0, v82
    v_fma_f32 v87, v91, 2.0, v90
    v_fma_f32 v82, v83, -2.0, v82
    v_fma_f32 v90, v91, -2.0, v90
    v_fmamk_f32 v80, v76, 0x41700000, v82
    v_fmamk_f32 v88, v84, 0x41700000, v90
    v_fmamk_f32 v80, v81, 0x41200000, v80
    v_fmamk_f32 v88, v89, 0x41200000, v88
    v_cvt_pk_bf16_f32 v54, v77, v85
    v_cvt_pk_bf16_f32 v58, v78, v86
    v_cvt_pk_bf16_f32 v66, v79, v87
    v_cvt_pk_bf16_f32 v70, v82, v90
    v_cvt_pk_bf16_f32 v74, v80, v88
    v_lshlrev_b32 v76, 16, v51
    v_and_b32 v84, s25, v51
    v_lshlrev_b32 v77, 16, v55
    v_and_b32 v85, s25, v55
    v_lshlrev_b32 v78, 16, v59
    v_and_b32 v86, s25, v59
    v_lshlrev_b32 v79, 16, v63
    v_and_b32 v87, s25, v63
    v_add_f32 v80, v76, v78
    v_add_f32 v88, v84, v86
    v_add_f32 v81, v77, v79
    v_add_f32 v89, v85, v87
    v_fma_f32 v82, v78, 4.0, v76
    v_fma_f32 v90, v86, 4.0, v84
    v_fma_f32 v83, v79, 4.0, v77
    v_fma_f32 v91, v87, 4.0, v85
    v_add_f32 v77, v80, v81
    v_add_f32 v85, v88, v89
    v_sub_f32 v78, v80, v81
    v_sub_f32 v86, v88, v89
    v_fma_f32 v79, v83, 2.0, v82
    v_fma_f32 v87, v91, 2.0, v90
    v_fma_f32 v82, v83, -2.0, v82
    v_fma_f32 v90, v91, -2.0, v90
    v_fmamk_f32 v80, v76, 0x41700000, v82
    v_fmamk_f32 v88, v84, 0x41700000, v90
    v_fmamk_f32 v80, v81, 0x41200000, v80
    v_fmamk_f32 v88, v89, 0x41200000, v88
    v_cvt_pk_bf16_f32 v55, v77, v85
    v_cvt_pk_bf16_f32 v59, v78, v86
    v_cvt_pk_bf16_f32 v67, v79, v87
    v_cvt_pk_bf16_f32 v71, v82, v90
    v_cvt_pk_bf16_f32 v75, v80, v88
    s_add_u32 s28, s28, 1
    s_waitcnt lgkmcnt(0)
    s_barrier
    s_cmp_eq_u32 s22, 1
    s_cbranch_scc1 L_conv2_kernel_hlast2
    s_add_u32 s24, s24, 1048576
    s_add_u32 s27, s27, 1048576
    ds_write_b128 v96, v[64:67] offset:57344
    ds_write_b128 v97, v[68:71] offset:8192
    ds_write_b128 v97, v[72:75] offset:24576
    ds_write_b128 v96, v[48:51] offset:8192
    ds_write_b128 v96, v[52:55] offset:24576
    ds_write_b128 v96, v[56:59] offset:40960
    ds_write_b128 v98, v[60:63] offset:8704
    s_waitcnt vmcnt(0)
    v_lshlrev_b32 v76, 16, v0
    v_and_b32 v84, s25, v0
    v_lshlrev_b32 v77, 16, v4
    v_and_b32 v85, s25, v4
    v_lshlrev_b32 v78, 16, v8
    v_and_b32 v86, s25, v8
    v_lshlrev_b32 v79, 16, v12
    v_and_b32 v87, s25, v12
    v_add_f32 v80, v76, v78
    v_add_f32 v88, v84, v86
    v_add_f32 v81, v77, v79
    v_add_f32 v89, v85, v87
    v_fma_f32 v82, v78, 4.0, v76
    v_fma_f32 v90, v86, 4.0, v84
    v_fma_f32 v83, v79, 4.0, v77
    v_fma_f32 v91, v87, 4.0, v85
    v_add_f32 v77, v80, v81
    v_add_f32 v85, v88, v89
    v_sub_f32 v78, v80, v81
    v_sub_f32 v86, v88, v89
    v_fma_f32 v79, v83, 2.0, v82
    v_fma_f32 v87, v91, 2.0, v90
    v_fma_f32 v82, v83, -2.0, v82
    v_fma_f32 v90, v91, -2.0, v90
    v_fmamk_f32 v80, v76, 0x41700000, v82
    v_fmamk_f32 v88, v84, 0x41700000, v90
    buffer_load_dwordx4 v[32:35], v92, s[8:11], s24 offen
    buffer_load_dwordx4 v[40:43], v94, s[8:11], s24 offen
    v_fmamk_f32 v80, v81, 0x41200000, v80
    v_fmamk_f32 v88, v89, 0x41200000, v88
    v_cvt_pk_bf16_f32 v4, v77, v85
    v_cvt_pk_bf16_f32 v8, v78, v86
    v_cvt_pk_bf16_f32 v64, v79, v87
    v_cvt_pk_bf16_f32 v68, v82, v90
    v_cvt_pk_bf16_f32 v72, v80, v88
    v_lshlrev_b32 v76, 16, v1
    v_and_b32 v84, s25, v1
    v_lshlrev_b32 v77, 16, v5
    v_and_b32 v85, s25, v5
    v_lshlrev_b32 v78, 16, v9
    v_and_b32 v86, s25, v9
    v_lshlrev_b32 v79, 16, v13
    v_and_b32 v87, s25, v13
    v_add_f32 v80, v76, v78
    v_add_f32 v88, v84, v86
    v_add_f32 v81, v77, v79
    v_add_f32 v89, v85, v87
    v_fma_f32 v82, v78, 4.0, v76
    v_fma_f32 v90, v86, 4.0, v84
    v_fma_f32 v83, v79, 4.0, v77
    v_fma_f32 v91, v87, 4.0, v85
    v_add_f32 v77, v80, v81
    v_add_f32 v85, v88, v89
    v_sub_f32 v78, v80, v81
    v_sub_f32 v86, v88, v89
    v_fma_f32 v79, v83, 2.0, v82
    v_fma_f32 v87, v91, 2.0, v90
    v_fma_f32 v82, v83, -2.0, v82
    v_fma_f32 v90, v91, -2.0, v90
    v_fmamk_f32 v80, v76, 0x41700000, v82
    v_fmamk_f32 v88, v84, 0x41700000, v90
    v_fmamk_f32 v80, v81, 0x41200000, v80
    v_fmamk_f32 v88, v89, 0x41200000, v88
    v_cvt_pk_bf16_f32 v5, v77, v85
    v_cvt_pk_bf16_f32 v9, v78, v86
    v_cvt_pk_bf16_f32 v65, v79, v87
    v_cvt_pk_bf16_f32 v69, v82, v90
    v_cvt_pk_bf16_f32 v73, v80, v88
    v_lshlrev_b32 v76, 16, v2
    v_and_b32 v84, s25, v2
    v_lshlrev_b32 v77, 16, v6
    v_and_b32 v85, s25, v6
    v_lshlrev_b32 v78, 16, v10
    v_and_b32 v86, s25, v10
    v_lshlrev_b32 v79, 16, v14
    v_and_b32 v87, s25, v14
    v_add_f32 v80, v76, v78
    v_add_f32 v88, v84, v86
    v_add_f32 v81, v77, v79
    v_add_f32 v89, v85, v87
    v_fma_f32 v82, v78, 4.0, v76
    buffer_load_dwordx4 v[36:39], v93, s[8:11], s24 offen
    buffer_load_dwordx4 v[44:47], v95, s[8:11], s24 offen
    v_fma_f32 v90, v86, 4.0, v84
    v_fma_f32 v83, v79, 4.0, v77
    v_fma_f32 v91, v87, 4.0, v85
    v_add_f32 v77, v80, v81
    v_add_f32 v85, v88, v89
    v_sub_f32 v78, v80, v81
    v_sub_f32 v86, v88, v89
    v_fma_f32 v79, v83, 2.0, v82
    v_fma_f32 v87, v91, 2.0, v90
    v_fma_f32 v82, v83, -2.0, v82
    v_fma_f32 v90, v91, -2.0, v90
    v_fmamk_f32 v80, v76, 0x41700000, v82
    v_fmamk_f32 v88, v84, 0x41700000, v90
    v_fmamk_f32 v80, v81, 0x41200000, v80
    v_fmamk_f32 v88, v89, 0x41200000, v88
    v_cvt_pk_bf16_f32 v6, v77, v85
    v_cvt_pk_bf16_f32 v10, v78, v86
    v_cvt_pk_bf16_f32 v66, v79, v87
    v_cvt_pk_bf16_f32 v70, v82, v90
    v_cvt_pk_bf16_f32 v74, v80, v88
    v_lshlrev_b32 v76, 16, v3
    v_and_b32 v84, s25, v3
    v_lshlrev_b32 v77, 16, v7
    v_and_b32 v85, s25, v7
    v_lshlrev_b32 v78, 16, v11
    v_and_b32 v86, s25, v11
    v_lshlrev_b32 v79, 16, v15
    v_and_b32 v87, s25, v15
    v_add_f32 v80, v76, v78
    v_add_f32 v88, v84, v86
    v_add_f32 v81, v77, v79
    v_add_f32 v89, v85, v87
    v_fma_f32 v82, v78, 4.0, v76
    v_fma_f32 v90, v86, 4.0, v84
    v_fma_f32 v83, v79, 4.0, v77
    v_fma_f32 v91, v87, 4.0, v85
    v_add_f32 v77, v80, v81
    v_add_f32 v85, v88, v89
    v_sub_f32 v78, v80, v81
    v_sub_f32 v86, v88, v89
    v_fma_f32 v79, v83, 2.0, v82
    v_fma_f32 v87, v91, 2.0, v90
    v_fma_f32 v82, v83, -2.0, v82
    v_fma_f32 v90, v91, -2.0, v90
    v_fmamk_f32 v80, v76, 0x41700000, v82
    v_fmamk_f32 v88, v84, 0x41700000, v90
    v_fmamk_f32 v80, v81, 0x41200000, v80
    v_fmamk_f32 v88, v89, 0x41200000, v88
    v_cvt_pk_bf16_f32 v7, v77, v85
    v_cvt_pk_bf16_f32 v11, v78, v86
    v_cvt_pk_bf16_f32 v67, v79, v87
    v_cvt_pk_bf16_f32 v71, v82, v90
    v_cvt_pk_bf16_f32 v75, v80, v88
    s_add_u32 s28, s28, 1
    s_waitcnt lgkmcnt(0)
    s_barrier
    ds_write_b128 v96, v[64:67] offset:49152
    ds_write_b128 v97, v[68:71] offset:0
    ds_write_b128 v97, v[72:75] offset:16384
    ds_write_b128 v96, v[0:3] offset:0
    ds_write_b128 v96, v[4:7] offset:16384
    ds_write_b128 v96, v[8:11] offset:32768
    ds_write_b128 v98, v[12:15] offset:0
    v_lshlrev_b32 v76, 16, v16
    v_and_b32 v84, s25, v16
    buffer_load_dwordx4 v[48:51], v92, s[8:11], s27 offen
    buffer_load_dwordx4 v[56:59], v94, s[8:11], s27 offen
    v_lshlrev_b32 v77, 16, v20
    v_and_b32 v85, s25, v20
    v_lshlrev_b32 v78, 16, v24
    v_and_b32 v86, s25, v24
    v_lshlrev_b32 v79, 16, v28
    v_and_b32 v87, s25, v28
    v_add_f32 v80, v76, v78
    v_add_f32 v88, v84, v86
    v_add_f32 v81, v77, v79
    v_add_f32 v89, v85, v87
    v_fma_f32 v82, v78, 4.0, v76
    v_fma_f32 v90, v86, 4.0, v84
    v_fma_f32 v83, v79, 4.0, v77
    v_fma_f32 v91, v87, 4.0, v85
    v_add_f32 v77, v80, v81
    v_add_f32 v85, v88, v89
    v_sub_f32 v78, v80, v81
    buffer_load_dwordx4 v[52:55], v93, s[8:11], s27 offen
    buffer_load_dwordx4 v[60:63], v95, s[8:11], s27 offen
    v_sub_f32 v86, v88, v89
    v_fma_f32 v79, v83, 2.0, v82
    v_fma_f32 v87, v91, 2.0, v90
    v_fma_f32 v82, v83, -2.0, v82
    v_fma_f32 v90, v91, -2.0, v90
    v_fmamk_f32 v80, v76, 0x41700000, v82
    v_fmamk_f32 v88, v84, 0x41700000, v90
    v_fmamk_f32 v80, v81, 0x41200000, v80
    v_fmamk_f32 v88, v89, 0x41200000, v88
    v_cvt_pk_bf16_f32 v20, v77, v85
    v_cvt_pk_bf16_f32 v24, v78, v86
    v_cvt_pk_bf16_f32 v64, v79, v87
    v_cvt_pk_bf16_f32 v68, v82, v90
    v_cvt_pk_bf16_f32 v72, v80, v88
    v_lshlrev_b32 v76, 16, v17
    v_and_b32 v84, s25, v17
    v_lshlrev_b32 v77, 16, v21
    v_and_b32 v85, s25, v21
    v_lshlrev_b32 v78, 16, v25
    v_and_b32 v86, s25, v25
    v_lshlrev_b32 v79, 16, v29
    v_and_b32 v87, s25, v29
    v_add_f32 v80, v76, v78
    v_add_f32 v88, v84, v86
    v_add_f32 v81, v77, v79
    v_add_f32 v89, v85, v87
    v_fma_f32 v82, v78, 4.0, v76
    v_fma_f32 v90, v86, 4.0, v84
    v_fma_f32 v83, v79, 4.0, v77
    v_fma_f32 v91, v87, 4.0, v85
    v_add_f32 v77, v80, v81
    v_add_f32 v85, v88, v89
    v_sub_f32 v78, v80, v81
    v_sub_f32 v86, v88, v89
    v_fma_f32 v79, v83, 2.0, v82
    v_fma_f32 v87, v91, 2.0, v90
    v_fma_f32 v82, v83, -2.0, v82
    v_fma_f32 v90, v91, -2.0, v90
    v_fmamk_f32 v80, v76, 0x41700000, v82
    v_fmamk_f32 v88, v84, 0x41700000, v90
    v_fmamk_f32 v80, v81, 0x41200000, v80
    v_fmamk_f32 v88, v89, 0x41200000, v88
    v_cvt_pk_bf16_f32 v21, v77, v85
    v_cvt_pk_bf16_f32 v25, v78, v86
    v_cvt_pk_bf16_f32 v65, v79, v87
    v_cvt_pk_bf16_f32 v69, v82, v90
    v_cvt_pk_bf16_f32 v73, v80, v88
    v_lshlrev_b32 v76, 16, v18
    v_and_b32 v84, s25, v18
    v_lshlrev_b32 v77, 16, v22
    v_and_b32 v85, s25, v22
    v_lshlrev_b32 v78, 16, v26
    v_and_b32 v86, s25, v26
    v_lshlrev_b32 v79, 16, v30
    v_and_b32 v87, s25, v30
    v_add_f32 v80, v76, v78
    v_add_f32 v88, v84, v86
    v_add_f32 v81, v77, v79
    v_add_f32 v89, v85, v87
    v_fma_f32 v82, v78, 4.0, v76
    v_fma_f32 v90, v86, 4.0, v84
    v_fma_f32 v83, v79, 4.0, v77
    v_fma_f32 v91, v87, 4.0, v85
    v_add_f32 v77, v80, v81
    v_add_f32 v85, v88, v89
    v_sub_f32 v78, v80, v81
    v_sub_f32 v86, v88, v89
    v_fma_f32 v79, v83, 2.0, v82
    v_fma_f32 v87, v91, 2.0, v90
    v_fma_f32 v82, v83, -2.0, v82
    v_fma_f32 v90, v91, -2.0, v90
    v_fmamk_f32 v80, v76, 0x41700000, v82
    v_fmamk_f32 v88, v84, 0x41700000, v90
    v_fmamk_f32 v80, v81, 0x41200000, v80
    v_fmamk_f32 v88, v89, 0x41200000, v88
    v_cvt_pk_bf16_f32 v22, v77, v85
    v_cvt_pk_bf16_f32 v26, v78, v86
    v_cvt_pk_bf16_f32 v66, v79, v87
    v_cvt_pk_bf16_f32 v70, v82, v90
    v_cvt_pk_bf16_f32 v74, v80, v88
    v_lshlrev_b32 v76, 16, v19
    v_and_b32 v84, s25, v19
    v_lshlrev_b32 v77, 16, v23
    v_and_b32 v85, s25, v23
    v_lshlrev_b32 v78, 16, v27
    v_and_b32 v86, s25, v27
    v_lshlrev_b32 v79, 16, v31
    v_and_b32 v87, s25, v31
    v_add_f32 v80, v76, v78
    v_add_f32 v88, v84, v86
    v_add_f32 v81, v77, v79
    v_add_f32 v89, v85, v87
    v_fma_f32 v82, v78, 4.0, v76
    v_fma_f32 v90, v86, 4.0, v84
    v_fma_f32 v83, v79, 4.0, v77
    v_fma_f32 v91, v87, 4.0, v85
    v_add_f32 v77, v80, v81
    v_add_f32 v85, v88, v89
    v_sub_f32 v78, v80, v81
    v_sub_f32 v86, v88, v89
    v_fma_f32 v79, v83, 2.0, v82
    v_fma_f32 v87, v91, 2.0, v90
    v_fma_f32 v82, v83, -2.0, v82
    v_fma_f32 v90, v91, -2.0, v90
    v_fmamk_f32 v80, v76, 0x41700000, v82
    v_fmamk_f32 v88, v84, 0x41700000, v90
    v_fmamk_f32 v80, v81, 0x41200000, v80
    v_fmamk_f32 v88, v89, 0x41200000, v88
    v_cvt_pk_bf16_f32 v23, v77, v85
    v_cvt_pk_bf16_f32 v27, v78, v86
    v_cvt_pk_bf16_f32 v67, v79, v87
    v_cvt_pk_bf16_f32 v71, v82, v90
    v_cvt_pk_bf16_f32 v75, v80, v88
    s_add_u32 s28, s28, 1
    s_waitcnt lgkmcnt(0)
    s_barrier
    s_sub_u32 s22, s22, 1
    s_branch L_conv2_kernel_hloop2
L_conv2_kernel_hlast2:
    s_mov_b32 s25, 0xffff0000
    ds_write_b128 v96, v[64:67] offset:57344
    ds_write_b128 v97, v[68:71] offset:8192
    ds_write_b128 v97, v[72:75] offset:24576
    ds_write_b128 v96, v[48:51] offset:8192
    ds_write_b128 v96, v[52:55] offset:24576
    ds_write_b128 v96, v[56:59] offset:40960
    ds_write_b128 v98, v[60:63] offset:8704
    s_waitcnt lgkmcnt(0)
    s_barrier
    s_branch L_conv2_kernel_end
L_conv2_kernel_epi:
    v_and_b32 v108, 15, v127
    v_lshrrev_b32 v109, 4, v127
    v_lshrrev_b32 v110, 3, v108
    s_lshl_b32 s36, s20, 1
    v_add_u32 v110, s36, v110
    v_xor_b32 v111, v110, v108
    v_and_b32 v111, 7, v111
    v_lshlrev_b32 v111, 4, v111
    v_lshl_add_u32 v111, v110, 7, v111
    v_lshl_add_u32 v120, v109, 11, v111
    v_add_u32 v121, 65536, v120
    v_add_u32 v125, 131072, v120
    s_lshl_b32 s36, s20, 9
    s_add_u32 s36, s36, 115712
    v_lshl_add_u32 v123, v109, 7, s36
    s_lshl_b32 s36, s20, 4
    v_add_u32 v108, s36, v108
    v_lshlrev_b32 v110, 6, v108
    v_lshl_add_u32 v110, v109, 4, v110
    s_mul_i32 s36, s29, 262144
    s_lshl_b32 s37, s21, 4
    s_add_u32 s36, s36, s37
    v_add_u32 v110, s36, v110
    v_mov_b32 v111, 2130706432
    v_cmp_gt_u32 vcc, 125, v108
    s_mov_b32 s4, 0xbeaaaaab
    s_mov_b32 s5, s4
    s_mov_b32 s6, 0x3e800000
    s_mov_b32 s7, s6
    s_mov_b32 s8, 0xc0a00000
    s_mov_b32 s9, s8
    s_mov_b32 s10, 0xc0638e39
    s_mov_b32 s11, s10
    s_mov_b32 s12, 0xbf638e39
    s_mov_b32 s13, s12
    s_mov_b32 s14, 0xbe638e39
    s_mov_b32 s15, s14
    s_mov_b32 s22, 0xbd638e39
    s_mov_b32 s23, s22
    s_mov_b32 s24, 0x3ff1c71c
    s_mov_b32 s25, s24
    s_mov_b32 s26, 0xbf2aaaab
    s_mov_b32 s27, s26
    s_mov_b32 s32, 0x3ecccccd
    s_mov_b32 s33, s32
    s_mov_b32 s34, 0xbd888889
    s_mov_b32 s35, s34
    s_mov_b32 s38, 0xbe4ccccd
    s_mov_b32 s39, s38
    s_mov_b32 s40, 0xbdd2d3e8
    s_mov_b32 s41, s40
    s_mov_b32 s42, 0x3f800000
    s_mov_b32 s43, s42
    s_waitcnt lgkmcnt(0)
    s_barrier
    v_cndmask_b32 v122, v111, v110, vcc
    ds_read_b128 v[0:3], v120 offset:0
    ds_read_b128 v[4:7], v120 offset:16384
    ds_read_b128 v[8:11], v120 offset:32768
    ds_read_b128 v[12:15], v120 offset:49152
    ds_read_b128 v[16:19], v121 offset:0
    ds_read_b128 v[20:23], v121 offset:16384
    ds_read_b128 v[24:27], v121 offset:32768
    ds_read_b128 v[28:31], v125 offset:15360
    ds_read_b128 v[32:35], v120 offset:8192
    ds_read_b128 v[36:39], v120 offset:24576
    ds_read_b128 v[40:43], v120 offset:40960
    ds_read_b128 v[44:47], v120 offset:57344
    ds_read_b128 v[48:51], v121 offset:56320
    ds_read_b128 v[52:55], v121 offset:64512
    ds_read_b128 v[56:59], v125 offset:7168
    s_waitcnt lgkmcnt(7)
    ds_read_b128 v[60:63], v125 offset:23552
    s_waitcnt lgkmcnt(8)
    v_pk_add_f32 v[88:89], v[24:25], v[28:29]
    v_pk_add_f32 v[90:91], v[26:27], v[30:31]
    v_pk_add_f32 v[24:25], v[4:5], v[8:9]
    v_pk_add_f32 v[26:27], v[6:7], v[10:11]
    v_pk_add_f32 v[4:5], v[4:5], v[8:9] neg_lo:[0,1] neg_hi:[0,1]
    v_pk_add_f32 v[6:7], v[6:7], v[10:11] neg_lo:[0,1] neg_hi:[0,1]
    v_pk_add_f32 v[72:73], v[12:13], v[16:17]
    v_pk_add_f32 v[74:75], v[14:15], v[18:19]
    v_pk_add_f32 v[12:13], v[12:13], v[16:17] neg_lo:[0,1] neg_hi:[0,1]
    v_pk_add_f32 v[14:15], v[14:15], v[18:19] neg_lo:[0,1] neg_hi:[0,1]
    v_pk_fma_f32 v[72:73], v[24:25], s[4:5], v[72:73]
    v_pk_fma_f32 v[74:75], v[26:27], s[4:5], v[74:75]
    v_pk_fma_f32 v[20:21], v[0:1], s[10:11], v[20:21]
    v_pk_fma_f32 v[22:23], v[2:3], s[10:11], v[22:23]
    v_pk_fma_f32 v[72:73], v[0:1], s[6:7], v[72:73]
    v_pk_fma_f32 v[74:75], v[2:3], s[6:7], v[74:75]
    v_pk_add_f32 v[24:25], v[24:25], v[0:1] neg_lo:[0,1] neg_hi:[0,1]
    v_pk_add_f32 v[26:27], v[26:27], v[2:3] neg_lo:[0,1] neg_hi:[0,1]
    v_pk_fma_f32 v[72:73], v[88:89], s[8:9], v[72:73]
    v_pk_fma_f32 v[74:75], v[90:91], s[8:9], v[74:75]
    v_pk_add_f32 v[24:25], v[24:25], v[88:89] neg_lo:[0,1] neg_hi:[0,1]
    v_pk_add_f32 v[26:27], v[26:27], v[90:91] neg_lo:[0,1] neg_hi:[0,1]
    v_pk_fma_f32 v[20:21], v[88:89], s[22:23], v[20:21]
    v_pk_fma_f32 v[22:23], v[90:91], s[22:23], v[22:23]
    v_pk_add_f32 v[8:9], v[24:25], v[72:73] neg_lo:[0,1] neg_hi:[0,1]
    v_pk_add_f32 v[10:11], v[26:27], v[74:75] neg_lo:[0,1] neg_hi:[0,1]
    v_pk_fma_f32 v[20:21], v[72:73], s[14:15], v[20:21]
    v_pk_fma_f32 v[22:23], v[74:75], s[14:15], v[22:23]
    v_pk_mul_f32 v[80:81], v[12:13], s[32:33]
    v_pk_mul_f32 v[82:83], v[14:15], s[32:33]
    v_pk_fma_f32 v[20:21], v[8:9], s[12:13], v[20:21]
    v_pk_fma_f32 v[22:23], v[10:11], s[12:13], v[22:23]
    v_pk_fma_f32 v[80:81], v[4:5], s[34:35], v[80:81]
    v_pk_fma_f32 v[82:83], v[6:7], s[34:35], v[82:83]
    v_pk_fma_f32 v[64:65], v[4:5], s[24:25], v[20:21] neg_lo:[0,0,1] neg_hi:[0,0,1]
    v_pk_fma_f32 v[66:67], v[6:7], s[24:25], v[22:23] neg_lo:[0,0,1] neg_hi:[0,0,1]
    v_pk_fma_f32 v[64:65], v[12:13], s[26:27], v[64:65]
    v_pk_fma_f32 v[66:67], v[14:15], s[26:27], v[66:67]
    v_pk_fma_f32 v[80:81], v[64:65], s[38:39], v[80:81]
    v_pk_fma_f32 v[82:83], v[66:67], s[38:39], v[82:83]
    v_pk_add_f32 v[4:5], v[4:5], v[64:65] neg_lo:[0,1] neg_hi:[0,1]
    v_pk_add_f32 v[6:7], v[6:7], v[66:67] neg_lo:[0,1] neg_hi:[0,1]
    v_pk_add_f32 v[4:5], v[4:5], v[80:81] neg_lo:[0,1] neg_hi:[0,1]
    v_pk_add_f32 v[6:7], v[6:7], v[82:83] neg_lo:[0,1] neg_hi:[0,1]
    s_waitcnt lgkmcnt(0)
    v_pk_add_f32 v[92:93], v[56:57], v[60:61]
    v_pk_add_f32 v[94:95], v[58:59], v[62:63]
    v_pk_add_f32 v[56:57], v[36:37], v[40:41]
    v_pk_add_f32 v[58:59], v[38:39], v[42:43]
    v_pk_add_f32 v[36:37], v[36:37], v[40:41] neg_lo:[0,1] neg_hi:[0,1]
    v_pk_add_f32 v[38:39], v[38:39], v[42:43] neg_lo:[0,1] neg_hi:[0,1]
    v_pk_add_f32 v[76:77], v[44:45], v[48:49]
    v_pk_add_f32 v[78:79], v[46:47], v[50:51]
    v_pk_add_f32 v[44:45], v[44:45], v[48:49] neg_lo:[0,1] neg_hi:[0,1]
    v_pk_add_f32 v[46:47], v[46:47], v[50:51] neg_lo:[0,1] neg_hi:[0,1]
    v_pk_fma_f32 v[76:77], v[56:57], s[4:5], v[76:77]
    v_pk_fma_f32 v[78:79], v[58:59], s[4:5], v[78:79]
    v_pk_fma_f32 v[52:53], v[32:33], s[10:11], v[52:53]
    v_pk_fma_f32 v[54:55], v[34:35], s[10:11], v[54:55]
    v_pk_fma_f32 v[76:77], v[32:33], s[6:7], v[76:77]
    v_pk_fma_f32 v[78:79], v[34:35], s[6:7], v[78:79]
    v_pk_add_f32 v[56:57], v[56:57], v[32:33] neg_lo:[0,1] neg_hi:[0,1]
    v_pk_add_f32 v[58:59], v[58:59], v[34:35] neg_lo:[0,1] neg_hi:[0,1]
    v_pk_fma_f32 v[76:77], v[92:93], s[8:9], v[76:77]
    v_pk_fma_f32 v[78:79], v[94:95], s[8:9], v[78:79]
    v_pk_add_f32 v[56:57], v[56:57], v[92:93] neg_lo:[0,1] neg_hi:[0,1]
    v_pk_add_f32 v[58:59], v[58:59], v[94:95] neg_lo:[0,1] neg_hi:[0,1]
    v_pk_fma_f32 v[52:53], v[92:93], s[22:23], v[52:53]
    v_pk_fma_f32 v[54:55], v[94:95], s[22:23], v[54:55]
    v_pk_add_f32 v[40:41], v[56:57], v[76:77] neg_lo:[0,1] neg_hi:[0,1]
    v_pk_add_f32 v[42:43], v[58:59], v[78:79] neg_lo:[0,1] neg_hi:[0,1]
    v_pk_fma_f32 v[52:53], v[76:77], s[14:15], v[52:53]
    v_pk_fma_f32 v[54:55], v[78:79], s[14:15], v[54:55]
    v_pk_mul_f32 v[84:85], v[44:45], s[32:33]
    v_pk_mul_f32 v[86:87], v[46:47], s[32:33]
    v_pk_fma_f32 v[52:53], v[40:41], s[12:13], v[52:53]
    v_pk_fma_f32 v[54:55], v[42:43], s[12:13], v[54:55]
    v_pk_fma_f32 v[84:85], v[36:37], s[34:35], v[84:85]
    v_pk_fma_f32 v[86:87], v[38:39], s[34:35], v[86:87]
    v_pk_fma_f32 v[68:69], v[36:37], s[24:25], v[52:53] neg_lo:[0,0,1] neg_hi:[0,0,1]
    v_pk_fma_f32 v[70:71], v[38:39], s[24:25], v[54:55] neg_lo:[0,0,1] neg_hi:[0,0,1]
    v_pk_fma_f32 v[68:69], v[44:45], s[26:27], v[68:69]
    v_pk_fma_f32 v[70:71], v[46:47], s[26:27], v[70:71]
    v_pk_fma_f32 v[84:85], v[68:69], s[38:39], v[84:85]
    v_pk_fma_f32 v[86:87], v[70:71], s[38:39], v[86:87]
    v_pk_add_f32 v[36:37], v[36:37], v[68:69] neg_lo:[0,1] neg_hi:[0,1]
    v_pk_add_f32 v[38:39], v[38:39], v[70:71] neg_lo:[0,1] neg_hi:[0,1]
    v_pk_add_f32 v[36:37], v[36:37], v[84:85] neg_lo:[0,1] neg_hi:[0,1]
    v_pk_add_f32 v[38:39], v[38:39], v[86:87] neg_lo:[0,1] neg_hi:[0,1]
    s_mov_b32 s36, 0x00010001
    s_mov_b32 s37, 0x00010001
    s_mov_b64 exec, s[36:37]
    ds_write_b128 v123, v[0:3] offset:0
    ds_write_b128 v123, v[32:35] offset:16
    ds_write_b128 v123, v[4:7] offset:32
    ds_write_b128 v123, v[36:39] offset:48
    ds_write_b128 v123, v[8:11] offset:64
    ds_write_b128 v123, v[40:43] offset:80
    s_mov_b64 exec, -1
    v_mov_b32 v44, 0xc0135761
    v_mov_b32 v45, v44
    v_cvt_pk_bf16_f32 v48, v64, v68
    v_cvt_pk_bf16_f32 v49, v65, v69
    v_cvt_pk_bf16_f32 v50, v66, v70
    v_cvt_pk_bf16_f32 v51, v67, v71
    s_mov_b32 s44, 0
    buffer_store_dwordx4 v[48:51], v122, s[16:19], s44 offen sc1
    s_waitcnt lgkmcnt(0)
    s_barrier
    ds_read_b128 v[96:99], v123 offset:512
    ds_read_b128 v[100:103], v123 offset:528
    ds_read_b128 v[104:107], v123 offset:544
    ds_read_b128 v[108:111], v123 offset:560
    ds_read_b128 v[112:115], v123 offset:576
    ds_read_b128 v[116:119], v123 offset:592
    s_waitcnt lgkmcnt(4)
    v_mov_b32_dpp v96, v0 row_shl:1 row_mask:0xf bank_mask:0xf
    v_mov_b32_dpp v97, v1 row_shl:1 row_mask:0xf bank_mask:0xf
    v_mov_b32_dpp v98, v2 row_shl:1 row_mask:0xf bank_mask:0xf
    v_mov_b32_dpp v99, v3 row_shl:1 row_mask:0xf bank_mask:0xf
    v_mov_b32_dpp v100, v32 row_shl:1 row_mask:0xf bank_mask:0xf
    v_mov_b32_dpp v101, v33 row_shl:1 row_mask:0xf bank_mask:0xf
    v_mov_b32_dpp v102, v34 row_shl:1 row_mask:0xf bank_mask:0xf
    v_mov_b32_dpp v103, v35 row_shl:1 row_mask:0xf bank_mask:0xf
    v_pk_add_f32 v[72:73], v[72:73], v[96:97]
    v_pk_add_f32 v[74:75], v[74:75], v[98:99]
    v_pk_add_f32 v[76:77], v[76:77], v[100:101]
    v_pk_add_f32 v[78:79], v[78:79], v[102:103]
    v_cvt_pk_bf16_f32 v52, v72, v76
    v_cvt_pk_bf16_f32 v53, v73, v77
    v_cvt_pk_bf16_f32 v54, v74, v78
    v_cvt_pk_bf16_f32 v55, v75, v79
    s_mov_b32 s44, 65536
    buffer_store_dwordx4 v[52:55], v122, s[16:19], s44 offen sc1
    s_waitcnt lgkmcnt(2)
    v_mov_b32_dpp v104, v4 row_shl:1 row_mask:0xf bank_mask:0xf
    v_mov_b32_dpp v105, v5 row_shl:1 row_mask:0xf bank_mask:0xf
    v_mov_b32_dpp v106, v6 row_shl:1 row_mask:0xf bank_mask:0xf
    v_mov_b32_dpp v107, v7 row_shl:1 row_mask:0xf bank_mask:0xf
    v_mov_b32_dpp v108, v36 row_shl:1 row_mask:0xf bank_mask:0xf
    v_mov_b32_dpp v109, v37 row_shl:1 row_mask:0xf bank_mask:0xf
    v_mov_b32_dpp v110, v38 row_shl:1 row_mask:0xf bank_mask:0xf
    v_mov_b32_dpp v111, v39 row_shl:1 row_mask:0xf bank_mask:0xf
    v_pk_add_f32 v[80:81], v[80:81], v[104:105]
    v_pk_add_f32 v[82:83], v[82:83], v[106:107]
    v_pk_add_f32 v[84:85], v[84:85], v[108:109]
    v_pk_add_f32 v[86:87], v[86:87], v[110:111]
    v_cvt_pk_bf16_f32 v56, v80, v84
    v_cvt_pk_bf16_f32 v57, v81, v85
    v_cvt_pk_bf16_f32 v58, v82, v86
    v_cvt_pk_bf16_f32 v59, v83, v87
    s_mov_b32 s44, 131072
    buffer_store_dwordx4 v[56:59], v122, s[16:19], s44 offen sc1
    s_waitcnt lgkmcnt(0)
    v_mov_b32_dpp v112, v8 row_shl:1 row_mask:0xf bank_mask:0xf
    v_mov_b32_dpp v113, v9 row_shl:1 row_mask:0xf bank_mask:0xf
    v_mov_b32_dpp v114, v10 row_shl:1 row_mask:0xf bank_mask:0xf
    v_mov_b32_dpp v115, v11 row_shl:1 row_mask:0xf bank_mask:0xf
    v_mov_b32_dpp v116, v40 row_shl:1 row_mask:0xf bank_mask:0xf
    v_mov_b32_dpp v117, v41 row_shl:1 row_mask:0xf bank_mask:0xf
    v_mov_b32_dpp v118, v42 row_shl:1 row_mask:0xf bank_mask:0xf
    v_mov_b32_dpp v119, v43 row_shl:1 row_mask:0xf bank_mask:0xf
    v_pk_add_f32 v[88:89], v[88:89], v[112:113]
    v_pk_add_f32 v[90:91], v[90:91], v[114:115]
    v_pk_add_f32 v[92:93], v[92:93], v[116:117]
    v_pk_add_f32 v[94:95], v[94:95], v[118:119]
    v_cvt_pk_bf16_f32 v60, v88, v92
    v_cvt_pk_bf16_f32 v61, v89, v93
    v_cvt_pk_bf16_f32 v62, v90, v94
    v_cvt_pk_bf16_f32 v63, v91, v95
    s_mov_b32 s44, 196608
    buffer_store_dwordx4 v[60:63], v122, s[16:19], s44 offen sc1
L_conv2_kernel_end:
L_conv2_kernel_done:
    s_endpgm
.globl joint_kernel
.p2align 8
.type joint_kernel,@function
joint_kernel:
    s_cmp_ge_u32 s2, 250
    s_cbranch_scc1 L_joint_kernel_done
    s_load_dwordx2 s[28:29], s[0:1], 56
    s_load_dwordx2 s[30:31], s[0:1], 72
    v_readfirstlane_b32 s20, v0
    s_lshr_b32 s20, s20, 6
    s_and_b32 s21, s20, 7
    v_and_b32 v127, 63, v0
    v_lshlrev_b32 v126, 4, v127
    s_cmp_ge_u32 s20, 8
    s_mov_b32 s33, 44171264
    s_cselect_b32 s33, 44040192, s33
    s_lshl_b32 s36, s21, 14
    s_add_u32 s33, s33, s36
    s_mov_b32 s14, 16384
    s_mov_b32 s15, 0x00020000
    s_lshl_b32 s35, s2, 9
    s_cmp_ge_u32 s2, 125
    s_cselect_b32 s36, 2033152, 0
    s_cselect_b32 s34, 8192, 0
    s_add_u32 s35, s35, s36
    s_add_u32 s34, s34, 44302336
    s_mov_b32 s10, 12582912
    s_mov_b32 s11, 0x00020000
    s_mov_b32 s42, 24576
    s_mov_b32 s43, 0x00020000
    s_waitcnt lgkmcnt(0)
    s_add_u32 s12, s30, s33
    s_addc_u32 s13, s31, 0
    s_add_u32 s40, s30, s34
    s_addc_u32 s41, s31, 0
    s_cmp_ge_u32 s20, 8
    s_cbranch_scc1 L_joint_kernel_T
    s_add_u32 s8, s30, 27262976
    s_addc_u32 s9, s31, 0
    v_mov_b32 v0, 99456
    v_mov_b32 v2, 0
    v_mov_b32 v3, 0
    ds_write_b64 v0, v[2:3]
    v_lshrrev_b32 v124, 5, v127
    v_and_b32 v123, 0x1ff, v126
    v_mul_u32_u24 v125, 65536, v124
    v_add_u32 v123, v125, v123
    s_mul_i32 s36, s21, 262144
    s_add_u32 s36, s36, s35
    s_add_u32 s37, s36, 8388608
    buffer_load_dwordx4 v[64:67], v123, s[8:11], s36 offen
    buffer_load_dwordx4 v[72:75], v123, s[8:11], s37 offen
    s_add_u32 s36, s36, 131072
    s_add_u32 s37, s36, 8388608
    buffer_load_dwordx4 v[68:71], v123, s[8:11], s36 offen
    buffer_load_dwordx4 v[76:79], v123, s[8:11], s37 offen
    s_lshl_b32 s38, s21, 10
    s_add_u32 s38, s38, 16384
    buffer_load_dwordx4 v[80:83], v126, s[40:43], s38 offen
    s_waitcnt lgkmcnt(0)
    s_barrier
    s_lshl_b32 s35, s2, 17
    s_add_u32 s16, s28, s35
    s_addc_u32 s17, s29, 0
    s_mov_b32 s18, 131072
    s_mov_b32 s19, 0x00020000
    s_mov_b32 s46, 0xbdd2d3e8
    s_mov_b32 s47, s46
    v_mov_b32 v120, 0xc0135761
    v_mov_b32 v121, v120
    s_mov_b32 s48, 1.0
    s_mov_b32 s49, 1.0
    v_bfe_u32 v123, v127, 2, 3
    v_lshl_add_u32 v124, v123, 2, v124
    v_mul_u32_u24 v124, 528, v124
    v_and_b32 v123, 0x30, v126
    s_lshl_b32 s36, s21, 6
    v_add3_u32 v124, v124, v123, s36
    s_mov_b32 s45, 0xffff0000
    s_mul_i32 s36, s21, 1040
    s_add_u32 s36, s36, 91136
    v_add_u32 v123, s36, v126
    s_mov_b32 s22, 2
    s_waitcnt vmcnt(3)
L_joint_kernel_floop:
    v_lshlrev_b32 v88, 16, v64
    v_and_b32 v89, s45, v64
    v_lshlrev_b32 v96, 16, v72
    v_and_b32 v97, s45, v72
    v_lshlrev_b32 v90, 16, v65
    v_and_b32 v91, s45, v65
    v_lshlrev_b32 v98, 16, v73
    v_and_b32 v99, s45, v73
    v_lshlrev_b32 v92, 16, v66
    v_and_b32 v93, s45, v66
    v_lshlrev_b32 v100, 16, v74
    v_and_b32 v101, s45, v74
    v_lshlrev_b32 v94, 16, v67
    v_and_b32 v95, s45, v67
    v_lshlrev_b32 v102, 16, v75
    v_and_b32 v103, s45, v75
    v_pk_add_f32 v[88:89], v[88:89], v[96:97]
    v_pk_add_f32 v[90:91], v[90:91], v[98:99]
    v_pk_add_f32 v[92:93], v[92:93], v[100:101]
    v_pk_add_f32 v[94:95], v[94:95], v[102:103]
    v_pk_mul_f32 v[96:97], v[88:89], v[88:89]
    v_pk_mul_f32 v[98:99], v[90:91], v[90:91]
    v_pk_mul_f32 v[100:101], v[92:93], v[92:93]
    v_pk_mul_f32 v[102:103], v[94:95], v[94:95]
    v_pk_fma_f32 v[96:97], v[96:97], s[46:47], v[120:121]
    v_pk_fma_f32 v[98:99], v[98:99], s[46:47], v[120:121]
    v_pk_fma_f32 v[100:101], v[100:101], s[46:47], v[120:121]
    v_pk_fma_f32 v[102:103], v[102:103], s[46:47], v[120:121]
    v_pk_mul_f32 v[96:97], v[96:97], v[88:89]
    v_pk_mul_f32 v[98:99], v[98:99], v[90:91]
    v_pk_mul_f32 v[100:101], v[100:101], v[92:93]
    v_pk_mul_f32 v[102:103], v[102:103], v[94:95]
    v_exp_f32 v96, v96
    v_exp_f32 v97, v97
    v_exp_f32 v98, v98
    v_exp_f32 v99, v99
    v_exp_f32 v100, v100
    v_exp_f32 v101, v101
    v_exp_f32 v102, v102
    v_exp_f32 v103, v103
    v_pk_add_f32 v[96:97], v[96:97], s[48:49]
    v_pk_add_f32 v[98:99], v[98:99], s[48:49]
    v_pk_add_f32 v[100:101], v[100:101], s[48:49]
    v_pk_add_f32 v[102:103], v[102:103], s[48:49]
    v_rcp_f32 v96, v96
    v_rcp_f32 v97, v97
    v_rcp_f32 v98, v98
    v_rcp_f32 v99, v99
    v_rcp_f32 v100, v100
    v_rcp_f32 v101, v101
    v_rcp_f32 v102, v102
    v_rcp_f32 v103, v103
    v_pk_mul_f32 v[88:89], v[88:89], v[96:97]
    v_pk_mul_f32 v[90:91], v[90:91], v[98:99]
    v_pk_mul_f32 v[92:93], v[92:93], v[100:101]
    v_pk_mul_f32 v[94:95], v[94:95], v[102:103]
    v_cvt_pk_bf16_f32 v104, v88, v89
    v_cvt_pk_bf16_f32 v105, v90, v91
    v_cvt_pk_bf16_f32 v106, v92, v93
    v_cvt_pk_bf16_f32 v107, v94, v95
    ds_write_b128 v124, v[104:107] offset:32768
    s_waitcnt vmcnt(0)
    v_pk_mov_b32 v[64:65], v[68:69], v[68:69] op_sel:[0,1]
    v_pk_mov_b32 v[72:73], v[76:77], v[76:77] op_sel:[0,1]
    v_pk_mov_b32 v[66:67], v[70:71], v[70:71] op_sel:[0,1]
    v_pk_mov_b32 v[74:75], v[78:79], v[78:79] op_sel:[0,1]
    v_add_u32 v124, 1056, v124
    s_sub_u32 s22, s22, 1
    s_cmp_lg_u32 s22, 0
    s_cbranch_scc1 L_joint_kernel_floop
    ds_write_b128 v123, v[80:83]
    s_waitcnt lgkmcnt(0)
    v_mov_b32 v120, 99456
    v_mov_b32 v121, 1
    s_mov_b64 exec, 1
    ds_add_u32 v120, v121 offset:0
    s_mov_b64 exec, -1
L_joint_kernel_ow:
    ds_read_b32 v121, v120 offset:4
    s_waitcnt lgkmcnt(0)
    v_readfirstlane_b32 s37, v121
    s_cmp_ge_u32 s37, 8
    s_cbranch_scc1 L_joint_kernel_ow_d
    s_sleep 1
    s_branch L_joint_kernel_ow
L_joint_kernel_ow_d:
    s_mov_b32 s36, 0
    buffer_load_dwordx4 v[0:3], v126, s[12:15], s36 offen offset:0
    buffer_load_dwordx4 v[4:7], v126, s[12:15], s36 offen offset:1024
    buffer_load_dwordx4 v[8:11], v126, s[12:15], s36 offen offset:2048
    buffer_load_dwordx4 v[12:15], v126, s[12:15], s36 offen offset:3072
    s_mov_b32 s36, 4096
    buffer_load_dwordx4 v[16:19], v126, s[12:15], s36 offen offset:0
    buffer_load_dwordx4 v[20:23], v126, s[12:15], s36 offen offset:1024
    buffer_load_dwordx4 v[24:27], v126, s[12:15], s36 offen offset:2048
    buffer_load_dwordx4 v[28:31], v126, s[12:15], s36 offen offset:3072
    s_mov_b32 s36, 8192
    buffer_load_dwordx4 v[32:35], v126, s[12:15], s36 offen offset:0
    buffer_load_dwordx4 v[36:39], v126, s[12:15], s36 offen offset:1024
    buffer_load_dwordx4 v[40:43], v126, s[12:15], s36 offen offset:2048
    buffer_load_dwordx4 v[44:47], v126, s[12:15], s36 offen offset:3072
    s_mov_b32 s36, 12288
    buffer_load_dwordx4 v[48:51], v126, s[12:15], s36 offen offset:0
    buffer_load_dwordx4 v[52:55], v126, s[12:15], s36 offen offset:1024
    buffer_load_dwordx4 v[56:59], v126, s[12:15], s36 offen offset:2048
    buffer_load_dwordx4 v[60:63], v126, s[12:15], s36 offen offset:3072
    v_lshrrev_b32 v125, 4, v127
    v_lshlrev_b32 v125, 11, v125
    v_and_b32 v124, 15, v127
    v_lshl_add_u32 v125, v124, 2, v125
    s_lshl_b32 s36, s21, 6
    v_add_u32 v125, s36, v125
    s_mov_b32 s44, 8192
    s_setprio 1
    s_barrier
    ds_read_b128 v[96:99], v126 offset:0
    ds_read_b128 v[100:103], v126 offset:1024
    ds_read_b128 v[104:107], v126 offset:2048
    ds_read_b128 v[108:111], v126 offset:3072
    s_waitcnt vmcnt(14) lgkmcnt(3)
    v_mfma_f32_16x16x32_bf16 v[64:67], v[96:99], v[0:3], 0
    v_mfma_f32_16x16x32_bf16 v[68:71], v[96:99], v[4:7], 0
    ds_read_b128 v[96:99], v126 offset:4096
    s_waitcnt lgkmcnt(3)
    v_mfma_f32_16x16x32_bf16 v[72:75], v[100:103], v[0:3], 0
    v_mfma_f32_16x16x32_bf16 v[76:79], v[100:103], v[4:7], 0
    ds_read_b128 v[100:103], v126 offset:5120
    s_waitcnt vmcnt(12) lgkmcnt(3)
    v_mfma_f32_16x16x32_bf16 v[64:67], v[104:107], v[8:11], v[64:67]
    v_mfma_f32_16x16x32_bf16 v[68:71], v[104:107], v[12:15], v[68:71]
    ds_read_b128 v[104:107], v126 offset:6144
    s_waitcnt lgkmcnt(3)
    v_mfma_f32_16x16x32_bf16 v[72:75], v[108:111], v[8:11], v[72:75]
    v_mfma_f32_16x16x32_bf16 v[76:79], v[108:111], v[12:15], v[76:79]
    ds_read_b128 v[108:111], v126 offset:7168
    s_waitcnt vmcnt(10) lgkmcnt(3)
    v_mfma_f32_16x16x32_bf16 v[64:67], v[96:99], v[16:19], v[64:67]
    v_mfma_f32_16x16x32_bf16 v[68:71], v[96:99], v[20:23], v[68:71]
    ds_read_b128 v[96:99], v126 offset:8192
    s_waitcnt lgkmcnt(3)
    v_mfma_f32_16x16x32_bf16 v[72:75], v[100:103], v[16:19], v[72:75]
    v_mfma_f32_16x16x32_bf16 v[76:79], v[100:103], v[20:23], v[76:79]
    ds_read_b128 v[100:103], v126 offset:9216
    s_waitcnt vmcnt(8) lgkmcnt(3)
    v_mfma_f32_16x16x32_bf16 v[64:67], v[104:107], v[24:27], v[64:67]
    v_mfma_f32_16x16x32_bf16 v[68:71], v[104:107], v[28:31], v[68:71]
    ds_read_b128 v[104:107], v126 offset:10240
    s_waitcnt lgkmcnt(3)
    v_mfma_f32_16x16x32_bf16 v[72:75], v[108:111], v[24:27], v[72:75]
    v_mfma_f32_16x16x32_bf16 v[76:79], v[108:111], v[28:31], v[76:79]
    ds_read_b128 v[108:111], v126 offset:11264
    s_waitcnt vmcnt(6) lgkmcnt(3)
    v_mfma_f32_16x16x32_bf16 v[64:67], v[96:99], v[32:35], v[64:67]
    v_mfma_f32_16x16x32_bf16 v[68:71], v[96:99], v[36:39], v[68:71]
    ds_read_b128 v[96:99], v126 offset:12288
    s_waitcnt lgkmcnt(3)
    v_mfma_f32_16x16x32_bf16 v[72:75], v[100:103], v[32:35], v[72:75]
    v_mfma_f32_16x16x32_bf16 v[76:79], v[100:103], v[36:39], v[76:79]
    ds_read_b128 v[100:103], v126 offset:13312
    s_waitcnt vmcnt(4) lgkmcnt(3)
    v_mfma_f32_16x16x32_bf16 v[64:67], v[104:107], v[40:43], v[64:67]
    v_mfma_f32_16x16x32_bf16 v[68:71], v[104:107], v[44:47], v[68:71]
    ds_read_b128 v[104:107], v126 offset:14336
    s_waitcnt lgkmcnt(3)
    v_mfma_f32_16x16x32_bf16 v[72:75], v[108:111], v[40:43], v[72:75]
    v_mfma_f32_16x16x32_bf16 v[76:79], v[108:111], v[44:47], v[76:79]
    ds_read_b128 v[108:111], v126 offset:15360
    s_waitcnt vmcnt(2) lgkmcnt(3)
    v_mfma_f32_16x16x32_bf16 v[64:67], v[96:99], v[48:51], v[64:67]
    v_mfma_f32_16x16x32_bf16 v[68:71], v[96:99], v[52:55], v[68:71]
    s_waitcnt lgkmcnt(0)
    s_barrier
    ds_read_b128 v[96:99], v126 offset:16384
    v_mfma_f32_16x16x32_bf16 v[72:75], v[100:103], v[48:51], v[72:75]
    v_mfma_f32_16x16x32_bf16 v[76:79], v[100:103], v[52:55], v[76:79]
    ds_read_b128 v[100:103], v126 offset:17408
    s_waitcnt vmcnt(0)
    v_mfma_f32_16x16x32_bf16 v[64:67], v[104:107], v[56:59], v[64:67]
    v_mfma_f32_16x16x32_bf16 v[68:71], v[104:107], v[60:63], v[68:71]
    ds_read_b128 v[104:107], v126 offset:18432
    v_mfma_f32_16x16x32_bf16 v[72:75], v[108:111], v[56:59], v[72:75]
    v_mfma_f32_16x16x32_bf16 v[76:79], v[108:111], v[60:63], v[76:79]
    ds_read_b128 v[108:111], v126 offset:19456
    s_mov_b32 s22, 4
L_joint_kernel_oloop:
    s_waitcnt lgkmcnt(3)
    v_mfma_f32_16x16x32_bf16 v[80:83], v[96:99], v[0:3], 0
    v_mfma_f32_16x16x32_bf16 v[84:87], v[96:99], v[4:7], 0
    ds_read_b128 v[96:99], v126 offset:20480
    s_waitcnt lgkmcnt(3)
    v_mfma_f32_16x16x32_bf16 v[88:91], v[100:103], v[0:3], 0
    v_mfma_f32_16x16x32_bf16 v[92:95], v[100:103], v[4:7], 0
    ds_read_b128 v[100:103], v126 offset:21504
    s_waitcnt lgkmcnt(3)
    v_mfma_f32_16x16x32_bf16 v[80:83], v[104:107], v[8:11], v[80:83]
    v_mfma_f32_16x16x32_bf16 v[84:87], v[104:107], v[12:15], v[84:87]
    ds_read_b128 v[104:107], v126 offset:22528
    s_waitcnt lgkmcnt(3)
    v_mfma_f32_16x16x32_bf16 v[88:91], v[108:111], v[8:11], v[88:91]
    v_cvt_pk_bf16_f32 v112, v64, v68
    v_mfma_f32_16x16x32_bf16 v[92:95], v[108:111], v[12:15], v[92:95]
    buffer_store_dword v112, v125, s[16:19], 0 offen offset:0 nt
    ds_read_b128 v[108:111], v126 offset:23552
    s_waitcnt lgkmcnt(3)
    v_mfma_f32_16x16x32_bf16 v[80:83], v[96:99], v[16:19], v[80:83]
    v_cvt_pk_bf16_f32 v113, v65, v69
    v_mfma_f32_16x16x32_bf16 v[84:87], v[96:99], v[20:23], v[84:87]
    buffer_store_dword v113, v125, s[16:19], 0 offen offset:512 nt
    ds_read_b128 v[96:99], v126 offset:24576
    s_waitcnt lgkmcnt(3)
    v_mfma_f32_16x16x32_bf16 v[88:91], v[100:103], v[16:19], v[88:91]
    v_cvt_pk_bf16_f32 v114, v66, v70
    v_mfma_f32_16x16x32_bf16 v[92:95], v[100:103], v[20:23], v[92:95]
    buffer_store_dword v114, v125, s[16:19], 0 offen offset:1024 nt
    ds_read_b128 v[100:103], v126 offset:25600
    s_waitcnt lgkmcnt(3)
    v_mfma_f32_16x16x32_bf16 v[80:83], v[104:107], v[24:27], v[80:83]
    v_cvt_pk_bf16_f32 v115, v67, v71
    v_mfma_f32_16x16x32_bf16 v[84:87], v[104:107], v[28:31], v[84:87]
    buffer_store_dword v115, v125, s[16:19], 0 offen offset:1536 nt
    ds_read_b128 v[104:107], v126 offset:26624
    s_waitcnt lgkmcnt(3)
    v_mfma_f32_16x16x32_bf16 v[88:91], v[108:111], v[24:27], v[88:91]
    v_cvt_pk_bf16_f32 v116, v72, v76
    v_mfma_f32_16x16x32_bf16 v[92:95], v[108:111], v[28:31], v[92:95]
    buffer_store_dword v116, v125, s[16:19], s44 offen offset:0 nt
    ds_read_b128 v[108:111], v126 offset:27648
    s_waitcnt lgkmcnt(3)
    v_mfma_f32_16x16x32_bf16 v[80:83], v[96:99], v[32:35], v[80:83]
    v_cvt_pk_bf16_f32 v117, v73, v77
    v_mfma_f32_16x16x32_bf16 v[84:87], v[96:99], v[36:39], v[84:87]
    buffer_store_dword v117, v125, s[16:19], s44 offen offset:512 nt
    ds_read_b128 v[96:99], v126 offset:28672
    s_waitcnt lgkmcnt(3)
    v_mfma_f32_16x16x32_bf16 v[88:91], v[100:103], v[32:35], v[88:91]
    v_cvt_pk_bf16_f32 v118, v74, v78
    v_mfma_f32_16x16x32_bf16 v[92:95], v[100:103], v[36:39], v[92:95]
    buffer_store_dword v118, v125, s[16:19], s44 offen offset:1024 nt
    ds_read_b128 v[100:103], v126 offset:29696
    s_waitcnt lgkmcnt(3)
    v_mfma_f32_16x16x32_bf16 v[80:83], v[104:107], v[40:43], v[80:83]
    v_cvt_pk_bf16_f32 v119, v75, v79
    v_mfma_f32_16x16x32_bf16 v[84:87], v[104:107], v[44:47], v[84:87]
    buffer_store_dword v119, v125, s[16:19], s44 offen offset:1536 nt
    ds_read_b128 v[104:107], v126 offset:30720
    s_waitcnt lgkmcnt(3)
    v_mfma_f32_16x16x32_bf16 v[88:91], v[108:111], v[40:43], v[88:91]
    v_add_u32 v125, 16384, v125
    v_mfma_f32_16x16x32_bf16 v[92:95], v[108:111], v[44:47], v[92:95]
    ds_read_b128 v[108:111], v126 offset:31744
    s_waitcnt lgkmcnt(3)
    v_mfma_f32_16x16x32_bf16 v[80:83], v[96:99], v[48:51], v[80:83]
    v_mfma_f32_16x16x32_bf16 v[84:87], v[96:99], v[52:55], v[84:87]
    s_waitcnt lgkmcnt(0)
    s_barrier
    ds_read_b128 v[96:99], v126 offset:0
    v_mfma_f32_16x16x32_bf16 v[88:91], v[100:103], v[48:51], v[88:91]
    v_mfma_f32_16x16x32_bf16 v[92:95], v[100:103], v[52:55], v[92:95]
    ds_read_b128 v[100:103], v126 offset:1024
    v_mfma_f32_16x16x32_bf16 v[80:83], v[104:107], v[56:59], v[80:83]
    v_mfma_f32_16x16x32_bf16 v[84:87], v[104:107], v[60:63], v[84:87]
    ds_read_b128 v[104:107], v126 offset:2048
    v_mfma_f32_16x16x32_bf16 v[88:91], v[108:111], v[56:59], v[88:91]
    v_mfma_f32_16x16x32_bf16 v[92:95], v[108:111], v[60:63], v[92:95]
    ds_read_b128 v[108:111], v126 offset:3072
    s_sub_u32 s22, s22, 1
    s_cmp_eq_u32 s22, 0
    s_cbranch_scc1 L_joint_kernel_oend
    s_waitcnt lgkmcnt(3)
    v_mfma_f32_16x16x32_bf16 v[64:67], v[96:99], v[0:3], 0
    v_mfma_f32_16x16x32_bf16 v[68:71], v[96:99], v[4:7], 0
    ds_read_b128 v[96:99], v126 offset:4096
    s_waitcnt lgkmcnt(3)
    v_mfma_f32_16x16x32_bf16 v[72:75], v[100:103], v[0:3], 0
    v_mfma_f32_16x16x32_bf16 v[76:79], v[100:103], v[4:7], 0
    ds_read_b128 v[100:103], v126 offset:5120
    s_waitcnt lgkmcnt(3)
    v_mfma_f32_16x16x32_bf16 v[64:67], v[104:107], v[8:11], v[64:67]
    v_mfma_f32_16x16x32_bf16 v[68:71], v[104:107], v[12:15], v[68:71]
    ds_read_b128 v[104:107], v126 offset:6144
    s_waitcnt lgkmcnt(3)
    v_mfma_f32_16x16x32_bf16 v[72:75], v[108:111], v[8:11], v[72:75]
    v_cvt_pk_bf16_f32 v112, v80, v84
    v_mfma_f32_16x16x32_bf16 v[76:79], v[108:111], v[12:15], v[76:79]
    buffer_store_dword v112, v125, s[16:19], 0 offen offset:0 nt
    ds_read_b128 v[108:111], v126 offset:7168
    s_waitcnt lgkmcnt(3)
    v_mfma_f32_16x16x32_bf16 v[64:67], v[96:99], v[16:19], v[64:67]
    v_cvt_pk_bf16_f32 v113, v81, v85
    v_mfma_f32_16x16x32_bf16 v[68:71], v[96:99], v[20:23], v[68:71]
    buffer_store_dword v113, v125, s[16:19], 0 offen offset:512 nt
    ds_read_b128 v[96:99], v126 offset:8192
    s_waitcnt lgkmcnt(3)
    v_mfma_f32_16x16x32_bf16 v[72:75], v[100:103], v[16:19], v[72:75]
    v_cvt_pk_bf16_f32 v114, v82, v86
    v_mfma_f32_16x16x32_bf16 v[76:79], v[100:103], v[20:23], v[76:79]
    buffer_store_dword v114, v125, s[16:19], 0 offen offset:1024 nt
    ds_read_b128 v[100:103], v126 offset:9216
    s_waitcnt lgkmcnt(3)
    v_mfma_f32_16x16x32_bf16 v[64:67], v[104:107], v[24:27], v[64:67]
    v_cvt_pk_bf16_f32 v115, v83, v87
    v_mfma_f32_16x16x32_bf16 v[68:71], v[104:107], v[28:31], v[68:71]
    buffer_store_dword v115, v125, s[16:19], 0 offen offset:1536 nt
    ds_read_b128 v[104:107], v126 offset:10240
    s_waitcnt lgkmcnt(3)
    v_mfma_f32_16x16x32_bf16 v[72:75], v[108:111], v[24:27], v[72:75]
    v_cvt_pk_bf16_f32 v116, v88, v92
    v_mfma_f32_16x16x32_bf16 v[76:79], v[108:111], v[28:31], v[76:79]
    buffer_store_dword v116, v125, s[16:19], s44 offen offset:0 nt
    ds_read_b128 v[108:111], v126 offset:11264
    s_waitcnt lgkmcnt(3)
    v_mfma_f32_16x16x32_bf16 v[64:67], v[96:99], v[32:35], v[64:67]
    v_cvt_pk_bf16_f32 v117, v89, v93
    v_mfma_f32_16x16x32_bf16 v[68:71], v[96:99], v[36:39], v[68:71]
    buffer_store_dword v117, v125, s[16:19], s44 offen offset:512 nt
    ds_read_b128 v[96:99], v126 offset:12288
    s_waitcnt lgkmcnt(3)
    v_mfma_f32_16x16x32_bf16 v[72:75], v[100:103], v[32:35], v[72:75]
    v_cvt_pk_bf16_f32 v118, v90, v94
    v_mfma_f32_16x16x32_bf16 v[76:79], v[100:103], v[36:39], v[76:79]
    buffer_store_dword v118, v125, s[16:19], s44 offen offset:1024 nt
    ds_read_b128 v[100:103], v126 offset:13312
    s_waitcnt lgkmcnt(3)
    v_mfma_f32_16x16x32_bf16 v[64:67], v[104:107], v[40:43], v[64:67]
    v_cvt_pk_bf16_f32 v119, v91, v95
    v_mfma_f32_16x16x32_bf16 v[68:71], v[104:107], v[44:47], v[68:71]
    buffer_store_dword v119, v125, s[16:19], s44 offen offset:1536 nt
    ds_read_b128 v[104:107], v126 offset:14336
    s_waitcnt lgkmcnt(3)
    v_mfma_f32_16x16x32_bf16 v[72:75], v[108:111], v[40:43], v[72:75]
    v_add_u32 v125, 16384, v125
    v_mfma_f32_16x16x32_bf16 v[76:79], v[108:111], v[44:47], v[76:79]
    ds_read_b128 v[108:111], v126 offset:15360
    s_waitcnt lgkmcnt(3)
    v_mfma_f32_16x16x32_bf16 v[64:67], v[96:99], v[48:51], v[64:67]
    v_mfma_f32_16x16x32_bf16 v[68:71], v[96:99], v[52:55], v[68:71]
    s_waitcnt lgkmcnt(0)
    s_barrier
    ds_read_b128 v[96:99], v126 offset:16384
    v_mfma_f32_16x16x32_bf16 v[72:75], v[100:103], v[48:51], v[72:75]
    v_mfma_f32_16x16x32_bf16 v[76:79], v[100:103], v[52:55], v[76:79]
    ds_read_b128 v[100:103], v126 offset:17408
    v_mfma_f32_16x16x32_bf16 v[64:67], v[104:107], v[56:59], v[64:67]
    v_mfma_f32_16x16x32_bf16 v[68:71], v[104:107], v[60:63], v[68:71]
    ds_read_b128 v[104:107], v126 offset:18432
    v_mfma_f32_16x16x32_bf16 v[72:75], v[108:111], v[56:59], v[72:75]
    v_mfma_f32_16x16x32_bf16 v[76:79], v[108:111], v[60:63], v[76:79]
    ds_read_b128 v[108:111], v126 offset:19456
    s_waitcnt vmcnt(32)
    s_branch L_joint_kernel_oloop
L_joint_kernel_oend:
    s_nop 7
    v_cvt_pk_bf16_f32 v112, v80, v84
    buffer_store_dword v112, v125, s[16:19], 0 offen offset:0 nt
    v_cvt_pk_bf16_f32 v113, v81, v85
    buffer_store_dword v113, v125, s[16:19], 0 offen offset:512 nt
    v_cvt_pk_bf16_f32 v114, v82, v86
    buffer_store_dword v114, v125, s[16:19], 0 offen offset:1024 nt
    v_cvt_pk_bf16_f32 v115, v83, v87
    buffer_store_dword v115, v125, s[16:19], 0 offen offset:1536 nt
    v_cvt_pk_bf16_f32 v116, v88, v92
    buffer_store_dword v116, v125, s[16:19], s44 offen offset:0 nt
    v_cvt_pk_bf16_f32 v117, v89, v93
    buffer_store_dword v117, v125, s[16:19], s44 offen offset:512 nt
    v_cvt_pk_bf16_f32 v118, v90, v94
    buffer_store_dword v118, v125, s[16:19], s44 offen offset:1024 nt
    v_cvt_pk_bf16_f32 v119, v91, v95
    buffer_store_dword v119, v125, s[16:19], s44 offen offset:1536 nt
    v_add_u32 v125, 16384, v125
    s_branch L_joint_kernel_fin
L_joint_kernel_T:
    s_setprio 3
    s_lshl_b32 s36, s21, 2
    s_add_u32 s36, s36, 44335104
    s_add_u32 s36, s30, s36
    s_addc_u32 s37, s31, 0
    s_load_dword s44, s[36:37], 0
    v_and_b32 v123, 15, v127
    v_lshrrev_b32 v121, 4, v127
    v_mul_u32_u24 v125, 528, v123
    v_lshl_add_u32 v125, v121, 4, v125
    v_lshlrev_b32 v121, 5, v121
    v_and_b32 v120, 7, v127
    v_lshl_add_u32 v124, v120, 10, v121
    s_lshl_b32 s38, s21, 7
    v_mul_u32_u24 v120, 1040, v120
    s_add_u32 s36, s38, 91136
    v_add3_u32 v120, v120, v121, s36
    s_mul_i32 s36, s21, 5184
    s_add_u32 s36, s36, 49664
    v_add_u32 v121, s36, v121
    v_mul_u32_u24 v122, 144, v123
    v_add_u32 v122, v122, v121
    v_lshrrev_b32 v123, 3, v123
    v_mul_u32_u24 v123, 144, v123
    v_add_u32 v121, v123, v121
    s_lshl_b32 s36, s21, 11
    v_add_u32 v123, s36, v126
    s_barrier
    s_mov_b32 s36, 0
    buffer_load_dwordx4 v[0:3], v126, s[12:15], s36 offen offset:0
    buffer_load_dwordx4 v[4:7], v126, s[12:15], s36 offen offset:1024
    buffer_load_dwordx4 v[8:11], v126, s[12:15], s36 offen offset:2048
    buffer_load_dwordx4 v[12:15], v126, s[12:15], s36 offen offset:3072
    s_mov_b32 s36, 4096
    buffer_load_dwordx4 v[16:19], v126, s[12:15], s36 offen offset:0
    buffer_load_dwordx4 v[20:23], v126, s[12:15], s36 offen offset:1024
    buffer_load_dwordx4 v[24:27], v126, s[12:15], s36 offen offset:2048
    buffer_load_dwordx4 v[28:31], v126, s[12:15], s36 offen offset:3072
    s_mov_b32 s36, 8192
    buffer_load_dwordx4 v[32:35], v126, s[12:15], s36 offen offset:0
    buffer_load_dwordx4 v[36:39], v126, s[12:15], s36 offen offset:1024
    buffer_load_dwordx4 v[40:43], v126, s[12:15], s36 offen offset:2048
    buffer_load_dwordx4 v[44:47], v126, s[12:15], s36 offen offset:3072
    s_mov_b32 s36, 12288
    buffer_load_dwordx4 v[48:51], v126, s[12:15], s36 offen offset:0
    buffer_load_dwordx4 v[52:55], v126, s[12:15], s36 offen offset:1024
    buffer_load_dwordx4 v[56:59], v126, s[12:15], s36 offen offset:2048
    buffer_load_dwordx4 v[60:63], v126, s[12:15], s36 offen offset:3072
    v_mov_b32 v64, 99456
    v_mov_b32 v65, 1
    s_mov_b64 exec, 1
    ds_add_u32 v64, v65 offset:4
    s_mov_b64 exec, -1
L_joint_kernel_tw:
    ds_read_b32 v65, v64 offset:0
    s_waitcnt lgkmcnt(0)
    v_readfirstlane_b32 s37, v65
    s_cmp_ge_u32 s37, 8
    s_cbranch_scc1 L_joint_kernel_tw_d
    s_sleep 1
    s_branch L_joint_kernel_tw
L_joint_kernel_tw_d:
    ds_read_b128 v[80:83], v125 offset:32768
    ds_read_b128 v[84:87], v125 offset:41216
    ds_read_b128 v[88:91], v125 offset:32832
    ds_read_b128 v[92:95], v125 offset:41280
    ds_read_b128 v[96:99], v125 offset:32896
    ds_read_b128 v[100:103], v125 offset:41344
    ds_read_b128 v[104:107], v125 offset:32960
    ds_read_b128 v[108:111], v125 offset:41408
    s_setprio 0
    s_waitcnt vmcnt(14) lgkmcnt(7)
    v_mfma_f32_16x16x32_bf16 v[64:67], v[0:3], v[80:83], 0
    v_mfma_f32_16x16x32_bf16 v[68:71], v[4:7], v[80:83], 0
    ds_read_b128 v[80:83], v125 offset:33024
    s_waitcnt lgkmcnt(7)
    v_mfma_f32_16x16x32_bf16 v[72:75], v[0:3], v[84:87], 0
    v_mfma_f32_16x16x32_bf16 v[76:79], v[4:7], v[84:87], 0
    ds_read_b128 v[84:87], v125 offset:41472
    s_waitcnt vmcnt(12) lgkmcnt(7)
    v_mfma_f32_16x16x32_bf16 v[64:67], v[8:11], v[88:91], v[64:67]
    v_mfma_f32_16x16x32_bf16 v[68:71], v[12:15], v[88:91], v[68:71]
    ds_read_b128 v[88:91], v125 offset:33088
    s_waitcnt lgkmcnt(7)
    v_mfma_f32_16x16x32_bf16 v[72:75], v[8:11], v[92:95], v[72:75]
    v_mfma_f32_16x16x32_bf16 v[76:79], v[12:15], v[92:95], v[76:79]
    ds_read_b128 v[92:95], v125 offset:41536
    s_waitcnt vmcnt(10) lgkmcnt(7)
    v_mfma_f32_16x16x32_bf16 v[64:67], v[16:19], v[96:99], v[64:67]
    v_mfma_f32_16x16x32_bf16 v[68:71], v[20:23], v[96:99], v[68:71]
    ds_read_b128 v[96:99], v125 offset:33152
    s_waitcnt lgkmcnt(7)
    v_mfma_f32_16x16x32_bf16 v[72:75], v[16:19], v[100:103], v[72:75]
    v_mfma_f32_16x16x32_bf16 v[76:79], v[20:23], v[100:103], v[76:79]
    ds_read_b128 v[100:103], v125 offset:41600
    s_waitcnt vmcnt(8) lgkmcnt(7)
    v_mfma_f32_16x16x32_bf16 v[64:67], v[24:27], v[104:107], v[64:67]
    v_mfma_f32_16x16x32_bf16 v[68:71], v[28:31], v[104:107], v[68:71]
    ds_read_b128 v[104:107], v125 offset:33216
    s_waitcnt lgkmcnt(7)
    v_mfma_f32_16x16x32_bf16 v[72:75], v[24:27], v[108:111], v[72:75]
    v_mfma_f32_16x16x32_bf16 v[76:79], v[28:31], v[108:111], v[76:79]
    ds_read_b128 v[108:111], v125 offset:41664
    s_waitcnt vmcnt(6) lgkmcnt(7)
    v_mfma_f32_16x16x32_bf16 v[64:67], v[32:35], v[80:83], v[64:67]
    v_mfma_f32_16x16x32_bf16 v[68:71], v[36:39], v[80:83], v[68:71]
    ds_read_b128 v[112:115], v120 offset:0
    s_waitcnt lgkmcnt(7)
    v_mfma_f32_16x16x32_bf16 v[72:75], v[32:35], v[84:87], v[72:75]
    v_mfma_f32_16x16x32_bf16 v[76:79], v[36:39], v[84:87], v[76:79]
    ds_read_b128 v[116:119], v120 offset:16
    s_waitcnt vmcnt(4) lgkmcnt(7)
    v_mfma_f32_16x16x32_bf16 v[64:67], v[40:43], v[88:91], v[64:67]
    v_mfma_f32_16x16x32_bf16 v[68:71], v[44:47], v[88:91], v[68:71]
    s_waitcnt lgkmcnt(6)
    v_mfma_f32_16x16x32_bf16 v[72:75], v[40:43], v[92:95], v[72:75]
    v_mfma_f32_16x16x32_bf16 v[76:79], v[44:47], v[92:95], v[76:79]
    s_waitcnt vmcnt(2) lgkmcnt(5)
    v_mfma_f32_16x16x32_bf16 v[64:67], v[48:51], v[96:99], v[64:67]
    v_mfma_f32_16x16x32_bf16 v[68:71], v[52:55], v[96:99], v[68:71]
    s_waitcnt lgkmcnt(4)
    v_mfma_f32_16x16x32_bf16 v[72:75], v[48:51], v[100:103], v[72:75]
    v_mfma_f32_16x16x32_bf16 v[76:79], v[52:55], v[100:103], v[76:79]
    s_waitcnt vmcnt(0) lgkmcnt(3)
    v_mfma_f32_16x16x32_bf16 v[64:67], v[56:59], v[104:107], v[64:67]
    v_mfma_f32_16x16x32_bf16 v[68:71], v[60:63], v[104:107], v[68:71]
    s_waitcnt lgkmcnt(2)
    v_mfma_f32_16x16x32_bf16 v[72:75], v[56:59], v[108:111], v[72:75]
    v_mfma_f32_16x16x32_bf16 v[76:79], v[60:63], v[108:111], v[76:79]
    s_mov_b32 s46, 0xffff0000
    s_mov_b32 s48, 0x4038aa3b
    s_mov_b32 s49, s48
    s_nop 3
    v_mov_b32 v28, 0
    s_waitcnt lgkmcnt(0)
    v_cvt_pk_bf16_f32 v24, v64, v68
    v_cvt_pk_bf16_f32 v25, v65, v69
    v_cvt_pk_bf16_f32 v26, v66, v70
    v_cvt_pk_bf16_f32 v27, v67, v71
    v_lshlrev_b32 v80, 16, v24
    v_and_b32 v81, s46, v24
    v_lshlrev_b32 v82, 16, v25
    v_and_b32 v83, s46, v25
    v_lshlrev_b32 v84, 16, v26
    v_and_b32 v85, s46, v26
    v_lshlrev_b32 v86, 16, v27
    v_and_b32 v87, s46, v27
    v_pk_mul_f32 v[80:81], v[80:81], s[48:49]
    v_pk_mul_f32 v[82:83], v[82:83], s[48:49]
    v_pk_mul_f32 v[84:85], v[84:85], s[48:49]
    v_pk_mul_f32 v[86:87], v[86:87], s[48:49]
    v_exp_f32 v96, v80
    v_exp_f32 v97, v81
    v_exp_f32 v98, v82
    v_exp_f32 v99, v83
    v_max3_f32 v28, |v80|, |v81|, v28
    v_max3_f32 v28, |v82|, |v83|, v28
    ds_write_b128 v122, v[96:99] offset:0
    v_exp_f32 v100, v84
    v_exp_f32 v101, v85
    v_exp_f32 v102, v86
    v_exp_f32 v103, v87
    v_max3_f32 v28, |v84|, |v85|, v28
    v_max3_f32 v28, |v86|, |v87|, v28
    ds_write_b128 v122, v[100:103] offset:16
    v_cvt_pk_bf16_f32 v24, v72, v76
    v_cvt_pk_bf16_f32 v25, v73, v77
    v_cvt_pk_bf16_f32 v26, v74, v78
    v_cvt_pk_bf16_f32 v27, v75, v79
    v_lshlrev_b32 v88, 16, v24
    v_and_b32 v89, s46, v24
    v_lshlrev_b32 v90, 16, v25
    v_and_b32 v91, s46, v25
    v_lshlrev_b32 v92, 16, v26
    v_and_b32 v93, s46, v26
    v_lshlrev_b32 v94, 16, v27
    v_and_b32 v95, s46, v27
    v_pk_mul_f32 v[88:89], v[88:89], s[48:49]
    v_pk_mul_f32 v[90:91], v[90:91], s[48:49]
    v_pk_mul_f32 v[92:93], v[92:93], s[48:49]
    v_pk_mul_f32 v[94:95], v[94:95], s[48:49]
    v_exp_f32 v104, v88
    v_exp_f32 v105, v89
    v_exp_f32 v106, v90
    v_exp_f32 v107, v91
    v_max3_f32 v28, |v88|, |v89|, v28
    v_max3_f32 v28, |v90|, |v91|, v28
    ds_write_b128 v122, v[104:107] offset:2304
    v_exp_f32 v108, v92
    v_exp_f32 v109, v93
    v_exp_f32 v110, v94
    v_exp_f32 v111, v95
    v_max3_f32 v28, |v92|, |v93|, v28
    v_max3_f32 v28, |v94|, |v95|, v28
    ds_write_b128 v122, v[108:111] offset:2320
    v_cmp_lt_f32 vcc, 0x42f00000, v28
    s_mov_b32 s22, 4
    s_or_b32 s44, s44, vcc_lo
    s_or_b32 s44, s44, vcc_hi
    s_cmp_lg_u32 s44, 0
    s_cbranch_scc1 L_joint_kernel_tslow
    ds_read_b128 v[32:35], v121 offset:0
    ds_read_b128 v[36:39], v121 offset:16
    ds_read_b128 v[40:43], v121 offset:288
    ds_read_b128 v[44:47], v121 offset:304
    v_add_u32 v121, 576, v121
    s_waitcnt vmcnt(0) lgkmcnt(0)
L_joint_kernel_tloop1:
    v_fma_f32 v48, v112, v32, 1.0
    v_fma_f32 v49, v113, v33, 1.0
    v_fma_f32 v50, v114, v34, 1.0
    v_fma_f32 v51, v115, v35, 1.0
    v_fma_f32 v52, v116, v36, 1.0
    v_fma_f32 v53, v117, v37, 1.0
    v_fma_f32 v54, v118, v38, 1.0
    v_fma_f32 v55, v119, v39, 1.0
    v_fma_f32 v56, v112, v40, 1.0
    v_fma_f32 v57, v113, v41, 1.0
    v_fma_f32 v58, v114, v42, 1.0
    v_fma_f32 v59, v115, v43, 1.0
    v_fma_f32 v60, v116, v44, 1.0
    v_fma_f32 v61, v117, v45, 1.0
    v_fma_f32 v62, v118, v46, 1.0
    v_fma_f32 v63, v119, v47, 1.0
    ds_read_b128 v[32:35], v121 offset:0
    ds_read_b128 v[36:39], v121 offset:16
    ds_read_b128 v[40:43], v121 offset:288
    ds_read_b128 v[44:47], v121 offset:304
    v_add_u32 v121, 576, v121
    v_rcp_f32 v48, v48
    v_rcp_f32 v49, v49
    v_rcp_f32 v50, v50
    v_rcp_f32 v51, v51
    v_rcp_f32 v52, v52
    v_rcp_f32 v53, v53
    v_rcp_f32 v54, v54
    v_rcp_f32 v55, v55
    v_fma_f32 v48, v48, -2.0, 1.0
    v_fma_f32 v49, v49, -2.0, 1.0
    v_fma_f32 v50, v50, -2.0, 1.0
    v_fma_f32 v51, v51, -2.0, 1.0
    v_fma_f32 v52, v52, -2.0, 1.0
    v_fma_f32 v53, v53, -2.0, 1.0
    v_fma_f32 v54, v54, -2.0, 1.0
    v_fma_f32 v55, v55, -2.0, 1.0
    v_cvt_pk_bf16_f32 v64, v48, v49
    v_cvt_pk_bf16_f32 v65, v50, v51
    v_cvt_pk_bf16_f32 v66, v52, v53
    v_cvt_pk_bf16_f32 v67, v54, v55
    ds_write_b128 v123, v[64:67] offset:0
    v_rcp_f32 v56, v56
    v_rcp_f32 v57, v57
    v_rcp_f32 v58, v58
    v_rcp_f32 v59, v59
    v_rcp_f32 v60, v60
    v_rcp_f32 v61, v61
    v_rcp_f32 v62, v62
    v_rcp_f32 v63, v63
    v_fma_f32 v56, v56, -2.0, 1.0
    v_fma_f32 v57, v57, -2.0, 1.0
    v_fma_f32 v58, v58, -2.0, 1.0
    v_fma_f32 v59, v59, -2.0, 1.0
    v_fma_f32 v60, v60, -2.0, 1.0
    v_fma_f32 v61, v61, -2.0, 1.0
    v_fma_f32 v62, v62, -2.0, 1.0
    v_fma_f32 v63, v63, -2.0, 1.0
    v_cvt_pk_bf16_f32 v68, v56, v57
    v_cvt_pk_bf16_f32 v69, v58, v59
    v_cvt_pk_bf16_f32 v70, v60, v61
    v_cvt_pk_bf16_f32 v71, v62, v63
    ds_write_b128 v123, v[68:71] offset:1024
    s_waitcnt lgkmcnt(0)
    s_barrier
    v_fma_f32 v48, v112, v32, 1.0
    v_fma_f32 v49, v113, v33, 1.0
    v_fma_f32 v50, v114, v34, 1.0
    v_fma_f32 v51, v115, v35, 1.0
    v_fma_f32 v52, v116, v36, 1.0
    v_fma_f32 v53, v117, v37, 1.0
    v_fma_f32 v54, v118, v38, 1.0
    v_fma_f32 v55, v119, v39, 1.0
    v_fma_f32 v56, v112, v40, 1.0
    v_fma_f32 v57, v113, v41, 1.0
    v_fma_f32 v58, v114, v42, 1.0
    v_fma_f32 v59, v115, v43, 1.0
    v_fma_f32 v60, v116, v44, 1.0
    v_fma_f32 v61, v117, v45, 1.0
    v_fma_f32 v62, v118, v46, 1.0
    v_fma_f32 v63, v119, v47, 1.0
    ds_read_b128 v[32:35], v121 offset:0
    ds_read_b128 v[36:39], v121 offset:16
    ds_read_b128 v[40:43], v121 offset:288
    ds_read_b128 v[44:47], v121 offset:304
    v_add_u32 v121, 576, v121
    v_rcp_f32 v48, v48
    v_rcp_f32 v49, v49
    v_rcp_f32 v50, v50
    v_rcp_f32 v51, v51
    v_rcp_f32 v52, v52
    v_rcp_f32 v53, v53
    v_rcp_f32 v54, v54
    v_rcp_f32 v55, v55
    v_fma_f32 v48, v48, -2.0, 1.0
    v_fma_f32 v49, v49, -2.0, 1.0
    v_fma_f32 v50, v50, -2.0, 1.0
    v_fma_f32 v51, v51, -2.0, 1.0
    v_fma_f32 v52, v52, -2.0, 1.0
    v_fma_f32 v53, v53, -2.0, 1.0
    v_fma_f32 v54, v54, -2.0, 1.0
    v_fma_f32 v55, v55, -2.0, 1.0
    v_cvt_pk_bf16_f32 v64, v48, v49
    v_cvt_pk_bf16_f32 v65, v50, v51
    v_cvt_pk_bf16_f32 v66, v52, v53
    v_cvt_pk_bf16_f32 v67, v54, v55
    ds_write_b128 v123, v[64:67] offset:16384
    v_rcp_f32 v56, v56
    v_rcp_f32 v57, v57
    v_rcp_f32 v58, v58
    v_rcp_f32 v59, v59
    v_rcp_f32 v60, v60
    v_rcp_f32 v61, v61
    v_rcp_f32 v62, v62
    v_rcp_f32 v63, v63
    v_fma_f32 v56, v56, -2.0, 1.0
    v_fma_f32 v57, v57, -2.0, 1.0
    v_fma_f32 v58, v58, -2.0, 1.0
    v_fma_f32 v59, v59, -2.0, 1.0
    v_fma_f32 v60, v60, -2.0, 1.0
    v_fma_f32 v61, v61, -2.0, 1.0
    v_fma_f32 v62, v62, -2.0, 1.0
    v_fma_f32 v63, v63, -2.0, 1.0
    v_cvt_pk_bf16_f32 v68, v56, v57
    v_cvt_pk_bf16_f32 v69, v58, v59
    v_cvt_pk_bf16_f32 v70, v60, v61
    v_cvt_pk_bf16_f32 v71, v62, v63
    ds_write_b128 v123, v[68:71] offset:17408
    s_waitcnt lgkmcnt(0)
    s_barrier
    s_sub_u32 s22, s22, 1
    s_cmp_lg_u32 s22, 0
    s_cbranch_scc1 L_joint_kernel_tloop1
    s_branch L_joint_kernel_fin
L_joint_kernel_tslow:
    buffer_load_dwordx4 v[112:115], v124, s[40:43], s38 offen offset:0
    buffer_load_dwordx4 v[116:119], v124, s[40:43], s38 offen offset:16
    ds_write_b128 v122, v[80:83] offset:0
    ds_write_b128 v122, v[84:87] offset:16
    ds_write_b128 v122, v[88:91] offset:2304
    ds_write_b128 v122, v[92:95] offset:2320
    ds_read_b128 v[32:35], v121 offset:0
    ds_read_b128 v[36:39], v121 offset:16
    ds_read_b128 v[40:43], v121 offset:288
    ds_read_b128 v[44:47], v121 offset:304
    v_add_u32 v121, 576, v121
    s_waitcnt vmcnt(0) lgkmcnt(0)
L_joint_kernel_tloop0:
    v_add_f32 v48, v112, v32
    v_add_f32 v49, v113, v33
    v_add_f32 v50, v114, v34
    v_add_f32 v51, v115, v35
    v_add_f32 v52, v116, v36
    v_add_f32 v53, v117, v37
    v_add_f32 v54, v118, v38
    v_add_f32 v55, v119, v39
    v_add_f32 v56, v112, v40
    v_add_f32 v57, v113, v41
    v_add_f32 v58, v114, v42
    v_add_f32 v59, v115, v43
    v_add_f32 v60, v116, v44
    v_add_f32 v61, v117, v45
    v_add_f32 v62, v118, v46
    v_add_f32 v63, v119, v47
    ds_read_b128 v[32:35], v121 offset:0
    ds_read_b128 v[36:39], v121 offset:16
    ds_read_b128 v[40:43], v121 offset:288
    ds_read_b128 v[44:47], v121 offset:304
    v_add_u32 v121, 576, v121
    v_exp_f32 v48, v48
    v_exp_f32 v49, v49
    v_exp_f32 v50, v50
    v_exp_f32 v51, v51
    v_exp_f32 v52, v52
    v_exp_f32 v53, v53
    v_exp_f32 v54, v54
    v_exp_f32 v55, v55
    v_add_f32 v48, 1.0, v48
    v_add_f32 v49, 1.0, v49
    v_add_f32 v50, 1.0, v50
    v_add_f32 v51, 1.0, v51
    v_add_f32 v52, 1.0, v52
    v_add_f32 v53, 1.0, v53
    v_add_f32 v54, 1.0, v54
    v_add_f32 v55, 1.0, v55
    v_rcp_f32 v48, v48
    v_rcp_f32 v49, v49
    v_rcp_f32 v50, v50
    v_rcp_f32 v51, v51
    v_rcp_f32 v52, v52
    v_rcp_f32 v53, v53
    v_rcp_f32 v54, v54
    v_rcp_f32 v55, v55
    v_fma_f32 v48, v48, -2.0, 1.0
    v_fma_f32 v49, v49, -2.0, 1.0
    v_fma_f32 v50, v50, -2.0, 1.0
    v_fma_f32 v51, v51, -2.0, 1.0
    v_fma_f32 v52, v52, -2.0, 1.0
    v_fma_f32 v53, v53, -2.0, 1.0
    v_fma_f32 v54, v54, -2.0, 1.0
    v_fma_f32 v55, v55, -2.0, 1.0
    v_cvt_pk_bf16_f32 v64, v48, v49
    v_cvt_pk_bf16_f32 v65, v50, v51
    v_cvt_pk_bf16_f32 v66, v52, v53
    v_cvt_pk_bf16_f32 v67, v54, v55
    ds_write_b128 v123, v[64:67] offset:0
    v_exp_f32 v56, v56
    v_exp_f32 v57, v57
    v_exp_f32 v58, v58
    v_exp_f32 v59, v59
    v_exp_f32 v60, v60
    v_exp_f32 v61, v61
    v_exp_f32 v62, v62
    v_exp_f32 v63, v63
    v_add_f32 v56, 1.0, v56
    v_add_f32 v57, 1.0, v57
    v_add_f32 v58, 1.0, v58
    v_add_f32 v59, 1.0, v59
    v_add_f32 v60, 1.0, v60
    v_add_f32 v61, 1.0, v61
    v_add_f32 v62, 1.0, v62
    v_add_f32 v63, 1.0, v63
    v_rcp_f32 v56, v56
    v_rcp_f32 v57, v57
    v_rcp_f32 v58, v58
    v_rcp_f32 v59, v59
    v_rcp_f32 v60, v60
    v_rcp_f32 v61, v61
    v_rcp_f32 v62, v62
    v_rcp_f32 v63, v63
    v_fma_f32 v56, v56, -2.0, 1.0
    v_fma_f32 v57, v57, -2.0, 1.0
    v_fma_f32 v58, v58, -2.0, 1.0
    v_fma_f32 v59, v59, -2.0, 1.0
    v_fma_f32 v60, v60, -2.0, 1.0
    v_fma_f32 v61, v61, -2.0, 1.0
    v_fma_f32 v62, v62, -2.0, 1.0
    v_fma_f32 v63, v63, -2.0, 1.0
    v_cvt_pk_bf16_f32 v68, v56, v57
    v_cvt_pk_bf16_f32 v69, v58, v59
    v_cvt_pk_bf16_f32 v70, v60, v61
    v_cvt_pk_bf16_f32 v71, v62, v63
    ds_write_b128 v123, v[68:71] offset:1024
    s_waitcnt lgkmcnt(0)
    s_barrier
    v_add_f32 v48, v112, v32
    v_add_f32 v49, v113, v33
    v_add_f32 v50, v114, v34
    v_add_f32 v51, v115, v35
    v_add_f32 v52, v116, v36
    v_add_f32 v53, v117, v37
    v_add_f32 v54, v118, v38
    v_add_f32 v55, v119, v39
    v_add_f32 v56, v112, v40
    v_add_f32 v57, v113, v41
    v_add_f32 v58, v114, v42
    v_add_f32 v59, v115, v43
    v_add_f32 v60, v116, v44
    v_add_f32 v61, v117, v45
    v_add_f32 v62, v118, v46
    v_add_f32 v63, v119, v47
    ds_read_b128 v[32:35], v121 offset:0
    ds_read_b128 v[36:39], v121 offset:16
    ds_read_b128 v[40:43], v121 offset:288
    ds_read_b128 v[44:47], v121 offset:304
    v_add_u32 v121, 576, v121
    v_exp_f32 v48, v48
    v_exp_f32 v49, v49
    v_exp_f32 v50, v50
    v_exp_f32 v51, v51
    v_exp_f32 v52, v52
    v_exp_f32 v53, v53
    v_exp_f32 v54, v54
    v_exp_f32 v55, v55
    v_add_f32 v48, 1.0, v48
    v_add_f32 v49, 1.0, v49
    v_add_f32 v50, 1.0, v50
    v_add_f32 v51, 1.0, v51
    v_add_f32 v52, 1.0, v52
    v_add_f32 v53, 1.0, v53
    v_add_f32 v54, 1.0, v54
    v_add_f32 v55, 1.0, v55
    v_rcp_f32 v48, v48
    v_rcp_f32 v49, v49
    v_rcp_f32 v50, v50
    v_rcp_f32 v51, v51
    v_rcp_f32 v52, v52
    v_rcp_f32 v53, v53
    v_rcp_f32 v54, v54
    v_rcp_f32 v55, v55
    v_fma_f32 v48, v48, -2.0, 1.0
    v_fma_f32 v49, v49, -2.0, 1.0
    v_fma_f32 v50, v50, -2.0, 1.0
    v_fma_f32 v51, v51, -2.0, 1.0
    v_fma_f32 v52, v52, -2.0, 1.0
    v_fma_f32 v53, v53, -2.0, 1.0
    v_fma_f32 v54, v54, -2.0, 1.0
    v_fma_f32 v55, v55, -2.0, 1.0
    v_cvt_pk_bf16_f32 v64, v48, v49
    v_cvt_pk_bf16_f32 v65, v50, v51
    v_cvt_pk_bf16_f32 v66, v52, v53
    v_cvt_pk_bf16_f32 v67, v54, v55
    ds_write_b128 v123, v[64:67] offset:16384
    v_exp_f32 v56, v56
    v_exp_f32 v57, v57
    v_exp_f32 v58, v58
    v_exp_f32 v59, v59
    v_exp_f32 v60, v60
    v_exp_f32 v61, v61
    v_exp_f32 v62, v62
    v_exp_f32 v63, v63
    v_add_f32 v56, 1.0, v56
    v_add_f32 v57, 1.0, v57
    v_add_f32 v58, 1.0, v58
    v_add_f32 v59, 1.0, v59
    v_add_f32 v60, 1.0, v60
    v_add_f32 v61, 1.0, v61
    v_add_f32 v62, 1.0, v62
    v_add_f32 v63, 1.0, v63
    v_rcp_f32 v56, v56
    v_rcp_f32 v57, v57
    v_rcp_f32 v58, v58
    v_rcp_f32 v59, v59
    v_rcp_f32 v60, v60
    v_rcp_f32 v61, v61
    v_rcp_f32 v62, v62
    v_rcp_f32 v63, v63
    v_fma_f32 v56, v56, -2.0, 1.0
    v_fma_f32 v57, v57, -2.0, 1.0
    v_fma_f32 v58, v58, -2.0, 1.0
    v_fma_f32 v59, v59, -2.0, 1.0
    v_fma_f32 v60, v60, -2.0, 1.0
    v_fma_f32 v61, v61, -2.0, 1.0
    v_fma_f32 v62, v62, -2.0, 1.0
    v_fma_f32 v63, v63, -2.0, 1.0
    v_cvt_pk_bf16_f32 v68, v56, v57
    v_cvt_pk_bf16_f32 v69, v58, v59
    v_cvt_pk_bf16_f32 v70, v60, v61
    v_cvt_pk_bf16_f32 v71, v62, v63
    ds_write_b128 v123, v[68:71] offset:17408
    s_waitcnt lgkmcnt(0)
    s_barrier
    s_sub_u32 s22, s22, 1
    s_cmp_lg_u32 s22, 0
    s_cbranch_scc1 L_joint_kernel_tloop0
L_joint_kernel_fin:
L_joint_kernel_done:
    s_endpgm
.section .rodata,"a"
.p2align 6
.amdhsa_kernel prep_kernel
  .amdhsa_next_free_vgpr 128
  .amdhsa_next_free_sgpr 102
  .amdhsa_accum_offset 128
  .amdhsa_group_segment_fixed_size 0
  .amdhsa_kernarg_size 80
  .amdhsa_user_sgpr_count 2
  .amdhsa_user_sgpr_kernarg_segment_ptr 1
  .amdhsa_system_sgpr_workgroup_id_x 1
.end_amdhsa_kernel
.p2align 6
.amdhsa_kernel conv1_kernel
  .amdhsa_next_free_vgpr 128
  .amdhsa_next_free_sgpr 102
  .amdhsa_accum_offset 128
  .amdhsa_group_segment_fixed_size 0
  .amdhsa_kernarg_size 80
  .amdhsa_user_sgpr_count 2
  .amdhsa_user_sgpr_kernarg_segment_ptr 1
  .amdhsa_system_sgpr_workgroup_id_x 1
.end_amdhsa_kernel
.p2align 6
.amdhsa_kernel conv2_kernel
  .amdhsa_next_free_vgpr 128
  .amdhsa_next_free_sgpr 102
  .amdhsa_accum_offset 128
  .amdhsa_group_segment_fixed_size 0
  .amdhsa_kernarg_size 80
  .amdhsa_user_sgpr_count 2
  .amdhsa_user_sgpr_kernarg_segment_ptr 1
  .amdhsa_system_sgpr_workgroup_id_x 1
.end_amdhsa_kernel
.p2align 6
.amdhsa_kernel joint_kernel
  .amdhsa_next_free_vgpr 128
  .amdhsa_next_free_sgpr 102
  .amdhsa_accum_offset 128
  .amdhsa_group_segment_fixed_size 0
  .amdhsa_kernarg_size 80
  .amdhsa_user_sgpr_count 2
  .amdhsa_user_sgpr_kernarg_segment_ptr 1
  .amdhsa_system_sgpr_workgroup_id_x 1
.end_amdhsa_kernel
```

```asm
; @launch kernel=prep_kernel grid=(268,1,1) block=(256,1,1) lds=4096
; @launch kernel=conv1_kernel grid=(256,1,1) block=(1024,1,1) lds=162816
; @launch kernel=conv2_kernel grid=(256,1,1) block=(1024,1,1) lds=162816
; @launch kernel=joint_kernel grid=(250,1,1) block=(1024,1,1) lds=99472
.amdgcn_target "amdgcn-amd-amdhsa--gfx950"
.text
.globl prep_kernel
.p2align 8
.type prep_kernel,@function
prep_kernel:
    s_cmp_ge_u32 s2, 268
    s_cbranch_scc1 L_prep_kernel_done
    s_mov_b32 s3, s2
    s_load_dwordx16 s[44:59], s[0:1], 0
    s_sub_u32 s2, s2, 12
    v_readfirstlane_b32 s40, v0
    s_lshr_b32 s40, s40, 6
    s_lshl_b32 s21, s2, 2
    s_add_u32 s20, s40, s21
    v_and_b32 v1, 63, v0
    s_load_dwordx2 s[8:9], s[0:1], 8
    s_load_dwordx2 s[30:31], s[0:1], 72
    s_lshr_b32 s22, s20, 8
    s_bfe_u32 s23, s20, 0x40004
    s_bfe_u32 s24, s20, 0x30001
    s_and_b32 s21, s20, 1
    v_lshrrev_b32 v2, 4, v1
    v_lshlrev_b32 v2, 12, v2
    v_and_b32 v3, 15, v1
    v_lshl_add_u32 v2, v3, 2, v2
    s_lshl_b32 s26, s22, 3
    s_lshr_b32 s27, s23, 3
    s_add_u32 s26, s26, s27
    s_lshl_b32 s26, s26, 17
    s_and_b32 s27, s23, 7
    s_lshl_b32 s27, s27, 14
    s_add_u32 s26, s26, s27
    s_lshl_b32 s27, s24, 6
    s_add_u32 s26, s26, s27
    s_mov_b32 s10, 4063232
    s_mov_b32 s11, 0x00020000
    s_lshr_b32 s41, s3, 2
    s_and_b32 s42, s3, 3
    s_lshl_b32 s42, s42, 1
    s_and_b32 s43, s40, 1
    s_add_u32 s42, s42, s43
    s_lshr_b32 s43, s40, 1
    s_lshl_b32 s4, s43, 16
    s_lshl_b32 s5, s42, 6
    s_add_u32 s4, s4, s5
    s_cmp_lt_u32 s3, 12
    s_cselect_b32 s26, s4, s26
    s_cselect_b32 s10, 131072, s10
    s_mov_b32 s5, 262144
    s_cselect_b32 s5, 16384, s5
    s_add_u32 s37, s26, s5
    s_add_u32 s38, s37, s5
    s_add_u32 s39, s38, s5
    s_waitcnt lgkmcnt(0)
    s_cmp_eq_u32 s41, 0
    s_cselect_b32 s8, s52, s8
    s_cselect_b32 s9, s53, s9
    s_cmp_eq_u32 s41, 1
    s_cselect_b32 s8, s56, s8
    s_cselect_b32 s9, s57, s9
    s_cmp_eq_u32 s41, 2
    s_cselect_b32 s8, s54, s8
    s_cselect_b32 s9, s55, s9
    buffer_load_dword v16, v2, s[8:11], s26 offen offset:0
    buffer_load_dword v17, v2, s[8:11], s26 offen offset:512
    buffer_load_dword v24, v2, s[8:11], s37 offen offset:0
    buffer_load_dword v25, v2, s[8:11], s37 offen offset:512
    buffer_load_dword v32, v2, s[8:11], s38 offen offset:0
    buffer_load_dword v33, v2, s[8:11], s38 offen offset:512
    buffer_load_dword v40, v2, s[8:11], s39 offen offset:0
    buffer_load_dword v41, v2, s[8:11], s39 offen offset:512
    buffer_load_dword v18, v2, s[8:11], s26 offen offset:1024
    buffer_load_dword v19, v2, s[8:11], s26 offen offset:1536
    buffer_load_dword v26, v2, s[8:11], s37 offen offset:1024
    buffer_load_dword v27, v2, s[8:11], s37 offen offset:1536
    buffer_load_dword v34, v2, s[8:11], s38 offen offset:1024
    buffer_load_dword v35, v2, s[8:11], s38 offen offset:1536
    buffer_load_dword v42, v2, s[8:11], s39 offen offset:1024
    buffer_load_dword v43, v2, s[8:11], s39 offen offset:1536
    buffer_load_dword v20, v2, s[8:11], s26 offen offset:2048
    buffer_load_dword v21, v2, s[8:11], s26 offen offset:2560
    buffer_load_dword v28, v2, s[8:11], s37 offen offset:2048
    buffer_load_dword v29, v2, s[8:11], s37 offen offset:2560
    buffer_load_dword v36, v2, s[8:11], s38 offen offset:2048
    buffer_load_dword v37, v2, s[8:11], s38 offen offset:2560
    buffer_load_dword v44, v2, s[8:11], s39 offen offset:2048
    buffer_load_dword v45, v2, s[8:11], s39 offen offset:2560
    buffer_load_dword v22, v2, s[8:11], s26 offen offset:3072
    buffer_load_dword v23, v2, s[8:11], s26 offen offset:3584
    buffer_load_dword v30, v2, s[8:11], s37 offen offset:3072
    buffer_load_dword v31, v2, s[8:11], s37 offen offset:3584
    buffer_load_dword v38, v2, s[8:11], s38 offen offset:3072
    buffer_load_dword v39, v2, s[8:11], s38 offen offset:3584
    buffer_load_dword v46, v2, s[8:11], s39 offen offset:3072
    buffer_load_dword v47, v2, s[8:11], s39 offen offset:3584
    s_cmp_lt_u32 s3, 12
    s_cbranch_scc1 L_prep_kernel_small
    s_add_u32 s12, s30, 0
    s_addc_u32 s13, s31, 0
    s_mov_b32 s14, 7340032
    s_mov_b32 s15, 0x00020000
    v_lshlrev_b32 v4, 4, v1
    s_lshl_b32 s27, s24, 4
    s_add_u32 s27, s27, s23
    s_mul_i32 s27, s27, 57344
    s_lshl_b32 s28, s22, 11
    s_add_u32 s27, s27, s28
    s_lshl_b32 s28, s21, 10
    s_add_u32 s27, s27, s28
    s_cmp_eq_u32 s21, 0
    s_mov_b32 s32, 0x07060302
    s_cselect_b32 s32, 0x05040100, s32
    s_mov_b32 s33, 0x03020c0c
    s_cselect_b32 s33, 0x01000c0c, s33
    s_mov_b32 s35, 0x3d2aaaab
    s_mov_b32 s36, 0x3c638e39
    s_waitcnt vmcnt(24)
    v_perm_b32 v72, v17, v16, s32
    v_perm_b32 v48, v41, v40, s32
    v_perm_b32 v76, v76, v40, s33
    v_perm_b32 v84, v84, v41, s33
    v_perm_b32 v77, v77, v32, s33
    v_perm_b32 v85, v85, v33, s33
    v_perm_b32 v78, v78, v24, s33
    v_perm_b32 v86, v86, v25, s33
    v_perm_b32 v79, v79, v16, s33
    v_perm_b32 v87, v87, v17, s33
    v_add_f32 v80, v76, v78
    v_add_f32 v88, v84, v86
    v_add_f32 v81, v77, v79
    v_add_f32 v89, v85, v87
    v_fma_f32 v82, v78, 4.0, v76
    v_fma_f32 v90, v86, 4.0, v84
    v_fma_f32 v83, v79, 4.0, v77
    v_fma_f32 v91, v87, 4.0, v85
    v_add_f32 v77, v80, v81
    v_add_f32 v85, v88, v89
    v_sub_f32 v78, v80, v81
    v_sub_f32 v86, v88, v89
    v_fma_f32 v79, v83, 2.0, v82
    v_fma_f32 v87, v91, 2.0, v90
    v_fma_f32 v82, v83, -2.0, v82
    v_fma_f32 v90, v91, -2.0, v90
    v_fmamk_f32 v80, v76, 0x41700000, v82
    v_fmamk_f32 v88, v84, 0x41700000, v90
    v_fmamk_f32 v80, v81, 0x41200000, v80
    v_fmamk_f32 v88, v89, 0x41200000, v88
    v_mul_f32 v77, 0.5, v77
    v_mul_f32 v85, 0.5, v85
    v_mul_f32 v78, 0.5, v78
    v_mul_f32 v86, 0.5, v86
    v_mul_f32 v79, s35, v79
    v_mul_f32 v87, s35, v87
    v_mul_f32 v82, s35, v82
    v_mul_f32 v90, s35, v90
    v_mul_f32 v80, s36, v80
    v_mul_f32 v88, s36, v88
    v_cvt_pk_bf16_f32 v52, v77, v85
    v_cvt_pk_bf16_f32 v56, v78, v86
    v_cvt_pk_bf16_f32 v60, v79, v87
    v_cvt_pk_bf16_f32 v64, v82, v90
    v_cvt_pk_bf16_f32 v68, v80, v88
    s_waitcnt vmcnt(16)
    v_perm_b32 v73, v19, v18, s32
    v_perm_b32 v49, v43, v42, s32
    v_perm_b32 v76, v76, v42, s33
    v_perm_b32 v84, v84, v43, s33
    v_perm_b32 v77, v77, v34, s33
    v_perm_b32 v85, v85, v35, s33
    v_perm_b32 v78, v78, v26, s33
    v_perm_b32 v86, v86, v27, s33
    v_perm_b32 v79, v79, v18, s33
    v_perm_b32 v87, v87, v19, s33
    v_add_f32 v80, v76, v78
    v_add_f32 v88, v84, v86
    v_add_f32 v81, v77, v79
    v_add_f32 v89, v85, v87
    v_fma_f32 v82, v78, 4.0, v76
    v_fma_f32 v90, v86, 4.0, v84
    v_fma_f32 v83, v79, 4.0, v77
    v_fma_f32 v91, v87, 4.0, v85
    v_add_f32 v77, v80, v81
    v_add_f32 v85, v88, v89
    v_sub_f32 v78, v80, v81
    v_sub_f32 v86, v88, v89
    v_fma_f32 v79, v83, 2.0, v82
    v_fma_f32 v87, v91, 2.0, v90
    v_fma_f32 v82, v83, -2.0, v82
    v_fma_f32 v90, v91, -2.0, v90
    v_fmamk_f32 v80, v76, 0x41700000, v82
    v_fmamk_f32 v88, v84, 0x41700000, v90
    v_fmamk_f32 v80, v81, 0x41200000, v80
    v_fmamk_f32 v88, v89, 0x41200000, v88
    v_mul_f32 v77, 0.5, v77
    v_mul_f32 v85, 0.5, v85
    v_mul_f32 v78, 0.5, v78
    v_mul_f32 v86, 0.5, v86
    v_mul_f32 v79, s35, v79
    v_mul_f32 v87, s35, v87
    v_mul_f32 v82, s35, v82
    v_mul_f32 v90, s35, v90
    v_mul_f32 v80, s36, v80
    v_mul_f32 v88, s36, v88
    v_cvt_pk_bf16_f32 v53, v77, v85
    v_cvt_pk_bf16_f32 v57, v78, v86
    v_cvt_pk_bf16_f32 v61, v79, v87
    v_cvt_pk_bf16_f32 v65, v82, v90
    v_cvt_pk_bf16_f32 v69, v80, v88
    s_waitcnt vmcnt(8)
    v_perm_b32 v74, v21, v20, s32
    v_perm_b32 v50, v45, v44, s32
    v_perm_b32 v76, v76, v44, s33
    v_perm_b32 v84, v84, v45, s33
    v_perm_b32 v77, v77, v36, s33
    v_perm_b32 v85, v85, v37, s33
    v_perm_b32 v78, v78, v28, s33
    v_perm_b32 v86, v86, v29, s33
    v_perm_b32 v79, v79, v20, s33
    v_perm_b32 v87, v87, v21, s33
    v_add_f32 v80, v76, v78
    v_add_f32 v88, v84, v86
    v_add_f32 v81, v77, v79
    v_add_f32 v89, v85, v87
    v_fma_f32 v82, v78, 4.0, v76
    v_fma_f32 v90, v86, 4.0, v84
    v_fma_f32 v83, v79, 4.0, v77
    v_fma_f32 v91, v87, 4.0, v85
    v_add_f32 v77, v80, v81
    v_add_f32 v85, v88, v89
    v_sub_f32 v78, v80, v81
    v_sub_f32 v86, v88, v89
    v_fma_f32 v79, v83, 2.0, v82
    v_fma_f32 v87, v91, 2.0, v90
    v_fma_f32 v82, v83, -2.0, v82
    v_fma_f32 v90, v91, -2.0, v90
    v_fmamk_f32 v80, v76, 0x41700000, v82
    v_fmamk_f32 v88, v84, 0x41700000, v90
    v_fmamk_f32 v80, v81, 0x41200000, v80
    v_fmamk_f32 v88, v89, 0x41200000, v88
    v_mul_f32 v77, 0.5, v77
    v_mul_f32 v85, 0.5, v85
    v_mul_f32 v78, 0.5, v78
    v_mul_f32 v86, 0.5, v86
    v_mul_f32 v79, s35, v79
    v_mul_f32 v87, s35, v87
    v_mul_f32 v82, s35, v82
    v_mul_f32 v90, s35, v90
    v_mul_f32 v80, s36, v80
    v_mul_f32 v88, s36, v88
    v_cvt_pk_bf16_f32 v54, v77, v85
    v_cvt_pk_bf16_f32 v58, v78, v86
    v_cvt_pk_bf16_f32 v62, v79, v87
    v_cvt_pk_bf16_f32 v66, v82, v90
    v_cvt_pk_bf16_f32 v70, v80, v88
    s_waitcnt vmcnt(0)
    s_cmp_ge_u32 s3, 44
    s_cbranch_scc1 L_prep_kernel_ncw
    s_getpc_b64 s[62:63]
L_prep_kernel_pc:
    s_and_b32 s64, s3, 8
    s_lshl_b32 s64, s64, 12
    v_lshlrev_b32 v120, 7, v0
    v_add_u32 v120, s64, v120
    v_min_u32 v120, L_joint_kernel_done-L_prep_kernel_pc, v120
    v_mov_b32 v121, s63
    v_add_co_u32 v120, vcc, s62, v120
    v_addc_co_u32 v121, vcc, 0, v121, vcc
    global_load_dword v122, v[120:121], off
L_prep_kernel_ncw:
    v_perm_b32 v75, v23, v22, s32
    v_perm_b32 v51, v47, v46, s32
    v_perm_b32 v76, v76, v46, s33
    v_perm_b32 v84, v84, v47, s33
    v_perm_b32 v77, v77, v38, s33
    v_perm_b32 v85, v85, v39, s33
    v_perm_b32 v78, v78, v30, s33
    v_perm_b32 v86, v86, v31, s33
    v_perm_b32 v79, v79, v22, s33
    v_perm_b32 v87, v87, v23, s33
    v_add_f32 v80, v76, v78
    v_add_f32 v88, v84, v86
    v_add_f32 v81, v77, v79
    v_add_f32 v89, v85, v87
    v_fma_f32 v82, v78, 4.0, v76
    v_fma_f32 v90, v86, 4.0, v84
    v_fma_f32 v83, v79, 4.0, v77
    v_fma_f32 v91, v87, 4.0, v85
    v_add_f32 v77, v80, v81
    v_add_f32 v85, v88, v89
    v_sub_f32 v78, v80, v81
    v_sub_f32 v86, v88, v89
    v_fma_f32 v79, v83, 2.0, v82
    v_fma_f32 v87, v91, 2.0, v90
    v_fma_f32 v82, v83, -2.0, v82
    v_fma_f32 v90, v91, -2.0, v90
    v_fmamk_f32 v80, v76, 0x41700000, v82
    v_fmamk_f32 v88, v84, 0x41700000, v90
    v_fmamk_f32 v80, v81, 0x41200000, v80
    v_fmamk_f32 v88, v89, 0x41200000, v88
    v_mul_f32 v77, 0.5, v77
    v_mul_f32 v85, 0.5, v85
    v_mul_f32 v78, 0.5, v78
    v_mul_f32 v86, 0.5, v86
    v_mul_f32 v79, s35, v79
    v_mul_f32 v87, s35, v87
    v_mul_f32 v82, s35, v82
    v_mul_f32 v90, s35, v90
    v_mul_f32 v80, s36, v80
    v_mul_f32 v88, s36, v88
    v_cvt_pk_bf16_f32 v55, v77, v85
    v_cvt_pk_bf16_f32 v59, v78, v86
    v_cvt_pk_bf16_f32 v63, v79, v87
    v_cvt_pk_bf16_f32 v67, v82, v90
    v_cvt_pk_bf16_f32 v71, v80, v88
    s_add_u32 s28, s27, 49152
    buffer_store_dwordx4 v[72:75], v4, s[12:15], s28 offen sc1
    s_add_u32 s28, s27, 0
    buffer_store_dwordx4 v[48:51], v4, s[12:15], s28 offen sc1
    s_add_u32 s28, s27, 8192
    buffer_store_dwordx4 v[52:55], v4, s[12:15], s28 offen sc1
    s_add_u32 s28, s27, 16384
    buffer_store_dwordx4 v[56:59], v4, s[12:15], s28 offen sc1
    s_add_u32 s28, s27, 24576
    buffer_store_dwordx4 v[60:63], v4, s[12:15], s28 offen sc1
    s_add_u32 s28, s27, 32768
    buffer_store_dwordx4 v[64:67], v4, s[12:15], s28 offen sc1
    s_add_u32 s28, s27, 40960
    buffer_store_dwordx4 v[68:71], v4, s[12:15], s28 offen sc1
L_prep_kernel_done:
    s_endpgm
L_prep_kernel_small:
    s_mov_b32 s16, s50
    s_mov_b32 s17, s51
    s_mov_b32 s18, 8192
    s_mov_b32 s19, 0x00020000
    v_lshrrev_b32 v2, 4, v1
    v_lshlrev_b32 v6, 9, v3
    v_lshl_add_u32 v6, v2, 4, v6
    s_lshl_b32 s24, s43, 8
    s_cmp_eq_u32 s41, 2
    s_cselect_b32 s24, s24, 0x100000
    buffer_load_dwordx4 v[80:83], v6, s[16:19], s24 offen offset:0
    buffer_load_dwordx4 v[84:87], v6, s[16:19], s24 offen offset:64
    buffer_load_dwordx4 v[88:91], v6, s[16:19], s24 offen offset:128
    buffer_load_dwordx4 v[92:95], v6, s[16:19], s24 offen offset:192
    s_lshl_b32 s24, s41, 17
    s_add_u32 s24, s24, 44040192
    s_add_u32 s12, s30, s24
    s_addc_u32 s13, s31, 0
    s_mov_b32 s14, 131072
    s_mov_b32 s15, 0x00020000
    s_mov_b32 s32, 0x05040100
    s_mov_b32 s33, 0x07060302
    v_lshlrev_b32 v4, 4, v1
    s_lshl_b32 s24, s42, 14
    s_lshl_b32 s25, s43, 13
    s_add_u32 s24, s24, s25
    s_add_u32 s25, s24, 4096
    s_waitcnt vmcnt(4)
    v_perm_b32 v48, v17, v16, s32
    v_perm_b32 v49, v19, v18, s32
    v_perm_b32 v50, v21, v20, s32
    v_perm_b32 v51, v23, v22, s32
    v_perm_b32 v52, v17, v16, s33
    v_perm_b32 v53, v19, v18, s33
    v_perm_b32 v54, v21, v20, s33
    v_perm_b32 v55, v23, v22, s33
    v_perm_b32 v56, v25, v24, s32
    v_perm_b32 v57, v27, v26, s32
    v_perm_b32 v58, v29, v28, s32
    v_perm_b32 v59, v31, v30, s32
    v_perm_b32 v60, v25, v24, s33
    v_perm_b32 v61, v27, v26, s33
    v_perm_b32 v62, v29, v28, s33
    v_perm_b32 v63, v31, v30, s33
    v_perm_b32 v64, v33, v32, s32
    v_perm_b32 v65, v35, v34, s32
    v_perm_b32 v66, v37, v36, s32
    v_perm_b32 v67, v39, v38, s32
    v_perm_b32 v68, v33, v32, s33
    v_perm_b32 v69, v35, v34, s33
    v_perm_b32 v70, v37, v36, s33
    v_perm_b32 v71, v39, v38, s33
    v_perm_b32 v72, v41, v40, s32
    v_perm_b32 v73, v43, v42, s32
    v_perm_b32 v74, v45, v44, s32
    v_perm_b32 v75, v47, v46, s32
    v_perm_b32 v76, v41, v40, s33
    v_perm_b32 v77, v43, v42, s33
    v_perm_b32 v78, v45, v44, s33
    v_perm_b32 v79, v47, v46, s33
    s_cmp_eq_u32 s41, 2
    s_cbranch_scc1 L_prep_kernel_ge
    buffer_store_dwordx4 v[48:51], v4, s[12:15], s24 offen offset:0 sc1
    buffer_store_dwordx4 v[52:55], v4, s[12:15], s24 offen offset:1024 sc1
    buffer_store_dwordx4 v[56:59], v4, s[12:15], s24 offen offset:2048 sc1
    buffer_store_dwordx4 v[60:63], v4, s[12:15], s24 offen offset:3072 sc1
    buffer_store_dwordx4 v[64:67], v4, s[12:15], s25 offen offset:0 sc1
    buffer_store_dwordx4 v[68:71], v4, s[12:15], s25 offen offset:1024 sc1
    buffer_store_dwordx4 v[72:75], v4, s[12:15], s25 offen offset:2048 sc1
    buffer_store_dwordx4 v[76:79], v4, s[12:15], s25 offen offset:3072 sc1
    s_endpgm
L_prep_kernel_ge:
    s_waitcnt vmcnt(0)
    v_mfma_f32_16x16x32_bf16 v[96:99], v[48:51], v[80:83], 0
    v_mfma_f32_16x16x32_bf16 v[100:103], v[52:55], v[80:83], 0
    v_mfma_f32_16x16x32_bf16 v[96:99], v[56:59], v[84:87], v[96:99]
    v_mfma_f32_16x16x32_bf16 v[100:103], v[60:63], v[84:87], v[100:103]
    v_mfma_f32_16x16x32_bf16 v[96:99], v[64:67], v[88:91], v[96:99]
    v_mfma_f32_16x16x32_bf16 v[100:103], v[68:71], v[88:91], v[100:103]
    v_mfma_f32_16x16x32_bf16 v[96:99], v[72:75], v[92:95], v[96:99]
    v_mfma_f32_16x16x32_bf16 v[100:103], v[76:79], v[92:95], v[100:103]
    s_and_b32 s24, s40, 1
    s_lshl_b32 s24, s24, 11
    v_add_u32 v7, s24, v4
    s_mov_b32 s14, 16384
    v_lshlrev_b32 v8, 10, v3
    v_lshl_add_u32 v8, v2, 5, v8
    s_lshl_b32 s24, s42, 7
    s_mov_b32 s34, 0xffff0000
    s_mov_b32 s35, 0x4038aa3b
    s_cmp_eq_u32 s43, 0
    s_cbranch_scc1 L_prep_kernel_ge0
    ds_write_b128 v7, v[96:99]
    ds_write_b128 v7, v[100:103] offset:1024
    s_waitcnt lgkmcnt(0)
    s_barrier
    s_endpgm
L_prep_kernel_ge0:
    s_barrier
    ds_read_b128 v[16:19], v7
    ds_read_b128 v[20:23], v7 offset:1024
    s_waitcnt lgkmcnt(0)
    v_add_f32 v16, v16, v96
    v_add_f32 v17, v17, v97
    v_add_f32 v18, v18, v98
    v_add_f32 v19, v19, v99
    v_add_f32 v20, v20, v100
    v_add_f32 v21, v21, v101
    v_add_f32 v22, v22, v102
    v_add_f32 v23, v23, v103
    v_cvt_pk_bf16_f32 v48, v16, v20
    v_cvt_pk_bf16_f32 v49, v17, v21
    v_cvt_pk_bf16_f32 v50, v18, v22
    v_cvt_pk_bf16_f32 v51, v19, v23
    v_lshlrev_b32 v56, 16, v48
    v_and_b32 v57, s34, v48
    v_lshlrev_b32 v58, 16, v49
    v_and_b32 v59, s34, v49
    v_lshlrev_b32 v60, 16, v50
    v_and_b32 v61, s34, v50
    v_lshlrev_b32 v62, 16, v51
    v_and_b32 v63, s34, v51
    v_mul_f32 v56, s35, v56
    v_mul_f32 v57, s35, v57
    v_mul_f32 v58, s35, v58
    v_mul_f32 v59, s35, v59
    v_mul_f32 v60, s35, v60
    v_mul_f32 v61, s35, v61
    v_mul_f32 v62, s35, v62
    v_mul_f32 v63, s35, v63
    buffer_store_dwordx4 v[56:59], v8, s[12:15], s24 offen sc1
    buffer_store_dwordx4 v[60:63], v8, s[12:15], s24 offen offset:16 sc1
    v_exp_f32 v64, v56
    v_exp_f32 v65, v57
    v_exp_f32 v66, v58
    v_exp_f32 v67, v59
    v_exp_f32 v68, v60
    v_exp_f32 v69, v61
    v_exp_f32 v70, v62
    v_exp_f32 v71, v63
    v_max3_f32 v72, |v56|, |v57|, |v58|
    v_max3_f32 v72, |v59|, |v60|, v72
    v_max3_f32 v72, |v61|, |v62|, v72
    v_max_f32 v72, |v63|, v72
    s_add_u32 s12, s12, 16384
    s_addc_u32 s13, s13, 0
    v_cmp_lt_f32 vcc, 0x42f00000, v72
    buffer_store_dwordx4 v[64:67], v8, s[12:15], s24 offen sc1
    buffer_store_dwordx4 v[68:71], v8, s[12:15], s24 offen offset:16 sc1
    s_add_u32 s12, s12, 16384
    s_addc_u32 s13, s13, 0
    s_or_b32 s26, vcc_lo, vcc_hi
    s_lshl_b32 s24, s42, 2
    v_mov_b32 v73, s26
    v_mov_b32 v74, 0
    buffer_store_dword v73, v74, s[12:15], s24 offen sc1
    s_endpgm
.globl conv1_kernel
.p2align 8
.type conv1_kernel,@function
conv1_kernel:
    s_cmp_ge_u32 s2, 256
    s_cbranch_scc1 L_conv1_kernel_done
    s_load_dwordx2 s[4:5], s[0:1], 0
    s_load_dwordx2 s[30:31], s[0:1], 72
    v_readfirstlane_b32 s20, v0
    s_lshr_b32 s20, s20, 6
    s_and_b32 s36, s2, 0
    s_lshl_b32 s36, s36, 3
    s_bfe_u32 s37, s2, 196611
    s_or_b32 s29, s36, s37
    s_bfe_u32 s36, s2, 196608
    s_lshl_b32 s36, s36, 2
    s_lshr_b32 s37, s2, 6
    s_or_b32 s36, s36, s37
    s_mov_b32 s33, 0
    s_and_b32 s34, s36, 15
    s_lshr_b32 s35, s36, 4
    s_mul_i32 s21, s34, 500
    s_and_b32 s32, s20, 3
    v_and_b32 v127, 63, v0
    v_lshrrev_b32 v5, 2, v127
    v_and_b32 v6, 3, v127
    s_and_b32 s42, s20, 7
    v_lshlrev_b32 v7, 15, v5
    v_lshl_add_u32 v7, v6, 4, v7
    s_lshl_b32 s41, s21, 10
    s_sub_u32 s41, s41, 7680
    s_lshl_b32 s37, s42, 12
    s_add_u32 s37, s37, s41
    v_add_u32 v7, s37, v7
    s_mul_i32 s36, s35, 8192000
    s_mov_b32 s10, 8192000
    s_mov_b32 s11, 0x00020000
    s_mov_b32 s25, 0xffff0000
    s_waitcnt lgkmcnt(0)
    s_add_u32 s8, s4, s36
    s_addc_u32 s9, s5, 0
    s_cmp_ge_u32 s20, 8
    s_cbranch_scc1 L_conv1_kernel_helper
    s_add_u32 s37, s41, 524288
    v_lshl_add_u32 v108, v127, 4, s37
    v_add_u32 v109, 1024, v108
    v_add_u32 v110, 2048, v108
    s_lshl_b32 s36, s29, 4
    s_lshl_b32 s37, s33, 3
    s_add_u32 s36, s36, s37
    s_mul_i32 s36, s36, 57344
    s_add_u32 s36, s36, 0
    s_add_u32 s12, s30, s36
    s_addc_u32 s13, s31, 0
    s_mov_b32 s14, 917504
    s_mov_b32 s15, 0x00020000
    s_mul_i32 s36, s35, 4194304
    s_add_u32 s36, s36, 18874368
    s_add_u32 s16, s30, s36
    s_addc_u32 s17, s31, 0
    s_mov_b32 s18, 4194304
    s_mov_b32 s19, 0x00020000
    v_and_b32 v10, 15, v127
    v_lshrrev_b32 v11, 4, v127
    v_add_u32 v8, 0, v10
    v_and_b32 v16, 4, v8
    v_lshrrev_b32 v16, 1, v16
    v_xor_b32 v16, v11, v16
    v_lshlrev_b32 v16, 4, v16
    v_lshl_add_u32 v8, v8, 6, v16
    v_add_u32 v9, 1, v10
    v_and_b32 v16, 4, v9
    v_lshrrev_b32 v16, 1, v16
    v_xor_b32 v16, v11, v16
    v_lshlrev_b32 v16, 4, v16
    v_lshl_add_u32 v9, v9, 6, v16
    s_lshr_b32 s38, s32, 1
    s_and_b32 s39, s32, 1
    s_add_u32 s40, s38, 4
    s_lshl_b32 s43, s39, 10
    s_cmp_lt_u32 s20, 4
    s_cselect_b32 s40, s20, s40
    s_cselect_b32 s36, 0, s43
    s_lshl_b32 s37, s40, 13
    s_add_u32 s37, s37, s36
    v_lshl_add_u32 v125, v127, 4, s37
    s_mul_i32 s37, s40, 16384
    v_add_u32 v120, s37, v8
    v_add_u32 v121, s37, v9
    s_lshl_b32 s37, s40, 10
    s_add_u32 s37, s37, 115712
    v_lshl_add_u32 v16, v11, 4, s37
    v_cmp_eq_u32 vcc, 15, v10
    v_mov_b32 v17, 8192
    v_mov_b32 v18, 4294959104
    v_mov_b32 v19, 64
    v_cndmask_b32 v122, v121, v16, vcc
    v_cndmask_b32 v123, v17, v19, vcc
    v_cndmask_b32 v124, v18, v19, vcc
    v_lshl_add_u32 v126, v127, 4, s37
    s_mov_b32 s44, 0x3f800000
    s_mov_b32 s45, 0x00000000
    s_mov_b32 s46, 0x00000000
    s_cmp_eq_u32 s40, 1
    s_cselect_b32 s45, 0x3f800000, s45
    s_cselect_b32 s46, 0x3f800000, s46
    s_cmp_eq_u32 s40, 2
    s_cselect_b32 s45, 0xbf800000, s45
    s_cselect_b32 s46, 0x3f800000, s46
    s_cmp_eq_u32 s40, 3
    s_cselect_b32 s45, 0x40000000, s45
    s_cselect_b32 s46, 0x40800000, s46
    s_cmp_eq_u32 s40, 4
    s_cselect_b32 s45, 0xc0000000, s45
    s_cselect_b32 s46, 0x40800000, s46
    s_cmp_eq_u32 s40, 5
    s_cselect_b32 s44, 0x41800000, s44
    s_cselect_b32 s45, 0x41000000, s45
    s_cselect_b32 s46, 0x40800000, s46
    s_cmp_ge_u32 s20, 4
    s_cbranch_scc1 L_conv1_kernel_m2
    v_mov_b32 v0, 0
    v_mov_b32 v1, 0
    v_mov_b32 v2, 0
    v_mov_b32 v3, 0
    v_mov_b32 v4, 0
    v_mov_b32 v5, 0
    v_mov_b32 v6, 0
    v_mov_b32 v7, 0
    v_mov_b32 v8, 0
    v_mov_b32 v9, 0
    v_mov_b32 v10, 0
    v_mov_b32 v11, 0
    v_mov_b32 v12, 0
    v_mov_b32 v13, 0
    v_mov_b32 v14, 0
    v_mov_b32 v15, 0
    v_mov_b32 v16, 0
    v_mov_b32 v17, 0
    v_mov_b32 v18, 0
    v_mov_b32 v19, 0
    v_mov_b32 v20, 0
    v_mov_b32 v21, 0
    v_mov_b32 v22, 0
    v_mov_b32 v23, 0
    v_mov_b32 v24, 0
    v_mov_b32 v25, 0
    v_mov_b32 v26, 0
    v_mov_b32 v27, 0
    v_mov_b32 v28, 0
    v_mov_b32 v29, 0
    v_mov_b32 v30, 0
    v_mov_b32 v31, 0
    v_mov_b32 v32, 0
    v_mov_b32 v33, 0
    v_mov_b32 v34, 0
    v_mov_b32 v35, 0
    v_mov_b32 v36, 0
    v_mov_b32 v37, 0
    v_mov_b32 v38, 0
    v_mov_b32 v39, 0
    v_mov_b32 v40, 0
    v_mov_b32 v41, 0
    v_mov_b32 v42, 0
    v_mov_b32 v43, 0
    v_mov_b32 v44, 0
    v_mov_b32 v45, 0
    v_mov_b32 v46, 0
    v_mov_b32 v47, 0
    v_mov_b32 v48, 0
    v_mov_b32 v49, 0
    v_mov_b32 v50, 0
    v_mov_b32 v51, 0
    v_mov_b32 v52, 0
    v_mov_b32 v53, 0
    v_mov_b32 v54, 0
    v_mov_b32 v55, 0
    v_mov_b32 v56, 0
    v_mov_b32 v57, 0
    v_mov_b32 v58, 0
    v_mov_b32 v59, 0
    v_mov_b32 v60, 0
    v_mov_b32 v61, 0
    v_mov_b32 v62, 0
    v_mov_b32 v63, 0
    s_barrier
    buffer_load_dwordx4 v[96:99], v108, s[8:11], 0 offen
    buffer_load_dwordx4 v[100:103], v109, s[8:11], 0 offen
    buffer_load_dwordx4 v[104:107], v110, s[8:11], 0 offen
    s_mov_b32 s23, 0
    s_mov_b32 s26, 4096
    buffer_load_dwordx4 v[64:67], v125, s[12:15], s23 offen offset:0
    buffer_load_dwordx4 v[68:71], v125, s[12:15], s23 offen offset:1024
    buffer_load_dwordx4 v[72:75], v125, s[12:15], s23 offen offset:2048
    buffer_load_dwordx4 v[76:79], v125, s[12:15], s23 offen offset:3072
    buffer_load_dwordx4 v[80:83], v125, s[12:15], s26 offen offset:0
    buffer_load_dwordx4 v[84:87], v125, s[12:15], s26 offen offset:1024
    buffer_load_dwordx4 v[88:91], v125, s[12:15], s26 offen offset:2048
    buffer_load_dwordx4 v[92:95], v125, s[12:15], s26 offen offset:3072
    s_mov_b32 s23, 57344
    s_mov_b32 s26, 61440
    s_waitcnt vmcnt(8)
    v_lshlrev_b32 v108, 16, v96
    v_and_b32 v111, s25, v96
    v_lshlrev_b32 v109, 16, v100
    v_and_b32 v112, s25, v100
    v_lshlrev_b32 v110, 16, v104
    v_and_b32 v113, s25, v104
    v_mul_f32 v114, s44, v108
    v_mul_f32 v115, s44, v111
    v_fmac_f32 v114, s45, v109
    v_fmac_f32 v115, s45, v112
    v_fmac_f32 v114, s46, v110
    v_fmac_f32 v115, s46, v113
    v_cvt_pk_bf16_f32 v96, v114, v115
    v_lshlrev_b32 v108, 16, v97
    v_and_b32 v111, s25, v97
    v_lshlrev_b32 v109, 16, v101
    v_and_b32 v112, s25, v101
    v_lshlrev_b32 v110, 16, v105
    v_and_b32 v113, s25, v105
    v_mul_f32 v114, s44, v108
    v_mul_f32 v115, s44, v111
    v_fmac_f32 v114, s45, v109
    v_fmac_f32 v115, s45, v112
    v_fmac_f32 v114, s46, v110
    v_fmac_f32 v115, s46, v113
    v_cvt_pk_bf16_f32 v97, v114, v115
    v_lshlrev_b32 v108, 16, v98
    v_and_b32 v111, s25, v98
    v_lshlrev_b32 v109, 16, v102
    v_and_b32 v112, s25, v102
    v_lshlrev_b32 v110, 16, v106
    v_and_b32 v113, s25, v106
    v_mul_f32 v114, s44, v108
    v_mul_f32 v115, s44, v111
    v_fmac_f32 v114, s45, v109
    v_fmac_f32 v115, s45, v112
    v_fmac_f32 v114, s46, v110
    v_fmac_f32 v115, s46, v113
    v_cvt_pk_bf16_f32 v98, v114, v115
    v_lshlrev_b32 v108, 16, v99
    v_and_b32 v111, s25, v99
    v_lshlrev_b32 v109, 16, v103
    v_and_b32 v112, s25, v103
    v_lshlrev_b32 v110, 16, v107
    v_and_b32 v113, s25, v107
    v_mul_f32 v114, s44, v108
    v_mul_f32 v115, s44, v111
    v_fmac_f32 v114, s45, v109
    v_fmac_f32 v115, s45, v112
    v_fmac_f32 v114, s46, v110
    v_fmac_f32 v115, s46, v113
    v_cvt_pk_bf16_f32 v99, v114, v115
    ds_write_b128 v126, v[96:99]
    s_waitcnt lgkmcnt(0)
    s_barrier
    s_mov_b32 s22, 8
    s_setprio 2
L_conv1_kernel_mloop1:
    ds_read_b128 v[96:99], v120 offset:0
    ds_read_b128 v[100:103], v120 offset:1024
    ds_read_b128 v[104:107], v120 offset:2048
    ds_read_b128 v[108:111], v120 offset:3072
    ds_read_b128 v[112:115], v120 offset:4096
    ds_read_b128 v[116:119], v120 offset:5120
    s_waitcnt vmcnt(6) lgkmcnt(5)
    v_mfma_f32_16x16x32_bf16 v[0:3], v[64:67], v[96:99], v[0:3]
    v_mfma_f32_16x16x32_bf16 v[32:35], v[68:71], v[96:99], v[32:35]
    ds_read_b128 v[96:99], v120 offset:6144
    s_waitcnt vmcnt(4) lgkmcnt(5)
    v_mfma_f32_16x16x32_bf16 v[4:7], v[64:67], v[100:103], v[4:7]
    v_mfma_f32_16x16x32_bf16 v[36:39], v[68:71], v[100:103], v[36:39]
    v_mfma_f32_16x16x32_bf16 v[0:3], v[72:75], v[100:103], v[0:3]
    v_mfma_f32_16x16x32_bf16 v[32:35], v[76:79], v[100:103], v[32:35]
    ds_read_b128 v[100:103], v120 offset:7168
    s_waitcnt vmcnt(2) lgkmcnt(5)
    v_mfma_f32_16x16x32_bf16 v[8:11], v[64:67], v[104:107], v[8:11]
    v_mfma_f32_16x16x32_bf16 v[40:43], v[68:71], v[104:107], v[40:43]
    v_mfma_f32_16x16x32_bf16 v[4:7], v[72:75], v[104:107], v[4:7]
    v_mfma_f32_16x16x32_bf16 v[36:39], v[76:79], v[104:107], v[36:39]
    v_mfma_f32_16x16x32_bf16 v[0:3], v[80:83], v[104:107], v[0:3]
    v_mfma_f32_16x16x32_bf16 v[32:35], v[84:87], v[104:107], v[32:35]
    ds_read_b128 v[104:107], v122 offset:0
    v_add_u32 v122, v123, v122
    s_waitcnt vmcnt(0) lgkmcnt(5)
    v_mfma_f32_16x16x32_bf16 v[12:15], v[64:67], v[108:111], v[12:15]
    v_mfma_f32_16x16x32_bf16 v[44:47], v[68:71], v[108:111], v[44:47]
    v_mfma_f32_16x16x32_bf16 v[8:11], v[72:75], v[108:111], v[8:11]
    v_mfma_f32_16x16x32_bf16 v[40:43], v[76:79], v[108:111], v[40:43]
    v_mfma_f32_16x16x32_bf16 v[4:7], v[80:83], v[108:111], v[4:7]
    v_mfma_f32_16x16x32_bf16 v[36:39], v[84:87], v[108:111], v[36:39]
    v_mfma_f32_16x16x32_bf16 v[0:3], v[88:91], v[108:111], v[0:3]
    v_mfma_f32_16x16x32_bf16 v[32:35], v[92:95], v[108:111], v[32:35]
    ds_read_b128 v[108:111], v121 offset:1024
    s_waitcnt lgkmcnt(5)
    v_mfma_f32_16x16x32_bf16 v[16:19], v[64:67], v[112:115], v[16:19]
    v_mfma_f32_16x16x32_bf16 v[48:51], v[68:71], v[112:115], v[48:51]
    v_mfma_f32_16x16x32_bf16 v[12:15], v[72:75], v[112:115], v[12:15]
    v_mfma_f32_16x16x32_bf16 v[44:47], v[76:79], v[112:115], v[44:47]
    v_mfma_f32_16x16x32_bf16 v[8:11], v[80:83], v[112:115], v[8:11]
    v_mfma_f32_16x16x32_bf16 v[40:43], v[84:87], v[112:115], v[40:43]
    v_mfma_f32_16x16x32_bf16 v[4:7], v[88:91], v[112:115], v[4:7]
    v_mfma_f32_16x16x32_bf16 v[36:39], v[92:95], v[112:115], v[36:39]
    ds_read_b128 v[112:115], v121 offset:2048
    s_waitcnt lgkmcnt(5)
    v_mfma_f32_16x16x32_bf16 v[20:23], v[64:67], v[116:119], v[20:23]
    v_mfma_f32_16x16x32_bf16 v[52:55], v[68:71], v[116:119], v[52:55]
    v_mfma_f32_16x16x32_bf16 v[16:19], v[72:75], v[116:119], v[16:19]
    v_mfma_f32_16x16x32_bf16 v[48:51], v[76:79], v[116:119], v[48:51]
    v_mfma_f32_16x16x32_bf16 v[12:15], v[80:83], v[116:119], v[12:15]
    v_mfma_f32_16x16x32_bf16 v[44:47], v[84:87], v[116:119], v[44:47]
    v_mfma_f32_16x16x32_bf16 v[8:11], v[88:91], v[116:119], v[8:11]
    v_mfma_f32_16x16x32_bf16 v[40:43], v[92:95], v[116:119], v[40:43]
    s_waitcnt lgkmcnt(4)
    v_mfma_f32_16x16x32_bf16 v[24:27], v[64:67], v[96:99], v[24:27]
    v_mfma_f32_16x16x32_bf16 v[56:59], v[68:71], v[96:99], v[56:59]
    v_mfma_f32_16x16x32_bf16 v[20:23], v[72:75], v[96:99], v[20:23]
    v_mfma_f32_16x16x32_bf16 v[52:55], v[76:79], v[96:99], v[52:55]
    v_mfma_f32_16x16x32_bf16 v[16:19], v[80:83], v[96:99], v[16:19]
    v_mfma_f32_16x16x32_bf16 v[48:51], v[84:87], v[96:99], v[48:51]
    v_mfma_f32_16x16x32_bf16 v[12:15], v[88:91], v[96:99], v[12:15]
    v_mfma_f32_16x16x32_bf16 v[44:47], v[92:95], v[96:99], v[44:47]
    s_waitcnt lgkmcnt(3)
    v_mfma_f32_16x16x32_bf16 v[28:31], v[64:67], v[100:103], v[28:31]
    v_mfma_f32_16x16x32_bf16 v[60:63], v[68:71], v[100:103], v[60:63]
    v_mfma_f32_16x16x32_bf16 v[24:27], v[72:75], v[100:103], v[24:27]
    v_mfma_f32_16x16x32_bf16 v[56:59], v[76:79], v[100:103], v[56:59]
    v_mfma_f32_16x16x32_bf16 v[20:23], v[80:83], v[100:103], v[20:23]
    v_mfma_f32_16x16x32_bf16 v[52:55], v[84:87], v[100:103], v[52:55]
    v_mfma_f32_16x16x32_bf16 v[16:19], v[88:91], v[100:103], v[16:19]
    v_mfma_f32_16x16x32_bf16 v[48:51], v[92:95], v[100:103], v[48:51]
    buffer_load_dwordx4 v[64:67], v125, s[12:15], s23 offen offset:0
    buffer_load_dwordx4 v[68:71], v125, s[12:15], s23 offen offset:1024
    s_waitcnt lgkmcnt(2)
    v_mfma_f32_16x16x32_bf16 v[28:31], v[72:75], v[104:107], v[28:31]
    v_mfma_f32_16x16x32_bf16 v[60:63], v[76:79], v[104:107], v[60:63]
    v_mfma_f32_16x16x32_bf16 v[24:27], v[80:83], v[104:107], v[24:27]
    v_mfma_f32_16x16x32_bf16 v[56:59], v[84:87], v[104:107], v[56:59]
    v_mfma_f32_16x16x32_bf16 v[20:23], v[88:91], v[104:107], v[20:23]
    v_mfma_f32_16x16x32_bf16 v[52:55], v[92:95], v[104:107], v[52:55]
    buffer_load_dwordx4 v[72:75], v125, s[12:15], s23 offen offset:2048
    buffer_load_dwordx4 v[76:79], v125, s[12:15], s23 offen offset:3072
    s_waitcnt lgkmcnt(1)
    v_mfma_f32_16x16x32_bf16 v[28:31], v[80:83], v[108:111], v[28:31]
    v_mfma_f32_16x16x32_bf16 v[60:63], v[84:87], v[108:111], v[60:63]
    v_mfma_f32_16x16x32_bf16 v[24:27], v[88:91], v[108:111], v[24:27]
    v_mfma_f32_16x16x32_bf16 v[56:59], v[92:95], v[108:111], v[56:59]
    buffer_load_dwordx4 v[80:83], v125, s[12:15], s26 offen offset:0
    buffer_load_dwordx4 v[84:87], v125, s[12:15], s26 offen offset:1024
    s_waitcnt lgkmcnt(0)
    v_mfma_f32_16x16x32_bf16 v[28:31], v[88:91], v[112:115], v[28:31]
    v_mfma_f32_16x16x32_bf16 v[60:63], v[92:95], v[112:115], v[60:63]
    buffer_load_dwordx4 v[88:91], v125, s[12:15], s26 offen offset:2048
    buffer_load_dwordx4 v[92:95], v125, s[12:15], s26 offen offset:3072
    s_add_u32 s23, s23, 57344
    s_add_u32 s26, s26, 57344
    s_barrier
    s_sub_u32 s22, s22, 1
    s_cmp_eq_u32 s22, 0
    s_cbranch_scc1 L_conv1_kernel_mlast1
    ds_read_b128 v[96:99], v120 offset:8192
    ds_read_b128 v[100:103], v120 offset:9216
    ds_read_b128 v[104:107], v120 offset:10240
    ds_read_b128 v[108:111], v120 offset:11264
    ds_read_b128 v[112:115], v120 offset:12288
    ds_read_b128 v[116:119], v120 offset:13312
    s_waitcnt vmcnt(6) lgkmcnt(5)
    v_mfma_f32_16x16x32_bf16 v[0:3], v[64:67], v[96:99], v[0:3]
    v_mfma_f32_16x16x32_bf16 v[32:35], v[68:71], v[96:99], v[32:35]
    ds_read_b128 v[96:99], v120 offset:14336
    s_waitcnt vmcnt(4) lgkmcnt(5)
    v_mfma_f32_16x16x32_bf16 v[4:7], v[64:67], v[100:103], v[4:7]
    v_mfma_f32_16x16x32_bf16 v[36:39], v[68:71], v[100:103], v[36:39]
    v_mfma_f32_16x16x32_bf16 v[0:3], v[72:75], v[100:103], v[0:3]
    v_mfma_f32_16x16x32_bf16 v[32:35], v[76:79], v[100:103], v[32:35]
    ds_read_b128 v[100:103], v120 offset:15360
    s_waitcnt vmcnt(2) lgkmcnt(5)
    v_mfma_f32_16x16x32_bf16 v[8:11], v[64:67], v[104:107], v[8:11]
    v_mfma_f32_16x16x32_bf16 v[40:43], v[68:71], v[104:107], v[40:43]
    v_mfma_f32_16x16x32_bf16 v[4:7], v[72:75], v[104:107], v[4:7]
    v_mfma_f32_16x16x32_bf16 v[36:39], v[76:79], v[104:107], v[36:39]
    v_mfma_f32_16x16x32_bf16 v[0:3], v[80:83], v[104:107], v[0:3]
    v_mfma_f32_16x16x32_bf16 v[32:35], v[84:87], v[104:107], v[32:35]
    ds_read_b128 v[104:107], v122 offset:0
    v_add_u32 v122, v124, v122
    s_waitcnt vmcnt(0) lgkmcnt(5)
    v_mfma_f32_16x16x32_bf16 v[12:15], v[64:67], v[108:111], v[12:15]
    v_mfma_f32_16x16x32_bf16 v[44:47], v[68:71], v[108:111], v[44:47]
    v_mfma_f32_16x16x32_bf16 v[8:11], v[72:75], v[108:111], v[8:11]
    v_mfma_f32_16x16x32_bf16 v[40:43], v[76:79], v[108:111], v[40:43]
    v_mfma_f32_16x16x32_bf16 v[4:7], v[80:83], v[108:111], v[4:7]
    v_mfma_f32_16x16x32_bf16 v[36:39], v[84:87], v[108:111], v[36:39]
    v_mfma_f32_16x16x32_bf16 v[0:3], v[88:91], v[108:111], v[0:3]
    v_mfma_f32_16x16x32_bf16 v[32:35], v[92:95], v[108:111], v[32:35]
    ds_read_b128 v[108:111], v121 offset:9216
    s_waitcnt lgkmcnt(5)
    v_mfma_f32_16x16x32_bf16 v[16:19], v[64:67], v[112:115], v[16:19]
    v_mfma_f32_16x16x32_bf16 v[48:51], v[68:71], v[112:115], v[48:51]
    v_mfma_f32_16x16x32_bf16 v[12:15], v[72:75], v[112:115], v[12:15]
    v_mfma_f32_16x16x32_bf16 v[44:47], v[76:79], v[112:115], v[44:47]
    v_mfma_f32_16x16x32_bf16 v[8:11], v[80:83], v[112:115], v[8:11]
    v_mfma_f32_16x16x32_bf16 v[40:43], v[84:87], v[112:115], v[40:43]
    v_mfma_f32_16x16x32_bf16 v[4:7], v[88:91], v[112:115], v[4:7]
    v_mfma_f32_16x16x32_bf16 v[36:39], v[92:95], v[112:115], v[36:39]
    ds_read_b128 v[112:115], v121 offset:10240
    s_waitcnt lgkmcnt(5)
    v_mfma_f32_16x16x32_bf16 v[20:23], v[64:67], v[116:119], v[20:23]
    v_mfma_f32_16x16x32_bf16 v[52:55], v[68:71], v[116:119], v[52:55]
    v_mfma_f32_16x16x32_bf16 v[16:19], v[72:75], v[116:119], v[16:19]
    v_mfma_f32_16x16x32_bf16 v[48:51], v[76:79], v[116:119], v[48:51]
    v_mfma_f32_16x16x32_bf16 v[12:15], v[80:83], v[116:119], v[12:15]
    v_mfma_f32_16x16x32_bf16 v[44:47], v[84:87], v[116:119], v[44:47]
    v_mfma_f32_16x16x32_bf16 v[8:11], v[88:91], v[116:119], v[8:11]
    v_mfma_f32_16x16x32_bf16 v[40:43], v[92:95], v[116:119], v[40:43]
    s_waitcnt lgkmcnt(4)
    v_mfma_f32_16x16x32_bf16 v[24:27], v[64:67], v[96:99], v[24:27]
    v_mfma_f32_16x16x32_bf16 v[56:59], v[68:71], v[96:99], v[56:59]
    v_mfma_f32_16x16x32_bf16 v[20:23], v[72:75], v[96:99], v[20:23]
    v_mfma_f32_16x16x32_bf16 v[52:55], v[76:79], v[96:99], v[52:55]
    v_mfma_f32_16x16x32_bf16 v[16:19], v[80:83], v[96:99], v[16:19]
    v_mfma_f32_16x16x32_bf16 v[48:51], v[84:87], v[96:99], v[48:51]
    v_mfma_f32_16x16x32_bf16 v[12:15], v[88:91], v[96:99], v[12:15]
    v_mfma_f32_16x16x32_bf16 v[44:47], v[92:95], v[96:99], v[44:47]
    s_waitcnt lgkmcnt(3)
    v_mfma_f32_16x16x32_bf16 v[28:31], v[64:67], v[100:103], v[28:31]
    v_mfma_f32_16x16x32_bf16 v[60:63], v[68:71], v[100:103], v[60:63]
    v_mfma_f32_16x16x32_bf16 v[24:27], v[72:75], v[100:103], v[24:27]
    v_mfma_f32_16x16x32_bf16 v[56:59], v[76:79], v[100:103], v[56:59]
    v_mfma_f32_16x16x32_bf16 v[20:23], v[80:83], v[100:103], v[20:23]
    v_mfma_f32_16x16x32_bf16 v[52:55], v[84:87], v[100:103], v[52:55]
    v_mfma_f32_16x16x32_bf16 v[16:19], v[88:91], v[100:103], v[16:19]
    v_mfma_f32_16x16x32_bf16 v[48:51], v[92:95], v[100:103], v[48:51]
    buffer_load_dwordx4 v[64:67], v125, s[12:15], s23 offen offset:0
    buffer_load_dwordx4 v[68:71], v125, s[12:15], s23 offen offset:1024
    s_waitcnt lgkmcnt(2)
    v_mfma_f32_16x16x32_bf16 v[28:31], v[72:75], v[104:107], v[28:31]
    v_mfma_f32_16x16x32_bf16 v[60:63], v[76:79], v[104:107], v[60:63]
    v_mfma_f32_16x16x32_bf16 v[24:27], v[80:83], v[104:107], v[24:27]
    v_mfma_f32_16x16x32_bf16 v[56:59], v[84:87], v[104:107], v[56:59]
    v_mfma_f32_16x16x32_bf16 v[20:23], v[88:91], v[104:107], v[20:23]
    v_mfma_f32_16x16x32_bf16 v[52:55], v[92:95], v[104:107], v[52:55]
    buffer_load_dwordx4 v[72:75], v125, s[12:15], s23 offen offset:2048
    buffer_load_dwordx4 v[76:79], v125, s[12:15], s23 offen offset:3072
    s_waitcnt lgkmcnt(1)
    v_mfma_f32_16x16x32_bf16 v[28:31], v[80:83], v[108:111], v[28:31]
    v_mfma_f32_16x16x32_bf16 v[60:63], v[84:87], v[108:111], v[60:63]
    v_mfma_f32_16x16x32_bf16 v[24:27], v[88:91], v[108:111], v[24:27]
    v_mfma_f32_16x16x32_bf16 v[56:59], v[92:95], v[108:111], v[56:59]
    buffer_load_dwordx4 v[80:83], v125, s[12:15], s26 offen offset:0
    buffer_load_dwordx4 v[84:87], v125, s[12:15], s26 offen offset:1024
    s_waitcnt lgkmcnt(0)
    v_mfma_f32_16x16x32_bf16 v[28:31], v[88:91], v[112:115], v[28:31]
    v_mfma_f32_16x16x32_bf16 v[60:63], v[92:95], v[112:115], v[60:63]
    buffer_load_dwordx4 v[88:91], v125, s[12:15], s26 offen offset:2048
    buffer_load_dwordx4 v[92:95], v125, s[12:15], s26 offen offset:3072
    s_add_u32 s23, s23, 57344
    s_add_u32 s26, s26, 57344
    s_barrier
    s_branch L_conv1_kernel_mloop1
L_conv1_kernel_mlast1:
    v_and_b32 v125, 15, v127
    v_and_b32 v126, 7, v127
    v_lshlrev_b32 v126, 4, v126
    v_lshl_add_u32 v125, v125, 7, v126
    v_lshrrev_b32 v126, 4, v127
    v_lshl_add_u32 v125, v126, 11, v125
    s_lshl_b32 s36, s20, 14
    s_add_u32 s37, s36, 8192
    v_add_u32 v126, s37, v125
    v_add_u32 v125, s36, v125
    ds_read_b128 v[96:99], v120 offset:8192
    ds_read_b128 v[100:103], v120 offset:9216
    ds_read_b128 v[104:107], v120 offset:10240
    ds_read_b128 v[108:111], v120 offset:11264
    ds_read_b128 v[112:115], v120 offset:12288
    ds_read_b128 v[116:119], v120 offset:13312
    s_waitcnt vmcnt(6) lgkmcnt(5)
    v_mfma_f32_16x16x32_bf16 v[0:3], v[64:67], v[96:99], v[0:3]
    v_mfma_f32_16x16x32_bf16 v[32:35], v[68:71], v[96:99], v[32:35]
    ds_read_b128 v[96:99], v120 offset:14336
    s_waitcnt vmcnt(4) lgkmcnt(5)
    v_mfma_f32_16x16x32_bf16 v[4:7], v[64:67], v[100:103], v[4:7]
    v_mfma_f32_16x16x32_bf16 v[36:39], v[68:71], v[100:103], v[36:39]
    v_mfma_f32_16x16x32_bf16 v[0:3], v[72:75], v[100:103], v[0:3]
    v_mfma_f32_16x16x32_bf16 v[32:35], v[76:79], v[100:103], v[32:35]
    ds_read_b128 v[100:103], v120 offset:15360
    s_waitcnt vmcnt(2) lgkmcnt(5)
    v_mfma_f32_16x16x32_bf16 v[8:11], v[64:67], v[104:107], v[8:11]
    v_mfma_f32_16x16x32_bf16 v[40:43], v[68:71], v[104:107], v[40:43]
    v_mfma_f32_16x16x32_bf16 v[4:7], v[72:75], v[104:107], v[4:7]
    v_mfma_f32_16x16x32_bf16 v[36:39], v[76:79], v[104:107], v[36:39]
    v_mfma_f32_16x16x32_bf16 v[0:3], v[80:83], v[104:107], v[0:3]
    v_mfma_f32_16x16x32_bf16 v[32:35], v[84:87], v[104:107], v[32:35]
    ds_read_b128 v[104:107], v122 offset:0
    s_waitcnt vmcnt(0) lgkmcnt(5)
    v_mfma_f32_16x16x32_bf16 v[12:15], v[64:67], v[108:111], v[12:15]
    v_mfma_f32_16x16x32_bf16 v[44:47], v[68:71], v[108:111], v[44:47]
    v_mfma_f32_16x16x32_bf16 v[8:11], v[72:75], v[108:111], v[8:11]
    v_mfma_f32_16x16x32_bf16 v[40:43], v[76:79], v[108:111], v[40:43]
    v_mfma_f32_16x16x32_bf16 v[4:7], v[80:83], v[108:111], v[4:7]
    v_mfma_f32_16x16x32_bf16 v[36:39], v[84:87], v[108:111], v[36:39]
    v_mfma_f32_16x16x32_bf16 v[0:3], v[88:91], v[108:111], v[0:3]
    v_mfma_f32_16x16x32_bf16 v[32:35], v[92:95], v[108:111], v[32:35]
    ds_read_b128 v[108:111], v121 offset:9216
    s_waitcnt lgkmcnt(5)
    v_mfma_f32_16x16x32_bf16 v[16:19], v[64:67], v[112:115], v[16:19]
    v_mfma_f32_16x16x32_bf16 v[48:51], v[68:71], v[112:115], v[48:51]
    v_mfma_f32_16x16x32_bf16 v[12:15], v[72:75], v[112:115], v[12:15]
    v_mfma_f32_16x16x32_bf16 v[44:47], v[76:79], v[112:115], v[44:47]
    v_mfma_f32_16x16x32_bf16 v[8:11], v[80:83], v[112:115], v[8:11]
    v_mfma_f32_16x16x32_bf16 v[40:43], v[84:87], v[112:115], v[40:43]
    v_mfma_f32_16x16x32_bf16 v[4:7], v[88:91], v[112:115], v[4:7]
    v_mfma_f32_16x16x32_bf16 v[36:39], v[92:95], v[112:115], v[36:39]
    ds_read_b128 v[112:115], v121 offset:10240
    v_xor_b32 v123, 0, v125
    ds_write_b128 v123, v[0:3]
    s_waitcnt lgkmcnt(6)
    v_mfma_f32_16x16x32_bf16 v[20:23], v[64:67], v[116:119], v[20:23]
    v_mfma_f32_16x16x32_bf16 v[52:55], v[68:71], v[116:119], v[52:55]
    v_mfma_f32_16x16x32_bf16 v[16:19], v[72:75], v[116:119], v[16:19]
    v_mfma_f32_16x16x32_bf16 v[48:51], v[76:79], v[116:119], v[48:51]
    v_mfma_f32_16x16x32_bf16 v[12:15], v[80:83], v[116:119], v[12:15]
    v_mfma_f32_16x16x32_bf16 v[44:47], v[84:87], v[116:119], v[44:47]
    v_mfma_f32_16x16x32_bf16 v[8:11], v[88:91], v[116:119], v[8:11]
    v_mfma_f32_16x16x32_bf16 v[40:43], v[92:95], v[116:119], v[40:43]
    v_xor_b32 v124, 16, v125
    ds_write_b128 v124, v[4:7]
    s_waitcnt lgkmcnt(2)
    v_mfma_f32_16x16x32_bf16 v[24:27], v[64:67], v[96:99], v[24:27]
    v_mfma_f32_16x16x32_bf16 v[56:59], v[68:71], v[96:99], v[56:59]
    v_mfma_f32_16x16x32_bf16 v[20:23], v[72:75], v[96:99], v[20:23]
    v_mfma_f32_16x16x32_bf16 v[52:55], v[76:79], v[96:99], v[52:55]
    v_mfma_f32_16x16x32_bf16 v[16:19], v[80:83], v[96:99], v[16:19]
    v_mfma_f32_16x16x32_bf16 v[48:51], v[84:87], v[96:99], v[48:51]
    v_mfma_f32_16x16x32_bf16 v[12:15], v[88:91], v[96:99], v[12:15]
    v_mfma_f32_16x16x32_bf16 v[44:47], v[92:95], v[96:99], v[44:47]
    v_xor_b32 v123, 32, v125
    ds_write_b128 v123, v[8:11]
    v_xor_b32 v124, 0, v126
    ds_write_b128 v124, v[32:35]
    v_mfma_f32_16x16x32_bf16 v[28:31], v[64:67], v[100:103], v[28:31]
    v_mfma_f32_16x16x32_bf16 v[60:63], v[68:71], v[100:103], v[60:63]
    v_mfma_f32_16x16x32_bf16 v[24:27], v[72:75], v[100:103], v[24:27]
    v_mfma_f32_16x16x32_bf16 v[56:59], v[76:79], v[100:103], v[56:59]
    v_mfma_f32_16x16x32_bf16 v[20:23], v[80:83], v[100:103], v[20:23]
    v_mfma_f32_16x16x32_bf16 v[52:55], v[84:87], v[100:103], v[52:55]
    v_mfma_f32_16x16x32_bf16 v[16:19], v[88:91], v[100:103], v[16:19]
    v_mfma_f32_16x16x32_bf16 v[48:51], v[92:95], v[100:103], v[48:51]
    v_xor_b32 v123, 16, v126
    ds_write_b128 v123, v[36:39]
    v_xor_b32 v124, 32, v126
    ds_write_b128 v124, v[40:43]
    v_mfma_f32_16x16x32_bf16 v[28:31], v[72:75], v[104:107], v[28:31]
    v_mfma_f32_16x16x32_bf16 v[60:63], v[76:79], v[104:107], v[60:63]
    v_mfma_f32_16x16x32_bf16 v[24:27], v[80:83], v[104:107], v[24:27]
    v_mfma_f32_16x16x32_bf16 v[56:59], v[84:87], v[104:107], v[56:59]
    v_mfma_f32_16x16x32_bf16 v[20:23], v[88:91], v[104:107], v[20:23]
    v_mfma_f32_16x16x32_bf16 v[52:55], v[92:95], v[104:107], v[52:55]
    v_xor_b32 v124, 48, v125
    ds_write_b128 v124, v[12:15]
    v_xor_b32 v123, 48, v126
    ds_write_b128 v123, v[44:47]
    v_mfma_f32_16x16x32_bf16 v[28:31], v[80:83], v[108:111], v[28:31]
    v_mfma_f32_16x16x32_bf16 v[60:63], v[84:87], v[108:111], v[60:63]
    v_mfma_f32_16x16x32_bf16 v[24:27], v[88:91], v[108:111], v[24:27]
    v_mfma_f32_16x16x32_bf16 v[56:59], v[92:95], v[108:111], v[56:59]
    v_xor_b32 v123, 64, v125
    ds_write_b128 v123, v[16:19]
    v_xor_b32 v124, 64, v126
    ds_write_b128 v124, v[48:51]
    v_mfma_f32_16x16x32_bf16 v[28:31], v[88:91], v[112:115], v[28:31]
    v_mfma_f32_16x16x32_bf16 v[60:63], v[92:95], v[112:115], v[60:63]
    v_xor_b32 v124, 80, v125
    ds_write_b128 v124, v[20:23]
    v_xor_b32 v123, 80, v126
    ds_write_b128 v123, v[52:55]
    v_and_b32 v108, 15, v127
    v_lshrrev_b32 v109, 4, v127
    v_lshrrev_b32 v110, 3, v108
    s_lshl_b32 s36, s20, 1
    v_add_u32 v110, s36, v110
    v_xor_b32 v111, v110, v108
    v_and_b32 v111, 7, v111
    v_lshlrev_b32 v111, 4, v111
    v_xor_b32 v123, 96, v125
    ds_write_b128 v123, v[24:27]
    v_lshl_add_u32 v111, v110, 7, v111
    v_lshl_add_u32 v120, v109, 11, v111
    v_add_u32 v121, 65536, v120
    v_add_u32 v64, 131072, v120
    s_lshl_b32 s36, s20, 9
    s_add_u32 s36, s36, 115712
    v_lshl_add_u32 v127, v109, 7, s36
    s_lshl_b32 s36, s20, 4
    v_add_u32 v108, s36, v108
    v_lshlrev_b32 v110, 6, v108
    v_lshl_add_u32 v110, v109, 4, v110
    s_mul_i32 s36, s29, 524288
    v_xor_b32 v124, 96, v126
    ds_write_b128 v124, v[56:59]
    s_lshl_b32 s37, s21, 4
    s_add_u32 s36, s36, s37
    v_add_u32 v110, s36, v110
    v_mov_b32 v111, 2130706432
    v_cmp_gt_u32 vcc, 125, v108
    s_mov_b32 s4, 0xbeaaaaab
    s_mov_b32 s5, s4
    s_mov_b32 s6, 0x3e800000
    s_mov_b32 s7, s6
    s_mov_b32 s8, 0xc0a00000
    s_mov_b32 s9, s8
    s_mov_b32 s10, 0xc0638e39
    v_xor_b32 v124, 112, v125
    ds_write_b128 v124, v[28:31]
    s_mov_b32 s11, s10
    s_mov_b32 s12, 0xbf638e39
    s_mov_b32 s13, s12
    s_mov_b32 s14, 0xbe638e39
    s_mov_b32 s15, s14
    s_mov_b32 s22, 0xbd638e39
    s_mov_b32 s23, s22
    s_mov_b32 s24, 0x3ff1c71c
    s_mov_b32 s25, s24
    s_mov_b32 s26, 0xbf2aaaab
    s_mov_b32 s27, s26
    s_mov_b32 s32, 0x3ecccccd
    v_xor_b32 v123, 112, v126
    s_waitcnt lgkmcnt(8)
    ds_write_b128 v123, v[60:63]
    s_mov_b32 s33, s32
    s_mov_b32 s34, 0xbd888889
    s_mov_b32 s35, s34
    s_mov_b32 s38, 0xbe4ccccd
    s_mov_b32 s39, s38
    s_mov_b32 s40, 0xbdd2d3e8
    s_mov_b32 s41, s40
    s_mov_b32 s42, 0x3f800000
    s_mov_b32 s43, s42
    s_setprio 0
    s_branch L_conv1_kernel_epi
L_conv1_kernel_m2:
    s_mul_i32 s37, s38, 2176
    s_add_u32 s37, s37, 98304
    v_add_u32 v116, s37, v8
    v_add_u32 v118, s37, v9
    v_add_u32 v117, 104832, v8
    s_cmp_eq_u32 s38, 0
    s_cbranch_scc1 L_conv1_kernel_hh0
    v_add_u32 v117, 98304, v9
L_conv1_kernel_hh0:
    s_lshl_b32 s37, s38, 12
    s_add_u32 s37, s37, s43
    s_add_u32 s37, s37, 49152
    v_lshl_add_u32 v119, v127, 4, s37
    v_mov_b32 v0, 0
    v_mov_b32 v1, 0
    v_mov_b32 v2, 0
    v_mov_b32 v3, 0
    v_mov_b32 v4, 0
    v_mov_b32 v5, 0
    v_mov_b32 v6, 0
    v_mov_b32 v7, 0
    v_mov_b32 v8, 0
    v_mov_b32 v9, 0
    v_mov_b32 v10, 0
    v_mov_b32 v11, 0
    v_mov_b32 v12, 0
    v_mov_b32 v13, 0
    v_mov_b32 v14, 0
    v_mov_b32 v15, 0
    v_mov_b32 v16, 0
    v_mov_b32 v17, 0
    v_mov_b32 v18, 0
    v_mov_b32 v19, 0
    v_mov_b32 v20, 0
    v_mov_b32 v21, 0
    v_mov_b32 v22, 0
    v_mov_b32 v23, 0
    v_mov_b32 v24, 0
    v_mov_b32 v25, 0
    v_mov_b32 v26, 0
    v_mov_b32 v27, 0
    v_mov_b32 v28, 0
    v_mov_b32 v29, 0
    v_mov_b32 v30, 0
    v_mov_b32 v31, 0
    v_mov_b32 v32, 0
    v_mov_b32 v33, 0
    v_mov_b32 v34, 0
    v_mov_b32 v35, 0
    v_mov_b32 v36, 0
    v_mov_b32 v37, 0
    v_mov_b32 v38, 0
    v_mov_b32 v39, 0
    v_mov_b32 v40, 0
    v_mov_b32 v41, 0
    v_mov_b32 v42, 0
    v_mov_b32 v43, 0
    v_mov_b32 v44, 0
    v_mov_b32 v45, 0
    v_mov_b32 v46, 0
    v_mov_b32 v47, 0
    v_mov_b32 v48, 0
    v_mov_b32 v49, 0
    v_mov_b32 v50, 0
    v_mov_b32 v51, 0
    v_mov_b32 v52, 0
    v_mov_b32 v53, 0
    v_mov_b32 v54, 0
    v_mov_b32 v55, 0
    v_mov_b32 v56, 0
    v_mov_b32 v57, 0
    v_mov_b32 v58, 0
    v_mov_b32 v59, 0
    v_mov_b32 v60, 0
    v_mov_b32 v61, 0
    v_mov_b32 v62, 0
    v_mov_b32 v63, 0
    s_barrier
    buffer_load_dwordx4 v[96:99], v108, s[8:11], 0 offen
    buffer_load_dwordx4 v[100:103], v109, s[8:11], 0 offen
    buffer_load_dwordx4 v[104:107], v110, s[8:11], 0 offen
    s_mov_b32 s23, 0
    s_mov_b32 s26, 4096
    buffer_load_dwordx4 v[64:67], v125, s[12:15], s23 offen offset:0
    buffer_load_dwordx4 v[68:71], v125, s[12:15], s23 offen offset:2048
    buffer_load_dwordx4 v[80:83], v119, s[12:15], s23 offen offset:0
    buffer_load_dwordx4 v[72:75], v125, s[12:15], s26 offen offset:0
    buffer_load_dwordx4 v[84:87], v119, s[12:15], s23 offen offset:2048
    buffer_load_dwordx4 v[76:79], v125, s[12:15], s26 offen offset:2048
    s_mov_b32 s23, 57344
    s_mov_b32 s26, 61440
    s_waitcnt vmcnt(6)
    v_lshlrev_b32 v108, 16, v96
    v_and_b32 v111, s25, v96
    v_lshlrev_b32 v109, 16, v100
    v_and_b32 v112, s25, v100
    v_lshlrev_b32 v110, 16, v104
    v_and_b32 v113, s25, v104
    v_mul_f32 v114, s44, v108
    v_mul_f32 v115, s44, v111
    v_fmac_f32 v114, s45, v109
    v_fmac_f32 v115, s45, v112
    v_fmac_f32 v114, s46, v110
    v_fmac_f32 v115, s46, v113
    v_cvt_pk_bf16_f32 v96, v114, v115
    v_lshlrev_b32 v108, 16, v97
    v_and_b32 v111, s25, v97
    v_lshlrev_b32 v109, 16, v101
    v_and_b32 v112, s25, v101
    v_lshlrev_b32 v110, 16, v105
    v_and_b32 v113, s25, v105
    v_mul_f32 v114, s44, v108
    v_mul_f32 v115, s44, v111
    v_fmac_f32 v114, s45, v109
    v_fmac_f32 v115, s45, v112
    v_fmac_f32 v114, s46, v110
    v_fmac_f32 v115, s46, v113
    v_cvt_pk_bf16_f32 v97, v114, v115
    v_lshlrev_b32 v108, 16, v98
    v_and_b32 v111, s25, v98
    v_lshlrev_b32 v109, 16, v102
    v_and_b32 v112, s25, v102
    v_lshlrev_b32 v110, 16, v106
    v_and_b32 v113, s25, v106
    v_mul_f32 v114, s44, v108
    v_mul_f32 v115, s44, v111
    v_fmac_f32 v114, s45, v109
    v_fmac_f32 v115, s45, v112
    v_fmac_f32 v114, s46, v110
    v_fmac_f32 v115, s46, v113
    v_cvt_pk_bf16_f32 v98, v114, v115
    v_lshlrev_b32 v108, 16, v99
    v_and_b32 v111, s25, v99
    v_lshlrev_b32 v109, 16, v103
    v_and_b32 v112, s25, v103
    v_lshlrev_b32 v110, 16, v107
    v_and_b32 v113, s25, v107
    v_mul_f32 v114, s44, v108
    v_mul_f32 v115, s44, v111
    v_fmac_f32 v114, s45, v109
    v_fmac_f32 v115, s45, v112
    v_fmac_f32 v114, s46, v110
    v_fmac_f32 v115, s46, v113
    v_cvt_pk_bf16_f32 v99, v114, v115
    ds_write_b128 v126, v[96:99]
    v_and_b32 v126, 15, v127
    v_lshlrev_b32 v126, 2, v126
    v_add_u32 v126, 99328, v126
    ds_write_b32 v126, v0
    ds_write_b32 v126, v0 offset:8704
    s_waitcnt lgkmcnt(0)
    s_barrier
    s_mov_b32 s22, 8
    s_setprio 2
L_conv1_kernel_mloop2:
    ds_read_b128 v[88:91], v120 offset:0
    ds_read_b128 v[92:95], v120 offset:1024
    ds_read_b128 v[96:99], v116 offset:0
    ds_read_b128 v[100:103], v120 offset:2048
    ds_read_b128 v[104:107], v116 offset:1088
    ds_read_b128 v[108:111], v120 offset:3072
    ds_read_b128 v[112:115], v116 offset:2176
    s_waitcnt vmcnt(5) lgkmcnt(6)
    v_mfma_f32_16x16x32_bf16 v[0:3], v[64:67], v[88:91], v[0:3]
    ds_read_b128 v[88:91], v120 offset:4096
    s_waitcnt vmcnt(4) lgkmcnt(6)
    v_mfma_f32_16x16x32_bf16 v[4:7], v[64:67], v[92:95], v[4:7]
    v_mfma_f32_16x16x32_bf16 v[0:3], v[68:71], v[92:95], v[0:3]
    ds_read_b128 v[92:95], v116 offset:3264
    s_waitcnt vmcnt(3) lgkmcnt(6)
    v_mfma_f32_16x16x32_bf16 v[32:35], v[80:83], v[96:99], v[32:35]
    ds_read_b128 v[96:99], v120 offset:5120
    s_waitcnt vmcnt(2) lgkmcnt(6)
    v_mfma_f32_16x16x32_bf16 v[8:11], v[64:67], v[100:103], v[8:11]
    v_mfma_f32_16x16x32_bf16 v[4:7], v[68:71], v[100:103], v[4:7]
    v_mfma_f32_16x16x32_bf16 v[0:3], v[72:75], v[100:103], v[0:3]
    ds_read_b128 v[100:103], v116 offset:4352
    s_waitcnt vmcnt(1) lgkmcnt(6)
    v_mfma_f32_16x16x32_bf16 v[36:39], v[80:83], v[104:107], v[36:39]
    v_mfma_f32_16x16x32_bf16 v[32:35], v[84:87], v[104:107], v[32:35]
    ds_read_b128 v[104:107], v120 offset:6144
    s_waitcnt vmcnt(0) lgkmcnt(6)
    v_mfma_f32_16x16x32_bf16 v[12:15], v[64:67], v[108:111], v[12:15]
    v_mfma_f32_16x16x32_bf16 v[8:11], v[68:71], v[108:111], v[8:11]
    v_mfma_f32_16x16x32_bf16 v[4:7], v[72:75], v[108:111], v[4:7]
    v_mfma_f32_16x16x32_bf16 v[0:3], v[76:79], v[108:111], v[0:3]
    ds_read_b128 v[108:111], v116 offset:5440
    s_waitcnt lgkmcnt(6)
    v_mfma_f32_16x16x32_bf16 v[40:43], v[80:83], v[112:115], v[40:43]
    v_mfma_f32_16x16x32_bf16 v[36:39], v[84:87], v[112:115], v[36:39]
    ds_read_b128 v[112:115], v120 offset:7168
    s_waitcnt lgkmcnt(6)
    v_mfma_f32_16x16x32_bf16 v[16:19], v[64:67], v[88:91], v[16:19]
    v_mfma_f32_16x16x32_bf16 v[12:15], v[68:71], v[88:91], v[12:15]
    v_mfma_f32_16x16x32_bf16 v[8:11], v[72:75], v[88:91], v[8:11]
    v_mfma_f32_16x16x32_bf16 v[4:7], v[76:79], v[88:91], v[4:7]
    ds_read_b128 v[88:91], v117 offset:0
    s_waitcnt lgkmcnt(6)
    v_mfma_f32_16x16x32_bf16 v[44:47], v[80:83], v[92:95], v[44:47]
    v_mfma_f32_16x16x32_bf16 v[40:43], v[84:87], v[92:95], v[40:43]
    ds_read_b128 v[92:95], v122 offset:0
    v_add_u32 v122, v123, v122
    s_waitcnt lgkmcnt(6)
    v_mfma_f32_16x16x32_bf16 v[20:23], v[64:67], v[96:99], v[20:23]
    v_mfma_f32_16x16x32_bf16 v[16:19], v[68:71], v[96:99], v[16:19]
    v_mfma_f32_16x16x32_bf16 v[12:15], v[72:75], v[96:99], v[12:15]
    v_mfma_f32_16x16x32_bf16 v[8:11], v[76:79], v[96:99], v[8:11]
    ds_read_b128 v[96:99], v117 offset:1088
    s_waitcnt lgkmcnt(6)
    v_mfma_f32_16x16x32_bf16 v[48:51], v[80:83], v[100:103], v[48:51]
    v_mfma_f32_16x16x32_bf16 v[44:47], v[84:87], v[100:103], v[44:47]
    ds_read_b128 v[100:103], v121 offset:1024
    s_waitcnt lgkmcnt(6)
    v_mfma_f32_16x16x32_bf16 v[24:27], v[64:67], v[104:107], v[24:27]
    v_mfma_f32_16x16x32_bf16 v[20:23], v[68:71], v[104:107], v[20:23]
    v_mfma_f32_16x16x32_bf16 v[16:19], v[72:75], v[104:107], v[16:19]
    v_mfma_f32_16x16x32_bf16 v[12:15], v[76:79], v[104:107], v[12:15]
    ds_read_b128 v[104:107], v118 offset:0
    s_waitcnt lgkmcnt(6)
    v_mfma_f32_16x16x32_bf16 v[52:55], v[80:83], v[108:111], v[52:55]
    v_mfma_f32_16x16x32_bf16 v[48:51], v[84:87], v[108:111], v[48:51]
    ds_read_b128 v[108:111], v121 offset:2048
    s_waitcnt lgkmcnt(6)
    v_mfma_f32_16x16x32_bf16 v[28:31], v[64:67], v[112:115], v[28:31]
    v_mfma_f32_16x16x32_bf16 v[24:27], v[68:71], v[112:115], v[24:27]
    v_mfma_f32_16x16x32_bf16 v[20:23], v[72:75], v[112:115], v[20:23]
    v_mfma_f32_16x16x32_bf16 v[16:19], v[76:79], v[112:115], v[16:19]
    buffer_load_dwordx4 v[64:67], v125, s[12:15], s23 offen offset:0
    s_waitcnt lgkmcnt(5)
    v_mfma_f32_16x16x32_bf16 v[56:59], v[80:83], v[88:91], v[56:59]
    v_mfma_f32_16x16x32_bf16 v[52:55], v[84:87], v[88:91], v[52:55]
    s_waitcnt lgkmcnt(0)
    s_barrier
    v_mfma_f32_16x16x32_bf16 v[28:31], v[68:71], v[92:95], v[28:31]
    v_mfma_f32_16x16x32_bf16 v[24:27], v[72:75], v[92:95], v[24:27]
    v_mfma_f32_16x16x32_bf16 v[20:23], v[76:79], v[92:95], v[20:23]
    buffer_load_dwordx4 v[68:71], v125, s[12:15], s23 offen offset:2048
    v_mfma_f32_16x16x32_bf16 v[60:63], v[80:83], v[96:99], v[60:63]
    v_mfma_f32_16x16x32_bf16 v[56:59], v[84:87], v[96:99], v[56:59]
    buffer_load_dwordx4 v[80:83], v119, s[12:15], s23 offen offset:0
    v_mfma_f32_16x16x32_bf16 v[28:31], v[72:75], v[100:103], v[28:31]
    v_mfma_f32_16x16x32_bf16 v[24:27], v[76:79], v[100:103], v[24:27]
    buffer_load_dwordx4 v[72:75], v125, s[12:15], s26 offen offset:0
    v_mfma_f32_16x16x32_bf16 v[60:63], v[84:87], v[104:107], v[60:63]
    buffer_load_dwordx4 v[84:87], v119, s[12:15], s23 offen offset:2048
    v_mfma_f32_16x16x32_bf16 v[28:31], v[76:79], v[108:111], v[28:31]
    buffer_load_dwordx4 v[76:79], v125, s[12:15], s26 offen offset:2048
    s_add_u32 s23, s23, 57344
    s_add_u32 s26, s26, 57344
    s_sub_u32 s22, s22, 1
    s_cmp_eq_u32 s22, 0
    s_cbranch_scc1 L_conv1_kernel_mlast2
    ds_read_b128 v[88:91], v120 offset:8192
    ds_read_b128 v[92:95], v120 offset:9216
    ds_read_b128 v[96:99], v116 offset:8704
    ds_read_b128 v[100:103], v120 offset:10240
    ds_read_b128 v[104:107], v116 offset:9792
    ds_read_b128 v[108:111], v120 offset:11264
    ds_read_b128 v[112:115], v116 offset:10880
    s_waitcnt vmcnt(5) lgkmcnt(6)
    v_mfma_f32_16x16x32_bf16 v[0:3], v[64:67], v[88:91], v[0:3]
    ds_read_b128 v[88:91], v120 offset:12288
    s_waitcnt vmcnt(4) lgkmcnt(6)
    v_mfma_f32_16x16x32_bf16 v[4:7], v[64:67], v[92:95], v[4:7]
    v_mfma_f32_16x16x32_bf16 v[0:3], v[68:71], v[92:95], v[0:3]
    ds_read_b128 v[92:95], v116 offset:11968
    s_waitcnt vmcnt(3) lgkmcnt(6)
    v_mfma_f32_16x16x32_bf16 v[32:35], v[80:83], v[96:99], v[32:35]
    ds_read_b128 v[96:99], v120 offset:13312
    s_waitcnt vmcnt(2) lgkmcnt(6)
    v_mfma_f32_16x16x32_bf16 v[8:11], v[64:67], v[100:103], v[8:11]
    v_mfma_f32_16x16x32_bf16 v[4:7], v[68:71], v[100:103], v[4:7]
    v_mfma_f32_16x16x32_bf16 v[0:3], v[72:75], v[100:103], v[0:3]
    ds_read_b128 v[100:103], v116 offset:13056
    s_waitcnt vmcnt(1) lgkmcnt(6)
    v_mfma_f32_16x16x32_bf16 v[36:39], v[80:83], v[104:107], v[36:39]
    v_mfma_f32_16x16x32_bf16 v[32:35], v[84:87], v[104:107], v[32:35]
    ds_read_b128 v[104:107], v120 offset:14336
    s_waitcnt vmcnt(0) lgkmcnt(6)
    v_mfma_f32_16x16x32_bf16 v[12:15], v[64:67], v[108:111], v[12:15]
    v_mfma_f32_16x16x32_bf16 v[8:11], v[68:71], v[108:111], v[8:11]
    v_mfma_f32_16x16x32_bf16 v[4:7], v[72:75], v[108:111], v[4:7]
    v_mfma_f32_16x16x32_bf16 v[0:3], v[76:79], v[108:111], v[0:3]
    ds_read_b128 v[108:111], v116 offset:14144
    s_waitcnt lgkmcnt(6)
    v_mfma_f32_16x16x32_bf16 v[40:43], v[80:83], v[112:115], v[40:43]
    v_mfma_f32_16x16x32_bf16 v[36:39], v[84:87], v[112:115], v[36:39]
    ds_read_b128 v[112:115], v120 offset:15360
    s_waitcnt lgkmcnt(6)
    v_mfma_f32_16x16x32_bf16 v[16:19], v[64:67], v[88:91], v[16:19]
    v_mfma_f32_16x16x32_bf16 v[12:15], v[68:71], v[88:91], v[12:15]
    v_mfma_f32_16x16x32_bf16 v[8:11], v[72:75], v[88:91], v[8:11]
    v_mfma_f32_16x16x32_bf16 v[4:7], v[76:79], v[88:91], v[4:7]
    ds_read_b128 v[88:91], v117 offset:8704
    s_waitcnt lgkmcnt(6)
    v_mfma_f32_16x16x32_bf16 v[44:47], v[80:83], v[92:95], v[44:47]
    v_mfma_f32_16x16x32_bf16 v[40:43], v[84:87], v[92:95], v[40:43]
    ds_read_b128 v[92:95], v122 offset:0
    v_add_u32 v122, v124, v122
    s_waitcnt lgkmcnt(6)
    v_mfma_f32_16x16x32_bf16 v[20:23], v[64:67], v[96:99], v[20:23]
    v_mfma_f32_16x16x32_bf16 v[16:19], v[68:71], v[96:99], v[16:19]
    v_mfma_f32_16x16x32_bf16 v[12:15], v[72:75], v[96:99], v[12:15]
    v_mfma_f32_16x16x32_bf16 v[8:11], v[76:79], v[96:99], v[8:11]
    ds_read_b128 v[96:99], v117 offset:9792
    s_waitcnt lgkmcnt(6)
    v_mfma_f32_16x16x32_bf16 v[48:51], v[80:83], v[100:103], v[48:51]
    v_mfma_f32_16x16x32_bf16 v[44:47], v[84:87], v[100:103], v[44:47]
    ds_read_b128 v[100:103], v121 offset:9216
    s_waitcnt lgkmcnt(6)
    v_mfma_f32_16x16x32_bf16 v[24:27], v[64:67], v[104:107], v[24:27]
    v_mfma_f32_16x16x32_bf16 v[20:23], v[68:71], v[104:107], v[20:23]
    v_mfma_f32_16x16x32_bf16 v[16:19], v[72:75], v[104:107], v[16:19]
    v_mfma_f32_16x16x32_bf16 v[12:15], v[76:79], v[104:107], v[12:15]
    ds_read_b128 v[104:107], v118 offset:8704
    s_waitcnt lgkmcnt(6)
    v_mfma_f32_16x16x32_bf16 v[52:55], v[80:83], v[108:111], v[52:55]
    v_mfma_f32_16x16x32_bf16 v[48:51], v[84:87], v[108:111], v[48:51]
    ds_read_b128 v[108:111], v121 offset:10240
    s_waitcnt lgkmcnt(6)
    v_mfma_f32_16x16x32_bf16 v[28:31], v[64:67], v[112:115], v[28:31]
    v_mfma_f32_16x16x32_bf16 v[24:27], v[68:71], v[112:115], v[24:27]
    v_mfma_f32_16x16x32_bf16 v[20:23], v[72:75], v[112:115], v[20:23]
    v_mfma_f32_16x16x32_bf16 v[16:19], v[76:79], v[112:115], v[16:19]
    buffer_load_dwordx4 v[64:67], v125, s[12:15], s23 offen offset:0
    s_waitcnt lgkmcnt(5)
    v_mfma_f32_16x16x32_bf16 v[56:59], v[80:83], v[88:91], v[56:59]
    v_mfma_f32_16x16x32_bf16 v[52:55], v[84:87], v[88:91], v[52:55]
    s_waitcnt lgkmcnt(0)
    s_barrier
    v_mfma_f32_16x16x32_bf16 v[28:31], v[68:71], v[92:95], v[28:31]
    v_mfma_f32_16x16x32_bf16 v[24:27], v[72:75], v[92:95], v[24:27]
    v_mfma_f32_16x16x32_bf16 v[20:23], v[76:79], v[92:95], v[20:23]
    buffer_load_dwordx4 v[68:71], v125, s[12:15], s23 offen offset:2048
    v_mfma_f32_16x16x32_bf16 v[60:63], v[80:83], v[96:99], v[60:63]
    v_mfma_f32_16x16x32_bf16 v[56:59], v[84:87], v[96:99], v[56:59]
    buffer_load_dwordx4 v[80:83], v119, s[12:15], s23 offen offset:0
    v_mfma_f32_16x16x32_bf16 v[28:31], v[72:75], v[100:103], v[28:31]
    v_mfma_f32_16x16x32_bf16 v[24:27], v[76:79], v[100:103], v[24:27]
    buffer_load_dwordx4 v[72:75], v125, s[12:15], s26 offen offset:0
    v_mfma_f32_16x16x32_bf16 v[60:63], v[84:87], v[104:107], v[60:63]
    buffer_load_dwordx4 v[84:87], v119, s[12:15], s23 offen offset:2048
    v_mfma_f32_16x16x32_bf16 v[28:31], v[76:79], v[108:111], v[28:31]
    buffer_load_dwordx4 v[76:79], v125, s[12:15], s26 offen offset:2048
    s_add_u32 s23, s23, 57344
    s_add_u32 s26, s26, 57344
    s_branch L_conv1_kernel_mloop2
L_conv1_kernel_mlast2:
    v_and_b32 v125, 15, v127
    v_and_b32 v126, 7, v127
    v_lshlrev_b32 v126, 4, v126
    v_lshl_add_u32 v125, v125, 7, v126
    v_lshrrev_b32 v126, 4, v127
    v_lshl_add_u32 v125, v126, 11, v125
    s_mov_b32 s36, 65536
    s_cmp_eq_u32 s32, 1
    s_cselect_b32 s36, 121856, s36
    s_cmp_eq_u32 s32, 2
    s_cselect_b32 s36, 81920, s36
    s_cmp_eq_u32 s32, 3
    s_cselect_b32 s36, 130048, s36
    s_mov_b32 s37, 98304
    s_cmp_eq_u32 s32, 1
    s_cselect_b32 s37, 138240, s37
    s_cmp_eq_u32 s32, 2
    s_cselect_b32 s37, 146432, s37
    s_cmp_eq_u32 s32, 3
    s_cselect_b32 s37, 154624, s37
    v_add_u32 v126, s37, v125
    v_add_u32 v125, s36, v125
    ds_read_b128 v[88:91], v120 offset:8192
    ds_read_b128 v[92:95], v120 offset:9216
    ds_read_b128 v[96:99], v116 offset:8704
    ds_read_b128 v[100:103], v120 offset:10240
    ds_read_b128 v[104:107], v116 offset:9792
    ds_read_b128 v[108:111], v120 offset:11264
    ds_read_b128 v[112:115], v116 offset:10880
    s_waitcnt vmcnt(5) lgkmcnt(6)
    v_mfma_f32_16x16x32_bf16 v[0:3], v[64:67], v[88:91], v[0:3]
    ds_read_b128 v[88:91], v120 offset:12288
    s_waitcnt vmcnt(4) lgkmcnt(6)
    v_mfma_f32_16x16x32_bf16 v[4:7], v[64:67], v[92:95], v[4:7]
    v_mfma_f32_16x16x32_bf16 v[0:3], v[68:71], v[92:95], v[0:3]
    ds_read_b128 v[92:95], v116 offset:11968
    s_waitcnt vmcnt(3) lgkmcnt(6)
    v_mfma_f32_16x16x32_bf16 v[32:35], v[80:83], v[96:99], v[32:35]
    ds_read_b128 v[96:99], v120 offset:13312
    s_waitcnt vmcnt(2) lgkmcnt(6)
    v_mfma_f32_16x16x32_bf16 v[8:11], v[64:67], v[100:103], v[8:11]
    v_mfma_f32_16x16x32_bf16 v[4:7], v[68:71], v[100:103], v[4:7]
    v_mfma_f32_16x16x32_bf16 v[0:3], v[72:75], v[100:103], v[0:3]
    ds_read_b128 v[100:103], v116 offset:13056
    s_waitcnt vmcnt(1) lgkmcnt(6)
    v_mfma_f32_16x16x32_bf16 v[36:39], v[80:83], v[104:107], v[36:39]
    v_mfma_f32_16x16x32_bf16 v[32:35], v[84:87], v[104:107], v[32:35]
    ds_read_b128 v[104:107], v120 offset:14336
    s_waitcnt vmcnt(0) lgkmcnt(6)
    v_mfma_f32_16x16x32_bf16 v[12:15], v[64:67], v[108:111], v[12:15]
    v_mfma_f32_16x16x32_bf16 v[8:11], v[68:71], v[108:111], v[8:11]
    v_mfma_f32_16x16x32_bf16 v[4:7], v[72:75], v[108:111], v[4:7]
    v_mfma_f32_16x16x32_bf16 v[0:3], v[76:79], v[108:111], v[0:3]
    ds_read_b128 v[108:111], v116 offset:14144
    s_waitcnt lgkmcnt(6)
    v_mfma_f32_16x16x32_bf16 v[40:43], v[80:83], v[112:115], v[40:43]
    v_mfma_f32_16x16x32_bf16 v[36:39], v[84:87], v[112:115], v[36:39]
    ds_read_b128 v[112:115], v120 offset:15360
    s_waitcnt lgkmcnt(6)
    v_mfma_f32_16x16x32_bf16 v[16:19], v[64:67], v[88:91], v[16:19]
    v_mfma_f32_16x16x32_bf16 v[12:15], v[68:71], v[88:91], v[12:15]
    v_mfma_f32_16x16x32_bf16 v[8:11], v[72:75], v[88:91], v[8:11]
    v_mfma_f32_16x16x32_bf16 v[4:7], v[76:79], v[88:91], v[4:7]
    ds_read_b128 v[88:91], v117 offset:8704
    v_xor_b32 v124, 0, v126
    ds_write_b128 v124, v[32:35]
    s_waitcnt lgkmcnt(7)
    v_mfma_f32_16x16x32_bf16 v[44:47], v[80:83], v[92:95], v[44:47]
    v_mfma_f32_16x16x32_bf16 v[40:43], v[84:87], v[92:95], v[40:43]
    ds_read_b128 v[92:95], v122 offset:0
    v_xor_b32 v123, 0, v125
    ds_write_b128 v123, v[0:3]
    s_waitcnt lgkmcnt(8)
    v_mfma_f32_16x16x32_bf16 v[20:23], v[64:67], v[96:99], v[20:23]
    v_mfma_f32_16x16x32_bf16 v[16:19], v[68:71], v[96:99], v[16:19]
    v_mfma_f32_16x16x32_bf16 v[12:15], v[72:75], v[96:99], v[12:15]
    v_mfma_f32_16x16x32_bf16 v[8:11], v[76:79], v[96:99], v[8:11]
    ds_read_b128 v[96:99], v117 offset:9792
    v_xor_b32 v123, 16, v126
    ds_write_b128 v123, v[36:39]
    s_waitcnt lgkmcnt(9)
    v_mfma_f32_16x16x32_bf16 v[48:51], v[80:83], v[100:103], v[48:51]
    v_mfma_f32_16x16x32_bf16 v[44:47], v[84:87], v[100:103], v[44:47]
    ds_read_b128 v[100:103], v121 offset:9216
    v_xor_b32 v124, 16, v125
    ds_write_b128 v124, v[4:7]
    s_waitcnt lgkmcnt(10)
    v_mfma_f32_16x16x32_bf16 v[24:27], v[64:67], v[104:107], v[24:27]
    v_mfma_f32_16x16x32_bf16 v[20:23], v[68:71], v[104:107], v[20:23]
    v_mfma_f32_16x16x32_bf16 v[16:19], v[72:75], v[104:107], v[16:19]
    v_mfma_f32_16x16x32_bf16 v[12:15], v[76:79], v[104:107], v[12:15]
    ds_read_b128 v[104:107], v118 offset:8704
    v_xor_b32 v124, 32, v126
    ds_write_b128 v124, v[40:43]
    s_waitcnt lgkmcnt(11)
    v_mfma_f32_16x16x32_bf16 v[52:55], v[80:83], v[108:111], v[52:55]
    v_mfma_f32_16x16x32_bf16 v[48:51], v[84:87], v[108:111], v[48:51]
    ds_read_b128 v[108:111], v121 offset:10240
    v_xor_b32 v123, 32, v125
    ds_write_b128 v123, v[8:11]
    s_waitcnt lgkmcnt(12)
    v_mfma_f32_16x16x32_bf16 v[28:31], v[64:67], v[112:115], v[28:31]
    v_mfma_f32_16x16x32_bf16 v[24:27], v[68:71], v[112:115], v[24:27]
    v_mfma_f32_16x16x32_bf16 v[20:23], v[72:75], v[112:115], v[20:23]
    v_mfma_f32_16x16x32_bf16 v[16:19], v[76:79], v[112:115], v[16:19]
    v_xor_b32 v123, 48, v126
    ds_write_b128 v123, v[44:47]
    s_waitcnt lgkmcnt(12)
    v_mfma_f32_16x16x32_bf16 v[56:59], v[80:83], v[88:91], v[56:59]
    v_mfma_f32_16x16x32_bf16 v[52:55], v[84:87], v[88:91], v[52:55]
    v_xor_b32 v124, 48, v125
    ds_write_b128 v124, v[12:15]
    s_waitcnt lgkmcnt(11)
    v_mfma_f32_16x16x32_bf16 v[28:31], v[68:71], v[92:95], v[28:31]
    v_mfma_f32_16x16x32_bf16 v[24:27], v[72:75], v[92:95], v[24:27]
    v_mfma_f32_16x16x32_bf16 v[20:23], v[76:79], v[92:95], v[20:23]
    v_xor_b32 v124, 64, v126
    ds_write_b128 v124, v[48:51]
    s_waitcnt lgkmcnt(10)
    v_mfma_f32_16x16x32_bf16 v[60:63], v[80:83], v[96:99], v[60:63]
    v_mfma_f32_16x16x32_bf16 v[56:59], v[84:87], v[96:99], v[56:59]
    v_xor_b32 v123, 64, v125
    ds_write_b128 v123, v[16:19]
    s_waitcnt lgkmcnt(9)
    v_mfma_f32_16x16x32_bf16 v[28:31], v[72:75], v[100:103], v[28:31]
    v_mfma_f32_16x16x32_bf16 v[24:27], v[76:79], v[100:103], v[24:27]
    v_xor_b32 v123, 80, v126
    ds_write_b128 v123, v[52:55]
    s_waitcnt lgkmcnt(8)
    v_mfma_f32_16x16x32_bf16 v[60:63], v[84:87], v[104:107], v[60:63]
    v_xor_b32 v124, 80, v125
    ds_write_b128 v124, v[20:23]
    s_waitcnt lgkmcnt(7)
    v_mfma_f32_16x16x32_bf16 v[28:31], v[76:79], v[108:111], v[28:31]
    v_xor_b32 v124, 96, v126
    ds_write_b128 v124, v[56:59]
    v_and_b32 v108, 15, v127
    v_lshrrev_b32 v109, 4, v127
    v_lshrrev_b32 v110, 3, v108
    s_lshl_b32 s36, s20, 1
    v_add_u32 v110, s36, v110
    v_xor_b32 v111, v110, v108
    v_and_b32 v111, 7, v111
    v_lshlrev_b32 v111, 4, v111
    v_xor_b32 v123, 96, v125
    ds_write_b128 v123, v[24:27]
    v_lshl_add_u32 v111, v110, 7, v111
    v_lshl_add_u32 v120, v109, 11, v111
    v_add_u32 v121, 65536, v120
    v_add_u32 v64, 131072, v120
    s_lshl_b32 s36, s20, 9
    s_add_u32 s36, s36, 115712
    v_lshl_add_u32 v127, v109, 7, s36
    s_lshl_b32 s36, s20, 4
    v_add_u32 v108, s36, v108
    v_lshlrev_b32 v110, 6, v108
    v_lshl_add_u32 v110, v109, 4, v110
    s_mul_i32 s36, s29, 524288
    v_xor_b32 v123, 112, v126
    ds_write_b128 v123, v[60:63]
    s_lshl_b32 s37, s21, 4
    s_add_u32 s36, s36, s37
    v_add_u32 v110, s36, v110
    v_mov_b32 v111, 2130706432
    v_cmp_gt_u32 vcc, 125, v108
    s_mov_b32 s4, 0xbeaaaaab
    s_mov_b32 s5, s4
    s_mov_b32 s6, 0x3e800000
    s_mov_b32 s7, s6
    s_mov_b32 s8, 0xc0a00000
    s_mov_b32 s9, s8
    s_mov_b32 s10, 0xc0638e39
    v_xor_b32 v124, 112, v125
    ds_write_b128 v124, v[28:31]
    s_mov_b32 s11, s10
    s_mov_b32 s12, 0xbf638e39
    s_mov_b32 s13, s12
    s_mov_b32 s14, 0xbe638e39
    s_mov_b32 s15, s14
    s_mov_b32 s22, 0xbd638e39
    s_mov_b32 s23, s22
    s_mov_b32 s24, 0x3ff1c71c
    s_mov_b32 s25, s24
    s_mov_b32 s26, 0xbf2aaaab
    s_mov_b32 s27, s26
    s_mov_b32 s32, 0x3ecccccd
    s_mov_b32 s33, s32
    s_mov_b32 s34, 0xbd888889
    s_mov_b32 s35, s34
    s_mov_b32 s38, 0xbe4ccccd
    s_mov_b32 s39, s38
    s_mov_b32 s40, 0xbdd2d3e8
    s_mov_b32 s41, s40
    s_mov_b32 s42, 0x3f800000
    s_mov_b32 s43, s42
    s_setprio 0
    s_branch L_conv1_kernel_epi
L_conv1_kernel_helper:
    s_setprio 3
    v_add_u32 v92, 0, v7
    v_add_u32 v93, 1024, v7
    v_add_u32 v94, 2048, v7
    v_add_u32 v95, 3072, v7
    v_and_b32 v76, 4, v5
    v_lshrrev_b32 v76, 1, v76
    v_xor_b32 v76, v6, v76
    v_lshlrev_b32 v76, 4, v76
    v_lshl_add_u32 v76, v5, 6, v76
    s_mov_b32 s24, 0
    s_mov_b32 s27, 524288
    buffer_load_dwordx4 v[0:3], v92, s[8:11], s24 offen offset:0
    buffer_load_dwordx4 v[16:19], v92, s[8:11], s24 offen offset:64
    v_add_u32 v92, 128, v92
    buffer_load_dwordx4 v[4:7], v93, s[8:11], s24 offen offset:0
    buffer_load_dwordx4 v[20:23], v93, s[8:11], s24 offen offset:64
    v_add_u32 v93, 128, v93
    buffer_load_dwordx4 v[8:11], v94, s[8:11], s24 offen offset:0
    buffer_load_dwordx4 v[24:27], v94, s[8:11], s24 offen offset:64
    v_add_u32 v94, 128, v94
    buffer_load_dwordx4 v[12:15], v95, s[8:11], s24 offen offset:0
    buffer_load_dwordx4 v[28:31], v95, s[8:11], s24 offen offset:64
    v_add_u32 v95, 128, v95
    s_barrier
    s_mul_i32 s36, s42, 1024
    v_add_u32 v96, s36, v76
    v_add_u32 v97, 65536, v96
    s_mul_i32 s36, s42, 1088
    s_add_u32 s36, s36, 98304
    v_add_u32 v98, s36, v76
    s_waitcnt vmcnt(0)
    s_mov_b32 s28, 0
    s_mov_b32 s22, 4
    s_cmp_ge_u32 s20, 12
    s_cbranch_scc1 L_conv1_kernel_h2
    ds_write_b128 v96, v[0:3] offset:0
    ds_write_b128 v98, v[12:15] offset:0
    v_lshlrev_b32 v76, 16, v0
    v_and_b32 v84, s25, v0
    v_lshlrev_b32 v77, 16, v4
    v_and_b32 v85, s25, v4
    v_lshlrev_b32 v78, 16, v8
    v_and_b32 v86, s25, v8
    v_lshlrev_b32 v79, 16, v12
    v_and_b32 v87, s25, v12
    v_add_f32 v80, v76, v78
    v_add_f32 v88, v84, v86
    v_add_f32 v81, v77, v79
    v_add_f32 v89, v85, v87
    v_fma_f32 v82, v78, 4.0, v76
    v_fma_f32 v90, v86, 4.0, v84
    v_fma_f32 v83, v79, 4.0, v77
    v_fma_f32 v91, v87, 4.0, v85
    v_add_f32 v77, v80, v81
    v_add_f32 v85, v88, v89
    v_sub_f32 v78, v80, v81
    v_sub_f32 v86, v88, v89
    v_fma_f32 v79, v83, 2.0, v82
    v_fma_f32 v87, v91, 2.0, v90
    v_fma_f32 v82, v83, -2.0, v82
    v_fma_f32 v90, v91, -2.0, v90
    v_fmamk_f32 v80, v76, 0x41700000, v82
    v_fmamk_f32 v88, v84, 0x41700000, v90
    v_fmamk_f32 v80, v81, 0x41200000, v80
    v_fmamk_f32 v88, v89, 0x41200000, v88
    v_cvt_pk_bf16_f32 v4, v77, v85
    v_cvt_pk_bf16_f32 v8, v78, v86
    v_cvt_pk_bf16_f32 v64, v79, v87
    v_cvt_pk_bf16_f32 v68, v82, v90
    v_cvt_pk_bf16_f32 v72, v80, v88
    v_lshlrev_b32 v76, 16, v1
    v_and_b32 v84, s25, v1
    v_lshlrev_b32 v77, 16, v5
    v_and_b32 v85, s25, v5
    v_lshlrev_b32 v78, 16, v9
    v_and_b32 v86, s25, v9
    v_lshlrev_b32 v79, 16, v13
    v_and_b32 v87, s25, v13
    v_add_f32 v80, v76, v78
    v_add_f32 v88, v84, v86
    v_add_f32 v81, v77, v79
    v_add_f32 v89, v85, v87
    v_fma_f32 v82, v78, 4.0, v76
    v_fma_f32 v90, v86, 4.0, v84
    v_fma_f32 v83, v79, 4.0, v77
    v_fma_f32 v91, v87, 4.0, v85
    v_add_f32 v77, v80, v81
    v_add_f32 v85, v88, v89
    v_sub_f32 v78, v80, v81
    v_sub_f32 v86, v88, v89
    v_fma_f32 v79, v83, 2.0, v82
    v_fma_f32 v87, v91, 2.0, v90
    v_fma_f32 v82, v83, -2.0, v82
    v_fma_f32 v90, v91, -2.0, v90
    v_fmamk_f32 v80, v76, 0x41700000, v82
    v_fmamk_f32 v88, v84, 0x41700000, v90
    v_fmamk_f32 v80, v81, 0x41200000, v80
    v_fmamk_f32 v88, v89, 0x41200000, v88
    v_cvt_pk_bf16_f32 v5, v77, v85
    v_cvt_pk_bf16_f32 v9, v78, v86
    v_cvt_pk_bf16_f32 v65, v79, v87
    v_cvt_pk_bf16_f32 v69, v82, v90
    v_cvt_pk_bf16_f32 v73, v80, v88
    v_lshlrev_b32 v76, 16, v2
    v_and_b32 v84, s25, v2
    v_lshlrev_b32 v77, 16, v6
    v_and_b32 v85, s25, v6
    v_lshlrev_b32 v78, 16, v10
    v_and_b32 v86, s25, v10
    v_lshlrev_b32 v79, 16, v14
    v_and_b32 v87, s25, v14
    v_add_f32 v80, v76, v78
    v_add_f32 v88, v84, v86
    v_add_f32 v81, v77, v79
    v_add_f32 v89, v85, v87
    v_fma_f32 v82, v78, 4.0, v76
    v_fma_f32 v90, v86, 4.0, v84
    v_fma_f32 v83, v79, 4.0, v77
    v_fma_f32 v91, v87, 4.0, v85
    v_add_f32 v77, v80, v81
    v_add_f32 v85, v88, v89
    v_sub_f32 v78, v80, v81
    v_sub_f32 v86, v88, v89
    v_fma_f32 v79, v83, 2.0, v82
    v_fma_f32 v87, v91, 2.0, v90
    v_fma_f32 v82, v83, -2.0, v82
    v_fma_f32 v90, v91, -2.0, v90
    v_fmamk_f32 v80, v76, 0x41700000, v82
    v_fmamk_f32 v88, v84, 0x41700000, v90
    v_fmamk_f32 v80, v81, 0x41200000, v80
    v_fmamk_f32 v88, v89, 0x41200000, v88
    v_cvt_pk_bf16_f32 v6, v77, v85
    v_cvt_pk_bf16_f32 v10, v78, v86
    v_cvt_pk_bf16_f32 v66, v79, v87
    v_cvt_pk_bf16_f32 v70, v82, v90
    v_cvt_pk_bf16_f32 v74, v80, v88
    v_lshlrev_b32 v76, 16, v3
    v_and_b32 v84, s25, v3
    v_lshlrev_b32 v77, 16, v7
    v_and_b32 v85, s25, v7
    v_lshlrev_b32 v78, 16, v11
    v_and_b32 v86, s25, v11
    v_lshlrev_b32 v79, 16, v15
    v_and_b32 v87, s25, v15
    v_add_f32 v80, v76, v78
    v_add_f32 v88, v84, v86
    v_add_f32 v81, v77, v79
    v_add_f32 v89, v85, v87
    v_fma_f32 v82, v78, 4.0, v76
    v_fma_f32 v90, v86, 4.0, v84
    v_fma_f32 v83, v79, 4.0, v77
    v_fma_f32 v91, v87, 4.0, v85
    v_add_f32 v77, v80, v81
    v_add_f32 v85, v88, v89
    v_sub_f32 v78, v80, v81
    v_sub_f32 v86, v88, v89
    v_fma_f32 v79, v83, 2.0, v82
    v_fma_f32 v87, v91, 2.0, v90
    v_fma_f32 v82, v83, -2.0, v82
    v_fma_f32 v90, v91, -2.0, v90
    v_fmamk_f32 v80, v76, 0x41700000, v82
    v_fmamk_f32 v88, v84, 0x41700000, v90
    v_fmamk_f32 v80, v81, 0x41200000, v80
    v_fmamk_f32 v88, v89, 0x41200000, v88
    v_cvt_pk_bf16_f32 v7, v77, v85
    v_cvt_pk_bf16_f32 v11, v78, v86
    v_cvt_pk_bf16_f32 v67, v79, v87
    v_cvt_pk_bf16_f32 v71, v82, v90
    v_cvt_pk_bf16_f32 v75, v80, v88
    ds_write_b128 v96, v[64:67] offset:49152
    ds_write_b128 v97, v[68:71] offset:0
    ds_write_b128 v97, v[72:75] offset:16384
    ds_write_b128 v96, v[4:7] offset:16384
    ds_write_b128 v96, v[8:11] offset:32768
    s_waitcnt vmcnt(0)
    buffer_load_dwordx4 v[32:35], v92, s[8:11], s24 offen offset:0
    buffer_load_dwordx4 v[48:51], v92, s[8:11], s24 offen offset:64
    v_add_u32 v92, 128, v92
    buffer_load_dwordx4 v[36:39], v93, s[8:11], s24 offen offset:0
    buffer_load_dwordx4 v[52:55], v93, s[8:11], s24 offen offset:64
    v_add_u32 v93, 128, v93
    s_waitcnt lgkmcnt(0)
    s_barrier
    s_setprio 1
L_conv1_kernel_hloop1:
    s_cmp_lt_u32 s28, 13
    s_cselect_b32 s24, 0, 2130706432
    v_lshlrev_b32 v76, 16, v16
    v_and_b32 v84, s25, v16
    v_lshlrev_b32 v77, 16, v20
    v_and_b32 v85, s25, v20
    v_lshlrev_b32 v78, 16, v24
    v_and_b32 v86, s25, v24
    v_lshlrev_b32 v79, 16, v28
    v_and_b32 v87, s25, v28
    v_add_f32 v80, v76, v78
    v_add_f32 v88, v84, v86
    v_add_f32 v81, v77, v79
    v_add_f32 v89, v85, v87
    v_fma_f32 v82, v78, 4.0, v76
    buffer_load_dwordx4 v[40:43], v94, s[8:11], s24 offen offset:0
    buffer_load_dwordx4 v[56:59], v94, s[8:11], s24 offen offset:64
    v_add_u32 v94, 128, v94
    v_fma_f32 v90, v86, 4.0, v84
    v_fma_f32 v83, v79, 4.0, v77
    v_fma_f32 v91, v87, 4.0, v85
    v_add_f32 v77, v80, v81
    v_add_f32 v85, v88, v89
    v_sub_f32 v78, v80, v81
    v_sub_f32 v86, v88, v89
    v_fma_f32 v79, v83, 2.0, v82
    v_fma_f32 v87, v91, 2.0, v90
    v_fma_f32 v82, v83, -2.0, v82
    v_fma_f32 v90, v91, -2.0, v90
    v_fmamk_f32 v80, v76, 0x41700000, v82
    v_fmamk_f32 v88, v84, 0x41700000, v90
    v_fmamk_f32 v80, v81, 0x41200000, v80
    v_fmamk_f32 v88, v89, 0x41200000, v88
    v_cvt_pk_bf16_f32 v20, v77, v85
    v_cvt_pk_bf16_f32 v24, v78, v86
    v_cvt_pk_bf16_f32 v64, v79, v87
    v_cvt_pk_bf16_f32 v68, v82, v90
    v_cvt_pk_bf16_f32 v72, v80, v88
    v_lshlrev_b32 v76, 16, v17
    v_and_b32 v84, s25, v17
    v_lshlrev_b32 v77, 16, v21
    v_and_b32 v85, s25, v21
    v_lshlrev_b32 v78, 16, v25
    v_and_b32 v86, s25, v25
    v_lshlrev_b32 v79, 16, v29
    v_and_b32 v87, s25, v29
    v_add_f32 v80, v76, v78
    v_add_f32 v88, v84, v86
    v_add_f32 v81, v77, v79
    v_add_f32 v89, v85, v87
    v_fma_f32 v82, v78, 4.0, v76
    v_fma_f32 v90, v86, 4.0, v84
    v_fma_f32 v83, v79, 4.0, v77
    v_fma_f32 v91, v87, 4.0, v85
    v_add_f32 v77, v80, v81
    v_add_f32 v85, v88, v89
    v_sub_f32 v78, v80, v81
    v_sub_f32 v86, v88, v89
    v_fma_f32 v79, v83, 2.0, v82
    v_fma_f32 v87, v91, 2.0, v90
    v_fma_f32 v82, v83, -2.0, v82
    v_fma_f32 v90, v91, -2.0, v90
    v_fmamk_f32 v80, v76, 0x41700000, v82
    v_fmamk_f32 v88, v84, 0x41700000, v90
    v_fmamk_f32 v80, v81, 0x41200000, v80
    v_fmamk_f32 v88, v89, 0x41200000, v88
    v_cvt_pk_bf16_f32 v21, v77, v85
    v_cvt_pk_bf16_f32 v25, v78, v86
    v_cvt_pk_bf16_f32 v65, v79, v87
    v_cvt_pk_bf16_f32 v69, v82, v90
    v_cvt_pk_bf16_f32 v73, v80, v88
    buffer_load_dwordx4 v[44:47], v95, s[8:11], s24 offen offset:0
    buffer_load_dwordx4 v[60:63], v95, s[8:11], s24 offen offset:64
    v_add_u32 v95, 128, v95
    v_lshlrev_b32 v76, 16, v18
    v_and_b32 v84, s25, v18
    v_lshlrev_b32 v77, 16, v22
    v_and_b32 v85, s25, v22
    v_lshlrev_b32 v78, 16, v26
    v_and_b32 v86, s25, v26
    v_lshlrev_b32 v79, 16, v30
    v_and_b32 v87, s25, v30
    v_add_f32 v80, v76, v78
    v_add_f32 v88, v84, v86
    v_add_f32 v81, v77, v79
    v_add_f32 v89, v85, v87
    v_fma_f32 v82, v78, 4.0, v76
    v_fma_f32 v90, v86, 4.0, v84
    v_fma_f32 v83, v79, 4.0, v77
    v_fma_f32 v91, v87, 4.0, v85
    v_add_f32 v77, v80, v81
    v_add_f32 v85, v88, v89
    v_sub_f32 v78, v80, v81
    v_sub_f32 v86, v88, v89
    v_fma_f32 v79, v83, 2.0, v82
    v_fma_f32 v87, v91, 2.0, v90
    v_fma_f32 v82, v83, -2.0, v82
    v_fma_f32 v90, v91, -2.0, v90
    v_fmamk_f32 v80, v76, 0x41700000, v82
    v_fmamk_f32 v88, v84, 0x41700000, v90
    v_fmamk_f32 v80, v81, 0x41200000, v80
    v_fmamk_f32 v88, v89, 0x41200000, v88
    v_cvt_pk_bf16_f32 v22, v77, v85
    v_cvt_pk_bf16_f32 v26, v78, v86
    v_cvt_pk_bf16_f32 v66, v79, v87
    v_cvt_pk_bf16_f32 v70, v82, v90
    v_cvt_pk_bf16_f32 v74, v80, v88
    v_lshlrev_b32 v76, 16, v19
    v_and_b32 v84, s25, v19
    v_lshlrev_b32 v77, 16, v23
    v_and_b32 v85, s25, v23
    v_lshlrev_b32 v78, 16, v27
    v_and_b32 v86, s25, v27
    v_lshlrev_b32 v79, 16, v31
    v_and_b32 v87, s25, v31
    v_add_f32 v80, v76, v78
    v_add_f32 v88, v84, v86
    v_add_f32 v81, v77, v79
    v_add_f32 v89, v85, v87
    v_fma_f32 v82, v78, 4.0, v76
    v_fma_f32 v90, v86, 4.0, v84
    v_fma_f32 v83, v79, 4.0, v77
    v_fma_f32 v91, v87, 4.0, v85
    v_add_f32 v77, v80, v81
    v_add_f32 v85, v88, v89
    v_sub_f32 v78, v80, v81
    v_sub_f32 v86, v88, v89
    v_fma_f32 v79, v83, 2.0, v82
    v_fma_f32 v87, v91, 2.0, v90
    v_fma_f32 v82, v83, -2.0, v82
    v_fma_f32 v90, v91, -2.0, v90
    v_fmamk_f32 v80, v76, 0x41700000, v82
    v_fmamk_f32 v88, v84, 0x41700000, v90
    v_fmamk_f32 v80, v81, 0x41200000, v80
    v_fmamk_f32 v88, v89, 0x41200000, v88
    v_cvt_pk_bf16_f32 v23, v77, v85
    v_cvt_pk_bf16_f32 v27, v78, v86
    v_cvt_pk_bf16_f32 v67, v79, v87
    v_cvt_pk_bf16_f32 v71, v82, v90
    v_cvt_pk_bf16_f32 v75, v80, v88
    ds_write_b128 v96, v[64:67] offset:57344
    ds_write_b128 v97, v[68:71] offset:8192
    ds_write_b128 v97, v[72:75] offset:24576
    ds_write_b128 v96, v[16:19] offset:8192
    ds_write_b128 v96, v[20:23] offset:24576
    ds_write_b128 v96, v[24:27] offset:40960
    ds_write_b128 v98, v[28:31] offset:8704
    s_add_u32 s28, s28, 1
    s_waitcnt lgkmcnt(0)
    s_barrier
    s_cmp_lt_u32 s28, 13
    s_cselect_b32 s24, 0, 2130706432
    s_waitcnt vmcnt(0)
    v_lshlrev_b32 v76, 16, v32
    v_and_b32 v84, s25, v32
    v_lshlrev_b32 v77, 16, v36
    v_and_b32 v85, s25, v36
    v_lshlrev_b32 v78, 16, v40
    v_and_b32 v86, s25, v40
    v_lshlrev_b32 v79, 16, v44
    v_and_b32 v87, s25, v44
    v_add_f32 v80, v76, v78
    v_add_f32 v88, v84, v86
    v_add_f32 v81, v77, v79
    v_add_f32 v89, v85, v87
    v_fma_f32 v82, v78, 4.0, v76
    v_fma_f32 v90, v86, 4.0, v84
    v_fma_f32 v83, v79, 4.0, v77
    v_fma_f32 v91, v87, 4.0, v85
    v_add_f32 v77, v80, v81
    v_add_f32 v85, v88, v89
    v_sub_f32 v78, v80, v81
    v_sub_f32 v86, v88, v89
    v_fma_f32 v79, v83, 2.0, v82
    v_fma_f32 v87, v91, 2.0, v90
    v_fma_f32 v82, v83, -2.0, v82
    v_fma_f32 v90, v91, -2.0, v90
    v_fmamk_f32 v80, v76, 0x41700000, v82
    v_fmamk_f32 v88, v84, 0x41700000, v90
    v_fmamk_f32 v80, v81, 0x41200000, v80
    v_fmamk_f32 v88, v89, 0x41200000, v88
    v_cvt_pk_bf16_f32 v36, v77, v85
    v_cvt_pk_bf16_f32 v40, v78, v86
    v_cvt_pk_bf16_f32 v64, v79, v87
    v_cvt_pk_bf16_f32 v68, v82, v90
    v_cvt_pk_bf16_f32 v72, v80, v88
    v_lshlrev_b32 v76, 16, v33
    v_and_b32 v84, s25, v33
    v_lshlrev_b32 v77, 16, v37
    v_and_b32 v85, s25, v37
    v_lshlrev_b32 v78, 16, v41
    v_and_b32 v86, s25, v41
    buffer_load_dwordx4 v[0:3], v92, s[8:11], s24 offen offset:0
    buffer_load_dwordx4 v[16:19], v92, s[8:11], s24 offen offset:64
    v_add_u32 v92, 128, v92
    v_lshlrev_b32 v79, 16, v45
    v_and_b32 v87, s25, v45
    v_add_f32 v80, v76, v78
    v_add_f32 v88, v84, v86
    v_add_f32 v81, v77, v79
    v_add_f32 v89, v85, v87
    v_fma_f32 v82, v78, 4.0, v76
    v_fma_f32 v90, v86, 4.0, v84
    v_fma_f32 v83, v79, 4.0, v77
    v_fma_f32 v91, v87, 4.0, v85
    v_add_f32 v77, v80, v81
    v_add_f32 v85, v88, v89
    v_sub_f32 v78, v80, v81
    v_sub_f32 v86, v88, v89
    v_fma_f32 v79, v83, 2.0, v82
    v_fma_f32 v87, v91, 2.0, v90
    v_fma_f32 v82, v83, -2.0, v82
    v_fma_f32 v90, v91, -2.0, v90
    v_fmamk_f32 v80, v76, 0x41700000, v82
    v_fmamk_f32 v88, v84, 0x41700000, v90
    v_fmamk_f32 v80, v81, 0x41200000, v80
    v_fmamk_f32 v88, v89, 0x41200000, v88
    v_cvt_pk_bf16_f32 v37, v77, v85
    v_cvt_pk_bf16_f32 v41, v78, v86
    v_cvt_pk_bf16_f32 v65, v79, v87
    v_cvt_pk_bf16_f32 v69, v82, v90
    v_cvt_pk_bf16_f32 v73, v80, v88
    v_lshlrev_b32 v76, 16, v34
    v_and_b32 v84, s25, v34
    v_lshlrev_b32 v77, 16, v38
    v_and_b32 v85, s25, v38
    v_lshlrev_b32 v78, 16, v42
    v_and_b32 v86, s25, v42
    v_lshlrev_b32 v79, 16, v46
    v_and_b32 v87, s25, v46
    v_add_f32 v80, v76, v78
    v_add_f32 v88, v84, v86
    v_add_f32 v81, v77, v79
    v_add_f32 v89, v85, v87
    v_fma_f32 v82, v78, 4.0, v76
    v_fma_f32 v90, v86, 4.0, v84
    v_fma_f32 v83, v79, 4.0, v77
    v_fma_f32 v91, v87, 4.0, v85
    v_add_f32 v77, v80, v81
    v_add_f32 v85, v88, v89
    v_sub_f32 v78, v80, v81
    v_sub_f32 v86, v88, v89
    v_fma_f32 v79, v83, 2.0, v82
    v_fma_f32 v87, v91, 2.0, v90
    v_fma_f32 v82, v83, -2.0, v82
    v_fma_f32 v90, v91, -2.0, v90
    v_fmamk_f32 v80, v76, 0x41700000, v82
    v_fmamk_f32 v88, v84, 0x41700000, v90
    buffer_load_dwordx4 v[4:7], v93, s[8:11], s24 offen offset:0
    buffer_load_dwordx4 v[20:23], v93, s[8:11], s24 offen offset:64
    v_add_u32 v93, 128, v93
    v_fmamk_f32 v80, v81, 0x41200000, v80
    v_fmamk_f32 v88, v89, 0x41200000, v88
    v_cvt_pk_bf16_f32 v38, v77, v85
    v_cvt_pk_bf16_f32 v42, v78, v86
    v_cvt_pk_bf16_f32 v66, v79, v87
    v_cvt_pk_bf16_f32 v70, v82, v90
    v_cvt_pk_bf16_f32 v74, v80, v88
    v_lshlrev_b32 v76, 16, v35
    v_and_b32 v84, s25, v35
    v_lshlrev_b32 v77, 16, v39
    v_and_b32 v85, s25, v39
    v_lshlrev_b32 v78, 16, v43
    v_and_b32 v86, s25, v43
    v_lshlrev_b32 v79, 16, v47
    v_and_b32 v87, s25, v47
    v_add_f32 v80, v76, v78
    v_add_f32 v88, v84, v86
    v_add_f32 v81, v77, v79
    v_add_f32 v89, v85, v87
    v_fma_f32 v82, v78, 4.0, v76
    v_fma_f32 v90, v86, 4.0, v84
    v_fma_f32 v83, v79, 4.0, v77
    v_fma_f32 v91, v87, 4.0, v85
    v_add_f32 v77, v80, v81
    v_add_f32 v85, v88, v89
    v_sub_f32 v78, v80, v81
    v_sub_f32 v86, v88, v89
    v_fma_f32 v79, v83, 2.0, v82
    v_fma_f32 v87, v91, 2.0, v90
    v_fma_f32 v82, v83, -2.0, v82
    v_fma_f32 v90, v91, -2.0, v90
    v_fmamk_f32 v80, v76, 0x41700000, v82
    v_fmamk_f32 v88, v84, 0x41700000, v90
    v_fmamk_f32 v80, v81, 0x41200000, v80
    v_fmamk_f32 v88, v89, 0x41200000, v88
    v_cvt_pk_bf16_f32 v39, v77, v85
    v_cvt_pk_bf16_f32 v43, v78, v86
    v_cvt_pk_bf16_f32 v67, v79, v87
    v_cvt_pk_bf16_f32 v71, v82, v90
    v_cvt_pk_bf16_f32 v75, v80, v88
    ds_write_b128 v96, v[64:67] offset:49152
    ds_write_b128 v97, v[68:71] offset:0
    ds_write_b128 v97, v[72:75] offset:16384
    ds_write_b128 v96, v[32:35] offset:0
    ds_write_b128 v96, v[36:39] offset:16384
    ds_write_b128 v96, v[40:43] offset:32768
    ds_write_b128 v98, v[44:47] offset:0
    s_add_u32 s28, s28, 1
    s_waitcnt lgkmcnt(0)
    s_barrier
    s_cmp_lt_u32 s28, 13
    s_cselect_b32 s24, 0, 2130706432
    v_lshlrev_b32 v76, 16, v48
    v_and_b32 v84, s25, v48
    v_lshlrev_b32 v77, 16, v52
    v_and_b32 v85, s25, v52
    v_lshlrev_b32 v78, 16, v56
    v_and_b32 v86, s25, v56
    v_lshlrev_b32 v79, 16, v60
    v_and_b32 v87, s25, v60
    v_add_f32 v80, v76, v78
    v_add_f32 v88, v84, v86
    v_add_f32 v81, v77, v79
    v_add_f32 v89, v85, v87
    v_fma_f32 v82, v78, 4.0, v76
    buffer_load_dwordx4 v[8:11], v94, s[8:11], s24 offen offset:0
    buffer_load_dwordx4 v[24:27], v94, s[8:11], s24 offen offset:64
    v_add_u32 v94, 128, v94
    v_fma_f32 v90, v86, 4.0, v84
    v_fma_f32 v83, v79, 4.0, v77
    v_fma_f32 v91, v87, 4.0, v85
    v_add_f32 v77, v80, v81
    v_add_f32 v85, v88, v89
    v_sub_f32 v78, v80, v81
    v_sub_f32 v86, v88, v89
    v_fma_f32 v79, v83, 2.0, v82
    v_fma_f32 v87, v91, 2.0, v90
    v_fma_f32 v82, v83, -2.0, v82
    v_fma_f32 v90, v91, -2.0, v90
    v_fmamk_f32 v80, v76, 0x41700000, v82
    v_fmamk_f32 v88, v84, 0x41700000, v90
    v_fmamk_f32 v80, v81, 0x41200000, v80
    v_fmamk_f32 v88, v89, 0x41200000, v88
    v_cvt_pk_bf16_f32 v52, v77, v85
    v_cvt_pk_bf16_f32 v56, v78, v86
    v_cvt_pk_bf16_f32 v64, v79, v87
    v_cvt_pk_bf16_f32 v68, v82, v90
    v_cvt_pk_bf16_f32 v72, v80, v88
    v_lshlrev_b32 v76, 16, v49
    v_and_b32 v84, s25, v49
    v_lshlrev_b32 v77, 16, v53
    v_and_b32 v85, s25, v53
    v_lshlrev_b32 v78, 16, v57
    v_and_b32 v86, s25, v57
    v_lshlrev_b32 v79, 16, v61
    v_and_b32 v87, s25, v61
    v_add_f32 v80, v76, v78
    v_add_f32 v88, v84, v86
    v_add_f32 v81, v77, v79
    v_add_f32 v89, v85, v87
    v_fma_f32 v82, v78, 4.0, v76
    v_fma_f32 v90, v86, 4.0, v84
    v_fma_f32 v83, v79, 4.0, v77
    v_fma_f32 v91, v87, 4.0, v85
    v_add_f32 v77, v80, v81
    v_add_f32 v85, v88, v89
    v_sub_f32 v78, v80, v81
    v_sub_f32 v86, v88, v89
    v_fma_f32 v79, v83, 2.0, v82
    v_fma_f32 v87, v91, 2.0, v90
    v_fma_f32 v82, v83, -2.0, v82
    v_fma_f32 v90, v91, -2.0, v90
    v_fmamk_f32 v80, v76, 0x41700000, v82
    v_fmamk_f32 v88, v84, 0x41700000, v90
    v_fmamk_f32 v80, v81, 0x41200000, v80
    v_fmamk_f32 v88, v89, 0x41200000, v88
    v_cvt_pk_bf16_f32 v53, v77, v85
    v_cvt_pk_bf16_f32 v57, v78, v86
    v_cvt_pk_bf16_f32 v65, v79, v87
    v_cvt_pk_bf16_f32 v69, v82, v90
    v_cvt_pk_bf16_f32 v73, v80, v88
    buffer_load_dwordx4 v[12:15], v95, s[8:11], s24 offen offset:0
    buffer_load_dwordx4 v[28:31], v95, s[8:11], s24 offen offset:64
    v_add_u32 v95, 128, v95
    v_lshlrev_b32 v76, 16, v50
    v_and_b32 v84, s25, v50
    v_lshlrev_b32 v77, 16, v54
    v_and_b32 v85, s25, v54
    v_lshlrev_b32 v78, 16, v58
    v_and_b32 v86, s25, v58
    v_lshlrev_b32 v79, 16, v62
    v_and_b32 v87, s25, v62
    v_add_f32 v80, v76, v78
    v_add_f32 v88, v84, v86
    v_add_f32 v81, v77, v79
    v_add_f32 v89, v85, v87
    v_fma_f32 v82, v78, 4.0, v76
    v_fma_f32 v90, v86, 4.0, v84
    v_fma_f32 v83, v79, 4.0, v77
    v_fma_f32 v91, v87, 4.0, v85
    v_add_f32 v77, v80, v81
    v_add_f32 v85, v88, v89
    v_sub_f32 v78, v80, v81
    v_sub_f32 v86, v88, v89
    v_fma_f32 v79, v83, 2.0, v82
    v_fma_f32 v87, v91, 2.0, v90
    v_fma_f32 v82, v83, -2.0, v82
    v_fma_f32 v90, v91, -2.0, v90
    v_fmamk_f32 v80, v76, 0x41700000, v82
    v_fmamk_f32 v88, v84, 0x41700000, v90
    v_fmamk_f32 v80, v81, 0x41200000, v80
    v_fmamk_f32 v88, v89, 0x41200000, v88
    v_cvt_pk_bf16_f32 v54, v77, v85
    v_cvt_pk_bf16_f32 v58, v78, v86
    v_cvt_pk_bf16_f32 v66, v79, v87
    v_cvt_pk_bf16_f32 v70, v82, v90
    v_cvt_pk_bf16_f32 v74, v80, v88
    v_lshlrev_b32 v76, 16, v51
    v_and_b32 v84, s25, v51
    v_lshlrev_b32 v77, 16, v55
    v_and_b32 v85, s25, v55
    v_lshlrev_b32 v78, 16, v59
    v_and_b32 v86, s25, v59
    v_lshlrev_b32 v79, 16, v63
    v_and_b32 v87, s25, v63
    v_add_f32 v80, v76, v78
    v_add_f32 v88, v84, v86
    v_add_f32 v81, v77, v79
    v_add_f32 v89, v85, v87
    v_fma_f32 v82, v78, 4.0, v76
    v_fma_f32 v90, v86, 4.0, v84
    v_fma_f32 v83, v79, 4.0, v77
    v_fma_f32 v91, v87, 4.0, v85
    v_add_f32 v77, v80, v81
    v_add_f32 v85, v88, v89
    v_sub_f32 v78, v80, v81
    v_sub_f32 v86, v88, v89
    v_fma_f32 v79, v83, 2.0, v82
    v_fma_f32 v87, v91, 2.0, v90
    v_fma_f32 v82, v83, -2.0, v82
    v_fma_f32 v90, v91, -2.0, v90
    v_fmamk_f32 v80, v76, 0x41700000, v82
    v_fmamk_f32 v88, v84, 0x41700000, v90
    v_fmamk_f32 v80, v81, 0x41200000, v80
    v_fmamk_f32 v88, v89, 0x41200000, v88
    v_cvt_pk_bf16_f32 v55, v77, v85
    v_cvt_pk_bf16_f32 v59, v78, v86
    v_cvt_pk_bf16_f32 v67, v79, v87
    v_cvt_pk_bf16_f32 v71, v82, v90
    v_cvt_pk_bf16_f32 v75, v80, v88
    ds_write_b128 v96, v[64:67] offset:57344
    ds_write_b128 v97, v[68:71] offset:8192
    ds_write_b128 v97, v[72:75] offset:24576
    ds_write_b128 v96, v[48:51] offset:8192
    ds_write_b128 v96, v[52:55] offset:24576
    ds_write_b128 v96, v[56:59] offset:40960
    ds_write_b128 v98, v[60:63] offset:8704
    s_add_u32 s28, s28, 1
    s_waitcnt lgkmcnt(0)
    s_barrier
    s_cmp_eq_u32 s22, 1
    s_cbranch_scc1 L_conv1_kernel_hlast1
    s_cmp_lt_u32 s28, 13
    s_cselect_b32 s24, 0, 2130706432
    s_waitcnt vmcnt(0)
    v_lshlrev_b32 v76, 16, v0
    v_and_b32 v84, s25, v0
    v_lshlrev_b32 v77, 16, v4
    v_and_b32 v85, s25, v4
    v_lshlrev_b32 v78, 16, v8
    v_and_b32 v86, s25, v8
    v_lshlrev_b32 v79, 16, v12
    v_and_b32 v87, s25, v12
    v_add_f32 v80, v76, v78
    v_add_f32 v88, v84, v86
    v_add_f32 v81, v77, v79
    v_add_f32 v89, v85, v87
    v_fma_f32 v82, v78, 4.0, v76
    v_fma_f32 v90, v86, 4.0, v84
    v_fma_f32 v83, v79, 4.0, v77
    v_fma_f32 v91, v87, 4.0, v85
    v_add_f32 v77, v80, v81
    v_add_f32 v85, v88, v89
    v_sub_f32 v78, v80, v81
    v_sub_f32 v86, v88, v89
    v_fma_f32 v79, v83, 2.0, v82
    v_fma_f32 v87, v91, 2.0, v90
    v_fma_f32 v82, v83, -2.0, v82
    v_fma_f32 v90, v91, -2.0, v90
    v_fmamk_f32 v80, v76, 0x41700000, v82
    v_fmamk_f32 v88, v84, 0x41700000, v90
    v_fmamk_f32 v80, v81, 0x41200000, v80
    v_fmamk_f32 v88, v89, 0x41200000, v88
    v_cvt_pk_bf16_f32 v4, v77, v85
    v_cvt_pk_bf16_f32 v8, v78, v86
    v_cvt_pk_bf16_f32 v64, v79, v87
    v_cvt_pk_bf16_f32 v68, v82, v90
    v_cvt_pk_bf16_f32 v72, v80, v88
    v_lshlrev_b32 v76, 16, v1
    v_and_b32 v84, s25, v1
    v_lshlrev_b32 v77, 16, v5
    v_and_b32 v85, s25, v5
    v_lshlrev_b32 v78, 16, v9
    v_and_b32 v86, s25, v9
    buffer_load_dwordx4 v[32:35], v92, s[8:11], s24 offen offset:0
    buffer_load_dwordx4 v[48:51], v92, s[8:11], s24 offen offset:64
    v_add_u32 v92, 128, v92
    v_lshlrev_b32 v79, 16, v13
    v_and_b32 v87, s25, v13
    v_add_f32 v80, v76, v78
    v_add_f32 v88, v84, v86
    v_add_f32 v81, v77, v79
    v_add_f32 v89, v85, v87
    v_fma_f32 v82, v78, 4.0, v76
    v_fma_f32 v90, v86, 4.0, v84
    v_fma_f32 v83, v79, 4.0, v77
    v_fma_f32 v91, v87, 4.0, v85
    v_add_f32 v77, v80, v81
    v_add_f32 v85, v88, v89
    v_sub_f32 v78, v80, v81
    v_sub_f32 v86, v88, v89
    v_fma_f32 v79, v83, 2.0, v82
    v_fma_f32 v87, v91, 2.0, v90
    v_fma_f32 v82, v83, -2.0, v82
    v_fma_f32 v90, v91, -2.0, v90
    v_fmamk_f32 v80, v76, 0x41700000, v82
    v_fmamk_f32 v88, v84, 0x41700000, v90
    v_fmamk_f32 v80, v81, 0x41200000, v80
    v_fmamk_f32 v88, v89, 0x41200000, v88
    v_cvt_pk_bf16_f32 v5, v77, v85
    v_cvt_pk_bf16_f32 v9, v78, v86
    v_cvt_pk_bf16_f32 v65, v79, v87
    v_cvt_pk_bf16_f32 v69, v82, v90
    v_cvt_pk_bf16_f32 v73, v80, v88
    v_lshlrev_b32 v76, 16, v2
    v_and_b32 v84, s25, v2
    v_lshlrev_b32 v77, 16, v6
    v_and_b32 v85, s25, v6
    v_lshlrev_b32 v78, 16, v10
    v_and_b32 v86, s25, v10
    v_lshlrev_b32 v79, 16, v14
    v_and_b32 v87, s25, v14
    v_add_f32 v80, v76, v78
    v_add_f32 v88, v84, v86
    v_add_f32 v81, v77, v79
    v_add_f32 v89, v85, v87
    v_fma_f32 v82, v78, 4.0, v76
    v_fma_f32 v90, v86, 4.0, v84
    v_fma_f32 v83, v79, 4.0, v77
    v_fma_f32 v91, v87, 4.0, v85
    v_add_f32 v77, v80, v81
    v_add_f32 v85, v88, v89
    v_sub_f32 v78, v80, v81
    v_sub_f32 v86, v88, v89
    v_fma_f32 v79, v83, 2.0, v82
    v_fma_f32 v87, v91, 2.0, v90
    v_fma_f32 v82, v83, -2.0, v82
    v_fma_f32 v90, v91, -2.0, v90
    v_fmamk_f32 v80, v76, 0x41700000, v82
    v_fmamk_f32 v88, v84, 0x41700000, v90
    buffer_load_dwordx4 v[36:39], v93, s[8:11], s24 offen offset:0
    buffer_load_dwordx4 v[52:55], v93, s[8:11], s24 offen offset:64
    v_add_u32 v93, 128, v93
    v_fmamk_f32 v80, v81, 0x41200000, v80
    v_fmamk_f32 v88, v89, 0x41200000, v88
    v_cvt_pk_bf16_f32 v6, v77, v85
    v_cvt_pk_bf16_f32 v10, v78, v86
    v_cvt_pk_bf16_f32 v66, v79, v87
    v_cvt_pk_bf16_f32 v70, v82, v90
    v_cvt_pk_bf16_f32 v74, v80, v88
    v_lshlrev_b32 v76, 16, v3
    v_and_b32 v84, s25, v3
    v_lshlrev_b32 v77, 16, v7
    v_and_b32 v85, s25, v7
    v_lshlrev_b32 v78, 16, v11
    v_and_b32 v86, s25, v11
    v_lshlrev_b32 v79, 16, v15
    v_and_b32 v87, s25, v15
    v_add_f32 v80, v76, v78
    v_add_f32 v88, v84, v86
    v_add_f32 v81, v77, v79
    v_add_f32 v89, v85, v87
    v_fma_f32 v82, v78, 4.0, v76
    v_fma_f32 v90, v86, 4.0, v84
    v_fma_f32 v83, v79, 4.0, v77
    v_fma_f32 v91, v87, 4.0, v85
    v_add_f32 v77, v80, v81
    v_add_f32 v85, v88, v89
    v_sub_f32 v78, v80, v81
    v_sub_f32 v86, v88, v89
    v_fma_f32 v79, v83, 2.0, v82
    v_fma_f32 v87, v91, 2.0, v90
    v_fma_f32 v82, v83, -2.0, v82
    v_fma_f32 v90, v91, -2.0, v90
    v_fmamk_f32 v80, v76, 0x41700000, v82
    v_fmamk_f32 v88, v84, 0x41700000, v90
    v_fmamk_f32 v80, v81, 0x41200000, v80
    v_fmamk_f32 v88, v89, 0x41200000, v88
    v_cvt_pk_bf16_f32 v7, v77, v85
    v_cvt_pk_bf16_f32 v11, v78, v86
    v_cvt_pk_bf16_f32 v67, v79, v87
    v_cvt_pk_bf16_f32 v71, v82, v90
    v_cvt_pk_bf16_f32 v75, v80, v88
    ds_write_b128 v96, v[64:67] offset:49152
    ds_write_b128 v97, v[68:71] offset:0
    ds_write_b128 v97, v[72:75] offset:16384
    ds_write_b128 v96, v[0:3] offset:0
    ds_write_b128 v96, v[4:7] offset:16384
    ds_write_b128 v96, v[8:11] offset:32768
    ds_write_b128 v98, v[12:15] offset:0
    s_add_u32 s28, s28, 1
    s_waitcnt lgkmcnt(0)
    s_barrier
    s_sub_u32 s22, s22, 1
    s_branch L_conv1_kernel_hloop1
L_conv1_kernel_hlast1:
    s_branch L_conv1_kernel_end
L_conv1_kernel_h2:
    ds_write_b128 v96, v[0:3] offset:0
    ds_write_b128 v98, v[12:15] offset:0
    v_lshlrev_b32 v76, 16, v0
    v_and_b32 v84, s25, v0
    v_lshlrev_b32 v77, 16, v4
    v_and_b32 v85, s25, v4
    v_lshlrev_b32 v78, 16, v8
    v_and_b32 v86, s25, v8
    v_lshlrev_b32 v79, 16, v12
    v_and_b32 v87, s25, v12
    v_add_f32 v80, v76, v78
    v_add_f32 v88, v84, v86
    v_add_f32 v81, v77, v79
    v_add_f32 v89, v85, v87
    v_fma_f32 v82, v78, 4.0, v76
    v_fma_f32 v90, v86, 4.0, v84
    v_fma_f32 v83, v79, 4.0, v77
    v_fma_f32 v91, v87, 4.0, v85
    v_add_f32 v77, v80, v81
    v_add_f32 v85, v88, v89
    v_sub_f32 v78, v80, v81
    v_sub_f32 v86, v88, v89
    v_fma_f32 v79, v83, 2.0, v82
    v_fma_f32 v87, v91, 2.0, v90
    v_fma_f32 v82, v83, -2.0, v82
    v_fma_f32 v90, v91, -2.0, v90
    v_fmamk_f32 v80, v76, 0x41700000, v82
    v_fmamk_f32 v88, v84, 0x41700000, v90
    v_fmamk_f32 v80, v81, 0x41200000, v80
    v_fmamk_f32 v88, v89, 0x41200000, v88
    v_cvt_pk_bf16_f32 v4, v77, v85
    v_cvt_pk_bf16_f32 v8, v78, v86
    v_cvt_pk_bf16_f32 v64, v79, v87
    v_cvt_pk_bf16_f32 v68, v82, v90
    v_cvt_pk_bf16_f32 v72, v80, v88
    v_lshlrev_b32 v76, 16, v1
    v_and_b32 v84, s25, v1
    v_lshlrev_b32 v77, 16, v5
    v_and_b32 v85, s25, v5
    v_lshlrev_b32 v78, 16, v9
    v_and_b32 v86, s25, v9
    v_lshlrev_b32 v79, 16, v13
    v_and_b32 v87, s25, v13
    v_add_f32 v80, v76, v78
    v_add_f32 v88, v84, v86
    v_add_f32 v81, v77, v79
    v_add_f32 v89, v85, v87
    v_fma_f32 v82, v78, 4.0, v76
    v_fma_f32 v90, v86, 4.0, v84
    v_fma_f32 v83, v79, 4.0, v77
    v_fma_f32 v91, v87, 4.0, v85
    v_add_f32 v77, v80, v81
    v_add_f32 v85, v88, v89
    v_sub_f32 v78, v80, v81
    v_sub_f32 v86, v88, v89
    v_fma_f32 v79, v83, 2.0, v82
    v_fma_f32 v87, v91, 2.0, v90
    v_fma_f32 v82, v83, -2.0, v82
    v_fma_f32 v90, v91, -2.0, v90
    v_fmamk_f32 v80, v76, 0x41700000, v82
    v_fmamk_f32 v88, v84, 0x41700000, v90
    v_fmamk_f32 v80, v81, 0x41200000, v80
    v_fmamk_f32 v88, v89, 0x41200000, v88
    v_cvt_pk_bf16_f32 v5, v77, v85
    v_cvt_pk_bf16_f32 v9, v78, v86
    v_cvt_pk_bf16_f32 v65, v79, v87
    v_cvt_pk_bf16_f32 v69, v82, v90
    v_cvt_pk_bf16_f32 v73, v80, v88
    v_lshlrev_b32 v76, 16, v2
    v_and_b32 v84, s25, v2
    v_lshlrev_b32 v77, 16, v6
    v_and_b32 v85, s25, v6
    v_lshlrev_b32 v78, 16, v10
    v_and_b32 v86, s25, v10
    v_lshlrev_b32 v79, 16, v14
    v_and_b32 v87, s25, v14
    v_add_f32 v80, v76, v78
    v_add_f32 v88, v84, v86
    v_add_f32 v81, v77, v79
    v_add_f32 v89, v85, v87
    v_fma_f32 v82, v78, 4.0, v76
    v_fma_f32 v90, v86, 4.0, v84
    v_fma_f32 v83, v79, 4.0, v77
    v_fma_f32 v91, v87, 4.0, v85
    v_add_f32 v77, v80, v81
    v_add_f32 v85, v88, v89
    v_sub_f32 v78, v80, v81
    v_sub_f32 v86, v88, v89
    v_fma_f32 v79, v83, 2.0, v82
    v_fma_f32 v87, v91, 2.0, v90
    v_fma_f32 v82, v83, -2.0, v82
    v_fma_f32 v90, v91, -2.0, v90
    v_fmamk_f32 v80, v76, 0x41700000, v82
    v_fmamk_f32 v88, v84, 0x41700000, v90
    v_fmamk_f32 v80, v81, 0x41200000, v80
    v_fmamk_f32 v88, v89, 0x41200000, v88
    v_cvt_pk_bf16_f32 v6, v77, v85
    v_cvt_pk_bf16_f32 v10, v78, v86
    v_cvt_pk_bf16_f32 v66, v79, v87
    v_cvt_pk_bf16_f32 v70, v82, v90
    v_cvt_pk_bf16_f32 v74, v80, v88
    v_lshlrev_b32 v76, 16, v3
    v_and_b32 v84, s25, v3
    v_lshlrev_b32 v77, 16, v7
    v_and_b32 v85, s25, v7
    v_lshlrev_b32 v78, 16, v11
    v_and_b32 v86, s25, v11
    v_lshlrev_b32 v79, 16, v15
    v_and_b32 v87, s25, v15
    v_add_f32 v80, v76, v78
    v_add_f32 v88, v84, v86
    v_add_f32 v81, v77, v79
    v_add_f32 v89, v85, v87
    v_fma_f32 v82, v78, 4.0, v76
    v_fma_f32 v90, v86, 4.0, v84
    v_fma_f32 v83, v79, 4.0, v77
    v_fma_f32 v91, v87, 4.0, v85
    v_add_f32 v77, v80, v81
    v_add_f32 v85, v88, v89
    v_sub_f32 v78, v80, v81
    v_sub_f32 v86, v88, v89
    v_fma_f32 v79, v83, 2.0, v82
    v_fma_f32 v87, v91, 2.0, v90
    v_fma_f32 v82, v83, -2.0, v82
    v_fma_f32 v90, v91, -2.0, v90
    v_fmamk_f32 v80, v76, 0x41700000, v82
    v_fmamk_f32 v88, v84, 0x41700000, v90
    v_fmamk_f32 v80, v81, 0x41200000, v80
    v_fmamk_f32 v88, v89, 0x41200000, v88
    v_cvt_pk_bf16_f32 v7, v77, v85
    v_cvt_pk_bf16_f32 v11, v78, v86
    v_cvt_pk_bf16_f32 v67, v79, v87
    v_cvt_pk_bf16_f32 v71, v82, v90
    v_cvt_pk_bf16_f32 v75, v80, v88
    ds_write_b128 v96, v[64:67] offset:49152
    ds_write_b128 v97, v[68:71] offset:0
    ds_write_b128 v97, v[72:75] offset:16384
    ds_write_b128 v96, v[4:7] offset:16384
    ds_write_b128 v96, v[8:11] offset:32768
    s_waitcnt vmcnt(0)
    buffer_load_dwordx4 v[32:35], v92, s[8:11], s24 offen offset:0
    buffer_load_dwordx4 v[48:51], v92, s[8:11], s24 offen offset:64
    v_add_u32 v92, 128, v92
    buffer_load_dwordx4 v[36:39], v93, s[8:11], s24 offen offset:0
    buffer_load_dwordx4 v[52:55], v93, s[8:11], s24 offen offset:64
    v_add_u32 v93, 128, v93
    buffer_load_dwordx4 v[40:43], v94, s[8:11], s24 offen offset:0
    buffer_load_dwordx4 v[56:59], v94, s[8:11], s24 offen offset:64
    v_add_u32 v94, 128, v94
    buffer_load_dwordx4 v[44:47], v95, s[8:11], s24 offen offset:0
    buffer_load_dwordx4 v[60:63], v95, s[8:11], s24 offen offset:64
    v_add_u32 v95, 128, v95
    s_waitcnt lgkmcnt(0)
    s_barrier
    s_setprio 0
    v_lshlrev_b32 v76, 16, v16
    v_and_b32 v84, s25, v16
    v_lshlrev_b32 v77, 16, v20
    v_and_b32 v85, s25, v20
    v_lshlrev_b32 v78, 16, v24
    v_and_b32 v86, s25, v24
    v_lshlrev_b32 v79, 16, v28
    v_and_b32 v87, s25, v28
    v_add_f32 v80, v76, v78
    v_add_f32 v88, v84, v86
    v_add_f32 v81, v77, v79
    v_add_f32 v89, v85, v87
    v_fma_f32 v82, v78, 4.0, v76
    v_fma_f32 v90, v86, 4.0, v84
    v_fma_f32 v83, v79, 4.0, v77
    v_fma_f32 v91, v87, 4.0, v85
    v_add_f32 v77, v80, v81
    v_add_f32 v85, v88, v89
    v_sub_f32 v78, v80, v81
    v_sub_f32 v86, v88, v89
    v_fma_f32 v79, v83, 2.0, v82
    v_fma_f32 v87, v91, 2.0, v90
    v_fma_f32 v82, v83, -2.0, v82
    v_fma_f32 v90, v91, -2.0, v90
    v_fmamk_f32 v80, v76, 0x41700000, v82
    v_fmamk_f32 v88, v84, 0x41700000, v90
    v_fmamk_f32 v80, v81, 0x41200000, v80
    v_fmamk_f32 v88, v89, 0x41200000, v88
    v_cvt_pk_bf16_f32 v20, v77, v85
    v_cvt_pk_bf16_f32 v24, v78, v86
    v_cvt_pk_bf16_f32 v64, v79, v87
    v_cvt_pk_bf16_f32 v68, v82, v90
    v_cvt_pk_bf16_f32 v72, v80, v88
    v_lshlrev_b32 v76, 16, v17
    v_and_b32 v84, s25, v17
    v_lshlrev_b32 v77, 16, v21
    v_and_b32 v85, s25, v21
    v_lshlrev_b32 v78, 16, v25
    v_and_b32 v86, s25, v25
    v_lshlrev_b32 v79, 16, v29
    v_and_b32 v87, s25, v29
    v_add_f32 v80, v76, v78
    v_add_f32 v88, v84, v86
    v_add_f32 v81, v77, v79
    v_add_f32 v89, v85, v87
    v_fma_f32 v82, v78, 4.0, v76
    v_fma_f32 v90, v86, 4.0, v84
    v_fma_f32 v83, v79, 4.0, v77
    v_fma_f32 v91, v87, 4.0, v85
    v_add_f32 v77, v80, v81
    v_add_f32 v85, v88, v89
    v_sub_f32 v78, v80, v81
    v_sub_f32 v86, v88, v89
    v_fma_f32 v79, v83, 2.0, v82
    v_fma_f32 v87, v91, 2.0, v90
    v_fma_f32 v82, v83, -2.0, v82
    v_fma_f32 v90, v91, -2.0, v90
    v_fmamk_f32 v80, v76, 0x41700000, v82
    v_fmamk_f32 v88, v84, 0x41700000, v90
    v_fmamk_f32 v80, v81, 0x41200000, v80
    v_fmamk_f32 v88, v89, 0x41200000, v88
    v_cvt_pk_bf16_f32 v21, v77, v85
    v_cvt_pk_bf16_f32 v25, v78, v86
    v_cvt_pk_bf16_f32 v65, v79, v87
    v_cvt_pk_bf16_f32 v69, v82, v90
    v_cvt_pk_bf16_f32 v73, v80, v88
    v_lshlrev_b32 v76, 16, v18
    v_and_b32 v84, s25, v18
    v_lshlrev_b32 v77, 16, v22
    v_and_b32 v85, s25, v22
    v_lshlrev_b32 v78, 16, v26
    v_and_b32 v86, s25, v26
    v_lshlrev_b32 v79, 16, v30
    v_and_b32 v87, s25, v30
    v_add_f32 v80, v76, v78
    v_add_f32 v88, v84, v86
    v_add_f32 v81, v77, v79
    v_add_f32 v89, v85, v87
    v_fma_f32 v82, v78, 4.0, v76
    v_fma_f32 v90, v86, 4.0, v84
    v_fma_f32 v83, v79, 4.0, v77
    v_fma_f32 v91, v87, 4.0, v85
    v_add_f32 v77, v80, v81
    v_add_f32 v85, v88, v89
    v_sub_f32 v78, v80, v81
    v_sub_f32 v86, v88, v89
    v_fma_f32 v79, v83, 2.0, v82
    v_fma_f32 v87, v91, 2.0, v90
    v_fma_f32 v82, v83, -2.0, v82
    v_fma_f32 v90, v91, -2.0, v90
    v_fmamk_f32 v80, v76, 0x41700000, v82
    v_fmamk_f32 v88, v84, 0x41700000, v90
    v_fmamk_f32 v80, v81, 0x41200000, v80
    v_fmamk_f32 v88, v89, 0x41200000, v88
    v_cvt_pk_bf16_f32 v22, v77, v85
    v_cvt_pk_bf16_f32 v26, v78, v86
    v_cvt_pk_bf16_f32 v66, v79, v87
    v_cvt_pk_bf16_f32 v70, v82, v90
    v_cvt_pk_bf16_f32 v74, v80, v88
    v_lshlrev_b32 v76, 16, v19
    v_and_b32 v84, s25, v19
    v_lshlrev_b32 v77, 16, v23
    v_and_b32 v85, s25, v23
    v_lshlrev_b32 v78, 16, v27
    v_and_b32 v86, s25, v27
    v_lshlrev_b32 v79, 16, v31
    v_and_b32 v87, s25, v31
    v_add_f32 v80, v76, v78
    v_add_f32 v88, v84, v86
    v_add_f32 v81, v77, v79
    v_add_f32 v89, v85, v87
    v_fma_f32 v82, v78, 4.0, v76
    v_fma_f32 v90, v86, 4.0, v84
    v_fma_f32 v83, v79, 4.0, v77
    v_fma_f32 v91, v87, 4.0, v85
    v_add_f32 v77, v80, v81
    v_add_f32 v85, v88, v89
    v_sub_f32 v78, v80, v81
    v_sub_f32 v86, v88, v89
    v_fma_f32 v79, v83, 2.0, v82
    v_fma_f32 v87, v91, 2.0, v90
    v_fma_f32 v82, v83, -2.0, v82
    v_fma_f32 v90, v91, -2.0, v90
    v_fmamk_f32 v80, v76, 0x41700000, v82
    v_fmamk_f32 v88, v84, 0x41700000, v90
    v_fmamk_f32 v80, v81, 0x41200000, v80
    v_fmamk_f32 v88, v89, 0x41200000, v88
    v_cvt_pk_bf16_f32 v23, v77, v85
    v_cvt_pk_bf16_f32 v27, v78, v86
    v_cvt_pk_bf16_f32 v67, v79, v87
    v_cvt_pk_bf16_f32 v71, v82, v90
    v_cvt_pk_bf16_f32 v75, v80, v88
L_conv1_kernel_hloop2:
    s_cmp_lt_u32 s28, 12
    s_cselect_b32 s24, 0, 2130706432
    ds_write_b128 v96, v[64:67] offset:57344
    ds_write_b128 v97, v[68:71] offset:8192
    ds_write_b128 v97, v[72:75] offset:24576
    ds_write_b128 v96, v[16:19] offset:8192
    ds_write_b128 v96, v[20:23] offset:24576
    ds_write_b128 v96, v[24:27] offset:40960
    ds_write_b128 v98, v[28:31] offset:8704
    s_waitcnt vmcnt(0)
    v_lshlrev_b32 v76, 16, v32
    v_and_b32 v84, s25, v32
    v_lshlrev_b32 v77, 16, v36
    v_and_b32 v85, s25, v36
    v_lshlrev_b32 v78, 16, v40
    v_and_b32 v86, s25, v40
    v_lshlrev_b32 v79, 16, v44
    v_and_b32 v87, s25, v44
    v_add_f32 v80, v76, v78
    v_add_f32 v88, v84, v86
    v_add_f32 v81, v77, v79
    v_add_f32 v89, v85, v87
    v_fma_f32 v82, v78, 4.0, v76
    v_fma_f32 v90, v86, 4.0, v84
    v_fma_f32 v83, v79, 4.0, v77
    v_fma_f32 v91, v87, 4.0, v85
    v_add_f32 v77, v80, v81
    v_add_f32 v85, v88, v89
    v_sub_f32 v78, v80, v81
    v_sub_f32 v86, v88, v89
    v_fma_f32 v79, v83, 2.0, v82
    v_fma_f32 v87, v91, 2.0, v90
    v_fma_f32 v82, v83, -2.0, v82
    v_fma_f32 v90, v91, -2.0, v90
    v_fmamk_f32 v80, v76, 0x41700000, v82
    v_fmamk_f32 v88, v84, 0x41700000, v90
    buffer_load_dwordx4 v[0:3], v92, s[8:11], s24 offen offset:0
    buffer_load_dwordx4 v[16:19], v92, s[8:11], s24 offen offset:64
    v_add_u32 v92, 128, v92
    v_fmamk_f32 v80, v81, 0x41200000, v80
    v_fmamk_f32 v88, v89, 0x41200000, v88
    v_cvt_pk_bf16_f32 v36, v77, v85
    v_cvt_pk_bf16_f32 v40, v78, v86
    v_cvt_pk_bf16_f32 v64, v79, v87
    v_cvt_pk_bf16_f32 v68, v82, v90
    v_cvt_pk_bf16_f32 v72, v80, v88
    v_lshlrev_b32 v76, 16, v33
    v_and_b32 v84, s25, v33
    v_lshlrev_b32 v77, 16, v37
    v_and_b32 v85, s25, v37
    v_lshlrev_b32 v78, 16, v41
    v_and_b32 v86, s25, v41
    v_lshlrev_b32 v79, 16, v45
    v_and_b32 v87, s25, v45
    v_add_f32 v80, v76, v78
    v_add_f32 v88, v84, v86
    v_add_f32 v81, v77, v79
    v_add_f32 v89, v85, v87
    v_fma_f32 v82, v78, 4.0, v76
    v_fma_f32 v90, v86, 4.0, v84
    v_fma_f32 v83, v79, 4.0, v77
    v_fma_f32 v91, v87, 4.0, v85
    v_add_f32 v77, v80, v81
    v_add_f32 v85, v88, v89
    v_sub_f32 v78, v80, v81
    v_sub_f32 v86, v88, v89
    v_fma_f32 v79, v83, 2.0, v82
    v_fma_f32 v87, v91, 2.0, v90
    v_fma_f32 v82, v83, -2.0, v82
    v_fma_f32 v90, v91, -2.0, v90
    v_fmamk_f32 v80, v76, 0x41700000, v82
    v_fmamk_f32 v88, v84, 0x41700000, v90
    v_fmamk_f32 v80, v81, 0x41200000, v80
    v_fmamk_f32 v88, v89, 0x41200000, v88
    v_cvt_pk_bf16_f32 v37, v77, v85
    v_cvt_pk_bf16_f32 v41, v78, v86
    v_cvt_pk_bf16_f32 v65, v79, v87
    v_cvt_pk_bf16_f32 v69, v82, v90
    v_cvt_pk_bf16_f32 v73, v80, v88
    v_lshlrev_b32 v76, 16, v34
    v_and_b32 v84, s25, v34
    v_lshlrev_b32 v77, 16, v38
    v_and_b32 v85, s25, v38
    v_lshlrev_b32 v78, 16, v42
    v_and_b32 v86, s25, v42
    v_lshlrev_b32 v79, 16, v46
    v_and_b32 v87, s25, v46
    v_add_f32 v80, v76, v78
    v_add_f32 v88, v84, v86
    v_add_f32 v81, v77, v79
    v_add_f32 v89, v85, v87
    v_fma_f32 v82, v78, 4.0, v76
    buffer_load_dwordx4 v[4:7], v93, s[8:11], s24 offen offset:0
    buffer_load_dwordx4 v[20:23], v93, s[8:11], s24 offen offset:64
    v_add_u32 v93, 128, v93
    v_fma_f32 v90, v86, 4.0, v84
    v_fma_f32 v83, v79, 4.0, v77
    v_fma_f32 v91, v87, 4.0, v85
    v_add_f32 v77, v80, v81
    v_add_f32 v85, v88, v89
    v_sub_f32 v78, v80, v81
    v_sub_f32 v86, v88, v89
    v_fma_f32 v79, v83, 2.0, v82
    v_fma_f32 v87, v91, 2.0, v90
    v_fma_f32 v82, v83, -2.0, v82
    v_fma_f32 v90, v91, -2.0, v90
    v_fmamk_f32 v80, v76, 0x41700000, v82
    v_fmamk_f32 v88, v84, 0x41700000, v90
    v_fmamk_f32 v80, v81, 0x41200000, v80
    v_fmamk_f32 v88, v89, 0x41200000, v88
    v_cvt_pk_bf16_f32 v38, v77, v85
    v_cvt_pk_bf16_f32 v42, v78, v86
    v_cvt_pk_bf16_f32 v66, v79, v87
    v_cvt_pk_bf16_f32 v70, v82, v90
    v_cvt_pk_bf16_f32 v74, v80, v88
    v_lshlrev_b32 v76, 16, v35
    v_and_b32 v84, s25, v35
    v_lshlrev_b32 v77, 16, v39
    v_and_b32 v85, s25, v39
    v_lshlrev_b32 v78, 16, v43
    v_and_b32 v86, s25, v43
    v_lshlrev_b32 v79, 16, v47
    v_and_b32 v87, s25, v47
    v_add_f32 v80, v76, v78
    v_add_f32 v88, v84, v86
    v_add_f32 v81, v77, v79
    v_add_f32 v89, v85, v87
    v_fma_f32 v82, v78, 4.0, v76
    v_fma_f32 v90, v86, 4.0, v84
    v_fma_f32 v83, v79, 4.0, v77
    v_fma_f32 v91, v87, 4.0, v85
    v_add_f32 v77, v80, v81
    v_add_f32 v85, v88, v89
    v_sub_f32 v78, v80, v81
    v_sub_f32 v86, v88, v89
    v_fma_f32 v79, v83, 2.0, v82
    v_fma_f32 v87, v91, 2.0, v90
    v_fma_f32 v82, v83, -2.0, v82
    v_fma_f32 v90, v91, -2.0, v90
    v_fmamk_f32 v80, v76, 0x41700000, v82
    v_fmamk_f32 v88, v84, 0x41700000, v90
    v_fmamk_f32 v80, v81, 0x41200000, v80
    v_fmamk_f32 v88, v89, 0x41200000, v88
    v_cvt_pk_bf16_f32 v39, v77, v85
    v_cvt_pk_bf16_f32 v43, v78, v86
    v_cvt_pk_bf16_f32 v67, v79, v87
    v_cvt_pk_bf16_f32 v71, v82, v90
    v_cvt_pk_bf16_f32 v75, v80, v88
    s_add_u32 s28, s28, 1
    s_waitcnt lgkmcnt(0)
    s_barrier
    s_cmp_lt_u32 s28, 12
    s_cselect_b32 s24, 0, 2130706432
    ds_write_b128 v96, v[64:67] offset:49152
    ds_write_b128 v97, v[68:71] offset:0
    ds_write_b128 v97, v[72:75] offset:16384
    ds_write_b128 v96, v[32:35] offset:0
    ds_write_b128 v96, v[36:39] offset:16384
    ds_write_b128 v96, v[40:43] offset:32768
    ds_write_b128 v98, v[44:47] offset:0
    v_lshlrev_b32 v76, 16, v48
    v_and_b32 v84, s25, v48
    buffer_load_dwordx4 v[8:11], v94, s[8:11], s24 offen offset:0
    buffer_load_dwordx4 v[24:27], v94, s[8:11], s24 offen offset:64
    v_add_u32 v94, 128, v94
    v_lshlrev_b32 v77, 16, v52
    v_and_b32 v85, s25, v52
    v_lshlrev_b32 v78, 16, v56
    v_and_b32 v86, s25, v56
    v_lshlrev_b32 v79, 16, v60
    v_and_b32 v87, s25, v60
    v_add_f32 v80, v76, v78
    v_add_f32 v88, v84, v86
    v_add_f32 v81, v77, v79
    v_add_f32 v89, v85, v87
    v_fma_f32 v82, v78, 4.0, v76
    v_fma_f32 v90, v86, 4.0, v84
    v_fma_f32 v83, v79, 4.0, v77
    v_fma_f32 v91, v87, 4.0, v85
    v_add_f32 v77, v80, v81
    v_add_f32 v85, v88, v89
    v_sub_f32 v78, v80, v81
    buffer_load_dwordx4 v[12:15], v95, s[8:11], s24 offen offset:0
    buffer_load_dwordx4 v[28:31], v95, s[8:11], s24 offen offset:64
    v_add_u32 v95, 128, v95
    v_sub_f32 v86, v88, v89
    v_fma_f32 v79, v83, 2.0, v82
    v_fma_f32 v87, v91, 2.0, v90
    v_fma_f32 v82, v83, -2.0, v82
    v_fma_f32 v90, v91, -2.0, v90
    v_fmamk_f32 v80, v76, 0x41700000, v82
    v_fmamk_f32 v88, v84, 0x41700000, v90
    v_fmamk_f32 v80, v81, 0x41200000, v80
    v_fmamk_f32 v88, v89, 0x41200000, v88
    v_cvt_pk_bf16_f32 v52, v77, v85
    v_cvt_pk_bf16_f32 v56, v78, v86
    v_cvt_pk_bf16_f32 v64, v79, v87
    v_cvt_pk_bf16_f32 v68, v82, v90
    v_cvt_pk_bf16_f32 v72, v80, v88
    v_lshlrev_b32 v76, 16, v49
    v_and_b32 v84, s25, v49
    v_lshlrev_b32 v77, 16, v53
    v_and_b32 v85, s25, v53
    v_lshlrev_b32 v78, 16, v57
    v_and_b32 v86, s25, v57
    v_lshlrev_b32 v79, 16, v61
    v_and_b32 v87, s25, v61
    v_add_f32 v80, v76, v78
    v_add_f32 v88, v84, v86
    v_add_f32 v81, v77, v79
    v_add_f32 v89, v85, v87
    v_fma_f32 v82, v78, 4.0, v76
    v_fma_f32 v90, v86, 4.0, v84
    v_fma_f32 v83, v79, 4.0, v77
    v_fma_f32 v91, v87, 4.0, v85
    v_add_f32 v77, v80, v81
    v_add_f32 v85, v88, v89
    v_sub_f32 v78, v80, v81
    v_sub_f32 v86, v88, v89
    v_fma_f32 v79, v83, 2.0, v82
    v_fma_f32 v87, v91, 2.0, v90
    v_fma_f32 v82, v83, -2.0, v82
    v_fma_f32 v90, v91, -2.0, v90
    v_fmamk_f32 v80, v76, 0x41700000, v82
    v_fmamk_f32 v88, v84, 0x41700000, v90
    v_fmamk_f32 v80, v81, 0x41200000, v80
    v_fmamk_f32 v88, v89, 0x41200000, v88
    v_cvt_pk_bf16_f32 v53, v77, v85
    v_cvt_pk_bf16_f32 v57, v78, v86
    v_cvt_pk_bf16_f32 v65, v79, v87
    v_cvt_pk_bf16_f32 v69, v82, v90
    v_cvt_pk_bf16_f32 v73, v80, v88
    v_lshlrev_b32 v76, 16, v50
    v_and_b32 v84, s25, v50
    v_lshlrev_b32 v77, 16, v54
    v_and_b32 v85, s25, v54
    v_lshlrev_b32 v78, 16, v58
    v_and_b32 v86, s25, v58
    v_lshlrev_b32 v79, 16, v62
    v_and_b32 v87, s25, v62
    v_add_f32 v80, v76, v78
    v_add_f32 v88, v84, v86
    v_add_f32 v81, v77, v79
    v_add_f32 v89, v85, v87
    v_fma_f32 v82, v78, 4.0, v76
    v_fma_f32 v90, v86, 4.0, v84
    v_fma_f32 v83, v79, 4.0, v77
    v_fma_f32 v91, v87, 4.0, v85
    v_add_f32 v77, v80, v81
    v_add_f32 v85, v88, v89
    v_sub_f32 v78, v80, v81
    v_sub_f32 v86, v88, v89
    v_fma_f32 v79, v83, 2.0, v82
    v_fma_f32 v87, v91, 2.0, v90
    v_fma_f32 v82, v83, -2.0, v82
    v_fma_f32 v90, v91, -2.0, v90
    v_fmamk_f32 v80, v76, 0x41700000, v82
    v_fmamk_f32 v88, v84, 0x41700000, v90
    v_fmamk_f32 v80, v81, 0x41200000, v80
    v_fmamk_f32 v88, v89, 0x41200000, v88
    v_cvt_pk_bf16_f32 v54, v77, v85
    v_cvt_pk_bf16_f32 v58, v78, v86
    v_cvt_pk_bf16_f32 v66, v79, v87
    v_cvt_pk_bf16_f32 v70, v82, v90
    v_cvt_pk_bf16_f32 v74, v80, v88
    v_lshlrev_b32 v76, 16, v51
    v_and_b32 v84, s25, v51
    v_lshlrev_b32 v77, 16, v55
    v_and_b32 v85, s25, v55
    v_lshlrev_b32 v78, 16, v59
    v_and_b32 v86, s25, v59
    v_lshlrev_b32 v79, 16, v63
    v_and_b32 v87, s25, v63
    v_add_f32 v80, v76, v78
    v_add_f32 v88, v84, v86
    v_add_f32 v81, v77, v79
    v_add_f32 v89, v85, v87
    v_fma_f32 v82, v78, 4.0, v76
    v_fma_f32 v90, v86, 4.0, v84
    v_fma_f32 v83, v79, 4.0, v77
    v_fma_f32 v91, v87, 4.0, v85
    v_add_f32 v77, v80, v81
    v_add_f32 v85, v88, v89
    v_sub_f32 v78, v80, v81
    v_sub_f32 v86, v88, v89
    v_fma_f32 v79, v83, 2.0, v82
    v_fma_f32 v87, v91, 2.0, v90
    v_fma_f32 v82, v83, -2.0, v82
    v_fma_f32 v90, v91, -2.0, v90
    v_fmamk_f32 v80, v76, 0x41700000, v82
    v_fmamk_f32 v88, v84, 0x41700000, v90
    v_fmamk_f32 v80, v81, 0x41200000, v80
    v_fmamk_f32 v88, v89, 0x41200000, v88
    v_cvt_pk_bf16_f32 v55, v77, v85
    v_cvt_pk_bf16_f32 v59, v78, v86
    v_cvt_pk_bf16_f32 v67, v79, v87
    v_cvt_pk_bf16_f32 v71, v82, v90
    v_cvt_pk_bf16_f32 v75, v80, v88
    s_add_u32 s28, s28, 1
    s_waitcnt lgkmcnt(0)
    s_barrier
    s_cmp_eq_u32 s22, 1
    s_cbranch_scc1 L_conv1_kernel_hlast2
    s_cmp_lt_u32 s28, 12
    s_cselect_b32 s24, 0, 2130706432
    ds_write_b128 v96, v[64:67] offset:57344
    ds_write_b128 v97, v[68:71] offset:8192
    ds_write_b128 v97, v[72:75] offset:24576
    ds_write_b128 v96, v[48:51] offset:8192
    ds_write_b128 v96, v[52:55] offset:24576
    ds_write_b128 v96, v[56:59] offset:40960
    ds_write_b128 v98, v[60:63] offset:8704
    s_waitcnt vmcnt(0)
    v_lshlrev_b32 v76, 16, v0
    v_and_b32 v84, s25, v0
    v_lshlrev_b32 v77, 16, v4
    v_and_b32 v85, s25, v4
    v_lshlrev_b32 v78, 16, v8
    v_and_b32 v86, s25, v8
    v_lshlrev_b32 v79, 16, v12
    v_and_b32 v87, s25, v12
    v_add_f32 v80, v76, v78
    v_add_f32 v88, v84, v86
    v_add_f32 v81, v77, v79
    v_add_f32 v89, v85, v87
    v_fma_f32 v82, v78, 4.0, v76
    v_fma_f32 v90, v86, 4.0, v84
    v_fma_f32 v83, v79, 4.0, v77
    v_fma_f32 v91, v87, 4.0, v85
    v_add_f32 v77, v80, v81
    v_add_f32 v85, v88, v89
    v_sub_f32 v78, v80, v81
    v_sub_f32 v86, v88, v89
    v_fma_f32 v79, v83, 2.0, v82
    v_fma_f32 v87, v91, 2.0, v90
    v_fma_f32 v82, v83, -2.0, v82
    v_fma_f32 v90, v91, -2.0, v90
    v_fmamk_f32 v80, v76, 0x41700000, v82
    v_fmamk_f32 v88, v84, 0x41700000, v90
    buffer_load_dwordx4 v[32:35], v92, s[8:11], s24 offen offset:0
    buffer_load_dwordx4 v[48:51], v92, s[8:11], s24 offen offset:64
    v_add_u32 v92, 128, v92
    v_fmamk_f32 v80, v81, 0x41200000, v80
    v_fmamk_f32 v88, v89, 0x41200000, v88
    v_cvt_pk_bf16_f32 v4, v77, v85
    v_cvt_pk_bf16_f32 v8, v78, v86
    v_cvt_pk_bf16_f32 v64, v79, v87
    v_cvt_pk_bf16_f32 v68, v82, v90
    v_cvt_pk_bf16_f32 v72, v80, v88
    v_lshlrev_b32 v76, 16, v1
    v_and_b32 v84, s25, v1
    v_lshlrev_b32 v77, 16, v5
    v_and_b32 v85, s25, v5
    v_lshlrev_b32 v78, 16, v9
    v_and_b32 v86, s25, v9
    v_lshlrev_b32 v79, 16, v13
    v_and_b32 v87, s25, v13
    v_add_f32 v80, v76, v78
    v_add_f32 v88, v84, v86
    v_add_f32 v81, v77, v79
    v_add_f32 v89, v85, v87
    v_fma_f32 v82, v78, 4.0, v76
    v_fma_f32 v90, v86, 4.0, v84
    v_fma_f32 v83, v79, 4.0, v77
    v_fma_f32 v91, v87, 4.0, v85
    v_add_f32 v77, v80, v81
    v_add_f32 v85, v88, v89
    v_sub_f32 v78, v80, v81
    v_sub_f32 v86, v88, v89
    v_fma_f32 v79, v83, 2.0, v82
    v_fma_f32 v87, v91, 2.0, v90
    v_fma_f32 v82, v83, -2.0, v82
    v_fma_f32 v90, v91, -2.0, v90
    v_fmamk_f32 v80, v76, 0x41700000, v82
    v_fmamk_f32 v88, v84, 0x41700000, v90
    v_fmamk_f32 v80, v81, 0x41200000, v80
    v_fmamk_f32 v88, v89, 0x41200000, v88
    v_cvt_pk_bf16_f32 v5, v77, v85
    v_cvt_pk_bf16_f32 v9, v78, v86
    v_cvt_pk_bf16_f32 v65, v79, v87
    v_cvt_pk_bf16_f32 v69, v82, v90
    v_cvt_pk_bf16_f32 v73, v80, v88
    v_lshlrev_b32 v76, 16, v2
    v_and_b32 v84, s25, v2
    v_lshlrev_b32 v77, 16, v6
    v_and_b32 v85, s25, v6
    v_lshlrev_b32 v78, 16, v10
    v_and_b32 v86, s25, v10
    v_lshlrev_b32 v79, 16, v14
    v_and_b32 v87, s25, v14
    v_add_f32 v80, v76, v78
    v_add_f32 v88, v84, v86
    v_add_f32 v81, v77, v79
    v_add_f32 v89, v85, v87
    v_fma_f32 v82, v78, 4.0, v76
    buffer_load_dwordx4 v[36:39], v93, s[8:11], s24 offen offset:0
    buffer_load_dwordx4 v[52:55], v93, s[8:11], s24 offen offset:64
    v_add_u32 v93, 128, v93
    v_fma_f32 v90, v86, 4.0, v84
    v_fma_f32 v83, v79, 4.0, v77
    v_fma_f32 v91, v87, 4.0, v85
    v_add_f32 v77, v80, v81
    v_add_f32 v85, v88, v89
    v_sub_f32 v78, v80, v81
    v_sub_f32 v86, v88, v89
    v_fma_f32 v79, v83, 2.0, v82
    v_fma_f32 v87, v91, 2.0, v90
    v_fma_f32 v82, v83, -2.0, v82
    v_fma_f32 v90, v91, -2.0, v90
    v_fmamk_f32 v80, v76, 0x41700000, v82
    v_fmamk_f32 v88, v84, 0x41700000, v90
    v_fmamk_f32 v80, v81, 0x41200000, v80
    v_fmamk_f32 v88, v89, 0x41200000, v88
    v_cvt_pk_bf16_f32 v6, v77, v85
    v_cvt_pk_bf16_f32 v10, v78, v86
    v_cvt_pk_bf16_f32 v66, v79, v87
    v_cvt_pk_bf16_f32 v70, v82, v90
    v_cvt_pk_bf16_f32 v74, v80, v88
    v_lshlrev_b32 v76, 16, v3
    v_and_b32 v84, s25, v3
    v_lshlrev_b32 v77, 16, v7
    v_and_b32 v85, s25, v7
    v_lshlrev_b32 v78, 16, v11
    v_and_b32 v86, s25, v11
    v_lshlrev_b32 v79, 16, v15
    v_and_b32 v87, s25, v15
    v_add_f32 v80, v76, v78
    v_add_f32 v88, v84, v86
    v_add_f32 v81, v77, v79
    v_add_f32 v89, v85, v87
    v_fma_f32 v82, v78, 4.0, v76
    v_fma_f32 v90, v86, 4.0, v84
    v_fma_f32 v83, v79, 4.0, v77
    v_fma_f32 v91, v87, 4.0, v85
    v_add_f32 v77, v80, v81
    v_add_f32 v85, v88, v89
    v_sub_f32 v78, v80, v81
    v_sub_f32 v86, v88, v89
    v_fma_f32 v79, v83, 2.0, v82
    v_fma_f32 v87, v91, 2.0, v90
    v_fma_f32 v82, v83, -2.0, v82
    v_fma_f32 v90, v91, -2.0, v90
    v_fmamk_f32 v80, v76, 0x41700000, v82
    v_fmamk_f32 v88, v84, 0x41700000, v90
    v_fmamk_f32 v80, v81, 0x41200000, v80
    v_fmamk_f32 v88, v89, 0x41200000, v88
    v_cvt_pk_bf16_f32 v7, v77, v85
    v_cvt_pk_bf16_f32 v11, v78, v86
    v_cvt_pk_bf16_f32 v67, v79, v87
    v_cvt_pk_bf16_f32 v71, v82, v90
    v_cvt_pk_bf16_f32 v75, v80, v88
    s_add_u32 s28, s28, 1
    s_waitcnt lgkmcnt(0)
    s_barrier
    s_cmp_lt_u32 s28, 12
    s_cselect_b32 s24, 0, 2130706432
    ds_write_b128 v96, v[64:67] offset:49152
    ds_write_b128 v97, v[68:71] offset:0
    ds_write_b128 v97, v[72:75] offset:16384
    ds_write_b128 v96, v[0:3] offset:0
    ds_write_b128 v96, v[4:7] offset:16384
    ds_write_b128 v96, v[8:11] offset:32768
    ds_write_b128 v98, v[12:15] offset:0
    v_lshlrev_b32 v76, 16, v16
    v_and_b32 v84, s25, v16
    buffer_load_dwordx4 v[40:43], v94, s[8:11], s24 offen offset:0
    buffer_load_dwordx4 v[56:59], v94, s[8:11], s24 offen offset:64
    v_add_u32 v94, 128, v94
    v_lshlrev_b32 v77, 16, v20
    v_and_b32 v85, s25, v20
    v_lshlrev_b32 v78, 16, v24
    v_and_b32 v86, s25, v24
    v_lshlrev_b32 v79, 16, v28
    v_and_b32 v87, s25, v28
    v_add_f32 v80, v76, v78
    v_add_f32 v88, v84, v86
    v_add_f32 v81, v77, v79
    v_add_f32 v89, v85, v87
    v_fma_f32 v82, v78, 4.0, v76
    v_fma_f32 v90, v86, 4.0, v84
    v_fma_f32 v83, v79, 4.0, v77
    v_fma_f32 v91, v87, 4.0, v85
    v_add_f32 v77, v80, v81
    v_add_f32 v85, v88, v89
    v_sub_f32 v78, v80, v81
    buffer_load_dwordx4 v[44:47], v95, s[8:11], s24 offen offset:0
    buffer_load_dwordx4 v[60:63], v95, s[8:11], s24 offen offset:64
    v_add_u32 v95, 128, v95
    v_sub_f32 v86, v88, v89
    v_fma_f32 v79, v83, 2.0, v82
    v_fma_f32 v87, v91, 2.0, v90
    v_fma_f32 v82, v83, -2.0, v82
    v_fma_f32 v90, v91, -2.0, v90
    v_fmamk_f32 v80, v76, 0x41700000, v82
    v_fmamk_f32 v88, v84, 0x41700000, v90
    v_fmamk_f32 v80, v81, 0x41200000, v80
    v_fmamk_f32 v88, v89, 0x41200000, v88
    v_cvt_pk_bf16_f32 v20, v77, v85
    v_cvt_pk_bf16_f32 v24, v78, v86
    v_cvt_pk_bf16_f32 v64, v79, v87
    v_cvt_pk_bf16_f32 v68, v82, v90
    v_cvt_pk_bf16_f32 v72, v80, v88
    v_lshlrev_b32 v76, 16, v17
    v_and_b32 v84, s25, v17
    v_lshlrev_b32 v77, 16, v21
    v_and_b32 v85, s25, v21
    v_lshlrev_b32 v78, 16, v25
    v_and_b32 v86, s25, v25
    v_lshlrev_b32 v79, 16, v29
    v_and_b32 v87, s25, v29
    v_add_f32 v80, v76, v78
    v_add_f32 v88, v84, v86
    v_add_f32 v81, v77, v79
    v_add_f32 v89, v85, v87
    v_fma_f32 v82, v78, 4.0, v76
    v_fma_f32 v90, v86, 4.0, v84
    v_fma_f32 v83, v79, 4.0, v77
    v_fma_f32 v91, v87, 4.0, v85
    v_add_f32 v77, v80, v81
    v_add_f32 v85, v88, v89
    v_sub_f32 v78, v80, v81
    v_sub_f32 v86, v88, v89
    v_fma_f32 v79, v83, 2.0, v82
    v_fma_f32 v87, v91, 2.0, v90
    v_fma_f32 v82, v83, -2.0, v82
    v_fma_f32 v90, v91, -2.0, v90
    v_fmamk_f32 v80, v76, 0x41700000, v82
    v_fmamk_f32 v88, v84, 0x41700000, v90
    v_fmamk_f32 v80, v81, 0x41200000, v80
    v_fmamk_f32 v88, v89, 0x41200000, v88
    v_cvt_pk_bf16_f32 v21, v77, v85
    v_cvt_pk_bf16_f32 v25, v78, v86
    v_cvt_pk_bf16_f32 v65, v79, v87
    v_cvt_pk_bf16_f32 v69, v82, v90
    v_cvt_pk_bf16_f32 v73, v80, v88
    v_lshlrev_b32 v76, 16, v18
    v_and_b32 v84, s25, v18
    v_lshlrev_b32 v77, 16, v22
    v_and_b32 v85, s25, v22
    v_lshlrev_b32 v78, 16, v26
    v_and_b32 v86, s25, v26
    v_lshlrev_b32 v79, 16, v30
    v_and_b32 v87, s25, v30
    v_add_f32 v80, v76, v78
    v_add_f32 v88, v84, v86
    v_add_f32 v81, v77, v79
    v_add_f32 v89, v85, v87
    v_fma_f32 v82, v78, 4.0, v76
    v_fma_f32 v90, v86, 4.0, v84
    v_fma_f32 v83, v79, 4.0, v77
    v_fma_f32 v91, v87, 4.0, v85
    v_add_f32 v77, v80, v81
    v_add_f32 v85, v88, v89
    v_sub_f32 v78, v80, v81
    v_sub_f32 v86, v88, v89
    v_fma_f32 v79, v83, 2.0, v82
    v_fma_f32 v87, v91, 2.0, v90
    v_fma_f32 v82, v83, -2.0, v82
    v_fma_f32 v90, v91, -2.0, v90
    v_fmamk_f32 v80, v76, 0x41700000, v82
    v_fmamk_f32 v88, v84, 0x41700000, v90
    v_fmamk_f32 v80, v81, 0x41200000, v80
    v_fmamk_f32 v88, v89, 0x41200000, v88
    v_cvt_pk_bf16_f32 v22, v77, v85
    v_cvt_pk_bf16_f32 v26, v78, v86
    v_cvt_pk_bf16_f32 v66, v79, v87
    v_cvt_pk_bf16_f32 v70, v82, v90
    v_cvt_pk_bf16_f32 v74, v80, v88
    v_lshlrev_b32 v76, 16, v19
    v_and_b32 v84, s25, v19
    v_lshlrev_b32 v77, 16, v23
    v_and_b32 v85, s25, v23
    v_lshlrev_b32 v78, 16, v27
    v_and_b32 v86, s25, v27
    v_lshlrev_b32 v79, 16, v31
    v_and_b32 v87, s25, v31
    v_add_f32 v80, v76, v78
    v_add_f32 v88, v84, v86
    v_add_f32 v81, v77, v79
    v_add_f32 v89, v85, v87
    v_fma_f32 v82, v78, 4.0, v76
    v_fma_f32 v90, v86, 4.0, v84
    v_fma_f32 v83, v79, 4.0, v77
    v_fma_f32 v91, v87, 4.0, v85
    v_add_f32 v77, v80, v81
    v_add_f32 v85, v88, v89
    v_sub_f32 v78, v80, v81
    v_sub_f32 v86, v88, v89
    v_fma_f32 v79, v83, 2.0, v82
    v_fma_f32 v87, v91, 2.0, v90
    v_fma_f32 v82, v83, -2.0, v82
    v_fma_f32 v90, v91, -2.0, v90
    v_fmamk_f32 v80, v76, 0x41700000, v82
    v_fmamk_f32 v88, v84, 0x41700000, v90
    v_fmamk_f32 v80, v81, 0x41200000, v80
    v_fmamk_f32 v88, v89, 0x41200000, v88
    v_cvt_pk_bf16_f32 v23, v77, v85
    v_cvt_pk_bf16_f32 v27, v78, v86
    v_cvt_pk_bf16_f32 v67, v79, v87
    v_cvt_pk_bf16_f32 v71, v82, v90
    v_cvt_pk_bf16_f32 v75, v80, v88
    s_add_u32 s28, s28, 1
    s_waitcnt lgkmcnt(0)
    s_barrier
    s_sub_u32 s22, s22, 1
    s_branch L_conv1_kernel_hloop2
L_conv1_kernel_hlast2:
    s_waitcnt vmcnt(0)
    s_mov_b32 s58, s20
    s_lshl_b32 s20, s2, 2
    s_add_u32 s20, s20, s32
    v_mov_b32 v1, v127
    s_load_dwordx2 s[8:9], s[0:1], 16
    s_lshr_b32 s22, s20, 8
    s_bfe_u32 s23, s20, 0x40004
    s_bfe_u32 s24, s20, 0x30001
    s_and_b32 s21, s20, 1
    v_lshrrev_b32 v2, 4, v1
    v_lshlrev_b32 v2, 12, v2
    v_and_b32 v3, 15, v1
    v_lshl_add_u32 v2, v3, 2, v2
    s_lshl_b32 s26, s22, 3
    s_lshr_b32 s27, s23, 3
    s_add_u32 s26, s26, s27
    s_lshl_b32 s26, s26, 17
    s_and_b32 s27, s23, 7
    s_lshl_b32 s27, s27, 14
    s_add_u32 s26, s26, s27
    s_lshl_b32 s27, s24, 6
    s_add_u32 s26, s26, s27
    s_mov_b32 s10, 4063232
    s_mov_b32 s11, 0x00020000
    s_add_u32 s37, s26, 262144
    s_add_u32 s38, s26, 524288
    s_add_u32 s39, s26, 786432
    s_waitcnt lgkmcnt(0)
    buffer_load_dword v16, v2, s[8:11], s26 offen offset:0
    buffer_load_dword v17, v2, s[8:11], s26 offen offset:512
    buffer_load_dword v24, v2, s[8:11], s37 offen offset:0
    buffer_load_dword v25, v2, s[8:11], s37 offen offset:512
    buffer_load_dword v32, v2, s[8:11], s38 offen offset:0
    buffer_load_dword v33, v2, s[8:11], s38 offen offset:512
    buffer_load_dword v40, v2, s[8:11], s39 offen offset:0
    buffer_load_dword v41, v2, s[8:11], s39 offen offset:512
    buffer_load_dword v18, v2, s[8:11], s26 offen offset:1024
    buffer_load_dword v19, v2, s[8:11], s26 offen offset:1536
    buffer_load_dword v26, v2, s[8:11], s37 offen offset:1024
    buffer_load_dword v27, v2, s[8:11], s37 offen offset:1536
    buffer_load_dword v34, v2, s[8:11], s38 offen offset:1024
    buffer_load_dword v35, v2, s[8:11], s38 offen offset:1536
    buffer_load_dword v42, v2, s[8:11], s39 offen offset:1024
    buffer_load_dword v43, v2, s[8:11], s39 offen offset:1536
    buffer_load_dword v20, v2, s[8:11], s26 offen offset:2048
    buffer_load_dword v21, v2, s[8:11], s26 offen offset:2560
    buffer_load_dword v28, v2, s[8:11], s37 offen offset:2048
    buffer_load_dword v29, v2, s[8:11], s37 offen offset:2560
    buffer_load_dword v36, v2, s[8:11], s38 offen offset:2048
    buffer_load_dword v37, v2, s[8:11], s38 offen offset:2560
    buffer_load_dword v44, v2, s[8:11], s39 offen offset:2048
    buffer_load_dword v45, v2, s[8:11], s39 offen offset:2560
    buffer_load_dword v22, v2, s[8:11], s26 offen offset:3072
    buffer_load_dword v23, v2, s[8:11], s26 offen offset:3584
    buffer_load_dword v30, v2, s[8:11], s37 offen offset:3072
    buffer_load_dword v31, v2, s[8:11], s37 offen offset:3584
    buffer_load_dword v38, v2, s[8:11], s38 offen offset:3072
    buffer_load_dword v39, v2, s[8:11], s38 offen offset:3584
    buffer_load_dword v46, v2, s[8:11], s39 offen offset:3072
    buffer_load_dword v47, v2, s[8:11], s39 offen offset:3584
    s_add_u32 s12, s30, 9437184
    s_addc_u32 s13, s31, 0
    s_mov_b32 s14, 7340032
    s_mov_b32 s15, 0x00020000
    v_lshlrev_b32 v4, 4, v1
    s_lshl_b32 s27, s24, 4
    s_add_u32 s27, s27, s23
    s_mul_i32 s27, s27, 57344
    s_lshl_b32 s28, s22, 11
    s_add_u32 s27, s27, s28
    s_lshl_b32 s28, s21, 10
    s_add_u32 s27, s27, s28
    s_cmp_eq_u32 s21, 0
    s_mov_b32 s32, 0x07060302
    s_cselect_b32 s32, 0x05040100, s32
    s_mov_b32 s33, 0x03020c0c
    s_cselect_b32 s33, 0x01000c0c, s33
    s_mov_b32 s35, 0x3d2aaaab
    s_mov_b32 s36, 0x3c638e39
    s_mov_b32 s25, 0xffff0000
    ds_write_b128 v96, v[64:67] offset:57344
    ds_write_b128 v97, v[68:71] offset:8192
    ds_write_b128 v97, v[72:75] offset:24576
    ds_write_b128 v96, v[48:51] offset:8192
    ds_write_b128 v96, v[52:55] offset:24576
    ds_write_b128 v96, v[56:59] offset:40960
    ds_write_b128 v98, v[60:63] offset:8704
    s_waitcnt lgkmcnt(0)
    s_barrier
    s_waitcnt vmcnt(24)
    v_perm_b32 v72, v17, v16, s32
    v_perm_b32 v48, v41, v40, s32
    v_perm_b32 v76, v76, v40, s33
    v_perm_b32 v84, v84, v41, s33
    v_perm_b32 v77, v77, v32, s33
    v_perm_b32 v85, v85, v33, s33
    v_perm_b32 v78, v78, v24, s33
    v_perm_b32 v86, v86, v25, s33
    v_perm_b32 v79, v79, v16, s33
    v_perm_b32 v87, v87, v17, s33
    v_add_f32 v80, v76, v78
    v_add_f32 v88, v84, v86
    v_add_f32 v81, v77, v79
    v_add_f32 v89, v85, v87
    v_fma_f32 v82, v78, 4.0, v76
    v_fma_f32 v90, v86, 4.0, v84
    v_fma_f32 v83, v79, 4.0, v77
    v_fma_f32 v91, v87, 4.0, v85
    v_add_f32 v77, v80, v81
    v_add_f32 v85, v88, v89
    v_sub_f32 v78, v80, v81
    v_sub_f32 v86, v88, v89
    v_fma_f32 v79, v83, 2.0, v82
    v_fma_f32 v87, v91, 2.0, v90
    v_fma_f32 v82, v83, -2.0, v82
    v_fma_f32 v90, v91, -2.0, v90
    v_fmamk_f32 v80, v76, 0x41700000, v82
    v_fmamk_f32 v88, v84, 0x41700000, v90
    v_fmamk_f32 v80, v81, 0x41200000, v80
    v_fmamk_f32 v88, v89, 0x41200000, v88
    v_mul_f32 v77, 0.5, v77
    v_mul_f32 v85, 0.5, v85
    v_mul_f32 v78, 0.5, v78
    v_mul_f32 v86, 0.5, v86
    v_mul_f32 v79, s35, v79
    v_mul_f32 v87, s35, v87
    v_mul_f32 v82, s35, v82
    v_mul_f32 v90, s35, v90
    v_mul_f32 v80, s36, v80
    v_mul_f32 v88, s36, v88
    v_cvt_pk_bf16_f32 v52, v77, v85
    v_cvt_pk_bf16_f32 v56, v78, v86
    v_cvt_pk_bf16_f32 v60, v79, v87
    v_cvt_pk_bf16_f32 v64, v82, v90
    v_cvt_pk_bf16_f32 v68, v80, v88
    s_waitcnt vmcnt(16)
    v_perm_b32 v73, v19, v18, s32
    v_perm_b32 v49, v43, v42, s32
    v_perm_b32 v76, v76, v42, s33
    v_perm_b32 v84, v84, v43, s33
    v_perm_b32 v77, v77, v34, s33
    v_perm_b32 v85, v85, v35, s33
    v_perm_b32 v78, v78, v26, s33
    v_perm_b32 v86, v86, v27, s33
    v_perm_b32 v79, v79, v18, s33
    v_perm_b32 v87, v87, v19, s33
    v_add_f32 v80, v76, v78
    v_add_f32 v88, v84, v86
    v_add_f32 v81, v77, v79
    v_add_f32 v89, v85, v87
    v_fma_f32 v82, v78, 4.0, v76
    v_fma_f32 v90, v86, 4.0, v84
    v_fma_f32 v83, v79, 4.0, v77
    v_fma_f32 v91, v87, 4.0, v85
    v_add_f32 v77, v80, v81
    v_add_f32 v85, v88, v89
    v_sub_f32 v78, v80, v81
    v_sub_f32 v86, v88, v89
    v_fma_f32 v79, v83, 2.0, v82
    v_fma_f32 v87, v91, 2.0, v90
    v_fma_f32 v82, v83, -2.0, v82
    v_fma_f32 v90, v91, -2.0, v90
    v_fmamk_f32 v80, v76, 0x41700000, v82
    v_fmamk_f32 v88, v84, 0x41700000, v90
    v_fmamk_f32 v80, v81, 0x41200000, v80
    v_fmamk_f32 v88, v89, 0x41200000, v88
    v_mul_f32 v77, 0.5, v77
    v_mul_f32 v85, 0.5, v85
    v_mul_f32 v78, 0.5, v78
    v_mul_f32 v86, 0.5, v86
    v_mul_f32 v79, s35, v79
    v_mul_f32 v87, s35, v87
    v_mul_f32 v82, s35, v82
    v_mul_f32 v90, s35, v90
    v_mul_f32 v80, s36, v80
    v_mul_f32 v88, s36, v88
    v_cvt_pk_bf16_f32 v53, v77, v85
    v_cvt_pk_bf16_f32 v57, v78, v86
    v_cvt_pk_bf16_f32 v61, v79, v87
    v_cvt_pk_bf16_f32 v65, v82, v90
    v_cvt_pk_bf16_f32 v69, v80, v88
    s_waitcnt vmcnt(8)
    v_perm_b32 v74, v21, v20, s32
    v_perm_b32 v50, v45, v44, s32
    v_perm_b32 v76, v76, v44, s33
    v_perm_b32 v84, v84, v45, s33
    v_perm_b32 v77, v77, v36, s33
    v_perm_b32 v85, v85, v37, s33
    v_perm_b32 v78, v78, v28, s33
    v_perm_b32 v86, v86, v29, s33
    v_perm_b32 v79, v79, v20, s33
    v_perm_b32 v87, v87, v21, s33
    v_add_f32 v80, v76, v78
    v_add_f32 v88, v84, v86
    v_add_f32 v81, v77, v79
    v_add_f32 v89, v85, v87
    v_fma_f32 v82, v78, 4.0, v76
    v_fma_f32 v90, v86, 4.0, v84
    v_fma_f32 v83, v79, 4.0, v77
    v_fma_f32 v91, v87, 4.0, v85
    v_add_f32 v77, v80, v81
    v_add_f32 v85, v88, v89
    v_sub_f32 v78, v80, v81
    v_sub_f32 v86, v88, v89
    v_fma_f32 v79, v83, 2.0, v82
    v_fma_f32 v87, v91, 2.0, v90
    v_fma_f32 v82, v83, -2.0, v82
    v_fma_f32 v90, v91, -2.0, v90
    v_fmamk_f32 v80, v76, 0x41700000, v82
    v_fmamk_f32 v88, v84, 0x41700000, v90
    v_fmamk_f32 v80, v81, 0x41200000, v80
    v_fmamk_f32 v88, v89, 0x41200000, v88
    v_mul_f32 v77, 0.5, v77
    v_mul_f32 v85, 0.5, v85
    v_mul_f32 v78, 0.5, v78
    v_mul_f32 v86, 0.5, v86
    v_mul_f32 v79, s35, v79
    v_mul_f32 v87, s35, v87
    v_mul_f32 v82, s35, v82
    v_mul_f32 v90, s35, v90
    v_mul_f32 v80, s36, v80
    v_mul_f32 v88, s36, v88
    v_cvt_pk_bf16_f32 v54, v77, v85
    v_cvt_pk_bf16_f32 v58, v78, v86
    v_cvt_pk_bf16_f32 v62, v79, v87
    v_cvt_pk_bf16_f32 v66, v82, v90
    v_cvt_pk_bf16_f32 v70, v80, v88
    s_waitcnt vmcnt(0)
    v_perm_b32 v75, v23, v22, s32
    v_perm_b32 v51, v47, v46, s32
    v_perm_b32 v76, v76, v46, s33
    v_perm_b32 v84, v84, v47, s33
    v_perm_b32 v77, v77, v38, s33
    v_perm_b32 v85, v85, v39, s33
    v_perm_b32 v78, v78, v30, s33
    v_perm_b32 v86, v86, v31, s33
    v_perm_b32 v79, v79, v22, s33
    v_perm_b32 v87, v87, v23, s33
    v_add_f32 v80, v76, v78
    v_add_f32 v88, v84, v86
    v_add_f32 v81, v77, v79
    v_add_f32 v89, v85, v87
    v_fma_f32 v82, v78, 4.0, v76
    v_fma_f32 v90, v86, 4.0, v84
    v_fma_f32 v83, v79, 4.0, v77
    v_fma_f32 v91, v87, 4.0, v85
    v_add_f32 v77, v80, v81
    v_add_f32 v85, v88, v89
    v_sub_f32 v78, v80, v81
    v_sub_f32 v86, v88, v89
    v_fma_f32 v79, v83, 2.0, v82
    v_fma_f32 v87, v91, 2.0, v90
    v_fma_f32 v82, v83, -2.0, v82
    v_fma_f32 v90, v91, -2.0, v90
    v_fmamk_f32 v80, v76, 0x41700000, v82
    v_fmamk_f32 v88, v84, 0x41700000, v90
    v_fmamk_f32 v80, v81, 0x41200000, v80
    v_fmamk_f32 v88, v89, 0x41200000, v88
    v_mul_f32 v77, 0.5, v77
    v_mul_f32 v85, 0.5, v85
    v_mul_f32 v78, 0.5, v78
    v_mul_f32 v86, 0.5, v86
    v_mul_f32 v79, s35, v79
    v_mul_f32 v87, s35, v87
    v_mul_f32 v82, s35, v82
    v_mul_f32 v90, s35, v90
    v_mul_f32 v80, s36, v80
    v_mul_f32 v88, s36, v88
    v_cvt_pk_bf16_f32 v55, v77, v85
    v_cvt_pk_bf16_f32 v59, v78, v86
    v_cvt_pk_bf16_f32 v63, v79, v87
    v_cvt_pk_bf16_f32 v67, v82, v90
    v_cvt_pk_bf16_f32 v71, v80, v88
    s_add_u32 s28, s27, 49152
    buffer_store_dwordx4 v[72:75], v4, s[12:15], s28 offen sc1
    s_add_u32 s28, s27, 0
    buffer_store_dwordx4 v[48:51], v4, s[12:15], s28 offen sc1
    s_add_u32 s28, s27, 8192
    buffer_store_dwordx4 v[52:55], v4, s[12:15], s28 offen sc1
    s_add_u32 s28, s27, 16384
    buffer_store_dwordx4 v[56:59], v4, s[12:15], s28 offen sc1
    s_add_u32 s28, s27, 24576
    buffer_store_dwordx4 v[60:63], v4, s[12:15], s28 offen sc1
    s_add_u32 s28, s27, 32768
    buffer_store_dwordx4 v[64:67], v4, s[12:15], s28 offen sc1
    s_add_u32 s28, s27, 40960
    buffer_store_dwordx4 v[68:71], v4, s[12:15], s28 offen sc1
    s_mov_b32 s20, s58
    s_branch L_conv1_kernel_end
L_conv1_kernel_epi:
    s_waitcnt lgkmcnt(0)
    s_barrier
    v_cndmask_b32 v122, v111, v110, vcc
    ds_read_b128 v[0:3], v120 offset:0
    ds_read_b128 v[4:7], v120 offset:16384
    ds_read_b128 v[8:11], v120 offset:32768
    ds_read_b128 v[12:15], v120 offset:49152
    ds_read_b128 v[16:19], v121 offset:0
    ds_read_b128 v[20:23], v121 offset:16384
    ds_read_b128 v[24:27], v121 offset:32768
    ds_read_b128 v[28:31], v64 offset:15360
    ds_read_b128 v[32:35], v120 offset:8192
    ds_read_b128 v[36:39], v120 offset:24576
    ds_read_b128 v[40:43], v120 offset:40960
    ds_read_b128 v[44:47], v120 offset:57344
    ds_read_b128 v[48:51], v121 offset:56320
    ds_read_b128 v[52:55], v121 offset:64512
    ds_read_b128 v[56:59], v64 offset:7168
    s_waitcnt lgkmcnt(7)
    ds_read_b128 v[60:63], v64 offset:23552
    s_waitcnt lgkmcnt(8)
    v_pk_add_f32 v[88:89], v[24:25], v[28:29]
    v_pk_add_f32 v[90:91], v[26:27], v[30:31]
    v_pk_add_f32 v[24:25], v[4:5], v[8:9]
    v_pk_add_f32 v[26:27], v[6:7], v[10:11]
    v_pk_add_f32 v[4:5], v[4:5], v[8:9] neg_lo:[0,1] neg_hi:[0,1]
    v_pk_add_f32 v[6:7], v[6:7], v[10:11] neg_lo:[0,1] neg_hi:[0,1]
    v_pk_add_f32 v[72:73], v[12:13], v[16:17]
    v_pk_add_f32 v[74:75], v[14:15], v[18:19]
    v_pk_add_f32 v[12:13], v[12:13], v[16:17] neg_lo:[0,1] neg_hi:[0,1]
    v_pk_add_f32 v[14:15], v[14:15], v[18:19] neg_lo:[0,1] neg_hi:[0,1]
    v_pk_fma_f32 v[72:73], v[24:25], s[4:5], v[72:73]
    v_pk_fma_f32 v[74:75], v[26:27], s[4:5], v[74:75]
    v_pk_fma_f32 v[20:21], v[0:1], s[10:11], v[20:21]
    v_pk_fma_f32 v[22:23], v[2:3], s[10:11], v[22:23]
    v_pk_fma_f32 v[72:73], v[0:1], s[6:7], v[72:73]
    v_pk_fma_f32 v[74:75], v[2:3], s[6:7], v[74:75]
    v_pk_add_f32 v[24:25], v[24:25], v[0:1] neg_lo:[0,1] neg_hi:[0,1]
    v_pk_add_f32 v[26:27], v[26:27], v[2:3] neg_lo:[0,1] neg_hi:[0,1]
    v_pk_fma_f32 v[72:73], v[88:89], s[8:9], v[72:73]
    v_pk_fma_f32 v[74:75], v[90:91], s[8:9], v[74:75]
    v_pk_add_f32 v[24:25], v[24:25], v[88:89] neg_lo:[0,1] neg_hi:[0,1]
    v_pk_add_f32 v[26:27], v[26:27], v[90:91] neg_lo:[0,1] neg_hi:[0,1]
    v_pk_fma_f32 v[20:21], v[88:89], s[22:23], v[20:21]
    v_pk_fma_f32 v[22:23], v[90:91], s[22:23], v[22:23]
    v_pk_add_f32 v[8:9], v[24:25], v[72:73] neg_lo:[0,1] neg_hi:[0,1]
    v_pk_add_f32 v[10:11], v[26:27], v[74:75] neg_lo:[0,1] neg_hi:[0,1]
    v_pk_fma_f32 v[20:21], v[72:73], s[14:15], v[20:21]
    v_pk_fma_f32 v[22:23], v[74:75], s[14:15], v[22:23]
    v_pk_mul_f32 v[80:81], v[12:13], s[32:33]
    v_pk_mul_f32 v[82:83], v[14:15], s[32:33]
    v_pk_fma_f32 v[20:21], v[8:9], s[12:13], v[20:21]
    v_pk_fma_f32 v[22:23], v[10:11], s[12:13], v[22:23]
    v_pk_fma_f32 v[80:81], v[4:5], s[34:35], v[80:81]
    v_pk_fma_f32 v[82:83], v[6:7], s[34:35], v[82:83]
    v_pk_fma_f32 v[64:65], v[4:5], s[24:25], v[20:21] neg_lo:[0,0,1] neg_hi:[0,0,1]
    v_pk_fma_f32 v[66:67], v[6:7], s[24:25], v[22:23] neg_lo:[0,0,1] neg_hi:[0,0,1]
    v_pk_fma_f32 v[64:65], v[12:13], s[26:27], v[64:65]
    v_pk_fma_f32 v[66:67], v[14:15], s[26:27], v[66:67]
    v_pk_fma_f32 v[80:81], v[64:65], s[38:39], v[80:81]
    v_pk_fma_f32 v[82:83], v[66:67], s[38:39], v[82:83]
    v_pk_add_f32 v[4:5], v[4:5], v[64:65] neg_lo:[0,1] neg_hi:[0,1]
    v_pk_add_f32 v[6:7], v[6:7], v[66:67] neg_lo:[0,1] neg_hi:[0,1]
    v_pk_add_f32 v[4:5], v[4:5], v[80:81] neg_lo:[0,1] neg_hi:[0,1]
    v_pk_add_f32 v[6:7], v[6:7], v[82:83] neg_lo:[0,1] neg_hi:[0,1]
    s_waitcnt lgkmcnt(0)
    v_pk_add_f32 v[92:93], v[56:57], v[60:61]
    v_pk_add_f32 v[94:95], v[58:59], v[62:63]
    v_pk_add_f32 v[56:57], v[36:37], v[40:41]
    v_pk_add_f32 v[58:59], v[38:39], v[42:43]
    v_pk_add_f32 v[36:37], v[36:37], v[40:41] neg_lo:[0,1] neg_hi:[0,1]
    v_pk_add_f32 v[38:39], v[38:39], v[42:43] neg_lo:[0,1] neg_hi:[0,1]
    v_pk_add_f32 v[76:77], v[44:45], v[48:49]
    v_pk_add_f32 v[78:79], v[46:47], v[50:51]
    v_pk_add_f32 v[44:45], v[44:45], v[48:49] neg_lo:[0,1] neg_hi:[0,1]
    v_pk_add_f32 v[46:47], v[46:47], v[50:51] neg_lo:[0,1] neg_hi:[0,1]
    v_pk_fma_f32 v[76:77], v[56:57], s[4:5], v[76:77]
    v_pk_fma_f32 v[78:79], v[58:59], s[4:5], v[78:79]
    v_pk_fma_f32 v[52:53], v[32:33], s[10:11], v[52:53]
    v_pk_fma_f32 v[54:55], v[34:35], s[10:11], v[54:55]
    v_pk_fma_f32 v[76:77], v[32:33], s[6:7], v[76:77]
    v_pk_fma_f32 v[78:79], v[34:35], s[6:7], v[78:79]
    v_pk_add_f32 v[56:57], v[56:57], v[32:33] neg_lo:[0,1] neg_hi:[0,1]
    v_pk_add_f32 v[58:59], v[58:59], v[34:35] neg_lo:[0,1] neg_hi:[0,1]
    v_pk_fma_f32 v[76:77], v[92:93], s[8:9], v[76:77]
    v_pk_fma_f32 v[78:79], v[94:95], s[8:9], v[78:79]
    v_pk_add_f32 v[56:57], v[56:57], v[92:93] neg_lo:[0,1] neg_hi:[0,1]
    v_pk_add_f32 v[58:59], v[58:59], v[94:95] neg_lo:[0,1] neg_hi:[0,1]
    v_pk_fma_f32 v[52:53], v[92:93], s[22:23], v[52:53]
    v_pk_fma_f32 v[54:55], v[94:95], s[22:23], v[54:55]
    v_pk_add_f32 v[40:41], v[56:57], v[76:77] neg_lo:[0,1] neg_hi:[0,1]
    v_pk_add_f32 v[42:43], v[58:59], v[78:79] neg_lo:[0,1] neg_hi:[0,1]
    v_pk_fma_f32 v[52:53], v[76:77], s[14:15], v[52:53]
    v_pk_fma_f32 v[54:55], v[78:79], s[14:15], v[54:55]
    v_pk_mul_f32 v[84:85], v[44:45], s[32:33]
    v_pk_mul_f32 v[86:87], v[46:47], s[32:33]
    v_pk_fma_f32 v[52:53], v[40:41], s[12:13], v[52:53]
    v_pk_fma_f32 v[54:55], v[42:43], s[12:13], v[54:55]
    v_pk_fma_f32 v[84:85], v[36:37], s[34:35], v[84:85]
    v_pk_fma_f32 v[86:87], v[38:39], s[34:35], v[86:87]
    v_pk_fma_f32 v[68:69], v[36:37], s[24:25], v[52:53] neg_lo:[0,0,1] neg_hi:[0,0,1]
    v_pk_fma_f32 v[70:71], v[38:39], s[24:25], v[54:55] neg_lo:[0,0,1] neg_hi:[0,0,1]
    v_pk_fma_f32 v[68:69], v[44:45], s[26:27], v[68:69]
    v_pk_fma_f32 v[70:71], v[46:47], s[26:27], v[70:71]
    v_pk_fma_f32 v[84:85], v[68:69], s[38:39], v[84:85]
    v_pk_fma_f32 v[86:87], v[70:71], s[38:39], v[86:87]
    v_pk_add_f32 v[36:37], v[36:37], v[68:69] neg_lo:[0,1] neg_hi:[0,1]
    v_pk_add_f32 v[38:39], v[38:39], v[70:71] neg_lo:[0,1] neg_hi:[0,1]
    v_pk_add_f32 v[36:37], v[36:37], v[84:85] neg_lo:[0,1] neg_hi:[0,1]
    v_pk_add_f32 v[38:39], v[38:39], v[86:87] neg_lo:[0,1] neg_hi:[0,1]
    s_mov_b32 s36, 0x00010001
    s_mov_b32 s37, 0x00010001
    s_mov_b64 exec, s[36:37]
    ds_write_b128 v127, v[0:3] offset:0
    ds_write_b128 v127, v[32:35] offset:16
    ds_write_b128 v127, v[4:7] offset:32
    ds_write_b128 v127, v[36:39] offset:48
    ds_write_b128 v127, v[8:11] offset:64
    ds_write_b128 v127, v[40:43] offset:80
    s_mov_b64 exec, -1
    v_mov_b32 v44, 0xc0135761
    v_mov_b32 v45, v44
    v_pk_mul_f32 v[16:17], v[64:65], v[64:65]
    v_pk_mul_f32 v[18:19], v[66:67], v[66:67]
    v_pk_mul_f32 v[20:21], v[68:69], v[68:69]
    v_pk_mul_f32 v[22:23], v[70:71], v[70:71]
    v_pk_fma_f32 v[16:17], v[16:17], s[40:41], v[44:45]
    v_pk_fma_f32 v[18:19], v[18:19], s[40:41], v[44:45]
    v_pk_fma_f32 v[20:21], v[20:21], s[40:41], v[44:45]
    v_pk_fma_f32 v[22:23], v[22:23], s[40:41], v[44:45]
    v_pk_mul_f32 v[16:17], v[16:17], v[64:65]
    v_pk_mul_f32 v[18:19], v[18:19], v[66:67]
    v_pk_mul_f32 v[20:21], v[20:21], v[68:69]
    v_pk_mul_f32 v[22:23], v[22:23], v[70:71]
    v_exp_f32 v16, v16
    v_exp_f32 v17, v17
    v_exp_f32 v18, v18
    v_exp_f32 v19, v19
    v_exp_f32 v20, v20
    v_exp_f32 v21, v21
    v_exp_f32 v22, v22
    v_exp_f32 v23, v23
    v_pk_add_f32 v[16:17], v[16:17], s[42:43]
    v_pk_add_f32 v[18:19], v[18:19], s[42:43]
    v_pk_add_f32 v[20:21], v[20:21], s[42:43]
    v_pk_add_f32 v[22:23], v[22:23], s[42:43]
    v_rcp_f32 v16, v16
    v_rcp_f32 v17, v17
    v_rcp_f32 v18, v18
    v_rcp_f32 v19, v19
    v_rcp_f32 v20, v20
    v_rcp_f32 v21, v21
    v_rcp_f32 v22, v22
    v_rcp_f32 v23, v23
    v_pk_mul_f32 v[64:65], v[64:65], v[16:17]
    v_pk_mul_f32 v[66:67], v[66:67], v[18:19]
    v_pk_mul_f32 v[68:69], v[68:69], v[20:21]
    v_pk_mul_f32 v[70:71], v[70:71], v[22:23]
    v_cvt_pk_bf16_f32 v48, v64, v68
    v_cvt_pk_bf16_f32 v49, v65, v69
    v_cvt_pk_bf16_f32 v50, v66, v70
    v_cvt_pk_bf16_f32 v51, v67, v71
    s_mov_b32 s44, 393280
    buffer_store_dwordx4 v[48:51], v122, s[16:19], s44 offen sc1
    s_waitcnt lgkmcnt(0)
    s_barrier
    ds_read_b128 v[96:99], v127 offset:512
    ds_read_b128 v[100:103], v127 offset:528
    ds_read_b128 v[104:107], v127 offset:544
    ds_read_b128 v[108:111], v127 offset:560
    ds_read_b128 v[112:115], v127 offset:576
    ds_read_b128 v[116:119], v127 offset:592
    s_waitcnt lgkmcnt(4)
    v_mov_b32_dpp v96, v0 row_shl:1 row_mask:0xf bank_mask:0xf
    v_mov_b32_dpp v97, v1 row_shl:1 row_mask:0xf bank_mask:0xf
    v_mov_b32_dpp v98, v2 row_shl:1 row_mask:0xf bank_mask:0xf
    v_mov_b32_dpp v99, v3 row_shl:1 row_mask:0xf bank_mask:0xf
    v_mov_b32_dpp v100, v32 row_shl:1 row_mask:0xf bank_mask:0xf
    v_mov_b32_dpp v101, v33 row_shl:1 row_mask:0xf bank_mask:0xf
    v_mov_b32_dpp v102, v34 row_shl:1 row_mask:0xf bank_mask:0xf
    v_mov_b32_dpp v103, v35 row_shl:1 row_mask:0xf bank_mask:0xf
    v_pk_add_f32 v[72:73], v[72:73], v[96:97]
    v_pk_add_f32 v[74:75], v[74:75], v[98:99]
    v_pk_add_f32 v[76:77], v[76:77], v[100:101]
    v_pk_add_f32 v[78:79], v[78:79], v[102:103]
    v_pk_mul_f32 v[24:25], v[72:73], v[72:73]
    v_pk_mul_f32 v[26:27], v[74:75], v[74:75]
    v_pk_mul_f32 v[28:29], v[76:77], v[76:77]
    v_pk_mul_f32 v[30:31], v[78:79], v[78:79]
    v_pk_fma_f32 v[24:25], v[24:25], s[40:41], v[44:45]
    v_pk_fma_f32 v[26:27], v[26:27], s[40:41], v[44:45]
    v_pk_fma_f32 v[28:29], v[28:29], s[40:41], v[44:45]
    v_pk_fma_f32 v[30:31], v[30:31], s[40:41], v[44:45]
    v_pk_mul_f32 v[24:25], v[24:25], v[72:73]
    v_pk_mul_f32 v[26:27], v[26:27], v[74:75]
    v_pk_mul_f32 v[28:29], v[28:29], v[76:77]
    v_pk_mul_f32 v[30:31], v[30:31], v[78:79]
    v_exp_f32 v24, v24
    v_exp_f32 v25, v25
    v_exp_f32 v26, v26
    v_exp_f32 v27, v27
    v_exp_f32 v28, v28
    v_exp_f32 v29, v29
    v_exp_f32 v30, v30
    v_exp_f32 v31, v31
    v_pk_add_f32 v[24:25], v[24:25], s[42:43]
    v_pk_add_f32 v[26:27], v[26:27], s[42:43]
    v_pk_add_f32 v[28:29], v[28:29], s[42:43]
    v_pk_add_f32 v[30:31], v[30:31], s[42:43]
    v_rcp_f32 v24, v24
    v_rcp_f32 v25, v25
    v_rcp_f32 v26, v26
    v_rcp_f32 v27, v27
    v_rcp_f32 v28, v28
    v_rcp_f32 v29, v29
    v_rcp_f32 v30, v30
    v_rcp_f32 v31, v31
    v_pk_mul_f32 v[72:73], v[72:73], v[24:25]
    v_pk_mul_f32 v[74:75], v[74:75], v[26:27]
    v_pk_mul_f32 v[76:77], v[76:77], v[28:29]
    v_pk_mul_f32 v[78:79], v[78:79], v[30:31]
    v_cvt_pk_bf16_f32 v52, v72, v76
    v_cvt_pk_bf16_f32 v53, v73, v77
    v_cvt_pk_bf16_f32 v54, v74, v78
    v_cvt_pk_bf16_f32 v55, v75, v79
    s_mov_b32 s44, 128
    buffer_store_dwordx4 v[52:55], v122, s[16:19], s44 offen sc1
    s_waitcnt lgkmcnt(2)
    v_mov_b32_dpp v104, v4 row_shl:1 row_mask:0xf bank_mask:0xf
    v_mov_b32_dpp v105, v5 row_shl:1 row_mask:0xf bank_mask:0xf
    v_mov_b32_dpp v106, v6 row_shl:1 row_mask:0xf bank_mask:0xf
    v_mov_b32_dpp v107, v7 row_shl:1 row_mask:0xf bank_mask:0xf
    v_mov_b32_dpp v108, v36 row_shl:1 row_mask:0xf bank_mask:0xf
    v_mov_b32_dpp v109, v37 row_shl:1 row_mask:0xf bank_mask:0xf
    v_mov_b32_dpp v110, v38 row_shl:1 row_mask:0xf bank_mask:0xf
    v_mov_b32_dpp v111, v39 row_shl:1 row_mask:0xf bank_mask:0xf
    v_pk_add_f32 v[80:81], v[80:81], v[104:105]
    v_pk_add_f32 v[82:83], v[82:83], v[106:107]
    v_pk_add_f32 v[84:85], v[84:85], v[108:109]
    v_pk_add_f32 v[86:87], v[86:87], v[110:111]
    v_pk_mul_f32 v[16:17], v[80:81], v[80:81]
    v_pk_mul_f32 v[18:19], v[82:83], v[82:83]
    v_pk_mul_f32 v[20:21], v[84:85], v[84:85]
    v_pk_mul_f32 v[22:23], v[86:87], v[86:87]
    v_pk_fma_f32 v[16:17], v[16:17], s[40:41], v[44:45]
    v_pk_fma_f32 v[18:19], v[18:19], s[40:41], v[44:45]
    v_pk_fma_f32 v[20:21], v[20:21], s[40:41], v[44:45]
    v_pk_fma_f32 v[22:23], v[22:23], s[40:41], v[44:45]
    v_pk_mul_f32 v[16:17], v[16:17], v[80:81]
    v_pk_mul_f32 v[18:19], v[18:19], v[82:83]
    v_pk_mul_f32 v[20:21], v[20:21], v[84:85]
    v_pk_mul_f32 v[22:23], v[22:23], v[86:87]
    v_exp_f32 v16, v16
    v_exp_f32 v17, v17
    v_exp_f32 v18, v18
    v_exp_f32 v19, v19
    v_exp_f32 v20, v20
    v_exp_f32 v21, v21
    v_exp_f32 v22, v22
    v_exp_f32 v23, v23
    v_pk_add_f32 v[16:17], v[16:17], s[42:43]
    v_pk_add_f32 v[18:19], v[18:19], s[42:43]
    v_pk_add_f32 v[20:21], v[20:21], s[42:43]
    v_pk_add_f32 v[22:23], v[22:23], s[42:43]
    v_rcp_f32 v16, v16
    v_rcp_f32 v17, v17
    v_rcp_f32 v18, v18
    v_rcp_f32 v19, v19
    v_rcp_f32 v20, v20
    v_rcp_f32 v21, v21
    v_rcp_f32 v22, v22
    v_rcp_f32 v23, v23
    v_pk_mul_f32 v[80:81], v[80:81], v[16:17]
    v_pk_mul_f32 v[82:83], v[82:83], v[18:19]
    v_pk_mul_f32 v[84:85], v[84:85], v[20:21]
    v_pk_mul_f32 v[86:87], v[86:87], v[22:23]
    v_cvt_pk_bf16_f32 v56, v80, v84
    v_cvt_pk_bf16_f32 v57, v81, v85
    v_cvt_pk_bf16_f32 v58, v82, v86
    v_cvt_pk_bf16_f32 v59, v83, v87
    s_mov_b32 s44, 131200
    buffer_store_dwordx4 v[56:59], v122, s[16:19], s44 offen sc1
    s_waitcnt lgkmcnt(0)
    v_mov_b32_dpp v112, v8 row_shl:1 row_mask:0xf bank_mask:0xf
    v_mov_b32_dpp v113, v9 row_shl:1 row_mask:0xf bank_mask:0xf
    v_mov_b32_dpp v114, v10 row_shl:1 row_mask:0xf bank_mask:0xf
    v_mov_b32_dpp v115, v11 row_shl:1 row_mask:0xf bank_mask:0xf
    v_mov_b32_dpp v116, v40 row_shl:1 row_mask:0xf bank_mask:0xf
    v_mov_b32_dpp v117, v41 row_shl:1 row_mask:0xf bank_mask:0xf
    v_mov_b32_dpp v118, v42 row_shl:1 row_mask:0xf bank_mask:0xf
    v_mov_b32_dpp v119, v43 row_shl:1 row_mask:0xf bank_mask:0xf
    v_pk_add_f32 v[88:89], v[88:89], v[112:113]
    v_pk_add_f32 v[90:91], v[90:91], v[114:115]
    v_pk_add_f32 v[92:93], v[92:93], v[116:117]
    v_pk_add_f32 v[94:95], v[94:95], v[118:119]
    v_pk_mul_f32 v[24:25], v[88:89], v[88:89]
    v_pk_mul_f32 v[26:27], v[90:91], v[90:91]
    v_pk_mul_f32 v[28:29], v[92:93], v[92:93]
    v_pk_mul_f32 v[30:31], v[94:95], v[94:95]
    v_pk_fma_f32 v[24:25], v[24:25], s[40:41], v[44:45]
    v_pk_fma_f32 v[26:27], v[26:27], s[40:41], v[44:45]
    v_pk_fma_f32 v[28:29], v[28:29], s[40:41], v[44:45]
    v_pk_fma_f32 v[30:31], v[30:31], s[40:41], v[44:45]
    v_pk_mul_f32 v[24:25], v[24:25], v[88:89]
    v_pk_mul_f32 v[26:27], v[26:27], v[90:91]
    v_pk_mul_f32 v[28:29], v[28:29], v[92:93]
    v_pk_mul_f32 v[30:31], v[30:31], v[94:95]
    v_exp_f32 v24, v24
    v_exp_f32 v25, v25
    v_exp_f32 v26, v26
    v_exp_f32 v27, v27
    v_exp_f32 v28, v28
    v_exp_f32 v29, v29
    v_exp_f32 v30, v30
    v_exp_f32 v31, v31
    v_pk_add_f32 v[24:25], v[24:25], s[42:43]
    v_pk_add_f32 v[26:27], v[26:27], s[42:43]
    v_pk_add_f32 v[28:29], v[28:29], s[42:43]
    v_pk_add_f32 v[30:31], v[30:31], s[42:43]
    v_rcp_f32 v24, v24
    v_rcp_f32 v25, v25
    v_rcp_f32 v26, v26
    v_rcp_f32 v27, v27
    v_rcp_f32 v28, v28
    v_rcp_f32 v29, v29
    v_rcp_f32 v30, v30
    v_rcp_f32 v31, v31
    v_pk_mul_f32 v[88:89], v[88:89], v[24:25]
    v_pk_mul_f32 v[90:91], v[90:91], v[26:27]
    v_pk_mul_f32 v[92:93], v[92:93], v[28:29]
    v_pk_mul_f32 v[94:95], v[94:95], v[30:31]
    v_cvt_pk_bf16_f32 v60, v88, v92
    v_cvt_pk_bf16_f32 v61, v89, v93
    v_cvt_pk_bf16_f32 v62, v90, v94
    v_cvt_pk_bf16_f32 v63, v91, v95
    s_mov_b32 s44, 262272
    buffer_store_dwordx4 v[60:63], v122, s[16:19], s44 offen sc1
L_conv1_kernel_end:
L_conv1_kernel_done:
    s_endpgm
.globl conv2_kernel
.p2align 8
.type conv2_kernel,@function
conv2_kernel:
    s_cmp_ge_u32 s2, 256
    s_cbranch_scc1 L_conv2_kernel_done
    s_load_dwordx2 s[4:5], s[0:1], 72
    s_load_dwordx2 s[30:31], s[0:1], 72
    v_readfirstlane_b32 s20, v0
    s_lshr_b32 s20, s20, 6
    s_and_b32 s36, s2, 0
    s_lshl_b32 s36, s36, 3
    s_bfe_u32 s37, s2, 196611
    s_or_b32 s29, s36, s37
    s_bfe_u32 s36, s2, 196608
    s_lshl_b32 s36, s36, 2
    s_lshr_b32 s37, s2, 6
    s_or_b32 s36, s36, s37
    s_lshr_b32 s33, s36, 4
    s_and_b32 s34, s36, 7
    s_bfe_u32 s35, s36, 0x10003
    s_mul_i32 s21, s34, 500
    s_and_b32 s32, s20, 3
    v_and_b32 v127, 63, v0
    v_lshrrev_b32 v5, 2, v127
    v_and_b32 v6, 3, v127
    s_and_b32 s42, s20, 7
    s_lshr_b32 s41, s21, 2
    s_sub_u32 s41, s41, 1
    s_add_u32 s37, s41, s42
    v_lshl_add_u32 v7, v5, 3, s37
    s_mul_i32 s36, s35, 4194304
    s_add_u32 s36, s36, 18874368
    s_mov_b32 s10, 4194304
    s_mov_b32 s11, 0x00020000
    s_mov_b32 s25, 0xffff0000
    s_waitcnt lgkmcnt(0)
    s_add_u32 s8, s4, s36
    s_addc_u32 s9, s5, 0
    s_cmp_ge_u32 s20, 8
    s_cbranch_scc1 L_conv2_kernel_helper
    s_add_u32 s37, s41, 128
    v_mov_b32 v16, s37
    v_mul_u32_u24 v17, 524288, v5
    v_lshl_add_u32 v17, v6, 4, v17
    s_add_u32 s37, s33, 4294967289
    v_lshl_add_u32 v18, v16, 3, s37
    v_cmp_gt_u32 vcc, 8000, v18
    s_mul_i32 s37, s33, 131072
    s_add_u32 s37, s37, 0
    v_lshl_add_u32 v108, v16, 7, s37
    v_add_u32 v108, v108, v17
    v_mov_b32 v18, 2130706432
    v_cndmask_b32 v108, v18, v108, vcc
    s_add_u32 s37, s33, 4294967291
    v_lshl_add_u32 v18, v16, 3, s37
    v_cmp_gt_u32 vcc, 8000, v18
    s_mul_i32 s37, s33, 131072
    s_add_u32 s37, s37, 262144
    v_lshl_add_u32 v109, v16, 7, s37
    v_add_u32 v109, v109, v17
    v_mov_b32 v18, 2130706432
    v_cndmask_b32 v109, v18, v109, vcc
    s_add_u32 s37, s33, 4294967293
    v_lshl_add_u32 v18, v16, 3, s37
    v_cmp_gt_u32 vcc, 8000, v18
    s_mul_i32 s37, s33, 131072
    s_add_u32 s37, s37, 64
    v_lshl_add_u32 v110, v16, 7, s37
    v_add_u32 v110, v110, v17
    v_mov_b32 v18, 2130706432
    v_cndmask_b32 v110, v18, v110, vcc
    s_lshl_b32 s36, s29, 4
    s_lshl_b32 s37, s33, 3
    s_add_u32 s36, s36, s37
    s_mul_i32 s36, s36, 57344
    s_add_u32 s36, s36, 9437184
    s_add_u32 s12, s30, s36
    s_addc_u32 s13, s31, 0
    s_mov_b32 s14, 458752
    s_mov_b32 s15, 0x00020000
    s_mul_i32 s36, s35, 2097152
    s_add_u32 s36, s36, 27262976
    s_mul_i32 s37, s33, 8388608
    s_add_u32 s36, s36, s37
    s_add_u32 s16, s30, s36
    s_addc_u32 s17, s31, 0
    s_mov_b32 s18, 2097152
    s_mov_b32 s19, 0x00020000
    v_and_b32 v10, 15, v127
    v_lshrrev_b32 v11, 4, v127
    v_add_u32 v8, 0, v10
    v_and_b32 v16, 4, v8
    v_lshrrev_b32 v16, 1, v16
    v_xor_b32 v16, v11, v16
    v_lshlrev_b32 v16, 4, v16
    v_lshl_add_u32 v8, v8, 6, v16
    v_add_u32 v9, 1, v10
    v_and_b32 v16, 4, v9
    v_lshrrev_b32 v16, 1, v16
    v_xor_b32 v16, v11, v16
    v_lshlrev_b32 v16, 4, v16
    v_lshl_add_u32 v9, v9, 6, v16
    s_lshr_b32 s38, s32, 1
    s_and_b32 s39, s32, 1
    s_add_u32 s40, s38, 4
    s_lshl_b32 s43, s39, 10
    s_cmp_lt_u32 s20, 4
    s_cselect_b32 s40, s20, s40
    s_cselect_b32 s36, 0, s43
    s_lshl_b32 s37, s40, 13
    s_add_u32 s37, s37, s36
    v_lshl_add_u32 v125, v127, 4, s37
    s_mul_i32 s37, s40, 16384
    v_add_u32 v120, s37, v8
    v_add_u32 v121, s37, v9
    s_lshl_b32 s37, s40, 10
    s_add_u32 s37, s37, 115712
    v_lshl_add_u32 v16, v11, 4, s37
    v_cmp_eq_u32 vcc, 15, v10
    v_mov_b32 v17, 8192
    v_mov_b32 v18, 4294959104
    v_mov_b32 v19, 64
    v_cndmask_b32 v122, v121, v16, vcc
    v_cndmask_b32 v123, v17, v19, vcc
    v_cndmask_b32 v124, v18, v19, vcc
    v_lshl_add_u32 v126, v127, 4, s37
    s_mov_b32 s44, 0x3f800000
    s_mov_b32 s45, 0x00000000
    s_mov_b32 s46, 0x00000000
    s_cmp_eq_u32 s40, 1
    s_cselect_b32 s45, 0x3f800000, s45
    s_cselect_b32 s46, 0x3f800000, s46
    s_cmp_eq_u32 s40, 2
    s_cselect_b32 s45, 0xbf800000, s45
    s_cselect_b32 s46, 0x3f800000, s46
    s_cmp_eq_u32 s40, 3
    s_cselect_b32 s45, 0x40000000, s45
    s_cselect_b32 s46, 0x40800000, s46
    s_cmp_eq_u32 s40, 4
    s_cselect_b32 s45, 0xc0000000, s45
    s_cselect_b32 s46, 0x40800000, s46
    s_cmp_eq_u32 s40, 5
    s_cselect_b32 s44, 0x41800000, s44
    s_cselect_b32 s45, 0x41000000, s45
    s_cselect_b32 s46, 0x40800000, s46
    s_cmp_ge_u32 s20, 4
    s_cbranch_scc1 L_conv2_kernel_m2
    v_mov_b32 v0, 0
    v_mov_b32 v1, 0
    v_mov_b32 v2, 0
    v_mov_b32 v3, 0
    v_mov_b32 v4, 0
    v_mov_b32 v5, 0
    v_mov_b32 v6, 0
    v_mov_b32 v7, 0
    v_mov_b32 v8, 0
    v_mov_b32 v9, 0
    v_mov_b32 v10, 0
    v_mov_b32 v11, 0
    v_mov_b32 v12, 0
    v_mov_b32 v13, 0
    v_mov_b32 v14, 0
    v_mov_b32 v15, 0
    v_mov_b32 v16, 0
    v_mov_b32 v17, 0
    v_mov_b32 v18, 0
    v_mov_b32 v19, 0
    v_mov_b32 v20, 0
    v_mov_b32 v21, 0
    v_mov_b32 v22, 0
    v_mov_b32 v23, 0
    v_mov_b32 v24, 0
    v_mov_b32 v25, 0
    v_mov_b32 v26, 0
    v_mov_b32 v27, 0
    v_mov_b32 v28, 0
    v_mov_b32 v29, 0
    v_mov_b32 v30, 0
    v_mov_b32 v31, 0
    v_mov_b32 v32, 0
    v_mov_b32 v33, 0
    v_mov_b32 v34, 0
    v_mov_b32 v35, 0
    v_mov_b32 v36, 0
    v_mov_b32 v37, 0
    v_mov_b32 v38, 0
    v_mov_b32 v39, 0
    v_mov_b32 v40, 0
    v_mov_b32 v41, 0
    v_mov_b32 v42, 0
    v_mov_b32 v43, 0
    v_mov_b32 v44, 0
    v_mov_b32 v45, 0
    v_mov_b32 v46, 0
    v_mov_b32 v47, 0
    v_mov_b32 v48, 0
    v_mov_b32 v49, 0
    v_mov_b32 v50, 0
    v_mov_b32 v51, 0
    v_mov_b32 v52, 0
    v_mov_b32 v53, 0
    v_mov_b32 v54, 0
    v_mov_b32 v55, 0
    v_mov_b32 v56, 0
    v_mov_b32 v57, 0
    v_mov_b32 v58, 0
    v_mov_b32 v59, 0
    v_mov_b32 v60, 0
    v_mov_b32 v61, 0
    v_mov_b32 v62, 0
    v_mov_b32 v63, 0
    s_barrier
    buffer_load_dwordx4 v[96:99], v108, s[8:11], 0 offen
    buffer_load_dwordx4 v[100:103], v109, s[8:11], 0 offen
    buffer_load_dwordx4 v[104:107], v110, s[8:11], 0 offen
    s_mov_b32 s23, 0
    s_mov_b32 s26, 4096
    buffer_load_dwordx4 v[64:67], v125, s[12:15], s23 offen offset:0
    buffer_load_dwordx4 v[68:71], v125, s[12:15], s23 offen offset:1024
    buffer_load_dwordx4 v[72:75], v125, s[12:15], s23 offen offset:2048
    buffer_load_dwordx4 v[76:79], v125, s[12:15], s23 offen offset:3072
    buffer_load_dwordx4 v[80:83], v125, s[12:15], s26 offen offset:0
    buffer_load_dwordx4 v[84:87], v125, s[12:15], s26 offen offset:1024
    buffer_load_dwordx4 v[88:91], v125, s[12:15], s26 offen offset:2048
    buffer_load_dwordx4 v[92:95], v125, s[12:15], s26 offen offset:3072
    s_mov_b32 s23, 57344
    s_mov_b32 s26, 61440
    s_waitcnt vmcnt(8)
    v_lshlrev_b32 v108, 16, v96
    v_and_b32 v111, s25, v96
    v_lshlrev_b32 v109, 16, v100
    v_and_b32 v112, s25, v100
    v_lshlrev_b32 v110, 16, v104
    v_and_b32 v113, s25, v104
    v_mul_f32 v114, s44, v108
    v_mul_f32 v115, s44, v111
    v_fmac_f32 v114, s45, v109
    v_fmac_f32 v115, s45, v112
    v_fmac_f32 v114, s46, v110
    v_fmac_f32 v115, s46, v113
    v_cvt_pk_bf16_f32 v96, v114, v115
    v_lshlrev_b32 v108, 16, v97
    v_and_b32 v111, s25, v97
    v_lshlrev_b32 v109, 16, v101
    v_and_b32 v112, s25, v101
    v_lshlrev_b32 v110, 16, v105
    v_and_b32 v113, s25, v105
    v_mul_f32 v114, s44, v108
    v_mul_f32 v115, s44, v111
    v_fmac_f32 v114, s45, v109
    v_fmac_f32 v115, s45, v112
    v_fmac_f32 v114, s46, v110
    v_fmac_f32 v115, s46, v113
    v_cvt_pk_bf16_f32 v97, v114, v115
    v_lshlrev_b32 v108, 16, v98
    v_and_b32 v111, s25, v98
    v_lshlrev_b32 v109, 16, v102
    v_and_b32 v112, s25, v102
    v_lshlrev_b32 v110, 16, v106
    v_and_b32 v113, s25, v106
    v_mul_f32 v114, s44, v108
    v_mul_f32 v115, s44, v111
    v_fmac_f32 v114, s45, v109
    v_fmac_f32 v115, s45, v112
    v_fmac_f32 v114, s46, v110
    v_fmac_f32 v115, s46, v113
    v_cvt_pk_bf16_f32 v98, v114, v115
    v_lshlrev_b32 v108, 16, v99
    v_and_b32 v111, s25, v99
    v_lshlrev_b32 v109, 16, v103
    v_and_b32 v112, s25, v103
    v_lshlrev_b32 v110, 16, v107
    v_and_b32 v113, s25, v107
    v_mul_f32 v114, s44, v108
    v_mul_f32 v115, s44, v111
    v_fmac_f32 v114, s45, v109
    v_fmac_f32 v115, s45, v112
    v_fmac_f32 v114, s46, v110
    v_fmac_f32 v115, s46, v113
    v_cvt_pk_bf16_f32 v99, v114, v115
    ds_write_b128 v126, v[96:99]
    s_waitcnt lgkmcnt(0)
    s_barrier
    s_mov_b32 s22, 4
    s_setprio 2
L_conv2_kernel_mloop1:
    ds_read_b128 v[96:99], v120 offset:0
    ds_read_b128 v[100:103], v120 offset:1024
    ds_read_b128 v[104:107], v120 offset:2048
    ds_read_b128 v[108:111], v120 offset:3072
    ds_read_b128 v[112:115], v120 offset:4096
    ds_read_b128 v[116:119], v120 offset:5120
    s_waitcnt vmcnt(6) lgkmcnt(5)
    v_mfma_f32_16x16x32_bf16 v[0:3], v[64:67], v[96:99], v[0:3]
    v_mfma_f32_16x16x32_bf16 v[32:35], v[68:71], v[96:99], v[32:35]
    ds_read_b128 v[96:99], v120 offset:6144
    s_waitcnt vmcnt(4) lgkmcnt(5)
    v_mfma_f32_16x16x32_bf16 v[4:7], v[64:67], v[100:103], v[4:7]
    v_mfma_f32_16x16x32_bf16 v[36:39], v[68:71], v[100:103], v[36:39]
    v_mfma_f32_16x16x32_bf16 v[0:3], v[72:75], v[100:103], v[0:3]
    v_mfma_f32_16x16x32_bf16 v[32:35], v[76:79], v[100:103], v[32:35]
    ds_read_b128 v[100:103], v120 offset:7168
    s_waitcnt vmcnt(2) lgkmcnt(5)
    v_mfma_f32_16x16x32_bf16 v[8:11], v[64:67], v[104:107], v[8:11]
    v_mfma_f32_16x16x32_bf16 v[40:43], v[68:71], v[104:107], v[40:43]
    v_mfma_f32_16x16x32_bf16 v[4:7], v[72:75], v[104:107], v[4:7]
    v_mfma_f32_16x16x32_bf16 v[36:39], v[76:79], v[104:107], v[36:39]
    v_mfma_f32_16x16x32_bf16 v[0:3], v[80:83], v[104:107], v[0:3]
    v_mfma_f32_16x16x32_bf16 v[32:35], v[84:87], v[104:107], v[32:35]
    ds_read_b128 v[104:107], v122 offset:0
    v_add_u32 v122, v123, v122
    s_waitcnt vmcnt(0) lgkmcnt(5)
    v_mfma_f32_16x16x32_bf16 v[12:15], v[64:67], v[108:111], v[12:15]
    v_mfma_f32_16x16x32_bf16 v[44:47], v[68:71], v[108:111], v[44:47]
    v_mfma_f32_16x16x32_bf16 v[8:11], v[72:75], v[108:111], v[8:11]
    v_mfma_f32_16x16x32_bf16 v[40:43], v[76:79], v[108:111], v[40:43]
    v_mfma_f32_16x16x32_bf16 v[4:7], v[80:83], v[108:111], v[4:7]
    v_mfma_f32_16x16x32_bf16 v[36:39], v[84:87], v[108:111], v[36:39]
    v_mfma_f32_16x16x32_bf16 v[0:3], v[88:91], v[108:111], v[0:3]
    v_mfma_f32_16x16x32_bf16 v[32:35], v[92:95], v[108:111], v[32:35]
    ds_read_b128 v[108:111], v121 offset:1024
    s_waitcnt lgkmcnt(5)
    v_mfma_f32_16x16x32_bf16 v[16:19], v[64:67], v[112:115], v[16:19]
    v_mfma_f32_16x16x32_bf16 v[48:51], v[68:71], v[112:115], v[48:51]
    v_mfma_f32_16x16x32_bf16 v[12:15], v[72:75], v[112:115], v[12:15]
    v_mfma_f32_16x16x32_bf16 v[44:47], v[76:79], v[112:115], v[44:47]
    v_mfma_f32_16x16x32_bf16 v[8:11], v[80:83], v[112:115], v[8:11]
    v_mfma_f32_16x16x32_bf16 v[40:43], v[84:87], v[112:115], v[40:43]
    v_mfma_f32_16x16x32_bf16 v[4:7], v[88:91], v[112:115], v[4:7]
    v_mfma_f32_16x16x32_bf16 v[36:39], v[92:95], v[112:115], v[36:39]
    ds_read_b128 v[112:115], v121 offset:2048
    s_waitcnt lgkmcnt(5)
    v_mfma_f32_16x16x32_bf16 v[20:23], v[64:67], v[116:119], v[20:23]
    v_mfma_f32_16x16x32_bf16 v[52:55], v[68:71], v[116:119], v[52:55]
    v_mfma_f32_16x16x32_bf16 v[16:19], v[72:75], v[116:119], v[16:19]
    v_mfma_f32_16x16x32_bf16 v[48:51], v[76:79], v[116:119], v[48:51]
    v_mfma_f32_16x16x32_bf16 v[12:15], v[80:83], v[116:119], v[12:15]
    v_mfma_f32_16x16x32_bf16 v[44:47], v[84:87], v[116:119], v[44:47]
    v_mfma_f32_16x16x32_bf16 v[8:11], v[88:91], v[116:119], v[8:11]
    v_mfma_f32_16x16x32_bf16 v[40:43], v[92:95], v[116:119], v[40:43]
    s_waitcnt lgkmcnt(4)
    v_mfma_f32_16x16x32_bf16 v[24:27], v[64:67], v[96:99], v[24:27]
    v_mfma_f32_16x16x32_bf16 v[56:59], v[68:71], v[96:99], v[56:59]
    v_mfma_f32_16x16x32_bf16 v[20:23], v[72:75], v[96:99], v[20:23]
    v_mfma_f32_16x16x32_bf16 v[52:55], v[76:79], v[96:99], v[52:55]
    v_mfma_f32_16x16x32_bf16 v[16:19], v[80:83], v[96:99], v[16:19]
    v_mfma_f32_16x16x32_bf16 v[48:51], v[84:87], v[96:99], v[48:51]
    v_mfma_f32_16x16x32_bf16 v[12:15], v[88:91], v[96:99], v[12:15]
    v_mfma_f32_16x16x32_bf16 v[44:47], v[92:95], v[96:99], v[44:47]
    s_waitcnt lgkmcnt(3)
    v_mfma_f32_16x16x32_bf16 v[28:31], v[64:67], v[100:103], v[28:31]
    v_mfma_f32_16x16x32_bf16 v[60:63], v[68:71], v[100:103], v[60:63]
    v_mfma_f32_16x16x32_bf16 v[24:27], v[72:75], v[100:103], v[24:27]
    v_mfma_f32_16x16x32_bf16 v[56:59], v[76:79], v[100:103], v[56:59]
    v_mfma_f32_16x16x32_bf16 v[20:23], v[80:83], v[100:103], v[20:23]
    v_mfma_f32_16x16x32_bf16 v[52:55], v[84:87], v[100:103], v[52:55]
    v_mfma_f32_16x16x32_bf16 v[16:19], v[88:91], v[100:103], v[16:19]
    v_mfma_f32_16x16x32_bf16 v[48:51], v[92:95], v[100:103], v[48:51]
    buffer_load_dwordx4 v[64:67], v125, s[12:15], s23 offen offset:0
    buffer_load_dwordx4 v[68:71], v125, s[12:15], s23 offen offset:1024
    s_waitcnt lgkmcnt(2)
    v_mfma_f32_16x16x32_bf16 v[28:31], v[72:75], v[104:107], v[28:31]
    v_mfma_f32_16x16x32_bf16 v[60:63], v[76:79], v[104:107], v[60:63]
    v_mfma_f32_16x16x32_bf16 v[24:27], v[80:83], v[104:107], v[24:27]
    v_mfma_f32_16x16x32_bf16 v[56:59], v[84:87], v[104:107], v[56:59]
    v_mfma_f32_16x16x32_bf16 v[20:23], v[88:91], v[104:107], v[20:23]
    v_mfma_f32_16x16x32_bf16 v[52:55], v[92:95], v[104:107], v[52:55]
    buffer_load_dwordx4 v[72:75], v125, s[12:15], s23 offen offset:2048
    buffer_load_dwordx4 v[76:79], v125, s[12:15], s23 offen offset:3072
    s_waitcnt lgkmcnt(1)
    v_mfma_f32_16x16x32_bf16 v[28:31], v[80:83], v[108:111], v[28:31]
    v_mfma_f32_16x16x32_bf16 v[60:63], v[84:87], v[108:111], v[60:63]
    v_mfma_f32_16x16x32_bf16 v[24:27], v[88:91], v[108:111], v[24:27]
    v_mfma_f32_16x16x32_bf16 v[56:59], v[92:95], v[108:111], v[56:59]
    buffer_load_dwordx4 v[80:83], v125, s[12:15], s26 offen offset:0
    buffer_load_dwordx4 v[84:87], v125, s[12:15], s26 offen offset:1024
    s_waitcnt lgkmcnt(0)
    v_mfma_f32_16x16x32_bf16 v[28:31], v[88:91], v[112:115], v[28:31]
    v_mfma_f32_16x16x32_bf16 v[60:63], v[92:95], v[112:115], v[60:63]
    buffer_load_dwordx4 v[88:91], v125, s[12:15], s26 offen offset:2048
    buffer_load_dwordx4 v[92:95], v125, s[12:15], s26 offen offset:3072
    s_add_u32 s23, s23, 57344
    s_add_u32 s26, s26, 57344
    s_barrier
    s_sub_u32 s22, s22, 1
    s_cmp_eq_u32 s22, 0
    s_cbranch_scc1 L_conv2_kernel_mlast1
    ds_read_b128 v[96:99], v120 offset:8192
    ds_read_b128 v[100:103], v120 offset:9216
    ds_read_b128 v[104:107], v120 offset:10240
    ds_read_b128 v[108:111], v120 offset:11264
    ds_read_b128 v[112:115], v120 offset:12288
    ds_read_b128 v[116:119], v120 offset:13312
    s_waitcnt vmcnt(6) lgkmcnt(5)
    v_mfma_f32_16x16x32_bf16 v[0:3], v[64:67], v[96:99], v[0:3]
    v_mfma_f32_16x16x32_bf16 v[32:35], v[68:71], v[96:99], v[32:35]
    ds_read_b128 v[96:99], v120 offset:14336
    s_waitcnt vmcnt(4) lgkmcnt(5)
    v_mfma_f32_16x16x32_bf16 v[4:7], v[64:67], v[100:103], v[4:7]
    v_mfma_f32_16x16x32_bf16 v[36:39], v[68:71], v[100:103], v[36:39]
    v_mfma_f32_16x16x32_bf16 v[0:3], v[72:75], v[100:103], v[0:3]
    v_mfma_f32_16x16x32_bf16 v[32:35], v[76:79], v[100:103], v[32:35]
    ds_read_b128 v[100:103], v120 offset:15360
    s_waitcnt vmcnt(2) lgkmcnt(5)
    v_mfma_f32_16x16x32_bf16 v[8:11], v[64:67], v[104:107], v[8:11]
    v_mfma_f32_16x16x32_bf16 v[40:43], v[68:71], v[104:107], v[40:43]
    v_mfma_f32_16x16x32_bf16 v[4:7], v[72:75], v[104:107], v[4:7]
    v_mfma_f32_16x16x32_bf16 v[36:39], v[76:79], v[104:107], v[36:39]
    v_mfma_f32_16x16x32_bf16 v[0:3], v[80:83], v[104:107], v[0:3]
    v_mfma_f32_16x16x32_bf16 v[32:35], v[84:87], v[104:107], v[32:35]
    ds_read_b128 v[104:107], v122 offset:0
    v_add_u32 v122, v124, v122
    s_waitcnt vmcnt(0) lgkmcnt(5)
    v_mfma_f32_16x16x32_bf16 v[12:15], v[64:67], v[108:111], v[12:15]
    v_mfma_f32_16x16x32_bf16 v[44:47], v[68:71], v[108:111], v[44:47]
    v_mfma_f32_16x16x32_bf16 v[8:11], v[72:75], v[108:111], v[8:11]
    v_mfma_f32_16x16x32_bf16 v[40:43], v[76:79], v[108:111], v[40:43]
    v_mfma_f32_16x16x32_bf16 v[4:7], v[80:83], v[108:111], v[4:7]
    v_mfma_f32_16x16x32_bf16 v[36:39], v[84:87], v[108:111], v[36:39]
    v_mfma_f32_16x16x32_bf16 v[0:3], v[88:91], v[108:111], v[0:3]
    v_mfma_f32_16x16x32_bf16 v[32:35], v[92:95], v[108:111], v[32:35]
    ds_read_b128 v[108:111], v121 offset:9216
    s_waitcnt lgkmcnt(5)
    v_mfma_f32_16x16x32_bf16 v[16:19], v[64:67], v[112:115], v[16:19]
    v_mfma_f32_16x16x32_bf16 v[48:51], v[68:71], v[112:115], v[48:51]
    v_mfma_f32_16x16x32_bf16 v[12:15], v[72:75], v[112:115], v[12:15]
    v_mfma_f32_16x16x32_bf16 v[44:47], v[76:79], v[112:115], v[44:47]
    v_mfma_f32_16x16x32_bf16 v[8:11], v[80:83], v[112:115], v[8:11]
    v_mfma_f32_16x16x32_bf16 v[40:43], v[84:87], v[112:115], v[40:43]
    v_mfma_f32_16x16x32_bf16 v[4:7], v[88:91], v[112:115], v[4:7]
    v_mfma_f32_16x16x32_bf16 v[36:39], v[92:95], v[112:115], v[36:39]
    ds_read_b128 v[112:115], v121 offset:10240
    s_waitcnt lgkmcnt(5)
    v_mfma_f32_16x16x32_bf16 v[20:23], v[64:67], v[116:119], v[20:23]
    v_mfma_f32_16x16x32_bf16 v[52:55], v[68:71], v[116:119], v[52:55]
    v_mfma_f32_16x16x32_bf16 v[16:19], v[72:75], v[116:119], v[16:19]
    v_mfma_f32_16x16x32_bf16 v[48:51], v[76:79], v[116:119], v[48:51]
    v_mfma_f32_16x16x32_bf16 v[12:15], v[80:83], v[116:119], v[12:15]
    v_mfma_f32_16x16x32_bf16 v[44:47], v[84:87], v[116:119], v[44:47]
    v_mfma_f32_16x16x32_bf16 v[8:11], v[88:91], v[116:119], v[8:11]
    v_mfma_f32_16x16x32_bf16 v[40:43], v[92:95], v[116:119], v[40:43]
    s_waitcnt lgkmcnt(4)
    v_mfma_f32_16x16x32_bf16 v[24:27], v[64:67], v[96:99], v[24:27]
    v_mfma_f32_16x16x32_bf16 v[56:59], v[68:71], v[96:99], v[56:59]
    v_mfma_f32_16x16x32_bf16 v[20:23], v[72:75], v[96:99], v[20:23]
    v_mfma_f32_16x16x32_bf16 v[52:55], v[76:79], v[96:99], v[52:55]
    v_mfma_f32_16x16x32_bf16 v[16:19], v[80:83], v[96:99], v[16:19]
    v_mfma_f32_16x16x32_bf16 v[48:51], v[84:87], v[96:99], v[48:51]
    v_mfma_f32_16x16x32_bf16 v[12:15], v[88:91], v[96:99], v[12:15]
    v_mfma_f32_16x16x32_bf16 v[44:47], v[92:95], v[96:99], v[44:47]
    s_waitcnt lgkmcnt(3)
    v_mfma_f32_16x16x32_bf16 v[28:31], v[64:67], v[100:103], v[28:31]
    v_mfma_f32_16x16x32_bf16 v[60:63], v[68:71], v[100:103], v[60:63]
    v_mfma_f32_16x16x32_bf16 v[24:27], v[72:75], v[100:103], v[24:27]
    v_mfma_f32_16x16x32_bf16 v[56:59], v[76:79], v[100:103], v[56:59]
    v_mfma_f32_16x16x32_bf16 v[20:23], v[80:83], v[100:103], v[20:23]
    v_mfma_f32_16x16x32_bf16 v[52:55], v[84:87], v[100:103], v[52:55]
    v_mfma_f32_16x16x32_bf16 v[16:19], v[88:91], v[100:103], v[16:19]
    v_mfma_f32_16x16x32_bf16 v[48:51], v[92:95], v[100:103], v[48:51]
    buffer_load_dwordx4 v[64:67], v125, s[12:15], s23 offen offset:0
    buffer_load_dwordx4 v[68:71], v125, s[12:15], s23 offen offset:1024
    s_waitcnt lgkmcnt(2)
    v_mfma_f32_16x16x32_bf16 v[28:31], v[72:75], v[104:107], v[28:31]
    v_mfma_f32_16x16x32_bf16 v[60:63], v[76:79], v[104:107], v[60:63]
    v_mfma_f32_16x16x32_bf16 v[24:27], v[80:83], v[104:107], v[24:27]
    v_mfma_f32_16x16x32_bf16 v[56:59], v[84:87], v[104:107], v[56:59]
    v_mfma_f32_16x16x32_bf16 v[20:23], v[88:91], v[104:107], v[20:23]
    v_mfma_f32_16x16x32_bf16 v[52:55], v[92:95], v[104:107], v[52:55]
    buffer_load_dwordx4 v[72:75], v125, s[12:15], s23 offen offset:2048
    buffer_load_dwordx4 v[76:79], v125, s[12:15], s23 offen offset:3072
    s_waitcnt lgkmcnt(1)
    v_mfma_f32_16x16x32_bf16 v[28:31], v[80:83], v[108:111], v[28:31]
    v_mfma_f32_16x16x32_bf16 v[60:63], v[84:87], v[108:111], v[60:63]
    v_mfma_f32_16x16x32_bf16 v[24:27], v[88:91], v[108:111], v[24:27]
    v_mfma_f32_16x16x32_bf16 v[56:59], v[92:95], v[108:111], v[56:59]
    buffer_load_dwordx4 v[80:83], v125, s[12:15], s26 offen offset:0
    buffer_load_dwordx4 v[84:87], v125, s[12:15], s26 offen offset:1024
    s_waitcnt lgkmcnt(0)
    v_mfma_f32_16x16x32_bf16 v[28:31], v[88:91], v[112:115], v[28:31]
    v_mfma_f32_16x16x32_bf16 v[60:63], v[92:95], v[112:115], v[60:63]
    buffer_load_dwordx4 v[88:91], v125, s[12:15], s26 offen offset:2048
    buffer_load_dwordx4 v[92:95], v125, s[12:15], s26 offen offset:3072
    s_add_u32 s23, s23, 57344
    s_add_u32 s26, s26, 57344
    s_barrier
    s_branch L_conv2_kernel_mloop1
L_conv2_kernel_mlast1:
    v_and_b32 v125, 15, v127
    v_and_b32 v126, 7, v127
    v_lshlrev_b32 v126, 4, v126
    v_lshl_add_u32 v125, v125, 7, v126
    v_lshrrev_b32 v126, 4, v127
    v_lshl_add_u32 v125, v126, 11, v125
    s_lshl_b32 s36, s20, 14
    s_add_u32 s37, s36, 8192
    v_add_u32 v126, s37, v125
    v_add_u32 v125, s36, v125
    ds_read_b128 v[96:99], v120 offset:8192
    ds_read_b128 v[100:103], v120 offset:9216
    ds_read_b128 v[104:107], v120 offset:10240
    ds_read_b128 v[108:111], v120 offset:11264
    ds_read_b128 v[112:115], v120 offset:12288
    ds_read_b128 v[116:119], v120 offset:13312
    s_waitcnt vmcnt(6) lgkmcnt(5)
    v_mfma_f32_16x16x32_bf16 v[0:3], v[64:67], v[96:99], v[0:3]
    v_mfma_f32_16x16x32_bf16 v[32:35], v[68:71], v[96:99], v[32:35]
    ds_read_b128 v[96:99], v120 offset:14336
    s_waitcnt vmcnt(4) lgkmcnt(5)
    v_mfma_f32_16x16x32_bf16 v[4:7], v[64:67], v[100:103], v[4:7]
    v_mfma_f32_16x16x32_bf16 v[36:39], v[68:71], v[100:103], v[36:39]
    v_mfma_f32_16x16x32_bf16 v[0:3], v[72:75], v[100:103], v[0:3]
    v_mfma_f32_16x16x32_bf16 v[32:35], v[76:79], v[100:103], v[32:35]
    ds_read_b128 v[100:103], v120 offset:15360
    s_waitcnt vmcnt(2) lgkmcnt(5)
    v_mfma_f32_16x16x32_bf16 v[8:11], v[64:67], v[104:107], v[8:11]
    v_mfma_f32_16x16x32_bf16 v[40:43], v[68:71], v[104:107], v[40:43]
    v_mfma_f32_16x16x32_bf16 v[4:7], v[72:75], v[104:107], v[4:7]
    v_mfma_f32_16x16x32_bf16 v[36:39], v[76:79], v[104:107], v[36:39]
    v_mfma_f32_16x16x32_bf16 v[0:3], v[80:83], v[104:107], v[0:3]
    v_mfma_f32_16x16x32_bf16 v[32:35], v[84:87], v[104:107], v[32:35]
    ds_read_b128 v[104:107], v122 offset:0
    s_waitcnt vmcnt(0) lgkmcnt(5)
    v_mfma_f32_16x16x32_bf16 v[12:15], v[64:67], v[108:111], v[12:15]
    v_mfma_f32_16x16x32_bf16 v[44:47], v[68:71], v[108:111], v[44:47]
    v_mfma_f32_16x16x32_bf16 v[8:11], v[72:75], v[108:111], v[8:11]
    v_mfma_f32_16x16x32_bf16 v[40:43], v[76:79], v[108:111], v[40:43]
    v_mfma_f32_16x16x32_bf16 v[4:7], v[80:83], v[108:111], v[4:7]
    v_mfma_f32_16x16x32_bf16 v[36:39], v[84:87], v[108:111], v[36:39]
    v_mfma_f32_16x16x32_bf16 v[0:3], v[88:91], v[108:111], v[0:3]
    v_mfma_f32_16x16x32_bf16 v[32:35], v[92:95], v[108:111], v[32:35]
    ds_read_b128 v[108:111], v121 offset:9216
    s_waitcnt lgkmcnt(5)
    v_mfma_f32_16x16x32_bf16 v[16:19], v[64:67], v[112:115], v[16:19]
    v_mfma_f32_16x16x32_bf16 v[48:51], v[68:71], v[112:115], v[48:51]
    v_mfma_f32_16x16x32_bf16 v[12:15], v[72:75], v[112:115], v[12:15]
    v_mfma_f32_16x16x32_bf16 v[44:47], v[76:79], v[112:115], v[44:47]
    v_mfma_f32_16x16x32_bf16 v[8:11], v[80:83], v[112:115], v[8:11]
    v_mfma_f32_16x16x32_bf16 v[40:43], v[84:87], v[112:115], v[40:43]
    v_mfma_f32_16x16x32_bf16 v[4:7], v[88:91], v[112:115], v[4:7]
    v_mfma_f32_16x16x32_bf16 v[36:39], v[92:95], v[112:115], v[36:39]
    ds_read_b128 v[112:115], v121 offset:10240
    v_xor_b32 v123, 0, v125
    ds_write_b128 v123, v[0:3]
    s_waitcnt lgkmcnt(6)
    v_mfma_f32_16x16x32_bf16 v[20:23], v[64:67], v[116:119], v[20:23]
    v_mfma_f32_16x16x32_bf16 v[52:55], v[68:71], v[116:119], v[52:55]
    v_mfma_f32_16x16x32_bf16 v[16:19], v[72:75], v[116:119], v[16:19]
    v_mfma_f32_16x16x32_bf16 v[48:51], v[76:79], v[116:119], v[48:51]
    v_mfma_f32_16x16x32_bf16 v[12:15], v[80:83], v[116:119], v[12:15]
    v_mfma_f32_16x16x32_bf16 v[44:47], v[84:87], v[116:119], v[44:47]
    v_mfma_f32_16x16x32_bf16 v[8:11], v[88:91], v[116:119], v[8:11]
    v_mfma_f32_16x16x32_bf16 v[40:43], v[92:95], v[116:119], v[40:43]
    v_xor_b32 v124, 16, v125
    ds_write_b128 v124, v[4:7]
    s_waitcnt lgkmcnt(2)
    v_mfma_f32_16x16x32_bf16 v[24:27], v[64:67], v[96:99], v[24:27]
    v_mfma_f32_16x16x32_bf16 v[56:59], v[68:71], v[96:99], v[56:59]
    v_mfma_f32_16x16x32_bf16 v[20:23], v[72:75], v[96:99], v[20:23]
    v_mfma_f32_16x16x32_bf16 v[52:55], v[76:79], v[96:99], v[52:55]
    v_mfma_f32_16x16x32_bf16 v[16:19], v[80:83], v[96:99], v[16:19]
    v_mfma_f32_16x16x32_bf16 v[48:51], v[84:87], v[96:99], v[48:51]
    v_mfma_f32_16x16x32_bf16 v[12:15], v[88:91], v[96:99], v[12:15]
    v_mfma_f32_16x16x32_bf16 v[44:47], v[92:95], v[96:99], v[44:47]
    v_xor_b32 v123, 32, v125
    ds_write_b128 v123, v[8:11]
    v_xor_b32 v124, 0, v126
    ds_write_b128 v124, v[32:35]
    v_mfma_f32_16x16x32_bf16 v[28:31], v[64:67], v[100:103], v[28:31]
    v_mfma_f32_16x16x32_bf16 v[60:63], v[68:71], v[100:103], v[60:63]
    v_mfma_f32_16x16x32_bf16 v[24:27], v[72:75], v[100:103], v[24:27]
    v_mfma_f32_16x16x32_bf16 v[56:59], v[76:79], v[100:103], v[56:59]
    v_mfma_f32_16x16x32_bf16 v[20:23], v[80:83], v[100:103], v[20:23]
    v_mfma_f32_16x16x32_bf16 v[52:55], v[84:87], v[100:103], v[52:55]
    v_mfma_f32_16x16x32_bf16 v[16:19], v[88:91], v[100:103], v[16:19]
    v_mfma_f32_16x16x32_bf16 v[48:51], v[92:95], v[100:103], v[48:51]
    v_xor_b32 v123, 16, v126
    ds_write_b128 v123, v[36:39]
    v_xor_b32 v124, 32, v126
    ds_write_b128 v124, v[40:43]
    v_mfma_f32_16x16x32_bf16 v[28:31], v[72:75], v[104:107], v[28:31]
    v_mfma_f32_16x16x32_bf16 v[60:63], v[76:79], v[104:107], v[60:63]
    v_mfma_f32_16x16x32_bf16 v[24:27], v[80:83], v[104:107], v[24:27]
    v_mfma_f32_16x16x32_bf16 v[56:59], v[84:87], v[104:107], v[56:59]
    v_mfma_f32_16x16x32_bf16 v[20:23], v[88:91], v[104:107], v[20:23]
    v_mfma_f32_16x16x32_bf16 v[52:55], v[92:95], v[104:107], v[52:55]
    v_xor_b32 v124, 48, v125
    ds_write_b128 v124, v[12:15]
    v_xor_b32 v123, 48, v126
    ds_write_b128 v123, v[44:47]
    v_mfma_f32_16x16x32_bf16 v[28:31], v[80:83], v[108:111], v[28:31]
    v_mfma_f32_16x16x32_bf16 v[60:63], v[84:87], v[108:111], v[60:63]
    v_mfma_f32_16x16x32_bf16 v[24:27], v[88:91], v[108:111], v[24:27]
    v_mfma_f32_16x16x32_bf16 v[56:59], v[92:95], v[108:111], v[56:59]
    v_xor_b32 v123, 64, v125
    ds_write_b128 v123, v[16:19]
    v_xor_b32 v124, 64, v126
    ds_write_b128 v124, v[48:51]
    v_mfma_f32_16x16x32_bf16 v[28:31], v[88:91], v[112:115], v[28:31]
    v_mfma_f32_16x16x32_bf16 v[60:63], v[92:95], v[112:115], v[60:63]
    v_xor_b32 v124, 80, v125
    ds_write_b128 v124, v[20:23]
    v_xor_b32 v123, 80, v126
    ds_write_b128 v123, v[52:55]
    v_and_b32 v108, 15, v127
    v_lshrrev_b32 v109, 4, v127
    v_lshrrev_b32 v110, 3, v108
    s_lshl_b32 s36, s20, 1
    v_add_u32 v110, s36, v110
    v_xor_b32 v111, v110, v108
    v_and_b32 v111, 7, v111
    v_lshlrev_b32 v111, 4, v111
    v_xor_b32 v123, 96, v125
    ds_write_b128 v123, v[24:27]
    v_lshl_add_u32 v111, v110, 7, v111
    v_lshl_add_u32 v120, v109, 11, v111
    v_add_u32 v121, 65536, v120
    v_add_u32 v64, 131072, v120
    s_lshl_b32 s36, s20, 9
    s_add_u32 s36, s36, 115712
    v_lshl_add_u32 v127, v109, 7, s36
    s_lshl_b32 s36, s20, 4
    v_add_u32 v108, s36, v108
    v_lshlrev_b32 v110, 6, v108
    v_lshl_add_u32 v110, v109, 4, v110
    s_mul_i32 s36, s29, 262144
    v_xor_b32 v124, 96, v126
    ds_write_b128 v124, v[56:59]
    s_lshl_b32 s37, s21, 4
    s_add_u32 s36, s36, s37
    v_add_u32 v110, s36, v110
    v_mov_b32 v111, 2130706432
    v_cmp_gt_u32 vcc, 125, v108
    s_mov_b32 s4, 0xbeaaaaab
    s_mov_b32 s5, s4
    s_mov_b32 s6, 0x3e800000
    s_mov_b32 s7, s6
    s_mov_b32 s8, 0xc0a00000
    s_mov_b32 s9, s8
    s_mov_b32 s10, 0xc0638e39
    v_xor_b32 v124, 112, v125
    ds_write_b128 v124, v[28:31]
    s_mov_b32 s11, s10
    s_mov_b32 s12, 0xbf638e39
    s_mov_b32 s13, s12
    s_mov_b32 s14, 0xbe638e39
    s_mov_b32 s15, s14
    s_mov_b32 s22, 0xbd638e39
    s_mov_b32 s23, s22
    s_mov_b32 s24, 0x3ff1c71c
    s_mov_b32 s25, s24
    s_mov_b32 s26, 0xbf2aaaab
    s_mov_b32 s27, s26
    s_mov_b32 s32, 0x3ecccccd
    v_xor_b32 v123, 112, v126
    s_waitcnt lgkmcnt(8)
    ds_write_b128 v123, v[60:63]
    s_mov_b32 s33, s32
    s_mov_b32 s34, 0xbd888889
    s_mov_b32 s35, s34
    s_mov_b32 s38, 0xbe4ccccd
    s_mov_b32 s39, s38
    s_mov_b32 s40, 0xbdd2d3e8
    s_mov_b32 s41, s40
    s_mov_b32 s42, 0x3f800000
    s_mov_b32 s43, s42
    s_setprio 0
    s_branch L_conv2_kernel_epi
L_conv2_kernel_m2:
    s_mul_i32 s37, s38, 2176
    s_add_u32 s37, s37, 98304
    v_add_u32 v116, s37, v8
    v_add_u32 v118, s37, v9
    v_add_u32 v117, 104832, v8
    s_cmp_eq_u32 s38, 0
    s_cbranch_scc1 L_conv2_kernel_hh0
    v_add_u32 v117, 98304, v9
L_conv2_kernel_hh0:
    s_lshl_b32 s37, s38, 12
    s_add_u32 s37, s37, s43
    s_add_u32 s37, s37, 49152
    v_lshl_add_u32 v119, v127, 4, s37
    v_mov_b32 v0, 0
    v_mov_b32 v1, 0
    v_mov_b32 v2, 0
    v_mov_b32 v3, 0
    v_mov_b32 v4, 0
    v_mov_b32 v5, 0
    v_mov_b32 v6, 0
    v_mov_b32 v7, 0
    v_mov_b32 v8, 0
    v_mov_b32 v9, 0
    v_mov_b32 v10, 0
    v_mov_b32 v11, 0
    v_mov_b32 v12, 0
    v_mov_b32 v13, 0
    v_mov_b32 v14, 0
    v_mov_b32 v15, 0
    v_mov_b32 v16, 0
    v_mov_b32 v17, 0
    v_mov_b32 v18, 0
    v_mov_b32 v19, 0
    v_mov_b32 v20, 0
    v_mov_b32 v21, 0
    v_mov_b32 v22, 0
    v_mov_b32 v23, 0
    v_mov_b32 v24, 0
    v_mov_b32 v25, 0
    v_mov_b32 v26, 0
    v_mov_b32 v27, 0
    v_mov_b32 v28, 0
    v_mov_b32 v29, 0
    v_mov_b32 v30, 0
    v_mov_b32 v31, 0
    v_mov_b32 v32, 0
    v_mov_b32 v33, 0
    v_mov_b32 v34, 0
    v_mov_b32 v35, 0
    v_mov_b32 v36, 0
    v_mov_b32 v37, 0
    v_mov_b32 v38, 0
    v_mov_b32 v39, 0
    v_mov_b32 v40, 0
    v_mov_b32 v41, 0
    v_mov_b32 v42, 0
    v_mov_b32 v43, 0
    v_mov_b32 v44, 0
    v_mov_b32 v45, 0
    v_mov_b32 v46, 0
    v_mov_b32 v47, 0
    v_mov_b32 v48, 0
    v_mov_b32 v49, 0
    v_mov_b32 v50, 0
    v_mov_b32 v51, 0
    v_mov_b32 v52, 0
    v_mov_b32 v53, 0
    v_mov_b32 v54, 0
    v_mov_b32 v55, 0
    v_mov_b32 v56, 0
    v_mov_b32 v57, 0
    v_mov_b32 v58, 0
    v_mov_b32 v59, 0
    v_mov_b32 v60, 0
    v_mov_b32 v61, 0
    v_mov_b32 v62, 0
    v_mov_b32 v63, 0
    s_barrier
    buffer_load_dwordx4 v[96:99], v108, s[8:11], 0 offen
    buffer_load_dwordx4 v[100:103], v109, s[8:11], 0 offen
    buffer_load_dwordx4 v[104:107], v110, s[8:11], 0 offen
    s_mov_b32 s23, 0
    s_mov_b32 s26, 4096
    buffer_load_dwordx4 v[64:67], v125, s[12:15], s23 offen offset:0
    buffer_load_dwordx4 v[68:71], v125, s[12:15], s23 offen offset:2048
    buffer_load_dwordx4 v[80:83], v119, s[12:15], s23 offen offset:0
    buffer_load_dwordx4 v[72:75], v125, s[12:15], s26 offen offset:0
    buffer_load_dwordx4 v[84:87], v119, s[12:15], s23 offen offset:2048
    buffer_load_dwordx4 v[76:79], v125, s[12:15], s26 offen offset:2048
    s_mov_b32 s23, 57344
    s_mov_b32 s26, 61440
    s_waitcnt vmcnt(6)
    v_lshlrev_b32 v108, 16, v96
    v_and_b32 v111, s25, v96
    v_lshlrev_b32 v109, 16, v100
    v_and_b32 v112, s25, v100
    v_lshlrev_b32 v110, 16, v104
    v_and_b32 v113, s25, v104
    v_mul_f32 v114, s44, v108
    v_mul_f32 v115, s44, v111
    v_fmac_f32 v114, s45, v109
    v_fmac_f32 v115, s45, v112
    v_fmac_f32 v114, s46, v110
    v_fmac_f32 v115, s46, v113
    v_cvt_pk_bf16_f32 v96, v114, v115
    v_lshlrev_b32 v108, 16, v97
    v_and_b32 v111, s25, v97
    v_lshlrev_b32 v109, 16, v101
    v_and_b32 v112, s25, v101
    v_lshlrev_b32 v110, 16, v105
    v_and_b32 v113, s25, v105
    v_mul_f32 v114, s44, v108
    v_mul_f32 v115, s44, v111
    v_fmac_f32 v114, s45, v109
    v_fmac_f32 v115, s45, v112
    v_fmac_f32 v114, s46, v110
    v_fmac_f32 v115, s46, v113
    v_cvt_pk_bf16_f32 v97, v114, v115
    v_lshlrev_b32 v108, 16, v98
    v_and_b32 v111, s25, v98
    v_lshlrev_b32 v109, 16, v102
    v_and_b32 v112, s25, v102
    v_lshlrev_b32 v110, 16, v106
    v_and_b32 v113, s25, v106
    v_mul_f32 v114, s44, v108
    v_mul_f32 v115, s44, v111
    v_fmac_f32 v114, s45, v109
    v_fmac_f32 v115, s45, v112
    v_fmac_f32 v114, s46, v110
    v_fmac_f32 v115, s46, v113
    v_cvt_pk_bf16_f32 v98, v114, v115
    v_lshlrev_b32 v108, 16, v99
    v_and_b32 v111, s25, v99
    v_lshlrev_b32 v109, 16, v103
    v_and_b32 v112, s25, v103
    v_lshlrev_b32 v110, 16, v107
    v_and_b32 v113, s25, v107
    v_mul_f32 v114, s44, v108
    v_mul_f32 v115, s44, v111
    v_fmac_f32 v114, s45, v109
    v_fmac_f32 v115, s45, v112
    v_fmac_f32 v114, s46, v110
    v_fmac_f32 v115, s46, v113
    v_cvt_pk_bf16_f32 v99, v114, v115
    ds_write_b128 v126, v[96:99]
    v_and_b32 v126, 15, v127
    v_lshlrev_b32 v126, 2, v126
    v_add_u32 v126, 99328, v126
    ds_write_b32 v126, v0
    ds_write_b32 v126, v0 offset:8704
    s_waitcnt lgkmcnt(0)
    s_barrier
    s_mov_b32 s22, 4
    s_setprio 2
L_conv2_kernel_mloop2:
    ds_read_b128 v[88:91], v120 offset:0
    ds_read_b128 v[92:95], v120 offset:1024
    ds_read_b128 v[96:99], v116 offset:0
    ds_read_b128 v[100:103], v120 offset:2048
    ds_read_b128 v[104:107], v116 offset:1088
    ds_read_b128 v[108:111], v120 offset:3072
    ds_read_b128 v[112:115], v116 offset:2176
    s_waitcnt vmcnt(5) lgkmcnt(6)
    v_mfma_f32_16x16x32_bf16 v[0:3], v[64:67], v[88:91], v[0:3]
    ds_read_b128 v[88:91], v120 offset:4096
    s_waitcnt vmcnt(4) lgkmcnt(6)
    v_mfma_f32_16x16x32_bf16 v[4:7], v[64:67], v[92:95], v[4:7]
    v_mfma_f32_16x16x32_bf16 v[0:3], v[68:71], v[92:95], v[0:3]
    ds_read_b128 v[92:95], v116 offset:3264
    s_waitcnt vmcnt(3) lgkmcnt(6)
    v_mfma_f32_16x16x32_bf16 v[32:35], v[80:83], v[96:99], v[32:35]
    ds_read_b128 v[96:99], v120 offset:5120
    s_waitcnt vmcnt(2) lgkmcnt(6)
    v_mfma_f32_16x16x32_bf16 v[8:11], v[64:67], v[100:103], v[8:11]
    v_mfma_f32_16x16x32_bf16 v[4:7], v[68:71], v[100:103], v[4:7]
    v_mfma_f32_16x16x32_bf16 v[0:3], v[72:75], v[100:103], v[0:3]
    ds_read_b128 v[100:103], v116 offset:4352
    s_waitcnt vmcnt(1) lgkmcnt(6)
    v_mfma_f32_16x16x32_bf16 v[36:39], v[80:83], v[104:107], v[36:39]
    v_mfma_f32_16x16x32_bf16 v[32:35], v[84:87], v[104:107], v[32:35]
    ds_read_b128 v[104:107], v120 offset:6144
    s_waitcnt vmcnt(0) lgkmcnt(6)
    v_mfma_f32_16x16x32_bf16 v[12:15], v[64:67], v[108:111], v[12:15]
    v_mfma_f32_16x16x32_bf16 v[8:11], v[68:71], v[108:111], v[8:11]
    v_mfma_f32_16x16x32_bf16 v[4:7], v[72:75], v[108:111], v[4:7]
    v_mfma_f32_16x16x32_bf16 v[0:3], v[76:79], v[108:111], v[0:3]
    ds_read_b128 v[108:111], v116 offset:5440
    s_waitcnt lgkmcnt(6)
    v_mfma_f32_16x16x32_bf16 v[40:43], v[80:83], v[112:115], v[40:43]
    v_mfma_f32_16x16x32_bf16 v[36:39], v[84:87], v[112:115], v[36:39]
    ds_read_b128 v[112:115], v120 offset:7168
    s_waitcnt lgkmcnt(6)
    v_mfma_f32_16x16x32_bf16 v[16:19], v[64:67], v[88:91], v[16:19]
    v_mfma_f32_16x16x32_bf16 v[12:15], v[68:71], v[88:91], v[12:15]
    v_mfma_f32_16x16x32_bf16 v[8:11], v[72:75], v[88:91], v[8:11]
    v_mfma_f32_16x16x32_bf16 v[4:7], v[76:79], v[88:91], v[4:7]
    ds_read_b128 v[88:91], v117 offset:0
    s_waitcnt lgkmcnt(6)
    v_mfma_f32_16x16x32_bf16 v[44:47], v[80:83], v[92:95], v[44:47]
    v_mfma_f32_16x16x32_bf16 v[40:43], v[84:87], v[92:95], v[40:43]
    ds_read_b128 v[92:95], v122 offset:0
    v_add_u32 v122, v123, v122
    s_waitcnt lgkmcnt(6)
    v_mfma_f32_16x16x32_bf16 v[20:23], v[64:67], v[96:99], v[20:23]
    v_mfma_f32_16x16x32_bf16 v[16:19], v[68:71], v[96:99], v[16:19]
    v_mfma_f32_16x16x32_bf16 v[12:15], v[72:75], v[96:99], v[12:15]
    v_mfma_f32_16x16x32_bf16 v[8:11], v[76:79], v[96:99], v[8:11]
    ds_read_b128 v[96:99], v117 offset:1088
    s_waitcnt lgkmcnt(6)
    v_mfma_f32_16x16x32_bf16 v[48:51], v[80:83], v[100:103], v[48:51]
    v_mfma_f32_16x16x32_bf16 v[44:47], v[84:87], v[100:103], v[44:47]
    ds_read_b128 v[100:103], v121 offset:1024
    s_waitcnt lgkmcnt(6)
    v_mfma_f32_16x16x32_bf16 v[24:27], v[64:67], v[104:107], v[24:27]
    v_mfma_f32_16x16x32_bf16 v[20:23], v[68:71], v[104:107], v[20:23]
    v_mfma_f32_16x16x32_bf16 v[16:19], v[72:75], v[104:107], v[16:19]
    v_mfma_f32_16x16x32_bf16 v[12:15], v[76:79], v[104:107], v[12:15]
    ds_read_b128 v[104:107], v118 offset:0
    s_waitcnt lgkmcnt(6)
    v_mfma_f32_16x16x32_bf16 v[52:55], v[80:83], v[108:111], v[52:55]
    v_mfma_f32_16x16x32_bf16 v[48:51], v[84:87], v[108:111], v[48:51]
    ds_read_b128 v[108:111], v121 offset:2048
    s_waitcnt lgkmcnt(6)
    v_mfma_f32_16x16x32_bf16 v[28:31], v[64:67], v[112:115], v[28:31]
    v_mfma_f32_16x16x32_bf16 v[24:27], v[68:71], v[112:115], v[24:27]
    v_mfma_f32_16x16x32_bf16 v[20:23], v[72:75], v[112:115], v[20:23]
    v_mfma_f32_16x16x32_bf16 v[16:19], v[76:79], v[112:115], v[16:19]
    buffer_load_dwordx4 v[64:67], v125, s[12:15], s23 offen offset:0
    s_waitcnt lgkmcnt(5)
    v_mfma_f32_16x16x32_bf16 v[56:59], v[80:83], v[88:91], v[56:59]
    v_mfma_f32_16x16x32_bf16 v[52:55], v[84:87], v[88:91], v[52:55]
    s_waitcnt lgkmcnt(0)
    s_barrier
    v_mfma_f32_16x16x32_bf16 v[28:31], v[68:71], v[92:95], v[28:31]
    v_mfma_f32_16x16x32_bf16 v[24:27], v[72:75], v[92:95], v[24:27]
    v_mfma_f32_16x16x32_bf16 v[20:23], v[76:79], v[92:95], v[20:23]
    buffer_load_dwordx4 v[68:71], v125, s[12:15], s23 offen offset:2048
    v_mfma_f32_16x16x32_bf16 v[60:63], v[80:83], v[96:99], v[60:63]
    v_mfma_f32_16x16x32_bf16 v[56:59], v[84:87], v[96:99], v[56:59]
    buffer_load_dwordx4 v[80:83], v119, s[12:15], s23 offen offset:0
    v_mfma_f32_16x16x32_bf16 v[28:31], v[72:75], v[100:103], v[28:31]
    v_mfma_f32_16x16x32_bf16 v[24:27], v[76:79], v[100:103], v[24:27]
    buffer_load_dwordx4 v[72:75], v125, s[12:15], s26 offen offset:0
    v_mfma_f32_16x16x32_bf16 v[60:63], v[84:87], v[104:107], v[60:63]
    buffer_load_dwordx4 v[84:87], v119, s[12:15], s23 offen offset:2048
    v_mfma_f32_16x16x32_bf16 v[28:31], v[76:79], v[108:111], v[28:31]
    buffer_load_dwordx4 v[76:79], v125, s[12:15], s26 offen offset:2048
    s_add_u32 s23, s23, 57344
    s_add_u32 s26, s26, 57344
    s_sub_u32 s22, s22, 1
    s_cmp_eq_u32 s22, 0
    s_cbranch_scc1 L_conv2_kernel_mlast2
    ds_read_b128 v[88:91], v120 offset:8192
    ds_read_b128 v[92:95], v120 offset:9216
    ds_read_b128 v[96:99], v116 offset:8704
    ds_read_b128 v[100:103], v120 offset:10240
    ds_read_b128 v[104:107], v116 offset:9792
    ds_read_b128 v[108:111], v120 offset:11264
    ds_read_b128 v[112:115], v116 offset:10880
    s_waitcnt vmcnt(5) lgkmcnt(6)
    v_mfma_f32_16x16x32_bf16 v[0:3], v[64:67], v[88:91], v[0:3]
    ds_read_b128 v[88:91], v120 offset:12288
    s_waitcnt vmcnt(4) lgkmcnt(6)
    v_mfma_f32_16x16x32_bf16 v[4:7], v[64:67], v[92:95], v[4:7]
    v_mfma_f32_16x16x32_bf16 v[0:3], v[68:71], v[92:95], v[0:3]
    ds_read_b128 v[92:95], v116 offset:11968
    s_waitcnt vmcnt(3) lgkmcnt(6)
    v_mfma_f32_16x16x32_bf16 v[32:35], v[80:83], v[96:99], v[32:35]
    ds_read_b128 v[96:99], v120 offset:13312
    s_waitcnt vmcnt(2) lgkmcnt(6)
    v_mfma_f32_16x16x32_bf16 v[8:11], v[64:67], v[100:103], v[8:11]
    v_mfma_f32_16x16x32_bf16 v[4:7], v[68:71], v[100:103], v[4:7]
    v_mfma_f32_16x16x32_bf16 v[0:3], v[72:75], v[100:103], v[0:3]
    ds_read_b128 v[100:103], v116 offset:13056
    s_waitcnt vmcnt(1) lgkmcnt(6)
    v_mfma_f32_16x16x32_bf16 v[36:39], v[80:83], v[104:107], v[36:39]
    v_mfma_f32_16x16x32_bf16 v[32:35], v[84:87], v[104:107], v[32:35]
    ds_read_b128 v[104:107], v120 offset:14336
    s_waitcnt vmcnt(0) lgkmcnt(6)
    v_mfma_f32_16x16x32_bf16 v[12:15], v[64:67], v[108:111], v[12:15]
    v_mfma_f32_16x16x32_bf16 v[8:11], v[68:71], v[108:111], v[8:11]
    v_mfma_f32_16x16x32_bf16 v[4:7], v[72:75], v[108:111], v[4:7]
    v_mfma_f32_16x16x32_bf16 v[0:3], v[76:79], v[108:111], v[0:3]
    ds_read_b128 v[108:111], v116 offset:14144
    s_waitcnt lgkmcnt(6)
    v_mfma_f32_16x16x32_bf16 v[40:43], v[80:83], v[112:115], v[40:43]
    v_mfma_f32_16x16x32_bf16 v[36:39], v[84:87], v[112:115], v[36:39]
    ds_read_b128 v[112:115], v120 offset:15360
    s_waitcnt lgkmcnt(6)
    v_mfma_f32_16x16x32_bf16 v[16:19], v[64:67], v[88:91], v[16:19]
    v_mfma_f32_16x16x32_bf16 v[12:15], v[68:71], v[88:91], v[12:15]
    v_mfma_f32_16x16x32_bf16 v[8:11], v[72:75], v[88:91], v[8:11]
    v_mfma_f32_16x16x32_bf16 v[4:7], v[76:79], v[88:91], v[4:7]
    ds_read_b128 v[88:91], v117 offset:8704
    s_waitcnt lgkmcnt(6)
    v_mfma_f32_16x16x32_bf16 v[44:47], v[80:83], v[92:95], v[44:47]
    v_mfma_f32_16x16x32_bf16 v[40:43], v[84:87], v[92:95], v[40:43]
    ds_read_b128 v[92:95], v122 offset:0
    v_add_u32 v122, v124, v122
    s_waitcnt lgkmcnt(6)
    v_mfma_f32_16x16x32_bf16 v[20:23], v[64:67], v[96:99], v[20:23]
    v_mfma_f32_16x16x32_bf16 v[16:19], v[68:71], v[96:99], v[16:19]
    v_mfma_f32_16x16x32_bf16 v[12:15], v[72:75], v[96:99], v[12:15]
    v_mfma_f32_16x16x32_bf16 v[8:11], v[76:79], v[96:99], v[8:11]
    ds_read_b128 v[96:99], v117 offset:9792
    s_waitcnt lgkmcnt(6)
    v_mfma_f32_16x16x32_bf16 v[48:51], v[80:83], v[100:103], v[48:51]
    v_mfma_f32_16x16x32_bf16 v[44:47], v[84:87], v[100:103], v[44:47]
    ds_read_b128 v[100:103], v121 offset:9216
    s_waitcnt lgkmcnt(6)
    v_mfma_f32_16x16x32_bf16 v[24:27], v[64:67], v[104:107], v[24:27]
    v_mfma_f32_16x16x32_bf16 v[20:23], v[68:71], v[104:107], v[20:23]
    v_mfma_f32_16x16x32_bf16 v[16:19], v[72:75], v[104:107], v[16:19]
    v_mfma_f32_16x16x32_bf16 v[12:15], v[76:79], v[104:107], v[12:15]
    ds_read_b128 v[104:107], v118 offset:8704
    s_waitcnt lgkmcnt(6)
    v_mfma_f32_16x16x32_bf16 v[52:55], v[80:83], v[108:111], v[52:55]
    v_mfma_f32_16x16x32_bf16 v[48:51], v[84:87], v[108:111], v[48:51]
    ds_read_b128 v[108:111], v121 offset:10240
    s_waitcnt lgkmcnt(6)
    v_mfma_f32_16x16x32_bf16 v[28:31], v[64:67], v[112:115], v[28:31]
    v_mfma_f32_16x16x32_bf16 v[24:27], v[68:71], v[112:115], v[24:27]
    v_mfma_f32_16x16x32_bf16 v[20:23], v[72:75], v[112:115], v[20:23]
    v_mfma_f32_16x16x32_bf16 v[16:19], v[76:79], v[112:115], v[16:19]
    buffer_load_dwordx4 v[64:67], v125, s[12:15], s23 offen offset:0
    s_waitcnt lgkmcnt(5)
    v_mfma_f32_16x16x32_bf16 v[56:59], v[80:83], v[88:91], v[56:59]
    v_mfma_f32_16x16x32_bf16 v[52:55], v[84:87], v[88:91], v[52:55]
    s_waitcnt lgkmcnt(0)
    s_barrier
    v_mfma_f32_16x16x32_bf16 v[28:31], v[68:71], v[92:95], v[28:31]
    v_mfma_f32_16x16x32_bf16 v[24:27], v[72:75], v[92:95], v[24:27]
    v_mfma_f32_16x16x32_bf16 v[20:23], v[76:79], v[92:95], v[20:23]
    buffer_load_dwordx4 v[68:71], v125, s[12:15], s23 offen offset:2048
    v_mfma_f32_16x16x32_bf16 v[60:63], v[80:83], v[96:99], v[60:63]
    v_mfma_f32_16x16x32_bf16 v[56:59], v[84:87], v[96:99], v[56:59]
    buffer_load_dwordx4 v[80:83], v119, s[12:15], s23 offen offset:0
    v_mfma_f32_16x16x32_bf16 v[28:31], v[72:75], v[100:103], v[28:31]
    v_mfma_f32_16x16x32_bf16 v[24:27], v[76:79], v[100:103], v[24:27]
    buffer_load_dwordx4 v[72:75], v125, s[12:15], s26 offen offset:0
    v_mfma_f32_16x16x32_bf16 v[60:63], v[84:87], v[104:107], v[60:63]
    buffer_load_dwordx4 v[84:87], v119, s[12:15], s23 offen offset:2048
    v_mfma_f32_16x16x32_bf16 v[28:31], v[76:79], v[108:111], v[28:31]
    buffer_load_dwordx4 v[76:79], v125, s[12:15], s26 offen offset:2048
    s_add_u32 s23, s23, 57344
    s_add_u32 s26, s26, 57344
    s_branch L_conv2_kernel_mloop2
L_conv2_kernel_mlast2:
    v_and_b32 v125, 15, v127
    v_and_b32 v126, 7, v127
    v_lshlrev_b32 v126, 4, v126
    v_lshl_add_u32 v125, v125, 7, v126
    v_lshrrev_b32 v126, 4, v127
    v_lshl_add_u32 v125, v126, 11, v125
    s_mov_b32 s36, 65536
    s_cmp_eq_u32 s32, 1
    s_cselect_b32 s36, 121856, s36
    s_cmp_eq_u32 s32, 2
    s_cselect_b32 s36, 81920, s36
    s_cmp_eq_u32 s32, 3
    s_cselect_b32 s36, 130048, s36
    s_mov_b32 s37, 98304
    s_cmp_eq_u32 s32, 1
    s_cselect_b32 s37, 138240, s37
    s_cmp_eq_u32 s32, 2
    s_cselect_b32 s37, 146432, s37
    s_cmp_eq_u32 s32, 3
    s_cselect_b32 s37, 154624, s37
    v_add_u32 v126, s37, v125
    v_add_u32 v125, s36, v125
    ds_read_b128 v[88:91], v120 offset:8192
    ds_read_b128 v[92:95], v120 offset:9216
    ds_read_b128 v[96:99], v116 offset:8704
    ds_read_b128 v[100:103], v120 offset:10240
    ds_read_b128 v[104:107], v116 offset:9792
    ds_read_b128 v[108:111], v120 offset:11264
    ds_read_b128 v[112:115], v116 offset:10880
    s_waitcnt vmcnt(5) lgkmcnt(6)
    v_mfma_f32_16x16x32_bf16 v[0:3], v[64:67], v[88:91], v[0:3]
    ds_read_b128 v[88:91], v120 offset:12288
    s_waitcnt vmcnt(4) lgkmcnt(6)
    v_mfma_f32_16x16x32_bf16 v[4:7], v[64:67], v[92:95], v[4:7]
    v_mfma_f32_16x16x32_bf16 v[0:3], v[68:71], v[92:95], v[0:3]
    ds_read_b128 v[92:95], v116 offset:11968
    s_waitcnt vmcnt(3) lgkmcnt(6)
    v_mfma_f32_16x16x32_bf16 v[32:35], v[80:83], v[96:99], v[32:35]
    ds_read_b128 v[96:99], v120 offset:13312
    s_waitcnt vmcnt(2) lgkmcnt(6)
    v_mfma_f32_16x16x32_bf16 v[8:11], v[64:67], v[100:103], v[8:11]
    v_mfma_f32_16x16x32_bf16 v[4:7], v[68:71], v[100:103], v[4:7]
    v_mfma_f32_16x16x32_bf16 v[0:3], v[72:75], v[100:103], v[0:3]
    ds_read_b128 v[100:103], v116 offset:13056
    s_waitcnt vmcnt(1) lgkmcnt(6)
    v_mfma_f32_16x16x32_bf16 v[36:39], v[80:83], v[104:107], v[36:39]
    v_mfma_f32_16x16x32_bf16 v[32:35], v[84:87], v[104:107], v[32:35]
    ds_read_b128 v[104:107], v120 offset:14336
    s_waitcnt vmcnt(0) lgkmcnt(6)
    v_mfma_f32_16x16x32_bf16 v[12:15], v[64:67], v[108:111], v[12:15]
    v_mfma_f32_16x16x32_bf16 v[8:11], v[68:71], v[108:111], v[8:11]
    v_mfma_f32_16x16x32_bf16 v[4:7], v[72:75], v[108:111], v[4:7]
    v_mfma_f32_16x16x32_bf16 v[0:3], v[76:79], v[108:111], v[0:3]
    ds_read_b128 v[108:111], v116 offset:14144
    s_waitcnt lgkmcnt(6)
    v_mfma_f32_16x16x32_bf16 v[40:43], v[80:83], v[112:115], v[40:43]
    v_mfma_f32_16x16x32_bf16 v[36:39], v[84:87], v[112:115], v[36:39]
    ds_read_b128 v[112:115], v120 offset:15360
    s_waitcnt lgkmcnt(6)
    v_mfma_f32_16x16x32_bf16 v[16:19], v[64:67], v[88:91], v[16:19]
    v_mfma_f32_16x16x32_bf16 v[12:15], v[68:71], v[88:91], v[12:15]
    v_mfma_f32_16x16x32_bf16 v[8:11], v[72:75], v[88:91], v[8:11]
    v_mfma_f32_16x16x32_bf16 v[4:7], v[76:79], v[88:91], v[4:7]
    ds_read_b128 v[88:91], v117 offset:8704
    v_xor_b32 v124, 0, v126
    ds_write_b128 v124, v[32:35]
    s_waitcnt lgkmcnt(7)
    v_mfma_f32_16x16x32_bf16 v[44:47], v[80:83], v[92:95], v[44:47]
    v_mfma_f32_16x16x32_bf16 v[40:43], v[84:87], v[92:95], v[40:43]
    ds_read_b128 v[92:95], v122 offset:0
    v_xor_b32 v123, 0, v125
    ds_write_b128 v123, v[0:3]
    s_waitcnt lgkmcnt(8)
    v_mfma_f32_16x16x32_bf16 v[20:23], v[64:67], v[96:99], v[20:23]
    v_mfma_f32_16x16x32_bf16 v[16:19], v[68:71], v[96:99], v[16:19]
    v_mfma_f32_16x16x32_bf16 v[12:15], v[72:75], v[96:99], v[12:15]
    v_mfma_f32_16x16x32_bf16 v[8:11], v[76:79], v[96:99], v[8:11]
    ds_read_b128 v[96:99], v117 offset:9792
    v_xor_b32 v123, 16, v126
    ds_write_b128 v123, v[36:39]
    s_waitcnt lgkmcnt(9)
    v_mfma_f32_16x16x32_bf16 v[48:51], v[80:83], v[100:103], v[48:51]
    v_mfma_f32_16x16x32_bf16 v[44:47], v[84:87], v[100:103], v[44:47]
    ds_read_b128 v[100:103], v121 offset:9216
    v_xor_b32 v124, 16, v125
    ds_write_b128 v124, v[4:7]
    s_waitcnt lgkmcnt(10)
    v_mfma_f32_16x16x32_bf16 v[24:27], v[64:67], v[104:107], v[24:27]
    v_mfma_f32_16x16x32_bf16 v[20:23], v[68:71], v[104:107], v[20:23]
    v_mfma_f32_16x16x32_bf16 v[16:19], v[72:75], v[104:107], v[16:19]
    v_mfma_f32_16x16x32_bf16 v[12:15], v[76:79], v[104:107], v[12:15]
    ds_read_b128 v[104:107], v118 offset:8704
    v_xor_b32 v124, 32, v126
    ds_write_b128 v124, v[40:43]
    s_waitcnt lgkmcnt(11)
    v_mfma_f32_16x16x32_bf16 v[52:55], v[80:83], v[108:111], v[52:55]
    v_mfma_f32_16x16x32_bf16 v[48:51], v[84:87], v[108:111], v[48:51]
    ds_read_b128 v[108:111], v121 offset:10240
    v_xor_b32 v123, 32, v125
    ds_write_b128 v123, v[8:11]
    s_waitcnt lgkmcnt(12)
    v_mfma_f32_16x16x32_bf16 v[28:31], v[64:67], v[112:115], v[28:31]
    v_mfma_f32_16x16x32_bf16 v[24:27], v[68:71], v[112:115], v[24:27]
    v_mfma_f32_16x16x32_bf16 v[20:23], v[72:75], v[112:115], v[20:23]
    v_mfma_f32_16x16x32_bf16 v[16:19], v[76:79], v[112:115], v[16:19]
    v_xor_b32 v123, 48, v126
    ds_write_b128 v123, v[44:47]
    s_waitcnt lgkmcnt(12)
    v_mfma_f32_16x16x32_bf16 v[56:59], v[80:83], v[88:91], v[56:59]
    v_mfma_f32_16x16x32_bf16 v[52:55], v[84:87], v[88:91], v[52:55]
    v_xor_b32 v124, 48, v125
    ds_write_b128 v124, v[12:15]
    s_waitcnt lgkmcnt(11)
    v_mfma_f32_16x16x32_bf16 v[28:31], v[68:71], v[92:95], v[28:31]
    v_mfma_f32_16x16x32_bf16 v[24:27], v[72:75], v[92:95], v[24:27]
    v_mfma_f32_16x16x32_bf16 v[20:23], v[76:79], v[92:95], v[20:23]
    v_xor_b32 v124, 64, v126
    ds_write_b128 v124, v[48:51]
    s_waitcnt lgkmcnt(10)
    v_mfma_f32_16x16x32_bf16 v[60:63], v[80:83], v[96:99], v[60:63]
    v_mfma_f32_16x16x32_bf16 v[56:59], v[84:87], v[96:99], v[56:59]
    v_xor_b32 v123, 64, v125
    ds_write_b128 v123, v[16:19]
    s_waitcnt lgkmcnt(9)
    v_mfma_f32_16x16x32_bf16 v[28:31], v[72:75], v[100:103], v[28:31]
    v_mfma_f32_16x16x32_bf16 v[24:27], v[76:79], v[100:103], v[24:27]
    v_xor_b32 v123, 80, v126
    ds_write_b128 v123, v[52:55]
    s_waitcnt lgkmcnt(8)
    v_mfma_f32_16x16x32_bf16 v[60:63], v[84:87], v[104:107], v[60:63]
    v_xor_b32 v124, 80, v125
    ds_write_b128 v124, v[20:23]
    s_waitcnt lgkmcnt(7)
    v_mfma_f32_16x16x32_bf16 v[28:31], v[76:79], v[108:111], v[28:31]
    v_xor_b32 v124, 96, v126
    ds_write_b128 v124, v[56:59]
    v_and_b32 v108, 15, v127
    v_lshrrev_b32 v109, 4, v127
    v_lshrrev_b32 v110, 3, v108
    s_lshl_b32 s36, s20, 1
    v_add_u32 v110, s36, v110
    v_xor_b32 v111, v110, v108
    v_and_b32 v111, 7, v111
    v_lshlrev_b32 v111, 4, v111
    v_xor_b32 v123, 96, v125
    ds_write_b128 v123, v[24:27]
    v_lshl_add_u32 v111, v110, 7, v111
    v_lshl_add_u32 v120, v109, 11, v111
    v_add_u32 v121, 65536, v120
    v_add_u32 v64, 131072, v120
    s_lshl_b32 s36, s20, 9
    s_add_u32 s36, s36, 115712
    v_lshl_add_u32 v127, v109, 7, s36
    s_lshl_b32 s36, s20, 4
    v_add_u32 v108, s36, v108
    v_lshlrev_b32 v110, 6, v108
    v_lshl_add_u32 v110, v109, 4, v110
    s_mul_i32 s36, s29, 262144
    v_xor_b32 v123, 112, v126
    ds_write_b128 v123, v[60:63]
    s_lshl_b32 s37, s21, 4
    s_add_u32 s36, s36, s37
    v_add_u32 v110, s36, v110
    v_mov_b32 v111, 2130706432
    v_cmp_gt_u32 vcc, 125, v108
    s_mov_b32 s4, 0xbeaaaaab
    s_mov_b32 s5, s4
    s_mov_b32 s6, 0x3e800000
    s_mov_b32 s7, s6
    s_mov_b32 s8, 0xc0a00000
    s_mov_b32 s9, s8
    s_mov_b32 s10, 0xc0638e39
    v_xor_b32 v124, 112, v125
    ds_write_b128 v124, v[28:31]
    s_mov_b32 s11, s10
    s_mov_b32 s12, 0xbf638e39
    s_mov_b32 s13, s12
    s_mov_b32 s14, 0xbe638e39
    s_mov_b32 s15, s14
    s_mov_b32 s22, 0xbd638e39
    s_mov_b32 s23, s22
    s_mov_b32 s24, 0x3ff1c71c
    s_mov_b32 s25, s24
    s_mov_b32 s26, 0xbf2aaaab
    s_mov_b32 s27, s26
    s_mov_b32 s32, 0x3ecccccd
    s_mov_b32 s33, s32
    s_mov_b32 s34, 0xbd888889
    s_mov_b32 s35, s34
    s_mov_b32 s38, 0xbe4ccccd
    s_mov_b32 s39, s38
    s_mov_b32 s40, 0xbdd2d3e8
    s_mov_b32 s41, s40
    s_mov_b32 s42, 0x3f800000
    s_mov_b32 s43, s42
    s_setprio 0
    s_branch L_conv2_kernel_epi
L_conv2_kernel_helper:
    s_setprio 3
    v_lshlrev_b32 v8, 4, v6
    s_add_u32 s37, s33, 4294967289
    v_lshl_add_u32 v9, v7, 3, s37
    v_cmp_gt_u32 vcc, 8000, v9
    s_mul_i32 s37, s33, 131072
    s_add_u32 s37, s37, 0
    v_lshl_add_u32 v92, v7, 7, s37
    v_add_u32 v92, v92, v8
    v_mov_b32 v9, 2130706432
    v_cndmask_b32 v92, v9, v92, vcc
    s_add_u32 s37, s33, 4294967291
    v_lshl_add_u32 v9, v7, 3, s37
    v_cmp_gt_u32 vcc, 8000, v9
    s_mul_i32 s37, s33, 131072
    s_add_u32 s37, s37, 262144
    v_lshl_add_u32 v93, v7, 7, s37
    v_add_u32 v93, v93, v8
    v_mov_b32 v9, 2130706432
    v_cndmask_b32 v93, v9, v93, vcc
    s_add_u32 s37, s33, 4294967293
    v_lshl_add_u32 v9, v7, 3, s37
    v_cmp_gt_u32 vcc, 8000, v9
    s_mul_i32 s37, s33, 131072
    s_add_u32 s37, s37, 64
    v_lshl_add_u32 v94, v7, 7, s37
    v_add_u32 v94, v94, v8
    v_mov_b32 v9, 2130706432
    v_cndmask_b32 v94, v9, v94, vcc
    s_add_u32 s37, s33, 4294967295
    v_lshl_add_u32 v9, v7, 3, s37
    v_cmp_gt_u32 vcc, 8000, v9
    s_mul_i32 s37, s33, 131072
    s_add_u32 s37, s37, 262208
    v_lshl_add_u32 v95, v7, 7, s37
    v_add_u32 v95, v95, v8
    v_mov_b32 v9, 2130706432
    v_cndmask_b32 v95, v9, v95, vcc
    v_and_b32 v76, 4, v5
    v_lshrrev_b32 v76, 1, v76
    v_xor_b32 v76, v6, v76
    v_lshlrev_b32 v76, 4, v76
    v_lshl_add_u32 v76, v5, 6, v76
    s_mov_b32 s24, 0
    s_mov_b32 s27, 524288
    buffer_load_dwordx4 v[0:3], v92, s[8:11], s24 offen
    buffer_load_dwordx4 v[8:11], v94, s[8:11], s24 offen
    buffer_load_dwordx4 v[4:7], v93, s[8:11], s24 offen
    buffer_load_dwordx4 v[12:15], v95, s[8:11], s24 offen
    buffer_load_dwordx4 v[16:19], v92, s[8:11], s27 offen
    buffer_load_dwordx4 v[24:27], v94, s[8:11], s27 offen
    buffer_load_dwordx4 v[20:23], v93, s[8:11], s27 offen
    buffer_load_dwordx4 v[28:31], v95, s[8:11], s27 offen
    s_barrier
    s_mul_i32 s36, s42, 1024
    v_add_u32 v96, s36, v76
    v_add_u32 v97, 65536, v96
    s_mul_i32 s36, s42, 1088
    s_add_u32 s36, s36, 98304
    v_add_u32 v98, s36, v76
    s_waitcnt vmcnt(0)
    s_mov_b32 s28, 0
    s_mov_b32 s22, 2
    s_cmp_ge_u32 s20, 12
    s_cbranch_scc1 L_conv2_kernel_h2
    ds_write_b128 v96, v[0:3] offset:0
    ds_write_b128 v98, v[12:15] offset:0
    v_lshlrev_b32 v76, 16, v0
    v_and_b32 v84, s25, v0
    v_lshlrev_b32 v77, 16, v4
    v_and_b32 v85, s25, v4
    v_lshlrev_b32 v78, 16, v8
    v_and_b32 v86, s25, v8
    v_lshlrev_b32 v79, 16, v12
    v_and_b32 v87, s25, v12
    v_add_f32 v80, v76, v78
    v_add_f32 v88, v84, v86
    v_add_f32 v81, v77, v79
    v_add_f32 v89, v85, v87
    v_fma_f32 v82, v78, 4.0, v76
    v_fma_f32 v90, v86, 4.0, v84
    v_fma_f32 v83, v79, 4.0, v77
    v_fma_f32 v91, v87, 4.0, v85
    v_add_f32 v77, v80, v81
    v_add_f32 v85, v88, v89
    v_sub_f32 v78, v80, v81
    v_sub_f32 v86, v88, v89
    v_fma_f32 v79, v83, 2.0, v82
    v_fma_f32 v87, v91, 2.0, v90
    v_fma_f32 v82, v83, -2.0, v82
    v_fma_f32 v90, v91, -2.0, v90
    v_fmamk_f32 v80, v76, 0x41700000, v82
    v_fmamk_f32 v88, v84, 0x41700000, v90
    v_fmamk_f32 v80, v81, 0x41200000, v80
    v_fmamk_f32 v88, v89, 0x41200000, v88
    v_cvt_pk_bf16_f32 v4, v77, v85
    v_cvt_pk_bf16_f32 v8, v78, v86
    v_cvt_pk_bf16_f32 v64, v79, v87
    v_cvt_pk_bf16_f32 v68, v82, v90
    v_cvt_pk_bf16_f32 v72, v80, v88
    v_lshlrev_b32 v76, 16, v1
    v_and_b32 v84, s25, v1
    v_lshlrev_b32 v77, 16, v5
    v_and_b32 v85, s25, v5
    v_lshlrev_b32 v78, 16, v9
    v_and_b32 v86, s25, v9
    v_lshlrev_b32 v79, 16, v13
    v_and_b32 v87, s25, v13
    v_add_f32 v80, v76, v78
    v_add_f32 v88, v84, v86
    v_add_f32 v81, v77, v79
    v_add_f32 v89, v85, v87
    v_fma_f32 v82, v78, 4.0, v76
    v_fma_f32 v90, v86, 4.0, v84
    v_fma_f32 v83, v79, 4.0, v77
    v_fma_f32 v91, v87, 4.0, v85
    v_add_f32 v77, v80, v81
    v_add_f32 v85, v88, v89
    v_sub_f32 v78, v80, v81
    v_sub_f32 v86, v88, v89
    v_fma_f32 v79, v83, 2.0, v82
    v_fma_f32 v87, v91, 2.0, v90
    v_fma_f32 v82, v83, -2.0, v82
    v_fma_f32 v90, v91, -2.0, v90
    v_fmamk_f32 v80, v76, 0x41700000, v82
    v_fmamk_f32 v88, v84, 0x41700000, v90
    v_fmamk_f32 v80, v81, 0x41200000, v80
    v_fmamk_f32 v88, v89, 0x41200000, v88
    v_cvt_pk_bf16_f32 v5, v77, v85
    v_cvt_pk_bf16_f32 v9, v78, v86
    v_cvt_pk_bf16_f32 v65, v79, v87
    v_cvt_pk_bf16_f32 v69, v82, v90
    v_cvt_pk_bf16_f32 v73, v80, v88
    v_lshlrev_b32 v76, 16, v2
    v_and_b32 v84, s25, v2
    v_lshlrev_b32 v77, 16, v6
    v_and_b32 v85, s25, v6
    v_lshlrev_b32 v78, 16, v10
    v_and_b32 v86, s25, v10
    v_lshlrev_b32 v79, 16, v14
    v_and_b32 v87, s25, v14
    v_add_f32 v80, v76, v78
    v_add_f32 v88, v84, v86
    v_add_f32 v81, v77, v79
    v_add_f32 v89, v85, v87
    v_fma_f32 v82, v78, 4.0, v76
    v_fma_f32 v90, v86, 4.0, v84
    v_fma_f32 v83, v79, 4.0, v77
    v_fma_f32 v91, v87, 4.0, v85
    v_add_f32 v77, v80, v81
    v_add_f32 v85, v88, v89
    v_sub_f32 v78, v80, v81
    v_sub_f32 v86, v88, v89
    v_fma_f32 v79, v83, 2.0, v82
    v_fma_f32 v87, v91, 2.0, v90
    v_fma_f32 v82, v83, -2.0, v82
    v_fma_f32 v90, v91, -2.0, v90
    v_fmamk_f32 v80, v76, 0x41700000, v82
    v_fmamk_f32 v88, v84, 0x41700000, v90
    v_fmamk_f32 v80, v81, 0x41200000, v80
    v_fmamk_f32 v88, v89, 0x41200000, v88
    v_cvt_pk_bf16_f32 v6, v77, v85
    v_cvt_pk_bf16_f32 v10, v78, v86
    v_cvt_pk_bf16_f32 v66, v79, v87
    v_cvt_pk_bf16_f32 v70, v82, v90
    v_cvt_pk_bf16_f32 v74, v80, v88
    v_lshlrev_b32 v76, 16, v3
    v_and_b32 v84, s25, v3
    v_lshlrev_b32 v77, 16, v7
    v_and_b32 v85, s25, v7
    v_lshlrev_b32 v78, 16, v11
    v_and_b32 v86, s25, v11
    v_lshlrev_b32 v79, 16, v15
    v_and_b32 v87, s25, v15
    v_add_f32 v80, v76, v78
    v_add_f32 v88, v84, v86
    v_add_f32 v81, v77, v79
    v_add_f32 v89, v85, v87
    v_fma_f32 v82, v78, 4.0, v76
    v_fma_f32 v90, v86, 4.0, v84
    v_fma_f32 v83, v79, 4.0, v77
    v_fma_f32 v91, v87, 4.0, v85
    v_add_f32 v77, v80, v81
    v_add_f32 v85, v88, v89
    v_sub_f32 v78, v80, v81
    v_sub_f32 v86, v88, v89
    v_fma_f32 v79, v83, 2.0, v82
    v_fma_f32 v87, v91, 2.0, v90
    v_fma_f32 v82, v83, -2.0, v82
    v_fma_f32 v90, v91, -2.0, v90
    v_fmamk_f32 v80, v76, 0x41700000, v82
    v_fmamk_f32 v88, v84, 0x41700000, v90
    v_fmamk_f32 v80, v81, 0x41200000, v80
    v_fmamk_f32 v88, v89, 0x41200000, v88
    v_cvt_pk_bf16_f32 v7, v77, v85
    v_cvt_pk_bf16_f32 v11, v78, v86
    v_cvt_pk_bf16_f32 v67, v79, v87
    v_cvt_pk_bf16_f32 v71, v82, v90
    v_cvt_pk_bf16_f32 v75, v80, v88
    ds_write_b128 v96, v[64:67] offset:49152
    ds_write_b128 v97, v[68:71] offset:0
    ds_write_b128 v97, v[72:75] offset:16384
    ds_write_b128 v96, v[4:7] offset:16384
    ds_write_b128 v96, v[8:11] offset:32768
    s_waitcnt vmcnt(0)
    s_mov_b32 s24, 1048576
    s_mov_b32 s27, 1572864
    buffer_load_dwordx4 v[32:35], v92, s[8:11], s24 offen
    buffer_load_dwordx4 v[40:43], v94, s[8:11], s24 offen
    buffer_load_dwordx4 v[36:39], v93, s[8:11], s24 offen
    buffer_load_dwordx4 v[44:47], v95, s[8:11], s24 offen
    s_waitcnt lgkmcnt(0)
    s_barrier
    s_setprio 1
L_conv2_kernel_hloop1:
    v_lshlrev_b32 v76, 16, v16
    v_and_b32 v84, s25, v16
    v_lshlrev_b32 v77, 16, v20
    v_and_b32 v85, s25, v20
    v_lshlrev_b32 v78, 16, v24
    v_and_b32 v86, s25, v24
    v_lshlrev_b32 v79, 16, v28
    v_and_b32 v87, s25, v28
    v_add_f32 v80, v76, v78
    v_add_f32 v88, v84, v86
    v_add_f32 v81, v77, v79
    v_add_f32 v89, v85, v87
    v_fma_f32 v82, v78, 4.0, v76
    buffer_load_dwordx4 v[48:51], v92, s[8:11], s27 offen
    buffer_load_dwordx4 v[56:59], v94, s[8:11], s27 offen
    v_fma_f32 v90, v86, 4.0, v84
    v_fma_f32 v83, v79, 4.0, v77
    v_fma_f32 v91, v87, 4.0, v85
    v_add_f32 v77, v80, v81
    v_add_f32 v85, v88, v89
    v_sub_f32 v78, v80, v81
    v_sub_f32 v86, v88, v89
    v_fma_f32 v79, v83, 2.0, v82
    v_fma_f32 v87, v91, 2.0, v90
    v_fma_f32 v82, v83, -2.0, v82
    v_fma_f32 v90, v91, -2.0, v90
    v_fmamk_f32 v80, v76, 0x41700000, v82
    v_fmamk_f32 v88, v84, 0x41700000, v90
    v_fmamk_f32 v80, v81, 0x41200000, v80
    v_fmamk_f32 v88, v89, 0x41200000, v88
    v_cvt_pk_bf16_f32 v20, v77, v85
    v_cvt_pk_bf16_f32 v24, v78, v86
    v_cvt_pk_bf16_f32 v64, v79, v87
    v_cvt_pk_bf16_f32 v68, v82, v90
    v_cvt_pk_bf16_f32 v72, v80, v88
    v_lshlrev_b32 v76, 16, v17
    v_and_b32 v84, s25, v17
    v_lshlrev_b32 v77, 16, v21
    v_and_b32 v85, s25, v21
    v_lshlrev_b32 v78, 16, v25
    v_and_b32 v86, s25, v25
    v_lshlrev_b32 v79, 16, v29
    v_and_b32 v87, s25, v29
    v_add_f32 v80, v76, v78
    v_add_f32 v88, v84, v86
    v_add_f32 v81, v77, v79
    v_add_f32 v89, v85, v87
    v_fma_f32 v82, v78, 4.0, v76
    v_fma_f32 v90, v86, 4.0, v84
    v_fma_f32 v83, v79, 4.0, v77
    v_fma_f32 v91, v87, 4.0, v85
    v_add_f32 v77, v80, v81
    v_add_f32 v85, v88, v89
    v_sub_f32 v78, v80, v81
    v_sub_f32 v86, v88, v89
    v_fma_f32 v79, v83, 2.0, v82
    v_fma_f32 v87, v91, 2.0, v90
    v_fma_f32 v82, v83, -2.0, v82
    v_fma_f32 v90, v91, -2.0, v90
    v_fmamk_f32 v80, v76, 0x41700000, v82
    v_fmamk_f32 v88, v84, 0x41700000, v90
    v_fmamk_f32 v80, v81, 0x41200000, v80
    v_fmamk_f32 v88, v89, 0x41200000, v88
    v_cvt_pk_bf16_f32 v21, v77, v85
    v_cvt_pk_bf16_f32 v25, v78, v86
    v_cvt_pk_bf16_f32 v65, v79, v87
    v_cvt_pk_bf16_f32 v69, v82, v90
    v_cvt_pk_bf16_f32 v73, v80, v88
    buffer_load_dwordx4 v[52:55], v93, s[8:11], s27 offen
    buffer_load_dwordx4 v[60:63], v95, s[8:11], s27 offen
    v_lshlrev_b32 v76, 16, v18
    v_and_b32 v84, s25, v18
    v_lshlrev_b32 v77, 16, v22
    v_and_b32 v85, s25, v22
    v_lshlrev_b32 v78, 16, v26
    v_and_b32 v86, s25, v26
    v_lshlrev_b32 v79, 16, v30
    v_and_b32 v87, s25, v30
    v_add_f32 v80, v76, v78
    v_add_f32 v88, v84, v86
    v_add_f32 v81, v77, v79
    v_add_f32 v89, v85, v87
    v_fma_f32 v82, v78, 4.0, v76
    v_fma_f32 v90, v86, 4.0, v84
    v_fma_f32 v83, v79, 4.0, v77
    v_fma_f32 v91, v87, 4.0, v85
    v_add_f32 v77, v80, v81
    v_add_f32 v85, v88, v89
    v_sub_f32 v78, v80, v81
    v_sub_f32 v86, v88, v89
    v_fma_f32 v79, v83, 2.0, v82
    v_fma_f32 v87, v91, 2.0, v90
    v_fma_f32 v82, v83, -2.0, v82
    v_fma_f32 v90, v91, -2.0, v90
    v_fmamk_f32 v80, v76, 0x41700000, v82
    v_fmamk_f32 v88, v84, 0x41700000, v90
    v_fmamk_f32 v80, v81, 0x41200000, v80
    v_fmamk_f32 v88, v89, 0x41200000, v88
    v_cvt_pk_bf16_f32 v22, v77, v85
    v_cvt_pk_bf16_f32 v26, v78, v86
    v_cvt_pk_bf16_f32 v66, v79, v87
    v_cvt_pk_bf16_f32 v70, v82, v90
    v_cvt_pk_bf16_f32 v74, v80, v88
    v_lshlrev_b32 v76, 16, v19
    v_and_b32 v84, s25, v19
    v_lshlrev_b32 v77, 16, v23
    v_and_b32 v85, s25, v23
    v_lshlrev_b32 v78, 16, v27
    v_and_b32 v86, s25, v27
    v_lshlrev_b32 v79, 16, v31
    v_and_b32 v87, s25, v31
    v_add_f32 v80, v76, v78
    v_add_f32 v88, v84, v86
    v_add_f32 v81, v77, v79
    v_add_f32 v89, v85, v87
    v_fma_f32 v82, v78, 4.0, v76
    v_fma_f32 v90, v86, 4.0, v84
    v_fma_f32 v83, v79, 4.0, v77
    v_fma_f32 v91, v87, 4.0, v85
    v_add_f32 v77, v80, v81
    v_add_f32 v85, v88, v89
    v_sub_f32 v78, v80, v81
    v_sub_f32 v86, v88, v89
    v_fma_f32 v79, v83, 2.0, v82
    v_fma_f32 v87, v91, 2.0, v90
    v_fma_f32 v82, v83, -2.0, v82
    v_fma_f32 v90, v91, -2.0, v90
    v_fmamk_f32 v80, v76, 0x41700000, v82
    v_fmamk_f32 v88, v84, 0x41700000, v90
    v_fmamk_f32 v80, v81, 0x41200000, v80
    v_fmamk_f32 v88, v89, 0x41200000, v88
    v_cvt_pk_bf16_f32 v23, v77, v85
    v_cvt_pk_bf16_f32 v27, v78, v86
    v_cvt_pk_bf16_f32 v67, v79, v87
    v_cvt_pk_bf16_f32 v71, v82, v90
    v_cvt_pk_bf16_f32 v75, v80, v88
    ds_write_b128 v96, v[64:67] offset:57344
    ds_write_b128 v97, v[68:71] offset:8192
    ds_write_b128 v97, v[72:75] offset:24576
    ds_write_b128 v96, v[16:19] offset:8192
    ds_write_b128 v96, v[20:23] offset:24576
    ds_write_b128 v96, v[24:27] offset:40960
    ds_write_b128 v98, v[28:31] offset:8704
    s_add_u32 s28, s28, 1
    s_waitcnt lgkmcnt(0)
    s_barrier
    s_add_u32 s24, s24, 1048576
    s_add_u32 s27, s27, 1048576
    s_waitcnt vmcnt(0)
    v_lshlrev_b32 v76, 16, v32
    v_and_b32 v84, s25, v32
    v_lshlrev_b32 v77, 16, v36
    v_and_b32 v85, s25, v36
    v_lshlrev_b32 v78, 16, v40
    v_and_b32 v86, s25, v40
    v_lshlrev_b32 v79, 16, v44
    v_and_b32 v87, s25, v44
    v_add_f32 v80, v76, v78
    v_add_f32 v88, v84, v86
    v_add_f32 v81, v77, v79
    v_add_f32 v89, v85, v87
    v_fma_f32 v82, v78, 4.0, v76
    v_fma_f32 v90, v86, 4.0, v84
    v_fma_f32 v83, v79, 4.0, v77
    v_fma_f32 v91, v87, 4.0, v85
    v_add_f32 v77, v80, v81
    v_add_f32 v85, v88, v89
    v_sub_f32 v78, v80, v81
    v_sub_f32 v86, v88, v89
    v_fma_f32 v79, v83, 2.0, v82
    v_fma_f32 v87, v91, 2.0, v90
    v_fma_f32 v82, v83, -2.0, v82
    v_fma_f32 v90, v91, -2.0, v90
    v_fmamk_f32 v80, v76, 0x41700000, v82
    v_fmamk_f32 v88, v84, 0x41700000, v90
    v_fmamk_f32 v80, v81, 0x41200000, v80
    v_fmamk_f32 v88, v89, 0x41200000, v88
    v_cvt_pk_bf16_f32 v36, v77, v85
    v_cvt_pk_bf16_f32 v40, v78, v86
    v_cvt_pk_bf16_f32 v64, v79, v87
    v_cvt_pk_bf16_f32 v68, v82, v90
    v_cvt_pk_bf16_f32 v72, v80, v88
    v_lshlrev_b32 v76, 16, v33
    v_and_b32 v84, s25, v33
    v_lshlrev_b32 v77, 16, v37
    v_and_b32 v85, s25, v37
    v_lshlrev_b32 v78, 16, v41
    v_and_b32 v86, s25, v41
    buffer_load_dwordx4 v[0:3], v92, s[8:11], s24 offen
    buffer_load_dwordx4 v[8:11], v94, s[8:11], s24 offen
    v_lshlrev_b32 v79, 16, v45
    v_and_b32 v87, s25, v45
    v_add_f32 v80, v76, v78
    v_add_f32 v88, v84, v86
    v_add_f32 v81, v77, v79
    v_add_f32 v89, v85, v87
    v_fma_f32 v82, v78, 4.0, v76
    v_fma_f32 v90, v86, 4.0, v84
    v_fma_f32 v83, v79, 4.0, v77
    v_fma_f32 v91, v87, 4.0, v85
    v_add_f32 v77, v80, v81
    v_add_f32 v85, v88, v89
    v_sub_f32 v78, v80, v81
    v_sub_f32 v86, v88, v89
    v_fma_f32 v79, v83, 2.0, v82
    v_fma_f32 v87, v91, 2.0, v90
    v_fma_f32 v82, v83, -2.0, v82
    v_fma_f32 v90, v91, -2.0, v90
    v_fmamk_f32 v80, v76, 0x41700000, v82
    v_fmamk_f32 v88, v84, 0x41700000, v90
    v_fmamk_f32 v80, v81, 0x41200000, v80
    v_fmamk_f32 v88, v89, 0x41200000, v88
    v_cvt_pk_bf16_f32 v37, v77, v85
    v_cvt_pk_bf16_f32 v41, v78, v86
    v_cvt_pk_bf16_f32 v65, v79, v87
    v_cvt_pk_bf16_f32 v69, v82, v90
    v_cvt_pk_bf16_f32 v73, v80, v88
    v_lshlrev_b32 v76, 16, v34
    v_and_b32 v84, s25, v34
    v_lshlrev_b32 v77, 16, v38
    v_and_b32 v85, s25, v38
    v_lshlrev_b32 v78, 16, v42
    v_and_b32 v86, s25, v42
    v_lshlrev_b32 v79, 16, v46
    v_and_b32 v87, s25, v46
    v_add_f32 v80, v76, v78
    v_add_f32 v88, v84, v86
    v_add_f32 v81, v77, v79
    v_add_f32 v89, v85, v87
    v_fma_f32 v82, v78, 4.0, v76
    v_fma_f32 v90, v86, 4.0, v84
    v_fma_f32 v83, v79, 4.0, v77
    v_fma_f32 v91, v87, 4.0, v85
    v_add_f32 v77, v80, v81
    v_add_f32 v85, v88, v89
    v_sub_f32 v78, v80, v81
    v_sub_f32 v86, v88, v89
    v_fma_f32 v79, v83, 2.0, v82
    v_fma_f32 v87, v91, 2.0, v90
    v_fma_f32 v82, v83, -2.0, v82
    v_fma_f32 v90, v91, -2.0, v90
    v_fmamk_f32 v80, v76, 0x41700000, v82
    v_fmamk_f32 v88, v84, 0x41700000, v90
    buffer_load_dwordx4 v[4:7], v93, s[8:11], s24 offen
    buffer_load_dwordx4 v[12:15], v95, s[8:11], s24 offen
    v_fmamk_f32 v80, v81, 0x41200000, v80
    v_fmamk_f32 v88, v89, 0x41200000, v88
    v_cvt_pk_bf16_f32 v38, v77, v85
    v_cvt_pk_bf16_f32 v42, v78, v86
    v_cvt_pk_bf16_f32 v66, v79, v87
    v_cvt_pk_bf16_f32 v70, v82, v90
    v_cvt_pk_bf16_f32 v74, v80, v88
    v_lshlrev_b32 v76, 16, v35
    v_and_b32 v84, s25, v35
    v_lshlrev_b32 v77, 16, v39
    v_and_b32 v85, s25, v39
    v_lshlrev_b32 v78, 16, v43
    v_and_b32 v86, s25, v43
    v_lshlrev_b32 v79, 16, v47
    v_and_b32 v87, s25, v47
    v_add_f32 v80, v76, v78
    v_add_f32 v88, v84, v86
    v_add_f32 v81, v77, v79
    v_add_f32 v89, v85, v87
    v_fma_f32 v82, v78, 4.0, v76
    v_fma_f32 v90, v86, 4.0, v84
    v_fma_f32 v83, v79, 4.0, v77
    v_fma_f32 v91, v87, 4.0, v85
    v_add_f32 v77, v80, v81
    v_add_f32 v85, v88, v89
    v_sub_f32 v78, v80, v81
    v_sub_f32 v86, v88, v89
    v_fma_f32 v79, v83, 2.0, v82
    v_fma_f32 v87, v91, 2.0, v90
    v_fma_f32 v82, v83, -2.0, v82
    v_fma_f32 v90, v91, -2.0, v90
    v_fmamk_f32 v80, v76, 0x41700000, v82
    v_fmamk_f32 v88, v84, 0x41700000, v90
    v_fmamk_f32 v80, v81, 0x41200000, v80
    v_fmamk_f32 v88, v89, 0x41200000, v88
    v_cvt_pk_bf16_f32 v39, v77, v85
    v_cvt_pk_bf16_f32 v43, v78, v86
    v_cvt_pk_bf16_f32 v67, v79, v87
    v_cvt_pk_bf16_f32 v71, v82, v90
    v_cvt_pk_bf16_f32 v75, v80, v88
    ds_write_b128 v96, v[64:67] offset:49152
    ds_write_b128 v97, v[68:71] offset:0
    ds_write_b128 v97, v[72:75] offset:16384
    ds_write_b128 v96, v[32:35] offset:0
    ds_write_b128 v96, v[36:39] offset:16384
    ds_write_b128 v96, v[40:43] offset:32768
    ds_write_b128 v98, v[44:47] offset:0
    s_add_u32 s28, s28, 1
    s_waitcnt lgkmcnt(0)
    s_barrier
    v_lshlrev_b32 v76, 16, v48
    v_and_b32 v84, s25, v48
    v_lshlrev_b32 v77, 16, v52
    v_and_b32 v85, s25, v52
    v_lshlrev_b32 v78, 16, v56
    v_and_b32 v86, s25, v56
    v_lshlrev_b32 v79, 16, v60
    v_and_b32 v87, s25, v60
    v_add_f32 v80, v76, v78
    v_add_f32 v88, v84, v86
    v_add_f32 v81, v77, v79
    v_add_f32 v89, v85, v87
    v_fma_f32 v82, v78, 4.0, v76
    buffer_load_dwordx4 v[16:19], v92, s[8:11], s27 offen
    buffer_load_dwordx4 v[24:27], v94, s[8:11], s27 offen
    v_fma_f32 v90, v86, 4.0, v84
    v_fma_f32 v83, v79, 4.0, v77
    v_fma_f32 v91, v87, 4.0, v85
    v_add_f32 v77, v80, v81
    v_add_f32 v85, v88, v89
    v_sub_f32 v78, v80, v81
    v_sub_f32 v86, v88, v89
    v_fma_f32 v79, v83, 2.0, v82
    v_fma_f32 v87, v91, 2.0, v90
    v_fma_f32 v82, v83, -2.0, v82
    v_fma_f32 v90, v91, -2.0, v90
    v_fmamk_f32 v80, v76, 0x41700000, v82
    v_fmamk_f32 v88, v84, 0x41700000, v90
    v_fmamk_f32 v80, v81, 0x41200000, v80
    v_fmamk_f32 v88, v89, 0x41200000, v88
    v_cvt_pk_bf16_f32 v52, v77, v85
    v_cvt_pk_bf16_f32 v56, v78, v86
    v_cvt_pk_bf16_f32 v64, v79, v87
    v_cvt_pk_bf16_f32 v68, v82, v90
    v_cvt_pk_bf16_f32 v72, v80, v88
    v_lshlrev_b32 v76, 16, v49
    v_and_b32 v84, s25, v49
    v_lshlrev_b32 v77, 16, v53
    v_and_b32 v85, s25, v53
    v_lshlrev_b32 v78, 16, v57
    v_and_b32 v86, s25, v57
    v_lshlrev_b32 v79, 16, v61
    v_and_b32 v87, s25, v61
    v_add_f32 v80, v76, v78
    v_add_f32 v88, v84, v86
    v_add_f32 v81, v77, v79
    v_add_f32 v89, v85, v87
    v_fma_f32 v82, v78, 4.0, v76
    v_fma_f32 v90, v86, 4.0, v84
    v_fma_f32 v83, v79, 4.0, v77
    v_fma_f32 v91, v87, 4.0, v85
    v_add_f32 v77, v80, v81
    v_add_f32 v85, v88, v89
    v_sub_f32 v78, v80, v81
    v_sub_f32 v86, v88, v89
    v_fma_f32 v79, v83, 2.0, v82
    v_fma_f32 v87, v91, 2.0, v90
    v_fma_f32 v82, v83, -2.0, v82
    v_fma_f32 v90, v91, -2.0, v90
    v_fmamk_f32 v80, v76, 0x41700000, v82
    v_fmamk_f32 v88, v84, 0x41700000, v90
    v_fmamk_f32 v80, v81, 0x41200000, v80
    v_fmamk_f32 v88, v89, 0x41200000, v88
    v_cvt_pk_bf16_f32 v53, v77, v85
    v_cvt_pk_bf16_f32 v57, v78, v86
    v_cvt_pk_bf16_f32 v65, v79, v87
    v_cvt_pk_bf16_f32 v69, v82, v90
    v_cvt_pk_bf16_f32 v73, v80, v88
    buffer_load_dwordx4 v[20:23], v93, s[8:11], s27 offen
    buffer_load_dwordx4 v[28:31], v95, s[8:11], s27 offen
    v_lshlrev_b32 v76, 16, v50
    v_and_b32 v84, s25, v50
    v_lshlrev_b32 v77, 16, v54
    v_and_b32 v85, s25, v54
    v_lshlrev_b32 v78, 16, v58
    v_and_b32 v86, s25, v58
    v_lshlrev_b32 v79, 16, v62
    v_and_b32 v87, s25, v62
    v_add_f32 v80, v76, v78
    v_add_f32 v88, v84, v86
    v_add_f32 v81, v77, v79
    v_add_f32 v89, v85, v87
    v_fma_f32 v82, v78, 4.0, v76
    v_fma_f32 v90, v86, 4.0, v84
    v_fma_f32 v83, v79, 4.0, v77
    v_fma_f32 v91, v87, 4.0, v85
    v_add_f32 v77, v80, v81
    v_add_f32 v85, v88, v89
    v_sub_f32 v78, v80, v81
    v_sub_f32 v86, v88, v89
    v_fma_f32 v79, v83, 2.0, v82
    v_fma_f32 v87, v91, 2.0, v90
    v_fma_f32 v82, v83, -2.0, v82
    v_fma_f32 v90, v91, -2.0, v90
    v_fmamk_f32 v80, v76, 0x41700000, v82
    v_fmamk_f32 v88, v84, 0x41700000, v90
    v_fmamk_f32 v80, v81, 0x41200000, v80
    v_fmamk_f32 v88, v89, 0x41200000, v88
    v_cvt_pk_bf16_f32 v54, v77, v85
    v_cvt_pk_bf16_f32 v58, v78, v86
    v_cvt_pk_bf16_f32 v66, v79, v87
    v_cvt_pk_bf16_f32 v70, v82, v90
    v_cvt_pk_bf16_f32 v74, v80, v88
    v_lshlrev_b32 v76, 16, v51
    v_and_b32 v84, s25, v51
    v_lshlrev_b32 v77, 16, v55
    v_and_b32 v85, s25, v55
    v_lshlrev_b32 v78, 16, v59
    v_and_b32 v86, s25, v59
    v_lshlrev_b32 v79, 16, v63
    v_and_b32 v87, s25, v63
    v_add_f32 v80, v76, v78
    v_add_f32 v88, v84, v86
    v_add_f32 v81, v77, v79
    v_add_f32 v89, v85, v87
    v_fma_f32 v82, v78, 4.0, v76
    v_fma_f32 v90, v86, 4.0, v84
    v_fma_f32 v83, v79, 4.0, v77
    v_fma_f32 v91, v87, 4.0, v85
    v_add_f32 v77, v80, v81
    v_add_f32 v85, v88, v89
    v_sub_f32 v78, v80, v81
    v_sub_f32 v86, v88, v89
    v_fma_f32 v79, v83, 2.0, v82
    v_fma_f32 v87, v91, 2.0, v90
    v_fma_f32 v82, v83, -2.0, v82
    v_fma_f32 v90, v91, -2.0, v90
    v_fmamk_f32 v80, v76, 0x41700000, v82
    v_fmamk_f32 v88, v84, 0x41700000, v90
    v_fmamk_f32 v80, v81, 0x41200000, v80
    v_fmamk_f32 v88, v89, 0x41200000, v88
    v_cvt_pk_bf16_f32 v55, v77, v85
    v_cvt_pk_bf16_f32 v59, v78, v86
    v_cvt_pk_bf16_f32 v67, v79, v87
    v_cvt_pk_bf16_f32 v71, v82, v90
    v_cvt_pk_bf16_f32 v75, v80, v88
    ds_write_b128 v96, v[64:67] offset:57344
    ds_write_b128 v97, v[68:71] offset:8192
    ds_write_b128 v97, v[72:75] offset:24576
    ds_write_b128 v96, v[48:51] offset:8192
    ds_write_b128 v96, v[52:55] offset:24576
    ds_write_b128 v96, v[56:59] offset:40960
    ds_write_b128 v98, v[60:63] offset:8704
    s_add_u32 s28, s28, 1
    s_waitcnt lgkmcnt(0)
    s_barrier
    s_cmp_eq_u32 s22, 1
    s_cbranch_scc1 L_conv2_kernel_hlast1
    s_add_u32 s24, s24, 1048576
    s_add_u32 s27, s27, 1048576
    s_waitcnt vmcnt(0)
    v_lshlrev_b32 v76, 16, v0
    v_and_b32 v84, s25, v0
    v_lshlrev_b32 v77, 16, v4
    v_and_b32 v85, s25, v4
    v_lshlrev_b32 v78, 16, v8
    v_and_b32 v86, s25, v8
    v_lshlrev_b32 v79, 16, v12
    v_and_b32 v87, s25, v12
    v_add_f32 v80, v76, v78
    v_add_f32 v88, v84, v86
    v_add_f32 v81, v77, v79
    v_add_f32 v89, v85, v87
    v_fma_f32 v82, v78, 4.0, v76
    v_fma_f32 v90, v86, 4.0, v84
    v_fma_f32 v83, v79, 4.0, v77
    v_fma_f32 v91, v87, 4.0, v85
    v_add_f32 v77, v80, v81
    v_add_f32 v85, v88, v89
    v_sub_f32 v78, v80, v81
    v_sub_f32 v86, v88, v89
    v_fma_f32 v79, v83, 2.0, v82
    v_fma_f32 v87, v91, 2.0, v90
    v_fma_f32 v82, v83, -2.0, v82
    v_fma_f32 v90, v91, -2.0, v90
    v_fmamk_f32 v80, v76, 0x41700000, v82
    v_fmamk_f32 v88, v84, 0x41700000, v90
    v_fmamk_f32 v80, v81, 0x41200000, v80
    v_fmamk_f32 v88, v89, 0x41200000, v88
    v_cvt_pk_bf16_f32 v4, v77, v85
    v_cvt_pk_bf16_f32 v8, v78, v86
    v_cvt_pk_bf16_f32 v64, v79, v87
    v_cvt_pk_bf16_f32 v68, v82, v90
    v_cvt_pk_bf16_f32 v72, v80, v88
    v_lshlrev_b32 v76, 16, v1
    v_and_b32 v84, s25, v1
    v_lshlrev_b32 v77, 16, v5
    v_and_b32 v85, s25, v5
    v_lshlrev_b32 v78, 16, v9
    v_and_b32 v86, s25, v9
    buffer_load_dwordx4 v[32:35], v92, s[8:11], s24 offen
    buffer_load_dwordx4 v[40:43], v94, s[8:11], s24 offen
    v_lshlrev_b32 v79, 16, v13
    v_and_b32 v87, s25, v13
    v_add_f32 v80, v76, v78
    v_add_f32 v88, v84, v86
    v_add_f32 v81, v77, v79
    v_add_f32 v89, v85, v87
    v_fma_f32 v82, v78, 4.0, v76
    v_fma_f32 v90, v86, 4.0, v84
    v_fma_f32 v83, v79, 4.0, v77
    v_fma_f32 v91, v87, 4.0, v85
    v_add_f32 v77, v80, v81
    v_add_f32 v85, v88, v89
    v_sub_f32 v78, v80, v81
    v_sub_f32 v86, v88, v89
    v_fma_f32 v79, v83, 2.0, v82
    v_fma_f32 v87, v91, 2.0, v90
    v_fma_f32 v82, v83, -2.0, v82
    v_fma_f32 v90, v91, -2.0, v90
    v_fmamk_f32 v80, v76, 0x41700000, v82
    v_fmamk_f32 v88, v84, 0x41700000, v90
    v_fmamk_f32 v80, v81, 0x41200000, v80
    v_fmamk_f32 v88, v89, 0x41200000, v88
    v_cvt_pk_bf16_f32 v5, v77, v85
    v_cvt_pk_bf16_f32 v9, v78, v86
    v_cvt_pk_bf16_f32 v65, v79, v87
    v_cvt_pk_bf16_f32 v69, v82, v90
    v_cvt_pk_bf16_f32 v73, v80, v88
    v_lshlrev_b32 v76, 16, v2
    v_and_b32 v84, s25, v2
    v_lshlrev_b32 v77, 16, v6
    v_and_b32 v85, s25, v6
    v_lshlrev_b32 v78, 16, v10
    v_and_b32 v86, s25, v10
    v_lshlrev_b32 v79, 16, v14
    v_and_b32 v87, s25, v14
    v_add_f32 v80, v76, v78
    v_add_f32 v88, v84, v86
    v_add_f32 v81, v77, v79
    v_add_f32 v89, v85, v87
    v_fma_f32 v82, v78, 4.0, v76
    v_fma_f32 v90, v86, 4.0, v84
    v_fma_f32 v83, v79, 4.0, v77
    v_fma_f32 v91, v87, 4.0, v85
    v_add_f32 v77, v80, v81
    v_add_f32 v85, v88, v89
    v_sub_f32 v78, v80, v81
    v_sub_f32 v86, v88, v89
    v_fma_f32 v79, v83, 2.0, v82
    v_fma_f32 v87, v91, 2.0, v90
    v_fma_f32 v82, v83, -2.0, v82
    v_fma_f32 v90, v91, -2.0, v90
    v_fmamk_f32 v80, v76, 0x41700000, v82
    v_fmamk_f32 v88, v84, 0x41700000, v90
    buffer_load_dwordx4 v[36:39], v93, s[8:11], s24 offen
    buffer_load_dwordx4 v[44:47], v95, s[8:11], s24 offen
    v_fmamk_f32 v80, v81, 0x41200000, v80
    v_fmamk_f32 v88, v89, 0x41200000, v88
    v_cvt_pk_bf16_f32 v6, v77, v85
    v_cvt_pk_bf16_f32 v10, v78, v86
    v_cvt_pk_bf16_f32 v66, v79, v87
    v_cvt_pk_bf16_f32 v70, v82, v90
    v_cvt_pk_bf16_f32 v74, v80, v88
    v_lshlrev_b32 v76, 16, v3
    v_and_b32 v84, s25, v3
    v_lshlrev_b32 v77, 16, v7
    v_and_b32 v85, s25, v7
    v_lshlrev_b32 v78, 16, v11
    v_and_b32 v86, s25, v11
    v_lshlrev_b32 v79, 16, v15
    v_and_b32 v87, s25, v15
    v_add_f32 v80, v76, v78
    v_add_f32 v88, v84, v86
    v_add_f32 v81, v77, v79
    v_add_f32 v89, v85, v87
    v_fma_f32 v82, v78, 4.0, v76
    v_fma_f32 v90, v86, 4.0, v84
    v_fma_f32 v83, v79, 4.0, v77
    v_fma_f32 v91, v87, 4.0, v85
    v_add_f32 v77, v80, v81
    v_add_f32 v85, v88, v89
    v_sub_f32 v78, v80, v81
    v_sub_f32 v86, v88, v89
    v_fma_f32 v79, v83, 2.0, v82
    v_fma_f32 v87, v91, 2.0, v90
    v_fma_f32 v82, v83, -2.0, v82
    v_fma_f32 v90, v91, -2.0, v90
    v_fmamk_f32 v80, v76, 0x41700000, v82
    v_fmamk_f32 v88, v84, 0x41700000, v90
    v_fmamk_f32 v80, v81, 0x41200000, v80
    v_fmamk_f32 v88, v89, 0x41200000, v88
    v_cvt_pk_bf16_f32 v7, v77, v85
    v_cvt_pk_bf16_f32 v11, v78, v86
    v_cvt_pk_bf16_f32 v67, v79, v87
    v_cvt_pk_bf16_f32 v71, v82, v90
    v_cvt_pk_bf16_f32 v75, v80, v88
    ds_write_b128 v96, v[64:67] offset:49152
    ds_write_b128 v97, v[68:71] offset:0
    ds_write_b128 v97, v[72:75] offset:16384
    ds_write_b128 v96, v[0:3] offset:0
    ds_write_b128 v96, v[4:7] offset:16384
    ds_write_b128 v96, v[8:11] offset:32768
    ds_write_b128 v98, v[12:15] offset:0
    s_add_u32 s28, s28, 1
    s_waitcnt lgkmcnt(0)
    s_barrier
    s_sub_u32 s22, s22, 1
    s_branch L_conv2_kernel_hloop1
L_conv2_kernel_hlast1:
    s_branch L_conv2_kernel_end
L_conv2_kernel_h2:
    ds_write_b128 v96, v[0:3] offset:0
    ds_write_b128 v98, v[12:15] offset:0
    v_lshlrev_b32 v76, 16, v0
    v_and_b32 v84, s25, v0
    v_lshlrev_b32 v77, 16, v4
    v_and_b32 v85, s25, v4
    v_lshlrev_b32 v78, 16, v8
    v_and_b32 v86, s25, v8
    v_lshlrev_b32 v79, 16, v12
    v_and_b32 v87, s25, v12
    v_add_f32 v80, v76, v78
    v_add_f32 v88, v84, v86
    v_add_f32 v81, v77, v79
    v_add_f32 v89, v85, v87
    v_fma_f32 v82, v78, 4.0, v76
    v_fma_f32 v90, v86, 4.0, v84
    v_fma_f32 v83, v79, 4.0, v77
    v_fma_f32 v91, v87, 4.0, v85
    v_add_f32 v77, v80, v81
    v_add_f32 v85, v88, v89
    v_sub_f32 v78, v80, v81
    v_sub_f32 v86, v88, v89
    v_fma_f32 v79, v83, 2.0, v82
    v_fma_f32 v87, v91, 2.0, v90
    v_fma_f32 v82, v83, -2.0, v82
    v_fma_f32 v90, v91, -2.0, v90
    v_fmamk_f32 v80, v76, 0x41700000, v82
    v_fmamk_f32 v88, v84, 0x41700000, v90
    v_fmamk_f32 v80, v81, 0x41200000, v80
    v_fmamk_f32 v88, v89, 0x41200000, v88
    v_cvt_pk_bf16_f32 v4, v77, v85
    v_cvt_pk_bf16_f32 v8, v78, v86
    v_cvt_pk_bf16_f32 v64, v79, v87
    v_cvt_pk_bf16_f32 v68, v82, v90
    v_cvt_pk_bf16_f32 v72, v80, v88
    v_lshlrev_b32 v76, 16, v1
    v_and_b32 v84, s25, v1
    v_lshlrev_b32 v77, 16, v5
    v_and_b32 v85, s25, v5
    v_lshlrev_b32 v78, 16, v9
    v_and_b32 v86, s25, v9
    v_lshlrev_b32 v79, 16, v13
    v_and_b32 v87, s25, v13
    v_add_f32 v80, v76, v78
    v_add_f32 v88, v84, v86
    v_add_f32 v81, v77, v79
    v_add_f32 v89, v85, v87
    v_fma_f32 v82, v78, 4.0, v76
    v_fma_f32 v90, v86, 4.0, v84
    v_fma_f32 v83, v79, 4.0, v77
    v_fma_f32 v91, v87, 4.0, v85
    v_add_f32 v77, v80, v81
    v_add_f32 v85, v88, v89
    v_sub_f32 v78, v80, v81
    v_sub_f32 v86, v88, v89
    v_fma_f32 v79, v83, 2.0, v82
    v_fma_f32 v87, v91, 2.0, v90
    v_fma_f32 v82, v83, -2.0, v82
    v_fma_f32 v90, v91, -2.0, v90
    v_fmamk_f32 v80, v76, 0x41700000, v82
    v_fmamk_f32 v88, v84, 0x41700000, v90
    v_fmamk_f32 v80, v81, 0x41200000, v80
    v_fmamk_f32 v88, v89, 0x41200000, v88
    v_cvt_pk_bf16_f32 v5, v77, v85
    v_cvt_pk_bf16_f32 v9, v78, v86
    v_cvt_pk_bf16_f32 v65, v79, v87
    v_cvt_pk_bf16_f32 v69, v82, v90
    v_cvt_pk_bf16_f32 v73, v80, v88
    v_lshlrev_b32 v76, 16, v2
    v_and_b32 v84, s25, v2
    v_lshlrev_b32 v77, 16, v6
    v_and_b32 v85, s25, v6
    v_lshlrev_b32 v78, 16, v10
    v_and_b32 v86, s25, v10
    v_lshlrev_b32 v79, 16, v14
    v_and_b32 v87, s25, v14
    v_add_f32 v80, v76, v78
    v_add_f32 v88, v84, v86
    v_add_f32 v81, v77, v79
    v_add_f32 v89, v85, v87
    v_fma_f32 v82, v78, 4.0, v76
    v_fma_f32 v90, v86, 4.0, v84
    v_fma_f32 v83, v79, 4.0, v77
    v_fma_f32 v91, v87, 4.0, v85
    v_add_f32 v77, v80, v81
    v_add_f32 v85, v88, v89
    v_sub_f32 v78, v80, v81
    v_sub_f32 v86, v88, v89
    v_fma_f32 v79, v83, 2.0, v82
    v_fma_f32 v87, v91, 2.0, v90
    v_fma_f32 v82, v83, -2.0, v82
    v_fma_f32 v90, v91, -2.0, v90
    v_fmamk_f32 v80, v76, 0x41700000, v82
    v_fmamk_f32 v88, v84, 0x41700000, v90
    v_fmamk_f32 v80, v81, 0x41200000, v80
    v_fmamk_f32 v88, v89, 0x41200000, v88
    v_cvt_pk_bf16_f32 v6, v77, v85
    v_cvt_pk_bf16_f32 v10, v78, v86
    v_cvt_pk_bf16_f32 v66, v79, v87
    v_cvt_pk_bf16_f32 v70, v82, v90
    v_cvt_pk_bf16_f32 v74, v80, v88
    v_lshlrev_b32 v76, 16, v3
    v_and_b32 v84, s25, v3
    v_lshlrev_b32 v77, 16, v7
    v_and_b32 v85, s25, v7
    v_lshlrev_b32 v78, 16, v11
    v_and_b32 v86, s25, v11
    v_lshlrev_b32 v79, 16, v15
    v_and_b32 v87, s25, v15
    v_add_f32 v80, v76, v78
    v_add_f32 v88, v84, v86
    v_add_f32 v81, v77, v79
    v_add_f32 v89, v85, v87
    v_fma_f32 v82, v78, 4.0, v76
    v_fma_f32 v90, v86, 4.0, v84
    v_fma_f32 v83, v79, 4.0, v77
    v_fma_f32 v91, v87, 4.0, v85
    v_add_f32 v77, v80, v81
    v_add_f32 v85, v88, v89
    v_sub_f32 v78, v80, v81
    v_sub_f32 v86, v88, v89
    v_fma_f32 v79, v83, 2.0, v82
    v_fma_f32 v87, v91, 2.0, v90
    v_fma_f32 v82, v83, -2.0, v82
    v_fma_f32 v90, v91, -2.0, v90
    v_fmamk_f32 v80, v76, 0x41700000, v82
    v_fmamk_f32 v88, v84, 0x41700000, v90
    v_fmamk_f32 v80, v81, 0x41200000, v80
    v_fmamk_f32 v88, v89, 0x41200000, v88
    v_cvt_pk_bf16_f32 v7, v77, v85
    v_cvt_pk_bf16_f32 v11, v78, v86
    v_cvt_pk_bf16_f32 v67, v79, v87
    v_cvt_pk_bf16_f32 v71, v82, v90
    v_cvt_pk_bf16_f32 v75, v80, v88
    ds_write_b128 v96, v[64:67] offset:49152
    ds_write_b128 v97, v[68:71] offset:0
    ds_write_b128 v97, v[72:75] offset:16384
    ds_write_b128 v96, v[4:7] offset:16384
    ds_write_b128 v96, v[8:11] offset:32768
    s_waitcnt vmcnt(0)
    s_mov_b32 s24, 1048576
    s_mov_b32 s27, 1572864
    buffer_load_dwordx4 v[32:35], v92, s[8:11], s24 offen
    buffer_load_dwordx4 v[40:43], v94, s[8:11], s24 offen
    buffer_load_dwordx4 v[36:39], v93, s[8:11], s24 offen
    buffer_load_dwordx4 v[44:47], v95, s[8:11], s24 offen
    buffer_load_dwordx4 v[48:51], v92, s[8:11], s27 offen
    buffer_load_dwordx4 v[56:59], v94, s[8:11], s27 offen
    buffer_load_dwordx4 v[52:55], v93, s[8:11], s27 offen
    buffer_load_dwordx4 v[60:63], v95, s[8:11], s27 offen
    s_waitcnt lgkmcnt(0)
    s_barrier
    s_setprio 0
    v_lshlrev_b32 v76, 16, v16
    v_and_b32 v84, s25, v16
    v_lshlrev_b32 v77, 16, v20
    v_and_b32 v85, s25, v20
    v_lshlrev_b32 v78, 16, v24
    v_and_b32 v86, s25, v24
    v_lshlrev_b32 v79, 16, v28
    v_and_b32 v87, s25, v28
    v_add_f32 v80, v76, v78
    v_add_f32 v88, v84, v86
    v_add_f32 v81, v77, v79
    v_add_f32 v89, v85, v87
    v_fma_f32 v82, v78, 4.0, v76
    v_fma_f32 v90, v86, 4.0, v84
    v_fma_f32 v83, v79, 4.0, v77
    v_fma_f32 v91, v87, 4.0, v85
    v_add_f32 v77, v80, v81
    v_add_f32 v85, v88, v89
    v_sub_f32 v78, v80, v81
    v_sub_f32 v86, v88, v89
    v_fma_f32 v79, v83, 2.0, v82
    v_fma_f32 v87, v91, 2.0, v90
    v_fma_f32 v82, v83, -2.0, v82
    v_fma_f32 v90, v91, -2.0, v90
    v_fmamk_f32 v80, v76, 0x41700000, v82
    v_fmamk_f32 v88, v84, 0x41700000, v90
    v_fmamk_f32 v80, v81, 0x41200000, v80
    v_fmamk_f32 v88, v89, 0x41200000, v88
    v_cvt_pk_bf16_f32 v20, v77, v85
    v_cvt_pk_bf16_f32 v24, v78, v86
    v_cvt_pk_bf16_f32 v64, v79, v87
    v_cvt_pk_bf16_f32 v68, v82, v90
    v_cvt_pk_bf16_f32 v72, v80, v88
    v_lshlrev_b32 v76, 16, v17
    v_and_b32 v84, s25, v17
    v_lshlrev_b32 v77, 16, v21
    v_and_b32 v85, s25, v21
    v_lshlrev_b32 v78, 16, v25
    v_and_b32 v86, s25, v25
    v_lshlrev_b32 v79, 16, v29
    v_and_b32 v87, s25, v29
    v_add_f32 v80, v76, v78
    v_add_f32 v88, v84, v86
    v_add_f32 v81, v77, v79
    v_add_f32 v89, v85, v87
    v_fma_f32 v82, v78, 4.0, v76
    v_fma_f32 v90, v86, 4.0, v84
    v_fma_f32 v83, v79, 4.0, v77
    v_fma_f32 v91, v87, 4.0, v85
    v_add_f32 v77, v80, v81
    v_add_f32 v85, v88, v89
    v_sub_f32 v78, v80, v81
    v_sub_f32 v86, v88, v89
    v_fma_f32 v79, v83, 2.0, v82
    v_fma_f32 v87, v91, 2.0, v90
    v_fma_f32 v82, v83, -2.0, v82
    v_fma_f32 v90, v91, -2.0, v90
    v_fmamk_f32 v80, v76, 0x41700000, v82
    v_fmamk_f32 v88, v84, 0x41700000, v90
    v_fmamk_f32 v80, v81, 0x41200000, v80
    v_fmamk_f32 v88, v89, 0x41200000, v88
    v_cvt_pk_bf16_f32 v21, v77, v85
    v_cvt_pk_bf16_f32 v25, v78, v86
    v_cvt_pk_bf16_f32 v65, v79, v87
    v_cvt_pk_bf16_f32 v69, v82, v90
    v_cvt_pk_bf16_f32 v73, v80, v88
    v_lshlrev_b32 v76, 16, v18
    v_and_b32 v84, s25, v18
    v_lshlrev_b32 v77, 16, v22
    v_and_b32 v85, s25, v22
    v_lshlrev_b32 v78, 16, v26
    v_and_b32 v86, s25, v26
    v_lshlrev_b32 v79, 16, v30
    v_and_b32 v87, s25, v30
    v_add_f32 v80, v76, v78
    v_add_f32 v88, v84, v86
    v_add_f32 v81, v77, v79
    v_add_f32 v89, v85, v87
    v_fma_f32 v82, v78, 4.0, v76
    v_fma_f32 v90, v86, 4.0, v84
    v_fma_f32 v83, v79, 4.0, v77
    v_fma_f32 v91, v87, 4.0, v85
    v_add_f32 v77, v80, v81
    v_add_f32 v85, v88, v89
    v_sub_f32 v78, v80, v81
    v_sub_f32 v86, v88, v89
    v_fma_f32 v79, v83, 2.0, v82
    v_fma_f32 v87, v91, 2.0, v90
    v_fma_f32 v82, v83, -2.0, v82
    v_fma_f32 v90, v91, -2.0, v90
    v_fmamk_f32 v80, v76, 0x41700000, v82
    v_fmamk_f32 v88, v84, 0x41700000, v90
    v_fmamk_f32 v80, v81, 0x41200000, v80
    v_fmamk_f32 v88, v89, 0x41200000, v88
    v_cvt_pk_bf16_f32 v22, v77, v85
    v_cvt_pk_bf16_f32 v26, v78, v86
    v_cvt_pk_bf16_f32 v66, v79, v87
    v_cvt_pk_bf16_f32 v70, v82, v90
    v_cvt_pk_bf16_f32 v74, v80, v88
    v_lshlrev_b32 v76, 16, v19
    v_and_b32 v84, s25, v19
    v_lshlrev_b32 v77, 16, v23
    v_and_b32 v85, s25, v23
    v_lshlrev_b32 v78, 16, v27
    v_and_b32 v86, s25, v27
    v_lshlrev_b32 v79, 16, v31
    v_and_b32 v87, s25, v31
    v_add_f32 v80, v76, v78
    v_add_f32 v88, v84, v86
    v_add_f32 v81, v77, v79
    v_add_f32 v89, v85, v87
    v_fma_f32 v82, v78, 4.0, v76
    v_fma_f32 v90, v86, 4.0, v84
    v_fma_f32 v83, v79, 4.0, v77
    v_fma_f32 v91, v87, 4.0, v85
    v_add_f32 v77, v80, v81
    v_add_f32 v85, v88, v89
    v_sub_f32 v78, v80, v81
    v_sub_f32 v86, v88, v89
    v_fma_f32 v79, v83, 2.0, v82
    v_fma_f32 v87, v91, 2.0, v90
    v_fma_f32 v82, v83, -2.0, v82
    v_fma_f32 v90, v91, -2.0, v90
    v_fmamk_f32 v80, v76, 0x41700000, v82
    v_fmamk_f32 v88, v84, 0x41700000, v90
    v_fmamk_f32 v80, v81, 0x41200000, v80
    v_fmamk_f32 v88, v89, 0x41200000, v88
    v_cvt_pk_bf16_f32 v23, v77, v85
    v_cvt_pk_bf16_f32 v27, v78, v86
    v_cvt_pk_bf16_f32 v67, v79, v87
    v_cvt_pk_bf16_f32 v71, v82, v90
    v_cvt_pk_bf16_f32 v75, v80, v88
L_conv2_kernel_hloop2:
    s_add_u32 s24, s24, 1048576
    s_add_u32 s27, s27, 1048576
    ds_write_b128 v96, v[64:67] offset:57344
    ds_write_b128 v97, v[68:71] offset:8192
    ds_write_b128 v97, v[72:75] offset:24576
    ds_write_b128 v96, v[16:19] offset:8192
    ds_write_b128 v96, v[20:23] offset:24576
    ds_write_b128 v96, v[24:27] offset:40960
    ds_write_b128 v98, v[28:31] offset:8704
    s_waitcnt vmcnt(0)
    v_lshlrev_b32 v76, 16, v32
    v_and_b32 v84, s25, v32
    v_lshlrev_b32 v77, 16, v36
    v_and_b32 v85, s25, v36
    v_lshlrev_b32 v78, 16, v40
    v_and_b32 v86, s25, v40
    v_lshlrev_b32 v79, 16, v44
    v_and_b32 v87, s25, v44
    v_add_f32 v80, v76, v78
    v_add_f32 v88, v84, v86
    v_add_f32 v81, v77, v79
    v_add_f32 v89, v85, v87
    v_fma_f32 v82, v78, 4.0, v76
    v_fma_f32 v90, v86, 4.0, v84
    v_fma_f32 v83, v79, 4.0, v77
    v_fma_f32 v91, v87, 4.0, v85
    v_add_f32 v77, v80, v81
    v_add_f32 v85, v88, v89
    v_sub_f32 v78, v80, v81
    v_sub_f32 v86, v88, v89
    v_fma_f32 v79, v83, 2.0, v82
    v_fma_f32 v87, v91, 2.0, v90
    v_fma_f32 v82, v83, -2.0, v82
    v_fma_f32 v90, v91, -2.0, v90
    v_fmamk_f32 v80, v76, 0x41700000, v82
    v_fmamk_f32 v88, v84, 0x41700000, v90
    buffer_load_dwordx4 v[0:3], v92, s[8:11], s24 offen
    buffer_load_dwordx4 v[8:11], v94, s[8:11], s24 offen
    v_fmamk_f32 v80, v81, 0x41200000, v80
    v_fmamk_f32 v88, v89, 0x41200000, v88
    v_cvt_pk_bf16_f32 v36, v77, v85
    v_cvt_pk_bf16_f32 v40, v78, v86
    v_cvt_pk_bf16_f32 v64, v79, v87
    v_cvt_pk_bf16_f32 v68, v82, v90
    v_cvt_pk_bf16_f32 v72, v80, v88
    v_lshlrev_b32 v76, 16, v33
    v_and_b32 v84, s25, v33
    v_lshlrev_b32 v77, 16, v37
    v_and_b32 v85, s25, v37
    v_lshlrev_b32 v78, 16, v41
    v_and_b32 v86, s25, v41
    v_lshlrev_b32 v79, 16, v45
    v_and_b32 v87, s25, v45
    v_add_f32 v80, v76, v78
    v_add_f32 v88, v84, v86
    v_add_f32 v81, v77, v79
    v_add_f32 v89, v85, v87
    v_fma_f32 v82, v78, 4.0, v76
    v_fma_f32 v90, v86, 4.0, v84
    v_fma_f32 v83, v79, 4.0, v77
    v_fma_f32 v91, v87, 4.0, v85
    v_add_f32 v77, v80, v81
    v_add_f32 v85, v88, v89
    v_sub_f32 v78, v80, v81
    v_sub_f32 v86, v88, v89
    v_fma_f32 v79, v83, 2.0, v82
    v_fma_f32 v87, v91, 2.0, v90
    v_fma_f32 v82, v83, -2.0, v82
    v_fma_f32 v90, v91, -2.0, v90
    v_fmamk_f32 v80, v76, 0x41700000, v82
    v_fmamk_f32 v88, v84, 0x41700000, v90
    v_fmamk_f32 v80, v81, 0x41200000, v80
    v_fmamk_f32 v88, v89, 0x41200000, v88
    v_cvt_pk_bf16_f32 v37, v77, v85
    v_cvt_pk_bf16_f32 v41, v78, v86
    v_cvt_pk_bf16_f32 v65, v79, v87
    v_cvt_pk_bf16_f32 v69, v82, v90
    v_cvt_pk_bf16_f32 v73, v80, v88
    v_lshlrev_b32 v76, 16, v34
    v_and_b32 v84, s25, v34
    v_lshlrev_b32 v77, 16, v38
    v_and_b32 v85, s25, v38
    v_lshlrev_b32 v78, 16, v42
    v_and_b32 v86, s25, v42
    v_lshlrev_b32 v79, 16, v46
    v_and_b32 v87, s25, v46
    v_add_f32 v80, v76, v78
    v_add_f32 v88, v84, v86
    v_add_f32 v81, v77, v79
    v_add_f32 v89, v85, v87
    v_fma_f32 v82, v78, 4.0, v76
    buffer_load_dwordx4 v[4:7], v93, s[8:11], s24 offen
    buffer_load_dwordx4 v[12:15], v95, s[8:11], s24 offen
    v_fma_f32 v90, v86, 4.0, v84
    v_fma_f32 v83, v79, 4.0, v77
    v_fma_f32 v91, v87, 4.0, v85
    v_add_f32 v77, v80, v81
    v_add_f32 v85, v88, v89
    v_sub_f32 v78, v80, v81
    v_sub_f32 v86, v88, v89
    v_fma_f32 v79, v83, 2.0, v82
    v_fma_f32 v87, v91, 2.0, v90
    v_fma_f32 v82, v83, -2.0, v82
    v_fma_f32 v90, v91, -2.0, v90
    v_fmamk_f32 v80, v76, 0x41700000, v82
    v_fmamk_f32 v88, v84, 0x41700000, v90
    v_fmamk_f32 v80, v81, 0x41200000, v80
    v_fmamk_f32 v88, v89, 0x41200000, v88
    v_cvt_pk_bf16_f32 v38, v77, v85
    v_cvt_pk_bf16_f32 v42, v78, v86
    v_cvt_pk_bf16_f32 v66, v79, v87
    v_cvt_pk_bf16_f32 v70, v82, v90
    v_cvt_pk_bf16_f32 v74, v80, v88
    v_lshlrev_b32 v76, 16, v35
    v_and_b32 v84, s25, v35
    v_lshlrev_b32 v77, 16, v39
    v_and_b32 v85, s25, v39
    v_lshlrev_b32 v78, 16, v43
    v_and_b32 v86, s25, v43
    v_lshlrev_b32 v79, 16, v47
    v_and_b32 v87, s25, v47
    v_add_f32 v80, v76, v78
    v_add_f32 v88, v84, v86
    v_add_f32 v81, v77, v79
    v_add_f32 v89, v85, v87
    v_fma_f32 v82, v78, 4.0, v76
    v_fma_f32 v90, v86, 4.0, v84
    v_fma_f32 v83, v79, 4.0, v77
    v_fma_f32 v91, v87, 4.0, v85
    v_add_f32 v77, v80, v81
    v_add_f32 v85, v88, v89
    v_sub_f32 v78, v80, v81
    v_sub_f32 v86, v88, v89
    v_fma_f32 v79, v83, 2.0, v82
    v_fma_f32 v87, v91, 2.0, v90
    v_fma_f32 v82, v83, -2.0, v82
    v_fma_f32 v90, v91, -2.0, v90
    v_fmamk_f32 v80, v76, 0x41700000, v82
    v_fmamk_f32 v88, v84, 0x41700000, v90
    v_fmamk_f32 v80, v81, 0x41200000, v80
    v_fmamk_f32 v88, v89, 0x41200000, v88
    v_cvt_pk_bf16_f32 v39, v77, v85
    v_cvt_pk_bf16_f32 v43, v78, v86
    v_cvt_pk_bf16_f32 v67, v79, v87
    v_cvt_pk_bf16_f32 v71, v82, v90
    v_cvt_pk_bf16_f32 v75, v80, v88
    s_add_u32 s28, s28, 1
    s_waitcnt lgkmcnt(0)
    s_barrier
    ds_write_b128 v96, v[64:67] offset:49152
    ds_write_b128 v97, v[68:71] offset:0
    ds_write_b128 v97, v[72:75] offset:16384
    ds_write_b128 v96, v[32:35] offset:0
    ds_write_b128 v96, v[36:39] offset:16384
    ds_write_b128 v96, v[40:43] offset:32768
    ds_write_b128 v98, v[44:47] offset:0
    v_lshlrev_b32 v76, 16, v48
    v_and_b32 v84, s25, v48
    buffer_load_dwordx4 v[16:19], v92, s[8:11], s27 offen
    buffer_load_dwordx4 v[24:27], v94, s[8:11], s27 offen
    v_lshlrev_b32 v77, 16, v52
    v_and_b32 v85, s25, v52
    v_lshlrev_b32 v78, 16, v56
    v_and_b32 v86, s25, v56
    v_lshlrev_b32 v79, 16, v60
    v_and_b32 v87, s25, v60
    v_add_f32 v80, v76, v78
    v_add_f32 v88, v84, v86
    v_add_f32 v81, v77, v79
    v_add_f32 v89, v85, v87
    v_fma_f32 v82, v78, 4.0, v76
    v_fma_f32 v90, v86, 4.0, v84
    v_fma_f32 v83, v79, 4.0, v77
    v_fma_f32 v91, v87, 4.0, v85
    v_add_f32 v77, v80, v81
    v_add_f32 v85, v88, v89
    v_sub_f32 v78, v80, v81
    buffer_load_dwordx4 v[20:23], v93, s[8:11], s27 offen
    buffer_load_dwordx4 v[28:31], v95, s[8:11], s27 offen
    v_sub_f32 v86, v88, v89
    v_fma_f32 v79, v83, 2.0, v82
    v_fma_f32 v87, v91, 2.0, v90
    v_fma_f32 v82, v83, -2.0, v82
    v_fma_f32 v90, v91, -2.0, v90
    v_fmamk_f32 v80, v76, 0x41700000, v82
    v_fmamk_f32 v88, v84, 0x41700000, v90
    v_fmamk_f32 v80, v81, 0x41200000, v80
    v_fmamk_f32 v88, v89, 0x41200000, v88
    v_cvt_pk_bf16_f32 v52, v77, v85
    v_cvt_pk_bf16_f32 v56, v78, v86
    v_cvt_pk_bf16_f32 v64, v79, v87
    v_cvt_pk_bf16_f32 v68, v82, v90
    v_cvt_pk_bf16_f32 v72, v80, v88
    v_lshlrev_b32 v76, 16, v49
    v_and_b32 v84, s25, v49
    v_lshlrev_b32 v77, 16, v53
    v_and_b32 v85, s25, v53
    v_lshlrev_b32 v78, 16, v57
    v_and_b32 v86, s25, v57
    v_lshlrev_b32 v79, 16, v61
    v_and_b32 v87, s25, v61
    v_add_f32 v80, v76, v78
    v_add_f32 v88, v84, v86
    v_add_f32 v81, v77, v79
    v_add_f32 v89, v85, v87
    v_fma_f32 v82, v78, 4.0, v76
    v_fma_f32 v90, v86, 4.0, v84
    v_fma_f32 v83, v79, 4.0, v77
    v_fma_f32 v91, v87, 4.0, v85
    v_add_f32 v77, v80, v81
    v_add_f32 v85, v88, v89
    v_sub_f32 v78, v80, v81
    v_sub_f32 v86, v88, v89
    v_fma_f32 v79, v83, 2.0, v82
    v_fma_f32 v87, v91, 2.0, v90
    v_fma_f32 v82, v83, -2.0, v82
    v_fma_f32 v90, v91, -2.0, v90
    v_fmamk_f32 v80, v76, 0x41700000, v82
    v_fmamk_f32 v88, v84, 0x41700000, v90
    v_fmamk_f32 v80, v81, 0x41200000, v80
    v_fmamk_f32 v88, v89, 0x41200000, v88
    v_cvt_pk_bf16_f32 v53, v77, v85
    v_cvt_pk_bf16_f32 v57, v78, v86
    v_cvt_pk_bf16_f32 v65, v79, v87
    v_cvt_pk_bf16_f32 v69, v82, v90
    v_cvt_pk_bf16_f32 v73, v80, v88
    v_lshlrev_b32 v76, 16, v50
    v_and_b32 v84, s25, v50
    v_lshlrev_b32 v77, 16, v54
    v_and_b32 v85, s25, v54
    v_lshlrev_b32 v78, 16, v58
    v_and_b32 v86, s25, v58
    v_lshlrev_b32 v79, 16, v62
    v_and_b32 v87, s25, v62
    v_add_f32 v80, v76, v78
    v_add_f32 v88, v84, v86
    v_add_f32 v81, v77, v79
    v_add_f32 v89, v85, v87
    v_fma_f32 v82, v78, 4.0, v76
    v_fma_f32 v90, v86, 4.0, v84
    v_fma_f32 v83, v79, 4.0, v77
    v_fma_f32 v91, v87, 4.0, v85
    v_add_f32 v77, v80, v81
    v_add_f32 v85, v88, v89
    v_sub_f32 v78, v80, v81
    v_sub_f32 v86, v88, v89
    v_fma_f32 v79, v83, 2.0, v82
    v_fma_f32 v87, v91, 2.0, v90
    v_fma_f32 v82, v83, -2.0, v82
    v_fma_f32 v90, v91, -2.0, v90
    v_fmamk_f32 v80, v76, 0x41700000, v82
    v_fmamk_f32 v88, v84, 0x41700000, v90
    v_fmamk_f32 v80, v81, 0x41200000, v80
    v_fmamk_f32 v88, v89, 0x41200000, v88
    v_cvt_pk_bf16_f32 v54, v77, v85
    v_cvt_pk_bf16_f32 v58, v78, v86
    v_cvt_pk_bf16_f32 v66, v79, v87
    v_cvt_pk_bf16_f32 v70, v82, v90
    v_cvt_pk_bf16_f32 v74, v80, v88
    v_lshlrev_b32 v76, 16, v51
    v_and_b32 v84, s25, v51
    v_lshlrev_b32 v77, 16, v55
    v_and_b32 v85, s25, v55
    v_lshlrev_b32 v78, 16, v59
    v_and_b32 v86, s25, v59
    v_lshlrev_b32 v79, 16, v63
    v_and_b32 v87, s25, v63
    v_add_f32 v80, v76, v78
    v_add_f32 v88, v84, v86
    v_add_f32 v81, v77, v79
    v_add_f32 v89, v85, v87
    v_fma_f32 v82, v78, 4.0, v76
    v_fma_f32 v90, v86, 4.0, v84
    v_fma_f32 v83, v79, 4.0, v77
    v_fma_f32 v91, v87, 4.0, v85
    v_add_f32 v77, v80, v81
    v_add_f32 v85, v88, v89
    v_sub_f32 v78, v80, v81
    v_sub_f32 v86, v88, v89
    v_fma_f32 v79, v83, 2.0, v82
    v_fma_f32 v87, v91, 2.0, v90
    v_fma_f32 v82, v83, -2.0, v82
    v_fma_f32 v90, v91, -2.0, v90
    v_fmamk_f32 v80, v76, 0x41700000, v82
    v_fmamk_f32 v88, v84, 0x41700000, v90
    v_fmamk_f32 v80, v81, 0x41200000, v80
    v_fmamk_f32 v88, v89, 0x41200000, v88
    v_cvt_pk_bf16_f32 v55, v77, v85
    v_cvt_pk_bf16_f32 v59, v78, v86
    v_cvt_pk_bf16_f32 v67, v79, v87
    v_cvt_pk_bf16_f32 v71, v82, v90
    v_cvt_pk_bf16_f32 v75, v80, v88
    s_add_u32 s28, s28, 1
    s_waitcnt lgkmcnt(0)
    s_barrier
    s_cmp_eq_u32 s22, 1
    s_cbranch_scc1 L_conv2_kernel_hlast2
    s_add_u32 s24, s24, 1048576
    s_add_u32 s27, s27, 1048576
    ds_write_b128 v96, v[64:67] offset:57344
    ds_write_b128 v97, v[68:71] offset:8192
    ds_write_b128 v97, v[72:75] offset:24576
    ds_write_b128 v96, v[48:51] offset:8192
    ds_write_b128 v96, v[52:55] offset:24576
    ds_write_b128 v96, v[56:59] offset:40960
    ds_write_b128 v98, v[60:63] offset:8704
    s_waitcnt vmcnt(0)
    v_lshlrev_b32 v76, 16, v0
    v_and_b32 v84, s25, v0
    v_lshlrev_b32 v77, 16, v4
    v_and_b32 v85, s25, v4
    v_lshlrev_b32 v78, 16, v8
    v_and_b32 v86, s25, v8
    v_lshlrev_b32 v79, 16, v12
    v_and_b32 v87, s25, v12
    v_add_f32 v80, v76, v78
    v_add_f32 v88, v84, v86
    v_add_f32 v81, v77, v79
    v_add_f32 v89, v85, v87
    v_fma_f32 v82, v78, 4.0, v76
    v_fma_f32 v90, v86, 4.0, v84
    v_fma_f32 v83, v79, 4.0, v77
    v_fma_f32 v91, v87, 4.0, v85
    v_add_f32 v77, v80, v81
    v_add_f32 v85, v88, v89
    v_sub_f32 v78, v80, v81
    v_sub_f32 v86, v88, v89
    v_fma_f32 v79, v83, 2.0, v82
    v_fma_f32 v87, v91, 2.0, v90
    v_fma_f32 v82, v83, -2.0, v82
    v_fma_f32 v90, v91, -2.0, v90
    v_fmamk_f32 v80, v76, 0x41700000, v82
    v_fmamk_f32 v88, v84, 0x41700000, v90
    buffer_load_dwordx4 v[32:35], v92, s[8:11], s24 offen
    buffer_load_dwordx4 v[40:43], v94, s[8:11], s24 offen
    v_fmamk_f32 v80, v81, 0x41200000, v80
    v_fmamk_f32 v88, v89, 0x41200000, v88
    v_cvt_pk_bf16_f32 v4, v77, v85
    v_cvt_pk_bf16_f32 v8, v78, v86
    v_cvt_pk_bf16_f32 v64, v79, v87
    v_cvt_pk_bf16_f32 v68, v82, v90
    v_cvt_pk_bf16_f32 v72, v80, v88
    v_lshlrev_b32 v76, 16, v1
    v_and_b32 v84, s25, v1
    v_lshlrev_b32 v77, 16, v5
    v_and_b32 v85, s25, v5
    v_lshlrev_b32 v78, 16, v9
    v_and_b32 v86, s25, v9
    v_lshlrev_b32 v79, 16, v13
    v_and_b32 v87, s25, v13
    v_add_f32 v80, v76, v78
    v_add_f32 v88, v84, v86
    v_add_f32 v81, v77, v79
    v_add_f32 v89, v85, v87
    v_fma_f32 v82, v78, 4.0, v76
    v_fma_f32 v90, v86, 4.0, v84
    v_fma_f32 v83, v79, 4.0, v77
    v_fma_f32 v91, v87, 4.0, v85
    v_add_f32 v77, v80, v81
    v_add_f32 v85, v88, v89
    v_sub_f32 v78, v80, v81
    v_sub_f32 v86, v88, v89
    v_fma_f32 v79, v83, 2.0, v82
    v_fma_f32 v87, v91, 2.0, v90
    v_fma_f32 v82, v83, -2.0, v82
    v_fma_f32 v90, v91, -2.0, v90
    v_fmamk_f32 v80, v76, 0x41700000, v82
    v_fmamk_f32 v88, v84, 0x41700000, v90
    v_fmamk_f32 v80, v81, 0x41200000, v80
    v_fmamk_f32 v88, v89, 0x41200000, v88
    v_cvt_pk_bf16_f32 v5, v77, v85
    v_cvt_pk_bf16_f32 v9, v78, v86
    v_cvt_pk_bf16_f32 v65, v79, v87
    v_cvt_pk_bf16_f32 v69, v82, v90
    v_cvt_pk_bf16_f32 v73, v80, v88
    v_lshlrev_b32 v76, 16, v2
    v_and_b32 v84, s25, v2
    v_lshlrev_b32 v77, 16, v6
    v_and_b32 v85, s25, v6
    v_lshlrev_b32 v78, 16, v10
    v_and_b32 v86, s25, v10
    v_lshlrev_b32 v79, 16, v14
    v_and_b32 v87, s25, v14
    v_add_f32 v80, v76, v78
    v_add_f32 v88, v84, v86
    v_add_f32 v81, v77, v79
    v_add_f32 v89, v85, v87
    v_fma_f32 v82, v78, 4.0, v76
    buffer_load_dwordx4 v[36:39], v93, s[8:11], s24 offen
    buffer_load_dwordx4 v[44:47], v95, s[8:11], s24 offen
    v_fma_f32 v90, v86, 4.0, v84
    v_fma_f32 v83, v79, 4.0, v77
    v_fma_f32 v91, v87, 4.0, v85
    v_add_f32 v77, v80, v81
    v_add_f32 v85, v88, v89
    v_sub_f32 v78, v80, v81
    v_sub_f32 v86, v88, v89
    v_fma_f32 v79, v83, 2.0, v82
    v_fma_f32 v87, v91, 2.0, v90
    v_fma_f32 v82, v83, -2.0, v82
    v_fma_f32 v90, v91, -2.0, v90
    v_fmamk_f32 v80, v76, 0x41700000, v82
    v_fmamk_f32 v88, v84, 0x41700000, v90
    v_fmamk_f32 v80, v81, 0x41200000, v80
    v_fmamk_f32 v88, v89, 0x41200000, v88
    v_cvt_pk_bf16_f32 v6, v77, v85
    v_cvt_pk_bf16_f32 v10, v78, v86
    v_cvt_pk_bf16_f32 v66, v79, v87
    v_cvt_pk_bf16_f32 v70, v82, v90
    v_cvt_pk_bf16_f32 v74, v80, v88
    v_lshlrev_b32 v76, 16, v3
    v_and_b32 v84, s25, v3
    v_lshlrev_b32 v77, 16, v7
    v_and_b32 v85, s25, v7
    v_lshlrev_b32 v78, 16, v11
    v_and_b32 v86, s25, v11
    v_lshlrev_b32 v79, 16, v15
    v_and_b32 v87, s25, v15
    v_add_f32 v80, v76, v78
    v_add_f32 v88, v84, v86
    v_add_f32 v81, v77, v79
    v_add_f32 v89, v85, v87
    v_fma_f32 v82, v78, 4.0, v76
    v_fma_f32 v90, v86, 4.0, v84
    v_fma_f32 v83, v79, 4.0, v77
    v_fma_f32 v91, v87, 4.0, v85
    v_add_f32 v77, v80, v81
    v_add_f32 v85, v88, v89
    v_sub_f32 v78, v80, v81
    v_sub_f32 v86, v88, v89
    v_fma_f32 v79, v83, 2.0, v82
    v_fma_f32 v87, v91, 2.0, v90
    v_fma_f32 v82, v83, -2.0, v82
    v_fma_f32 v90, v91, -2.0, v90
    v_fmamk_f32 v80, v76, 0x41700000, v82
    v_fmamk_f32 v88, v84, 0x41700000, v90
    v_fmamk_f32 v80, v81, 0x41200000, v80
    v_fmamk_f32 v88, v89, 0x41200000, v88
    v_cvt_pk_bf16_f32 v7, v77, v85
    v_cvt_pk_bf16_f32 v11, v78, v86
    v_cvt_pk_bf16_f32 v67, v79, v87
    v_cvt_pk_bf16_f32 v71, v82, v90
    v_cvt_pk_bf16_f32 v75, v80, v88
    s_add_u32 s28, s28, 1
    s_waitcnt lgkmcnt(0)
    s_barrier
    ds_write_b128 v96, v[64:67] offset:49152
    ds_write_b128 v97, v[68:71] offset:0
    ds_write_b128 v97, v[72:75] offset:16384
    ds_write_b128 v96, v[0:3] offset:0
    ds_write_b128 v96, v[4:7] offset:16384
    ds_write_b128 v96, v[8:11] offset:32768
    ds_write_b128 v98, v[12:15] offset:0
    v_lshlrev_b32 v76, 16, v16
    v_and_b32 v84, s25, v16
    buffer_load_dwordx4 v[48:51], v92, s[8:11], s27 offen
    buffer_load_dwordx4 v[56:59], v94, s[8:11], s27 offen
    v_lshlrev_b32 v77, 16, v20
    v_and_b32 v85, s25, v20
    v_lshlrev_b32 v78, 16, v24
    v_and_b32 v86, s25, v24
    v_lshlrev_b32 v79, 16, v28
    v_and_b32 v87, s25, v28
    v_add_f32 v80, v76, v78
    v_add_f32 v88, v84, v86
    v_add_f32 v81, v77, v79
    v_add_f32 v89, v85, v87
    v_fma_f32 v82, v78, 4.0, v76
    v_fma_f32 v90, v86, 4.0, v84
    v_fma_f32 v83, v79, 4.0, v77
    v_fma_f32 v91, v87, 4.0, v85
    v_add_f32 v77, v80, v81
    v_add_f32 v85, v88, v89
    v_sub_f32 v78, v80, v81
    buffer_load_dwordx4 v[52:55], v93, s[8:11], s27 offen
    buffer_load_dwordx4 v[60:63], v95, s[8:11], s27 offen
    v_sub_f32 v86, v88, v89
    v_fma_f32 v79, v83, 2.0, v82
    v_fma_f32 v87, v91, 2.0, v90
    v_fma_f32 v82, v83, -2.0, v82
    v_fma_f32 v90, v91, -2.0, v90
    v_fmamk_f32 v80, v76, 0x41700000, v82
    v_fmamk_f32 v88, v84, 0x41700000, v90
    v_fmamk_f32 v80, v81, 0x41200000, v80
    v_fmamk_f32 v88, v89, 0x41200000, v88
    v_cvt_pk_bf16_f32 v20, v77, v85
    v_cvt_pk_bf16_f32 v24, v78, v86
    v_cvt_pk_bf16_f32 v64, v79, v87
    v_cvt_pk_bf16_f32 v68, v82, v90
    v_cvt_pk_bf16_f32 v72, v80, v88
    v_lshlrev_b32 v76, 16, v17
    v_and_b32 v84, s25, v17
    v_lshlrev_b32 v77, 16, v21
    v_and_b32 v85, s25, v21
    v_lshlrev_b32 v78, 16, v25
    v_and_b32 v86, s25, v25
    v_lshlrev_b32 v79, 16, v29
    v_and_b32 v87, s25, v29
    v_add_f32 v80, v76, v78
    v_add_f32 v88, v84, v86
    v_add_f32 v81, v77, v79
    v_add_f32 v89, v85, v87
    v_fma_f32 v82, v78, 4.0, v76
    v_fma_f32 v90, v86, 4.0, v84
    v_fma_f32 v83, v79, 4.0, v77
    v_fma_f32 v91, v87, 4.0, v85
    v_add_f32 v77, v80, v81
    v_add_f32 v85, v88, v89
    v_sub_f32 v78, v80, v81
    v_sub_f32 v86, v88, v89
    v_fma_f32 v79, v83, 2.0, v82
    v_fma_f32 v87, v91, 2.0, v90
    v_fma_f32 v82, v83, -2.0, v82
    v_fma_f32 v90, v91, -2.0, v90
    v_fmamk_f32 v80, v76, 0x41700000, v82
    v_fmamk_f32 v88, v84, 0x41700000, v90
    v_fmamk_f32 v80, v81, 0x41200000, v80
    v_fmamk_f32 v88, v89, 0x41200000, v88
    v_cvt_pk_bf16_f32 v21, v77, v85
    v_cvt_pk_bf16_f32 v25, v78, v86
    v_cvt_pk_bf16_f32 v65, v79, v87
    v_cvt_pk_bf16_f32 v69, v82, v90
    v_cvt_pk_bf16_f32 v73, v80, v88
    v_lshlrev_b32 v76, 16, v18
    v_and_b32 v84, s25, v18
    v_lshlrev_b32 v77, 16, v22
    v_and_b32 v85, s25, v22
    v_lshlrev_b32 v78, 16, v26
    v_and_b32 v86, s25, v26
    v_lshlrev_b32 v79, 16, v30
    v_and_b32 v87, s25, v30
    v_add_f32 v80, v76, v78
    v_add_f32 v88, v84, v86
    v_add_f32 v81, v77, v79
    v_add_f32 v89, v85, v87
    v_fma_f32 v82, v78, 4.0, v76
    v_fma_f32 v90, v86, 4.0, v84
    v_fma_f32 v83, v79, 4.0, v77
    v_fma_f32 v91, v87, 4.0, v85
    v_add_f32 v77, v80, v81
    v_add_f32 v85, v88, v89
    v_sub_f32 v78, v80, v81
    v_sub_f32 v86, v88, v89
    v_fma_f32 v79, v83, 2.0, v82
    v_fma_f32 v87, v91, 2.0, v90
    v_fma_f32 v82, v83, -2.0, v82
    v_fma_f32 v90, v91, -2.0, v90
    v_fmamk_f32 v80, v76, 0x41700000, v82
    v_fmamk_f32 v88, v84, 0x41700000, v90
    v_fmamk_f32 v80, v81, 0x41200000, v80
    v_fmamk_f32 v88, v89, 0x41200000, v88
    v_cvt_pk_bf16_f32 v22, v77, v85
    v_cvt_pk_bf16_f32 v26, v78, v86
    v_cvt_pk_bf16_f32 v66, v79, v87
    v_cvt_pk_bf16_f32 v70, v82, v90
    v_cvt_pk_bf16_f32 v74, v80, v88
    v_lshlrev_b32 v76, 16, v19
    v_and_b32 v84, s25, v19
    v_lshlrev_b32 v77, 16, v23
    v_and_b32 v85, s25, v23
    v_lshlrev_b32 v78, 16, v27
    v_and_b32 v86, s25, v27
    v_lshlrev_b32 v79, 16, v31
    v_and_b32 v87, s25, v31
    v_add_f32 v80, v76, v78
    v_add_f32 v88, v84, v86
    v_add_f32 v81, v77, v79
    v_add_f32 v89, v85, v87
    v_fma_f32 v82, v78, 4.0, v76
    v_fma_f32 v90, v86, 4.0, v84
    v_fma_f32 v83, v79, 4.0, v77
    v_fma_f32 v91, v87, 4.0, v85
    v_add_f32 v77, v80, v81
    v_add_f32 v85, v88, v89
    v_sub_f32 v78, v80, v81
    v_sub_f32 v86, v88, v89
    v_fma_f32 v79, v83, 2.0, v82
    v_fma_f32 v87, v91, 2.0, v90
    v_fma_f32 v82, v83, -2.0, v82
    v_fma_f32 v90, v91, -2.0, v90
    v_fmamk_f32 v80, v76, 0x41700000, v82
    v_fmamk_f32 v88, v84, 0x41700000, v90
    v_fmamk_f32 v80, v81, 0x41200000, v80
    v_fmamk_f32 v88, v89, 0x41200000, v88
    v_cvt_pk_bf16_f32 v23, v77, v85
    v_cvt_pk_bf16_f32 v27, v78, v86
    v_cvt_pk_bf16_f32 v67, v79, v87
    v_cvt_pk_bf16_f32 v71, v82, v90
    v_cvt_pk_bf16_f32 v75, v80, v88
    s_add_u32 s28, s28, 1
    s_waitcnt lgkmcnt(0)
    s_barrier
    s_sub_u32 s22, s22, 1
    s_branch L_conv2_kernel_hloop2
L_conv2_kernel_hlast2:
    s_mov_b32 s25, 0xffff0000
    ds_write_b128 v96, v[64:67] offset:57344
    ds_write_b128 v97, v[68:71] offset:8192
    ds_write_b128 v97, v[72:75] offset:24576
    ds_write_b128 v96, v[48:51] offset:8192
    ds_write_b128 v96, v[52:55] offset:24576
    ds_write_b128 v96, v[56:59] offset:40960
    ds_write_b128 v98, v[60:63] offset:8704
    s_waitcnt lgkmcnt(0)
    s_barrier
    s_branch L_conv2_kernel_end
L_conv2_kernel_epi:
    s_waitcnt lgkmcnt(0)
    s_barrier
    v_cndmask_b32 v122, v111, v110, vcc
    ds_read_b128 v[0:3], v120 offset:0
    ds_read_b128 v[4:7], v120 offset:16384
    ds_read_b128 v[8:11], v120 offset:32768
    ds_read_b128 v[12:15], v120 offset:49152
    ds_read_b128 v[16:19], v121 offset:0
    ds_read_b128 v[20:23], v121 offset:16384
    ds_read_b128 v[24:27], v121 offset:32768
    ds_read_b128 v[28:31], v64 offset:15360
    ds_read_b128 v[32:35], v120 offset:8192
    ds_read_b128 v[36:39], v120 offset:24576
    ds_read_b128 v[40:43], v120 offset:40960
    ds_read_b128 v[44:47], v120 offset:57344
    ds_read_b128 v[48:51], v121 offset:56320
    ds_read_b128 v[52:55], v121 offset:64512
    ds_read_b128 v[56:59], v64 offset:7168
    s_waitcnt lgkmcnt(7)
    ds_read_b128 v[60:63], v64 offset:23552
    s_waitcnt lgkmcnt(8)
    v_pk_add_f32 v[88:89], v[24:25], v[28:29]
    v_pk_add_f32 v[90:91], v[26:27], v[30:31]
    v_pk_add_f32 v[24:25], v[4:5], v[8:9]
    v_pk_add_f32 v[26:27], v[6:7], v[10:11]
    v_pk_add_f32 v[4:5], v[4:5], v[8:9] neg_lo:[0,1] neg_hi:[0,1]
    v_pk_add_f32 v[6:7], v[6:7], v[10:11] neg_lo:[0,1] neg_hi:[0,1]
    v_pk_add_f32 v[72:73], v[12:13], v[16:17]
    v_pk_add_f32 v[74:75], v[14:15], v[18:19]
    v_pk_add_f32 v[12:13], v[12:13], v[16:17] neg_lo:[0,1] neg_hi:[0,1]
    v_pk_add_f32 v[14:15], v[14:15], v[18:19] neg_lo:[0,1] neg_hi:[0,1]
    v_pk_fma_f32 v[72:73], v[24:25], s[4:5], v[72:73]
    v_pk_fma_f32 v[74:75], v[26:27], s[4:5], v[74:75]
    v_pk_fma_f32 v[20:21], v[0:1], s[10:11], v[20:21]
    v_pk_fma_f32 v[22:23], v[2:3], s[10:11], v[22:23]
    v_pk_fma_f32 v[72:73], v[0:1], s[6:7], v[72:73]
    v_pk_fma_f32 v[74:75], v[2:3], s[6:7], v[74:75]
    v_pk_add_f32 v[24:25], v[24:25], v[0:1] neg_lo:[0,1] neg_hi:[0,1]
    v_pk_add_f32 v[26:27], v[26:27], v[2:3] neg_lo:[0,1] neg_hi:[0,1]
    v_pk_fma_f32 v[72:73], v[88:89], s[8:9], v[72:73]
    v_pk_fma_f32 v[74:75], v[90:91], s[8:9], v[74:75]
    v_pk_add_f32 v[24:25], v[24:25], v[88:89] neg_lo:[0,1] neg_hi:[0,1]
    v_pk_add_f32 v[26:27], v[26:27], v[90:91] neg_lo:[0,1] neg_hi:[0,1]
    v_pk_fma_f32 v[20:21], v[88:89], s[22:23], v[20:21]
    v_pk_fma_f32 v[22:23], v[90:91], s[22:23], v[22:23]
    v_pk_add_f32 v[8:9], v[24:25], v[72:73] neg_lo:[0,1] neg_hi:[0,1]
    v_pk_add_f32 v[10:11], v[26:27], v[74:75] neg_lo:[0,1] neg_hi:[0,1]
    v_pk_fma_f32 v[20:21], v[72:73], s[14:15], v[20:21]
    v_pk_fma_f32 v[22:23], v[74:75], s[14:15], v[22:23]
    v_pk_mul_f32 v[80:81], v[12:13], s[32:33]
    v_pk_mul_f32 v[82:83], v[14:15], s[32:33]
    v_pk_fma_f32 v[20:21], v[8:9], s[12:13], v[20:21]
    v_pk_fma_f32 v[22:23], v[10:11], s[12:13], v[22:23]
    v_pk_fma_f32 v[80:81], v[4:5], s[34:35], v[80:81]
    v_pk_fma_f32 v[82:83], v[6:7], s[34:35], v[82:83]
    v_pk_fma_f32 v[64:65], v[4:5], s[24:25], v[20:21] neg_lo:[0,0,1] neg_hi:[0,0,1]
    v_pk_fma_f32 v[66:67], v[6:7], s[24:25], v[22:23] neg_lo:[0,0,1] neg_hi:[0,0,1]
    v_pk_fma_f32 v[64:65], v[12:13], s[26:27], v[64:65]
    v_pk_fma_f32 v[66:67], v[14:15], s[26:27], v[66:67]
    v_pk_fma_f32 v[80:81], v[64:65], s[38:39], v[80:81]
    v_pk_fma_f32 v[82:83], v[66:67], s[38:39], v[82:83]
    v_pk_add_f32 v[4:5], v[4:5], v[64:65] neg_lo:[0,1] neg_hi:[0,1]
    v_pk_add_f32 v[6:7], v[6:7], v[66:67] neg_lo:[0,1] neg_hi:[0,1]
    v_pk_add_f32 v[4:5], v[4:5], v[80:81] neg_lo:[0,1] neg_hi:[0,1]
    v_pk_add_f32 v[6:7], v[6:7], v[82:83] neg_lo:[0,1] neg_hi:[0,1]
    s_waitcnt lgkmcnt(0)
    v_pk_add_f32 v[92:93], v[56:57], v[60:61]
    v_pk_add_f32 v[94:95], v[58:59], v[62:63]
    v_pk_add_f32 v[56:57], v[36:37], v[40:41]
    v_pk_add_f32 v[58:59], v[38:39], v[42:43]
    v_pk_add_f32 v[36:37], v[36:37], v[40:41] neg_lo:[0,1] neg_hi:[0,1]
    v_pk_add_f32 v[38:39], v[38:39], v[42:43] neg_lo:[0,1] neg_hi:[0,1]
    v_pk_add_f32 v[76:77], v[44:45], v[48:49]
    v_pk_add_f32 v[78:79], v[46:47], v[50:51]
    v_pk_add_f32 v[44:45], v[44:45], v[48:49] neg_lo:[0,1] neg_hi:[0,1]
    v_pk_add_f32 v[46:47], v[46:47], v[50:51] neg_lo:[0,1] neg_hi:[0,1]
    v_pk_fma_f32 v[76:77], v[56:57], s[4:5], v[76:77]
    v_pk_fma_f32 v[78:79], v[58:59], s[4:5], v[78:79]
    v_pk_fma_f32 v[52:53], v[32:33], s[10:11], v[52:53]
    v_pk_fma_f32 v[54:55], v[34:35], s[10:11], v[54:55]
    v_pk_fma_f32 v[76:77], v[32:33], s[6:7], v[76:77]
    v_pk_fma_f32 v[78:79], v[34:35], s[6:7], v[78:79]
    v_pk_add_f32 v[56:57], v[56:57], v[32:33] neg_lo:[0,1] neg_hi:[0,1]
    v_pk_add_f32 v[58:59], v[58:59], v[34:35] neg_lo:[0,1] neg_hi:[0,1]
    v_pk_fma_f32 v[76:77], v[92:93], s[8:9], v[76:77]
    v_pk_fma_f32 v[78:79], v[94:95], s[8:9], v[78:79]
    v_pk_add_f32 v[56:57], v[56:57], v[92:93] neg_lo:[0,1] neg_hi:[0,1]
    v_pk_add_f32 v[58:59], v[58:59], v[94:95] neg_lo:[0,1] neg_hi:[0,1]
    v_pk_fma_f32 v[52:53], v[92:93], s[22:23], v[52:53]
    v_pk_fma_f32 v[54:55], v[94:95], s[22:23], v[54:55]
    v_pk_add_f32 v[40:41], v[56:57], v[76:77] neg_lo:[0,1] neg_hi:[0,1]
    v_pk_add_f32 v[42:43], v[58:59], v[78:79] neg_lo:[0,1] neg_hi:[0,1]
    v_pk_fma_f32 v[52:53], v[76:77], s[14:15], v[52:53]
    v_pk_fma_f32 v[54:55], v[78:79], s[14:15], v[54:55]
    v_pk_mul_f32 v[84:85], v[44:45], s[32:33]
    v_pk_mul_f32 v[86:87], v[46:47], s[32:33]
    v_pk_fma_f32 v[52:53], v[40:41], s[12:13], v[52:53]
    v_pk_fma_f32 v[54:55], v[42:43], s[12:13], v[54:55]
    v_pk_fma_f32 v[84:85], v[36:37], s[34:35], v[84:85]
    v_pk_fma_f32 v[86:87], v[38:39], s[34:35], v[86:87]
    v_pk_fma_f32 v[68:69], v[36:37], s[24:25], v[52:53] neg_lo:[0,0,1] neg_hi:[0,0,1]
    v_pk_fma_f32 v[70:71], v[38:39], s[24:25], v[54:55] neg_lo:[0,0,1] neg_hi:[0,0,1]
    v_pk_fma_f32 v[68:69], v[44:45], s[26:27], v[68:69]
    v_pk_fma_f32 v[70:71], v[46:47], s[26:27], v[70:71]
    v_pk_fma_f32 v[84:85], v[68:69], s[38:39], v[84:85]
    v_pk_fma_f32 v[86:87], v[70:71], s[38:39], v[86:87]
    v_pk_add_f32 v[36:37], v[36:37], v[68:69] neg_lo:[0,1] neg_hi:[0,1]
    v_pk_add_f32 v[38:39], v[38:39], v[70:71] neg_lo:[0,1] neg_hi:[0,1]
    v_pk_add_f32 v[36:37], v[36:37], v[84:85] neg_lo:[0,1] neg_hi:[0,1]
    v_pk_add_f32 v[38:39], v[38:39], v[86:87] neg_lo:[0,1] neg_hi:[0,1]
    s_mov_b32 s36, 0x00010001
    s_mov_b32 s37, 0x00010001
    s_mov_b64 exec, s[36:37]
    ds_write_b128 v127, v[0:3] offset:0
    ds_write_b128 v127, v[32:35] offset:16
    ds_write_b128 v127, v[4:7] offset:32
    ds_write_b128 v127, v[36:39] offset:48
    ds_write_b128 v127, v[8:11] offset:64
    ds_write_b128 v127, v[40:43] offset:80
    s_mov_b64 exec, -1
    v_mov_b32 v44, 0xc0135761
    v_mov_b32 v45, v44
    v_cvt_pk_bf16_f32 v48, v64, v68
    v_cvt_pk_bf16_f32 v49, v65, v69
    v_cvt_pk_bf16_f32 v50, v66, v70
    v_cvt_pk_bf16_f32 v51, v67, v71
    s_mov_b32 s44, 0
    buffer_store_dwordx4 v[48:51], v122, s[16:19], s44 offen sc1
    s_waitcnt lgkmcnt(0)
    s_barrier
    ds_read_b128 v[96:99], v127 offset:512
    ds_read_b128 v[100:103], v127 offset:528
    ds_read_b128 v[104:107], v127 offset:544
    ds_read_b128 v[108:111], v127 offset:560
    ds_read_b128 v[112:115], v127 offset:576
    ds_read_b128 v[116:119], v127 offset:592
    s_waitcnt lgkmcnt(4)
    v_mov_b32_dpp v96, v0 row_shl:1 row_mask:0xf bank_mask:0xf
    v_mov_b32_dpp v97, v1 row_shl:1 row_mask:0xf bank_mask:0xf
    v_mov_b32_dpp v98, v2 row_shl:1 row_mask:0xf bank_mask:0xf
    v_mov_b32_dpp v99, v3 row_shl:1 row_mask:0xf bank_mask:0xf
    v_mov_b32_dpp v100, v32 row_shl:1 row_mask:0xf bank_mask:0xf
    v_mov_b32_dpp v101, v33 row_shl:1 row_mask:0xf bank_mask:0xf
    v_mov_b32_dpp v102, v34 row_shl:1 row_mask:0xf bank_mask:0xf
    v_mov_b32_dpp v103, v35 row_shl:1 row_mask:0xf bank_mask:0xf
    v_pk_add_f32 v[72:73], v[72:73], v[96:97]
    v_pk_add_f32 v[74:75], v[74:75], v[98:99]
    v_pk_add_f32 v[76:77], v[76:77], v[100:101]
    v_pk_add_f32 v[78:79], v[78:79], v[102:103]
    v_cvt_pk_bf16_f32 v52, v72, v76
    v_cvt_pk_bf16_f32 v53, v73, v77
    v_cvt_pk_bf16_f32 v54, v74, v78
    v_cvt_pk_bf16_f32 v55, v75, v79
    s_mov_b32 s44, 65536
    buffer_store_dwordx4 v[52:55], v122, s[16:19], s44 offen sc1
    s_waitcnt lgkmcnt(2)
    v_mov_b32_dpp v104, v4 row_shl:1 row_mask:0xf bank_mask:0xf
    v_mov_b32_dpp v105, v5 row_shl:1 row_mask:0xf bank_mask:0xf
    v_mov_b32_dpp v106, v6 row_shl:1 row_mask:0xf bank_mask:0xf
    v_mov_b32_dpp v107, v7 row_shl:1 row_mask:0xf bank_mask:0xf
    v_mov_b32_dpp v108, v36 row_shl:1 row_mask:0xf bank_mask:0xf
    v_mov_b32_dpp v109, v37 row_shl:1 row_mask:0xf bank_mask:0xf
    v_mov_b32_dpp v110, v38 row_shl:1 row_mask:0xf bank_mask:0xf
    v_mov_b32_dpp v111, v39 row_shl:1 row_mask:0xf bank_mask:0xf
    v_pk_add_f32 v[80:81], v[80:81], v[104:105]
    v_pk_add_f32 v[82:83], v[82:83], v[106:107]
    v_pk_add_f32 v[84:85], v[84:85], v[108:109]
    v_pk_add_f32 v[86:87], v[86:87], v[110:111]
    v_cvt_pk_bf16_f32 v56, v80, v84
    v_cvt_pk_bf16_f32 v57, v81, v85
    v_cvt_pk_bf16_f32 v58, v82, v86
    v_cvt_pk_bf16_f32 v59, v83, v87
    s_mov_b32 s44, 131072
    buffer_store_dwordx4 v[56:59], v122, s[16:19], s44 offen sc1
    s_waitcnt lgkmcnt(0)
    v_mov_b32_dpp v112, v8 row_shl:1 row_mask:0xf bank_mask:0xf
    v_mov_b32_dpp v113, v9 row_shl:1 row_mask:0xf bank_mask:0xf
    v_mov_b32_dpp v114, v10 row_shl:1 row_mask:0xf bank_mask:0xf
    v_mov_b32_dpp v115, v11 row_shl:1 row_mask:0xf bank_mask:0xf
    v_mov_b32_dpp v116, v40 row_shl:1 row_mask:0xf bank_mask:0xf
    v_mov_b32_dpp v117, v41 row_shl:1 row_mask:0xf bank_mask:0xf
    v_mov_b32_dpp v118, v42 row_shl:1 row_mask:0xf bank_mask:0xf
    v_mov_b32_dpp v119, v43 row_shl:1 row_mask:0xf bank_mask:0xf
    v_pk_add_f32 v[88:89], v[88:89], v[112:113]
    v_pk_add_f32 v[90:91], v[90:91], v[114:115]
    v_pk_add_f32 v[92:93], v[92:93], v[116:117]
    v_pk_add_f32 v[94:95], v[94:95], v[118:119]
    v_cvt_pk_bf16_f32 v60, v88, v92
    v_cvt_pk_bf16_f32 v61, v89, v93
    v_cvt_pk_bf16_f32 v62, v90, v94
    v_cvt_pk_bf16_f32 v63, v91, v95
    s_mov_b32 s44, 196608
    buffer_store_dwordx4 v[60:63], v122, s[16:19], s44 offen sc1
L_conv2_kernel_end:
L_conv2_kernel_done:
    s_endpgm
.globl joint_kernel
.p2align 8
.type joint_kernel,@function
joint_kernel:
    s_cmp_ge_u32 s2, 250
    s_cbranch_scc1 L_joint_kernel_done
    s_load_dwordx2 s[28:29], s[0:1], 56
    s_load_dwordx2 s[30:31], s[0:1], 72
    v_readfirstlane_b32 s20, v0
    s_lshr_b32 s20, s20, 6
    s_and_b32 s21, s20, 7
    v_and_b32 v127, 63, v0
    v_lshlrev_b32 v126, 4, v127
    s_cmp_ge_u32 s20, 8
    s_mov_b32 s33, 44171264
    s_cselect_b32 s33, 44040192, s33
    s_lshl_b32 s36, s21, 14
    s_add_u32 s33, s33, s36
    s_mov_b32 s14, 16384
    s_mov_b32 s15, 0x00020000
    s_lshl_b32 s35, s2, 9
    s_cmp_ge_u32 s2, 125
    s_cselect_b32 s36, 2033152, 0
    s_cselect_b32 s34, 8192, 0
    s_add_u32 s35, s35, s36
    s_add_u32 s34, s34, 44302336
    s_mov_b32 s10, 12582912
    s_mov_b32 s11, 0x00020000
    s_mov_b32 s42, 24576
    s_mov_b32 s43, 0x00020000
    s_waitcnt lgkmcnt(0)
    s_add_u32 s12, s30, s33
    s_addc_u32 s13, s31, 0
    s_add_u32 s40, s30, s34
    s_addc_u32 s41, s31, 0
    s_cmp_ge_u32 s20, 8
    s_cbranch_scc1 L_joint_kernel_T
    s_add_u32 s8, s30, 27262976
    s_addc_u32 s9, s31, 0
    v_mov_b32 v0, 99456
    v_mov_b32 v2, 0
    v_mov_b32 v3, 0
    ds_write_b64 v0, v[2:3]
    v_lshrrev_b32 v124, 5, v127
    v_and_b32 v123, 0x1ff, v126
    v_mul_u32_u24 v125, 65536, v124
    v_add_u32 v123, v125, v123
    s_mul_i32 s36, s21, 262144
    s_add_u32 s36, s36, s35
    s_add_u32 s37, s36, 8388608
    buffer_load_dwordx4 v[64:67], v123, s[8:11], s36 offen
    buffer_load_dwordx4 v[72:75], v123, s[8:11], s37 offen
    s_add_u32 s36, s36, 131072
    s_add_u32 s37, s36, 8388608
    buffer_load_dwordx4 v[68:71], v123, s[8:11], s36 offen
    buffer_load_dwordx4 v[76:79], v123, s[8:11], s37 offen
    s_lshl_b32 s38, s21, 10
    s_add_u32 s38, s38, 16384
    buffer_load_dwordx4 v[80:83], v126, s[40:43], s38 offen
    s_waitcnt lgkmcnt(0)
    s_barrier
    s_lshl_b32 s35, s2, 17
    s_add_u32 s16, s28, s35
    s_addc_u32 s17, s29, 0
    s_mov_b32 s18, 131072
    s_mov_b32 s19, 0x00020000
    s_mov_b32 s46, 0xbdd2d3e8
    s_mov_b32 s47, s46
    v_mov_b32 v120, 0xc0135761
    v_mov_b32 v121, v120
    s_mov_b32 s48, 1.0
    s_mov_b32 s49, 1.0
    v_bfe_u32 v123, v127, 2, 3
    v_lshl_add_u32 v124, v123, 2, v124
    v_mul_u32_u24 v124, 528, v124
    v_and_b32 v123, 0x30, v126
    s_lshl_b32 s36, s21, 6
    v_add3_u32 v124, v124, v123, s36
    s_mov_b32 s45, 0xffff0000
    s_mul_i32 s36, s21, 1040
    s_add_u32 s36, s36, 91136
    v_add_u32 v123, s36, v126
    s_mov_b32 s22, 2
    s_waitcnt vmcnt(3)
L_joint_kernel_floop:
    v_lshlrev_b32 v88, 16, v64
    v_and_b32 v89, s45, v64
    v_lshlrev_b32 v96, 16, v72
    v_and_b32 v97, s45, v72
    v_lshlrev_b32 v90, 16, v65
    v_and_b32 v91, s45, v65
    v_lshlrev_b32 v98, 16, v73
    v_and_b32 v99, s45, v73
    v_lshlrev_b32 v92, 16, v66
    v_and_b32 v93, s45, v66
    v_lshlrev_b32 v100, 16, v74
    v_and_b32 v101, s45, v74
    v_lshlrev_b32 v94, 16, v67
    v_and_b32 v95, s45, v67
    v_lshlrev_b32 v102, 16, v75
    v_and_b32 v103, s45, v75
    v_pk_add_f32 v[88:89], v[88:89], v[96:97]
    v_pk_add_f32 v[90:91], v[90:91], v[98:99]
    v_pk_add_f32 v[92:93], v[92:93], v[100:101]
    v_pk_add_f32 v[94:95], v[94:95], v[102:103]
    v_pk_mul_f32 v[96:97], v[88:89], v[88:89]
    v_pk_mul_f32 v[98:99], v[90:91], v[90:91]
    v_pk_mul_f32 v[100:101], v[92:93], v[92:93]
    v_pk_mul_f32 v[102:103], v[94:95], v[94:95]
    v_pk_fma_f32 v[96:97], v[96:97], s[46:47], v[120:121]
    v_pk_fma_f32 v[98:99], v[98:99], s[46:47], v[120:121]
    v_pk_fma_f32 v[100:101], v[100:101], s[46:47], v[120:121]
    v_pk_fma_f32 v[102:103], v[102:103], s[46:47], v[120:121]
    v_pk_mul_f32 v[96:97], v[96:97], v[88:89]
    v_pk_mul_f32 v[98:99], v[98:99], v[90:91]
    v_pk_mul_f32 v[100:101], v[100:101], v[92:93]
    v_pk_mul_f32 v[102:103], v[102:103], v[94:95]
    v_exp_f32 v96, v96
    v_exp_f32 v97, v97
    v_exp_f32 v98, v98
    v_exp_f32 v99, v99
    v_exp_f32 v100, v100
    v_exp_f32 v101, v101
    v_exp_f32 v102, v102
    v_exp_f32 v103, v103
    v_pk_add_f32 v[96:97], v[96:97], s[48:49]
    v_pk_add_f32 v[98:99], v[98:99], s[48:49]
    v_pk_add_f32 v[100:101], v[100:101], s[48:49]
    v_pk_add_f32 v[102:103], v[102:103], s[48:49]
    v_rcp_f32 v96, v96
    v_rcp_f32 v97, v97
    v_rcp_f32 v98, v98
    v_rcp_f32 v99, v99
    v_rcp_f32 v100, v100
    v_rcp_f32 v101, v101
    v_rcp_f32 v102, v102
    v_rcp_f32 v103, v103
    v_pk_mul_f32 v[88:89], v[88:89], v[96:97]
    v_pk_mul_f32 v[90:91], v[90:91], v[98:99]
    v_pk_mul_f32 v[92:93], v[92:93], v[100:101]
    v_pk_mul_f32 v[94:95], v[94:95], v[102:103]
    v_cvt_pk_bf16_f32 v104, v88, v89
    v_cvt_pk_bf16_f32 v105, v90, v91
    v_cvt_pk_bf16_f32 v106, v92, v93
    v_cvt_pk_bf16_f32 v107, v94, v95
    ds_write_b128 v124, v[104:107] offset:32768
    s_waitcnt vmcnt(0)
    v_pk_mov_b32 v[64:65], v[68:69], v[68:69] op_sel:[0,1]
    v_pk_mov_b32 v[72:73], v[76:77], v[76:77] op_sel:[0,1]
    v_pk_mov_b32 v[66:67], v[70:71], v[70:71] op_sel:[0,1]
    v_pk_mov_b32 v[74:75], v[78:79], v[78:79] op_sel:[0,1]
    v_add_u32 v124, 1056, v124
    s_sub_u32 s22, s22, 1
    s_cmp_lg_u32 s22, 0
    s_cbranch_scc1 L_joint_kernel_floop
    ds_write_b128 v123, v[80:83]
    s_waitcnt lgkmcnt(0)
    v_mov_b32 v120, 99456
    v_mov_b32 v121, 1
    s_mov_b64 exec, 1
    ds_add_u32 v120, v121 offset:0
    s_mov_b64 exec, -1
L_joint_kernel_ow:
    ds_read_b32 v121, v120 offset:4
    s_waitcnt lgkmcnt(0)
    v_readfirstlane_b32 s37, v121
    s_cmp_ge_u32 s37, 8
    s_cbranch_scc1 L_joint_kernel_ow_d
    s_sleep 1
    s_branch L_joint_kernel_ow
L_joint_kernel_ow_d:
    s_mov_b32 s36, 0
    buffer_load_dwordx4 v[0:3], v126, s[12:15], s36 offen offset:0
    buffer_load_dwordx4 v[4:7], v126, s[12:15], s36 offen offset:1024
    buffer_load_dwordx4 v[8:11], v126, s[12:15], s36 offen offset:2048
    buffer_load_dwordx4 v[12:15], v126, s[12:15], s36 offen offset:3072
    s_mov_b32 s36, 4096
    buffer_load_dwordx4 v[16:19], v126, s[12:15], s36 offen offset:0
    buffer_load_dwordx4 v[20:23], v126, s[12:15], s36 offen offset:1024
    buffer_load_dwordx4 v[24:27], v126, s[12:15], s36 offen offset:2048
    buffer_load_dwordx4 v[28:31], v126, s[12:15], s36 offen offset:3072
    s_mov_b32 s36, 8192
    buffer_load_dwordx4 v[32:35], v126, s[12:15], s36 offen offset:0
    buffer_load_dwordx4 v[36:39], v126, s[12:15], s36 offen offset:1024
    buffer_load_dwordx4 v[40:43], v126, s[12:15], s36 offen offset:2048
    buffer_load_dwordx4 v[44:47], v126, s[12:15], s36 offen offset:3072
    s_mov_b32 s36, 12288
    buffer_load_dwordx4 v[48:51], v126, s[12:15], s36 offen offset:0
    buffer_load_dwordx4 v[52:55], v126, s[12:15], s36 offen offset:1024
    buffer_load_dwordx4 v[56:59], v126, s[12:15], s36 offen offset:2048
    buffer_load_dwordx4 v[60:63], v126, s[12:15], s36 offen offset:3072
    v_lshrrev_b32 v125, 4, v127
    v_lshlrev_b32 v125, 11, v125
    v_and_b32 v124, 15, v127
    v_lshl_add_u32 v125, v124, 2, v125
    s_lshl_b32 s36, s21, 6
    v_add_u32 v125, s36, v125
    s_mov_b32 s44, 8192
    s_setprio 1
    s_barrier
    ds_read_b128 v[96:99], v126 offset:0
    ds_read_b128 v[100:103], v126 offset:1024
    ds_read_b128 v[104:107], v126 offset:2048
    ds_read_b128 v[108:111], v126 offset:3072
    s_waitcnt vmcnt(14) lgkmcnt(3)
    v_mfma_f32_16x16x32_bf16 v[64:67], v[96:99], v[0:3], 0
    v_mfma_f32_16x16x32_bf16 v[68:71], v[96:99], v[4:7], 0
    ds_read_b128 v[96:99], v126 offset:4096
    s_waitcnt lgkmcnt(3)
    v_mfma_f32_16x16x32_bf16 v[72:75], v[100:103], v[0:3], 0
    v_mfma_f32_16x16x32_bf16 v[76:79], v[100:103], v[4:7], 0
    ds_read_b128 v[100:103], v126 offset:5120
    s_waitcnt vmcnt(12) lgkmcnt(3)
    v_mfma_f32_16x16x32_bf16 v[64:67], v[104:107], v[8:11], v[64:67]
    v_mfma_f32_16x16x32_bf16 v[68:71], v[104:107], v[12:15], v[68:71]
    ds_read_b128 v[104:107], v126 offset:6144
    s_waitcnt lgkmcnt(3)
    v_mfma_f32_16x16x32_bf16 v[72:75], v[108:111], v[8:11], v[72:75]
    v_mfma_f32_16x16x32_bf16 v[76:79], v[108:111], v[12:15], v[76:79]
    ds_read_b128 v[108:111], v126 offset:7168
    s_waitcnt vmcnt(10) lgkmcnt(3)
    v_mfma_f32_16x16x32_bf16 v[64:67], v[96:99], v[16:19], v[64:67]
    v_mfma_f32_16x16x32_bf16 v[68:71], v[96:99], v[20:23], v[68:71]
    ds_read_b128 v[96:99], v126 offset:8192
    s_waitcnt lgkmcnt(3)
    v_mfma_f32_16x16x32_bf16 v[72:75], v[100:103], v[16:19], v[72:75]
    v_mfma_f32_16x16x32_bf16 v[76:79], v[100:103], v[20:23], v[76:79]
    ds_read_b128 v[100:103], v126 offset:9216
    s_waitcnt vmcnt(8) lgkmcnt(3)
    v_mfma_f32_16x16x32_bf16 v[64:67], v[104:107], v[24:27], v[64:67]
    v_mfma_f32_16x16x32_bf16 v[68:71], v[104:107], v[28:31], v[68:71]
    ds_read_b128 v[104:107], v126 offset:10240
    s_waitcnt lgkmcnt(3)
    v_mfma_f32_16x16x32_bf16 v[72:75], v[108:111], v[24:27], v[72:75]
    v_mfma_f32_16x16x32_bf16 v[76:79], v[108:111], v[28:31], v[76:79]
    ds_read_b128 v[108:111], v126 offset:11264
    s_waitcnt vmcnt(6) lgkmcnt(3)
    v_mfma_f32_16x16x32_bf16 v[64:67], v[96:99], v[32:35], v[64:67]
    v_mfma_f32_16x16x32_bf16 v[68:71], v[96:99], v[36:39], v[68:71]
    ds_read_b128 v[96:99], v126 offset:12288
    s_waitcnt lgkmcnt(3)
    v_mfma_f32_16x16x32_bf16 v[72:75], v[100:103], v[32:35], v[72:75]
    v_mfma_f32_16x16x32_bf16 v[76:79], v[100:103], v[36:39], v[76:79]
    ds_read_b128 v[100:103], v126 offset:13312
    s_waitcnt vmcnt(4) lgkmcnt(3)
    v_mfma_f32_16x16x32_bf16 v[64:67], v[104:107], v[40:43], v[64:67]
    v_mfma_f32_16x16x32_bf16 v[68:71], v[104:107], v[44:47], v[68:71]
    ds_read_b128 v[104:107], v126 offset:14336
    s_waitcnt lgkmcnt(3)
    v_mfma_f32_16x16x32_bf16 v[72:75], v[108:111], v[40:43], v[72:75]
    v_mfma_f32_16x16x32_bf16 v[76:79], v[108:111], v[44:47], v[76:79]
    ds_read_b128 v[108:111], v126 offset:15360
    s_waitcnt vmcnt(2) lgkmcnt(3)
    v_mfma_f32_16x16x32_bf16 v[64:67], v[96:99], v[48:51], v[64:67]
    v_mfma_f32_16x16x32_bf16 v[68:71], v[96:99], v[52:55], v[68:71]
    s_waitcnt lgkmcnt(0)
    s_barrier
    ds_read_b128 v[96:99], v126 offset:16384
    v_mfma_f32_16x16x32_bf16 v[72:75], v[100:103], v[48:51], v[72:75]
    v_mfma_f32_16x16x32_bf16 v[76:79], v[100:103], v[52:55], v[76:79]
    ds_read_b128 v[100:103], v126 offset:17408
    s_waitcnt vmcnt(0)
    v_mfma_f32_16x16x32_bf16 v[64:67], v[104:107], v[56:59], v[64:67]
    v_mfma_f32_16x16x32_bf16 v[68:71], v[104:107], v[60:63], v[68:71]
    ds_read_b128 v[104:107], v126 offset:18432
    v_mfma_f32_16x16x32_bf16 v[72:75], v[108:111], v[56:59], v[72:75]
    v_mfma_f32_16x16x32_bf16 v[76:79], v[108:111], v[60:63], v[76:79]
    ds_read_b128 v[108:111], v126 offset:19456
    s_mov_b32 s22, 4
L_joint_kernel_oloop:
    s_waitcnt lgkmcnt(3)
    v_mfma_f32_16x16x32_bf16 v[80:83], v[96:99], v[0:3], 0
    v_mfma_f32_16x16x32_bf16 v[84:87], v[96:99], v[4:7], 0
    ds_read_b128 v[96:99], v126 offset:20480
    s_waitcnt lgkmcnt(3)
    v_mfma_f32_16x16x32_bf16 v[88:91], v[100:103], v[0:3], 0
    v_mfma_f32_16x16x32_bf16 v[92:95], v[100:103], v[4:7], 0
    ds_read_b128 v[100:103], v126 offset:21504
    s_waitcnt lgkmcnt(3)
    v_mfma_f32_16x16x32_bf16 v[80:83], v[104:107], v[8:11], v[80:83]
    v_mfma_f32_16x16x32_bf16 v[84:87], v[104:107], v[12:15], v[84:87]
    ds_read_b128 v[104:107], v126 offset:22528
    s_waitcnt lgkmcnt(3)
    v_mfma_f32_16x16x32_bf16 v[88:91], v[108:111], v[8:11], v[88:91]
    v_cvt_pk_bf16_f32 v112, v64, v68
    v_mfma_f32_16x16x32_bf16 v[92:95], v[108:111], v[12:15], v[92:95]
    buffer_store_dword v112, v125, s[16:19], 0 offen offset:0 nt
    ds_read_b128 v[108:111], v126 offset:23552
    s_waitcnt lgkmcnt(3)
    v_mfma_f32_16x16x32_bf16 v[80:83], v[96:99], v[16:19], v[80:83]
    v_cvt_pk_bf16_f32 v113, v65, v69
    v_mfma_f32_16x16x32_bf16 v[84:87], v[96:99], v[20:23], v[84:87]
    buffer_store_dword v113, v125, s[16:19], 0 offen offset:512 nt
    ds_read_b128 v[96:99], v126 offset:24576
    s_waitcnt lgkmcnt(3)
    v_mfma_f32_16x16x32_bf16 v[88:91], v[100:103], v[16:19], v[88:91]
    v_cvt_pk_bf16_f32 v114, v66, v70
    v_mfma_f32_16x16x32_bf16 v[92:95], v[100:103], v[20:23], v[92:95]
    buffer_store_dword v114, v125, s[16:19], 0 offen offset:1024 nt
    ds_read_b128 v[100:103], v126 offset:25600
    s_waitcnt lgkmcnt(3)
    v_mfma_f32_16x16x32_bf16 v[80:83], v[104:107], v[24:27], v[80:83]
    v_cvt_pk_bf16_f32 v115, v67, v71
    v_mfma_f32_16x16x32_bf16 v[84:87], v[104:107], v[28:31], v[84:87]
    buffer_store_dword v115, v125, s[16:19], 0 offen offset:1536 nt
    ds_read_b128 v[104:107], v126 offset:26624
    s_waitcnt lgkmcnt(3)
    v_mfma_f32_16x16x32_bf16 v[88:91], v[108:111], v[24:27], v[88:91]
    v_cvt_pk_bf16_f32 v116, v72, v76
    v_mfma_f32_16x16x32_bf16 v[92:95], v[108:111], v[28:31], v[92:95]
    buffer_store_dword v116, v125, s[16:19], s44 offen offset:0 nt
    ds_read_b128 v[108:111], v126 offset:27648
    s_waitcnt lgkmcnt(3)
    v_mfma_f32_16x16x32_bf16 v[80:83], v[96:99], v[32:35], v[80:83]
    v_cvt_pk_bf16_f32 v117, v73, v77
    v_mfma_f32_16x16x32_bf16 v[84:87], v[96:99], v[36:39], v[84:87]
    buffer_store_dword v117, v125, s[16:19], s44 offen offset:512 nt
    ds_read_b128 v[96:99], v126 offset:28672
    s_waitcnt lgkmcnt(3)
    v_mfma_f32_16x16x32_bf16 v[88:91], v[100:103], v[32:35], v[88:91]
    v_cvt_pk_bf16_f32 v118, v74, v78
    v_mfma_f32_16x16x32_bf16 v[92:95], v[100:103], v[36:39], v[92:95]
    buffer_store_dword v118, v125, s[16:19], s44 offen offset:1024 nt
    ds_read_b128 v[100:103], v126 offset:29696
    s_waitcnt lgkmcnt(3)
    v_mfma_f32_16x16x32_bf16 v[80:83], v[104:107], v[40:43], v[80:83]
    v_cvt_pk_bf16_f32 v119, v75, v79
    v_mfma_f32_16x16x32_bf16 v[84:87], v[104:107], v[44:47], v[84:87]
    buffer_store_dword v119, v125, s[16:19], s44 offen offset:1536 nt
    ds_read_b128 v[104:107], v126 offset:30720
    s_waitcnt lgkmcnt(3)
    v_mfma_f32_16x16x32_bf16 v[88:91], v[108:111], v[40:43], v[88:91]
    v_add_u32 v125, 16384, v125
    v_mfma_f32_16x16x32_bf16 v[92:95], v[108:111], v[44:47], v[92:95]
    ds_read_b128 v[108:111], v126 offset:31744
    s_waitcnt lgkmcnt(3)
    v_mfma_f32_16x16x32_bf16 v[80:83], v[96:99], v[48:51], v[80:83]
    v_mfma_f32_16x16x32_bf16 v[84:87], v[96:99], v[52:55], v[84:87]
    s_waitcnt lgkmcnt(0)
    s_barrier
    ds_read_b128 v[96:99], v126 offset:0
    v_mfma_f32_16x16x32_bf16 v[88:91], v[100:103], v[48:51], v[88:91]
    v_mfma_f32_16x16x32_bf16 v[92:95], v[100:103], v[52:55], v[92:95]
    ds_read_b128 v[100:103], v126 offset:1024
    v_mfma_f32_16x16x32_bf16 v[80:83], v[104:107], v[56:59], v[80:83]
    v_mfma_f32_16x16x32_bf16 v[84:87], v[104:107], v[60:63], v[84:87]
    ds_read_b128 v[104:107], v126 offset:2048
    v_mfma_f32_16x16x32_bf16 v[88:91], v[108:111], v[56:59], v[88:91]
    v_mfma_f32_16x16x32_bf16 v[92:95], v[108:111], v[60:63], v[92:95]
    ds_read_b128 v[108:111], v126 offset:3072
    s_sub_u32 s22, s22, 1
    s_cmp_eq_u32 s22, 0
    s_cbranch_scc1 L_joint_kernel_oend
    s_waitcnt lgkmcnt(3)
    v_mfma_f32_16x16x32_bf16 v[64:67], v[96:99], v[0:3], 0
    v_mfma_f32_16x16x32_bf16 v[68:71], v[96:99], v[4:7], 0
    ds_read_b128 v[96:99], v126 offset:4096
    s_waitcnt lgkmcnt(3)
    v_mfma_f32_16x16x32_bf16 v[72:75], v[100:103], v[0:3], 0
    v_mfma_f32_16x16x32_bf16 v[76:79], v[100:103], v[4:7], 0
    ds_read_b128 v[100:103], v126 offset:5120
    s_waitcnt lgkmcnt(3)
    v_mfma_f32_16x16x32_bf16 v[64:67], v[104:107], v[8:11], v[64:67]
    v_mfma_f32_16x16x32_bf16 v[68:71], v[104:107], v[12:15], v[68:71]
    ds_read_b128 v[104:107], v126 offset:6144
    s_waitcnt lgkmcnt(3)
    v_mfma_f32_16x16x32_bf16 v[72:75], v[108:111], v[8:11], v[72:75]
    v_cvt_pk_bf16_f32 v112, v80, v84
    v_mfma_f32_16x16x32_bf16 v[76:79], v[108:111], v[12:15], v[76:79]
    buffer_store_dword v112, v125, s[16:19], 0 offen offset:0 nt
    ds_read_b128 v[108:111], v126 offset:7168
    s_waitcnt lgkmcnt(3)
    v_mfma_f32_16x16x32_bf16 v[64:67], v[96:99], v[16:19], v[64:67]
    v_cvt_pk_bf16_f32 v113, v81, v85
    v_mfma_f32_16x16x32_bf16 v[68:71], v[96:99], v[20:23], v[68:71]
    buffer_store_dword v113, v125, s[16:19], 0 offen offset:512 nt
    ds_read_b128 v[96:99], v126 offset:8192
    s_waitcnt lgkmcnt(3)
    v_mfma_f32_16x16x32_bf16 v[72:75], v[100:103], v[16:19], v[72:75]
    v_cvt_pk_bf16_f32 v114, v82, v86
    v_mfma_f32_16x16x32_bf16 v[76:79], v[100:103], v[20:23], v[76:79]
    buffer_store_dword v114, v125, s[16:19], 0 offen offset:1024 nt
    ds_read_b128 v[100:103], v126 offset:9216
    s_waitcnt lgkmcnt(3)
    v_mfma_f32_16x16x32_bf16 v[64:67], v[104:107], v[24:27], v[64:67]
    v_cvt_pk_bf16_f32 v115, v83, v87
    v_mfma_f32_16x16x32_bf16 v[68:71], v[104:107], v[28:31], v[68:71]
    buffer_store_dword v115, v125, s[16:19], 0 offen offset:1536 nt
    ds_read_b128 v[104:107], v126 offset:10240
    s_waitcnt lgkmcnt(3)
    v_mfma_f32_16x16x32_bf16 v[72:75], v[108:111], v[24:27], v[72:75]
    v_cvt_pk_bf16_f32 v116, v88, v92
    v_mfma_f32_16x16x32_bf16 v[76:79], v[108:111], v[28:31], v[76:79]
    buffer_store_dword v116, v125, s[16:19], s44 offen offset:0 nt
    ds_read_b128 v[108:111], v126 offset:11264
    s_waitcnt lgkmcnt(3)
    v_mfma_f32_16x16x32_bf16 v[64:67], v[96:99], v[32:35], v[64:67]
    v_cvt_pk_bf16_f32 v117, v89, v93
    v_mfma_f32_16x16x32_bf16 v[68:71], v[96:99], v[36:39], v[68:71]
    buffer_store_dword v117, v125, s[16:19], s44 offen offset:512 nt
    ds_read_b128 v[96:99], v126 offset:12288
    s_waitcnt lgkmcnt(3)
    v_mfma_f32_16x16x32_bf16 v[72:75], v[100:103], v[32:35], v[72:75]
    v_cvt_pk_bf16_f32 v118, v90, v94
    v_mfma_f32_16x16x32_bf16 v[76:79], v[100:103], v[36:39], v[76:79]
    buffer_store_dword v118, v125, s[16:19], s44 offen offset:1024 nt
    ds_read_b128 v[100:103], v126 offset:13312
    s_waitcnt lgkmcnt(3)
    v_mfma_f32_16x16x32_bf16 v[64:67], v[104:107], v[40:43], v[64:67]
    v_cvt_pk_bf16_f32 v119, v91, v95
    v_mfma_f32_16x16x32_bf16 v[68:71], v[104:107], v[44:47], v[68:71]
    buffer_store_dword v119, v125, s[16:19], s44 offen offset:1536 nt
    ds_read_b128 v[104:107], v126 offset:14336
    s_waitcnt lgkmcnt(3)
    v_mfma_f32_16x16x32_bf16 v[72:75], v[108:111], v[40:43], v[72:75]
    v_add_u32 v125, 16384, v125
    v_mfma_f32_16x16x32_bf16 v[76:79], v[108:111], v[44:47], v[76:79]
    ds_read_b128 v[108:111], v126 offset:15360
    s_waitcnt lgkmcnt(3)
    v_mfma_f32_16x16x32_bf16 v[64:67], v[96:99], v[48:51], v[64:67]
    v_mfma_f32_16x16x32_bf16 v[68:71], v[96:99], v[52:55], v[68:71]
    s_waitcnt lgkmcnt(0)
    s_barrier
    ds_read_b128 v[96:99], v126 offset:16384
    v_mfma_f32_16x16x32_bf16 v[72:75], v[100:103], v[48:51], v[72:75]
    v_mfma_f32_16x16x32_bf16 v[76:79], v[100:103], v[52:55], v[76:79]
    ds_read_b128 v[100:103], v126 offset:17408
    v_mfma_f32_16x16x32_bf16 v[64:67], v[104:107], v[56:59], v[64:67]
    v_mfma_f32_16x16x32_bf16 v[68:71], v[104:107], v[60:63], v[68:71]
    ds_read_b128 v[104:107], v126 offset:18432
    v_mfma_f32_16x16x32_bf16 v[72:75], v[108:111], v[56:59], v[72:75]
    v_mfma_f32_16x16x32_bf16 v[76:79], v[108:111], v[60:63], v[76:79]
    ds_read_b128 v[108:111], v126 offset:19456
    s_waitcnt vmcnt(32)
    s_branch L_joint_kernel_oloop
L_joint_kernel_oend:
    s_nop 7
    v_cvt_pk_bf16_f32 v112, v80, v84
    buffer_store_dword v112, v125, s[16:19], 0 offen offset:0 nt
    v_cvt_pk_bf16_f32 v113, v81, v85
    buffer_store_dword v113, v125, s[16:19], 0 offen offset:512 nt
    v_cvt_pk_bf16_f32 v114, v82, v86
    buffer_store_dword v114, v125, s[16:19], 0 offen offset:1024 nt
    v_cvt_pk_bf16_f32 v115, v83, v87
    buffer_store_dword v115, v125, s[16:19], 0 offen offset:1536 nt
    v_cvt_pk_bf16_f32 v116, v88, v92
    buffer_store_dword v116, v125, s[16:19], s44 offen offset:0 nt
    v_cvt_pk_bf16_f32 v117, v89, v93
    buffer_store_dword v117, v125, s[16:19], s44 offen offset:512 nt
    v_cvt_pk_bf16_f32 v118, v90, v94
    buffer_store_dword v118, v125, s[16:19], s44 offen offset:1024 nt
    v_cvt_pk_bf16_f32 v119, v91, v95
    buffer_store_dword v119, v125, s[16:19], s44 offen offset:1536 nt
    v_add_u32 v125, 16384, v125
    s_branch L_joint_kernel_fin
L_joint_kernel_T:
    s_setprio 3
    s_lshl_b32 s36, s21, 2
    s_add_u32 s36, s36, 44335104
    s_add_u32 s36, s30, s36
    s_addc_u32 s37, s31, 0
    s_load_dword s44, s[36:37], 0
    v_and_b32 v123, 15, v127
    v_lshrrev_b32 v121, 4, v127
    v_mul_u32_u24 v125, 528, v123
    v_lshl_add_u32 v125, v121, 4, v125
    v_lshlrev_b32 v121, 5, v121
    v_and_b32 v120, 7, v127
    v_lshl_add_u32 v124, v120, 10, v121
    s_lshl_b32 s38, s21, 7
    v_mul_u32_u24 v120, 1040, v120
    s_add_u32 s36, s38, 91136
    v_add3_u32 v120, v120, v121, s36
    s_mul_i32 s36, s21, 5184
    s_add_u32 s36, s36, 49664
    v_add_u32 v121, s36, v121
    v_mul_u32_u24 v122, 144, v123
    v_add_u32 v122, v122, v121
    v_lshrrev_b32 v123, 3, v123
    v_mul_u32_u24 v123, 144, v123
    v_add_u32 v121, v123, v121
    s_lshl_b32 s36, s21, 11
    v_add_u32 v123, s36, v126
    s_barrier
    s_mov_b32 s36, 0
    buffer_load_dwordx4 v[0:3], v126, s[12:15], s36 offen offset:0
    buffer_load_dwordx4 v[4:7], v126, s[12:15], s36 offen offset:1024
    buffer_load_dwordx4 v[8:11], v126, s[12:15], s36 offen offset:2048
    buffer_load_dwordx4 v[12:15], v126, s[12:15], s36 offen offset:3072
    s_mov_b32 s36, 4096
    buffer_load_dwordx4 v[16:19], v126, s[12:15], s36 offen offset:0
    buffer_load_dwordx4 v[20:23], v126, s[12:15], s36 offen offset:1024
    buffer_load_dwordx4 v[24:27], v126, s[12:15], s36 offen offset:2048
    buffer_load_dwordx4 v[28:31], v126, s[12:15], s36 offen offset:3072
    s_mov_b32 s36, 8192
    buffer_load_dwordx4 v[32:35], v126, s[12:15], s36 offen offset:0
    buffer_load_dwordx4 v[36:39], v126, s[12:15], s36 offen offset:1024
    buffer_load_dwordx4 v[40:43], v126, s[12:15], s36 offen offset:2048
    buffer_load_dwordx4 v[44:47], v126, s[12:15], s36 offen offset:3072
    s_mov_b32 s36, 12288
    buffer_load_dwordx4 v[48:51], v126, s[12:15], s36 offen offset:0
    buffer_load_dwordx4 v[52:55], v126, s[12:15], s36 offen offset:1024
    buffer_load_dwordx4 v[56:59], v126, s[12:15], s36 offen offset:2048
    buffer_load_dwordx4 v[60:63], v126, s[12:15], s36 offen offset:3072
    v_mov_b32 v64, 99456
    v_mov_b32 v65, 1
    s_mov_b64 exec, 1
    ds_add_u32 v64, v65 offset:4
    s_mov_b64 exec, -1
L_joint_kernel_tw:
    ds_read_b32 v65, v64 offset:0
    s_waitcnt lgkmcnt(0)
    v_readfirstlane_b32 s37, v65
    s_cmp_ge_u32 s37, 8
    s_cbranch_scc1 L_joint_kernel_tw_d
    s_sleep 1
    s_branch L_joint_kernel_tw
L_joint_kernel_tw_d:
    ds_read_b128 v[80:83], v125 offset:32768
    ds_read_b128 v[84:87], v125 offset:41216
    ds_read_b128 v[88:91], v125 offset:32832
    ds_read_b128 v[92:95], v125 offset:41280
    ds_read_b128 v[96:99], v125 offset:32896
    ds_read_b128 v[100:103], v125 offset:41344
    ds_read_b128 v[104:107], v125 offset:32960
    ds_read_b128 v[108:111], v125 offset:41408
    s_setprio 0
    s_waitcnt vmcnt(14) lgkmcnt(7)
    v_mfma_f32_16x16x32_bf16 v[64:67], v[0:3], v[80:83], 0
    v_mfma_f32_16x16x32_bf16 v[68:71], v[4:7], v[80:83], 0
    ds_read_b128 v[80:83], v125 offset:33024
    s_waitcnt lgkmcnt(7)
    v_mfma_f32_16x16x32_bf16 v[72:75], v[0:3], v[84:87], 0
    v_mfma_f32_16x16x32_bf16 v[76:79], v[4:7], v[84:87], 0
    ds_read_b128 v[84:87], v125 offset:41472
    s_waitcnt vmcnt(12) lgkmcnt(7)
    v_mfma_f32_16x16x32_bf16 v[64:67], v[8:11], v[88:91], v[64:67]
    v_mfma_f32_16x16x32_bf16 v[68:71], v[12:15], v[88:91], v[68:71]
    ds_read_b128 v[88:91], v125 offset:33088
    s_waitcnt lgkmcnt(7)
    v_mfma_f32_16x16x32_bf16 v[72:75], v[8:11], v[92:95], v[72:75]
    v_mfma_f32_16x16x32_bf16 v[76:79], v[12:15], v[92:95], v[76:79]
    ds_read_b128 v[92:95], v125 offset:41536
    s_waitcnt vmcnt(10) lgkmcnt(7)
    v_mfma_f32_16x16x32_bf16 v[64:67], v[16:19], v[96:99], v[64:67]
    v_mfma_f32_16x16x32_bf16 v[68:71], v[20:23], v[96:99], v[68:71]
    ds_read_b128 v[96:99], v125 offset:33152
    s_waitcnt lgkmcnt(7)
    v_mfma_f32_16x16x32_bf16 v[72:75], v[16:19], v[100:103], v[72:75]
    v_mfma_f32_16x16x32_bf16 v[76:79], v[20:23], v[100:103], v[76:79]
    ds_read_b128 v[100:103], v125 offset:41600
    s_waitcnt vmcnt(8) lgkmcnt(7)
    v_mfma_f32_16x16x32_bf16 v[64:67], v[24:27], v[104:107], v[64:67]
    v_mfma_f32_16x16x32_bf16 v[68:71], v[28:31], v[104:107], v[68:71]
    ds_read_b128 v[104:107], v125 offset:33216
    s_waitcnt lgkmcnt(7)
    v_mfma_f32_16x16x32_bf16 v[72:75], v[24:27], v[108:111], v[72:75]
    v_mfma_f32_16x16x32_bf16 v[76:79], v[28:31], v[108:111], v[76:79]
    ds_read_b128 v[108:111], v125 offset:41664
    s_waitcnt vmcnt(6) lgkmcnt(7)
    v_mfma_f32_16x16x32_bf16 v[64:67], v[32:35], v[80:83], v[64:67]
    v_mfma_f32_16x16x32_bf16 v[68:71], v[36:39], v[80:83], v[68:71]
    ds_read_b128 v[112:115], v120 offset:0
    s_waitcnt lgkmcnt(7)
    v_mfma_f32_16x16x32_bf16 v[72:75], v[32:35], v[84:87], v[72:75]
    v_mfma_f32_16x16x32_bf16 v[76:79], v[36:39], v[84:87], v[76:79]
    ds_read_b128 v[116:119], v120 offset:16
    s_waitcnt vmcnt(4) lgkmcnt(7)
    v_mfma_f32_16x16x32_bf16 v[64:67], v[40:43], v[88:91], v[64:67]
    v_mfma_f32_16x16x32_bf16 v[68:71], v[44:47], v[88:91], v[68:71]
    s_waitcnt lgkmcnt(6)
    v_mfma_f32_16x16x32_bf16 v[72:75], v[40:43], v[92:95], v[72:75]
    v_mfma_f32_16x16x32_bf16 v[76:79], v[44:47], v[92:95], v[76:79]
    s_waitcnt vmcnt(2) lgkmcnt(5)
    v_mfma_f32_16x16x32_bf16 v[64:67], v[48:51], v[96:99], v[64:67]
    v_mfma_f32_16x16x32_bf16 v[68:71], v[52:55], v[96:99], v[68:71]
    s_waitcnt lgkmcnt(4)
    v_mfma_f32_16x16x32_bf16 v[72:75], v[48:51], v[100:103], v[72:75]
    v_mfma_f32_16x16x32_bf16 v[76:79], v[52:55], v[100:103], v[76:79]
    s_waitcnt vmcnt(0) lgkmcnt(3)
    v_mfma_f32_16x16x32_bf16 v[64:67], v[56:59], v[104:107], v[64:67]
    v_mfma_f32_16x16x32_bf16 v[68:71], v[60:63], v[104:107], v[68:71]
    s_waitcnt lgkmcnt(2)
    v_mfma_f32_16x16x32_bf16 v[72:75], v[56:59], v[108:111], v[72:75]
    v_mfma_f32_16x16x32_bf16 v[76:79], v[60:63], v[108:111], v[76:79]
    s_mov_b32 s46, 0xffff0000
    s_mov_b32 s48, 0x4038aa3b
    s_mov_b32 s49, s48
    s_nop 3
    v_mov_b32 v28, 0
    s_waitcnt lgkmcnt(0)
    v_cvt_pk_bf16_f32 v24, v64, v68
    v_cvt_pk_bf16_f32 v25, v65, v69
    v_cvt_pk_bf16_f32 v26, v66, v70
    v_cvt_pk_bf16_f32 v27, v67, v71
    v_lshlrev_b32 v80, 16, v24
    v_and_b32 v81, s46, v24
    v_lshlrev_b32 v82, 16, v25
    v_and_b32 v83, s46, v25
    v_lshlrev_b32 v84, 16, v26
    v_and_b32 v85, s46, v26
    v_lshlrev_b32 v86, 16, v27
    v_and_b32 v87, s46, v27
    v_pk_mul_f32 v[80:81], v[80:81], s[48:49]
    v_pk_mul_f32 v[82:83], v[82:83], s[48:49]
    v_pk_mul_f32 v[84:85], v[84:85], s[48:49]
    v_pk_mul_f32 v[86:87], v[86:87], s[48:49]
    v_exp_f32 v96, v80
    v_exp_f32 v97, v81
    v_exp_f32 v98, v82
    v_exp_f32 v99, v83
    v_max3_f32 v28, |v80|, |v81|, v28
    v_max3_f32 v28, |v82|, |v83|, v28
    ds_write_b128 v122, v[96:99] offset:0
    v_exp_f32 v100, v84
    v_exp_f32 v101, v85
    v_exp_f32 v102, v86
    v_exp_f32 v103, v87
    v_max3_f32 v28, |v84|, |v85|, v28
    v_max3_f32 v28, |v86|, |v87|, v28
    ds_write_b128 v122, v[100:103] offset:16
    v_cvt_pk_bf16_f32 v24, v72, v76
    v_cvt_pk_bf16_f32 v25, v73, v77
    v_cvt_pk_bf16_f32 v26, v74, v78
    v_cvt_pk_bf16_f32 v27, v75, v79
    v_lshlrev_b32 v88, 16, v24
    v_and_b32 v89, s46, v24
    v_lshlrev_b32 v90, 16, v25
    v_and_b32 v91, s46, v25
    v_lshlrev_b32 v92, 16, v26
    v_and_b32 v93, s46, v26
    v_lshlrev_b32 v94, 16, v27
    v_and_b32 v95, s46, v27
    v_pk_mul_f32 v[88:89], v[88:89], s[48:49]
    v_pk_mul_f32 v[90:91], v[90:91], s[48:49]
    v_pk_mul_f32 v[92:93], v[92:93], s[48:49]
    v_pk_mul_f32 v[94:95], v[94:95], s[48:49]
    v_exp_f32 v104, v88
    v_exp_f32 v105, v89
    v_exp_f32 v106, v90
    v_exp_f32 v107, v91
    v_max3_f32 v28, |v88|, |v89|, v28
    v_max3_f32 v28, |v90|, |v91|, v28
    ds_write_b128 v122, v[104:107] offset:2304
    v_exp_f32 v108, v92
    v_exp_f32 v109, v93
    v_exp_f32 v110, v94
    v_exp_f32 v111, v95
    v_max3_f32 v28, |v92|, |v93|, v28
    v_max3_f32 v28, |v94|, |v95|, v28
    ds_write_b128 v122, v[108:111] offset:2320
    v_cmp_lt_f32 vcc, 0x42f00000, v28
    s_mov_b32 s22, 4
    s_or_b32 s44, s44, vcc_lo
    s_or_b32 s44, s44, vcc_hi
    s_cmp_lg_u32 s44, 0
    s_cbranch_scc1 L_joint_kernel_tslow
    ds_read_b128 v[32:35], v121 offset:0
    ds_read_b128 v[36:39], v121 offset:16
    ds_read_b128 v[40:43], v121 offset:288
    ds_read_b128 v[44:47], v121 offset:304
    v_add_u32 v121, 576, v121
    s_waitcnt vmcnt(0) lgkmcnt(0)
L_joint_kernel_tloop1:
    v_fma_f32 v48, v112, v32, 1.0
    v_fma_f32 v49, v113, v33, 1.0
    v_fma_f32 v50, v114, v34, 1.0
    v_fma_f32 v51, v115, v35, 1.0
    v_fma_f32 v52, v116, v36, 1.0
    v_fma_f32 v53, v117, v37, 1.0
    v_fma_f32 v54, v118, v38, 1.0
    v_fma_f32 v55, v119, v39, 1.0
    v_fma_f32 v56, v112, v40, 1.0
    v_fma_f32 v57, v113, v41, 1.0
    v_fma_f32 v58, v114, v42, 1.0
    v_fma_f32 v59, v115, v43, 1.0
    v_fma_f32 v60, v116, v44, 1.0
    v_fma_f32 v61, v117, v45, 1.0
    v_fma_f32 v62, v118, v46, 1.0
    v_fma_f32 v63, v119, v47, 1.0
    ds_read_b128 v[32:35], v121 offset:0
    ds_read_b128 v[36:39], v121 offset:16
    ds_read_b128 v[40:43], v121 offset:288
    ds_read_b128 v[44:47], v121 offset:304
    v_add_u32 v121, 576, v121
    v_rcp_f32 v48, v48
    v_rcp_f32 v49, v49
    v_rcp_f32 v50, v50
    v_rcp_f32 v51, v51
    v_rcp_f32 v52, v52
    v_rcp_f32 v53, v53
    v_rcp_f32 v54, v54
    v_rcp_f32 v55, v55
    v_fma_f32 v48, v48, -2.0, 1.0
    v_fma_f32 v49, v49, -2.0, 1.0
    v_fma_f32 v50, v50, -2.0, 1.0
    v_fma_f32 v51, v51, -2.0, 1.0
    v_fma_f32 v52, v52, -2.0, 1.0
    v_fma_f32 v53, v53, -2.0, 1.0
    v_fma_f32 v54, v54, -2.0, 1.0
    v_fma_f32 v55, v55, -2.0, 1.0
    v_cvt_pk_bf16_f32 v64, v48, v49
    v_cvt_pk_bf16_f32 v65, v50, v51
    v_cvt_pk_bf16_f32 v66, v52, v53
    v_cvt_pk_bf16_f32 v67, v54, v55
    ds_write_b128 v123, v[64:67] offset:0
    v_rcp_f32 v56, v56
    v_rcp_f32 v57, v57
    v_rcp_f32 v58, v58
    v_rcp_f32 v59, v59
    v_rcp_f32 v60, v60
    v_rcp_f32 v61, v61
    v_rcp_f32 v62, v62
    v_rcp_f32 v63, v63
    v_fma_f32 v56, v56, -2.0, 1.0
    v_fma_f32 v57, v57, -2.0, 1.0
    v_fma_f32 v58, v58, -2.0, 1.0
    v_fma_f32 v59, v59, -2.0, 1.0
    v_fma_f32 v60, v60, -2.0, 1.0
    v_fma_f32 v61, v61, -2.0, 1.0
    v_fma_f32 v62, v62, -2.0, 1.0
    v_fma_f32 v63, v63, -2.0, 1.0
    v_cvt_pk_bf16_f32 v68, v56, v57
    v_cvt_pk_bf16_f32 v69, v58, v59
    v_cvt_pk_bf16_f32 v70, v60, v61
    v_cvt_pk_bf16_f32 v71, v62, v63
    ds_write_b128 v123, v[68:71] offset:1024
    s_waitcnt lgkmcnt(0)
    s_barrier
    v_fma_f32 v48, v112, v32, 1.0
    v_fma_f32 v49, v113, v33, 1.0
    v_fma_f32 v50, v114, v34, 1.0
    v_fma_f32 v51, v115, v35, 1.0
    v_fma_f32 v52, v116, v36, 1.0
    v_fma_f32 v53, v117, v37, 1.0
    v_fma_f32 v54, v118, v38, 1.0
    v_fma_f32 v55, v119, v39, 1.0
    v_fma_f32 v56, v112, v40, 1.0
    v_fma_f32 v57, v113, v41, 1.0
    v_fma_f32 v58, v114, v42, 1.0
    v_fma_f32 v59, v115, v43, 1.0
    v_fma_f32 v60, v116, v44, 1.0
    v_fma_f32 v61, v117, v45, 1.0
    v_fma_f32 v62, v118, v46, 1.0
    v_fma_f32 v63, v119, v47, 1.0
    ds_read_b128 v[32:35], v121 offset:0
    ds_read_b128 v[36:39], v121 offset:16
    ds_read_b128 v[40:43], v121 offset:288
    ds_read_b128 v[44:47], v121 offset:304
    v_add_u32 v121, 576, v121
    v_rcp_f32 v48, v48
    v_rcp_f32 v49, v49
    v_rcp_f32 v50, v50
    v_rcp_f32 v51, v51
    v_rcp_f32 v52, v52
    v_rcp_f32 v53, v53
    v_rcp_f32 v54, v54
    v_rcp_f32 v55, v55
    v_fma_f32 v48, v48, -2.0, 1.0
    v_fma_f32 v49, v49, -2.0, 1.0
    v_fma_f32 v50, v50, -2.0, 1.0
    v_fma_f32 v51, v51, -2.0, 1.0
    v_fma_f32 v52, v52, -2.0, 1.0
    v_fma_f32 v53, v53, -2.0, 1.0
    v_fma_f32 v54, v54, -2.0, 1.0
    v_fma_f32 v55, v55, -2.0, 1.0
    v_cvt_pk_bf16_f32 v64, v48, v49
    v_cvt_pk_bf16_f32 v65, v50, v51
    v_cvt_pk_bf16_f32 v66, v52, v53
    v_cvt_pk_bf16_f32 v67, v54, v55
    ds_write_b128 v123, v[64:67] offset:16384
    v_rcp_f32 v56, v56
    v_rcp_f32 v57, v57
    v_rcp_f32 v58, v58
    v_rcp_f32 v59, v59
    v_rcp_f32 v60, v60
    v_rcp_f32 v61, v61
    v_rcp_f32 v62, v62
    v_rcp_f32 v63, v63
    v_fma_f32 v56, v56, -2.0, 1.0
    v_fma_f32 v57, v57, -2.0, 1.0
    v_fma_f32 v58, v58, -2.0, 1.0
    v_fma_f32 v59, v59, -2.0, 1.0
    v_fma_f32 v60, v60, -2.0, 1.0
    v_fma_f32 v61, v61, -2.0, 1.0
    v_fma_f32 v62, v62, -2.0, 1.0
    v_fma_f32 v63, v63, -2.0, 1.0
    v_cvt_pk_bf16_f32 v68, v56, v57
    v_cvt_pk_bf16_f32 v69, v58, v59
    v_cvt_pk_bf16_f32 v70, v60, v61
    v_cvt_pk_bf16_f32 v71, v62, v63
    ds_write_b128 v123, v[68:71] offset:17408
    s_waitcnt lgkmcnt(0)
    s_barrier
    s_sub_u32 s22, s22, 1
    s_cmp_lg_u32 s22, 0
    s_cbranch_scc1 L_joint_kernel_tloop1
    s_branch L_joint_kernel_fin
L_joint_kernel_tslow:
    buffer_load_dwordx4 v[112:115], v124, s[40:43], s38 offen offset:0
    buffer_load_dwordx4 v[116:119], v124, s[40:43], s38 offen offset:16
    ds_write_b128 v122, v[80:83] offset:0
    ds_write_b128 v122, v[84:87] offset:16
    ds_write_b128 v122, v[88:91] offset:2304
    ds_write_b128 v122, v[92:95] offset:2320
    ds_read_b128 v[32:35], v121 offset:0
    ds_read_b128 v[36:39], v121 offset:16
    ds_read_b128 v[40:43], v121 offset:288
    ds_read_b128 v[44:47], v121 offset:304
    v_add_u32 v121, 576, v121
    s_waitcnt vmcnt(0) lgkmcnt(0)
L_joint_kernel_tloop0:
    v_add_f32 v48, v112, v32
    v_add_f32 v49, v113, v33
    v_add_f32 v50, v114, v34
    v_add_f32 v51, v115, v35
    v_add_f32 v52, v116, v36
    v_add_f32 v53, v117, v37
    v_add_f32 v54, v118, v38
    v_add_f32 v55, v119, v39
    v_add_f32 v56, v112, v40
    v_add_f32 v57, v113, v41
    v_add_f32 v58, v114, v42
    v_add_f32 v59, v115, v43
    v_add_f32 v60, v116, v44
    v_add_f32 v61, v117, v45
    v_add_f32 v62, v118, v46
    v_add_f32 v63, v119, v47
    ds_read_b128 v[32:35], v121 offset:0
    ds_read_b128 v[36:39], v121 offset:16
    ds_read_b128 v[40:43], v121 offset:288
    ds_read_b128 v[44:47], v121 offset:304
    v_add_u32 v121, 576, v121
    v_exp_f32 v48, v48
    v_exp_f32 v49, v49
    v_exp_f32 v50, v50
    v_exp_f32 v51, v51
    v_exp_f32 v52, v52
    v_exp_f32 v53, v53
    v_exp_f32 v54, v54
    v_exp_f32 v55, v55
    v_add_f32 v48, 1.0, v48
    v_add_f32 v49, 1.0, v49
    v_add_f32 v50, 1.0, v50
    v_add_f32 v51, 1.0, v51
    v_add_f32 v52, 1.0, v52
    v_add_f32 v53, 1.0, v53
    v_add_f32 v54, 1.0, v54
    v_add_f32 v55, 1.0, v55
    v_rcp_f32 v48, v48
    v_rcp_f32 v49, v49
    v_rcp_f32 v50, v50
    v_rcp_f32 v51, v51
    v_rcp_f32 v52, v52
    v_rcp_f32 v53, v53
    v_rcp_f32 v54, v54
    v_rcp_f32 v55, v55
    v_fma_f32 v48, v48, -2.0, 1.0
    v_fma_f32 v49, v49, -2.0, 1.0
    v_fma_f32 v50, v50, -2.0, 1.0
    v_fma_f32 v51, v51, -2.0, 1.0
    v_fma_f32 v52, v52, -2.0, 1.0
    v_fma_f32 v53, v53, -2.0, 1.0
    v_fma_f32 v54, v54, -2.0, 1.0
    v_fma_f32 v55, v55, -2.0, 1.0
    v_cvt_pk_bf16_f32 v64, v48, v49
    v_cvt_pk_bf16_f32 v65, v50, v51
    v_cvt_pk_bf16_f32 v66, v52, v53
    v_cvt_pk_bf16_f32 v67, v54, v55
    ds_write_b128 v123, v[64:67] offset:0
    v_exp_f32 v56, v56
    v_exp_f32 v57, v57
    v_exp_f32 v58, v58
    v_exp_f32 v59, v59
    v_exp_f32 v60, v60
    v_exp_f32 v61, v61
    v_exp_f32 v62, v62
    v_exp_f32 v63, v63
    v_add_f32 v56, 1.0, v56
    v_add_f32 v57, 1.0, v57
    v_add_f32 v58, 1.0, v58
    v_add_f32 v59, 1.0, v59
    v_add_f32 v60, 1.0, v60
    v_add_f32 v61, 1.0, v61
    v_add_f32 v62, 1.0, v62
    v_add_f32 v63, 1.0, v63
    v_rcp_f32 v56, v56
    v_rcp_f32 v57, v57
    v_rcp_f32 v58, v58
    v_rcp_f32 v59, v59
    v_rcp_f32 v60, v60
    v_rcp_f32 v61, v61
    v_rcp_f32 v62, v62
    v_rcp_f32 v63, v63
    v_fma_f32 v56, v56, -2.0, 1.0
    v_fma_f32 v57, v57, -2.0, 1.0
    v_fma_f32 v58, v58, -2.0, 1.0
    v_fma_f32 v59, v59, -2.0, 1.0
    v_fma_f32 v60, v60, -2.0, 1.0
    v_fma_f32 v61, v61, -2.0, 1.0
    v_fma_f32 v62, v62, -2.0, 1.0
    v_fma_f32 v63, v63, -2.0, 1.0
    v_cvt_pk_bf16_f32 v68, v56, v57
    v_cvt_pk_bf16_f32 v69, v58, v59
    v_cvt_pk_bf16_f32 v70, v60, v61
    v_cvt_pk_bf16_f32 v71, v62, v63
    ds_write_b128 v123, v[68:71] offset:1024
    s_waitcnt lgkmcnt(0)
    s_barrier
    v_add_f32 v48, v112, v32
    v_add_f32 v49, v113, v33
    v_add_f32 v50, v114, v34
    v_add_f32 v51, v115, v35
    v_add_f32 v52, v116, v36
    v_add_f32 v53, v117, v37
    v_add_f32 v54, v118, v38
    v_add_f32 v55, v119, v39
    v_add_f32 v56, v112, v40
    v_add_f32 v57, v113, v41
    v_add_f32 v58, v114, v42
    v_add_f32 v59, v115, v43
    v_add_f32 v60, v116, v44
    v_add_f32 v61, v117, v45
    v_add_f32 v62, v118, v46
    v_add_f32 v63, v119, v47
    ds_read_b128 v[32:35], v121 offset:0
    ds_read_b128 v[36:39], v121 offset:16
    ds_read_b128 v[40:43], v121 offset:288
    ds_read_b128 v[44:47], v121 offset:304
    v_add_u32 v121, 576, v121
    v_exp_f32 v48, v48
    v_exp_f32 v49, v49
    v_exp_f32 v50, v50
    v_exp_f32 v51, v51
    v_exp_f32 v52, v52
    v_exp_f32 v53, v53
    v_exp_f32 v54, v54
    v_exp_f32 v55, v55
    v_add_f32 v48, 1.0, v48
    v_add_f32 v49, 1.0, v49
    v_add_f32 v50, 1.0, v50
    v_add_f32 v51, 1.0, v51
    v_add_f32 v52, 1.0, v52
    v_add_f32 v53, 1.0, v53
    v_add_f32 v54, 1.0, v54
    v_add_f32 v55, 1.0, v55
    v_rcp_f32 v48, v48
    v_rcp_f32 v49, v49
    v_rcp_f32 v50, v50
    v_rcp_f32 v51, v51
    v_rcp_f32 v52, v52
    v_rcp_f32 v53, v53
    v_rcp_f32 v54, v54
    v_rcp_f32 v55, v55
    v_fma_f32 v48, v48, -2.0, 1.0
    v_fma_f32 v49, v49, -2.0, 1.0
    v_fma_f32 v50, v50, -2.0, 1.0
    v_fma_f32 v51, v51, -2.0, 1.0
    v_fma_f32 v52, v52, -2.0, 1.0
    v_fma_f32 v53, v53, -2.0, 1.0
    v_fma_f32 v54, v54, -2.0, 1.0
    v_fma_f32 v55, v55, -2.0, 1.0
    v_cvt_pk_bf16_f32 v64, v48, v49
    v_cvt_pk_bf16_f32 v65, v50, v51
    v_cvt_pk_bf16_f32 v66, v52, v53
    v_cvt_pk_bf16_f32 v67, v54, v55
    ds_write_b128 v123, v[64:67] offset:16384
    v_exp_f32 v56, v56
    v_exp_f32 v57, v57
    v_exp_f32 v58, v58
    v_exp_f32 v59, v59
    v_exp_f32 v60, v60
    v_exp_f32 v61, v61
    v_exp_f32 v62, v62
    v_exp_f32 v63, v63
    v_add_f32 v56, 1.0, v56
    v_add_f32 v57, 1.0, v57
    v_add_f32 v58, 1.0, v58
    v_add_f32 v59, 1.0, v59
    v_add_f32 v60, 1.0, v60
    v_add_f32 v61, 1.0, v61
    v_add_f32 v62, 1.0, v62
    v_add_f32 v63, 1.0, v63
    v_rcp_f32 v56, v56
    v_rcp_f32 v57, v57
    v_rcp_f32 v58, v58
    v_rcp_f32 v59, v59
    v_rcp_f32 v60, v60
    v_rcp_f32 v61, v61
    v_rcp_f32 v62, v62
    v_rcp_f32 v63, v63
    v_fma_f32 v56, v56, -2.0, 1.0
    v_fma_f32 v57, v57, -2.0, 1.0
    v_fma_f32 v58, v58, -2.0, 1.0
    v_fma_f32 v59, v59, -2.0, 1.0
    v_fma_f32 v60, v60, -2.0, 1.0
    v_fma_f32 v61, v61, -2.0, 1.0
    v_fma_f32 v62, v62, -2.0, 1.0
    v_fma_f32 v63, v63, -2.0, 1.0
    v_cvt_pk_bf16_f32 v68, v56, v57
    v_cvt_pk_bf16_f32 v69, v58, v59
    v_cvt_pk_bf16_f32 v70, v60, v61
    v_cvt_pk_bf16_f32 v71, v62, v63
    ds_write_b128 v123, v[68:71] offset:17408
    s_waitcnt lgkmcnt(0)
    s_barrier
    s_sub_u32 s22, s22, 1
    s_cmp_lg_u32 s22, 0
    s_cbranch_scc1 L_joint_kernel_tloop0
L_joint_kernel_fin:
L_joint_kernel_done:
    s_endpgm
.section .rodata,"a"
.p2align 6
.amdhsa_kernel prep_kernel
  .amdhsa_next_free_vgpr 128
  .amdhsa_next_free_sgpr 102
  .amdhsa_accum_offset 128
  .amdhsa_group_segment_fixed_size 0
  .amdhsa_kernarg_size 80
  .amdhsa_user_sgpr_count 2
  .amdhsa_user_sgpr_kernarg_segment_ptr 1
  .amdhsa_system_sgpr_workgroup_id_x 1
.end_amdhsa_kernel
.p2align 6
.amdhsa_kernel conv1_kernel
  .amdhsa_next_free_vgpr 128
  .amdhsa_next_free_sgpr 102
  .amdhsa_accum_offset 128
  .amdhsa_group_segment_fixed_size 0
  .amdhsa_kernarg_size 80
  .amdhsa_user_sgpr_count 2
  .amdhsa_user_sgpr_kernarg_segment_ptr 1
  .amdhsa_system_sgpr_workgroup_id_x 1
.end_amdhsa_kernel
.p2align 6
.amdhsa_kernel conv2_kernel
  .amdhsa_next_free_vgpr 128
  .amdhsa_next_free_sgpr 102
  .amdhsa_accum_offset 128
  .amdhsa_group_segment_fixed_size 0
  .amdhsa_kernarg_size 80
  .amdhsa_user_sgpr_count 2
  .amdhsa_user_sgpr_kernarg_segment_ptr 1
  .amdhsa_system_sgpr_workgroup_id_x 1
.end_amdhsa_kernel
.p2align 6
.amdhsa_kernel joint_kernel
  .amdhsa_next_free_vgpr 128
  .amdhsa_next_free_sgpr 102
  .amdhsa_accum_offset 128
  .amdhsa_group_segment_fixed_size 0
  .amdhsa_kernarg_size 80
  .amdhsa_user_sgpr_count 2
  .amdhsa_user_sgpr_kernarg_segment_ptr 1
  .amdhsa_system_sgpr_workgroup_id_x 1
.end_amdhsa_kernel
```

```asm
; @launch kernel=prep_kernel grid=(268,1,1) block=(256,1,1) lds=4096
; @launch kernel=conv1_kernel grid=(256,1,1) block=(1024,1,1) lds=162816
; @launch kernel=conv2_kernel grid=(256,1,1) block=(1024,1,1) lds=162816
; @launch kernel=joint_kernel grid=(250,1,1) block=(1024,1,1) lds=99472
.amdgcn_target "amdgcn-amd-amdhsa--gfx950"
.text
.globl prep_kernel
.p2align 8
.type prep_kernel,@function
prep_kernel:
    s_cmp_ge_u32 s2, 268
    s_cbranch_scc1 L_prep_kernel_done
    s_mov_b32 s3, s2
    s_load_dwordx16 s[44:59], s[0:1], 0
    s_sub_u32 s2, s2, 12
    v_readfirstlane_b32 s40, v0
    s_lshr_b32 s40, s40, 6
    s_lshl_b32 s21, s2, 2
    s_add_u32 s20, s40, s21
    v_and_b32 v1, 63, v0
    s_load_dwordx2 s[8:9], s[0:1], 8
    s_load_dwordx2 s[30:31], s[0:1], 72
    s_lshr_b32 s22, s20, 8
    s_bfe_u32 s23, s20, 0x40004
    s_bfe_u32 s24, s20, 0x30001
    s_and_b32 s21, s20, 1
    v_lshrrev_b32 v2, 4, v1
    v_lshlrev_b32 v2, 12, v2
    v_and_b32 v3, 15, v1
    v_lshl_add_u32 v2, v3, 2, v2
    s_lshl_b32 s26, s22, 3
    s_lshr_b32 s27, s23, 3
    s_add_u32 s26, s26, s27
    s_lshl_b32 s26, s26, 17
    s_and_b32 s27, s23, 7
    s_lshl_b32 s27, s27, 14
    s_add_u32 s26, s26, s27
    s_lshl_b32 s27, s24, 6
    s_add_u32 s26, s26, s27
    s_mov_b32 s10, 4063232
    s_mov_b32 s11, 0x00020000
    s_lshr_b32 s41, s3, 2
    s_and_b32 s42, s3, 3
    s_lshl_b32 s42, s42, 1
    s_and_b32 s43, s40, 1
    s_add_u32 s42, s42, s43
    s_lshr_b32 s43, s40, 1
    s_lshl_b32 s4, s43, 16
    s_lshl_b32 s5, s42, 6
    s_add_u32 s4, s4, s5
    s_cmp_lt_u32 s3, 12
    s_cselect_b32 s26, s4, s26
    s_cselect_b32 s10, 131072, s10
    s_mov_b32 s5, 262144
    s_cselect_b32 s5, 16384, s5
    s_add_u32 s37, s26, s5
    s_add_u32 s38, s37, s5
    s_add_u32 s39, s38, s5
    s_waitcnt lgkmcnt(0)
    s_cmp_eq_u32 s41, 0
    s_cselect_b32 s8, s52, s8
    s_cselect_b32 s9, s53, s9
    s_cmp_eq_u32 s41, 1
    s_cselect_b32 s8, s56, s8
    s_cselect_b32 s9, s57, s9
    s_cmp_eq_u32 s41, 2
    s_cselect_b32 s8, s54, s8
    s_cselect_b32 s9, s55, s9
    buffer_load_dword v16, v2, s[8:11], s26 offen offset:0
    buffer_load_dword v17, v2, s[8:11], s26 offen offset:512
    buffer_load_dword v24, v2, s[8:11], s37 offen offset:0
    buffer_load_dword v25, v2, s[8:11], s37 offen offset:512
    buffer_load_dword v32, v2, s[8:11], s38 offen offset:0
    buffer_load_dword v33, v2, s[8:11], s38 offen offset:512
    buffer_load_dword v40, v2, s[8:11], s39 offen offset:0
    buffer_load_dword v41, v2, s[8:11], s39 offen offset:512
    buffer_load_dword v18, v2, s[8:11], s26 offen offset:1024
    buffer_load_dword v19, v2, s[8:11], s26 offen offset:1536
    buffer_load_dword v26, v2, s[8:11], s37 offen offset:1024
    buffer_load_dword v27, v2, s[8:11], s37 offen offset:1536
    buffer_load_dword v34, v2, s[8:11], s38 offen offset:1024
    buffer_load_dword v35, v2, s[8:11], s38 offen offset:1536
    buffer_load_dword v42, v2, s[8:11], s39 offen offset:1024
    buffer_load_dword v43, v2, s[8:11], s39 offen offset:1536
    buffer_load_dword v20, v2, s[8:11], s26 offen offset:2048
    buffer_load_dword v21, v2, s[8:11], s26 offen offset:2560
    buffer_load_dword v28, v2, s[8:11], s37 offen offset:2048
    buffer_load_dword v29, v2, s[8:11], s37 offen offset:2560
    buffer_load_dword v36, v2, s[8:11], s38 offen offset:2048
    buffer_load_dword v37, v2, s[8:11], s38 offen offset:2560
    buffer_load_dword v44, v2, s[8:11], s39 offen offset:2048
    buffer_load_dword v45, v2, s[8:11], s39 offen offset:2560
    buffer_load_dword v22, v2, s[8:11], s26 offen offset:3072
    buffer_load_dword v23, v2, s[8:11], s26 offen offset:3584
    buffer_load_dword v30, v2, s[8:11], s37 offen offset:3072
    buffer_load_dword v31, v2, s[8:11], s37 offen offset:3584
    buffer_load_dword v38, v2, s[8:11], s38 offen offset:3072
    buffer_load_dword v39, v2, s[8:11], s38 offen offset:3584
    buffer_load_dword v46, v2, s[8:11], s39 offen offset:3072
    buffer_load_dword v47, v2, s[8:11], s39 offen offset:3584
    s_cmp_lt_u32 s3, 12
    s_cbranch_scc1 L_prep_kernel_small
    s_add_u32 s12, s30, 0
    s_addc_u32 s13, s31, 0
    s_mov_b32 s14, 7340032
    s_mov_b32 s15, 0x00020000
    v_lshlrev_b32 v4, 4, v1
    s_lshl_b32 s27, s24, 4
    s_add_u32 s27, s27, s23
    s_mul_i32 s27, s27, 57344
    s_lshl_b32 s28, s22, 11
    s_add_u32 s27, s27, s28
    s_lshl_b32 s28, s21, 10
    s_add_u32 s27, s27, s28
    s_cmp_eq_u32 s21, 0
    s_mov_b32 s32, 0x07060302
    s_cselect_b32 s32, 0x05040100, s32
    s_mov_b32 s33, 0x03020c0c
    s_cselect_b32 s33, 0x01000c0c, s33
    s_mov_b32 s35, 0x3d2aaaab
    s_mov_b32 s36, 0x3c638e39
    s_waitcnt vmcnt(24)
    v_perm_b32 v72, v17, v16, s32
    v_perm_b32 v48, v41, v40, s32
    v_perm_b32 v76, v76, v40, s33
    v_perm_b32 v84, v84, v41, s33
    v_perm_b32 v77, v77, v32, s33
    v_perm_b32 v85, v85, v33, s33
    v_perm_b32 v78, v78, v24, s33
    v_perm_b32 v86, v86, v25, s33
    v_perm_b32 v79, v79, v16, s33
    v_perm_b32 v87, v87, v17, s33
    v_add_f32 v80, v76, v78
    v_add_f32 v88, v84, v86
    v_add_f32 v81, v77, v79
    v_add_f32 v89, v85, v87
    v_fma_f32 v82, v78, 4.0, v76
    v_fma_f32 v90, v86, 4.0, v84
    v_fma_f32 v83, v79, 4.0, v77
    v_fma_f32 v91, v87, 4.0, v85
    v_add_f32 v77, v80, v81
    v_add_f32 v85, v88, v89
    v_sub_f32 v78, v80, v81
    v_sub_f32 v86, v88, v89
    v_fma_f32 v79, v83, 2.0, v82
    v_fma_f32 v87, v91, 2.0, v90
    v_fma_f32 v82, v83, -2.0, v82
    v_fma_f32 v90, v91, -2.0, v90
    v_fmamk_f32 v80, v76, 0x41700000, v82
    v_fmamk_f32 v88, v84, 0x41700000, v90
    v_fmamk_f32 v80, v81, 0x41200000, v80
    v_fmamk_f32 v88, v89, 0x41200000, v88
    v_mul_f32 v77, 0.5, v77
    v_mul_f32 v85, 0.5, v85
    v_mul_f32 v78, 0.5, v78
    v_mul_f32 v86, 0.5, v86
    v_mul_f32 v79, s35, v79
    v_mul_f32 v87, s35, v87
    v_mul_f32 v82, s35, v82
    v_mul_f32 v90, s35, v90
    v_mul_f32 v80, s36, v80
    v_mul_f32 v88, s36, v88
    v_cvt_pk_bf16_f32 v52, v77, v85
    v_cvt_pk_bf16_f32 v56, v78, v86
    v_cvt_pk_bf16_f32 v60, v79, v87
    v_cvt_pk_bf16_f32 v64, v82, v90
    v_cvt_pk_bf16_f32 v68, v80, v88
    s_waitcnt vmcnt(16)
    v_perm_b32 v73, v19, v18, s32
    v_perm_b32 v49, v43, v42, s32
    v_perm_b32 v76, v76, v42, s33
    v_perm_b32 v84, v84, v43, s33
    v_perm_b32 v77, v77, v34, s33
    v_perm_b32 v85, v85, v35, s33
    v_perm_b32 v78, v78, v26, s33
    v_perm_b32 v86, v86, v27, s33
    v_perm_b32 v79, v79, v18, s33
    v_perm_b32 v87, v87, v19, s33
    v_add_f32 v80, v76, v78
    v_add_f32 v88, v84, v86
    v_add_f32 v81, v77, v79
    v_add_f32 v89, v85, v87
    v_fma_f32 v82, v78, 4.0, v76
    v_fma_f32 v90, v86, 4.0, v84
    v_fma_f32 v83, v79, 4.0, v77
    v_fma_f32 v91, v87, 4.0, v85
    v_add_f32 v77, v80, v81
    v_add_f32 v85, v88, v89
    v_sub_f32 v78, v80, v81
    v_sub_f32 v86, v88, v89
    v_fma_f32 v79, v83, 2.0, v82
    v_fma_f32 v87, v91, 2.0, v90
    v_fma_f32 v82, v83, -2.0, v82
    v_fma_f32 v90, v91, -2.0, v90
    v_fmamk_f32 v80, v76, 0x41700000, v82
    v_fmamk_f32 v88, v84, 0x41700000, v90
    v_fmamk_f32 v80, v81, 0x41200000, v80
    v_fmamk_f32 v88, v89, 0x41200000, v88
    v_mul_f32 v77, 0.5, v77
    v_mul_f32 v85, 0.5, v85
    v_mul_f32 v78, 0.5, v78
    v_mul_f32 v86, 0.5, v86
    v_mul_f32 v79, s35, v79
    v_mul_f32 v87, s35, v87
    v_mul_f32 v82, s35, v82
    v_mul_f32 v90, s35, v90
    v_mul_f32 v80, s36, v80
    v_mul_f32 v88, s36, v88
    v_cvt_pk_bf16_f32 v53, v77, v85
    v_cvt_pk_bf16_f32 v57, v78, v86
    v_cvt_pk_bf16_f32 v61, v79, v87
    v_cvt_pk_bf16_f32 v65, v82, v90
    v_cvt_pk_bf16_f32 v69, v80, v88
    s_waitcnt vmcnt(8)
    v_perm_b32 v74, v21, v20, s32
    v_perm_b32 v50, v45, v44, s32
    v_perm_b32 v76, v76, v44, s33
    v_perm_b32 v84, v84, v45, s33
    v_perm_b32 v77, v77, v36, s33
    v_perm_b32 v85, v85, v37, s33
    v_perm_b32 v78, v78, v28, s33
    v_perm_b32 v86, v86, v29, s33
    v_perm_b32 v79, v79, v20, s33
    v_perm_b32 v87, v87, v21, s33
    v_add_f32 v80, v76, v78
    v_add_f32 v88, v84, v86
    v_add_f32 v81, v77, v79
    v_add_f32 v89, v85, v87
    v_fma_f32 v82, v78, 4.0, v76
    v_fma_f32 v90, v86, 4.0, v84
    v_fma_f32 v83, v79, 4.0, v77
    v_fma_f32 v91, v87, 4.0, v85
    v_add_f32 v77, v80, v81
    v_add_f32 v85, v88, v89
    v_sub_f32 v78, v80, v81
    v_sub_f32 v86, v88, v89
    v_fma_f32 v79, v83, 2.0, v82
    v_fma_f32 v87, v91, 2.0, v90
    v_fma_f32 v82, v83, -2.0, v82
    v_fma_f32 v90, v91, -2.0, v90
    v_fmamk_f32 v80, v76, 0x41700000, v82
    v_fmamk_f32 v88, v84, 0x41700000, v90
    v_fmamk_f32 v80, v81, 0x41200000, v80
    v_fmamk_f32 v88, v89, 0x41200000, v88
    v_mul_f32 v77, 0.5, v77
    v_mul_f32 v85, 0.5, v85
    v_mul_f32 v78, 0.5, v78
    v_mul_f32 v86, 0.5, v86
    v_mul_f32 v79, s35, v79
    v_mul_f32 v87, s35, v87
    v_mul_f32 v82, s35, v82
    v_mul_f32 v90, s35, v90
    v_mul_f32 v80, s36, v80
    v_mul_f32 v88, s36, v88
    v_cvt_pk_bf16_f32 v54, v77, v85
    v_cvt_pk_bf16_f32 v58, v78, v86
    v_cvt_pk_bf16_f32 v62, v79, v87
    v_cvt_pk_bf16_f32 v66, v82, v90
    v_cvt_pk_bf16_f32 v70, v80, v88
    s_waitcnt vmcnt(0)
    s_cmp_ge_u32 s3, 44
    s_cbranch_scc1 L_prep_kernel_ncw
    s_getpc_b64 s[62:63]
L_prep_kernel_pc:
    s_and_b32 s64, s3, 8
    s_lshl_b32 s64, s64, 12
    v_lshlrev_b32 v120, 7, v0
    v_add_u32 v120, s64, v120
    v_min_u32 v120, L_joint_kernel_done-L_prep_kernel_pc, v120
    v_mov_b32 v121, s63
    v_add_co_u32 v120, vcc, s62, v120
    s_nop 1
    v_addc_co_u32 v121, vcc, 0, v121, vcc
    global_load_dword v122, v[120:121], off
L_prep_kernel_ncw:
    v_perm_b32 v75, v23, v22, s32
    v_perm_b32 v51, v47, v46, s32
    v_perm_b32 v76, v76, v46, s33
    v_perm_b32 v84, v84, v47, s33
    v_perm_b32 v77, v77, v38, s33
    v_perm_b32 v85, v85, v39, s33
    v_perm_b32 v78, v78, v30, s33
    v_perm_b32 v86, v86, v31, s33
    v_perm_b32 v79, v79, v22, s33
    v_perm_b32 v87, v87, v23, s33
    v_add_f32 v80, v76, v78
    v_add_f32 v88, v84, v86
    v_add_f32 v81, v77, v79
    v_add_f32 v89, v85, v87
    v_fma_f32 v82, v78, 4.0, v76
    v_fma_f32 v90, v86, 4.0, v84
    v_fma_f32 v83, v79, 4.0, v77
    v_fma_f32 v91, v87, 4.0, v85
    v_add_f32 v77, v80, v81
    v_add_f32 v85, v88, v89
    v_sub_f32 v78, v80, v81
    v_sub_f32 v86, v88, v89
    v_fma_f32 v79, v83, 2.0, v82
    v_fma_f32 v87, v91, 2.0, v90
    v_fma_f32 v82, v83, -2.0, v82
    v_fma_f32 v90, v91, -2.0, v90
    v_fmamk_f32 v80, v76, 0x41700000, v82
    v_fmamk_f32 v88, v84, 0x41700000, v90
    v_fmamk_f32 v80, v81, 0x41200000, v80
    v_fmamk_f32 v88, v89, 0x41200000, v88
    v_mul_f32 v77, 0.5, v77
    v_mul_f32 v85, 0.5, v85
    v_mul_f32 v78, 0.5, v78
    v_mul_f32 v86, 0.5, v86
    v_mul_f32 v79, s35, v79
    v_mul_f32 v87, s35, v87
    v_mul_f32 v82, s35, v82
    v_mul_f32 v90, s35, v90
    v_mul_f32 v80, s36, v80
    v_mul_f32 v88, s36, v88
    v_cvt_pk_bf16_f32 v55, v77, v85
    v_cvt_pk_bf16_f32 v59, v78, v86
    v_cvt_pk_bf16_f32 v63, v79, v87
    v_cvt_pk_bf16_f32 v67, v82, v90
    v_cvt_pk_bf16_f32 v71, v80, v88
    s_add_u32 s28, s27, 49152
    buffer_store_dwordx4 v[72:75], v4, s[12:15], s28 offen sc1
    s_add_u32 s28, s27, 0
    buffer_store_dwordx4 v[48:51], v4, s[12:15], s28 offen sc1
    s_add_u32 s28, s27, 8192
    buffer_store_dwordx4 v[52:55], v4, s[12:15], s28 offen sc1
    s_add_u32 s28, s27, 16384
    buffer_store_dwordx4 v[56:59], v4, s[12:15], s28 offen sc1
    s_add_u32 s28, s27, 24576
    buffer_store_dwordx4 v[60:63], v4, s[12:15], s28 offen sc1
    s_add_u32 s28, s27, 32768
    buffer_store_dwordx4 v[64:67], v4, s[12:15], s28 offen sc1
    s_add_u32 s28, s27, 40960
    buffer_store_dwordx4 v[68:71], v4, s[12:15], s28 offen sc1
L_prep_kernel_done:
    s_endpgm
L_prep_kernel_small:
    s_mov_b32 s16, s50
    s_mov_b32 s17, s51
    s_mov_b32 s18, 8192
    s_mov_b32 s19, 0x00020000
    v_lshrrev_b32 v2, 4, v1
    v_lshlrev_b32 v6, 9, v3
    v_lshl_add_u32 v6, v2, 4, v6
    s_lshl_b32 s24, s43, 8
    s_cmp_eq_u32 s41, 2
    s_cselect_b32 s24, s24, 0x100000
    buffer_load_dwordx4 v[80:83], v6, s[16:19], s24 offen offset:0
    buffer_load_dwordx4 v[84:87], v6, s[16:19], s24 offen offset:64
    buffer_load_dwordx4 v[88:91], v6, s[16:19], s24 offen offset:128
    buffer_load_dwordx4 v[92:95], v6, s[16:19], s24 offen offset:192
    s_lshl_b32 s24, s41, 17
    s_add_u32 s24, s24, 44040192
    s_add_u32 s12, s30, s24
    s_addc_u32 s13, s31, 0
    s_mov_b32 s14, 131072
    s_mov_b32 s15, 0x00020000
    s_mov_b32 s32, 0x05040100
    s_mov_b32 s33, 0x07060302
    v_lshlrev_b32 v4, 4, v1
    s_lshl_b32 s24, s42, 14
    s_lshl_b32 s25, s43, 13
    s_add_u32 s24, s24, s25
    s_add_u32 s25, s24, 4096
    s_waitcnt vmcnt(4)
    v_perm_b32 v48, v17, v16, s32
    v_perm_b32 v49, v19, v18, s32
    v_perm_b32 v50, v21, v20, s32
    v_perm_b32 v51, v23, v22, s32
    v_perm_b32 v52, v17, v16, s33
    v_perm_b32 v53, v19, v18, s33
    v_perm_b32 v54, v21, v20, s33
    v_perm_b32 v55, v23, v22, s33
    v_perm_b32 v56, v25, v24, s32
    v_perm_b32 v57, v27, v26, s32
    v_perm_b32 v58, v29, v28, s32
    v_perm_b32 v59, v31, v30, s32
    v_perm_b32 v60, v25, v24, s33
    v_perm_b32 v61, v27, v26, s33
    v_perm_b32 v62, v29, v28, s33
    v_perm_b32 v63, v31, v30, s33
    v_perm_b32 v64, v33, v32, s32
    v_perm_b32 v65, v35, v34, s32
    v_perm_b32 v66, v37, v36, s32
    v_perm_b32 v67, v39, v38, s32
    v_perm_b32 v68, v33, v32, s33
    v_perm_b32 v69, v35, v34, s33
    v_perm_b32 v70, v37, v36, s33
    v_perm_b32 v71, v39, v38, s33
    v_perm_b32 v72, v41, v40, s32
    v_perm_b32 v73, v43, v42, s32
    v_perm_b32 v74, v45, v44, s32
    v_perm_b32 v75, v47, v46, s32
    v_perm_b32 v76, v41, v40, s33
    v_perm_b32 v77, v43, v42, s33
    v_perm_b32 v78, v45, v44, s33
    v_perm_b32 v79, v47, v46, s33
    s_cmp_eq_u32 s41, 2
    s_cbranch_scc1 L_prep_kernel_ge
    buffer_store_dwordx4 v[48:51], v4, s[12:15], s24 offen offset:0 sc1
    buffer_store_dwordx4 v[52:55], v4, s[12:15], s24 offen offset:1024 sc1
    buffer_store_dwordx4 v[56:59], v4, s[12:15], s24 offen offset:2048 sc1
    buffer_store_dwordx4 v[60:63], v4, s[12:15], s24 offen offset:3072 sc1
    buffer_store_dwordx4 v[64:67], v4, s[12:15], s25 offen offset:0 sc1
    buffer_store_dwordx4 v[68:71], v4, s[12:15], s25 offen offset:1024 sc1
    buffer_store_dwordx4 v[72:75], v4, s[12:15], s25 offen offset:2048 sc1
    buffer_store_dwordx4 v[76:79], v4, s[12:15], s25 offen offset:3072 sc1
    s_endpgm
L_prep_kernel_ge:
    s_waitcnt vmcnt(0)
    v_mfma_f32_16x16x32_bf16 v[96:99], v[48:51], v[80:83], 0
    v_mfma_f32_16x16x32_bf16 v[100:103], v[52:55], v[80:83], 0
    v_mfma_f32_16x16x32_bf16 v[96:99], v[56:59], v[84:87], v[96:99]
    v_mfma_f32_16x16x32_bf16 v[100:103], v[60:63], v[84:87], v[100:103]
    v_mfma_f32_16x16x32_bf16 v[96:99], v[64:67], v[88:91], v[96:99]
    v_mfma_f32_16x16x32_bf16 v[100:103], v[68:71], v[88:91], v[100:103]
    v_mfma_f32_16x16x32_bf16 v[96:99], v[72:75], v[92:95], v[96:99]
    v_mfma_f32_16x16x32_bf16 v[100:103], v[76:79], v[92:95], v[100:103]
    s_and_b32 s24, s40, 1
    s_lshl_b32 s24, s24, 11
    v_add_u32 v7, s24, v4
    s_mov_b32 s14, 16384
    v_lshlrev_b32 v8, 10, v3
    v_lshl_add_u32 v8, v2, 5, v8
    s_lshl_b32 s24, s42, 7
    s_mov_b32 s34, 0xffff0000
    s_mov_b32 s35, 0x4038aa3b
    s_cmp_eq_u32 s43, 0
    s_cbranch_scc1 L_prep_kernel_ge0
    ds_write_b128 v7, v[96:99]
    ds_write_b128 v7, v[100:103] offset:1024
    s_waitcnt lgkmcnt(0)
    s_barrier
    s_endpgm
L_prep_kernel_ge0:
    s_barrier
    ds_read_b128 v[16:19], v7
    ds_read_b128 v[20:23], v7 offset:1024
    s_waitcnt lgkmcnt(0)
    v_add_f32 v16, v16, v96
    v_add_f32 v17, v17, v97
    v_add_f32 v18, v18, v98
    v_add_f32 v19, v19, v99
    v_add_f32 v20, v20, v100
    v_add_f32 v21, v21, v101
    v_add_f32 v22, v22, v102
    v_add_f32 v23, v23, v103
    v_cvt_pk_bf16_f32 v48, v16, v20
    v_cvt_pk_bf16_f32 v49, v17, v21
    v_cvt_pk_bf16_f32 v50, v18, v22
    v_cvt_pk_bf16_f32 v51, v19, v23
    v_lshlrev_b32 v56, 16, v48
    v_and_b32 v57, s34, v48
    v_lshlrev_b32 v58, 16, v49
    v_and_b32 v59, s34, v49
    v_lshlrev_b32 v60, 16, v50
    v_and_b32 v61, s34, v50
    v_lshlrev_b32 v62, 16, v51
    v_and_b32 v63, s34, v51
    v_mul_f32 v56, s35, v56
    v_mul_f32 v57, s35, v57
    v_mul_f32 v58, s35, v58
    v_mul_f32 v59, s35, v59
    v_mul_f32 v60, s35, v60
    v_mul_f32 v61, s35, v61
    v_mul_f32 v62, s35, v62
    v_mul_f32 v63, s35, v63
    buffer_store_dwordx4 v[56:59], v8, s[12:15], s24 offen sc1
    buffer_store_dwordx4 v[60:63], v8, s[12:15], s24 offen offset:16 sc1
    v_exp_f32 v64, v56
    v_exp_f32 v65, v57
    v_exp_f32 v66, v58
    v_exp_f32 v67, v59
    v_exp_f32 v68, v60
    v_exp_f32 v69, v61
    v_exp_f32 v70, v62
    v_exp_f32 v71, v63
    v_max3_f32 v72, |v56|, |v57|, |v58|
    v_max3_f32 v72, |v59|, |v60|, v72
    v_max3_f32 v72, |v61|, |v62|, v72
    v_max_f32 v72, |v63|, v72
    s_add_u32 s12, s12, 16384
    s_addc_u32 s13, s13, 0
    v_cmp_lt_f32 vcc, 0x42f00000, v72
    buffer_store_dwordx4 v[64:67], v8, s[12:15], s24 offen sc1
    buffer_store_dwordx4 v[68:71], v8, s[12:15], s24 offen offset:16 sc1
    s_add_u32 s12, s12, 16384
    s_addc_u32 s13, s13, 0
    s_or_b32 s26, vcc_lo, vcc_hi
    s_lshl_b32 s24, s42, 2
    v_mov_b32 v73, s26
    v_mov_b32 v74, 0
    buffer_store_dword v73, v74, s[12:15], s24 offen sc1
    s_endpgm
.globl conv1_kernel
.p2align 8
.type conv1_kernel,@function
conv1_kernel:
    s_cmp_ge_u32 s2, 256
    s_cbranch_scc1 L_conv1_kernel_done
    s_load_dwordx2 s[4:5], s[0:1], 0
    s_load_dwordx2 s[30:31], s[0:1], 72
    v_readfirstlane_b32 s20, v0
    s_lshr_b32 s20, s20, 6
    s_xor_b32 s20, s20, 8
    s_and_b32 s36, s2, 0
    s_lshl_b32 s36, s36, 3
    s_bfe_u32 s37, s2, 196611
    s_or_b32 s29, s36, s37
    s_bfe_u32 s36, s2, 196608
    s_lshl_b32 s36, s36, 2
    s_lshr_b32 s37, s2, 6
    s_or_b32 s36, s36, s37
    s_mov_b32 s33, 0
    s_and_b32 s34, s36, 15
    s_lshr_b32 s35, s36, 4
    s_mul_i32 s21, s34, 500
    s_and_b32 s32, s20, 3
    v_and_b32 v127, 63, v0
    v_lshrrev_b32 v5, 2, v127
    v_and_b32 v6, 3, v127
    s_and_b32 s42, s20, 7
    v_lshlrev_b32 v7, 15, v5
    v_lshl_add_u32 v7, v6, 4, v7
    s_lshl_b32 s41, s21, 10
    s_sub_u32 s41, s41, 7680
    s_lshl_b32 s37, s42, 12
    s_add_u32 s37, s37, s41
    v_add_u32 v7, s37, v7
    s_mul_i32 s36, s35, 8192000
    s_mov_b32 s10, 8192000
    s_mov_b32 s11, 0x00020000
    s_mov_b32 s25, 0xffff0000
    s_mov_b32 s47, s36
    s_cmp_ge_u32 s20, 8
    s_cbranch_scc1 L_conv1_kernel_helper
    s_add_u32 s37, s41, 524288
    v_lshl_add_u32 v108, v127, 4, s37
    v_add_u32 v109, 1024, v108
    v_add_u32 v110, 2048, v108
    s_waitcnt lgkmcnt(0)
    s_add_u32 s8, s4, s47
    s_addc_u32 s9, s5, 0
    s_lshl_b32 s36, s29, 4
    s_lshl_b32 s37, s33, 3
    s_add_u32 s36, s36, s37
    s_mul_i32 s36, s36, 57344
    s_add_u32 s36, s36, 0
    s_add_u32 s12, s30, s36
    s_addc_u32 s13, s31, 0
    s_mov_b32 s14, 917504
    s_mov_b32 s15, 0x00020000
    s_mul_i32 s36, s35, 4194304
    s_add_u32 s36, s36, 18874368
    s_add_u32 s16, s30, s36
    s_addc_u32 s17, s31, 0
    s_mov_b32 s18, 4194304
    s_mov_b32 s19, 0x00020000
    v_and_b32 v10, 15, v127
    v_lshrrev_b32 v11, 4, v127
    v_add_u32 v8, 0, v10
    v_and_b32 v16, 4, v8
    v_lshrrev_b32 v16, 1, v16
    v_xor_b32 v16, v11, v16
    v_lshlrev_b32 v16, 4, v16
    v_lshl_add_u32 v8, v8, 6, v16
    v_add_u32 v9, 1, v10
    v_and_b32 v16, 4, v9
    v_lshrrev_b32 v16, 1, v16
    v_xor_b32 v16, v11, v16
    v_lshlrev_b32 v16, 4, v16
    v_lshl_add_u32 v9, v9, 6, v16
    s_lshr_b32 s38, s32, 1
    s_and_b32 s39, s32, 1
    s_add_u32 s40, s38, 4
    s_lshl_b32 s43, s39, 10
    s_cmp_lt_u32 s20, 4
    s_cselect_b32 s40, s20, s40
    s_cselect_b32 s36, 0, s43
    s_lshl_b32 s37, s40, 13
    s_add_u32 s37, s37, s36
    v_lshl_add_u32 v125, v127, 4, s37
    s_mul_i32 s37, s40, 16384
    v_add_u32 v120, s37, v8
    v_add_u32 v121, s37, v9
    s_lshl_b32 s37, s40, 10
    s_add_u32 s37, s37, 115712
    v_lshl_add_u32 v16, v11, 4, s37
    v_cmp_eq_u32 vcc, 15, v10
    v_mov_b32 v17, 8192
    v_mov_b32 v18, 4294959104
    v_mov_b32 v19, 64
    v_cndmask_b32 v122, v121, v16, vcc
    v_cndmask_b32 v123, v17, v19, vcc
    v_cndmask_b32 v124, v18, v19, vcc
    v_lshl_add_u32 v126, v127, 4, s37
    s_mov_b32 s44, 0x3f800000
    s_mov_b32 s45, 0x00000000
    s_mov_b32 s46, 0x00000000
    s_cmp_eq_u32 s40, 1
    s_cselect_b32 s45, 0x3f800000, s45
    s_cselect_b32 s46, 0x3f800000, s46
    s_cmp_eq_u32 s40, 2
    s_cselect_b32 s45, 0xbf800000, s45
    s_cselect_b32 s46, 0x3f800000, s46
    s_cmp_eq_u32 s40, 3
    s_cselect_b32 s45, 0x40000000, s45
    s_cselect_b32 s46, 0x40800000, s46
    s_cmp_eq_u32 s40, 4
    s_cselect_b32 s45, 0xc0000000, s45
    s_cselect_b32 s46, 0x40800000, s46
    s_cmp_eq_u32 s40, 5
    s_cselect_b32 s44, 0x41800000, s44
    s_cselect_b32 s45, 0x41000000, s45
    s_cselect_b32 s46, 0x40800000, s46
    s_cmp_ge_u32 s20, 4
    s_cbranch_scc1 L_conv1_kernel_m2
    v_mov_b32 v0, 0
    v_mov_b32 v1, 0
    v_mov_b32 v2, 0
    v_mov_b32 v3, 0
    v_mov_b32 v4, 0
    v_mov_b32 v5, 0
    v_mov_b32 v6, 0
    v_mov_b32 v7, 0
    v_mov_b32 v8, 0
    v_mov_b32 v9, 0
    v_mov_b32 v10, 0
    v_mov_b32 v11, 0
    v_mov_b32 v12, 0
    v_mov_b32 v13, 0
    v_mov_b32 v14, 0
    v_mov_b32 v15, 0
    v_mov_b32 v16, 0
    v_mov_b32 v17, 0
    v_mov_b32 v18, 0
    v_mov_b32 v19, 0
    v_mov_b32 v20, 0
    v_mov_b32 v21, 0
    v_mov_b32 v22, 0
    v_mov_b32 v23, 0
    v_mov_b32 v24, 0
    v_mov_b32 v25, 0
    v_mov_b32 v26, 0
    v_mov_b32 v27, 0
    v_mov_b32 v28, 0
    v_mov_b32 v29, 0
    v_mov_b32 v30, 0
    v_mov_b32 v31, 0
    v_mov_b32 v32, 0
    v_mov_b32 v33, 0
    v_mov_b32 v34, 0
    v_mov_b32 v35, 0
    v_mov_b32 v36, 0
    v_mov_b32 v37, 0
    v_mov_b32 v38, 0
    v_mov_b32 v39, 0
    v_mov_b32 v40, 0
    v_mov_b32 v41, 0
    v_mov_b32 v42, 0
    v_mov_b32 v43, 0
    v_mov_b32 v44, 0
    v_mov_b32 v45, 0
    v_mov_b32 v46, 0
    v_mov_b32 v47, 0
    v_mov_b32 v48, 0
    v_mov_b32 v49, 0
    v_mov_b32 v50, 0
    v_mov_b32 v51, 0
    v_mov_b32 v52, 0
    v_mov_b32 v53, 0
    v_mov_b32 v54, 0
    v_mov_b32 v55, 0
    v_mov_b32 v56, 0
    v_mov_b32 v57, 0
    v_mov_b32 v58, 0
    v_mov_b32 v59, 0
    v_mov_b32 v60, 0
    v_mov_b32 v61, 0
    v_mov_b32 v62, 0
    v_mov_b32 v63, 0
    buffer_load_dwordx4 v[96:99], v108, s[8:11], 0 offen
    buffer_load_dwordx4 v[100:103], v109, s[8:11], 0 offen
    buffer_load_dwordx4 v[104:107], v110, s[8:11], 0 offen
    s_mov_b32 s23, 0
    s_mov_b32 s26, 4096
    buffer_load_dwordx4 v[64:67], v125, s[12:15], s23 offen offset:0
    buffer_load_dwordx4 v[68:71], v125, s[12:15], s23 offen offset:1024
    buffer_load_dwordx4 v[72:75], v125, s[12:15], s23 offen offset:2048
    buffer_load_dwordx4 v[76:79], v125, s[12:15], s23 offen offset:3072
    buffer_load_dwordx4 v[80:83], v125, s[12:15], s26 offen offset:0
    buffer_load_dwordx4 v[84:87], v125, s[12:15], s26 offen offset:1024
    buffer_load_dwordx4 v[88:91], v125, s[12:15], s26 offen offset:2048
    buffer_load_dwordx4 v[92:95], v125, s[12:15], s26 offen offset:3072
    s_mov_b32 s23, 57344
    s_mov_b32 s26, 61440
    s_waitcnt vmcnt(8)
    v_lshlrev_b32 v108, 16, v96
    v_and_b32 v111, s25, v96
    v_lshlrev_b32 v109, 16, v100
    v_and_b32 v112, s25, v100
    v_lshlrev_b32 v110, 16, v104
    v_and_b32 v113, s25, v104
    v_mul_f32 v114, s44, v108
    v_mul_f32 v115, s44, v111
    v_fmac_f32 v114, s45, v109
    v_fmac_f32 v115, s45, v112
    v_fmac_f32 v114, s46, v110
    v_fmac_f32 v115, s46, v113
    v_cvt_pk_bf16_f32 v96, v114, v115
    v_lshlrev_b32 v108, 16, v97
    v_and_b32 v111, s25, v97
    v_lshlrev_b32 v109, 16, v101
    v_and_b32 v112, s25, v101
    v_lshlrev_b32 v110, 16, v105
    v_and_b32 v113, s25, v105
    v_mul_f32 v114, s44, v108
    v_mul_f32 v115, s44, v111
    v_fmac_f32 v114, s45, v109
    v_fmac_f32 v115, s45, v112
    v_fmac_f32 v114, s46, v110
    v_fmac_f32 v115, s46, v113
    v_cvt_pk_bf16_f32 v97, v114, v115
    v_lshlrev_b32 v108, 16, v98
    v_and_b32 v111, s25, v98
    v_lshlrev_b32 v109, 16, v102
    v_and_b32 v112, s25, v102
    v_lshlrev_b32 v110, 16, v106
    v_and_b32 v113, s25, v106
    v_mul_f32 v114, s44, v108
    v_mul_f32 v115, s44, v111
    v_fmac_f32 v114, s45, v109
    v_fmac_f32 v115, s45, v112
    v_fmac_f32 v114, s46, v110
    v_fmac_f32 v115, s46, v113
    v_cvt_pk_bf16_f32 v98, v114, v115
    v_lshlrev_b32 v108, 16, v99
    v_and_b32 v111, s25, v99
    v_lshlrev_b32 v109, 16, v103
    v_and_b32 v112, s25, v103
    v_lshlrev_b32 v110, 16, v107
    v_and_b32 v113, s25, v107
    v_mul_f32 v114, s44, v108
    v_mul_f32 v115, s44, v111
    v_fmac_f32 v114, s45, v109
    v_fmac_f32 v115, s45, v112
    v_fmac_f32 v114, s46, v110
    v_fmac_f32 v115, s46, v113
    v_cvt_pk_bf16_f32 v99, v114, v115
    ds_write_b128 v126, v[96:99]
    s_waitcnt lgkmcnt(0)
    s_barrier
    s_mov_b32 s22, 8
    s_setprio 2
L_conv1_kernel_mloop1:
    ds_read_b128 v[96:99], v120 offset:0
    ds_read_b128 v[100:103], v120 offset:1024
    ds_read_b128 v[104:107], v120 offset:2048
    ds_read_b128 v[108:111], v120 offset:3072
    ds_read_b128 v[112:115], v120 offset:4096
    ds_read_b128 v[116:119], v120 offset:5120
    s_waitcnt vmcnt(6) lgkmcnt(5)
    v_mfma_f32_16x16x32_bf16 v[0:3], v[64:67], v[96:99], v[0:3]
    v_mfma_f32_16x16x32_bf16 v[32:35], v[68:71], v[96:99], v[32:35]
    ds_read_b128 v[96:99], v120 offset:6144
    s_waitcnt vmcnt(4) lgkmcnt(5)
    v_mfma_f32_16x16x32_bf16 v[4:7], v[64:67], v[100:103], v[4:7]
    v_mfma_f32_16x16x32_bf16 v[36:39], v[68:71], v[100:103], v[36:39]
    v_mfma_f32_16x16x32_bf16 v[0:3], v[72:75], v[100:103], v[0:3]
    v_mfma_f32_16x16x32_bf16 v[32:35], v[76:79], v[100:103], v[32:35]
    ds_read_b128 v[100:103], v120 offset:7168
    s_waitcnt vmcnt(2) lgkmcnt(5)
    v_mfma_f32_16x16x32_bf16 v[8:11], v[64:67], v[104:107], v[8:11]
    v_mfma_f32_16x16x32_bf16 v[40:43], v[68:71], v[104:107], v[40:43]
    v_mfma_f32_16x16x32_bf16 v[4:7], v[72:75], v[104:107], v[4:7]
    v_mfma_f32_16x16x32_bf16 v[36:39], v[76:79], v[104:107], v[36:39]
    v_mfma_f32_16x16x32_bf16 v[0:3], v[80:83], v[104:107], v[0:3]
    v_mfma_f32_16x16x32_bf16 v[32:35], v[84:87], v[104:107], v[32:35]
    ds_read_b128 v[104:107], v122 offset:0
    v_add_u32 v122, v123, v122
    s_waitcnt vmcnt(0) lgkmcnt(5)
    v_mfma_f32_16x16x32_bf16 v[12:15], v[64:67], v[108:111], v[12:15]
    v_mfma_f32_16x16x32_bf16 v[44:47], v[68:71], v[108:111], v[44:47]
    v_mfma_f32_16x16x32_bf16 v[8:11], v[72:75], v[108:111], v[8:11]
    v_mfma_f32_16x16x32_bf16 v[40:43], v[76:79], v[108:111], v[40:43]
    v_mfma_f32_16x16x32_bf16 v[4:7], v[80:83], v[108:111], v[4:7]
    v_mfma_f32_16x16x32_bf16 v[36:39], v[84:87], v[108:111], v[36:39]
    v_mfma_f32_16x16x32_bf16 v[0:3], v[88:91], v[108:111], v[0:3]
    v_mfma_f32_16x16x32_bf16 v[32:35], v[92:95], v[108:111], v[32:35]
    ds_read_b128 v[108:111], v121 offset:1024
    s_waitcnt lgkmcnt(5)
    v_mfma_f32_16x16x32_bf16 v[16:19], v[64:67], v[112:115], v[16:19]
    v_mfma_f32_16x16x32_bf16 v[48:51], v[68:71], v[112:115], v[48:51]
    v_mfma_f32_16x16x32_bf16 v[12:15], v[72:75], v[112:115], v[12:15]
    v_mfma_f32_16x16x32_bf16 v[44:47], v[76:79], v[112:115], v[44:47]
    v_mfma_f32_16x16x32_bf16 v[8:11], v[80:83], v[112:115], v[8:11]
    v_mfma_f32_16x16x32_bf16 v[40:43], v[84:87], v[112:115], v[40:43]
    v_mfma_f32_16x16x32_bf16 v[4:7], v[88:91], v[112:115], v[4:7]
    v_mfma_f32_16x16x32_bf16 v[36:39], v[92:95], v[112:115], v[36:39]
    ds_read_b128 v[112:115], v121 offset:2048
    s_waitcnt lgkmcnt(5)
    v_mfma_f32_16x16x32_bf16 v[20:23], v[64:67], v[116:119], v[20:23]
    v_mfma_f32_16x16x32_bf16 v[52:55], v[68:71], v[116:119], v[52:55]
    v_mfma_f32_16x16x32_bf16 v[16:19], v[72:75], v[116:119], v[16:19]
    v_mfma_f32_16x16x32_bf16 v[48:51], v[76:79], v[116:119], v[48:51]
    v_mfma_f32_16x16x32_bf16 v[12:15], v[80:83], v[116:119], v[12:15]
    v_mfma_f32_16x16x32_bf16 v[44:47], v[84:87], v[116:119], v[44:47]
    v_mfma_f32_16x16x32_bf16 v[8:11], v[88:91], v[116:119], v[8:11]
    v_mfma_f32_16x16x32_bf16 v[40:43], v[92:95], v[116:119], v[40:43]
    s_waitcnt lgkmcnt(4)
    v_mfma_f32_16x16x32_bf16 v[24:27], v[64:67], v[96:99], v[24:27]
    v_mfma_f32_16x16x32_bf16 v[56:59], v[68:71], v[96:99], v[56:59]
    v_mfma_f32_16x16x32_bf16 v[20:23], v[72:75], v[96:99], v[20:23]
    v_mfma_f32_16x16x32_bf16 v[52:55], v[76:79], v[96:99], v[52:55]
    v_mfma_f32_16x16x32_bf16 v[16:19], v[80:83], v[96:99], v[16:19]
    v_mfma_f32_16x16x32_bf16 v[48:51], v[84:87], v[96:99], v[48:51]
    v_mfma_f32_16x16x32_bf16 v[12:15], v[88:91], v[96:99], v[12:15]
    v_mfma_f32_16x16x32_bf16 v[44:47], v[92:95], v[96:99], v[44:47]
    s_waitcnt lgkmcnt(3)
    v_mfma_f32_16x16x32_bf16 v[28:31], v[64:67], v[100:103], v[28:31]
    v_mfma_f32_16x16x32_bf16 v[60:63], v[68:71], v[100:103], v[60:63]
    v_mfma_f32_16x16x32_bf16 v[24:27], v[72:75], v[100:103], v[24:27]
    v_mfma_f32_16x16x32_bf16 v[56:59], v[76:79], v[100:103], v[56:59]
    v_mfma_f32_16x16x32_bf16 v[20:23], v[80:83], v[100:103], v[20:23]
    v_mfma_f32_16x16x32_bf16 v[52:55], v[84:87], v[100:103], v[52:55]
    v_mfma_f32_16x16x32_bf16 v[16:19], v[88:91], v[100:103], v[16:19]
    v_mfma_f32_16x16x32_bf16 v[48:51], v[92:95], v[100:103], v[48:51]
    buffer_load_dwordx4 v[64:67], v125, s[12:15], s23 offen offset:0
    buffer_load_dwordx4 v[68:71], v125, s[12:15], s23 offen offset:1024
    s_waitcnt lgkmcnt(2)
    v_mfma_f32_16x16x32_bf16 v[28:31], v[72:75], v[104:107], v[28:31]
    v_mfma_f32_16x16x32_bf16 v[60:63], v[76:79], v[104:107], v[60:63]
    v_mfma_f32_16x16x32_bf16 v[24:27], v[80:83], v[104:107], v[24:27]
    v_mfma_f32_16x16x32_bf16 v[56:59], v[84:87], v[104:107], v[56:59]
    v_mfma_f32_16x16x32_bf16 v[20:23], v[88:91], v[104:107], v[20:23]
    v_mfma_f32_16x16x32_bf16 v[52:55], v[92:95], v[104:107], v[52:55]
    buffer_load_dwordx4 v[72:75], v125, s[12:15], s23 offen offset:2048
    buffer_load_dwordx4 v[76:79], v125, s[12:15], s23 offen offset:3072
    s_waitcnt lgkmcnt(1)
    v_mfma_f32_16x16x32_bf16 v[28:31], v[80:83], v[108:111], v[28:31]
    v_mfma_f32_16x16x32_bf16 v[60:63], v[84:87], v[108:111], v[60:63]
    v_mfma_f32_16x16x32_bf16 v[24:27], v[88:91], v[108:111], v[24:27]
    v_mfma_f32_16x16x32_bf16 v[56:59], v[92:95], v[108:111], v[56:59]
    buffer_load_dwordx4 v[80:83], v125, s[12:15], s26 offen offset:0
    buffer_load_dwordx4 v[84:87], v125, s[12:15], s26 offen offset:1024
    s_waitcnt lgkmcnt(0)
    v_mfma_f32_16x16x32_bf16 v[28:31], v[88:91], v[112:115], v[28:31]
    v_mfma_f32_16x16x32_bf16 v[60:63], v[92:95], v[112:115], v[60:63]
    buffer_load_dwordx4 v[88:91], v125, s[12:15], s26 offen offset:2048
    buffer_load_dwordx4 v[92:95], v125, s[12:15], s26 offen offset:3072
    s_add_u32 s23, s23, 57344
    s_add_u32 s26, s26, 57344
    s_barrier
    s_sub_u32 s22, s22, 1
    s_cmp_eq_u32 s22, 0
    s_cbranch_scc1 L_conv1_kernel_mlast1
    ds_read_b128 v[96:99], v120 offset:8192
    ds_read_b128 v[100:103], v120 offset:9216
    ds_read_b128 v[104:107], v120 offset:10240
    ds_read_b128 v[108:111], v120 offset:11264
    ds_read_b128 v[112:115], v120 offset:12288
    ds_read_b128 v[116:119], v120 offset:13312
    s_waitcnt vmcnt(6) lgkmcnt(5)
    v_mfma_f32_16x16x32_bf16 v[0:3], v[64:67], v[96:99], v[0:3]
    v_mfma_f32_16x16x32_bf16 v[32:35], v[68:71], v[96:99], v[32:35]
    ds_read_b128 v[96:99], v120 offset:14336
    s_waitcnt vmcnt(4) lgkmcnt(5)
    v_mfma_f32_16x16x32_bf16 v[4:7], v[64:67], v[100:103], v[4:7]
    v_mfma_f32_16x16x32_bf16 v[36:39], v[68:71], v[100:103], v[36:39]
    v_mfma_f32_16x16x32_bf16 v[0:3], v[72:75], v[100:103], v[0:3]
    v_mfma_f32_16x16x32_bf16 v[32:35], v[76:79], v[100:103], v[32:35]
    ds_read_b128 v[100:103], v120 offset:15360
    s_waitcnt vmcnt(2) lgkmcnt(5)
    v_mfma_f32_16x16x32_bf16 v[8:11], v[64:67], v[104:107], v[8:11]
    v_mfma_f32_16x16x32_bf16 v[40:43], v[68:71], v[104:107], v[40:43]
    v_mfma_f32_16x16x32_bf16 v[4:7], v[72:75], v[104:107], v[4:7]
    v_mfma_f32_16x16x32_bf16 v[36:39], v[76:79], v[104:107], v[36:39]
    v_mfma_f32_16x16x32_bf16 v[0:3], v[80:83], v[104:107], v[0:3]
    v_mfma_f32_16x16x32_bf16 v[32:35], v[84:87], v[104:107], v[32:35]
    ds_read_b128 v[104:107], v122 offset:0
    v_add_u32 v122, v124, v122
    s_waitcnt vmcnt(0) lgkmcnt(5)
    v_mfma_f32_16x16x32_bf16 v[12:15], v[64:67], v[108:111], v[12:15]
    v_mfma_f32_16x16x32_bf16 v[44:47], v[68:71], v[108:111], v[44:47]
    v_mfma_f32_16x16x32_bf16 v[8:11], v[72:75], v[108:111], v[8:11]
    v_mfma_f32_16x16x32_bf16 v[40:43], v[76:79], v[108:111], v[40:43]
    v_mfma_f32_16x16x32_bf16 v[4:7], v[80:83], v[108:111], v[4:7]
    v_mfma_f32_16x16x32_bf16 v[36:39], v[84:87], v[108:111], v[36:39]
    v_mfma_f32_16x16x32_bf16 v[0:3], v[88:91], v[108:111], v[0:3]
    v_mfma_f32_16x16x32_bf16 v[32:35], v[92:95], v[108:111], v[32:35]
    ds_read_b128 v[108:111], v121 offset:9216
    s_waitcnt lgkmcnt(5)
    v_mfma_f32_16x16x32_bf16 v[16:19], v[64:67], v[112:115], v[16:19]
    v_mfma_f32_16x16x32_bf16 v[48:51], v[68:71], v[112:115], v[48:51]
    v_mfma_f32_16x16x32_bf16 v[12:15], v[72:75], v[112:115], v[12:15]
    v_mfma_f32_16x16x32_bf16 v[44:47], v[76:79], v[112:115], v[44:47]
    v_mfma_f32_16x16x32_bf16 v[8:11], v[80:83], v[112:115], v[8:11]
    v_mfma_f32_16x16x32_bf16 v[40:43], v[84:87], v[112:115], v[40:43]
    v_mfma_f32_16x16x32_bf16 v[4:7], v[88:91], v[112:115], v[4:7]
    v_mfma_f32_16x16x32_bf16 v[36:39], v[92:95], v[112:115], v[36:39]
    ds_read_b128 v[112:115], v121 offset:10240
    s_waitcnt lgkmcnt(5)
    v_mfma_f32_16x16x32_bf16 v[20:23], v[64:67], v[116:119], v[20:23]
    v_mfma_f32_16x16x32_bf16 v[52:55], v[68:71], v[116:119], v[52:55]
    v_mfma_f32_16x16x32_bf16 v[16:19], v[72:75], v[116:119], v[16:19]
    v_mfma_f32_16x16x32_bf16 v[48:51], v[76:79], v[116:119], v[48:51]
    v_mfma_f32_16x16x32_bf16 v[12:15], v[80:83], v[116:119], v[12:15]
    v_mfma_f32_16x16x32_bf16 v[44:47], v[84:87], v[116:119], v[44:47]
    v_mfma_f32_16x16x32_bf16 v[8:11], v[88:91], v[116:119], v[8:11]
    v_mfma_f32_16x16x32_bf16 v[40:43], v[92:95], v[116:119], v[40:43]
    s_waitcnt lgkmcnt(4)
    v_mfma_f32_16x16x32_bf16 v[24:27], v[64:67], v[96:99], v[24:27]
    v_mfma_f32_16x16x32_bf16 v[56:59], v[68:71], v[96:99], v[56:59]
    v_mfma_f32_16x16x32_bf16 v[20:23], v[72:75], v[96:99], v[20:23]
    v_mfma_f32_16x16x32_bf16 v[52:55], v[76:79], v[96:99], v[52:55]
    v_mfma_f32_16x16x32_bf16 v[16:19], v[80:83], v[96:99], v[16:19]
    v_mfma_f32_16x16x32_bf16 v[48:51], v[84:87], v[96:99], v[48:51]
    v_mfma_f32_16x16x32_bf16 v[12:15], v[88:91], v[96:99], v[12:15]
    v_mfma_f32_16x16x32_bf16 v[44:47], v[92:95], v[96:99], v[44:47]
    s_waitcnt lgkmcnt(3)
    v_mfma_f32_16x16x32_bf16 v[28:31], v[64:67], v[100:103], v[28:31]
    v_mfma_f32_16x16x32_bf16 v[60:63], v[68:71], v[100:103], v[60:63]
    v_mfma_f32_16x16x32_bf16 v[24:27], v[72:75], v[100:103], v[24:27]
    v_mfma_f32_16x16x32_bf16 v[56:59], v[76:79], v[100:103], v[56:59]
    v_mfma_f32_16x16x32_bf16 v[20:23], v[80:83], v[100:103], v[20:23]
    v_mfma_f32_16x16x32_bf16 v[52:55], v[84:87], v[100:103], v[52:55]
    v_mfma_f32_16x16x32_bf16 v[16:19], v[88:91], v[100:103], v[16:19]
    v_mfma_f32_16x16x32_bf16 v[48:51], v[92:95], v[100:103], v[48:51]
    buffer_load_dwordx4 v[64:67], v125, s[12:15], s23 offen offset:0
    buffer_load_dwordx4 v[68:71], v125, s[12:15], s23 offen offset:1024
    s_waitcnt lgkmcnt(2)
    v_mfma_f32_16x16x32_bf16 v[28:31], v[72:75], v[104:107], v[28:31]
    v_mfma_f32_16x16x32_bf16 v[60:63], v[76:79], v[104:107], v[60:63]
    v_mfma_f32_16x16x32_bf16 v[24:27], v[80:83], v[104:107], v[24:27]
    v_mfma_f32_16x16x32_bf16 v[56:59], v[84:87], v[104:107], v[56:59]
    v_mfma_f32_16x16x32_bf16 v[20:23], v[88:91], v[104:107], v[20:23]
    v_mfma_f32_16x16x32_bf16 v[52:55], v[92:95], v[104:107], v[52:55]
    buffer_load_dwordx4 v[72:75], v125, s[12:15], s23 offen offset:2048
    buffer_load_dwordx4 v[76:79], v125, s[12:15], s23 offen offset:3072
    s_waitcnt lgkmcnt(1)
    v_mfma_f32_16x16x32_bf16 v[28:31], v[80:83], v[108:111], v[28:31]
    v_mfma_f32_16x16x32_bf16 v[60:63], v[84:87], v[108:111], v[60:63]
    v_mfma_f32_16x16x32_bf16 v[24:27], v[88:91], v[108:111], v[24:27]
    v_mfma_f32_16x16x32_bf16 v[56:59], v[92:95], v[108:111], v[56:59]
    buffer_load_dwordx4 v[80:83], v125, s[12:15], s26 offen offset:0
    buffer_load_dwordx4 v[84:87], v125, s[12:15], s26 offen offset:1024
    s_waitcnt lgkmcnt(0)
    v_mfma_f32_16x16x32_bf16 v[28:31], v[88:91], v[112:115], v[28:31]
    v_mfma_f32_16x16x32_bf16 v[60:63], v[92:95], v[112:115], v[60:63]
    buffer_load_dwordx4 v[88:91], v125, s[12:15], s26 offen offset:2048
    buffer_load_dwordx4 v[92:95], v125, s[12:15], s26 offen offset:3072
    s_add_u32 s23, s23, 57344
    s_add_u32 s26, s26, 57344
    s_barrier
    s_branch L_conv1_kernel_mloop1
L_conv1_kernel_mlast1:
    v_and_b32 v125, 15, v127
    v_and_b32 v126, 7, v127
    v_lshlrev_b32 v126, 4, v126
    v_lshl_add_u32 v125, v125, 7, v126
    v_lshrrev_b32 v126, 4, v127
    v_lshl_add_u32 v125, v126, 11, v125
    s_lshl_b32 s36, s20, 14
    s_add_u32 s37, s36, 8192
    v_add_u32 v126, s37, v125
    v_add_u32 v125, s36, v125
    ds_read_b128 v[96:99], v120 offset:8192
    ds_read_b128 v[100:103], v120 offset:9216
    ds_read_b128 v[104:107], v120 offset:10240
    ds_read_b128 v[108:111], v120 offset:11264
    ds_read_b128 v[112:115], v120 offset:12288
    ds_read_b128 v[116:119], v120 offset:13312
    s_waitcnt vmcnt(6) lgkmcnt(5)
    v_mfma_f32_16x16x32_bf16 v[0:3], v[64:67], v[96:99], v[0:3]
    v_mfma_f32_16x16x32_bf16 v[32:35], v[68:71], v[96:99], v[32:35]
    ds_read_b128 v[96:99], v120 offset:14336
    s_waitcnt vmcnt(4) lgkmcnt(5)
    v_mfma_f32_16x16x32_bf16 v[4:7], v[64:67], v[100:103], v[4:7]
    v_mfma_f32_16x16x32_bf16 v[36:39], v[68:71], v[100:103], v[36:39]
    v_mfma_f32_16x16x32_bf16 v[0:3], v[72:75], v[100:103], v[0:3]
    v_mfma_f32_16x16x32_bf16 v[32:35], v[76:79], v[100:103], v[32:35]
    ds_read_b128 v[100:103], v120 offset:15360
    s_waitcnt vmcnt(2) lgkmcnt(5)
    v_mfma_f32_16x16x32_bf16 v[8:11], v[64:67], v[104:107], v[8:11]
    v_mfma_f32_16x16x32_bf16 v[40:43], v[68:71], v[104:107], v[40:43]
    v_mfma_f32_16x16x32_bf16 v[4:7], v[72:75], v[104:107], v[4:7]
    v_mfma_f32_16x16x32_bf16 v[36:39], v[76:79], v[104:107], v[36:39]
    v_mfma_f32_16x16x32_bf16 v[0:3], v[80:83], v[104:107], v[0:3]
    v_mfma_f32_16x16x32_bf16 v[32:35], v[84:87], v[104:107], v[32:35]
    ds_read_b128 v[104:107], v122 offset:0
    s_waitcnt vmcnt(0) lgkmcnt(5)
    v_mfma_f32_16x16x32_bf16 v[12:15], v[64:67], v[108:111], v[12:15]
    v_mfma_f32_16x16x32_bf16 v[44:47], v[68:71], v[108:111], v[44:47]
    v_mfma_f32_16x16x32_bf16 v[8:11], v[72:75], v[108:111], v[8:11]
    v_mfma_f32_16x16x32_bf16 v[40:43], v[76:79], v[108:111], v[40:43]
    v_mfma_f32_16x16x32_bf16 v[4:7], v[80:83], v[108:111], v[4:7]
    v_mfma_f32_16x16x32_bf16 v[36:39], v[84:87], v[108:111], v[36:39]
    v_mfma_f32_16x16x32_bf16 v[0:3], v[88:91], v[108:111], v[0:3]
    v_mfma_f32_16x16x32_bf16 v[32:35], v[92:95], v[108:111], v[32:35]
    ds_read_b128 v[108:111], v121 offset:9216
    s_waitcnt lgkmcnt(5)
    v_mfma_f32_16x16x32_bf16 v[16:19], v[64:67], v[112:115], v[16:19]
    v_mfma_f32_16x16x32_bf16 v[48:51], v[68:71], v[112:115], v[48:51]
    v_mfma_f32_16x16x32_bf16 v[12:15], v[72:75], v[112:115], v[12:15]
    v_mfma_f32_16x16x32_bf16 v[44:47], v[76:79], v[112:115], v[44:47]
    v_mfma_f32_16x16x32_bf16 v[8:11], v[80:83], v[112:115], v[8:11]
    v_mfma_f32_16x16x32_bf16 v[40:43], v[84:87], v[112:115], v[40:43]
    v_mfma_f32_16x16x32_bf16 v[4:7], v[88:91], v[112:115], v[4:7]
    v_mfma_f32_16x16x32_bf16 v[36:39], v[92:95], v[112:115], v[36:39]
    ds_read_b128 v[112:115], v121 offset:10240
    v_xor_b32 v123, 0, v125
    ds_write_b128 v123, v[0:3]
    s_waitcnt lgkmcnt(6)
    v_mfma_f32_16x16x32_bf16 v[20:23], v[64:67], v[116:119], v[20:23]
    v_mfma_f32_16x16x32_bf16 v[52:55], v[68:71], v[116:119], v[52:55]
    v_mfma_f32_16x16x32_bf16 v[16:19], v[72:75], v[116:119], v[16:19]
    v_mfma_f32_16x16x32_bf16 v[48:51], v[76:79], v[116:119], v[48:51]
    v_mfma_f32_16x16x32_bf16 v[12:15], v[80:83], v[116:119], v[12:15]
    v_mfma_f32_16x16x32_bf16 v[44:47], v[84:87], v[116:119], v[44:47]
    v_mfma_f32_16x16x32_bf16 v[8:11], v[88:91], v[116:119], v[8:11]
    v_mfma_f32_16x16x32_bf16 v[40:43], v[92:95], v[116:119], v[40:43]
    v_xor_b32 v124, 16, v125
    ds_write_b128 v124, v[4:7]
    s_waitcnt lgkmcnt(2)
    v_mfma_f32_16x16x32_bf16 v[24:27], v[64:67], v[96:99], v[24:27]
    v_mfma_f32_16x16x32_bf16 v[56:59], v[68:71], v[96:99], v[56:59]
    v_mfma_f32_16x16x32_bf16 v[20:23], v[72:75], v[96:99], v[20:23]
    v_mfma_f32_16x16x32_bf16 v[52:55], v[76:79], v[96:99], v[52:55]
    v_mfma_f32_16x16x32_bf16 v[16:19], v[80:83], v[96:99], v[16:19]
    v_mfma_f32_16x16x32_bf16 v[48:51], v[84:87], v[96:99], v[48:51]
    v_mfma_f32_16x16x32_bf16 v[12:15], v[88:91], v[96:99], v[12:15]
    v_mfma_f32_16x16x32_bf16 v[44:47], v[92:95], v[96:99], v[44:47]
    v_xor_b32 v123, 32, v125
    ds_write_b128 v123, v[8:11]
    v_xor_b32 v124, 0, v126
    ds_write_b128 v124, v[32:35]
    v_mfma_f32_16x16x32_bf16 v[28:31], v[64:67], v[100:103], v[28:31]
    v_mfma_f32_16x16x32_bf16 v[60:63], v[68:71], v[100:103], v[60:63]
    v_mfma_f32_16x16x32_bf16 v[24:27], v[72:75], v[100:103], v[24:27]
    v_mfma_f32_16x16x32_bf16 v[56:59], v[76:79], v[100:103], v[56:59]
    v_mfma_f32_16x16x32_bf16 v[20:23], v[80:83], v[100:103], v[20:23]
    v_mfma_f32_16x16x32_bf16 v[52:55], v[84:87], v[100:103], v[52:55]
    v_mfma_f32_16x16x32_bf16 v[16:19], v[88:91], v[100:103], v[16:19]
    v_mfma_f32_16x16x32_bf16 v[48:51], v[92:95], v[100:103], v[48:51]
    v_xor_b32 v123, 16, v126
    ds_write_b128 v123, v[36:39]
    v_xor_b32 v124, 32, v126
    ds_write_b128 v124, v[40:43]
    v_mfma_f32_16x16x32_bf16 v[28:31], v[72:75], v[104:107], v[28:31]
    v_mfma_f32_16x16x32_bf16 v[60:63], v[76:79], v[104:107], v[60:63]
    v_mfma_f32_16x16x32_bf16 v[24:27], v[80:83], v[104:107], v[24:27]
    v_mfma_f32_16x16x32_bf16 v[56:59], v[84:87], v[104:107], v[56:59]
    v_mfma_f32_16x16x32_bf16 v[20:23], v[88:91], v[104:107], v[20:23]
    v_mfma_f32_16x16x32_bf16 v[52:55], v[92:95], v[104:107], v[52:55]
    v_xor_b32 v124, 48, v125
    ds_write_b128 v124, v[12:15]
    v_xor_b32 v123, 48, v126
    ds_write_b128 v123, v[44:47]
    v_mfma_f32_16x16x32_bf16 v[28:31], v[80:83], v[108:111], v[28:31]
    v_mfma_f32_16x16x32_bf16 v[60:63], v[84:87], v[108:111], v[60:63]
    v_mfma_f32_16x16x32_bf16 v[24:27], v[88:91], v[108:111], v[24:27]
    v_mfma_f32_16x16x32_bf16 v[56:59], v[92:95], v[108:111], v[56:59]
    v_xor_b32 v123, 64, v125
    ds_write_b128 v123, v[16:19]
    v_xor_b32 v124, 64, v126
    ds_write_b128 v124, v[48:51]
    v_mfma_f32_16x16x32_bf16 v[28:31], v[88:91], v[112:115], v[28:31]
    v_mfma_f32_16x16x32_bf16 v[60:63], v[92:95], v[112:115], v[60:63]
    v_xor_b32 v124, 80, v125
    ds_write_b128 v124, v[20:23]
    v_xor_b32 v123, 80, v126
    ds_write_b128 v123, v[52:55]
    v_and_b32 v108, 15, v127
    v_lshrrev_b32 v109, 4, v127
    v_lshrrev_b32 v110, 3, v108
    s_lshl_b32 s36, s20, 1
    v_add_u32 v110, s36, v110
    v_xor_b32 v111, v110, v108
    v_and_b32 v111, 7, v111
    v_lshlrev_b32 v111, 4, v111
    v_xor_b32 v123, 96, v125
    ds_write_b128 v123, v[24:27]
    v_lshl_add_u32 v111, v110, 7, v111
    v_lshl_add_u32 v120, v109, 11, v111
    v_add_u32 v121, 65536, v120
    v_add_u32 v64, 131072, v120
    s_lshl_b32 s36, s20, 9
    s_add_u32 s36, s36, 115712
    v_lshl_add_u32 v127, v109, 7, s36
    s_lshl_b32 s36, s20, 4
    v_add_u32 v108, s36, v108
    v_lshlrev_b32 v110, 6, v108
    v_lshl_add_u32 v110, v109, 4, v110
    s_mul_i32 s36, s29, 524288
    v_xor_b32 v124, 96, v126
    ds_write_b128 v124, v[56:59]
    s_lshl_b32 s37, s21, 4
    s_add_u32 s36, s36, s37
    v_add_u32 v110, s36, v110
    v_mov_b32 v111, 2130706432
    v_cmp_gt_u32 vcc, 125, v108
    s_mov_b32 s4, 0xbeaaaaab
    s_mov_b32 s5, s4
    s_mov_b32 s6, 0x3e800000
    s_mov_b32 s7, s6
    s_mov_b32 s8, 0xc0a00000
    s_mov_b32 s9, s8
    s_mov_b32 s10, 0xc0638e39
    v_xor_b32 v124, 112, v125
    ds_write_b128 v124, v[28:31]
    s_mov_b32 s11, s10
    s_mov_b32 s12, 0xbf638e39
    s_mov_b32 s13, s12
    s_mov_b32 s14, 0xbe638e39
    s_mov_b32 s15, s14
    s_mov_b32 s22, 0xbd638e39
    s_mov_b32 s23, s22
    s_mov_b32 s24, 0x3ff1c71c
    s_mov_b32 s25, s24
    s_mov_b32 s26, 0xbf2aaaab
    s_mov_b32 s27, s26
    s_mov_b32 s32, 0x3ecccccd
    v_xor_b32 v123, 112, v126
    s_waitcnt lgkmcnt(8)
    ds_write_b128 v123, v[60:63]
    s_mov_b32 s33, s32
    s_mov_b32 s34, 0xbd888889
    s_mov_b32 s35, s34
    s_mov_b32 s38, 0xbe4ccccd
    s_mov_b32 s39, s38
    s_mov_b32 s40, 0xbdd2d3e8
    s_mov_b32 s41, s40
    s_mov_b32 s42, 0x3f800000
    s_mov_b32 s43, s42
    s_setprio 0
    s_branch L_conv1_kernel_epi
L_conv1_kernel_m2:
    s_mul_i32 s37, s38, 2176
    s_add_u32 s37, s37, 98304
    v_add_u32 v116, s37, v8
    v_add_u32 v118, s37, v9
    v_add_u32 v117, 104832, v8
    s_cmp_eq_u32 s38, 0
    s_cbranch_scc1 L_conv1_kernel_hh0
    v_add_u32 v117, 98304, v9
L_conv1_kernel_hh0:
    s_lshl_b32 s37, s38, 12
    s_add_u32 s37, s37, s43
    s_add_u32 s37, s37, 49152
    v_lshl_add_u32 v119, v127, 4, s37
    v_mov_b32 v0, 0
    v_mov_b32 v1, 0
    v_mov_b32 v2, 0
    v_mov_b32 v3, 0
    v_mov_b32 v4, 0
    v_mov_b32 v5, 0
    v_mov_b32 v6, 0
    v_mov_b32 v7, 0
    v_mov_b32 v8, 0
    v_mov_b32 v9, 0
    v_mov_b32 v10, 0
    v_mov_b32 v11, 0
    v_mov_b32 v12, 0
    v_mov_b32 v13, 0
    v_mov_b32 v14, 0
    v_mov_b32 v15, 0
    v_mov_b32 v16, 0
    v_mov_b32 v17, 0
    v_mov_b32 v18, 0
    v_mov_b32 v19, 0
    v_mov_b32 v20, 0
    v_mov_b32 v21, 0
    v_mov_b32 v22, 0
    v_mov_b32 v23, 0
    v_mov_b32 v24, 0
    v_mov_b32 v25, 0
    v_mov_b32 v26, 0
    v_mov_b32 v27, 0
    v_mov_b32 v28, 0
    v_mov_b32 v29, 0
    v_mov_b32 v30, 0
    v_mov_b32 v31, 0
    v_mov_b32 v32, 0
    v_mov_b32 v33, 0
    v_mov_b32 v34, 0
    v_mov_b32 v35, 0
    v_mov_b32 v36, 0
    v_mov_b32 v37, 0
    v_mov_b32 v38, 0
    v_mov_b32 v39, 0
    v_mov_b32 v40, 0
    v_mov_b32 v41, 0
    v_mov_b32 v42, 0
    v_mov_b32 v43, 0
    v_mov_b32 v44, 0
    v_mov_b32 v45, 0
    v_mov_b32 v46, 0
    v_mov_b32 v47, 0
    v_mov_b32 v48, 0
    v_mov_b32 v49, 0
    v_mov_b32 v50, 0
    v_mov_b32 v51, 0
    v_mov_b32 v52, 0
    v_mov_b32 v53, 0
    v_mov_b32 v54, 0
    v_mov_b32 v55, 0
    v_mov_b32 v56, 0
    v_mov_b32 v57, 0
    v_mov_b32 v58, 0
    v_mov_b32 v59, 0
    v_mov_b32 v60, 0
    v_mov_b32 v61, 0
    v_mov_b32 v62, 0
    v_mov_b32 v63, 0
    buffer_load_dwordx4 v[96:99], v108, s[8:11], 0 offen
    buffer_load_dwordx4 v[100:103], v109, s[8:11], 0 offen
    buffer_load_dwordx4 v[104:107], v110, s[8:11], 0 offen
    s_mov_b32 s23, 0
    s_mov_b32 s26, 4096
    buffer_load_dwordx4 v[64:67], v125, s[12:15], s23 offen offset:0
    buffer_load_dwordx4 v[68:71], v125, s[12:15], s23 offen offset:2048
    buffer_load_dwordx4 v[80:83], v119, s[12:15], s23 offen offset:0
    buffer_load_dwordx4 v[72:75], v125, s[12:15], s26 offen offset:0
    buffer_load_dwordx4 v[84:87], v119, s[12:15], s23 offen offset:2048
    buffer_load_dwordx4 v[76:79], v125, s[12:15], s26 offen offset:2048
    s_mov_b32 s23, 57344
    s_mov_b32 s26, 61440
    s_waitcnt vmcnt(6)
    v_lshlrev_b32 v108, 16, v96
    v_and_b32 v111, s25, v96
    v_lshlrev_b32 v109, 16, v100
    v_and_b32 v112, s25, v100
    v_lshlrev_b32 v110, 16, v104
    v_and_b32 v113, s25, v104
    v_mul_f32 v114, s44, v108
    v_mul_f32 v115, s44, v111
    v_fmac_f32 v114, s45, v109
    v_fmac_f32 v115, s45, v112
    v_fmac_f32 v114, s46, v110
    v_fmac_f32 v115, s46, v113
    v_cvt_pk_bf16_f32 v96, v114, v115
    v_lshlrev_b32 v108, 16, v97
    v_and_b32 v111, s25, v97
    v_lshlrev_b32 v109, 16, v101
    v_and_b32 v112, s25, v101
    v_lshlrev_b32 v110, 16, v105
    v_and_b32 v113, s25, v105
    v_mul_f32 v114, s44, v108
    v_mul_f32 v115, s44, v111
    v_fmac_f32 v114, s45, v109
    v_fmac_f32 v115, s45, v112
    v_fmac_f32 v114, s46, v110
    v_fmac_f32 v115, s46, v113
    v_cvt_pk_bf16_f32 v97, v114, v115
    v_lshlrev_b32 v108, 16, v98
    v_and_b32 v111, s25, v98
    v_lshlrev_b32 v109, 16, v102
    v_and_b32 v112, s25, v102
    v_lshlrev_b32 v110, 16, v106
    v_and_b32 v113, s25, v106
    v_mul_f32 v114, s44, v108
    v_mul_f32 v115, s44, v111
    v_fmac_f32 v114, s45, v109
    v_fmac_f32 v115, s45, v112
    v_fmac_f32 v114, s46, v110
    v_fmac_f32 v115, s46, v113
    v_cvt_pk_bf16_f32 v98, v114, v115
    v_lshlrev_b32 v108, 16, v99
    v_and_b32 v111, s25, v99
    v_lshlrev_b32 v109, 16, v103
    v_and_b32 v112, s25, v103
    v_lshlrev_b32 v110, 16, v107
    v_and_b32 v113, s25, v107
    v_mul_f32 v114, s44, v108
    v_mul_f32 v115, s44, v111
    v_fmac_f32 v114, s45, v109
    v_fmac_f32 v115, s45, v112
    v_fmac_f32 v114, s46, v110
    v_fmac_f32 v115, s46, v113
    v_cvt_pk_bf16_f32 v99, v114, v115
    ds_write_b128 v126, v[96:99]
    v_and_b32 v111, 15, v127
    v_lshlrev_b32 v111, 2, v111
    v_add_u32 v111, 99328, v111
    ds_write_b32 v111, v0
    ds_write_b32 v111, v0 offset:8704
    s_waitcnt lgkmcnt(0)
    s_barrier
    s_mov_b32 s22, 8
    s_setprio 2
L_conv1_kernel_mloop2:
    ds_read_b128 v[88:91], v120 offset:0
    ds_read_b128 v[92:95], v120 offset:1024
    ds_read_b128 v[96:99], v116 offset:0
    ds_read_b128 v[100:103], v120 offset:2048
    ds_read_b128 v[104:107], v116 offset:1088
    ds_read_b128 v[108:111], v120 offset:3072
    ds_read_b128 v[112:115], v116 offset:2176
    s_waitcnt vmcnt(5) lgkmcnt(6)
    v_mfma_f32_16x16x32_bf16 v[0:3], v[64:67], v[88:91], v[0:3]
    ds_read_b128 v[88:91], v120 offset:4096
    s_waitcnt vmcnt(4) lgkmcnt(6)
    v_mfma_f32_16x16x32_bf16 v[4:7], v[64:67], v[92:95], v[4:7]
    v_mfma_f32_16x16x32_bf16 v[0:3], v[68:71], v[92:95], v[0:3]
    ds_read_b128 v[92:95], v116 offset:3264
    s_waitcnt vmcnt(3) lgkmcnt(6)
    v_mfma_f32_16x16x32_bf16 v[32:35], v[80:83], v[96:99], v[32:35]
    ds_read_b128 v[96:99], v120 offset:5120
    s_waitcnt vmcnt(2) lgkmcnt(6)
    v_mfma_f32_16x16x32_bf16 v[8:11], v[64:67], v[100:103], v[8:11]
    v_mfma_f32_16x16x32_bf16 v[4:7], v[68:71], v[100:103], v[4:7]
    v_mfma_f32_16x16x32_bf16 v[0:3], v[72:75], v[100:103], v[0:3]
    ds_read_b128 v[100:103], v116 offset:4352
    s_waitcnt vmcnt(1) lgkmcnt(6)
    v_mfma_f32_16x16x32_bf16 v[36:39], v[80:83], v[104:107], v[36:39]
    v_mfma_f32_16x16x32_bf16 v[32:35], v[84:87], v[104:107], v[32:35]
    ds_read_b128 v[104:107], v120 offset:6144
    s_waitcnt vmcnt(0) lgkmcnt(6)
    v_mfma_f32_16x16x32_bf16 v[12:15], v[64:67], v[108:111], v[12:15]
    v_mfma_f32_16x16x32_bf16 v[8:11], v[68:71], v[108:111], v[8:11]
    v_mfma_f32_16x16x32_bf16 v[4:7], v[72:75], v[108:111], v[4:7]
    v_mfma_f32_16x16x32_bf16 v[0:3], v[76:79], v[108:111], v[0:3]
    ds_read_b128 v[108:111], v116 offset:5440
    s_waitcnt lgkmcnt(6)
    v_mfma_f32_16x16x32_bf16 v[40:43], v[80:83], v[112:115], v[40:43]
    v_mfma_f32_16x16x32_bf16 v[36:39], v[84:87], v[112:115], v[36:39]
    ds_read_b128 v[112:115], v120 offset:7168
    s_waitcnt lgkmcnt(6)
    v_mfma_f32_16x16x32_bf16 v[16:19], v[64:67], v[88:91], v[16:19]
    v_mfma_f32_16x16x32_bf16 v[12:15], v[68:71], v[88:91], v[12:15]
    v_mfma_f32_16x16x32_bf16 v[8:11], v[72:75], v[88:91], v[8:11]
    v_mfma_f32_16x16x32_bf16 v[4:7], v[76:79], v[88:91], v[4:7]
    ds_read_b128 v[88:91], v117 offset:0
    s_waitcnt lgkmcnt(6)
    v_mfma_f32_16x16x32_bf16 v[44:47], v[80:83], v[92:95], v[44:47]
    v_mfma_f32_16x16x32_bf16 v[40:43], v[84:87], v[92:95], v[40:43]
    ds_read_b128 v[92:95], v122 offset:0
    v_add_u32 v122, v123, v122
    s_waitcnt lgkmcnt(6)
    v_mfma_f32_16x16x32_bf16 v[20:23], v[64:67], v[96:99], v[20:23]
    v_mfma_f32_16x16x32_bf16 v[16:19], v[68:71], v[96:99], v[16:19]
    v_mfma_f32_16x16x32_bf16 v[12:15], v[72:75], v[96:99], v[12:15]
    v_mfma_f32_16x16x32_bf16 v[8:11], v[76:79], v[96:99], v[8:11]
    ds_read_b128 v[96:99], v117 offset:1088
    s_waitcnt lgkmcnt(6)
    v_mfma_f32_16x16x32_bf16 v[48:51], v[80:83], v[100:103], v[48:51]
    v_mfma_f32_16x16x32_bf16 v[44:47], v[84:87], v[100:103], v[44:47]
    ds_read_b128 v[100:103], v121 offset:1024
    s_waitcnt lgkmcnt(6)
    v_mfma_f32_16x16x32_bf16 v[24:27], v[64:67], v[104:107], v[24:27]
    v_mfma_f32_16x16x32_bf16 v[20:23], v[68:71], v[104:107], v[20:23]
    v_mfma_f32_16x16x32_bf16 v[16:19], v[72:75], v[104:107], v[16:19]
    v_mfma_f32_16x16x32_bf16 v[12:15], v[76:79], v[104:107], v[12:15]
    ds_read_b128 v[104:107], v118 offset:0
    s_waitcnt lgkmcnt(6)
    v_mfma_f32_16x16x32_bf16 v[52:55], v[80:83], v[108:111], v[52:55]
    v_mfma_f32_16x16x32_bf16 v[48:51], v[84:87], v[108:111], v[48:51]
    ds_read_b128 v[108:111], v121 offset:2048
    s_waitcnt lgkmcnt(6)
    v_mfma_f32_16x16x32_bf16 v[28:31], v[64:67], v[112:115], v[28:31]
    v_mfma_f32_16x16x32_bf16 v[24:27], v[68:71], v[112:115], v[24:27]
    v_mfma_f32_16x16x32_bf16 v[20:23], v[72:75], v[112:115], v[20:23]
    v_mfma_f32_16x16x32_bf16 v[16:19], v[76:79], v[112:115], v[16:19]
    buffer_load_dwordx4 v[64:67], v125, s[12:15], s23 offen offset:0
    s_waitcnt lgkmcnt(5)
    v_mfma_f32_16x16x32_bf16 v[56:59], v[80:83], v[88:91], v[56:59]
    v_mfma_f32_16x16x32_bf16 v[52:55], v[84:87], v[88:91], v[52:55]
    s_waitcnt lgkmcnt(0)
    s_barrier
    v_mfma_f32_16x16x32_bf16 v[28:31], v[68:71], v[92:95], v[28:31]
    v_mfma_f32_16x16x32_bf16 v[24:27], v[72:75], v[92:95], v[24:27]
    v_mfma_f32_16x16x32_bf16 v[20:23], v[76:79], v[92:95], v[20:23]
    buffer_load_dwordx4 v[68:71], v125, s[12:15], s23 offen offset:2048
    v_mfma_f32_16x16x32_bf16 v[60:63], v[80:83], v[96:99], v[60:63]
    v_mfma_f32_16x16x32_bf16 v[56:59], v[84:87], v[96:99], v[56:59]
    buffer_load_dwordx4 v[80:83], v119, s[12:15], s23 offen offset:0
    v_mfma_f32_16x16x32_bf16 v[28:31], v[72:75], v[100:103], v[28:31]
    v_mfma_f32_16x16x32_bf16 v[24:27], v[76:79], v[100:103], v[24:27]
    buffer_load_dwordx4 v[72:75], v125, s[12:15], s26 offen offset:0
    v_mfma_f32_16x16x32_bf16 v[60:63], v[84:87], v[104:107], v[60:63]
    buffer_load_dwordx4 v[84:87], v119, s[12:15], s23 offen offset:2048
    v_mfma_f32_16x16x32_bf16 v[28:31], v[76:79], v[108:111], v[28:31]
    buffer_load_dwordx4 v[76:79], v125, s[12:15], s26 offen offset:2048
    s_add_u32 s23, s23, 57344
    s_add_u32 s26, s26, 57344
    s_sub_u32 s22, s22, 1
    s_cmp_eq_u32 s22, 0
    s_cbranch_scc1 L_conv1_kernel_mlast2
    ds_read_b128 v[88:91], v120 offset:8192
    ds_read_b128 v[92:95], v120 offset:9216
    ds_read_b128 v[96:99], v116 offset:8704
    ds_read_b128 v[100:103], v120 offset:10240
    ds_read_b128 v[104:107], v116 offset:9792
    ds_read_b128 v[108:111], v120 offset:11264
    ds_read_b128 v[112:115], v116 offset:10880
    s_waitcnt vmcnt(5) lgkmcnt(6)
    v_mfma_f32_16x16x32_bf16 v[0:3], v[64:67], v[88:91], v[0:3]
    ds_read_b128 v[88:91], v120 offset:12288
    s_waitcnt vmcnt(4) lgkmcnt(6)
    v_mfma_f32_16x16x32_bf16 v[4:7], v[64:67], v[92:95], v[4:7]
    v_mfma_f32_16x16x32_bf16 v[0:3], v[68:71], v[92:95], v[0:3]
    ds_read_b128 v[92:95], v116 offset:11968
    s_waitcnt vmcnt(3) lgkmcnt(6)
    v_mfma_f32_16x16x32_bf16 v[32:35], v[80:83], v[96:99], v[32:35]
    ds_read_b128 v[96:99], v120 offset:13312
    s_waitcnt vmcnt(2) lgkmcnt(6)
    v_mfma_f32_16x16x32_bf16 v[8:11], v[64:67], v[100:103], v[8:11]
    v_mfma_f32_16x16x32_bf16 v[4:7], v[68:71], v[100:103], v[4:7]
    v_mfma_f32_16x16x32_bf16 v[0:3], v[72:75], v[100:103], v[0:3]
    ds_read_b128 v[100:103], v116 offset:13056
    s_waitcnt vmcnt(1) lgkmcnt(6)
    v_mfma_f32_16x16x32_bf16 v[36:39], v[80:83], v[104:107], v[36:39]
    v_mfma_f32_16x16x32_bf16 v[32:35], v[84:87], v[104:107], v[32:35]
    ds_read_b128 v[104:107], v120 offset:14336
    s_waitcnt vmcnt(0) lgkmcnt(6)
    v_mfma_f32_16x16x32_bf16 v[12:15], v[64:67], v[108:111], v[12:15]
    v_mfma_f32_16x16x32_bf16 v[8:11], v[68:71], v[108:111], v[8:11]
    v_mfma_f32_16x16x32_bf16 v[4:7], v[72:75], v[108:111], v[4:7]
    v_mfma_f32_16x16x32_bf16 v[0:3], v[76:79], v[108:111], v[0:3]
    ds_read_b128 v[108:111], v116 offset:14144
    s_waitcnt lgkmcnt(6)
    v_mfma_f32_16x16x32_bf16 v[40:43], v[80:83], v[112:115], v[40:43]
    v_mfma_f32_16x16x32_bf16 v[36:39], v[84:87], v[112:115], v[36:39]
    ds_read_b128 v[112:115], v120 offset:15360
    s_waitcnt lgkmcnt(6)
    v_mfma_f32_16x16x32_bf16 v[16:19], v[64:67], v[88:91], v[16:19]
    v_mfma_f32_16x16x32_bf16 v[12:15], v[68:71], v[88:91], v[12:15]
    v_mfma_f32_16x16x32_bf16 v[8:11], v[72:75], v[88:91], v[8:11]
    v_mfma_f32_16x16x32_bf16 v[4:7], v[76:79], v[88:91], v[4:7]
    ds_read_b128 v[88:91], v117 offset:8704
    s_waitcnt lgkmcnt(6)
    v_mfma_f32_16x16x32_bf16 v[44:47], v[80:83], v[92:95], v[44:47]
    v_mfma_f32_16x16x32_bf16 v[40:43], v[84:87], v[92:95], v[40:43]
    ds_read_b128 v[92:95], v122 offset:0
    v_add_u32 v122, v124, v122
    s_waitcnt lgkmcnt(6)
    v_mfma_f32_16x16x32_bf16 v[20:23], v[64:67], v[96:99], v[20:23]
    v_mfma_f32_16x16x32_bf16 v[16:19], v[68:71], v[96:99], v[16:19]
    v_mfma_f32_16x16x32_bf16 v[12:15], v[72:75], v[96:99], v[12:15]
    v_mfma_f32_16x16x32_bf16 v[8:11], v[76:79], v[96:99], v[8:11]
    ds_read_b128 v[96:99], v117 offset:9792
    s_waitcnt lgkmcnt(6)
    v_mfma_f32_16x16x32_bf16 v[48:51], v[80:83], v[100:103], v[48:51]
    v_mfma_f32_16x16x32_bf16 v[44:47], v[84:87], v[100:103], v[44:47]
    ds_read_b128 v[100:103], v121 offset:9216
    s_waitcnt lgkmcnt(6)
    v_mfma_f32_16x16x32_bf16 v[24:27], v[64:67], v[104:107], v[24:27]
    v_mfma_f32_16x16x32_bf16 v[20:23], v[68:71], v[104:107], v[20:23]
    v_mfma_f32_16x16x32_bf16 v[16:19], v[72:75], v[104:107], v[16:19]
    v_mfma_f32_16x16x32_bf16 v[12:15], v[76:79], v[104:107], v[12:15]
    ds_read_b128 v[104:107], v118 offset:8704
    s_waitcnt lgkmcnt(6)
    v_mfma_f32_16x16x32_bf16 v[52:55], v[80:83], v[108:111], v[52:55]
    v_mfma_f32_16x16x32_bf16 v[48:51], v[84:87], v[108:111], v[48:51]
    ds_read_b128 v[108:111], v121 offset:10240
    s_waitcnt lgkmcnt(6)
    v_mfma_f32_16x16x32_bf16 v[28:31], v[64:67], v[112:115], v[28:31]
    v_mfma_f32_16x16x32_bf16 v[24:27], v[68:71], v[112:115], v[24:27]
    v_mfma_f32_16x16x32_bf16 v[20:23], v[72:75], v[112:115], v[20:23]
    v_mfma_f32_16x16x32_bf16 v[16:19], v[76:79], v[112:115], v[16:19]
    buffer_load_dwordx4 v[64:67], v125, s[12:15], s23 offen offset:0
    s_waitcnt lgkmcnt(5)
    v_mfma_f32_16x16x32_bf16 v[56:59], v[80:83], v[88:91], v[56:59]
    v_mfma_f32_16x16x32_bf16 v[52:55], v[84:87], v[88:91], v[52:55]
    s_waitcnt lgkmcnt(0)
    s_barrier
    v_mfma_f32_16x16x32_bf16 v[28:31], v[68:71], v[92:95], v[28:31]
    v_mfma_f32_16x16x32_bf16 v[24:27], v[72:75], v[92:95], v[24:27]
    v_mfma_f32_16x16x32_bf16 v[20:23], v[76:79], v[92:95], v[20:23]
    buffer_load_dwordx4 v[68:71], v125, s[12:15], s23 offen offset:2048
    v_mfma_f32_16x16x32_bf16 v[60:63], v[80:83], v[96:99], v[60:63]
    v_mfma_f32_16x16x32_bf16 v[56:59], v[84:87], v[96:99], v[56:59]
    buffer_load_dwordx4 v[80:83], v119, s[12:15], s23 offen offset:0
    v_mfma_f32_16x16x32_bf16 v[28:31], v[72:75], v[100:103], v[28:31]
    v_mfma_f32_16x16x32_bf16 v[24:27], v[76:79], v[100:103], v[24:27]
    buffer_load_dwordx4 v[72:75], v125, s[12:15], s26 offen offset:0
    v_mfma_f32_16x16x32_bf16 v[60:63], v[84:87], v[104:107], v[60:63]
    buffer_load_dwordx4 v[84:87], v119, s[12:15], s23 offen offset:2048
    v_mfma_f32_16x16x32_bf16 v[28:31], v[76:79], v[108:111], v[28:31]
    buffer_load_dwordx4 v[76:79], v125, s[12:15], s26 offen offset:2048
    s_add_u32 s23, s23, 57344
    s_add_u32 s26, s26, 57344
    s_branch L_conv1_kernel_mloop2
L_conv1_kernel_mlast2:
    v_and_b32 v125, 15, v127
    v_and_b32 v126, 7, v127
    v_lshlrev_b32 v126, 4, v126
    v_lshl_add_u32 v125, v125, 7, v126
    v_lshrrev_b32 v126, 4, v127
    v_lshl_add_u32 v125, v126, 11, v125
    s_mov_b32 s36, 65536
    s_cmp_eq_u32 s32, 1
    s_cselect_b32 s36, 121856, s36
    s_cmp_eq_u32 s32, 2
    s_cselect_b32 s36, 81920, s36
    s_cmp_eq_u32 s32, 3
    s_cselect_b32 s36, 130048, s36
    s_mov_b32 s37, 98304
    s_cmp_eq_u32 s32, 1
    s_cselect_b32 s37, 138240, s37
    s_cmp_eq_u32 s32, 2
    s_cselect_b32 s37, 146432, s37
    s_cmp_eq_u32 s32, 3
    s_cselect_b32 s37, 154624, s37
    v_add_u32 v126, s37, v125
    v_add_u32 v125, s36, v125
    ds_read_b128 v[88:91], v120 offset:8192
    ds_read_b128 v[92:95], v120 offset:9216
    ds_read_b128 v[96:99], v116 offset:8704
    ds_read_b128 v[100:103], v120 offset:10240
    ds_read_b128 v[104:107], v116 offset:9792
    ds_read_b128 v[108:111], v120 offset:11264
    ds_read_b128 v[112:115], v116 offset:10880
    s_waitcnt vmcnt(5) lgkmcnt(6)
    v_mfma_f32_16x16x32_bf16 v[0:3], v[64:67], v[88:91], v[0:3]
    ds_read_b128 v[88:91], v120 offset:12288
    s_waitcnt vmcnt(4) lgkmcnt(6)
    v_mfma_f32_16x16x32_bf16 v[4:7], v[64:67], v[92:95], v[4:7]
    v_mfma_f32_16x16x32_bf16 v[0:3], v[68:71], v[92:95], v[0:3]
    ds_read_b128 v[92:95], v116 offset:11968
    s_waitcnt vmcnt(3) lgkmcnt(6)
    v_mfma_f32_16x16x32_bf16 v[32:35], v[80:83], v[96:99], v[32:35]
    ds_read_b128 v[96:99], v120 offset:13312
    s_waitcnt vmcnt(2) lgkmcnt(6)
    v_mfma_f32_16x16x32_bf16 v[8:11], v[64:67], v[100:103], v[8:11]
    v_mfma_f32_16x16x32_bf16 v[4:7], v[68:71], v[100:103], v[4:7]
    v_mfma_f32_16x16x32_bf16 v[0:3], v[72:75], v[100:103], v[0:3]
    ds_read_b128 v[100:103], v116 offset:13056
    s_waitcnt vmcnt(1) lgkmcnt(6)
    v_mfma_f32_16x16x32_bf16 v[36:39], v[80:83], v[104:107], v[36:39]
    v_mfma_f32_16x16x32_bf16 v[32:35], v[84:87], v[104:107], v[32:35]
    ds_read_b128 v[104:107], v120 offset:14336
    s_waitcnt vmcnt(0) lgkmcnt(6)
    v_mfma_f32_16x16x32_bf16 v[12:15], v[64:67], v[108:111], v[12:15]
    v_mfma_f32_16x16x32_bf16 v[8:11], v[68:71], v[108:111], v[8:11]
    v_mfma_f32_16x16x32_bf16 v[4:7], v[72:75], v[108:111], v[4:7]
    v_mfma_f32_16x16x32_bf16 v[0:3], v[76:79], v[108:111], v[0:3]
    ds_read_b128 v[108:111], v116 offset:14144
    s_waitcnt lgkmcnt(6)
    v_mfma_f32_16x16x32_bf16 v[40:43], v[80:83], v[112:115], v[40:43]
    v_mfma_f32_16x16x32_bf16 v[36:39], v[84:87], v[112:115], v[36:39]
    ds_read_b128 v[112:115], v120 offset:15360
    s_waitcnt lgkmcnt(6)
    v_mfma_f32_16x16x32_bf16 v[16:19], v[64:67], v[88:91], v[16:19]
    v_mfma_f32_16x16x32_bf16 v[12:15], v[68:71], v[88:91], v[12:15]
    v_mfma_f32_16x16x32_bf16 v[8:11], v[72:75], v[88:91], v[8:11]
    v_mfma_f32_16x16x32_bf16 v[4:7], v[76:79], v[88:91], v[4:7]
    ds_read_b128 v[88:91], v117 offset:8704
    v_xor_b32 v124, 0, v126
    ds_write_b128 v124, v[32:35]
    s_waitcnt lgkmcnt(7)
    v_mfma_f32_16x16x32_bf16 v[44:47], v[80:83], v[92:95], v[44:47]
    v_mfma_f32_16x16x32_bf16 v[40:43], v[84:87], v[92:95], v[40:43]
    ds_read_b128 v[92:95], v122 offset:0
    v_xor_b32 v123, 0, v125
    ds_write_b128 v123, v[0:3]
    s_waitcnt lgkmcnt(8)
    v_mfma_f32_16x16x32_bf16 v[20:23], v[64:67], v[96:99], v[20:23]
    v_mfma_f32_16x16x32_bf16 v[16:19], v[68:71], v[96:99], v[16:19]
    v_mfma_f32_16x16x32_bf16 v[12:15], v[72:75], v[96:99], v[12:15]
    v_mfma_f32_16x16x32_bf16 v[8:11], v[76:79], v[96:99], v[8:11]
    ds_read_b128 v[96:99], v117 offset:9792
    v_xor_b32 v123, 16, v126
    ds_write_b128 v123, v[36:39]
    s_waitcnt lgkmcnt(9)
    v_mfma_f32_16x16x32_bf16 v[48:51], v[80:83], v[100:103], v[48:51]
    v_mfma_f32_16x16x32_bf16 v[44:47], v[84:87], v[100:103], v[44:47]
    ds_read_b128 v[100:103], v121 offset:9216
    v_xor_b32 v124, 16, v125
    ds_write_b128 v124, v[4:7]
    s_waitcnt lgkmcnt(10)
    v_mfma_f32_16x16x32_bf16 v[24:27], v[64:67], v[104:107], v[24:27]
    v_mfma_f32_16x16x32_bf16 v[20:23], v[68:71], v[104:107], v[20:23]
    v_mfma_f32_16x16x32_bf16 v[16:19], v[72:75], v[104:107], v[16:19]
    v_mfma_f32_16x16x32_bf16 v[12:15], v[76:79], v[104:107], v[12:15]
    ds_read_b128 v[104:107], v118 offset:8704
    v_xor_b32 v124, 32, v126
    ds_write_b128 v124, v[40:43]
    s_waitcnt lgkmcnt(11)
    v_mfma_f32_16x16x32_bf16 v[52:55], v[80:83], v[108:111], v[52:55]
    v_mfma_f32_16x16x32_bf16 v[48:51], v[84:87], v[108:111], v[48:51]
    ds_read_b128 v[108:111], v121 offset:10240
    v_xor_b32 v123, 32, v125
    ds_write_b128 v123, v[8:11]
    s_waitcnt lgkmcnt(12)
    v_mfma_f32_16x16x32_bf16 v[28:31], v[64:67], v[112:115], v[28:31]
    v_mfma_f32_16x16x32_bf16 v[24:27], v[68:71], v[112:115], v[24:27]
    v_mfma_f32_16x16x32_bf16 v[20:23], v[72:75], v[112:115], v[20:23]
    v_mfma_f32_16x16x32_bf16 v[16:19], v[76:79], v[112:115], v[16:19]
    v_xor_b32 v123, 48, v126
    ds_write_b128 v123, v[44:47]
    s_waitcnt lgkmcnt(12)
    v_mfma_f32_16x16x32_bf16 v[56:59], v[80:83], v[88:91], v[56:59]
    v_mfma_f32_16x16x32_bf16 v[52:55], v[84:87], v[88:91], v[52:55]
    v_xor_b32 v124, 48, v125
    ds_write_b128 v124, v[12:15]
    s_waitcnt lgkmcnt(11)
    v_mfma_f32_16x16x32_bf16 v[28:31], v[68:71], v[92:95], v[28:31]
    v_mfma_f32_16x16x32_bf16 v[24:27], v[72:75], v[92:95], v[24:27]
    v_mfma_f32_16x16x32_bf16 v[20:23], v[76:79], v[92:95], v[20:23]
    v_xor_b32 v124, 64, v126
    ds_write_b128 v124, v[48:51]
    s_waitcnt lgkmcnt(10)
    v_mfma_f32_16x16x32_bf16 v[60:63], v[80:83], v[96:99], v[60:63]
    v_mfma_f32_16x16x32_bf16 v[56:59], v[84:87], v[96:99], v[56:59]
    v_xor_b32 v123, 64, v125
    ds_write_b128 v123, v[16:19]
    s_waitcnt lgkmcnt(9)
    v_mfma_f32_16x16x32_bf16 v[28:31], v[72:75], v[100:103], v[28:31]
    v_mfma_f32_16x16x32_bf16 v[24:27], v[76:79], v[100:103], v[24:27]
    v_xor_b32 v123, 80, v126
    ds_write_b128 v123, v[52:55]
    s_waitcnt lgkmcnt(8)
    v_mfma_f32_16x16x32_bf16 v[60:63], v[84:87], v[104:107], v[60:63]
    v_xor_b32 v124, 80, v125
    ds_write_b128 v124, v[20:23]
    s_waitcnt lgkmcnt(7)
    v_mfma_f32_16x16x32_bf16 v[28:31], v[76:79], v[108:111], v[28:31]
    v_xor_b32 v124, 96, v126
    ds_write_b128 v124, v[56:59]
    v_and_b32 v108, 15, v127
    v_lshrrev_b32 v109, 4, v127
    v_lshrrev_b32 v110, 3, v108
    s_lshl_b32 s36, s20, 1
    v_add_u32 v110, s36, v110
    v_xor_b32 v111, v110, v108
    v_and_b32 v111, 7, v111
    v_lshlrev_b32 v111, 4, v111
    v_xor_b32 v123, 96, v125
    ds_write_b128 v123, v[24:27]
    v_lshl_add_u32 v111, v110, 7, v111
    v_lshl_add_u32 v120, v109, 11, v111
    v_add_u32 v121, 65536, v120
    v_add_u32 v64, 131072, v120
    s_lshl_b32 s36, s20, 9
    s_add_u32 s36, s36, 115712
    v_lshl_add_u32 v127, v109, 7, s36
    s_lshl_b32 s36, s20, 4
    v_add_u32 v108, s36, v108
    v_lshlrev_b32 v110, 6, v108
    v_lshl_add_u32 v110, v109, 4, v110
    s_mul_i32 s36, s29, 524288
    v_xor_b32 v123, 112, v126
    ds_write_b128 v123, v[60:63]
    s_lshl_b32 s37, s21, 4
    s_add_u32 s36, s36, s37
    v_add_u32 v110, s36, v110
    v_mov_b32 v111, 2130706432
    v_cmp_gt_u32 vcc, 125, v108
    s_mov_b32 s4, 0xbeaaaaab
    s_mov_b32 s5, s4
    s_mov_b32 s6, 0x3e800000
    s_mov_b32 s7, s6
    s_mov_b32 s8, 0xc0a00000
    s_mov_b32 s9, s8
    s_mov_b32 s10, 0xc0638e39
    v_xor_b32 v124, 112, v125
    ds_write_b128 v124, v[28:31]
    s_mov_b32 s11, s10
    s_mov_b32 s12, 0xbf638e39
    s_mov_b32 s13, s12
    s_mov_b32 s14, 0xbe638e39
    s_mov_b32 s15, s14
    s_mov_b32 s22, 0xbd638e39
    s_mov_b32 s23, s22
    s_mov_b32 s24, 0x3ff1c71c
    s_mov_b32 s25, s24
    s_mov_b32 s26, 0xbf2aaaab
    s_mov_b32 s27, s26
    s_mov_b32 s32, 0x3ecccccd
    s_mov_b32 s33, s32
    s_mov_b32 s34, 0xbd888889
    s_mov_b32 s35, s34
    s_mov_b32 s38, 0xbe4ccccd
    s_mov_b32 s39, s38
    s_mov_b32 s40, 0xbdd2d3e8
    s_mov_b32 s41, s40
    s_mov_b32 s42, 0x3f800000
    s_mov_b32 s43, s42
    s_setprio 0
    s_branch L_conv1_kernel_epi
L_conv1_kernel_helper:
    s_setprio 3
    v_add_u32 v92, 0, v7
    v_add_u32 v93, 1024, v7
    v_add_u32 v94, 2048, v7
    v_add_u32 v95, 3072, v7
    v_and_b32 v76, 4, v5
    v_lshrrev_b32 v76, 1, v76
    v_xor_b32 v76, v6, v76
    v_lshlrev_b32 v76, 4, v76
    v_lshl_add_u32 v76, v5, 6, v76
    s_mov_b32 s24, 0
    s_mov_b32 s27, 524288
    s_waitcnt lgkmcnt(0)
    s_add_u32 s8, s4, s47
    s_addc_u32 s9, s5, 0
    buffer_load_dwordx4 v[0:3], v92, s[8:11], s24 offen offset:0
    buffer_load_dwordx4 v[16:19], v92, s[8:11], s24 offen offset:64
    v_add_u32 v92, 128, v92
    buffer_load_dwordx4 v[4:7], v93, s[8:11], s24 offen offset:0
    buffer_load_dwordx4 v[20:23], v93, s[8:11], s24 offen offset:64
    v_add_u32 v93, 128, v93
    buffer_load_dwordx4 v[8:11], v94, s[8:11], s24 offen offset:0
    buffer_load_dwordx4 v[24:27], v94, s[8:11], s24 offen offset:64
    v_add_u32 v94, 128, v94
    buffer_load_dwordx4 v[12:15], v95, s[8:11], s24 offen offset:0
    buffer_load_dwordx4 v[28:31], v95, s[8:11], s24 offen offset:64
    v_add_u32 v95, 128, v95
    s_mul_i32 s36, s42, 1024
    v_add_u32 v96, s36, v76
    v_add_u32 v97, 65536, v96
    s_mul_i32 s36, s42, 1088
    s_add_u32 s36, s36, 98304
    v_add_u32 v98, s36, v76
    s_waitcnt vmcnt(0)
    s_mov_b32 s28, 0
    s_mov_b32 s22, 4
    s_cmp_ge_u32 s20, 12
    s_cbranch_scc1 L_conv1_kernel_h2
    ds_write_b128 v96, v[0:3] offset:0
    ds_write_b128 v98, v[12:15] offset:0
    v_lshlrev_b32 v76, 16, v0
    v_and_b32 v84, s25, v0
    v_lshlrev_b32 v77, 16, v4
    v_and_b32 v85, s25, v4
    v_lshlrev_b32 v78, 16, v8
    v_and_b32 v86, s25, v8
    v_lshlrev_b32 v79, 16, v12
    v_and_b32 v87, s25, v12
    v_add_f32 v80, v76, v78
    v_add_f32 v88, v84, v86
    v_add_f32 v81, v77, v79
    v_add_f32 v89, v85, v87
    v_fma_f32 v82, v78, 4.0, v76
    v_fma_f32 v90, v86, 4.0, v84
    v_fma_f32 v83, v79, 4.0, v77
    v_fma_f32 v91, v87, 4.0, v85
    v_add_f32 v77, v80, v81
    v_add_f32 v85, v88, v89
    v_sub_f32 v78, v80, v81
    v_sub_f32 v86, v88, v89
    v_fma_f32 v79, v83, 2.0, v82
    v_fma_f32 v87, v91, 2.0, v90
    v_fma_f32 v82, v83, -2.0, v82
    v_fma_f32 v90, v91, -2.0, v90
    v_fmamk_f32 v80, v76, 0x41700000, v82
    v_fmamk_f32 v88, v84, 0x41700000, v90
    v_fmamk_f32 v80, v81, 0x41200000, v80
    v_fmamk_f32 v88, v89, 0x41200000, v88
    v_cvt_pk_bf16_f32 v4, v77, v85
    v_cvt_pk_bf16_f32 v8, v78, v86
    v_cvt_pk_bf16_f32 v64, v79, v87
    v_cvt_pk_bf16_f32 v68, v82, v90
    v_cvt_pk_bf16_f32 v72, v80, v88
    v_lshlrev_b32 v76, 16, v1
    v_and_b32 v84, s25, v1
    v_lshlrev_b32 v77, 16, v5
    v_and_b32 v85, s25, v5
    v_lshlrev_b32 v78, 16, v9
    v_and_b32 v86, s25, v9
    v_lshlrev_b32 v79, 16, v13
    v_and_b32 v87, s25, v13
    v_add_f32 v80, v76, v78
    v_add_f32 v88, v84, v86
    v_add_f32 v81, v77, v79
    v_add_f32 v89, v85, v87
    v_fma_f32 v82, v78, 4.0, v76
    v_fma_f32 v90, v86, 4.0, v84
    v_fma_f32 v83, v79, 4.0, v77
    v_fma_f32 v91, v87, 4.0, v85
    v_add_f32 v77, v80, v81
    v_add_f32 v85, v88, v89
    v_sub_f32 v78, v80, v81
    v_sub_f32 v86, v88, v89
    v_fma_f32 v79, v83, 2.0, v82
    v_fma_f32 v87, v91, 2.0, v90
    v_fma_f32 v82, v83, -2.0, v82
    v_fma_f32 v90, v91, -2.0, v90
    v_fmamk_f32 v80, v76, 0x41700000, v82
    v_fmamk_f32 v88, v84, 0x41700000, v90
    v_fmamk_f32 v80, v81, 0x41200000, v80
    v_fmamk_f32 v88, v89, 0x41200000, v88
    v_cvt_pk_bf16_f32 v5, v77, v85
    v_cvt_pk_bf16_f32 v9, v78, v86
    v_cvt_pk_bf16_f32 v65, v79, v87
    v_cvt_pk_bf16_f32 v69, v82, v90
    v_cvt_pk_bf16_f32 v73, v80, v88
    v_lshlrev_b32 v76, 16, v2
    v_and_b32 v84, s25, v2
    v_lshlrev_b32 v77, 16, v6
    v_and_b32 v85, s25, v6
    v_lshlrev_b32 v78, 16, v10
    v_and_b32 v86, s25, v10
    v_lshlrev_b32 v79, 16, v14
    v_and_b32 v87, s25, v14
    v_add_f32 v80, v76, v78
    v_add_f32 v88, v84, v86
    v_add_f32 v81, v77, v79
    v_add_f32 v89, v85, v87
    v_fma_f32 v82, v78, 4.0, v76
    v_fma_f32 v90, v86, 4.0, v84
    v_fma_f32 v83, v79, 4.0, v77
    v_fma_f32 v91, v87, 4.0, v85
    v_add_f32 v77, v80, v81
    v_add_f32 v85, v88, v89
    v_sub_f32 v78, v80, v81
    v_sub_f32 v86, v88, v89
    v_fma_f32 v79, v83, 2.0, v82
    v_fma_f32 v87, v91, 2.0, v90
    v_fma_f32 v82, v83, -2.0, v82
    v_fma_f32 v90, v91, -2.0, v90
    v_fmamk_f32 v80, v76, 0x41700000, v82
    v_fmamk_f32 v88, v84, 0x41700000, v90
    v_fmamk_f32 v80, v81, 0x41200000, v80
    v_fmamk_f32 v88, v89, 0x41200000, v88
    v_cvt_pk_bf16_f32 v6, v77, v85
    v_cvt_pk_bf16_f32 v10, v78, v86
    v_cvt_pk_bf16_f32 v66, v79, v87
    v_cvt_pk_bf16_f32 v70, v82, v90
    v_cvt_pk_bf16_f32 v74, v80, v88
    v_lshlrev_b32 v76, 16, v3
    v_and_b32 v84, s25, v3
    v_lshlrev_b32 v77, 16, v7
    v_and_b32 v85, s25, v7
    v_lshlrev_b32 v78, 16, v11
    v_and_b32 v86, s25, v11
    v_lshlrev_b32 v79, 16, v15
    v_and_b32 v87, s25, v15
    v_add_f32 v80, v76, v78
    v_add_f32 v88, v84, v86
    v_add_f32 v81, v77, v79
    v_add_f32 v89, v85, v87
    v_fma_f32 v82, v78, 4.0, v76
    v_fma_f32 v90, v86, 4.0, v84
    v_fma_f32 v83, v79, 4.0, v77
    v_fma_f32 v91, v87, 4.0, v85
    v_add_f32 v77, v80, v81
    v_add_f32 v85, v88, v89
    v_sub_f32 v78, v80, v81
    v_sub_f32 v86, v88, v89
    v_fma_f32 v79, v83, 2.0, v82
    v_fma_f32 v87, v91, 2.0, v90
    v_fma_f32 v82, v83, -2.0, v82
    v_fma_f32 v90, v91, -2.0, v90
    v_fmamk_f32 v80, v76, 0x41700000, v82
    v_fmamk_f32 v88, v84, 0x41700000, v90
    v_fmamk_f32 v80, v81, 0x41200000, v80
    v_fmamk_f32 v88, v89, 0x41200000, v88
    v_cvt_pk_bf16_f32 v7, v77, v85
    v_cvt_pk_bf16_f32 v11, v78, v86
    v_cvt_pk_bf16_f32 v67, v79, v87
    v_cvt_pk_bf16_f32 v71, v82, v90
    v_cvt_pk_bf16_f32 v75, v80, v88
    ds_write_b128 v96, v[64:67] offset:49152
    ds_write_b128 v97, v[68:71] offset:0
    ds_write_b128 v97, v[72:75] offset:16384
    ds_write_b128 v96, v[4:7] offset:16384
    ds_write_b128 v96, v[8:11] offset:32768
    s_waitcnt vmcnt(0)
    s_waitcnt lgkmcnt(0)
    s_barrier
    buffer_load_dwordx4 v[32:35], v92, s[8:11], s24 offen offset:0
    buffer_load_dwordx4 v[48:51], v92, s[8:11], s24 offen offset:64
    v_add_u32 v92, 128, v92
    buffer_load_dwordx4 v[36:39], v93, s[8:11], s24 offen offset:0
    buffer_load_dwordx4 v[52:55], v93, s[8:11], s24 offen offset:64
    v_add_u32 v93, 128, v93
    s_setprio 1
L_conv1_kernel_hloop1:
    s_cmp_lt_u32 s28, 13
    s_cselect_b32 s24, 0, 2130706432
    v_lshlrev_b32 v76, 16, v16
    v_and_b32 v84, s25, v16
    v_lshlrev_b32 v77, 16, v20
    v_and_b32 v85, s25, v20
    v_lshlrev_b32 v78, 16, v24
    v_and_b32 v86, s25, v24
    v_lshlrev_b32 v79, 16, v28
    v_and_b32 v87, s25, v28
    v_add_f32 v80, v76, v78
    v_add_f32 v88, v84, v86
    v_add_f32 v81, v77, v79
    v_add_f32 v89, v85, v87
    v_fma_f32 v82, v78, 4.0, v76
    buffer_load_dwordx4 v[40:43], v94, s[8:11], s24 offen offset:0
    buffer_load_dwordx4 v[56:59], v94, s[8:11], s24 offen offset:64
    v_add_u32 v94, 128, v94
    v_fma_f32 v90, v86, 4.0, v84
    v_fma_f32 v83, v79, 4.0, v77
    v_fma_f32 v91, v87, 4.0, v85
    v_add_f32 v77, v80, v81
    v_add_f32 v85, v88, v89
    v_sub_f32 v78, v80, v81
    v_sub_f32 v86, v88, v89
    v_fma_f32 v79, v83, 2.0, v82
    v_fma_f32 v87, v91, 2.0, v90
    v_fma_f32 v82, v83, -2.0, v82
    v_fma_f32 v90, v91, -2.0, v90
    v_fmamk_f32 v80, v76, 0x41700000, v82
    v_fmamk_f32 v88, v84, 0x41700000, v90
    v_fmamk_f32 v80, v81, 0x41200000, v80
    v_fmamk_f32 v88, v89, 0x41200000, v88
    v_cvt_pk_bf16_f32 v20, v77, v85
    v_cvt_pk_bf16_f32 v24, v78, v86
    v_cvt_pk_bf16_f32 v64, v79, v87
    v_cvt_pk_bf16_f32 v68, v82, v90
    v_cvt_pk_bf16_f32 v72, v80, v88
    v_lshlrev_b32 v76, 16, v17
    v_and_b32 v84, s25, v17
    v_lshlrev_b32 v77, 16, v21
    v_and_b32 v85, s25, v21
    v_lshlrev_b32 v78, 16, v25
    v_and_b32 v86, s25, v25
    v_lshlrev_b32 v79, 16, v29
    v_and_b32 v87, s25, v29
    v_add_f32 v80, v76, v78
    v_add_f32 v88, v84, v86
    v_add_f32 v81, v77, v79
    v_add_f32 v89, v85, v87
    v_fma_f32 v82, v78, 4.0, v76
    v_fma_f32 v90, v86, 4.0, v84
    v_fma_f32 v83, v79, 4.0, v77
    v_fma_f32 v91, v87, 4.0, v85
    v_add_f32 v77, v80, v81
    v_add_f32 v85, v88, v89
    v_sub_f32 v78, v80, v81
    v_sub_f32 v86, v88, v89
    v_fma_f32 v79, v83, 2.0, v82
    v_fma_f32 v87, v91, 2.0, v90
    v_fma_f32 v82, v83, -2.0, v82
    v_fma_f32 v90, v91, -2.0, v90
    v_fmamk_f32 v80, v76, 0x41700000, v82
    v_fmamk_f32 v88, v84, 0x41700000, v90
    v_fmamk_f32 v80, v81, 0x41200000, v80
    v_fmamk_f32 v88, v89, 0x41200000, v88
    v_cvt_pk_bf16_f32 v21, v77, v85
    v_cvt_pk_bf16_f32 v25, v78, v86
    v_cvt_pk_bf16_f32 v65, v79, v87
    v_cvt_pk_bf16_f32 v69, v82, v90
    v_cvt_pk_bf16_f32 v73, v80, v88
    buffer_load_dwordx4 v[44:47], v95, s[8:11], s24 offen offset:0
    buffer_load_dwordx4 v[60:63], v95, s[8:11], s24 offen offset:64
    v_add_u32 v95, 128, v95
    v_lshlrev_b32 v76, 16, v18
    v_and_b32 v84, s25, v18
    v_lshlrev_b32 v77, 16, v22
    v_and_b32 v85, s25, v22
    v_lshlrev_b32 v78, 16, v26
    v_and_b32 v86, s25, v26
    v_lshlrev_b32 v79, 16, v30
    v_and_b32 v87, s25, v30
    v_add_f32 v80, v76, v78
    v_add_f32 v88, v84, v86
    v_add_f32 v81, v77, v79
    v_add_f32 v89, v85, v87
    v_fma_f32 v82, v78, 4.0, v76
    v_fma_f32 v90, v86, 4.0, v84
    v_fma_f32 v83, v79, 4.0, v77
    v_fma_f32 v91, v87, 4.0, v85
    v_add_f32 v77, v80, v81
    v_add_f32 v85, v88, v89
    v_sub_f32 v78, v80, v81
    v_sub_f32 v86, v88, v89
    v_fma_f32 v79, v83, 2.0, v82
    v_fma_f32 v87, v91, 2.0, v90
    v_fma_f32 v82, v83, -2.0, v82
    v_fma_f32 v90, v91, -2.0, v90
    v_fmamk_f32 v80, v76, 0x41700000, v82
    v_fmamk_f32 v88, v84, 0x41700000, v90
    v_fmamk_f32 v80, v81, 0x41200000, v80
    v_fmamk_f32 v88, v89, 0x41200000, v88
    v_cvt_pk_bf16_f32 v22, v77, v85
    v_cvt_pk_bf16_f32 v26, v78, v86
    v_cvt_pk_bf16_f32 v66, v79, v87
    v_cvt_pk_bf16_f32 v70, v82, v90
    v_cvt_pk_bf16_f32 v74, v80, v88
    v_lshlrev_b32 v76, 16, v19
    v_and_b32 v84, s25, v19
    v_lshlrev_b32 v77, 16, v23
    v_and_b32 v85, s25, v23
    v_lshlrev_b32 v78, 16, v27
    v_and_b32 v86, s25, v27
    v_lshlrev_b32 v79, 16, v31
    v_and_b32 v87, s25, v31
    v_add_f32 v80, v76, v78
    v_add_f32 v88, v84, v86
    v_add_f32 v81, v77, v79
    v_add_f32 v89, v85, v87
    v_fma_f32 v82, v78, 4.0, v76
    v_fma_f32 v90, v86, 4.0, v84
    v_fma_f32 v83, v79, 4.0, v77
    v_fma_f32 v91, v87, 4.0, v85
    v_add_f32 v77, v80, v81
    v_add_f32 v85, v88, v89
    v_sub_f32 v78, v80, v81
    v_sub_f32 v86, v88, v89
    v_fma_f32 v79, v83, 2.0, v82
    v_fma_f32 v87, v91, 2.0, v90
    v_fma_f32 v82, v83, -2.0, v82
    v_fma_f32 v90, v91, -2.0, v90
    v_fmamk_f32 v80, v76, 0x41700000, v82
    v_fmamk_f32 v88, v84, 0x41700000, v90
    v_fmamk_f32 v80, v81, 0x41200000, v80
    v_fmamk_f32 v88, v89, 0x41200000, v88
    v_cvt_pk_bf16_f32 v23, v77, v85
    v_cvt_pk_bf16_f32 v27, v78, v86
    v_cvt_pk_bf16_f32 v67, v79, v87
    v_cvt_pk_bf16_f32 v71, v82, v90
    v_cvt_pk_bf16_f32 v75, v80, v88
    ds_write_b128 v96, v[64:67] offset:57344
    ds_write_b128 v97, v[68:71] offset:8192
    ds_write_b128 v97, v[72:75] offset:24576
    ds_write_b128 v96, v[16:19] offset:8192
    ds_write_b128 v96, v[20:23] offset:24576
    ds_write_b128 v96, v[24:27] offset:40960
    ds_write_b128 v98, v[28:31] offset:8704
    s_add_u32 s28, s28, 1
    s_waitcnt lgkmcnt(0)
    s_barrier
    s_cmp_lt_u32 s28, 13
    s_cselect_b32 s24, 0, 2130706432
    s_waitcnt vmcnt(0)
    v_lshlrev_b32 v76, 16, v32
    v_and_b32 v84, s25, v32
    v_lshlrev_b32 v77, 16, v36
    v_and_b32 v85, s25, v36
    v_lshlrev_b32 v78, 16, v40
    v_and_b32 v86, s25, v40
    v_lshlrev_b32 v79, 16, v44
    v_and_b32 v87, s25, v44
    v_add_f32 v80, v76, v78
    v_add_f32 v88, v84, v86
    v_add_f32 v81, v77, v79
    v_add_f32 v89, v85, v87
    v_fma_f32 v82, v78, 4.0, v76
    v_fma_f32 v90, v86, 4.0, v84
    v_fma_f32 v83, v79, 4.0, v77
    v_fma_f32 v91, v87, 4.0, v85
    v_add_f32 v77, v80, v81
    v_add_f32 v85, v88, v89
    v_sub_f32 v78, v80, v81
    v_sub_f32 v86, v88, v89
    v_fma_f32 v79, v83, 2.0, v82
    v_fma_f32 v87, v91, 2.0, v90
    v_fma_f32 v82, v83, -2.0, v82
    v_fma_f32 v90, v91, -2.0, v90
    v_fmamk_f32 v80, v76, 0x41700000, v82
    v_fmamk_f32 v88, v84, 0x41700000, v90
    v_fmamk_f32 v80, v81, 0x41200000, v80
    v_fmamk_f32 v88, v89, 0x41200000, v88
    v_cvt_pk_bf16_f32 v36, v77, v85
    v_cvt_pk_bf16_f32 v40, v78, v86
    v_cvt_pk_bf16_f32 v64, v79, v87
    v_cvt_pk_bf16_f32 v68, v82, v90
    v_cvt_pk_bf16_f32 v72, v80, v88
    v_lshlrev_b32 v76, 16, v33
    v_and_b32 v84, s25, v33
    v_lshlrev_b32 v77, 16, v37
    v_and_b32 v85, s25, v37
    v_lshlrev_b32 v78, 16, v41
    v_and_b32 v86, s25, v41
    buffer_load_dwordx4 v[0:3], v92, s[8:11], s24 offen offset:0
    buffer_load_dwordx4 v[16:19], v92, s[8:11], s24 offen offset:64
    v_add_u32 v92, 128, v92
    v_lshlrev_b32 v79, 16, v45
    v_and_b32 v87, s25, v45
    v_add_f32 v80, v76, v78
    v_add_f32 v88, v84, v86
    v_add_f32 v81, v77, v79
    v_add_f32 v89, v85, v87
    v_fma_f32 v82, v78, 4.0, v76
    v_fma_f32 v90, v86, 4.0, v84
    v_fma_f32 v83, v79, 4.0, v77
    v_fma_f32 v91, v87, 4.0, v85
    v_add_f32 v77, v80, v81
    v_add_f32 v85, v88, v89
    v_sub_f32 v78, v80, v81
    v_sub_f32 v86, v88, v89
    v_fma_f32 v79, v83, 2.0, v82
    v_fma_f32 v87, v91, 2.0, v90
    v_fma_f32 v82, v83, -2.0, v82
    v_fma_f32 v90, v91, -2.0, v90
    v_fmamk_f32 v80, v76, 0x41700000, v82
    v_fmamk_f32 v88, v84, 0x41700000, v90
    v_fmamk_f32 v80, v81, 0x41200000, v80
    v_fmamk_f32 v88, v89, 0x41200000, v88
    v_cvt_pk_bf16_f32 v37, v77, v85
    v_cvt_pk_bf16_f32 v41, v78, v86
    v_cvt_pk_bf16_f32 v65, v79, v87
    v_cvt_pk_bf16_f32 v69, v82, v90
    v_cvt_pk_bf16_f32 v73, v80, v88
    v_lshlrev_b32 v76, 16, v34
    v_and_b32 v84, s25, v34
    v_lshlrev_b32 v77, 16, v38
    v_and_b32 v85, s25, v38
    v_lshlrev_b32 v78, 16, v42
    v_and_b32 v86, s25, v42
    v_lshlrev_b32 v79, 16, v46
    v_and_b32 v87, s25, v46
    v_add_f32 v80, v76, v78
    v_add_f32 v88, v84, v86
    v_add_f32 v81, v77, v79
    v_add_f32 v89, v85, v87
    v_fma_f32 v82, v78, 4.0, v76
    v_fma_f32 v90, v86, 4.0, v84
    v_fma_f32 v83, v79, 4.0, v77
    v_fma_f32 v91, v87, 4.0, v85
    v_add_f32 v77, v80, v81
    v_add_f32 v85, v88, v89
    v_sub_f32 v78, v80, v81
    v_sub_f32 v86, v88, v89
    v_fma_f32 v79, v83, 2.0, v82
    v_fma_f32 v87, v91, 2.0, v90
    v_fma_f32 v82, v83, -2.0, v82
    v_fma_f32 v90, v91, -2.0, v90
    v_fmamk_f32 v80, v76, 0x41700000, v82
    v_fmamk_f32 v88, v84, 0x41700000, v90
    buffer_load_dwordx4 v[4:7], v93, s[8:11], s24 offen offset:0
    buffer_load_dwordx4 v[20:23], v93, s[8:11], s24 offen offset:64
    v_add_u32 v93, 128, v93
    v_fmamk_f32 v80, v81, 0x41200000, v80
    v_fmamk_f32 v88, v89, 0x41200000, v88
    v_cvt_pk_bf16_f32 v38, v77, v85
    v_cvt_pk_bf16_f32 v42, v78, v86
    v_cvt_pk_bf16_f32 v66, v79, v87
    v_cvt_pk_bf16_f32 v70, v82, v90
    v_cvt_pk_bf16_f32 v74, v80, v88
    v_lshlrev_b32 v76, 16, v35
    v_and_b32 v84, s25, v35
    v_lshlrev_b32 v77, 16, v39
    v_and_b32 v85, s25, v39
    v_lshlrev_b32 v78, 16, v43
    v_and_b32 v86, s25, v43
    v_lshlrev_b32 v79, 16, v47
    v_and_b32 v87, s25, v47
    v_add_f32 v80, v76, v78
    v_add_f32 v88, v84, v86
    v_add_f32 v81, v77, v79
    v_add_f32 v89, v85, v87
    v_fma_f32 v82, v78, 4.0, v76
    v_fma_f32 v90, v86, 4.0, v84
    v_fma_f32 v83, v79, 4.0, v77
    v_fma_f32 v91, v87, 4.0, v85
    v_add_f32 v77, v80, v81
    v_add_f32 v85, v88, v89
    v_sub_f32 v78, v80, v81
    v_sub_f32 v86, v88, v89
    v_fma_f32 v79, v83, 2.0, v82
    v_fma_f32 v87, v91, 2.0, v90
    v_fma_f32 v82, v83, -2.0, v82
    v_fma_f32 v90, v91, -2.0, v90
    v_fmamk_f32 v80, v76, 0x41700000, v82
    v_fmamk_f32 v88, v84, 0x41700000, v90
    v_fmamk_f32 v80, v81, 0x41200000, v80
    v_fmamk_f32 v88, v89, 0x41200000, v88
    v_cvt_pk_bf16_f32 v39, v77, v85
    v_cvt_pk_bf16_f32 v43, v78, v86
    v_cvt_pk_bf16_f32 v67, v79, v87
    v_cvt_pk_bf16_f32 v71, v82, v90
    v_cvt_pk_bf16_f32 v75, v80, v88
    ds_write_b128 v96, v[64:67] offset:49152
    ds_write_b128 v97, v[68:71] offset:0
    ds_write_b128 v97, v[72:75] offset:16384
    ds_write_b128 v96, v[32:35] offset:0
    ds_write_b128 v96, v[36:39] offset:16384
    ds_write_b128 v96, v[40:43] offset:32768
    ds_write_b128 v98, v[44:47] offset:0
    s_add_u32 s28, s28, 1
    s_waitcnt lgkmcnt(0)
    s_barrier
    s_cmp_lt_u32 s28, 13
    s_cselect_b32 s24, 0, 2130706432
    v_lshlrev_b32 v76, 16, v48
    v_and_b32 v84, s25, v48
    v_lshlrev_b32 v77, 16, v52
    v_and_b32 v85, s25, v52
    v_lshlrev_b32 v78, 16, v56
    v_and_b32 v86, s25, v56
    v_lshlrev_b32 v79, 16, v60
    v_and_b32 v87, s25, v60
    v_add_f32 v80, v76, v78
    v_add_f32 v88, v84, v86
    v_add_f32 v81, v77, v79
    v_add_f32 v89, v85, v87
    v_fma_f32 v82, v78, 4.0, v76
    buffer_load_dwordx4 v[8:11], v94, s[8:11], s24 offen offset:0
    buffer_load_dwordx4 v[24:27], v94, s[8:11], s24 offen offset:64
    v_add_u32 v94, 128, v94
    v_fma_f32 v90, v86, 4.0, v84
    v_fma_f32 v83, v79, 4.0, v77
    v_fma_f32 v91, v87, 4.0, v85
    v_add_f32 v77, v80, v81
    v_add_f32 v85, v88, v89
    v_sub_f32 v78, v80, v81
    v_sub_f32 v86, v88, v89
    v_fma_f32 v79, v83, 2.0, v82
    v_fma_f32 v87, v91, 2.0, v90
    v_fma_f32 v82, v83, -2.0, v82
    v_fma_f32 v90, v91, -2.0, v90
    v_fmamk_f32 v80, v76, 0x41700000, v82
    v_fmamk_f32 v88, v84, 0x41700000, v90
    v_fmamk_f32 v80, v81, 0x41200000, v80
    v_fmamk_f32 v88, v89, 0x41200000, v88
    v_cvt_pk_bf16_f32 v52, v77, v85
    v_cvt_pk_bf16_f32 v56, v78, v86
    v_cvt_pk_bf16_f32 v64, v79, v87
    v_cvt_pk_bf16_f32 v68, v82, v90
    v_cvt_pk_bf16_f32 v72, v80, v88
    v_lshlrev_b32 v76, 16, v49
    v_and_b32 v84, s25, v49
    v_lshlrev_b32 v77, 16, v53
    v_and_b32 v85, s25, v53
    v_lshlrev_b32 v78, 16, v57
    v_and_b32 v86, s25, v57
    v_lshlrev_b32 v79, 16, v61
    v_and_b32 v87, s25, v61
    v_add_f32 v80, v76, v78
    v_add_f32 v88, v84, v86
    v_add_f32 v81, v77, v79
    v_add_f32 v89, v85, v87
    v_fma_f32 v82, v78, 4.0, v76
    v_fma_f32 v90, v86, 4.0, v84
    v_fma_f32 v83, v79, 4.0, v77
    v_fma_f32 v91, v87, 4.0, v85
    v_add_f32 v77, v80, v81
    v_add_f32 v85, v88, v89
    v_sub_f32 v78, v80, v81
    v_sub_f32 v86, v88, v89
    v_fma_f32 v79, v83, 2.0, v82
    v_fma_f32 v87, v91, 2.0, v90
    v_fma_f32 v82, v83, -2.0, v82
    v_fma_f32 v90, v91, -2.0, v90
    v_fmamk_f32 v80, v76, 0x41700000, v82
    v_fmamk_f32 v88, v84, 0x41700000, v90
    v_fmamk_f32 v80, v81, 0x41200000, v80
    v_fmamk_f32 v88, v89, 0x41200000, v88
    v_cvt_pk_bf16_f32 v53, v77, v85
    v_cvt_pk_bf16_f32 v57, v78, v86
    v_cvt_pk_bf16_f32 v65, v79, v87
    v_cvt_pk_bf16_f32 v69, v82, v90
    v_cvt_pk_bf16_f32 v73, v80, v88
    buffer_load_dwordx4 v[12:15], v95, s[8:11], s24 offen offset:0
    buffer_load_dwordx4 v[28:31], v95, s[8:11], s24 offen offset:64
    v_add_u32 v95, 128, v95
    v_lshlrev_b32 v76, 16, v50
    v_and_b32 v84, s25, v50
    v_lshlrev_b32 v77, 16, v54
    v_and_b32 v85, s25, v54
    v_lshlrev_b32 v78, 16, v58
    v_and_b32 v86, s25, v58
    v_lshlrev_b32 v79, 16, v62
    v_and_b32 v87, s25, v62
    v_add_f32 v80, v76, v78
    v_add_f32 v88, v84, v86
    v_add_f32 v81, v77, v79
    v_add_f32 v89, v85, v87
    v_fma_f32 v82, v78, 4.0, v76
    v_fma_f32 v90, v86, 4.0, v84
    v_fma_f32 v83, v79, 4.0, v77
    v_fma_f32 v91, v87, 4.0, v85
    v_add_f32 v77, v80, v81
    v_add_f32 v85, v88, v89
    v_sub_f32 v78, v80, v81
    v_sub_f32 v86, v88, v89
    v_fma_f32 v79, v83, 2.0, v82
    v_fma_f32 v87, v91, 2.0, v90
    v_fma_f32 v82, v83, -2.0, v82
    v_fma_f32 v90, v91, -2.0, v90
    v_fmamk_f32 v80, v76, 0x41700000, v82
    v_fmamk_f32 v88, v84, 0x41700000, v90
    v_fmamk_f32 v80, v81, 0x41200000, v80
    v_fmamk_f32 v88, v89, 0x41200000, v88
    v_cvt_pk_bf16_f32 v54, v77, v85
    v_cvt_pk_bf16_f32 v58, v78, v86
    v_cvt_pk_bf16_f32 v66, v79, v87
    v_cvt_pk_bf16_f32 v70, v82, v90
    v_cvt_pk_bf16_f32 v74, v80, v88
    v_lshlrev_b32 v76, 16, v51
    v_and_b32 v84, s25, v51
    v_lshlrev_b32 v77, 16, v55
    v_and_b32 v85, s25, v55
    v_lshlrev_b32 v78, 16, v59
    v_and_b32 v86, s25, v59
    v_lshlrev_b32 v79, 16, v63
    v_and_b32 v87, s25, v63
    v_add_f32 v80, v76, v78
    v_add_f32 v88, v84, v86
    v_add_f32 v81, v77, v79
    v_add_f32 v89, v85, v87
    v_fma_f32 v82, v78, 4.0, v76
    v_fma_f32 v90, v86, 4.0, v84
    v_fma_f32 v83, v79, 4.0, v77
    v_fma_f32 v91, v87, 4.0, v85
    v_add_f32 v77, v80, v81
    v_add_f32 v85, v88, v89
    v_sub_f32 v78, v80, v81
    v_sub_f32 v86, v88, v89
    v_fma_f32 v79, v83, 2.0, v82
    v_fma_f32 v87, v91, 2.0, v90
    v_fma_f32 v82, v83, -2.0, v82
    v_fma_f32 v90, v91, -2.0, v90
    v_fmamk_f32 v80, v76, 0x41700000, v82
    v_fmamk_f32 v88, v84, 0x41700000, v90
    v_fmamk_f32 v80, v81, 0x41200000, v80
    v_fmamk_f32 v88, v89, 0x41200000, v88
    v_cvt_pk_bf16_f32 v55, v77, v85
    v_cvt_pk_bf16_f32 v59, v78, v86
    v_cvt_pk_bf16_f32 v67, v79, v87
    v_cvt_pk_bf16_f32 v71, v82, v90
    v_cvt_pk_bf16_f32 v75, v80, v88
    ds_write_b128 v96, v[64:67] offset:57344
    ds_write_b128 v97, v[68:71] offset:8192
    ds_write_b128 v97, v[72:75] offset:24576
    ds_write_b128 v96, v[48:51] offset:8192
    ds_write_b128 v96, v[52:55] offset:24576
    ds_write_b128 v96, v[56:59] offset:40960
    ds_write_b128 v98, v[60:63] offset:8704
    s_add_u32 s28, s28, 1
    s_waitcnt lgkmcnt(0)
    s_barrier
    s_cmp_eq_u32 s22, 1
    s_cbranch_scc1 L_conv1_kernel_hlast1
    s_cmp_lt_u32 s28, 13
    s_cselect_b32 s24, 0, 2130706432
    s_waitcnt vmcnt(0)
    v_lshlrev_b32 v76, 16, v0
    v_and_b32 v84, s25, v0
    v_lshlrev_b32 v77, 16, v4
    v_and_b32 v85, s25, v4
    v_lshlrev_b32 v78, 16, v8
    v_and_b32 v86, s25, v8
    v_lshlrev_b32 v79, 16, v12
    v_and_b32 v87, s25, v12
    v_add_f32 v80, v76, v78
    v_add_f32 v88, v84, v86
    v_add_f32 v81, v77, v79
    v_add_f32 v89, v85, v87
    v_fma_f32 v82, v78, 4.0, v76
    v_fma_f32 v90, v86, 4.0, v84
    v_fma_f32 v83, v79, 4.0, v77
    v_fma_f32 v91, v87, 4.0, v85
    v_add_f32 v77, v80, v81
    v_add_f32 v85, v88, v89
    v_sub_f32 v78, v80, v81
    v_sub_f32 v86, v88, v89
    v_fma_f32 v79, v83, 2.0, v82
    v_fma_f32 v87, v91, 2.0, v90
    v_fma_f32 v82, v83, -2.0, v82
    v_fma_f32 v90, v91, -2.0, v90
    v_fmamk_f32 v80, v76, 0x41700000, v82
    v_fmamk_f32 v88, v84, 0x41700000, v90
    v_fmamk_f32 v80, v81, 0x41200000, v80
    v_fmamk_f32 v88, v89, 0x41200000, v88
    v_cvt_pk_bf16_f32 v4, v77, v85
    v_cvt_pk_bf16_f32 v8, v78, v86
    v_cvt_pk_bf16_f32 v64, v79, v87
    v_cvt_pk_bf16_f32 v68, v82, v90
    v_cvt_pk_bf16_f32 v72, v80, v88
    v_lshlrev_b32 v76, 16, v1
    v_and_b32 v84, s25, v1
    v_lshlrev_b32 v77, 16, v5
    v_and_b32 v85, s25, v5
    v_lshlrev_b32 v78, 16, v9
    v_and_b32 v86, s25, v9
    buffer_load_dwordx4 v[32:35], v92, s[8:11], s24 offen offset:0
    buffer_load_dwordx4 v[48:51], v92, s[8:11], s24 offen offset:64
    v_add_u32 v92, 128, v92
    v_lshlrev_b32 v79, 16, v13
    v_and_b32 v87, s25, v13
    v_add_f32 v80, v76, v78
    v_add_f32 v88, v84, v86
    v_add_f32 v81, v77, v79
    v_add_f32 v89, v85, v87
    v_fma_f32 v82, v78, 4.0, v76
    v_fma_f32 v90, v86, 4.0, v84
    v_fma_f32 v83, v79, 4.0, v77
    v_fma_f32 v91, v87, 4.0, v85
    v_add_f32 v77, v80, v81
    v_add_f32 v85, v88, v89
    v_sub_f32 v78, v80, v81
    v_sub_f32 v86, v88, v89
    v_fma_f32 v79, v83, 2.0, v82
    v_fma_f32 v87, v91, 2.0, v90
    v_fma_f32 v82, v83, -2.0, v82
    v_fma_f32 v90, v91, -2.0, v90
    v_fmamk_f32 v80, v76, 0x41700000, v82
    v_fmamk_f32 v88, v84, 0x41700000, v90
    v_fmamk_f32 v80, v81, 0x41200000, v80
    v_fmamk_f32 v88, v89, 0x41200000, v88
    v_cvt_pk_bf16_f32 v5, v77, v85
    v_cvt_pk_bf16_f32 v9, v78, v86
    v_cvt_pk_bf16_f32 v65, v79, v87
    v_cvt_pk_bf16_f32 v69, v82, v90
    v_cvt_pk_bf16_f32 v73, v80, v88
    v_lshlrev_b32 v76, 16, v2
    v_and_b32 v84, s25, v2
    v_lshlrev_b32 v77, 16, v6
    v_and_b32 v85, s25, v6
    v_lshlrev_b32 v78, 16, v10
    v_and_b32 v86, s25, v10
    v_lshlrev_b32 v79, 16, v14
    v_and_b32 v87, s25, v14
    v_add_f32 v80, v76, v78
    v_add_f32 v88, v84, v86
    v_add_f32 v81, v77, v79
    v_add_f32 v89, v85, v87
    v_fma_f32 v82, v78, 4.0, v76
    v_fma_f32 v90, v86, 4.0, v84
    v_fma_f32 v83, v79, 4.0, v77
    v_fma_f32 v91, v87, 4.0, v85
    v_add_f32 v77, v80, v81
    v_add_f32 v85, v88, v89
    v_sub_f32 v78, v80, v81
    v_sub_f32 v86, v88, v89
    v_fma_f32 v79, v83, 2.0, v82
    v_fma_f32 v87, v91, 2.0, v90
    v_fma_f32 v82, v83, -2.0, v82
    v_fma_f32 v90, v91, -2.0, v90
    v_fmamk_f32 v80, v76, 0x41700000, v82
    v_fmamk_f32 v88, v84, 0x41700000, v90
    buffer_load_dwordx4 v[36:39], v93, s[8:11], s24 offen offset:0
    buffer_load_dwordx4 v[52:55], v93, s[8:11], s24 offen offset:64
    v_add_u32 v93, 128, v93
    v_fmamk_f32 v80, v81, 0x41200000, v80
    v_fmamk_f32 v88, v89, 0x41200000, v88
    v_cvt_pk_bf16_f32 v6, v77, v85
    v_cvt_pk_bf16_f32 v10, v78, v86
    v_cvt_pk_bf16_f32 v66, v79, v87
    v_cvt_pk_bf16_f32 v70, v82, v90
    v_cvt_pk_bf16_f32 v74, v80, v88
    v_lshlrev_b32 v76, 16, v3
    v_and_b32 v84, s25, v3
    v_lshlrev_b32 v77, 16, v7
    v_and_b32 v85, s25, v7
    v_lshlrev_b32 v78, 16, v11
    v_and_b32 v86, s25, v11
    v_lshlrev_b32 v79, 16, v15
    v_and_b32 v87, s25, v15
    v_add_f32 v80, v76, v78
    v_add_f32 v88, v84, v86
    v_add_f32 v81, v77, v79
    v_add_f32 v89, v85, v87
    v_fma_f32 v82, v78, 4.0, v76
    v_fma_f32 v90, v86, 4.0, v84
    v_fma_f32 v83, v79, 4.0, v77
    v_fma_f32 v91, v87, 4.0, v85
    v_add_f32 v77, v80, v81
    v_add_f32 v85, v88, v89
    v_sub_f32 v78, v80, v81
    v_sub_f32 v86, v88, v89
    v_fma_f32 v79, v83, 2.0, v82
    v_fma_f32 v87, v91, 2.0, v90
    v_fma_f32 v82, v83, -2.0, v82
    v_fma_f32 v90, v91, -2.0, v90
    v_fmamk_f32 v80, v76, 0x41700000, v82
    v_fmamk_f32 v88, v84, 0x41700000, v90
    v_fmamk_f32 v80, v81, 0x41200000, v80
    v_fmamk_f32 v88, v89, 0x41200000, v88
    v_cvt_pk_bf16_f32 v7, v77, v85
    v_cvt_pk_bf16_f32 v11, v78, v86
    v_cvt_pk_bf16_f32 v67, v79, v87
    v_cvt_pk_bf16_f32 v71, v82, v90
    v_cvt_pk_bf16_f32 v75, v80, v88
    ds_write_b128 v96, v[64:67] offset:49152
    ds_write_b128 v97, v[68:71] offset:0
    ds_write_b128 v97, v[72:75] offset:16384
    ds_write_b128 v96, v[0:3] offset:0
    ds_write_b128 v96, v[4:7] offset:16384
    ds_write_b128 v96, v[8:11] offset:32768
    ds_write_b128 v98, v[12:15] offset:0
    s_add_u32 s28, s28, 1
    s_waitcnt lgkmcnt(0)
    s_barrier
    s_sub_u32 s22, s22, 1
    s_branch L_conv1_kernel_hloop1
L_conv1_kernel_hlast1:
    s_branch L_conv1_kernel_end
L_conv1_kernel_h2:
    ds_write_b128 v96, v[0:3] offset:0
    ds_write_b128 v98, v[12:15] offset:0
    v_lshlrev_b32 v76, 16, v0
    v_and_b32 v84, s25, v0
    v_lshlrev_b32 v77, 16, v4
    v_and_b32 v85, s25, v4
    v_lshlrev_b32 v78, 16, v8
    v_and_b32 v86, s25, v8
    v_lshlrev_b32 v79, 16, v12
    v_and_b32 v87, s25, v12
    v_add_f32 v80, v76, v78
    v_add_f32 v88, v84, v86
    v_add_f32 v81, v77, v79
    v_add_f32 v89, v85, v87
    v_fma_f32 v82, v78, 4.0, v76
    v_fma_f32 v90, v86, 4.0, v84
    v_fma_f32 v83, v79, 4.0, v77
    v_fma_f32 v91, v87, 4.0, v85
    v_add_f32 v77, v80, v81
    v_add_f32 v85, v88, v89
    v_sub_f32 v78, v80, v81
    v_sub_f32 v86, v88, v89
    v_fma_f32 v79, v83, 2.0, v82
    v_fma_f32 v87, v91, 2.0, v90
    v_fma_f32 v82, v83, -2.0, v82
    v_fma_f32 v90, v91, -2.0, v90
    v_fmamk_f32 v80, v76, 0x41700000, v82
    v_fmamk_f32 v88, v84, 0x41700000, v90
    v_fmamk_f32 v80, v81, 0x41200000, v80
    v_fmamk_f32 v88, v89, 0x41200000, v88
    v_cvt_pk_bf16_f32 v4, v77, v85
    v_cvt_pk_bf16_f32 v8, v78, v86
    v_cvt_pk_bf16_f32 v64, v79, v87
    v_cvt_pk_bf16_f32 v68, v82, v90
    v_cvt_pk_bf16_f32 v72, v80, v88
    v_lshlrev_b32 v76, 16, v1
    v_and_b32 v84, s25, v1
    v_lshlrev_b32 v77, 16, v5
    v_and_b32 v85, s25, v5
    v_lshlrev_b32 v78, 16, v9
    v_and_b32 v86, s25, v9
    v_lshlrev_b32 v79, 16, v13
    v_and_b32 v87, s25, v13
    v_add_f32 v80, v76, v78
    v_add_f32 v88, v84, v86
    v_add_f32 v81, v77, v79
    v_add_f32 v89, v85, v87
    v_fma_f32 v82, v78, 4.0, v76
    v_fma_f32 v90, v86, 4.0, v84
    v_fma_f32 v83, v79, 4.0, v77
    v_fma_f32 v91, v87, 4.0, v85
    v_add_f32 v77, v80, v81
    v_add_f32 v85, v88, v89
    v_sub_f32 v78, v80, v81
    v_sub_f32 v86, v88, v89
    v_fma_f32 v79, v83, 2.0, v82
    v_fma_f32 v87, v91, 2.0, v90
    v_fma_f32 v82, v83, -2.0, v82
    v_fma_f32 v90, v91, -2.0, v90
    v_fmamk_f32 v80, v76, 0x41700000, v82
    v_fmamk_f32 v88, v84, 0x41700000, v90
    v_fmamk_f32 v80, v81, 0x41200000, v80
    v_fmamk_f32 v88, v89, 0x41200000, v88
    v_cvt_pk_bf16_f32 v5, v77, v85
    v_cvt_pk_bf16_f32 v9, v78, v86
    v_cvt_pk_bf16_f32 v65, v79, v87
    v_cvt_pk_bf16_f32 v69, v82, v90
    v_cvt_pk_bf16_f32 v73, v80, v88
    v_lshlrev_b32 v76, 16, v2
    v_and_b32 v84, s25, v2
    v_lshlrev_b32 v77, 16, v6
    v_and_b32 v85, s25, v6
    v_lshlrev_b32 v78, 16, v10
    v_and_b32 v86, s25, v10
    v_lshlrev_b32 v79, 16, v14
    v_and_b32 v87, s25, v14
    v_add_f32 v80, v76, v78
    v_add_f32 v88, v84, v86
    v_add_f32 v81, v77, v79
    v_add_f32 v89, v85, v87
    v_fma_f32 v82, v78, 4.0, v76
    v_fma_f32 v90, v86, 4.0, v84
    v_fma_f32 v83, v79, 4.0, v77
    v_fma_f32 v91, v87, 4.0, v85
    v_add_f32 v77, v80, v81
    v_add_f32 v85, v88, v89
    v_sub_f32 v78, v80, v81
    v_sub_f32 v86, v88, v89
    v_fma_f32 v79, v83, 2.0, v82
    v_fma_f32 v87, v91, 2.0, v90
    v_fma_f32 v82, v83, -2.0, v82
    v_fma_f32 v90, v91, -2.0, v90
    v_fmamk_f32 v80, v76, 0x41700000, v82
    v_fmamk_f32 v88, v84, 0x41700000, v90
    v_fmamk_f32 v80, v81, 0x41200000, v80
    v_fmamk_f32 v88, v89, 0x41200000, v88
    v_cvt_pk_bf16_f32 v6, v77, v85
    v_cvt_pk_bf16_f32 v10, v78, v86
    v_cvt_pk_bf16_f32 v66, v79, v87
    v_cvt_pk_bf16_f32 v70, v82, v90
    v_cvt_pk_bf16_f32 v74, v80, v88
    v_lshlrev_b32 v76, 16, v3
    v_and_b32 v84, s25, v3
    v_lshlrev_b32 v77, 16, v7
    v_and_b32 v85, s25, v7
    v_lshlrev_b32 v78, 16, v11
    v_and_b32 v86, s25, v11
    v_lshlrev_b32 v79, 16, v15
    v_and_b32 v87, s25, v15
    v_add_f32 v80, v76, v78
    v_add_f32 v88, v84, v86
    v_add_f32 v81, v77, v79
    v_add_f32 v89, v85, v87
    v_fma_f32 v82, v78, 4.0, v76
    v_fma_f32 v90, v86, 4.0, v84
    v_fma_f32 v83, v79, 4.0, v77
    v_fma_f32 v91, v87, 4.0, v85
    v_add_f32 v77, v80, v81
    v_add_f32 v85, v88, v89
    v_sub_f32 v78, v80, v81
    v_sub_f32 v86, v88, v89
    v_fma_f32 v79, v83, 2.0, v82
    v_fma_f32 v87, v91, 2.0, v90
    v_fma_f32 v82, v83, -2.0, v82
    v_fma_f32 v90, v91, -2.0, v90
    v_fmamk_f32 v80, v76, 0x41700000, v82
    v_fmamk_f32 v88, v84, 0x41700000, v90
    v_fmamk_f32 v80, v81, 0x41200000, v80
    v_fmamk_f32 v88, v89, 0x41200000, v88
    v_cvt_pk_bf16_f32 v7, v77, v85
    v_cvt_pk_bf16_f32 v11, v78, v86
    v_cvt_pk_bf16_f32 v67, v79, v87
    v_cvt_pk_bf16_f32 v71, v82, v90
    v_cvt_pk_bf16_f32 v75, v80, v88
    ds_write_b128 v96, v[64:67] offset:49152
    ds_write_b128 v97, v[68:71] offset:0
    ds_write_b128 v97, v[72:75] offset:16384
    ds_write_b128 v96, v[4:7] offset:16384
    ds_write_b128 v96, v[8:11] offset:32768
    s_waitcnt vmcnt(0)
    s_waitcnt lgkmcnt(0)
    s_barrier
    buffer_load_dwordx4 v[32:35], v92, s[8:11], s24 offen offset:0
    buffer_load_dwordx4 v[48:51], v92, s[8:11], s24 offen offset:64
    v_add_u32 v92, 128, v92
    buffer_load_dwordx4 v[36:39], v93, s[8:11], s24 offen offset:0
    buffer_load_dwordx4 v[52:55], v93, s[8:11], s24 offen offset:64
    v_add_u32 v93, 128, v93
    buffer_load_dwordx4 v[40:43], v94, s[8:11], s24 offen offset:0
    buffer_load_dwordx4 v[56:59], v94, s[8:11], s24 offen offset:64
    v_add_u32 v94, 128, v94
    buffer_load_dwordx4 v[44:47], v95, s[8:11], s24 offen offset:0
    buffer_load_dwordx4 v[60:63], v95, s[8:11], s24 offen offset:64
    v_add_u32 v95, 128, v95
    s_setprio 0
    v_lshlrev_b32 v76, 16, v16
    v_and_b32 v84, s25, v16
    v_lshlrev_b32 v77, 16, v20
    v_and_b32 v85, s25, v20
    v_lshlrev_b32 v78, 16, v24
    v_and_b32 v86, s25, v24
    v_lshlrev_b32 v79, 16, v28
    v_and_b32 v87, s25, v28
    v_add_f32 v80, v76, v78
    v_add_f32 v88, v84, v86
    v_add_f32 v81, v77, v79
    v_add_f32 v89, v85, v87
    v_fma_f32 v82, v78, 4.0, v76
    v_fma_f32 v90, v86, 4.0, v84
    v_fma_f32 v83, v79, 4.0, v77
    v_fma_f32 v91, v87, 4.0, v85
    v_add_f32 v77, v80, v81
    v_add_f32 v85, v88, v89
    v_sub_f32 v78, v80, v81
    v_sub_f32 v86, v88, v89
    v_fma_f32 v79, v83, 2.0, v82
    v_fma_f32 v87, v91, 2.0, v90
    v_fma_f32 v82, v83, -2.0, v82
    v_fma_f32 v90, v91, -2.0, v90
    v_fmamk_f32 v80, v76, 0x41700000, v82
    v_fmamk_f32 v88, v84, 0x41700000, v90
    v_fmamk_f32 v80, v81, 0x41200000, v80
    v_fmamk_f32 v88, v89, 0x41200000, v88
    v_cvt_pk_bf16_f32 v20, v77, v85
    v_cvt_pk_bf16_f32 v24, v78, v86
    v_cvt_pk_bf16_f32 v64, v79, v87
    v_cvt_pk_bf16_f32 v68, v82, v90
    v_cvt_pk_bf16_f32 v72, v80, v88
    v_lshlrev_b32 v76, 16, v17
    v_and_b32 v84, s25, v17
    v_lshlrev_b32 v77, 16, v21
    v_and_b32 v85, s25, v21
    v_lshlrev_b32 v78, 16, v25
    v_and_b32 v86, s25, v25
    v_lshlrev_b32 v79, 16, v29
    v_and_b32 v87, s25, v29
    v_add_f32 v80, v76, v78
    v_add_f32 v88, v84, v86
    v_add_f32 v81, v77, v79
    v_add_f32 v89, v85, v87
    v_fma_f32 v82, v78, 4.0, v76
    v_fma_f32 v90, v86, 4.0, v84
    v_fma_f32 v83, v79, 4.0, v77
    v_fma_f32 v91, v87, 4.0, v85
    v_add_f32 v77, v80, v81
    v_add_f32 v85, v88, v89
    v_sub_f32 v78, v80, v81
    v_sub_f32 v86, v88, v89
    v_fma_f32 v79, v83, 2.0, v82
    v_fma_f32 v87, v91, 2.0, v90
    v_fma_f32 v82, v83, -2.0, v82
    v_fma_f32 v90, v91, -2.0, v90
    v_fmamk_f32 v80, v76, 0x41700000, v82
    v_fmamk_f32 v88, v84, 0x41700000, v90
    v_fmamk_f32 v80, v81, 0x41200000, v80
    v_fmamk_f32 v88, v89, 0x41200000, v88
    v_cvt_pk_bf16_f32 v21, v77, v85
    v_cvt_pk_bf16_f32 v25, v78, v86
    v_cvt_pk_bf16_f32 v65, v79, v87
    v_cvt_pk_bf16_f32 v69, v82, v90
    v_cvt_pk_bf16_f32 v73, v80, v88
    v_lshlrev_b32 v76, 16, v18
    v_and_b32 v84, s25, v18
    v_lshlrev_b32 v77, 16, v22
    v_and_b32 v85, s25, v22
    v_lshlrev_b32 v78, 16, v26
    v_and_b32 v86, s25, v26
    v_lshlrev_b32 v79, 16, v30
    v_and_b32 v87, s25, v30
    v_add_f32 v80, v76, v78
    v_add_f32 v88, v84, v86
    v_add_f32 v81, v77, v79
    v_add_f32 v89, v85, v87
    v_fma_f32 v82, v78, 4.0, v76
    v_fma_f32 v90, v86, 4.0, v84
    v_fma_f32 v83, v79, 4.0, v77
    v_fma_f32 v91, v87, 4.0, v85
    v_add_f32 v77, v80, v81
    v_add_f32 v85, v88, v89
    v_sub_f32 v78, v80, v81
    v_sub_f32 v86, v88, v89
    v_fma_f32 v79, v83, 2.0, v82
    v_fma_f32 v87, v91, 2.0, v90
    v_fma_f32 v82, v83, -2.0, v82
    v_fma_f32 v90, v91, -2.0, v90
    v_fmamk_f32 v80, v76, 0x41700000, v82
    v_fmamk_f32 v88, v84, 0x41700000, v90
    v_fmamk_f32 v80, v81, 0x41200000, v80
    v_fmamk_f32 v88, v89, 0x41200000, v88
    v_cvt_pk_bf16_f32 v22, v77, v85
    v_cvt_pk_bf16_f32 v26, v78, v86
    v_cvt_pk_bf16_f32 v66, v79, v87
    v_cvt_pk_bf16_f32 v70, v82, v90
    v_cvt_pk_bf16_f32 v74, v80, v88
    v_lshlrev_b32 v76, 16, v19
    v_and_b32 v84, s25, v19
    v_lshlrev_b32 v77, 16, v23
    v_and_b32 v85, s25, v23
    v_lshlrev_b32 v78, 16, v27
    v_and_b32 v86, s25, v27
    v_lshlrev_b32 v79, 16, v31
    v_and_b32 v87, s25, v31
    v_add_f32 v80, v76, v78
    v_add_f32 v88, v84, v86
    v_add_f32 v81, v77, v79
    v_add_f32 v89, v85, v87
    v_fma_f32 v82, v78, 4.0, v76
    v_fma_f32 v90, v86, 4.0, v84
    v_fma_f32 v83, v79, 4.0, v77
    v_fma_f32 v91, v87, 4.0, v85
    v_add_f32 v77, v80, v81
    v_add_f32 v85, v88, v89
    v_sub_f32 v78, v80, v81
    v_sub_f32 v86, v88, v89
    v_fma_f32 v79, v83, 2.0, v82
    v_fma_f32 v87, v91, 2.0, v90
    v_fma_f32 v82, v83, -2.0, v82
    v_fma_f32 v90, v91, -2.0, v90
    v_fmamk_f32 v80, v76, 0x41700000, v82
    v_fmamk_f32 v88, v84, 0x41700000, v90
    v_fmamk_f32 v80, v81, 0x41200000, v80
    v_fmamk_f32 v88, v89, 0x41200000, v88
    v_cvt_pk_bf16_f32 v23, v77, v85
    v_cvt_pk_bf16_f32 v27, v78, v86
    v_cvt_pk_bf16_f32 v67, v79, v87
    v_cvt_pk_bf16_f32 v71, v82, v90
    v_cvt_pk_bf16_f32 v75, v80, v88
L_conv1_kernel_hloop2:
    s_cmp_lt_u32 s28, 12
    s_cselect_b32 s24, 0, 2130706432
    ds_write_b128 v96, v[64:67] offset:57344
    ds_write_b128 v97, v[68:71] offset:8192
    ds_write_b128 v97, v[72:75] offset:24576
    ds_write_b128 v96, v[16:19] offset:8192
    ds_write_b128 v96, v[20:23] offset:24576
    ds_write_b128 v96, v[24:27] offset:40960
    ds_write_b128 v98, v[28:31] offset:8704
    s_waitcnt vmcnt(0)
    v_lshlrev_b32 v76, 16, v32
    v_and_b32 v84, s25, v32
    v_lshlrev_b32 v77, 16, v36
    v_and_b32 v85, s25, v36
    v_lshlrev_b32 v78, 16, v40
    v_and_b32 v86, s25, v40
    v_lshlrev_b32 v79, 16, v44
    v_and_b32 v87, s25, v44
    v_add_f32 v80, v76, v78
    v_add_f32 v88, v84, v86
    v_add_f32 v81, v77, v79
    v_add_f32 v89, v85, v87
    v_fma_f32 v82, v78, 4.0, v76
    v_fma_f32 v90, v86, 4.0, v84
    v_fma_f32 v83, v79, 4.0, v77
    v_fma_f32 v91, v87, 4.0, v85
    v_add_f32 v77, v80, v81
    v_add_f32 v85, v88, v89
    v_sub_f32 v78, v80, v81
    v_sub_f32 v86, v88, v89
    v_fma_f32 v79, v83, 2.0, v82
    v_fma_f32 v87, v91, 2.0, v90
    v_fma_f32 v82, v83, -2.0, v82
    v_fma_f32 v90, v91, -2.0, v90
    v_fmamk_f32 v80, v76, 0x41700000, v82
    v_fmamk_f32 v88, v84, 0x41700000, v90
    buffer_load_dwordx4 v[0:3], v92, s[8:11], s24 offen offset:0
    buffer_load_dwordx4 v[16:19], v92, s[8:11], s24 offen offset:64
    v_add_u32 v92, 128, v92
    v_fmamk_f32 v80, v81, 0x41200000, v80
    v_fmamk_f32 v88, v89, 0x41200000, v88
    v_cvt_pk_bf16_f32 v36, v77, v85
    v_cvt_pk_bf16_f32 v40, v78, v86
    v_cvt_pk_bf16_f32 v64, v79, v87
    v_cvt_pk_bf16_f32 v68, v82, v90
    v_cvt_pk_bf16_f32 v72, v80, v88
    v_lshlrev_b32 v76, 16, v33
    v_and_b32 v84, s25, v33
    v_lshlrev_b32 v77, 16, v37
    v_and_b32 v85, s25, v37
    v_lshlrev_b32 v78, 16, v41
    v_and_b32 v86, s25, v41
    v_lshlrev_b32 v79, 16, v45
    v_and_b32 v87, s25, v45
    v_add_f32 v80, v76, v78
    v_add_f32 v88, v84, v86
    v_add_f32 v81, v77, v79
    v_add_f32 v89, v85, v87
    v_fma_f32 v82, v78, 4.0, v76
    v_fma_f32 v90, v86, 4.0, v84
    v_fma_f32 v83, v79, 4.0, v77
    v_fma_f32 v91, v87, 4.0, v85
    v_add_f32 v77, v80, v81
    v_add_f32 v85, v88, v89
    v_sub_f32 v78, v80, v81
    v_sub_f32 v86, v88, v89
    v_fma_f32 v79, v83, 2.0, v82
    v_fma_f32 v87, v91, 2.0, v90
    v_fma_f32 v82, v83, -2.0, v82
    v_fma_f32 v90, v91, -2.0, v90
    v_fmamk_f32 v80, v76, 0x41700000, v82
    v_fmamk_f32 v88, v84, 0x41700000, v90
    v_fmamk_f32 v80, v81, 0x41200000, v80
    v_fmamk_f32 v88, v89, 0x41200000, v88
    v_cvt_pk_bf16_f32 v37, v77, v85
    v_cvt_pk_bf16_f32 v41, v78, v86
    v_cvt_pk_bf16_f32 v65, v79, v87
    v_cvt_pk_bf16_f32 v69, v82, v90
    v_cvt_pk_bf16_f32 v73, v80, v88
    v_lshlrev_b32 v76, 16, v34
    v_and_b32 v84, s25, v34
    v_lshlrev_b32 v77, 16, v38
    v_and_b32 v85, s25, v38
    v_lshlrev_b32 v78, 16, v42
    v_and_b32 v86, s25, v42
    v_lshlrev_b32 v79, 16, v46
    v_and_b32 v87, s25, v46
    v_add_f32 v80, v76, v78
    v_add_f32 v88, v84, v86
    v_add_f32 v81, v77, v79
    v_add_f32 v89, v85, v87
    v_fma_f32 v82, v78, 4.0, v76
    buffer_load_dwordx4 v[4:7], v93, s[8:11], s24 offen offset:0
    buffer_load_dwordx4 v[20:23], v93, s[8:11], s24 offen offset:64
    v_add_u32 v93, 128, v93
    v_fma_f32 v90, v86, 4.0, v84
    v_fma_f32 v83, v79, 4.0, v77
    v_fma_f32 v91, v87, 4.0, v85
    v_add_f32 v77, v80, v81
    v_add_f32 v85, v88, v89
    v_sub_f32 v78, v80, v81
    v_sub_f32 v86, v88, v89
    v_fma_f32 v79, v83, 2.0, v82
    v_fma_f32 v87, v91, 2.0, v90
    v_fma_f32 v82, v83, -2.0, v82
    v_fma_f32 v90, v91, -2.0, v90
    v_fmamk_f32 v80, v76, 0x41700000, v82
    v_fmamk_f32 v88, v84, 0x41700000, v90
    v_fmamk_f32 v80, v81, 0x41200000, v80
    v_fmamk_f32 v88, v89, 0x41200000, v88
    v_cvt_pk_bf16_f32 v38, v77, v85
    v_cvt_pk_bf16_f32 v42, v78, v86
    v_cvt_pk_bf16_f32 v66, v79, v87
    v_cvt_pk_bf16_f32 v70, v82, v90
    v_cvt_pk_bf16_f32 v74, v80, v88
    v_lshlrev_b32 v76, 16, v35
    v_and_b32 v84, s25, v35
    v_lshlrev_b32 v77, 16, v39
    v_and_b32 v85, s25, v39
    v_lshlrev_b32 v78, 16, v43
    v_and_b32 v86, s25, v43
    v_lshlrev_b32 v79, 16, v47
    v_and_b32 v87, s25, v47
    v_add_f32 v80, v76, v78
    v_add_f32 v88, v84, v86
    v_add_f32 v81, v77, v79
    v_add_f32 v89, v85, v87
    v_fma_f32 v82, v78, 4.0, v76
    v_fma_f32 v90, v86, 4.0, v84
    v_fma_f32 v83, v79, 4.0, v77
    v_fma_f32 v91, v87, 4.0, v85
    v_add_f32 v77, v80, v81
    v_add_f32 v85, v88, v89
    v_sub_f32 v78, v80, v81
    v_sub_f32 v86, v88, v89
    v_fma_f32 v79, v83, 2.0, v82
    v_fma_f32 v87, v91, 2.0, v90
    v_fma_f32 v82, v83, -2.0, v82
    v_fma_f32 v90, v91, -2.0, v90
    v_fmamk_f32 v80, v76, 0x41700000, v82
    v_fmamk_f32 v88, v84, 0x41700000, v90
    v_fmamk_f32 v80, v81, 0x41200000, v80
    v_fmamk_f32 v88, v89, 0x41200000, v88
    v_cvt_pk_bf16_f32 v39, v77, v85
    v_cvt_pk_bf16_f32 v43, v78, v86
    v_cvt_pk_bf16_f32 v67, v79, v87
    v_cvt_pk_bf16_f32 v71, v82, v90
    v_cvt_pk_bf16_f32 v75, v80, v88
    s_add_u32 s28, s28, 1
    s_waitcnt lgkmcnt(0)
    s_barrier
    s_cmp_lt_u32 s28, 12
    s_cselect_b32 s24, 0, 2130706432
    ds_write_b128 v96, v[64:67] offset:49152
    ds_write_b128 v97, v[68:71] offset:0
    ds_write_b128 v97, v[72:75] offset:16384
    ds_write_b128 v96, v[32:35] offset:0
    ds_write_b128 v96, v[36:39] offset:16384
    ds_write_b128 v96, v[40:43] offset:32768
    ds_write_b128 v98, v[44:47] offset:0
    v_lshlrev_b32 v76, 16, v48
    v_and_b32 v84, s25, v48
    buffer_load_dwordx4 v[8:11], v94, s[8:11], s24 offen offset:0
    buffer_load_dwordx4 v[24:27], v94, s[8:11], s24 offen offset:64
    v_add_u32 v94, 128, v94
    v_lshlrev_b32 v77, 16, v52
    v_and_b32 v85, s25, v52
    v_lshlrev_b32 v78, 16, v56
    v_and_b32 v86, s25, v56
    v_lshlrev_b32 v79, 16, v60
    v_and_b32 v87, s25, v60
    v_add_f32 v80, v76, v78
    v_add_f32 v88, v84, v86
    v_add_f32 v81, v77, v79
    v_add_f32 v89, v85, v87
    v_fma_f32 v82, v78, 4.0, v76
    v_fma_f32 v90, v86, 4.0, v84
    v_fma_f32 v83, v79, 4.0, v77
    v_fma_f32 v91, v87, 4.0, v85
    v_add_f32 v77, v80, v81
    v_add_f32 v85, v88, v89
    v_sub_f32 v78, v80, v81
    buffer_load_dwordx4 v[12:15], v95, s[8:11], s24 offen offset:0
    buffer_load_dwordx4 v[28:31], v95, s[8:11], s24 offen offset:64
    v_add_u32 v95, 128, v95
    v_sub_f32 v86, v88, v89
    v_fma_f32 v79, v83, 2.0, v82
    v_fma_f32 v87, v91, 2.0, v90
    v_fma_f32 v82, v83, -2.0, v82
    v_fma_f32 v90, v91, -2.0, v90
    v_fmamk_f32 v80, v76, 0x41700000, v82
    v_fmamk_f32 v88, v84, 0x41700000, v90
    v_fmamk_f32 v80, v81, 0x41200000, v80
    v_fmamk_f32 v88, v89, 0x41200000, v88
    v_cvt_pk_bf16_f32 v52, v77, v85
    v_cvt_pk_bf16_f32 v56, v78, v86
    v_cvt_pk_bf16_f32 v64, v79, v87
    v_cvt_pk_bf16_f32 v68, v82, v90
    v_cvt_pk_bf16_f32 v72, v80, v88
    v_lshlrev_b32 v76, 16, v49
    v_and_b32 v84, s25, v49
    v_lshlrev_b32 v77, 16, v53
    v_and_b32 v85, s25, v53
    v_lshlrev_b32 v78, 16, v57
    v_and_b32 v86, s25, v57
    v_lshlrev_b32 v79, 16, v61
    v_and_b32 v87, s25, v61
    v_add_f32 v80, v76, v78
    v_add_f32 v88, v84, v86
    v_add_f32 v81, v77, v79
    v_add_f32 v89, v85, v87
    v_fma_f32 v82, v78, 4.0, v76
    v_fma_f32 v90, v86, 4.0, v84
    v_fma_f32 v83, v79, 4.0, v77
    v_fma_f32 v91, v87, 4.0, v85
    v_add_f32 v77, v80, v81
    v_add_f32 v85, v88, v89
    v_sub_f32 v78, v80, v81
    v_sub_f32 v86, v88, v89
    v_fma_f32 v79, v83, 2.0, v82
    v_fma_f32 v87, v91, 2.0, v90
    v_fma_f32 v82, v83, -2.0, v82
    v_fma_f32 v90, v91, -2.0, v90
    v_fmamk_f32 v80, v76, 0x41700000, v82
    v_fmamk_f32 v88, v84, 0x41700000, v90
    v_fmamk_f32 v80, v81, 0x41200000, v80
    v_fmamk_f32 v88, v89, 0x41200000, v88
    v_cvt_pk_bf16_f32 v53, v77, v85
    v_cvt_pk_bf16_f32 v57, v78, v86
    v_cvt_pk_bf16_f32 v65, v79, v87
    v_cvt_pk_bf16_f32 v69, v82, v90
    v_cvt_pk_bf16_f32 v73, v80, v88
    v_lshlrev_b32 v76, 16, v50
    v_and_b32 v84, s25, v50
    v_lshlrev_b32 v77, 16, v54
    v_and_b32 v85, s25, v54
    v_lshlrev_b32 v78, 16, v58
    v_and_b32 v86, s25, v58
    v_lshlrev_b32 v79, 16, v62
    v_and_b32 v87, s25, v62
    v_add_f32 v80, v76, v78
    v_add_f32 v88, v84, v86
    v_add_f32 v81, v77, v79
    v_add_f32 v89, v85, v87
    v_fma_f32 v82, v78, 4.0, v76
    v_fma_f32 v90, v86, 4.0, v84
    v_fma_f32 v83, v79, 4.0, v77
    v_fma_f32 v91, v87, 4.0, v85
    v_add_f32 v77, v80, v81
    v_add_f32 v85, v88, v89
    v_sub_f32 v78, v80, v81
    v_sub_f32 v86, v88, v89
    v_fma_f32 v79, v83, 2.0, v82
    v_fma_f32 v87, v91, 2.0, v90
    v_fma_f32 v82, v83, -2.0, v82
    v_fma_f32 v90, v91, -2.0, v90
    v_fmamk_f32 v80, v76, 0x41700000, v82
    v_fmamk_f32 v88, v84, 0x41700000, v90
    v_fmamk_f32 v80, v81, 0x41200000, v80
    v_fmamk_f32 v88, v89, 0x41200000, v88
    v_cvt_pk_bf16_f32 v54, v77, v85
    v_cvt_pk_bf16_f32 v58, v78, v86
    v_cvt_pk_bf16_f32 v66, v79, v87
    v_cvt_pk_bf16_f32 v70, v82, v90
    v_cvt_pk_bf16_f32 v74, v80, v88
    v_lshlrev_b32 v76, 16, v51
    v_and_b32 v84, s25, v51
    v_lshlrev_b32 v77, 16, v55
    v_and_b32 v85, s25, v55
    v_lshlrev_b32 v78, 16, v59
    v_and_b32 v86, s25, v59
    v_lshlrev_b32 v79, 16, v63
    v_and_b32 v87, s25, v63
    v_add_f32 v80, v76, v78
    v_add_f32 v88, v84, v86
    v_add_f32 v81, v77, v79
    v_add_f32 v89, v85, v87
    v_fma_f32 v82, v78, 4.0, v76
    v_fma_f32 v90, v86, 4.0, v84
    v_fma_f32 v83, v79, 4.0, v77
    v_fma_f32 v91, v87, 4.0, v85
    v_add_f32 v77, v80, v81
    v_add_f32 v85, v88, v89
    v_sub_f32 v78, v80, v81
    v_sub_f32 v86, v88, v89
    v_fma_f32 v79, v83, 2.0, v82
    v_fma_f32 v87, v91, 2.0, v90
    v_fma_f32 v82, v83, -2.0, v82
    v_fma_f32 v90, v91, -2.0, v90
    v_fmamk_f32 v80, v76, 0x41700000, v82
    v_fmamk_f32 v88, v84, 0x41700000, v90
    v_fmamk_f32 v80, v81, 0x41200000, v80
    v_fmamk_f32 v88, v89, 0x41200000, v88
    v_cvt_pk_bf16_f32 v55, v77, v85
    v_cvt_pk_bf16_f32 v59, v78, v86
    v_cvt_pk_bf16_f32 v67, v79, v87
    v_cvt_pk_bf16_f32 v71, v82, v90
    v_cvt_pk_bf16_f32 v75, v80, v88
    s_add_u32 s28, s28, 1
    s_waitcnt lgkmcnt(0)
    s_barrier
    s_cmp_eq_u32 s22, 1
    s_cbranch_scc1 L_conv1_kernel_hlast2
    s_cmp_lt_u32 s28, 12
    s_cselect_b32 s24, 0, 2130706432
    ds_write_b128 v96, v[64:67] offset:57344
    ds_write_b128 v97, v[68:71] offset:8192
    ds_write_b128 v97, v[72:75] offset:24576
    ds_write_b128 v96, v[48:51] offset:8192
    ds_write_b128 v96, v[52:55] offset:24576
    ds_write_b128 v96, v[56:59] offset:40960
    ds_write_b128 v98, v[60:63] offset:8704
    s_waitcnt vmcnt(0)
    v_lshlrev_b32 v76, 16, v0
    v_and_b32 v84, s25, v0
    v_lshlrev_b32 v77, 16, v4
    v_and_b32 v85, s25, v4
    v_lshlrev_b32 v78, 16, v8
    v_and_b32 v86, s25, v8
    v_lshlrev_b32 v79, 16, v12
    v_and_b32 v87, s25, v12
    v_add_f32 v80, v76, v78
    v_add_f32 v88, v84, v86
    v_add_f32 v81, v77, v79
    v_add_f32 v89, v85, v87
    v_fma_f32 v82, v78, 4.0, v76
    v_fma_f32 v90, v86, 4.0, v84
    v_fma_f32 v83, v79, 4.0, v77
    v_fma_f32 v91, v87, 4.0, v85
    v_add_f32 v77, v80, v81
    v_add_f32 v85, v88, v89
    v_sub_f32 v78, v80, v81
    v_sub_f32 v86, v88, v89
    v_fma_f32 v79, v83, 2.0, v82
    v_fma_f32 v87, v91, 2.0, v90
    v_fma_f32 v82, v83, -2.0, v82
    v_fma_f32 v90, v91, -2.0, v90
    v_fmamk_f32 v80, v76, 0x41700000, v82
    v_fmamk_f32 v88, v84, 0x41700000, v90
    buffer_load_dwordx4 v[32:35], v92, s[8:11], s24 offen offset:0
    buffer_load_dwordx4 v[48:51], v92, s[8:11], s24 offen offset:64
    v_add_u32 v92, 128, v92
    v_fmamk_f32 v80, v81, 0x41200000, v80
    v_fmamk_f32 v88, v89, 0x41200000, v88
    v_cvt_pk_bf16_f32 v4, v77, v85
    v_cvt_pk_bf16_f32 v8, v78, v86
    v_cvt_pk_bf16_f32 v64, v79, v87
    v_cvt_pk_bf16_f32 v68, v82, v90
    v_cvt_pk_bf16_f32 v72, v80, v88
    v_lshlrev_b32 v76, 16, v1
    v_and_b32 v84, s25, v1
    v_lshlrev_b32 v77, 16, v5
    v_and_b32 v85, s25, v5
    v_lshlrev_b32 v78, 16, v9
    v_and_b32 v86, s25, v9
    v_lshlrev_b32 v79, 16, v13
    v_and_b32 v87, s25, v13
    v_add_f32 v80, v76, v78
    v_add_f32 v88, v84, v86
    v_add_f32 v81, v77, v79
    v_add_f32 v89, v85, v87
    v_fma_f32 v82, v78, 4.0, v76
    v_fma_f32 v90, v86, 4.0, v84
    v_fma_f32 v83, v79, 4.0, v77
    v_fma_f32 v91, v87, 4.0, v85
    v_add_f32 v77, v80, v81
    v_add_f32 v85, v88, v89
    v_sub_f32 v78, v80, v81
    v_sub_f32 v86, v88, v89
    v_fma_f32 v79, v83, 2.0, v82
    v_fma_f32 v87, v91, 2.0, v90
    v_fma_f32 v82, v83, -2.0, v82
    v_fma_f32 v90, v91, -2.0, v90
    v_fmamk_f32 v80, v76, 0x41700000, v82
    v_fmamk_f32 v88, v84, 0x41700000, v90
    v_fmamk_f32 v80, v81, 0x41200000, v80
    v_fmamk_f32 v88, v89, 0x41200000, v88
    v_cvt_pk_bf16_f32 v5, v77, v85
    v_cvt_pk_bf16_f32 v9, v78, v86
    v_cvt_pk_bf16_f32 v65, v79, v87
    v_cvt_pk_bf16_f32 v69, v82, v90
    v_cvt_pk_bf16_f32 v73, v80, v88
    v_lshlrev_b32 v76, 16, v2
    v_and_b32 v84, s25, v2
    v_lshlrev_b32 v77, 16, v6
    v_and_b32 v85, s25, v6
    v_lshlrev_b32 v78, 16, v10
    v_and_b32 v86, s25, v10
    v_lshlrev_b32 v79, 16, v14
    v_and_b32 v87, s25, v14
    v_add_f32 v80, v76, v78
    v_add_f32 v88, v84, v86
    v_add_f32 v81, v77, v79
    v_add_f32 v89, v85, v87
    v_fma_f32 v82, v78, 4.0, v76
    buffer_load_dwordx4 v[36:39], v93, s[8:11], s24 offen offset:0
    buffer_load_dwordx4 v[52:55], v93, s[8:11], s24 offen offset:64
    v_add_u32 v93, 128, v93
    v_fma_f32 v90, v86, 4.0, v84
    v_fma_f32 v83, v79, 4.0, v77
    v_fma_f32 v91, v87, 4.0, v85
    v_add_f32 v77, v80, v81
    v_add_f32 v85, v88, v89
    v_sub_f32 v78, v80, v81
    v_sub_f32 v86, v88, v89
    v_fma_f32 v79, v83, 2.0, v82
    v_fma_f32 v87, v91, 2.0, v90
    v_fma_f32 v82, v83, -2.0, v82
    v_fma_f32 v90, v91, -2.0, v90
    v_fmamk_f32 v80, v76, 0x41700000, v82
    v_fmamk_f32 v88, v84, 0x41700000, v90
    v_fmamk_f32 v80, v81, 0x41200000, v80
    v_fmamk_f32 v88, v89, 0x41200000, v88
    v_cvt_pk_bf16_f32 v6, v77, v85
    v_cvt_pk_bf16_f32 v10, v78, v86
    v_cvt_pk_bf16_f32 v66, v79, v87
    v_cvt_pk_bf16_f32 v70, v82, v90
    v_cvt_pk_bf16_f32 v74, v80, v88
    v_lshlrev_b32 v76, 16, v3
    v_and_b32 v84, s25, v3
    v_lshlrev_b32 v77, 16, v7
    v_and_b32 v85, s25, v7
    v_lshlrev_b32 v78, 16, v11
    v_and_b32 v86, s25, v11
    v_lshlrev_b32 v79, 16, v15
    v_and_b32 v87, s25, v15
    v_add_f32 v80, v76, v78
    v_add_f32 v88, v84, v86
    v_add_f32 v81, v77, v79
    v_add_f32 v89, v85, v87
    v_fma_f32 v82, v78, 4.0, v76
    v_fma_f32 v90, v86, 4.0, v84
    v_fma_f32 v83, v79, 4.0, v77
    v_fma_f32 v91, v87, 4.0, v85
    v_add_f32 v77, v80, v81
    v_add_f32 v85, v88, v89
    v_sub_f32 v78, v80, v81
    v_sub_f32 v86, v88, v89
    v_fma_f32 v79, v83, 2.0, v82
    v_fma_f32 v87, v91, 2.0, v90
    v_fma_f32 v82, v83, -2.0, v82
    v_fma_f32 v90, v91, -2.0, v90
    v_fmamk_f32 v80, v76, 0x41700000, v82
    v_fmamk_f32 v88, v84, 0x41700000, v90
    v_fmamk_f32 v80, v81, 0x41200000, v80
    v_fmamk_f32 v88, v89, 0x41200000, v88
    v_cvt_pk_bf16_f32 v7, v77, v85
    v_cvt_pk_bf16_f32 v11, v78, v86
    v_cvt_pk_bf16_f32 v67, v79, v87
    v_cvt_pk_bf16_f32 v71, v82, v90
    v_cvt_pk_bf16_f32 v75, v80, v88
    s_add_u32 s28, s28, 1
    s_waitcnt lgkmcnt(0)
    s_barrier
    s_cmp_lt_u32 s28, 12
    s_cselect_b32 s24, 0, 2130706432
    ds_write_b128 v96, v[64:67] offset:49152
    ds_write_b128 v97, v[68:71] offset:0
    ds_write_b128 v97, v[72:75] offset:16384
    ds_write_b128 v96, v[0:3] offset:0
    ds_write_b128 v96, v[4:7] offset:16384
    ds_write_b128 v96, v[8:11] offset:32768
    ds_write_b128 v98, v[12:15] offset:0
    v_lshlrev_b32 v76, 16, v16
    v_and_b32 v84, s25, v16
    buffer_load_dwordx4 v[40:43], v94, s[8:11], s24 offen offset:0
    buffer_load_dwordx4 v[56:59], v94, s[8:11], s24 offen offset:64
    v_add_u32 v94, 128, v94
    v_lshlrev_b32 v77, 16, v20
    v_and_b32 v85, s25, v20
    v_lshlrev_b32 v78, 16, v24
    v_and_b32 v86, s25, v24
    v_lshlrev_b32 v79, 16, v28
    v_and_b32 v87, s25, v28
    v_add_f32 v80, v76, v78
    v_add_f32 v88, v84, v86
    v_add_f32 v81, v77, v79
    v_add_f32 v89, v85, v87
    v_fma_f32 v82, v78, 4.0, v76
    v_fma_f32 v90, v86, 4.0, v84
    v_fma_f32 v83, v79, 4.0, v77
    v_fma_f32 v91, v87, 4.0, v85
    v_add_f32 v77, v80, v81
    v_add_f32 v85, v88, v89
    v_sub_f32 v78, v80, v81
    buffer_load_dwordx4 v[44:47], v95, s[8:11], s24 offen offset:0
    buffer_load_dwordx4 v[60:63], v95, s[8:11], s24 offen offset:64
    v_add_u32 v95, 128, v95
    v_sub_f32 v86, v88, v89
    v_fma_f32 v79, v83, 2.0, v82
    v_fma_f32 v87, v91, 2.0, v90
    v_fma_f32 v82, v83, -2.0, v82
    v_fma_f32 v90, v91, -2.0, v90
    v_fmamk_f32 v80, v76, 0x41700000, v82
    v_fmamk_f32 v88, v84, 0x41700000, v90
    v_fmamk_f32 v80, v81, 0x41200000, v80
    v_fmamk_f32 v88, v89, 0x41200000, v88
    v_cvt_pk_bf16_f32 v20, v77, v85
    v_cvt_pk_bf16_f32 v24, v78, v86
    v_cvt_pk_bf16_f32 v64, v79, v87
    v_cvt_pk_bf16_f32 v68, v82, v90
    v_cvt_pk_bf16_f32 v72, v80, v88
    v_lshlrev_b32 v76, 16, v17
    v_and_b32 v84, s25, v17
    v_lshlrev_b32 v77, 16, v21
    v_and_b32 v85, s25, v21
    v_lshlrev_b32 v78, 16, v25
    v_and_b32 v86, s25, v25
    v_lshlrev_b32 v79, 16, v29
    v_and_b32 v87, s25, v29
    v_add_f32 v80, v76, v78
    v_add_f32 v88, v84, v86
    v_add_f32 v81, v77, v79
    v_add_f32 v89, v85, v87
    v_fma_f32 v82, v78, 4.0, v76
    v_fma_f32 v90, v86, 4.0, v84
    v_fma_f32 v83, v79, 4.0, v77
    v_fma_f32 v91, v87, 4.0, v85
    v_add_f32 v77, v80, v81
    v_add_f32 v85, v88, v89
    v_sub_f32 v78, v80, v81
    v_sub_f32 v86, v88, v89
    v_fma_f32 v79, v83, 2.0, v82
    v_fma_f32 v87, v91, 2.0, v90
    v_fma_f32 v82, v83, -2.0, v82
    v_fma_f32 v90, v91, -2.0, v90
    v_fmamk_f32 v80, v76, 0x41700000, v82
    v_fmamk_f32 v88, v84, 0x41700000, v90
    v_fmamk_f32 v80, v81, 0x41200000, v80
    v_fmamk_f32 v88, v89, 0x41200000, v88
    v_cvt_pk_bf16_f32 v21, v77, v85
    v_cvt_pk_bf16_f32 v25, v78, v86
    v_cvt_pk_bf16_f32 v65, v79, v87
    v_cvt_pk_bf16_f32 v69, v82, v90
    v_cvt_pk_bf16_f32 v73, v80, v88
    v_lshlrev_b32 v76, 16, v18
    v_and_b32 v84, s25, v18
    v_lshlrev_b32 v77, 16, v22
    v_and_b32 v85, s25, v22
    v_lshlrev_b32 v78, 16, v26
    v_and_b32 v86, s25, v26
    v_lshlrev_b32 v79, 16, v30
    v_and_b32 v87, s25, v30
    v_add_f32 v80, v76, v78
    v_add_f32 v88, v84, v86
    v_add_f32 v81, v77, v79
    v_add_f32 v89, v85, v87
    v_fma_f32 v82, v78, 4.0, v76
    v_fma_f32 v90, v86, 4.0, v84
    v_fma_f32 v83, v79, 4.0, v77
    v_fma_f32 v91, v87, 4.0, v85
    v_add_f32 v77, v80, v81
    v_add_f32 v85, v88, v89
    v_sub_f32 v78, v80, v81
    v_sub_f32 v86, v88, v89
    v_fma_f32 v79, v83, 2.0, v82
    v_fma_f32 v87, v91, 2.0, v90
    v_fma_f32 v82, v83, -2.0, v82
    v_fma_f32 v90, v91, -2.0, v90
    v_fmamk_f32 v80, v76, 0x41700000, v82
    v_fmamk_f32 v88, v84, 0x41700000, v90
    v_fmamk_f32 v80, v81, 0x41200000, v80
    v_fmamk_f32 v88, v89, 0x41200000, v88
    v_cvt_pk_bf16_f32 v22, v77, v85
    v_cvt_pk_bf16_f32 v26, v78, v86
    v_cvt_pk_bf16_f32 v66, v79, v87
    v_cvt_pk_bf16_f32 v70, v82, v90
    v_cvt_pk_bf16_f32 v74, v80, v88
    v_lshlrev_b32 v76, 16, v19
    v_and_b32 v84, s25, v19
    v_lshlrev_b32 v77, 16, v23
    v_and_b32 v85, s25, v23
    v_lshlrev_b32 v78, 16, v27
    v_and_b32 v86, s25, v27
    v_lshlrev_b32 v79, 16, v31
    v_and_b32 v87, s25, v31
    v_add_f32 v80, v76, v78
    v_add_f32 v88, v84, v86
    v_add_f32 v81, v77, v79
    v_add_f32 v89, v85, v87
    v_fma_f32 v82, v78, 4.0, v76
    v_fma_f32 v90, v86, 4.0, v84
    v_fma_f32 v83, v79, 4.0, v77
    v_fma_f32 v91, v87, 4.0, v85
    v_add_f32 v77, v80, v81
    v_add_f32 v85, v88, v89
    v_sub_f32 v78, v80, v81
    v_sub_f32 v86, v88, v89
    v_fma_f32 v79, v83, 2.0, v82
    v_fma_f32 v87, v91, 2.0, v90
    v_fma_f32 v82, v83, -2.0, v82
    v_fma_f32 v90, v91, -2.0, v90
    v_fmamk_f32 v80, v76, 0x41700000, v82
    v_fmamk_f32 v88, v84, 0x41700000, v90
    v_fmamk_f32 v80, v81, 0x41200000, v80
    v_fmamk_f32 v88, v89, 0x41200000, v88
    v_cvt_pk_bf16_f32 v23, v77, v85
    v_cvt_pk_bf16_f32 v27, v78, v86
    v_cvt_pk_bf16_f32 v67, v79, v87
    v_cvt_pk_bf16_f32 v71, v82, v90
    v_cvt_pk_bf16_f32 v75, v80, v88
    s_add_u32 s28, s28, 1
    s_waitcnt lgkmcnt(0)
    s_barrier
    s_sub_u32 s22, s22, 1
    s_branch L_conv1_kernel_hloop2
L_conv1_kernel_hlast2:
    s_waitcnt vmcnt(0)
    s_mov_b32 s58, s20
    s_lshl_b32 s20, s2, 2
    s_add_u32 s20, s20, s32
    v_mov_b32 v1, v127
    s_load_dwordx2 s[8:9], s[0:1], 16
    s_lshr_b32 s22, s20, 8
    s_bfe_u32 s23, s20, 0x40004
    s_bfe_u32 s24, s20, 0x30001
    s_and_b32 s21, s20, 1
    v_lshrrev_b32 v2, 4, v1
    v_lshlrev_b32 v2, 12, v2
    v_and_b32 v3, 15, v1
    v_lshl_add_u32 v2, v3, 2, v2
    s_lshl_b32 s26, s22, 3
    s_lshr_b32 s27, s23, 3
    s_add_u32 s26, s26, s27
    s_lshl_b32 s26, s26, 17
    s_and_b32 s27, s23, 7
    s_lshl_b32 s27, s27, 14
    s_add_u32 s26, s26, s27
    s_lshl_b32 s27, s24, 6
    s_add_u32 s26, s26, s27
    s_mov_b32 s10, 4063232
    s_mov_b32 s11, 0x00020000
    s_add_u32 s37, s26, 262144
    s_add_u32 s38, s26, 524288
    s_add_u32 s39, s26, 786432
    s_waitcnt lgkmcnt(0)
    buffer_load_dword v16, v2, s[8:11], s26 offen offset:0
    buffer_load_dword v17, v2, s[8:11], s26 offen offset:512
    buffer_load_dword v24, v2, s[8:11], s37 offen offset:0
    buffer_load_dword v25, v2, s[8:11], s37 offen offset:512
    buffer_load_dword v32, v2, s[8:11], s38 offen offset:0
    buffer_load_dword v33, v2, s[8:11], s38 offen offset:512
    buffer_load_dword v40, v2, s[8:11], s39 offen offset:0
    buffer_load_dword v41, v2, s[8:11], s39 offen offset:512
    buffer_load_dword v18, v2, s[8:11], s26 offen offset:1024
    buffer_load_dword v19, v2, s[8:11], s26 offen offset:1536
    buffer_load_dword v26, v2, s[8:11], s37 offen offset:1024
    buffer_load_dword v27, v2, s[8:11], s37 offen offset:1536
    buffer_load_dword v34, v2, s[8:11], s38 offen offset:1024
    buffer_load_dword v35, v2, s[8:11], s38 offen offset:1536
    buffer_load_dword v42, v2, s[8:11], s39 offen offset:1024
    buffer_load_dword v43, v2, s[8:11], s39 offen offset:1536
    buffer_load_dword v20, v2, s[8:11], s26 offen offset:2048
    buffer_load_dword v21, v2, s[8:11], s26 offen offset:2560
    buffer_load_dword v28, v2, s[8:11], s37 offen offset:2048
    buffer_load_dword v29, v2, s[8:11], s37 offen offset:2560
    buffer_load_dword v36, v2, s[8:11], s38 offen offset:2048
    buffer_load_dword v37, v2, s[8:11], s38 offen offset:2560
    buffer_load_dword v44, v2, s[8:11], s39 offen offset:2048
    buffer_load_dword v45, v2, s[8:11], s39 offen offset:2560
    buffer_load_dword v22, v2, s[8:11], s26 offen offset:3072
    buffer_load_dword v23, v2, s[8:11], s26 offen offset:3584
    buffer_load_dword v30, v2, s[8:11], s37 offen offset:3072
    buffer_load_dword v31, v2, s[8:11], s37 offen offset:3584
    buffer_load_dword v38, v2, s[8:11], s38 offen offset:3072
    buffer_load_dword v39, v2, s[8:11], s38 offen offset:3584
    buffer_load_dword v46, v2, s[8:11], s39 offen offset:3072
    buffer_load_dword v47, v2, s[8:11], s39 offen offset:3584
    s_add_u32 s12, s30, 9437184
    s_addc_u32 s13, s31, 0
    s_mov_b32 s14, 7340032
    s_mov_b32 s15, 0x00020000
    v_lshlrev_b32 v4, 4, v1
    s_lshl_b32 s27, s24, 4
    s_add_u32 s27, s27, s23
    s_mul_i32 s27, s27, 57344
    s_lshl_b32 s28, s22, 11
    s_add_u32 s27, s27, s28
    s_lshl_b32 s28, s21, 10
    s_add_u32 s27, s27, s28
    s_cmp_eq_u32 s21, 0
    s_mov_b32 s32, 0x07060302
    s_cselect_b32 s32, 0x05040100, s32
    s_mov_b32 s33, 0x03020c0c
    s_cselect_b32 s33, 0x01000c0c, s33
    s_mov_b32 s35, 0x3d2aaaab
    s_mov_b32 s36, 0x3c638e39
    s_mov_b32 s25, 0xffff0000
    ds_write_b128 v96, v[64:67] offset:57344
    ds_write_b128 v97, v[68:71] offset:8192
    ds_write_b128 v97, v[72:75] offset:24576
    ds_write_b128 v96, v[48:51] offset:8192
    ds_write_b128 v96, v[52:55] offset:24576
    ds_write_b128 v96, v[56:59] offset:40960
    ds_write_b128 v98, v[60:63] offset:8704
    s_waitcnt lgkmcnt(0)
    s_barrier
    s_waitcnt vmcnt(24)
    v_perm_b32 v72, v17, v16, s32
    v_perm_b32 v48, v41, v40, s32
    v_perm_b32 v76, v76, v40, s33
    v_perm_b32 v84, v84, v41, s33
    v_perm_b32 v77, v77, v32, s33
    v_perm_b32 v85, v85, v33, s33
    v_perm_b32 v78, v78, v24, s33
    v_perm_b32 v86, v86, v25, s33
    v_perm_b32 v79, v79, v16, s33
    v_perm_b32 v87, v87, v17, s33
    v_add_f32 v80, v76, v78
    v_add_f32 v88, v84, v86
    v_add_f32 v81, v77, v79
    v_add_f32 v89, v85, v87
    v_fma_f32 v82, v78, 4.0, v76
    v_fma_f32 v90, v86, 4.0, v84
    v_fma_f32 v83, v79, 4.0, v77
    v_fma_f32 v91, v87, 4.0, v85
    v_add_f32 v77, v80, v81
    v_add_f32 v85, v88, v89
    v_sub_f32 v78, v80, v81
    v_sub_f32 v86, v88, v89
    v_fma_f32 v79, v83, 2.0, v82
    v_fma_f32 v87, v91, 2.0, v90
    v_fma_f32 v82, v83, -2.0, v82
    v_fma_f32 v90, v91, -2.0, v90
    v_fmamk_f32 v80, v76, 0x41700000, v82
    v_fmamk_f32 v88, v84, 0x41700000, v90
    v_fmamk_f32 v80, v81, 0x41200000, v80
    v_fmamk_f32 v88, v89, 0x41200000, v88
    v_mul_f32 v77, 0.5, v77
    v_mul_f32 v85, 0.5, v85
    v_mul_f32 v78, 0.5, v78
    v_mul_f32 v86, 0.5, v86
    v_mul_f32 v79, s35, v79
    v_mul_f32 v87, s35, v87
    v_mul_f32 v82, s35, v82
    v_mul_f32 v90, s35, v90
    v_mul_f32 v80, s36, v80
    v_mul_f32 v88, s36, v88
    v_cvt_pk_bf16_f32 v52, v77, v85
    v_cvt_pk_bf16_f32 v56, v78, v86
    v_cvt_pk_bf16_f32 v60, v79, v87
    v_cvt_pk_bf16_f32 v64, v82, v90
    v_cvt_pk_bf16_f32 v68, v80, v88
    s_waitcnt vmcnt(16)
    v_perm_b32 v73, v19, v18, s32
    v_perm_b32 v49, v43, v42, s32
    v_perm_b32 v76, v76, v42, s33
    v_perm_b32 v84, v84, v43, s33
    v_perm_b32 v77, v77, v34, s33
    v_perm_b32 v85, v85, v35, s33
    v_perm_b32 v78, v78, v26, s33
    v_perm_b32 v86, v86, v27, s33
    v_perm_b32 v79, v79, v18, s33
    v_perm_b32 v87, v87, v19, s33
    v_add_f32 v80, v76, v78
    v_add_f32 v88, v84, v86
    v_add_f32 v81, v77, v79
    v_add_f32 v89, v85, v87
    v_fma_f32 v82, v78, 4.0, v76
    v_fma_f32 v90, v86, 4.0, v84
    v_fma_f32 v83, v79, 4.0, v77
    v_fma_f32 v91, v87, 4.0, v85
    v_add_f32 v77, v80, v81
    v_add_f32 v85, v88, v89
    v_sub_f32 v78, v80, v81
    v_sub_f32 v86, v88, v89
    v_fma_f32 v79, v83, 2.0, v82
    v_fma_f32 v87, v91, 2.0, v90
    v_fma_f32 v82, v83, -2.0, v82
    v_fma_f32 v90, v91, -2.0, v90
    v_fmamk_f32 v80, v76, 0x41700000, v82
    v_fmamk_f32 v88, v84, 0x41700000, v90
    v_fmamk_f32 v80, v81, 0x41200000, v80
    v_fmamk_f32 v88, v89, 0x41200000, v88
    v_mul_f32 v77, 0.5, v77
    v_mul_f32 v85, 0.5, v85
    v_mul_f32 v78, 0.5, v78
    v_mul_f32 v86, 0.5, v86
    v_mul_f32 v79, s35, v79
    v_mul_f32 v87, s35, v87
    v_mul_f32 v82, s35, v82
    v_mul_f32 v90, s35, v90
    v_mul_f32 v80, s36, v80
    v_mul_f32 v88, s36, v88
    v_cvt_pk_bf16_f32 v53, v77, v85
    v_cvt_pk_bf16_f32 v57, v78, v86
    v_cvt_pk_bf16_f32 v61, v79, v87
    v_cvt_pk_bf16_f32 v65, v82, v90
    v_cvt_pk_bf16_f32 v69, v80, v88
    s_waitcnt vmcnt(8)
    v_perm_b32 v74, v21, v20, s32
    v_perm_b32 v50, v45, v44, s32
    v_perm_b32 v76, v76, v44, s33
    v_perm_b32 v84, v84, v45, s33
    v_perm_b32 v77, v77, v36, s33
    v_perm_b32 v85, v85, v37, s33
    v_perm_b32 v78, v78, v28, s33
    v_perm_b32 v86, v86, v29, s33
    v_perm_b32 v79, v79, v20, s33
    v_perm_b32 v87, v87, v21, s33
    v_add_f32 v80, v76, v78
    v_add_f32 v88, v84, v86
    v_add_f32 v81, v77, v79
    v_add_f32 v89, v85, v87
    v_fma_f32 v82, v78, 4.0, v76
    v_fma_f32 v90, v86, 4.0, v84
    v_fma_f32 v83, v79, 4.0, v77
    v_fma_f32 v91, v87, 4.0, v85
    v_add_f32 v77, v80, v81
    v_add_f32 v85, v88, v89
    v_sub_f32 v78, v80, v81
    v_sub_f32 v86, v88, v89
    v_fma_f32 v79, v83, 2.0, v82
    v_fma_f32 v87, v91, 2.0, v90
    v_fma_f32 v82, v83, -2.0, v82
    v_fma_f32 v90, v91, -2.0, v90
    v_fmamk_f32 v80, v76, 0x41700000, v82
    v_fmamk_f32 v88, v84, 0x41700000, v90
    v_fmamk_f32 v80, v81, 0x41200000, v80
    v_fmamk_f32 v88, v89, 0x41200000, v88
    v_mul_f32 v77, 0.5, v77
    v_mul_f32 v85, 0.5, v85
    v_mul_f32 v78, 0.5, v78
    v_mul_f32 v86, 0.5, v86
    v_mul_f32 v79, s35, v79
    v_mul_f32 v87, s35, v87
    v_mul_f32 v82, s35, v82
    v_mul_f32 v90, s35, v90
    v_mul_f32 v80, s36, v80
    v_mul_f32 v88, s36, v88
    v_cvt_pk_bf16_f32 v54, v77, v85
    v_cvt_pk_bf16_f32 v58, v78, v86
    v_cvt_pk_bf16_f32 v62, v79, v87
    v_cvt_pk_bf16_f32 v66, v82, v90
    v_cvt_pk_bf16_f32 v70, v80, v88
    s_waitcnt vmcnt(0)
    v_perm_b32 v75, v23, v22, s32
    v_perm_b32 v51, v47, v46, s32
    v_perm_b32 v76, v76, v46, s33
    v_perm_b32 v84, v84, v47, s33
    v_perm_b32 v77, v77, v38, s33
    v_perm_b32 v85, v85, v39, s33
    v_perm_b32 v78, v78, v30, s33
    v_perm_b32 v86, v86, v31, s33
    v_perm_b32 v79, v79, v22, s33
    v_perm_b32 v87, v87, v23, s33
    v_add_f32 v80, v76, v78
    v_add_f32 v88, v84, v86
    v_add_f32 v81, v77, v79
    v_add_f32 v89, v85, v87
    v_fma_f32 v82, v78, 4.0, v76
    v_fma_f32 v90, v86, 4.0, v84
    v_fma_f32 v83, v79, 4.0, v77
    v_fma_f32 v91, v87, 4.0, v85
    v_add_f32 v77, v80, v81
    v_add_f32 v85, v88, v89
    v_sub_f32 v78, v80, v81
    v_sub_f32 v86, v88, v89
    v_fma_f32 v79, v83, 2.0, v82
    v_fma_f32 v87, v91, 2.0, v90
    v_fma_f32 v82, v83, -2.0, v82
    v_fma_f32 v90, v91, -2.0, v90
    v_fmamk_f32 v80, v76, 0x41700000, v82
    v_fmamk_f32 v88, v84, 0x41700000, v90
    v_fmamk_f32 v80, v81, 0x41200000, v80
    v_fmamk_f32 v88, v89, 0x41200000, v88
    v_mul_f32 v77, 0.5, v77
    v_mul_f32 v85, 0.5, v85
    v_mul_f32 v78, 0.5, v78
    v_mul_f32 v86, 0.5, v86
    v_mul_f32 v79, s35, v79
    v_mul_f32 v87, s35, v87
    v_mul_f32 v82, s35, v82
    v_mul_f32 v90, s35, v90
    v_mul_f32 v80, s36, v80
    v_mul_f32 v88, s36, v88
    v_cvt_pk_bf16_f32 v55, v77, v85
    v_cvt_pk_bf16_f32 v59, v78, v86
    v_cvt_pk_bf16_f32 v63, v79, v87
    v_cvt_pk_bf16_f32 v67, v82, v90
    v_cvt_pk_bf16_f32 v71, v80, v88
    s_add_u32 s28, s27, 49152
    buffer_store_dwordx4 v[72:75], v4, s[12:15], s28 offen sc1
    s_add_u32 s28, s27, 0
    buffer_store_dwordx4 v[48:51], v4, s[12:15], s28 offen sc1
    s_add_u32 s28, s27, 8192
    buffer_store_dwordx4 v[52:55], v4, s[12:15], s28 offen sc1
    s_add_u32 s28, s27, 16384
    buffer_store_dwordx4 v[56:59], v4, s[12:15], s28 offen sc1
    s_add_u32 s28, s27, 24576
    buffer_store_dwordx4 v[60:63], v4, s[12:15], s28 offen sc1
    s_add_u32 s28, s27, 32768
    buffer_store_dwordx4 v[64:67], v4, s[12:15], s28 offen sc1
    s_add_u32 s28, s27, 40960
    buffer_store_dwordx4 v[68:71], v4, s[12:15], s28 offen sc1
    s_mov_b32 s20, s58
    s_branch L_conv1_kernel_end
L_conv1_kernel_epi:
    s_waitcnt lgkmcnt(0)
    s_barrier
    v_cndmask_b32 v122, v111, v110, vcc
    ds_read_b128 v[0:3], v120 offset:0
    ds_read_b128 v[4:7], v120 offset:16384
    ds_read_b128 v[8:11], v120 offset:32768
    ds_read_b128 v[12:15], v120 offset:49152
    ds_read_b128 v[16:19], v121 offset:0
    ds_read_b128 v[20:23], v121 offset:16384
    ds_read_b128 v[24:27], v121 offset:32768
    ds_read_b128 v[28:31], v64 offset:15360
    ds_read_b128 v[32:35], v120 offset:8192
    ds_read_b128 v[36:39], v120 offset:24576
    ds_read_b128 v[40:43], v120 offset:40960
    ds_read_b128 v[44:47], v120 offset:57344
    ds_read_b128 v[48:51], v121 offset:56320
    ds_read_b128 v[52:55], v121 offset:64512
    ds_read_b128 v[56:59], v64 offset:7168
    s_waitcnt lgkmcnt(7)
    ds_read_b128 v[60:63], v64 offset:23552
    s_waitcnt lgkmcnt(8)
    v_pk_add_f32 v[88:89], v[24:25], v[28:29]
    v_pk_add_f32 v[90:91], v[26:27], v[30:31]
    v_pk_add_f32 v[24:25], v[4:5], v[8:9]
    v_pk_add_f32 v[26:27], v[6:7], v[10:11]
    v_pk_add_f32 v[4:5], v[4:5], v[8:9] neg_lo:[0,1] neg_hi:[0,1]
    v_pk_add_f32 v[6:7], v[6:7], v[10:11] neg_lo:[0,1] neg_hi:[0,1]
    v_pk_add_f32 v[72:73], v[12:13], v[16:17]
    v_pk_add_f32 v[74:75], v[14:15], v[18:19]
    v_pk_add_f32 v[12:13], v[12:13], v[16:17] neg_lo:[0,1] neg_hi:[0,1]
    v_pk_add_f32 v[14:15], v[14:15], v[18:19] neg_lo:[0,1] neg_hi:[0,1]
    v_pk_fma_f32 v[72:73], v[24:25], s[4:5], v[72:73]
    v_pk_fma_f32 v[74:75], v[26:27], s[4:5], v[74:75]
    v_pk_fma_f32 v[20:21], v[0:1], s[10:11], v[20:21]
    v_pk_fma_f32 v[22:23], v[2:3], s[10:11], v[22:23]
    v_pk_fma_f32 v[72:73], v[0:1], s[6:7], v[72:73]
    v_pk_fma_f32 v[74:75], v[2:3], s[6:7], v[74:75]
    v_pk_add_f32 v[24:25], v[24:25], v[0:1] neg_lo:[0,1] neg_hi:[0,1]
    v_pk_add_f32 v[26:27], v[26:27], v[2:3] neg_lo:[0,1] neg_hi:[0,1]
    v_pk_fma_f32 v[72:73], v[88:89], s[8:9], v[72:73]
    v_pk_fma_f32 v[74:75], v[90:91], s[8:9], v[74:75]
    v_pk_add_f32 v[24:25], v[24:25], v[88:89] neg_lo:[0,1] neg_hi:[0,1]
    v_pk_add_f32 v[26:27], v[26:27], v[90:91] neg_lo:[0,1] neg_hi:[0,1]
    v_pk_fma_f32 v[20:21], v[88:89], s[22:23], v[20:21]
    v_pk_fma_f32 v[22:23], v[90:91], s[22:23], v[22:23]
    v_pk_add_f32 v[8:9], v[24:25], v[72:73] neg_lo:[0,1] neg_hi:[0,1]
    v_pk_add_f32 v[10:11], v[26:27], v[74:75] neg_lo:[0,1] neg_hi:[0,1]
    v_pk_fma_f32 v[20:21], v[72:73], s[14:15], v[20:21]
    v_pk_fma_f32 v[22:23], v[74:75], s[14:15], v[22:23]
    v_pk_mul_f32 v[80:81], v[12:13], s[32:33]
    v_pk_mul_f32 v[82:83], v[14:15], s[32:33]
    v_pk_fma_f32 v[20:21], v[8:9], s[12:13], v[20:21]
    v_pk_fma_f32 v[22:23], v[10:11], s[12:13], v[22:23]
    v_pk_fma_f32 v[80:81], v[4:5], s[34:35], v[80:81]
    v_pk_fma_f32 v[82:83], v[6:7], s[34:35], v[82:83]
    v_pk_fma_f32 v[64:65], v[4:5], s[24:25], v[20:21] neg_lo:[0,0,1] neg_hi:[0,0,1]
    v_pk_fma_f32 v[66:67], v[6:7], s[24:25], v[22:23] neg_lo:[0,0,1] neg_hi:[0,0,1]
    v_pk_fma_f32 v[64:65], v[12:13], s[26:27], v[64:65]
    v_pk_fma_f32 v[66:67], v[14:15], s[26:27], v[66:67]
    v_pk_fma_f32 v[80:81], v[64:65], s[38:39], v[80:81]
    v_pk_fma_f32 v[82:83], v[66:67], s[38:39], v[82:83]
    v_pk_add_f32 v[4:5], v[4:5], v[64:65] neg_lo:[0,1] neg_hi:[0,1]
    v_pk_add_f32 v[6:7], v[6:7], v[66:67] neg_lo:[0,1] neg_hi:[0,1]
    v_pk_add_f32 v[4:5], v[4:5], v[80:81] neg_lo:[0,1] neg_hi:[0,1]
    v_pk_add_f32 v[6:7], v[6:7], v[82:83] neg_lo:[0,1] neg_hi:[0,1]
    s_waitcnt lgkmcnt(0)
    v_pk_add_f32 v[92:93], v[56:57], v[60:61]
    v_pk_add_f32 v[94:95], v[58:59], v[62:63]
    v_pk_add_f32 v[56:57], v[36:37], v[40:41]
    v_pk_add_f32 v[58:59], v[38:39], v[42:43]
    v_pk_add_f32 v[36:37], v[36:37], v[40:41] neg_lo:[0,1] neg_hi:[0,1]
    v_pk_add_f32 v[38:39], v[38:39], v[42:43] neg_lo:[0,1] neg_hi:[0,1]
    v_pk_add_f32 v[76:77], v[44:45], v[48:49]
    v_pk_add_f32 v[78:79], v[46:47], v[50:51]
    v_pk_add_f32 v[44:45], v[44:45], v[48:49] neg_lo:[0,1] neg_hi:[0,1]
    v_pk_add_f32 v[46:47], v[46:47], v[50:51] neg_lo:[0,1] neg_hi:[0,1]
    v_pk_fma_f32 v[76:77], v[56:57], s[4:5], v[76:77]
    v_pk_fma_f32 v[78:79], v[58:59], s[4:5], v[78:79]
    v_pk_fma_f32 v[52:53], v[32:33], s[10:11], v[52:53]
    v_pk_fma_f32 v[54:55], v[34:35], s[10:11], v[54:55]
    v_pk_fma_f32 v[76:77], v[32:33], s[6:7], v[76:77]
    v_pk_fma_f32 v[78:79], v[34:35], s[6:7], v[78:79]
    v_pk_add_f32 v[56:57], v[56:57], v[32:33] neg_lo:[0,1] neg_hi:[0,1]
    v_pk_add_f32 v[58:59], v[58:59], v[34:35] neg_lo:[0,1] neg_hi:[0,1]
    v_pk_fma_f32 v[76:77], v[92:93], s[8:9], v[76:77]
    v_pk_fma_f32 v[78:79], v[94:95], s[8:9], v[78:79]
    v_pk_add_f32 v[56:57], v[56:57], v[92:93] neg_lo:[0,1] neg_hi:[0,1]
    v_pk_add_f32 v[58:59], v[58:59], v[94:95] neg_lo:[0,1] neg_hi:[0,1]
    v_pk_fma_f32 v[52:53], v[92:93], s[22:23], v[52:53]
    v_pk_fma_f32 v[54:55], v[94:95], s[22:23], v[54:55]
    v_pk_add_f32 v[40:41], v[56:57], v[76:77] neg_lo:[0,1] neg_hi:[0,1]
    v_pk_add_f32 v[42:43], v[58:59], v[78:79] neg_lo:[0,1] neg_hi:[0,1]
    v_pk_fma_f32 v[52:53], v[76:77], s[14:15], v[52:53]
    v_pk_fma_f32 v[54:55], v[78:79], s[14:15], v[54:55]
    v_pk_mul_f32 v[84:85], v[44:45], s[32:33]
    v_pk_mul_f32 v[86:87], v[46:47], s[32:33]
    v_pk_fma_f32 v[52:53], v[40:41], s[12:13], v[52:53]
    v_pk_fma_f32 v[54:55], v[42:43], s[12:13], v[54:55]
    v_pk_fma_f32 v[84:85], v[36:37], s[34:35], v[84:85]
    v_pk_fma_f32 v[86:87], v[38:39], s[34:35], v[86:87]
    v_pk_fma_f32 v[68:69], v[36:37], s[24:25], v[52:53] neg_lo:[0,0,1] neg_hi:[0,0,1]
    v_pk_fma_f32 v[70:71], v[38:39], s[24:25], v[54:55] neg_lo:[0,0,1] neg_hi:[0,0,1]
    v_pk_fma_f32 v[68:69], v[44:45], s[26:27], v[68:69]
    v_pk_fma_f32 v[70:71], v[46:47], s[26:27], v[70:71]
    v_pk_fma_f32 v[84:85], v[68:69], s[38:39], v[84:85]
    v_pk_fma_f32 v[86:87], v[70:71], s[38:39], v[86:87]
    v_pk_add_f32 v[36:37], v[36:37], v[68:69] neg_lo:[0,1] neg_hi:[0,1]
    v_pk_add_f32 v[38:39], v[38:39], v[70:71] neg_lo:[0,1] neg_hi:[0,1]
    v_pk_add_f32 v[36:37], v[36:37], v[84:85] neg_lo:[0,1] neg_hi:[0,1]
    v_pk_add_f32 v[38:39], v[38:39], v[86:87] neg_lo:[0,1] neg_hi:[0,1]
    s_mov_b32 s36, 0x00010001
    s_mov_b32 s37, 0x00010001
    s_mov_b64 exec, s[36:37]
    ds_write_b128 v127, v[0:3] offset:0
    ds_write_b128 v127, v[32:35] offset:16
    ds_write_b128 v127, v[4:7] offset:32
    ds_write_b128 v127, v[36:39] offset:48
    ds_write_b128 v127, v[8:11] offset:64
    ds_write_b128 v127, v[40:43] offset:80
    s_mov_b64 exec, -1
    v_mov_b32 v44, 0xc0135761
    v_mov_b32 v45, v44
    v_pk_mul_f32 v[16:17], v[64:65], v[64:65]
    v_pk_mul_f32 v[18:19], v[66:67], v[66:67]
    v_pk_mul_f32 v[20:21], v[68:69], v[68:69]
    v_pk_mul_f32 v[22:23], v[70:71], v[70:71]
    v_pk_fma_f32 v[16:17], v[16:17], s[40:41], v[44:45]
    v_pk_fma_f32 v[18:19], v[18:19], s[40:41], v[44:45]
    v_pk_fma_f32 v[20:21], v[20:21], s[40:41], v[44:45]
    v_pk_fma_f32 v[22:23], v[22:23], s[40:41], v[44:45]
    v_pk_mul_f32 v[16:17], v[16:17], v[64:65]
    v_pk_mul_f32 v[18:19], v[18:19], v[66:67]
    v_pk_mul_f32 v[20:21], v[20:21], v[68:69]
    v_pk_mul_f32 v[22:23], v[22:23], v[70:71]
    v_exp_f32 v16, v16
    v_exp_f32 v17, v17
    v_exp_f32 v18, v18
    v_exp_f32 v19, v19
    v_exp_f32 v20, v20
    v_exp_f32 v21, v21
    v_exp_f32 v22, v22
    v_exp_f32 v23, v23
    v_pk_add_f32 v[16:17], v[16:17], s[42:43]
    v_pk_add_f32 v[18:19], v[18:19], s[42:43]
    v_pk_add_f32 v[20:21], v[20:21], s[42:43]
    v_pk_add_f32 v[22:23], v[22:23], s[42:43]
    v_rcp_f32 v16, v16
    v_rcp_f32 v17, v17
    v_rcp_f32 v18, v18
    v_rcp_f32 v19, v19
    v_rcp_f32 v20, v20
    v_rcp_f32 v21, v21
    v_rcp_f32 v22, v22
    v_rcp_f32 v23, v23
    v_pk_mul_f32 v[64:65], v[64:65], v[16:17]
    v_pk_mul_f32 v[66:67], v[66:67], v[18:19]
    v_pk_mul_f32 v[68:69], v[68:69], v[20:21]
    v_pk_mul_f32 v[70:71], v[70:71], v[22:23]
    v_cvt_pk_bf16_f32 v48, v64, v68
    v_cvt_pk_bf16_f32 v49, v65, v69
    v_cvt_pk_bf16_f32 v50, v66, v70
    v_cvt_pk_bf16_f32 v51, v67, v71
    s_mov_b32 s44, 393280
    buffer_store_dwordx4 v[48:51], v122, s[16:19], s44 offen sc1
    s_waitcnt lgkmcnt(0)
    s_barrier
    ds_read_b128 v[96:99], v127 offset:512
    ds_read_b128 v[100:103], v127 offset:528
    ds_read_b128 v[104:107], v127 offset:544
    ds_read_b128 v[108:111], v127 offset:560
    ds_read_b128 v[112:115], v127 offset:576
    ds_read_b128 v[116:119], v127 offset:592
    s_waitcnt lgkmcnt(4)
    v_mov_b32_dpp v96, v0 row_shl:1 row_mask:0xf bank_mask:0xf
    v_mov_b32_dpp v97, v1 row_shl:1 row_mask:0xf bank_mask:0xf
    v_mov_b32_dpp v98, v2 row_shl:1 row_mask:0xf bank_mask:0xf
    v_mov_b32_dpp v99, v3 row_shl:1 row_mask:0xf bank_mask:0xf
    v_mov_b32_dpp v100, v32 row_shl:1 row_mask:0xf bank_mask:0xf
    v_mov_b32_dpp v101, v33 row_shl:1 row_mask:0xf bank_mask:0xf
    v_mov_b32_dpp v102, v34 row_shl:1 row_mask:0xf bank_mask:0xf
    v_mov_b32_dpp v103, v35 row_shl:1 row_mask:0xf bank_mask:0xf
    v_pk_add_f32 v[72:73], v[72:73], v[96:97]
    v_pk_add_f32 v[74:75], v[74:75], v[98:99]
    v_pk_add_f32 v[76:77], v[76:77], v[100:101]
    v_pk_add_f32 v[78:79], v[78:79], v[102:103]
    v_pk_mul_f32 v[24:25], v[72:73], v[72:73]
    v_pk_mul_f32 v[26:27], v[74:75], v[74:75]
    v_pk_mul_f32 v[28:29], v[76:77], v[76:77]
    v_pk_mul_f32 v[30:31], v[78:79], v[78:79]
    v_pk_fma_f32 v[24:25], v[24:25], s[40:41], v[44:45]
    v_pk_fma_f32 v[26:27], v[26:27], s[40:41], v[44:45]
    v_pk_fma_f32 v[28:29], v[28:29], s[40:41], v[44:45]
    v_pk_fma_f32 v[30:31], v[30:31], s[40:41], v[44:45]
    v_pk_mul_f32 v[24:25], v[24:25], v[72:73]
    v_pk_mul_f32 v[26:27], v[26:27], v[74:75]
    v_pk_mul_f32 v[28:29], v[28:29], v[76:77]
    v_pk_mul_f32 v[30:31], v[30:31], v[78:79]
    v_exp_f32 v24, v24
    v_exp_f32 v25, v25
    v_exp_f32 v26, v26
    v_exp_f32 v27, v27
    v_exp_f32 v28, v28
    v_exp_f32 v29, v29
    v_exp_f32 v30, v30
    v_exp_f32 v31, v31
    v_pk_add_f32 v[24:25], v[24:25], s[42:43]
    v_pk_add_f32 v[26:27], v[26:27], s[42:43]
    v_pk_add_f32 v[28:29], v[28:29], s[42:43]
    v_pk_add_f32 v[30:31], v[30:31], s[42:43]
    v_rcp_f32 v24, v24
    v_rcp_f32 v25, v25
    v_rcp_f32 v26, v26
    v_rcp_f32 v27, v27
    v_rcp_f32 v28, v28
    v_rcp_f32 v29, v29
    v_rcp_f32 v30, v30
    v_rcp_f32 v31, v31
    v_pk_mul_f32 v[72:73], v[72:73], v[24:25]
    v_pk_mul_f32 v[74:75], v[74:75], v[26:27]
    v_pk_mul_f32 v[76:77], v[76:77], v[28:29]
    v_pk_mul_f32 v[78:79], v[78:79], v[30:31]
    v_cvt_pk_bf16_f32 v52, v72, v76
    v_cvt_pk_bf16_f32 v53, v73, v77
    v_cvt_pk_bf16_f32 v54, v74, v78
    v_cvt_pk_bf16_f32 v55, v75, v79
    s_mov_b32 s44, 128
    buffer_store_dwordx4 v[52:55], v122, s[16:19], s44 offen sc1
    s_waitcnt lgkmcnt(2)
    v_mov_b32_dpp v104, v4 row_shl:1 row_mask:0xf bank_mask:0xf
    v_mov_b32_dpp v105, v5 row_shl:1 row_mask:0xf bank_mask:0xf
    v_mov_b32_dpp v106, v6 row_shl:1 row_mask:0xf bank_mask:0xf
    v_mov_b32_dpp v107, v7 row_shl:1 row_mask:0xf bank_mask:0xf
    v_mov_b32_dpp v108, v36 row_shl:1 row_mask:0xf bank_mask:0xf
    v_mov_b32_dpp v109, v37 row_shl:1 row_mask:0xf bank_mask:0xf
    v_mov_b32_dpp v110, v38 row_shl:1 row_mask:0xf bank_mask:0xf
    v_mov_b32_dpp v111, v39 row_shl:1 row_mask:0xf bank_mask:0xf
    v_pk_add_f32 v[80:81], v[80:81], v[104:105]
    v_pk_add_f32 v[82:83], v[82:83], v[106:107]
    v_pk_add_f32 v[84:85], v[84:85], v[108:109]
    v_pk_add_f32 v[86:87], v[86:87], v[110:111]
    v_pk_mul_f32 v[16:17], v[80:81], v[80:81]
    v_pk_mul_f32 v[18:19], v[82:83], v[82:83]
    v_pk_mul_f32 v[20:21], v[84:85], v[84:85]
    v_pk_mul_f32 v[22:23], v[86:87], v[86:87]
    v_pk_fma_f32 v[16:17], v[16:17], s[40:41], v[44:45]
    v_pk_fma_f32 v[18:19], v[18:19], s[40:41], v[44:45]
    v_pk_fma_f32 v[20:21], v[20:21], s[40:41], v[44:45]
    v_pk_fma_f32 v[22:23], v[22:23], s[40:41], v[44:45]
    v_pk_mul_f32 v[16:17], v[16:17], v[80:81]
    v_pk_mul_f32 v[18:19], v[18:19], v[82:83]
    v_pk_mul_f32 v[20:21], v[20:21], v[84:85]
    v_pk_mul_f32 v[22:23], v[22:23], v[86:87]
    v_exp_f32 v16, v16
    v_exp_f32 v17, v17
    v_exp_f32 v18, v18
    v_exp_f32 v19, v19
    v_exp_f32 v20, v20
    v_exp_f32 v21, v21
    v_exp_f32 v22, v22
    v_exp_f32 v23, v23
    v_pk_add_f32 v[16:17], v[16:17], s[42:43]
    v_pk_add_f32 v[18:19], v[18:19], s[42:43]
    v_pk_add_f32 v[20:21], v[20:21], s[42:43]
    v_pk_add_f32 v[22:23], v[22:23], s[42:43]
    v_rcp_f32 v16, v16
    v_rcp_f32 v17, v17
    v_rcp_f32 v18, v18
    v_rcp_f32 v19, v19
    v_rcp_f32 v20, v20
    v_rcp_f32 v21, v21
    v_rcp_f32 v22, v22
    v_rcp_f32 v23, v23
    v_pk_mul_f32 v[80:81], v[80:81], v[16:17]
    v_pk_mul_f32 v[82:83], v[82:83], v[18:19]
    v_pk_mul_f32 v[84:85], v[84:85], v[20:21]
    v_pk_mul_f32 v[86:87], v[86:87], v[22:23]
    v_cvt_pk_bf16_f32 v56, v80, v84
    v_cvt_pk_bf16_f32 v57, v81, v85
    v_cvt_pk_bf16_f32 v58, v82, v86
    v_cvt_pk_bf16_f32 v59, v83, v87
    s_mov_b32 s44, 131200
    buffer_store_dwordx4 v[56:59], v122, s[16:19], s44 offen sc1
    s_waitcnt lgkmcnt(0)
    v_mov_b32_dpp v112, v8 row_shl:1 row_mask:0xf bank_mask:0xf
    v_mov_b32_dpp v113, v9 row_shl:1 row_mask:0xf bank_mask:0xf
    v_mov_b32_dpp v114, v10 row_shl:1 row_mask:0xf bank_mask:0xf
    v_mov_b32_dpp v115, v11 row_shl:1 row_mask:0xf bank_mask:0xf
    v_mov_b32_dpp v116, v40 row_shl:1 row_mask:0xf bank_mask:0xf
    v_mov_b32_dpp v117, v41 row_shl:1 row_mask:0xf bank_mask:0xf
    v_mov_b32_dpp v118, v42 row_shl:1 row_mask:0xf bank_mask:0xf
    v_mov_b32_dpp v119, v43 row_shl:1 row_mask:0xf bank_mask:0xf
    v_pk_add_f32 v[88:89], v[88:89], v[112:113]
    v_pk_add_f32 v[90:91], v[90:91], v[114:115]
    v_pk_add_f32 v[92:93], v[92:93], v[116:117]
    v_pk_add_f32 v[94:95], v[94:95], v[118:119]
    v_pk_mul_f32 v[24:25], v[88:89], v[88:89]
    v_pk_mul_f32 v[26:27], v[90:91], v[90:91]
    v_pk_mul_f32 v[28:29], v[92:93], v[92:93]
    v_pk_mul_f32 v[30:31], v[94:95], v[94:95]
    v_pk_fma_f32 v[24:25], v[24:25], s[40:41], v[44:45]
    v_pk_fma_f32 v[26:27], v[26:27], s[40:41], v[44:45]
    v_pk_fma_f32 v[28:29], v[28:29], s[40:41], v[44:45]
    v_pk_fma_f32 v[30:31], v[30:31], s[40:41], v[44:45]
    v_pk_mul_f32 v[24:25], v[24:25], v[88:89]
    v_pk_mul_f32 v[26:27], v[26:27], v[90:91]
    v_pk_mul_f32 v[28:29], v[28:29], v[92:93]
    v_pk_mul_f32 v[30:31], v[30:31], v[94:95]
    v_exp_f32 v24, v24
    v_exp_f32 v25, v25
    v_exp_f32 v26, v26
    v_exp_f32 v27, v27
    v_exp_f32 v28, v28
    v_exp_f32 v29, v29
    v_exp_f32 v30, v30
    v_exp_f32 v31, v31
    v_pk_add_f32 v[24:25], v[24:25], s[42:43]
    v_pk_add_f32 v[26:27], v[26:27], s[42:43]
    v_pk_add_f32 v[28:29], v[28:29], s[42:43]
    v_pk_add_f32 v[30:31], v[30:31], s[42:43]
    v_rcp_f32 v24, v24
    v_rcp_f32 v25, v25
    v_rcp_f32 v26, v26
    v_rcp_f32 v27, v27
    v_rcp_f32 v28, v28
    v_rcp_f32 v29, v29
    v_rcp_f32 v30, v30
    v_rcp_f32 v31, v31
    v_pk_mul_f32 v[88:89], v[88:89], v[24:25]
    v_pk_mul_f32 v[90:91], v[90:91], v[26:27]
    v_pk_mul_f32 v[92:93], v[92:93], v[28:29]
    v_pk_mul_f32 v[94:95], v[94:95], v[30:31]
    v_cvt_pk_bf16_f32 v60, v88, v92
    v_cvt_pk_bf16_f32 v61, v89, v93
    v_cvt_pk_bf16_f32 v62, v90, v94
    v_cvt_pk_bf16_f32 v63, v91, v95
    s_mov_b32 s44, 262272
    buffer_store_dwordx4 v[60:63], v122, s[16:19], s44 offen sc1
L_conv1_kernel_end:
L_conv1_kernel_done:
    s_endpgm
.globl conv2_kernel
.p2align 8
.type conv2_kernel,@function
conv2_kernel:
    s_cmp_ge_u32 s2, 256
    s_cbranch_scc1 L_conv2_kernel_done
    s_load_dwordx2 s[4:5], s[0:1], 72
    s_load_dwordx2 s[30:31], s[0:1], 72
    v_readfirstlane_b32 s20, v0
    s_lshr_b32 s20, s20, 6
    s_xor_b32 s20, s20, 8
    s_and_b32 s36, s2, 0
    s_lshl_b32 s36, s36, 3
    s_bfe_u32 s37, s2, 196611
    s_or_b32 s29, s36, s37
    s_bfe_u32 s36, s2, 196608
    s_lshl_b32 s36, s36, 2
    s_lshr_b32 s37, s2, 6
    s_or_b32 s36, s36, s37
    s_lshr_b32 s33, s36, 4
    s_and_b32 s34, s36, 7
    s_bfe_u32 s35, s36, 0x10003
    s_mul_i32 s21, s34, 500
    s_and_b32 s32, s20, 3
    v_and_b32 v127, 63, v0
    v_lshrrev_b32 v5, 2, v127
    v_and_b32 v6, 3, v127
    s_and_b32 s42, s20, 7
    s_lshr_b32 s41, s21, 2
    s_sub_u32 s41, s41, 1
    s_add_u32 s37, s41, s42
    v_lshl_add_u32 v7, v5, 3, s37
    s_mul_i32 s36, s35, 4194304
    s_add_u32 s36, s36, 18874368
    s_mov_b32 s10, 4194304
    s_mov_b32 s11, 0x00020000
    s_mov_b32 s25, 0xffff0000
    s_mov_b32 s47, s36
    s_cmp_ge_u32 s20, 8
    s_cbranch_scc1 L_conv2_kernel_helper
    s_add_u32 s37, s41, 128
    v_mov_b32 v16, s37
    v_mul_u32_u24 v17, 524288, v5
    v_lshl_add_u32 v17, v6, 4, v17
    s_add_u32 s37, s33, 4294967289
    v_lshl_add_u32 v18, v16, 3, s37
    v_cmp_gt_u32 vcc, 8000, v18
    s_mul_i32 s37, s33, 131072
    s_add_u32 s37, s37, 0
    v_lshl_add_u32 v108, v16, 7, s37
    v_add_u32 v108, v108, v17
    v_mov_b32 v18, 2130706432
    v_cndmask_b32 v108, v18, v108, vcc
    s_add_u32 s37, s33, 4294967291
    v_lshl_add_u32 v18, v16, 3, s37
    v_cmp_gt_u32 vcc, 8000, v18
    s_mul_i32 s37, s33, 131072
    s_add_u32 s37, s37, 262144
    v_lshl_add_u32 v109, v16, 7, s37
    v_add_u32 v109, v109, v17
    v_mov_b32 v18, 2130706432
    v_cndmask_b32 v109, v18, v109, vcc
    s_add_u32 s37, s33, 4294967293
    v_lshl_add_u32 v18, v16, 3, s37
    v_cmp_gt_u32 vcc, 8000, v18
    s_mul_i32 s37, s33, 131072
    s_add_u32 s37, s37, 64
    v_lshl_add_u32 v110, v16, 7, s37
    v_add_u32 v110, v110, v17
    v_mov_b32 v18, 2130706432
    v_cndmask_b32 v110, v18, v110, vcc
    s_waitcnt lgkmcnt(0)
    s_add_u32 s8, s4, s47
    s_addc_u32 s9, s5, 0
    s_lshl_b32 s36, s29, 4
    s_lshl_b32 s37, s33, 3
    s_add_u32 s36, s36, s37
    s_mul_i32 s36, s36, 57344
    s_add_u32 s36, s36, 9437184
    s_add_u32 s12, s30, s36
    s_addc_u32 s13, s31, 0
    s_mov_b32 s14, 458752
    s_mov_b32 s15, 0x00020000
    s_mul_i32 s36, s35, 2097152
    s_add_u32 s36, s36, 27262976
    s_mul_i32 s37, s33, 8388608
    s_add_u32 s36, s36, s37
    s_add_u32 s16, s30, s36
    s_addc_u32 s17, s31, 0
    s_mov_b32 s18, 2097152
    s_mov_b32 s19, 0x00020000
    v_and_b32 v10, 15, v127
    v_lshrrev_b32 v11, 4, v127
    v_add_u32 v8, 0, v10
    v_and_b32 v16, 4, v8
    v_lshrrev_b32 v16, 1, v16
    v_xor_b32 v16, v11, v16
    v_lshlrev_b32 v16, 4, v16
    v_lshl_add_u32 v8, v8, 6, v16
    v_add_u32 v9, 1, v10
    v_and_b32 v16, 4, v9
    v_lshrrev_b32 v16, 1, v16
    v_xor_b32 v16, v11, v16
    v_lshlrev_b32 v16, 4, v16
    v_lshl_add_u32 v9, v9, 6, v16
    s_lshr_b32 s38, s32, 1
    s_and_b32 s39, s32, 1
    s_add_u32 s40, s38, 4
    s_lshl_b32 s43, s39, 10
    s_cmp_lt_u32 s20, 4
    s_cselect_b32 s40, s20, s40
    s_cselect_b32 s36, 0, s43
    s_lshl_b32 s37, s40, 13
    s_add_u32 s37, s37, s36
    v_lshl_add_u32 v125, v127, 4, s37
    s_mul_i32 s37, s40, 16384
    v_add_u32 v120, s37, v8
    v_add_u32 v121, s37, v9
    s_lshl_b32 s37, s40, 10
    s_add_u32 s37, s37, 115712
    v_lshl_add_u32 v16, v11, 4, s37
    v_cmp_eq_u32 vcc, 15, v10
    v_mov_b32 v17, 8192
    v_mov_b32 v18, 4294959104
    v_mov_b32 v19, 64
    v_cndmask_b32 v122, v121, v16, vcc
    v_cndmask_b32 v123, v17, v19, vcc
    v_cndmask_b32 v124, v18, v19, vcc
    v_lshl_add_u32 v126, v127, 4, s37
    s_mov_b32 s44, 0x3f800000
    s_mov_b32 s45, 0x00000000
    s_mov_b32 s46, 0x00000000
    s_cmp_eq_u32 s40, 1
    s_cselect_b32 s45, 0x3f800000, s45
    s_cselect_b32 s46, 0x3f800000, s46
    s_cmp_eq_u32 s40, 2
    s_cselect_b32 s45, 0xbf800000, s45
    s_cselect_b32 s46, 0x3f800000, s46
    s_cmp_eq_u32 s40, 3
    s_cselect_b32 s45, 0x40000000, s45
    s_cselect_b32 s46, 0x40800000, s46
    s_cmp_eq_u32 s40, 4
    s_cselect_b32 s45, 0xc0000000, s45
    s_cselect_b32 s46, 0x40800000, s46
    s_cmp_eq_u32 s40, 5
    s_cselect_b32 s44, 0x41800000, s44
    s_cselect_b32 s45, 0x41000000, s45
    s_cselect_b32 s46, 0x40800000, s46
    s_cmp_ge_u32 s20, 4
    s_cbranch_scc1 L_conv2_kernel_m2
    v_mov_b32 v0, 0
    v_mov_b32 v1, 0
    v_mov_b32 v2, 0
    v_mov_b32 v3, 0
    v_mov_b32 v4, 0
    v_mov_b32 v5, 0
    v_mov_b32 v6, 0
    v_mov_b32 v7, 0
    v_mov_b32 v8, 0
    v_mov_b32 v9, 0
    v_mov_b32 v10, 0
    v_mov_b32 v11, 0
    v_mov_b32 v12, 0
    v_mov_b32 v13, 0
    v_mov_b32 v14, 0
    v_mov_b32 v15, 0
    v_mov_b32 v16, 0
    v_mov_b32 v17, 0
    v_mov_b32 v18, 0
    v_mov_b32 v19, 0
    v_mov_b32 v20, 0
    v_mov_b32 v21, 0
    v_mov_b32 v22, 0
    v_mov_b32 v23, 0
    v_mov_b32 v24, 0
    v_mov_b32 v25, 0
    v_mov_b32 v26, 0
    v_mov_b32 v27, 0
    v_mov_b32 v28, 0
    v_mov_b32 v29, 0
    v_mov_b32 v30, 0
    v_mov_b32 v31, 0
    v_mov_b32 v32, 0
    v_mov_b32 v33, 0
    v_mov_b32 v34, 0
    v_mov_b32 v35, 0
    v_mov_b32 v36, 0
    v_mov_b32 v37, 0
    v_mov_b32 v38, 0
    v_mov_b32 v39, 0
    v_mov_b32 v40, 0
    v_mov_b32 v41, 0
    v_mov_b32 v42, 0
    v_mov_b32 v43, 0
    v_mov_b32 v44, 0
    v_mov_b32 v45, 0
    v_mov_b32 v46, 0
    v_mov_b32 v47, 0
    v_mov_b32 v48, 0
    v_mov_b32 v49, 0
    v_mov_b32 v50, 0
    v_mov_b32 v51, 0
    v_mov_b32 v52, 0
    v_mov_b32 v53, 0
    v_mov_b32 v54, 0
    v_mov_b32 v55, 0
    v_mov_b32 v56, 0
    v_mov_b32 v57, 0
    v_mov_b32 v58, 0
    v_mov_b32 v59, 0
    v_mov_b32 v60, 0
    v_mov_b32 v61, 0
    v_mov_b32 v62, 0
    v_mov_b32 v63, 0
    buffer_load_dwordx4 v[96:99], v108, s[8:11], 0 offen
    buffer_load_dwordx4 v[100:103], v109, s[8:11], 0 offen
    buffer_load_dwordx4 v[104:107], v110, s[8:11], 0 offen
    s_mov_b32 s23, 0
    s_mov_b32 s26, 4096
    buffer_load_dwordx4 v[64:67], v125, s[12:15], s23 offen offset:0
    buffer_load_dwordx4 v[68:71], v125, s[12:15], s23 offen offset:1024
    buffer_load_dwordx4 v[72:75], v125, s[12:15], s23 offen offset:2048
    buffer_load_dwordx4 v[76:79], v125, s[12:15], s23 offen offset:3072
    buffer_load_dwordx4 v[80:83], v125, s[12:15], s26 offen offset:0
    buffer_load_dwordx4 v[84:87], v125, s[12:15], s26 offen offset:1024
    buffer_load_dwordx4 v[88:91], v125, s[12:15], s26 offen offset:2048
    buffer_load_dwordx4 v[92:95], v125, s[12:15], s26 offen offset:3072
    s_mov_b32 s23, 57344
    s_mov_b32 s26, 61440
    s_waitcnt vmcnt(8)
    v_lshlrev_b32 v108, 16, v96
    v_and_b32 v111, s25, v96
    v_lshlrev_b32 v109, 16, v100
    v_and_b32 v112, s25, v100
    v_lshlrev_b32 v110, 16, v104
    v_and_b32 v113, s25, v104
    v_mul_f32 v114, s44, v108
    v_mul_f32 v115, s44, v111
    v_fmac_f32 v114, s45, v109
    v_fmac_f32 v115, s45, v112
    v_fmac_f32 v114, s46, v110
    v_fmac_f32 v115, s46, v113
    v_cvt_pk_bf16_f32 v96, v114, v115
    v_lshlrev_b32 v108, 16, v97
    v_and_b32 v111, s25, v97
    v_lshlrev_b32 v109, 16, v101
    v_and_b32 v112, s25, v101
    v_lshlrev_b32 v110, 16, v105
    v_and_b32 v113, s25, v105
    v_mul_f32 v114, s44, v108
    v_mul_f32 v115, s44, v111
    v_fmac_f32 v114, s45, v109
    v_fmac_f32 v115, s45, v112
    v_fmac_f32 v114, s46, v110
    v_fmac_f32 v115, s46, v113
    v_cvt_pk_bf16_f32 v97, v114, v115
    v_lshlrev_b32 v108, 16, v98
    v_and_b32 v111, s25, v98
    v_lshlrev_b32 v109, 16, v102
    v_and_b32 v112, s25, v102
    v_lshlrev_b32 v110, 16, v106
    v_and_b32 v113, s25, v106
    v_mul_f32 v114, s44, v108
    v_mul_f32 v115, s44, v111
    v_fmac_f32 v114, s45, v109
    v_fmac_f32 v115, s45, v112
    v_fmac_f32 v114, s46, v110
    v_fmac_f32 v115, s46, v113
    v_cvt_pk_bf16_f32 v98, v114, v115
    v_lshlrev_b32 v108, 16, v99
    v_and_b32 v111, s25, v99
    v_lshlrev_b32 v109, 16, v103
    v_and_b32 v112, s25, v103
    v_lshlrev_b32 v110, 16, v107
    v_and_b32 v113, s25, v107
    v_mul_f32 v114, s44, v108
    v_mul_f32 v115, s44, v111
    v_fmac_f32 v114, s45, v109
    v_fmac_f32 v115, s45, v112
    v_fmac_f32 v114, s46, v110
    v_fmac_f32 v115, s46, v113
    v_cvt_pk_bf16_f32 v99, v114, v115
    ds_write_b128 v126, v[96:99]
    s_waitcnt lgkmcnt(0)
    s_barrier
    s_mov_b32 s22, 4
    s_setprio 2
L_conv2_kernel_mloop1:
    ds_read_b128 v[96:99], v120 offset:0
    ds_read_b128 v[100:103], v120 offset:1024
    ds_read_b128 v[104:107], v120 offset:2048
    ds_read_b128 v[108:111], v120 offset:3072
    ds_read_b128 v[112:115], v120 offset:4096
    ds_read_b128 v[116:119], v120 offset:5120
    s_waitcnt vmcnt(6) lgkmcnt(5)
    v_mfma_f32_16x16x32_bf16 v[0:3], v[64:67], v[96:99], v[0:3]
    v_mfma_f32_16x16x32_bf16 v[32:35], v[68:71], v[96:99], v[32:35]
    ds_read_b128 v[96:99], v120 offset:6144
    s_waitcnt vmcnt(4) lgkmcnt(5)
    v_mfma_f32_16x16x32_bf16 v[4:7], v[64:67], v[100:103], v[4:7]
    v_mfma_f32_16x16x32_bf16 v[36:39], v[68:71], v[100:103], v[36:39]
    v_mfma_f32_16x16x32_bf16 v[0:3], v[72:75], v[100:103], v[0:3]
    v_mfma_f32_16x16x32_bf16 v[32:35], v[76:79], v[100:103], v[32:35]
    ds_read_b128 v[100:103], v120 offset:7168
    s_waitcnt vmcnt(2) lgkmcnt(5)
    v_mfma_f32_16x16x32_bf16 v[8:11], v[64:67], v[104:107], v[8:11]
    v_mfma_f32_16x16x32_bf16 v[40:43], v[68:71], v[104:107], v[40:43]
    v_mfma_f32_16x16x32_bf16 v[4:7], v[72:75], v[104:107], v[4:7]
    v_mfma_f32_16x16x32_bf16 v[36:39], v[76:79], v[104:107], v[36:39]
    v_mfma_f32_16x16x32_bf16 v[0:3], v[80:83], v[104:107], v[0:3]
    v_mfma_f32_16x16x32_bf16 v[32:35], v[84:87], v[104:107], v[32:35]
    ds_read_b128 v[104:107], v122 offset:0
    v_add_u32 v122, v123, v122
    s_waitcnt vmcnt(0) lgkmcnt(5)
    v_mfma_f32_16x16x32_bf16 v[12:15], v[64:67], v[108:111], v[12:15]
    v_mfma_f32_16x16x32_bf16 v[44:47], v[68:71], v[108:111], v[44:47]
    v_mfma_f32_16x16x32_bf16 v[8:11], v[72:75], v[108:111], v[8:11]
    v_mfma_f32_16x16x32_bf16 v[40:43], v[76:79], v[108:111], v[40:43]
    v_mfma_f32_16x16x32_bf16 v[4:7], v[80:83], v[108:111], v[4:7]
    v_mfma_f32_16x16x32_bf16 v[36:39], v[84:87], v[108:111], v[36:39]
    v_mfma_f32_16x16x32_bf16 v[0:3], v[88:91], v[108:111], v[0:3]
    v_mfma_f32_16x16x32_bf16 v[32:35], v[92:95], v[108:111], v[32:35]
    ds_read_b128 v[108:111], v121 offset:1024
    s_waitcnt lgkmcnt(5)
    v_mfma_f32_16x16x32_bf16 v[16:19], v[64:67], v[112:115], v[16:19]
    v_mfma_f32_16x16x32_bf16 v[48:51], v[68:71], v[112:115], v[48:51]
    v_mfma_f32_16x16x32_bf16 v[12:15], v[72:75], v[112:115], v[12:15]
    v_mfma_f32_16x16x32_bf16 v[44:47], v[76:79], v[112:115], v[44:47]
    v_mfma_f32_16x16x32_bf16 v[8:11], v[80:83], v[112:115], v[8:11]
    v_mfma_f32_16x16x32_bf16 v[40:43], v[84:87], v[112:115], v[40:43]
    v_mfma_f32_16x16x32_bf16 v[4:7], v[88:91], v[112:115], v[4:7]
    v_mfma_f32_16x16x32_bf16 v[36:39], v[92:95], v[112:115], v[36:39]
    ds_read_b128 v[112:115], v121 offset:2048
    s_waitcnt lgkmcnt(5)
    v_mfma_f32_16x16x32_bf16 v[20:23], v[64:67], v[116:119], v[20:23]
    v_mfma_f32_16x16x32_bf16 v[52:55], v[68:71], v[116:119], v[52:55]
    v_mfma_f32_16x16x32_bf16 v[16:19], v[72:75], v[116:119], v[16:19]
    v_mfma_f32_16x16x32_bf16 v[48:51], v[76:79], v[116:119], v[48:51]
    v_mfma_f32_16x16x32_bf16 v[12:15], v[80:83], v[116:119], v[12:15]
    v_mfma_f32_16x16x32_bf16 v[44:47], v[84:87], v[116:119], v[44:47]
    v_mfma_f32_16x16x32_bf16 v[8:11], v[88:91], v[116:119], v[8:11]
    v_mfma_f32_16x16x32_bf16 v[40:43], v[92:95], v[116:119], v[40:43]
    s_waitcnt lgkmcnt(4)
    v_mfma_f32_16x16x32_bf16 v[24:27], v[64:67], v[96:99], v[24:27]
    v_mfma_f32_16x16x32_bf16 v[56:59], v[68:71], v[96:99], v[56:59]
    v_mfma_f32_16x16x32_bf16 v[20:23], v[72:75], v[96:99], v[20:23]
    v_mfma_f32_16x16x32_bf16 v[52:55], v[76:79], v[96:99], v[52:55]
    v_mfma_f32_16x16x32_bf16 v[16:19], v[80:83], v[96:99], v[16:19]
    v_mfma_f32_16x16x32_bf16 v[48:51], v[84:87], v[96:99], v[48:51]
    v_mfma_f32_16x16x32_bf16 v[12:15], v[88:91], v[96:99], v[12:15]
    v_mfma_f32_16x16x32_bf16 v[44:47], v[92:95], v[96:99], v[44:47]
    s_waitcnt lgkmcnt(3)
    v_mfma_f32_16x16x32_bf16 v[28:31], v[64:67], v[100:103], v[28:31]
    v_mfma_f32_16x16x32_bf16 v[60:63], v[68:71], v[100:103], v[60:63]
    v_mfma_f32_16x16x32_bf16 v[24:27], v[72:75], v[100:103], v[24:27]
    v_mfma_f32_16x16x32_bf16 v[56:59], v[76:79], v[100:103], v[56:59]
    v_mfma_f32_16x16x32_bf16 v[20:23], v[80:83], v[100:103], v[20:23]
    v_mfma_f32_16x16x32_bf16 v[52:55], v[84:87], v[100:103], v[52:55]
    v_mfma_f32_16x16x32_bf16 v[16:19], v[88:91], v[100:103], v[16:19]
    v_mfma_f32_16x16x32_bf16 v[48:51], v[92:95], v[100:103], v[48:51]
    buffer_load_dwordx4 v[64:67], v125, s[12:15], s23 offen offset:0
    buffer_load_dwordx4 v[68:71], v125, s[12:15], s23 offen offset:1024
    s_waitcnt lgkmcnt(2)
    v_mfma_f32_16x16x32_bf16 v[28:31], v[72:75], v[104:107], v[28:31]
    v_mfma_f32_16x16x32_bf16 v[60:63], v[76:79], v[104:107], v[60:63]
    v_mfma_f32_16x16x32_bf16 v[24:27], v[80:83], v[104:107], v[24:27]
    v_mfma_f32_16x16x32_bf16 v[56:59], v[84:87], v[104:107], v[56:59]
    v_mfma_f32_16x16x32_bf16 v[20:23], v[88:91], v[104:107], v[20:23]
    v_mfma_f32_16x16x32_bf16 v[52:55], v[92:95], v[104:107], v[52:55]
    buffer_load_dwordx4 v[72:75], v125, s[12:15], s23 offen offset:2048
    buffer_load_dwordx4 v[76:79], v125, s[12:15], s23 offen offset:3072
    s_waitcnt lgkmcnt(1)
    v_mfma_f32_16x16x32_bf16 v[28:31], v[80:83], v[108:111], v[28:31]
    v_mfma_f32_16x16x32_bf16 v[60:63], v[84:87], v[108:111], v[60:63]
    v_mfma_f32_16x16x32_bf16 v[24:27], v[88:91], v[108:111], v[24:27]
    v_mfma_f32_16x16x32_bf16 v[56:59], v[92:95], v[108:111], v[56:59]
    buffer_load_dwordx4 v[80:83], v125, s[12:15], s26 offen offset:0
    buffer_load_dwordx4 v[84:87], v125, s[12:15], s26 offen offset:1024
    s_waitcnt lgkmcnt(0)
    v_mfma_f32_16x16x32_bf16 v[28:31], v[88:91], v[112:115], v[28:31]
    v_mfma_f32_16x16x32_bf16 v[60:63], v[92:95], v[112:115], v[60:63]
    buffer_load_dwordx4 v[88:91], v125, s[12:15], s26 offen offset:2048
    buffer_load_dwordx4 v[92:95], v125, s[12:15], s26 offen offset:3072
    s_add_u32 s23, s23, 57344
    s_add_u32 s26, s26, 57344
    s_barrier
    s_sub_u32 s22, s22, 1
    s_cmp_eq_u32 s22, 0
    s_cbranch_scc1 L_conv2_kernel_mlast1
    ds_read_b128 v[96:99], v120 offset:8192
    ds_read_b128 v[100:103], v120 offset:9216
    ds_read_b128 v[104:107], v120 offset:10240
    ds_read_b128 v[108:111], v120 offset:11264
    ds_read_b128 v[112:115], v120 offset:12288
    ds_read_b128 v[116:119], v120 offset:13312
    s_waitcnt vmcnt(6) lgkmcnt(5)
    v_mfma_f32_16x16x32_bf16 v[0:3], v[64:67], v[96:99], v[0:3]
    v_mfma_f32_16x16x32_bf16 v[32:35], v[68:71], v[96:99], v[32:35]
    ds_read_b128 v[96:99], v120 offset:14336
    s_waitcnt vmcnt(4) lgkmcnt(5)
    v_mfma_f32_16x16x32_bf16 v[4:7], v[64:67], v[100:103], v[4:7]
    v_mfma_f32_16x16x32_bf16 v[36:39], v[68:71], v[100:103], v[36:39]
    v_mfma_f32_16x16x32_bf16 v[0:3], v[72:75], v[100:103], v[0:3]
    v_mfma_f32_16x16x32_bf16 v[32:35], v[76:79], v[100:103], v[32:35]
    ds_read_b128 v[100:103], v120 offset:15360
    s_waitcnt vmcnt(2) lgkmcnt(5)
    v_mfma_f32_16x16x32_bf16 v[8:11], v[64:67], v[104:107], v[8:11]
    v_mfma_f32_16x16x32_bf16 v[40:43], v[68:71], v[104:107], v[40:43]
    v_mfma_f32_16x16x32_bf16 v[4:7], v[72:75], v[104:107], v[4:7]
    v_mfma_f32_16x16x32_bf16 v[36:39], v[76:79], v[104:107], v[36:39]
    v_mfma_f32_16x16x32_bf16 v[0:3], v[80:83], v[104:107], v[0:3]
    v_mfma_f32_16x16x32_bf16 v[32:35], v[84:87], v[104:107], v[32:35]
    ds_read_b128 v[104:107], v122 offset:0
    v_add_u32 v122, v124, v122
    s_waitcnt vmcnt(0) lgkmcnt(5)
    v_mfma_f32_16x16x32_bf16 v[12:15], v[64:67], v[108:111], v[12:15]
    v_mfma_f32_16x16x32_bf16 v[44:47], v[68:71], v[108:111], v[44:47]
    v_mfma_f32_16x16x32_bf16 v[8:11], v[72:75], v[108:111], v[8:11]
    v_mfma_f32_16x16x32_bf16 v[40:43], v[76:79], v[108:111], v[40:43]
    v_mfma_f32_16x16x32_bf16 v[4:7], v[80:83], v[108:111], v[4:7]
    v_mfma_f32_16x16x32_bf16 v[36:39], v[84:87], v[108:111], v[36:39]
    v_mfma_f32_16x16x32_bf16 v[0:3], v[88:91], v[108:111], v[0:3]
    v_mfma_f32_16x16x32_bf16 v[32:35], v[92:95], v[108:111], v[32:35]
    ds_read_b128 v[108:111], v121 offset:9216
    s_waitcnt lgkmcnt(5)
    v_mfma_f32_16x16x32_bf16 v[16:19], v[64:67], v[112:115], v[16:19]
    v_mfma_f32_16x16x32_bf16 v[48:51], v[68:71], v[112:115], v[48:51]
    v_mfma_f32_16x16x32_bf16 v[12:15], v[72:75], v[112:115], v[12:15]
    v_mfma_f32_16x16x32_bf16 v[44:47], v[76:79], v[112:115], v[44:47]
    v_mfma_f32_16x16x32_bf16 v[8:11], v[80:83], v[112:115], v[8:11]
    v_mfma_f32_16x16x32_bf16 v[40:43], v[84:87], v[112:115], v[40:43]
    v_mfma_f32_16x16x32_bf16 v[4:7], v[88:91], v[112:115], v[4:7]
    v_mfma_f32_16x16x32_bf16 v[36:39], v[92:95], v[112:115], v[36:39]
    ds_read_b128 v[112:115], v121 offset:10240
    s_waitcnt lgkmcnt(5)
    v_mfma_f32_16x16x32_bf16 v[20:23], v[64:67], v[116:119], v[20:23]
    v_mfma_f32_16x16x32_bf16 v[52:55], v[68:71], v[116:119], v[52:55]
    v_mfma_f32_16x16x32_bf16 v[16:19], v[72:75], v[116:119], v[16:19]
    v_mfma_f32_16x16x32_bf16 v[48:51], v[76:79], v[116:119], v[48:51]
    v_mfma_f32_16x16x32_bf16 v[12:15], v[80:83], v[116:119], v[12:15]
    v_mfma_f32_16x16x32_bf16 v[44:47], v[84:87], v[116:119], v[44:47]
    v_mfma_f32_16x16x32_bf16 v[8:11], v[88:91], v[116:119], v[8:11]
    v_mfma_f32_16x16x32_bf16 v[40:43], v[92:95], v[116:119], v[40:43]
    s_waitcnt lgkmcnt(4)
    v_mfma_f32_16x16x32_bf16 v[24:27], v[64:67], v[96:99], v[24:27]
    v_mfma_f32_16x16x32_bf16 v[56:59], v[68:71], v[96:99], v[56:59]
    v_mfma_f32_16x16x32_bf16 v[20:23], v[72:75], v[96:99], v[20:23]
    v_mfma_f32_16x16x32_bf16 v[52:55], v[76:79], v[96:99], v[52:55]
    v_mfma_f32_16x16x32_bf16 v[16:19], v[80:83], v[96:99], v[16:19]
    v_mfma_f32_16x16x32_bf16 v[48:51], v[84:87], v[96:99], v[48:51]
    v_mfma_f32_16x16x32_bf16 v[12:15], v[88:91], v[96:99], v[12:15]
    v_mfma_f32_16x16x32_bf16 v[44:47], v[92:95], v[96:99], v[44:47]
    s_waitcnt lgkmcnt(3)
    v_mfma_f32_16x16x32_bf16 v[28:31], v[64:67], v[100:103], v[28:31]
    v_mfma_f32_16x16x32_bf16 v[60:63], v[68:71], v[100:103], v[60:63]
    v_mfma_f32_16x16x32_bf16 v[24:27], v[72:75], v[100:103], v[24:27]
    v_mfma_f32_16x16x32_bf16 v[56:59], v[76:79], v[100:103], v[56:59]
    v_mfma_f32_16x16x32_bf16 v[20:23], v[80:83], v[100:103], v[20:23]
    v_mfma_f32_16x16x32_bf16 v[52:55], v[84:87], v[100:103], v[52:55]
    v_mfma_f32_16x16x32_bf16 v[16:19], v[88:91], v[100:103], v[16:19]
    v_mfma_f32_16x16x32_bf16 v[48:51], v[92:95], v[100:103], v[48:51]
    buffer_load_dwordx4 v[64:67], v125, s[12:15], s23 offen offset:0
    buffer_load_dwordx4 v[68:71], v125, s[12:15], s23 offen offset:1024
    s_waitcnt lgkmcnt(2)
    v_mfma_f32_16x16x32_bf16 v[28:31], v[72:75], v[104:107], v[28:31]
    v_mfma_f32_16x16x32_bf16 v[60:63], v[76:79], v[104:107], v[60:63]
    v_mfma_f32_16x16x32_bf16 v[24:27], v[80:83], v[104:107], v[24:27]
    v_mfma_f32_16x16x32_bf16 v[56:59], v[84:87], v[104:107], v[56:59]
    v_mfma_f32_16x16x32_bf16 v[20:23], v[88:91], v[104:107], v[20:23]
    v_mfma_f32_16x16x32_bf16 v[52:55], v[92:95], v[104:107], v[52:55]
    buffer_load_dwordx4 v[72:75], v125, s[12:15], s23 offen offset:2048
    buffer_load_dwordx4 v[76:79], v125, s[12:15], s23 offen offset:3072
    s_waitcnt lgkmcnt(1)
    v_mfma_f32_16x16x32_bf16 v[28:31], v[80:83], v[108:111], v[28:31]
    v_mfma_f32_16x16x32_bf16 v[60:63], v[84:87], v[108:111], v[60:63]
    v_mfma_f32_16x16x32_bf16 v[24:27], v[88:91], v[108:111], v[24:27]
    v_mfma_f32_16x16x32_bf16 v[56:59], v[92:95], v[108:111], v[56:59]
    buffer_load_dwordx4 v[80:83], v125, s[12:15], s26 offen offset:0
    buffer_load_dwordx4 v[84:87], v125, s[12:15], s26 offen offset:1024
    s_waitcnt lgkmcnt(0)
    v_mfma_f32_16x16x32_bf16 v[28:31], v[88:91], v[112:115], v[28:31]
    v_mfma_f32_16x16x32_bf16 v[60:63], v[92:95], v[112:115], v[60:63]
    buffer_load_dwordx4 v[88:91], v125, s[12:15], s26 offen offset:2048
    buffer_load_dwordx4 v[92:95], v125, s[12:15], s26 offen offset:3072
    s_add_u32 s23, s23, 57344
    s_add_u32 s26, s26, 57344
    s_barrier
    s_branch L_conv2_kernel_mloop1
L_conv2_kernel_mlast1:
    v_and_b32 v125, 15, v127
    v_and_b32 v126, 7, v127
    v_lshlrev_b32 v126, 4, v126
    v_lshl_add_u32 v125, v125, 7, v126
    v_lshrrev_b32 v126, 4, v127
    v_lshl_add_u32 v125, v126, 11, v125
    s_lshl_b32 s36, s20, 14
    s_add_u32 s37, s36, 8192
    v_add_u32 v126, s37, v125
    v_add_u32 v125, s36, v125
    ds_read_b128 v[96:99], v120 offset:8192
    ds_read_b128 v[100:103], v120 offset:9216
    ds_read_b128 v[104:107], v120 offset:10240
    ds_read_b128 v[108:111], v120 offset:11264
    ds_read_b128 v[112:115], v120 offset:12288
    ds_read_b128 v[116:119], v120 offset:13312
    s_waitcnt vmcnt(6) lgkmcnt(5)
    v_mfma_f32_16x16x32_bf16 v[0:3], v[64:67], v[96:99], v[0:3]
    v_mfma_f32_16x16x32_bf16 v[32:35], v[68:71], v[96:99], v[32:35]
    ds_read_b128 v[96:99], v120 offset:14336
    s_waitcnt vmcnt(4) lgkmcnt(5)
    v_mfma_f32_16x16x32_bf16 v[4:7], v[64:67], v[100:103], v[4:7]
    v_mfma_f32_16x16x32_bf16 v[36:39], v[68:71], v[100:103], v[36:39]
    v_mfma_f32_16x16x32_bf16 v[0:3], v[72:75], v[100:103], v[0:3]
    v_mfma_f32_16x16x32_bf16 v[32:35], v[76:79], v[100:103], v[32:35]
    ds_read_b128 v[100:103], v120 offset:15360
    s_waitcnt vmcnt(2) lgkmcnt(5)
    v_mfma_f32_16x16x32_bf16 v[8:11], v[64:67], v[104:107], v[8:11]
    v_mfma_f32_16x16x32_bf16 v[40:43], v[68:71], v[104:107], v[40:43]
    v_mfma_f32_16x16x32_bf16 v[4:7], v[72:75], v[104:107], v[4:7]
    v_mfma_f32_16x16x32_bf16 v[36:39], v[76:79], v[104:107], v[36:39]
    v_mfma_f32_16x16x32_bf16 v[0:3], v[80:83], v[104:107], v[0:3]
    v_mfma_f32_16x16x32_bf16 v[32:35], v[84:87], v[104:107], v[32:35]
    ds_read_b128 v[104:107], v122 offset:0
    s_waitcnt vmcnt(0) lgkmcnt(5)
    v_mfma_f32_16x16x32_bf16 v[12:15], v[64:67], v[108:111], v[12:15]
    v_mfma_f32_16x16x32_bf16 v[44:47], v[68:71], v[108:111], v[44:47]
    v_mfma_f32_16x16x32_bf16 v[8:11], v[72:75], v[108:111], v[8:11]
    v_mfma_f32_16x16x32_bf16 v[40:43], v[76:79], v[108:111], v[40:43]
    v_mfma_f32_16x16x32_bf16 v[4:7], v[80:83], v[108:111], v[4:7]
    v_mfma_f32_16x16x32_bf16 v[36:39], v[84:87], v[108:111], v[36:39]
    v_mfma_f32_16x16x32_bf16 v[0:3], v[88:91], v[108:111], v[0:3]
    v_mfma_f32_16x16x32_bf16 v[32:35], v[92:95], v[108:111], v[32:35]
    ds_read_b128 v[108:111], v121 offset:9216
    s_waitcnt lgkmcnt(5)
    v_mfma_f32_16x16x32_bf16 v[16:19], v[64:67], v[112:115], v[16:19]
    v_mfma_f32_16x16x32_bf16 v[48:51], v[68:71], v[112:115], v[48:51]
    v_mfma_f32_16x16x32_bf16 v[12:15], v[72:75], v[112:115], v[12:15]
    v_mfma_f32_16x16x32_bf16 v[44:47], v[76:79], v[112:115], v[44:47]
    v_mfma_f32_16x16x32_bf16 v[8:11], v[80:83], v[112:115], v[8:11]
    v_mfma_f32_16x16x32_bf16 v[40:43], v[84:87], v[112:115], v[40:43]
    v_mfma_f32_16x16x32_bf16 v[4:7], v[88:91], v[112:115], v[4:7]
    v_mfma_f32_16x16x32_bf16 v[36:39], v[92:95], v[112:115], v[36:39]
    ds_read_b128 v[112:115], v121 offset:10240
    v_xor_b32 v123, 0, v125
    ds_write_b128 v123, v[0:3]
    s_waitcnt lgkmcnt(6)
    v_mfma_f32_16x16x32_bf16 v[20:23], v[64:67], v[116:119], v[20:23]
    v_mfma_f32_16x16x32_bf16 v[52:55], v[68:71], v[116:119], v[52:55]
    v_mfma_f32_16x16x32_bf16 v[16:19], v[72:75], v[116:119], v[16:19]
    v_mfma_f32_16x16x32_bf16 v[48:51], v[76:79], v[116:119], v[48:51]
    v_mfma_f32_16x16x32_bf16 v[12:15], v[80:83], v[116:119], v[12:15]
    v_mfma_f32_16x16x32_bf16 v[44:47], v[84:87], v[116:119], v[44:47]
    v_mfma_f32_16x16x32_bf16 v[8:11], v[88:91], v[116:119], v[8:11]
    v_mfma_f32_16x16x32_bf16 v[40:43], v[92:95], v[116:119], v[40:43]
    v_xor_b32 v124, 16, v125
    ds_write_b128 v124, v[4:7]
    s_waitcnt lgkmcnt(2)
    v_mfma_f32_16x16x32_bf16 v[24:27], v[64:67], v[96:99], v[24:27]
    v_mfma_f32_16x16x32_bf16 v[56:59], v[68:71], v[96:99], v[56:59]
    v_mfma_f32_16x16x32_bf16 v[20:23], v[72:75], v[96:99], v[20:23]
    v_mfma_f32_16x16x32_bf16 v[52:55], v[76:79], v[96:99], v[52:55]
    v_mfma_f32_16x16x32_bf16 v[16:19], v[80:83], v[96:99], v[16:19]
    v_mfma_f32_16x16x32_bf16 v[48:51], v[84:87], v[96:99], v[48:51]
    v_mfma_f32_16x16x32_bf16 v[12:15], v[88:91], v[96:99], v[12:15]
    v_mfma_f32_16x16x32_bf16 v[44:47], v[92:95], v[96:99], v[44:47]
    v_xor_b32 v123, 32, v125
    ds_write_b128 v123, v[8:11]
    v_xor_b32 v124, 0, v126
    ds_write_b128 v124, v[32:35]
    v_mfma_f32_16x16x32_bf16 v[28:31], v[64:67], v[100:103], v[28:31]
    v_mfma_f32_16x16x32_bf16 v[60:63], v[68:71], v[100:103], v[60:63]
    v_mfma_f32_16x16x32_bf16 v[24:27], v[72:75], v[100:103], v[24:27]
    v_mfma_f32_16x16x32_bf16 v[56:59], v[76:79], v[100:103], v[56:59]
    v_mfma_f32_16x16x32_bf16 v[20:23], v[80:83], v[100:103], v[20:23]
    v_mfma_f32_16x16x32_bf16 v[52:55], v[84:87], v[100:103], v[52:55]
    v_mfma_f32_16x16x32_bf16 v[16:19], v[88:91], v[100:103], v[16:19]
    v_mfma_f32_16x16x32_bf16 v[48:51], v[92:95], v[100:103], v[48:51]
    v_xor_b32 v123, 16, v126
    ds_write_b128 v123, v[36:39]
    v_xor_b32 v124, 32, v126
    ds_write_b128 v124, v[40:43]
    v_mfma_f32_16x16x32_bf16 v[28:31], v[72:75], v[104:107], v[28:31]
    v_mfma_f32_16x16x32_bf16 v[60:63], v[76:79], v[104:107], v[60:63]
    v_mfma_f32_16x16x32_bf16 v[24:27], v[80:83], v[104:107], v[24:27]
    v_mfma_f32_16x16x32_bf16 v[56:59], v[84:87], v[104:107], v[56:59]
    v_mfma_f32_16x16x32_bf16 v[20:23], v[88:91], v[104:107], v[20:23]
    v_mfma_f32_16x16x32_bf16 v[52:55], v[92:95], v[104:107], v[52:55]
    v_xor_b32 v124, 48, v125
    ds_write_b128 v124, v[12:15]
    v_xor_b32 v123, 48, v126
    ds_write_b128 v123, v[44:47]
    v_mfma_f32_16x16x32_bf16 v[28:31], v[80:83], v[108:111], v[28:31]
    v_mfma_f32_16x16x32_bf16 v[60:63], v[84:87], v[108:111], v[60:63]
    v_mfma_f32_16x16x32_bf16 v[24:27], v[88:91], v[108:111], v[24:27]
    v_mfma_f32_16x16x32_bf16 v[56:59], v[92:95], v[108:111], v[56:59]
    v_xor_b32 v123, 64, v125
    ds_write_b128 v123, v[16:19]
    v_xor_b32 v124, 64, v126
    ds_write_b128 v124, v[48:51]
    v_mfma_f32_16x16x32_bf16 v[28:31], v[88:91], v[112:115], v[28:31]
    v_mfma_f32_16x16x32_bf16 v[60:63], v[92:95], v[112:115], v[60:63]
    v_xor_b32 v124, 80, v125
    ds_write_b128 v124, v[20:23]
    v_xor_b32 v123, 80, v126
    ds_write_b128 v123, v[52:55]
    v_and_b32 v108, 15, v127
    v_lshrrev_b32 v109, 4, v127
    v_lshrrev_b32 v110, 3, v108
    s_lshl_b32 s36, s20, 1
    v_add_u32 v110, s36, v110
    v_xor_b32 v111, v110, v108
    v_and_b32 v111, 7, v111
    v_lshlrev_b32 v111, 4, v111
    v_xor_b32 v123, 96, v125
    ds_write_b128 v123, v[24:27]
    v_lshl_add_u32 v111, v110, 7, v111
    v_lshl_add_u32 v120, v109, 11, v111
    v_add_u32 v121, 65536, v120
    v_add_u32 v64, 131072, v120
    s_lshl_b32 s36, s20, 9
    s_add_u32 s36, s36, 115712
    v_lshl_add_u32 v127, v109, 7, s36
    s_lshl_b32 s36, s20, 4
    v_add_u32 v108, s36, v108
    v_lshlrev_b32 v110, 6, v108
    v_lshl_add_u32 v110, v109, 4, v110
    s_mul_i32 s36, s29, 262144
    v_xor_b32 v124, 96, v126
    ds_write_b128 v124, v[56:59]
    s_lshl_b32 s37, s21, 4
    s_add_u32 s36, s36, s37
    v_add_u32 v110, s36, v110
    v_mov_b32 v111, 2130706432
    v_cmp_gt_u32 vcc, 125, v108
    s_mov_b32 s4, 0xbeaaaaab
    s_mov_b32 s5, s4
    s_mov_b32 s6, 0x3e800000
    s_mov_b32 s7, s6
    s_mov_b32 s8, 0xc0a00000
    s_mov_b32 s9, s8
    s_mov_b32 s10, 0xc0638e39
    v_xor_b32 v124, 112, v125
    ds_write_b128 v124, v[28:31]
    s_mov_b32 s11, s10
    s_mov_b32 s12, 0xbf638e39
    s_mov_b32 s13, s12
    s_mov_b32 s14, 0xbe638e39
    s_mov_b32 s15, s14
    s_mov_b32 s22, 0xbd638e39
    s_mov_b32 s23, s22
    s_mov_b32 s24, 0x3ff1c71c
    s_mov_b32 s25, s24
    s_mov_b32 s26, 0xbf2aaaab
    s_mov_b32 s27, s26
    s_mov_b32 s32, 0x3ecccccd
    v_xor_b32 v123, 112, v126
    s_waitcnt lgkmcnt(8)
    ds_write_b128 v123, v[60:63]
    s_mov_b32 s33, s32
    s_mov_b32 s34, 0xbd888889
    s_mov_b32 s35, s34
    s_mov_b32 s38, 0xbe4ccccd
    s_mov_b32 s39, s38
    s_mov_b32 s40, 0xbdd2d3e8
    s_mov_b32 s41, s40
    s_mov_b32 s42, 0x3f800000
    s_mov_b32 s43, s42
    s_setprio 0
    s_branch L_conv2_kernel_epi
L_conv2_kernel_m2:
    s_mul_i32 s37, s38, 2176
    s_add_u32 s37, s37, 98304
    v_add_u32 v116, s37, v8
    v_add_u32 v118, s37, v9
    v_add_u32 v117, 104832, v8
    s_cmp_eq_u32 s38, 0
    s_cbranch_scc1 L_conv2_kernel_hh0
    v_add_u32 v117, 98304, v9
L_conv2_kernel_hh0:
    s_lshl_b32 s37, s38, 12
    s_add_u32 s37, s37, s43
    s_add_u32 s37, s37, 49152
    v_lshl_add_u32 v119, v127, 4, s37
    v_mov_b32 v0, 0
    v_mov_b32 v1, 0
    v_mov_b32 v2, 0
    v_mov_b32 v3, 0
    v_mov_b32 v4, 0
    v_mov_b32 v5, 0
    v_mov_b32 v6, 0
    v_mov_b32 v7, 0
    v_mov_b32 v8, 0
    v_mov_b32 v9, 0
    v_mov_b32 v10, 0
    v_mov_b32 v11, 0
    v_mov_b32 v12, 0
    v_mov_b32 v13, 0
    v_mov_b32 v14, 0
    v_mov_b32 v15, 0
    v_mov_b32 v16, 0
    v_mov_b32 v17, 0
    v_mov_b32 v18, 0
    v_mov_b32 v19, 0
    v_mov_b32 v20, 0
    v_mov_b32 v21, 0
    v_mov_b32 v22, 0
    v_mov_b32 v23, 0
    v_mov_b32 v24, 0
    v_mov_b32 v25, 0
    v_mov_b32 v26, 0
    v_mov_b32 v27, 0
    v_mov_b32 v28, 0
    v_mov_b32 v29, 0
    v_mov_b32 v30, 0
    v_mov_b32 v31, 0
    v_mov_b32 v32, 0
    v_mov_b32 v33, 0
    v_mov_b32 v34, 0
    v_mov_b32 v35, 0
    v_mov_b32 v36, 0
    v_mov_b32 v37, 0
    v_mov_b32 v38, 0
    v_mov_b32 v39, 0
    v_mov_b32 v40, 0
    v_mov_b32 v41, 0
    v_mov_b32 v42, 0
    v_mov_b32 v43, 0
    v_mov_b32 v44, 0
    v_mov_b32 v45, 0
    v_mov_b32 v46, 0
    v_mov_b32 v47, 0
    v_mov_b32 v48, 0
    v_mov_b32 v49, 0
    v_mov_b32 v50, 0
    v_mov_b32 v51, 0
    v_mov_b32 v52, 0
    v_mov_b32 v53, 0
    v_mov_b32 v54, 0
    v_mov_b32 v55, 0
    v_mov_b32 v56, 0
    v_mov_b32 v57, 0
    v_mov_b32 v58, 0
    v_mov_b32 v59, 0
    v_mov_b32 v60, 0
    v_mov_b32 v61, 0
    v_mov_b32 v62, 0
    v_mov_b32 v63, 0
    buffer_load_dwordx4 v[96:99], v108, s[8:11], 0 offen
    buffer_load_dwordx4 v[100:103], v109, s[8:11], 0 offen
    buffer_load_dwordx4 v[104:107], v110, s[8:11], 0 offen
    s_mov_b32 s23, 0
    s_mov_b32 s26, 4096
    buffer_load_dwordx4 v[64:67], v125, s[12:15], s23 offen offset:0
    buffer_load_dwordx4 v[68:71], v125, s[12:15], s23 offen offset:2048
    buffer_load_dwordx4 v[80:83], v119, s[12:15], s23 offen offset:0
    buffer_load_dwordx4 v[72:75], v125, s[12:15], s26 offen offset:0
    buffer_load_dwordx4 v[84:87], v119, s[12:15], s23 offen offset:2048
    buffer_load_dwordx4 v[76:79], v125, s[12:15], s26 offen offset:2048
    s_mov_b32 s23, 57344
    s_mov_b32 s26, 61440
    s_waitcnt vmcnt(6)
    v_lshlrev_b32 v108, 16, v96
    v_and_b32 v111, s25, v96
    v_lshlrev_b32 v109, 16, v100
    v_and_b32 v112, s25, v100
    v_lshlrev_b32 v110, 16, v104
    v_and_b32 v113, s25, v104
    v_mul_f32 v114, s44, v108
    v_mul_f32 v115, s44, v111
    v_fmac_f32 v114, s45, v109
    v_fmac_f32 v115, s45, v112
    v_fmac_f32 v114, s46, v110
    v_fmac_f32 v115, s46, v113
    v_cvt_pk_bf16_f32 v96, v114, v115
    v_lshlrev_b32 v108, 16, v97
    v_and_b32 v111, s25, v97
    v_lshlrev_b32 v109, 16, v101
    v_and_b32 v112, s25, v101
    v_lshlrev_b32 v110, 16, v105
    v_and_b32 v113, s25, v105
    v_mul_f32 v114, s44, v108
    v_mul_f32 v115, s44, v111
    v_fmac_f32 v114, s45, v109
    v_fmac_f32 v115, s45, v112
    v_fmac_f32 v114, s46, v110
    v_fmac_f32 v115, s46, v113
    v_cvt_pk_bf16_f32 v97, v114, v115
    v_lshlrev_b32 v108, 16, v98
    v_and_b32 v111, s25, v98
    v_lshlrev_b32 v109, 16, v102
    v_and_b32 v112, s25, v102
    v_lshlrev_b32 v110, 16, v106
    v_and_b32 v113, s25, v106
    v_mul_f32 v114, s44, v108
    v_mul_f32 v115, s44, v111
    v_fmac_f32 v114, s45, v109
    v_fmac_f32 v115, s45, v112
    v_fmac_f32 v114, s46, v110
    v_fmac_f32 v115, s46, v113
    v_cvt_pk_bf16_f32 v98, v114, v115
    v_lshlrev_b32 v108, 16, v99
    v_and_b32 v111, s25, v99
    v_lshlrev_b32 v109, 16, v103
    v_and_b32 v112, s25, v103
    v_lshlrev_b32 v110, 16, v107
    v_and_b32 v113, s25, v107
    v_mul_f32 v114, s44, v108
    v_mul_f32 v115, s44, v111
    v_fmac_f32 v114, s45, v109
    v_fmac_f32 v115, s45, v112
    v_fmac_f32 v114, s46, v110
    v_fmac_f32 v115, s46, v113
    v_cvt_pk_bf16_f32 v99, v114, v115
    ds_write_b128 v126, v[96:99]
    v_and_b32 v111, 15, v127
    v_lshlrev_b32 v111, 2, v111
    v_add_u32 v111, 99328, v111
    ds_write_b32 v111, v0
    ds_write_b32 v111, v0 offset:8704
    s_waitcnt lgkmcnt(0)
    s_barrier
    s_mov_b32 s22, 4
    s_setprio 2
L_conv2_kernel_mloop2:
    ds_read_b128 v[88:91], v120 offset:0
    ds_read_b128 v[92:95], v120 offset:1024
    ds_read_b128 v[96:99], v116 offset:0
    ds_read_b128 v[100:103], v120 offset:2048
    ds_read_b128 v[104:107], v116 offset:1088
    ds_read_b128 v[108:111], v120 offset:3072
    ds_read_b128 v[112:115], v116 offset:2176
    s_waitcnt vmcnt(5) lgkmcnt(6)
    v_mfma_f32_16x16x32_bf16 v[0:3], v[64:67], v[88:91], v[0:3]
    ds_read_b128 v[88:91], v120 offset:4096
    s_waitcnt vmcnt(4) lgkmcnt(6)
    v_mfma_f32_16x16x32_bf16 v[4:7], v[64:67], v[92:95], v[4:7]
    v_mfma_f32_16x16x32_bf16 v[0:3], v[68:71], v[92:95], v[0:3]
    ds_read_b128 v[92:95], v116 offset:3264
    s_waitcnt vmcnt(3) lgkmcnt(6)
    v_mfma_f32_16x16x32_bf16 v[32:35], v[80:83], v[96:99], v[32:35]
    ds_read_b128 v[96:99], v120 offset:5120
    s_waitcnt vmcnt(2) lgkmcnt(6)
    v_mfma_f32_16x16x32_bf16 v[8:11], v[64:67], v[100:103], v[8:11]
    v_mfma_f32_16x16x32_bf16 v[4:7], v[68:71], v[100:103], v[4:7]
    v_mfma_f32_16x16x32_bf16 v[0:3], v[72:75], v[100:103], v[0:3]
    ds_read_b128 v[100:103], v116 offset:4352
    s_waitcnt vmcnt(1) lgkmcnt(6)
    v_mfma_f32_16x16x32_bf16 v[36:39], v[80:83], v[104:107], v[36:39]
    v_mfma_f32_16x16x32_bf16 v[32:35], v[84:87], v[104:107], v[32:35]
    ds_read_b128 v[104:107], v120 offset:6144
    s_waitcnt vmcnt(0) lgkmcnt(6)
    v_mfma_f32_16x16x32_bf16 v[12:15], v[64:67], v[108:111], v[12:15]
    v_mfma_f32_16x16x32_bf16 v[8:11], v[68:71], v[108:111], v[8:11]
    v_mfma_f32_16x16x32_bf16 v[4:7], v[72:75], v[108:111], v[4:7]
    v_mfma_f32_16x16x32_bf16 v[0:3], v[76:79], v[108:111], v[0:3]
    ds_read_b128 v[108:111], v116 offset:5440
    s_waitcnt lgkmcnt(6)
    v_mfma_f32_16x16x32_bf16 v[40:43], v[80:83], v[112:115], v[40:43]
    v_mfma_f32_16x16x32_bf16 v[36:39], v[84:87], v[112:115], v[36:39]
    ds_read_b128 v[112:115], v120 offset:7168
    s_waitcnt lgkmcnt(6)
    v_mfma_f32_16x16x32_bf16 v[16:19], v[64:67], v[88:91], v[16:19]
    v_mfma_f32_16x16x32_bf16 v[12:15], v[68:71], v[88:91], v[12:15]
    v_mfma_f32_16x16x32_bf16 v[8:11], v[72:75], v[88:91], v[8:11]
    v_mfma_f32_16x16x32_bf16 v[4:7], v[76:79], v[88:91], v[4:7]
    ds_read_b128 v[88:91], v117 offset:0
    s_waitcnt lgkmcnt(6)
    v_mfma_f32_16x16x32_bf16 v[44:47], v[80:83], v[92:95], v[44:47]
    v_mfma_f32_16x16x32_bf16 v[40:43], v[84:87], v[92:95], v[40:43]
    ds_read_b128 v[92:95], v122 offset:0
    v_add_u32 v122, v123, v122
    s_waitcnt lgkmcnt(6)
    v_mfma_f32_16x16x32_bf16 v[20:23], v[64:67], v[96:99], v[20:23]
    v_mfma_f32_16x16x32_bf16 v[16:19], v[68:71], v[96:99], v[16:19]
    v_mfma_f32_16x16x32_bf16 v[12:15], v[72:75], v[96:99], v[12:15]
    v_mfma_f32_16x16x32_bf16 v[8:11], v[76:79], v[96:99], v[8:11]
    ds_read_b128 v[96:99], v117 offset:1088
    s_waitcnt lgkmcnt(6)
    v_mfma_f32_16x16x32_bf16 v[48:51], v[80:83], v[100:103], v[48:51]
    v_mfma_f32_16x16x32_bf16 v[44:47], v[84:87], v[100:103], v[44:47]
    ds_read_b128 v[100:103], v121 offset:1024
    s_waitcnt lgkmcnt(6)
    v_mfma_f32_16x16x32_bf16 v[24:27], v[64:67], v[104:107], v[24:27]
    v_mfma_f32_16x16x32_bf16 v[20:23], v[68:71], v[104:107], v[20:23]
    v_mfma_f32_16x16x32_bf16 v[16:19], v[72:75], v[104:107], v[16:19]
    v_mfma_f32_16x16x32_bf16 v[12:15], v[76:79], v[104:107], v[12:15]
    ds_read_b128 v[104:107], v118 offset:0
    s_waitcnt lgkmcnt(6)
    v_mfma_f32_16x16x32_bf16 v[52:55], v[80:83], v[108:111], v[52:55]
    v_mfma_f32_16x16x32_bf16 v[48:51], v[84:87], v[108:111], v[48:51]
    ds_read_b128 v[108:111], v121 offset:2048
    s_waitcnt lgkmcnt(6)
    v_mfma_f32_16x16x32_bf16 v[28:31], v[64:67], v[112:115], v[28:31]
    v_mfma_f32_16x16x32_bf16 v[24:27], v[68:71], v[112:115], v[24:27]
    v_mfma_f32_16x16x32_bf16 v[20:23], v[72:75], v[112:115], v[20:23]
    v_mfma_f32_16x16x32_bf16 v[16:19], v[76:79], v[112:115], v[16:19]
    buffer_load_dwordx4 v[64:67], v125, s[12:15], s23 offen offset:0
    s_waitcnt lgkmcnt(5)
    v_mfma_f32_16x16x32_bf16 v[56:59], v[80:83], v[88:91], v[56:59]
    v_mfma_f32_16x16x32_bf16 v[52:55], v[84:87], v[88:91], v[52:55]
    s_waitcnt lgkmcnt(0)
    s_barrier
    v_mfma_f32_16x16x32_bf16 v[28:31], v[68:71], v[92:95], v[28:31]
    v_mfma_f32_16x16x32_bf16 v[24:27], v[72:75], v[92:95], v[24:27]
    v_mfma_f32_16x16x32_bf16 v[20:23], v[76:79], v[92:95], v[20:23]
    buffer_load_dwordx4 v[68:71], v125, s[12:15], s23 offen offset:2048
    v_mfma_f32_16x16x32_bf16 v[60:63], v[80:83], v[96:99], v[60:63]
    v_mfma_f32_16x16x32_bf16 v[56:59], v[84:87], v[96:99], v[56:59]
    buffer_load_dwordx4 v[80:83], v119, s[12:15], s23 offen offset:0
    v_mfma_f32_16x16x32_bf16 v[28:31], v[72:75], v[100:103], v[28:31]
    v_mfma_f32_16x16x32_bf16 v[24:27], v[76:79], v[100:103], v[24:27]
    buffer_load_dwordx4 v[72:75], v125, s[12:15], s26 offen offset:0
    v_mfma_f32_16x16x32_bf16 v[60:63], v[84:87], v[104:107], v[60:63]
    buffer_load_dwordx4 v[84:87], v119, s[12:15], s23 offen offset:2048
    v_mfma_f32_16x16x32_bf16 v[28:31], v[76:79], v[108:111], v[28:31]
    buffer_load_dwordx4 v[76:79], v125, s[12:15], s26 offen offset:2048
    s_add_u32 s23, s23, 57344
    s_add_u32 s26, s26, 57344
    s_sub_u32 s22, s22, 1
    s_cmp_eq_u32 s22, 0
    s_cbranch_scc1 L_conv2_kernel_mlast2
    ds_read_b128 v[88:91], v120 offset:8192
    ds_read_b128 v[92:95], v120 offset:9216
    ds_read_b128 v[96:99], v116 offset:8704
    ds_read_b128 v[100:103], v120 offset:10240
    ds_read_b128 v[104:107], v116 offset:9792
    ds_read_b128 v[108:111], v120 offset:11264
    ds_read_b128 v[112:115], v116 offset:10880
    s_waitcnt vmcnt(5) lgkmcnt(6)
    v_mfma_f32_16x16x32_bf16 v[0:3], v[64:67], v[88:91], v[0:3]
    ds_read_b128 v[88:91], v120 offset:12288
    s_waitcnt vmcnt(4) lgkmcnt(6)
    v_mfma_f32_16x16x32_bf16 v[4:7], v[64:67], v[92:95], v[4:7]
    v_mfma_f32_16x16x32_bf16 v[0:3], v[68:71], v[92:95], v[0:3]
    ds_read_b128 v[92:95], v116 offset:11968
    s_waitcnt vmcnt(3) lgkmcnt(6)
    v_mfma_f32_16x16x32_bf16 v[32:35], v[80:83], v[96:99], v[32:35]
    ds_read_b128 v[96:99], v120 offset:13312
    s_waitcnt vmcnt(2) lgkmcnt(6)
    v_mfma_f32_16x16x32_bf16 v[8:11], v[64:67], v[100:103], v[8:11]
    v_mfma_f32_16x16x32_bf16 v[4:7], v[68:71], v[100:103], v[4:7]
    v_mfma_f32_16x16x32_bf16 v[0:3], v[72:75], v[100:103], v[0:3]
    ds_read_b128 v[100:103], v116 offset:13056
    s_waitcnt vmcnt(1) lgkmcnt(6)
    v_mfma_f32_16x16x32_bf16 v[36:39], v[80:83], v[104:107], v[36:39]
    v_mfma_f32_16x16x32_bf16 v[32:35], v[84:87], v[104:107], v[32:35]
    ds_read_b128 v[104:107], v120 offset:14336
    s_waitcnt vmcnt(0) lgkmcnt(6)
    v_mfma_f32_16x16x32_bf16 v[12:15], v[64:67], v[108:111], v[12:15]
    v_mfma_f32_16x16x32_bf16 v[8:11], v[68:71], v[108:111], v[8:11]
    v_mfma_f32_16x16x32_bf16 v[4:7], v[72:75], v[108:111], v[4:7]
    v_mfma_f32_16x16x32_bf16 v[0:3], v[76:79], v[108:111], v[0:3]
    ds_read_b128 v[108:111], v116 offset:14144
    s_waitcnt lgkmcnt(6)
    v_mfma_f32_16x16x32_bf16 v[40:43], v[80:83], v[112:115], v[40:43]
    v_mfma_f32_16x16x32_bf16 v[36:39], v[84:87], v[112:115], v[36:39]
    ds_read_b128 v[112:115], v120 offset:15360
    s_waitcnt lgkmcnt(6)
    v_mfma_f32_16x16x32_bf16 v[16:19], v[64:67], v[88:91], v[16:19]
    v_mfma_f32_16x16x32_bf16 v[12:15], v[68:71], v[88:91], v[12:15]
    v_mfma_f32_16x16x32_bf16 v[8:11], v[72:75], v[88:91], v[8:11]
    v_mfma_f32_16x16x32_bf16 v[4:7], v[76:79], v[88:91], v[4:7]
    ds_read_b128 v[88:91], v117 offset:8704
    s_waitcnt lgkmcnt(6)
    v_mfma_f32_16x16x32_bf16 v[44:47], v[80:83], v[92:95], v[44:47]
    v_mfma_f32_16x16x32_bf16 v[40:43], v[84:87], v[92:95], v[40:43]
    ds_read_b128 v[92:95], v122 offset:0
    v_add_u32 v122, v124, v122
    s_waitcnt lgkmcnt(6)
    v_mfma_f32_16x16x32_bf16 v[20:23], v[64:67], v[96:99], v[20:23]
    v_mfma_f32_16x16x32_bf16 v[16:19], v[68:71], v[96:99], v[16:19]
    v_mfma_f32_16x16x32_bf16 v[12:15], v[72:75], v[96:99], v[12:15]
    v_mfma_f32_16x16x32_bf16 v[8:11], v[76:79], v[96:99], v[8:11]
    ds_read_b128 v[96:99], v117 offset:9792
    s_waitcnt lgkmcnt(6)
    v_mfma_f32_16x16x32_bf16 v[48:51], v[80:83], v[100:103], v[48:51]
    v_mfma_f32_16x16x32_bf16 v[44:47], v[84:87], v[100:103], v[44:47]
    ds_read_b128 v[100:103], v121 offset:9216
    s_waitcnt lgkmcnt(6)
    v_mfma_f32_16x16x32_bf16 v[24:27], v[64:67], v[104:107], v[24:27]
    v_mfma_f32_16x16x32_bf16 v[20:23], v[68:71], v[104:107], v[20:23]
    v_mfma_f32_16x16x32_bf16 v[16:19], v[72:75], v[104:107], v[16:19]
    v_mfma_f32_16x16x32_bf16 v[12:15], v[76:79], v[104:107], v[12:15]
    ds_read_b128 v[104:107], v118 offset:8704
    s_waitcnt lgkmcnt(6)
    v_mfma_f32_16x16x32_bf16 v[52:55], v[80:83], v[108:111], v[52:55]
    v_mfma_f32_16x16x32_bf16 v[48:51], v[84:87], v[108:111], v[48:51]
    ds_read_b128 v[108:111], v121 offset:10240
    s_waitcnt lgkmcnt(6)
    v_mfma_f32_16x16x32_bf16 v[28:31], v[64:67], v[112:115], v[28:31]
    v_mfma_f32_16x16x32_bf16 v[24:27], v[68:71], v[112:115], v[24:27]
    v_mfma_f32_16x16x32_bf16 v[20:23], v[72:75], v[112:115], v[20:23]
    v_mfma_f32_16x16x32_bf16 v[16:19], v[76:79], v[112:115], v[16:19]
    buffer_load_dwordx4 v[64:67], v125, s[12:15], s23 offen offset:0
    s_waitcnt lgkmcnt(5)
    v_mfma_f32_16x16x32_bf16 v[56:59], v[80:83], v[88:91], v[56:59]
    v_mfma_f32_16x16x32_bf16 v[52:55], v[84:87], v[88:91], v[52:55]
    s_waitcnt lgkmcnt(0)
    s_barrier
    v_mfma_f32_16x16x32_bf16 v[28:31], v[68:71], v[92:95], v[28:31]
    v_mfma_f32_16x16x32_bf16 v[24:27], v[72:75], v[92:95], v[24:27]
    v_mfma_f32_16x16x32_bf16 v[20:23], v[76:79], v[92:95], v[20:23]
    buffer_load_dwordx4 v[68:71], v125, s[12:15], s23 offen offset:2048
    v_mfma_f32_16x16x32_bf16 v[60:63], v[80:83], v[96:99], v[60:63]
    v_mfma_f32_16x16x32_bf16 v[56:59], v[84:87], v[96:99], v[56:59]
    buffer_load_dwordx4 v[80:83], v119, s[12:15], s23 offen offset:0
    v_mfma_f32_16x16x32_bf16 v[28:31], v[72:75], v[100:103], v[28:31]
    v_mfma_f32_16x16x32_bf16 v[24:27], v[76:79], v[100:103], v[24:27]
    buffer_load_dwordx4 v[72:75], v125, s[12:15], s26 offen offset:0
    v_mfma_f32_16x16x32_bf16 v[60:63], v[84:87], v[104:107], v[60:63]
    buffer_load_dwordx4 v[84:87], v119, s[12:15], s23 offen offset:2048
    v_mfma_f32_16x16x32_bf16 v[28:31], v[76:79], v[108:111], v[28:31]
    buffer_load_dwordx4 v[76:79], v125, s[12:15], s26 offen offset:2048
    s_add_u32 s23, s23, 57344
    s_add_u32 s26, s26, 57344
    s_branch L_conv2_kernel_mloop2
L_conv2_kernel_mlast2:
    v_and_b32 v125, 15, v127
    v_and_b32 v126, 7, v127
    v_lshlrev_b32 v126, 4, v126
    v_lshl_add_u32 v125, v125, 7, v126
    v_lshrrev_b32 v126, 4, v127
    v_lshl_add_u32 v125, v126, 11, v125
    s_mov_b32 s36, 65536
    s_cmp_eq_u32 s32, 1
    s_cselect_b32 s36, 121856, s36
    s_cmp_eq_u32 s32, 2
    s_cselect_b32 s36, 81920, s36
    s_cmp_eq_u32 s32, 3
    s_cselect_b32 s36, 130048, s36
    s_mov_b32 s37, 98304
    s_cmp_eq_u32 s32, 1
    s_cselect_b32 s37, 138240, s37
    s_cmp_eq_u32 s32, 2
    s_cselect_b32 s37, 146432, s37
    s_cmp_eq_u32 s32, 3
    s_cselect_b32 s37, 154624, s37
    v_add_u32 v126, s37, v125
    v_add_u32 v125, s36, v125
    ds_read_b128 v[88:91], v120 offset:8192
    ds_read_b128 v[92:95], v120 offset:9216
    ds_read_b128 v[96:99], v116 offset:8704
    ds_read_b128 v[100:103], v120 offset:10240
    ds_read_b128 v[104:107], v116 offset:9792
    ds_read_b128 v[108:111], v120 offset:11264
    ds_read_b128 v[112:115], v116 offset:10880
    s_waitcnt vmcnt(5) lgkmcnt(6)
    v_mfma_f32_16x16x32_bf16 v[0:3], v[64:67], v[88:91], v[0:3]
    ds_read_b128 v[88:91], v120 offset:12288
    s_waitcnt vmcnt(4) lgkmcnt(6)
    v_mfma_f32_16x16x32_bf16 v[4:7], v[64:67], v[92:95], v[4:7]
    v_mfma_f32_16x16x32_bf16 v[0:3], v[68:71], v[92:95], v[0:3]
    ds_read_b128 v[92:95], v116 offset:11968
    s_waitcnt vmcnt(3) lgkmcnt(6)
    v_mfma_f32_16x16x32_bf16 v[32:35], v[80:83], v[96:99], v[32:35]
    ds_read_b128 v[96:99], v120 offset:13312
    s_waitcnt vmcnt(2) lgkmcnt(6)
    v_mfma_f32_16x16x32_bf16 v[8:11], v[64:67], v[100:103], v[8:11]
    v_mfma_f32_16x16x32_bf16 v[4:7], v[68:71], v[100:103], v[4:7]
    v_mfma_f32_16x16x32_bf16 v[0:3], v[72:75], v[100:103], v[0:3]
    ds_read_b128 v[100:103], v116 offset:13056
    s_waitcnt vmcnt(1) lgkmcnt(6)
    v_mfma_f32_16x16x32_bf16 v[36:39], v[80:83], v[104:107], v[36:39]
    v_mfma_f32_16x16x32_bf16 v[32:35], v[84:87], v[104:107], v[32:35]
    ds_read_b128 v[104:107], v120 offset:14336
    s_waitcnt vmcnt(0) lgkmcnt(6)
    v_mfma_f32_16x16x32_bf16 v[12:15], v[64:67], v[108:111], v[12:15]
    v_mfma_f32_16x16x32_bf16 v[8:11], v[68:71], v[108:111], v[8:11]
    v_mfma_f32_16x16x32_bf16 v[4:7], v[72:75], v[108:111], v[4:7]
    v_mfma_f32_16x16x32_bf16 v[0:3], v[76:79], v[108:111], v[0:3]
    ds_read_b128 v[108:111], v116 offset:14144
    s_waitcnt lgkmcnt(6)
    v_mfma_f32_16x16x32_bf16 v[40:43], v[80:83], v[112:115], v[40:43]
    v_mfma_f32_16x16x32_bf16 v[36:39], v[84:87], v[112:115], v[36:39]
    ds_read_b128 v[112:115], v120 offset:15360
    s_waitcnt lgkmcnt(6)
    v_mfma_f32_16x16x32_bf16 v[16:19], v[64:67], v[88:91], v[16:19]
    v_mfma_f32_16x16x32_bf16 v[12:15], v[68:71], v[88:91], v[12:15]
    v_mfma_f32_16x16x32_bf16 v[8:11], v[72:75], v[88:91], v[8:11]
    v_mfma_f32_16x16x32_bf16 v[4:7], v[76:79], v[88:91], v[4:7]
    ds_read_b128 v[88:91], v117 offset:8704
    v_xor_b32 v124, 0, v126
    ds_write_b128 v124, v[32:35]
    s_waitcnt lgkmcnt(7)
    v_mfma_f32_16x16x32_bf16 v[44:47], v[80:83], v[92:95], v[44:47]
    v_mfma_f32_16x16x32_bf16 v[40:43], v[84:87], v[92:95], v[40:43]
    ds_read_b128 v[92:95], v122 offset:0
    v_xor_b32 v123, 0, v125
    ds_write_b128 v123, v[0:3]
    s_waitcnt lgkmcnt(8)
    v_mfma_f32_16x16x32_bf16 v[20:23], v[64:67], v[96:99], v[20:23]
    v_mfma_f32_16x16x32_bf16 v[16:19], v[68:71], v[96:99], v[16:19]
    v_mfma_f32_16x16x32_bf16 v[12:15], v[72:75], v[96:99], v[12:15]
    v_mfma_f32_16x16x32_bf16 v[8:11], v[76:79], v[96:99], v[8:11]
    ds_read_b128 v[96:99], v117 offset:9792
    v_xor_b32 v123, 16, v126
    ds_write_b128 v123, v[36:39]
    s_waitcnt lgkmcnt(9)
    v_mfma_f32_16x16x32_bf16 v[48:51], v[80:83], v[100:103], v[48:51]
    v_mfma_f32_16x16x32_bf16 v[44:47], v[84:87], v[100:103], v[44:47]
    ds_read_b128 v[100:103], v121 offset:9216
    v_xor_b32 v124, 16, v125
    ds_write_b128 v124, v[4:7]
    s_waitcnt lgkmcnt(10)
    v_mfma_f32_16x16x32_bf16 v[24:27], v[64:67], v[104:107], v[24:27]
    v_mfma_f32_16x16x32_bf16 v[20:23], v[68:71], v[104:107], v[20:23]
    v_mfma_f32_16x16x32_bf16 v[16:19], v[72:75], v[104:107], v[16:19]
    v_mfma_f32_16x16x32_bf16 v[12:15], v[76:79], v[104:107], v[12:15]
    ds_read_b128 v[104:107], v118 offset:8704
    v_xor_b32 v124, 32, v126
    ds_write_b128 v124, v[40:43]
    s_waitcnt lgkmcnt(11)
    v_mfma_f32_16x16x32_bf16 v[52:55], v[80:83], v[108:111], v[52:55]
    v_mfma_f32_16x16x32_bf16 v[48:51], v[84:87], v[108:111], v[48:51]
    ds_read_b128 v[108:111], v121 offset:10240
    v_xor_b32 v123, 32, v125
    ds_write_b128 v123, v[8:11]
    s_waitcnt lgkmcnt(12)
    v_mfma_f32_16x16x32_bf16 v[28:31], v[64:67], v[112:115], v[28:31]
    v_mfma_f32_16x16x32_bf16 v[24:27], v[68:71], v[112:115], v[24:27]
    v_mfma_f32_16x16x32_bf16 v[20:23], v[72:75], v[112:115], v[20:23]
    v_mfma_f32_16x16x32_bf16 v[16:19], v[76:79], v[112:115], v[16:19]
    v_xor_b32 v123, 48, v126
    ds_write_b128 v123, v[44:47]
    s_waitcnt lgkmcnt(12)
    v_mfma_f32_16x16x32_bf16 v[56:59], v[80:83], v[88:91], v[56:59]
    v_mfma_f32_16x16x32_bf16 v[52:55], v[84:87], v[88:91], v[52:55]
    v_xor_b32 v124, 48, v125
    ds_write_b128 v124, v[12:15]
    s_waitcnt lgkmcnt(11)
    v_mfma_f32_16x16x32_bf16 v[28:31], v[68:71], v[92:95], v[28:31]
    v_mfma_f32_16x16x32_bf16 v[24:27], v[72:75], v[92:95], v[24:27]
    v_mfma_f32_16x16x32_bf16 v[20:23], v[76:79], v[92:95], v[20:23]
    v_xor_b32 v124, 64, v126
    ds_write_b128 v124, v[48:51]
    s_waitcnt lgkmcnt(10)
    v_mfma_f32_16x16x32_bf16 v[60:63], v[80:83], v[96:99], v[60:63]
    v_mfma_f32_16x16x32_bf16 v[56:59], v[84:87], v[96:99], v[56:59]
    v_xor_b32 v123, 64, v125
    ds_write_b128 v123, v[16:19]
    s_waitcnt lgkmcnt(9)
    v_mfma_f32_16x16x32_bf16 v[28:31], v[72:75], v[100:103], v[28:31]
    v_mfma_f32_16x16x32_bf16 v[24:27], v[76:79], v[100:103], v[24:27]
    v_xor_b32 v123, 80, v126
    ds_write_b128 v123, v[52:55]
    s_waitcnt lgkmcnt(8)
    v_mfma_f32_16x16x32_bf16 v[60:63], v[84:87], v[104:107], v[60:63]
    v_xor_b32 v124, 80, v125
    ds_write_b128 v124, v[20:23]
    s_waitcnt lgkmcnt(7)
    v_mfma_f32_16x16x32_bf16 v[28:31], v[76:79], v[108:111], v[28:31]
    v_xor_b32 v124, 96, v126
    ds_write_b128 v124, v[56:59]
    v_and_b32 v108, 15, v127
    v_lshrrev_b32 v109, 4, v127
    v_lshrrev_b32 v110, 3, v108
    s_lshl_b32 s36, s20, 1
    v_add_u32 v110, s36, v110
    v_xor_b32 v111, v110, v108
    v_and_b32 v111, 7, v111
    v_lshlrev_b32 v111, 4, v111
    v_xor_b32 v123, 96, v125
    ds_write_b128 v123, v[24:27]
    v_lshl_add_u32 v111, v110, 7, v111
    v_lshl_add_u32 v120, v109, 11, v111
    v_add_u32 v121, 65536, v120
    v_add_u32 v64, 131072, v120
    s_lshl_b32 s36, s20, 9
    s_add_u32 s36, s36, 115712
    v_lshl_add_u32 v127, v109, 7, s36
    s_lshl_b32 s36, s20, 4
    v_add_u32 v108, s36, v108
    v_lshlrev_b32 v110, 6, v108
    v_lshl_add_u32 v110, v109, 4, v110
    s_mul_i32 s36, s29, 262144
    v_xor_b32 v123, 112, v126
    ds_write_b128 v123, v[60:63]
    s_lshl_b32 s37, s21, 4
    s_add_u32 s36, s36, s37
    v_add_u32 v110, s36, v110
    v_mov_b32 v111, 2130706432
    v_cmp_gt_u32 vcc, 125, v108
    s_mov_b32 s4, 0xbeaaaaab
    s_mov_b32 s5, s4
    s_mov_b32 s6, 0x3e800000
    s_mov_b32 s7, s6
    s_mov_b32 s8, 0xc0a00000
    s_mov_b32 s9, s8
    s_mov_b32 s10, 0xc0638e39
    v_xor_b32 v124, 112, v125
    ds_write_b128 v124, v[28:31]
    s_mov_b32 s11, s10
    s_mov_b32 s12, 0xbf638e39
    s_mov_b32 s13, s12
    s_mov_b32 s14, 0xbe638e39
    s_mov_b32 s15, s14
    s_mov_b32 s22, 0xbd638e39
    s_mov_b32 s23, s22
    s_mov_b32 s24, 0x3ff1c71c
    s_mov_b32 s25, s24
    s_mov_b32 s26, 0xbf2aaaab
    s_mov_b32 s27, s26
    s_mov_b32 s32, 0x3ecccccd
    s_mov_b32 s33, s32
    s_mov_b32 s34, 0xbd888889
    s_mov_b32 s35, s34
    s_mov_b32 s38, 0xbe4ccccd
    s_mov_b32 s39, s38
    s_mov_b32 s40, 0xbdd2d3e8
    s_mov_b32 s41, s40
    s_mov_b32 s42, 0x3f800000
    s_mov_b32 s43, s42
    s_setprio 0
    s_branch L_conv2_kernel_epi
L_conv2_kernel_helper:
    s_setprio 3
    v_lshlrev_b32 v8, 4, v6
    s_add_u32 s37, s33, 4294967289
    v_lshl_add_u32 v9, v7, 3, s37
    v_cmp_gt_u32 vcc, 8000, v9
    s_mul_i32 s37, s33, 131072
    s_add_u32 s37, s37, 0
    v_lshl_add_u32 v92, v7, 7, s37
    v_add_u32 v92, v92, v8
    v_mov_b32 v9, 2130706432
    v_cndmask_b32 v92, v9, v92, vcc
    s_add_u32 s37, s33, 4294967291
    v_lshl_add_u32 v9, v7, 3, s37
    v_cmp_gt_u32 vcc, 8000, v9
    s_mul_i32 s37, s33, 131072
    s_add_u32 s37, s37, 262144
    v_lshl_add_u32 v93, v7, 7, s37
    v_add_u32 v93, v93, v8
    v_mov_b32 v9, 2130706432
    v_cndmask_b32 v93, v9, v93, vcc
    s_add_u32 s37, s33, 4294967293
    v_lshl_add_u32 v9, v7, 3, s37
    v_cmp_gt_u32 vcc, 8000, v9
    s_mul_i32 s37, s33, 131072
    s_add_u32 s37, s37, 64
    v_lshl_add_u32 v94, v7, 7, s37
    v_add_u32 v94, v94, v8
    v_mov_b32 v9, 2130706432
    v_cndmask_b32 v94, v9, v94, vcc
    s_add_u32 s37, s33, 4294967295
    v_lshl_add_u32 v9, v7, 3, s37
    v_cmp_gt_u32 vcc, 8000, v9
    s_mul_i32 s37, s33, 131072
    s_add_u32 s37, s37, 262208
    v_lshl_add_u32 v95, v7, 7, s37
    v_add_u32 v95, v95, v8
    v_mov_b32 v9, 2130706432
    v_cndmask_b32 v95, v9, v95, vcc
    v_and_b32 v76, 4, v5
    v_lshrrev_b32 v76, 1, v76
    v_xor_b32 v76, v6, v76
    v_lshlrev_b32 v76, 4, v76
    v_lshl_add_u32 v76, v5, 6, v76
    s_mov_b32 s24, 0
    s_mov_b32 s27, 524288
    s_waitcnt lgkmcnt(0)
    s_add_u32 s8, s4, s47
    s_addc_u32 s9, s5, 0
    buffer_load_dwordx4 v[0:3], v92, s[8:11], s24 offen
    buffer_load_dwordx4 v[8:11], v94, s[8:11], s24 offen
    buffer_load_dwordx4 v[4:7], v93, s[8:11], s24 offen
    buffer_load_dwordx4 v[12:15], v95, s[8:11], s24 offen
    buffer_load_dwordx4 v[16:19], v92, s[8:11], s27 offen
    buffer_load_dwordx4 v[24:27], v94, s[8:11], s27 offen
    buffer_load_dwordx4 v[20:23], v93, s[8:11], s27 offen
    buffer_load_dwordx4 v[28:31], v95, s[8:11], s27 offen
    s_mul_i32 s36, s42, 1024
    v_add_u32 v96, s36, v76
    v_add_u32 v97, 65536, v96
    s_mul_i32 s36, s42, 1088
    s_add_u32 s36, s36, 98304
    v_add_u32 v98, s36, v76
    s_waitcnt vmcnt(0)
    s_mov_b32 s28, 0
    s_mov_b32 s22, 2
    s_cmp_ge_u32 s20, 12
    s_cbranch_scc1 L_conv2_kernel_h2
    ds_write_b128 v96, v[0:3] offset:0
    ds_write_b128 v98, v[12:15] offset:0
    v_lshlrev_b32 v76, 16, v0
    v_and_b32 v84, s25, v0
    v_lshlrev_b32 v77, 16, v4
    v_and_b32 v85, s25, v4
    v_lshlrev_b32 v78, 16, v8
    v_and_b32 v86, s25, v8
    v_lshlrev_b32 v79, 16, v12
    v_and_b32 v87, s25, v12
    v_add_f32 v80, v76, v78
    v_add_f32 v88, v84, v86
    v_add_f32 v81, v77, v79
    v_add_f32 v89, v85, v87
    v_fma_f32 v82, v78, 4.0, v76
    v_fma_f32 v90, v86, 4.0, v84
    v_fma_f32 v83, v79, 4.0, v77
    v_fma_f32 v91, v87, 4.0, v85
    v_add_f32 v77, v80, v81
    v_add_f32 v85, v88, v89
    v_sub_f32 v78, v80, v81
    v_sub_f32 v86, v88, v89
    v_fma_f32 v79, v83, 2.0, v82
    v_fma_f32 v87, v91, 2.0, v90
    v_fma_f32 v82, v83, -2.0, v82
    v_fma_f32 v90, v91, -2.0, v90
    v_fmamk_f32 v80, v76, 0x41700000, v82
    v_fmamk_f32 v88, v84, 0x41700000, v90
    v_fmamk_f32 v80, v81, 0x41200000, v80
    v_fmamk_f32 v88, v89, 0x41200000, v88
    v_cvt_pk_bf16_f32 v4, v77, v85
    v_cvt_pk_bf16_f32 v8, v78, v86
    v_cvt_pk_bf16_f32 v64, v79, v87
    v_cvt_pk_bf16_f32 v68, v82, v90
    v_cvt_pk_bf16_f32 v72, v80, v88
    v_lshlrev_b32 v76, 16, v1
    v_and_b32 v84, s25, v1
    v_lshlrev_b32 v77, 16, v5
    v_and_b32 v85, s25, v5
    v_lshlrev_b32 v78, 16, v9
    v_and_b32 v86, s25, v9
    v_lshlrev_b32 v79, 16, v13
    v_and_b32 v87, s25, v13
    v_add_f32 v80, v76, v78
    v_add_f32 v88, v84, v86
    v_add_f32 v81, v77, v79
    v_add_f32 v89, v85, v87
    v_fma_f32 v82, v78, 4.0, v76
    v_fma_f32 v90, v86, 4.0, v84
    v_fma_f32 v83, v79, 4.0, v77
    v_fma_f32 v91, v87, 4.0, v85
    v_add_f32 v77, v80, v81
    v_add_f32 v85, v88, v89
    v_sub_f32 v78, v80, v81
    v_sub_f32 v86, v88, v89
    v_fma_f32 v79, v83, 2.0, v82
    v_fma_f32 v87, v91, 2.0, v90
    v_fma_f32 v82, v83, -2.0, v82
    v_fma_f32 v90, v91, -2.0, v90
    v_fmamk_f32 v80, v76, 0x41700000, v82
    v_fmamk_f32 v88, v84, 0x41700000, v90
    v_fmamk_f32 v80, v81, 0x41200000, v80
    v_fmamk_f32 v88, v89, 0x41200000, v88
    v_cvt_pk_bf16_f32 v5, v77, v85
    v_cvt_pk_bf16_f32 v9, v78, v86
    v_cvt_pk_bf16_f32 v65, v79, v87
    v_cvt_pk_bf16_f32 v69, v82, v90
    v_cvt_pk_bf16_f32 v73, v80, v88
    v_lshlrev_b32 v76, 16, v2
    v_and_b32 v84, s25, v2
    v_lshlrev_b32 v77, 16, v6
    v_and_b32 v85, s25, v6
    v_lshlrev_b32 v78, 16, v10
    v_and_b32 v86, s25, v10
    v_lshlrev_b32 v79, 16, v14
    v_and_b32 v87, s25, v14
    v_add_f32 v80, v76, v78
    v_add_f32 v88, v84, v86
    v_add_f32 v81, v77, v79
    v_add_f32 v89, v85, v87
    v_fma_f32 v82, v78, 4.0, v76
    v_fma_f32 v90, v86, 4.0, v84
    v_fma_f32 v83, v79, 4.0, v77
    v_fma_f32 v91, v87, 4.0, v85
    v_add_f32 v77, v80, v81
    v_add_f32 v85, v88, v89
    v_sub_f32 v78, v80, v81
    v_sub_f32 v86, v88, v89
    v_fma_f32 v79, v83, 2.0, v82
    v_fma_f32 v87, v91, 2.0, v90
    v_fma_f32 v82, v83, -2.0, v82
    v_fma_f32 v90, v91, -2.0, v90
    v_fmamk_f32 v80, v76, 0x41700000, v82
    v_fmamk_f32 v88, v84, 0x41700000, v90
    v_fmamk_f32 v80, v81, 0x41200000, v80
    v_fmamk_f32 v88, v89, 0x41200000, v88
    v_cvt_pk_bf16_f32 v6, v77, v85
    v_cvt_pk_bf16_f32 v10, v78, v86
    v_cvt_pk_bf16_f32 v66, v79, v87
    v_cvt_pk_bf16_f32 v70, v82, v90
    v_cvt_pk_bf16_f32 v74, v80, v88
    v_lshlrev_b32 v76, 16, v3
    v_and_b32 v84, s25, v3
    v_lshlrev_b32 v77, 16, v7
    v_and_b32 v85, s25, v7
    v_lshlrev_b32 v78, 16, v11
    v_and_b32 v86, s25, v11
    v_lshlrev_b32 v79, 16, v15
    v_and_b32 v87, s25, v15
    v_add_f32 v80, v76, v78
    v_add_f32 v88, v84, v86
    v_add_f32 v81, v77, v79
    v_add_f32 v89, v85, v87
    v_fma_f32 v82, v78, 4.0, v76
    v_fma_f32 v90, v86, 4.0, v84
    v_fma_f32 v83, v79, 4.0, v77
    v_fma_f32 v91, v87, 4.0, v85
    v_add_f32 v77, v80, v81
    v_add_f32 v85, v88, v89
    v_sub_f32 v78, v80, v81
    v_sub_f32 v86, v88, v89
    v_fma_f32 v79, v83, 2.0, v82
    v_fma_f32 v87, v91, 2.0, v90
    v_fma_f32 v82, v83, -2.0, v82
    v_fma_f32 v90, v91, -2.0, v90
    v_fmamk_f32 v80, v76, 0x41700000, v82
    v_fmamk_f32 v88, v84, 0x41700000, v90
    v_fmamk_f32 v80, v81, 0x41200000, v80
    v_fmamk_f32 v88, v89, 0x41200000, v88
    v_cvt_pk_bf16_f32 v7, v77, v85
    v_cvt_pk_bf16_f32 v11, v78, v86
    v_cvt_pk_bf16_f32 v67, v79, v87
    v_cvt_pk_bf16_f32 v71, v82, v90
    v_cvt_pk_bf16_f32 v75, v80, v88
    ds_write_b128 v96, v[64:67] offset:49152
    ds_write_b128 v97, v[68:71] offset:0
    ds_write_b128 v97, v[72:75] offset:16384
    ds_write_b128 v96, v[4:7] offset:16384
    ds_write_b128 v96, v[8:11] offset:32768
    s_waitcnt vmcnt(0)
    s_mov_b32 s24, 1048576
    s_mov_b32 s27, 1572864
    s_waitcnt lgkmcnt(0)
    s_barrier
    buffer_load_dwordx4 v[32:35], v92, s[8:11], s24 offen
    buffer_load_dwordx4 v[40:43], v94, s[8:11], s24 offen
    buffer_load_dwordx4 v[36:39], v93, s[8:11], s24 offen
    buffer_load_dwordx4 v[44:47], v95, s[8:11], s24 offen
    s_setprio 1
L_conv2_kernel_hloop1:
    v_lshlrev_b32 v76, 16, v16
    v_and_b32 v84, s25, v16
    v_lshlrev_b32 v77, 16, v20
    v_and_b32 v85, s25, v20
    v_lshlrev_b32 v78, 16, v24
    v_and_b32 v86, s25, v24
    v_lshlrev_b32 v79, 16, v28
    v_and_b32 v87, s25, v28
    v_add_f32 v80, v76, v78
    v_add_f32 v88, v84, v86
    v_add_f32 v81, v77, v79
    v_add_f32 v89, v85, v87
    v_fma_f32 v82, v78, 4.0, v76
    buffer_load_dwordx4 v[48:51], v92, s[8:11], s27 offen
    buffer_load_dwordx4 v[56:59], v94, s[8:11], s27 offen
    v_fma_f32 v90, v86, 4.0, v84
    v_fma_f32 v83, v79, 4.0, v77
    v_fma_f32 v91, v87, 4.0, v85
    v_add_f32 v77, v80, v81
    v_add_f32 v85, v88, v89
    v_sub_f32 v78, v80, v81
    v_sub_f32 v86, v88, v89
    v_fma_f32 v79, v83, 2.0, v82
    v_fma_f32 v87, v91, 2.0, v90
    v_fma_f32 v82, v83, -2.0, v82
    v_fma_f32 v90, v91, -2.0, v90
    v_fmamk_f32 v80, v76, 0x41700000, v82
    v_fmamk_f32 v88, v84, 0x41700000, v90
    v_fmamk_f32 v80, v81, 0x41200000, v80
    v_fmamk_f32 v88, v89, 0x41200000, v88
    v_cvt_pk_bf16_f32 v20, v77, v85
    v_cvt_pk_bf16_f32 v24, v78, v86
    v_cvt_pk_bf16_f32 v64, v79, v87
    v_cvt_pk_bf16_f32 v68, v82, v90
    v_cvt_pk_bf16_f32 v72, v80, v88
    v_lshlrev_b32 v76, 16, v17
    v_and_b32 v84, s25, v17
    v_lshlrev_b32 v77, 16, v21
    v_and_b32 v85, s25, v21
    v_lshlrev_b32 v78, 16, v25
    v_and_b32 v86, s25, v25
    v_lshlrev_b32 v79, 16, v29
    v_and_b32 v87, s25, v29
    v_add_f32 v80, v76, v78
    v_add_f32 v88, v84, v86
    v_add_f32 v81, v77, v79
    v_add_f32 v89, v85, v87
    v_fma_f32 v82, v78, 4.0, v76
    v_fma_f32 v90, v86, 4.0, v84
    v_fma_f32 v83, v79, 4.0, v77
    v_fma_f32 v91, v87, 4.0, v85
    v_add_f32 v77, v80, v81
    v_add_f32 v85, v88, v89
    v_sub_f32 v78, v80, v81
    v_sub_f32 v86, v88, v89
    v_fma_f32 v79, v83, 2.0, v82
    v_fma_f32 v87, v91, 2.0, v90
    v_fma_f32 v82, v83, -2.0, v82
    v_fma_f32 v90, v91, -2.0, v90
    v_fmamk_f32 v80, v76, 0x41700000, v82
    v_fmamk_f32 v88, v84, 0x41700000, v90
    v_fmamk_f32 v80, v81, 0x41200000, v80
    v_fmamk_f32 v88, v89, 0x41200000, v88
    v_cvt_pk_bf16_f32 v21, v77, v85
    v_cvt_pk_bf16_f32 v25, v78, v86
    v_cvt_pk_bf16_f32 v65, v79, v87
    v_cvt_pk_bf16_f32 v69, v82, v90
    v_cvt_pk_bf16_f32 v73, v80, v88
    buffer_load_dwordx4 v[52:55], v93, s[8:11], s27 offen
    buffer_load_dwordx4 v[60:63], v95, s[8:11], s27 offen
    v_lshlrev_b32 v76, 16, v18
    v_and_b32 v84, s25, v18
    v_lshlrev_b32 v77, 16, v22
    v_and_b32 v85, s25, v22
    v_lshlrev_b32 v78, 16, v26
    v_and_b32 v86, s25, v26
    v_lshlrev_b32 v79, 16, v30
    v_and_b32 v87, s25, v30
    v_add_f32 v80, v76, v78
    v_add_f32 v88, v84, v86
    v_add_f32 v81, v77, v79
    v_add_f32 v89, v85, v87
    v_fma_f32 v82, v78, 4.0, v76
    v_fma_f32 v90, v86, 4.0, v84
    v_fma_f32 v83, v79, 4.0, v77
    v_fma_f32 v91, v87, 4.0, v85
    v_add_f32 v77, v80, v81
    v_add_f32 v85, v88, v89
    v_sub_f32 v78, v80, v81
    v_sub_f32 v86, v88, v89
    v_fma_f32 v79, v83, 2.0, v82
    v_fma_f32 v87, v91, 2.0, v90
    v_fma_f32 v82, v83, -2.0, v82
    v_fma_f32 v90, v91, -2.0, v90
    v_fmamk_f32 v80, v76, 0x41700000, v82
    v_fmamk_f32 v88, v84, 0x41700000, v90
    v_fmamk_f32 v80, v81, 0x41200000, v80
    v_fmamk_f32 v88, v89, 0x41200000, v88
    v_cvt_pk_bf16_f32 v22, v77, v85
    v_cvt_pk_bf16_f32 v26, v78, v86
    v_cvt_pk_bf16_f32 v66, v79, v87
    v_cvt_pk_bf16_f32 v70, v82, v90
    v_cvt_pk_bf16_f32 v74, v80, v88
    v_lshlrev_b32 v76, 16, v19
    v_and_b32 v84, s25, v19
    v_lshlrev_b32 v77, 16, v23
    v_and_b32 v85, s25, v23
    v_lshlrev_b32 v78, 16, v27
    v_and_b32 v86, s25, v27
    v_lshlrev_b32 v79, 16, v31
    v_and_b32 v87, s25, v31
    v_add_f32 v80, v76, v78
    v_add_f32 v88, v84, v86
    v_add_f32 v81, v77, v79
    v_add_f32 v89, v85, v87
    v_fma_f32 v82, v78, 4.0, v76
    v_fma_f32 v90, v86, 4.0, v84
    v_fma_f32 v83, v79, 4.0, v77
    v_fma_f32 v91, v87, 4.0, v85
    v_add_f32 v77, v80, v81
    v_add_f32 v85, v88, v89
    v_sub_f32 v78, v80, v81
    v_sub_f32 v86, v88, v89
    v_fma_f32 v79, v83, 2.0, v82
    v_fma_f32 v87, v91, 2.0, v90
    v_fma_f32 v82, v83, -2.0, v82
    v_fma_f32 v90, v91, -2.0, v90
    v_fmamk_f32 v80, v76, 0x41700000, v82
    v_fmamk_f32 v88, v84, 0x41700000, v90
    v_fmamk_f32 v80, v81, 0x41200000, v80
    v_fmamk_f32 v88, v89, 0x41200000, v88
    v_cvt_pk_bf16_f32 v23, v77, v85
    v_cvt_pk_bf16_f32 v27, v78, v86
    v_cvt_pk_bf16_f32 v67, v79, v87
    v_cvt_pk_bf16_f32 v71, v82, v90
    v_cvt_pk_bf16_f32 v75, v80, v88
    ds_write_b128 v96, v[64:67] offset:57344
    ds_write_b128 v97, v[68:71] offset:8192
    ds_write_b128 v97, v[72:75] offset:24576
    ds_write_b128 v96, v[16:19] offset:8192
    ds_write_b128 v96, v[20:23] offset:24576
    ds_write_b128 v96, v[24:27] offset:40960
    ds_write_b128 v98, v[28:31] offset:8704
    s_add_u32 s28, s28, 1
    s_waitcnt lgkmcnt(0)
    s_barrier
    s_add_u32 s24, s24, 1048576
    s_add_u32 s27, s27, 1048576
    s_waitcnt vmcnt(0)
    v_lshlrev_b32 v76, 16, v32
    v_and_b32 v84, s25, v32
    v_lshlrev_b32 v77, 16, v36
    v_and_b32 v85, s25, v36
    v_lshlrev_b32 v78, 16, v40
    v_and_b32 v86, s25, v40
    v_lshlrev_b32 v79, 16, v44
    v_and_b32 v87, s25, v44
    v_add_f32 v80, v76, v78
    v_add_f32 v88, v84, v86
    v_add_f32 v81, v77, v79
    v_add_f32 v89, v85, v87
    v_fma_f32 v82, v78, 4.0, v76
    v_fma_f32 v90, v86, 4.0, v84
    v_fma_f32 v83, v79, 4.0, v77
    v_fma_f32 v91, v87, 4.0, v85
    v_add_f32 v77, v80, v81
    v_add_f32 v85, v88, v89
    v_sub_f32 v78, v80, v81
    v_sub_f32 v86, v88, v89
    v_fma_f32 v79, v83, 2.0, v82
    v_fma_f32 v87, v91, 2.0, v90
    v_fma_f32 v82, v83, -2.0, v82
    v_fma_f32 v90, v91, -2.0, v90
    v_fmamk_f32 v80, v76, 0x41700000, v82
    v_fmamk_f32 v88, v84, 0x41700000, v90
    v_fmamk_f32 v80, v81, 0x41200000, v80
    v_fmamk_f32 v88, v89, 0x41200000, v88
    v_cvt_pk_bf16_f32 v36, v77, v85
    v_cvt_pk_bf16_f32 v40, v78, v86
    v_cvt_pk_bf16_f32 v64, v79, v87
    v_cvt_pk_bf16_f32 v68, v82, v90
    v_cvt_pk_bf16_f32 v72, v80, v88
    v_lshlrev_b32 v76, 16, v33
    v_and_b32 v84, s25, v33
    v_lshlrev_b32 v77, 16, v37
    v_and_b32 v85, s25, v37
    v_lshlrev_b32 v78, 16, v41
    v_and_b32 v86, s25, v41
    buffer_load_dwordx4 v[0:3], v92, s[8:11], s24 offen
    buffer_load_dwordx4 v[8:11], v94, s[8:11], s24 offen
    v_lshlrev_b32 v79, 16, v45
    v_and_b32 v87, s25, v45
    v_add_f32 v80, v76, v78
    v_add_f32 v88, v84, v86
    v_add_f32 v81, v77, v79
    v_add_f32 v89, v85, v87
    v_fma_f32 v82, v78, 4.0, v76
    v_fma_f32 v90, v86, 4.0, v84
    v_fma_f32 v83, v79, 4.0, v77
    v_fma_f32 v91, v87, 4.0, v85
    v_add_f32 v77, v80, v81
    v_add_f32 v85, v88, v89
    v_sub_f32 v78, v80, v81
    v_sub_f32 v86, v88, v89
    v_fma_f32 v79, v83, 2.0, v82
    v_fma_f32 v87, v91, 2.0, v90
    v_fma_f32 v82, v83, -2.0, v82
    v_fma_f32 v90, v91, -2.0, v90
    v_fmamk_f32 v80, v76, 0x41700000, v82
    v_fmamk_f32 v88, v84, 0x41700000, v90
    v_fmamk_f32 v80, v81, 0x41200000, v80
    v_fmamk_f32 v88, v89, 0x41200000, v88
    v_cvt_pk_bf16_f32 v37, v77, v85
    v_cvt_pk_bf16_f32 v41, v78, v86
    v_cvt_pk_bf16_f32 v65, v79, v87
    v_cvt_pk_bf16_f32 v69, v82, v90
    v_cvt_pk_bf16_f32 v73, v80, v88
    v_lshlrev_b32 v76, 16, v34
    v_and_b32 v84, s25, v34
    v_lshlrev_b32 v77, 16, v38
    v_and_b32 v85, s25, v38
    v_lshlrev_b32 v78, 16, v42
    v_and_b32 v86, s25, v42
    v_lshlrev_b32 v79, 16, v46
    v_and_b32 v87, s25, v46
    v_add_f32 v80, v76, v78
    v_add_f32 v88, v84, v86
    v_add_f32 v81, v77, v79
    v_add_f32 v89, v85, v87
    v_fma_f32 v82, v78, 4.0, v76
    v_fma_f32 v90, v86, 4.0, v84
    v_fma_f32 v83, v79, 4.0, v77
    v_fma_f32 v91, v87, 4.0, v85
    v_add_f32 v77, v80, v81
    v_add_f32 v85, v88, v89
    v_sub_f32 v78, v80, v81
    v_sub_f32 v86, v88, v89
    v_fma_f32 v79, v83, 2.0, v82
    v_fma_f32 v87, v91, 2.0, v90
    v_fma_f32 v82, v83, -2.0, v82
    v_fma_f32 v90, v91, -2.0, v90
    v_fmamk_f32 v80, v76, 0x41700000, v82
    v_fmamk_f32 v88, v84, 0x41700000, v90
    buffer_load_dwordx4 v[4:7], v93, s[8:11], s24 offen
    buffer_load_dwordx4 v[12:15], v95, s[8:11], s24 offen
    v_fmamk_f32 v80, v81, 0x41200000, v80
    v_fmamk_f32 v88, v89, 0x41200000, v88
    v_cvt_pk_bf16_f32 v38, v77, v85
    v_cvt_pk_bf16_f32 v42, v78, v86
    v_cvt_pk_bf16_f32 v66, v79, v87
    v_cvt_pk_bf16_f32 v70, v82, v90
    v_cvt_pk_bf16_f32 v74, v80, v88
    v_lshlrev_b32 v76, 16, v35
    v_and_b32 v84, s25, v35
    v_lshlrev_b32 v77, 16, v39
    v_and_b32 v85, s25, v39
    v_lshlrev_b32 v78, 16, v43
    v_and_b32 v86, s25, v43
    v_lshlrev_b32 v79, 16, v47
    v_and_b32 v87, s25, v47
    v_add_f32 v80, v76, v78
    v_add_f32 v88, v84, v86
    v_add_f32 v81, v77, v79
    v_add_f32 v89, v85, v87
    v_fma_f32 v82, v78, 4.0, v76
    v_fma_f32 v90, v86, 4.0, v84
    v_fma_f32 v83, v79, 4.0, v77
    v_fma_f32 v91, v87, 4.0, v85
    v_add_f32 v77, v80, v81
    v_add_f32 v85, v88, v89
    v_sub_f32 v78, v80, v81
    v_sub_f32 v86, v88, v89
    v_fma_f32 v79, v83, 2.0, v82
    v_fma_f32 v87, v91, 2.0, v90
    v_fma_f32 v82, v83, -2.0, v82
    v_fma_f32 v90, v91, -2.0, v90
    v_fmamk_f32 v80, v76, 0x41700000, v82
    v_fmamk_f32 v88, v84, 0x41700000, v90
    v_fmamk_f32 v80, v81, 0x41200000, v80
    v_fmamk_f32 v88, v89, 0x41200000, v88
    v_cvt_pk_bf16_f32 v39, v77, v85
    v_cvt_pk_bf16_f32 v43, v78, v86
    v_cvt_pk_bf16_f32 v67, v79, v87
    v_cvt_pk_bf16_f32 v71, v82, v90
    v_cvt_pk_bf16_f32 v75, v80, v88
    ds_write_b128 v96, v[64:67] offset:49152
    ds_write_b128 v97, v[68:71] offset:0
    ds_write_b128 v97, v[72:75] offset:16384
    ds_write_b128 v96, v[32:35] offset:0
    ds_write_b128 v96, v[36:39] offset:16384
    ds_write_b128 v96, v[40:43] offset:32768
    ds_write_b128 v98, v[44:47] offset:0
    s_add_u32 s28, s28, 1
    s_waitcnt lgkmcnt(0)
    s_barrier
    v_lshlrev_b32 v76, 16, v48
    v_and_b32 v84, s25, v48
    v_lshlrev_b32 v77, 16, v52
    v_and_b32 v85, s25, v52
    v_lshlrev_b32 v78, 16, v56
    v_and_b32 v86, s25, v56
    v_lshlrev_b32 v79, 16, v60
    v_and_b32 v87, s25, v60
    v_add_f32 v80, v76, v78
    v_add_f32 v88, v84, v86
    v_add_f32 v81, v77, v79
    v_add_f32 v89, v85, v87
    v_fma_f32 v82, v78, 4.0, v76
    buffer_load_dwordx4 v[16:19], v92, s[8:11], s27 offen
    buffer_load_dwordx4 v[24:27], v94, s[8:11], s27 offen
    v_fma_f32 v90, v86, 4.0, v84
    v_fma_f32 v83, v79, 4.0, v77
    v_fma_f32 v91, v87, 4.0, v85
    v_add_f32 v77, v80, v81
    v_add_f32 v85, v88, v89
    v_sub_f32 v78, v80, v81
    v_sub_f32 v86, v88, v89
    v_fma_f32 v79, v83, 2.0, v82
    v_fma_f32 v87, v91, 2.0, v90
    v_fma_f32 v82, v83, -2.0, v82
    v_fma_f32 v90, v91, -2.0, v90
    v_fmamk_f32 v80, v76, 0x41700000, v82
    v_fmamk_f32 v88, v84, 0x41700000, v90
    v_fmamk_f32 v80, v81, 0x41200000, v80
    v_fmamk_f32 v88, v89, 0x41200000, v88
    v_cvt_pk_bf16_f32 v52, v77, v85
    v_cvt_pk_bf16_f32 v56, v78, v86
    v_cvt_pk_bf16_f32 v64, v79, v87
    v_cvt_pk_bf16_f32 v68, v82, v90
    v_cvt_pk_bf16_f32 v72, v80, v88
    v_lshlrev_b32 v76, 16, v49
    v_and_b32 v84, s25, v49
    v_lshlrev_b32 v77, 16, v53
    v_and_b32 v85, s25, v53
    v_lshlrev_b32 v78, 16, v57
    v_and_b32 v86, s25, v57
    v_lshlrev_b32 v79, 16, v61
    v_and_b32 v87, s25, v61
    v_add_f32 v80, v76, v78
    v_add_f32 v88, v84, v86
    v_add_f32 v81, v77, v79
    v_add_f32 v89, v85, v87
    v_fma_f32 v82, v78, 4.0, v76
    v_fma_f32 v90, v86, 4.0, v84
    v_fma_f32 v83, v79, 4.0, v77
    v_fma_f32 v91, v87, 4.0, v85
    v_add_f32 v77, v80, v81
    v_add_f32 v85, v88, v89
    v_sub_f32 v78, v80, v81
    v_sub_f32 v86, v88, v89
    v_fma_f32 v79, v83, 2.0, v82
    v_fma_f32 v87, v91, 2.0, v90
    v_fma_f32 v82, v83, -2.0, v82
    v_fma_f32 v90, v91, -2.0, v90
    v_fmamk_f32 v80, v76, 0x41700000, v82
    v_fmamk_f32 v88, v84, 0x41700000, v90
    v_fmamk_f32 v80, v81, 0x41200000, v80
    v_fmamk_f32 v88, v89, 0x41200000, v88
    v_cvt_pk_bf16_f32 v53, v77, v85
    v_cvt_pk_bf16_f32 v57, v78, v86
    v_cvt_pk_bf16_f32 v65, v79, v87
    v_cvt_pk_bf16_f32 v69, v82, v90
    v_cvt_pk_bf16_f32 v73, v80, v88
    buffer_load_dwordx4 v[20:23], v93, s[8:11], s27 offen
    buffer_load_dwordx4 v[28:31], v95, s[8:11], s27 offen
    v_lshlrev_b32 v76, 16, v50
    v_and_b32 v84, s25, v50
    v_lshlrev_b32 v77, 16, v54
    v_and_b32 v85, s25, v54
    v_lshlrev_b32 v78, 16, v58
    v_and_b32 v86, s25, v58
    v_lshlrev_b32 v79, 16, v62
    v_and_b32 v87, s25, v62
    v_add_f32 v80, v76, v78
    v_add_f32 v88, v84, v86
    v_add_f32 v81, v77, v79
    v_add_f32 v89, v85, v87
    v_fma_f32 v82, v78, 4.0, v76
    v_fma_f32 v90, v86, 4.0, v84
    v_fma_f32 v83, v79, 4.0, v77
    v_fma_f32 v91, v87, 4.0, v85
    v_add_f32 v77, v80, v81
    v_add_f32 v85, v88, v89
    v_sub_f32 v78, v80, v81
    v_sub_f32 v86, v88, v89
    v_fma_f32 v79, v83, 2.0, v82
    v_fma_f32 v87, v91, 2.0, v90
    v_fma_f32 v82, v83, -2.0, v82
    v_fma_f32 v90, v91, -2.0, v90
    v_fmamk_f32 v80, v76, 0x41700000, v82
    v_fmamk_f32 v88, v84, 0x41700000, v90
    v_fmamk_f32 v80, v81, 0x41200000, v80
    v_fmamk_f32 v88, v89, 0x41200000, v88
    v_cvt_pk_bf16_f32 v54, v77, v85
    v_cvt_pk_bf16_f32 v58, v78, v86
    v_cvt_pk_bf16_f32 v66, v79, v87
    v_cvt_pk_bf16_f32 v70, v82, v90
    v_cvt_pk_bf16_f32 v74, v80, v88
    v_lshlrev_b32 v76, 16, v51
    v_and_b32 v84, s25, v51
    v_lshlrev_b32 v77, 16, v55
    v_and_b32 v85, s25, v55
    v_lshlrev_b32 v78, 16, v59
    v_and_b32 v86, s25, v59
    v_lshlrev_b32 v79, 16, v63
    v_and_b32 v87, s25, v63
    v_add_f32 v80, v76, v78
    v_add_f32 v88, v84, v86
    v_add_f32 v81, v77, v79
    v_add_f32 v89, v85, v87
    v_fma_f32 v82, v78, 4.0, v76
    v_fma_f32 v90, v86, 4.0, v84
    v_fma_f32 v83, v79, 4.0, v77
    v_fma_f32 v91, v87, 4.0, v85
    v_add_f32 v77, v80, v81
    v_add_f32 v85, v88, v89
    v_sub_f32 v78, v80, v81
    v_sub_f32 v86, v88, v89
    v_fma_f32 v79, v83, 2.0, v82
    v_fma_f32 v87, v91, 2.0, v90
    v_fma_f32 v82, v83, -2.0, v82
    v_fma_f32 v90, v91, -2.0, v90
    v_fmamk_f32 v80, v76, 0x41700000, v82
    v_fmamk_f32 v88, v84, 0x41700000, v90
    v_fmamk_f32 v80, v81, 0x41200000, v80
    v_fmamk_f32 v88, v89, 0x41200000, v88
    v_cvt_pk_bf16_f32 v55, v77, v85
    v_cvt_pk_bf16_f32 v59, v78, v86
    v_cvt_pk_bf16_f32 v67, v79, v87
    v_cvt_pk_bf16_f32 v71, v82, v90
    v_cvt_pk_bf16_f32 v75, v80, v88
    ds_write_b128 v96, v[64:67] offset:57344
    ds_write_b128 v97, v[68:71] offset:8192
    ds_write_b128 v97, v[72:75] offset:24576
    ds_write_b128 v96, v[48:51] offset:8192
    ds_write_b128 v96, v[52:55] offset:24576
    ds_write_b128 v96, v[56:59] offset:40960
    ds_write_b128 v98, v[60:63] offset:8704
    s_add_u32 s28, s28, 1
    s_waitcnt lgkmcnt(0)
    s_barrier
    s_cmp_eq_u32 s22, 1
    s_cbranch_scc1 L_conv2_kernel_hlast1
    s_add_u32 s24, s24, 1048576
    s_add_u32 s27, s27, 1048576
    s_waitcnt vmcnt(0)
    v_lshlrev_b32 v76, 16, v0
    v_and_b32 v84, s25, v0
    v_lshlrev_b32 v77, 16, v4
    v_and_b32 v85, s25, v4
    v_lshlrev_b32 v78, 16, v8
    v_and_b32 v86, s25, v8
    v_lshlrev_b32 v79, 16, v12
    v_and_b32 v87, s25, v12
    v_add_f32 v80, v76, v78
    v_add_f32 v88, v84, v86
    v_add_f32 v81, v77, v79
    v_add_f32 v89, v85, v87
    v_fma_f32 v82, v78, 4.0, v76
    v_fma_f32 v90, v86, 4.0, v84
    v_fma_f32 v83, v79, 4.0, v77
    v_fma_f32 v91, v87, 4.0, v85
    v_add_f32 v77, v80, v81
    v_add_f32 v85, v88, v89
    v_sub_f32 v78, v80, v81
    v_sub_f32 v86, v88, v89
    v_fma_f32 v79, v83, 2.0, v82
    v_fma_f32 v87, v91, 2.0, v90
    v_fma_f32 v82, v83, -2.0, v82
    v_fma_f32 v90, v91, -2.0, v90
    v_fmamk_f32 v80, v76, 0x41700000, v82
    v_fmamk_f32 v88, v84, 0x41700000, v90
    v_fmamk_f32 v80, v81, 0x41200000, v80
    v_fmamk_f32 v88, v89, 0x41200000, v88
    v_cvt_pk_bf16_f32 v4, v77, v85
    v_cvt_pk_bf16_f32 v8, v78, v86
    v_cvt_pk_bf16_f32 v64, v79, v87
    v_cvt_pk_bf16_f32 v68, v82, v90
    v_cvt_pk_bf16_f32 v72, v80, v88
    v_lshlrev_b32 v76, 16, v1
    v_and_b32 v84, s25, v1
    v_lshlrev_b32 v77, 16, v5
    v_and_b32 v85, s25, v5
    v_lshlrev_b32 v78, 16, v9
    v_and_b32 v86, s25, v9
    buffer_load_dwordx4 v[32:35], v92, s[8:11], s24 offen
    buffer_load_dwordx4 v[40:43], v94, s[8:11], s24 offen
    v_lshlrev_b32 v79, 16, v13
    v_and_b32 v87, s25, v13
    v_add_f32 v80, v76, v78
    v_add_f32 v88, v84, v86
    v_add_f32 v81, v77, v79
    v_add_f32 v89, v85, v87
    v_fma_f32 v82, v78, 4.0, v76
    v_fma_f32 v90, v86, 4.0, v84
    v_fma_f32 v83, v79, 4.0, v77
    v_fma_f32 v91, v87, 4.0, v85
    v_add_f32 v77, v80, v81
    v_add_f32 v85, v88, v89
    v_sub_f32 v78, v80, v81
    v_sub_f32 v86, v88, v89
    v_fma_f32 v79, v83, 2.0, v82
    v_fma_f32 v87, v91, 2.0, v90
    v_fma_f32 v82, v83, -2.0, v82
    v_fma_f32 v90, v91, -2.0, v90
    v_fmamk_f32 v80, v76, 0x41700000, v82
    v_fmamk_f32 v88, v84, 0x41700000, v90
    v_fmamk_f32 v80, v81, 0x41200000, v80
    v_fmamk_f32 v88, v89, 0x41200000, v88
    v_cvt_pk_bf16_f32 v5, v77, v85
    v_cvt_pk_bf16_f32 v9, v78, v86
    v_cvt_pk_bf16_f32 v65, v79, v87
    v_cvt_pk_bf16_f32 v69, v82, v90
    v_cvt_pk_bf16_f32 v73, v80, v88
    v_lshlrev_b32 v76, 16, v2
    v_and_b32 v84, s25, v2
    v_lshlrev_b32 v77, 16, v6
    v_and_b32 v85, s25, v6
    v_lshlrev_b32 v78, 16, v10
    v_and_b32 v86, s25, v10
    v_lshlrev_b32 v79, 16, v14
    v_and_b32 v87, s25, v14
    v_add_f32 v80, v76, v78
    v_add_f32 v88, v84, v86
    v_add_f32 v81, v77, v79
    v_add_f32 v89, v85, v87
    v_fma_f32 v82, v78, 4.0, v76
    v_fma_f32 v90, v86, 4.0, v84
    v_fma_f32 v83, v79, 4.0, v77
    v_fma_f32 v91, v87, 4.0, v85
    v_add_f32 v77, v80, v81
    v_add_f32 v85, v88, v89
    v_sub_f32 v78, v80, v81
    v_sub_f32 v86, v88, v89
    v_fma_f32 v79, v83, 2.0, v82
    v_fma_f32 v87, v91, 2.0, v90
    v_fma_f32 v82, v83, -2.0, v82
    v_fma_f32 v90, v91, -2.0, v90
    v_fmamk_f32 v80, v76, 0x41700000, v82
    v_fmamk_f32 v88, v84, 0x41700000, v90
    buffer_load_dwordx4 v[36:39], v93, s[8:11], s24 offen
    buffer_load_dwordx4 v[44:47], v95, s[8:11], s24 offen
    v_fmamk_f32 v80, v81, 0x41200000, v80
    v_fmamk_f32 v88, v89, 0x41200000, v88
    v_cvt_pk_bf16_f32 v6, v77, v85
    v_cvt_pk_bf16_f32 v10, v78, v86
    v_cvt_pk_bf16_f32 v66, v79, v87
    v_cvt_pk_bf16_f32 v70, v82, v90
    v_cvt_pk_bf16_f32 v74, v80, v88
    v_lshlrev_b32 v76, 16, v3
    v_and_b32 v84, s25, v3
    v_lshlrev_b32 v77, 16, v7
    v_and_b32 v85, s25, v7
    v_lshlrev_b32 v78, 16, v11
    v_and_b32 v86, s25, v11
    v_lshlrev_b32 v79, 16, v15
    v_and_b32 v87, s25, v15
    v_add_f32 v80, v76, v78
    v_add_f32 v88, v84, v86
    v_add_f32 v81, v77, v79
    v_add_f32 v89, v85, v87
    v_fma_f32 v82, v78, 4.0, v76
    v_fma_f32 v90, v86, 4.0, v84
    v_fma_f32 v83, v79, 4.0, v77
    v_fma_f32 v91, v87, 4.0, v85
    v_add_f32 v77, v80, v81
    v_add_f32 v85, v88, v89
    v_sub_f32 v78, v80, v81
    v_sub_f32 v86, v88, v89
    v_fma_f32 v79, v83, 2.0, v82
    v_fma_f32 v87, v91, 2.0, v90
    v_fma_f32 v82, v83, -2.0, v82
    v_fma_f32 v90, v91, -2.0, v90
    v_fmamk_f32 v80, v76, 0x41700000, v82
    v_fmamk_f32 v88, v84, 0x41700000, v90
    v_fmamk_f32 v80, v81, 0x41200000, v80
    v_fmamk_f32 v88, v89, 0x41200000, v88
    v_cvt_pk_bf16_f32 v7, v77, v85
    v_cvt_pk_bf16_f32 v11, v78, v86
    v_cvt_pk_bf16_f32 v67, v79, v87
    v_cvt_pk_bf16_f32 v71, v82, v90
    v_cvt_pk_bf16_f32 v75, v80, v88
    ds_write_b128 v96, v[64:67] offset:49152
    ds_write_b128 v97, v[68:71] offset:0
    ds_write_b128 v97, v[72:75] offset:16384
    ds_write_b128 v96, v[0:3] offset:0
    ds_write_b128 v96, v[4:7] offset:16384
    ds_write_b128 v96, v[8:11] offset:32768
    ds_write_b128 v98, v[12:15] offset:0
    s_add_u32 s28, s28, 1
    s_waitcnt lgkmcnt(0)
    s_barrier
    s_sub_u32 s22, s22, 1
    s_branch L_conv2_kernel_hloop1
L_conv2_kernel_hlast1:
    s_branch L_conv2_kernel_end
L_conv2_kernel_h2:
    ds_write_b128 v96, v[0:3] offset:0
    ds_write_b128 v98, v[12:15] offset:0
    v_lshlrev_b32 v76, 16, v0
    v_and_b32 v84, s25, v0
    v_lshlrev_b32 v77, 16, v4
    v_and_b32 v85, s25, v4
    v_lshlrev_b32 v78, 16, v8
    v_and_b32 v86, s25, v8
    v_lshlrev_b32 v79, 16, v12
    v_and_b32 v87, s25, v12
    v_add_f32 v80, v76, v78
    v_add_f32 v88, v84, v86
    v_add_f32 v81, v77, v79
    v_add_f32 v89, v85, v87
    v_fma_f32 v82, v78, 4.0, v76
    v_fma_f32 v90, v86, 4.0, v84
    v_fma_f32 v83, v79, 4.0, v77
    v_fma_f32 v91, v87, 4.0, v85
    v_add_f32 v77, v80, v81
    v_add_f32 v85, v88, v89
    v_sub_f32 v78, v80, v81
    v_sub_f32 v86, v88, v89
    v_fma_f32 v79, v83, 2.0, v82
    v_fma_f32 v87, v91, 2.0, v90
    v_fma_f32 v82, v83, -2.0, v82
    v_fma_f32 v90, v91, -2.0, v90
    v_fmamk_f32 v80, v76, 0x41700000, v82
    v_fmamk_f32 v88, v84, 0x41700000, v90
    v_fmamk_f32 v80, v81, 0x41200000, v80
    v_fmamk_f32 v88, v89, 0x41200000, v88
    v_cvt_pk_bf16_f32 v4, v77, v85
    v_cvt_pk_bf16_f32 v8, v78, v86
    v_cvt_pk_bf16_f32 v64, v79, v87
    v_cvt_pk_bf16_f32 v68, v82, v90
    v_cvt_pk_bf16_f32 v72, v80, v88
    v_lshlrev_b32 v76, 16, v1
    v_and_b32 v84, s25, v1
    v_lshlrev_b32 v77, 16, v5
    v_and_b32 v85, s25, v5
    v_lshlrev_b32 v78, 16, v9
    v_and_b32 v86, s25, v9
    v_lshlrev_b32 v79, 16, v13
    v_and_b32 v87, s25, v13
    v_add_f32 v80, v76, v78
    v_add_f32 v88, v84, v86
    v_add_f32 v81, v77, v79
    v_add_f32 v89, v85, v87
    v_fma_f32 v82, v78, 4.0, v76
    v_fma_f32 v90, v86, 4.0, v84
    v_fma_f32 v83, v79, 4.0, v77
    v_fma_f32 v91, v87, 4.0, v85
    v_add_f32 v77, v80, v81
    v_add_f32 v85, v88, v89
    v_sub_f32 v78, v80, v81
    v_sub_f32 v86, v88, v89
    v_fma_f32 v79, v83, 2.0, v82
    v_fma_f32 v87, v91, 2.0, v90
    v_fma_f32 v82, v83, -2.0, v82
    v_fma_f32 v90, v91, -2.0, v90
    v_fmamk_f32 v80, v76, 0x41700000, v82
    v_fmamk_f32 v88, v84, 0x41700000, v90
    v_fmamk_f32 v80, v81, 0x41200000, v80
    v_fmamk_f32 v88, v89, 0x41200000, v88
    v_cvt_pk_bf16_f32 v5, v77, v85
    v_cvt_pk_bf16_f32 v9, v78, v86
    v_cvt_pk_bf16_f32 v65, v79, v87
    v_cvt_pk_bf16_f32 v69, v82, v90
    v_cvt_pk_bf16_f32 v73, v80, v88
    v_lshlrev_b32 v76, 16, v2
    v_and_b32 v84, s25, v2
    v_lshlrev_b32 v77, 16, v6
    v_and_b32 v85, s25, v6
    v_lshlrev_b32 v78, 16, v10
    v_and_b32 v86, s25, v10
    v_lshlrev_b32 v79, 16, v14
    v_and_b32 v87, s25, v14
    v_add_f32 v80, v76, v78
    v_add_f32 v88, v84, v86
    v_add_f32 v81, v77, v79
    v_add_f32 v89, v85, v87
    v_fma_f32 v82, v78, 4.0, v76
    v_fma_f32 v90, v86, 4.0, v84
    v_fma_f32 v83, v79, 4.0, v77
    v_fma_f32 v91, v87, 4.0, v85
    v_add_f32 v77, v80, v81
    v_add_f32 v85, v88, v89
    v_sub_f32 v78, v80, v81
    v_sub_f32 v86, v88, v89
    v_fma_f32 v79, v83, 2.0, v82
    v_fma_f32 v87, v91, 2.0, v90
    v_fma_f32 v82, v83, -2.0, v82
    v_fma_f32 v90, v91, -2.0, v90
    v_fmamk_f32 v80, v76, 0x41700000, v82
    v_fmamk_f32 v88, v84, 0x41700000, v90
    v_fmamk_f32 v80, v81, 0x41200000, v80
    v_fmamk_f32 v88, v89, 0x41200000, v88
    v_cvt_pk_bf16_f32 v6, v77, v85
    v_cvt_pk_bf16_f32 v10, v78, v86
    v_cvt_pk_bf16_f32 v66, v79, v87
    v_cvt_pk_bf16_f32 v70, v82, v90
    v_cvt_pk_bf16_f32 v74, v80, v88
    v_lshlrev_b32 v76, 16, v3
    v_and_b32 v84, s25, v3
    v_lshlrev_b32 v77, 16, v7
    v_and_b32 v85, s25, v7
    v_lshlrev_b32 v78, 16, v11
    v_and_b32 v86, s25, v11
    v_lshlrev_b32 v79, 16, v15
    v_and_b32 v87, s25, v15
    v_add_f32 v80, v76, v78
    v_add_f32 v88, v84, v86
    v_add_f32 v81, v77, v79
    v_add_f32 v89, v85, v87
    v_fma_f32 v82, v78, 4.0, v76
    v_fma_f32 v90, v86, 4.0, v84
    v_fma_f32 v83, v79, 4.0, v77
    v_fma_f32 v91, v87, 4.0, v85
    v_add_f32 v77, v80, v81
    v_add_f32 v85, v88, v89
    v_sub_f32 v78, v80, v81
    v_sub_f32 v86, v88, v89
    v_fma_f32 v79, v83, 2.0, v82
    v_fma_f32 v87, v91, 2.0, v90
    v_fma_f32 v82, v83, -2.0, v82
    v_fma_f32 v90, v91, -2.0, v90
    v_fmamk_f32 v80, v76, 0x41700000, v82
    v_fmamk_f32 v88, v84, 0x41700000, v90
    v_fmamk_f32 v80, v81, 0x41200000, v80
    v_fmamk_f32 v88, v89, 0x41200000, v88
    v_cvt_pk_bf16_f32 v7, v77, v85
    v_cvt_pk_bf16_f32 v11, v78, v86
    v_cvt_pk_bf16_f32 v67, v79, v87
    v_cvt_pk_bf16_f32 v71, v82, v90
    v_cvt_pk_bf16_f32 v75, v80, v88
    ds_write_b128 v96, v[64:67] offset:49152
    ds_write_b128 v97, v[68:71] offset:0
    ds_write_b128 v97, v[72:75] offset:16384
    ds_write_b128 v96, v[4:7] offset:16384
    ds_write_b128 v96, v[8:11] offset:32768
    s_waitcnt vmcnt(0)
    s_mov_b32 s24, 1048576
    s_mov_b32 s27, 1572864
    s_waitcnt lgkmcnt(0)
    s_barrier
    buffer_load_dwordx4 v[32:35], v92, s[8:11], s24 offen
    buffer_load_dwordx4 v[40:43], v94, s[8:11], s24 offen
    buffer_load_dwordx4 v[36:39], v93, s[8:11], s24 offen
    buffer_load_dwordx4 v[44:47], v95, s[8:11], s24 offen
    buffer_load_dwordx4 v[48:51], v92, s[8:11], s27 offen
    buffer_load_dwordx4 v[56:59], v94, s[8:11], s27 offen
    buffer_load_dwordx4 v[52:55], v93, s[8:11], s27 offen
    buffer_load_dwordx4 v[60:63], v95, s[8:11], s27 offen
    s_setprio 0
    v_lshlrev_b32 v76, 16, v16
    v_and_b32 v84, s25, v16
    v_lshlrev_b32 v77, 16, v20
    v_and_b32 v85, s25, v20
    v_lshlrev_b32 v78, 16, v24
    v_and_b32 v86, s25, v24
    v_lshlrev_b32 v79, 16, v28
    v_and_b32 v87, s25, v28
    v_add_f32 v80, v76, v78
    v_add_f32 v88, v84, v86
    v_add_f32 v81, v77, v79
    v_add_f32 v89, v85, v87
    v_fma_f32 v82, v78, 4.0, v76
    v_fma_f32 v90, v86, 4.0, v84
    v_fma_f32 v83, v79, 4.0, v77
    v_fma_f32 v91, v87, 4.0, v85
    v_add_f32 v77, v80, v81
    v_add_f32 v85, v88, v89
    v_sub_f32 v78, v80, v81
    v_sub_f32 v86, v88, v89
    v_fma_f32 v79, v83, 2.0, v82
    v_fma_f32 v87, v91, 2.0, v90
    v_fma_f32 v82, v83, -2.0, v82
    v_fma_f32 v90, v91, -2.0, v90
    v_fmamk_f32 v80, v76, 0x41700000, v82
    v_fmamk_f32 v88, v84, 0x41700000, v90
    v_fmamk_f32 v80, v81, 0x41200000, v80
    v_fmamk_f32 v88, v89, 0x41200000, v88
    v_cvt_pk_bf16_f32 v20, v77, v85
    v_cvt_pk_bf16_f32 v24, v78, v86
    v_cvt_pk_bf16_f32 v64, v79, v87
    v_cvt_pk_bf16_f32 v68, v82, v90
    v_cvt_pk_bf16_f32 v72, v80, v88
    v_lshlrev_b32 v76, 16, v17
    v_and_b32 v84, s25, v17
    v_lshlrev_b32 v77, 16, v21
    v_and_b32 v85, s25, v21
    v_lshlrev_b32 v78, 16, v25
    v_and_b32 v86, s25, v25
    v_lshlrev_b32 v79, 16, v29
    v_and_b32 v87, s25, v29
    v_add_f32 v80, v76, v78
    v_add_f32 v88, v84, v86
    v_add_f32 v81, v77, v79
    v_add_f32 v89, v85, v87
    v_fma_f32 v82, v78, 4.0, v76
    v_fma_f32 v90, v86, 4.0, v84
    v_fma_f32 v83, v79, 4.0, v77
    v_fma_f32 v91, v87, 4.0, v85
    v_add_f32 v77, v80, v81
    v_add_f32 v85, v88, v89
    v_sub_f32 v78, v80, v81
    v_sub_f32 v86, v88, v89
    v_fma_f32 v79, v83, 2.0, v82
    v_fma_f32 v87, v91, 2.0, v90
    v_fma_f32 v82, v83, -2.0, v82
    v_fma_f32 v90, v91, -2.0, v90
    v_fmamk_f32 v80, v76, 0x41700000, v82
    v_fmamk_f32 v88, v84, 0x41700000, v90
    v_fmamk_f32 v80, v81, 0x41200000, v80
    v_fmamk_f32 v88, v89, 0x41200000, v88
    v_cvt_pk_bf16_f32 v21, v77, v85
    v_cvt_pk_bf16_f32 v25, v78, v86
    v_cvt_pk_bf16_f32 v65, v79, v87
    v_cvt_pk_bf16_f32 v69, v82, v90
    v_cvt_pk_bf16_f32 v73, v80, v88
    v_lshlrev_b32 v76, 16, v18
    v_and_b32 v84, s25, v18
    v_lshlrev_b32 v77, 16, v22
    v_and_b32 v85, s25, v22
    v_lshlrev_b32 v78, 16, v26
    v_and_b32 v86, s25, v26
    v_lshlrev_b32 v79, 16, v30
    v_and_b32 v87, s25, v30
    v_add_f32 v80, v76, v78
    v_add_f32 v88, v84, v86
    v_add_f32 v81, v77, v79
    v_add_f32 v89, v85, v87
    v_fma_f32 v82, v78, 4.0, v76
    v_fma_f32 v90, v86, 4.0, v84
    v_fma_f32 v83, v79, 4.0, v77
    v_fma_f32 v91, v87, 4.0, v85
    v_add_f32 v77, v80, v81
    v_add_f32 v85, v88, v89
    v_sub_f32 v78, v80, v81
    v_sub_f32 v86, v88, v89
    v_fma_f32 v79, v83, 2.0, v82
    v_fma_f32 v87, v91, 2.0, v90
    v_fma_f32 v82, v83, -2.0, v82
    v_fma_f32 v90, v91, -2.0, v90
    v_fmamk_f32 v80, v76, 0x41700000, v82
    v_fmamk_f32 v88, v84, 0x41700000, v90
    v_fmamk_f32 v80, v81, 0x41200000, v80
    v_fmamk_f32 v88, v89, 0x41200000, v88
    v_cvt_pk_bf16_f32 v22, v77, v85
    v_cvt_pk_bf16_f32 v26, v78, v86
    v_cvt_pk_bf16_f32 v66, v79, v87
    v_cvt_pk_bf16_f32 v70, v82, v90
    v_cvt_pk_bf16_f32 v74, v80, v88
    v_lshlrev_b32 v76, 16, v19
    v_and_b32 v84, s25, v19
    v_lshlrev_b32 v77, 16, v23
    v_and_b32 v85, s25, v23
    v_lshlrev_b32 v78, 16, v27
    v_and_b32 v86, s25, v27
    v_lshlrev_b32 v79, 16, v31
    v_and_b32 v87, s25, v31
    v_add_f32 v80, v76, v78
    v_add_f32 v88, v84, v86
    v_add_f32 v81, v77, v79
    v_add_f32 v89, v85, v87
    v_fma_f32 v82, v78, 4.0, v76
    v_fma_f32 v90, v86, 4.0, v84
    v_fma_f32 v83, v79, 4.0, v77
    v_fma_f32 v91, v87, 4.0, v85
    v_add_f32 v77, v80, v81
    v_add_f32 v85, v88, v89
    v_sub_f32 v78, v80, v81
    v_sub_f32 v86, v88, v89
    v_fma_f32 v79, v83, 2.0, v82
    v_fma_f32 v87, v91, 2.0, v90
    v_fma_f32 v82, v83, -2.0, v82
    v_fma_f32 v90, v91, -2.0, v90
    v_fmamk_f32 v80, v76, 0x41700000, v82
    v_fmamk_f32 v88, v84, 0x41700000, v90
    v_fmamk_f32 v80, v81, 0x41200000, v80
    v_fmamk_f32 v88, v89, 0x41200000, v88
    v_cvt_pk_bf16_f32 v23, v77, v85
    v_cvt_pk_bf16_f32 v27, v78, v86
    v_cvt_pk_bf16_f32 v67, v79, v87
    v_cvt_pk_bf16_f32 v71, v82, v90
    v_cvt_pk_bf16_f32 v75, v80, v88
L_conv2_kernel_hloop2:
    s_add_u32 s24, s24, 1048576
    s_add_u32 s27, s27, 1048576
    ds_write_b128 v96, v[64:67] offset:57344
    ds_write_b128 v97, v[68:71] offset:8192
    ds_write_b128 v97, v[72:75] offset:24576
    ds_write_b128 v96, v[16:19] offset:8192
    ds_write_b128 v96, v[20:23] offset:24576
    ds_write_b128 v96, v[24:27] offset:40960
    ds_write_b128 v98, v[28:31] offset:8704
    s_waitcnt vmcnt(0)
    v_lshlrev_b32 v76, 16, v32
    v_and_b32 v84, s25, v32
    v_lshlrev_b32 v77, 16, v36
    v_and_b32 v85, s25, v36
    v_lshlrev_b32 v78, 16, v40
    v_and_b32 v86, s25, v40
    v_lshlrev_b32 v79, 16, v44
    v_and_b32 v87, s25, v44
    v_add_f32 v80, v76, v78
    v_add_f32 v88, v84, v86
    v_add_f32 v81, v77, v79
    v_add_f32 v89, v85, v87
    v_fma_f32 v82, v78, 4.0, v76
    v_fma_f32 v90, v86, 4.0, v84
    v_fma_f32 v83, v79, 4.0, v77
    v_fma_f32 v91, v87, 4.0, v85
    v_add_f32 v77, v80, v81
    v_add_f32 v85, v88, v89
    v_sub_f32 v78, v80, v81
    v_sub_f32 v86, v88, v89
    v_fma_f32 v79, v83, 2.0, v82
    v_fma_f32 v87, v91, 2.0, v90
    v_fma_f32 v82, v83, -2.0, v82
    v_fma_f32 v90, v91, -2.0, v90
    v_fmamk_f32 v80, v76, 0x41700000, v82
    v_fmamk_f32 v88, v84, 0x41700000, v90
    buffer_load_dwordx4 v[0:3], v92, s[8:11], s24 offen
    buffer_load_dwordx4 v[8:11], v94, s[8:11], s24 offen
    v_fmamk_f32 v80, v81, 0x41200000, v80
    v_fmamk_f32 v88, v89, 0x41200000, v88
    v_cvt_pk_bf16_f32 v36, v77, v85
    v_cvt_pk_bf16_f32 v40, v78, v86
    v_cvt_pk_bf16_f32 v64, v79, v87
    v_cvt_pk_bf16_f32 v68, v82, v90
    v_cvt_pk_bf16_f32 v72, v80, v88
    v_lshlrev_b32 v76, 16, v33
    v_and_b32 v84, s25, v33
    v_lshlrev_b32 v77, 16, v37
    v_and_b32 v85, s25, v37
    v_lshlrev_b32 v78, 16, v41
    v_and_b32 v86, s25, v41
    v_lshlrev_b32 v79, 16, v45
    v_and_b32 v87, s25, v45
    v_add_f32 v80, v76, v78
    v_add_f32 v88, v84, v86
    v_add_f32 v81, v77, v79
    v_add_f32 v89, v85, v87
    v_fma_f32 v82, v78, 4.0, v76
    v_fma_f32 v90, v86, 4.0, v84
    v_fma_f32 v83, v79, 4.0, v77
    v_fma_f32 v91, v87, 4.0, v85
    v_add_f32 v77, v80, v81
    v_add_f32 v85, v88, v89
    v_sub_f32 v78, v80, v81
    v_sub_f32 v86, v88, v89
    v_fma_f32 v79, v83, 2.0, v82
    v_fma_f32 v87, v91, 2.0, v90
    v_fma_f32 v82, v83, -2.0, v82
    v_fma_f32 v90, v91, -2.0, v90
    v_fmamk_f32 v80, v76, 0x41700000, v82
    v_fmamk_f32 v88, v84, 0x41700000, v90
    v_fmamk_f32 v80, v81, 0x41200000, v80
    v_fmamk_f32 v88, v89, 0x41200000, v88
    v_cvt_pk_bf16_f32 v37, v77, v85
    v_cvt_pk_bf16_f32 v41, v78, v86
    v_cvt_pk_bf16_f32 v65, v79, v87
    v_cvt_pk_bf16_f32 v69, v82, v90
    v_cvt_pk_bf16_f32 v73, v80, v88
    v_lshlrev_b32 v76, 16, v34
    v_and_b32 v84, s25, v34
    v_lshlrev_b32 v77, 16, v38
    v_and_b32 v85, s25, v38
    v_lshlrev_b32 v78, 16, v42
    v_and_b32 v86, s25, v42
    v_lshlrev_b32 v79, 16, v46
    v_and_b32 v87, s25, v46
    v_add_f32 v80, v76, v78
    v_add_f32 v88, v84, v86
    v_add_f32 v81, v77, v79
    v_add_f32 v89, v85, v87
    v_fma_f32 v82, v78, 4.0, v76
    buffer_load_dwordx4 v[4:7], v93, s[8:11], s24 offen
    buffer_load_dwordx4 v[12:15], v95, s[8:11], s24 offen
    v_fma_f32 v90, v86, 4.0, v84
    v_fma_f32 v83, v79, 4.0, v77
    v_fma_f32 v91, v87, 4.0, v85
    v_add_f32 v77, v80, v81
    v_add_f32 v85, v88, v89
    v_sub_f32 v78, v80, v81
    v_sub_f32 v86, v88, v89
    v_fma_f32 v79, v83, 2.0, v82
    v_fma_f32 v87, v91, 2.0, v90
    v_fma_f32 v82, v83, -2.0, v82
    v_fma_f32 v90, v91, -2.0, v90
    v_fmamk_f32 v80, v76, 0x41700000, v82
    v_fmamk_f32 v88, v84, 0x41700000, v90
    v_fmamk_f32 v80, v81, 0x41200000, v80
    v_fmamk_f32 v88, v89, 0x41200000, v88
    v_cvt_pk_bf16_f32 v38, v77, v85
    v_cvt_pk_bf16_f32 v42, v78, v86
    v_cvt_pk_bf16_f32 v66, v79, v87
    v_cvt_pk_bf16_f32 v70, v82, v90
    v_cvt_pk_bf16_f32 v74, v80, v88
    v_lshlrev_b32 v76, 16, v35
    v_and_b32 v84, s25, v35
    v_lshlrev_b32 v77, 16, v39
    v_and_b32 v85, s25, v39
    v_lshlrev_b32 v78, 16, v43
    v_and_b32 v86, s25, v43
    v_lshlrev_b32 v79, 16, v47
    v_and_b32 v87, s25, v47
    v_add_f32 v80, v76, v78
    v_add_f32 v88, v84, v86
    v_add_f32 v81, v77, v79
    v_add_f32 v89, v85, v87
    v_fma_f32 v82, v78, 4.0, v76
    v_fma_f32 v90, v86, 4.0, v84
    v_fma_f32 v83, v79, 4.0, v77
    v_fma_f32 v91, v87, 4.0, v85
    v_add_f32 v77, v80, v81
    v_add_f32 v85, v88, v89
    v_sub_f32 v78, v80, v81
    v_sub_f32 v86, v88, v89
    v_fma_f32 v79, v83, 2.0, v82
    v_fma_f32 v87, v91, 2.0, v90
    v_fma_f32 v82, v83, -2.0, v82
    v_fma_f32 v90, v91, -2.0, v90
    v_fmamk_f32 v80, v76, 0x41700000, v82
    v_fmamk_f32 v88, v84, 0x41700000, v90
    v_fmamk_f32 v80, v81, 0x41200000, v80
    v_fmamk_f32 v88, v89, 0x41200000, v88
    v_cvt_pk_bf16_f32 v39, v77, v85
    v_cvt_pk_bf16_f32 v43, v78, v86
    v_cvt_pk_bf16_f32 v67, v79, v87
    v_cvt_pk_bf16_f32 v71, v82, v90
    v_cvt_pk_bf16_f32 v75, v80, v88
    s_add_u32 s28, s28, 1
    s_waitcnt lgkmcnt(0)
    s_barrier
    ds_write_b128 v96, v[64:67] offset:49152
    ds_write_b128 v97, v[68:71] offset:0
    ds_write_b128 v97, v[72:75] offset:16384
    ds_write_b128 v96, v[32:35] offset:0
    ds_write_b128 v96, v[36:39] offset:16384
    ds_write_b128 v96, v[40:43] offset:32768
    ds_write_b128 v98, v[44:47] offset:0
    v_lshlrev_b32 v76, 16, v48
    v_and_b32 v84, s25, v48
    buffer_load_dwordx4 v[16:19], v92, s[8:11], s27 offen
    buffer_load_dwordx4 v[24:27], v94, s[8:11], s27 offen
    v_lshlrev_b32 v77, 16, v52
    v_and_b32 v85, s25, v52
    v_lshlrev_b32 v78, 16, v56
    v_and_b32 v86, s25, v56
    v_lshlrev_b32 v79, 16, v60
    v_and_b32 v87, s25, v60
    v_add_f32 v80, v76, v78
    v_add_f32 v88, v84, v86
    v_add_f32 v81, v77, v79
    v_add_f32 v89, v85, v87
    v_fma_f32 v82, v78, 4.0, v76
    v_fma_f32 v90, v86, 4.0, v84
    v_fma_f32 v83, v79, 4.0, v77
    v_fma_f32 v91, v87, 4.0, v85
    v_add_f32 v77, v80, v81
    v_add_f32 v85, v88, v89
    v_sub_f32 v78, v80, v81
    buffer_load_dwordx4 v[20:23], v93, s[8:11], s27 offen
    buffer_load_dwordx4 v[28:31], v95, s[8:11], s27 offen
    v_sub_f32 v86, v88, v89
    v_fma_f32 v79, v83, 2.0, v82
    v_fma_f32 v87, v91, 2.0, v90
    v_fma_f32 v82, v83, -2.0, v82
    v_fma_f32 v90, v91, -2.0, v90
    v_fmamk_f32 v80, v76, 0x41700000, v82
    v_fmamk_f32 v88, v84, 0x41700000, v90
    v_fmamk_f32 v80, v81, 0x41200000, v80
    v_fmamk_f32 v88, v89, 0x41200000, v88
    v_cvt_pk_bf16_f32 v52, v77, v85
    v_cvt_pk_bf16_f32 v56, v78, v86
    v_cvt_pk_bf16_f32 v64, v79, v87
    v_cvt_pk_bf16_f32 v68, v82, v90
    v_cvt_pk_bf16_f32 v72, v80, v88
    v_lshlrev_b32 v76, 16, v49
    v_and_b32 v84, s25, v49
    v_lshlrev_b32 v77, 16, v53
    v_and_b32 v85, s25, v53
    v_lshlrev_b32 v78, 16, v57
    v_and_b32 v86, s25, v57
    v_lshlrev_b32 v79, 16, v61
    v_and_b32 v87, s25, v61
    v_add_f32 v80, v76, v78
    v_add_f32 v88, v84, v86
    v_add_f32 v81, v77, v79
    v_add_f32 v89, v85, v87
    v_fma_f32 v82, v78, 4.0, v76
    v_fma_f32 v90, v86, 4.0, v84
    v_fma_f32 v83, v79, 4.0, v77
    v_fma_f32 v91, v87, 4.0, v85
    v_add_f32 v77, v80, v81
    v_add_f32 v85, v88, v89
    v_sub_f32 v78, v80, v81
    v_sub_f32 v86, v88, v89
    v_fma_f32 v79, v83, 2.0, v82
    v_fma_f32 v87, v91, 2.0, v90
    v_fma_f32 v82, v83, -2.0, v82
    v_fma_f32 v90, v91, -2.0, v90
    v_fmamk_f32 v80, v76, 0x41700000, v82
    v_fmamk_f32 v88, v84, 0x41700000, v90
    v_fmamk_f32 v80, v81, 0x41200000, v80
    v_fmamk_f32 v88, v89, 0x41200000, v88
    v_cvt_pk_bf16_f32 v53, v77, v85
    v_cvt_pk_bf16_f32 v57, v78, v86
    v_cvt_pk_bf16_f32 v65, v79, v87
    v_cvt_pk_bf16_f32 v69, v82, v90
    v_cvt_pk_bf16_f32 v73, v80, v88
    v_lshlrev_b32 v76, 16, v50
    v_and_b32 v84, s25, v50
    v_lshlrev_b32 v77, 16, v54
    v_and_b32 v85, s25, v54
    v_lshlrev_b32 v78, 16, v58
    v_and_b32 v86, s25, v58
    v_lshlrev_b32 v79, 16, v62
    v_and_b32 v87, s25, v62
    v_add_f32 v80, v76, v78
    v_add_f32 v88, v84, v86
    v_add_f32 v81, v77, v79
    v_add_f32 v89, v85, v87
    v_fma_f32 v82, v78, 4.0, v76
    v_fma_f32 v90, v86, 4.0, v84
    v_fma_f32 v83, v79, 4.0, v77
    v_fma_f32 v91, v87, 4.0, v85
    v_add_f32 v77, v80, v81
    v_add_f32 v85, v88, v89
    v_sub_f32 v78, v80, v81
    v_sub_f32 v86, v88, v89
    v_fma_f32 v79, v83, 2.0, v82
    v_fma_f32 v87, v91, 2.0, v90
    v_fma_f32 v82, v83, -2.0, v82
    v_fma_f32 v90, v91, -2.0, v90
    v_fmamk_f32 v80, v76, 0x41700000, v82
    v_fmamk_f32 v88, v84, 0x41700000, v90
    v_fmamk_f32 v80, v81, 0x41200000, v80
    v_fmamk_f32 v88, v89, 0x41200000, v88
    v_cvt_pk_bf16_f32 v54, v77, v85
    v_cvt_pk_bf16_f32 v58, v78, v86
    v_cvt_pk_bf16_f32 v66, v79, v87
    v_cvt_pk_bf16_f32 v70, v82, v90
    v_cvt_pk_bf16_f32 v74, v80, v88
    v_lshlrev_b32 v76, 16, v51
    v_and_b32 v84, s25, v51
    v_lshlrev_b32 v77, 16, v55
    v_and_b32 v85, s25, v55
    v_lshlrev_b32 v78, 16, v59
    v_and_b32 v86, s25, v59
    v_lshlrev_b32 v79, 16, v63
    v_and_b32 v87, s25, v63
    v_add_f32 v80, v76, v78
    v_add_f32 v88, v84, v86
    v_add_f32 v81, v77, v79
    v_add_f32 v89, v85, v87
    v_fma_f32 v82, v78, 4.0, v76
    v_fma_f32 v90, v86, 4.0, v84
    v_fma_f32 v83, v79, 4.0, v77
    v_fma_f32 v91, v87, 4.0, v85
    v_add_f32 v77, v80, v81
    v_add_f32 v85, v88, v89
    v_sub_f32 v78, v80, v81
    v_sub_f32 v86, v88, v89
    v_fma_f32 v79, v83, 2.0, v82
    v_fma_f32 v87, v91, 2.0, v90
    v_fma_f32 v82, v83, -2.0, v82
    v_fma_f32 v90, v91, -2.0, v90
    v_fmamk_f32 v80, v76, 0x41700000, v82
    v_fmamk_f32 v88, v84, 0x41700000, v90
    v_fmamk_f32 v80, v81, 0x41200000, v80
    v_fmamk_f32 v88, v89, 0x41200000, v88
    v_cvt_pk_bf16_f32 v55, v77, v85
    v_cvt_pk_bf16_f32 v59, v78, v86
    v_cvt_pk_bf16_f32 v67, v79, v87
    v_cvt_pk_bf16_f32 v71, v82, v90
    v_cvt_pk_bf16_f32 v75, v80, v88
    s_add_u32 s28, s28, 1
    s_waitcnt lgkmcnt(0)
    s_barrier
    s_cmp_eq_u32 s22, 1
    s_cbranch_scc1 L_conv2_kernel_hlast2
    s_add_u32 s24, s24, 1048576
    s_add_u32 s27, s27, 1048576
    ds_write_b128 v96, v[64:67] offset:57344
    ds_write_b128 v97, v[68:71] offset:8192
    ds_write_b128 v97, v[72:75] offset:24576
    ds_write_b128 v96, v[48:51] offset:8192
    ds_write_b128 v96, v[52:55] offset:24576
    ds_write_b128 v96, v[56:59] offset:40960
    ds_write_b128 v98, v[60:63] offset:8704
    s_waitcnt vmcnt(0)
    v_lshlrev_b32 v76, 16, v0
    v_and_b32 v84, s25, v0
    v_lshlrev_b32 v77, 16, v4
    v_and_b32 v85, s25, v4
    v_lshlrev_b32 v78, 16, v8
    v_and_b32 v86, s25, v8
    v_lshlrev_b32 v79, 16, v12
    v_and_b32 v87, s25, v12
    v_add_f32 v80, v76, v78
    v_add_f32 v88, v84, v86
    v_add_f32 v81, v77, v79
    v_add_f32 v89, v85, v87
    v_fma_f32 v82, v78, 4.0, v76
    v_fma_f32 v90, v86, 4.0, v84
    v_fma_f32 v83, v79, 4.0, v77
    v_fma_f32 v91, v87, 4.0, v85
    v_add_f32 v77, v80, v81
    v_add_f32 v85, v88, v89
    v_sub_f32 v78, v80, v81
    v_sub_f32 v86, v88, v89
    v_fma_f32 v79, v83, 2.0, v82
    v_fma_f32 v87, v91, 2.0, v90
    v_fma_f32 v82, v83, -2.0, v82
    v_fma_f32 v90, v91, -2.0, v90
    v_fmamk_f32 v80, v76, 0x41700000, v82
    v_fmamk_f32 v88, v84, 0x41700000, v90
    buffer_load_dwordx4 v[32:35], v92, s[8:11], s24 offen
    buffer_load_dwordx4 v[40:43], v94, s[8:11], s24 offen
    v_fmamk_f32 v80, v81, 0x41200000, v80
    v_fmamk_f32 v88, v89, 0x41200000, v88
    v_cvt_pk_bf16_f32 v4, v77, v85
    v_cvt_pk_bf16_f32 v8, v78, v86
    v_cvt_pk_bf16_f32 v64, v79, v87
    v_cvt_pk_bf16_f32 v68, v82, v90
    v_cvt_pk_bf16_f32 v72, v80, v88
    v_lshlrev_b32 v76, 16, v1
    v_and_b32 v84, s25, v1
    v_lshlrev_b32 v77, 16, v5
    v_and_b32 v85, s25, v5
    v_lshlrev_b32 v78, 16, v9
    v_and_b32 v86, s25, v9
    v_lshlrev_b32 v79, 16, v13
    v_and_b32 v87, s25, v13
    v_add_f32 v80, v76, v78
    v_add_f32 v88, v84, v86
    v_add_f32 v81, v77, v79
    v_add_f32 v89, v85, v87
    v_fma_f32 v82, v78, 4.0, v76
    v_fma_f32 v90, v86, 4.0, v84
    v_fma_f32 v83, v79, 4.0, v77
    v_fma_f32 v91, v87, 4.0, v85
    v_add_f32 v77, v80, v81
    v_add_f32 v85, v88, v89
    v_sub_f32 v78, v80, v81
    v_sub_f32 v86, v88, v89
    v_fma_f32 v79, v83, 2.0, v82
    v_fma_f32 v87, v91, 2.0, v90
    v_fma_f32 v82, v83, -2.0, v82
    v_fma_f32 v90, v91, -2.0, v90
    v_fmamk_f32 v80, v76, 0x41700000, v82
    v_fmamk_f32 v88, v84, 0x41700000, v90
    v_fmamk_f32 v80, v81, 0x41200000, v80
    v_fmamk_f32 v88, v89, 0x41200000, v88
    v_cvt_pk_bf16_f32 v5, v77, v85
    v_cvt_pk_bf16_f32 v9, v78, v86
    v_cvt_pk_bf16_f32 v65, v79, v87
    v_cvt_pk_bf16_f32 v69, v82, v90
    v_cvt_pk_bf16_f32 v73, v80, v88
    v_lshlrev_b32 v76, 16, v2
    v_and_b32 v84, s25, v2
    v_lshlrev_b32 v77, 16, v6
    v_and_b32 v85, s25, v6
    v_lshlrev_b32 v78, 16, v10
    v_and_b32 v86, s25, v10
    v_lshlrev_b32 v79, 16, v14
    v_and_b32 v87, s25, v14
    v_add_f32 v80, v76, v78
    v_add_f32 v88, v84, v86
    v_add_f32 v81, v77, v79
    v_add_f32 v89, v85, v87
    v_fma_f32 v82, v78, 4.0, v76
    buffer_load_dwordx4 v[36:39], v93, s[8:11], s24 offen
    buffer_load_dwordx4 v[44:47], v95, s[8:11], s24 offen
    v_fma_f32 v90, v86, 4.0, v84
    v_fma_f32 v83, v79, 4.0, v77
    v_fma_f32 v91, v87, 4.0, v85
    v_add_f32 v77, v80, v81
    v_add_f32 v85, v88, v89
    v_sub_f32 v78, v80, v81
    v_sub_f32 v86, v88, v89
    v_fma_f32 v79, v83, 2.0, v82
    v_fma_f32 v87, v91, 2.0, v90
    v_fma_f32 v82, v83, -2.0, v82
    v_fma_f32 v90, v91, -2.0, v90
    v_fmamk_f32 v80, v76, 0x41700000, v82
    v_fmamk_f32 v88, v84, 0x41700000, v90
    v_fmamk_f32 v80, v81, 0x41200000, v80
    v_fmamk_f32 v88, v89, 0x41200000, v88
    v_cvt_pk_bf16_f32 v6, v77, v85
    v_cvt_pk_bf16_f32 v10, v78, v86
    v_cvt_pk_bf16_f32 v66, v79, v87
    v_cvt_pk_bf16_f32 v70, v82, v90
    v_cvt_pk_bf16_f32 v74, v80, v88
    v_lshlrev_b32 v76, 16, v3
    v_and_b32 v84, s25, v3
    v_lshlrev_b32 v77, 16, v7
    v_and_b32 v85, s25, v7
    v_lshlrev_b32 v78, 16, v11
    v_and_b32 v86, s25, v11
    v_lshlrev_b32 v79, 16, v15
    v_and_b32 v87, s25, v15
    v_add_f32 v80, v76, v78
    v_add_f32 v88, v84, v86
    v_add_f32 v81, v77, v79
    v_add_f32 v89, v85, v87
    v_fma_f32 v82, v78, 4.0, v76
    v_fma_f32 v90, v86, 4.0, v84
    v_fma_f32 v83, v79, 4.0, v77
    v_fma_f32 v91, v87, 4.0, v85
    v_add_f32 v77, v80, v81
    v_add_f32 v85, v88, v89
    v_sub_f32 v78, v80, v81
    v_sub_f32 v86, v88, v89
    v_fma_f32 v79, v83, 2.0, v82
    v_fma_f32 v87, v91, 2.0, v90
    v_fma_f32 v82, v83, -2.0, v82
    v_fma_f32 v90, v91, -2.0, v90
    v_fmamk_f32 v80, v76, 0x41700000, v82
    v_fmamk_f32 v88, v84, 0x41700000, v90
    v_fmamk_f32 v80, v81, 0x41200000, v80
    v_fmamk_f32 v88, v89, 0x41200000, v88
    v_cvt_pk_bf16_f32 v7, v77, v85
    v_cvt_pk_bf16_f32 v11, v78, v86
    v_cvt_pk_bf16_f32 v67, v79, v87
    v_cvt_pk_bf16_f32 v71, v82, v90
    v_cvt_pk_bf16_f32 v75, v80, v88
    s_add_u32 s28, s28, 1
    s_waitcnt lgkmcnt(0)
    s_barrier
    ds_write_b128 v96, v[64:67] offset:49152
    ds_write_b128 v97, v[68:71] offset:0
    ds_write_b128 v97, v[72:75] offset:16384
    ds_write_b128 v96, v[0:3] offset:0
    ds_write_b128 v96, v[4:7] offset:16384
    ds_write_b128 v96, v[8:11] offset:32768
    ds_write_b128 v98, v[12:15] offset:0
    v_lshlrev_b32 v76, 16, v16
    v_and_b32 v84, s25, v16
    buffer_load_dwordx4 v[48:51], v92, s[8:11], s27 offen
    buffer_load_dwordx4 v[56:59], v94, s[8:11], s27 offen
    v_lshlrev_b32 v77, 16, v20
    v_and_b32 v85, s25, v20
    v_lshlrev_b32 v78, 16, v24
    v_and_b32 v86, s25, v24
    v_lshlrev_b32 v79, 16, v28
    v_and_b32 v87, s25, v28
    v_add_f32 v80, v76, v78
    v_add_f32 v88, v84, v86
    v_add_f32 v81, v77, v79
    v_add_f32 v89, v85, v87
    v_fma_f32 v82, v78, 4.0, v76
    v_fma_f32 v90, v86, 4.0, v84
    v_fma_f32 v83, v79, 4.0, v77
    v_fma_f32 v91, v87, 4.0, v85
    v_add_f32 v77, v80, v81
    v_add_f32 v85, v88, v89
    v_sub_f32 v78, v80, v81
    buffer_load_dwordx4 v[52:55], v93, s[8:11], s27 offen
    buffer_load_dwordx4 v[60:63], v95, s[8:11], s27 offen
    v_sub_f32 v86, v88, v89
    v_fma_f32 v79, v83, 2.0, v82
    v_fma_f32 v87, v91, 2.0, v90
    v_fma_f32 v82, v83, -2.0, v82
    v_fma_f32 v90, v91, -2.0, v90
    v_fmamk_f32 v80, v76, 0x41700000, v82
    v_fmamk_f32 v88, v84, 0x41700000, v90
    v_fmamk_f32 v80, v81, 0x41200000, v80
    v_fmamk_f32 v88, v89, 0x41200000, v88
    v_cvt_pk_bf16_f32 v20, v77, v85
    v_cvt_pk_bf16_f32 v24, v78, v86
    v_cvt_pk_bf16_f32 v64, v79, v87
    v_cvt_pk_bf16_f32 v68, v82, v90
    v_cvt_pk_bf16_f32 v72, v80, v88
    v_lshlrev_b32 v76, 16, v17
    v_and_b32 v84, s25, v17
    v_lshlrev_b32 v77, 16, v21
    v_and_b32 v85, s25, v21
    v_lshlrev_b32 v78, 16, v25
    v_and_b32 v86, s25, v25
    v_lshlrev_b32 v79, 16, v29
    v_and_b32 v87, s25, v29
    v_add_f32 v80, v76, v78
    v_add_f32 v88, v84, v86
    v_add_f32 v81, v77, v79
    v_add_f32 v89, v85, v87
    v_fma_f32 v82, v78, 4.0, v76
    v_fma_f32 v90, v86, 4.0, v84
    v_fma_f32 v83, v79, 4.0, v77
    v_fma_f32 v91, v87, 4.0, v85
    v_add_f32 v77, v80, v81
    v_add_f32 v85, v88, v89
    v_sub_f32 v78, v80, v81
    v_sub_f32 v86, v88, v89
    v_fma_f32 v79, v83, 2.0, v82
    v_fma_f32 v87, v91, 2.0, v90
    v_fma_f32 v82, v83, -2.0, v82
    v_fma_f32 v90, v91, -2.0, v90
    v_fmamk_f32 v80, v76, 0x41700000, v82
    v_fmamk_f32 v88, v84, 0x41700000, v90
    v_fmamk_f32 v80, v81, 0x41200000, v80
    v_fmamk_f32 v88, v89, 0x41200000, v88
    v_cvt_pk_bf16_f32 v21, v77, v85
    v_cvt_pk_bf16_f32 v25, v78, v86
    v_cvt_pk_bf16_f32 v65, v79, v87
    v_cvt_pk_bf16_f32 v69, v82, v90
    v_cvt_pk_bf16_f32 v73, v80, v88
    v_lshlrev_b32 v76, 16, v18
    v_and_b32 v84, s25, v18
    v_lshlrev_b32 v77, 16, v22
    v_and_b32 v85, s25, v22
    v_lshlrev_b32 v78, 16, v26
    v_and_b32 v86, s25, v26
    v_lshlrev_b32 v79, 16, v30
    v_and_b32 v87, s25, v30
    v_add_f32 v80, v76, v78
    v_add_f32 v88, v84, v86
    v_add_f32 v81, v77, v79
    v_add_f32 v89, v85, v87
    v_fma_f32 v82, v78, 4.0, v76
    v_fma_f32 v90, v86, 4.0, v84
    v_fma_f32 v83, v79, 4.0, v77
    v_fma_f32 v91, v87, 4.0, v85
    v_add_f32 v77, v80, v81
    v_add_f32 v85, v88, v89
    v_sub_f32 v78, v80, v81
    v_sub_f32 v86, v88, v89
    v_fma_f32 v79, v83, 2.0, v82
    v_fma_f32 v87, v91, 2.0, v90
    v_fma_f32 v82, v83, -2.0, v82
    v_fma_f32 v90, v91, -2.0, v90
    v_fmamk_f32 v80, v76, 0x41700000, v82
    v_fmamk_f32 v88, v84, 0x41700000, v90
    v_fmamk_f32 v80, v81, 0x41200000, v80
    v_fmamk_f32 v88, v89, 0x41200000, v88
    v_cvt_pk_bf16_f32 v22, v77, v85
    v_cvt_pk_bf16_f32 v26, v78, v86
    v_cvt_pk_bf16_f32 v66, v79, v87
    v_cvt_pk_bf16_f32 v70, v82, v90
    v_cvt_pk_bf16_f32 v74, v80, v88
    v_lshlrev_b32 v76, 16, v19
    v_and_b32 v84, s25, v19
    v_lshlrev_b32 v77, 16, v23
    v_and_b32 v85, s25, v23
    v_lshlrev_b32 v78, 16, v27
    v_and_b32 v86, s25, v27
    v_lshlrev_b32 v79, 16, v31
    v_and_b32 v87, s25, v31
    v_add_f32 v80, v76, v78
    v_add_f32 v88, v84, v86
    v_add_f32 v81, v77, v79
    v_add_f32 v89, v85, v87
    v_fma_f32 v82, v78, 4.0, v76
    v_fma_f32 v90, v86, 4.0, v84
    v_fma_f32 v83, v79, 4.0, v77
    v_fma_f32 v91, v87, 4.0, v85
    v_add_f32 v77, v80, v81
    v_add_f32 v85, v88, v89
    v_sub_f32 v78, v80, v81
    v_sub_f32 v86, v88, v89
    v_fma_f32 v79, v83, 2.0, v82
    v_fma_f32 v87, v91, 2.0, v90
    v_fma_f32 v82, v83, -2.0, v82
    v_fma_f32 v90, v91, -2.0, v90
    v_fmamk_f32 v80, v76, 0x41700000, v82
    v_fmamk_f32 v88, v84, 0x41700000, v90
    v_fmamk_f32 v80, v81, 0x41200000, v80
    v_fmamk_f32 v88, v89, 0x41200000, v88
    v_cvt_pk_bf16_f32 v23, v77, v85
    v_cvt_pk_bf16_f32 v27, v78, v86
    v_cvt_pk_bf16_f32 v67, v79, v87
    v_cvt_pk_bf16_f32 v71, v82, v90
    v_cvt_pk_bf16_f32 v75, v80, v88
    s_add_u32 s28, s28, 1
    s_waitcnt lgkmcnt(0)
    s_barrier
    s_sub_u32 s22, s22, 1
    s_branch L_conv2_kernel_hloop2
L_conv2_kernel_hlast2:
    s_mov_b32 s25, 0xffff0000
    ds_write_b128 v96, v[64:67] offset:57344
    ds_write_b128 v97, v[68:71] offset:8192
    ds_write_b128 v97, v[72:75] offset:24576
    ds_write_b128 v96, v[48:51] offset:8192
    ds_write_b128 v96, v[52:55] offset:24576
    ds_write_b128 v96, v[56:59] offset:40960
    ds_write_b128 v98, v[60:63] offset:8704
    s_waitcnt lgkmcnt(0)
    s_barrier
    s_branch L_conv2_kernel_end
L_conv2_kernel_epi:
    s_waitcnt lgkmcnt(0)
    s_barrier
    v_cndmask_b32 v122, v111, v110, vcc
    ds_read_b128 v[0:3], v120 offset:0
    ds_read_b128 v[4:7], v120 offset:16384
    ds_read_b128 v[8:11], v120 offset:32768
    ds_read_b128 v[12:15], v120 offset:49152
    ds_read_b128 v[16:19], v121 offset:0
    ds_read_b128 v[20:23], v121 offset:16384
    ds_read_b128 v[24:27], v121 offset:32768
    ds_read_b128 v[28:31], v64 offset:15360
    ds_read_b128 v[32:35], v120 offset:8192
    ds_read_b128 v[36:39], v120 offset:24576
    ds_read_b128 v[40:43], v120 offset:40960
    ds_read_b128 v[44:47], v120 offset:57344
    ds_read_b128 v[48:51], v121 offset:56320
    ds_read_b128 v[52:55], v121 offset:64512
    ds_read_b128 v[56:59], v64 offset:7168
    s_waitcnt lgkmcnt(7)
    ds_read_b128 v[60:63], v64 offset:23552
    s_waitcnt lgkmcnt(8)
    v_pk_add_f32 v[88:89], v[24:25], v[28:29]
    v_pk_add_f32 v[90:91], v[26:27], v[30:31]
    v_pk_add_f32 v[24:25], v[4:5], v[8:9]
    v_pk_add_f32 v[26:27], v[6:7], v[10:11]
    v_pk_add_f32 v[4:5], v[4:5], v[8:9] neg_lo:[0,1] neg_hi:[0,1]
    v_pk_add_f32 v[6:7], v[6:7], v[10:11] neg_lo:[0,1] neg_hi:[0,1]
    v_pk_add_f32 v[72:73], v[12:13], v[16:17]
    v_pk_add_f32 v[74:75], v[14:15], v[18:19]
    v_pk_add_f32 v[12:13], v[12:13], v[16:17] neg_lo:[0,1] neg_hi:[0,1]
    v_pk_add_f32 v[14:15], v[14:15], v[18:19] neg_lo:[0,1] neg_hi:[0,1]
    v_pk_fma_f32 v[72:73], v[24:25], s[4:5], v[72:73]
    v_pk_fma_f32 v[74:75], v[26:27], s[4:5], v[74:75]
    v_pk_fma_f32 v[20:21], v[0:1], s[10:11], v[20:21]
    v_pk_fma_f32 v[22:23], v[2:3], s[10:11], v[22:23]
    v_pk_fma_f32 v[72:73], v[0:1], s[6:7], v[72:73]
    v_pk_fma_f32 v[74:75], v[2:3], s[6:7], v[74:75]
    v_pk_add_f32 v[24:25], v[24:25], v[0:1] neg_lo:[0,1] neg_hi:[0,1]
    v_pk_add_f32 v[26:27], v[26:27], v[2:3] neg_lo:[0,1] neg_hi:[0,1]
    v_pk_fma_f32 v[72:73], v[88:89], s[8:9], v[72:73]
    v_pk_fma_f32 v[74:75], v[90:91], s[8:9], v[74:75]
    v_pk_add_f32 v[24:25], v[24:25], v[88:89] neg_lo:[0,1] neg_hi:[0,1]
    v_pk_add_f32 v[26:27], v[26:27], v[90:91] neg_lo:[0,1] neg_hi:[0,1]
    v_pk_fma_f32 v[20:21], v[88:89], s[22:23], v[20:21]
    v_pk_fma_f32 v[22:23], v[90:91], s[22:23], v[22:23]
    v_pk_add_f32 v[8:9], v[24:25], v[72:73] neg_lo:[0,1] neg_hi:[0,1]
    v_pk_add_f32 v[10:11], v[26:27], v[74:75] neg_lo:[0,1] neg_hi:[0,1]
    v_pk_fma_f32 v[20:21], v[72:73], s[14:15], v[20:21]
    v_pk_fma_f32 v[22:23], v[74:75], s[14:15], v[22:23]
    v_pk_mul_f32 v[80:81], v[12:13], s[32:33]
    v_pk_mul_f32 v[82:83], v[14:15], s[32:33]
    v_pk_fma_f32 v[20:21], v[8:9], s[12:13], v[20:21]
    v_pk_fma_f32 v[22:23], v[10:11], s[12:13], v[22:23]
    v_pk_fma_f32 v[80:81], v[4:5], s[34:35], v[80:81]
    v_pk_fma_f32 v[82:83], v[6:7], s[34:35], v[82:83]
    v_pk_fma_f32 v[64:65], v[4:5], s[24:25], v[20:21] neg_lo:[0,0,1] neg_hi:[0,0,1]
    v_pk_fma_f32 v[66:67], v[6:7], s[24:25], v[22:23] neg_lo:[0,0,1] neg_hi:[0,0,1]
    v_pk_fma_f32 v[64:65], v[12:13], s[26:27], v[64:65]
    v_pk_fma_f32 v[66:67], v[14:15], s[26:27], v[66:67]
    v_pk_fma_f32 v[80:81], v[64:65], s[38:39], v[80:81]
    v_pk_fma_f32 v[82:83], v[66:67], s[38:39], v[82:83]
    v_pk_add_f32 v[4:5], v[4:5], v[64:65] neg_lo:[0,1] neg_hi:[0,1]
    v_pk_add_f32 v[6:7], v[6:7], v[66:67] neg_lo:[0,1] neg_hi:[0,1]
    v_pk_add_f32 v[4:5], v[4:5], v[80:81] neg_lo:[0,1] neg_hi:[0,1]
    v_pk_add_f32 v[6:7], v[6:7], v[82:83] neg_lo:[0,1] neg_hi:[0,1]
    s_waitcnt lgkmcnt(0)
    v_pk_add_f32 v[92:93], v[56:57], v[60:61]
    v_pk_add_f32 v[94:95], v[58:59], v[62:63]
    v_pk_add_f32 v[56:57], v[36:37], v[40:41]
    v_pk_add_f32 v[58:59], v[38:39], v[42:43]
    v_pk_add_f32 v[36:37], v[36:37], v[40:41] neg_lo:[0,1] neg_hi:[0,1]
    v_pk_add_f32 v[38:39], v[38:39], v[42:43] neg_lo:[0,1] neg_hi:[0,1]
    v_pk_add_f32 v[76:77], v[44:45], v[48:49]
    v_pk_add_f32 v[78:79], v[46:47], v[50:51]
    v_pk_add_f32 v[44:45], v[44:45], v[48:49] neg_lo:[0,1] neg_hi:[0,1]
    v_pk_add_f32 v[46:47], v[46:47], v[50:51] neg_lo:[0,1] neg_hi:[0,1]
    v_pk_fma_f32 v[76:77], v[56:57], s[4:5], v[76:77]
    v_pk_fma_f32 v[78:79], v[58:59], s[4:5], v[78:79]
    v_pk_fma_f32 v[52:53], v[32:33], s[10:11], v[52:53]
    v_pk_fma_f32 v[54:55], v[34:35], s[10:11], v[54:55]
    v_pk_fma_f32 v[76:77], v[32:33], s[6:7], v[76:77]
    v_pk_fma_f32 v[78:79], v[34:35], s[6:7], v[78:79]
    v_pk_add_f32 v[56:57], v[56:57], v[32:33] neg_lo:[0,1] neg_hi:[0,1]
    v_pk_add_f32 v[58:59], v[58:59], v[34:35] neg_lo:[0,1] neg_hi:[0,1]
    v_pk_fma_f32 v[76:77], v[92:93], s[8:9], v[76:77]
    v_pk_fma_f32 v[78:79], v[94:95], s[8:9], v[78:79]
    v_pk_add_f32 v[56:57], v[56:57], v[92:93] neg_lo:[0,1] neg_hi:[0,1]
    v_pk_add_f32 v[58:59], v[58:59], v[94:95] neg_lo:[0,1] neg_hi:[0,1]
    v_pk_fma_f32 v[52:53], v[92:93], s[22:23], v[52:53]
    v_pk_fma_f32 v[54:55], v[94:95], s[22:23], v[54:55]
    v_pk_add_f32 v[40:41], v[56:57], v[76:77] neg_lo:[0,1] neg_hi:[0,1]
    v_pk_add_f32 v[42:43], v[58:59], v[78:79] neg_lo:[0,1] neg_hi:[0,1]
    v_pk_fma_f32 v[52:53], v[76:77], s[14:15], v[52:53]
    v_pk_fma_f32 v[54:55], v[78:79], s[14:15], v[54:55]
    v_pk_mul_f32 v[84:85], v[44:45], s[32:33]
    v_pk_mul_f32 v[86:87], v[46:47], s[32:33]
    v_pk_fma_f32 v[52:53], v[40:41], s[12:13], v[52:53]
    v_pk_fma_f32 v[54:55], v[42:43], s[12:13], v[54:55]
    v_pk_fma_f32 v[84:85], v[36:37], s[34:35], v[84:85]
    v_pk_fma_f32 v[86:87], v[38:39], s[34:35], v[86:87]
    v_pk_fma_f32 v[68:69], v[36:37], s[24:25], v[52:53] neg_lo:[0,0,1] neg_hi:[0,0,1]
    v_pk_fma_f32 v[70:71], v[38:39], s[24:25], v[54:55] neg_lo:[0,0,1] neg_hi:[0,0,1]
    v_pk_fma_f32 v[68:69], v[44:45], s[26:27], v[68:69]
    v_pk_fma_f32 v[70:71], v[46:47], s[26:27], v[70:71]
    v_pk_fma_f32 v[84:85], v[68:69], s[38:39], v[84:85]
    v_pk_fma_f32 v[86:87], v[70:71], s[38:39], v[86:87]
    v_pk_add_f32 v[36:37], v[36:37], v[68:69] neg_lo:[0,1] neg_hi:[0,1]
    v_pk_add_f32 v[38:39], v[38:39], v[70:71] neg_lo:[0,1] neg_hi:[0,1]
    v_pk_add_f32 v[36:37], v[36:37], v[84:85] neg_lo:[0,1] neg_hi:[0,1]
    v_pk_add_f32 v[38:39], v[38:39], v[86:87] neg_lo:[0,1] neg_hi:[0,1]
    s_mov_b32 s36, 0x00010001
    s_mov_b32 s37, 0x00010001
    s_mov_b64 exec, s[36:37]
    ds_write_b128 v127, v[0:3] offset:0
    ds_write_b128 v127, v[32:35] offset:16
    ds_write_b128 v127, v[4:7] offset:32
    ds_write_b128 v127, v[36:39] offset:48
    ds_write_b128 v127, v[8:11] offset:64
    ds_write_b128 v127, v[40:43] offset:80
    s_mov_b64 exec, -1
    v_mov_b32 v44, 0xc0135761
    v_mov_b32 v45, v44
    v_cvt_pk_bf16_f32 v48, v64, v68
    v_cvt_pk_bf16_f32 v49, v65, v69
    v_cvt_pk_bf16_f32 v50, v66, v70
    v_cvt_pk_bf16_f32 v51, v67, v71
    s_mov_b32 s44, 0
    buffer_store_dwordx4 v[48:51], v122, s[16:19], s44 offen sc1
    s_waitcnt lgkmcnt(0)
    s_barrier
    ds_read_b128 v[96:99], v127 offset:512
    ds_read_b128 v[100:103], v127 offset:528
    ds_read_b128 v[104:107], v127 offset:544
    ds_read_b128 v[108:111], v127 offset:560
    ds_read_b128 v[112:115], v127 offset:576
    ds_read_b128 v[116:119], v127 offset:592
    s_waitcnt lgkmcnt(4)
    v_mov_b32_dpp v96, v0 row_shl:1 row_mask:0xf bank_mask:0xf
    v_mov_b32_dpp v97, v1 row_shl:1 row_mask:0xf bank_mask:0xf
    v_mov_b32_dpp v98, v2 row_shl:1 row_mask:0xf bank_mask:0xf
    v_mov_b32_dpp v99, v3 row_shl:1 row_mask:0xf bank_mask:0xf
    v_mov_b32_dpp v100, v32 row_shl:1 row_mask:0xf bank_mask:0xf
    v_mov_b32_dpp v101, v33 row_shl:1 row_mask:0xf bank_mask:0xf
    v_mov_b32_dpp v102, v34 row_shl:1 row_mask:0xf bank_mask:0xf
    v_mov_b32_dpp v103, v35 row_shl:1 row_mask:0xf bank_mask:0xf
    v_pk_add_f32 v[72:73], v[72:73], v[96:97]
    v_pk_add_f32 v[74:75], v[74:75], v[98:99]
    v_pk_add_f32 v[76:77], v[76:77], v[100:101]
    v_pk_add_f32 v[78:79], v[78:79], v[102:103]
    v_cvt_pk_bf16_f32 v52, v72, v76
    v_cvt_pk_bf16_f32 v53, v73, v77
    v_cvt_pk_bf16_f32 v54, v74, v78
    v_cvt_pk_bf16_f32 v55, v75, v79
    s_mov_b32 s44, 65536
    buffer_store_dwordx4 v[52:55], v122, s[16:19], s44 offen sc1
    s_waitcnt lgkmcnt(2)
    v_mov_b32_dpp v104, v4 row_shl:1 row_mask:0xf bank_mask:0xf
    v_mov_b32_dpp v105, v5 row_shl:1 row_mask:0xf bank_mask:0xf
    v_mov_b32_dpp v106, v6 row_shl:1 row_mask:0xf bank_mask:0xf
    v_mov_b32_dpp v107, v7 row_shl:1 row_mask:0xf bank_mask:0xf
    v_mov_b32_dpp v108, v36 row_shl:1 row_mask:0xf bank_mask:0xf
    v_mov_b32_dpp v109, v37 row_shl:1 row_mask:0xf bank_mask:0xf
    v_mov_b32_dpp v110, v38 row_shl:1 row_mask:0xf bank_mask:0xf
    v_mov_b32_dpp v111, v39 row_shl:1 row_mask:0xf bank_mask:0xf
    v_pk_add_f32 v[80:81], v[80:81], v[104:105]
    v_pk_add_f32 v[82:83], v[82:83], v[106:107]
    v_pk_add_f32 v[84:85], v[84:85], v[108:109]
    v_pk_add_f32 v[86:87], v[86:87], v[110:111]
    v_cvt_pk_bf16_f32 v56, v80, v84
    v_cvt_pk_bf16_f32 v57, v81, v85
    v_cvt_pk_bf16_f32 v58, v82, v86
    v_cvt_pk_bf16_f32 v59, v83, v87
    s_mov_b32 s44, 131072
    buffer_store_dwordx4 v[56:59], v122, s[16:19], s44 offen sc1
    s_waitcnt lgkmcnt(0)
    v_mov_b32_dpp v112, v8 row_shl:1 row_mask:0xf bank_mask:0xf
    v_mov_b32_dpp v113, v9 row_shl:1 row_mask:0xf bank_mask:0xf
    v_mov_b32_dpp v114, v10 row_shl:1 row_mask:0xf bank_mask:0xf
    v_mov_b32_dpp v115, v11 row_shl:1 row_mask:0xf bank_mask:0xf
    v_mov_b32_dpp v116, v40 row_shl:1 row_mask:0xf bank_mask:0xf
    v_mov_b32_dpp v117, v41 row_shl:1 row_mask:0xf bank_mask:0xf
    v_mov_b32_dpp v118, v42 row_shl:1 row_mask:0xf bank_mask:0xf
    v_mov_b32_dpp v119, v43 row_shl:1 row_mask:0xf bank_mask:0xf
    v_pk_add_f32 v[88:89], v[88:89], v[112:113]
    v_pk_add_f32 v[90:91], v[90:91], v[114:115]
    v_pk_add_f32 v[92:93], v[92:93], v[116:117]
    v_pk_add_f32 v[94:95], v[94:95], v[118:119]
    v_cvt_pk_bf16_f32 v60, v88, v92
    v_cvt_pk_bf16_f32 v61, v89, v93
    v_cvt_pk_bf16_f32 v62, v90, v94
    v_cvt_pk_bf16_f32 v63, v91, v95
    s_mov_b32 s44, 196608
    buffer_store_dwordx4 v[60:63], v122, s[16:19], s44 offen sc1
L_conv2_kernel_end:
L_conv2_kernel_done:
    s_endpgm
.globl joint_kernel
.p2align 8
.type joint_kernel,@function
joint_kernel:
    s_cmp_ge_u32 s2, 250
    s_cbranch_scc1 L_joint_kernel_done
    s_load_dwordx2 s[28:29], s[0:1], 56
    s_load_dwordx2 s[30:31], s[0:1], 72
    v_readfirstlane_b32 s20, v0
    s_lshr_b32 s20, s20, 6
    s_and_b32 s21, s20, 7
    v_and_b32 v127, 63, v0
    v_lshlrev_b32 v126, 4, v127
    s_cmp_ge_u32 s20, 8
    s_mov_b32 s33, 44171264
    s_cselect_b32 s33, 44040192, s33
    s_lshl_b32 s36, s21, 14
    s_add_u32 s33, s33, s36
    s_mov_b32 s14, 16384
    s_mov_b32 s15, 0x00020000
    s_lshl_b32 s35, s2, 9
    s_cmp_ge_u32 s2, 125
    s_cselect_b32 s36, 2033152, 0
    s_cselect_b32 s34, 8192, 0
    s_add_u32 s35, s35, s36
    s_add_u32 s34, s34, 44302336
    s_mov_b32 s10, 12582912
    s_mov_b32 s11, 0x00020000
    s_mov_b32 s42, 24576
    s_mov_b32 s43, 0x00020000
    s_waitcnt lgkmcnt(0)
    s_add_u32 s12, s30, s33
    s_addc_u32 s13, s31, 0
    s_add_u32 s40, s30, s34
    s_addc_u32 s41, s31, 0
    s_cmp_ge_u32 s20, 8
    s_cbranch_scc1 L_joint_kernel_T
    s_add_u32 s8, s30, 27262976
    s_addc_u32 s9, s31, 0
    v_mov_b32 v0, 99456
    v_mov_b32 v2, 0
    v_mov_b32 v3, 0
    ds_write_b64 v0, v[2:3]
    v_lshrrev_b32 v124, 5, v127
    v_and_b32 v123, 0x1ff, v126
    v_mul_u32_u24 v125, 65536, v124
    v_add_u32 v123, v125, v123
    s_mul_i32 s36, s21, 262144
    s_add_u32 s36, s36, s35
    s_add_u32 s37, s36, 8388608
    buffer_load_dwordx4 v[64:67], v123, s[8:11], s36 offen
    buffer_load_dwordx4 v[72:75], v123, s[8:11], s37 offen
    s_add_u32 s36, s36, 131072
    s_add_u32 s37, s36, 8388608
    buffer_load_dwordx4 v[68:71], v123, s[8:11], s36 offen
    buffer_load_dwordx4 v[76:79], v123, s[8:11], s37 offen
    s_lshl_b32 s38, s21, 10
    s_add_u32 s38, s38, 16384
    buffer_load_dwordx4 v[80:83], v126, s[40:43], s38 offen
    s_waitcnt lgkmcnt(0)
    s_barrier
    s_lshl_b32 s35, s2, 17
    s_add_u32 s16, s28, s35
    s_addc_u32 s17, s29, 0
    s_mov_b32 s18, 131072
    s_mov_b32 s19, 0x00020000
    s_mov_b32 s46, 0xbdd2d3e8
    s_mov_b32 s47, s46
    v_mov_b32 v120, 0xc0135761
    v_mov_b32 v121, v120
    s_mov_b32 s48, 1.0
    s_mov_b32 s49, 1.0
    v_bfe_u32 v123, v127, 2, 3
    v_lshl_add_u32 v124, v123, 2, v124
    v_mul_u32_u24 v124, 528, v124
    v_and_b32 v123, 0x30, v126
    s_lshl_b32 s36, s21, 6
    v_add3_u32 v124, v124, v123, s36
    s_mov_b32 s45, 0xffff0000
    s_mul_i32 s36, s21, 1040
    s_add_u32 s36, s36, 91136
    v_add_u32 v123, s36, v126
    s_mov_b32 s22, 2
    s_waitcnt vmcnt(3)
L_joint_kernel_floop:
    v_lshlrev_b32 v88, 16, v64
    v_and_b32 v89, s45, v64
    v_lshlrev_b32 v96, 16, v72
    v_and_b32 v97, s45, v72
    v_lshlrev_b32 v90, 16, v65
    v_and_b32 v91, s45, v65
    v_lshlrev_b32 v98, 16, v73
    v_and_b32 v99, s45, v73
    v_lshlrev_b32 v92, 16, v66
    v_and_b32 v93, s45, v66
    v_lshlrev_b32 v100, 16, v74
    v_and_b32 v101, s45, v74
    v_lshlrev_b32 v94, 16, v67
    v_and_b32 v95, s45, v67
    v_lshlrev_b32 v102, 16, v75
    v_and_b32 v103, s45, v75
    v_pk_add_f32 v[88:89], v[88:89], v[96:97]
    v_pk_add_f32 v[90:91], v[90:91], v[98:99]
    v_pk_add_f32 v[92:93], v[92:93], v[100:101]
    v_pk_add_f32 v[94:95], v[94:95], v[102:103]
    v_pk_mul_f32 v[96:97], v[88:89], v[88:89]
    v_pk_mul_f32 v[98:99], v[90:91], v[90:91]
    v_pk_mul_f32 v[100:101], v[92:93], v[92:93]
    v_pk_mul_f32 v[102:103], v[94:95], v[94:95]
    v_pk_fma_f32 v[96:97], v[96:97], s[46:47], v[120:121]
    v_pk_fma_f32 v[98:99], v[98:99], s[46:47], v[120:121]
    v_pk_fma_f32 v[100:101], v[100:101], s[46:47], v[120:121]
    v_pk_fma_f32 v[102:103], v[102:103], s[46:47], v[120:121]
    v_pk_mul_f32 v[96:97], v[96:97], v[88:89]
    v_pk_mul_f32 v[98:99], v[98:99], v[90:91]
    v_pk_mul_f32 v[100:101], v[100:101], v[92:93]
    v_pk_mul_f32 v[102:103], v[102:103], v[94:95]
    v_exp_f32 v96, v96
    v_exp_f32 v97, v97
    v_exp_f32 v98, v98
    v_exp_f32 v99, v99
    v_exp_f32 v100, v100
    v_exp_f32 v101, v101
    v_exp_f32 v102, v102
    v_exp_f32 v103, v103
    v_pk_add_f32 v[96:97], v[96:97], s[48:49]
    v_pk_add_f32 v[98:99], v[98:99], s[48:49]
    v_pk_add_f32 v[100:101], v[100:101], s[48:49]
    v_pk_add_f32 v[102:103], v[102:103], s[48:49]
    v_rcp_f32 v96, v96
    v_rcp_f32 v97, v97
    v_rcp_f32 v98, v98
    v_rcp_f32 v99, v99
    v_rcp_f32 v100, v100
    v_rcp_f32 v101, v101
    v_rcp_f32 v102, v102
    v_rcp_f32 v103, v103
    v_pk_mul_f32 v[88:89], v[88:89], v[96:97]
    v_pk_mul_f32 v[90:91], v[90:91], v[98:99]
    v_pk_mul_f32 v[92:93], v[92:93], v[100:101]
    v_pk_mul_f32 v[94:95], v[94:95], v[102:103]
    v_cvt_pk_bf16_f32 v104, v88, v89
    v_cvt_pk_bf16_f32 v105, v90, v91
    v_cvt_pk_bf16_f32 v106, v92, v93
    v_cvt_pk_bf16_f32 v107, v94, v95
    ds_write_b128 v124, v[104:107] offset:32768
    s_waitcnt vmcnt(0)
    v_pk_mov_b32 v[64:65], v[68:69], v[68:69] op_sel:[0,1]
    v_pk_mov_b32 v[72:73], v[76:77], v[76:77] op_sel:[0,1]
    v_pk_mov_b32 v[66:67], v[70:71], v[70:71] op_sel:[0,1]
    v_pk_mov_b32 v[74:75], v[78:79], v[78:79] op_sel:[0,1]
    v_add_u32 v124, 1056, v124
    s_sub_u32 s22, s22, 1
    s_cmp_lg_u32 s22, 0
    s_cbranch_scc1 L_joint_kernel_floop
    ds_write_b128 v123, v[80:83]
    s_waitcnt lgkmcnt(0)
    v_mov_b32 v120, 99456
    v_mov_b32 v121, 1
    s_mov_b64 exec, 1
    ds_add_u32 v120, v121 offset:0
    s_mov_b64 exec, -1
L_joint_kernel_ow:
    ds_read_b32 v121, v120 offset:4
    s_waitcnt lgkmcnt(0)
    v_readfirstlane_b32 s37, v121
    s_cmp_ge_u32 s37, 8
    s_cbranch_scc1 L_joint_kernel_ow_d
    s_sleep 1
    s_branch L_joint_kernel_ow
L_joint_kernel_ow_d:
    s_mov_b32 s36, 0
    buffer_load_dwordx4 v[0:3], v126, s[12:15], s36 offen offset:0
    buffer_load_dwordx4 v[4:7], v126, s[12:15], s36 offen offset:1024
    buffer_load_dwordx4 v[8:11], v126, s[12:15], s36 offen offset:2048
    buffer_load_dwordx4 v[12:15], v126, s[12:15], s36 offen offset:3072
    s_mov_b32 s36, 4096
    buffer_load_dwordx4 v[16:19], v126, s[12:15], s36 offen offset:0
    buffer_load_dwordx4 v[20:23], v126, s[12:15], s36 offen offset:1024
    buffer_load_dwordx4 v[24:27], v126, s[12:15], s36 offen offset:2048
    buffer_load_dwordx4 v[28:31], v126, s[12:15], s36 offen offset:3072
    s_mov_b32 s36, 8192
    buffer_load_dwordx4 v[32:35], v126, s[12:15], s36 offen offset:0
    buffer_load_dwordx4 v[36:39], v126, s[12:15], s36 offen offset:1024
    buffer_load_dwordx4 v[40:43], v126, s[12:15], s36 offen offset:2048
    buffer_load_dwordx4 v[44:47], v126, s[12:15], s36 offen offset:3072
    s_mov_b32 s36, 12288
    buffer_load_dwordx4 v[48:51], v126, s[12:15], s36 offen offset:0
    buffer_load_dwordx4 v[52:55], v126, s[12:15], s36 offen offset:1024
    buffer_load_dwordx4 v[56:59], v126, s[12:15], s36 offen offset:2048
    buffer_load_dwordx4 v[60:63], v126, s[12:15], s36 offen offset:3072
    v_lshrrev_b32 v125, 4, v127
    v_lshlrev_b32 v125, 11, v125
    v_and_b32 v124, 15, v127
    v_lshl_add_u32 v125, v124, 2, v125
    s_lshl_b32 s36, s21, 6
    v_add_u32 v125, s36, v125
    s_mov_b32 s44, 8192
    s_setprio 1
    s_barrier
    ds_read_b128 v[96:99], v126 offset:0
    ds_read_b128 v[100:103], v126 offset:1024
    ds_read_b128 v[104:107], v126 offset:2048
    ds_read_b128 v[108:111], v126 offset:3072
    s_waitcnt vmcnt(14) lgkmcnt(3)
    v_mfma_f32_16x16x32_bf16 v[64:67], v[96:99], v[0:3], 0
    v_mfma_f32_16x16x32_bf16 v[68:71], v[96:99], v[4:7], 0
    ds_read_b128 v[96:99], v126 offset:4096
    s_waitcnt lgkmcnt(3)
    v_mfma_f32_16x16x32_bf16 v[72:75], v[100:103], v[0:3], 0
    v_mfma_f32_16x16x32_bf16 v[76:79], v[100:103], v[4:7], 0
    ds_read_b128 v[100:103], v126 offset:5120
    s_waitcnt vmcnt(12) lgkmcnt(3)
    v_mfma_f32_16x16x32_bf16 v[64:67], v[104:107], v[8:11], v[64:67]
    v_mfma_f32_16x16x32_bf16 v[68:71], v[104:107], v[12:15], v[68:71]
    ds_read_b128 v[104:107], v126 offset:6144
    s_waitcnt lgkmcnt(3)
    v_mfma_f32_16x16x32_bf16 v[72:75], v[108:111], v[8:11], v[72:75]
    v_mfma_f32_16x16x32_bf16 v[76:79], v[108:111], v[12:15], v[76:79]
    ds_read_b128 v[108:111], v126 offset:7168
    s_waitcnt vmcnt(10) lgkmcnt(3)
    v_mfma_f32_16x16x32_bf16 v[64:67], v[96:99], v[16:19], v[64:67]
    v_mfma_f32_16x16x32_bf16 v[68:71], v[96:99], v[20:23], v[68:71]
    ds_read_b128 v[96:99], v126 offset:8192
    s_waitcnt lgkmcnt(3)
    v_mfma_f32_16x16x32_bf16 v[72:75], v[100:103], v[16:19], v[72:75]
    v_mfma_f32_16x16x32_bf16 v[76:79], v[100:103], v[20:23], v[76:79]
    ds_read_b128 v[100:103], v126 offset:9216
    s_waitcnt vmcnt(8) lgkmcnt(3)
    v_mfma_f32_16x16x32_bf16 v[64:67], v[104:107], v[24:27], v[64:67]
    v_mfma_f32_16x16x32_bf16 v[68:71], v[104:107], v[28:31], v[68:71]
    ds_read_b128 v[104:107], v126 offset:10240
    s_waitcnt lgkmcnt(3)
    v_mfma_f32_16x16x32_bf16 v[72:75], v[108:111], v[24:27], v[72:75]
    v_mfma_f32_16x16x32_bf16 v[76:79], v[108:111], v[28:31], v[76:79]
    ds_read_b128 v[108:111], v126 offset:11264
    s_waitcnt vmcnt(6) lgkmcnt(3)
    v_mfma_f32_16x16x32_bf16 v[64:67], v[96:99], v[32:35], v[64:67]
    v_mfma_f32_16x16x32_bf16 v[68:71], v[96:99], v[36:39], v[68:71]
    ds_read_b128 v[96:99], v126 offset:12288
    s_waitcnt lgkmcnt(3)
    v_mfma_f32_16x16x32_bf16 v[72:75], v[100:103], v[32:35], v[72:75]
    v_mfma_f32_16x16x32_bf16 v[76:79], v[100:103], v[36:39], v[76:79]
    ds_read_b128 v[100:103], v126 offset:13312
    s_waitcnt vmcnt(4) lgkmcnt(3)
    v_mfma_f32_16x16x32_bf16 v[64:67], v[104:107], v[40:43], v[64:67]
    v_mfma_f32_16x16x32_bf16 v[68:71], v[104:107], v[44:47], v[68:71]
    ds_read_b128 v[104:107], v126 offset:14336
    s_waitcnt lgkmcnt(3)
    v_mfma_f32_16x16x32_bf16 v[72:75], v[108:111], v[40:43], v[72:75]
    v_mfma_f32_16x16x32_bf16 v[76:79], v[108:111], v[44:47], v[76:79]
    ds_read_b128 v[108:111], v126 offset:15360
    s_waitcnt vmcnt(2) lgkmcnt(3)
    v_mfma_f32_16x16x32_bf16 v[64:67], v[96:99], v[48:51], v[64:67]
    v_mfma_f32_16x16x32_bf16 v[68:71], v[96:99], v[52:55], v[68:71]
    s_waitcnt lgkmcnt(0)
    s_barrier
    ds_read_b128 v[96:99], v126 offset:16384
    v_mfma_f32_16x16x32_bf16 v[72:75], v[100:103], v[48:51], v[72:75]
    v_mfma_f32_16x16x32_bf16 v[76:79], v[100:103], v[52:55], v[76:79]
    ds_read_b128 v[100:103], v126 offset:17408
    s_waitcnt vmcnt(0)
    v_mfma_f32_16x16x32_bf16 v[64:67], v[104:107], v[56:59], v[64:67]
    v_mfma_f32_16x16x32_bf16 v[68:71], v[104:107], v[60:63], v[68:71]
    ds_read_b128 v[104:107], v126 offset:18432
    v_mfma_f32_16x16x32_bf16 v[72:75], v[108:111], v[56:59], v[72:75]
    v_mfma_f32_16x16x32_bf16 v[76:79], v[108:111], v[60:63], v[76:79]
    ds_read_b128 v[108:111], v126 offset:19456
    s_mov_b32 s22, 4
L_joint_kernel_oloop:
    s_waitcnt lgkmcnt(3)
    v_mfma_f32_16x16x32_bf16 v[80:83], v[96:99], v[0:3], 0
    v_mfma_f32_16x16x32_bf16 v[84:87], v[96:99], v[4:7], 0
    ds_read_b128 v[96:99], v126 offset:20480
    s_waitcnt lgkmcnt(3)
    v_mfma_f32_16x16x32_bf16 v[88:91], v[100:103], v[0:3], 0
    v_mfma_f32_16x16x32_bf16 v[92:95], v[100:103], v[4:7], 0
    ds_read_b128 v[100:103], v126 offset:21504
    s_waitcnt lgkmcnt(3)
    v_mfma_f32_16x16x32_bf16 v[80:83], v[104:107], v[8:11], v[80:83]
    v_mfma_f32_16x16x32_bf16 v[84:87], v[104:107], v[12:15], v[84:87]
    ds_read_b128 v[104:107], v126 offset:22528
    s_waitcnt lgkmcnt(3)
    v_mfma_f32_16x16x32_bf16 v[88:91], v[108:111], v[8:11], v[88:91]
    v_cvt_pk_bf16_f32 v112, v64, v68
    v_mfma_f32_16x16x32_bf16 v[92:95], v[108:111], v[12:15], v[92:95]
    buffer_store_dword v112, v125, s[16:19], 0 offen offset:0 nt
    ds_read_b128 v[108:111], v126 offset:23552
    s_waitcnt lgkmcnt(3)
    v_mfma_f32_16x16x32_bf16 v[80:83], v[96:99], v[16:19], v[80:83]
    v_cvt_pk_bf16_f32 v113, v65, v69
    v_mfma_f32_16x16x32_bf16 v[84:87], v[96:99], v[20:23], v[84:87]
    buffer_store_dword v113, v125, s[16:19], 0 offen offset:512 nt
    ds_read_b128 v[96:99], v126 offset:24576
    s_waitcnt lgkmcnt(3)
    v_mfma_f32_16x16x32_bf16 v[88:91], v[100:103], v[16:19], v[88:91]
    v_cvt_pk_bf16_f32 v114, v66, v70
    v_mfma_f32_16x16x32_bf16 v[92:95], v[100:103], v[20:23], v[92:95]
    buffer_store_dword v114, v125, s[16:19], 0 offen offset:1024 nt
    ds_read_b128 v[100:103], v126 offset:25600
    s_waitcnt lgkmcnt(3)
    v_mfma_f32_16x16x32_bf16 v[80:83], v[104:107], v[24:27], v[80:83]
    v_cvt_pk_bf16_f32 v115, v67, v71
    v_mfma_f32_16x16x32_bf16 v[84:87], v[104:107], v[28:31], v[84:87]
    buffer_store_dword v115, v125, s[16:19], 0 offen offset:1536 nt
    ds_read_b128 v[104:107], v126 offset:26624
    s_waitcnt lgkmcnt(3)
    v_mfma_f32_16x16x32_bf16 v[88:91], v[108:111], v[24:27], v[88:91]
    v_cvt_pk_bf16_f32 v116, v72, v76
    v_mfma_f32_16x16x32_bf16 v[92:95], v[108:111], v[28:31], v[92:95]
    buffer_store_dword v116, v125, s[16:19], s44 offen offset:0 nt
    ds_read_b128 v[108:111], v126 offset:27648
    s_waitcnt lgkmcnt(3)
    v_mfma_f32_16x16x32_bf16 v[80:83], v[96:99], v[32:35], v[80:83]
    v_cvt_pk_bf16_f32 v117, v73, v77
    v_mfma_f32_16x16x32_bf16 v[84:87], v[96:99], v[36:39], v[84:87]
    buffer_store_dword v117, v125, s[16:19], s44 offen offset:512 nt
    ds_read_b128 v[96:99], v126 offset:28672
    s_waitcnt lgkmcnt(3)
    v_mfma_f32_16x16x32_bf16 v[88:91], v[100:103], v[32:35], v[88:91]
    v_cvt_pk_bf16_f32 v118, v74, v78
    v_mfma_f32_16x16x32_bf16 v[92:95], v[100:103], v[36:39], v[92:95]
    buffer_store_dword v118, v125, s[16:19], s44 offen offset:1024 nt
    ds_read_b128 v[100:103], v126 offset:29696
    s_waitcnt lgkmcnt(3)
    v_mfma_f32_16x16x32_bf16 v[80:83], v[104:107], v[40:43], v[80:83]
    v_cvt_pk_bf16_f32 v119, v75, v79
    v_mfma_f32_16x16x32_bf16 v[84:87], v[104:107], v[44:47], v[84:87]
    buffer_store_dword v119, v125, s[16:19], s44 offen offset:1536 nt
    ds_read_b128 v[104:107], v126 offset:30720
    s_waitcnt lgkmcnt(3)
    v_mfma_f32_16x16x32_bf16 v[88:91], v[108:111], v[40:43], v[88:91]
    v_add_u32 v125, 16384, v125
    v_mfma_f32_16x16x32_bf16 v[92:95], v[108:111], v[44:47], v[92:95]
    ds_read_b128 v[108:111], v126 offset:31744
    s_waitcnt lgkmcnt(3)
    v_mfma_f32_16x16x32_bf16 v[80:83], v[96:99], v[48:51], v[80:83]
    v_mfma_f32_16x16x32_bf16 v[84:87], v[96:99], v[52:55], v[84:87]
    s_waitcnt lgkmcnt(0)
    s_barrier
    ds_read_b128 v[96:99], v126 offset:0
    v_mfma_f32_16x16x32_bf16 v[88:91], v[100:103], v[48:51], v[88:91]
    v_mfma_f32_16x16x32_bf16 v[92:95], v[100:103], v[52:55], v[92:95]
    ds_read_b128 v[100:103], v126 offset:1024
    v_mfma_f32_16x16x32_bf16 v[80:83], v[104:107], v[56:59], v[80:83]
    v_mfma_f32_16x16x32_bf16 v[84:87], v[104:107], v[60:63], v[84:87]
    ds_read_b128 v[104:107], v126 offset:2048
    v_mfma_f32_16x16x32_bf16 v[88:91], v[108:111], v[56:59], v[88:91]
    v_mfma_f32_16x16x32_bf16 v[92:95], v[108:111], v[60:63], v[92:95]
    ds_read_b128 v[108:111], v126 offset:3072
    s_sub_u32 s22, s22, 1
    s_cmp_eq_u32 s22, 0
    s_cbranch_scc1 L_joint_kernel_oend
    s_waitcnt lgkmcnt(3)
    v_mfma_f32_16x16x32_bf16 v[64:67], v[96:99], v[0:3], 0
    v_mfma_f32_16x16x32_bf16 v[68:71], v[96:99], v[4:7], 0
    ds_read_b128 v[96:99], v126 offset:4096
    s_waitcnt lgkmcnt(3)
    v_mfma_f32_16x16x32_bf16 v[72:75], v[100:103], v[0:3], 0
    v_mfma_f32_16x16x32_bf16 v[76:79], v[100:103], v[4:7], 0
    ds_read_b128 v[100:103], v126 offset:5120
    s_waitcnt lgkmcnt(3)
    v_mfma_f32_16x16x32_bf16 v[64:67], v[104:107], v[8:11], v[64:67]
    v_mfma_f32_16x16x32_bf16 v[68:71], v[104:107], v[12:15], v[68:71]
    ds_read_b128 v[104:107], v126 offset:6144
    s_waitcnt lgkmcnt(3)
    v_mfma_f32_16x16x32_bf16 v[72:75], v[108:111], v[8:11], v[72:75]
    v_cvt_pk_bf16_f32 v112, v80, v84
    v_mfma_f32_16x16x32_bf16 v[76:79], v[108:111], v[12:15], v[76:79]
    buffer_store_dword v112, v125, s[16:19], 0 offen offset:0 nt
    ds_read_b128 v[108:111], v126 offset:7168
    s_waitcnt lgkmcnt(3)
    v_mfma_f32_16x16x32_bf16 v[64:67], v[96:99], v[16:19], v[64:67]
    v_cvt_pk_bf16_f32 v113, v81, v85
    v_mfma_f32_16x16x32_bf16 v[68:71], v[96:99], v[20:23], v[68:71]
    buffer_store_dword v113, v125, s[16:19], 0 offen offset:512 nt
    ds_read_b128 v[96:99], v126 offset:8192
    s_waitcnt lgkmcnt(3)
    v_mfma_f32_16x16x32_bf16 v[72:75], v[100:103], v[16:19], v[72:75]
    v_cvt_pk_bf16_f32 v114, v82, v86
    v_mfma_f32_16x16x32_bf16 v[76:79], v[100:103], v[20:23], v[76:79]
    buffer_store_dword v114, v125, s[16:19], 0 offen offset:1024 nt
    ds_read_b128 v[100:103], v126 offset:9216
    s_waitcnt lgkmcnt(3)
    v_mfma_f32_16x16x32_bf16 v[64:67], v[104:107], v[24:27], v[64:67]
    v_cvt_pk_bf16_f32 v115, v83, v87
    v_mfma_f32_16x16x32_bf16 v[68:71], v[104:107], v[28:31], v[68:71]
    buffer_store_dword v115, v125, s[16:19], 0 offen offset:1536 nt
    ds_read_b128 v[104:107], v126 offset:10240
    s_waitcnt lgkmcnt(3)
    v_mfma_f32_16x16x32_bf16 v[72:75], v[108:111], v[24:27], v[72:75]
    v_cvt_pk_bf16_f32 v116, v88, v92
    v_mfma_f32_16x16x32_bf16 v[76:79], v[108:111], v[28:31], v[76:79]
    buffer_store_dword v116, v125, s[16:19], s44 offen offset:0 nt
    ds_read_b128 v[108:111], v126 offset:11264
    s_waitcnt lgkmcnt(3)
    v_mfma_f32_16x16x32_bf16 v[64:67], v[96:99], v[32:35], v[64:67]
    v_cvt_pk_bf16_f32 v117, v89, v93
    v_mfma_f32_16x16x32_bf16 v[68:71], v[96:99], v[36:39], v[68:71]
    buffer_store_dword v117, v125, s[16:19], s44 offen offset:512 nt
    ds_read_b128 v[96:99], v126 offset:12288
    s_waitcnt lgkmcnt(3)
    v_mfma_f32_16x16x32_bf16 v[72:75], v[100:103], v[32:35], v[72:75]
    v_cvt_pk_bf16_f32 v118, v90, v94
    v_mfma_f32_16x16x32_bf16 v[76:79], v[100:103], v[36:39], v[76:79]
    buffer_store_dword v118, v125, s[16:19], s44 offen offset:1024 nt
    ds_read_b128 v[100:103], v126 offset:13312
    s_waitcnt lgkmcnt(3)
    v_mfma_f32_16x16x32_bf16 v[64:67], v[104:107], v[40:43], v[64:67]
    v_cvt_pk_bf16_f32 v119, v91, v95
    v_mfma_f32_16x16x32_bf16 v[68:71], v[104:107], v[44:47], v[68:71]
    buffer_store_dword v119, v125, s[16:19], s44 offen offset:1536 nt
    ds_read_b128 v[104:107], v126 offset:14336
    s_waitcnt lgkmcnt(3)
    v_mfma_f32_16x16x32_bf16 v[72:75], v[108:111], v[40:43], v[72:75]
    v_add_u32 v125, 16384, v125
    v_mfma_f32_16x16x32_bf16 v[76:79], v[108:111], v[44:47], v[76:79]
    ds_read_b128 v[108:111], v126 offset:15360
    s_waitcnt lgkmcnt(3)
    v_mfma_f32_16x16x32_bf16 v[64:67], v[96:99], v[48:51], v[64:67]
    v_mfma_f32_16x16x32_bf16 v[68:71], v[96:99], v[52:55], v[68:71]
    s_waitcnt lgkmcnt(0)
    s_barrier
    ds_read_b128 v[96:99], v126 offset:16384
    v_mfma_f32_16x16x32_bf16 v[72:75], v[100:103], v[48:51], v[72:75]
    v_mfma_f32_16x16x32_bf16 v[76:79], v[100:103], v[52:55], v[76:79]
    ds_read_b128 v[100:103], v126 offset:17408
    v_mfma_f32_16x16x32_bf16 v[64:67], v[104:107], v[56:59], v[64:67]
    v_mfma_f32_16x16x32_bf16 v[68:71], v[104:107], v[60:63], v[68:71]
    ds_read_b128 v[104:107], v126 offset:18432
    v_mfma_f32_16x16x32_bf16 v[72:75], v[108:111], v[56:59], v[72:75]
    v_mfma_f32_16x16x32_bf16 v[76:79], v[108:111], v[60:63], v[76:79]
    ds_read_b128 v[108:111], v126 offset:19456
    s_waitcnt vmcnt(32)
    s_branch L_joint_kernel_oloop
L_joint_kernel_oend:
    s_nop 7
    v_cvt_pk_bf16_f32 v112, v80, v84
    buffer_store_dword v112, v125, s[16:19], 0 offen offset:0 nt
    v_cvt_pk_bf16_f32 v113, v81, v85
    buffer_store_dword v113, v125, s[16:19], 0 offen offset:512 nt
    v_cvt_pk_bf16_f32 v114, v82, v86
    buffer_store_dword v114, v125, s[16:19], 0 offen offset:1024 nt
    v_cvt_pk_bf16_f32 v115, v83, v87
    buffer_store_dword v115, v125, s[16:19], 0 offen offset:1536 nt
    v_cvt_pk_bf16_f32 v116, v88, v92
    buffer_store_dword v116, v125, s[16:19], s44 offen offset:0 nt
    v_cvt_pk_bf16_f32 v117, v89, v93
    buffer_store_dword v117, v125, s[16:19], s44 offen offset:512 nt
    v_cvt_pk_bf16_f32 v118, v90, v94
    buffer_store_dword v118, v125, s[16:19], s44 offen offset:1024 nt
    v_cvt_pk_bf16_f32 v119, v91, v95
    buffer_store_dword v119, v125, s[16:19], s44 offen offset:1536 nt
    v_add_u32 v125, 16384, v125
    s_branch L_joint_kernel_fin
L_joint_kernel_T:
    s_setprio 3
    s_lshl_b32 s36, s21, 2
    s_add_u32 s36, s36, 44335104
    s_add_u32 s36, s30, s36
    s_addc_u32 s37, s31, 0
    s_load_dword s44, s[36:37], 0
    v_and_b32 v123, 15, v127
    v_lshrrev_b32 v121, 4, v127
    v_mul_u32_u24 v125, 528, v123
    v_lshl_add_u32 v125, v121, 4, v125
    v_lshlrev_b32 v121, 5, v121
    v_and_b32 v120, 7, v127
    v_lshl_add_u32 v124, v120, 10, v121
    s_lshl_b32 s38, s21, 7
    v_mul_u32_u24 v120, 1040, v120
    s_add_u32 s36, s38, 91136
    v_add3_u32 v120, v120, v121, s36
    s_mul_i32 s36, s21, 5184
    s_add_u32 s36, s36, 49664
    v_add_u32 v121, s36, v121
    v_mul_u32_u24 v122, 144, v123
    v_add_u32 v122, v122, v121
    v_lshrrev_b32 v123, 3, v123
    v_mul_u32_u24 v123, 144, v123
    v_add_u32 v121, v123, v121
    s_lshl_b32 s36, s21, 11
    v_add_u32 v123, s36, v126
    s_barrier
    s_mov_b32 s36, 0
    buffer_load_dwordx4 v[0:3], v126, s[12:15], s36 offen offset:0
    buffer_load_dwordx4 v[4:7], v126, s[12:15], s36 offen offset:1024
    buffer_load_dwordx4 v[8:11], v126, s[12:15], s36 offen offset:2048
    buffer_load_dwordx4 v[12:15], v126, s[12:15], s36 offen offset:3072
    s_mov_b32 s36, 4096
    buffer_load_dwordx4 v[16:19], v126, s[12:15], s36 offen offset:0
    buffer_load_dwordx4 v[20:23], v126, s[12:15], s36 offen offset:1024
    buffer_load_dwordx4 v[24:27], v126, s[12:15], s36 offen offset:2048
    buffer_load_dwordx4 v[28:31], v126, s[12:15], s36 offen offset:3072
    s_mov_b32 s36, 8192
    buffer_load_dwordx4 v[32:35], v126, s[12:15], s36 offen offset:0
    buffer_load_dwordx4 v[36:39], v126, s[12:15], s36 offen offset:1024
    buffer_load_dwordx4 v[40:43], v126, s[12:15], s36 offen offset:2048
    buffer_load_dwordx4 v[44:47], v126, s[12:15], s36 offen offset:3072
    s_mov_b32 s36, 12288
    buffer_load_dwordx4 v[48:51], v126, s[12:15], s36 offen offset:0
    buffer_load_dwordx4 v[52:55], v126, s[12:15], s36 offen offset:1024
    buffer_load_dwordx4 v[56:59], v126, s[12:15], s36 offen offset:2048
    buffer_load_dwordx4 v[60:63], v126, s[12:15], s36 offen offset:3072
    v_mov_b32 v64, 99456
    v_mov_b32 v65, 1
    s_mov_b64 exec, 1
    ds_add_u32 v64, v65 offset:4
    s_mov_b64 exec, -1
L_joint_kernel_tw:
    ds_read_b32 v65, v64 offset:0
    s_waitcnt lgkmcnt(0)
    v_readfirstlane_b32 s37, v65
    s_cmp_ge_u32 s37, 8
    s_cbranch_scc1 L_joint_kernel_tw_d
    s_sleep 1
    s_branch L_joint_kernel_tw
L_joint_kernel_tw_d:
    ds_read_b128 v[80:83], v125 offset:32768
    ds_read_b128 v[84:87], v125 offset:41216
    ds_read_b128 v[88:91], v125 offset:32832
    ds_read_b128 v[92:95], v125 offset:41280
    ds_read_b128 v[96:99], v125 offset:32896
    ds_read_b128 v[100:103], v125 offset:41344
    ds_read_b128 v[104:107], v125 offset:32960
    ds_read_b128 v[108:111], v125 offset:41408
    s_setprio 0
    s_waitcnt vmcnt(14) lgkmcnt(7)
    v_mfma_f32_16x16x32_bf16 v[64:67], v[0:3], v[80:83], 0
    v_mfma_f32_16x16x32_bf16 v[68:71], v[4:7], v[80:83], 0
    ds_read_b128 v[80:83], v125 offset:33024
    s_waitcnt lgkmcnt(7)
    v_mfma_f32_16x16x32_bf16 v[72:75], v[0:3], v[84:87], 0
    v_mfma_f32_16x16x32_bf16 v[76:79], v[4:7], v[84:87], 0
    ds_read_b128 v[84:87], v125 offset:41472
    s_waitcnt vmcnt(12) lgkmcnt(7)
    v_mfma_f32_16x16x32_bf16 v[64:67], v[8:11], v[88:91], v[64:67]
    v_mfma_f32_16x16x32_bf16 v[68:71], v[12:15], v[88:91], v[68:71]
    ds_read_b128 v[88:91], v125 offset:33088
    s_waitcnt lgkmcnt(7)
    v_mfma_f32_16x16x32_bf16 v[72:75], v[8:11], v[92:95], v[72:75]
    v_mfma_f32_16x16x32_bf16 v[76:79], v[12:15], v[92:95], v[76:79]
    ds_read_b128 v[92:95], v125 offset:41536
    s_waitcnt vmcnt(10) lgkmcnt(7)
    v_mfma_f32_16x16x32_bf16 v[64:67], v[16:19], v[96:99], v[64:67]
    v_mfma_f32_16x16x32_bf16 v[68:71], v[20:23], v[96:99], v[68:71]
    ds_read_b128 v[96:99], v125 offset:33152
    s_waitcnt lgkmcnt(7)
    v_mfma_f32_16x16x32_bf16 v[72:75], v[16:19], v[100:103], v[72:75]
    v_mfma_f32_16x16x32_bf16 v[76:79], v[20:23], v[100:103], v[76:79]
    ds_read_b128 v[100:103], v125 offset:41600
    s_waitcnt vmcnt(8) lgkmcnt(7)
    v_mfma_f32_16x16x32_bf16 v[64:67], v[24:27], v[104:107], v[64:67]
    v_mfma_f32_16x16x32_bf16 v[68:71], v[28:31], v[104:107], v[68:71]
    ds_read_b128 v[104:107], v125 offset:33216
    s_waitcnt lgkmcnt(7)
    v_mfma_f32_16x16x32_bf16 v[72:75], v[24:27], v[108:111], v[72:75]
    v_mfma_f32_16x16x32_bf16 v[76:79], v[28:31], v[108:111], v[76:79]
    ds_read_b128 v[108:111], v125 offset:41664
    s_waitcnt vmcnt(6) lgkmcnt(7)
    v_mfma_f32_16x16x32_bf16 v[64:67], v[32:35], v[80:83], v[64:67]
    v_mfma_f32_16x16x32_bf16 v[68:71], v[36:39], v[80:83], v[68:71]
    ds_read_b128 v[112:115], v120 offset:0
    s_waitcnt lgkmcnt(7)
    v_mfma_f32_16x16x32_bf16 v[72:75], v[32:35], v[84:87], v[72:75]
    v_mfma_f32_16x16x32_bf16 v[76:79], v[36:39], v[84:87], v[76:79]
    ds_read_b128 v[116:119], v120 offset:16
    s_waitcnt vmcnt(4) lgkmcnt(7)
    v_mfma_f32_16x16x32_bf16 v[64:67], v[40:43], v[88:91], v[64:67]
    v_mfma_f32_16x16x32_bf16 v[68:71], v[44:47], v[88:91], v[68:71]
    s_waitcnt lgkmcnt(6)
    v_mfma_f32_16x16x32_bf16 v[72:75], v[40:43], v[92:95], v[72:75]
    v_mfma_f32_16x16x32_bf16 v[76:79], v[44:47], v[92:95], v[76:79]
    s_waitcnt vmcnt(2) lgkmcnt(5)
    v_mfma_f32_16x16x32_bf16 v[64:67], v[48:51], v[96:99], v[64:67]
    v_mfma_f32_16x16x32_bf16 v[68:71], v[52:55], v[96:99], v[68:71]
    s_waitcnt lgkmcnt(4)
    v_mfma_f32_16x16x32_bf16 v[72:75], v[48:51], v[100:103], v[72:75]
    v_mfma_f32_16x16x32_bf16 v[76:79], v[52:55], v[100:103], v[76:79]
    s_waitcnt vmcnt(0) lgkmcnt(3)
    v_mfma_f32_16x16x32_bf16 v[64:67], v[56:59], v[104:107], v[64:67]
    v_mfma_f32_16x16x32_bf16 v[68:71], v[60:63], v[104:107], v[68:71]
    s_waitcnt lgkmcnt(2)
    v_mfma_f32_16x16x32_bf16 v[72:75], v[56:59], v[108:111], v[72:75]
    v_mfma_f32_16x16x32_bf16 v[76:79], v[60:63], v[108:111], v[76:79]
    s_mov_b32 s46, 0xffff0000
    s_mov_b32 s48, 0x4038aa3b
    s_mov_b32 s49, s48
    s_nop 3
    v_mov_b32 v28, 0
    s_waitcnt lgkmcnt(0)
    v_cvt_pk_bf16_f32 v24, v64, v68
    v_cvt_pk_bf16_f32 v25, v65, v69
    v_cvt_pk_bf16_f32 v26, v66, v70
    v_cvt_pk_bf16_f32 v27, v67, v71
    v_lshlrev_b32 v80, 16, v24
    v_and_b32 v81, s46, v24
    v_lshlrev_b32 v82, 16, v25
    v_and_b32 v83, s46, v25
    v_lshlrev_b32 v84, 16, v26
    v_and_b32 v85, s46, v26
    v_lshlrev_b32 v86, 16, v27
    v_and_b32 v87, s46, v27
    v_pk_mul_f32 v[80:81], v[80:81], s[48:49]
    v_pk_mul_f32 v[82:83], v[82:83], s[48:49]
    v_pk_mul_f32 v[84:85], v[84:85], s[48:49]
    v_pk_mul_f32 v[86:87], v[86:87], s[48:49]
    v_exp_f32 v96, v80
    v_exp_f32 v97, v81
    v_exp_f32 v98, v82
    v_exp_f32 v99, v83
    v_max3_f32 v28, |v80|, |v81|, v28
    v_max3_f32 v28, |v82|, |v83|, v28
    ds_write_b128 v122, v[96:99] offset:0
    v_exp_f32 v100, v84
    v_exp_f32 v101, v85
    v_exp_f32 v102, v86
    v_exp_f32 v103, v87
    v_max3_f32 v28, |v84|, |v85|, v28
    v_max3_f32 v28, |v86|, |v87|, v28
    ds_write_b128 v122, v[100:103] offset:16
    v_cvt_pk_bf16_f32 v24, v72, v76
    v_cvt_pk_bf16_f32 v25, v73, v77
    v_cvt_pk_bf16_f32 v26, v74, v78
    v_cvt_pk_bf16_f32 v27, v75, v79
    v_lshlrev_b32 v88, 16, v24
    v_and_b32 v89, s46, v24
    v_lshlrev_b32 v90, 16, v25
    v_and_b32 v91, s46, v25
    v_lshlrev_b32 v92, 16, v26
    v_and_b32 v93, s46, v26
    v_lshlrev_b32 v94, 16, v27
    v_and_b32 v95, s46, v27
    v_pk_mul_f32 v[88:89], v[88:89], s[48:49]
    v_pk_mul_f32 v[90:91], v[90:91], s[48:49]
    v_pk_mul_f32 v[92:93], v[92:93], s[48:49]
    v_pk_mul_f32 v[94:95], v[94:95], s[48:49]
    v_exp_f32 v104, v88
    v_exp_f32 v105, v89
    v_exp_f32 v106, v90
    v_exp_f32 v107, v91
    v_max3_f32 v28, |v88|, |v89|, v28
    v_max3_f32 v28, |v90|, |v91|, v28
    ds_write_b128 v122, v[104:107] offset:2304
    v_exp_f32 v108, v92
    v_exp_f32 v109, v93
    v_exp_f32 v110, v94
    v_exp_f32 v111, v95
    v_max3_f32 v28, |v92|, |v93|, v28
    v_max3_f32 v28, |v94|, |v95|, v28
    ds_write_b128 v122, v[108:111] offset:2320
    v_cmp_lt_f32 vcc, 0x42f00000, v28
    s_mov_b32 s22, 4
    s_or_b32 s44, s44, vcc_lo
    s_or_b32 s44, s44, vcc_hi
    s_cmp_lg_u32 s44, 0
    s_cbranch_scc1 L_joint_kernel_tslow
    ds_read_b128 v[32:35], v121 offset:0
    ds_read_b128 v[36:39], v121 offset:16
    ds_read_b128 v[40:43], v121 offset:288
    ds_read_b128 v[44:47], v121 offset:304
    v_add_u32 v121, 576, v121
    s_waitcnt vmcnt(0) lgkmcnt(0)
L_joint_kernel_tloop1:
    v_fma_f32 v48, v112, v32, 1.0
    v_fma_f32 v49, v113, v33, 1.0
    v_fma_f32 v50, v114, v34, 1.0
    v_fma_f32 v51, v115, v35, 1.0
    v_fma_f32 v52, v116, v36, 1.0
    v_fma_f32 v53, v117, v37, 1.0
    v_fma_f32 v54, v118, v38, 1.0
    v_fma_f32 v55, v119, v39, 1.0
    v_fma_f32 v56, v112, v40, 1.0
    v_fma_f32 v57, v113, v41, 1.0
    v_fma_f32 v58, v114, v42, 1.0
    v_fma_f32 v59, v115, v43, 1.0
    v_fma_f32 v60, v116, v44, 1.0
    v_fma_f32 v61, v117, v45, 1.0
    v_fma_f32 v62, v118, v46, 1.0
    v_fma_f32 v63, v119, v47, 1.0
    ds_read_b128 v[32:35], v121 offset:0
    ds_read_b128 v[36:39], v121 offset:16
    ds_read_b128 v[40:43], v121 offset:288
    ds_read_b128 v[44:47], v121 offset:304
    v_add_u32 v121, 576, v121
    v_rcp_f32 v48, v48
    v_rcp_f32 v49, v49
    v_rcp_f32 v50, v50
    v_rcp_f32 v51, v51
    v_rcp_f32 v52, v52
    v_rcp_f32 v53, v53
    v_rcp_f32 v54, v54
    v_rcp_f32 v55, v55
    v_fma_f32 v48, v48, -2.0, 1.0
    v_fma_f32 v49, v49, -2.0, 1.0
    v_fma_f32 v50, v50, -2.0, 1.0
    v_fma_f32 v51, v51, -2.0, 1.0
    v_fma_f32 v52, v52, -2.0, 1.0
    v_fma_f32 v53, v53, -2.0, 1.0
    v_fma_f32 v54, v54, -2.0, 1.0
    v_fma_f32 v55, v55, -2.0, 1.0
    v_cvt_pk_bf16_f32 v64, v48, v49
    v_cvt_pk_bf16_f32 v65, v50, v51
    v_cvt_pk_bf16_f32 v66, v52, v53
    v_cvt_pk_bf16_f32 v67, v54, v55
    ds_write_b128 v123, v[64:67] offset:0
    v_rcp_f32 v56, v56
    v_rcp_f32 v57, v57
    v_rcp_f32 v58, v58
    v_rcp_f32 v59, v59
    v_rcp_f32 v60, v60
    v_rcp_f32 v61, v61
    v_rcp_f32 v62, v62
    v_rcp_f32 v63, v63
    v_fma_f32 v56, v56, -2.0, 1.0
    v_fma_f32 v57, v57, -2.0, 1.0
    v_fma_f32 v58, v58, -2.0, 1.0
    v_fma_f32 v59, v59, -2.0, 1.0
    v_fma_f32 v60, v60, -2.0, 1.0
    v_fma_f32 v61, v61, -2.0, 1.0
    v_fma_f32 v62, v62, -2.0, 1.0
    v_fma_f32 v63, v63, -2.0, 1.0
    v_cvt_pk_bf16_f32 v68, v56, v57
    v_cvt_pk_bf16_f32 v69, v58, v59
    v_cvt_pk_bf16_f32 v70, v60, v61
    v_cvt_pk_bf16_f32 v71, v62, v63
    ds_write_b128 v123, v[68:71] offset:1024
    s_waitcnt lgkmcnt(0)
    s_barrier
    v_fma_f32 v48, v112, v32, 1.0
    v_fma_f32 v49, v113, v33, 1.0
    v_fma_f32 v50, v114, v34, 1.0
    v_fma_f32 v51, v115, v35, 1.0
    v_fma_f32 v52, v116, v36, 1.0
    v_fma_f32 v53, v117, v37, 1.0
    v_fma_f32 v54, v118, v38, 1.0
    v_fma_f32 v55, v119, v39, 1.0
    v_fma_f32 v56, v112, v40, 1.0
    v_fma_f32 v57, v113, v41, 1.0
    v_fma_f32 v58, v114, v42, 1.0
    v_fma_f32 v59, v115, v43, 1.0
    v_fma_f32 v60, v116, v44, 1.0
    v_fma_f32 v61, v117, v45, 1.0
    v_fma_f32 v62, v118, v46, 1.0
    v_fma_f32 v63, v119, v47, 1.0
    ds_read_b128 v[32:35], v121 offset:0
    ds_read_b128 v[36:39], v121 offset:16
    ds_read_b128 v[40:43], v121 offset:288
    ds_read_b128 v[44:47], v121 offset:304
    v_add_u32 v121, 576, v121
    v_rcp_f32 v48, v48
    v_rcp_f32 v49, v49
    v_rcp_f32 v50, v50
    v_rcp_f32 v51, v51
    v_rcp_f32 v52, v52
    v_rcp_f32 v53, v53
    v_rcp_f32 v54, v54
    v_rcp_f32 v55, v55
    v_fma_f32 v48, v48, -2.0, 1.0
    v_fma_f32 v49, v49, -2.0, 1.0
    v_fma_f32 v50, v50, -2.0, 1.0
    v_fma_f32 v51, v51, -2.0, 1.0
    v_fma_f32 v52, v52, -2.0, 1.0
    v_fma_f32 v53, v53, -2.0, 1.0
    v_fma_f32 v54, v54, -2.0, 1.0
    v_fma_f32 v55, v55, -2.0, 1.0
    v_cvt_pk_bf16_f32 v64, v48, v49
    v_cvt_pk_bf16_f32 v65, v50, v51
    v_cvt_pk_bf16_f32 v66, v52, v53
    v_cvt_pk_bf16_f32 v67, v54, v55
    ds_write_b128 v123, v[64:67] offset:16384
    v_rcp_f32 v56, v56
    v_rcp_f32 v57, v57
    v_rcp_f32 v58, v58
    v_rcp_f32 v59, v59
    v_rcp_f32 v60, v60
    v_rcp_f32 v61, v61
    v_rcp_f32 v62, v62
    v_rcp_f32 v63, v63
    v_fma_f32 v56, v56, -2.0, 1.0
    v_fma_f32 v57, v57, -2.0, 1.0
    v_fma_f32 v58, v58, -2.0, 1.0
    v_fma_f32 v59, v59, -2.0, 1.0
    v_fma_f32 v60, v60, -2.0, 1.0
    v_fma_f32 v61, v61, -2.0, 1.0
    v_fma_f32 v62, v62, -2.0, 1.0
    v_fma_f32 v63, v63, -2.0, 1.0
    v_cvt_pk_bf16_f32 v68, v56, v57
    v_cvt_pk_bf16_f32 v69, v58, v59
    v_cvt_pk_bf16_f32 v70, v60, v61
    v_cvt_pk_bf16_f32 v71, v62, v63
    ds_write_b128 v123, v[68:71] offset:17408
    s_waitcnt lgkmcnt(0)
    s_barrier
    s_sub_u32 s22, s22, 1
    s_cmp_lg_u32 s22, 0
    s_cbranch_scc1 L_joint_kernel_tloop1
    s_branch L_joint_kernel_fin
L_joint_kernel_tslow:
    buffer_load_dwordx4 v[112:115], v124, s[40:43], s38 offen offset:0
    buffer_load_dwordx4 v[116:119], v124, s[40:43], s38 offen offset:16
    ds_write_b128 v122, v[80:83] offset:0
    ds_write_b128 v122, v[84:87] offset:16
    ds_write_b128 v122, v[88:91] offset:2304
    ds_write_b128 v122, v[92:95] offset:2320
    ds_read_b128 v[32:35], v121 offset:0
    ds_read_b128 v[36:39], v121 offset:16
    ds_read_b128 v[40:43], v121 offset:288
    ds_read_b128 v[44:47], v121 offset:304
    v_add_u32 v121, 576, v121
    s_waitcnt vmcnt(0) lgkmcnt(0)
L_joint_kernel_tloop0:
    v_add_f32 v48, v112, v32
    v_add_f32 v49, v113, v33
    v_add_f32 v50, v114, v34
    v_add_f32 v51, v115, v35
    v_add_f32 v52, v116, v36
    v_add_f32 v53, v117, v37
    v_add_f32 v54, v118, v38
    v_add_f32 v55, v119, v39
    v_add_f32 v56, v112, v40
    v_add_f32 v57, v113, v41
    v_add_f32 v58, v114, v42
    v_add_f32 v59, v115, v43
    v_add_f32 v60, v116, v44
    v_add_f32 v61, v117, v45
    v_add_f32 v62, v118, v46
    v_add_f32 v63, v119, v47
    ds_read_b128 v[32:35], v121 offset:0
    ds_read_b128 v[36:39], v121 offset:16
    ds_read_b128 v[40:43], v121 offset:288
    ds_read_b128 v[44:47], v121 offset:304
    v_add_u32 v121, 576, v121
    v_exp_f32 v48, v48
    v_exp_f32 v49, v49
    v_exp_f32 v50, v50
    v_exp_f32 v51, v51
    v_exp_f32 v52, v52
    v_exp_f32 v53, v53
    v_exp_f32 v54, v54
    v_exp_f32 v55, v55
    v_add_f32 v48, 1.0, v48
    v_add_f32 v49, 1.0, v49
    v_add_f32 v50, 1.0, v50
    v_add_f32 v51, 1.0, v51
    v_add_f32 v52, 1.0, v52
    v_add_f32 v53, 1.0, v53
    v_add_f32 v54, 1.0, v54
    v_add_f32 v55, 1.0, v55
    v_rcp_f32 v48, v48
    v_rcp_f32 v49, v49
    v_rcp_f32 v50, v50
    v_rcp_f32 v51, v51
    v_rcp_f32 v52, v52
    v_rcp_f32 v53, v53
    v_rcp_f32 v54, v54
    v_rcp_f32 v55, v55
    v_fma_f32 v48, v48, -2.0, 1.0
    v_fma_f32 v49, v49, -2.0, 1.0
    v_fma_f32 v50, v50, -2.0, 1.0
    v_fma_f32 v51, v51, -2.0, 1.0
    v_fma_f32 v52, v52, -2.0, 1.0
    v_fma_f32 v53, v53, -2.0, 1.0
    v_fma_f32 v54, v54, -2.0, 1.0
    v_fma_f32 v55, v55, -2.0, 1.0
    v_cvt_pk_bf16_f32 v64, v48, v49
    v_cvt_pk_bf16_f32 v65, v50, v51
    v_cvt_pk_bf16_f32 v66, v52, v53
    v_cvt_pk_bf16_f32 v67, v54, v55
    ds_write_b128 v123, v[64:67] offset:0
    v_exp_f32 v56, v56
    v_exp_f32 v57, v57
    v_exp_f32 v58, v58
    v_exp_f32 v59, v59
    v_exp_f32 v60, v60
    v_exp_f32 v61, v61
    v_exp_f32 v62, v62
    v_exp_f32 v63, v63
    v_add_f32 v56, 1.0, v56
    v_add_f32 v57, 1.0, v57
    v_add_f32 v58, 1.0, v58
    v_add_f32 v59, 1.0, v59
    v_add_f32 v60, 1.0, v60
    v_add_f32 v61, 1.0, v61
    v_add_f32 v62, 1.0, v62
    v_add_f32 v63, 1.0, v63
    v_rcp_f32 v56, v56
    v_rcp_f32 v57, v57
    v_rcp_f32 v58, v58
    v_rcp_f32 v59, v59
    v_rcp_f32 v60, v60
    v_rcp_f32 v61, v61
    v_rcp_f32 v62, v62
    v_rcp_f32 v63, v63
    v_fma_f32 v56, v56, -2.0, 1.0
    v_fma_f32 v57, v57, -2.0, 1.0
    v_fma_f32 v58, v58, -2.0, 1.0
    v_fma_f32 v59, v59, -2.0, 1.0
    v_fma_f32 v60, v60, -2.0, 1.0
    v_fma_f32 v61, v61, -2.0, 1.0
    v_fma_f32 v62, v62, -2.0, 1.0
    v_fma_f32 v63, v63, -2.0, 1.0
    v_cvt_pk_bf16_f32 v68, v56, v57
    v_cvt_pk_bf16_f32 v69, v58, v59
    v_cvt_pk_bf16_f32 v70, v60, v61
    v_cvt_pk_bf16_f32 v71, v62, v63
    ds_write_b128 v123, v[68:71] offset:1024
    s_waitcnt lgkmcnt(0)
    s_barrier
    v_add_f32 v48, v112, v32
    v_add_f32 v49, v113, v33
    v_add_f32 v50, v114, v34
    v_add_f32 v51, v115, v35
    v_add_f32 v52, v116, v36
    v_add_f32 v53, v117, v37
    v_add_f32 v54, v118, v38
    v_add_f32 v55, v119, v39
    v_add_f32 v56, v112, v40
    v_add_f32 v57, v113, v41
    v_add_f32 v58, v114, v42
    v_add_f32 v59, v115, v43
    v_add_f32 v60, v116, v44
    v_add_f32 v61, v117, v45
    v_add_f32 v62, v118, v46
    v_add_f32 v63, v119, v47
    ds_read_b128 v[32:35], v121 offset:0
    ds_read_b128 v[36:39], v121 offset:16
    ds_read_b128 v[40:43], v121 offset:288
    ds_read_b128 v[44:47], v121 offset:304
    v_add_u32 v121, 576, v121
    v_exp_f32 v48, v48
    v_exp_f32 v49, v49
    v_exp_f32 v50, v50
    v_exp_f32 v51, v51
    v_exp_f32 v52, v52
    v_exp_f32 v53, v53
    v_exp_f32 v54, v54
    v_exp_f32 v55, v55
    v_add_f32 v48, 1.0, v48
    v_add_f32 v49, 1.0, v49
    v_add_f32 v50, 1.0, v50
    v_add_f32 v51, 1.0, v51
    v_add_f32 v52, 1.0, v52
    v_add_f32 v53, 1.0, v53
    v_add_f32 v54, 1.0, v54
    v_add_f32 v55, 1.0, v55
    v_rcp_f32 v48, v48
    v_rcp_f32 v49, v49
    v_rcp_f32 v50, v50
    v_rcp_f32 v51, v51
    v_rcp_f32 v52, v52
    v_rcp_f32 v53, v53
    v_rcp_f32 v54, v54
    v_rcp_f32 v55, v55
    v_fma_f32 v48, v48, -2.0, 1.0
    v_fma_f32 v49, v49, -2.0, 1.0
    v_fma_f32 v50, v50, -2.0, 1.0
    v_fma_f32 v51, v51, -2.0, 1.0
    v_fma_f32 v52, v52, -2.0, 1.0
    v_fma_f32 v53, v53, -2.0, 1.0
    v_fma_f32 v54, v54, -2.0, 1.0
    v_fma_f32 v55, v55, -2.0, 1.0
    v_cvt_pk_bf16_f32 v64, v48, v49
    v_cvt_pk_bf16_f32 v65, v50, v51
    v_cvt_pk_bf16_f32 v66, v52, v53
    v_cvt_pk_bf16_f32 v67, v54, v55
    ds_write_b128 v123, v[64:67] offset:16384
    v_exp_f32 v56, v56
    v_exp_f32 v57, v57
    v_exp_f32 v58, v58
    v_exp_f32 v59, v59
    v_exp_f32 v60, v60
    v_exp_f32 v61, v61
    v_exp_f32 v62, v62
    v_exp_f32 v63, v63
    v_add_f32 v56, 1.0, v56
    v_add_f32 v57, 1.0, v57
    v_add_f32 v58, 1.0, v58
    v_add_f32 v59, 1.0, v59
    v_add_f32 v60, 1.0, v60
    v_add_f32 v61, 1.0, v61
    v_add_f32 v62, 1.0, v62
    v_add_f32 v63, 1.0, v63
    v_rcp_f32 v56, v56
    v_rcp_f32 v57, v57
    v_rcp_f32 v58, v58
    v_rcp_f32 v59, v59
    v_rcp_f32 v60, v60
    v_rcp_f32 v61, v61
    v_rcp_f32 v62, v62
    v_rcp_f32 v63, v63
    v_fma_f32 v56, v56, -2.0, 1.0
    v_fma_f32 v57, v57, -2.0, 1.0
    v_fma_f32 v58, v58, -2.0, 1.0
    v_fma_f32 v59, v59, -2.0, 1.0
    v_fma_f32 v60, v60, -2.0, 1.0
    v_fma_f32 v61, v61, -2.0, 1.0
    v_fma_f32 v62, v62, -2.0, 1.0
    v_fma_f32 v63, v63, -2.0, 1.0
    v_cvt_pk_bf16_f32 v68, v56, v57
    v_cvt_pk_bf16_f32 v69, v58, v59
    v_cvt_pk_bf16_f32 v70, v60, v61
    v_cvt_pk_bf16_f32 v71, v62, v63
    ds_write_b128 v123, v[68:71] offset:17408
    s_waitcnt lgkmcnt(0)
    s_barrier
    s_sub_u32 s22, s22, 1
    s_cmp_lg_u32 s22, 0
    s_cbranch_scc1 L_joint_kernel_tloop0
L_joint_kernel_fin:
L_joint_kernel_done:
    s_endpgm
.section .rodata,"a"
.p2align 6
.amdhsa_kernel prep_kernel
  .amdhsa_next_free_vgpr 128
  .amdhsa_next_free_sgpr 102
  .amdhsa_accum_offset 128
  .amdhsa_group_segment_fixed_size 0
  .amdhsa_kernarg_size 80
  .amdhsa_user_sgpr_count 2
  .amdhsa_user_sgpr_kernarg_segment_ptr 1
  .amdhsa_system_sgpr_workgroup_id_x 1
.end_amdhsa_kernel
.p2align 6
.amdhsa_kernel conv1_kernel
  .amdhsa_next_free_vgpr 128
  .amdhsa_next_free_sgpr 102
  .amdhsa_accum_offset 128
  .amdhsa_group_segment_fixed_size 0
  .amdhsa_kernarg_size 80
  .amdhsa_user_sgpr_count 2
  .amdhsa_user_sgpr_kernarg_segment_ptr 1
  .amdhsa_system_sgpr_workgroup_id_x 1
.end_amdhsa_kernel
.p2align 6
.amdhsa_kernel conv2_kernel
  .amdhsa_next_free_vgpr 128
  .amdhsa_next_free_sgpr 102
  .amdhsa_accum_offset 128
  .amdhsa_group_segment_fixed_size 0
  .amdhsa_kernarg_size 80
  .amdhsa_user_sgpr_count 2
  .amdhsa_user_sgpr_kernarg_segment_ptr 1
  .amdhsa_system_sgpr_workgroup_id_x 1
.end_amdhsa_kernel
.p2align 6
.amdhsa_kernel joint_kernel
  .amdhsa_next_free_vgpr 128
  .amdhsa_next_free_sgpr 102
  .amdhsa_accum_offset 128
  .amdhsa_group_segment_fixed_size 0
  .amdhsa_kernarg_size 80
  .amdhsa_user_sgpr_count 2
  .amdhsa_user_sgpr_kernarg_segment_ptr 1
  .amdhsa_system_sgpr_workgroup_id_x 1
.end_amdhsa_kernel
```

```asm
; @launch kernel=prep_kernel grid=(268,1,1) block=(256,1,1) lds=4096
; @launch kernel=conv1_kernel grid=(256,1,1) block=(1024,1,1) lds=162816
; @launch kernel=conv2_kernel grid=(256,1,1) block=(1024,1,1) lds=162816
; @launch kernel=joint_kernel grid=(250,1,1) block=(1024,1,1) lds=99472
.amdgcn_target "amdgcn-amd-amdhsa--gfx950"
.text
.globl prep_kernel
.p2align 8
.type prep_kernel,@function
prep_kernel:
    s_cmp_ge_u32 s2, 268
    s_cbranch_scc1 L_prep_kernel_done
    s_mov_b32 s3, s2
    s_load_dwordx16 s[44:59], s[0:1], 0
    s_sub_u32 s2, s2, 12
    v_readfirstlane_b32 s40, v0
    s_lshr_b32 s40, s40, 6
    s_lshl_b32 s21, s2, 2
    s_add_u32 s20, s40, s21
    v_and_b32 v1, 63, v0
    s_load_dwordx2 s[8:9], s[0:1], 8
    s_load_dwordx2 s[30:31], s[0:1], 72
    s_lshr_b32 s22, s20, 8
    s_bfe_u32 s23, s20, 0x40004
    s_bfe_u32 s24, s20, 0x30001
    s_and_b32 s21, s20, 1
    v_lshrrev_b32 v2, 4, v1
    v_lshlrev_b32 v2, 12, v2
    v_and_b32 v3, 15, v1
    v_lshl_add_u32 v2, v3, 2, v2
    s_lshl_b32 s26, s22, 3
    s_lshr_b32 s27, s23, 3
    s_add_u32 s26, s26, s27
    s_lshl_b32 s26, s26, 17
    s_and_b32 s27, s23, 7
    s_lshl_b32 s27, s27, 14
    s_add_u32 s26, s26, s27
    s_lshl_b32 s27, s24, 6
    s_add_u32 s26, s26, s27
    s_mov_b32 s10, 4063232
    s_mov_b32 s11, 0x00020000
    s_lshr_b32 s41, s3, 2
    s_and_b32 s42, s3, 3
    s_lshl_b32 s42, s42, 1
    s_and_b32 s43, s40, 1
    s_add_u32 s42, s42, s43
    s_lshr_b32 s43, s40, 1
    s_lshl_b32 s4, s43, 16
    s_lshl_b32 s5, s42, 6
    s_add_u32 s4, s4, s5
    s_cmp_lt_u32 s3, 12
    s_cselect_b32 s26, s4, s26
    s_cselect_b32 s10, 131072, s10
    s_mov_b32 s5, 262144
    s_cselect_b32 s5, 16384, s5
    s_add_u32 s37, s26, s5
    s_add_u32 s38, s37, s5
    s_add_u32 s39, s38, s5
    s_waitcnt lgkmcnt(0)
    s_cmp_eq_u32 s41, 0
    s_cselect_b32 s8, s52, s8
    s_cselect_b32 s9, s53, s9
    s_cmp_eq_u32 s41, 1
    s_cselect_b32 s8, s56, s8
    s_cselect_b32 s9, s57, s9
    s_cmp_eq_u32 s41, 2
    s_cselect_b32 s8, s54, s8
    s_cselect_b32 s9, s55, s9
    buffer_load_dword v16, v2, s[8:11], s26 offen offset:0
    buffer_load_dword v17, v2, s[8:11], s26 offen offset:512
    buffer_load_dword v24, v2, s[8:11], s37 offen offset:0
    buffer_load_dword v25, v2, s[8:11], s37 offen offset:512
    buffer_load_dword v32, v2, s[8:11], s38 offen offset:0
    buffer_load_dword v33, v2, s[8:11], s38 offen offset:512
    buffer_load_dword v40, v2, s[8:11], s39 offen offset:0
    buffer_load_dword v41, v2, s[8:11], s39 offen offset:512
    buffer_load_dword v18, v2, s[8:11], s26 offen offset:1024
    buffer_load_dword v19, v2, s[8:11], s26 offen offset:1536
    buffer_load_dword v26, v2, s[8:11], s37 offen offset:1024
    buffer_load_dword v27, v2, s[8:11], s37 offen offset:1536
    buffer_load_dword v34, v2, s[8:11], s38 offen offset:1024
    buffer_load_dword v35, v2, s[8:11], s38 offen offset:1536
    buffer_load_dword v42, v2, s[8:11], s39 offen offset:1024
    buffer_load_dword v43, v2, s[8:11], s39 offen offset:1536
    buffer_load_dword v20, v2, s[8:11], s26 offen offset:2048
    buffer_load_dword v21, v2, s[8:11], s26 offen offset:2560
    buffer_load_dword v28, v2, s[8:11], s37 offen offset:2048
    buffer_load_dword v29, v2, s[8:11], s37 offen offset:2560
    buffer_load_dword v36, v2, s[8:11], s38 offen offset:2048
    buffer_load_dword v37, v2, s[8:11], s38 offen offset:2560
    buffer_load_dword v44, v2, s[8:11], s39 offen offset:2048
    buffer_load_dword v45, v2, s[8:11], s39 offen offset:2560
    buffer_load_dword v22, v2, s[8:11], s26 offen offset:3072
    buffer_load_dword v23, v2, s[8:11], s26 offen offset:3584
    buffer_load_dword v30, v2, s[8:11], s37 offen offset:3072
    buffer_load_dword v31, v2, s[8:11], s37 offen offset:3584
    buffer_load_dword v38, v2, s[8:11], s38 offen offset:3072
    buffer_load_dword v39, v2, s[8:11], s38 offen offset:3584
    buffer_load_dword v46, v2, s[8:11], s39 offen offset:3072
    buffer_load_dword v47, v2, s[8:11], s39 offen offset:3584
    s_cmp_lt_u32 s3, 12
    s_cbranch_scc1 L_prep_kernel_small
    s_add_u32 s12, s30, 0
    s_addc_u32 s13, s31, 0
    s_mov_b32 s14, 7340032
    s_mov_b32 s15, 0x00020000
    v_lshlrev_b32 v4, 4, v1
    s_lshl_b32 s27, s24, 4
    s_add_u32 s27, s27, s23
    s_mul_i32 s27, s27, 57344
    s_lshl_b32 s28, s22, 11
    s_add_u32 s27, s27, s28
    s_lshl_b32 s28, s21, 10
    s_add_u32 s27, s27, s28
    s_cmp_eq_u32 s21, 0
    s_mov_b32 s32, 0x07060302
    s_cselect_b32 s32, 0x05040100, s32
    s_mov_b32 s33, 0x03020c0c
    s_cselect_b32 s33, 0x01000c0c, s33
    s_mov_b32 s35, 0x3d2aaaab
    s_mov_b32 s36, 0x3c638e39
    s_waitcnt vmcnt(24)
    v_perm_b32 v72, v17, v16, s32
    v_perm_b32 v48, v41, v40, s32
    v_perm_b32 v76, v76, v40, s33
    v_perm_b32 v84, v84, v41, s33
    v_perm_b32 v77, v77, v32, s33
    v_perm_b32 v85, v85, v33, s33
    v_perm_b32 v78, v78, v24, s33
    v_perm_b32 v86, v86, v25, s33
    v_perm_b32 v79, v79, v16, s33
    v_perm_b32 v87, v87, v17, s33
    v_add_f32 v80, v76, v78
    v_add_f32 v88, v84, v86
    v_add_f32 v81, v77, v79
    v_add_f32 v89, v85, v87
    v_fma_f32 v82, v78, 4.0, v76
    v_fma_f32 v90, v86, 4.0, v84
    v_fma_f32 v83, v79, 4.0, v77
    v_fma_f32 v91, v87, 4.0, v85
    v_add_f32 v77, v80, v81
    v_add_f32 v85, v88, v89
    v_sub_f32 v78, v80, v81
    v_sub_f32 v86, v88, v89
    v_fma_f32 v79, v83, 2.0, v82
    v_fma_f32 v87, v91, 2.0, v90
    v_fma_f32 v82, v83, -2.0, v82
    v_fma_f32 v90, v91, -2.0, v90
    v_fmamk_f32 v80, v76, 0x41700000, v82
    v_fmamk_f32 v88, v84, 0x41700000, v90
    v_fmamk_f32 v80, v81, 0x41200000, v80
    v_fmamk_f32 v88, v89, 0x41200000, v88
    v_mul_f32 v77, 0.5, v77
    v_mul_f32 v85, 0.5, v85
    v_mul_f32 v78, 0.5, v78
    v_mul_f32 v86, 0.5, v86
    v_mul_f32 v79, s35, v79
    v_mul_f32 v87, s35, v87
    v_mul_f32 v82, s35, v82
    v_mul_f32 v90, s35, v90
    v_mul_f32 v80, s36, v80
    v_mul_f32 v88, s36, v88
    v_cvt_pk_bf16_f32 v52, v77, v85
    v_cvt_pk_bf16_f32 v56, v78, v86
    v_cvt_pk_bf16_f32 v60, v79, v87
    v_cvt_pk_bf16_f32 v64, v82, v90
    v_cvt_pk_bf16_f32 v68, v80, v88
    s_waitcnt vmcnt(16)
    v_perm_b32 v73, v19, v18, s32
    v_perm_b32 v49, v43, v42, s32
    v_perm_b32 v76, v76, v42, s33
    v_perm_b32 v84, v84, v43, s33
    v_perm_b32 v77, v77, v34, s33
    v_perm_b32 v85, v85, v35, s33
    v_perm_b32 v78, v78, v26, s33
    v_perm_b32 v86, v86, v27, s33
    v_perm_b32 v79, v79, v18, s33
    v_perm_b32 v87, v87, v19, s33
    v_add_f32 v80, v76, v78
    v_add_f32 v88, v84, v86
    v_add_f32 v81, v77, v79
    v_add_f32 v89, v85, v87
    v_fma_f32 v82, v78, 4.0, v76
    v_fma_f32 v90, v86, 4.0, v84
    v_fma_f32 v83, v79, 4.0, v77
    v_fma_f32 v91, v87, 4.0, v85
    v_add_f32 v77, v80, v81
    v_add_f32 v85, v88, v89
    v_sub_f32 v78, v80, v81
    v_sub_f32 v86, v88, v89
    v_fma_f32 v79, v83, 2.0, v82
    v_fma_f32 v87, v91, 2.0, v90
    v_fma_f32 v82, v83, -2.0, v82
    v_fma_f32 v90, v91, -2.0, v90
    v_fmamk_f32 v80, v76, 0x41700000, v82
    v_fmamk_f32 v88, v84, 0x41700000, v90
    v_fmamk_f32 v80, v81, 0x41200000, v80
    v_fmamk_f32 v88, v89, 0x41200000, v88
    v_mul_f32 v77, 0.5, v77
    v_mul_f32 v85, 0.5, v85
    v_mul_f32 v78, 0.5, v78
    v_mul_f32 v86, 0.5, v86
    v_mul_f32 v79, s35, v79
    v_mul_f32 v87, s35, v87
    v_mul_f32 v82, s35, v82
    v_mul_f32 v90, s35, v90
    v_mul_f32 v80, s36, v80
    v_mul_f32 v88, s36, v88
    v_cvt_pk_bf16_f32 v53, v77, v85
    v_cvt_pk_bf16_f32 v57, v78, v86
    v_cvt_pk_bf16_f32 v61, v79, v87
    v_cvt_pk_bf16_f32 v65, v82, v90
    v_cvt_pk_bf16_f32 v69, v80, v88
    s_waitcnt vmcnt(8)
    v_perm_b32 v74, v21, v20, s32
    v_perm_b32 v50, v45, v44, s32
    v_perm_b32 v76, v76, v44, s33
    v_perm_b32 v84, v84, v45, s33
    v_perm_b32 v77, v77, v36, s33
    v_perm_b32 v85, v85, v37, s33
    v_perm_b32 v78, v78, v28, s33
    v_perm_b32 v86, v86, v29, s33
    v_perm_b32 v79, v79, v20, s33
    v_perm_b32 v87, v87, v21, s33
    v_add_f32 v80, v76, v78
    v_add_f32 v88, v84, v86
    v_add_f32 v81, v77, v79
    v_add_f32 v89, v85, v87
    v_fma_f32 v82, v78, 4.0, v76
    v_fma_f32 v90, v86, 4.0, v84
    v_fma_f32 v83, v79, 4.0, v77
    v_fma_f32 v91, v87, 4.0, v85
    v_add_f32 v77, v80, v81
    v_add_f32 v85, v88, v89
    v_sub_f32 v78, v80, v81
    v_sub_f32 v86, v88, v89
    v_fma_f32 v79, v83, 2.0, v82
    v_fma_f32 v87, v91, 2.0, v90
    v_fma_f32 v82, v83, -2.0, v82
    v_fma_f32 v90, v91, -2.0, v90
    v_fmamk_f32 v80, v76, 0x41700000, v82
    v_fmamk_f32 v88, v84, 0x41700000, v90
    v_fmamk_f32 v80, v81, 0x41200000, v80
    v_fmamk_f32 v88, v89, 0x41200000, v88
    v_mul_f32 v77, 0.5, v77
    v_mul_f32 v85, 0.5, v85
    v_mul_f32 v78, 0.5, v78
    v_mul_f32 v86, 0.5, v86
    v_mul_f32 v79, s35, v79
    v_mul_f32 v87, s35, v87
    v_mul_f32 v82, s35, v82
    v_mul_f32 v90, s35, v90
    v_mul_f32 v80, s36, v80
    v_mul_f32 v88, s36, v88
    v_cvt_pk_bf16_f32 v54, v77, v85
    v_cvt_pk_bf16_f32 v58, v78, v86
    v_cvt_pk_bf16_f32 v62, v79, v87
    v_cvt_pk_bf16_f32 v66, v82, v90
    v_cvt_pk_bf16_f32 v70, v80, v88
    s_waitcnt vmcnt(0)
    s_cmp_ge_u32 s3, 44
    s_cbranch_scc1 L_prep_kernel_ncw
    s_getpc_b64 s[62:63]
L_prep_kernel_pc:
    s_and_b32 s64, s3, 8
    s_lshl_b32 s64, s64, 12
    v_lshlrev_b32 v120, 7, v0
    v_add_u32 v120, s64, v120
    v_min_u32 v120, L_joint_kernel_done-L_prep_kernel_pc, v120
    v_mov_b32 v121, s63
    v_add_co_u32 v120, vcc, s62, v120
    s_nop 1
    v_addc_co_u32 v121, vcc, 0, v121, vcc
    global_load_dword v122, v[120:121], off
L_prep_kernel_ncw:
    v_perm_b32 v75, v23, v22, s32
    v_perm_b32 v51, v47, v46, s32
    v_perm_b32 v76, v76, v46, s33
    v_perm_b32 v84, v84, v47, s33
    v_perm_b32 v77, v77, v38, s33
    v_perm_b32 v85, v85, v39, s33
    v_perm_b32 v78, v78, v30, s33
    v_perm_b32 v86, v86, v31, s33
    v_perm_b32 v79, v79, v22, s33
    v_perm_b32 v87, v87, v23, s33
    v_add_f32 v80, v76, v78
    v_add_f32 v88, v84, v86
    v_add_f32 v81, v77, v79
    v_add_f32 v89, v85, v87
    v_fma_f32 v82, v78, 4.0, v76
    v_fma_f32 v90, v86, 4.0, v84
    v_fma_f32 v83, v79, 4.0, v77
    v_fma_f32 v91, v87, 4.0, v85
    v_add_f32 v77, v80, v81
    v_add_f32 v85, v88, v89
    v_sub_f32 v78, v80, v81
    v_sub_f32 v86, v88, v89
    v_fma_f32 v79, v83, 2.0, v82
    v_fma_f32 v87, v91, 2.0, v90
    v_fma_f32 v82, v83, -2.0, v82
    v_fma_f32 v90, v91, -2.0, v90
    v_fmamk_f32 v80, v76, 0x41700000, v82
    v_fmamk_f32 v88, v84, 0x41700000, v90
    v_fmamk_f32 v80, v81, 0x41200000, v80
    v_fmamk_f32 v88, v89, 0x41200000, v88
    v_mul_f32 v77, 0.5, v77
    v_mul_f32 v85, 0.5, v85
    v_mul_f32 v78, 0.5, v78
    v_mul_f32 v86, 0.5, v86
    v_mul_f32 v79, s35, v79
    v_mul_f32 v87, s35, v87
    v_mul_f32 v82, s35, v82
    v_mul_f32 v90, s35, v90
    v_mul_f32 v80, s36, v80
    v_mul_f32 v88, s36, v88
    v_cvt_pk_bf16_f32 v55, v77, v85
    v_cvt_pk_bf16_f32 v59, v78, v86
    v_cvt_pk_bf16_f32 v63, v79, v87
    v_cvt_pk_bf16_f32 v67, v82, v90
    v_cvt_pk_bf16_f32 v71, v80, v88
    s_add_u32 s28, s27, 49152
    buffer_store_dwordx4 v[72:75], v4, s[12:15], s28 offen sc1
    s_add_u32 s28, s27, 0
    buffer_store_dwordx4 v[48:51], v4, s[12:15], s28 offen sc1
    s_add_u32 s28, s27, 8192
    buffer_store_dwordx4 v[52:55], v4, s[12:15], s28 offen sc1
    s_add_u32 s28, s27, 16384
    buffer_store_dwordx4 v[56:59], v4, s[12:15], s28 offen sc1
    s_add_u32 s28, s27, 24576
    buffer_store_dwordx4 v[60:63], v4, s[12:15], s28 offen sc1
    s_add_u32 s28, s27, 32768
    buffer_store_dwordx4 v[64:67], v4, s[12:15], s28 offen sc1
    s_add_u32 s28, s27, 40960
    buffer_store_dwordx4 v[68:71], v4, s[12:15], s28 offen sc1
L_prep_kernel_done:
    s_endpgm
L_prep_kernel_small:
    s_mov_b32 s16, s50
    s_mov_b32 s17, s51
    s_mov_b32 s18, 8192
    s_mov_b32 s19, 0x00020000
    v_lshrrev_b32 v2, 4, v1
    v_lshlrev_b32 v6, 9, v3
    v_lshl_add_u32 v6, v2, 4, v6
    s_lshl_b32 s24, s43, 8
    s_cmp_eq_u32 s41, 2
    s_cselect_b32 s24, s24, 0x100000
    buffer_load_dwordx4 v[80:83], v6, s[16:19], s24 offen offset:0
    buffer_load_dwordx4 v[84:87], v6, s[16:19], s24 offen offset:64
    buffer_load_dwordx4 v[88:91], v6, s[16:19], s24 offen offset:128
    buffer_load_dwordx4 v[92:95], v6, s[16:19], s24 offen offset:192
    s_lshl_b32 s24, s41, 17
    s_add_u32 s24, s24, 44040192
    s_add_u32 s12, s30, s24
    s_addc_u32 s13, s31, 0
    s_mov_b32 s14, 131072
    s_mov_b32 s15, 0x00020000
    s_mov_b32 s32, 0x05040100
    s_mov_b32 s33, 0x07060302
    v_lshlrev_b32 v4, 4, v1
    s_lshl_b32 s24, s42, 14
    s_lshl_b32 s25, s43, 13
    s_add_u32 s24, s24, s25
    s_add_u32 s25, s24, 4096
    s_waitcnt vmcnt(4)
    v_perm_b32 v48, v17, v16, s32
    v_perm_b32 v49, v19, v18, s32
    v_perm_b32 v50, v21, v20, s32
    v_perm_b32 v51, v23, v22, s32
    v_perm_b32 v52, v17, v16, s33
    v_perm_b32 v53, v19, v18, s33
    v_perm_b32 v54, v21, v20, s33
    v_perm_b32 v55, v23, v22, s33
    v_perm_b32 v56, v25, v24, s32
    v_perm_b32 v57, v27, v26, s32
    v_perm_b32 v58, v29, v28, s32
    v_perm_b32 v59, v31, v30, s32
    v_perm_b32 v60, v25, v24, s33
    v_perm_b32 v61, v27, v26, s33
    v_perm_b32 v62, v29, v28, s33
    v_perm_b32 v63, v31, v30, s33
    v_perm_b32 v64, v33, v32, s32
    v_perm_b32 v65, v35, v34, s32
    v_perm_b32 v66, v37, v36, s32
    v_perm_b32 v67, v39, v38, s32
    v_perm_b32 v68, v33, v32, s33
    v_perm_b32 v69, v35, v34, s33
    v_perm_b32 v70, v37, v36, s33
    v_perm_b32 v71, v39, v38, s33
    v_perm_b32 v72, v41, v40, s32
    v_perm_b32 v73, v43, v42, s32
    v_perm_b32 v74, v45, v44, s32
    v_perm_b32 v75, v47, v46, s32
    v_perm_b32 v76, v41, v40, s33
    v_perm_b32 v77, v43, v42, s33
    v_perm_b32 v78, v45, v44, s33
    v_perm_b32 v79, v47, v46, s33
    s_cmp_eq_u32 s41, 2
    s_cbranch_scc1 L_prep_kernel_ge
    buffer_store_dwordx4 v[48:51], v4, s[12:15], s24 offen offset:0 sc1
    buffer_store_dwordx4 v[52:55], v4, s[12:15], s24 offen offset:1024 sc1
    buffer_store_dwordx4 v[56:59], v4, s[12:15], s24 offen offset:2048 sc1
    buffer_store_dwordx4 v[60:63], v4, s[12:15], s24 offen offset:3072 sc1
    buffer_store_dwordx4 v[64:67], v4, s[12:15], s25 offen offset:0 sc1
    buffer_store_dwordx4 v[68:71], v4, s[12:15], s25 offen offset:1024 sc1
    buffer_store_dwordx4 v[72:75], v4, s[12:15], s25 offen offset:2048 sc1
    buffer_store_dwordx4 v[76:79], v4, s[12:15], s25 offen offset:3072 sc1
    s_endpgm
L_prep_kernel_ge:
    s_waitcnt vmcnt(0)
    v_mfma_f32_16x16x32_bf16 v[96:99], v[48:51], v[80:83], 0
    v_mfma_f32_16x16x32_bf16 v[100:103], v[52:55], v[80:83], 0
    v_mfma_f32_16x16x32_bf16 v[96:99], v[56:59], v[84:87], v[96:99]
    v_mfma_f32_16x16x32_bf16 v[100:103], v[60:63], v[84:87], v[100:103]
    v_mfma_f32_16x16x32_bf16 v[96:99], v[64:67], v[88:91], v[96:99]
    v_mfma_f32_16x16x32_bf16 v[100:103], v[68:71], v[88:91], v[100:103]
    v_mfma_f32_16x16x32_bf16 v[96:99], v[72:75], v[92:95], v[96:99]
    v_mfma_f32_16x16x32_bf16 v[100:103], v[76:79], v[92:95], v[100:103]
    s_and_b32 s24, s40, 1
    s_lshl_b32 s24, s24, 11
    v_add_u32 v7, s24, v4
    s_mov_b32 s14, 16384
    v_lshlrev_b32 v8, 10, v3
    v_lshl_add_u32 v8, v2, 5, v8
    s_lshl_b32 s24, s42, 7
    s_mov_b32 s34, 0xffff0000
    s_mov_b32 s35, 0x4038aa3b
    s_cmp_eq_u32 s43, 0
    s_cbranch_scc1 L_prep_kernel_ge0
    ds_write_b128 v7, v[96:99]
    ds_write_b128 v7, v[100:103] offset:1024
    s_waitcnt lgkmcnt(0)
    s_barrier
    s_endpgm
L_prep_kernel_ge0:
    s_barrier
    ds_read_b128 v[16:19], v7
    ds_read_b128 v[20:23], v7 offset:1024
    s_waitcnt lgkmcnt(0)
    v_add_f32 v16, v16, v96
    v_add_f32 v17, v17, v97
    v_add_f32 v18, v18, v98
    v_add_f32 v19, v19, v99
    v_add_f32 v20, v20, v100
    v_add_f32 v21, v21, v101
    v_add_f32 v22, v22, v102
    v_add_f32 v23, v23, v103
    v_cvt_pk_bf16_f32 v48, v16, v20
    v_cvt_pk_bf16_f32 v49, v17, v21
    v_cvt_pk_bf16_f32 v50, v18, v22
    v_cvt_pk_bf16_f32 v51, v19, v23
    v_lshlrev_b32 v56, 16, v48
    v_and_b32 v57, s34, v48
    v_lshlrev_b32 v58, 16, v49
    v_and_b32 v59, s34, v49
    v_lshlrev_b32 v60, 16, v50
    v_and_b32 v61, s34, v50
    v_lshlrev_b32 v62, 16, v51
    v_and_b32 v63, s34, v51
    v_mul_f32 v56, s35, v56
    v_mul_f32 v57, s35, v57
    v_mul_f32 v58, s35, v58
    v_mul_f32 v59, s35, v59
    v_mul_f32 v60, s35, v60
    v_mul_f32 v61, s35, v61
    v_mul_f32 v62, s35, v62
    v_mul_f32 v63, s35, v63
    buffer_store_dwordx4 v[56:59], v8, s[12:15], s24 offen sc1
    buffer_store_dwordx4 v[60:63], v8, s[12:15], s24 offen offset:16 sc1
    v_exp_f32 v64, v56
    v_exp_f32 v65, v57
    v_exp_f32 v66, v58
    v_exp_f32 v67, v59
    v_exp_f32 v68, v60
    v_exp_f32 v69, v61
    v_exp_f32 v70, v62
    v_exp_f32 v71, v63
    v_max3_f32 v72, |v56|, |v57|, |v58|
    v_max3_f32 v72, |v59|, |v60|, v72
    v_max3_f32 v72, |v61|, |v62|, v72
    v_max_f32 v72, |v63|, v72
    s_add_u32 s12, s12, 16384
    s_addc_u32 s13, s13, 0
    v_cmp_lt_f32 vcc, 0x42f00000, v72
    buffer_store_dwordx4 v[64:67], v8, s[12:15], s24 offen sc1
    buffer_store_dwordx4 v[68:71], v8, s[12:15], s24 offen offset:16 sc1
    s_add_u32 s12, s12, 16384
    s_addc_u32 s13, s13, 0
    s_or_b32 s26, vcc_lo, vcc_hi
    s_lshl_b32 s24, s42, 2
    v_mov_b32 v73, s26
    v_mov_b32 v74, 0
    buffer_store_dword v73, v74, s[12:15], s24 offen sc1
    s_endpgm
.globl conv1_kernel
.p2align 8
.type conv1_kernel,@function
conv1_kernel:
    s_cmp_ge_u32 s2, 256
    s_cbranch_scc1 L_conv1_kernel_done
    s_load_dwordx2 s[4:5], s[0:1], 0
    s_load_dwordx2 s[30:31], s[0:1], 72
    v_readfirstlane_b32 s20, v0
    s_lshr_b32 s20, s20, 6
    s_xor_b32 s20, s20, 8
    s_and_b32 s36, s2, 0
    s_lshl_b32 s36, s36, 3
    s_bfe_u32 s37, s2, 196611
    s_or_b32 s29, s36, s37
    s_bfe_u32 s36, s2, 196608
    s_lshl_b32 s36, s36, 2
    s_lshr_b32 s37, s2, 6
    s_or_b32 s36, s36, s37
    s_mov_b32 s33, 0
    s_and_b32 s34, s36, 15
    s_lshr_b32 s35, s36, 4
    s_mul_i32 s21, s34, 500
    s_and_b32 s32, s20, 3
    v_and_b32 v127, 63, v0
    v_lshrrev_b32 v5, 2, v127
    v_and_b32 v6, 3, v127
    s_and_b32 s42, s20, 7
    v_lshlrev_b32 v7, 15, v5
    v_lshl_add_u32 v7, v6, 4, v7
    s_lshl_b32 s41, s21, 10
    s_sub_u32 s41, s41, 7680
    s_lshl_b32 s37, s42, 12
    s_add_u32 s37, s37, s41
    v_add_u32 v7, s37, v7
    s_mul_i32 s36, s35, 8192000
    s_mov_b32 s10, 8192000
    s_mov_b32 s11, 0x00020000
    s_mov_b32 s25, 0xffff0000
    s_mov_b32 s47, s36
    s_cmp_ge_u32 s20, 8
    s_cbranch_scc1 L_conv1_kernel_helper
    s_add_u32 s37, s41, 524288
    v_lshl_add_u32 v108, v127, 4, s37
    v_add_u32 v109, 1024, v108
    v_add_u32 v110, 2048, v108
    s_waitcnt lgkmcnt(0)
    s_add_u32 s8, s4, s47
    s_addc_u32 s9, s5, 0
    s_lshl_b32 s36, s29, 4
    s_lshl_b32 s37, s33, 3
    s_add_u32 s36, s36, s37
    s_mul_i32 s36, s36, 57344
    s_add_u32 s36, s36, 0
    s_add_u32 s12, s30, s36
    s_addc_u32 s13, s31, 0
    s_mov_b32 s14, 917504
    s_mov_b32 s15, 0x00020000
    s_mul_i32 s36, s35, 4194304
    s_add_u32 s36, s36, 18874368
    s_add_u32 s16, s30, s36
    s_addc_u32 s17, s31, 0
    s_mov_b32 s18, 4194304
    s_mov_b32 s19, 0x00020000
    v_and_b32 v10, 15, v127
    v_lshrrev_b32 v11, 4, v127
    v_add_u32 v8, 0, v10
    v_and_b32 v16, 4, v8
    v_lshrrev_b32 v16, 1, v16
    v_xor_b32 v16, v11, v16
    v_lshlrev_b32 v16, 4, v16
    v_lshl_add_u32 v8, v8, 6, v16
    v_add_u32 v9, 1, v10
    v_and_b32 v16, 4, v9
    v_lshrrev_b32 v16, 1, v16
    v_xor_b32 v16, v11, v16
    v_lshlrev_b32 v16, 4, v16
    v_lshl_add_u32 v9, v9, 6, v16
    s_lshr_b32 s38, s32, 1
    s_and_b32 s39, s32, 1
    s_add_u32 s40, s38, 4
    s_lshl_b32 s43, s39, 10
    s_cmp_lt_u32 s20, 4
    s_cselect_b32 s40, s20, s40
    s_cselect_b32 s36, 0, s43
    s_lshl_b32 s37, s40, 13
    s_add_u32 s37, s37, s36
    v_lshl_add_u32 v125, v127, 4, s37
    s_mul_i32 s37, s40, 16384
    v_add_u32 v120, s37, v8
    v_add_u32 v121, s37, v9
    s_lshl_b32 s37, s40, 10
    s_add_u32 s37, s37, 115712
    v_lshl_add_u32 v16, v11, 4, s37
    v_cmp_eq_u32 vcc, 15, v10
    v_mov_b32 v17, 8192
    v_mov_b32 v18, 4294959104
    v_mov_b32 v19, 64
    v_cndmask_b32 v122, v121, v16, vcc
    v_cndmask_b32 v123, v17, v19, vcc
    v_cndmask_b32 v124, v18, v19, vcc
    v_lshl_add_u32 v126, v127, 4, s37
    s_mov_b32 s44, 0x3f800000
    s_mov_b32 s45, 0x00000000
    s_mov_b32 s46, 0x00000000
    s_cmp_eq_u32 s40, 1
    s_cselect_b32 s45, 0x3f800000, s45
    s_cselect_b32 s46, 0x3f800000, s46
    s_cmp_eq_u32 s40, 2
    s_cselect_b32 s45, 0xbf800000, s45
    s_cselect_b32 s46, 0x3f800000, s46
    s_cmp_eq_u32 s40, 3
    s_cselect_b32 s45, 0x40000000, s45
    s_cselect_b32 s46, 0x40800000, s46
    s_cmp_eq_u32 s40, 4
    s_cselect_b32 s45, 0xc0000000, s45
    s_cselect_b32 s46, 0x40800000, s46
    s_cmp_eq_u32 s40, 5
    s_cselect_b32 s44, 0x41800000, s44
    s_cselect_b32 s45, 0x41000000, s45
    s_cselect_b32 s46, 0x40800000, s46
    s_cmp_ge_u32 s20, 4
    s_cbranch_scc1 L_conv1_kernel_m2
    v_mov_b32 v0, 0
    v_mov_b32 v1, 0
    v_mov_b32 v2, 0
    v_mov_b32 v3, 0
    v_mov_b32 v4, 0
    v_mov_b32 v5, 0
    v_mov_b32 v6, 0
    v_mov_b32 v7, 0
    v_mov_b32 v8, 0
    v_mov_b32 v9, 0
    v_mov_b32 v10, 0
    v_mov_b32 v11, 0
    v_mov_b32 v12, 0
    v_mov_b32 v13, 0
    v_mov_b32 v14, 0
    v_mov_b32 v15, 0
    v_mov_b32 v16, 0
    v_mov_b32 v17, 0
    v_mov_b32 v18, 0
    v_mov_b32 v19, 0
    v_mov_b32 v20, 0
    v_mov_b32 v21, 0
    v_mov_b32 v22, 0
    v_mov_b32 v23, 0
    v_mov_b32 v24, 0
    v_mov_b32 v25, 0
    v_mov_b32 v26, 0
    v_mov_b32 v27, 0
    v_mov_b32 v28, 0
    v_mov_b32 v29, 0
    v_mov_b32 v30, 0
    v_mov_b32 v31, 0
    v_mov_b32 v32, 0
    v_mov_b32 v33, 0
    v_mov_b32 v34, 0
    v_mov_b32 v35, 0
    v_mov_b32 v36, 0
    v_mov_b32 v37, 0
    v_mov_b32 v38, 0
    v_mov_b32 v39, 0
    v_mov_b32 v40, 0
    v_mov_b32 v41, 0
    v_mov_b32 v42, 0
    v_mov_b32 v43, 0
    v_mov_b32 v44, 0
    v_mov_b32 v45, 0
    v_mov_b32 v46, 0
    v_mov_b32 v47, 0
    v_mov_b32 v48, 0
    v_mov_b32 v49, 0
    v_mov_b32 v50, 0
    v_mov_b32 v51, 0
    v_mov_b32 v52, 0
    v_mov_b32 v53, 0
    v_mov_b32 v54, 0
    v_mov_b32 v55, 0
    v_mov_b32 v56, 0
    v_mov_b32 v57, 0
    v_mov_b32 v58, 0
    v_mov_b32 v59, 0
    v_mov_b32 v60, 0
    v_mov_b32 v61, 0
    v_mov_b32 v62, 0
    v_mov_b32 v63, 0
    buffer_load_dwordx4 v[96:99], v108, s[8:11], 0 offen
    buffer_load_dwordx4 v[100:103], v109, s[8:11], 0 offen
    buffer_load_dwordx4 v[104:107], v110, s[8:11], 0 offen
    s_mov_b32 s23, 0
    s_mov_b32 s26, 4096
    buffer_load_dwordx4 v[64:67], v125, s[12:15], s23 offen offset:0
    buffer_load_dwordx4 v[68:71], v125, s[12:15], s23 offen offset:1024
    buffer_load_dwordx4 v[72:75], v125, s[12:15], s23 offen offset:2048
    buffer_load_dwordx4 v[76:79], v125, s[12:15], s23 offen offset:3072
    buffer_load_dwordx4 v[80:83], v125, s[12:15], s26 offen offset:0
    buffer_load_dwordx4 v[84:87], v125, s[12:15], s26 offen offset:1024
    buffer_load_dwordx4 v[88:91], v125, s[12:15], s26 offen offset:2048
    buffer_load_dwordx4 v[92:95], v125, s[12:15], s26 offen offset:3072
    s_mov_b32 s23, 57344
    s_mov_b32 s26, 61440
    s_waitcnt vmcnt(8)
    v_lshlrev_b32 v108, 16, v96
    v_and_b32 v111, s25, v96
    v_lshlrev_b32 v109, 16, v100
    v_and_b32 v112, s25, v100
    v_lshlrev_b32 v110, 16, v104
    v_and_b32 v113, s25, v104
    v_mul_f32 v114, s44, v108
    v_mul_f32 v115, s44, v111
    v_fmac_f32 v114, s45, v109
    v_fmac_f32 v115, s45, v112
    v_fmac_f32 v114, s46, v110
    v_fmac_f32 v115, s46, v113
    v_cvt_pk_bf16_f32 v96, v114, v115
    v_lshlrev_b32 v108, 16, v97
    v_and_b32 v111, s25, v97
    v_lshlrev_b32 v109, 16, v101
    v_and_b32 v112, s25, v101
    v_lshlrev_b32 v110, 16, v105
    v_and_b32 v113, s25, v105
    v_mul_f32 v114, s44, v108
    v_mul_f32 v115, s44, v111
    v_fmac_f32 v114, s45, v109
    v_fmac_f32 v115, s45, v112
    v_fmac_f32 v114, s46, v110
    v_fmac_f32 v115, s46, v113
    v_cvt_pk_bf16_f32 v97, v114, v115
    v_lshlrev_b32 v108, 16, v98
    v_and_b32 v111, s25, v98
    v_lshlrev_b32 v109, 16, v102
    v_and_b32 v112, s25, v102
    v_lshlrev_b32 v110, 16, v106
    v_and_b32 v113, s25, v106
    v_mul_f32 v114, s44, v108
    v_mul_f32 v115, s44, v111
    v_fmac_f32 v114, s45, v109
    v_fmac_f32 v115, s45, v112
    v_fmac_f32 v114, s46, v110
    v_fmac_f32 v115, s46, v113
    v_cvt_pk_bf16_f32 v98, v114, v115
    v_lshlrev_b32 v108, 16, v99
    v_and_b32 v111, s25, v99
    v_lshlrev_b32 v109, 16, v103
    v_and_b32 v112, s25, v103
    v_lshlrev_b32 v110, 16, v107
    v_and_b32 v113, s25, v107
    v_mul_f32 v114, s44, v108
    v_mul_f32 v115, s44, v111
    v_fmac_f32 v114, s45, v109
    v_fmac_f32 v115, s45, v112
    v_fmac_f32 v114, s46, v110
    v_fmac_f32 v115, s46, v113
    v_cvt_pk_bf16_f32 v99, v114, v115
    ds_write_b128 v126, v[96:99]
    s_waitcnt lgkmcnt(0)
    s_barrier
    s_mov_b32 s22, 8
    s_setprio 2
L_conv1_kernel_mloop1:
    ds_read_b128 v[96:99], v120 offset:0
    ds_read_b128 v[100:103], v120 offset:1024
    ds_read_b128 v[104:107], v120 offset:2048
    ds_read_b128 v[108:111], v120 offset:3072
    ds_read_b128 v[112:115], v120 offset:4096
    ds_read_b128 v[116:119], v120 offset:5120
    s_waitcnt vmcnt(6) lgkmcnt(5)
    v_mfma_f32_16x16x32_bf16 v[0:3], v[64:67], v[96:99], v[0:3]
    v_mfma_f32_16x16x32_bf16 v[32:35], v[68:71], v[96:99], v[32:35]
    ds_read_b128 v[96:99], v120 offset:6144
    s_waitcnt vmcnt(4) lgkmcnt(5)
    v_mfma_f32_16x16x32_bf16 v[4:7], v[64:67], v[100:103], v[4:7]
    v_mfma_f32_16x16x32_bf16 v[36:39], v[68:71], v[100:103], v[36:39]
    v_mfma_f32_16x16x32_bf16 v[0:3], v[72:75], v[100:103], v[0:3]
    v_mfma_f32_16x16x32_bf16 v[32:35], v[76:79], v[100:103], v[32:35]
    ds_read_b128 v[100:103], v120 offset:7168
    s_waitcnt vmcnt(2) lgkmcnt(5)
    v_mfma_f32_16x16x32_bf16 v[8:11], v[64:67], v[104:107], v[8:11]
    v_mfma_f32_16x16x32_bf16 v[40:43], v[68:71], v[104:107], v[40:43]
    v_mfma_f32_16x16x32_bf16 v[4:7], v[72:75], v[104:107], v[4:7]
    v_mfma_f32_16x16x32_bf16 v[36:39], v[76:79], v[104:107], v[36:39]
    v_mfma_f32_16x16x32_bf16 v[0:3], v[80:83], v[104:107], v[0:3]
    v_mfma_f32_16x16x32_bf16 v[32:35], v[84:87], v[104:107], v[32:35]
    ds_read_b128 v[104:107], v122 offset:0
    v_add_u32 v122, v123, v122
    s_waitcnt vmcnt(0) lgkmcnt(5)
    v_mfma_f32_16x16x32_bf16 v[12:15], v[64:67], v[108:111], v[12:15]
    v_mfma_f32_16x16x32_bf16 v[44:47], v[68:71], v[108:111], v[44:47]
    v_mfma_f32_16x16x32_bf16 v[8:11], v[72:75], v[108:111], v[8:11]
    v_mfma_f32_16x16x32_bf16 v[40:43], v[76:79], v[108:111], v[40:43]
    v_mfma_f32_16x16x32_bf16 v[4:7], v[80:83], v[108:111], v[4:7]
    v_mfma_f32_16x16x32_bf16 v[36:39], v[84:87], v[108:111], v[36:39]
    v_mfma_f32_16x16x32_bf16 v[0:3], v[88:91], v[108:111], v[0:3]
    v_mfma_f32_16x16x32_bf16 v[32:35], v[92:95], v[108:111], v[32:35]
    ds_read_b128 v[108:111], v121 offset:1024
    s_waitcnt lgkmcnt(5)
    v_mfma_f32_16x16x32_bf16 v[16:19], v[64:67], v[112:115], v[16:19]
    v_mfma_f32_16x16x32_bf16 v[48:51], v[68:71], v[112:115], v[48:51]
    v_mfma_f32_16x16x32_bf16 v[12:15], v[72:75], v[112:115], v[12:15]
    v_mfma_f32_16x16x32_bf16 v[44:47], v[76:79], v[112:115], v[44:47]
    v_mfma_f32_16x16x32_bf16 v[8:11], v[80:83], v[112:115], v[8:11]
    v_mfma_f32_16x16x32_bf16 v[40:43], v[84:87], v[112:115], v[40:43]
    v_mfma_f32_16x16x32_bf16 v[4:7], v[88:91], v[112:115], v[4:7]
    v_mfma_f32_16x16x32_bf16 v[36:39], v[92:95], v[112:115], v[36:39]
    ds_read_b128 v[112:115], v121 offset:2048
    s_waitcnt lgkmcnt(5)
    v_mfma_f32_16x16x32_bf16 v[20:23], v[64:67], v[116:119], v[20:23]
    v_mfma_f32_16x16x32_bf16 v[52:55], v[68:71], v[116:119], v[52:55]
    v_mfma_f32_16x16x32_bf16 v[16:19], v[72:75], v[116:119], v[16:19]
    v_mfma_f32_16x16x32_bf16 v[48:51], v[76:79], v[116:119], v[48:51]
    v_mfma_f32_16x16x32_bf16 v[12:15], v[80:83], v[116:119], v[12:15]
    v_mfma_f32_16x16x32_bf16 v[44:47], v[84:87], v[116:119], v[44:47]
    v_mfma_f32_16x16x32_bf16 v[8:11], v[88:91], v[116:119], v[8:11]
    v_mfma_f32_16x16x32_bf16 v[40:43], v[92:95], v[116:119], v[40:43]
    s_waitcnt lgkmcnt(4)
    v_mfma_f32_16x16x32_bf16 v[24:27], v[64:67], v[96:99], v[24:27]
    v_mfma_f32_16x16x32_bf16 v[56:59], v[68:71], v[96:99], v[56:59]
    v_mfma_f32_16x16x32_bf16 v[20:23], v[72:75], v[96:99], v[20:23]
    v_mfma_f32_16x16x32_bf16 v[52:55], v[76:79], v[96:99], v[52:55]
    v_mfma_f32_16x16x32_bf16 v[16:19], v[80:83], v[96:99], v[16:19]
    v_mfma_f32_16x16x32_bf16 v[48:51], v[84:87], v[96:99], v[48:51]
    v_mfma_f32_16x16x32_bf16 v[12:15], v[88:91], v[96:99], v[12:15]
    v_mfma_f32_16x16x32_bf16 v[44:47], v[92:95], v[96:99], v[44:47]
    s_waitcnt lgkmcnt(3)
    v_mfma_f32_16x16x32_bf16 v[28:31], v[64:67], v[100:103], v[28:31]
    v_mfma_f32_16x16x32_bf16 v[60:63], v[68:71], v[100:103], v[60:63]
    v_mfma_f32_16x16x32_bf16 v[24:27], v[72:75], v[100:103], v[24:27]
    v_mfma_f32_16x16x32_bf16 v[56:59], v[76:79], v[100:103], v[56:59]
    v_mfma_f32_16x16x32_bf16 v[20:23], v[80:83], v[100:103], v[20:23]
    v_mfma_f32_16x16x32_bf16 v[52:55], v[84:87], v[100:103], v[52:55]
    v_mfma_f32_16x16x32_bf16 v[16:19], v[88:91], v[100:103], v[16:19]
    v_mfma_f32_16x16x32_bf16 v[48:51], v[92:95], v[100:103], v[48:51]
    buffer_load_dwordx4 v[64:67], v125, s[12:15], s23 offen offset:0
    buffer_load_dwordx4 v[68:71], v125, s[12:15], s23 offen offset:1024
    s_waitcnt lgkmcnt(2)
    v_mfma_f32_16x16x32_bf16 v[28:31], v[72:75], v[104:107], v[28:31]
    v_mfma_f32_16x16x32_bf16 v[60:63], v[76:79], v[104:107], v[60:63]
    v_mfma_f32_16x16x32_bf16 v[24:27], v[80:83], v[104:107], v[24:27]
    v_mfma_f32_16x16x32_bf16 v[56:59], v[84:87], v[104:107], v[56:59]
    v_mfma_f32_16x16x32_bf16 v[20:23], v[88:91], v[104:107], v[20:23]
    v_mfma_f32_16x16x32_bf16 v[52:55], v[92:95], v[104:107], v[52:55]
    buffer_load_dwordx4 v[72:75], v125, s[12:15], s23 offen offset:2048
    buffer_load_dwordx4 v[76:79], v125, s[12:15], s23 offen offset:3072
    s_waitcnt lgkmcnt(1)
    v_mfma_f32_16x16x32_bf16 v[28:31], v[80:83], v[108:111], v[28:31]
    v_mfma_f32_16x16x32_bf16 v[60:63], v[84:87], v[108:111], v[60:63]
    v_mfma_f32_16x16x32_bf16 v[24:27], v[88:91], v[108:111], v[24:27]
    v_mfma_f32_16x16x32_bf16 v[56:59], v[92:95], v[108:111], v[56:59]
    buffer_load_dwordx4 v[80:83], v125, s[12:15], s26 offen offset:0
    buffer_load_dwordx4 v[84:87], v125, s[12:15], s26 offen offset:1024
    s_waitcnt lgkmcnt(0)
    v_mfma_f32_16x16x32_bf16 v[28:31], v[88:91], v[112:115], v[28:31]
    v_mfma_f32_16x16x32_bf16 v[60:63], v[92:95], v[112:115], v[60:63]
    buffer_load_dwordx4 v[88:91], v125, s[12:15], s26 offen offset:2048
    buffer_load_dwordx4 v[92:95], v125, s[12:15], s26 offen offset:3072
    s_add_u32 s23, s23, 57344
    s_add_u32 s26, s26, 57344
    s_barrier
    s_sub_u32 s22, s22, 1
    s_cmp_eq_u32 s22, 0
    s_cbranch_scc1 L_conv1_kernel_mlast1
    ds_read_b128 v[96:99], v120 offset:8192
    ds_read_b128 v[100:103], v120 offset:9216
    ds_read_b128 v[104:107], v120 offset:10240
    ds_read_b128 v[108:111], v120 offset:11264
    ds_read_b128 v[112:115], v120 offset:12288
    ds_read_b128 v[116:119], v120 offset:13312
    s_waitcnt vmcnt(6) lgkmcnt(5)
    v_mfma_f32_16x16x32_bf16 v[0:3], v[64:67], v[96:99], v[0:3]
    v_mfma_f32_16x16x32_bf16 v[32:35], v[68:71], v[96:99], v[32:35]
    ds_read_b128 v[96:99], v120 offset:14336
    s_waitcnt vmcnt(4) lgkmcnt(5)
    v_mfma_f32_16x16x32_bf16 v[4:7], v[64:67], v[100:103], v[4:7]
    v_mfma_f32_16x16x32_bf16 v[36:39], v[68:71], v[100:103], v[36:39]
    v_mfma_f32_16x16x32_bf16 v[0:3], v[72:75], v[100:103], v[0:3]
    v_mfma_f32_16x16x32_bf16 v[32:35], v[76:79], v[100:103], v[32:35]
    ds_read_b128 v[100:103], v120 offset:15360
    s_waitcnt vmcnt(2) lgkmcnt(5)
    v_mfma_f32_16x16x32_bf16 v[8:11], v[64:67], v[104:107], v[8:11]
    v_mfma_f32_16x16x32_bf16 v[40:43], v[68:71], v[104:107], v[40:43]
    v_mfma_f32_16x16x32_bf16 v[4:7], v[72:75], v[104:107], v[4:7]
    v_mfma_f32_16x16x32_bf16 v[36:39], v[76:79], v[104:107], v[36:39]
    v_mfma_f32_16x16x32_bf16 v[0:3], v[80:83], v[104:107], v[0:3]
    v_mfma_f32_16x16x32_bf16 v[32:35], v[84:87], v[104:107], v[32:35]
    ds_read_b128 v[104:107], v122 offset:0
    v_add_u32 v122, v124, v122
    s_waitcnt vmcnt(0) lgkmcnt(5)
    v_mfma_f32_16x16x32_bf16 v[12:15], v[64:67], v[108:111], v[12:15]
    v_mfma_f32_16x16x32_bf16 v[44:47], v[68:71], v[108:111], v[44:47]
    v_mfma_f32_16x16x32_bf16 v[8:11], v[72:75], v[108:111], v[8:11]
    v_mfma_f32_16x16x32_bf16 v[40:43], v[76:79], v[108:111], v[40:43]
    v_mfma_f32_16x16x32_bf16 v[4:7], v[80:83], v[108:111], v[4:7]
    v_mfma_f32_16x16x32_bf16 v[36:39], v[84:87], v[108:111], v[36:39]
    v_mfma_f32_16x16x32_bf16 v[0:3], v[88:91], v[108:111], v[0:3]
    v_mfma_f32_16x16x32_bf16 v[32:35], v[92:95], v[108:111], v[32:35]
    ds_read_b128 v[108:111], v121 offset:9216
    s_waitcnt lgkmcnt(5)
    v_mfma_f32_16x16x32_bf16 v[16:19], v[64:67], v[112:115], v[16:19]
    v_mfma_f32_16x16x32_bf16 v[48:51], v[68:71], v[112:115], v[48:51]
    v_mfma_f32_16x16x32_bf16 v[12:15], v[72:75], v[112:115], v[12:15]
    v_mfma_f32_16x16x32_bf16 v[44:47], v[76:79], v[112:115], v[44:47]
    v_mfma_f32_16x16x32_bf16 v[8:11], v[80:83], v[112:115], v[8:11]
    v_mfma_f32_16x16x32_bf16 v[40:43], v[84:87], v[112:115], v[40:43]
    v_mfma_f32_16x16x32_bf16 v[4:7], v[88:91], v[112:115], v[4:7]
    v_mfma_f32_16x16x32_bf16 v[36:39], v[92:95], v[112:115], v[36:39]
    ds_read_b128 v[112:115], v121 offset:10240
    s_waitcnt lgkmcnt(5)
    v_mfma_f32_16x16x32_bf16 v[20:23], v[64:67], v[116:119], v[20:23]
    v_mfma_f32_16x16x32_bf16 v[52:55], v[68:71], v[116:119], v[52:55]
    v_mfma_f32_16x16x32_bf16 v[16:19], v[72:75], v[116:119], v[16:19]
    v_mfma_f32_16x16x32_bf16 v[48:51], v[76:79], v[116:119], v[48:51]
    v_mfma_f32_16x16x32_bf16 v[12:15], v[80:83], v[116:119], v[12:15]
    v_mfma_f32_16x16x32_bf16 v[44:47], v[84:87], v[116:119], v[44:47]
    v_mfma_f32_16x16x32_bf16 v[8:11], v[88:91], v[116:119], v[8:11]
    v_mfma_f32_16x16x32_bf16 v[40:43], v[92:95], v[116:119], v[40:43]
    s_waitcnt lgkmcnt(4)
    v_mfma_f32_16x16x32_bf16 v[24:27], v[64:67], v[96:99], v[24:27]
    v_mfma_f32_16x16x32_bf16 v[56:59], v[68:71], v[96:99], v[56:59]
    v_mfma_f32_16x16x32_bf16 v[20:23], v[72:75], v[96:99], v[20:23]
    v_mfma_f32_16x16x32_bf16 v[52:55], v[76:79], v[96:99], v[52:55]
    v_mfma_f32_16x16x32_bf16 v[16:19], v[80:83], v[96:99], v[16:19]
    v_mfma_f32_16x16x32_bf16 v[48:51], v[84:87], v[96:99], v[48:51]
    v_mfma_f32_16x16x32_bf16 v[12:15], v[88:91], v[96:99], v[12:15]
    v_mfma_f32_16x16x32_bf16 v[44:47], v[92:95], v[96:99], v[44:47]
    s_waitcnt lgkmcnt(3)
    v_mfma_f32_16x16x32_bf16 v[28:31], v[64:67], v[100:103], v[28:31]
    v_mfma_f32_16x16x32_bf16 v[60:63], v[68:71], v[100:103], v[60:63]
    v_mfma_f32_16x16x32_bf16 v[24:27], v[72:75], v[100:103], v[24:27]
    v_mfma_f32_16x16x32_bf16 v[56:59], v[76:79], v[100:103], v[56:59]
    v_mfma_f32_16x16x32_bf16 v[20:23], v[80:83], v[100:103], v[20:23]
    v_mfma_f32_16x16x32_bf16 v[52:55], v[84:87], v[100:103], v[52:55]
    v_mfma_f32_16x16x32_bf16 v[16:19], v[88:91], v[100:103], v[16:19]
    v_mfma_f32_16x16x32_bf16 v[48:51], v[92:95], v[100:103], v[48:51]
    buffer_load_dwordx4 v[64:67], v125, s[12:15], s23 offen offset:0
    buffer_load_dwordx4 v[68:71], v125, s[12:15], s23 offen offset:1024
    s_waitcnt lgkmcnt(2)
    v_mfma_f32_16x16x32_bf16 v[28:31], v[72:75], v[104:107], v[28:31]
    v_mfma_f32_16x16x32_bf16 v[60:63], v[76:79], v[104:107], v[60:63]
    v_mfma_f32_16x16x32_bf16 v[24:27], v[80:83], v[104:107], v[24:27]
    v_mfma_f32_16x16x32_bf16 v[56:59], v[84:87], v[104:107], v[56:59]
    v_mfma_f32_16x16x32_bf16 v[20:23], v[88:91], v[104:107], v[20:23]
    v_mfma_f32_16x16x32_bf16 v[52:55], v[92:95], v[104:107], v[52:55]
    buffer_load_dwordx4 v[72:75], v125, s[12:15], s23 offen offset:2048
    buffer_load_dwordx4 v[76:79], v125, s[12:15], s23 offen offset:3072
    s_waitcnt lgkmcnt(1)
    v_mfma_f32_16x16x32_bf16 v[28:31], v[80:83], v[108:111], v[28:31]
    v_mfma_f32_16x16x32_bf16 v[60:63], v[84:87], v[108:111], v[60:63]
    v_mfma_f32_16x16x32_bf16 v[24:27], v[88:91], v[108:111], v[24:27]
    v_mfma_f32_16x16x32_bf16 v[56:59], v[92:95], v[108:111], v[56:59]
    buffer_load_dwordx4 v[80:83], v125, s[12:15], s26 offen offset:0
    buffer_load_dwordx4 v[84:87], v125, s[12:15], s26 offen offset:1024
    s_waitcnt lgkmcnt(0)
    v_mfma_f32_16x16x32_bf16 v[28:31], v[88:91], v[112:115], v[28:31]
    v_mfma_f32_16x16x32_bf16 v[60:63], v[92:95], v[112:115], v[60:63]
    buffer_load_dwordx4 v[88:91], v125, s[12:15], s26 offen offset:2048
    buffer_load_dwordx4 v[92:95], v125, s[12:15], s26 offen offset:3072
    s_add_u32 s23, s23, 57344
    s_add_u32 s26, s26, 57344
    s_barrier
    s_branch L_conv1_kernel_mloop1
L_conv1_kernel_mlast1:
    v_and_b32 v125, 15, v127
    v_and_b32 v126, 7, v127
    v_lshlrev_b32 v126, 4, v126
    v_lshl_add_u32 v125, v125, 7, v126
    v_lshrrev_b32 v126, 4, v127
    v_lshl_add_u32 v125, v126, 11, v125
    s_lshl_b32 s36, s20, 14
    s_add_u32 s37, s36, 8192
    v_add_u32 v126, s37, v125
    v_add_u32 v125, s36, v125
    ds_read_b128 v[96:99], v120 offset:8192
    ds_read_b128 v[100:103], v120 offset:9216
    ds_read_b128 v[104:107], v120 offset:10240
    ds_read_b128 v[108:111], v120 offset:11264
    ds_read_b128 v[112:115], v120 offset:12288
    ds_read_b128 v[116:119], v120 offset:13312
    s_waitcnt vmcnt(6) lgkmcnt(5)
    v_mfma_f32_16x16x32_bf16 v[0:3], v[64:67], v[96:99], v[0:3]
    v_mfma_f32_16x16x32_bf16 v[32:35], v[68:71], v[96:99], v[32:35]
    ds_read_b128 v[96:99], v120 offset:14336
    s_waitcnt vmcnt(4) lgkmcnt(5)
    v_mfma_f32_16x16x32_bf16 v[4:7], v[64:67], v[100:103], v[4:7]
    v_mfma_f32_16x16x32_bf16 v[36:39], v[68:71], v[100:103], v[36:39]
    v_mfma_f32_16x16x32_bf16 v[0:3], v[72:75], v[100:103], v[0:3]
    v_mfma_f32_16x16x32_bf16 v[32:35], v[76:79], v[100:103], v[32:35]
    ds_read_b128 v[100:103], v120 offset:15360
    s_waitcnt vmcnt(2) lgkmcnt(5)
    v_mfma_f32_16x16x32_bf16 v[8:11], v[64:67], v[104:107], v[8:11]
    v_mfma_f32_16x16x32_bf16 v[40:43], v[68:71], v[104:107], v[40:43]
    v_mfma_f32_16x16x32_bf16 v[4:7], v[72:75], v[104:107], v[4:7]
    v_mfma_f32_16x16x32_bf16 v[36:39], v[76:79], v[104:107], v[36:39]
    v_mfma_f32_16x16x32_bf16 v[0:3], v[80:83], v[104:107], v[0:3]
    v_mfma_f32_16x16x32_bf16 v[32:35], v[84:87], v[104:107], v[32:35]
    ds_read_b128 v[104:107], v122 offset:0
    s_waitcnt vmcnt(0) lgkmcnt(5)
    v_mfma_f32_16x16x32_bf16 v[12:15], v[64:67], v[108:111], v[12:15]
    v_mfma_f32_16x16x32_bf16 v[44:47], v[68:71], v[108:111], v[44:47]
    v_mfma_f32_16x16x32_bf16 v[8:11], v[72:75], v[108:111], v[8:11]
    v_mfma_f32_16x16x32_bf16 v[40:43], v[76:79], v[108:111], v[40:43]
    v_mfma_f32_16x16x32_bf16 v[4:7], v[80:83], v[108:111], v[4:7]
    v_mfma_f32_16x16x32_bf16 v[36:39], v[84:87], v[108:111], v[36:39]
    v_mfma_f32_16x16x32_bf16 v[0:3], v[88:91], v[108:111], v[0:3]
    v_mfma_f32_16x16x32_bf16 v[32:35], v[92:95], v[108:111], v[32:35]
    ds_read_b128 v[108:111], v121 offset:9216
    s_waitcnt lgkmcnt(5)
    v_mfma_f32_16x16x32_bf16 v[16:19], v[64:67], v[112:115], v[16:19]
    v_mfma_f32_16x16x32_bf16 v[48:51], v[68:71], v[112:115], v[48:51]
    v_mfma_f32_16x16x32_bf16 v[12:15], v[72:75], v[112:115], v[12:15]
    v_mfma_f32_16x16x32_bf16 v[44:47], v[76:79], v[112:115], v[44:47]
    v_mfma_f32_16x16x32_bf16 v[8:11], v[80:83], v[112:115], v[8:11]
    v_mfma_f32_16x16x32_bf16 v[40:43], v[84:87], v[112:115], v[40:43]
    v_mfma_f32_16x16x32_bf16 v[4:7], v[88:91], v[112:115], v[4:7]
    v_mfma_f32_16x16x32_bf16 v[36:39], v[92:95], v[112:115], v[36:39]
    ds_read_b128 v[112:115], v121 offset:10240
    v_xor_b32 v123, 0, v125
    ds_write_b128 v123, v[0:3]
    s_waitcnt lgkmcnt(6)
    v_mfma_f32_16x16x32_bf16 v[20:23], v[64:67], v[116:119], v[20:23]
    v_mfma_f32_16x16x32_bf16 v[52:55], v[68:71], v[116:119], v[52:55]
    v_mfma_f32_16x16x32_bf16 v[16:19], v[72:75], v[116:119], v[16:19]
    v_mfma_f32_16x16x32_bf16 v[48:51], v[76:79], v[116:119], v[48:51]
    v_mfma_f32_16x16x32_bf16 v[12:15], v[80:83], v[116:119], v[12:15]
    v_mfma_f32_16x16x32_bf16 v[44:47], v[84:87], v[116:119], v[44:47]
    v_mfma_f32_16x16x32_bf16 v[8:11], v[88:91], v[116:119], v[8:11]
    v_mfma_f32_16x16x32_bf16 v[40:43], v[92:95], v[116:119], v[40:43]
    v_xor_b32 v124, 16, v125
    ds_write_b128 v124, v[4:7]
    s_waitcnt lgkmcnt(2)
    v_mfma_f32_16x16x32_bf16 v[24:27], v[64:67], v[96:99], v[24:27]
    v_mfma_f32_16x16x32_bf16 v[56:59], v[68:71], v[96:99], v[56:59]
    v_mfma_f32_16x16x32_bf16 v[20:23], v[72:75], v[96:99], v[20:23]
    v_mfma_f32_16x16x32_bf16 v[52:55], v[76:79], v[96:99], v[52:55]
    v_mfma_f32_16x16x32_bf16 v[16:19], v[80:83], v[96:99], v[16:19]
    v_mfma_f32_16x16x32_bf16 v[48:51], v[84:87], v[96:99], v[48:51]
    v_mfma_f32_16x16x32_bf16 v[12:15], v[88:91], v[96:99], v[12:15]
    v_mfma_f32_16x16x32_bf16 v[44:47], v[92:95], v[96:99], v[44:47]
    v_xor_b32 v123, 32, v125
    ds_write_b128 v123, v[8:11]
    v_xor_b32 v124, 0, v126
    ds_write_b128 v124, v[32:35]
    v_mfma_f32_16x16x32_bf16 v[28:31], v[64:67], v[100:103], v[28:31]
    v_mfma_f32_16x16x32_bf16 v[60:63], v[68:71], v[100:103], v[60:63]
    v_mfma_f32_16x16x32_bf16 v[24:27], v[72:75], v[100:103], v[24:27]
    v_mfma_f32_16x16x32_bf16 v[56:59], v[76:79], v[100:103], v[56:59]
    v_mfma_f32_16x16x32_bf16 v[20:23], v[80:83], v[100:103], v[20:23]
    v_mfma_f32_16x16x32_bf16 v[52:55], v[84:87], v[100:103], v[52:55]
    v_mfma_f32_16x16x32_bf16 v[16:19], v[88:91], v[100:103], v[16:19]
    v_mfma_f32_16x16x32_bf16 v[48:51], v[92:95], v[100:103], v[48:51]
    v_xor_b32 v123, 16, v126
    ds_write_b128 v123, v[36:39]
    v_xor_b32 v124, 32, v126
    ds_write_b128 v124, v[40:43]
    v_mfma_f32_16x16x32_bf16 v[28:31], v[72:75], v[104:107], v[28:31]
    v_mfma_f32_16x16x32_bf16 v[60:63], v[76:79], v[104:107], v[60:63]
    v_mfma_f32_16x16x32_bf16 v[24:27], v[80:83], v[104:107], v[24:27]
    v_mfma_f32_16x16x32_bf16 v[56:59], v[84:87], v[104:107], v[56:59]
    v_mfma_f32_16x16x32_bf16 v[20:23], v[88:91], v[104:107], v[20:23]
    v_mfma_f32_16x16x32_bf16 v[52:55], v[92:95], v[104:107], v[52:55]
    v_xor_b32 v124, 48, v125
    ds_write_b128 v124, v[12:15]
    v_xor_b32 v123, 48, v126
    ds_write_b128 v123, v[44:47]
    v_mfma_f32_16x16x32_bf16 v[28:31], v[80:83], v[108:111], v[28:31]
    v_mfma_f32_16x16x32_bf16 v[60:63], v[84:87], v[108:111], v[60:63]
    v_mfma_f32_16x16x32_bf16 v[24:27], v[88:91], v[108:111], v[24:27]
    v_mfma_f32_16x16x32_bf16 v[56:59], v[92:95], v[108:111], v[56:59]
    v_xor_b32 v123, 64, v125
    ds_write_b128 v123, v[16:19]
    v_xor_b32 v124, 64, v126
    ds_write_b128 v124, v[48:51]
    v_mfma_f32_16x16x32_bf16 v[28:31], v[88:91], v[112:115], v[28:31]
    v_mfma_f32_16x16x32_bf16 v[60:63], v[92:95], v[112:115], v[60:63]
    v_xor_b32 v124, 80, v125
    ds_write_b128 v124, v[20:23]
    v_xor_b32 v123, 80, v126
    ds_write_b128 v123, v[52:55]
    v_and_b32 v108, 15, v127
    v_lshrrev_b32 v109, 4, v127
    v_lshrrev_b32 v110, 3, v108
    s_lshl_b32 s36, s20, 1
    v_add_u32 v110, s36, v110
    v_xor_b32 v111, v110, v108
    v_and_b32 v111, 7, v111
    v_lshlrev_b32 v111, 4, v111
    v_xor_b32 v123, 96, v125
    ds_write_b128 v123, v[24:27]
    v_lshl_add_u32 v111, v110, 7, v111
    v_lshl_add_u32 v120, v109, 11, v111
    v_add_u32 v121, 65536, v120
    v_add_u32 v64, 131072, v120
    s_lshl_b32 s36, s20, 9
    s_add_u32 s36, s36, 115712
    v_lshl_add_u32 v127, v109, 7, s36
    s_lshl_b32 s36, s20, 4
    v_add_u32 v108, s36, v108
    v_lshlrev_b32 v110, 6, v108
    v_lshl_add_u32 v110, v109, 4, v110
    s_mul_i32 s36, s29, 524288
    v_xor_b32 v124, 96, v126
    ds_write_b128 v124, v[56:59]
    s_lshl_b32 s37, s21, 4
    s_add_u32 s36, s36, s37
    v_add_u32 v110, s36, v110
    v_mov_b32 v111, 2130706432
    v_cmp_gt_u32 vcc, 125, v108
    s_mov_b32 s4, 0xbeaaaaab
    s_mov_b32 s5, s4
    s_mov_b32 s6, 0x3e800000
    s_mov_b32 s7, s6
    s_mov_b32 s8, 0xc0a00000
    s_mov_b32 s9, s8
    s_mov_b32 s10, 0xc0638e39
    v_xor_b32 v124, 112, v125
    ds_write_b128 v124, v[28:31]
    s_mov_b32 s11, s10
    s_mov_b32 s12, 0xbf638e39
    s_mov_b32 s13, s12
    s_mov_b32 s14, 0xbe638e39
    s_mov_b32 s15, s14
    s_mov_b32 s22, 0xbd638e39
    s_mov_b32 s23, s22
    s_mov_b32 s24, 0x3ff1c71c
    s_mov_b32 s25, s24
    s_mov_b32 s26, 0xbf2aaaab
    s_mov_b32 s27, s26
    s_mov_b32 s32, 0x3ecccccd
    v_xor_b32 v123, 112, v126
    s_waitcnt lgkmcnt(8)
    ds_write_b128 v123, v[60:63]
    s_mov_b32 s33, s32
    s_mov_b32 s34, 0xbd888889
    s_mov_b32 s35, s34
    s_mov_b32 s38, 0xbe4ccccd
    s_mov_b32 s39, s38
    s_mov_b32 s40, 0xbdd2d3e8
    s_mov_b32 s41, s40
    s_mov_b32 s42, 0x3f800000
    s_mov_b32 s43, s42
    s_setprio 0
    s_branch L_conv1_kernel_epi
L_conv1_kernel_m2:
    s_mul_i32 s37, s38, 2176
    s_add_u32 s37, s37, 98304
    v_add_u32 v116, s37, v8
    v_add_u32 v118, s37, v9
    v_add_u32 v117, 104832, v8
    s_cmp_eq_u32 s38, 0
    s_cbranch_scc1 L_conv1_kernel_hh0
    v_add_u32 v117, 98304, v9
L_conv1_kernel_hh0:
    s_lshl_b32 s37, s38, 12
    s_add_u32 s37, s37, s43
    s_add_u32 s37, s37, 49152
    v_lshl_add_u32 v119, v127, 4, s37
    v_mov_b32 v0, 0
    v_mov_b32 v1, 0
    v_mov_b32 v2, 0
    v_mov_b32 v3, 0
    v_mov_b32 v4, 0
    v_mov_b32 v5, 0
    v_mov_b32 v6, 0
    v_mov_b32 v7, 0
    v_mov_b32 v8, 0
    v_mov_b32 v9, 0
    v_mov_b32 v10, 0
    v_mov_b32 v11, 0
    v_mov_b32 v12, 0
    v_mov_b32 v13, 0
    v_mov_b32 v14, 0
    v_mov_b32 v15, 0
    v_mov_b32 v16, 0
    v_mov_b32 v17, 0
    v_mov_b32 v18, 0
    v_mov_b32 v19, 0
    v_mov_b32 v20, 0
    v_mov_b32 v21, 0
    v_mov_b32 v22, 0
    v_mov_b32 v23, 0
    v_mov_b32 v24, 0
    v_mov_b32 v25, 0
    v_mov_b32 v26, 0
    v_mov_b32 v27, 0
    v_mov_b32 v28, 0
    v_mov_b32 v29, 0
    v_mov_b32 v30, 0
    v_mov_b32 v31, 0
    v_mov_b32 v32, 0
    v_mov_b32 v33, 0
    v_mov_b32 v34, 0
    v_mov_b32 v35, 0
    v_mov_b32 v36, 0
    v_mov_b32 v37, 0
    v_mov_b32 v38, 0
    v_mov_b32 v39, 0
    v_mov_b32 v40, 0
    v_mov_b32 v41, 0
    v_mov_b32 v42, 0
    v_mov_b32 v43, 0
    v_mov_b32 v44, 0
    v_mov_b32 v45, 0
    v_mov_b32 v46, 0
    v_mov_b32 v47, 0
    v_mov_b32 v48, 0
    v_mov_b32 v49, 0
    v_mov_b32 v50, 0
    v_mov_b32 v51, 0
    v_mov_b32 v52, 0
    v_mov_b32 v53, 0
    v_mov_b32 v54, 0
    v_mov_b32 v55, 0
    v_mov_b32 v56, 0
    v_mov_b32 v57, 0
    v_mov_b32 v58, 0
    v_mov_b32 v59, 0
    v_mov_b32 v60, 0
    v_mov_b32 v61, 0
    v_mov_b32 v62, 0
    v_mov_b32 v63, 0
    buffer_load_dwordx4 v[96:99], v108, s[8:11], 0 offen
    buffer_load_dwordx4 v[100:103], v109, s[8:11], 0 offen
    buffer_load_dwordx4 v[104:107], v110, s[8:11], 0 offen
    s_mov_b32 s23, 0
    s_mov_b32 s26, 4096
    buffer_load_dwordx4 v[64:67], v125, s[12:15], s23 offen offset:0
    buffer_load_dwordx4 v[68:71], v125, s[12:15], s23 offen offset:2048
    buffer_load_dwordx4 v[80:83], v119, s[12:15], s23 offen offset:0
    buffer_load_dwordx4 v[72:75], v125, s[12:15], s26 offen offset:0
    buffer_load_dwordx4 v[84:87], v119, s[12:15], s23 offen offset:2048
    buffer_load_dwordx4 v[76:79], v125, s[12:15], s26 offen offset:2048
    s_mov_b32 s23, 57344
    s_mov_b32 s26, 61440
    s_waitcnt vmcnt(6)
    v_lshlrev_b32 v108, 16, v96
    v_and_b32 v111, s25, v96
    v_lshlrev_b32 v109, 16, v100
    v_and_b32 v112, s25, v100
    v_lshlrev_b32 v110, 16, v104
    v_and_b32 v113, s25, v104
    v_mul_f32 v114, s44, v108
    v_mul_f32 v115, s44, v111
    v_fmac_f32 v114, s45, v109
    v_fmac_f32 v115, s45, v112
    v_fmac_f32 v114, s46, v110
    v_fmac_f32 v115, s46, v113
    v_cvt_pk_bf16_f32 v96, v114, v115
    v_lshlrev_b32 v108, 16, v97
    v_and_b32 v111, s25, v97
    v_lshlrev_b32 v109, 16, v101
    v_and_b32 v112, s25, v101
    v_lshlrev_b32 v110, 16, v105
    v_and_b32 v113, s25, v105
    v_mul_f32 v114, s44, v108
    v_mul_f32 v115, s44, v111
    v_fmac_f32 v114, s45, v109
    v_fmac_f32 v115, s45, v112
    v_fmac_f32 v114, s46, v110
    v_fmac_f32 v115, s46, v113
    v_cvt_pk_bf16_f32 v97, v114, v115
    v_lshlrev_b32 v108, 16, v98
    v_and_b32 v111, s25, v98
    v_lshlrev_b32 v109, 16, v102
    v_and_b32 v112, s25, v102
    v_lshlrev_b32 v110, 16, v106
    v_and_b32 v113, s25, v106
    v_mul_f32 v114, s44, v108
    v_mul_f32 v115, s44, v111
    v_fmac_f32 v114, s45, v109
    v_fmac_f32 v115, s45, v112
    v_fmac_f32 v114, s46, v110
    v_fmac_f32 v115, s46, v113
    v_cvt_pk_bf16_f32 v98, v114, v115
    v_lshlrev_b32 v108, 16, v99
    v_and_b32 v111, s25, v99
    v_lshlrev_b32 v109, 16, v103
    v_and_b32 v112, s25, v103
    v_lshlrev_b32 v110, 16, v107
    v_and_b32 v113, s25, v107
    v_mul_f32 v114, s44, v108
    v_mul_f32 v115, s44, v111
    v_fmac_f32 v114, s45, v109
    v_fmac_f32 v115, s45, v112
    v_fmac_f32 v114, s46, v110
    v_fmac_f32 v115, s46, v113
    v_cvt_pk_bf16_f32 v99, v114, v115
    ds_write_b128 v126, v[96:99]
    v_and_b32 v111, 15, v127
    v_lshlrev_b32 v111, 2, v111
    v_add_u32 v111, 99328, v111
    ds_write_b32 v111, v0
    ds_write_b32 v111, v0 offset:8704
    s_waitcnt lgkmcnt(0)
    s_barrier
    s_mov_b32 s22, 8
    s_setprio 2
L_conv1_kernel_mloop2:
    ds_read_b128 v[88:91], v120 offset:0
    ds_read_b128 v[92:95], v120 offset:1024
    ds_read_b128 v[96:99], v116 offset:0
    ds_read_b128 v[100:103], v120 offset:2048
    ds_read_b128 v[104:107], v116 offset:1088
    ds_read_b128 v[108:111], v120 offset:3072
    ds_read_b128 v[112:115], v116 offset:2176
    s_waitcnt vmcnt(5) lgkmcnt(6)
    v_mfma_f32_16x16x32_bf16 v[0:3], v[64:67], v[88:91], v[0:3]
    ds_read_b128 v[88:91], v120 offset:4096
    s_waitcnt vmcnt(4) lgkmcnt(6)
    v_mfma_f32_16x16x32_bf16 v[4:7], v[64:67], v[92:95], v[4:7]
    v_mfma_f32_16x16x32_bf16 v[0:3], v[68:71], v[92:95], v[0:3]
    ds_read_b128 v[92:95], v116 offset:3264
    s_waitcnt vmcnt(3) lgkmcnt(6)
    v_mfma_f32_16x16x32_bf16 v[32:35], v[80:83], v[96:99], v[32:35]
    ds_read_b128 v[96:99], v120 offset:5120
    s_waitcnt vmcnt(2) lgkmcnt(6)
    v_mfma_f32_16x16x32_bf16 v[8:11], v[64:67], v[100:103], v[8:11]
    v_mfma_f32_16x16x32_bf16 v[4:7], v[68:71], v[100:103], v[4:7]
    v_mfma_f32_16x16x32_bf16 v[0:3], v[72:75], v[100:103], v[0:3]
    ds_read_b128 v[100:103], v116 offset:4352
    s_waitcnt vmcnt(1) lgkmcnt(6)
    v_mfma_f32_16x16x32_bf16 v[36:39], v[80:83], v[104:107], v[36:39]
    v_mfma_f32_16x16x32_bf16 v[32:35], v[84:87], v[104:107], v[32:35]
    ds_read_b128 v[104:107], v120 offset:6144
    s_waitcnt vmcnt(0) lgkmcnt(6)
    v_mfma_f32_16x16x32_bf16 v[12:15], v[64:67], v[108:111], v[12:15]
    v_mfma_f32_16x16x32_bf16 v[8:11], v[68:71], v[108:111], v[8:11]
    v_mfma_f32_16x16x32_bf16 v[4:7], v[72:75], v[108:111], v[4:7]
    v_mfma_f32_16x16x32_bf16 v[0:3], v[76:79], v[108:111], v[0:3]
    ds_read_b128 v[108:111], v116 offset:5440
    s_waitcnt lgkmcnt(6)
    v_mfma_f32_16x16x32_bf16 v[40:43], v[80:83], v[112:115], v[40:43]
    v_mfma_f32_16x16x32_bf16 v[36:39], v[84:87], v[112:115], v[36:39]
    ds_read_b128 v[112:115], v120 offset:7168
    s_waitcnt lgkmcnt(6)
    v_mfma_f32_16x16x32_bf16 v[16:19], v[64:67], v[88:91], v[16:19]
    v_mfma_f32_16x16x32_bf16 v[12:15], v[68:71], v[88:91], v[12:15]
    v_mfma_f32_16x16x32_bf16 v[8:11], v[72:75], v[88:91], v[8:11]
    v_mfma_f32_16x16x32_bf16 v[4:7], v[76:79], v[88:91], v[4:7]
    ds_read_b128 v[88:91], v117 offset:0
    s_waitcnt lgkmcnt(6)
    v_mfma_f32_16x16x32_bf16 v[44:47], v[80:83], v[92:95], v[44:47]
    v_mfma_f32_16x16x32_bf16 v[40:43], v[84:87], v[92:95], v[40:43]
    ds_read_b128 v[92:95], v122 offset:0
    v_add_u32 v122, v123, v122
    s_waitcnt lgkmcnt(6)
    v_mfma_f32_16x16x32_bf16 v[20:23], v[64:67], v[96:99], v[20:23]
    v_mfma_f32_16x16x32_bf16 v[16:19], v[68:71], v[96:99], v[16:19]
    v_mfma_f32_16x16x32_bf16 v[12:15], v[72:75], v[96:99], v[12:15]
    v_mfma_f32_16x16x32_bf16 v[8:11], v[76:79], v[96:99], v[8:11]
    ds_read_b128 v[96:99], v117 offset:1088
    s_waitcnt lgkmcnt(6)
    v_mfma_f32_16x16x32_bf16 v[48:51], v[80:83], v[100:103], v[48:51]
    v_mfma_f32_16x16x32_bf16 v[44:47], v[84:87], v[100:103], v[44:47]
    ds_read_b128 v[100:103], v121 offset:1024
    s_waitcnt lgkmcnt(6)
    v_mfma_f32_16x16x32_bf16 v[24:27], v[64:67], v[104:107], v[24:27]
    v_mfma_f32_16x16x32_bf16 v[20:23], v[68:71], v[104:107], v[20:23]
    v_mfma_f32_16x16x32_bf16 v[16:19], v[72:75], v[104:107], v[16:19]
    v_mfma_f32_16x16x32_bf16 v[12:15], v[76:79], v[104:107], v[12:15]
    ds_read_b128 v[104:107], v118 offset:0
    s_waitcnt lgkmcnt(6)
    v_mfma_f32_16x16x32_bf16 v[52:55], v[80:83], v[108:111], v[52:55]
    v_mfma_f32_16x16x32_bf16 v[48:51], v[84:87], v[108:111], v[48:51]
    ds_read_b128 v[108:111], v121 offset:2048
    s_waitcnt lgkmcnt(6)
    v_mfma_f32_16x16x32_bf16 v[28:31], v[64:67], v[112:115], v[28:31]
    v_mfma_f32_16x16x32_bf16 v[24:27], v[68:71], v[112:115], v[24:27]
    v_mfma_f32_16x16x32_bf16 v[20:23], v[72:75], v[112:115], v[20:23]
    v_mfma_f32_16x16x32_bf16 v[16:19], v[76:79], v[112:115], v[16:19]
    buffer_load_dwordx4 v[64:67], v125, s[12:15], s23 offen offset:0
    s_waitcnt lgkmcnt(5)
    v_mfma_f32_16x16x32_bf16 v[56:59], v[80:83], v[88:91], v[56:59]
    v_mfma_f32_16x16x32_bf16 v[52:55], v[84:87], v[88:91], v[52:55]
    s_waitcnt lgkmcnt(0)
    s_barrier
    v_mfma_f32_16x16x32_bf16 v[28:31], v[68:71], v[92:95], v[28:31]
    v_mfma_f32_16x16x32_bf16 v[24:27], v[72:75], v[92:95], v[24:27]
    v_mfma_f32_16x16x32_bf16 v[20:23], v[76:79], v[92:95], v[20:23]
    buffer_load_dwordx4 v[68:71], v125, s[12:15], s23 offen offset:2048
    v_mfma_f32_16x16x32_bf16 v[60:63], v[80:83], v[96:99], v[60:63]
    v_mfma_f32_16x16x32_bf16 v[56:59], v[84:87], v[96:99], v[56:59]
    buffer_load_dwordx4 v[80:83], v119, s[12:15], s23 offen offset:0
    v_mfma_f32_16x16x32_bf16 v[28:31], v[72:75], v[100:103], v[28:31]
    v_mfma_f32_16x16x32_bf16 v[24:27], v[76:79], v[100:103], v[24:27]
    buffer_load_dwordx4 v[72:75], v125, s[12:15], s26 offen offset:0
    v_mfma_f32_16x16x32_bf16 v[60:63], v[84:87], v[104:107], v[60:63]
    buffer_load_dwordx4 v[84:87], v119, s[12:15], s23 offen offset:2048
    v_mfma_f32_16x16x32_bf16 v[28:31], v[76:79], v[108:111], v[28:31]
    buffer_load_dwordx4 v[76:79], v125, s[12:15], s26 offen offset:2048
    s_add_u32 s23, s23, 57344
    s_add_u32 s26, s26, 57344
    s_sub_u32 s22, s22, 1
    s_cmp_eq_u32 s22, 0
    s_cbranch_scc1 L_conv1_kernel_mlast2
    ds_read_b128 v[88:91], v120 offset:8192
    ds_read_b128 v[92:95], v120 offset:9216
    ds_read_b128 v[96:99], v116 offset:8704
    ds_read_b128 v[100:103], v120 offset:10240
    ds_read_b128 v[104:107], v116 offset:9792
    ds_read_b128 v[108:111], v120 offset:11264
    ds_read_b128 v[112:115], v116 offset:10880
    s_waitcnt vmcnt(5) lgkmcnt(6)
    v_mfma_f32_16x16x32_bf16 v[0:3], v[64:67], v[88:91], v[0:3]
    ds_read_b128 v[88:91], v120 offset:12288
    s_waitcnt vmcnt(4) lgkmcnt(6)
    v_mfma_f32_16x16x32_bf16 v[4:7], v[64:67], v[92:95], v[4:7]
    v_mfma_f32_16x16x32_bf16 v[0:3], v[68:71], v[92:95], v[0:3]
    ds_read_b128 v[92:95], v116 offset:11968
    s_waitcnt vmcnt(3) lgkmcnt(6)
    v_mfma_f32_16x16x32_bf16 v[32:35], v[80:83], v[96:99], v[32:35]
    ds_read_b128 v[96:99], v120 offset:13312
    s_waitcnt vmcnt(2) lgkmcnt(6)
    v_mfma_f32_16x16x32_bf16 v[8:11], v[64:67], v[100:103], v[8:11]
    v_mfma_f32_16x16x32_bf16 v[4:7], v[68:71], v[100:103], v[4:7]
    v_mfma_f32_16x16x32_bf16 v[0:3], v[72:75], v[100:103], v[0:3]
    ds_read_b128 v[100:103], v116 offset:13056
    s_waitcnt vmcnt(1) lgkmcnt(6)
    v_mfma_f32_16x16x32_bf16 v[36:39], v[80:83], v[104:107], v[36:39]
    v_mfma_f32_16x16x32_bf16 v[32:35], v[84:87], v[104:107], v[32:35]
    ds_read_b128 v[104:107], v120 offset:14336
    s_waitcnt vmcnt(0) lgkmcnt(6)
    v_mfma_f32_16x16x32_bf16 v[12:15], v[64:67], v[108:111], v[12:15]
    v_mfma_f32_16x16x32_bf16 v[8:11], v[68:71], v[108:111], v[8:11]
    v_mfma_f32_16x16x32_bf16 v[4:7], v[72:75], v[108:111], v[4:7]
    v_mfma_f32_16x16x32_bf16 v[0:3], v[76:79], v[108:111], v[0:3]
    ds_read_b128 v[108:111], v116 offset:14144
    s_waitcnt lgkmcnt(6)
    v_mfma_f32_16x16x32_bf16 v[40:43], v[80:83], v[112:115], v[40:43]
    v_mfma_f32_16x16x32_bf16 v[36:39], v[84:87], v[112:115], v[36:39]
    ds_read_b128 v[112:115], v120 offset:15360
    s_waitcnt lgkmcnt(6)
    v_mfma_f32_16x16x32_bf16 v[16:19], v[64:67], v[88:91], v[16:19]
    v_mfma_f32_16x16x32_bf16 v[12:15], v[68:71], v[88:91], v[12:15]
    v_mfma_f32_16x16x32_bf16 v[8:11], v[72:75], v[88:91], v[8:11]
    v_mfma_f32_16x16x32_bf16 v[4:7], v[76:79], v[88:91], v[4:7]
    ds_read_b128 v[88:91], v117 offset:8704
    s_waitcnt lgkmcnt(6)
    v_mfma_f32_16x16x32_bf16 v[44:47], v[80:83], v[92:95], v[44:47]
    v_mfma_f32_16x16x32_bf16 v[40:43], v[84:87], v[92:95], v[40:43]
    ds_read_b128 v[92:95], v122 offset:0
    v_add_u32 v122, v124, v122
    s_waitcnt lgkmcnt(6)
    v_mfma_f32_16x16x32_bf16 v[20:23], v[64:67], v[96:99], v[20:23]
    v_mfma_f32_16x16x32_bf16 v[16:19], v[68:71], v[96:99], v[16:19]
    v_mfma_f32_16x16x32_bf16 v[12:15], v[72:75], v[96:99], v[12:15]
    v_mfma_f32_16x16x32_bf16 v[8:11], v[76:79], v[96:99], v[8:11]
    ds_read_b128 v[96:99], v117 offset:9792
    s_waitcnt lgkmcnt(6)
    v_mfma_f32_16x16x32_bf16 v[48:51], v[80:83], v[100:103], v[48:51]
    v_mfma_f32_16x16x32_bf16 v[44:47], v[84:87], v[100:103], v[44:47]
    ds_read_b128 v[100:103], v121 offset:9216
    s_waitcnt lgkmcnt(6)
    v_mfma_f32_16x16x32_bf16 v[24:27], v[64:67], v[104:107], v[24:27]
    v_mfma_f32_16x16x32_bf16 v[20:23], v[68:71], v[104:107], v[20:23]
    v_mfma_f32_16x16x32_bf16 v[16:19], v[72:75], v[104:107], v[16:19]
    v_mfma_f32_16x16x32_bf16 v[12:15], v[76:79], v[104:107], v[12:15]
    ds_read_b128 v[104:107], v118 offset:8704
    s_waitcnt lgkmcnt(6)
    v_mfma_f32_16x16x32_bf16 v[52:55], v[80:83], v[108:111], v[52:55]
    v_mfma_f32_16x16x32_bf16 v[48:51], v[84:87], v[108:111], v[48:51]
    ds_read_b128 v[108:111], v121 offset:10240
    s_waitcnt lgkmcnt(6)
    v_mfma_f32_16x16x32_bf16 v[28:31], v[64:67], v[112:115], v[28:31]
    v_mfma_f32_16x16x32_bf16 v[24:27], v[68:71], v[112:115], v[24:27]
    v_mfma_f32_16x16x32_bf16 v[20:23], v[72:75], v[112:115], v[20:23]
    v_mfma_f32_16x16x32_bf16 v[16:19], v[76:79], v[112:115], v[16:19]
    buffer_load_dwordx4 v[64:67], v125, s[12:15], s23 offen offset:0
    s_waitcnt lgkmcnt(5)
    v_mfma_f32_16x16x32_bf16 v[56:59], v[80:83], v[88:91], v[56:59]
    v_mfma_f32_16x16x32_bf16 v[52:55], v[84:87], v[88:91], v[52:55]
    s_waitcnt lgkmcnt(0)
    s_barrier
    v_mfma_f32_16x16x32_bf16 v[28:31], v[68:71], v[92:95], v[28:31]
    v_mfma_f32_16x16x32_bf16 v[24:27], v[72:75], v[92:95], v[24:27]
    v_mfma_f32_16x16x32_bf16 v[20:23], v[76:79], v[92:95], v[20:23]
    buffer_load_dwordx4 v[68:71], v125, s[12:15], s23 offen offset:2048
    v_mfma_f32_16x16x32_bf16 v[60:63], v[80:83], v[96:99], v[60:63]
    v_mfma_f32_16x16x32_bf16 v[56:59], v[84:87], v[96:99], v[56:59]
    buffer_load_dwordx4 v[80:83], v119, s[12:15], s23 offen offset:0
    v_mfma_f32_16x16x32_bf16 v[28:31], v[72:75], v[100:103], v[28:31]
    v_mfma_f32_16x16x32_bf16 v[24:27], v[76:79], v[100:103], v[24:27]
    buffer_load_dwordx4 v[72:75], v125, s[12:15], s26 offen offset:0
    v_mfma_f32_16x16x32_bf16 v[60:63], v[84:87], v[104:107], v[60:63]
    buffer_load_dwordx4 v[84:87], v119, s[12:15], s23 offen offset:2048
    v_mfma_f32_16x16x32_bf16 v[28:31], v[76:79], v[108:111], v[28:31]
    buffer_load_dwordx4 v[76:79], v125, s[12:15], s26 offen offset:2048
    s_add_u32 s23, s23, 57344
    s_add_u32 s26, s26, 57344
    s_branch L_conv1_kernel_mloop2
L_conv1_kernel_mlast2:
    v_and_b32 v125, 15, v127
    v_and_b32 v126, 7, v127
    v_lshlrev_b32 v126, 4, v126
    v_lshl_add_u32 v125, v125, 7, v126
    v_lshrrev_b32 v126, 4, v127
    v_lshl_add_u32 v125, v126, 11, v125
    s_mov_b32 s36, 65536
    s_cmp_eq_u32 s32, 1
    s_cselect_b32 s36, 121856, s36
    s_cmp_eq_u32 s32, 2
    s_cselect_b32 s36, 81920, s36
    s_cmp_eq_u32 s32, 3
    s_cselect_b32 s36, 130048, s36
    s_mov_b32 s37, 98304
    s_cmp_eq_u32 s32, 1
    s_cselect_b32 s37, 138240, s37
    s_cmp_eq_u32 s32, 2
    s_cselect_b32 s37, 146432, s37
    s_cmp_eq_u32 s32, 3
    s_cselect_b32 s37, 154624, s37
    v_add_u32 v126, s37, v125
    v_add_u32 v125, s36, v125
    ds_read_b128 v[88:91], v120 offset:8192
    ds_read_b128 v[92:95], v120 offset:9216
    ds_read_b128 v[96:99], v116 offset:8704
    ds_read_b128 v[100:103], v120 offset:10240
    ds_read_b128 v[104:107], v116 offset:9792
    ds_read_b128 v[108:111], v120 offset:11264
    ds_read_b128 v[112:115], v116 offset:10880
    s_waitcnt vmcnt(5) lgkmcnt(6)
    v_mfma_f32_16x16x32_bf16 v[0:3], v[64:67], v[88:91], v[0:3]
    ds_read_b128 v[88:91], v120 offset:12288
    s_waitcnt vmcnt(4) lgkmcnt(6)
    v_mfma_f32_16x16x32_bf16 v[4:7], v[64:67], v[92:95], v[4:7]
    v_mfma_f32_16x16x32_bf16 v[0:3], v[68:71], v[92:95], v[0:3]
    ds_read_b128 v[92:95], v116 offset:11968
    s_waitcnt vmcnt(3) lgkmcnt(6)
    v_mfma_f32_16x16x32_bf16 v[32:35], v[80:83], v[96:99], v[32:35]
    ds_read_b128 v[96:99], v120 offset:13312
    s_waitcnt vmcnt(2) lgkmcnt(6)
    v_mfma_f32_16x16x32_bf16 v[8:11], v[64:67], v[100:103], v[8:11]
    v_mfma_f32_16x16x32_bf16 v[4:7], v[68:71], v[100:103], v[4:7]
    v_mfma_f32_16x16x32_bf16 v[0:3], v[72:75], v[100:103], v[0:3]
    ds_read_b128 v[100:103], v116 offset:13056
    s_waitcnt vmcnt(1) lgkmcnt(6)
    v_mfma_f32_16x16x32_bf16 v[36:39], v[80:83], v[104:107], v[36:39]
    v_mfma_f32_16x16x32_bf16 v[32:35], v[84:87], v[104:107], v[32:35]
    ds_read_b128 v[104:107], v120 offset:14336
    s_waitcnt vmcnt(0) lgkmcnt(6)
    v_mfma_f32_16x16x32_bf16 v[12:15], v[64:67], v[108:111], v[12:15]
    v_mfma_f32_16x16x32_bf16 v[8:11], v[68:71], v[108:111], v[8:11]
    v_mfma_f32_16x16x32_bf16 v[4:7], v[72:75], v[108:111], v[4:7]
    v_mfma_f32_16x16x32_bf16 v[0:3], v[76:79], v[108:111], v[0:3]
    ds_read_b128 v[108:111], v116 offset:14144
    s_waitcnt lgkmcnt(6)
    v_mfma_f32_16x16x32_bf16 v[40:43], v[80:83], v[112:115], v[40:43]
    v_mfma_f32_16x16x32_bf16 v[36:39], v[84:87], v[112:115], v[36:39]
    ds_read_b128 v[112:115], v120 offset:15360
    s_waitcnt lgkmcnt(6)
    v_mfma_f32_16x16x32_bf16 v[16:19], v[64:67], v[88:91], v[16:19]
    v_mfma_f32_16x16x32_bf16 v[12:15], v[68:71], v[88:91], v[12:15]
    v_mfma_f32_16x16x32_bf16 v[8:11], v[72:75], v[88:91], v[8:11]
    v_mfma_f32_16x16x32_bf16 v[4:7], v[76:79], v[88:91], v[4:7]
    ds_read_b128 v[88:91], v117 offset:8704
    v_xor_b32 v124, 0, v126
    ds_write_b128 v124, v[32:35]
    s_waitcnt lgkmcnt(7)
    v_mfma_f32_16x16x32_bf16 v[44:47], v[80:83], v[92:95], v[44:47]
    v_mfma_f32_16x16x32_bf16 v[40:43], v[84:87], v[92:95], v[40:43]
    ds_read_b128 v[92:95], v122 offset:0
    v_xor_b32 v123, 0, v125
    ds_write_b128 v123, v[0:3]
    s_waitcnt lgkmcnt(8)
    v_mfma_f32_16x16x32_bf16 v[20:23], v[64:67], v[96:99], v[20:23]
    v_mfma_f32_16x16x32_bf16 v[16:19], v[68:71], v[96:99], v[16:19]
    v_mfma_f32_16x16x32_bf16 v[12:15], v[72:75], v[96:99], v[12:15]
    v_mfma_f32_16x16x32_bf16 v[8:11], v[76:79], v[96:99], v[8:11]
    ds_read_b128 v[96:99], v117 offset:9792
    v_xor_b32 v123, 16, v126
    ds_write_b128 v123, v[36:39]
    s_waitcnt lgkmcnt(9)
    v_mfma_f32_16x16x32_bf16 v[48:51], v[80:83], v[100:103], v[48:51]
    v_mfma_f32_16x16x32_bf16 v[44:47], v[84:87], v[100:103], v[44:47]
    ds_read_b128 v[100:103], v121 offset:9216
    v_xor_b32 v124, 16, v125
    ds_write_b128 v124, v[4:7]
    s_waitcnt lgkmcnt(10)
    v_mfma_f32_16x16x32_bf16 v[24:27], v[64:67], v[104:107], v[24:27]
    v_mfma_f32_16x16x32_bf16 v[20:23], v[68:71], v[104:107], v[20:23]
    v_mfma_f32_16x16x32_bf16 v[16:19], v[72:75], v[104:107], v[16:19]
    v_mfma_f32_16x16x32_bf16 v[12:15], v[76:79], v[104:107], v[12:15]
    ds_read_b128 v[104:107], v118 offset:8704
    v_xor_b32 v124, 32, v126
    ds_write_b128 v124, v[40:43]
    s_waitcnt lgkmcnt(11)
    v_mfma_f32_16x16x32_bf16 v[52:55], v[80:83], v[108:111], v[52:55]
    v_mfma_f32_16x16x32_bf16 v[48:51], v[84:87], v[108:111], v[48:51]
    ds_read_b128 v[108:111], v121 offset:10240
    v_xor_b32 v123, 32, v125
    ds_write_b128 v123, v[8:11]
    s_waitcnt lgkmcnt(12)
    v_mfma_f32_16x16x32_bf16 v[28:31], v[64:67], v[112:115], v[28:31]
    v_mfma_f32_16x16x32_bf16 v[24:27], v[68:71], v[112:115], v[24:27]
    v_mfma_f32_16x16x32_bf16 v[20:23], v[72:75], v[112:115], v[20:23]
    v_mfma_f32_16x16x32_bf16 v[16:19], v[76:79], v[112:115], v[16:19]
    v_xor_b32 v123, 48, v126
    ds_write_b128 v123, v[44:47]
    s_waitcnt lgkmcnt(12)
    v_mfma_f32_16x16x32_bf16 v[56:59], v[80:83], v[88:91], v[56:59]
    v_mfma_f32_16x16x32_bf16 v[52:55], v[84:87], v[88:91], v[52:55]
    v_xor_b32 v124, 48, v125
    ds_write_b128 v124, v[12:15]
    s_waitcnt lgkmcnt(11)
    v_mfma_f32_16x16x32_bf16 v[28:31], v[68:71], v[92:95], v[28:31]
    v_mfma_f32_16x16x32_bf16 v[24:27], v[72:75], v[92:95], v[24:27]
    v_mfma_f32_16x16x32_bf16 v[20:23], v[76:79], v[92:95], v[20:23]
    v_xor_b32 v124, 64, v126
    ds_write_b128 v124, v[48:51]
    s_waitcnt lgkmcnt(10)
    v_mfma_f32_16x16x32_bf16 v[60:63], v[80:83], v[96:99], v[60:63]
    v_mfma_f32_16x16x32_bf16 v[56:59], v[84:87], v[96:99], v[56:59]
    v_xor_b32 v123, 64, v125
    ds_write_b128 v123, v[16:19]
    s_waitcnt lgkmcnt(9)
    v_mfma_f32_16x16x32_bf16 v[28:31], v[72:75], v[100:103], v[28:31]
    v_mfma_f32_16x16x32_bf16 v[24:27], v[76:79], v[100:103], v[24:27]
    v_xor_b32 v123, 80, v126
    ds_write_b128 v123, v[52:55]
    s_waitcnt lgkmcnt(8)
    v_mfma_f32_16x16x32_bf16 v[60:63], v[84:87], v[104:107], v[60:63]
    v_xor_b32 v124, 80, v125
    ds_write_b128 v124, v[20:23]
    s_waitcnt lgkmcnt(7)
    v_mfma_f32_16x16x32_bf16 v[28:31], v[76:79], v[108:111], v[28:31]
    v_xor_b32 v124, 96, v126
    ds_write_b128 v124, v[56:59]
    v_and_b32 v108, 15, v127
    v_lshrrev_b32 v109, 4, v127
    v_lshrrev_b32 v110, 3, v108
    s_lshl_b32 s36, s20, 1
    v_add_u32 v110, s36, v110
    v_xor_b32 v111, v110, v108
    v_and_b32 v111, 7, v111
    v_lshlrev_b32 v111, 4, v111
    v_xor_b32 v123, 96, v125
    ds_write_b128 v123, v[24:27]
    v_lshl_add_u32 v111, v110, 7, v111
    v_lshl_add_u32 v120, v109, 11, v111
    v_add_u32 v121, 65536, v120
    v_add_u32 v64, 131072, v120
    s_lshl_b32 s36, s20, 9
    s_add_u32 s36, s36, 115712
    v_lshl_add_u32 v127, v109, 7, s36
    s_lshl_b32 s36, s20, 4
    v_add_u32 v108, s36, v108
    v_lshlrev_b32 v110, 6, v108
    v_lshl_add_u32 v110, v109, 4, v110
    s_mul_i32 s36, s29, 524288
    v_xor_b32 v123, 112, v126
    ds_write_b128 v123, v[60:63]
    s_lshl_b32 s37, s21, 4
    s_add_u32 s36, s36, s37
    v_add_u32 v110, s36, v110
    v_mov_b32 v111, 2130706432
    v_cmp_gt_u32 vcc, 125, v108
    s_mov_b32 s4, 0xbeaaaaab
    s_mov_b32 s5, s4
    s_mov_b32 s6, 0x3e800000
    s_mov_b32 s7, s6
    s_mov_b32 s8, 0xc0a00000
    s_mov_b32 s9, s8
    s_mov_b32 s10, 0xc0638e39
    v_xor_b32 v124, 112, v125
    ds_write_b128 v124, v[28:31]
    s_mov_b32 s11, s10
    s_mov_b32 s12, 0xbf638e39
    s_mov_b32 s13, s12
    s_mov_b32 s14, 0xbe638e39
    s_mov_b32 s15, s14
    s_mov_b32 s22, 0xbd638e39
    s_mov_b32 s23, s22
    s_mov_b32 s24, 0x3ff1c71c
    s_mov_b32 s25, s24
    s_mov_b32 s26, 0xbf2aaaab
    s_mov_b32 s27, s26
    s_mov_b32 s32, 0x3ecccccd
    s_mov_b32 s33, s32
    s_mov_b32 s34, 0xbd888889
    s_mov_b32 s35, s34
    s_mov_b32 s38, 0xbe4ccccd
    s_mov_b32 s39, s38
    s_mov_b32 s40, 0xbdd2d3e8
    s_mov_b32 s41, s40
    s_mov_b32 s42, 0x3f800000
    s_mov_b32 s43, s42
    s_setprio 0
    s_branch L_conv1_kernel_epi
L_conv1_kernel_helper:
    s_setprio 3
    v_add_u32 v92, 0, v7
    v_add_u32 v93, 1024, v7
    v_add_u32 v94, 2048, v7
    v_add_u32 v95, 3072, v7
    v_and_b32 v76, 4, v5
    v_lshrrev_b32 v76, 1, v76
    v_xor_b32 v76, v6, v76
    v_lshlrev_b32 v76, 4, v76
    v_lshl_add_u32 v76, v5, 6, v76
    s_mov_b32 s24, 0
    s_mov_b32 s27, 524288
    s_waitcnt lgkmcnt(0)
    s_add_u32 s8, s4, s47
    s_addc_u32 s9, s5, 0
    buffer_load_dwordx4 v[0:3], v92, s[8:11], s24 offen offset:0
    buffer_load_dwordx4 v[16:19], v92, s[8:11], s24 offen offset:64
    v_add_u32 v92, 128, v92
    buffer_load_dwordx4 v[4:7], v93, s[8:11], s24 offen offset:0
    buffer_load_dwordx4 v[20:23], v93, s[8:11], s24 offen offset:64
    v_add_u32 v93, 128, v93
    buffer_load_dwordx4 v[8:11], v94, s[8:11], s24 offen offset:0
    buffer_load_dwordx4 v[24:27], v94, s[8:11], s24 offen offset:64
    v_add_u32 v94, 128, v94
    buffer_load_dwordx4 v[12:15], v95, s[8:11], s24 offen offset:0
    buffer_load_dwordx4 v[28:31], v95, s[8:11], s24 offen offset:64
    v_add_u32 v95, 128, v95
    s_mul_i32 s36, s42, 1024
    v_add_u32 v96, s36, v76
    v_add_u32 v97, 65536, v96
    s_mul_i32 s36, s42, 1088
    s_add_u32 s36, s36, 98304
    v_add_u32 v98, s36, v76
    s_waitcnt vmcnt(0)
    s_mov_b32 s28, 0
    s_mov_b32 s22, 4
    s_cmp_ge_u32 s20, 12
    s_cbranch_scc1 L_conv1_kernel_h2
    ds_write_b128 v96, v[0:3] offset:0
    ds_write_b128 v98, v[12:15] offset:0
    v_lshlrev_b32 v76, 16, v0
    v_and_b32 v84, s25, v0
    v_lshlrev_b32 v77, 16, v4
    v_and_b32 v85, s25, v4
    v_lshlrev_b32 v78, 16, v8
    v_and_b32 v86, s25, v8
    v_lshlrev_b32 v79, 16, v12
    v_and_b32 v87, s25, v12
    v_add_f32 v80, v76, v78
    v_add_f32 v88, v84, v86
    v_add_f32 v81, v77, v79
    v_add_f32 v89, v85, v87
    v_fma_f32 v82, v78, 4.0, v76
    v_fma_f32 v90, v86, 4.0, v84
    v_fma_f32 v83, v79, 4.0, v77
    v_fma_f32 v91, v87, 4.0, v85
    v_add_f32 v77, v80, v81
    v_add_f32 v85, v88, v89
    v_sub_f32 v78, v80, v81
    v_sub_f32 v86, v88, v89
    v_fma_f32 v79, v83, 2.0, v82
    v_fma_f32 v87, v91, 2.0, v90
    v_fma_f32 v82, v83, -2.0, v82
    v_fma_f32 v90, v91, -2.0, v90
    v_fmamk_f32 v80, v76, 0x41700000, v82
    v_fmamk_f32 v88, v84, 0x41700000, v90
    v_fmamk_f32 v80, v81, 0x41200000, v80
    v_fmamk_f32 v88, v89, 0x41200000, v88
    v_cvt_pk_bf16_f32 v4, v77, v85
    v_cvt_pk_bf16_f32 v8, v78, v86
    v_cvt_pk_bf16_f32 v64, v79, v87
    v_cvt_pk_bf16_f32 v68, v82, v90
    v_cvt_pk_bf16_f32 v72, v80, v88
    v_lshlrev_b32 v76, 16, v1
    v_and_b32 v84, s25, v1
    v_lshlrev_b32 v77, 16, v5
    v_and_b32 v85, s25, v5
    v_lshlrev_b32 v78, 16, v9
    v_and_b32 v86, s25, v9
    v_lshlrev_b32 v79, 16, v13
    v_and_b32 v87, s25, v13
    v_add_f32 v80, v76, v78
    v_add_f32 v88, v84, v86
    v_add_f32 v81, v77, v79
    v_add_f32 v89, v85, v87
    v_fma_f32 v82, v78, 4.0, v76
    v_fma_f32 v90, v86, 4.0, v84
    v_fma_f32 v83, v79, 4.0, v77
    v_fma_f32 v91, v87, 4.0, v85
    v_add_f32 v77, v80, v81
    v_add_f32 v85, v88, v89
    v_sub_f32 v78, v80, v81
    v_sub_f32 v86, v88, v89
    v_fma_f32 v79, v83, 2.0, v82
    v_fma_f32 v87, v91, 2.0, v90
    v_fma_f32 v82, v83, -2.0, v82
    v_fma_f32 v90, v91, -2.0, v90
    v_fmamk_f32 v80, v76, 0x41700000, v82
    v_fmamk_f32 v88, v84, 0x41700000, v90
    v_fmamk_f32 v80, v81, 0x41200000, v80
    v_fmamk_f32 v88, v89, 0x41200000, v88
    v_cvt_pk_bf16_f32 v5, v77, v85
    v_cvt_pk_bf16_f32 v9, v78, v86
    v_cvt_pk_bf16_f32 v65, v79, v87
    v_cvt_pk_bf16_f32 v69, v82, v90
    v_cvt_pk_bf16_f32 v73, v80, v88
    v_lshlrev_b32 v76, 16, v2
    v_and_b32 v84, s25, v2
    v_lshlrev_b32 v77, 16, v6
    v_and_b32 v85, s25, v6
    v_lshlrev_b32 v78, 16, v10
    v_and_b32 v86, s25, v10
    v_lshlrev_b32 v79, 16, v14
    v_and_b32 v87, s25, v14
    v_add_f32 v80, v76, v78
    v_add_f32 v88, v84, v86
    v_add_f32 v81, v77, v79
    v_add_f32 v89, v85, v87
    v_fma_f32 v82, v78, 4.0, v76
    v_fma_f32 v90, v86, 4.0, v84
    v_fma_f32 v83, v79, 4.0, v77
    v_fma_f32 v91, v87, 4.0, v85
    v_add_f32 v77, v80, v81
    v_add_f32 v85, v88, v89
    v_sub_f32 v78, v80, v81
    v_sub_f32 v86, v88, v89
    v_fma_f32 v79, v83, 2.0, v82
    v_fma_f32 v87, v91, 2.0, v90
    v_fma_f32 v82, v83, -2.0, v82
    v_fma_f32 v90, v91, -2.0, v90
    v_fmamk_f32 v80, v76, 0x41700000, v82
    v_fmamk_f32 v88, v84, 0x41700000, v90
    v_fmamk_f32 v80, v81, 0x41200000, v80
    v_fmamk_f32 v88, v89, 0x41200000, v88
    v_cvt_pk_bf16_f32 v6, v77, v85
    v_cvt_pk_bf16_f32 v10, v78, v86
    v_cvt_pk_bf16_f32 v66, v79, v87
    v_cvt_pk_bf16_f32 v70, v82, v90
    v_cvt_pk_bf16_f32 v74, v80, v88
    v_lshlrev_b32 v76, 16, v3
    v_and_b32 v84, s25, v3
    v_lshlrev_b32 v77, 16, v7
    v_and_b32 v85, s25, v7
    v_lshlrev_b32 v78, 16, v11
    v_and_b32 v86, s25, v11
    v_lshlrev_b32 v79, 16, v15
    v_and_b32 v87, s25, v15
    v_add_f32 v80, v76, v78
    v_add_f32 v88, v84, v86
    v_add_f32 v81, v77, v79
    v_add_f32 v89, v85, v87
    v_fma_f32 v82, v78, 4.0, v76
    v_fma_f32 v90, v86, 4.0, v84
    v_fma_f32 v83, v79, 4.0, v77
    v_fma_f32 v91, v87, 4.0, v85
    v_add_f32 v77, v80, v81
    v_add_f32 v85, v88, v89
    v_sub_f32 v78, v80, v81
    v_sub_f32 v86, v88, v89
    v_fma_f32 v79, v83, 2.0, v82
    v_fma_f32 v87, v91, 2.0, v90
    v_fma_f32 v82, v83, -2.0, v82
    v_fma_f32 v90, v91, -2.0, v90
    v_fmamk_f32 v80, v76, 0x41700000, v82
    v_fmamk_f32 v88, v84, 0x41700000, v90
    v_fmamk_f32 v80, v81, 0x41200000, v80
    v_fmamk_f32 v88, v89, 0x41200000, v88
    v_cvt_pk_bf16_f32 v7, v77, v85
    v_cvt_pk_bf16_f32 v11, v78, v86
    v_cvt_pk_bf16_f32 v67, v79, v87
    v_cvt_pk_bf16_f32 v71, v82, v90
    v_cvt_pk_bf16_f32 v75, v80, v88
    ds_write_b128 v96, v[64:67] offset:49152
    ds_write_b128 v97, v[68:71] offset:0
    ds_write_b128 v97, v[72:75] offset:16384
    ds_write_b128 v96, v[4:7] offset:16384
    ds_write_b128 v96, v[8:11] offset:32768
    s_waitcnt vmcnt(0)
    s_waitcnt lgkmcnt(0)
    s_barrier
    buffer_load_dwordx4 v[32:35], v92, s[8:11], s24 offen offset:0
    buffer_load_dwordx4 v[48:51], v92, s[8:11], s24 offen offset:64
    v_add_u32 v92, 128, v92
    buffer_load_dwordx4 v[36:39], v93, s[8:11], s24 offen offset:0
    buffer_load_dwordx4 v[52:55], v93, s[8:11], s24 offen offset:64
    v_add_u32 v93, 128, v93
    buffer_load_dwordx4 v[40:43], v94, s[8:11], s24 offen offset:0
    buffer_load_dwordx4 v[56:59], v94, s[8:11], s24 offen offset:64
    v_add_u32 v94, 128, v94
    buffer_load_dwordx4 v[44:47], v95, s[8:11], s24 offen offset:0
    buffer_load_dwordx4 v[60:63], v95, s[8:11], s24 offen offset:64
    v_add_u32 v95, 128, v95
    s_setprio 1
L_conv1_kernel_hloop1:
    s_cmp_lt_u32 s28, 13
    s_cselect_b32 s24, 0, 2130706432
    v_lshlrev_b32 v76, 16, v16
    v_and_b32 v84, s25, v16
    v_lshlrev_b32 v77, 16, v20
    v_and_b32 v85, s25, v20
    v_lshlrev_b32 v78, 16, v24
    v_and_b32 v86, s25, v24
    v_lshlrev_b32 v79, 16, v28
    v_and_b32 v87, s25, v28
    v_add_f32 v80, v76, v78
    v_add_f32 v88, v84, v86
    v_add_f32 v81, v77, v79
    v_add_f32 v89, v85, v87
    v_fma_f32 v82, v78, 4.0, v76
    v_fma_f32 v90, v86, 4.0, v84
    v_fma_f32 v83, v79, 4.0, v77
    v_fma_f32 v91, v87, 4.0, v85
    v_add_f32 v77, v80, v81
    v_add_f32 v85, v88, v89
    v_sub_f32 v78, v80, v81
    v_sub_f32 v86, v88, v89
    v_fma_f32 v79, v83, 2.0, v82
    v_fma_f32 v87, v91, 2.0, v90
    v_fma_f32 v82, v83, -2.0, v82
    v_fma_f32 v90, v91, -2.0, v90
    v_fmamk_f32 v80, v76, 0x41700000, v82
    v_fmamk_f32 v88, v84, 0x41700000, v90
    v_fmamk_f32 v80, v81, 0x41200000, v80
    v_fmamk_f32 v88, v89, 0x41200000, v88
    v_cvt_pk_bf16_f32 v20, v77, v85
    v_cvt_pk_bf16_f32 v24, v78, v86
    v_cvt_pk_bf16_f32 v64, v79, v87
    v_cvt_pk_bf16_f32 v68, v82, v90
    v_cvt_pk_bf16_f32 v72, v80, v88
    v_lshlrev_b32 v76, 16, v17
    v_and_b32 v84, s25, v17
    v_lshlrev_b32 v77, 16, v21
    v_and_b32 v85, s25, v21
    v_lshlrev_b32 v78, 16, v25
    v_and_b32 v86, s25, v25
    v_lshlrev_b32 v79, 16, v29
    v_and_b32 v87, s25, v29
    v_add_f32 v80, v76, v78
    v_add_f32 v88, v84, v86
    v_add_f32 v81, v77, v79
    v_add_f32 v89, v85, v87
    v_fma_f32 v82, v78, 4.0, v76
    v_fma_f32 v90, v86, 4.0, v84
    v_fma_f32 v83, v79, 4.0, v77
    v_fma_f32 v91, v87, 4.0, v85
    v_add_f32 v77, v80, v81
    v_add_f32 v85, v88, v89
    v_sub_f32 v78, v80, v81
    v_sub_f32 v86, v88, v89
    v_fma_f32 v79, v83, 2.0, v82
    v_fma_f32 v87, v91, 2.0, v90
    v_fma_f32 v82, v83, -2.0, v82
    v_fma_f32 v90, v91, -2.0, v90
    v_fmamk_f32 v80, v76, 0x41700000, v82
    v_fmamk_f32 v88, v84, 0x41700000, v90
    v_fmamk_f32 v80, v81, 0x41200000, v80
    v_fmamk_f32 v88, v89, 0x41200000, v88
    v_cvt_pk_bf16_f32 v21, v77, v85
    v_cvt_pk_bf16_f32 v25, v78, v86
    v_cvt_pk_bf16_f32 v65, v79, v87
    v_cvt_pk_bf16_f32 v69, v82, v90
    v_cvt_pk_bf16_f32 v73, v80, v88
    v_lshlrev_b32 v76, 16, v18
    v_and_b32 v84, s25, v18
    v_lshlrev_b32 v77, 16, v22
    v_and_b32 v85, s25, v22
    v_lshlrev_b32 v78, 16, v26
    v_and_b32 v86, s25, v26
    v_lshlrev_b32 v79, 16, v30
    v_and_b32 v87, s25, v30
    v_add_f32 v80, v76, v78
    v_add_f32 v88, v84, v86
    v_add_f32 v81, v77, v79
    v_add_f32 v89, v85, v87
    v_fma_f32 v82, v78, 4.0, v76
    v_fma_f32 v90, v86, 4.0, v84
    v_fma_f32 v83, v79, 4.0, v77
    v_fma_f32 v91, v87, 4.0, v85
    v_add_f32 v77, v80, v81
    v_add_f32 v85, v88, v89
    v_sub_f32 v78, v80, v81
    v_sub_f32 v86, v88, v89
    v_fma_f32 v79, v83, 2.0, v82
    v_fma_f32 v87, v91, 2.0, v90
    v_fma_f32 v82, v83, -2.0, v82
    v_fma_f32 v90, v91, -2.0, v90
    v_fmamk_f32 v80, v76, 0x41700000, v82
    v_fmamk_f32 v88, v84, 0x41700000, v90
    v_fmamk_f32 v80, v81, 0x41200000, v80
    v_fmamk_f32 v88, v89, 0x41200000, v88
    v_cvt_pk_bf16_f32 v22, v77, v85
    v_cvt_pk_bf16_f32 v26, v78, v86
    v_cvt_pk_bf16_f32 v66, v79, v87
    v_cvt_pk_bf16_f32 v70, v82, v90
    v_cvt_pk_bf16_f32 v74, v80, v88
    v_lshlrev_b32 v76, 16, v19
    v_and_b32 v84, s25, v19
    v_lshlrev_b32 v77, 16, v23
    v_and_b32 v85, s25, v23
    v_lshlrev_b32 v78, 16, v27
    v_and_b32 v86, s25, v27
    v_lshlrev_b32 v79, 16, v31
    v_and_b32 v87, s25, v31
    v_add_f32 v80, v76, v78
    v_add_f32 v88, v84, v86
    v_add_f32 v81, v77, v79
    v_add_f32 v89, v85, v87
    v_fma_f32 v82, v78, 4.0, v76
    v_fma_f32 v90, v86, 4.0, v84
    v_fma_f32 v83, v79, 4.0, v77
    v_fma_f32 v91, v87, 4.0, v85
    v_add_f32 v77, v80, v81
    v_add_f32 v85, v88, v89
    v_sub_f32 v78, v80, v81
    v_sub_f32 v86, v88, v89
    v_fma_f32 v79, v83, 2.0, v82
    v_fma_f32 v87, v91, 2.0, v90
    v_fma_f32 v82, v83, -2.0, v82
    v_fma_f32 v90, v91, -2.0, v90
    v_fmamk_f32 v80, v76, 0x41700000, v82
    v_fmamk_f32 v88, v84, 0x41700000, v90
    v_fmamk_f32 v80, v81, 0x41200000, v80
    v_fmamk_f32 v88, v89, 0x41200000, v88
    v_cvt_pk_bf16_f32 v23, v77, v85
    v_cvt_pk_bf16_f32 v27, v78, v86
    v_cvt_pk_bf16_f32 v67, v79, v87
    v_cvt_pk_bf16_f32 v71, v82, v90
    v_cvt_pk_bf16_f32 v75, v80, v88
    ds_write_b128 v96, v[64:67] offset:57344
    ds_write_b128 v97, v[68:71] offset:8192
    ds_write_b128 v97, v[72:75] offset:24576
    ds_write_b128 v96, v[16:19] offset:8192
    ds_write_b128 v96, v[20:23] offset:24576
    ds_write_b128 v96, v[24:27] offset:40960
    ds_write_b128 v98, v[28:31] offset:8704
    s_add_u32 s28, s28, 1
    s_waitcnt lgkmcnt(0)
    s_barrier
    s_cmp_lt_u32 s28, 13
    s_cselect_b32 s24, 0, 2130706432
    s_waitcnt vmcnt(0)
    v_lshlrev_b32 v76, 16, v32
    v_and_b32 v84, s25, v32
    v_lshlrev_b32 v77, 16, v36
    v_and_b32 v85, s25, v36
    v_lshlrev_b32 v78, 16, v40
    v_and_b32 v86, s25, v40
    v_lshlrev_b32 v79, 16, v44
    v_and_b32 v87, s25, v44
    v_add_f32 v80, v76, v78
    v_add_f32 v88, v84, v86
    v_add_f32 v81, v77, v79
    v_add_f32 v89, v85, v87
    v_fma_f32 v82, v78, 4.0, v76
    v_fma_f32 v90, v86, 4.0, v84
    v_fma_f32 v83, v79, 4.0, v77
    v_fma_f32 v91, v87, 4.0, v85
    v_add_f32 v77, v80, v81
    v_add_f32 v85, v88, v89
    v_sub_f32 v78, v80, v81
    v_sub_f32 v86, v88, v89
    v_fma_f32 v79, v83, 2.0, v82
    v_fma_f32 v87, v91, 2.0, v90
    v_fma_f32 v82, v83, -2.0, v82
    v_fma_f32 v90, v91, -2.0, v90
    v_fmamk_f32 v80, v76, 0x41700000, v82
    v_fmamk_f32 v88, v84, 0x41700000, v90
    v_fmamk_f32 v80, v81, 0x41200000, v80
    v_fmamk_f32 v88, v89, 0x41200000, v88
    v_cvt_pk_bf16_f32 v36, v77, v85
    v_cvt_pk_bf16_f32 v40, v78, v86
    v_cvt_pk_bf16_f32 v64, v79, v87
    v_cvt_pk_bf16_f32 v68, v82, v90
    v_cvt_pk_bf16_f32 v72, v80, v88
    v_lshlrev_b32 v76, 16, v33
    v_and_b32 v84, s25, v33
    v_lshlrev_b32 v77, 16, v37
    v_and_b32 v85, s25, v37
    v_lshlrev_b32 v78, 16, v41
    v_and_b32 v86, s25, v41
    v_lshlrev_b32 v79, 16, v45
    v_and_b32 v87, s25, v45
    v_add_f32 v80, v76, v78
    v_add_f32 v88, v84, v86
    v_add_f32 v81, v77, v79
    v_add_f32 v89, v85, v87
    v_fma_f32 v82, v78, 4.0, v76
    v_fma_f32 v90, v86, 4.0, v84
    v_fma_f32 v83, v79, 4.0, v77
    v_fma_f32 v91, v87, 4.0, v85
    v_add_f32 v77, v80, v81
    v_add_f32 v85, v88, v89
    v_sub_f32 v78, v80, v81
    v_sub_f32 v86, v88, v89
    v_fma_f32 v79, v83, 2.0, v82
    v_fma_f32 v87, v91, 2.0, v90
    v_fma_f32 v82, v83, -2.0, v82
    v_fma_f32 v90, v91, -2.0, v90
    v_fmamk_f32 v80, v76, 0x41700000, v82
    v_fmamk_f32 v88, v84, 0x41700000, v90
    v_fmamk_f32 v80, v81, 0x41200000, v80
    v_fmamk_f32 v88, v89, 0x41200000, v88
    v_cvt_pk_bf16_f32 v37, v77, v85
    v_cvt_pk_bf16_f32 v41, v78, v86
    v_cvt_pk_bf16_f32 v65, v79, v87
    v_cvt_pk_bf16_f32 v69, v82, v90
    v_cvt_pk_bf16_f32 v73, v80, v88
    v_lshlrev_b32 v76, 16, v34
    v_and_b32 v84, s25, v34
    v_lshlrev_b32 v77, 16, v38
    v_and_b32 v85, s25, v38
    v_lshlrev_b32 v78, 16, v42
    v_and_b32 v86, s25, v42
    v_lshlrev_b32 v79, 16, v46
    v_and_b32 v87, s25, v46
    v_add_f32 v80, v76, v78
    v_add_f32 v88, v84, v86
    v_add_f32 v81, v77, v79
    v_add_f32 v89, v85, v87
    v_fma_f32 v82, v78, 4.0, v76
    v_fma_f32 v90, v86, 4.0, v84
    v_fma_f32 v83, v79, 4.0, v77
    v_fma_f32 v91, v87, 4.0, v85
    v_add_f32 v77, v80, v81
    v_add_f32 v85, v88, v89
    v_sub_f32 v78, v80, v81
    v_sub_f32 v86, v88, v89
    v_fma_f32 v79, v83, 2.0, v82
    v_fma_f32 v87, v91, 2.0, v90
    v_fma_f32 v82, v83, -2.0, v82
    v_fma_f32 v90, v91, -2.0, v90
    v_fmamk_f32 v80, v76, 0x41700000, v82
    v_fmamk_f32 v88, v84, 0x41700000, v90
    v_fmamk_f32 v80, v81, 0x41200000, v80
    v_fmamk_f32 v88, v89, 0x41200000, v88
    v_cvt_pk_bf16_f32 v38, v77, v85
    v_cvt_pk_bf16_f32 v42, v78, v86
    v_cvt_pk_bf16_f32 v66, v79, v87
    v_cvt_pk_bf16_f32 v70, v82, v90
    v_cvt_pk_bf16_f32 v74, v80, v88
    v_lshlrev_b32 v76, 16, v35
    v_and_b32 v84, s25, v35
    v_lshlrev_b32 v77, 16, v39
    v_and_b32 v85, s25, v39
    v_lshlrev_b32 v78, 16, v43
    v_and_b32 v86, s25, v43
    v_lshlrev_b32 v79, 16, v47
    v_and_b32 v87, s25, v47
    v_add_f32 v80, v76, v78
    v_add_f32 v88, v84, v86
    v_add_f32 v81, v77, v79
    v_add_f32 v89, v85, v87
    v_fma_f32 v82, v78, 4.0, v76
    v_fma_f32 v90, v86, 4.0, v84
    v_fma_f32 v83, v79, 4.0, v77
    v_fma_f32 v91, v87, 4.0, v85
    v_add_f32 v77, v80, v81
    v_add_f32 v85, v88, v89
    v_sub_f32 v78, v80, v81
    v_sub_f32 v86, v88, v89
    v_fma_f32 v79, v83, 2.0, v82
    v_fma_f32 v87, v91, 2.0, v90
    v_fma_f32 v82, v83, -2.0, v82
    v_fma_f32 v90, v91, -2.0, v90
    v_fmamk_f32 v80, v76, 0x41700000, v82
    v_fmamk_f32 v88, v84, 0x41700000, v90
    v_fmamk_f32 v80, v81, 0x41200000, v80
    v_fmamk_f32 v88, v89, 0x41200000, v88
    v_cvt_pk_bf16_f32 v39, v77, v85
    v_cvt_pk_bf16_f32 v43, v78, v86
    v_cvt_pk_bf16_f32 v67, v79, v87
    v_cvt_pk_bf16_f32 v71, v82, v90
    v_cvt_pk_bf16_f32 v75, v80, v88
    ds_write_b128 v96, v[64:67] offset:49152
    ds_write_b128 v97, v[68:71] offset:0
    ds_write_b128 v97, v[72:75] offset:16384
    ds_write_b128 v96, v[32:35] offset:0
    ds_write_b128 v96, v[36:39] offset:16384
    ds_write_b128 v96, v[40:43] offset:32768
    ds_write_b128 v98, v[44:47] offset:0
    buffer_load_dwordx4 v[0:3], v92, s[8:11], s24 offen offset:0
    buffer_load_dwordx4 v[16:19], v92, s[8:11], s24 offen offset:64
    v_add_u32 v92, 128, v92
    buffer_load_dwordx4 v[4:7], v93, s[8:11], s24 offen offset:0
    buffer_load_dwordx4 v[20:23], v93, s[8:11], s24 offen offset:64
    v_add_u32 v93, 128, v93
    buffer_load_dwordx4 v[8:11], v94, s[8:11], s24 offen offset:0
    buffer_load_dwordx4 v[24:27], v94, s[8:11], s24 offen offset:64
    v_add_u32 v94, 128, v94
    buffer_load_dwordx4 v[12:15], v95, s[8:11], s24 offen offset:0
    buffer_load_dwordx4 v[28:31], v95, s[8:11], s24 offen offset:64
    v_add_u32 v95, 128, v95
    s_add_u32 s28, s28, 1
    s_waitcnt lgkmcnt(0)
    s_barrier
    s_cmp_lt_u32 s28, 13
    s_cselect_b32 s24, 0, 2130706432
    v_lshlrev_b32 v76, 16, v48
    v_and_b32 v84, s25, v48
    v_lshlrev_b32 v77, 16, v52
    v_and_b32 v85, s25, v52
    v_lshlrev_b32 v78, 16, v56
    v_and_b32 v86, s25, v56
    v_lshlrev_b32 v79, 16, v60
    v_and_b32 v87, s25, v60
    v_add_f32 v80, v76, v78
    v_add_f32 v88, v84, v86
    v_add_f32 v81, v77, v79
    v_add_f32 v89, v85, v87
    v_fma_f32 v82, v78, 4.0, v76
    v_fma_f32 v90, v86, 4.0, v84
    v_fma_f32 v83, v79, 4.0, v77
    v_fma_f32 v91, v87, 4.0, v85
    v_add_f32 v77, v80, v81
    v_add_f32 v85, v88, v89
    v_sub_f32 v78, v80, v81
    v_sub_f32 v86, v88, v89
    v_fma_f32 v79, v83, 2.0, v82
    v_fma_f32 v87, v91, 2.0, v90
    v_fma_f32 v82, v83, -2.0, v82
    v_fma_f32 v90, v91, -2.0, v90
    v_fmamk_f32 v80, v76, 0x41700000, v82
    v_fmamk_f32 v88, v84, 0x41700000, v90
    v_fmamk_f32 v80, v81, 0x41200000, v80
    v_fmamk_f32 v88, v89, 0x41200000, v88
    v_cvt_pk_bf16_f32 v52, v77, v85
    v_cvt_pk_bf16_f32 v56, v78, v86
    v_cvt_pk_bf16_f32 v64, v79, v87
    v_cvt_pk_bf16_f32 v68, v82, v90
    v_cvt_pk_bf16_f32 v72, v80, v88
    v_lshlrev_b32 v76, 16, v49
    v_and_b32 v84, s25, v49
    v_lshlrev_b32 v77, 16, v53
    v_and_b32 v85, s25, v53
    v_lshlrev_b32 v78, 16, v57
    v_and_b32 v86, s25, v57
    v_lshlrev_b32 v79, 16, v61
    v_and_b32 v87, s25, v61
    v_add_f32 v80, v76, v78
    v_add_f32 v88, v84, v86
    v_add_f32 v81, v77, v79
    v_add_f32 v89, v85, v87
    v_fma_f32 v82, v78, 4.0, v76
    v_fma_f32 v90, v86, 4.0, v84
    v_fma_f32 v83, v79, 4.0, v77
    v_fma_f32 v91, v87, 4.0, v85
    v_add_f32 v77, v80, v81
    v_add_f32 v85, v88, v89
    v_sub_f32 v78, v80, v81
    v_sub_f32 v86, v88, v89
    v_fma_f32 v79, v83, 2.0, v82
    v_fma_f32 v87, v91, 2.0, v90
    v_fma_f32 v82, v83, -2.0, v82
    v_fma_f32 v90, v91, -2.0, v90
    v_fmamk_f32 v80, v76, 0x41700000, v82
    v_fmamk_f32 v88, v84, 0x41700000, v90
    v_fmamk_f32 v80, v81, 0x41200000, v80
    v_fmamk_f32 v88, v89, 0x41200000, v88
    v_cvt_pk_bf16_f32 v53, v77, v85
    v_cvt_pk_bf16_f32 v57, v78, v86
    v_cvt_pk_bf16_f32 v65, v79, v87
    v_cvt_pk_bf16_f32 v69, v82, v90
    v_cvt_pk_bf16_f32 v73, v80, v88
    v_lshlrev_b32 v76, 16, v50
    v_and_b32 v84, s25, v50
    v_lshlrev_b32 v77, 16, v54
    v_and_b32 v85, s25, v54
    v_lshlrev_b32 v78, 16, v58
    v_and_b32 v86, s25, v58
    v_lshlrev_b32 v79, 16, v62
    v_and_b32 v87, s25, v62
    v_add_f32 v80, v76, v78
    v_add_f32 v88, v84, v86
    v_add_f32 v81, v77, v79
    v_add_f32 v89, v85, v87
    v_fma_f32 v82, v78, 4.0, v76
    v_fma_f32 v90, v86, 4.0, v84
    v_fma_f32 v83, v79, 4.0, v77
    v_fma_f32 v91, v87, 4.0, v85
    v_add_f32 v77, v80, v81
    v_add_f32 v85, v88, v89
    v_sub_f32 v78, v80, v81
    v_sub_f32 v86, v88, v89
    v_fma_f32 v79, v83, 2.0, v82
    v_fma_f32 v87, v91, 2.0, v90
    v_fma_f32 v82, v83, -2.0, v82
    v_fma_f32 v90, v91, -2.0, v90
    v_fmamk_f32 v80, v76, 0x41700000, v82
    v_fmamk_f32 v88, v84, 0x41700000, v90
    v_fmamk_f32 v80, v81, 0x41200000, v80
    v_fmamk_f32 v88, v89, 0x41200000, v88
    v_cvt_pk_bf16_f32 v54, v77, v85
    v_cvt_pk_bf16_f32 v58, v78, v86
    v_cvt_pk_bf16_f32 v66, v79, v87
    v_cvt_pk_bf16_f32 v70, v82, v90
    v_cvt_pk_bf16_f32 v74, v80, v88
    v_lshlrev_b32 v76, 16, v51
    v_and_b32 v84, s25, v51
    v_lshlrev_b32 v77, 16, v55
    v_and_b32 v85, s25, v55
    v_lshlrev_b32 v78, 16, v59
    v_and_b32 v86, s25, v59
    v_lshlrev_b32 v79, 16, v63
    v_and_b32 v87, s25, v63
    v_add_f32 v80, v76, v78
    v_add_f32 v88, v84, v86
    v_add_f32 v81, v77, v79
    v_add_f32 v89, v85, v87
    v_fma_f32 v82, v78, 4.0, v76
    v_fma_f32 v90, v86, 4.0, v84
    v_fma_f32 v83, v79, 4.0, v77
    v_fma_f32 v91, v87, 4.0, v85
    v_add_f32 v77, v80, v81
    v_add_f32 v85, v88, v89
    v_sub_f32 v78, v80, v81
    v_sub_f32 v86, v88, v89
    v_fma_f32 v79, v83, 2.0, v82
    v_fma_f32 v87, v91, 2.0, v90
    v_fma_f32 v82, v83, -2.0, v82
    v_fma_f32 v90, v91, -2.0, v90
    v_fmamk_f32 v80, v76, 0x41700000, v82
    v_fmamk_f32 v88, v84, 0x41700000, v90
    v_fmamk_f32 v80, v81, 0x41200000, v80
    v_fmamk_f32 v88, v89, 0x41200000, v88
    v_cvt_pk_bf16_f32 v55, v77, v85
    v_cvt_pk_bf16_f32 v59, v78, v86
    v_cvt_pk_bf16_f32 v67, v79, v87
    v_cvt_pk_bf16_f32 v71, v82, v90
    v_cvt_pk_bf16_f32 v75, v80, v88
    ds_write_b128 v96, v[64:67] offset:57344
    ds_write_b128 v97, v[68:71] offset:8192
    ds_write_b128 v97, v[72:75] offset:24576
    ds_write_b128 v96, v[48:51] offset:8192
    ds_write_b128 v96, v[52:55] offset:24576
    ds_write_b128 v96, v[56:59] offset:40960
    ds_write_b128 v98, v[60:63] offset:8704
    s_add_u32 s28, s28, 1
    s_waitcnt lgkmcnt(0)
    s_barrier
    s_cmp_eq_u32 s22, 1
    s_cbranch_scc1 L_conv1_kernel_hlast1
    s_cmp_lt_u32 s28, 13
    s_cselect_b32 s24, 0, 2130706432
    s_waitcnt vmcnt(0)
    v_lshlrev_b32 v76, 16, v0
    v_and_b32 v84, s25, v0
    v_lshlrev_b32 v77, 16, v4
    v_and_b32 v85, s25, v4
    v_lshlrev_b32 v78, 16, v8
    v_and_b32 v86, s25, v8
    v_lshlrev_b32 v79, 16, v12
    v_and_b32 v87, s25, v12
    v_add_f32 v80, v76, v78
    v_add_f32 v88, v84, v86
    v_add_f32 v81, v77, v79
    v_add_f32 v89, v85, v87
    v_fma_f32 v82, v78, 4.0, v76
    v_fma_f32 v90, v86, 4.0, v84
    v_fma_f32 v83, v79, 4.0, v77
    v_fma_f32 v91, v87, 4.0, v85
    v_add_f32 v77, v80, v81
    v_add_f32 v85, v88, v89
    v_sub_f32 v78, v80, v81
    v_sub_f32 v86, v88, v89
    v_fma_f32 v79, v83, 2.0, v82
    v_fma_f32 v87, v91, 2.0, v90
    v_fma_f32 v82, v83, -2.0, v82
    v_fma_f32 v90, v91, -2.0, v90
    v_fmamk_f32 v80, v76, 0x41700000, v82
    v_fmamk_f32 v88, v84, 0x41700000, v90
    v_fmamk_f32 v80, v81, 0x41200000, v80
    v_fmamk_f32 v88, v89, 0x41200000, v88
    v_cvt_pk_bf16_f32 v4, v77, v85
    v_cvt_pk_bf16_f32 v8, v78, v86
    v_cvt_pk_bf16_f32 v64, v79, v87
    v_cvt_pk_bf16_f32 v68, v82, v90
    v_cvt_pk_bf16_f32 v72, v80, v88
    v_lshlrev_b32 v76, 16, v1
    v_and_b32 v84, s25, v1
    v_lshlrev_b32 v77, 16, v5
    v_and_b32 v85, s25, v5
    v_lshlrev_b32 v78, 16, v9
    v_and_b32 v86, s25, v9
    v_lshlrev_b32 v79, 16, v13
    v_and_b32 v87, s25, v13
    v_add_f32 v80, v76, v78
    v_add_f32 v88, v84, v86
    v_add_f32 v81, v77, v79
    v_add_f32 v89, v85, v87
    v_fma_f32 v82, v78, 4.0, v76
    v_fma_f32 v90, v86, 4.0, v84
    v_fma_f32 v83, v79, 4.0, v77
    v_fma_f32 v91, v87, 4.0, v85
    v_add_f32 v77, v80, v81
    v_add_f32 v85, v88, v89
    v_sub_f32 v78, v80, v81
    v_sub_f32 v86, v88, v89
    v_fma_f32 v79, v83, 2.0, v82
    v_fma_f32 v87, v91, 2.0, v90
    v_fma_f32 v82, v83, -2.0, v82
    v_fma_f32 v90, v91, -2.0, v90
    v_fmamk_f32 v80, v76, 0x41700000, v82
    v_fmamk_f32 v88, v84, 0x41700000, v90
    v_fmamk_f32 v80, v81, 0x41200000, v80
    v_fmamk_f32 v88, v89, 0x41200000, v88
    v_cvt_pk_bf16_f32 v5, v77, v85
    v_cvt_pk_bf16_f32 v9, v78, v86
    v_cvt_pk_bf16_f32 v65, v79, v87
    v_cvt_pk_bf16_f32 v69, v82, v90
    v_cvt_pk_bf16_f32 v73, v80, v88
    v_lshlrev_b32 v76, 16, v2
    v_and_b32 v84, s25, v2
    v_lshlrev_b32 v77, 16, v6
    v_and_b32 v85, s25, v6
    v_lshlrev_b32 v78, 16, v10
    v_and_b32 v86, s25, v10
    v_lshlrev_b32 v79, 16, v14
    v_and_b32 v87, s25, v14
    v_add_f32 v80, v76, v78
    v_add_f32 v88, v84, v86
    v_add_f32 v81, v77, v79
    v_add_f32 v89, v85, v87
    v_fma_f32 v82, v78, 4.0, v76
    v_fma_f32 v90, v86, 4.0, v84
    v_fma_f32 v83, v79, 4.0, v77
    v_fma_f32 v91, v87, 4.0, v85
    v_add_f32 v77, v80, v81
    v_add_f32 v85, v88, v89
    v_sub_f32 v78, v80, v81
    v_sub_f32 v86, v88, v89
    v_fma_f32 v79, v83, 2.0, v82
    v_fma_f32 v87, v91, 2.0, v90
    v_fma_f32 v82, v83, -2.0, v82
    v_fma_f32 v90, v91, -2.0, v90
    v_fmamk_f32 v80, v76, 0x41700000, v82
    v_fmamk_f32 v88, v84, 0x41700000, v90
    v_fmamk_f32 v80, v81, 0x41200000, v80
    v_fmamk_f32 v88, v89, 0x41200000, v88
    v_cvt_pk_bf16_f32 v6, v77, v85
    v_cvt_pk_bf16_f32 v10, v78, v86
    v_cvt_pk_bf16_f32 v66, v79, v87
    v_cvt_pk_bf16_f32 v70, v82, v90
    v_cvt_pk_bf16_f32 v74, v80, v88
    v_lshlrev_b32 v76, 16, v3
    v_and_b32 v84, s25, v3
    v_lshlrev_b32 v77, 16, v7
    v_and_b32 v85, s25, v7
    v_lshlrev_b32 v78, 16, v11
    v_and_b32 v86, s25, v11
    v_lshlrev_b32 v79, 16, v15
    v_and_b32 v87, s25, v15
    v_add_f32 v80, v76, v78
    v_add_f32 v88, v84, v86
    v_add_f32 v81, v77, v79
    v_add_f32 v89, v85, v87
    v_fma_f32 v82, v78, 4.0, v76
    v_fma_f32 v90, v86, 4.0, v84
    v_fma_f32 v83, v79, 4.0, v77
    v_fma_f32 v91, v87, 4.0, v85
    v_add_f32 v77, v80, v81
    v_add_f32 v85, v88, v89
    v_sub_f32 v78, v80, v81
    v_sub_f32 v86, v88, v89
    v_fma_f32 v79, v83, 2.0, v82
    v_fma_f32 v87, v91, 2.0, v90
    v_fma_f32 v82, v83, -2.0, v82
    v_fma_f32 v90, v91, -2.0, v90
    v_fmamk_f32 v80, v76, 0x41700000, v82
    v_fmamk_f32 v88, v84, 0x41700000, v90
    v_fmamk_f32 v80, v81, 0x41200000, v80
    v_fmamk_f32 v88, v89, 0x41200000, v88
    v_cvt_pk_bf16_f32 v7, v77, v85
    v_cvt_pk_bf16_f32 v11, v78, v86
    v_cvt_pk_bf16_f32 v67, v79, v87
    v_cvt_pk_bf16_f32 v71, v82, v90
    v_cvt_pk_bf16_f32 v75, v80, v88
    ds_write_b128 v96, v[64:67] offset:49152
    ds_write_b128 v97, v[68:71] offset:0
    ds_write_b128 v97, v[72:75] offset:16384
    ds_write_b128 v96, v[0:3] offset:0
    ds_write_b128 v96, v[4:7] offset:16384
    ds_write_b128 v96, v[8:11] offset:32768
    ds_write_b128 v98, v[12:15] offset:0
    buffer_load_dwordx4 v[32:35], v92, s[8:11], s24 offen offset:0
    buffer_load_dwordx4 v[48:51], v92, s[8:11], s24 offen offset:64
    v_add_u32 v92, 128, v92
    buffer_load_dwordx4 v[36:39], v93, s[8:11], s24 offen offset:0
    buffer_load_dwordx4 v[52:55], v93, s[8:11], s24 offen offset:64
    v_add_u32 v93, 128, v93
    buffer_load_dwordx4 v[40:43], v94, s[8:11], s24 offen offset:0
    buffer_load_dwordx4 v[56:59], v94, s[8:11], s24 offen offset:64
    v_add_u32 v94, 128, v94
    buffer_load_dwordx4 v[44:47], v95, s[8:11], s24 offen offset:0
    buffer_load_dwordx4 v[60:63], v95, s[8:11], s24 offen offset:64
    v_add_u32 v95, 128, v95
    s_add_u32 s28, s28, 1
    s_waitcnt lgkmcnt(0)
    s_barrier
    s_sub_u32 s22, s22, 1
    s_branch L_conv1_kernel_hloop1
L_conv1_kernel_hlast1:
    s_branch L_conv1_kernel_end
L_conv1_kernel_h2:
    ds_write_b128 v96, v[0:3] offset:0
    ds_write_b128 v98, v[12:15] offset:0
    v_lshlrev_b32 v76, 16, v0
    v_and_b32 v84, s25, v0
    v_lshlrev_b32 v77, 16, v4
    v_and_b32 v85, s25, v4
    v_lshlrev_b32 v78, 16, v8
    v_and_b32 v86, s25, v8
    v_lshlrev_b32 v79, 16, v12
    v_and_b32 v87, s25, v12
    v_add_f32 v80, v76, v78
    v_add_f32 v88, v84, v86
    v_add_f32 v81, v77, v79
    v_add_f32 v89, v85, v87
    v_fma_f32 v82, v78, 4.0, v76
    v_fma_f32 v90, v86, 4.0, v84
    v_fma_f32 v83, v79, 4.0, v77
    v_fma_f32 v91, v87, 4.0, v85
    v_add_f32 v77, v80, v81
    v_add_f32 v85, v88, v89
    v_sub_f32 v78, v80, v81
    v_sub_f32 v86, v88, v89
    v_fma_f32 v79, v83, 2.0, v82
    v_fma_f32 v87, v91, 2.0, v90
    v_fma_f32 v82, v83, -2.0, v82
    v_fma_f32 v90, v91, -2.0, v90
    v_fmamk_f32 v80, v76, 0x41700000, v82
    v_fmamk_f32 v88, v84, 0x41700000, v90
    v_fmamk_f32 v80, v81, 0x41200000, v80
    v_fmamk_f32 v88, v89, 0x41200000, v88
    v_cvt_pk_bf16_f32 v4, v77, v85
    v_cvt_pk_bf16_f32 v8, v78, v86
    v_cvt_pk_bf16_f32 v64, v79, v87
    v_cvt_pk_bf16_f32 v68, v82, v90
    v_cvt_pk_bf16_f32 v72, v80, v88
    v_lshlrev_b32 v76, 16, v1
    v_and_b32 v84, s25, v1
    v_lshlrev_b32 v77, 16, v5
    v_and_b32 v85, s25, v5
    v_lshlrev_b32 v78, 16, v9
    v_and_b32 v86, s25, v9
    v_lshlrev_b32 v79, 16, v13
    v_and_b32 v87, s25, v13
    v_add_f32 v80, v76, v78
    v_add_f32 v88, v84, v86
    v_add_f32 v81, v77, v79
    v_add_f32 v89, v85, v87
    v_fma_f32 v82, v78, 4.0, v76
    v_fma_f32 v90, v86, 4.0, v84
    v_fma_f32 v83, v79, 4.0, v77
    v_fma_f32 v91, v87, 4.0, v85
    v_add_f32 v77, v80, v81
    v_add_f32 v85, v88, v89
    v_sub_f32 v78, v80, v81
    v_sub_f32 v86, v88, v89
    v_fma_f32 v79, v83, 2.0, v82
    v_fma_f32 v87, v91, 2.0, v90
    v_fma_f32 v82, v83, -2.0, v82
    v_fma_f32 v90, v91, -2.0, v90
    v_fmamk_f32 v80, v76, 0x41700000, v82
    v_fmamk_f32 v88, v84, 0x41700000, v90
    v_fmamk_f32 v80, v81, 0x41200000, v80
    v_fmamk_f32 v88, v89, 0x41200000, v88
    v_cvt_pk_bf16_f32 v5, v77, v85
    v_cvt_pk_bf16_f32 v9, v78, v86
    v_cvt_pk_bf16_f32 v65, v79, v87
    v_cvt_pk_bf16_f32 v69, v82, v90
    v_cvt_pk_bf16_f32 v73, v80, v88
    v_lshlrev_b32 v76, 16, v2
    v_and_b32 v84, s25, v2
    v_lshlrev_b32 v77, 16, v6
    v_and_b32 v85, s25, v6
    v_lshlrev_b32 v78, 16, v10
    v_and_b32 v86, s25, v10
    v_lshlrev_b32 v79, 16, v14
    v_and_b32 v87, s25, v14
    v_add_f32 v80, v76, v78
    v_add_f32 v88, v84, v86
    v_add_f32 v81, v77, v79
    v_add_f32 v89, v85, v87
    v_fma_f32 v82, v78, 4.0, v76
    v_fma_f32 v90, v86, 4.0, v84
    v_fma_f32 v83, v79, 4.0, v77
    v_fma_f32 v91, v87, 4.0, v85
    v_add_f32 v77, v80, v81
    v_add_f32 v85, v88, v89
    v_sub_f32 v78, v80, v81
    v_sub_f32 v86, v88, v89
    v_fma_f32 v79, v83, 2.0, v82
    v_fma_f32 v87, v91, 2.0, v90
    v_fma_f32 v82, v83, -2.0, v82
    v_fma_f32 v90, v91, -2.0, v90
    v_fmamk_f32 v80, v76, 0x41700000, v82
    v_fmamk_f32 v88, v84, 0x41700000, v90
    v_fmamk_f32 v80, v81, 0x41200000, v80
    v_fmamk_f32 v88, v89, 0x41200000, v88
    v_cvt_pk_bf16_f32 v6, v77, v85
    v_cvt_pk_bf16_f32 v10, v78, v86
    v_cvt_pk_bf16_f32 v66, v79, v87
    v_cvt_pk_bf16_f32 v70, v82, v90
    v_cvt_pk_bf16_f32 v74, v80, v88
    v_lshlrev_b32 v76, 16, v3
    v_and_b32 v84, s25, v3
    v_lshlrev_b32 v77, 16, v7
    v_and_b32 v85, s25, v7
    v_lshlrev_b32 v78, 16, v11
    v_and_b32 v86, s25, v11
    v_lshlrev_b32 v79, 16, v15
    v_and_b32 v87, s25, v15
    v_add_f32 v80, v76, v78
    v_add_f32 v88, v84, v86
    v_add_f32 v81, v77, v79
    v_add_f32 v89, v85, v87
    v_fma_f32 v82, v78, 4.0, v76
    v_fma_f32 v90, v86, 4.0, v84
    v_fma_f32 v83, v79, 4.0, v77
    v_fma_f32 v91, v87, 4.0, v85
    v_add_f32 v77, v80, v81
    v_add_f32 v85, v88, v89
    v_sub_f32 v78, v80, v81
    v_sub_f32 v86, v88, v89
    v_fma_f32 v79, v83, 2.0, v82
    v_fma_f32 v87, v91, 2.0, v90
    v_fma_f32 v82, v83, -2.0, v82
    v_fma_f32 v90, v91, -2.0, v90
    v_fmamk_f32 v80, v76, 0x41700000, v82
    v_fmamk_f32 v88, v84, 0x41700000, v90
    v_fmamk_f32 v80, v81, 0x41200000, v80
    v_fmamk_f32 v88, v89, 0x41200000, v88
    v_cvt_pk_bf16_f32 v7, v77, v85
    v_cvt_pk_bf16_f32 v11, v78, v86
    v_cvt_pk_bf16_f32 v67, v79, v87
    v_cvt_pk_bf16_f32 v71, v82, v90
    v_cvt_pk_bf16_f32 v75, v80, v88
    ds_write_b128 v96, v[64:67] offset:49152
    ds_write_b128 v97, v[68:71] offset:0
    ds_write_b128 v97, v[72:75] offset:16384
    ds_write_b128 v96, v[4:7] offset:16384
    ds_write_b128 v96, v[8:11] offset:32768
    s_waitcnt vmcnt(0)
    s_waitcnt lgkmcnt(0)
    s_barrier
    buffer_load_dwordx4 v[32:35], v92, s[8:11], s24 offen offset:0
    buffer_load_dwordx4 v[48:51], v92, s[8:11], s24 offen offset:64
    v_add_u32 v92, 128, v92
    buffer_load_dwordx4 v[36:39], v93, s[8:11], s24 offen offset:0
    buffer_load_dwordx4 v[52:55], v93, s[8:11], s24 offen offset:64
    v_add_u32 v93, 128, v93
    buffer_load_dwordx4 v[40:43], v94, s[8:11], s24 offen offset:0
    buffer_load_dwordx4 v[56:59], v94, s[8:11], s24 offen offset:64
    v_add_u32 v94, 128, v94
    buffer_load_dwordx4 v[44:47], v95, s[8:11], s24 offen offset:0
    buffer_load_dwordx4 v[60:63], v95, s[8:11], s24 offen offset:64
    v_add_u32 v95, 128, v95
    s_setprio 0
    v_lshlrev_b32 v76, 16, v16
    v_and_b32 v84, s25, v16
    v_lshlrev_b32 v77, 16, v20
    v_and_b32 v85, s25, v20
    v_lshlrev_b32 v78, 16, v24
    v_and_b32 v86, s25, v24
    v_lshlrev_b32 v79, 16, v28
    v_and_b32 v87, s25, v28
    v_add_f32 v80, v76, v78
    v_add_f32 v88, v84, v86
    v_add_f32 v81, v77, v79
    v_add_f32 v89, v85, v87
    v_fma_f32 v82, v78, 4.0, v76
    v_fma_f32 v90, v86, 4.0, v84
    v_fma_f32 v83, v79, 4.0, v77
    v_fma_f32 v91, v87, 4.0, v85
    v_add_f32 v77, v80, v81
    v_add_f32 v85, v88, v89
    v_sub_f32 v78, v80, v81
    v_sub_f32 v86, v88, v89
    v_fma_f32 v79, v83, 2.0, v82
    v_fma_f32 v87, v91, 2.0, v90
    v_fma_f32 v82, v83, -2.0, v82
    v_fma_f32 v90, v91, -2.0, v90
    v_fmamk_f32 v80, v76, 0x41700000, v82
    v_fmamk_f32 v88, v84, 0x41700000, v90
    v_fmamk_f32 v80, v81, 0x41200000, v80
    v_fmamk_f32 v88, v89, 0x41200000, v88
    v_cvt_pk_bf16_f32 v20, v77, v85
    v_cvt_pk_bf16_f32 v24, v78, v86
    v_cvt_pk_bf16_f32 v64, v79, v87
    v_cvt_pk_bf16_f32 v68, v82, v90
    v_cvt_pk_bf16_f32 v72, v80, v88
    v_lshlrev_b32 v76, 16, v17
    v_and_b32 v84, s25, v17
    v_lshlrev_b32 v77, 16, v21
    v_and_b32 v85, s25, v21
    v_lshlrev_b32 v78, 16, v25
    v_and_b32 v86, s25, v25
    v_lshlrev_b32 v79, 16, v29
    v_and_b32 v87, s25, v29
    v_add_f32 v80, v76, v78
    v_add_f32 v88, v84, v86
    v_add_f32 v81, v77, v79
    v_add_f32 v89, v85, v87
    v_fma_f32 v82, v78, 4.0, v76
    v_fma_f32 v90, v86, 4.0, v84
    v_fma_f32 v83, v79, 4.0, v77
    v_fma_f32 v91, v87, 4.0, v85
    v_add_f32 v77, v80, v81
    v_add_f32 v85, v88, v89
    v_sub_f32 v78, v80, v81
    v_sub_f32 v86, v88, v89
    v_fma_f32 v79, v83, 2.0, v82
    v_fma_f32 v87, v91, 2.0, v90
    v_fma_f32 v82, v83, -2.0, v82
    v_fma_f32 v90, v91, -2.0, v90
    v_fmamk_f32 v80, v76, 0x41700000, v82
    v_fmamk_f32 v88, v84, 0x41700000, v90
    v_fmamk_f32 v80, v81, 0x41200000, v80
    v_fmamk_f32 v88, v89, 0x41200000, v88
    v_cvt_pk_bf16_f32 v21, v77, v85
    v_cvt_pk_bf16_f32 v25, v78, v86
    v_cvt_pk_bf16_f32 v65, v79, v87
    v_cvt_pk_bf16_f32 v69, v82, v90
    v_cvt_pk_bf16_f32 v73, v80, v88
    v_lshlrev_b32 v76, 16, v18
    v_and_b32 v84, s25, v18
    v_lshlrev_b32 v77, 16, v22
    v_and_b32 v85, s25, v22
    v_lshlrev_b32 v78, 16, v26
    v_and_b32 v86, s25, v26
    v_lshlrev_b32 v79, 16, v30
    v_and_b32 v87, s25, v30
    v_add_f32 v80, v76, v78
    v_add_f32 v88, v84, v86
    v_add_f32 v81, v77, v79
    v_add_f32 v89, v85, v87
    v_fma_f32 v82, v78, 4.0, v76
    v_fma_f32 v90, v86, 4.0, v84
    v_fma_f32 v83, v79, 4.0, v77
    v_fma_f32 v91, v87, 4.0, v85
    v_add_f32 v77, v80, v81
    v_add_f32 v85, v88, v89
    v_sub_f32 v78, v80, v81
    v_sub_f32 v86, v88, v89
    v_fma_f32 v79, v83, 2.0, v82
    v_fma_f32 v87, v91, 2.0, v90
    v_fma_f32 v82, v83, -2.0, v82
    v_fma_f32 v90, v91, -2.0, v90
    v_fmamk_f32 v80, v76, 0x41700000, v82
    v_fmamk_f32 v88, v84, 0x41700000, v90
    v_fmamk_f32 v80, v81, 0x41200000, v80
    v_fmamk_f32 v88, v89, 0x41200000, v88
    v_cvt_pk_bf16_f32 v22, v77, v85
    v_cvt_pk_bf16_f32 v26, v78, v86
    v_cvt_pk_bf16_f32 v66, v79, v87
    v_cvt_pk_bf16_f32 v70, v82, v90
    v_cvt_pk_bf16_f32 v74, v80, v88
    v_lshlrev_b32 v76, 16, v19
    v_and_b32 v84, s25, v19
    v_lshlrev_b32 v77, 16, v23
    v_and_b32 v85, s25, v23
    v_lshlrev_b32 v78, 16, v27
    v_and_b32 v86, s25, v27
    v_lshlrev_b32 v79, 16, v31
    v_and_b32 v87, s25, v31
    v_add_f32 v80, v76, v78
    v_add_f32 v88, v84, v86
    v_add_f32 v81, v77, v79
    v_add_f32 v89, v85, v87
    v_fma_f32 v82, v78, 4.0, v76
    v_fma_f32 v90, v86, 4.0, v84
    v_fma_f32 v83, v79, 4.0, v77
    v_fma_f32 v91, v87, 4.0, v85
    v_add_f32 v77, v80, v81
    v_add_f32 v85, v88, v89
    v_sub_f32 v78, v80, v81
    v_sub_f32 v86, v88, v89
    v_fma_f32 v79, v83, 2.0, v82
    v_fma_f32 v87, v91, 2.0, v90
    v_fma_f32 v82, v83, -2.0, v82
    v_fma_f32 v90, v91, -2.0, v90
    v_fmamk_f32 v80, v76, 0x41700000, v82
    v_fmamk_f32 v88, v84, 0x41700000, v90
    v_fmamk_f32 v80, v81, 0x41200000, v80
    v_fmamk_f32 v88, v89, 0x41200000, v88
    v_cvt_pk_bf16_f32 v23, v77, v85
    v_cvt_pk_bf16_f32 v27, v78, v86
    v_cvt_pk_bf16_f32 v67, v79, v87
    v_cvt_pk_bf16_f32 v71, v82, v90
    v_cvt_pk_bf16_f32 v75, v80, v88
L_conv1_kernel_hloop2:
    s_cmp_lt_u32 s28, 12
    s_cselect_b32 s24, 0, 2130706432
    ds_write_b128 v96, v[64:67] offset:57344
    ds_write_b128 v97, v[68:71] offset:8192
    ds_write_b128 v97, v[72:75] offset:24576
    ds_write_b128 v96, v[16:19] offset:8192
    ds_write_b128 v96, v[20:23] offset:24576
    ds_write_b128 v96, v[24:27] offset:40960
    ds_write_b128 v98, v[28:31] offset:8704
    s_waitcnt vmcnt(0)
    buffer_load_dwordx4 v[0:3], v92, s[8:11], s24 offen offset:0
    buffer_load_dwordx4 v[16:19], v92, s[8:11], s24 offen offset:64
    v_add_u32 v92, 128, v92
    buffer_load_dwordx4 v[4:7], v93, s[8:11], s24 offen offset:0
    buffer_load_dwordx4 v[20:23], v93, s[8:11], s24 offen offset:64
    v_add_u32 v93, 128, v93
    buffer_load_dwordx4 v[8:11], v94, s[8:11], s24 offen offset:0
    buffer_load_dwordx4 v[24:27], v94, s[8:11], s24 offen offset:64
    v_add_u32 v94, 128, v94
    buffer_load_dwordx4 v[12:15], v95, s[8:11], s24 offen offset:0
    buffer_load_dwordx4 v[28:31], v95, s[8:11], s24 offen offset:64
    v_add_u32 v95, 128, v95
    v_lshlrev_b32 v76, 16, v32
    v_and_b32 v84, s25, v32
    v_lshlrev_b32 v77, 16, v36
    v_and_b32 v85, s25, v36
    v_lshlrev_b32 v78, 16, v40
    v_and_b32 v86, s25, v40
    v_lshlrev_b32 v79, 16, v44
    v_and_b32 v87, s25, v44
    v_add_f32 v80, v76, v78
    v_add_f32 v88, v84, v86
    v_add_f32 v81, v77, v79
    v_add_f32 v89, v85, v87
    v_fma_f32 v82, v78, 4.0, v76
    v_fma_f32 v90, v86, 4.0, v84
    v_fma_f32 v83, v79, 4.0, v77
    v_fma_f32 v91, v87, 4.0, v85
    v_add_f32 v77, v80, v81
    v_add_f32 v85, v88, v89
    v_sub_f32 v78, v80, v81
    v_sub_f32 v86, v88, v89
    v_fma_f32 v79, v83, 2.0, v82
    v_fma_f32 v87, v91, 2.0, v90
    v_fma_f32 v82, v83, -2.0, v82
    v_fma_f32 v90, v91, -2.0, v90
    v_fmamk_f32 v80, v76, 0x41700000, v82
    v_fmamk_f32 v88, v84, 0x41700000, v90
    v_fmamk_f32 v80, v81, 0x41200000, v80
    v_fmamk_f32 v88, v89, 0x41200000, v88
    v_cvt_pk_bf16_f32 v36, v77, v85
    v_cvt_pk_bf16_f32 v40, v78, v86
    v_cvt_pk_bf16_f32 v64, v79, v87
    v_cvt_pk_bf16_f32 v68, v82, v90
    v_cvt_pk_bf16_f32 v72, v80, v88
    v_lshlrev_b32 v76, 16, v33
    v_and_b32 v84, s25, v33
    v_lshlrev_b32 v77, 16, v37
    v_and_b32 v85, s25, v37
    v_lshlrev_b32 v78, 16, v41
    v_and_b32 v86, s25, v41
    v_lshlrev_b32 v79, 16, v45
    v_and_b32 v87, s25, v45
    v_add_f32 v80, v76, v78
    v_add_f32 v88, v84, v86
    v_add_f32 v81, v77, v79
    v_add_f32 v89, v85, v87
    v_fma_f32 v82, v78, 4.0, v76
    v_fma_f32 v90, v86, 4.0, v84
    v_fma_f32 v83, v79, 4.0, v77
    v_fma_f32 v91, v87, 4.0, v85
    v_add_f32 v77, v80, v81
    v_add_f32 v85, v88, v89
    v_sub_f32 v78, v80, v81
    v_sub_f32 v86, v88, v89
    v_fma_f32 v79, v83, 2.0, v82
    v_fma_f32 v87, v91, 2.0, v90
    v_fma_f32 v82, v83, -2.0, v82
    v_fma_f32 v90, v91, -2.0, v90
    v_fmamk_f32 v80, v76, 0x41700000, v82
    v_fmamk_f32 v88, v84, 0x41700000, v90
    v_fmamk_f32 v80, v81, 0x41200000, v80
    v_fmamk_f32 v88, v89, 0x41200000, v88
    v_cvt_pk_bf16_f32 v37, v77, v85
    v_cvt_pk_bf16_f32 v41, v78, v86
    v_cvt_pk_bf16_f32 v65, v79, v87
    v_cvt_pk_bf16_f32 v69, v82, v90
    v_cvt_pk_bf16_f32 v73, v80, v88
    v_lshlrev_b32 v76, 16, v34
    v_and_b32 v84, s25, v34
    v_lshlrev_b32 v77, 16, v38
    v_and_b32 v85, s25, v38
    v_lshlrev_b32 v78, 16, v42
    v_and_b32 v86, s25, v42
    v_lshlrev_b32 v79, 16, v46
    v_and_b32 v87, s25, v46
    v_add_f32 v80, v76, v78
    v_add_f32 v88, v84, v86
    v_add_f32 v81, v77, v79
    v_add_f32 v89, v85, v87
    v_fma_f32 v82, v78, 4.0, v76
    v_fma_f32 v90, v86, 4.0, v84
    v_fma_f32 v83, v79, 4.0, v77
    v_fma_f32 v91, v87, 4.0, v85
    v_add_f32 v77, v80, v81
    v_add_f32 v85, v88, v89
    v_sub_f32 v78, v80, v81
    v_sub_f32 v86, v88, v89
    v_fma_f32 v79, v83, 2.0, v82
    v_fma_f32 v87, v91, 2.0, v90
    v_fma_f32 v82, v83, -2.0, v82
    v_fma_f32 v90, v91, -2.0, v90
    v_fmamk_f32 v80, v76, 0x41700000, v82
    v_fmamk_f32 v88, v84, 0x41700000, v90
    v_fmamk_f32 v80, v81, 0x41200000, v80
    v_fmamk_f32 v88, v89, 0x41200000, v88
    v_cvt_pk_bf16_f32 v38, v77, v85
    v_cvt_pk_bf16_f32 v42, v78, v86
    v_cvt_pk_bf16_f32 v66, v79, v87
    v_cvt_pk_bf16_f32 v70, v82, v90
    v_cvt_pk_bf16_f32 v74, v80, v88
    v_lshlrev_b32 v76, 16, v35
    v_and_b32 v84, s25, v35
    v_lshlrev_b32 v77, 16, v39
    v_and_b32 v85, s25, v39
    v_lshlrev_b32 v78, 16, v43
    v_and_b32 v86, s25, v43
    v_lshlrev_b32 v79, 16, v47
    v_and_b32 v87, s25, v47
    v_add_f32 v80, v76, v78
    v_add_f32 v88, v84, v86
    v_add_f32 v81, v77, v79
    v_add_f32 v89, v85, v87
    v_fma_f32 v82, v78, 4.0, v76
    v_fma_f32 v90, v86, 4.0, v84
    v_fma_f32 v83, v79, 4.0, v77
    v_fma_f32 v91, v87, 4.0, v85
    v_add_f32 v77, v80, v81
    v_add_f32 v85, v88, v89
    v_sub_f32 v78, v80, v81
    v_sub_f32 v86, v88, v89
    v_fma_f32 v79, v83, 2.0, v82
    v_fma_f32 v87, v91, 2.0, v90
    v_fma_f32 v82, v83, -2.0, v82
    v_fma_f32 v90, v91, -2.0, v90
    v_fmamk_f32 v80, v76, 0x41700000, v82
    v_fmamk_f32 v88, v84, 0x41700000, v90
    v_fmamk_f32 v80, v81, 0x41200000, v80
    v_fmamk_f32 v88, v89, 0x41200000, v88
    v_cvt_pk_bf16_f32 v39, v77, v85
    v_cvt_pk_bf16_f32 v43, v78, v86
    v_cvt_pk_bf16_f32 v67, v79, v87
    v_cvt_pk_bf16_f32 v71, v82, v90
    v_cvt_pk_bf16_f32 v75, v80, v88
    s_add_u32 s28, s28, 1
    s_waitcnt lgkmcnt(0)
    s_barrier
    s_cmp_lt_u32 s28, 12
    s_cselect_b32 s24, 0, 2130706432
    ds_write_b128 v96, v[64:67] offset:49152
    ds_write_b128 v97, v[68:71] offset:0
    ds_write_b128 v97, v[72:75] offset:16384
    ds_write_b128 v96, v[32:35] offset:0
    ds_write_b128 v96, v[36:39] offset:16384
    ds_write_b128 v96, v[40:43] offset:32768
    ds_write_b128 v98, v[44:47] offset:0
    v_lshlrev_b32 v76, 16, v48
    v_and_b32 v84, s25, v48
    v_lshlrev_b32 v77, 16, v52
    v_and_b32 v85, s25, v52
    v_lshlrev_b32 v78, 16, v56
    v_and_b32 v86, s25, v56
    v_lshlrev_b32 v79, 16, v60
    v_and_b32 v87, s25, v60
    v_add_f32 v80, v76, v78
    v_add_f32 v88, v84, v86
    v_add_f32 v81, v77, v79
    v_add_f32 v89, v85, v87
    v_fma_f32 v82, v78, 4.0, v76
    v_fma_f32 v90, v86, 4.0, v84
    v_fma_f32 v83, v79, 4.0, v77
    v_fma_f32 v91, v87, 4.0, v85
    v_add_f32 v77, v80, v81
    v_add_f32 v85, v88, v89
    v_sub_f32 v78, v80, v81
    v_sub_f32 v86, v88, v89
    v_fma_f32 v79, v83, 2.0, v82
    v_fma_f32 v87, v91, 2.0, v90
    v_fma_f32 v82, v83, -2.0, v82
    v_fma_f32 v90, v91, -2.0, v90
    v_fmamk_f32 v80, v76, 0x41700000, v82
    v_fmamk_f32 v88, v84, 0x41700000, v90
    v_fmamk_f32 v80, v81, 0x41200000, v80
    v_fmamk_f32 v88, v89, 0x41200000, v88
    v_cvt_pk_bf16_f32 v52, v77, v85
    v_cvt_pk_bf16_f32 v56, v78, v86
    v_cvt_pk_bf16_f32 v64, v79, v87
    v_cvt_pk_bf16_f32 v68, v82, v90
    v_cvt_pk_bf16_f32 v72, v80, v88
    v_lshlrev_b32 v76, 16, v49
    v_and_b32 v84, s25, v49
    v_lshlrev_b32 v77, 16, v53
    v_and_b32 v85, s25, v53
    v_lshlrev_b32 v78, 16, v57
    v_and_b32 v86, s25, v57
    v_lshlrev_b32 v79, 16, v61
    v_and_b32 v87, s25, v61
    v_add_f32 v80, v76, v78
    v_add_f32 v88, v84, v86
    v_add_f32 v81, v77, v79
    v_add_f32 v89, v85, v87
    v_fma_f32 v82, v78, 4.0, v76
    v_fma_f32 v90, v86, 4.0, v84
    v_fma_f32 v83, v79, 4.0, v77
    v_fma_f32 v91, v87, 4.0, v85
    v_add_f32 v77, v80, v81
    v_add_f32 v85, v88, v89
    v_sub_f32 v78, v80, v81
    v_sub_f32 v86, v88, v89
    v_fma_f32 v79, v83, 2.0, v82
    v_fma_f32 v87, v91, 2.0, v90
    v_fma_f32 v82, v83, -2.0, v82
    v_fma_f32 v90, v91, -2.0, v90
    v_fmamk_f32 v80, v76, 0x41700000, v82
    v_fmamk_f32 v88, v84, 0x41700000, v90
    v_fmamk_f32 v80, v81, 0x41200000, v80
    v_fmamk_f32 v88, v89, 0x41200000, v88
    v_cvt_pk_bf16_f32 v53, v77, v85
    v_cvt_pk_bf16_f32 v57, v78, v86
    v_cvt_pk_bf16_f32 v65, v79, v87
    v_cvt_pk_bf16_f32 v69, v82, v90
    v_cvt_pk_bf16_f32 v73, v80, v88
    v_lshlrev_b32 v76, 16, v50
    v_and_b32 v84, s25, v50
    v_lshlrev_b32 v77, 16, v54
    v_and_b32 v85, s25, v54
    v_lshlrev_b32 v78, 16, v58
    v_and_b32 v86, s25, v58
    v_lshlrev_b32 v79, 16, v62
    v_and_b32 v87, s25, v62
    v_add_f32 v80, v76, v78
    v_add_f32 v88, v84, v86
    v_add_f32 v81, v77, v79
    v_add_f32 v89, v85, v87
    v_fma_f32 v82, v78, 4.0, v76
    v_fma_f32 v90, v86, 4.0, v84
    v_fma_f32 v83, v79, 4.0, v77
    v_fma_f32 v91, v87, 4.0, v85
    v_add_f32 v77, v80, v81
    v_add_f32 v85, v88, v89
    v_sub_f32 v78, v80, v81
    v_sub_f32 v86, v88, v89
    v_fma_f32 v79, v83, 2.0, v82
    v_fma_f32 v87, v91, 2.0, v90
    v_fma_f32 v82, v83, -2.0, v82
    v_fma_f32 v90, v91, -2.0, v90
    v_fmamk_f32 v80, v76, 0x41700000, v82
    v_fmamk_f32 v88, v84, 0x41700000, v90
    v_fmamk_f32 v80, v81, 0x41200000, v80
    v_fmamk_f32 v88, v89, 0x41200000, v88
    v_cvt_pk_bf16_f32 v54, v77, v85
    v_cvt_pk_bf16_f32 v58, v78, v86
    v_cvt_pk_bf16_f32 v66, v79, v87
    v_cvt_pk_bf16_f32 v70, v82, v90
    v_cvt_pk_bf16_f32 v74, v80, v88
    v_lshlrev_b32 v76, 16, v51
    v_and_b32 v84, s25, v51
    v_lshlrev_b32 v77, 16, v55
    v_and_b32 v85, s25, v55
    v_lshlrev_b32 v78, 16, v59
    v_and_b32 v86, s25, v59
    v_lshlrev_b32 v79, 16, v63
    v_and_b32 v87, s25, v63
    v_add_f32 v80, v76, v78
    v_add_f32 v88, v84, v86
    v_add_f32 v81, v77, v79
    v_add_f32 v89, v85, v87
    v_fma_f32 v82, v78, 4.0, v76
    v_fma_f32 v90, v86, 4.0, v84
    v_fma_f32 v83, v79, 4.0, v77
    v_fma_f32 v91, v87, 4.0, v85
    v_add_f32 v77, v80, v81
    v_add_f32 v85, v88, v89
    v_sub_f32 v78, v80, v81
    v_sub_f32 v86, v88, v89
    v_fma_f32 v79, v83, 2.0, v82
    v_fma_f32 v87, v91, 2.0, v90
    v_fma_f32 v82, v83, -2.0, v82
    v_fma_f32 v90, v91, -2.0, v90
    v_fmamk_f32 v80, v76, 0x41700000, v82
    v_fmamk_f32 v88, v84, 0x41700000, v90
    v_fmamk_f32 v80, v81, 0x41200000, v80
    v_fmamk_f32 v88, v89, 0x41200000, v88
    v_cvt_pk_bf16_f32 v55, v77, v85
    v_cvt_pk_bf16_f32 v59, v78, v86
    v_cvt_pk_bf16_f32 v67, v79, v87
    v_cvt_pk_bf16_f32 v71, v82, v90
    v_cvt_pk_bf16_f32 v75, v80, v88
    s_add_u32 s28, s28, 1
    s_waitcnt lgkmcnt(0)
    s_barrier
    s_cmp_eq_u32 s22, 1
    s_cbranch_scc1 L_conv1_kernel_hlast2
    s_cmp_lt_u32 s28, 12
    s_cselect_b32 s24, 0, 2130706432
    ds_write_b128 v96, v[64:67] offset:57344
    ds_write_b128 v97, v[68:71] offset:8192
    ds_write_b128 v97, v[72:75] offset:24576
    ds_write_b128 v96, v[48:51] offset:8192
    ds_write_b128 v96, v[52:55] offset:24576
    ds_write_b128 v96, v[56:59] offset:40960
    ds_write_b128 v98, v[60:63] offset:8704
    s_waitcnt vmcnt(0)
    buffer_load_dwordx4 v[32:35], v92, s[8:11], s24 offen offset:0
    buffer_load_dwordx4 v[48:51], v92, s[8:11], s24 offen offset:64
    v_add_u32 v92, 128, v92
    buffer_load_dwordx4 v[36:39], v93, s[8:11], s24 offen offset:0
    buffer_load_dwordx4 v[52:55], v93, s[8:11], s24 offen offset:64
    v_add_u32 v93, 128, v93
    buffer_load_dwordx4 v[40:43], v94, s[8:11], s24 offen offset:0
    buffer_load_dwordx4 v[56:59], v94, s[8:11], s24 offen offset:64
    v_add_u32 v94, 128, v94
    buffer_load_dwordx4 v[44:47], v95, s[8:11], s24 offen offset:0
    buffer_load_dwordx4 v[60:63], v95, s[8:11], s24 offen offset:64
    v_add_u32 v95, 128, v95
    v_lshlrev_b32 v76, 16, v0
    v_and_b32 v84, s25, v0
    v_lshlrev_b32 v77, 16, v4
    v_and_b32 v85, s25, v4
    v_lshlrev_b32 v78, 16, v8
    v_and_b32 v86, s25, v8
    v_lshlrev_b32 v79, 16, v12
    v_and_b32 v87, s25, v12
    v_add_f32 v80, v76, v78
    v_add_f32 v88, v84, v86
    v_add_f32 v81, v77, v79
    v_add_f32 v89, v85, v87
    v_fma_f32 v82, v78, 4.0, v76
    v_fma_f32 v90, v86, 4.0, v84
    v_fma_f32 v83, v79, 4.0, v77
    v_fma_f32 v91, v87, 4.0, v85
    v_add_f32 v77, v80, v81
    v_add_f32 v85, v88, v89
    v_sub_f32 v78, v80, v81
    v_sub_f32 v86, v88, v89
    v_fma_f32 v79, v83, 2.0, v82
    v_fma_f32 v87, v91, 2.0, v90
    v_fma_f32 v82, v83, -2.0, v82
    v_fma_f32 v90, v91, -2.0, v90
    v_fmamk_f32 v80, v76, 0x41700000, v82
    v_fmamk_f32 v88, v84, 0x41700000, v90
    v_fmamk_f32 v80, v81, 0x41200000, v80
    v_fmamk_f32 v88, v89, 0x41200000, v88
    v_cvt_pk_bf16_f32 v4, v77, v85
    v_cvt_pk_bf16_f32 v8, v78, v86
    v_cvt_pk_bf16_f32 v64, v79, v87
    v_cvt_pk_bf16_f32 v68, v82, v90
    v_cvt_pk_bf16_f32 v72, v80, v88
    v_lshlrev_b32 v76, 16, v1
    v_and_b32 v84, s25, v1
    v_lshlrev_b32 v77, 16, v5
    v_and_b32 v85, s25, v5
    v_lshlrev_b32 v78, 16, v9
    v_and_b32 v86, s25, v9
    v_lshlrev_b32 v79, 16, v13
    v_and_b32 v87, s25, v13
    v_add_f32 v80, v76, v78
    v_add_f32 v88, v84, v86
    v_add_f32 v81, v77, v79
    v_add_f32 v89, v85, v87
    v_fma_f32 v82, v78, 4.0, v76
    v_fma_f32 v90, v86, 4.0, v84
    v_fma_f32 v83, v79, 4.0, v77
    v_fma_f32 v91, v87, 4.0, v85
    v_add_f32 v77, v80, v81
    v_add_f32 v85, v88, v89
    v_sub_f32 v78, v80, v81
    v_sub_f32 v86, v88, v89
    v_fma_f32 v79, v83, 2.0, v82
    v_fma_f32 v87, v91, 2.0, v90
    v_fma_f32 v82, v83, -2.0, v82
    v_fma_f32 v90, v91, -2.0, v90
    v_fmamk_f32 v80, v76, 0x41700000, v82
    v_fmamk_f32 v88, v84, 0x41700000, v90
    v_fmamk_f32 v80, v81, 0x41200000, v80
    v_fmamk_f32 v88, v89, 0x41200000, v88
    v_cvt_pk_bf16_f32 v5, v77, v85
    v_cvt_pk_bf16_f32 v9, v78, v86
    v_cvt_pk_bf16_f32 v65, v79, v87
    v_cvt_pk_bf16_f32 v69, v82, v90
    v_cvt_pk_bf16_f32 v73, v80, v88
    v_lshlrev_b32 v76, 16, v2
    v_and_b32 v84, s25, v2
    v_lshlrev_b32 v77, 16, v6
    v_and_b32 v85, s25, v6
    v_lshlrev_b32 v78, 16, v10
    v_and_b32 v86, s25, v10
    v_lshlrev_b32 v79, 16, v14
    v_and_b32 v87, s25, v14
    v_add_f32 v80, v76, v78
    v_add_f32 v88, v84, v86
    v_add_f32 v81, v77, v79
    v_add_f32 v89, v85, v87
    v_fma_f32 v82, v78, 4.0, v76
    v_fma_f32 v90, v86, 4.0, v84
    v_fma_f32 v83, v79, 4.0, v77
    v_fma_f32 v91, v87, 4.0, v85
    v_add_f32 v77, v80, v81
    v_add_f32 v85, v88, v89
    v_sub_f32 v78, v80, v81
    v_sub_f32 v86, v88, v89
    v_fma_f32 v79, v83, 2.0, v82
    v_fma_f32 v87, v91, 2.0, v90
    v_fma_f32 v82, v83, -2.0, v82
    v_fma_f32 v90, v91, -2.0, v90
    v_fmamk_f32 v80, v76, 0x41700000, v82
    v_fmamk_f32 v88, v84, 0x41700000, v90
    v_fmamk_f32 v80, v81, 0x41200000, v80
    v_fmamk_f32 v88, v89, 0x41200000, v88
    v_cvt_pk_bf16_f32 v6, v77, v85
    v_cvt_pk_bf16_f32 v10, v78, v86
    v_cvt_pk_bf16_f32 v66, v79, v87
    v_cvt_pk_bf16_f32 v70, v82, v90
    v_cvt_pk_bf16_f32 v74, v80, v88
    v_lshlrev_b32 v76, 16, v3
    v_and_b32 v84, s25, v3
    v_lshlrev_b32 v77, 16, v7
    v_and_b32 v85, s25, v7
    v_lshlrev_b32 v78, 16, v11
    v_and_b32 v86, s25, v11
    v_lshlrev_b32 v79, 16, v15
    v_and_b32 v87, s25, v15
    v_add_f32 v80, v76, v78
    v_add_f32 v88, v84, v86
    v_add_f32 v81, v77, v79
    v_add_f32 v89, v85, v87
    v_fma_f32 v82, v78, 4.0, v76
    v_fma_f32 v90, v86, 4.0, v84
    v_fma_f32 v83, v79, 4.0, v77
    v_fma_f32 v91, v87, 4.0, v85
    v_add_f32 v77, v80, v81
    v_add_f32 v85, v88, v89
    v_sub_f32 v78, v80, v81
    v_sub_f32 v86, v88, v89
    v_fma_f32 v79, v83, 2.0, v82
    v_fma_f32 v87, v91, 2.0, v90
    v_fma_f32 v82, v83, -2.0, v82
    v_fma_f32 v90, v91, -2.0, v90
    v_fmamk_f32 v80, v76, 0x41700000, v82
    v_fmamk_f32 v88, v84, 0x41700000, v90
    v_fmamk_f32 v80, v81, 0x41200000, v80
    v_fmamk_f32 v88, v89, 0x41200000, v88
    v_cvt_pk_bf16_f32 v7, v77, v85
    v_cvt_pk_bf16_f32 v11, v78, v86
    v_cvt_pk_bf16_f32 v67, v79, v87
    v_cvt_pk_bf16_f32 v71, v82, v90
    v_cvt_pk_bf16_f32 v75, v80, v88
    s_add_u32 s28, s28, 1
    s_waitcnt lgkmcnt(0)
    s_barrier
    s_cmp_lt_u32 s28, 12
    s_cselect_b32 s24, 0, 2130706432
    ds_write_b128 v96, v[64:67] offset:49152
    ds_write_b128 v97, v[68:71] offset:0
    ds_write_b128 v97, v[72:75] offset:16384
    ds_write_b128 v96, v[0:3] offset:0
    ds_write_b128 v96, v[4:7] offset:16384
    ds_write_b128 v96, v[8:11] offset:32768
    ds_write_b128 v98, v[12:15] offset:0
    v_lshlrev_b32 v76, 16, v16
    v_and_b32 v84, s25, v16
    v_lshlrev_b32 v77, 16, v20
    v_and_b32 v85, s25, v20
    v_lshlrev_b32 v78, 16, v24
    v_and_b32 v86, s25, v24
    v_lshlrev_b32 v79, 16, v28
    v_and_b32 v87, s25, v28
    v_add_f32 v80, v76, v78
    v_add_f32 v88, v84, v86
    v_add_f32 v81, v77, v79
    v_add_f32 v89, v85, v87
    v_fma_f32 v82, v78, 4.0, v76
    v_fma_f32 v90, v86, 4.0, v84
    v_fma_f32 v83, v79, 4.0, v77
    v_fma_f32 v91, v87, 4.0, v85
    v_add_f32 v77, v80, v81
    v_add_f32 v85, v88, v89
    v_sub_f32 v78, v80, v81
    v_sub_f32 v86, v88, v89
    v_fma_f32 v79, v83, 2.0, v82
    v_fma_f32 v87, v91, 2.0, v90
    v_fma_f32 v82, v83, -2.0, v82
    v_fma_f32 v90, v91, -2.0, v90
    v_fmamk_f32 v80, v76, 0x41700000, v82
    v_fmamk_f32 v88, v84, 0x41700000, v90
    v_fmamk_f32 v80, v81, 0x41200000, v80
    v_fmamk_f32 v88, v89, 0x41200000, v88
    v_cvt_pk_bf16_f32 v20, v77, v85
    v_cvt_pk_bf16_f32 v24, v78, v86
    v_cvt_pk_bf16_f32 v64, v79, v87
    v_cvt_pk_bf16_f32 v68, v82, v90
    v_cvt_pk_bf16_f32 v72, v80, v88
    v_lshlrev_b32 v76, 16, v17
    v_and_b32 v84, s25, v17
    v_lshlrev_b32 v77, 16, v21
    v_and_b32 v85, s25, v21
    v_lshlrev_b32 v78, 16, v25
    v_and_b32 v86, s25, v25
    v_lshlrev_b32 v79, 16, v29
    v_and_b32 v87, s25, v29
    v_add_f32 v80, v76, v78
    v_add_f32 v88, v84, v86
    v_add_f32 v81, v77, v79
    v_add_f32 v89, v85, v87
    v_fma_f32 v82, v78, 4.0, v76
    v_fma_f32 v90, v86, 4.0, v84
    v_fma_f32 v83, v79, 4.0, v77
    v_fma_f32 v91, v87, 4.0, v85
    v_add_f32 v77, v80, v81
    v_add_f32 v85, v88, v89
    v_sub_f32 v78, v80, v81
    v_sub_f32 v86, v88, v89
    v_fma_f32 v79, v83, 2.0, v82
    v_fma_f32 v87, v91, 2.0, v90
    v_fma_f32 v82, v83, -2.0, v82
    v_fma_f32 v90, v91, -2.0, v90
    v_fmamk_f32 v80, v76, 0x41700000, v82
    v_fmamk_f32 v88, v84, 0x41700000, v90
    v_fmamk_f32 v80, v81, 0x41200000, v80
    v_fmamk_f32 v88, v89, 0x41200000, v88
    v_cvt_pk_bf16_f32 v21, v77, v85
    v_cvt_pk_bf16_f32 v25, v78, v86
    v_cvt_pk_bf16_f32 v65, v79, v87
    v_cvt_pk_bf16_f32 v69, v82, v90
    v_cvt_pk_bf16_f32 v73, v80, v88
    v_lshlrev_b32 v76, 16, v18
    v_and_b32 v84, s25, v18
    v_lshlrev_b32 v77, 16, v22
    v_and_b32 v85, s25, v22
    v_lshlrev_b32 v78, 16, v26
    v_and_b32 v86, s25, v26
    v_lshlrev_b32 v79, 16, v30
    v_and_b32 v87, s25, v30
    v_add_f32 v80, v76, v78
    v_add_f32 v88, v84, v86
    v_add_f32 v81, v77, v79
    v_add_f32 v89, v85, v87
    v_fma_f32 v82, v78, 4.0, v76
    v_fma_f32 v90, v86, 4.0, v84
    v_fma_f32 v83, v79, 4.0, v77
    v_fma_f32 v91, v87, 4.0, v85
    v_add_f32 v77, v80, v81
    v_add_f32 v85, v88, v89
    v_sub_f32 v78, v80, v81
    v_sub_f32 v86, v88, v89
    v_fma_f32 v79, v83, 2.0, v82
    v_fma_f32 v87, v91, 2.0, v90
    v_fma_f32 v82, v83, -2.0, v82
    v_fma_f32 v90, v91, -2.0, v90
    v_fmamk_f32 v80, v76, 0x41700000, v82
    v_fmamk_f32 v88, v84, 0x41700000, v90
    v_fmamk_f32 v80, v81, 0x41200000, v80
    v_fmamk_f32 v88, v89, 0x41200000, v88
    v_cvt_pk_bf16_f32 v22, v77, v85
    v_cvt_pk_bf16_f32 v26, v78, v86
    v_cvt_pk_bf16_f32 v66, v79, v87
    v_cvt_pk_bf16_f32 v70, v82, v90
    v_cvt_pk_bf16_f32 v74, v80, v88
    v_lshlrev_b32 v76, 16, v19
    v_and_b32 v84, s25, v19
    v_lshlrev_b32 v77, 16, v23
    v_and_b32 v85, s25, v23
    v_lshlrev_b32 v78, 16, v27
    v_and_b32 v86, s25, v27
    v_lshlrev_b32 v79, 16, v31
    v_and_b32 v87, s25, v31
    v_add_f32 v80, v76, v78
    v_add_f32 v88, v84, v86
    v_add_f32 v81, v77, v79
    v_add_f32 v89, v85, v87
    v_fma_f32 v82, v78, 4.0, v76
    v_fma_f32 v90, v86, 4.0, v84
    v_fma_f32 v83, v79, 4.0, v77
    v_fma_f32 v91, v87, 4.0, v85
    v_add_f32 v77, v80, v81
    v_add_f32 v85, v88, v89
    v_sub_f32 v78, v80, v81
    v_sub_f32 v86, v88, v89
    v_fma_f32 v79, v83, 2.0, v82
    v_fma_f32 v87, v91, 2.0, v90
    v_fma_f32 v82, v83, -2.0, v82
    v_fma_f32 v90, v91, -2.0, v90
    v_fmamk_f32 v80, v76, 0x41700000, v82
    v_fmamk_f32 v88, v84, 0x41700000, v90
    v_fmamk_f32 v80, v81, 0x41200000, v80
    v_fmamk_f32 v88, v89, 0x41200000, v88
    v_cvt_pk_bf16_f32 v23, v77, v85
    v_cvt_pk_bf16_f32 v27, v78, v86
    v_cvt_pk_bf16_f32 v67, v79, v87
    v_cvt_pk_bf16_f32 v71, v82, v90
    v_cvt_pk_bf16_f32 v75, v80, v88
    s_add_u32 s28, s28, 1
    s_waitcnt lgkmcnt(0)
    s_barrier
    s_sub_u32 s22, s22, 1
    s_branch L_conv1_kernel_hloop2
L_conv1_kernel_hlast2:
    s_waitcnt vmcnt(0)
    s_mov_b32 s58, s20
    s_lshl_b32 s20, s2, 2
    s_add_u32 s20, s20, s32
    v_mov_b32 v1, v127
    s_load_dwordx2 s[8:9], s[0:1], 16
    s_lshr_b32 s22, s20, 8
    s_bfe_u32 s23, s20, 0x40004
    s_bfe_u32 s24, s20, 0x30001
    s_and_b32 s21, s20, 1
    v_lshrrev_b32 v2, 4, v1
    v_lshlrev_b32 v2, 12, v2
    v_and_b32 v3, 15, v1
    v_lshl_add_u32 v2, v3, 2, v2
    s_lshl_b32 s26, s22, 3
    s_lshr_b32 s27, s23, 3
    s_add_u32 s26, s26, s27
    s_lshl_b32 s26, s26, 17
    s_and_b32 s27, s23, 7
    s_lshl_b32 s27, s27, 14
    s_add_u32 s26, s26, s27
    s_lshl_b32 s27, s24, 6
    s_add_u32 s26, s26, s27
    s_mov_b32 s10, 4063232
    s_mov_b32 s11, 0x00020000
    s_add_u32 s37, s26, 262144
    s_add_u32 s38, s26, 524288
    s_add_u32 s39, s26, 786432
    s_waitcnt lgkmcnt(0)
    buffer_load_dword v16, v2, s[8:11], s26 offen offset:0
    buffer_load_dword v17, v2, s[8:11], s26 offen offset:512
    buffer_load_dword v24, v2, s[8:11], s37 offen offset:0
    buffer_load_dword v25, v2, s[8:11], s37 offen offset:512
    buffer_load_dword v32, v2, s[8:11], s38 offen offset:0
    buffer_load_dword v33, v2, s[8:11], s38 offen offset:512
    buffer_load_dword v40, v2, s[8:11], s39 offen offset:0
    buffer_load_dword v41, v2, s[8:11], s39 offen offset:512
    buffer_load_dword v18, v2, s[8:11], s26 offen offset:1024
    buffer_load_dword v19, v2, s[8:11], s26 offen offset:1536
    buffer_load_dword v26, v2, s[8:11], s37 offen offset:1024
    buffer_load_dword v27, v2, s[8:11], s37 offen offset:1536
    buffer_load_dword v34, v2, s[8:11], s38 offen offset:1024
    buffer_load_dword v35, v2, s[8:11], s38 offen offset:1536
    buffer_load_dword v42, v2, s[8:11], s39 offen offset:1024
    buffer_load_dword v43, v2, s[8:11], s39 offen offset:1536
    buffer_load_dword v20, v2, s[8:11], s26 offen offset:2048
    buffer_load_dword v21, v2, s[8:11], s26 offen offset:2560
    buffer_load_dword v28, v2, s[8:11], s37 offen offset:2048
    buffer_load_dword v29, v2, s[8:11], s37 offen offset:2560
    buffer_load_dword v36, v2, s[8:11], s38 offen offset:2048
    buffer_load_dword v37, v2, s[8:11], s38 offen offset:2560
    buffer_load_dword v44, v2, s[8:11], s39 offen offset:2048
    buffer_load_dword v45, v2, s[8:11], s39 offen offset:2560
    buffer_load_dword v22, v2, s[8:11], s26 offen offset:3072
    buffer_load_dword v23, v2, s[8:11], s26 offen offset:3584
    buffer_load_dword v30, v2, s[8:11], s37 offen offset:3072
    buffer_load_dword v31, v2, s[8:11], s37 offen offset:3584
    buffer_load_dword v38, v2, s[8:11], s38 offen offset:3072
    buffer_load_dword v39, v2, s[8:11], s38 offen offset:3584
    buffer_load_dword v46, v2, s[8:11], s39 offen offset:3072
    buffer_load_dword v47, v2, s[8:11], s39 offen offset:3584
    s_add_u32 s12, s30, 9437184
    s_addc_u32 s13, s31, 0
    s_mov_b32 s14, 7340032
    s_mov_b32 s15, 0x00020000
    v_lshlrev_b32 v4, 4, v1
    s_lshl_b32 s27, s24, 4
    s_add_u32 s27, s27, s23
    s_mul_i32 s27, s27, 57344
    s_lshl_b32 s28, s22, 11
    s_add_u32 s27, s27, s28
    s_lshl_b32 s28, s21, 10
    s_add_u32 s27, s27, s28
    s_cmp_eq_u32 s21, 0
    s_mov_b32 s32, 0x07060302
    s_cselect_b32 s32, 0x05040100, s32
    s_mov_b32 s33, 0x03020c0c
    s_cselect_b32 s33, 0x01000c0c, s33
    s_mov_b32 s35, 0x3d2aaaab
    s_mov_b32 s36, 0x3c638e39
    s_mov_b32 s25, 0xffff0000
    ds_write_b128 v96, v[64:67] offset:57344
    ds_write_b128 v97, v[68:71] offset:8192
    ds_write_b128 v97, v[72:75] offset:24576
    ds_write_b128 v96, v[48:51] offset:8192
    ds_write_b128 v96, v[52:55] offset:24576
    ds_write_b128 v96, v[56:59] offset:40960
    ds_write_b128 v98, v[60:63] offset:8704
    s_waitcnt lgkmcnt(0)
    s_barrier
    s_waitcnt vmcnt(24)
    v_perm_b32 v72, v17, v16, s32
    v_perm_b32 v48, v41, v40, s32
    v_perm_b32 v76, v76, v40, s33
    v_perm_b32 v84, v84, v41, s33
    v_perm_b32 v77, v77, v32, s33
    v_perm_b32 v85, v85, v33, s33
    v_perm_b32 v78, v78, v24, s33
    v_perm_b32 v86, v86, v25, s33
    v_perm_b32 v79, v79, v16, s33
    v_perm_b32 v87, v87, v17, s33
    v_add_f32 v80, v76, v78
    v_add_f32 v88, v84, v86
    v_add_f32 v81, v77, v79
    v_add_f32 v89, v85, v87
    v_fma_f32 v82, v78, 4.0, v76
    v_fma_f32 v90, v86, 4.0, v84
    v_fma_f32 v83, v79, 4.0, v77
    v_fma_f32 v91, v87, 4.0, v85
    v_add_f32 v77, v80, v81
    v_add_f32 v85, v88, v89
    v_sub_f32 v78, v80, v81
    v_sub_f32 v86, v88, v89
    v_fma_f32 v79, v83, 2.0, v82
    v_fma_f32 v87, v91, 2.0, v90
    v_fma_f32 v82, v83, -2.0, v82
    v_fma_f32 v90, v91, -2.0, v90
    v_fmamk_f32 v80, v76, 0x41700000, v82
    v_fmamk_f32 v88, v84, 0x41700000, v90
    v_fmamk_f32 v80, v81, 0x41200000, v80
    v_fmamk_f32 v88, v89, 0x41200000, v88
    v_mul_f32 v77, 0.5, v77
    v_mul_f32 v85, 0.5, v85
    v_mul_f32 v78, 0.5, v78
    v_mul_f32 v86, 0.5, v86
    v_mul_f32 v79, s35, v79
    v_mul_f32 v87, s35, v87
    v_mul_f32 v82, s35, v82
    v_mul_f32 v90, s35, v90
    v_mul_f32 v80, s36, v80
    v_mul_f32 v88, s36, v88
    v_cvt_pk_bf16_f32 v52, v77, v85
    v_cvt_pk_bf16_f32 v56, v78, v86
    v_cvt_pk_bf16_f32 v60, v79, v87
    v_cvt_pk_bf16_f32 v64, v82, v90
    v_cvt_pk_bf16_f32 v68, v80, v88
    s_waitcnt vmcnt(16)
    v_perm_b32 v73, v19, v18, s32
    v_perm_b32 v49, v43, v42, s32
    v_perm_b32 v76, v76, v42, s33
    v_perm_b32 v84, v84, v43, s33
    v_perm_b32 v77, v77, v34, s33
    v_perm_b32 v85, v85, v35, s33
    v_perm_b32 v78, v78, v26, s33
    v_perm_b32 v86, v86, v27, s33
    v_perm_b32 v79, v79, v18, s33
    v_perm_b32 v87, v87, v19, s33
    v_add_f32 v80, v76, v78
    v_add_f32 v88, v84, v86
    v_add_f32 v81, v77, v79
    v_add_f32 v89, v85, v87
    v_fma_f32 v82, v78, 4.0, v76
    v_fma_f32 v90, v86, 4.0, v84
    v_fma_f32 v83, v79, 4.0, v77
    v_fma_f32 v91, v87, 4.0, v85
    v_add_f32 v77, v80, v81
    v_add_f32 v85, v88, v89
    v_sub_f32 v78, v80, v81
    v_sub_f32 v86, v88, v89
    v_fma_f32 v79, v83, 2.0, v82
    v_fma_f32 v87, v91, 2.0, v90
    v_fma_f32 v82, v83, -2.0, v82
    v_fma_f32 v90, v91, -2.0, v90
    v_fmamk_f32 v80, v76, 0x41700000, v82
    v_fmamk_f32 v88, v84, 0x41700000, v90
    v_fmamk_f32 v80, v81, 0x41200000, v80
    v_fmamk_f32 v88, v89, 0x41200000, v88
    v_mul_f32 v77, 0.5, v77
    v_mul_f32 v85, 0.5, v85
    v_mul_f32 v78, 0.5, v78
    v_mul_f32 v86, 0.5, v86
    v_mul_f32 v79, s35, v79
    v_mul_f32 v87, s35, v87
    v_mul_f32 v82, s35, v82
    v_mul_f32 v90, s35, v90
    v_mul_f32 v80, s36, v80
    v_mul_f32 v88, s36, v88
    v_cvt_pk_bf16_f32 v53, v77, v85
    v_cvt_pk_bf16_f32 v57, v78, v86
    v_cvt_pk_bf16_f32 v61, v79, v87
    v_cvt_pk_bf16_f32 v65, v82, v90
    v_cvt_pk_bf16_f32 v69, v80, v88
    s_waitcnt vmcnt(8)
    v_perm_b32 v74, v21, v20, s32
    v_perm_b32 v50, v45, v44, s32
    v_perm_b32 v76, v76, v44, s33
    v_perm_b32 v84, v84, v45, s33
    v_perm_b32 v77, v77, v36, s33
    v_perm_b32 v85, v85, v37, s33
    v_perm_b32 v78, v78, v28, s33
    v_perm_b32 v86, v86, v29, s33
    v_perm_b32 v79, v79, v20, s33
    v_perm_b32 v87, v87, v21, s33
    v_add_f32 v80, v76, v78
    v_add_f32 v88, v84, v86
    v_add_f32 v81, v77, v79
    v_add_f32 v89, v85, v87
    v_fma_f32 v82, v78, 4.0, v76
    v_fma_f32 v90, v86, 4.0, v84
    v_fma_f32 v83, v79, 4.0, v77
    v_fma_f32 v91, v87, 4.0, v85
    v_add_f32 v77, v80, v81
    v_add_f32 v85, v88, v89
    v_sub_f32 v78, v80, v81
    v_sub_f32 v86, v88, v89
    v_fma_f32 v79, v83, 2.0, v82
    v_fma_f32 v87, v91, 2.0, v90
    v_fma_f32 v82, v83, -2.0, v82
    v_fma_f32 v90, v91, -2.0, v90
    v_fmamk_f32 v80, v76, 0x41700000, v82
    v_fmamk_f32 v88, v84, 0x41700000, v90
    v_fmamk_f32 v80, v81, 0x41200000, v80
    v_fmamk_f32 v88, v89, 0x41200000, v88
    v_mul_f32 v77, 0.5, v77
    v_mul_f32 v85, 0.5, v85
    v_mul_f32 v78, 0.5, v78
    v_mul_f32 v86, 0.5, v86
    v_mul_f32 v79, s35, v79
    v_mul_f32 v87, s35, v87
    v_mul_f32 v82, s35, v82
    v_mul_f32 v90, s35, v90
    v_mul_f32 v80, s36, v80
    v_mul_f32 v88, s36, v88
    v_cvt_pk_bf16_f32 v54, v77, v85
    v_cvt_pk_bf16_f32 v58, v78, v86
    v_cvt_pk_bf16_f32 v62, v79, v87
    v_cvt_pk_bf16_f32 v66, v82, v90
    v_cvt_pk_bf16_f32 v70, v80, v88
    s_waitcnt vmcnt(0)
    v_perm_b32 v75, v23, v22, s32
    v_perm_b32 v51, v47, v46, s32
    v_perm_b32 v76, v76, v46, s33
    v_perm_b32 v84, v84, v47, s33
    v_perm_b32 v77, v77, v38, s33
    v_perm_b32 v85, v85, v39, s33
    v_perm_b32 v78, v78, v30, s33
    v_perm_b32 v86, v86, v31, s33
    v_perm_b32 v79, v79, v22, s33
    v_perm_b32 v87, v87, v23, s33
    v_add_f32 v80, v76, v78
    v_add_f32 v88, v84, v86
    v_add_f32 v81, v77, v79
    v_add_f32 v89, v85, v87
    v_fma_f32 v82, v78, 4.0, v76
    v_fma_f32 v90, v86, 4.0, v84
    v_fma_f32 v83, v79, 4.0, v77
    v_fma_f32 v91, v87, 4.0, v85
    v_add_f32 v77, v80, v81
    v_add_f32 v85, v88, v89
    v_sub_f32 v78, v80, v81
    v_sub_f32 v86, v88, v89
    v_fma_f32 v79, v83, 2.0, v82
    v_fma_f32 v87, v91, 2.0, v90
    v_fma_f32 v82, v83, -2.0, v82
    v_fma_f32 v90, v91, -2.0, v90
    v_fmamk_f32 v80, v76, 0x41700000, v82
    v_fmamk_f32 v88, v84, 0x41700000, v90
    v_fmamk_f32 v80, v81, 0x41200000, v80
    v_fmamk_f32 v88, v89, 0x41200000, v88
    v_mul_f32 v77, 0.5, v77
    v_mul_f32 v85, 0.5, v85
    v_mul_f32 v78, 0.5, v78
    v_mul_f32 v86, 0.5, v86
    v_mul_f32 v79, s35, v79
    v_mul_f32 v87, s35, v87
    v_mul_f32 v82, s35, v82
    v_mul_f32 v90, s35, v90
    v_mul_f32 v80, s36, v80
    v_mul_f32 v88, s36, v88
    v_cvt_pk_bf16_f32 v55, v77, v85
    v_cvt_pk_bf16_f32 v59, v78, v86
    v_cvt_pk_bf16_f32 v63, v79, v87
    v_cvt_pk_bf16_f32 v67, v82, v90
    v_cvt_pk_bf16_f32 v71, v80, v88
    s_add_u32 s28, s27, 49152
    buffer_store_dwordx4 v[72:75], v4, s[12:15], s28 offen sc1
    s_add_u32 s28, s27, 0
    buffer_store_dwordx4 v[48:51], v4, s[12:15], s28 offen sc1
    s_add_u32 s28, s27, 8192
    buffer_store_dwordx4 v[52:55], v4, s[12:15], s28 offen sc1
    s_add_u32 s28, s27, 16384
    buffer_store_dwordx4 v[56:59], v4, s[12:15], s28 offen sc1
    s_add_u32 s28, s27, 24576
    buffer_store_dwordx4 v[60:63], v4, s[12:15], s28 offen sc1
    s_add_u32 s28, s27, 32768
    buffer_store_dwordx4 v[64:67], v4, s[12:15], s28 offen sc1
    s_add_u32 s28, s27, 40960
    buffer_store_dwordx4 v[68:71], v4, s[12:15], s28 offen sc1
    s_mov_b32 s20, s58
    s_branch L_conv1_kernel_end
L_conv1_kernel_epi:
    s_waitcnt lgkmcnt(0)
    s_barrier
    v_cndmask_b32 v122, v111, v110, vcc
    ds_read_b128 v[0:3], v120 offset:0
    ds_read_b128 v[4:7], v120 offset:16384
    ds_read_b128 v[8:11], v120 offset:32768
    ds_read_b128 v[12:15], v120 offset:49152
    ds_read_b128 v[16:19], v121 offset:0
    ds_read_b128 v[20:23], v121 offset:16384
    ds_read_b128 v[24:27], v121 offset:32768
    ds_read_b128 v[28:31], v64 offset:15360
    ds_read_b128 v[32:35], v120 offset:8192
    ds_read_b128 v[36:39], v120 offset:24576
    ds_read_b128 v[40:43], v120 offset:40960
    ds_read_b128 v[44:47], v120 offset:57344
    ds_read_b128 v[48:51], v121 offset:56320
    ds_read_b128 v[52:55], v121 offset:64512
    ds_read_b128 v[56:59], v64 offset:7168
    s_waitcnt lgkmcnt(7)
    ds_read_b128 v[60:63], v64 offset:23552
    s_waitcnt lgkmcnt(8)
    v_pk_add_f32 v[88:89], v[24:25], v[28:29]
    v_pk_add_f32 v[90:91], v[26:27], v[30:31]
    v_pk_add_f32 v[24:25], v[4:5], v[8:9]
    v_pk_add_f32 v[26:27], v[6:7], v[10:11]
    v_pk_add_f32 v[4:5], v[4:5], v[8:9] neg_lo:[0,1] neg_hi:[0,1]
    v_pk_add_f32 v[6:7], v[6:7], v[10:11] neg_lo:[0,1] neg_hi:[0,1]
    v_pk_add_f32 v[72:73], v[12:13], v[16:17]
    v_pk_add_f32 v[74:75], v[14:15], v[18:19]
    v_pk_add_f32 v[12:13], v[12:13], v[16:17] neg_lo:[0,1] neg_hi:[0,1]
    v_pk_add_f32 v[14:15], v[14:15], v[18:19] neg_lo:[0,1] neg_hi:[0,1]
    v_pk_fma_f32 v[72:73], v[24:25], s[4:5], v[72:73]
    v_pk_fma_f32 v[74:75], v[26:27], s[4:5], v[74:75]
    v_pk_fma_f32 v[20:21], v[0:1], s[10:11], v[20:21]
    v_pk_fma_f32 v[22:23], v[2:3], s[10:11], v[22:23]
    v_pk_fma_f32 v[72:73], v[0:1], s[6:7], v[72:73]
    v_pk_fma_f32 v[74:75], v[2:3], s[6:7], v[74:75]
    v_pk_add_f32 v[24:25], v[24:25], v[0:1] neg_lo:[0,1] neg_hi:[0,1]
    v_pk_add_f32 v[26:27], v[26:27], v[2:3] neg_lo:[0,1] neg_hi:[0,1]
    v_pk_fma_f32 v[72:73], v[88:89], s[8:9], v[72:73]
    v_pk_fma_f32 v[74:75], v[90:91], s[8:9], v[74:75]
    v_pk_add_f32 v[24:25], v[24:25], v[88:89] neg_lo:[0,1] neg_hi:[0,1]
    v_pk_add_f32 v[26:27], v[26:27], v[90:91] neg_lo:[0,1] neg_hi:[0,1]
    v_pk_fma_f32 v[20:21], v[88:89], s[22:23], v[20:21]
    v_pk_fma_f32 v[22:23], v[90:91], s[22:23], v[22:23]
    v_pk_add_f32 v[8:9], v[24:25], v[72:73] neg_lo:[0,1] neg_hi:[0,1]
    v_pk_add_f32 v[10:11], v[26:27], v[74:75] neg_lo:[0,1] neg_hi:[0,1]
    v_pk_fma_f32 v[20:21], v[72:73], s[14:15], v[20:21]
    v_pk_fma_f32 v[22:23], v[74:75], s[14:15], v[22:23]
    v_pk_mul_f32 v[80:81], v[12:13], s[32:33]
    v_pk_mul_f32 v[82:83], v[14:15], s[32:33]
    v_pk_fma_f32 v[20:21], v[8:9], s[12:13], v[20:21]
    v_pk_fma_f32 v[22:23], v[10:11], s[12:13], v[22:23]
    v_pk_fma_f32 v[80:81], v[4:5], s[34:35], v[80:81]
    v_pk_fma_f32 v[82:83], v[6:7], s[34:35], v[82:83]
    v_pk_fma_f32 v[64:65], v[4:5], s[24:25], v[20:21] neg_lo:[0,0,1] neg_hi:[0,0,1]
    v_pk_fma_f32 v[66:67], v[6:7], s[24:25], v[22:23] neg_lo:[0,0,1] neg_hi:[0,0,1]
    v_pk_fma_f32 v[64:65], v[12:13], s[26:27], v[64:65]
    v_pk_fma_f32 v[66:67], v[14:15], s[26:27], v[66:67]
    v_pk_fma_f32 v[80:81], v[64:65], s[38:39], v[80:81]
    v_pk_fma_f32 v[82:83], v[66:67], s[38:39], v[82:83]
    v_pk_add_f32 v[4:5], v[4:5], v[64:65] neg_lo:[0,1] neg_hi:[0,1]
    v_pk_add_f32 v[6:7], v[6:7], v[66:67] neg_lo:[0,1] neg_hi:[0,1]
    v_pk_add_f32 v[4:5], v[4:5], v[80:81] neg_lo:[0,1] neg_hi:[0,1]
    v_pk_add_f32 v[6:7], v[6:7], v[82:83] neg_lo:[0,1] neg_hi:[0,1]
    s_waitcnt lgkmcnt(0)
    v_pk_add_f32 v[92:93], v[56:57], v[60:61]
    v_pk_add_f32 v[94:95], v[58:59], v[62:63]
    v_pk_add_f32 v[56:57], v[36:37], v[40:41]
    v_pk_add_f32 v[58:59], v[38:39], v[42:43]
    v_pk_add_f32 v[36:37], v[36:37], v[40:41] neg_lo:[0,1] neg_hi:[0,1]
    v_pk_add_f32 v[38:39], v[38:39], v[42:43] neg_lo:[0,1] neg_hi:[0,1]
    v_pk_add_f32 v[76:77], v[44:45], v[48:49]
    v_pk_add_f32 v[78:79], v[46:47], v[50:51]
    v_pk_add_f32 v[44:45], v[44:45], v[48:49] neg_lo:[0,1] neg_hi:[0,1]
    v_pk_add_f32 v[46:47], v[46:47], v[50:51] neg_lo:[0,1] neg_hi:[0,1]
    v_pk_fma_f32 v[76:77], v[56:57], s[4:5], v[76:77]
    v_pk_fma_f32 v[78:79], v[58:59], s[4:5], v[78:79]
    v_pk_fma_f32 v[52:53], v[32:33], s[10:11], v[52:53]
    v_pk_fma_f32 v[54:55], v[34:35], s[10:11], v[54:55]
    v_pk_fma_f32 v[76:77], v[32:33], s[6:7], v[76:77]
    v_pk_fma_f32 v[78:79], v[34:35], s[6:7], v[78:79]
    v_pk_add_f32 v[56:57], v[56:57], v[32:33] neg_lo:[0,1] neg_hi:[0,1]
    v_pk_add_f32 v[58:59], v[58:59], v[34:35] neg_lo:[0,1] neg_hi:[0,1]
    v_pk_fma_f32 v[76:77], v[92:93], s[8:9], v[76:77]
    v_pk_fma_f32 v[78:79], v[94:95], s[8:9], v[78:79]
    v_pk_add_f32 v[56:57], v[56:57], v[92:93] neg_lo:[0,1] neg_hi:[0,1]
    v_pk_add_f32 v[58:59], v[58:59], v[94:95] neg_lo:[0,1] neg_hi:[0,1]
    v_pk_fma_f32 v[52:53], v[92:93], s[22:23], v[52:53]
    v_pk_fma_f32 v[54:55], v[94:95], s[22:23], v[54:55]
    v_pk_add_f32 v[40:41], v[56:57], v[76:77] neg_lo:[0,1] neg_hi:[0,1]
    v_pk_add_f32 v[42:43], v[58:59], v[78:79] neg_lo:[0,1] neg_hi:[0,1]
    v_pk_fma_f32 v[52:53], v[76:77], s[14:15], v[52:53]
    v_pk_fma_f32 v[54:55], v[78:79], s[14:15], v[54:55]
    v_pk_mul_f32 v[84:85], v[44:45], s[32:33]
    v_pk_mul_f32 v[86:87], v[46:47], s[32:33]
    v_pk_fma_f32 v[52:53], v[40:41], s[12:13], v[52:53]
    v_pk_fma_f32 v[54:55], v[42:43], s[12:13], v[54:55]
    v_pk_fma_f32 v[84:85], v[36:37], s[34:35], v[84:85]
    v_pk_fma_f32 v[86:87], v[38:39], s[34:35], v[86:87]
    v_pk_fma_f32 v[68:69], v[36:37], s[24:25], v[52:53] neg_lo:[0,0,1] neg_hi:[0,0,1]
    v_pk_fma_f32 v[70:71], v[38:39], s[24:25], v[54:55] neg_lo:[0,0,1] neg_hi:[0,0,1]
    v_pk_fma_f32 v[68:69], v[44:45], s[26:27], v[68:69]
    v_pk_fma_f32 v[70:71], v[46:47], s[26:27], v[70:71]
    v_pk_fma_f32 v[84:85], v[68:69], s[38:39], v[84:85]
    v_pk_fma_f32 v[86:87], v[70:71], s[38:39], v[86:87]
    v_pk_add_f32 v[36:37], v[36:37], v[68:69] neg_lo:[0,1] neg_hi:[0,1]
    v_pk_add_f32 v[38:39], v[38:39], v[70:71] neg_lo:[0,1] neg_hi:[0,1]
    v_pk_add_f32 v[36:37], v[36:37], v[84:85] neg_lo:[0,1] neg_hi:[0,1]
    v_pk_add_f32 v[38:39], v[38:39], v[86:87] neg_lo:[0,1] neg_hi:[0,1]
    s_mov_b32 s36, 0x00010001
    s_mov_b32 s37, 0x00010001
    s_mov_b64 exec, s[36:37]
    ds_write_b128 v127, v[0:3] offset:0
    ds_write_b128 v127, v[32:35] offset:16
    ds_write_b128 v127, v[4:7] offset:32
    ds_write_b128 v127, v[36:39] offset:48
    ds_write_b128 v127, v[8:11] offset:64
    ds_write_b128 v127, v[40:43] offset:80
    s_mov_b64 exec, -1
    v_mov_b32 v44, 0xc0135761
    v_mov_b32 v45, v44
    v_pk_mul_f32 v[16:17], v[64:65], v[64:65]
    v_pk_mul_f32 v[18:19], v[66:67], v[66:67]
    v_pk_mul_f32 v[20:21], v[68:69], v[68:69]
    v_pk_mul_f32 v[22:23], v[70:71], v[70:71]
    v_pk_fma_f32 v[16:17], v[16:17], s[40:41], v[44:45]
    v_pk_fma_f32 v[18:19], v[18:19], s[40:41], v[44:45]
    v_pk_fma_f32 v[20:21], v[20:21], s[40:41], v[44:45]
    v_pk_fma_f32 v[22:23], v[22:23], s[40:41], v[44:45]
    v_pk_mul_f32 v[16:17], v[16:17], v[64:65]
    v_pk_mul_f32 v[18:19], v[18:19], v[66:67]
    v_pk_mul_f32 v[20:21], v[20:21], v[68:69]
    v_pk_mul_f32 v[22:23], v[22:23], v[70:71]
    v_exp_f32 v16, v16
    v_exp_f32 v17, v17
    v_exp_f32 v18, v18
    v_exp_f32 v19, v19
    v_exp_f32 v20, v20
    v_exp_f32 v21, v21
    v_exp_f32 v22, v22
    v_exp_f32 v23, v23
    v_pk_add_f32 v[16:17], v[16:17], s[42:43]
    v_pk_add_f32 v[18:19], v[18:19], s[42:43]
    v_pk_add_f32 v[20:21], v[20:21], s[42:43]
    v_pk_add_f32 v[22:23], v[22:23], s[42:43]
    v_rcp_f32 v16, v16
    v_rcp_f32 v17, v17
    v_rcp_f32 v18, v18
    v_rcp_f32 v19, v19
    v_rcp_f32 v20, v20
    v_rcp_f32 v21, v21
    v_rcp_f32 v22, v22
    v_rcp_f32 v23, v23
    v_pk_mul_f32 v[64:65], v[64:65], v[16:17]
    v_pk_mul_f32 v[66:67], v[66:67], v[18:19]
    v_pk_mul_f32 v[68:69], v[68:69], v[20:21]
    v_pk_mul_f32 v[70:71], v[70:71], v[22:23]
    v_cvt_pk_bf16_f32 v48, v64, v68
    v_cvt_pk_bf16_f32 v49, v65, v69
    v_cvt_pk_bf16_f32 v50, v66, v70
    v_cvt_pk_bf16_f32 v51, v67, v71
    s_mov_b32 s44, 393280
    buffer_store_dwordx4 v[48:51], v122, s[16:19], s44 offen sc1
    s_waitcnt lgkmcnt(0)
    s_barrier
    ds_read_b128 v[96:99], v127 offset:512
    ds_read_b128 v[100:103], v127 offset:528
    ds_read_b128 v[104:107], v127 offset:544
    ds_read_b128 v[108:111], v127 offset:560
    ds_read_b128 v[112:115], v127 offset:576
    ds_read_b128 v[116:119], v127 offset:592
    s_waitcnt lgkmcnt(4)
    v_mov_b32_dpp v96, v0 row_shl:1 row_mask:0xf bank_mask:0xf
    v_mov_b32_dpp v97, v1 row_shl:1 row_mask:0xf bank_mask:0xf
    v_mov_b32_dpp v98, v2 row_shl:1 row_mask:0xf bank_mask:0xf
    v_mov_b32_dpp v99, v3 row_shl:1 row_mask:0xf bank_mask:0xf
    v_mov_b32_dpp v100, v32 row_shl:1 row_mask:0xf bank_mask:0xf
    v_mov_b32_dpp v101, v33 row_shl:1 row_mask:0xf bank_mask:0xf
    v_mov_b32_dpp v102, v34 row_shl:1 row_mask:0xf bank_mask:0xf
    v_mov_b32_dpp v103, v35 row_shl:1 row_mask:0xf bank_mask:0xf
    v_pk_add_f32 v[72:73], v[72:73], v[96:97]
    v_pk_add_f32 v[74:75], v[74:75], v[98:99]
    v_pk_add_f32 v[76:77], v[76:77], v[100:101]
    v_pk_add_f32 v[78:79], v[78:79], v[102:103]
    v_pk_mul_f32 v[24:25], v[72:73], v[72:73]
    v_pk_mul_f32 v[26:27], v[74:75], v[74:75]
    v_pk_mul_f32 v[28:29], v[76:77], v[76:77]
    v_pk_mul_f32 v[30:31], v[78:79], v[78:79]
    v_pk_fma_f32 v[24:25], v[24:25], s[40:41], v[44:45]
    v_pk_fma_f32 v[26:27], v[26:27], s[40:41], v[44:45]
    v_pk_fma_f32 v[28:29], v[28:29], s[40:41], v[44:45]
    v_pk_fma_f32 v[30:31], v[30:31], s[40:41], v[44:45]
    v_pk_mul_f32 v[24:25], v[24:25], v[72:73]
    v_pk_mul_f32 v[26:27], v[26:27], v[74:75]
    v_pk_mul_f32 v[28:29], v[28:29], v[76:77]
    v_pk_mul_f32 v[30:31], v[30:31], v[78:79]
    v_exp_f32 v24, v24
    v_exp_f32 v25, v25
    v_exp_f32 v26, v26
    v_exp_f32 v27, v27
    v_exp_f32 v28, v28
    v_exp_f32 v29, v29
    v_exp_f32 v30, v30
    v_exp_f32 v31, v31
    v_pk_add_f32 v[24:25], v[24:25], s[42:43]
    v_pk_add_f32 v[26:27], v[26:27], s[42:43]
    v_pk_add_f32 v[28:29], v[28:29], s[42:43]
    v_pk_add_f32 v[30:31], v[30:31], s[42:43]
    v_rcp_f32 v24, v24
    v_rcp_f32 v25, v25
    v_rcp_f32 v26, v26
    v_rcp_f32 v27, v27
    v_rcp_f32 v28, v28
    v_rcp_f32 v29, v29
    v_rcp_f32 v30, v30
    v_rcp_f32 v31, v31
    v_pk_mul_f32 v[72:73], v[72:73], v[24:25]
    v_pk_mul_f32 v[74:75], v[74:75], v[26:27]
    v_pk_mul_f32 v[76:77], v[76:77], v[28:29]
    v_pk_mul_f32 v[78:79], v[78:79], v[30:31]
    v_cvt_pk_bf16_f32 v52, v72, v76
    v_cvt_pk_bf16_f32 v53, v73, v77
    v_cvt_pk_bf16_f32 v54, v74, v78
    v_cvt_pk_bf16_f32 v55, v75, v79
    s_mov_b32 s44, 128
    buffer_store_dwordx4 v[52:55], v122, s[16:19], s44 offen sc1
    s_waitcnt lgkmcnt(2)
    v_mov_b32_dpp v104, v4 row_shl:1 row_mask:0xf bank_mask:0xf
    v_mov_b32_dpp v105, v5 row_shl:1 row_mask:0xf bank_mask:0xf
    v_mov_b32_dpp v106, v6 row_shl:1 row_mask:0xf bank_mask:0xf
    v_mov_b32_dpp v107, v7 row_shl:1 row_mask:0xf bank_mask:0xf
    v_mov_b32_dpp v108, v36 row_shl:1 row_mask:0xf bank_mask:0xf
    v_mov_b32_dpp v109, v37 row_shl:1 row_mask:0xf bank_mask:0xf
    v_mov_b32_dpp v110, v38 row_shl:1 row_mask:0xf bank_mask:0xf
    v_mov_b32_dpp v111, v39 row_shl:1 row_mask:0xf bank_mask:0xf
    v_pk_add_f32 v[80:81], v[80:81], v[104:105]
    v_pk_add_f32 v[82:83], v[82:83], v[106:107]
    v_pk_add_f32 v[84:85], v[84:85], v[108:109]
    v_pk_add_f32 v[86:87], v[86:87], v[110:111]
    v_pk_mul_f32 v[16:17], v[80:81], v[80:81]
    v_pk_mul_f32 v[18:19], v[82:83], v[82:83]
    v_pk_mul_f32 v[20:21], v[84:85], v[84:85]
    v_pk_mul_f32 v[22:23], v[86:87], v[86:87]
    v_pk_fma_f32 v[16:17], v[16:17], s[40:41], v[44:45]
    v_pk_fma_f32 v[18:19], v[18:19], s[40:41], v[44:45]
    v_pk_fma_f32 v[20:21], v[20:21], s[40:41], v[44:45]
    v_pk_fma_f32 v[22:23], v[22:23], s[40:41], v[44:45]
    v_pk_mul_f32 v[16:17], v[16:17], v[80:81]
    v_pk_mul_f32 v[18:19], v[18:19], v[82:83]
    v_pk_mul_f32 v[20:21], v[20:21], v[84:85]
    v_pk_mul_f32 v[22:23], v[22:23], v[86:87]
    v_exp_f32 v16, v16
    v_exp_f32 v17, v17
    v_exp_f32 v18, v18
    v_exp_f32 v19, v19
    v_exp_f32 v20, v20
    v_exp_f32 v21, v21
    v_exp_f32 v22, v22
    v_exp_f32 v23, v23
    v_pk_add_f32 v[16:17], v[16:17], s[42:43]
    v_pk_add_f32 v[18:19], v[18:19], s[42:43]
    v_pk_add_f32 v[20:21], v[20:21], s[42:43]
    v_pk_add_f32 v[22:23], v[22:23], s[42:43]
    v_rcp_f32 v16, v16
    v_rcp_f32 v17, v17
    v_rcp_f32 v18, v18
    v_rcp_f32 v19, v19
    v_rcp_f32 v20, v20
    v_rcp_f32 v21, v21
    v_rcp_f32 v22, v22
    v_rcp_f32 v23, v23
    v_pk_mul_f32 v[80:81], v[80:81], v[16:17]
    v_pk_mul_f32 v[82:83], v[82:83], v[18:19]
    v_pk_mul_f32 v[84:85], v[84:85], v[20:21]
    v_pk_mul_f32 v[86:87], v[86:87], v[22:23]
    v_cvt_pk_bf16_f32 v56, v80, v84
    v_cvt_pk_bf16_f32 v57, v81, v85
    v_cvt_pk_bf16_f32 v58, v82, v86
    v_cvt_pk_bf16_f32 v59, v83, v87
    s_mov_b32 s44, 131200
    buffer_store_dwordx4 v[56:59], v122, s[16:19], s44 offen sc1
    s_waitcnt lgkmcnt(0)
    v_mov_b32_dpp v112, v8 row_shl:1 row_mask:0xf bank_mask:0xf
    v_mov_b32_dpp v113, v9 row_shl:1 row_mask:0xf bank_mask:0xf
    v_mov_b32_dpp v114, v10 row_shl:1 row_mask:0xf bank_mask:0xf
    v_mov_b32_dpp v115, v11 row_shl:1 row_mask:0xf bank_mask:0xf
    v_mov_b32_dpp v116, v40 row_shl:1 row_mask:0xf bank_mask:0xf
    v_mov_b32_dpp v117, v41 row_shl:1 row_mask:0xf bank_mask:0xf
    v_mov_b32_dpp v118, v42 row_shl:1 row_mask:0xf bank_mask:0xf
    v_mov_b32_dpp v119, v43 row_shl:1 row_mask:0xf bank_mask:0xf
    v_pk_add_f32 v[88:89], v[88:89], v[112:113]
    v_pk_add_f32 v[90:91], v[90:91], v[114:115]
    v_pk_add_f32 v[92:93], v[92:93], v[116:117]
    v_pk_add_f32 v[94:95], v[94:95], v[118:119]
    v_pk_mul_f32 v[24:25], v[88:89], v[88:89]
    v_pk_mul_f32 v[26:27], v[90:91], v[90:91]
    v_pk_mul_f32 v[28:29], v[92:93], v[92:93]
    v_pk_mul_f32 v[30:31], v[94:95], v[94:95]
    v_pk_fma_f32 v[24:25], v[24:25], s[40:41], v[44:45]
    v_pk_fma_f32 v[26:27], v[26:27], s[40:41], v[44:45]
    v_pk_fma_f32 v[28:29], v[28:29], s[40:41], v[44:45]
    v_pk_fma_f32 v[30:31], v[30:31], s[40:41], v[44:45]
    v_pk_mul_f32 v[24:25], v[24:25], v[88:89]
    v_pk_mul_f32 v[26:27], v[26:27], v[90:91]
    v_pk_mul_f32 v[28:29], v[28:29], v[92:93]
    v_pk_mul_f32 v[30:31], v[30:31], v[94:95]
    v_exp_f32 v24, v24
    v_exp_f32 v25, v25
    v_exp_f32 v26, v26
    v_exp_f32 v27, v27
    v_exp_f32 v28, v28
    v_exp_f32 v29, v29
    v_exp_f32 v30, v30
    v_exp_f32 v31, v31
    v_pk_add_f32 v[24:25], v[24:25], s[42:43]
    v_pk_add_f32 v[26:27], v[26:27], s[42:43]
    v_pk_add_f32 v[28:29], v[28:29], s[42:43]
    v_pk_add_f32 v[30:31], v[30:31], s[42:43]
    v_rcp_f32 v24, v24
    v_rcp_f32 v25, v25
    v_rcp_f32 v26, v26
    v_rcp_f32 v27, v27
    v_rcp_f32 v28, v28
    v_rcp_f32 v29, v29
    v_rcp_f32 v30, v30
    v_rcp_f32 v31, v31
    v_pk_mul_f32 v[88:89], v[88:89], v[24:25]
    v_pk_mul_f32 v[90:91], v[90:91], v[26:27]
    v_pk_mul_f32 v[92:93], v[92:93], v[28:29]
    v_pk_mul_f32 v[94:95], v[94:95], v[30:31]
    v_cvt_pk_bf16_f32 v60, v88, v92
    v_cvt_pk_bf16_f32 v61, v89, v93
    v_cvt_pk_bf16_f32 v62, v90, v94
    v_cvt_pk_bf16_f32 v63, v91, v95
    s_mov_b32 s44, 262272
    buffer_store_dwordx4 v[60:63], v122, s[16:19], s44 offen sc1
L_conv1_kernel_end:
L_conv1_kernel_done:
    s_endpgm
.globl conv2_kernel
.p2align 8
.type conv2_kernel,@function
conv2_kernel:
    s_cmp_ge_u32 s2, 256
    s_cbranch_scc1 L_conv2_kernel_done
    s_load_dwordx2 s[4:5], s[0:1], 72
    s_load_dwordx2 s[30:31], s[0:1], 72
    v_readfirstlane_b32 s20, v0
    s_lshr_b32 s20, s20, 6
    s_xor_b32 s20, s20, 8
    s_and_b32 s36, s2, 0
    s_lshl_b32 s36, s36, 3
    s_bfe_u32 s37, s2, 196611
    s_or_b32 s29, s36, s37
    s_bfe_u32 s36, s2, 196608
    s_lshl_b32 s36, s36, 2
    s_lshr_b32 s37, s2, 6
    s_or_b32 s36, s36, s37
    s_lshr_b32 s33, s36, 4
    s_and_b32 s34, s36, 7
    s_bfe_u32 s35, s36, 0x10003
    s_mul_i32 s21, s34, 500
    s_and_b32 s32, s20, 3
    v_and_b32 v127, 63, v0
    v_lshrrev_b32 v5, 2, v127
    v_and_b32 v6, 3, v127
    s_and_b32 s42, s20, 7
    s_lshr_b32 s41, s21, 2
    s_sub_u32 s41, s41, 1
    s_add_u32 s37, s41, s42
    v_lshl_add_u32 v7, v5, 3, s37
    s_mul_i32 s36, s35, 4194304
    s_add_u32 s36, s36, 18874368
    s_mov_b32 s10, 4194304
    s_mov_b32 s11, 0x00020000
    s_mov_b32 s25, 0xffff0000
    s_mov_b32 s47, s36
    s_cmp_ge_u32 s20, 8
    s_cbranch_scc1 L_conv2_kernel_helper
    s_add_u32 s37, s41, 128
    v_mov_b32 v16, s37
    v_mul_u32_u24 v17, 524288, v5
    v_lshl_add_u32 v17, v6, 4, v17
    s_add_u32 s37, s33, 4294967289
    v_lshl_add_u32 v18, v16, 3, s37
    v_cmp_gt_u32 vcc, 8000, v18
    s_mul_i32 s37, s33, 131072
    s_add_u32 s37, s37, 0
    v_lshl_add_u32 v108, v16, 7, s37
    v_add_u32 v108, v108, v17
    v_mov_b32 v18, 2130706432
    v_cndmask_b32 v108, v18, v108, vcc
    s_add_u32 s37, s33, 4294967291
    v_lshl_add_u32 v18, v16, 3, s37
    v_cmp_gt_u32 vcc, 8000, v18
    s_mul_i32 s37, s33, 131072
    s_add_u32 s37, s37, 262144
    v_lshl_add_u32 v109, v16, 7, s37
    v_add_u32 v109, v109, v17
    v_mov_b32 v18, 2130706432
    v_cndmask_b32 v109, v18, v109, vcc
    s_add_u32 s37, s33, 4294967293
    v_lshl_add_u32 v18, v16, 3, s37
    v_cmp_gt_u32 vcc, 8000, v18
    s_mul_i32 s37, s33, 131072
    s_add_u32 s37, s37, 64
    v_lshl_add_u32 v110, v16, 7, s37
    v_add_u32 v110, v110, v17
    v_mov_b32 v18, 2130706432
    v_cndmask_b32 v110, v18, v110, vcc
    s_waitcnt lgkmcnt(0)
    s_add_u32 s8, s4, s47
    s_addc_u32 s9, s5, 0
    s_lshl_b32 s36, s29, 4
    s_lshl_b32 s37, s33, 3
    s_add_u32 s36, s36, s37
    s_mul_i32 s36, s36, 57344
    s_add_u32 s36, s36, 9437184
    s_add_u32 s12, s30, s36
    s_addc_u32 s13, s31, 0
    s_mov_b32 s14, 458752
    s_mov_b32 s15, 0x00020000
    s_mul_i32 s36, s35, 2097152
    s_add_u32 s36, s36, 27262976
    s_mul_i32 s37, s33, 8388608
    s_add_u32 s36, s36, s37
    s_add_u32 s16, s30, s36
    s_addc_u32 s17, s31, 0
    s_mov_b32 s18, 2097152
    s_mov_b32 s19, 0x00020000
    v_and_b32 v10, 15, v127
    v_lshrrev_b32 v11, 4, v127
    v_add_u32 v8, 0, v10
    v_and_b32 v16, 4, v8
    v_lshrrev_b32 v16, 1, v16
    v_xor_b32 v16, v11, v16
    v_lshlrev_b32 v16, 4, v16
    v_lshl_add_u32 v8, v8, 6, v16
    v_add_u32 v9, 1, v10
    v_and_b32 v16, 4, v9
    v_lshrrev_b32 v16, 1, v16
    v_xor_b32 v16, v11, v16
    v_lshlrev_b32 v16, 4, v16
    v_lshl_add_u32 v9, v9, 6, v16
    s_lshr_b32 s38, s32, 1
    s_and_b32 s39, s32, 1
    s_add_u32 s40, s38, 4
    s_lshl_b32 s43, s39, 10
    s_cmp_lt_u32 s20, 4
    s_cselect_b32 s40, s20, s40
    s_cselect_b32 s36, 0, s43
    s_lshl_b32 s37, s40, 13
    s_add_u32 s37, s37, s36
    v_lshl_add_u32 v125, v127, 4, s37
    s_mul_i32 s37, s40, 16384
    v_add_u32 v120, s37, v8
    v_add_u32 v121, s37, v9
    s_lshl_b32 s37, s40, 10
    s_add_u32 s37, s37, 115712
    v_lshl_add_u32 v16, v11, 4, s37
    v_cmp_eq_u32 vcc, 15, v10
    v_mov_b32 v17, 8192
    v_mov_b32 v18, 4294959104
    v_mov_b32 v19, 64
    v_cndmask_b32 v122, v121, v16, vcc
    v_cndmask_b32 v123, v17, v19, vcc
    v_cndmask_b32 v124, v18, v19, vcc
    v_lshl_add_u32 v126, v127, 4, s37
    s_mov_b32 s44, 0x3f800000
    s_mov_b32 s45, 0x00000000
    s_mov_b32 s46, 0x00000000
    s_cmp_eq_u32 s40, 1
    s_cselect_b32 s45, 0x3f800000, s45
    s_cselect_b32 s46, 0x3f800000, s46
    s_cmp_eq_u32 s40, 2
    s_cselect_b32 s45, 0xbf800000, s45
    s_cselect_b32 s46, 0x3f800000, s46
    s_cmp_eq_u32 s40, 3
    s_cselect_b32 s45, 0x40000000, s45
    s_cselect_b32 s46, 0x40800000, s46
    s_cmp_eq_u32 s40, 4
    s_cselect_b32 s45, 0xc0000000, s45
    s_cselect_b32 s46, 0x40800000, s46
    s_cmp_eq_u32 s40, 5
    s_cselect_b32 s44, 0x41800000, s44
    s_cselect_b32 s45, 0x41000000, s45
    s_cselect_b32 s46, 0x40800000, s46
    s_cmp_ge_u32 s20, 4
    s_cbranch_scc1 L_conv2_kernel_m2
    v_mov_b32 v0, 0
    v_mov_b32 v1, 0
    v_mov_b32 v2, 0
    v_mov_b32 v3, 0
    v_mov_b32 v4, 0
    v_mov_b32 v5, 0
    v_mov_b32 v6, 0
    v_mov_b32 v7, 0
    v_mov_b32 v8, 0
    v_mov_b32 v9, 0
    v_mov_b32 v10, 0
    v_mov_b32 v11, 0
    v_mov_b32 v12, 0
    v_mov_b32 v13, 0
    v_mov_b32 v14, 0
    v_mov_b32 v15, 0
    v_mov_b32 v16, 0
    v_mov_b32 v17, 0
    v_mov_b32 v18, 0
    v_mov_b32 v19, 0
    v_mov_b32 v20, 0
    v_mov_b32 v21, 0
    v_mov_b32 v22, 0
    v_mov_b32 v23, 0
    v_mov_b32 v24, 0
    v_mov_b32 v25, 0
    v_mov_b32 v26, 0
    v_mov_b32 v27, 0
    v_mov_b32 v28, 0
    v_mov_b32 v29, 0
    v_mov_b32 v30, 0
    v_mov_b32 v31, 0
    v_mov_b32 v32, 0
    v_mov_b32 v33, 0
    v_mov_b32 v34, 0
    v_mov_b32 v35, 0
    v_mov_b32 v36, 0
    v_mov_b32 v37, 0
    v_mov_b32 v38, 0
    v_mov_b32 v39, 0
    v_mov_b32 v40, 0
    v_mov_b32 v41, 0
    v_mov_b32 v42, 0
    v_mov_b32 v43, 0
    v_mov_b32 v44, 0
    v_mov_b32 v45, 0
    v_mov_b32 v46, 0
    v_mov_b32 v47, 0
    v_mov_b32 v48, 0
    v_mov_b32 v49, 0
    v_mov_b32 v50, 0
    v_mov_b32 v51, 0
    v_mov_b32 v52, 0
    v_mov_b32 v53, 0
    v_mov_b32 v54, 0
    v_mov_b32 v55, 0
    v_mov_b32 v56, 0
    v_mov_b32 v57, 0
    v_mov_b32 v58, 0
    v_mov_b32 v59, 0
    v_mov_b32 v60, 0
    v_mov_b32 v61, 0
    v_mov_b32 v62, 0
    v_mov_b32 v63, 0
    buffer_load_dwordx4 v[96:99], v108, s[8:11], 0 offen
    buffer_load_dwordx4 v[100:103], v109, s[8:11], 0 offen
    buffer_load_dwordx4 v[104:107], v110, s[8:11], 0 offen
    s_mov_b32 s23, 0
    s_mov_b32 s26, 4096
    buffer_load_dwordx4 v[64:67], v125, s[12:15], s23 offen offset:0
    buffer_load_dwordx4 v[68:71], v125, s[12:15], s23 offen offset:1024
    buffer_load_dwordx4 v[72:75], v125, s[12:15], s23 offen offset:2048
    buffer_load_dwordx4 v[76:79], v125, s[12:15], s23 offen offset:3072
    buffer_load_dwordx4 v[80:83], v125, s[12:15], s26 offen offset:0
    buffer_load_dwordx4 v[84:87], v125, s[12:15], s26 offen offset:1024
    buffer_load_dwordx4 v[88:91], v125, s[12:15], s26 offen offset:2048
    buffer_load_dwordx4 v[92:95], v125, s[12:15], s26 offen offset:3072
    s_mov_b32 s23, 57344
    s_mov_b32 s26, 61440
    s_waitcnt vmcnt(8)
    v_lshlrev_b32 v108, 16, v96
    v_and_b32 v111, s25, v96
    v_lshlrev_b32 v109, 16, v100
    v_and_b32 v112, s25, v100
    v_lshlrev_b32 v110, 16, v104
    v_and_b32 v113, s25, v104
    v_mul_f32 v114, s44, v108
    v_mul_f32 v115, s44, v111
    v_fmac_f32 v114, s45, v109
    v_fmac_f32 v115, s45, v112
    v_fmac_f32 v114, s46, v110
    v_fmac_f32 v115, s46, v113
    v_cvt_pk_bf16_f32 v96, v114, v115
    v_lshlrev_b32 v108, 16, v97
    v_and_b32 v111, s25, v97
    v_lshlrev_b32 v109, 16, v101
    v_and_b32 v112, s25, v101
    v_lshlrev_b32 v110, 16, v105
    v_and_b32 v113, s25, v105
    v_mul_f32 v114, s44, v108
    v_mul_f32 v115, s44, v111
    v_fmac_f32 v114, s45, v109
    v_fmac_f32 v115, s45, v112
    v_fmac_f32 v114, s46, v110
    v_fmac_f32 v115, s46, v113
    v_cvt_pk_bf16_f32 v97, v114, v115
    v_lshlrev_b32 v108, 16, v98
    v_and_b32 v111, s25, v98
    v_lshlrev_b32 v109, 16, v102
    v_and_b32 v112, s25, v102
    v_lshlrev_b32 v110, 16, v106
    v_and_b32 v113, s25, v106
    v_mul_f32 v114, s44, v108
    v_mul_f32 v115, s44, v111
    v_fmac_f32 v114, s45, v109
    v_fmac_f32 v115, s45, v112
    v_fmac_f32 v114, s46, v110
    v_fmac_f32 v115, s46, v113
    v_cvt_pk_bf16_f32 v98, v114, v115
    v_lshlrev_b32 v108, 16, v99
    v_and_b32 v111, s25, v99
    v_lshlrev_b32 v109, 16, v103
    v_and_b32 v112, s25, v103
    v_lshlrev_b32 v110, 16, v107
    v_and_b32 v113, s25, v107
    v_mul_f32 v114, s44, v108
    v_mul_f32 v115, s44, v111
    v_fmac_f32 v114, s45, v109
    v_fmac_f32 v115, s45, v112
    v_fmac_f32 v114, s46, v110
    v_fmac_f32 v115, s46, v113
    v_cvt_pk_bf16_f32 v99, v114, v115
    ds_write_b128 v126, v[96:99]
    s_waitcnt lgkmcnt(0)
    s_barrier
    s_mov_b32 s22, 4
    s_setprio 2
L_conv2_kernel_mloop1:
    ds_read_b128 v[96:99], v120 offset:0
    ds_read_b128 v[100:103], v120 offset:1024
    ds_read_b128 v[104:107], v120 offset:2048
    ds_read_b128 v[108:111], v120 offset:3072
    ds_read_b128 v[112:115], v120 offset:4096
    ds_read_b128 v[116:119], v120 offset:5120
    s_waitcnt vmcnt(6) lgkmcnt(5)
    v_mfma_f32_16x16x32_bf16 v[0:3], v[64:67], v[96:99], v[0:3]
    v_mfma_f32_16x16x32_bf16 v[32:35], v[68:71], v[96:99], v[32:35]
    ds_read_b128 v[96:99], v120 offset:6144
    s_waitcnt vmcnt(4) lgkmcnt(5)
    v_mfma_f32_16x16x32_bf16 v[4:7], v[64:67], v[100:103], v[4:7]
    v_mfma_f32_16x16x32_bf16 v[36:39], v[68:71], v[100:103], v[36:39]
    v_mfma_f32_16x16x32_bf16 v[0:3], v[72:75], v[100:103], v[0:3]
    v_mfma_f32_16x16x32_bf16 v[32:35], v[76:79], v[100:103], v[32:35]
    ds_read_b128 v[100:103], v120 offset:7168
    s_waitcnt vmcnt(2) lgkmcnt(5)
    v_mfma_f32_16x16x32_bf16 v[8:11], v[64:67], v[104:107], v[8:11]
    v_mfma_f32_16x16x32_bf16 v[40:43], v[68:71], v[104:107], v[40:43]
    v_mfma_f32_16x16x32_bf16 v[4:7], v[72:75], v[104:107], v[4:7]
    v_mfma_f32_16x16x32_bf16 v[36:39], v[76:79], v[104:107], v[36:39]
    v_mfma_f32_16x16x32_bf16 v[0:3], v[80:83], v[104:107], v[0:3]
    v_mfma_f32_16x16x32_bf16 v[32:35], v[84:87], v[104:107], v[32:35]
    ds_read_b128 v[104:107], v122 offset:0
    v_add_u32 v122, v123, v122
    s_waitcnt vmcnt(0) lgkmcnt(5)
    v_mfma_f32_16x16x32_bf16 v[12:15], v[64:67], v[108:111], v[12:15]
    v_mfma_f32_16x16x32_bf16 v[44:47], v[68:71], v[108:111], v[44:47]
    v_mfma_f32_16x16x32_bf16 v[8:11], v[72:75], v[108:111], v[8:11]
    v_mfma_f32_16x16x32_bf16 v[40:43], v[76:79], v[108:111], v[40:43]
    v_mfma_f32_16x16x32_bf16 v[4:7], v[80:83], v[108:111], v[4:7]
    v_mfma_f32_16x16x32_bf16 v[36:39], v[84:87], v[108:111], v[36:39]
    v_mfma_f32_16x16x32_bf16 v[0:3], v[88:91], v[108:111], v[0:3]
    v_mfma_f32_16x16x32_bf16 v[32:35], v[92:95], v[108:111], v[32:35]
    ds_read_b128 v[108:111], v121 offset:1024
    s_waitcnt lgkmcnt(5)
    v_mfma_f32_16x16x32_bf16 v[16:19], v[64:67], v[112:115], v[16:19]
    v_mfma_f32_16x16x32_bf16 v[48:51], v[68:71], v[112:115], v[48:51]
    v_mfma_f32_16x16x32_bf16 v[12:15], v[72:75], v[112:115], v[12:15]
    v_mfma_f32_16x16x32_bf16 v[44:47], v[76:79], v[112:115], v[44:47]
    v_mfma_f32_16x16x32_bf16 v[8:11], v[80:83], v[112:115], v[8:11]
    v_mfma_f32_16x16x32_bf16 v[40:43], v[84:87], v[112:115], v[40:43]
    v_mfma_f32_16x16x32_bf16 v[4:7], v[88:91], v[112:115], v[4:7]
    v_mfma_f32_16x16x32_bf16 v[36:39], v[92:95], v[112:115], v[36:39]
    ds_read_b128 v[112:115], v121 offset:2048
    s_waitcnt lgkmcnt(5)
    v_mfma_f32_16x16x32_bf16 v[20:23], v[64:67], v[116:119], v[20:23]
    v_mfma_f32_16x16x32_bf16 v[52:55], v[68:71], v[116:119], v[52:55]
    v_mfma_f32_16x16x32_bf16 v[16:19], v[72:75], v[116:119], v[16:19]
    v_mfma_f32_16x16x32_bf16 v[48:51], v[76:79], v[116:119], v[48:51]
    v_mfma_f32_16x16x32_bf16 v[12:15], v[80:83], v[116:119], v[12:15]
    v_mfma_f32_16x16x32_bf16 v[44:47], v[84:87], v[116:119], v[44:47]
    v_mfma_f32_16x16x32_bf16 v[8:11], v[88:91], v[116:119], v[8:11]
    v_mfma_f32_16x16x32_bf16 v[40:43], v[92:95], v[116:119], v[40:43]
    s_waitcnt lgkmcnt(4)
    v_mfma_f32_16x16x32_bf16 v[24:27], v[64:67], v[96:99], v[24:27]
    v_mfma_f32_16x16x32_bf16 v[56:59], v[68:71], v[96:99], v[56:59]
    v_mfma_f32_16x16x32_bf16 v[20:23], v[72:75], v[96:99], v[20:23]
    v_mfma_f32_16x16x32_bf16 v[52:55], v[76:79], v[96:99], v[52:55]
    v_mfma_f32_16x16x32_bf16 v[16:19], v[80:83], v[96:99], v[16:19]
    v_mfma_f32_16x16x32_bf16 v[48:51], v[84:87], v[96:99], v[48:51]
    v_mfma_f32_16x16x32_bf16 v[12:15], v[88:91], v[96:99], v[12:15]
    v_mfma_f32_16x16x32_bf16 v[44:47], v[92:95], v[96:99], v[44:47]
    s_waitcnt lgkmcnt(3)
    v_mfma_f32_16x16x32_bf16 v[28:31], v[64:67], v[100:103], v[28:31]
    v_mfma_f32_16x16x32_bf16 v[60:63], v[68:71], v[100:103], v[60:63]
    v_mfma_f32_16x16x32_bf16 v[24:27], v[72:75], v[100:103], v[24:27]
    v_mfma_f32_16x16x32_bf16 v[56:59], v[76:79], v[100:103], v[56:59]
    v_mfma_f32_16x16x32_bf16 v[20:23], v[80:83], v[100:103], v[20:23]
    v_mfma_f32_16x16x32_bf16 v[52:55], v[84:87], v[100:103], v[52:55]
    v_mfma_f32_16x16x32_bf16 v[16:19], v[88:91], v[100:103], v[16:19]
    v_mfma_f32_16x16x32_bf16 v[48:51], v[92:95], v[100:103], v[48:51]
    buffer_load_dwordx4 v[64:67], v125, s[12:15], s23 offen offset:0
    buffer_load_dwordx4 v[68:71], v125, s[12:15], s23 offen offset:1024
    s_waitcnt lgkmcnt(2)
    v_mfma_f32_16x16x32_bf16 v[28:31], v[72:75], v[104:107], v[28:31]
    v_mfma_f32_16x16x32_bf16 v[60:63], v[76:79], v[104:107], v[60:63]
    v_mfma_f32_16x16x32_bf16 v[24:27], v[80:83], v[104:107], v[24:27]
    v_mfma_f32_16x16x32_bf16 v[56:59], v[84:87], v[104:107], v[56:59]
    v_mfma_f32_16x16x32_bf16 v[20:23], v[88:91], v[104:107], v[20:23]
    v_mfma_f32_16x16x32_bf16 v[52:55], v[92:95], v[104:107], v[52:55]
    buffer_load_dwordx4 v[72:75], v125, s[12:15], s23 offen offset:2048
    buffer_load_dwordx4 v[76:79], v125, s[12:15], s23 offen offset:3072
    s_waitcnt lgkmcnt(1)
    v_mfma_f32_16x16x32_bf16 v[28:31], v[80:83], v[108:111], v[28:31]
    v_mfma_f32_16x16x32_bf16 v[60:63], v[84:87], v[108:111], v[60:63]
    v_mfma_f32_16x16x32_bf16 v[24:27], v[88:91], v[108:111], v[24:27]
    v_mfma_f32_16x16x32_bf16 v[56:59], v[92:95], v[108:111], v[56:59]
    buffer_load_dwordx4 v[80:83], v125, s[12:15], s26 offen offset:0
    buffer_load_dwordx4 v[84:87], v125, s[12:15], s26 offen offset:1024
    s_waitcnt lgkmcnt(0)
    v_mfma_f32_16x16x32_bf16 v[28:31], v[88:91], v[112:115], v[28:31]
    v_mfma_f32_16x16x32_bf16 v[60:63], v[92:95], v[112:115], v[60:63]
    buffer_load_dwordx4 v[88:91], v125, s[12:15], s26 offen offset:2048
    buffer_load_dwordx4 v[92:95], v125, s[12:15], s26 offen offset:3072
    s_add_u32 s23, s23, 57344
    s_add_u32 s26, s26, 57344
    s_barrier
    s_sub_u32 s22, s22, 1
    s_cmp_eq_u32 s22, 0
    s_cbranch_scc1 L_conv2_kernel_mlast1
    ds_read_b128 v[96:99], v120 offset:8192
    ds_read_b128 v[100:103], v120 offset:9216
    ds_read_b128 v[104:107], v120 offset:10240
    ds_read_b128 v[108:111], v120 offset:11264
    ds_read_b128 v[112:115], v120 offset:12288
    ds_read_b128 v[116:119], v120 offset:13312
    s_waitcnt vmcnt(6) lgkmcnt(5)
    v_mfma_f32_16x16x32_bf16 v[0:3], v[64:67], v[96:99], v[0:3]
    v_mfma_f32_16x16x32_bf16 v[32:35], v[68:71], v[96:99], v[32:35]
    ds_read_b128 v[96:99], v120 offset:14336
    s_waitcnt vmcnt(4) lgkmcnt(5)
    v_mfma_f32_16x16x32_bf16 v[4:7], v[64:67], v[100:103], v[4:7]
    v_mfma_f32_16x16x32_bf16 v[36:39], v[68:71], v[100:103], v[36:39]
    v_mfma_f32_16x16x32_bf16 v[0:3], v[72:75], v[100:103], v[0:3]
    v_mfma_f32_16x16x32_bf16 v[32:35], v[76:79], v[100:103], v[32:35]
    ds_read_b128 v[100:103], v120 offset:15360
    s_waitcnt vmcnt(2) lgkmcnt(5)
    v_mfma_f32_16x16x32_bf16 v[8:11], v[64:67], v[104:107], v[8:11]
    v_mfma_f32_16x16x32_bf16 v[40:43], v[68:71], v[104:107], v[40:43]
    v_mfma_f32_16x16x32_bf16 v[4:7], v[72:75], v[104:107], v[4:7]
    v_mfma_f32_16x16x32_bf16 v[36:39], v[76:79], v[104:107], v[36:39]
    v_mfma_f32_16x16x32_bf16 v[0:3], v[80:83], v[104:107], v[0:3]
    v_mfma_f32_16x16x32_bf16 v[32:35], v[84:87], v[104:107], v[32:35]
    ds_read_b128 v[104:107], v122 offset:0
    v_add_u32 v122, v124, v122
    s_waitcnt vmcnt(0) lgkmcnt(5)
    v_mfma_f32_16x16x32_bf16 v[12:15], v[64:67], v[108:111], v[12:15]
    v_mfma_f32_16x16x32_bf16 v[44:47], v[68:71], v[108:111], v[44:47]
    v_mfma_f32_16x16x32_bf16 v[8:11], v[72:75], v[108:111], v[8:11]
    v_mfma_f32_16x16x32_bf16 v[40:43], v[76:79], v[108:111], v[40:43]
    v_mfma_f32_16x16x32_bf16 v[4:7], v[80:83], v[108:111], v[4:7]
    v_mfma_f32_16x16x32_bf16 v[36:39], v[84:87], v[108:111], v[36:39]
    v_mfma_f32_16x16x32_bf16 v[0:3], v[88:91], v[108:111], v[0:3]
    v_mfma_f32_16x16x32_bf16 v[32:35], v[92:95], v[108:111], v[32:35]
    ds_read_b128 v[108:111], v121 offset:9216
    s_waitcnt lgkmcnt(5)
    v_mfma_f32_16x16x32_bf16 v[16:19], v[64:67], v[112:115], v[16:19]
    v_mfma_f32_16x16x32_bf16 v[48:51], v[68:71], v[112:115], v[48:51]
    v_mfma_f32_16x16x32_bf16 v[12:15], v[72:75], v[112:115], v[12:15]
    v_mfma_f32_16x16x32_bf16 v[44:47], v[76:79], v[112:115], v[44:47]
    v_mfma_f32_16x16x32_bf16 v[8:11], v[80:83], v[112:115], v[8:11]
    v_mfma_f32_16x16x32_bf16 v[40:43], v[84:87], v[112:115], v[40:43]
    v_mfma_f32_16x16x32_bf16 v[4:7], v[88:91], v[112:115], v[4:7]
    v_mfma_f32_16x16x32_bf16 v[36:39], v[92:95], v[112:115], v[36:39]
    ds_read_b128 v[112:115], v121 offset:10240
    s_waitcnt lgkmcnt(5)
    v_mfma_f32_16x16x32_bf16 v[20:23], v[64:67], v[116:119], v[20:23]
    v_mfma_f32_16x16x32_bf16 v[52:55], v[68:71], v[116:119], v[52:55]
    v_mfma_f32_16x16x32_bf16 v[16:19], v[72:75], v[116:119], v[16:19]
    v_mfma_f32_16x16x32_bf16 v[48:51], v[76:79], v[116:119], v[48:51]
    v_mfma_f32_16x16x32_bf16 v[12:15], v[80:83], v[116:119], v[12:15]
    v_mfma_f32_16x16x32_bf16 v[44:47], v[84:87], v[116:119], v[44:47]
    v_mfma_f32_16x16x32_bf16 v[8:11], v[88:91], v[116:119], v[8:11]
    v_mfma_f32_16x16x32_bf16 v[40:43], v[92:95], v[116:119], v[40:43]
    s_waitcnt lgkmcnt(4)
    v_mfma_f32_16x16x32_bf16 v[24:27], v[64:67], v[96:99], v[24:27]
    v_mfma_f32_16x16x32_bf16 v[56:59], v[68:71], v[96:99], v[56:59]
    v_mfma_f32_16x16x32_bf16 v[20:23], v[72:75], v[96:99], v[20:23]
    v_mfma_f32_16x16x32_bf16 v[52:55], v[76:79], v[96:99], v[52:55]
    v_mfma_f32_16x16x32_bf16 v[16:19], v[80:83], v[96:99], v[16:19]
    v_mfma_f32_16x16x32_bf16 v[48:51], v[84:87], v[96:99], v[48:51]
    v_mfma_f32_16x16x32_bf16 v[12:15], v[88:91], v[96:99], v[12:15]
    v_mfma_f32_16x16x32_bf16 v[44:47], v[92:95], v[96:99], v[44:47]
    s_waitcnt lgkmcnt(3)
    v_mfma_f32_16x16x32_bf16 v[28:31], v[64:67], v[100:103], v[28:31]
    v_mfma_f32_16x16x32_bf16 v[60:63], v[68:71], v[100:103], v[60:63]
    v_mfma_f32_16x16x32_bf16 v[24:27], v[72:75], v[100:103], v[24:27]
    v_mfma_f32_16x16x32_bf16 v[56:59], v[76:79], v[100:103], v[56:59]
    v_mfma_f32_16x16x32_bf16 v[20:23], v[80:83], v[100:103], v[20:23]
    v_mfma_f32_16x16x32_bf16 v[52:55], v[84:87], v[100:103], v[52:55]
    v_mfma_f32_16x16x32_bf16 v[16:19], v[88:91], v[100:103], v[16:19]
    v_mfma_f32_16x16x32_bf16 v[48:51], v[92:95], v[100:103], v[48:51]
    buffer_load_dwordx4 v[64:67], v125, s[12:15], s23 offen offset:0
    buffer_load_dwordx4 v[68:71], v125, s[12:15], s23 offen offset:1024
    s_waitcnt lgkmcnt(2)
    v_mfma_f32_16x16x32_bf16 v[28:31], v[72:75], v[104:107], v[28:31]
    v_mfma_f32_16x16x32_bf16 v[60:63], v[76:79], v[104:107], v[60:63]
    v_mfma_f32_16x16x32_bf16 v[24:27], v[80:83], v[104:107], v[24:27]
    v_mfma_f32_16x16x32_bf16 v[56:59], v[84:87], v[104:107], v[56:59]
    v_mfma_f32_16x16x32_bf16 v[20:23], v[88:91], v[104:107], v[20:23]
    v_mfma_f32_16x16x32_bf16 v[52:55], v[92:95], v[104:107], v[52:55]
    buffer_load_dwordx4 v[72:75], v125, s[12:15], s23 offen offset:2048
    buffer_load_dwordx4 v[76:79], v125, s[12:15], s23 offen offset:3072
    s_waitcnt lgkmcnt(1)
    v_mfma_f32_16x16x32_bf16 v[28:31], v[80:83], v[108:111], v[28:31]
    v_mfma_f32_16x16x32_bf16 v[60:63], v[84:87], v[108:111], v[60:63]
    v_mfma_f32_16x16x32_bf16 v[24:27], v[88:91], v[108:111], v[24:27]
    v_mfma_f32_16x16x32_bf16 v[56:59], v[92:95], v[108:111], v[56:59]
    buffer_load_dwordx4 v[80:83], v125, s[12:15], s26 offen offset:0
    buffer_load_dwordx4 v[84:87], v125, s[12:15], s26 offen offset:1024
    s_waitcnt lgkmcnt(0)
    v_mfma_f32_16x16x32_bf16 v[28:31], v[88:91], v[112:115], v[28:31]
    v_mfma_f32_16x16x32_bf16 v[60:63], v[92:95], v[112:115], v[60:63]
    buffer_load_dwordx4 v[88:91], v125, s[12:15], s26 offen offset:2048
    buffer_load_dwordx4 v[92:95], v125, s[12:15], s26 offen offset:3072
    s_add_u32 s23, s23, 57344
    s_add_u32 s26, s26, 57344
    s_barrier
    s_branch L_conv2_kernel_mloop1
L_conv2_kernel_mlast1:
    v_and_b32 v125, 15, v127
    v_and_b32 v126, 7, v127
    v_lshlrev_b32 v126, 4, v126
    v_lshl_add_u32 v125, v125, 7, v126
    v_lshrrev_b32 v126, 4, v127
    v_lshl_add_u32 v125, v126, 11, v125
    s_lshl_b32 s36, s20, 14
    s_add_u32 s37, s36, 8192
    v_add_u32 v126, s37, v125
    v_add_u32 v125, s36, v125
    ds_read_b128 v[96:99], v120 offset:8192
    ds_read_b128 v[100:103], v120 offset:9216
    ds_read_b128 v[104:107], v120 offset:10240
    ds_read_b128 v[108:111], v120 offset:11264
    ds_read_b128 v[112:115], v120 offset:12288
    ds_read_b128 v[116:119], v120 offset:13312
    s_waitcnt vmcnt(6) lgkmcnt(5)
    v_mfma_f32_16x16x32_bf16 v[0:3], v[64:67], v[96:99], v[0:3]
    v_mfma_f32_16x16x32_bf16 v[32:35], v[68:71], v[96:99], v[32:35]
    ds_read_b128 v[96:99], v120 offset:14336
    s_waitcnt vmcnt(4) lgkmcnt(5)
    v_mfma_f32_16x16x32_bf16 v[4:7], v[64:67], v[100:103], v[4:7]
    v_mfma_f32_16x16x32_bf16 v[36:39], v[68:71], v[100:103], v[36:39]
    v_mfma_f32_16x16x32_bf16 v[0:3], v[72:75], v[100:103], v[0:3]
    v_mfma_f32_16x16x32_bf16 v[32:35], v[76:79], v[100:103], v[32:35]
    ds_read_b128 v[100:103], v120 offset:15360
    s_waitcnt vmcnt(2) lgkmcnt(5)
    v_mfma_f32_16x16x32_bf16 v[8:11], v[64:67], v[104:107], v[8:11]
    v_mfma_f32_16x16x32_bf16 v[40:43], v[68:71], v[104:107], v[40:43]
    v_mfma_f32_16x16x32_bf16 v[4:7], v[72:75], v[104:107], v[4:7]
    v_mfma_f32_16x16x32_bf16 v[36:39], v[76:79], v[104:107], v[36:39]
    v_mfma_f32_16x16x32_bf16 v[0:3], v[80:83], v[104:107], v[0:3]
    v_mfma_f32_16x16x32_bf16 v[32:35], v[84:87], v[104:107], v[32:35]
    ds_read_b128 v[104:107], v122 offset:0
    s_waitcnt vmcnt(0) lgkmcnt(5)
    v_mfma_f32_16x16x32_bf16 v[12:15], v[64:67], v[108:111], v[12:15]
    v_mfma_f32_16x16x32_bf16 v[44:47], v[68:71], v[108:111], v[44:47]
    v_mfma_f32_16x16x32_bf16 v[8:11], v[72:75], v[108:111], v[8:11]
    v_mfma_f32_16x16x32_bf16 v[40:43], v[76:79], v[108:111], v[40:43]
    v_mfma_f32_16x16x32_bf16 v[4:7], v[80:83], v[108:111], v[4:7]
    v_mfma_f32_16x16x32_bf16 v[36:39], v[84:87], v[108:111], v[36:39]
    v_mfma_f32_16x16x32_bf16 v[0:3], v[88:91], v[108:111], v[0:3]
    v_mfma_f32_16x16x32_bf16 v[32:35], v[92:95], v[108:111], v[32:35]
    ds_read_b128 v[108:111], v121 offset:9216
    s_waitcnt lgkmcnt(5)
    v_mfma_f32_16x16x32_bf16 v[16:19], v[64:67], v[112:115], v[16:19]
    v_mfma_f32_16x16x32_bf16 v[48:51], v[68:71], v[112:115], v[48:51]
    v_mfma_f32_16x16x32_bf16 v[12:15], v[72:75], v[112:115], v[12:15]
    v_mfma_f32_16x16x32_bf16 v[44:47], v[76:79], v[112:115], v[44:47]
    v_mfma_f32_16x16x32_bf16 v[8:11], v[80:83], v[112:115], v[8:11]
    v_mfma_f32_16x16x32_bf16 v[40:43], v[84:87], v[112:115], v[40:43]
    v_mfma_f32_16x16x32_bf16 v[4:7], v[88:91], v[112:115], v[4:7]
    v_mfma_f32_16x16x32_bf16 v[36:39], v[92:95], v[112:115], v[36:39]
    ds_read_b128 v[112:115], v121 offset:10240
    v_xor_b32 v123, 0, v125
    ds_write_b128 v123, v[0:3]
    s_waitcnt lgkmcnt(6)
    v_mfma_f32_16x16x32_bf16 v[20:23], v[64:67], v[116:119], v[20:23]
    v_mfma_f32_16x16x32_bf16 v[52:55], v[68:71], v[116:119], v[52:55]
    v_mfma_f32_16x16x32_bf16 v[16:19], v[72:75], v[116:119], v[16:19]
    v_mfma_f32_16x16x32_bf16 v[48:51], v[76:79], v[116:119], v[48:51]
    v_mfma_f32_16x16x32_bf16 v[12:15], v[80:83], v[116:119], v[12:15]
    v_mfma_f32_16x16x32_bf16 v[44:47], v[84:87], v[116:119], v[44:47]
    v_mfma_f32_16x16x32_bf16 v[8:11], v[88:91], v[116:119], v[8:11]
    v_mfma_f32_16x16x32_bf16 v[40:43], v[92:95], v[116:119], v[40:43]
    v_xor_b32 v124, 16, v125
    ds_write_b128 v124, v[4:7]
    s_waitcnt lgkmcnt(2)
    v_mfma_f32_16x16x32_bf16 v[24:27], v[64:67], v[96:99], v[24:27]
    v_mfma_f32_16x16x32_bf16 v[56:59], v[68:71], v[96:99], v[56:59]
    v_mfma_f32_16x16x32_bf16 v[20:23], v[72:75], v[96:99], v[20:23]
    v_mfma_f32_16x16x32_bf16 v[52:55], v[76:79], v[96:99], v[52:55]
    v_mfma_f32_16x16x32_bf16 v[16:19], v[80:83], v[96:99], v[16:19]
    v_mfma_f32_16x16x32_bf16 v[48:51], v[84:87], v[96:99], v[48:51]
    v_mfma_f32_16x16x32_bf16 v[12:15], v[88:91], v[96:99], v[12:15]
    v_mfma_f32_16x16x32_bf16 v[44:47], v[92:95], v[96:99], v[44:47]
    v_xor_b32 v123, 32, v125
    ds_write_b128 v123, v[8:11]
    v_xor_b32 v124, 0, v126
    ds_write_b128 v124, v[32:35]
    v_mfma_f32_16x16x32_bf16 v[28:31], v[64:67], v[100:103], v[28:31]
    v_mfma_f32_16x16x32_bf16 v[60:63], v[68:71], v[100:103], v[60:63]
    v_mfma_f32_16x16x32_bf16 v[24:27], v[72:75], v[100:103], v[24:27]
    v_mfma_f32_16x16x32_bf16 v[56:59], v[76:79], v[100:103], v[56:59]
    v_mfma_f32_16x16x32_bf16 v[20:23], v[80:83], v[100:103], v[20:23]
    v_mfma_f32_16x16x32_bf16 v[52:55], v[84:87], v[100:103], v[52:55]
    v_mfma_f32_16x16x32_bf16 v[16:19], v[88:91], v[100:103], v[16:19]
    v_mfma_f32_16x16x32_bf16 v[48:51], v[92:95], v[100:103], v[48:51]
    v_xor_b32 v123, 16, v126
    ds_write_b128 v123, v[36:39]
    v_xor_b32 v124, 32, v126
    ds_write_b128 v124, v[40:43]
    v_mfma_f32_16x16x32_bf16 v[28:31], v[72:75], v[104:107], v[28:31]
    v_mfma_f32_16x16x32_bf16 v[60:63], v[76:79], v[104:107], v[60:63]
    v_mfma_f32_16x16x32_bf16 v[24:27], v[80:83], v[104:107], v[24:27]
    v_mfma_f32_16x16x32_bf16 v[56:59], v[84:87], v[104:107], v[56:59]
    v_mfma_f32_16x16x32_bf16 v[20:23], v[88:91], v[104:107], v[20:23]
    v_mfma_f32_16x16x32_bf16 v[52:55], v[92:95], v[104:107], v[52:55]
    v_xor_b32 v124, 48, v125
    ds_write_b128 v124, v[12:15]
    v_xor_b32 v123, 48, v126
    ds_write_b128 v123, v[44:47]
    v_mfma_f32_16x16x32_bf16 v[28:31], v[80:83], v[108:111], v[28:31]
    v_mfma_f32_16x16x32_bf16 v[60:63], v[84:87], v[108:111], v[60:63]
    v_mfma_f32_16x16x32_bf16 v[24:27], v[88:91], v[108:111], v[24:27]
    v_mfma_f32_16x16x32_bf16 v[56:59], v[92:95], v[108:111], v[56:59]
    v_xor_b32 v123, 64, v125
    ds_write_b128 v123, v[16:19]
    v_xor_b32 v124, 64, v126
    ds_write_b128 v124, v[48:51]
    v_mfma_f32_16x16x32_bf16 v[28:31], v[88:91], v[112:115], v[28:31]
    v_mfma_f32_16x16x32_bf16 v[60:63], v[92:95], v[112:115], v[60:63]
    v_xor_b32 v124, 80, v125
    ds_write_b128 v124, v[20:23]
    v_xor_b32 v123, 80, v126
    ds_write_b128 v123, v[52:55]
    v_and_b32 v108, 15, v127
    v_lshrrev_b32 v109, 4, v127
    v_lshrrev_b32 v110, 3, v108
    s_lshl_b32 s36, s20, 1
    v_add_u32 v110, s36, v110
    v_xor_b32 v111, v110, v108
    v_and_b32 v111, 7, v111
    v_lshlrev_b32 v111, 4, v111
    v_xor_b32 v123, 96, v125
    ds_write_b128 v123, v[24:27]
    v_lshl_add_u32 v111, v110, 7, v111
    v_lshl_add_u32 v120, v109, 11, v111
    v_add_u32 v121, 65536, v120
    v_add_u32 v64, 131072, v120
    s_lshl_b32 s36, s20, 9
    s_add_u32 s36, s36, 115712
    v_lshl_add_u32 v127, v109, 7, s36
    s_lshl_b32 s36, s20, 4
    v_add_u32 v108, s36, v108
    v_lshlrev_b32 v110, 6, v108
    v_lshl_add_u32 v110, v109, 4, v110
    s_mul_i32 s36, s29, 262144
    v_xor_b32 v124, 96, v126
    ds_write_b128 v124, v[56:59]
    s_lshl_b32 s37, s21, 4
    s_add_u32 s36, s36, s37
    v_add_u32 v110, s36, v110
    v_mov_b32 v111, 2130706432
    v_cmp_gt_u32 vcc, 125, v108
    s_mov_b32 s4, 0xbeaaaaab
    s_mov_b32 s5, s4
    s_mov_b32 s6, 0x3e800000
    s_mov_b32 s7, s6
    s_mov_b32 s8, 0xc0a00000
    s_mov_b32 s9, s8
    s_mov_b32 s10, 0xc0638e39
    v_xor_b32 v124, 112, v125
    ds_write_b128 v124, v[28:31]
    s_mov_b32 s11, s10
    s_mov_b32 s12, 0xbf638e39
    s_mov_b32 s13, s12
    s_mov_b32 s14, 0xbe638e39
    s_mov_b32 s15, s14
    s_mov_b32 s22, 0xbd638e39
    s_mov_b32 s23, s22
    s_mov_b32 s24, 0x3ff1c71c
    s_mov_b32 s25, s24
    s_mov_b32 s26, 0xbf2aaaab
    s_mov_b32 s27, s26
    s_mov_b32 s32, 0x3ecccccd
    v_xor_b32 v123, 112, v126
    s_waitcnt lgkmcnt(8)
    ds_write_b128 v123, v[60:63]
    s_mov_b32 s33, s32
    s_mov_b32 s34, 0xbd888889
    s_mov_b32 s35, s34
    s_mov_b32 s38, 0xbe4ccccd
    s_mov_b32 s39, s38
    s_mov_b32 s40, 0xbdd2d3e8
    s_mov_b32 s41, s40
    s_mov_b32 s42, 0x3f800000
    s_mov_b32 s43, s42
    s_setprio 0
    s_branch L_conv2_kernel_epi
L_conv2_kernel_m2:
    s_mul_i32 s37, s38, 2176
    s_add_u32 s37, s37, 98304
    v_add_u32 v116, s37, v8
    v_add_u32 v118, s37, v9
    v_add_u32 v117, 104832, v8
    s_cmp_eq_u32 s38, 0
    s_cbranch_scc1 L_conv2_kernel_hh0
    v_add_u32 v117, 98304, v9
L_conv2_kernel_hh0:
    s_lshl_b32 s37, s38, 12
    s_add_u32 s37, s37, s43
    s_add_u32 s37, s37, 49152
    v_lshl_add_u32 v119, v127, 4, s37
    v_mov_b32 v0, 0
    v_mov_b32 v1, 0
    v_mov_b32 v2, 0
    v_mov_b32 v3, 0
    v_mov_b32 v4, 0
    v_mov_b32 v5, 0
    v_mov_b32 v6, 0
    v_mov_b32 v7, 0
    v_mov_b32 v8, 0
    v_mov_b32 v9, 0
    v_mov_b32 v10, 0
    v_mov_b32 v11, 0
    v_mov_b32 v12, 0
    v_mov_b32 v13, 0
    v_mov_b32 v14, 0
    v_mov_b32 v15, 0
    v_mov_b32 v16, 0
    v_mov_b32 v17, 0
    v_mov_b32 v18, 0
    v_mov_b32 v19, 0
    v_mov_b32 v20, 0
    v_mov_b32 v21, 0
    v_mov_b32 v22, 0
    v_mov_b32 v23, 0
    v_mov_b32 v24, 0
    v_mov_b32 v25, 0
    v_mov_b32 v26, 0
    v_mov_b32 v27, 0
    v_mov_b32 v28, 0
    v_mov_b32 v29, 0
    v_mov_b32 v30, 0
    v_mov_b32 v31, 0
    v_mov_b32 v32, 0
    v_mov_b32 v33, 0
    v_mov_b32 v34, 0
    v_mov_b32 v35, 0
    v_mov_b32 v36, 0
    v_mov_b32 v37, 0
    v_mov_b32 v38, 0
    v_mov_b32 v39, 0
    v_mov_b32 v40, 0
    v_mov_b32 v41, 0
    v_mov_b32 v42, 0
    v_mov_b32 v43, 0
    v_mov_b32 v44, 0
    v_mov_b32 v45, 0
    v_mov_b32 v46, 0
    v_mov_b32 v47, 0
    v_mov_b32 v48, 0
    v_mov_b32 v49, 0
    v_mov_b32 v50, 0
    v_mov_b32 v51, 0
    v_mov_b32 v52, 0
    v_mov_b32 v53, 0
    v_mov_b32 v54, 0
    v_mov_b32 v55, 0
    v_mov_b32 v56, 0
    v_mov_b32 v57, 0
    v_mov_b32 v58, 0
    v_mov_b32 v59, 0
    v_mov_b32 v60, 0
    v_mov_b32 v61, 0
    v_mov_b32 v62, 0
    v_mov_b32 v63, 0
    buffer_load_dwordx4 v[96:99], v108, s[8:11], 0 offen
    buffer_load_dwordx4 v[100:103], v109, s[8:11], 0 offen
    buffer_load_dwordx4 v[104:107], v110, s[8:11], 0 offen
    s_mov_b32 s23, 0
    s_mov_b32 s26, 4096
    buffer_load_dwordx4 v[64:67], v125, s[12:15], s23 offen offset:0
    buffer_load_dwordx4 v[68:71], v125, s[12:15], s23 offen offset:2048
    buffer_load_dwordx4 v[80:83], v119, s[12:15], s23 offen offset:0
    buffer_load_dwordx4 v[72:75], v125, s[12:15], s26 offen offset:0
    buffer_load_dwordx4 v[84:87], v119, s[12:15], s23 offen offset:2048
    buffer_load_dwordx4 v[76:79], v125, s[12:15], s26 offen offset:2048
    s_mov_b32 s23, 57344
    s_mov_b32 s26, 61440
    s_waitcnt vmcnt(6)
    v_lshlrev_b32 v108, 16, v96
    v_and_b32 v111, s25, v96
    v_lshlrev_b32 v109, 16, v100
    v_and_b32 v112, s25, v100
    v_lshlrev_b32 v110, 16, v104
    v_and_b32 v113, s25, v104
    v_mul_f32 v114, s44, v108
    v_mul_f32 v115, s44, v111
    v_fmac_f32 v114, s45, v109
    v_fmac_f32 v115, s45, v112
    v_fmac_f32 v114, s46, v110
    v_fmac_f32 v115, s46, v113
    v_cvt_pk_bf16_f32 v96, v114, v115
    v_lshlrev_b32 v108, 16, v97
    v_and_b32 v111, s25, v97
    v_lshlrev_b32 v109, 16, v101
    v_and_b32 v112, s25, v101
    v_lshlrev_b32 v110, 16, v105
    v_and_b32 v113, s25, v105
    v_mul_f32 v114, s44, v108
    v_mul_f32 v115, s44, v111
    v_fmac_f32 v114, s45, v109
    v_fmac_f32 v115, s45, v112
    v_fmac_f32 v114, s46, v110
    v_fmac_f32 v115, s46, v113
    v_cvt_pk_bf16_f32 v97, v114, v115
    v_lshlrev_b32 v108, 16, v98
    v_and_b32 v111, s25, v98
    v_lshlrev_b32 v109, 16, v102
    v_and_b32 v112, s25, v102
    v_lshlrev_b32 v110, 16, v106
    v_and_b32 v113, s25, v106
    v_mul_f32 v114, s44, v108
    v_mul_f32 v115, s44, v111
    v_fmac_f32 v114, s45, v109
    v_fmac_f32 v115, s45, v112
    v_fmac_f32 v114, s46, v110
    v_fmac_f32 v115, s46, v113
    v_cvt_pk_bf16_f32 v98, v114, v115
    v_lshlrev_b32 v108, 16, v99
    v_and_b32 v111, s25, v99
    v_lshlrev_b32 v109, 16, v103
    v_and_b32 v112, s25, v103
    v_lshlrev_b32 v110, 16, v107
    v_and_b32 v113, s25, v107
    v_mul_f32 v114, s44, v108
    v_mul_f32 v115, s44, v111
    v_fmac_f32 v114, s45, v109
    v_fmac_f32 v115, s45, v112
    v_fmac_f32 v114, s46, v110
    v_fmac_f32 v115, s46, v113
    v_cvt_pk_bf16_f32 v99, v114, v115
    ds_write_b128 v126, v[96:99]
    v_and_b32 v111, 15, v127
    v_lshlrev_b32 v111, 2, v111
    v_add_u32 v111, 99328, v111
    ds_write_b32 v111, v0
    ds_write_b32 v111, v0 offset:8704
    s_waitcnt lgkmcnt(0)
    s_barrier
    s_mov_b32 s22, 4
    s_setprio 2
L_conv2_kernel_mloop2:
    ds_read_b128 v[88:91], v120 offset:0
    ds_read_b128 v[92:95], v120 offset:1024
    ds_read_b128 v[96:99], v116 offset:0
    ds_read_b128 v[100:103], v120 offset:2048
    ds_read_b128 v[104:107], v116 offset:1088
    ds_read_b128 v[108:111], v120 offset:3072
    ds_read_b128 v[112:115], v116 offset:2176
    s_waitcnt vmcnt(5) lgkmcnt(6)
    v_mfma_f32_16x16x32_bf16 v[0:3], v[64:67], v[88:91], v[0:3]
    ds_read_b128 v[88:91], v120 offset:4096
    s_waitcnt vmcnt(4) lgkmcnt(6)
    v_mfma_f32_16x16x32_bf16 v[4:7], v[64:67], v[92:95], v[4:7]
    v_mfma_f32_16x16x32_bf16 v[0:3], v[68:71], v[92:95], v[0:3]
    ds_read_b128 v[92:95], v116 offset:3264
    s_waitcnt vmcnt(3) lgkmcnt(6)
    v_mfma_f32_16x16x32_bf16 v[32:35], v[80:83], v[96:99], v[32:35]
    ds_read_b128 v[96:99], v120 offset:5120
    s_waitcnt vmcnt(2) lgkmcnt(6)
    v_mfma_f32_16x16x32_bf16 v[8:11], v[64:67], v[100:103], v[8:11]
    v_mfma_f32_16x16x32_bf16 v[4:7], v[68:71], v[100:103], v[4:7]
    v_mfma_f32_16x16x32_bf16 v[0:3], v[72:75], v[100:103], v[0:3]
    ds_read_b128 v[100:103], v116 offset:4352
    s_waitcnt vmcnt(1) lgkmcnt(6)
    v_mfma_f32_16x16x32_bf16 v[36:39], v[80:83], v[104:107], v[36:39]
    v_mfma_f32_16x16x32_bf16 v[32:35], v[84:87], v[104:107], v[32:35]
    ds_read_b128 v[104:107], v120 offset:6144
    s_waitcnt vmcnt(0) lgkmcnt(6)
    v_mfma_f32_16x16x32_bf16 v[12:15], v[64:67], v[108:111], v[12:15]
    v_mfma_f32_16x16x32_bf16 v[8:11], v[68:71], v[108:111], v[8:11]
    v_mfma_f32_16x16x32_bf16 v[4:7], v[72:75], v[108:111], v[4:7]
    v_mfma_f32_16x16x32_bf16 v[0:3], v[76:79], v[108:111], v[0:3]
    ds_read_b128 v[108:111], v116 offset:5440
    s_waitcnt lgkmcnt(6)
    v_mfma_f32_16x16x32_bf16 v[40:43], v[80:83], v[112:115], v[40:43]
    v_mfma_f32_16x16x32_bf16 v[36:39], v[84:87], v[112:115], v[36:39]
    ds_read_b128 v[112:115], v120 offset:7168
    s_waitcnt lgkmcnt(6)
    v_mfma_f32_16x16x32_bf16 v[16:19], v[64:67], v[88:91], v[16:19]
    v_mfma_f32_16x16x32_bf16 v[12:15], v[68:71], v[88:91], v[12:15]
    v_mfma_f32_16x16x32_bf16 v[8:11], v[72:75], v[88:91], v[8:11]
    v_mfma_f32_16x16x32_bf16 v[4:7], v[76:79], v[88:91], v[4:7]
    ds_read_b128 v[88:91], v117 offset:0
    s_waitcnt lgkmcnt(6)
    v_mfma_f32_16x16x32_bf16 v[44:47], v[80:83], v[92:95], v[44:47]
    v_mfma_f32_16x16x32_bf16 v[40:43], v[84:87], v[92:95], v[40:43]
    ds_read_b128 v[92:95], v122 offset:0
    v_add_u32 v122, v123, v122
    s_waitcnt lgkmcnt(6)
    v_mfma_f32_16x16x32_bf16 v[20:23], v[64:67], v[96:99], v[20:23]
    v_mfma_f32_16x16x32_bf16 v[16:19], v[68:71], v[96:99], v[16:19]
    v_mfma_f32_16x16x32_bf16 v[12:15], v[72:75], v[96:99], v[12:15]
    v_mfma_f32_16x16x32_bf16 v[8:11], v[76:79], v[96:99], v[8:11]
    ds_read_b128 v[96:99], v117 offset:1088
    s_waitcnt lgkmcnt(6)
    v_mfma_f32_16x16x32_bf16 v[48:51], v[80:83], v[100:103], v[48:51]
    v_mfma_f32_16x16x32_bf16 v[44:47], v[84:87], v[100:103], v[44:47]
    ds_read_b128 v[100:103], v121 offset:1024
    s_waitcnt lgkmcnt(6)
    v_mfma_f32_16x16x32_bf16 v[24:27], v[64:67], v[104:107], v[24:27]
    v_mfma_f32_16x16x32_bf16 v[20:23], v[68:71], v[104:107], v[20:23]
    v_mfma_f32_16x16x32_bf16 v[16:19], v[72:75], v[104:107], v[16:19]
    v_mfma_f32_16x16x32_bf16 v[12:15], v[76:79], v[104:107], v[12:15]
    ds_read_b128 v[104:107], v118 offset:0
    s_waitcnt lgkmcnt(6)
    v_mfma_f32_16x16x32_bf16 v[52:55], v[80:83], v[108:111], v[52:55]
    v_mfma_f32_16x16x32_bf16 v[48:51], v[84:87], v[108:111], v[48:51]
    ds_read_b128 v[108:111], v121 offset:2048
    s_waitcnt lgkmcnt(6)
    v_mfma_f32_16x16x32_bf16 v[28:31], v[64:67], v[112:115], v[28:31]
    v_mfma_f32_16x16x32_bf16 v[24:27], v[68:71], v[112:115], v[24:27]
    v_mfma_f32_16x16x32_bf16 v[20:23], v[72:75], v[112:115], v[20:23]
    v_mfma_f32_16x16x32_bf16 v[16:19], v[76:79], v[112:115], v[16:19]
    buffer_load_dwordx4 v[64:67], v125, s[12:15], s23 offen offset:0
    s_waitcnt lgkmcnt(5)
    v_mfma_f32_16x16x32_bf16 v[56:59], v[80:83], v[88:91], v[56:59]
    v_mfma_f32_16x16x32_bf16 v[52:55], v[84:87], v[88:91], v[52:55]
    s_waitcnt lgkmcnt(0)
    s_barrier
    v_mfma_f32_16x16x32_bf16 v[28:31], v[68:71], v[92:95], v[28:31]
    v_mfma_f32_16x16x32_bf16 v[24:27], v[72:75], v[92:95], v[24:27]
    v_mfma_f32_16x16x32_bf16 v[20:23], v[76:79], v[92:95], v[20:23]
    buffer_load_dwordx4 v[68:71], v125, s[12:15], s23 offen offset:2048
    v_mfma_f32_16x16x32_bf16 v[60:63], v[80:83], v[96:99], v[60:63]
    v_mfma_f32_16x16x32_bf16 v[56:59], v[84:87], v[96:99], v[56:59]
    buffer_load_dwordx4 v[80:83], v119, s[12:15], s23 offen offset:0
    v_mfma_f32_16x16x32_bf16 v[28:31], v[72:75], v[100:103], v[28:31]
    v_mfma_f32_16x16x32_bf16 v[24:27], v[76:79], v[100:103], v[24:27]
    buffer_load_dwordx4 v[72:75], v125, s[12:15], s26 offen offset:0
    v_mfma_f32_16x16x32_bf16 v[60:63], v[84:87], v[104:107], v[60:63]
    buffer_load_dwordx4 v[84:87], v119, s[12:15], s23 offen offset:2048
    v_mfma_f32_16x16x32_bf16 v[28:31], v[76:79], v[108:111], v[28:31]
    buffer_load_dwordx4 v[76:79], v125, s[12:15], s26 offen offset:2048
    s_add_u32 s23, s23, 57344
    s_add_u32 s26, s26, 57344
    s_sub_u32 s22, s22, 1
    s_cmp_eq_u32 s22, 0
    s_cbranch_scc1 L_conv2_kernel_mlast2
    ds_read_b128 v[88:91], v120 offset:8192
    ds_read_b128 v[92:95], v120 offset:9216
    ds_read_b128 v[96:99], v116 offset:8704
    ds_read_b128 v[100:103], v120 offset:10240
    ds_read_b128 v[104:107], v116 offset:9792
    ds_read_b128 v[108:111], v120 offset:11264
    ds_read_b128 v[112:115], v116 offset:10880
    s_waitcnt vmcnt(5) lgkmcnt(6)
    v_mfma_f32_16x16x32_bf16 v[0:3], v[64:67], v[88:91], v[0:3]
    ds_read_b128 v[88:91], v120 offset:12288
    s_waitcnt vmcnt(4) lgkmcnt(6)
    v_mfma_f32_16x16x32_bf16 v[4:7], v[64:67], v[92:95], v[4:7]
    v_mfma_f32_16x16x32_bf16 v[0:3], v[68:71], v[92:95], v[0:3]
    ds_read_b128 v[92:95], v116 offset:11968
    s_waitcnt vmcnt(3) lgkmcnt(6)
    v_mfma_f32_16x16x32_bf16 v[32:35], v[80:83], v[96:99], v[32:35]
    ds_read_b128 v[96:99], v120 offset:13312
    s_waitcnt vmcnt(2) lgkmcnt(6)
    v_mfma_f32_16x16x32_bf16 v[8:11], v[64:67], v[100:103], v[8:11]
    v_mfma_f32_16x16x32_bf16 v[4:7], v[68:71], v[100:103], v[4:7]
    v_mfma_f32_16x16x32_bf16 v[0:3], v[72:75], v[100:103], v[0:3]
    ds_read_b128 v[100:103], v116 offset:13056
    s_waitcnt vmcnt(1) lgkmcnt(6)
    v_mfma_f32_16x16x32_bf16 v[36:39], v[80:83], v[104:107], v[36:39]
    v_mfma_f32_16x16x32_bf16 v[32:35], v[84:87], v[104:107], v[32:35]
    ds_read_b128 v[104:107], v120 offset:14336
    s_waitcnt vmcnt(0) lgkmcnt(6)
    v_mfma_f32_16x16x32_bf16 v[12:15], v[64:67], v[108:111], v[12:15]
    v_mfma_f32_16x16x32_bf16 v[8:11], v[68:71], v[108:111], v[8:11]
    v_mfma_f32_16x16x32_bf16 v[4:7], v[72:75], v[108:111], v[4:7]
    v_mfma_f32_16x16x32_bf16 v[0:3], v[76:79], v[108:111], v[0:3]
    ds_read_b128 v[108:111], v116 offset:14144
    s_waitcnt lgkmcnt(6)
    v_mfma_f32_16x16x32_bf16 v[40:43], v[80:83], v[112:115], v[40:43]
    v_mfma_f32_16x16x32_bf16 v[36:39], v[84:87], v[112:115], v[36:39]
    ds_read_b128 v[112:115], v120 offset:15360
    s_waitcnt lgkmcnt(6)
    v_mfma_f32_16x16x32_bf16 v[16:19], v[64:67], v[88:91], v[16:19]
    v_mfma_f32_16x16x32_bf16 v[12:15], v[68:71], v[88:91], v[12:15]
    v_mfma_f32_16x16x32_bf16 v[8:11], v[72:75], v[88:91], v[8:11]
    v_mfma_f32_16x16x32_bf16 v[4:7], v[76:79], v[88:91], v[4:7]
    ds_read_b128 v[88:91], v117 offset:8704
    s_waitcnt lgkmcnt(6)
    v_mfma_f32_16x16x32_bf16 v[44:47], v[80:83], v[92:95], v[44:47]
    v_mfma_f32_16x16x32_bf16 v[40:43], v[84:87], v[92:95], v[40:43]
    ds_read_b128 v[92:95], v122 offset:0
    v_add_u32 v122, v124, v122
    s_waitcnt lgkmcnt(6)
    v_mfma_f32_16x16x32_bf16 v[20:23], v[64:67], v[96:99], v[20:23]
    v_mfma_f32_16x16x32_bf16 v[16:19], v[68:71], v[96:99], v[16:19]
    v_mfma_f32_16x16x32_bf16 v[12:15], v[72:75], v[96:99], v[12:15]
    v_mfma_f32_16x16x32_bf16 v[8:11], v[76:79], v[96:99], v[8:11]
    ds_read_b128 v[96:99], v117 offset:9792
    s_waitcnt lgkmcnt(6)
    v_mfma_f32_16x16x32_bf16 v[48:51], v[80:83], v[100:103], v[48:51]
    v_mfma_f32_16x16x32_bf16 v[44:47], v[84:87], v[100:103], v[44:47]
    ds_read_b128 v[100:103], v121 offset:9216
    s_waitcnt lgkmcnt(6)
    v_mfma_f32_16x16x32_bf16 v[24:27], v[64:67], v[104:107], v[24:27]
    v_mfma_f32_16x16x32_bf16 v[20:23], v[68:71], v[104:107], v[20:23]
    v_mfma_f32_16x16x32_bf16 v[16:19], v[72:75], v[104:107], v[16:19]
    v_mfma_f32_16x16x32_bf16 v[12:15], v[76:79], v[104:107], v[12:15]
    ds_read_b128 v[104:107], v118 offset:8704
    s_waitcnt lgkmcnt(6)
    v_mfma_f32_16x16x32_bf16 v[52:55], v[80:83], v[108:111], v[52:55]
    v_mfma_f32_16x16x32_bf16 v[48:51], v[84:87], v[108:111], v[48:51]
    ds_read_b128 v[108:111], v121 offset:10240
    s_waitcnt lgkmcnt(6)
    v_mfma_f32_16x16x32_bf16 v[28:31], v[64:67], v[112:115], v[28:31]
    v_mfma_f32_16x16x32_bf16 v[24:27], v[68:71], v[112:115], v[24:27]
    v_mfma_f32_16x16x32_bf16 v[20:23], v[72:75], v[112:115], v[20:23]
    v_mfma_f32_16x16x32_bf16 v[16:19], v[76:79], v[112:115], v[16:19]
    buffer_load_dwordx4 v[64:67], v125, s[12:15], s23 offen offset:0
    s_waitcnt lgkmcnt(5)
    v_mfma_f32_16x16x32_bf16 v[56:59], v[80:83], v[88:91], v[56:59]
    v_mfma_f32_16x16x32_bf16 v[52:55], v[84:87], v[88:91], v[52:55]
    s_waitcnt lgkmcnt(0)
    s_barrier
    v_mfma_f32_16x16x32_bf16 v[28:31], v[68:71], v[92:95], v[28:31]
    v_mfma_f32_16x16x32_bf16 v[24:27], v[72:75], v[92:95], v[24:27]
    v_mfma_f32_16x16x32_bf16 v[20:23], v[76:79], v[92:95], v[20:23]
    buffer_load_dwordx4 v[68:71], v125, s[12:15], s23 offen offset:2048
    v_mfma_f32_16x16x32_bf16 v[60:63], v[80:83], v[96:99], v[60:63]
    v_mfma_f32_16x16x32_bf16 v[56:59], v[84:87], v[96:99], v[56:59]
    buffer_load_dwordx4 v[80:83], v119, s[12:15], s23 offen offset:0
    v_mfma_f32_16x16x32_bf16 v[28:31], v[72:75], v[100:103], v[28:31]
    v_mfma_f32_16x16x32_bf16 v[24:27], v[76:79], v[100:103], v[24:27]
    buffer_load_dwordx4 v[72:75], v125, s[12:15], s26 offen offset:0
    v_mfma_f32_16x16x32_bf16 v[60:63], v[84:87], v[104:107], v[60:63]
    buffer_load_dwordx4 v[84:87], v119, s[12:15], s23 offen offset:2048
    v_mfma_f32_16x16x32_bf16 v[28:31], v[76:79], v[108:111], v[28:31]
    buffer_load_dwordx4 v[76:79], v125, s[12:15], s26 offen offset:2048
    s_add_u32 s23, s23, 57344
    s_add_u32 s26, s26, 57344
    s_branch L_conv2_kernel_mloop2
L_conv2_kernel_mlast2:
    v_and_b32 v125, 15, v127
    v_and_b32 v126, 7, v127
    v_lshlrev_b32 v126, 4, v126
    v_lshl_add_u32 v125, v125, 7, v126
    v_lshrrev_b32 v126, 4, v127
    v_lshl_add_u32 v125, v126, 11, v125
    s_mov_b32 s36, 65536
    s_cmp_eq_u32 s32, 1
    s_cselect_b32 s36, 121856, s36
    s_cmp_eq_u32 s32, 2
    s_cselect_b32 s36, 81920, s36
    s_cmp_eq_u32 s32, 3
    s_cselect_b32 s36, 130048, s36
    s_mov_b32 s37, 98304
    s_cmp_eq_u32 s32, 1
    s_cselect_b32 s37, 138240, s37
    s_cmp_eq_u32 s32, 2
    s_cselect_b32 s37, 146432, s37
    s_cmp_eq_u32 s32, 3
    s_cselect_b32 s37, 154624, s37
    v_add_u32 v126, s37, v125
    v_add_u32 v125, s36, v125
    ds_read_b128 v[88:91], v120 offset:8192
    ds_read_b128 v[92:95], v120 offset:9216
    ds_read_b128 v[96:99], v116 offset:8704
    ds_read_b128 v[100:103], v120 offset:10240
    ds_read_b128 v[104:107], v116 offset:9792
    ds_read_b128 v[108:111], v120 offset:11264
    ds_read_b128 v[112:115], v116 offset:10880
    s_waitcnt vmcnt(5) lgkmcnt(6)
    v_mfma_f32_16x16x32_bf16 v[0:3], v[64:67], v[88:91], v[0:3]
    ds_read_b128 v[88:91], v120 offset:12288
    s_waitcnt vmcnt(4) lgkmcnt(6)
    v_mfma_f32_16x16x32_bf16 v[4:7], v[64:67], v[92:95], v[4:7]
    v_mfma_f32_16x16x32_bf16 v[0:3], v[68:71], v[92:95], v[0:3]
    ds_read_b128 v[92:95], v116 offset:11968
    s_waitcnt vmcnt(3) lgkmcnt(6)
    v_mfma_f32_16x16x32_bf16 v[32:35], v[80:83], v[96:99], v[32:35]
    ds_read_b128 v[96:99], v120 offset:13312
    s_waitcnt vmcnt(2) lgkmcnt(6)
    v_mfma_f32_16x16x32_bf16 v[8:11], v[64:67], v[100:103], v[8:11]
    v_mfma_f32_16x16x32_bf16 v[4:7], v[68:71], v[100:103], v[4:7]
    v_mfma_f32_16x16x32_bf16 v[0:3], v[72:75], v[100:103], v[0:3]
    ds_read_b128 v[100:103], v116 offset:13056
    s_waitcnt vmcnt(1) lgkmcnt(6)
    v_mfma_f32_16x16x32_bf16 v[36:39], v[80:83], v[104:107], v[36:39]
    v_mfma_f32_16x16x32_bf16 v[32:35], v[84:87], v[104:107], v[32:35]
    ds_read_b128 v[104:107], v120 offset:14336
    s_waitcnt vmcnt(0) lgkmcnt(6)
    v_mfma_f32_16x16x32_bf16 v[12:15], v[64:67], v[108:111], v[12:15]
    v_mfma_f32_16x16x32_bf16 v[8:11], v[68:71], v[108:111], v[8:11]
    v_mfma_f32_16x16x32_bf16 v[4:7], v[72:75], v[108:111], v[4:7]
    v_mfma_f32_16x16x32_bf16 v[0:3], v[76:79], v[108:111], v[0:3]
    ds_read_b128 v[108:111], v116 offset:14144
    s_waitcnt lgkmcnt(6)
    v_mfma_f32_16x16x32_bf16 v[40:43], v[80:83], v[112:115], v[40:43]
    v_mfma_f32_16x16x32_bf16 v[36:39], v[84:87], v[112:115], v[36:39]
    ds_read_b128 v[112:115], v120 offset:15360
    s_waitcnt lgkmcnt(6)
    v_mfma_f32_16x16x32_bf16 v[16:19], v[64:67], v[88:91], v[16:19]
    v_mfma_f32_16x16x32_bf16 v[12:15], v[68:71], v[88:91], v[12:15]
    v_mfma_f32_16x16x32_bf16 v[8:11], v[72:75], v[88:91], v[8:11]
    v_mfma_f32_16x16x32_bf16 v[4:7], v[76:79], v[88:91], v[4:7]
    ds_read_b128 v[88:91], v117 offset:8704
    v_xor_b32 v124, 0, v126
    ds_write_b128 v124, v[32:35]
    s_waitcnt lgkmcnt(7)
    v_mfma_f32_16x16x32_bf16 v[44:47], v[80:83], v[92:95], v[44:47]
    v_mfma_f32_16x16x32_bf16 v[40:43], v[84:87], v[92:95], v[40:43]
    ds_read_b128 v[92:95], v122 offset:0
    v_xor_b32 v123, 0, v125
    ds_write_b128 v123, v[0:3]
    s_waitcnt lgkmcnt(8)
    v_mfma_f32_16x16x32_bf16 v[20:23], v[64:67], v[96:99], v[20:23]
    v_mfma_f32_16x16x32_bf16 v[16:19], v[68:71], v[96:99], v[16:19]
    v_mfma_f32_16x16x32_bf16 v[12:15], v[72:75], v[96:99], v[12:15]
    v_mfma_f32_16x16x32_bf16 v[8:11], v[76:79], v[96:99], v[8:11]
    ds_read_b128 v[96:99], v117 offset:9792
    v_xor_b32 v123, 16, v126
    ds_write_b128 v123, v[36:39]
    s_waitcnt lgkmcnt(9)
    v_mfma_f32_16x16x32_bf16 v[48:51], v[80:83], v[100:103], v[48:51]
    v_mfma_f32_16x16x32_bf16 v[44:47], v[84:87], v[100:103], v[44:47]
    ds_read_b128 v[100:103], v121 offset:9216
    v_xor_b32 v124, 16, v125
    ds_write_b128 v124, v[4:7]
    s_waitcnt lgkmcnt(10)
    v_mfma_f32_16x16x32_bf16 v[24:27], v[64:67], v[104:107], v[24:27]
    v_mfma_f32_16x16x32_bf16 v[20:23], v[68:71], v[104:107], v[20:23]
    v_mfma_f32_16x16x32_bf16 v[16:19], v[72:75], v[104:107], v[16:19]
    v_mfma_f32_16x16x32_bf16 v[12:15], v[76:79], v[104:107], v[12:15]
    ds_read_b128 v[104:107], v118 offset:8704
    v_xor_b32 v124, 32, v126
    ds_write_b128 v124, v[40:43]
    s_waitcnt lgkmcnt(11)
    v_mfma_f32_16x16x32_bf16 v[52:55], v[80:83], v[108:111], v[52:55]
    v_mfma_f32_16x16x32_bf16 v[48:51], v[84:87], v[108:111], v[48:51]
    ds_read_b128 v[108:111], v121 offset:10240
    v_xor_b32 v123, 32, v125
    ds_write_b128 v123, v[8:11]
    s_waitcnt lgkmcnt(12)
    v_mfma_f32_16x16x32_bf16 v[28:31], v[64:67], v[112:115], v[28:31]
    v_mfma_f32_16x16x32_bf16 v[24:27], v[68:71], v[112:115], v[24:27]
    v_mfma_f32_16x16x32_bf16 v[20:23], v[72:75], v[112:115], v[20:23]
    v_mfma_f32_16x16x32_bf16 v[16:19], v[76:79], v[112:115], v[16:19]
    v_xor_b32 v123, 48, v126
    ds_write_b128 v123, v[44:47]
    s_waitcnt lgkmcnt(12)
    v_mfma_f32_16x16x32_bf16 v[56:59], v[80:83], v[88:91], v[56:59]
    v_mfma_f32_16x16x32_bf16 v[52:55], v[84:87], v[88:91], v[52:55]
    v_xor_b32 v124, 48, v125
    ds_write_b128 v124, v[12:15]
    s_waitcnt lgkmcnt(11)
    v_mfma_f32_16x16x32_bf16 v[28:31], v[68:71], v[92:95], v[28:31]
    v_mfma_f32_16x16x32_bf16 v[24:27], v[72:75], v[92:95], v[24:27]
    v_mfma_f32_16x16x32_bf16 v[20:23], v[76:79], v[92:95], v[20:23]
    v_xor_b32 v124, 64, v126
    ds_write_b128 v124, v[48:51]
    s_waitcnt lgkmcnt(10)
    v_mfma_f32_16x16x32_bf16 v[60:63], v[80:83], v[96:99], v[60:63]
    v_mfma_f32_16x16x32_bf16 v[56:59], v[84:87], v[96:99], v[56:59]
    v_xor_b32 v123, 64, v125
    ds_write_b128 v123, v[16:19]
    s_waitcnt lgkmcnt(9)
    v_mfma_f32_16x16x32_bf16 v[28:31], v[72:75], v[100:103], v[28:31]
    v_mfma_f32_16x16x32_bf16 v[24:27], v[76:79], v[100:103], v[24:27]
    v_xor_b32 v123, 80, v126
    ds_write_b128 v123, v[52:55]
    s_waitcnt lgkmcnt(8)
    v_mfma_f32_16x16x32_bf16 v[60:63], v[84:87], v[104:107], v[60:63]
    v_xor_b32 v124, 80, v125
    ds_write_b128 v124, v[20:23]
    s_waitcnt lgkmcnt(7)
    v_mfma_f32_16x16x32_bf16 v[28:31], v[76:79], v[108:111], v[28:31]
    v_xor_b32 v124, 96, v126
    ds_write_b128 v124, v[56:59]
    v_and_b32 v108, 15, v127
    v_lshrrev_b32 v109, 4, v127
    v_lshrrev_b32 v110, 3, v108
    s_lshl_b32 s36, s20, 1
    v_add_u32 v110, s36, v110
    v_xor_b32 v111, v110, v108
    v_and_b32 v111, 7, v111
    v_lshlrev_b32 v111, 4, v111
    v_xor_b32 v123, 96, v125
    ds_write_b128 v123, v[24:27]
    v_lshl_add_u32 v111, v110, 7, v111
    v_lshl_add_u32 v120, v109, 11, v111
    v_add_u32 v121, 65536, v120
    v_add_u32 v64, 131072, v120
    s_lshl_b32 s36, s20, 9
    s_add_u32 s36, s36, 115712
    v_lshl_add_u32 v127, v109, 7, s36
    s_lshl_b32 s36, s20, 4
    v_add_u32 v108, s36, v108
    v_lshlrev_b32 v110, 6, v108
    v_lshl_add_u32 v110, v109, 4, v110
    s_mul_i32 s36, s29, 262144
    v_xor_b32 v123, 112, v126
    ds_write_b128 v123, v[60:63]
    s_lshl_b32 s37, s21, 4
    s_add_u32 s36, s36, s37
    v_add_u32 v110, s36, v110
    v_mov_b32 v111, 2130706432
    v_cmp_gt_u32 vcc, 125, v108
    s_mov_b32 s4, 0xbeaaaaab
    s_mov_b32 s5, s4
    s_mov_b32 s6, 0x3e800000
    s_mov_b32 s7, s6
    s_mov_b32 s8, 0xc0a00000
    s_mov_b32 s9, s8
    s_mov_b32 s10, 0xc0638e39
    v_xor_b32 v124, 112, v125
    ds_write_b128 v124, v[28:31]
    s_mov_b32 s11, s10
    s_mov_b32 s12, 0xbf638e39
    s_mov_b32 s13, s12
    s_mov_b32 s14, 0xbe638e39
    s_mov_b32 s15, s14
    s_mov_b32 s22, 0xbd638e39
    s_mov_b32 s23, s22
    s_mov_b32 s24, 0x3ff1c71c
    s_mov_b32 s25, s24
    s_mov_b32 s26, 0xbf2aaaab
    s_mov_b32 s27, s26
    s_mov_b32 s32, 0x3ecccccd
    s_mov_b32 s33, s32
    s_mov_b32 s34, 0xbd888889
    s_mov_b32 s35, s34
    s_mov_b32 s38, 0xbe4ccccd
    s_mov_b32 s39, s38
    s_mov_b32 s40, 0xbdd2d3e8
    s_mov_b32 s41, s40
    s_mov_b32 s42, 0x3f800000
    s_mov_b32 s43, s42
    s_setprio 0
    s_branch L_conv2_kernel_epi
L_conv2_kernel_helper:
    s_setprio 3
    v_lshlrev_b32 v8, 4, v6
    s_add_u32 s37, s33, 4294967289
    v_lshl_add_u32 v9, v7, 3, s37
    v_cmp_gt_u32 vcc, 8000, v9
    s_mul_i32 s37, s33, 131072
    s_add_u32 s37, s37, 0
    v_lshl_add_u32 v92, v7, 7, s37
    v_add_u32 v92, v92, v8
    v_mov_b32 v9, 2130706432
    v_cndmask_b32 v92, v9, v92, vcc
    s_add_u32 s37, s33, 4294967291
    v_lshl_add_u32 v9, v7, 3, s37
    v_cmp_gt_u32 vcc, 8000, v9
    s_mul_i32 s37, s33, 131072
    s_add_u32 s37, s37, 262144
    v_lshl_add_u32 v93, v7, 7, s37
    v_add_u32 v93, v93, v8
    v_mov_b32 v9, 2130706432
    v_cndmask_b32 v93, v9, v93, vcc
    s_add_u32 s37, s33, 4294967293
    v_lshl_add_u32 v9, v7, 3, s37
    v_cmp_gt_u32 vcc, 8000, v9
    s_mul_i32 s37, s33, 131072
    s_add_u32 s37, s37, 64
    v_lshl_add_u32 v94, v7, 7, s37
    v_add_u32 v94, v94, v8
    v_mov_b32 v9, 2130706432
    v_cndmask_b32 v94, v9, v94, vcc
    s_add_u32 s37, s33, 4294967295
    v_lshl_add_u32 v9, v7, 3, s37
    v_cmp_gt_u32 vcc, 8000, v9
    s_mul_i32 s37, s33, 131072
    s_add_u32 s37, s37, 262208
    v_lshl_add_u32 v95, v7, 7, s37
    v_add_u32 v95, v95, v8
    v_mov_b32 v9, 2130706432
    v_cndmask_b32 v95, v9, v95, vcc
    v_and_b32 v76, 4, v5
    v_lshrrev_b32 v76, 1, v76
    v_xor_b32 v76, v6, v76
    v_lshlrev_b32 v76, 4, v76
    v_lshl_add_u32 v76, v5, 6, v76
    s_mov_b32 s24, 0
    s_mov_b32 s27, 524288
    s_waitcnt lgkmcnt(0)
    s_add_u32 s8, s4, s47
    s_addc_u32 s9, s5, 0
    buffer_load_dwordx4 v[0:3], v92, s[8:11], s24 offen
    buffer_load_dwordx4 v[8:11], v94, s[8:11], s24 offen
    buffer_load_dwordx4 v[4:7], v93, s[8:11], s24 offen
    buffer_load_dwordx4 v[12:15], v95, s[8:11], s24 offen
    buffer_load_dwordx4 v[16:19], v92, s[8:11], s27 offen
    buffer_load_dwordx4 v[24:27], v94, s[8:11], s27 offen
    buffer_load_dwordx4 v[20:23], v93, s[8:11], s27 offen
    buffer_load_dwordx4 v[28:31], v95, s[8:11], s27 offen
    s_mul_i32 s36, s42, 1024
    v_add_u32 v96, s36, v76
    v_add_u32 v97, 65536, v96
    s_mul_i32 s36, s42, 1088
    s_add_u32 s36, s36, 98304
    v_add_u32 v98, s36, v76
    s_waitcnt vmcnt(0)
    s_mov_b32 s28, 0
    s_mov_b32 s22, 2
    s_cmp_ge_u32 s20, 12
    s_cbranch_scc1 L_conv2_kernel_h2
    ds_write_b128 v96, v[0:3] offset:0
    ds_write_b128 v98, v[12:15] offset:0
    v_lshlrev_b32 v76, 16, v0
    v_and_b32 v84, s25, v0
    v_lshlrev_b32 v77, 16, v4
    v_and_b32 v85, s25, v4
    v_lshlrev_b32 v78, 16, v8
    v_and_b32 v86, s25, v8
    v_lshlrev_b32 v79, 16, v12
    v_and_b32 v87, s25, v12
    v_add_f32 v80, v76, v78
    v_add_f32 v88, v84, v86
    v_add_f32 v81, v77, v79
    v_add_f32 v89, v85, v87
    v_fma_f32 v82, v78, 4.0, v76
    v_fma_f32 v90, v86, 4.0, v84
    v_fma_f32 v83, v79, 4.0, v77
    v_fma_f32 v91, v87, 4.0, v85
    v_add_f32 v77, v80, v81
    v_add_f32 v85, v88, v89
    v_sub_f32 v78, v80, v81
    v_sub_f32 v86, v88, v89
    v_fma_f32 v79, v83, 2.0, v82
    v_fma_f32 v87, v91, 2.0, v90
    v_fma_f32 v82, v83, -2.0, v82
    v_fma_f32 v90, v91, -2.0, v90
    v_fmamk_f32 v80, v76, 0x41700000, v82
    v_fmamk_f32 v88, v84, 0x41700000, v90
    v_fmamk_f32 v80, v81, 0x41200000, v80
    v_fmamk_f32 v88, v89, 0x41200000, v88
    v_cvt_pk_bf16_f32 v4, v77, v85
    v_cvt_pk_bf16_f32 v8, v78, v86
    v_cvt_pk_bf16_f32 v64, v79, v87
    v_cvt_pk_bf16_f32 v68, v82, v90
    v_cvt_pk_bf16_f32 v72, v80, v88
    v_lshlrev_b32 v76, 16, v1
    v_and_b32 v84, s25, v1
    v_lshlrev_b32 v77, 16, v5
    v_and_b32 v85, s25, v5
    v_lshlrev_b32 v78, 16, v9
    v_and_b32 v86, s25, v9
    v_lshlrev_b32 v79, 16, v13
    v_and_b32 v87, s25, v13
    v_add_f32 v80, v76, v78
    v_add_f32 v88, v84, v86
    v_add_f32 v81, v77, v79
    v_add_f32 v89, v85, v87
    v_fma_f32 v82, v78, 4.0, v76
    v_fma_f32 v90, v86, 4.0, v84
    v_fma_f32 v83, v79, 4.0, v77
    v_fma_f32 v91, v87, 4.0, v85
    v_add_f32 v77, v80, v81
    v_add_f32 v85, v88, v89
    v_sub_f32 v78, v80, v81
    v_sub_f32 v86, v88, v89
    v_fma_f32 v79, v83, 2.0, v82
    v_fma_f32 v87, v91, 2.0, v90
    v_fma_f32 v82, v83, -2.0, v82
    v_fma_f32 v90, v91, -2.0, v90
    v_fmamk_f32 v80, v76, 0x41700000, v82
    v_fmamk_f32 v88, v84, 0x41700000, v90
    v_fmamk_f32 v80, v81, 0x41200000, v80
    v_fmamk_f32 v88, v89, 0x41200000, v88
    v_cvt_pk_bf16_f32 v5, v77, v85
    v_cvt_pk_bf16_f32 v9, v78, v86
    v_cvt_pk_bf16_f32 v65, v79, v87
    v_cvt_pk_bf16_f32 v69, v82, v90
    v_cvt_pk_bf16_f32 v73, v80, v88
    v_lshlrev_b32 v76, 16, v2
    v_and_b32 v84, s25, v2
    v_lshlrev_b32 v77, 16, v6
    v_and_b32 v85, s25, v6
    v_lshlrev_b32 v78, 16, v10
    v_and_b32 v86, s25, v10
    v_lshlrev_b32 v79, 16, v14
    v_and_b32 v87, s25, v14
    v_add_f32 v80, v76, v78
    v_add_f32 v88, v84, v86
    v_add_f32 v81, v77, v79
    v_add_f32 v89, v85, v87
    v_fma_f32 v82, v78, 4.0, v76
    v_fma_f32 v90, v86, 4.0, v84
    v_fma_f32 v83, v79, 4.0, v77
    v_fma_f32 v91, v87, 4.0, v85
    v_add_f32 v77, v80, v81
    v_add_f32 v85, v88, v89
    v_sub_f32 v78, v80, v81
    v_sub_f32 v86, v88, v89
    v_fma_f32 v79, v83, 2.0, v82
    v_fma_f32 v87, v91, 2.0, v90
    v_fma_f32 v82, v83, -2.0, v82
    v_fma_f32 v90, v91, -2.0, v90
    v_fmamk_f32 v80, v76, 0x41700000, v82
    v_fmamk_f32 v88, v84, 0x41700000, v90
    v_fmamk_f32 v80, v81, 0x41200000, v80
    v_fmamk_f32 v88, v89, 0x41200000, v88
    v_cvt_pk_bf16_f32 v6, v77, v85
    v_cvt_pk_bf16_f32 v10, v78, v86
    v_cvt_pk_bf16_f32 v66, v79, v87
    v_cvt_pk_bf16_f32 v70, v82, v90
    v_cvt_pk_bf16_f32 v74, v80, v88
    v_lshlrev_b32 v76, 16, v3
    v_and_b32 v84, s25, v3
    v_lshlrev_b32 v77, 16, v7
    v_and_b32 v85, s25, v7
    v_lshlrev_b32 v78, 16, v11
    v_and_b32 v86, s25, v11
    v_lshlrev_b32 v79, 16, v15
    v_and_b32 v87, s25, v15
    v_add_f32 v80, v76, v78
    v_add_f32 v88, v84, v86
    v_add_f32 v81, v77, v79
    v_add_f32 v89, v85, v87
    v_fma_f32 v82, v78, 4.0, v76
    v_fma_f32 v90, v86, 4.0, v84
    v_fma_f32 v83, v79, 4.0, v77
    v_fma_f32 v91, v87, 4.0, v85
    v_add_f32 v77, v80, v81
    v_add_f32 v85, v88, v89
    v_sub_f32 v78, v80, v81
    v_sub_f32 v86, v88, v89
    v_fma_f32 v79, v83, 2.0, v82
    v_fma_f32 v87, v91, 2.0, v90
    v_fma_f32 v82, v83, -2.0, v82
    v_fma_f32 v90, v91, -2.0, v90
    v_fmamk_f32 v80, v76, 0x41700000, v82
    v_fmamk_f32 v88, v84, 0x41700000, v90
    v_fmamk_f32 v80, v81, 0x41200000, v80
    v_fmamk_f32 v88, v89, 0x41200000, v88
    v_cvt_pk_bf16_f32 v7, v77, v85
    v_cvt_pk_bf16_f32 v11, v78, v86
    v_cvt_pk_bf16_f32 v67, v79, v87
    v_cvt_pk_bf16_f32 v71, v82, v90
    v_cvt_pk_bf16_f32 v75, v80, v88
    ds_write_b128 v96, v[64:67] offset:49152
    ds_write_b128 v97, v[68:71] offset:0
    ds_write_b128 v97, v[72:75] offset:16384
    ds_write_b128 v96, v[4:7] offset:16384
    ds_write_b128 v96, v[8:11] offset:32768
    s_waitcnt vmcnt(0)
    s_mov_b32 s24, 1048576
    s_mov_b32 s27, 1572864
    s_waitcnt lgkmcnt(0)
    s_barrier
    buffer_load_dwordx4 v[32:35], v92, s[8:11], s24 offen
    buffer_load_dwordx4 v[40:43], v94, s[8:11], s24 offen
    buffer_load_dwordx4 v[36:39], v93, s[8:11], s24 offen
    buffer_load_dwordx4 v[44:47], v95, s[8:11], s24 offen
    buffer_load_dwordx4 v[48:51], v92, s[8:11], s27 offen
    buffer_load_dwordx4 v[56:59], v94, s[8:11], s27 offen
    buffer_load_dwordx4 v[52:55], v93, s[8:11], s27 offen
    buffer_load_dwordx4 v[60:63], v95, s[8:11], s27 offen
    s_setprio 1
L_conv2_kernel_hloop1:
    v_lshlrev_b32 v76, 16, v16
    v_and_b32 v84, s25, v16
    v_lshlrev_b32 v77, 16, v20
    v_and_b32 v85, s25, v20
    v_lshlrev_b32 v78, 16, v24
    v_and_b32 v86, s25, v24
    v_lshlrev_b32 v79, 16, v28
    v_and_b32 v87, s25, v28
    v_add_f32 v80, v76, v78
    v_add_f32 v88, v84, v86
    v_add_f32 v81, v77, v79
    v_add_f32 v89, v85, v87
    v_fma_f32 v82, v78, 4.0, v76
    v_fma_f32 v90, v86, 4.0, v84
    v_fma_f32 v83, v79, 4.0, v77
    v_fma_f32 v91, v87, 4.0, v85
    v_add_f32 v77, v80, v81
    v_add_f32 v85, v88, v89
    v_sub_f32 v78, v80, v81
    v_sub_f32 v86, v88, v89
    v_fma_f32 v79, v83, 2.0, v82
    v_fma_f32 v87, v91, 2.0, v90
    v_fma_f32 v82, v83, -2.0, v82
    v_fma_f32 v90, v91, -2.0, v90
    v_fmamk_f32 v80, v76, 0x41700000, v82
    v_fmamk_f32 v88, v84, 0x41700000, v90
    v_fmamk_f32 v80, v81, 0x41200000, v80
    v_fmamk_f32 v88, v89, 0x41200000, v88
    v_cvt_pk_bf16_f32 v20, v77, v85
    v_cvt_pk_bf16_f32 v24, v78, v86
    v_cvt_pk_bf16_f32 v64, v79, v87
    v_cvt_pk_bf16_f32 v68, v82, v90
    v_cvt_pk_bf16_f32 v72, v80, v88
    v_lshlrev_b32 v76, 16, v17
    v_and_b32 v84, s25, v17
    v_lshlrev_b32 v77, 16, v21
    v_and_b32 v85, s25, v21
    v_lshlrev_b32 v78, 16, v25
    v_and_b32 v86, s25, v25
    v_lshlrev_b32 v79, 16, v29
    v_and_b32 v87, s25, v29
    v_add_f32 v80, v76, v78
    v_add_f32 v88, v84, v86
    v_add_f32 v81, v77, v79
    v_add_f32 v89, v85, v87
    v_fma_f32 v82, v78, 4.0, v76
    v_fma_f32 v90, v86, 4.0, v84
    v_fma_f32 v83, v79, 4.0, v77
    v_fma_f32 v91, v87, 4.0, v85
    v_add_f32 v77, v80, v81
    v_add_f32 v85, v88, v89
    v_sub_f32 v78, v80, v81
    v_sub_f32 v86, v88, v89
    v_fma_f32 v79, v83, 2.0, v82
    v_fma_f32 v87, v91, 2.0, v90
    v_fma_f32 v82, v83, -2.0, v82
    v_fma_f32 v90, v91, -2.0, v90
    v_fmamk_f32 v80, v76, 0x41700000, v82
    v_fmamk_f32 v88, v84, 0x41700000, v90
    v_fmamk_f32 v80, v81, 0x41200000, v80
    v_fmamk_f32 v88, v89, 0x41200000, v88
    v_cvt_pk_bf16_f32 v21, v77, v85
    v_cvt_pk_bf16_f32 v25, v78, v86
    v_cvt_pk_bf16_f32 v65, v79, v87
    v_cvt_pk_bf16_f32 v69, v82, v90
    v_cvt_pk_bf16_f32 v73, v80, v88
    v_lshlrev_b32 v76, 16, v18
    v_and_b32 v84, s25, v18
    v_lshlrev_b32 v77, 16, v22
    v_and_b32 v85, s25, v22
    v_lshlrev_b32 v78, 16, v26
    v_and_b32 v86, s25, v26
    v_lshlrev_b32 v79, 16, v30
    v_and_b32 v87, s25, v30
    v_add_f32 v80, v76, v78
    v_add_f32 v88, v84, v86
    v_add_f32 v81, v77, v79
    v_add_f32 v89, v85, v87
    v_fma_f32 v82, v78, 4.0, v76
    v_fma_f32 v90, v86, 4.0, v84
    v_fma_f32 v83, v79, 4.0, v77
    v_fma_f32 v91, v87, 4.0, v85
    v_add_f32 v77, v80, v81
    v_add_f32 v85, v88, v89
    v_sub_f32 v78, v80, v81
    v_sub_f32 v86, v88, v89
    v_fma_f32 v79, v83, 2.0, v82
    v_fma_f32 v87, v91, 2.0, v90
    v_fma_f32 v82, v83, -2.0, v82
    v_fma_f32 v90, v91, -2.0, v90
    v_fmamk_f32 v80, v76, 0x41700000, v82
    v_fmamk_f32 v88, v84, 0x41700000, v90
    v_fmamk_f32 v80, v81, 0x41200000, v80
    v_fmamk_f32 v88, v89, 0x41200000, v88
    v_cvt_pk_bf16_f32 v22, v77, v85
    v_cvt_pk_bf16_f32 v26, v78, v86
    v_cvt_pk_bf16_f32 v66, v79, v87
    v_cvt_pk_bf16_f32 v70, v82, v90
    v_cvt_pk_bf16_f32 v74, v80, v88
    v_lshlrev_b32 v76, 16, v19
    v_and_b32 v84, s25, v19
    v_lshlrev_b32 v77, 16, v23
    v_and_b32 v85, s25, v23
    v_lshlrev_b32 v78, 16, v27
    v_and_b32 v86, s25, v27
    v_lshlrev_b32 v79, 16, v31
    v_and_b32 v87, s25, v31
    v_add_f32 v80, v76, v78
    v_add_f32 v88, v84, v86
    v_add_f32 v81, v77, v79
    v_add_f32 v89, v85, v87
    v_fma_f32 v82, v78, 4.0, v76
    v_fma_f32 v90, v86, 4.0, v84
    v_fma_f32 v83, v79, 4.0, v77
    v_fma_f32 v91, v87, 4.0, v85
    v_add_f32 v77, v80, v81
    v_add_f32 v85, v88, v89
    v_sub_f32 v78, v80, v81
    v_sub_f32 v86, v88, v89
    v_fma_f32 v79, v83, 2.0, v82
    v_fma_f32 v87, v91, 2.0, v90
    v_fma_f32 v82, v83, -2.0, v82
    v_fma_f32 v90, v91, -2.0, v90
    v_fmamk_f32 v80, v76, 0x41700000, v82
    v_fmamk_f32 v88, v84, 0x41700000, v90
    v_fmamk_f32 v80, v81, 0x41200000, v80
    v_fmamk_f32 v88, v89, 0x41200000, v88
    v_cvt_pk_bf16_f32 v23, v77, v85
    v_cvt_pk_bf16_f32 v27, v78, v86
    v_cvt_pk_bf16_f32 v67, v79, v87
    v_cvt_pk_bf16_f32 v71, v82, v90
    v_cvt_pk_bf16_f32 v75, v80, v88
    ds_write_b128 v96, v[64:67] offset:57344
    ds_write_b128 v97, v[68:71] offset:8192
    ds_write_b128 v97, v[72:75] offset:24576
    ds_write_b128 v96, v[16:19] offset:8192
    ds_write_b128 v96, v[20:23] offset:24576
    ds_write_b128 v96, v[24:27] offset:40960
    ds_write_b128 v98, v[28:31] offset:8704
    s_add_u32 s28, s28, 1
    s_waitcnt lgkmcnt(0)
    s_barrier
    s_add_u32 s24, s24, 1048576
    s_add_u32 s27, s27, 1048576
    s_waitcnt vmcnt(0)
    v_lshlrev_b32 v76, 16, v32
    v_and_b32 v84, s25, v32
    v_lshlrev_b32 v77, 16, v36
    v_and_b32 v85, s25, v36
    v_lshlrev_b32 v78, 16, v40
    v_and_b32 v86, s25, v40
    v_lshlrev_b32 v79, 16, v44
    v_and_b32 v87, s25, v44
    v_add_f32 v80, v76, v78
    v_add_f32 v88, v84, v86
    v_add_f32 v81, v77, v79
    v_add_f32 v89, v85, v87
    v_fma_f32 v82, v78, 4.0, v76
    v_fma_f32 v90, v86, 4.0, v84
    v_fma_f32 v83, v79, 4.0, v77
    v_fma_f32 v91, v87, 4.0, v85
    v_add_f32 v77, v80, v81
    v_add_f32 v85, v88, v89
    v_sub_f32 v78, v80, v81
    v_sub_f32 v86, v88, v89
    v_fma_f32 v79, v83, 2.0, v82
    v_fma_f32 v87, v91, 2.0, v90
    v_fma_f32 v82, v83, -2.0, v82
    v_fma_f32 v90, v91, -2.0, v90
    v_fmamk_f32 v80, v76, 0x41700000, v82
    v_fmamk_f32 v88, v84, 0x41700000, v90
    v_fmamk_f32 v80, v81, 0x41200000, v80
    v_fmamk_f32 v88, v89, 0x41200000, v88
    v_cvt_pk_bf16_f32 v36, v77, v85
    v_cvt_pk_bf16_f32 v40, v78, v86
    v_cvt_pk_bf16_f32 v64, v79, v87
    v_cvt_pk_bf16_f32 v68, v82, v90
    v_cvt_pk_bf16_f32 v72, v80, v88
    v_lshlrev_b32 v76, 16, v33
    v_and_b32 v84, s25, v33
    v_lshlrev_b32 v77, 16, v37
    v_and_b32 v85, s25, v37
    v_lshlrev_b32 v78, 16, v41
    v_and_b32 v86, s25, v41
    v_lshlrev_b32 v79, 16, v45
    v_and_b32 v87, s25, v45
    v_add_f32 v80, v76, v78
    v_add_f32 v88, v84, v86
    v_add_f32 v81, v77, v79
    v_add_f32 v89, v85, v87
    v_fma_f32 v82, v78, 4.0, v76
    v_fma_f32 v90, v86, 4.0, v84
    v_fma_f32 v83, v79, 4.0, v77
    v_fma_f32 v91, v87, 4.0, v85
    v_add_f32 v77, v80, v81
    v_add_f32 v85, v88, v89
    v_sub_f32 v78, v80, v81
    v_sub_f32 v86, v88, v89
    v_fma_f32 v79, v83, 2.0, v82
    v_fma_f32 v87, v91, 2.0, v90
    v_fma_f32 v82, v83, -2.0, v82
    v_fma_f32 v90, v91, -2.0, v90
    v_fmamk_f32 v80, v76, 0x41700000, v82
    v_fmamk_f32 v88, v84, 0x41700000, v90
    v_fmamk_f32 v80, v81, 0x41200000, v80
    v_fmamk_f32 v88, v89, 0x41200000, v88
    v_cvt_pk_bf16_f32 v37, v77, v85
    v_cvt_pk_bf16_f32 v41, v78, v86
    v_cvt_pk_bf16_f32 v65, v79, v87
    v_cvt_pk_bf16_f32 v69, v82, v90
    v_cvt_pk_bf16_f32 v73, v80, v88
    v_lshlrev_b32 v76, 16, v34
    v_and_b32 v84, s25, v34
    v_lshlrev_b32 v77, 16, v38
    v_and_b32 v85, s25, v38
    v_lshlrev_b32 v78, 16, v42
    v_and_b32 v86, s25, v42
    v_lshlrev_b32 v79, 16, v46
    v_and_b32 v87, s25, v46
    v_add_f32 v80, v76, v78
    v_add_f32 v88, v84, v86
    v_add_f32 v81, v77, v79
    v_add_f32 v89, v85, v87
    v_fma_f32 v82, v78, 4.0, v76
    v_fma_f32 v90, v86, 4.0, v84
    v_fma_f32 v83, v79, 4.0, v77
    v_fma_f32 v91, v87, 4.0, v85
    v_add_f32 v77, v80, v81
    v_add_f32 v85, v88, v89
    v_sub_f32 v78, v80, v81
    v_sub_f32 v86, v88, v89
    v_fma_f32 v79, v83, 2.0, v82
    v_fma_f32 v87, v91, 2.0, v90
    v_fma_f32 v82, v83, -2.0, v82
    v_fma_f32 v90, v91, -2.0, v90
    v_fmamk_f32 v80, v76, 0x41700000, v82
    v_fmamk_f32 v88, v84, 0x41700000, v90
    v_fmamk_f32 v80, v81, 0x41200000, v80
    v_fmamk_f32 v88, v89, 0x41200000, v88
    v_cvt_pk_bf16_f32 v38, v77, v85
    v_cvt_pk_bf16_f32 v42, v78, v86
    v_cvt_pk_bf16_f32 v66, v79, v87
    v_cvt_pk_bf16_f32 v70, v82, v90
    v_cvt_pk_bf16_f32 v74, v80, v88
    v_lshlrev_b32 v76, 16, v35
    v_and_b32 v84, s25, v35
    v_lshlrev_b32 v77, 16, v39
    v_and_b32 v85, s25, v39
    v_lshlrev_b32 v78, 16, v43
    v_and_b32 v86, s25, v43
    v_lshlrev_b32 v79, 16, v47
    v_and_b32 v87, s25, v47
    v_add_f32 v80, v76, v78
    v_add_f32 v88, v84, v86
    v_add_f32 v81, v77, v79
    v_add_f32 v89, v85, v87
    v_fma_f32 v82, v78, 4.0, v76
    v_fma_f32 v90, v86, 4.0, v84
    v_fma_f32 v83, v79, 4.0, v77
    v_fma_f32 v91, v87, 4.0, v85
    v_add_f32 v77, v80, v81
    v_add_f32 v85, v88, v89
    v_sub_f32 v78, v80, v81
    v_sub_f32 v86, v88, v89
    v_fma_f32 v79, v83, 2.0, v82
    v_fma_f32 v87, v91, 2.0, v90
    v_fma_f32 v82, v83, -2.0, v82
    v_fma_f32 v90, v91, -2.0, v90
    v_fmamk_f32 v80, v76, 0x41700000, v82
    v_fmamk_f32 v88, v84, 0x41700000, v90
    v_fmamk_f32 v80, v81, 0x41200000, v80
    v_fmamk_f32 v88, v89, 0x41200000, v88
    v_cvt_pk_bf16_f32 v39, v77, v85
    v_cvt_pk_bf16_f32 v43, v78, v86
    v_cvt_pk_bf16_f32 v67, v79, v87
    v_cvt_pk_bf16_f32 v71, v82, v90
    v_cvt_pk_bf16_f32 v75, v80, v88
    ds_write_b128 v96, v[64:67] offset:49152
    ds_write_b128 v97, v[68:71] offset:0
    ds_write_b128 v97, v[72:75] offset:16384
    ds_write_b128 v96, v[32:35] offset:0
    ds_write_b128 v96, v[36:39] offset:16384
    ds_write_b128 v96, v[40:43] offset:32768
    ds_write_b128 v98, v[44:47] offset:0
    buffer_load_dwordx4 v[0:3], v92, s[8:11], s24 offen
    buffer_load_dwordx4 v[8:11], v94, s[8:11], s24 offen
    buffer_load_dwordx4 v[4:7], v93, s[8:11], s24 offen
    buffer_load_dwordx4 v[12:15], v95, s[8:11], s24 offen
    buffer_load_dwordx4 v[16:19], v92, s[8:11], s27 offen
    buffer_load_dwordx4 v[24:27], v94, s[8:11], s27 offen
    buffer_load_dwordx4 v[20:23], v93, s[8:11], s27 offen
    buffer_load_dwordx4 v[28:31], v95, s[8:11], s27 offen
    s_add_u32 s28, s28, 1
    s_waitcnt lgkmcnt(0)
    s_barrier
    v_lshlrev_b32 v76, 16, v48
    v_and_b32 v84, s25, v48
    v_lshlrev_b32 v77, 16, v52
    v_and_b32 v85, s25, v52
    v_lshlrev_b32 v78, 16, v56
    v_and_b32 v86, s25, v56
    v_lshlrev_b32 v79, 16, v60
    v_and_b32 v87, s25, v60
    v_add_f32 v80, v76, v78
    v_add_f32 v88, v84, v86
    v_add_f32 v81, v77, v79
    v_add_f32 v89, v85, v87
    v_fma_f32 v82, v78, 4.0, v76
    v_fma_f32 v90, v86, 4.0, v84
    v_fma_f32 v83, v79, 4.0, v77
    v_fma_f32 v91, v87, 4.0, v85
    v_add_f32 v77, v80, v81
    v_add_f32 v85, v88, v89
    v_sub_f32 v78, v80, v81
    v_sub_f32 v86, v88, v89
    v_fma_f32 v79, v83, 2.0, v82
    v_fma_f32 v87, v91, 2.0, v90
    v_fma_f32 v82, v83, -2.0, v82
    v_fma_f32 v90, v91, -2.0, v90
    v_fmamk_f32 v80, v76, 0x41700000, v82
    v_fmamk_f32 v88, v84, 0x41700000, v90
    v_fmamk_f32 v80, v81, 0x41200000, v80
    v_fmamk_f32 v88, v89, 0x41200000, v88
    v_cvt_pk_bf16_f32 v52, v77, v85
    v_cvt_pk_bf16_f32 v56, v78, v86
    v_cvt_pk_bf16_f32 v64, v79, v87
    v_cvt_pk_bf16_f32 v68, v82, v90
    v_cvt_pk_bf16_f32 v72, v80, v88
    v_lshlrev_b32 v76, 16, v49
    v_and_b32 v84, s25, v49
    v_lshlrev_b32 v77, 16, v53
    v_and_b32 v85, s25, v53
    v_lshlrev_b32 v78, 16, v57
    v_and_b32 v86, s25, v57
    v_lshlrev_b32 v79, 16, v61
    v_and_b32 v87, s25, v61
    v_add_f32 v80, v76, v78
    v_add_f32 v88, v84, v86
    v_add_f32 v81, v77, v79
    v_add_f32 v89, v85, v87
    v_fma_f32 v82, v78, 4.0, v76
    v_fma_f32 v90, v86, 4.0, v84
    v_fma_f32 v83, v79, 4.0, v77
    v_fma_f32 v91, v87, 4.0, v85
    v_add_f32 v77, v80, v81
    v_add_f32 v85, v88, v89
    v_sub_f32 v78, v80, v81
    v_sub_f32 v86, v88, v89
    v_fma_f32 v79, v83, 2.0, v82
    v_fma_f32 v87, v91, 2.0, v90
    v_fma_f32 v82, v83, -2.0, v82
    v_fma_f32 v90, v91, -2.0, v90
    v_fmamk_f32 v80, v76, 0x41700000, v82
    v_fmamk_f32 v88, v84, 0x41700000, v90
    v_fmamk_f32 v80, v81, 0x41200000, v80
    v_fmamk_f32 v88, v89, 0x41200000, v88
    v_cvt_pk_bf16_f32 v53, v77, v85
    v_cvt_pk_bf16_f32 v57, v78, v86
    v_cvt_pk_bf16_f32 v65, v79, v87
    v_cvt_pk_bf16_f32 v69, v82, v90
    v_cvt_pk_bf16_f32 v73, v80, v88
    v_lshlrev_b32 v76, 16, v50
    v_and_b32 v84, s25, v50
    v_lshlrev_b32 v77, 16, v54
    v_and_b32 v85, s25, v54
    v_lshlrev_b32 v78, 16, v58
    v_and_b32 v86, s25, v58
    v_lshlrev_b32 v79, 16, v62
    v_and_b32 v87, s25, v62
    v_add_f32 v80, v76, v78
    v_add_f32 v88, v84, v86
    v_add_f32 v81, v77, v79
    v_add_f32 v89, v85, v87
    v_fma_f32 v82, v78, 4.0, v76
    v_fma_f32 v90, v86, 4.0, v84
    v_fma_f32 v83, v79, 4.0, v77
    v_fma_f32 v91, v87, 4.0, v85
    v_add_f32 v77, v80, v81
    v_add_f32 v85, v88, v89
    v_sub_f32 v78, v80, v81
    v_sub_f32 v86, v88, v89
    v_fma_f32 v79, v83, 2.0, v82
    v_fma_f32 v87, v91, 2.0, v90
    v_fma_f32 v82, v83, -2.0, v82
    v_fma_f32 v90, v91, -2.0, v90
    v_fmamk_f32 v80, v76, 0x41700000, v82
    v_fmamk_f32 v88, v84, 0x41700000, v90
    v_fmamk_f32 v80, v81, 0x41200000, v80
    v_fmamk_f32 v88, v89, 0x41200000, v88
    v_cvt_pk_bf16_f32 v54, v77, v85
    v_cvt_pk_bf16_f32 v58, v78, v86
    v_cvt_pk_bf16_f32 v66, v79, v87
    v_cvt_pk_bf16_f32 v70, v82, v90
    v_cvt_pk_bf16_f32 v74, v80, v88
    v_lshlrev_b32 v76, 16, v51
    v_and_b32 v84, s25, v51
    v_lshlrev_b32 v77, 16, v55
    v_and_b32 v85, s25, v55
    v_lshlrev_b32 v78, 16, v59
    v_and_b32 v86, s25, v59
    v_lshlrev_b32 v79, 16, v63
    v_and_b32 v87, s25, v63
    v_add_f32 v80, v76, v78
    v_add_f32 v88, v84, v86
    v_add_f32 v81, v77, v79
    v_add_f32 v89, v85, v87
    v_fma_f32 v82, v78, 4.0, v76
    v_fma_f32 v90, v86, 4.0, v84
    v_fma_f32 v83, v79, 4.0, v77
    v_fma_f32 v91, v87, 4.0, v85
    v_add_f32 v77, v80, v81
    v_add_f32 v85, v88, v89
    v_sub_f32 v78, v80, v81
    v_sub_f32 v86, v88, v89
    v_fma_f32 v79, v83, 2.0, v82
    v_fma_f32 v87, v91, 2.0, v90
    v_fma_f32 v82, v83, -2.0, v82
    v_fma_f32 v90, v91, -2.0, v90
    v_fmamk_f32 v80, v76, 0x41700000, v82
    v_fmamk_f32 v88, v84, 0x41700000, v90
    v_fmamk_f32 v80, v81, 0x41200000, v80
    v_fmamk_f32 v88, v89, 0x41200000, v88
    v_cvt_pk_bf16_f32 v55, v77, v85
    v_cvt_pk_bf16_f32 v59, v78, v86
    v_cvt_pk_bf16_f32 v67, v79, v87
    v_cvt_pk_bf16_f32 v71, v82, v90
    v_cvt_pk_bf16_f32 v75, v80, v88
    ds_write_b128 v96, v[64:67] offset:57344
    ds_write_b128 v97, v[68:71] offset:8192
    ds_write_b128 v97, v[72:75] offset:24576
    ds_write_b128 v96, v[48:51] offset:8192
    ds_write_b128 v96, v[52:55] offset:24576
    ds_write_b128 v96, v[56:59] offset:40960
    ds_write_b128 v98, v[60:63] offset:8704
    s_add_u32 s28, s28, 1
    s_waitcnt lgkmcnt(0)
    s_barrier
    s_cmp_eq_u32 s22, 1
    s_cbranch_scc1 L_conv2_kernel_hlast1
    s_add_u32 s24, s24, 1048576
    s_add_u32 s27, s27, 1048576
    s_waitcnt vmcnt(0)
    v_lshlrev_b32 v76, 16, v0
    v_and_b32 v84, s25, v0
    v_lshlrev_b32 v77, 16, v4
    v_and_b32 v85, s25, v4
    v_lshlrev_b32 v78, 16, v8
    v_and_b32 v86, s25, v8
    v_lshlrev_b32 v79, 16, v12
    v_and_b32 v87, s25, v12
    v_add_f32 v80, v76, v78
    v_add_f32 v88, v84, v86
    v_add_f32 v81, v77, v79
    v_add_f32 v89, v85, v87
    v_fma_f32 v82, v78, 4.0, v76
    v_fma_f32 v90, v86, 4.0, v84
    v_fma_f32 v83, v79, 4.0, v77
    v_fma_f32 v91, v87, 4.0, v85
    v_add_f32 v77, v80, v81
    v_add_f32 v85, v88, v89
    v_sub_f32 v78, v80, v81
    v_sub_f32 v86, v88, v89
    v_fma_f32 v79, v83, 2.0, v82
    v_fma_f32 v87, v91, 2.0, v90
    v_fma_f32 v82, v83, -2.0, v82
    v_fma_f32 v90, v91, -2.0, v90
    v_fmamk_f32 v80, v76, 0x41700000, v82
    v_fmamk_f32 v88, v84, 0x41700000, v90
    v_fmamk_f32 v80, v81, 0x41200000, v80
    v_fmamk_f32 v88, v89, 0x41200000, v88
    v_cvt_pk_bf16_f32 v4, v77, v85
    v_cvt_pk_bf16_f32 v8, v78, v86
    v_cvt_pk_bf16_f32 v64, v79, v87
    v_cvt_pk_bf16_f32 v68, v82, v90
    v_cvt_pk_bf16_f32 v72, v80, v88
    v_lshlrev_b32 v76, 16, v1
    v_and_b32 v84, s25, v1
    v_lshlrev_b32 v77, 16, v5
    v_and_b32 v85, s25, v5
    v_lshlrev_b32 v78, 16, v9
    v_and_b32 v86, s25, v9
    v_lshlrev_b32 v79, 16, v13
    v_and_b32 v87, s25, v13
    v_add_f32 v80, v76, v78
    v_add_f32 v88, v84, v86
    v_add_f32 v81, v77, v79
    v_add_f32 v89, v85, v87
    v_fma_f32 v82, v78, 4.0, v76
    v_fma_f32 v90, v86, 4.0, v84
    v_fma_f32 v83, v79, 4.0, v77
    v_fma_f32 v91, v87, 4.0, v85
    v_add_f32 v77, v80, v81
    v_add_f32 v85, v88, v89
    v_sub_f32 v78, v80, v81
    v_sub_f32 v86, v88, v89
    v_fma_f32 v79, v83, 2.0, v82
    v_fma_f32 v87, v91, 2.0, v90
    v_fma_f32 v82, v83, -2.0, v82
    v_fma_f32 v90, v91, -2.0, v90
    v_fmamk_f32 v80, v76, 0x41700000, v82
    v_fmamk_f32 v88, v84, 0x41700000, v90
    v_fmamk_f32 v80, v81, 0x41200000, v80
    v_fmamk_f32 v88, v89, 0x41200000, v88
    v_cvt_pk_bf16_f32 v5, v77, v85
    v_cvt_pk_bf16_f32 v9, v78, v86
    v_cvt_pk_bf16_f32 v65, v79, v87
    v_cvt_pk_bf16_f32 v69, v82, v90
    v_cvt_pk_bf16_f32 v73, v80, v88
    v_lshlrev_b32 v76, 16, v2
    v_and_b32 v84, s25, v2
    v_lshlrev_b32 v77, 16, v6
    v_and_b32 v85, s25, v6
    v_lshlrev_b32 v78, 16, v10
    v_and_b32 v86, s25, v10
    v_lshlrev_b32 v79, 16, v14
    v_and_b32 v87, s25, v14
    v_add_f32 v80, v76, v78
    v_add_f32 v88, v84, v86
    v_add_f32 v81, v77, v79
    v_add_f32 v89, v85, v87
    v_fma_f32 v82, v78, 4.0, v76
    v_fma_f32 v90, v86, 4.0, v84
    v_fma_f32 v83, v79, 4.0, v77
    v_fma_f32 v91, v87, 4.0, v85
    v_add_f32 v77, v80, v81
    v_add_f32 v85, v88, v89
    v_sub_f32 v78, v80, v81
    v_sub_f32 v86, v88, v89
    v_fma_f32 v79, v83, 2.0, v82
    v_fma_f32 v87, v91, 2.0, v90
    v_fma_f32 v82, v83, -2.0, v82
    v_fma_f32 v90, v91, -2.0, v90
    v_fmamk_f32 v80, v76, 0x41700000, v82
    v_fmamk_f32 v88, v84, 0x41700000, v90
    v_fmamk_f32 v80, v81, 0x41200000, v80
    v_fmamk_f32 v88, v89, 0x41200000, v88
    v_cvt_pk_bf16_f32 v6, v77, v85
    v_cvt_pk_bf16_f32 v10, v78, v86
    v_cvt_pk_bf16_f32 v66, v79, v87
    v_cvt_pk_bf16_f32 v70, v82, v90
    v_cvt_pk_bf16_f32 v74, v80, v88
    v_lshlrev_b32 v76, 16, v3
    v_and_b32 v84, s25, v3
    v_lshlrev_b32 v77, 16, v7
    v_and_b32 v85, s25, v7
    v_lshlrev_b32 v78, 16, v11
    v_and_b32 v86, s25, v11
    v_lshlrev_b32 v79, 16, v15
    v_and_b32 v87, s25, v15
    v_add_f32 v80, v76, v78
    v_add_f32 v88, v84, v86
    v_add_f32 v81, v77, v79
    v_add_f32 v89, v85, v87
    v_fma_f32 v82, v78, 4.0, v76
    v_fma_f32 v90, v86, 4.0, v84
    v_fma_f32 v83, v79, 4.0, v77
    v_fma_f32 v91, v87, 4.0, v85
    v_add_f32 v77, v80, v81
    v_add_f32 v85, v88, v89
    v_sub_f32 v78, v80, v81
    v_sub_f32 v86, v88, v89
    v_fma_f32 v79, v83, 2.0, v82
    v_fma_f32 v87, v91, 2.0, v90
    v_fma_f32 v82, v83, -2.0, v82
    v_fma_f32 v90, v91, -2.0, v90
    v_fmamk_f32 v80, v76, 0x41700000, v82
    v_fmamk_f32 v88, v84, 0x41700000, v90
    v_fmamk_f32 v80, v81, 0x41200000, v80
    v_fmamk_f32 v88, v89, 0x41200000, v88
    v_cvt_pk_bf16_f32 v7, v77, v85
    v_cvt_pk_bf16_f32 v11, v78, v86
    v_cvt_pk_bf16_f32 v67, v79, v87
    v_cvt_pk_bf16_f32 v71, v82, v90
    v_cvt_pk_bf16_f32 v75, v80, v88
    ds_write_b128 v96, v[64:67] offset:49152
    ds_write_b128 v97, v[68:71] offset:0
    ds_write_b128 v97, v[72:75] offset:16384
    ds_write_b128 v96, v[0:3] offset:0
    ds_write_b128 v96, v[4:7] offset:16384
    ds_write_b128 v96, v[8:11] offset:32768
    ds_write_b128 v98, v[12:15] offset:0
    buffer_load_dwordx4 v[32:35], v92, s[8:11], s24 offen
    buffer_load_dwordx4 v[40:43], v94, s[8:11], s24 offen
    buffer_load_dwordx4 v[36:39], v93, s[8:11], s24 offen
    buffer_load_dwordx4 v[44:47], v95, s[8:11], s24 offen
    buffer_load_dwordx4 v[48:51], v92, s[8:11], s27 offen
    buffer_load_dwordx4 v[56:59], v94, s[8:11], s27 offen
    buffer_load_dwordx4 v[52:55], v93, s[8:11], s27 offen
    buffer_load_dwordx4 v[60:63], v95, s[8:11], s27 offen
    s_add_u32 s28, s28, 1
    s_waitcnt lgkmcnt(0)
    s_barrier
    s_sub_u32 s22, s22, 1
    s_branch L_conv2_kernel_hloop1
L_conv2_kernel_hlast1:
    s_branch L_conv2_kernel_end
L_conv2_kernel_h2:
    ds_write_b128 v96, v[0:3] offset:0
    ds_write_b128 v98, v[12:15] offset:0
    v_lshlrev_b32 v76, 16, v0
    v_and_b32 v84, s25, v0
    v_lshlrev_b32 v77, 16, v4
    v_and_b32 v85, s25, v4
    v_lshlrev_b32 v78, 16, v8
    v_and_b32 v86, s25, v8
    v_lshlrev_b32 v79, 16, v12
    v_and_b32 v87, s25, v12
    v_add_f32 v80, v76, v78
    v_add_f32 v88, v84, v86
    v_add_f32 v81, v77, v79
    v_add_f32 v89, v85, v87
    v_fma_f32 v82, v78, 4.0, v76
    v_fma_f32 v90, v86, 4.0, v84
    v_fma_f32 v83, v79, 4.0, v77
    v_fma_f32 v91, v87, 4.0, v85
    v_add_f32 v77, v80, v81
    v_add_f32 v85, v88, v89
    v_sub_f32 v78, v80, v81
    v_sub_f32 v86, v88, v89
    v_fma_f32 v79, v83, 2.0, v82
    v_fma_f32 v87, v91, 2.0, v90
    v_fma_f32 v82, v83, -2.0, v82
    v_fma_f32 v90, v91, -2.0, v90
    v_fmamk_f32 v80, v76, 0x41700000, v82
    v_fmamk_f32 v88, v84, 0x41700000, v90
    v_fmamk_f32 v80, v81, 0x41200000, v80
    v_fmamk_f32 v88, v89, 0x41200000, v88
    v_cvt_pk_bf16_f32 v4, v77, v85
    v_cvt_pk_bf16_f32 v8, v78, v86
    v_cvt_pk_bf16_f32 v64, v79, v87
    v_cvt_pk_bf16_f32 v68, v82, v90
    v_cvt_pk_bf16_f32 v72, v80, v88
    v_lshlrev_b32 v76, 16, v1
    v_and_b32 v84, s25, v1
    v_lshlrev_b32 v77, 16, v5
    v_and_b32 v85, s25, v5
    v_lshlrev_b32 v78, 16, v9
    v_and_b32 v86, s25, v9
    v_lshlrev_b32 v79, 16, v13
    v_and_b32 v87, s25, v13
    v_add_f32 v80, v76, v78
    v_add_f32 v88, v84, v86
    v_add_f32 v81, v77, v79
    v_add_f32 v89, v85, v87
    v_fma_f32 v82, v78, 4.0, v76
    v_fma_f32 v90, v86, 4.0, v84
    v_fma_f32 v83, v79, 4.0, v77
    v_fma_f32 v91, v87, 4.0, v85
    v_add_f32 v77, v80, v81
    v_add_f32 v85, v88, v89
    v_sub_f32 v78, v80, v81
    v_sub_f32 v86, v88, v89
    v_fma_f32 v79, v83, 2.0, v82
    v_fma_f32 v87, v91, 2.0, v90
    v_fma_f32 v82, v83, -2.0, v82
    v_fma_f32 v90, v91, -2.0, v90
    v_fmamk_f32 v80, v76, 0x41700000, v82
    v_fmamk_f32 v88, v84, 0x41700000, v90
    v_fmamk_f32 v80, v81, 0x41200000, v80
    v_fmamk_f32 v88, v89, 0x41200000, v88
    v_cvt_pk_bf16_f32 v5, v77, v85
    v_cvt_pk_bf16_f32 v9, v78, v86
    v_cvt_pk_bf16_f32 v65, v79, v87
    v_cvt_pk_bf16_f32 v69, v82, v90
    v_cvt_pk_bf16_f32 v73, v80, v88
    v_lshlrev_b32 v76, 16, v2
    v_and_b32 v84, s25, v2
    v_lshlrev_b32 v77, 16, v6
    v_and_b32 v85, s25, v6
    v_lshlrev_b32 v78, 16, v10
    v_and_b32 v86, s25, v10
    v_lshlrev_b32 v79, 16, v14
    v_and_b32 v87, s25, v14
    v_add_f32 v80, v76, v78
    v_add_f32 v88, v84, v86
    v_add_f32 v81, v77, v79
    v_add_f32 v89, v85, v87
    v_fma_f32 v82, v78, 4.0, v76
    v_fma_f32 v90, v86, 4.0, v84
    v_fma_f32 v83, v79, 4.0, v77
    v_fma_f32 v91, v87, 4.0, v85
    v_add_f32 v77, v80, v81
    v_add_f32 v85, v88, v89
    v_sub_f32 v78, v80, v81
    v_sub_f32 v86, v88, v89
    v_fma_f32 v79, v83, 2.0, v82
    v_fma_f32 v87, v91, 2.0, v90
    v_fma_f32 v82, v83, -2.0, v82
    v_fma_f32 v90, v91, -2.0, v90
    v_fmamk_f32 v80, v76, 0x41700000, v82
    v_fmamk_f32 v88, v84, 0x41700000, v90
    v_fmamk_f32 v80, v81, 0x41200000, v80
    v_fmamk_f32 v88, v89, 0x41200000, v88
    v_cvt_pk_bf16_f32 v6, v77, v85
    v_cvt_pk_bf16_f32 v10, v78, v86
    v_cvt_pk_bf16_f32 v66, v79, v87
    v_cvt_pk_bf16_f32 v70, v82, v90
    v_cvt_pk_bf16_f32 v74, v80, v88
    v_lshlrev_b32 v76, 16, v3
    v_and_b32 v84, s25, v3
    v_lshlrev_b32 v77, 16, v7
    v_and_b32 v85, s25, v7
    v_lshlrev_b32 v78, 16, v11
    v_and_b32 v86, s25, v11
    v_lshlrev_b32 v79, 16, v15
    v_and_b32 v87, s25, v15
    v_add_f32 v80, v76, v78
    v_add_f32 v88, v84, v86
    v_add_f32 v81, v77, v79
    v_add_f32 v89, v85, v87
    v_fma_f32 v82, v78, 4.0, v76
    v_fma_f32 v90, v86, 4.0, v84
    v_fma_f32 v83, v79, 4.0, v77
    v_fma_f32 v91, v87, 4.0, v85
    v_add_f32 v77, v80, v81
    v_add_f32 v85, v88, v89
    v_sub_f32 v78, v80, v81
    v_sub_f32 v86, v88, v89
    v_fma_f32 v79, v83, 2.0, v82
    v_fma_f32 v87, v91, 2.0, v90
    v_fma_f32 v82, v83, -2.0, v82
    v_fma_f32 v90, v91, -2.0, v90
    v_fmamk_f32 v80, v76, 0x41700000, v82
    v_fmamk_f32 v88, v84, 0x41700000, v90
    v_fmamk_f32 v80, v81, 0x41200000, v80
    v_fmamk_f32 v88, v89, 0x41200000, v88
    v_cvt_pk_bf16_f32 v7, v77, v85
    v_cvt_pk_bf16_f32 v11, v78, v86
    v_cvt_pk_bf16_f32 v67, v79, v87
    v_cvt_pk_bf16_f32 v71, v82, v90
    v_cvt_pk_bf16_f32 v75, v80, v88
    ds_write_b128 v96, v[64:67] offset:49152
    ds_write_b128 v97, v[68:71] offset:0
    ds_write_b128 v97, v[72:75] offset:16384
    ds_write_b128 v96, v[4:7] offset:16384
    ds_write_b128 v96, v[8:11] offset:32768
    s_waitcnt vmcnt(0)
    s_mov_b32 s24, 1048576
    s_mov_b32 s27, 1572864
    s_waitcnt lgkmcnt(0)
    s_barrier
    buffer_load_dwordx4 v[32:35], v92, s[8:11], s24 offen
    buffer_load_dwordx4 v[40:43], v94, s[8:11], s24 offen
    buffer_load_dwordx4 v[36:39], v93, s[8:11], s24 offen
    buffer_load_dwordx4 v[44:47], v95, s[8:11], s24 offen
    buffer_load_dwordx4 v[48:51], v92, s[8:11], s27 offen
    buffer_load_dwordx4 v[56:59], v94, s[8:11], s27 offen
    buffer_load_dwordx4 v[52:55], v93, s[8:11], s27 offen
    buffer_load_dwordx4 v[60:63], v95, s[8:11], s27 offen
    s_setprio 0
    v_lshlrev_b32 v76, 16, v16
    v_and_b32 v84, s25, v16
    v_lshlrev_b32 v77, 16, v20
    v_and_b32 v85, s25, v20
    v_lshlrev_b32 v78, 16, v24
    v_and_b32 v86, s25, v24
    v_lshlrev_b32 v79, 16, v28
    v_and_b32 v87, s25, v28
    v_add_f32 v80, v76, v78
    v_add_f32 v88, v84, v86
    v_add_f32 v81, v77, v79
    v_add_f32 v89, v85, v87
    v_fma_f32 v82, v78, 4.0, v76
    v_fma_f32 v90, v86, 4.0, v84
    v_fma_f32 v83, v79, 4.0, v77
    v_fma_f32 v91, v87, 4.0, v85
    v_add_f32 v77, v80, v81
    v_add_f32 v85, v88, v89
    v_sub_f32 v78, v80, v81
    v_sub_f32 v86, v88, v89
    v_fma_f32 v79, v83, 2.0, v82
    v_fma_f32 v87, v91, 2.0, v90
    v_fma_f32 v82, v83, -2.0, v82
    v_fma_f32 v90, v91, -2.0, v90
    v_fmamk_f32 v80, v76, 0x41700000, v82
    v_fmamk_f32 v88, v84, 0x41700000, v90
    v_fmamk_f32 v80, v81, 0x41200000, v80
    v_fmamk_f32 v88, v89, 0x41200000, v88
    v_cvt_pk_bf16_f32 v20, v77, v85
    v_cvt_pk_bf16_f32 v24, v78, v86
    v_cvt_pk_bf16_f32 v64, v79, v87
    v_cvt_pk_bf16_f32 v68, v82, v90
    v_cvt_pk_bf16_f32 v72, v80, v88
    v_lshlrev_b32 v76, 16, v17
    v_and_b32 v84, s25, v17
    v_lshlrev_b32 v77, 16, v21
    v_and_b32 v85, s25, v21
    v_lshlrev_b32 v78, 16, v25
    v_and_b32 v86, s25, v25
    v_lshlrev_b32 v79, 16, v29
    v_and_b32 v87, s25, v29
    v_add_f32 v80, v76, v78
    v_add_f32 v88, v84, v86
    v_add_f32 v81, v77, v79
    v_add_f32 v89, v85, v87
    v_fma_f32 v82, v78, 4.0, v76
    v_fma_f32 v90, v86, 4.0, v84
    v_fma_f32 v83, v79, 4.0, v77
    v_fma_f32 v91, v87, 4.0, v85
    v_add_f32 v77, v80, v81
    v_add_f32 v85, v88, v89
    v_sub_f32 v78, v80, v81
    v_sub_f32 v86, v88, v89
    v_fma_f32 v79, v83, 2.0, v82
    v_fma_f32 v87, v91, 2.0, v90
    v_fma_f32 v82, v83, -2.0, v82
    v_fma_f32 v90, v91, -2.0, v90
    v_fmamk_f32 v80, v76, 0x41700000, v82
    v_fmamk_f32 v88, v84, 0x41700000, v90
    v_fmamk_f32 v80, v81, 0x41200000, v80
    v_fmamk_f32 v88, v89, 0x41200000, v88
    v_cvt_pk_bf16_f32 v21, v77, v85
    v_cvt_pk_bf16_f32 v25, v78, v86
    v_cvt_pk_bf16_f32 v65, v79, v87
    v_cvt_pk_bf16_f32 v69, v82, v90
    v_cvt_pk_bf16_f32 v73, v80, v88
    v_lshlrev_b32 v76, 16, v18
    v_and_b32 v84, s25, v18
    v_lshlrev_b32 v77, 16, v22
    v_and_b32 v85, s25, v22
    v_lshlrev_b32 v78, 16, v26
    v_and_b32 v86, s25, v26
    v_lshlrev_b32 v79, 16, v30
    v_and_b32 v87, s25, v30
    v_add_f32 v80, v76, v78
    v_add_f32 v88, v84, v86
    v_add_f32 v81, v77, v79
    v_add_f32 v89, v85, v87
    v_fma_f32 v82, v78, 4.0, v76
    v_fma_f32 v90, v86, 4.0, v84
    v_fma_f32 v83, v79, 4.0, v77
    v_fma_f32 v91, v87, 4.0, v85
    v_add_f32 v77, v80, v81
    v_add_f32 v85, v88, v89
    v_sub_f32 v78, v80, v81
    v_sub_f32 v86, v88, v89
    v_fma_f32 v79, v83, 2.0, v82
    v_fma_f32 v87, v91, 2.0, v90
    v_fma_f32 v82, v83, -2.0, v82
    v_fma_f32 v90, v91, -2.0, v90
    v_fmamk_f32 v80, v76, 0x41700000, v82
    v_fmamk_f32 v88, v84, 0x41700000, v90
    v_fmamk_f32 v80, v81, 0x41200000, v80
    v_fmamk_f32 v88, v89, 0x41200000, v88
    v_cvt_pk_bf16_f32 v22, v77, v85
    v_cvt_pk_bf16_f32 v26, v78, v86
    v_cvt_pk_bf16_f32 v66, v79, v87
    v_cvt_pk_bf16_f32 v70, v82, v90
    v_cvt_pk_bf16_f32 v74, v80, v88
    v_lshlrev_b32 v76, 16, v19
    v_and_b32 v84, s25, v19
    v_lshlrev_b32 v77, 16, v23
    v_and_b32 v85, s25, v23
    v_lshlrev_b32 v78, 16, v27
    v_and_b32 v86, s25, v27
    v_lshlrev_b32 v79, 16, v31
    v_and_b32 v87, s25, v31
    v_add_f32 v80, v76, v78
    v_add_f32 v88, v84, v86
    v_add_f32 v81, v77, v79
    v_add_f32 v89, v85, v87
    v_fma_f32 v82, v78, 4.0, v76
    v_fma_f32 v90, v86, 4.0, v84
    v_fma_f32 v83, v79, 4.0, v77
    v_fma_f32 v91, v87, 4.0, v85
    v_add_f32 v77, v80, v81
    v_add_f32 v85, v88, v89
    v_sub_f32 v78, v80, v81
    v_sub_f32 v86, v88, v89
    v_fma_f32 v79, v83, 2.0, v82
    v_fma_f32 v87, v91, 2.0, v90
    v_fma_f32 v82, v83, -2.0, v82
    v_fma_f32 v90, v91, -2.0, v90
    v_fmamk_f32 v80, v76, 0x41700000, v82
    v_fmamk_f32 v88, v84, 0x41700000, v90
    v_fmamk_f32 v80, v81, 0x41200000, v80
    v_fmamk_f32 v88, v89, 0x41200000, v88
    v_cvt_pk_bf16_f32 v23, v77, v85
    v_cvt_pk_bf16_f32 v27, v78, v86
    v_cvt_pk_bf16_f32 v67, v79, v87
    v_cvt_pk_bf16_f32 v71, v82, v90
    v_cvt_pk_bf16_f32 v75, v80, v88
L_conv2_kernel_hloop2:
    s_add_u32 s24, s24, 1048576
    s_add_u32 s27, s27, 1048576
    ds_write_b128 v96, v[64:67] offset:57344
    ds_write_b128 v97, v[68:71] offset:8192
    ds_write_b128 v97, v[72:75] offset:24576
    ds_write_b128 v96, v[16:19] offset:8192
    ds_write_b128 v96, v[20:23] offset:24576
    ds_write_b128 v96, v[24:27] offset:40960
    ds_write_b128 v98, v[28:31] offset:8704
    s_waitcnt vmcnt(0)
    buffer_load_dwordx4 v[0:3], v92, s[8:11], s24 offen
    buffer_load_dwordx4 v[8:11], v94, s[8:11], s24 offen
    buffer_load_dwordx4 v[4:7], v93, s[8:11], s24 offen
    buffer_load_dwordx4 v[12:15], v95, s[8:11], s24 offen
    buffer_load_dwordx4 v[16:19], v92, s[8:11], s27 offen
    buffer_load_dwordx4 v[24:27], v94, s[8:11], s27 offen
    buffer_load_dwordx4 v[20:23], v93, s[8:11], s27 offen
    buffer_load_dwordx4 v[28:31], v95, s[8:11], s27 offen
    v_lshlrev_b32 v76, 16, v32
    v_and_b32 v84, s25, v32
    v_lshlrev_b32 v77, 16, v36
    v_and_b32 v85, s25, v36
    v_lshlrev_b32 v78, 16, v40
    v_and_b32 v86, s25, v40
    v_lshlrev_b32 v79, 16, v44
    v_and_b32 v87, s25, v44
    v_add_f32 v80, v76, v78
    v_add_f32 v88, v84, v86
    v_add_f32 v81, v77, v79
    v_add_f32 v89, v85, v87
    v_fma_f32 v82, v78, 4.0, v76
    v_fma_f32 v90, v86, 4.0, v84
    v_fma_f32 v83, v79, 4.0, v77
    v_fma_f32 v91, v87, 4.0, v85
    v_add_f32 v77, v80, v81
    v_add_f32 v85, v88, v89
    v_sub_f32 v78, v80, v81
    v_sub_f32 v86, v88, v89
    v_fma_f32 v79, v83, 2.0, v82
    v_fma_f32 v87, v91, 2.0, v90
    v_fma_f32 v82, v83, -2.0, v82
    v_fma_f32 v90, v91, -2.0, v90
    v_fmamk_f32 v80, v76, 0x41700000, v82
    v_fmamk_f32 v88, v84, 0x41700000, v90
    v_fmamk_f32 v80, v81, 0x41200000, v80
    v_fmamk_f32 v88, v89, 0x41200000, v88
    v_cvt_pk_bf16_f32 v36, v77, v85
    v_cvt_pk_bf16_f32 v40, v78, v86
    v_cvt_pk_bf16_f32 v64, v79, v87
    v_cvt_pk_bf16_f32 v68, v82, v90
    v_cvt_pk_bf16_f32 v72, v80, v88
    v_lshlrev_b32 v76, 16, v33
    v_and_b32 v84, s25, v33
    v_lshlrev_b32 v77, 16, v37
    v_and_b32 v85, s25, v37
    v_lshlrev_b32 v78, 16, v41
    v_and_b32 v86, s25, v41
    v_lshlrev_b32 v79, 16, v45
    v_and_b32 v87, s25, v45
    v_add_f32 v80, v76, v78
    v_add_f32 v88, v84, v86
    v_add_f32 v81, v77, v79
    v_add_f32 v89, v85, v87
    v_fma_f32 v82, v78, 4.0, v76
    v_fma_f32 v90, v86, 4.0, v84
    v_fma_f32 v83, v79, 4.0, v77
    v_fma_f32 v91, v87, 4.0, v85
    v_add_f32 v77, v80, v81
    v_add_f32 v85, v88, v89
    v_sub_f32 v78, v80, v81
    v_sub_f32 v86, v88, v89
    v_fma_f32 v79, v83, 2.0, v82
    v_fma_f32 v87, v91, 2.0, v90
    v_fma_f32 v82, v83, -2.0, v82
    v_fma_f32 v90, v91, -2.0, v90
    v_fmamk_f32 v80, v76, 0x41700000, v82
    v_fmamk_f32 v88, v84, 0x41700000, v90
    v_fmamk_f32 v80, v81, 0x41200000, v80
    v_fmamk_f32 v88, v89, 0x41200000, v88
    v_cvt_pk_bf16_f32 v37, v77, v85
    v_cvt_pk_bf16_f32 v41, v78, v86
    v_cvt_pk_bf16_f32 v65, v79, v87
    v_cvt_pk_bf16_f32 v69, v82, v90
    v_cvt_pk_bf16_f32 v73, v80, v88
    v_lshlrev_b32 v76, 16, v34
    v_and_b32 v84, s25, v34
    v_lshlrev_b32 v77, 16, v38
    v_and_b32 v85, s25, v38
    v_lshlrev_b32 v78, 16, v42
    v_and_b32 v86, s25, v42
    v_lshlrev_b32 v79, 16, v46
    v_and_b32 v87, s25, v46
    v_add_f32 v80, v76, v78
    v_add_f32 v88, v84, v86
    v_add_f32 v81, v77, v79
    v_add_f32 v89, v85, v87
    v_fma_f32 v82, v78, 4.0, v76
    v_fma_f32 v90, v86, 4.0, v84
    v_fma_f32 v83, v79, 4.0, v77
    v_fma_f32 v91, v87, 4.0, v85
    v_add_f32 v77, v80, v81
    v_add_f32 v85, v88, v89
    v_sub_f32 v78, v80, v81
    v_sub_f32 v86, v88, v89
    v_fma_f32 v79, v83, 2.0, v82
    v_fma_f32 v87, v91, 2.0, v90
    v_fma_f32 v82, v83, -2.0, v82
    v_fma_f32 v90, v91, -2.0, v90
    v_fmamk_f32 v80, v76, 0x41700000, v82
    v_fmamk_f32 v88, v84, 0x41700000, v90
    v_fmamk_f32 v80, v81, 0x41200000, v80
    v_fmamk_f32 v88, v89, 0x41200000, v88
    v_cvt_pk_bf16_f32 v38, v77, v85
    v_cvt_pk_bf16_f32 v42, v78, v86
    v_cvt_pk_bf16_f32 v66, v79, v87
    v_cvt_pk_bf16_f32 v70, v82, v90
    v_cvt_pk_bf16_f32 v74, v80, v88
    v_lshlrev_b32 v76, 16, v35
    v_and_b32 v84, s25, v35
    v_lshlrev_b32 v77, 16, v39
    v_and_b32 v85, s25, v39
    v_lshlrev_b32 v78, 16, v43
    v_and_b32 v86, s25, v43
    v_lshlrev_b32 v79, 16, v47
    v_and_b32 v87, s25, v47
    v_add_f32 v80, v76, v78
    v_add_f32 v88, v84, v86
    v_add_f32 v81, v77, v79
    v_add_f32 v89, v85, v87
    v_fma_f32 v82, v78, 4.0, v76
    v_fma_f32 v90, v86, 4.0, v84
    v_fma_f32 v83, v79, 4.0, v77
    v_fma_f32 v91, v87, 4.0, v85
    v_add_f32 v77, v80, v81
    v_add_f32 v85, v88, v89
    v_sub_f32 v78, v80, v81
    v_sub_f32 v86, v88, v89
    v_fma_f32 v79, v83, 2.0, v82
    v_fma_f32 v87, v91, 2.0, v90
    v_fma_f32 v82, v83, -2.0, v82
    v_fma_f32 v90, v91, -2.0, v90
    v_fmamk_f32 v80, v76, 0x41700000, v82
    v_fmamk_f32 v88, v84, 0x41700000, v90
    v_fmamk_f32 v80, v81, 0x41200000, v80
    v_fmamk_f32 v88, v89, 0x41200000, v88
    v_cvt_pk_bf16_f32 v39, v77, v85
    v_cvt_pk_bf16_f32 v43, v78, v86
    v_cvt_pk_bf16_f32 v67, v79, v87
    v_cvt_pk_bf16_f32 v71, v82, v90
    v_cvt_pk_bf16_f32 v75, v80, v88
    s_add_u32 s28, s28, 1
    s_waitcnt lgkmcnt(0)
    s_barrier
    ds_write_b128 v96, v[64:67] offset:49152
    ds_write_b128 v97, v[68:71] offset:0
    ds_write_b128 v97, v[72:75] offset:16384
    ds_write_b128 v96, v[32:35] offset:0
    ds_write_b128 v96, v[36:39] offset:16384
    ds_write_b128 v96, v[40:43] offset:32768
    ds_write_b128 v98, v[44:47] offset:0
    v_lshlrev_b32 v76, 16, v48
    v_and_b32 v84, s25, v48
    v_lshlrev_b32 v77, 16, v52
    v_and_b32 v85, s25, v52
    v_lshlrev_b32 v78, 16, v56
    v_and_b32 v86, s25, v56
    v_lshlrev_b32 v79, 16, v60
    v_and_b32 v87, s25, v60
    v_add_f32 v80, v76, v78
    v_add_f32 v88, v84, v86
    v_add_f32 v81, v77, v79
    v_add_f32 v89, v85, v87
    v_fma_f32 v82, v78, 4.0, v76
    v_fma_f32 v90, v86, 4.0, v84
    v_fma_f32 v83, v79, 4.0, v77
    v_fma_f32 v91, v87, 4.0, v85
    v_add_f32 v77, v80, v81
    v_add_f32 v85, v88, v89
    v_sub_f32 v78, v80, v81
    v_sub_f32 v86, v88, v89
    v_fma_f32 v79, v83, 2.0, v82
    v_fma_f32 v87, v91, 2.0, v90
    v_fma_f32 v82, v83, -2.0, v82
    v_fma_f32 v90, v91, -2.0, v90
    v_fmamk_f32 v80, v76, 0x41700000, v82
    v_fmamk_f32 v88, v84, 0x41700000, v90
    v_fmamk_f32 v80, v81, 0x41200000, v80
    v_fmamk_f32 v88, v89, 0x41200000, v88
    v_cvt_pk_bf16_f32 v52, v77, v85
    v_cvt_pk_bf16_f32 v56, v78, v86
    v_cvt_pk_bf16_f32 v64, v79, v87
    v_cvt_pk_bf16_f32 v68, v82, v90
    v_cvt_pk_bf16_f32 v72, v80, v88
    v_lshlrev_b32 v76, 16, v49
    v_and_b32 v84, s25, v49
    v_lshlrev_b32 v77, 16, v53
    v_and_b32 v85, s25, v53
    v_lshlrev_b32 v78, 16, v57
    v_and_b32 v86, s25, v57
    v_lshlrev_b32 v79, 16, v61
    v_and_b32 v87, s25, v61
    v_add_f32 v80, v76, v78
    v_add_f32 v88, v84, v86
    v_add_f32 v81, v77, v79
    v_add_f32 v89, v85, v87
    v_fma_f32 v82, v78, 4.0, v76
    v_fma_f32 v90, v86, 4.0, v84
    v_fma_f32 v83, v79, 4.0, v77
    v_fma_f32 v91, v87, 4.0, v85
    v_add_f32 v77, v80, v81
    v_add_f32 v85, v88, v89
    v_sub_f32 v78, v80, v81
    v_sub_f32 v86, v88, v89
    v_fma_f32 v79, v83, 2.0, v82
    v_fma_f32 v87, v91, 2.0, v90
    v_fma_f32 v82, v83, -2.0, v82
    v_fma_f32 v90, v91, -2.0, v90
    v_fmamk_f32 v80, v76, 0x41700000, v82
    v_fmamk_f32 v88, v84, 0x41700000, v90
    v_fmamk_f32 v80, v81, 0x41200000, v80
    v_fmamk_f32 v88, v89, 0x41200000, v88
    v_cvt_pk_bf16_f32 v53, v77, v85
    v_cvt_pk_bf16_f32 v57, v78, v86
    v_cvt_pk_bf16_f32 v65, v79, v87
    v_cvt_pk_bf16_f32 v69, v82, v90
    v_cvt_pk_bf16_f32 v73, v80, v88
    v_lshlrev_b32 v76, 16, v50
    v_and_b32 v84, s25, v50
    v_lshlrev_b32 v77, 16, v54
    v_and_b32 v85, s25, v54
    v_lshlrev_b32 v78, 16, v58
    v_and_b32 v86, s25, v58
    v_lshlrev_b32 v79, 16, v62
    v_and_b32 v87, s25, v62
    v_add_f32 v80, v76, v78
    v_add_f32 v88, v84, v86
    v_add_f32 v81, v77, v79
    v_add_f32 v89, v85, v87
    v_fma_f32 v82, v78, 4.0, v76
    v_fma_f32 v90, v86, 4.0, v84
    v_fma_f32 v83, v79, 4.0, v77
    v_fma_f32 v91, v87, 4.0, v85
    v_add_f32 v77, v80, v81
    v_add_f32 v85, v88, v89
    v_sub_f32 v78, v80, v81
    v_sub_f32 v86, v88, v89
    v_fma_f32 v79, v83, 2.0, v82
    v_fma_f32 v87, v91, 2.0, v90
    v_fma_f32 v82, v83, -2.0, v82
    v_fma_f32 v90, v91, -2.0, v90
    v_fmamk_f32 v80, v76, 0x41700000, v82
    v_fmamk_f32 v88, v84, 0x41700000, v90
    v_fmamk_f32 v80, v81, 0x41200000, v80
    v_fmamk_f32 v88, v89, 0x41200000, v88
    v_cvt_pk_bf16_f32 v54, v77, v85
    v_cvt_pk_bf16_f32 v58, v78, v86
    v_cvt_pk_bf16_f32 v66, v79, v87
    v_cvt_pk_bf16_f32 v70, v82, v90
    v_cvt_pk_bf16_f32 v74, v80, v88
    v_lshlrev_b32 v76, 16, v51
    v_and_b32 v84, s25, v51
    v_lshlrev_b32 v77, 16, v55
    v_and_b32 v85, s25, v55
    v_lshlrev_b32 v78, 16, v59
    v_and_b32 v86, s25, v59
    v_lshlrev_b32 v79, 16, v63
    v_and_b32 v87, s25, v63
    v_add_f32 v80, v76, v78
    v_add_f32 v88, v84, v86
    v_add_f32 v81, v77, v79
    v_add_f32 v89, v85, v87
    v_fma_f32 v82, v78, 4.0, v76
    v_fma_f32 v90, v86, 4.0, v84
    v_fma_f32 v83, v79, 4.0, v77
    v_fma_f32 v91, v87, 4.0, v85
    v_add_f32 v77, v80, v81
    v_add_f32 v85, v88, v89
    v_sub_f32 v78, v80, v81
    v_sub_f32 v86, v88, v89
    v_fma_f32 v79, v83, 2.0, v82
    v_fma_f32 v87, v91, 2.0, v90
    v_fma_f32 v82, v83, -2.0, v82
    v_fma_f32 v90, v91, -2.0, v90
    v_fmamk_f32 v80, v76, 0x41700000, v82
    v_fmamk_f32 v88, v84, 0x41700000, v90
    v_fmamk_f32 v80, v81, 0x41200000, v80
    v_fmamk_f32 v88, v89, 0x41200000, v88
    v_cvt_pk_bf16_f32 v55, v77, v85
    v_cvt_pk_bf16_f32 v59, v78, v86
    v_cvt_pk_bf16_f32 v67, v79, v87
    v_cvt_pk_bf16_f32 v71, v82, v90
    v_cvt_pk_bf16_f32 v75, v80, v88
    s_add_u32 s28, s28, 1
    s_waitcnt lgkmcnt(0)
    s_barrier
    s_cmp_eq_u32 s22, 1
    s_cbranch_scc1 L_conv2_kernel_hlast2
    s_add_u32 s24, s24, 1048576
    s_add_u32 s27, s27, 1048576
    ds_write_b128 v96, v[64:67] offset:57344
    ds_write_b128 v97, v[68:71] offset:8192
    ds_write_b128 v97, v[72:75] offset:24576
    ds_write_b128 v96, v[48:51] offset:8192
    ds_write_b128 v96, v[52:55] offset:24576
    ds_write_b128 v96, v[56:59] offset:40960
    ds_write_b128 v98, v[60:63] offset:8704
    s_waitcnt vmcnt(0)
    buffer_load_dwordx4 v[32:35], v92, s[8:11], s24 offen
    buffer_load_dwordx4 v[40:43], v94, s[8:11], s24 offen
    buffer_load_dwordx4 v[36:39], v93, s[8:11], s24 offen
    buffer_load_dwordx4 v[44:47], v95, s[8:11], s24 offen
    buffer_load_dwordx4 v[48:51], v92, s[8:11], s27 offen
    buffer_load_dwordx4 v[56:59], v94, s[8:11], s27 offen
    buffer_load_dwordx4 v[52:55], v93, s[8:11], s27 offen
    buffer_load_dwordx4 v[60:63], v95, s[8:11], s27 offen
    v_lshlrev_b32 v76, 16, v0
    v_and_b32 v84, s25, v0
    v_lshlrev_b32 v77, 16, v4
    v_and_b32 v85, s25, v4
    v_lshlrev_b32 v78, 16, v8
    v_and_b32 v86, s25, v8
    v_lshlrev_b32 v79, 16, v12
    v_and_b32 v87, s25, v12
    v_add_f32 v80, v76, v78
    v_add_f32 v88, v84, v86
    v_add_f32 v81, v77, v79
    v_add_f32 v89, v85, v87
    v_fma_f32 v82, v78, 4.0, v76
    v_fma_f32 v90, v86, 4.0, v84
    v_fma_f32 v83, v79, 4.0, v77
    v_fma_f32 v91, v87, 4.0, v85
    v_add_f32 v77, v80, v81
    v_add_f32 v85, v88, v89
    v_sub_f32 v78, v80, v81
    v_sub_f32 v86, v88, v89
    v_fma_f32 v79, v83, 2.0, v82
    v_fma_f32 v87, v91, 2.0, v90
    v_fma_f32 v82, v83, -2.0, v82
    v_fma_f32 v90, v91, -2.0, v90
    v_fmamk_f32 v80, v76, 0x41700000, v82
    v_fmamk_f32 v88, v84, 0x41700000, v90
    v_fmamk_f32 v80, v81, 0x41200000, v80
    v_fmamk_f32 v88, v89, 0x41200000, v88
    v_cvt_pk_bf16_f32 v4, v77, v85
    v_cvt_pk_bf16_f32 v8, v78, v86
    v_cvt_pk_bf16_f32 v64, v79, v87
    v_cvt_pk_bf16_f32 v68, v82, v90
    v_cvt_pk_bf16_f32 v72, v80, v88
    v_lshlrev_b32 v76, 16, v1
    v_and_b32 v84, s25, v1
    v_lshlrev_b32 v77, 16, v5
    v_and_b32 v85, s25, v5
    v_lshlrev_b32 v78, 16, v9
    v_and_b32 v86, s25, v9
    v_lshlrev_b32 v79, 16, v13
    v_and_b32 v87, s25, v13
    v_add_f32 v80, v76, v78
    v_add_f32 v88, v84, v86
    v_add_f32 v81, v77, v79
    v_add_f32 v89, v85, v87
    v_fma_f32 v82, v78, 4.0, v76
    v_fma_f32 v90, v86, 4.0, v84
    v_fma_f32 v83, v79, 4.0, v77
    v_fma_f32 v91, v87, 4.0, v85
    v_add_f32 v77, v80, v81
    v_add_f32 v85, v88, v89
    v_sub_f32 v78, v80, v81
    v_sub_f32 v86, v88, v89
    v_fma_f32 v79, v83, 2.0, v82
    v_fma_f32 v87, v91, 2.0, v90
    v_fma_f32 v82, v83, -2.0, v82
    v_fma_f32 v90, v91, -2.0, v90
    v_fmamk_f32 v80, v76, 0x41700000, v82
    v_fmamk_f32 v88, v84, 0x41700000, v90
    v_fmamk_f32 v80, v81, 0x41200000, v80
    v_fmamk_f32 v88, v89, 0x41200000, v88
    v_cvt_pk_bf16_f32 v5, v77, v85
    v_cvt_pk_bf16_f32 v9, v78, v86
    v_cvt_pk_bf16_f32 v65, v79, v87
    v_cvt_pk_bf16_f32 v69, v82, v90
    v_cvt_pk_bf16_f32 v73, v80, v88
    v_lshlrev_b32 v76, 16, v2
    v_and_b32 v84, s25, v2
    v_lshlrev_b32 v77, 16, v6
    v_and_b32 v85, s25, v6
    v_lshlrev_b32 v78, 16, v10
    v_and_b32 v86, s25, v10
    v_lshlrev_b32 v79, 16, v14
    v_and_b32 v87, s25, v14
    v_add_f32 v80, v76, v78
    v_add_f32 v88, v84, v86
    v_add_f32 v81, v77, v79
    v_add_f32 v89, v85, v87
    v_fma_f32 v82, v78, 4.0, v76
    v_fma_f32 v90, v86, 4.0, v84
    v_fma_f32 v83, v79, 4.0, v77
    v_fma_f32 v91, v87, 4.0, v85
    v_add_f32 v77, v80, v81
    v_add_f32 v85, v88, v89
    v_sub_f32 v78, v80, v81
    v_sub_f32 v86, v88, v89
    v_fma_f32 v79, v83, 2.0, v82
    v_fma_f32 v87, v91, 2.0, v90
    v_fma_f32 v82, v83, -2.0, v82
    v_fma_f32 v90, v91, -2.0, v90
    v_fmamk_f32 v80, v76, 0x41700000, v82
    v_fmamk_f32 v88, v84, 0x41700000, v90
    v_fmamk_f32 v80, v81, 0x41200000, v80
    v_fmamk_f32 v88, v89, 0x41200000, v88
    v_cvt_pk_bf16_f32 v6, v77, v85
    v_cvt_pk_bf16_f32 v10, v78, v86
    v_cvt_pk_bf16_f32 v66, v79, v87
    v_cvt_pk_bf16_f32 v70, v82, v90
    v_cvt_pk_bf16_f32 v74, v80, v88
    v_lshlrev_b32 v76, 16, v3
    v_and_b32 v84, s25, v3
    v_lshlrev_b32 v77, 16, v7
    v_and_b32 v85, s25, v7
    v_lshlrev_b32 v78, 16, v11
    v_and_b32 v86, s25, v11
    v_lshlrev_b32 v79, 16, v15
    v_and_b32 v87, s25, v15
    v_add_f32 v80, v76, v78
    v_add_f32 v88, v84, v86
    v_add_f32 v81, v77, v79
    v_add_f32 v89, v85, v87
    v_fma_f32 v82, v78, 4.0, v76
    v_fma_f32 v90, v86, 4.0, v84
    v_fma_f32 v83, v79, 4.0, v77
    v_fma_f32 v91, v87, 4.0, v85
    v_add_f32 v77, v80, v81
    v_add_f32 v85, v88, v89
    v_sub_f32 v78, v80, v81
    v_sub_f32 v86, v88, v89
    v_fma_f32 v79, v83, 2.0, v82
    v_fma_f32 v87, v91, 2.0, v90
    v_fma_f32 v82, v83, -2.0, v82
    v_fma_f32 v90, v91, -2.0, v90
    v_fmamk_f32 v80, v76, 0x41700000, v82
    v_fmamk_f32 v88, v84, 0x41700000, v90
    v_fmamk_f32 v80, v81, 0x41200000, v80
    v_fmamk_f32 v88, v89, 0x41200000, v88
    v_cvt_pk_bf16_f32 v7, v77, v85
    v_cvt_pk_bf16_f32 v11, v78, v86
    v_cvt_pk_bf16_f32 v67, v79, v87
    v_cvt_pk_bf16_f32 v71, v82, v90
    v_cvt_pk_bf16_f32 v75, v80, v88
    s_add_u32 s28, s28, 1
    s_waitcnt lgkmcnt(0)
    s_barrier
    ds_write_b128 v96, v[64:67] offset:49152
    ds_write_b128 v97, v[68:71] offset:0
    ds_write_b128 v97, v[72:75] offset:16384
    ds_write_b128 v96, v[0:3] offset:0
    ds_write_b128 v96, v[4:7] offset:16384
    ds_write_b128 v96, v[8:11] offset:32768
    ds_write_b128 v98, v[12:15] offset:0
    v_lshlrev_b32 v76, 16, v16
    v_and_b32 v84, s25, v16
    v_lshlrev_b32 v77, 16, v20
    v_and_b32 v85, s25, v20
    v_lshlrev_b32 v78, 16, v24
    v_and_b32 v86, s25, v24
    v_lshlrev_b32 v79, 16, v28
    v_and_b32 v87, s25, v28
    v_add_f32 v80, v76, v78
    v_add_f32 v88, v84, v86
    v_add_f32 v81, v77, v79
    v_add_f32 v89, v85, v87
    v_fma_f32 v82, v78, 4.0, v76
    v_fma_f32 v90, v86, 4.0, v84
    v_fma_f32 v83, v79, 4.0, v77
    v_fma_f32 v91, v87, 4.0, v85
    v_add_f32 v77, v80, v81
    v_add_f32 v85, v88, v89
    v_sub_f32 v78, v80, v81
    v_sub_f32 v86, v88, v89
    v_fma_f32 v79, v83, 2.0, v82
    v_fma_f32 v87, v91, 2.0, v90
    v_fma_f32 v82, v83, -2.0, v82
    v_fma_f32 v90, v91, -2.0, v90
    v_fmamk_f32 v80, v76, 0x41700000, v82
    v_fmamk_f32 v88, v84, 0x41700000, v90
    v_fmamk_f32 v80, v81, 0x41200000, v80
    v_fmamk_f32 v88, v89, 0x41200000, v88
    v_cvt_pk_bf16_f32 v20, v77, v85
    v_cvt_pk_bf16_f32 v24, v78, v86
    v_cvt_pk_bf16_f32 v64, v79, v87
    v_cvt_pk_bf16_f32 v68, v82, v90
    v_cvt_pk_bf16_f32 v72, v80, v88
    v_lshlrev_b32 v76, 16, v17
    v_and_b32 v84, s25, v17
    v_lshlrev_b32 v77, 16, v21
    v_and_b32 v85, s25, v21
    v_lshlrev_b32 v78, 16, v25
    v_and_b32 v86, s25, v25
    v_lshlrev_b32 v79, 16, v29
    v_and_b32 v87, s25, v29
    v_add_f32 v80, v76, v78
    v_add_f32 v88, v84, v86
    v_add_f32 v81, v77, v79
    v_add_f32 v89, v85, v87
    v_fma_f32 v82, v78, 4.0, v76
    v_fma_f32 v90, v86, 4.0, v84
    v_fma_f32 v83, v79, 4.0, v77
    v_fma_f32 v91, v87, 4.0, v85
    v_add_f32 v77, v80, v81
    v_add_f32 v85, v88, v89
    v_sub_f32 v78, v80, v81
    v_sub_f32 v86, v88, v89
    v_fma_f32 v79, v83, 2.0, v82
    v_fma_f32 v87, v91, 2.0, v90
    v_fma_f32 v82, v83, -2.0, v82
    v_fma_f32 v90, v91, -2.0, v90
    v_fmamk_f32 v80, v76, 0x41700000, v82
    v_fmamk_f32 v88, v84, 0x41700000, v90
    v_fmamk_f32 v80, v81, 0x41200000, v80
    v_fmamk_f32 v88, v89, 0x41200000, v88
    v_cvt_pk_bf16_f32 v21, v77, v85
    v_cvt_pk_bf16_f32 v25, v78, v86
    v_cvt_pk_bf16_f32 v65, v79, v87
    v_cvt_pk_bf16_f32 v69, v82, v90
    v_cvt_pk_bf16_f32 v73, v80, v88
    v_lshlrev_b32 v76, 16, v18
    v_and_b32 v84, s25, v18
    v_lshlrev_b32 v77, 16, v22
    v_and_b32 v85, s25, v22
    v_lshlrev_b32 v78, 16, v26
    v_and_b32 v86, s25, v26
    v_lshlrev_b32 v79, 16, v30
    v_and_b32 v87, s25, v30
    v_add_f32 v80, v76, v78
    v_add_f32 v88, v84, v86
    v_add_f32 v81, v77, v79
    v_add_f32 v89, v85, v87
    v_fma_f32 v82, v78, 4.0, v76
    v_fma_f32 v90, v86, 4.0, v84
    v_fma_f32 v83, v79, 4.0, v77
    v_fma_f32 v91, v87, 4.0, v85
    v_add_f32 v77, v80, v81
    v_add_f32 v85, v88, v89
    v_sub_f32 v78, v80, v81
    v_sub_f32 v86, v88, v89
    v_fma_f32 v79, v83, 2.0, v82
    v_fma_f32 v87, v91, 2.0, v90
    v_fma_f32 v82, v83, -2.0, v82
    v_fma_f32 v90, v91, -2.0, v90
    v_fmamk_f32 v80, v76, 0x41700000, v82
    v_fmamk_f32 v88, v84, 0x41700000, v90
    v_fmamk_f32 v80, v81, 0x41200000, v80
    v_fmamk_f32 v88, v89, 0x41200000, v88
    v_cvt_pk_bf16_f32 v22, v77, v85
    v_cvt_pk_bf16_f32 v26, v78, v86
    v_cvt_pk_bf16_f32 v66, v79, v87
    v_cvt_pk_bf16_f32 v70, v82, v90
    v_cvt_pk_bf16_f32 v74, v80, v88
    v_lshlrev_b32 v76, 16, v19
    v_and_b32 v84, s25, v19
    v_lshlrev_b32 v77, 16, v23
    v_and_b32 v85, s25, v23
    v_lshlrev_b32 v78, 16, v27
    v_and_b32 v86, s25, v27
    v_lshlrev_b32 v79, 16, v31
    v_and_b32 v87, s25, v31
    v_add_f32 v80, v76, v78
    v_add_f32 v88, v84, v86
    v_add_f32 v81, v77, v79
    v_add_f32 v89, v85, v87
    v_fma_f32 v82, v78, 4.0, v76
    v_fma_f32 v90, v86, 4.0, v84
    v_fma_f32 v83, v79, 4.0, v77
    v_fma_f32 v91, v87, 4.0, v85
    v_add_f32 v77, v80, v81
    v_add_f32 v85, v88, v89
    v_sub_f32 v78, v80, v81
    v_sub_f32 v86, v88, v89
    v_fma_f32 v79, v83, 2.0, v82
    v_fma_f32 v87, v91, 2.0, v90
    v_fma_f32 v82, v83, -2.0, v82
    v_fma_f32 v90, v91, -2.0, v90
    v_fmamk_f32 v80, v76, 0x41700000, v82
    v_fmamk_f32 v88, v84, 0x41700000, v90
    v_fmamk_f32 v80, v81, 0x41200000, v80
    v_fmamk_f32 v88, v89, 0x41200000, v88
    v_cvt_pk_bf16_f32 v23, v77, v85
    v_cvt_pk_bf16_f32 v27, v78, v86
    v_cvt_pk_bf16_f32 v67, v79, v87
    v_cvt_pk_bf16_f32 v71, v82, v90
    v_cvt_pk_bf16_f32 v75, v80, v88
    s_add_u32 s28, s28, 1
    s_waitcnt lgkmcnt(0)
    s_barrier
    s_sub_u32 s22, s22, 1
    s_branch L_conv2_kernel_hloop2
L_conv2_kernel_hlast2:
    s_mov_b32 s25, 0xffff0000
    ds_write_b128 v96, v[64:67] offset:57344
    ds_write_b128 v97, v[68:71] offset:8192
    ds_write_b128 v97, v[72:75] offset:24576
    ds_write_b128 v96, v[48:51] offset:8192
    ds_write_b128 v96, v[52:55] offset:24576
    ds_write_b128 v96, v[56:59] offset:40960
    ds_write_b128 v98, v[60:63] offset:8704
    s_waitcnt lgkmcnt(0)
    s_barrier
    s_branch L_conv2_kernel_end
L_conv2_kernel_epi:
    s_waitcnt lgkmcnt(0)
    s_barrier
    v_cndmask_b32 v122, v111, v110, vcc
    ds_read_b128 v[0:3], v120 offset:0
    ds_read_b128 v[4:7], v120 offset:16384
    ds_read_b128 v[8:11], v120 offset:32768
    ds_read_b128 v[12:15], v120 offset:49152
    ds_read_b128 v[16:19], v121 offset:0
    ds_read_b128 v[20:23], v121 offset:16384
    ds_read_b128 v[24:27], v121 offset:32768
    ds_read_b128 v[28:31], v64 offset:15360
    ds_read_b128 v[32:35], v120 offset:8192
    ds_read_b128 v[36:39], v120 offset:24576
    ds_read_b128 v[40:43], v120 offset:40960
    ds_read_b128 v[44:47], v120 offset:57344
    ds_read_b128 v[48:51], v121 offset:56320
    ds_read_b128 v[52:55], v121 offset:64512
    ds_read_b128 v[56:59], v64 offset:7168
    s_waitcnt lgkmcnt(7)
    ds_read_b128 v[60:63], v64 offset:23552
    s_waitcnt lgkmcnt(8)
    v_pk_add_f32 v[88:89], v[24:25], v[28:29]
    v_pk_add_f32 v[90:91], v[26:27], v[30:31]
    v_pk_add_f32 v[24:25], v[4:5], v[8:9]
    v_pk_add_f32 v[26:27], v[6:7], v[10:11]
    v_pk_add_f32 v[4:5], v[4:5], v[8:9] neg_lo:[0,1] neg_hi:[0,1]
    v_pk_add_f32 v[6:7], v[6:7], v[10:11] neg_lo:[0,1] neg_hi:[0,1]
    v_pk_add_f32 v[72:73], v[12:13], v[16:17]
    v_pk_add_f32 v[74:75], v[14:15], v[18:19]
    v_pk_add_f32 v[12:13], v[12:13], v[16:17] neg_lo:[0,1] neg_hi:[0,1]
    v_pk_add_f32 v[14:15], v[14:15], v[18:19] neg_lo:[0,1] neg_hi:[0,1]
    v_pk_fma_f32 v[72:73], v[24:25], s[4:5], v[72:73]
    v_pk_fma_f32 v[74:75], v[26:27], s[4:5], v[74:75]
    v_pk_fma_f32 v[20:21], v[0:1], s[10:11], v[20:21]
    v_pk_fma_f32 v[22:23], v[2:3], s[10:11], v[22:23]
    v_pk_fma_f32 v[72:73], v[0:1], s[6:7], v[72:73]
    v_pk_fma_f32 v[74:75], v[2:3], s[6:7], v[74:75]
    v_pk_add_f32 v[24:25], v[24:25], v[0:1] neg_lo:[0,1] neg_hi:[0,1]
    v_pk_add_f32 v[26:27], v[26:27], v[2:3] neg_lo:[0,1] neg_hi:[0,1]
    v_pk_fma_f32 v[72:73], v[88:89], s[8:9], v[72:73]
    v_pk_fma_f32 v[74:75], v[90:91], s[8:9], v[74:75]
    v_pk_add_f32 v[24:25], v[24:25], v[88:89] neg_lo:[0,1] neg_hi:[0,1]
    v_pk_add_f32 v[26:27], v[26:27], v[90:91] neg_lo:[0,1] neg_hi:[0,1]
    v_pk_fma_f32 v[20:21], v[88:89], s[22:23], v[20:21]
    v_pk_fma_f32 v[22:23], v[90:91], s[22:23], v[22:23]
    v_pk_add_f32 v[8:9], v[24:25], v[72:73] neg_lo:[0,1] neg_hi:[0,1]
    v_pk_add_f32 v[10:11], v[26:27], v[74:75] neg_lo:[0,1] neg_hi:[0,1]
    v_pk_fma_f32 v[20:21], v[72:73], s[14:15], v[20:21]
    v_pk_fma_f32 v[22:23], v[74:75], s[14:15], v[22:23]
    v_pk_mul_f32 v[80:81], v[12:13], s[32:33]
    v_pk_mul_f32 v[82:83], v[14:15], s[32:33]
    v_pk_fma_f32 v[20:21], v[8:9], s[12:13], v[20:21]
    v_pk_fma_f32 v[22:23], v[10:11], s[12:13], v[22:23]
    v_pk_fma_f32 v[80:81], v[4:5], s[34:35], v[80:81]
    v_pk_fma_f32 v[82:83], v[6:7], s[34:35], v[82:83]
    v_pk_fma_f32 v[64:65], v[4:5], s[24:25], v[20:21] neg_lo:[0,0,1] neg_hi:[0,0,1]
    v_pk_fma_f32 v[66:67], v[6:7], s[24:25], v[22:23] neg_lo:[0,0,1] neg_hi:[0,0,1]
    v_pk_fma_f32 v[64:65], v[12:13], s[26:27], v[64:65]
    v_pk_fma_f32 v[66:67], v[14:15], s[26:27], v[66:67]
    v_pk_fma_f32 v[80:81], v[64:65], s[38:39], v[80:81]
    v_pk_fma_f32 v[82:83], v[66:67], s[38:39], v[82:83]
    v_pk_add_f32 v[4:5], v[4:5], v[64:65] neg_lo:[0,1] neg_hi:[0,1]
    v_pk_add_f32 v[6:7], v[6:7], v[66:67] neg_lo:[0,1] neg_hi:[0,1]
    v_pk_add_f32 v[4:5], v[4:5], v[80:81] neg_lo:[0,1] neg_hi:[0,1]
    v_pk_add_f32 v[6:7], v[6:7], v[82:83] neg_lo:[0,1] neg_hi:[0,1]
    s_waitcnt lgkmcnt(0)
    v_pk_add_f32 v[92:93], v[56:57], v[60:61]
    v_pk_add_f32 v[94:95], v[58:59], v[62:63]
    v_pk_add_f32 v[56:57], v[36:37], v[40:41]
    v_pk_add_f32 v[58:59], v[38:39], v[42:43]
    v_pk_add_f32 v[36:37], v[36:37], v[40:41] neg_lo:[0,1] neg_hi:[0,1]
    v_pk_add_f32 v[38:39], v[38:39], v[42:43] neg_lo:[0,1] neg_hi:[0,1]
    v_pk_add_f32 v[76:77], v[44:45], v[48:49]
    v_pk_add_f32 v[78:79], v[46:47], v[50:51]
    v_pk_add_f32 v[44:45], v[44:45], v[48:49] neg_lo:[0,1] neg_hi:[0,1]
    v_pk_add_f32 v[46:47], v[46:47], v[50:51] neg_lo:[0,1] neg_hi:[0,1]
    v_pk_fma_f32 v[76:77], v[56:57], s[4:5], v[76:77]
    v_pk_fma_f32 v[78:79], v[58:59], s[4:5], v[78:79]
    v_pk_fma_f32 v[52:53], v[32:33], s[10:11], v[52:53]
    v_pk_fma_f32 v[54:55], v[34:35], s[10:11], v[54:55]
    v_pk_fma_f32 v[76:77], v[32:33], s[6:7], v[76:77]
    v_pk_fma_f32 v[78:79], v[34:35], s[6:7], v[78:79]
    v_pk_add_f32 v[56:57], v[56:57], v[32:33] neg_lo:[0,1] neg_hi:[0,1]
    v_pk_add_f32 v[58:59], v[58:59], v[34:35] neg_lo:[0,1] neg_hi:[0,1]
    v_pk_fma_f32 v[76:77], v[92:93], s[8:9], v[76:77]
    v_pk_fma_f32 v[78:79], v[94:95], s[8:9], v[78:79]
    v_pk_add_f32 v[56:57], v[56:57], v[92:93] neg_lo:[0,1] neg_hi:[0,1]
    v_pk_add_f32 v[58:59], v[58:59], v[94:95] neg_lo:[0,1] neg_hi:[0,1]
    v_pk_fma_f32 v[52:53], v[92:93], s[22:23], v[52:53]
    v_pk_fma_f32 v[54:55], v[94:95], s[22:23], v[54:55]
    v_pk_add_f32 v[40:41], v[56:57], v[76:77] neg_lo:[0,1] neg_hi:[0,1]
    v_pk_add_f32 v[42:43], v[58:59], v[78:79] neg_lo:[0,1] neg_hi:[0,1]
    v_pk_fma_f32 v[52:53], v[76:77], s[14:15], v[52:53]
    v_pk_fma_f32 v[54:55], v[78:79], s[14:15], v[54:55]
    v_pk_mul_f32 v[84:85], v[44:45], s[32:33]
    v_pk_mul_f32 v[86:87], v[46:47], s[32:33]
    v_pk_fma_f32 v[52:53], v[40:41], s[12:13], v[52:53]
    v_pk_fma_f32 v[54:55], v[42:43], s[12:13], v[54:55]
    v_pk_fma_f32 v[84:85], v[36:37], s[34:35], v[84:85]
    v_pk_fma_f32 v[86:87], v[38:39], s[34:35], v[86:87]
    v_pk_fma_f32 v[68:69], v[36:37], s[24:25], v[52:53] neg_lo:[0,0,1] neg_hi:[0,0,1]
    v_pk_fma_f32 v[70:71], v[38:39], s[24:25], v[54:55] neg_lo:[0,0,1] neg_hi:[0,0,1]
    v_pk_fma_f32 v[68:69], v[44:45], s[26:27], v[68:69]
    v_pk_fma_f32 v[70:71], v[46:47], s[26:27], v[70:71]
    v_pk_fma_f32 v[84:85], v[68:69], s[38:39], v[84:85]
    v_pk_fma_f32 v[86:87], v[70:71], s[38:39], v[86:87]
    v_pk_add_f32 v[36:37], v[36:37], v[68:69] neg_lo:[0,1] neg_hi:[0,1]
    v_pk_add_f32 v[38:39], v[38:39], v[70:71] neg_lo:[0,1] neg_hi:[0,1]
    v_pk_add_f32 v[36:37], v[36:37], v[84:85] neg_lo:[0,1] neg_hi:[0,1]
    v_pk_add_f32 v[38:39], v[38:39], v[86:87] neg_lo:[0,1] neg_hi:[0,1]
    s_mov_b32 s36, 0x00010001
    s_mov_b32 s37, 0x00010001
    s_mov_b64 exec, s[36:37]
    ds_write_b128 v127, v[0:3] offset:0
    ds_write_b128 v127, v[32:35] offset:16
    ds_write_b128 v127, v[4:7] offset:32
    ds_write_b128 v127, v[36:39] offset:48
    ds_write_b128 v127, v[8:11] offset:64
    ds_write_b128 v127, v[40:43] offset:80
    s_mov_b64 exec, -1
    v_mov_b32 v44, 0xc0135761
    v_mov_b32 v45, v44
    v_cvt_pk_bf16_f32 v48, v64, v68
    v_cvt_pk_bf16_f32 v49, v65, v69
    v_cvt_pk_bf16_f32 v50, v66, v70
    v_cvt_pk_bf16_f32 v51, v67, v71
    s_mov_b32 s44, 0
    buffer_store_dwordx4 v[48:51], v122, s[16:19], s44 offen sc1
    s_waitcnt lgkmcnt(0)
    s_barrier
    ds_read_b128 v[96:99], v127 offset:512
    ds_read_b128 v[100:103], v127 offset:528
    ds_read_b128 v[104:107], v127 offset:544
    ds_read_b128 v[108:111], v127 offset:560
    ds_read_b128 v[112:115], v127 offset:576
    ds_read_b128 v[116:119], v127 offset:592
    s_waitcnt lgkmcnt(4)
    v_mov_b32_dpp v96, v0 row_shl:1 row_mask:0xf bank_mask:0xf
    v_mov_b32_dpp v97, v1 row_shl:1 row_mask:0xf bank_mask:0xf
    v_mov_b32_dpp v98, v2 row_shl:1 row_mask:0xf bank_mask:0xf
    v_mov_b32_dpp v99, v3 row_shl:1 row_mask:0xf bank_mask:0xf
    v_mov_b32_dpp v100, v32 row_shl:1 row_mask:0xf bank_mask:0xf
    v_mov_b32_dpp v101, v33 row_shl:1 row_mask:0xf bank_mask:0xf
    v_mov_b32_dpp v102, v34 row_shl:1 row_mask:0xf bank_mask:0xf
    v_mov_b32_dpp v103, v35 row_shl:1 row_mask:0xf bank_mask:0xf
    v_pk_add_f32 v[72:73], v[72:73], v[96:97]
    v_pk_add_f32 v[74:75], v[74:75], v[98:99]
    v_pk_add_f32 v[76:77], v[76:77], v[100:101]
    v_pk_add_f32 v[78:79], v[78:79], v[102:103]
    v_cvt_pk_bf16_f32 v52, v72, v76
    v_cvt_pk_bf16_f32 v53, v73, v77
    v_cvt_pk_bf16_f32 v54, v74, v78
    v_cvt_pk_bf16_f32 v55, v75, v79
    s_mov_b32 s44, 65536
    buffer_store_dwordx4 v[52:55], v122, s[16:19], s44 offen sc1
    s_waitcnt lgkmcnt(2)
    v_mov_b32_dpp v104, v4 row_shl:1 row_mask:0xf bank_mask:0xf
    v_mov_b32_dpp v105, v5 row_shl:1 row_mask:0xf bank_mask:0xf
    v_mov_b32_dpp v106, v6 row_shl:1 row_mask:0xf bank_mask:0xf
    v_mov_b32_dpp v107, v7 row_shl:1 row_mask:0xf bank_mask:0xf
    v_mov_b32_dpp v108, v36 row_shl:1 row_mask:0xf bank_mask:0xf
    v_mov_b32_dpp v109, v37 row_shl:1 row_mask:0xf bank_mask:0xf
    v_mov_b32_dpp v110, v38 row_shl:1 row_mask:0xf bank_mask:0xf
    v_mov_b32_dpp v111, v39 row_shl:1 row_mask:0xf bank_mask:0xf
    v_pk_add_f32 v[80:81], v[80:81], v[104:105]
    v_pk_add_f32 v[82:83], v[82:83], v[106:107]
    v_pk_add_f32 v[84:85], v[84:85], v[108:109]
    v_pk_add_f32 v[86:87], v[86:87], v[110:111]
    v_cvt_pk_bf16_f32 v56, v80, v84
    v_cvt_pk_bf16_f32 v57, v81, v85
    v_cvt_pk_bf16_f32 v58, v82, v86
    v_cvt_pk_bf16_f32 v59, v83, v87
    s_mov_b32 s44, 131072
    buffer_store_dwordx4 v[56:59], v122, s[16:19], s44 offen sc1
    s_waitcnt lgkmcnt(0)
    v_mov_b32_dpp v112, v8 row_shl:1 row_mask:0xf bank_mask:0xf
    v_mov_b32_dpp v113, v9 row_shl:1 row_mask:0xf bank_mask:0xf
    v_mov_b32_dpp v114, v10 row_shl:1 row_mask:0xf bank_mask:0xf
    v_mov_b32_dpp v115, v11 row_shl:1 row_mask:0xf bank_mask:0xf
    v_mov_b32_dpp v116, v40 row_shl:1 row_mask:0xf bank_mask:0xf
    v_mov_b32_dpp v117, v41 row_shl:1 row_mask:0xf bank_mask:0xf
    v_mov_b32_dpp v118, v42 row_shl:1 row_mask:0xf bank_mask:0xf
    v_mov_b32_dpp v119, v43 row_shl:1 row_mask:0xf bank_mask:0xf
    v_pk_add_f32 v[88:89], v[88:89], v[112:113]
    v_pk_add_f32 v[90:91], v[90:91], v[114:115]
    v_pk_add_f32 v[92:93], v[92:93], v[116:117]
    v_pk_add_f32 v[94:95], v[94:95], v[118:119]
    v_cvt_pk_bf16_f32 v60, v88, v92
    v_cvt_pk_bf16_f32 v61, v89, v93
    v_cvt_pk_bf16_f32 v62, v90, v94
    v_cvt_pk_bf16_f32 v63, v91, v95
    s_mov_b32 s44, 196608
    buffer_store_dwordx4 v[60:63], v122, s[16:19], s44 offen sc1
L_conv2_kernel_end:
L_conv2_kernel_done:
    s_endpgm
.globl joint_kernel
.p2align 8
.type joint_kernel,@function
joint_kernel:
    s_cmp_ge_u32 s2, 250
    s_cbranch_scc1 L_joint_kernel_done
    s_load_dwordx2 s[28:29], s[0:1], 56
    s_load_dwordx2 s[30:31], s[0:1], 72
    v_readfirstlane_b32 s20, v0
    s_lshr_b32 s20, s20, 6
    s_and_b32 s21, s20, 7
    v_and_b32 v127, 63, v0
    v_lshlrev_b32 v126, 4, v127
    s_cmp_ge_u32 s20, 8
    s_mov_b32 s33, 44171264
    s_cselect_b32 s33, 44040192, s33
    s_lshl_b32 s36, s21, 14
    s_add_u32 s33, s33, s36
    s_mov_b32 s14, 16384
    s_mov_b32 s15, 0x00020000
    s_lshl_b32 s35, s2, 9
    s_cmp_ge_u32 s2, 125
    s_cselect_b32 s36, 2033152, 0
    s_cselect_b32 s34, 8192, 0
    s_add_u32 s35, s35, s36
    s_add_u32 s34, s34, 44302336
    s_mov_b32 s10, 12582912
    s_mov_b32 s11, 0x00020000
    s_mov_b32 s42, 24576
    s_mov_b32 s43, 0x00020000
    s_waitcnt lgkmcnt(0)
    s_add_u32 s12, s30, s33
    s_addc_u32 s13, s31, 0
    s_add_u32 s40, s30, s34
    s_addc_u32 s41, s31, 0
    s_cmp_ge_u32 s20, 8
    s_cbranch_scc1 L_joint_kernel_T
    s_add_u32 s8, s30, 27262976
    s_addc_u32 s9, s31, 0
    v_mov_b32 v0, 99456
    v_mov_b32 v2, 0
    v_mov_b32 v3, 0
    ds_write_b64 v0, v[2:3]
    v_lshrrev_b32 v124, 5, v127
    v_and_b32 v123, 0x1ff, v126
    v_mul_u32_u24 v125, 65536, v124
    v_add_u32 v123, v125, v123
    s_mul_i32 s36, s21, 262144
    s_add_u32 s36, s36, s35
    s_add_u32 s37, s36, 8388608
    buffer_load_dwordx4 v[64:67], v123, s[8:11], s36 offen
    buffer_load_dwordx4 v[72:75], v123, s[8:11], s37 offen
    s_add_u32 s36, s36, 131072
    s_add_u32 s37, s36, 8388608
    buffer_load_dwordx4 v[68:71], v123, s[8:11], s36 offen
    buffer_load_dwordx4 v[76:79], v123, s[8:11], s37 offen
    s_lshl_b32 s38, s21, 10
    s_add_u32 s38, s38, 16384
    buffer_load_dwordx4 v[80:83], v126, s[40:43], s38 offen
    s_waitcnt lgkmcnt(0)
    s_barrier
    s_lshl_b32 s35, s2, 17
    s_add_u32 s16, s28, s35
    s_addc_u32 s17, s29, 0
    s_mov_b32 s18, 131072
    s_mov_b32 s19, 0x00020000
    s_mov_b32 s46, 0xbdd2d3e8
    s_mov_b32 s47, s46
    v_mov_b32 v120, 0xc0135761
    v_mov_b32 v121, v120
    s_mov_b32 s48, 1.0
    s_mov_b32 s49, 1.0
    v_bfe_u32 v123, v127, 2, 3
    v_lshl_add_u32 v124, v123, 2, v124
    v_mul_u32_u24 v124, 528, v124
    v_and_b32 v123, 0x30, v126
    s_lshl_b32 s36, s21, 6
    v_add3_u32 v124, v124, v123, s36
    s_mov_b32 s45, 0xffff0000
    s_mul_i32 s36, s21, 1040
    s_add_u32 s36, s36, 91136
    v_add_u32 v123, s36, v126
    s_mov_b32 s22, 2
    s_waitcnt vmcnt(3)
L_joint_kernel_floop:
    v_lshlrev_b32 v88, 16, v64
    v_and_b32 v89, s45, v64
    v_lshlrev_b32 v96, 16, v72
    v_and_b32 v97, s45, v72
    v_lshlrev_b32 v90, 16, v65
    v_and_b32 v91, s45, v65
    v_lshlrev_b32 v98, 16, v73
    v_and_b32 v99, s45, v73
    v_lshlrev_b32 v92, 16, v66
    v_and_b32 v93, s45, v66
    v_lshlrev_b32 v100, 16, v74
    v_and_b32 v101, s45, v74
    v_lshlrev_b32 v94, 16, v67
    v_and_b32 v95, s45, v67
    v_lshlrev_b32 v102, 16, v75
    v_and_b32 v103, s45, v75
    v_pk_add_f32 v[88:89], v[88:89], v[96:97]
    v_pk_add_f32 v[90:91], v[90:91], v[98:99]
    v_pk_add_f32 v[92:93], v[92:93], v[100:101]
    v_pk_add_f32 v[94:95], v[94:95], v[102:103]
    v_pk_mul_f32 v[96:97], v[88:89], v[88:89]
    v_pk_mul_f32 v[98:99], v[90:91], v[90:91]
    v_pk_mul_f32 v[100:101], v[92:93], v[92:93]
    v_pk_mul_f32 v[102:103], v[94:95], v[94:95]
    v_pk_fma_f32 v[96:97], v[96:97], s[46:47], v[120:121]
    v_pk_fma_f32 v[98:99], v[98:99], s[46:47], v[120:121]
    v_pk_fma_f32 v[100:101], v[100:101], s[46:47], v[120:121]
    v_pk_fma_f32 v[102:103], v[102:103], s[46:47], v[120:121]
    v_pk_mul_f32 v[96:97], v[96:97], v[88:89]
    v_pk_mul_f32 v[98:99], v[98:99], v[90:91]
    v_pk_mul_f32 v[100:101], v[100:101], v[92:93]
    v_pk_mul_f32 v[102:103], v[102:103], v[94:95]
    v_exp_f32 v96, v96
    v_exp_f32 v97, v97
    v_exp_f32 v98, v98
    v_exp_f32 v99, v99
    v_exp_f32 v100, v100
    v_exp_f32 v101, v101
    v_exp_f32 v102, v102
    v_exp_f32 v103, v103
    v_pk_add_f32 v[96:97], v[96:97], s[48:49]
    v_pk_add_f32 v[98:99], v[98:99], s[48:49]
    v_pk_add_f32 v[100:101], v[100:101], s[48:49]
    v_pk_add_f32 v[102:103], v[102:103], s[48:49]
    v_rcp_f32 v96, v96
    v_rcp_f32 v97, v97
    v_rcp_f32 v98, v98
    v_rcp_f32 v99, v99
    v_rcp_f32 v100, v100
    v_rcp_f32 v101, v101
    v_rcp_f32 v102, v102
    v_rcp_f32 v103, v103
    v_pk_mul_f32 v[88:89], v[88:89], v[96:97]
    v_pk_mul_f32 v[90:91], v[90:91], v[98:99]
    v_pk_mul_f32 v[92:93], v[92:93], v[100:101]
    v_pk_mul_f32 v[94:95], v[94:95], v[102:103]
    v_cvt_pk_bf16_f32 v104, v88, v89
    v_cvt_pk_bf16_f32 v105, v90, v91
    v_cvt_pk_bf16_f32 v106, v92, v93
    v_cvt_pk_bf16_f32 v107, v94, v95
    ds_write_b128 v124, v[104:107] offset:32768
    s_waitcnt vmcnt(0)
    v_pk_mov_b32 v[64:65], v[68:69], v[68:69] op_sel:[0,1]
    v_pk_mov_b32 v[72:73], v[76:77], v[76:77] op_sel:[0,1]
    v_pk_mov_b32 v[66:67], v[70:71], v[70:71] op_sel:[0,1]
    v_pk_mov_b32 v[74:75], v[78:79], v[78:79] op_sel:[0,1]
    v_add_u32 v124, 1056, v124
    s_sub_u32 s22, s22, 1
    s_cmp_lg_u32 s22, 0
    s_cbranch_scc1 L_joint_kernel_floop
    ds_write_b128 v123, v[80:83]
    s_waitcnt lgkmcnt(0)
    v_mov_b32 v120, 99456
    v_mov_b32 v121, 1
    s_mov_b64 exec, 1
    ds_add_u32 v120, v121 offset:0
    s_mov_b64 exec, -1
L_joint_kernel_ow:
    ds_read_b32 v121, v120 offset:4
    s_waitcnt lgkmcnt(0)
    v_readfirstlane_b32 s37, v121
    s_cmp_ge_u32 s37, 8
    s_cbranch_scc1 L_joint_kernel_ow_d
    s_sleep 1
    s_branch L_joint_kernel_ow
L_joint_kernel_ow_d:
    s_mov_b32 s36, 0
    buffer_load_dwordx4 v[0:3], v126, s[12:15], s36 offen offset:0
    buffer_load_dwordx4 v[4:7], v126, s[12:15], s36 offen offset:1024
    buffer_load_dwordx4 v[8:11], v126, s[12:15], s36 offen offset:2048
    buffer_load_dwordx4 v[12:15], v126, s[12:15], s36 offen offset:3072
    s_mov_b32 s36, 4096
    buffer_load_dwordx4 v[16:19], v126, s[12:15], s36 offen offset:0
    buffer_load_dwordx4 v[20:23], v126, s[12:15], s36 offen offset:1024
    buffer_load_dwordx4 v[24:27], v126, s[12:15], s36 offen offset:2048
    buffer_load_dwordx4 v[28:31], v126, s[12:15], s36 offen offset:3072
    s_mov_b32 s36, 8192
    buffer_load_dwordx4 v[32:35], v126, s[12:15], s36 offen offset:0
    buffer_load_dwordx4 v[36:39], v126, s[12:15], s36 offen offset:1024
    buffer_load_dwordx4 v[40:43], v126, s[12:15], s36 offen offset:2048
    buffer_load_dwordx4 v[44:47], v126, s[12:15], s36 offen offset:3072
    s_mov_b32 s36, 12288
    buffer_load_dwordx4 v[48:51], v126, s[12:15], s36 offen offset:0
    buffer_load_dwordx4 v[52:55], v126, s[12:15], s36 offen offset:1024
    buffer_load_dwordx4 v[56:59], v126, s[12:15], s36 offen offset:2048
    buffer_load_dwordx4 v[60:63], v126, s[12:15], s36 offen offset:3072
    v_lshrrev_b32 v125, 4, v127
    v_lshlrev_b32 v125, 11, v125
    v_and_b32 v124, 15, v127
    v_lshl_add_u32 v125, v124, 2, v125
    s_lshl_b32 s36, s21, 6
    v_add_u32 v125, s36, v125
    s_mov_b32 s44, 8192
    s_setprio 1
    s_barrier
    ds_read_b128 v[96:99], v126 offset:0
    ds_read_b128 v[100:103], v126 offset:1024
    ds_read_b128 v[104:107], v126 offset:2048
    ds_read_b128 v[108:111], v126 offset:3072
    s_waitcnt vmcnt(14) lgkmcnt(3)
    v_mfma_f32_16x16x32_bf16 v[64:67], v[96:99], v[0:3], 0
    v_mfma_f32_16x16x32_bf16 v[68:71], v[96:99], v[4:7], 0
    ds_read_b128 v[96:99], v126 offset:4096
    s_waitcnt lgkmcnt(3)
    v_mfma_f32_16x16x32_bf16 v[72:75], v[100:103], v[0:3], 0
    v_mfma_f32_16x16x32_bf16 v[76:79], v[100:103], v[4:7], 0
    ds_read_b128 v[100:103], v126 offset:5120
    s_waitcnt vmcnt(12) lgkmcnt(3)
    v_mfma_f32_16x16x32_bf16 v[64:67], v[104:107], v[8:11], v[64:67]
    v_mfma_f32_16x16x32_bf16 v[68:71], v[104:107], v[12:15], v[68:71]
    ds_read_b128 v[104:107], v126 offset:6144
    s_waitcnt lgkmcnt(3)
    v_mfma_f32_16x16x32_bf16 v[72:75], v[108:111], v[8:11], v[72:75]
    v_mfma_f32_16x16x32_bf16 v[76:79], v[108:111], v[12:15], v[76:79]
    ds_read_b128 v[108:111], v126 offset:7168
    s_waitcnt vmcnt(10) lgkmcnt(3)
    v_mfma_f32_16x16x32_bf16 v[64:67], v[96:99], v[16:19], v[64:67]
    v_mfma_f32_16x16x32_bf16 v[68:71], v[96:99], v[20:23], v[68:71]
    ds_read_b128 v[96:99], v126 offset:8192
    s_waitcnt lgkmcnt(3)
    v_mfma_f32_16x16x32_bf16 v[72:75], v[100:103], v[16:19], v[72:75]
    v_mfma_f32_16x16x32_bf16 v[76:79], v[100:103], v[20:23], v[76:79]
    ds_read_b128 v[100:103], v126 offset:9216
    s_waitcnt vmcnt(8) lgkmcnt(3)
    v_mfma_f32_16x16x32_bf16 v[64:67], v[104:107], v[24:27], v[64:67]
    v_mfma_f32_16x16x32_bf16 v[68:71], v[104:107], v[28:31], v[68:71]
    ds_read_b128 v[104:107], v126 offset:10240
    s_waitcnt lgkmcnt(3)
    v_mfma_f32_16x16x32_bf16 v[72:75], v[108:111], v[24:27], v[72:75]
    v_mfma_f32_16x16x32_bf16 v[76:79], v[108:111], v[28:31], v[76:79]
    ds_read_b128 v[108:111], v126 offset:11264
    s_waitcnt vmcnt(6) lgkmcnt(3)
    v_mfma_f32_16x16x32_bf16 v[64:67], v[96:99], v[32:35], v[64:67]
    v_mfma_f32_16x16x32_bf16 v[68:71], v[96:99], v[36:39], v[68:71]
    ds_read_b128 v[96:99], v126 offset:12288
    s_waitcnt lgkmcnt(3)
    v_mfma_f32_16x16x32_bf16 v[72:75], v[100:103], v[32:35], v[72:75]
    v_mfma_f32_16x16x32_bf16 v[76:79], v[100:103], v[36:39], v[76:79]
    ds_read_b128 v[100:103], v126 offset:13312
    s_waitcnt vmcnt(4) lgkmcnt(3)
    v_mfma_f32_16x16x32_bf16 v[64:67], v[104:107], v[40:43], v[64:67]
    v_mfma_f32_16x16x32_bf16 v[68:71], v[104:107], v[44:47], v[68:71]
    ds_read_b128 v[104:107], v126 offset:14336
    s_waitcnt lgkmcnt(3)
    v_mfma_f32_16x16x32_bf16 v[72:75], v[108:111], v[40:43], v[72:75]
    v_mfma_f32_16x16x32_bf16 v[76:79], v[108:111], v[44:47], v[76:79]
    ds_read_b128 v[108:111], v126 offset:15360
    s_waitcnt vmcnt(2) lgkmcnt(3)
    v_mfma_f32_16x16x32_bf16 v[64:67], v[96:99], v[48:51], v[64:67]
    v_mfma_f32_16x16x32_bf16 v[68:71], v[96:99], v[52:55], v[68:71]
    s_waitcnt lgkmcnt(0)
    s_barrier
    ds_read_b128 v[96:99], v126 offset:16384
    v_mfma_f32_16x16x32_bf16 v[72:75], v[100:103], v[48:51], v[72:75]
    v_mfma_f32_16x16x32_bf16 v[76:79], v[100:103], v[52:55], v[76:79]
    ds_read_b128 v[100:103], v126 offset:17408
    s_waitcnt vmcnt(0)
    v_mfma_f32_16x16x32_bf16 v[64:67], v[104:107], v[56:59], v[64:67]
    v_mfma_f32_16x16x32_bf16 v[68:71], v[104:107], v[60:63], v[68:71]
    ds_read_b128 v[104:107], v126 offset:18432
    v_mfma_f32_16x16x32_bf16 v[72:75], v[108:111], v[56:59], v[72:75]
    v_mfma_f32_16x16x32_bf16 v[76:79], v[108:111], v[60:63], v[76:79]
    ds_read_b128 v[108:111], v126 offset:19456
    s_mov_b32 s22, 4
L_joint_kernel_oloop:
    s_waitcnt lgkmcnt(3)
    v_mfma_f32_16x16x32_bf16 v[80:83], v[96:99], v[0:3], 0
    v_mfma_f32_16x16x32_bf16 v[84:87], v[96:99], v[4:7], 0
    ds_read_b128 v[96:99], v126 offset:20480
    s_waitcnt lgkmcnt(3)
    v_mfma_f32_16x16x32_bf16 v[88:91], v[100:103], v[0:3], 0
    v_mfma_f32_16x16x32_bf16 v[92:95], v[100:103], v[4:7], 0
    ds_read_b128 v[100:103], v126 offset:21504
    s_waitcnt lgkmcnt(3)
    v_mfma_f32_16x16x32_bf16 v[80:83], v[104:107], v[8:11], v[80:83]
    v_mfma_f32_16x16x32_bf16 v[84:87], v[104:107], v[12:15], v[84:87]
    ds_read_b128 v[104:107], v126 offset:22528
    s_waitcnt lgkmcnt(3)
    v_mfma_f32_16x16x32_bf16 v[88:91], v[108:111], v[8:11], v[88:91]
    v_cvt_pk_bf16_f32 v112, v64, v68
    v_mfma_f32_16x16x32_bf16 v[92:95], v[108:111], v[12:15], v[92:95]
    buffer_store_dword v112, v125, s[16:19], 0 offen offset:0 nt
    ds_read_b128 v[108:111], v126 offset:23552
    s_waitcnt lgkmcnt(3)
    v_mfma_f32_16x16x32_bf16 v[80:83], v[96:99], v[16:19], v[80:83]
    v_cvt_pk_bf16_f32 v113, v65, v69
    v_mfma_f32_16x16x32_bf16 v[84:87], v[96:99], v[20:23], v[84:87]
    buffer_store_dword v113, v125, s[16:19], 0 offen offset:512 nt
    ds_read_b128 v[96:99], v126 offset:24576
    s_waitcnt lgkmcnt(3)
    v_mfma_f32_16x16x32_bf16 v[88:91], v[100:103], v[16:19], v[88:91]
    v_cvt_pk_bf16_f32 v114, v66, v70
    v_mfma_f32_16x16x32_bf16 v[92:95], v[100:103], v[20:23], v[92:95]
    buffer_store_dword v114, v125, s[16:19], 0 offen offset:1024 nt
    ds_read_b128 v[100:103], v126 offset:25600
    s_waitcnt lgkmcnt(3)
    v_mfma_f32_16x16x32_bf16 v[80:83], v[104:107], v[24:27], v[80:83]
    v_cvt_pk_bf16_f32 v115, v67, v71
    v_mfma_f32_16x16x32_bf16 v[84:87], v[104:107], v[28:31], v[84:87]
    buffer_store_dword v115, v125, s[16:19], 0 offen offset:1536 nt
    ds_read_b128 v[104:107], v126 offset:26624
    s_waitcnt lgkmcnt(3)
    v_mfma_f32_16x16x32_bf16 v[88:91], v[108:111], v[24:27], v[88:91]
    v_cvt_pk_bf16_f32 v116, v72, v76
    v_mfma_f32_16x16x32_bf16 v[92:95], v[108:111], v[28:31], v[92:95]
    buffer_store_dword v116, v125, s[16:19], s44 offen offset:0 nt
    ds_read_b128 v[108:111], v126 offset:27648
    s_waitcnt lgkmcnt(3)
    v_mfma_f32_16x16x32_bf16 v[80:83], v[96:99], v[32:35], v[80:83]
    v_cvt_pk_bf16_f32 v117, v73, v77
    v_mfma_f32_16x16x32_bf16 v[84:87], v[96:99], v[36:39], v[84:87]
    buffer_store_dword v117, v125, s[16:19], s44 offen offset:512 nt
    ds_read_b128 v[96:99], v126 offset:28672
    s_waitcnt lgkmcnt(3)
    v_mfma_f32_16x16x32_bf16 v[88:91], v[100:103], v[32:35], v[88:91]
    v_cvt_pk_bf16_f32 v118, v74, v78
    v_mfma_f32_16x16x32_bf16 v[92:95], v[100:103], v[36:39], v[92:95]
    buffer_store_dword v118, v125, s[16:19], s44 offen offset:1024 nt
    ds_read_b128 v[100:103], v126 offset:29696
    s_waitcnt lgkmcnt(3)
    v_mfma_f32_16x16x32_bf16 v[80:83], v[104:107], v[40:43], v[80:83]
    v_cvt_pk_bf16_f32 v119, v75, v79
    v_mfma_f32_16x16x32_bf16 v[84:87], v[104:107], v[44:47], v[84:87]
    buffer_store_dword v119, v125, s[16:19], s44 offen offset:1536 nt
    ds_read_b128 v[104:107], v126 offset:30720
    s_waitcnt lgkmcnt(3)
    v_mfma_f32_16x16x32_bf16 v[88:91], v[108:111], v[40:43], v[88:91]
    v_add_u32 v125, 16384, v125
    v_mfma_f32_16x16x32_bf16 v[92:95], v[108:111], v[44:47], v[92:95]
    ds_read_b128 v[108:111], v126 offset:31744
    s_waitcnt lgkmcnt(3)
    v_mfma_f32_16x16x32_bf16 v[80:83], v[96:99], v[48:51], v[80:83]
    v_mfma_f32_16x16x32_bf16 v[84:87], v[96:99], v[52:55], v[84:87]
    s_waitcnt lgkmcnt(0)
    s_barrier
    ds_read_b128 v[96:99], v126 offset:0
    v_mfma_f32_16x16x32_bf16 v[88:91], v[100:103], v[48:51], v[88:91]
    v_mfma_f32_16x16x32_bf16 v[92:95], v[100:103], v[52:55], v[92:95]
    ds_read_b128 v[100:103], v126 offset:1024
    v_mfma_f32_16x16x32_bf16 v[80:83], v[104:107], v[56:59], v[80:83]
    v_mfma_f32_16x16x32_bf16 v[84:87], v[104:107], v[60:63], v[84:87]
    ds_read_b128 v[104:107], v126 offset:2048
    v_mfma_f32_16x16x32_bf16 v[88:91], v[108:111], v[56:59], v[88:91]
    v_mfma_f32_16x16x32_bf16 v[92:95], v[108:111], v[60:63], v[92:95]
    ds_read_b128 v[108:111], v126 offset:3072
    s_sub_u32 s22, s22, 1
    s_cmp_eq_u32 s22, 0
    s_cbranch_scc1 L_joint_kernel_oend
    s_waitcnt lgkmcnt(3)
    v_mfma_f32_16x16x32_bf16 v[64:67], v[96:99], v[0:3], 0
    v_mfma_f32_16x16x32_bf16 v[68:71], v[96:99], v[4:7], 0
    ds_read_b128 v[96:99], v126 offset:4096
    s_waitcnt lgkmcnt(3)
    v_mfma_f32_16x16x32_bf16 v[72:75], v[100:103], v[0:3], 0
    v_mfma_f32_16x16x32_bf16 v[76:79], v[100:103], v[4:7], 0
    ds_read_b128 v[100:103], v126 offset:5120
    s_waitcnt lgkmcnt(3)
    v_mfma_f32_16x16x32_bf16 v[64:67], v[104:107], v[8:11], v[64:67]
    v_mfma_f32_16x16x32_bf16 v[68:71], v[104:107], v[12:15], v[68:71]
    ds_read_b128 v[104:107], v126 offset:6144
    s_waitcnt lgkmcnt(3)
    v_mfma_f32_16x16x32_bf16 v[72:75], v[108:111], v[8:11], v[72:75]
    v_cvt_pk_bf16_f32 v112, v80, v84
    v_mfma_f32_16x16x32_bf16 v[76:79], v[108:111], v[12:15], v[76:79]
    buffer_store_dword v112, v125, s[16:19], 0 offen offset:0 nt
    ds_read_b128 v[108:111], v126 offset:7168
    s_waitcnt lgkmcnt(3)
    v_mfma_f32_16x16x32_bf16 v[64:67], v[96:99], v[16:19], v[64:67]
    v_cvt_pk_bf16_f32 v113, v81, v85
    v_mfma_f32_16x16x32_bf16 v[68:71], v[96:99], v[20:23], v[68:71]
    buffer_store_dword v113, v125, s[16:19], 0 offen offset:512 nt
    ds_read_b128 v[96:99], v126 offset:8192
    s_waitcnt lgkmcnt(3)
    v_mfma_f32_16x16x32_bf16 v[72:75], v[100:103], v[16:19], v[72:75]
    v_cvt_pk_bf16_f32 v114, v82, v86
    v_mfma_f32_16x16x32_bf16 v[76:79], v[100:103], v[20:23], v[76:79]
    buffer_store_dword v114, v125, s[16:19], 0 offen offset:1024 nt
    ds_read_b128 v[100:103], v126 offset:9216
    s_waitcnt lgkmcnt(3)
    v_mfma_f32_16x16x32_bf16 v[64:67], v[104:107], v[24:27], v[64:67]
    v_cvt_pk_bf16_f32 v115, v83, v87
    v_mfma_f32_16x16x32_bf16 v[68:71], v[104:107], v[28:31], v[68:71]
    buffer_store_dword v115, v125, s[16:19], 0 offen offset:1536 nt
    ds_read_b128 v[104:107], v126 offset:10240
    s_waitcnt lgkmcnt(3)
    v_mfma_f32_16x16x32_bf16 v[72:75], v[108:111], v[24:27], v[72:75]
    v_cvt_pk_bf16_f32 v116, v88, v92
    v_mfma_f32_16x16x32_bf16 v[76:79], v[108:111], v[28:31], v[76:79]
    buffer_store_dword v116, v125, s[16:19], s44 offen offset:0 nt
    ds_read_b128 v[108:111], v126 offset:11264
    s_waitcnt lgkmcnt(3)
    v_mfma_f32_16x16x32_bf16 v[64:67], v[96:99], v[32:35], v[64:67]
    v_cvt_pk_bf16_f32 v117, v89, v93
    v_mfma_f32_16x16x32_bf16 v[68:71], v[96:99], v[36:39], v[68:71]
    buffer_store_dword v117, v125, s[16:19], s44 offen offset:512 nt
    ds_read_b128 v[96:99], v126 offset:12288
    s_waitcnt lgkmcnt(3)
    v_mfma_f32_16x16x32_bf16 v[72:75], v[100:103], v[32:35], v[72:75]
    v_cvt_pk_bf16_f32 v118, v90, v94
    v_mfma_f32_16x16x32_bf16 v[76:79], v[100:103], v[36:39], v[76:79]
    buffer_store_dword v118, v125, s[16:19], s44 offen offset:1024 nt
    ds_read_b128 v[100:103], v126 offset:13312
    s_waitcnt lgkmcnt(3)
    v_mfma_f32_16x16x32_bf16 v[64:67], v[104:107], v[40:43], v[64:67]
    v_cvt_pk_bf16_f32 v119, v91, v95
    v_mfma_f32_16x16x32_bf16 v[68:71], v[104:107], v[44:47], v[68:71]
    buffer_store_dword v119, v125, s[16:19], s44 offen offset:1536 nt
    ds_read_b128 v[104:107], v126 offset:14336
    s_waitcnt lgkmcnt(3)
    v_mfma_f32_16x16x32_bf16 v[72:75], v[108:111], v[40:43], v[72:75]
    v_add_u32 v125, 16384, v125
    v_mfma_f32_16x16x32_bf16 v[76:79], v[108:111], v[44:47], v[76:79]
    ds_read_b128 v[108:111], v126 offset:15360
    s_waitcnt lgkmcnt(3)
    v_mfma_f32_16x16x32_bf16 v[64:67], v[96:99], v[48:51], v[64:67]
    v_mfma_f32_16x16x32_bf16 v[68:71], v[96:99], v[52:55], v[68:71]
    s_waitcnt lgkmcnt(0)
    s_barrier
    ds_read_b128 v[96:99], v126 offset:16384
    v_mfma_f32_16x16x32_bf16 v[72:75], v[100:103], v[48:51], v[72:75]
    v_mfma_f32_16x16x32_bf16 v[76:79], v[100:103], v[52:55], v[76:79]
    ds_read_b128 v[100:103], v126 offset:17408
    v_mfma_f32_16x16x32_bf16 v[64:67], v[104:107], v[56:59], v[64:67]
    v_mfma_f32_16x16x32_bf16 v[68:71], v[104:107], v[60:63], v[68:71]
    ds_read_b128 v[104:107], v126 offset:18432
    v_mfma_f32_16x16x32_bf16 v[72:75], v[108:111], v[56:59], v[72:75]
    v_mfma_f32_16x16x32_bf16 v[76:79], v[108:111], v[60:63], v[76:79]
    ds_read_b128 v[108:111], v126 offset:19456
    s_waitcnt vmcnt(32)
    s_branch L_joint_kernel_oloop
L_joint_kernel_oend:
    s_nop 7
    v_cvt_pk_bf16_f32 v112, v80, v84
    buffer_store_dword v112, v125, s[16:19], 0 offen offset:0 nt
    v_cvt_pk_bf16_f32 v113, v81, v85
    buffer_store_dword v113, v125, s[16:19], 0 offen offset:512 nt
    v_cvt_pk_bf16_f32 v114, v82, v86
    buffer_store_dword v114, v125, s[16:19], 0 offen offset:1024 nt
    v_cvt_pk_bf16_f32 v115, v83, v87
    buffer_store_dword v115, v125, s[16:19], 0 offen offset:1536 nt
    v_cvt_pk_bf16_f32 v116, v88, v92
    buffer_store_dword v116, v125, s[16:19], s44 offen offset:0 nt
    v_cvt_pk_bf16_f32 v117, v89, v93
    buffer_store_dword v117, v125, s[16:19], s44 offen offset:512 nt
    v_cvt_pk_bf16_f32 v118, v90, v94
    buffer_store_dword v118, v125, s[16:19], s44 offen offset:1024 nt
    v_cvt_pk_bf16_f32 v119, v91, v95
    buffer_store_dword v119, v125, s[16:19], s44 offen offset:1536 nt
    v_add_u32 v125, 16384, v125
    s_branch L_joint_kernel_fin
L_joint_kernel_T:
    s_setprio 3
    s_lshl_b32 s36, s21, 2
    s_add_u32 s36, s36, 44335104
    s_add_u32 s36, s30, s36
    s_addc_u32 s37, s31, 0
    s_load_dword s44, s[36:37], 0
    v_and_b32 v123, 15, v127
    v_lshrrev_b32 v121, 4, v127
    v_mul_u32_u24 v125, 528, v123
    v_lshl_add_u32 v125, v121, 4, v125
    v_lshlrev_b32 v121, 5, v121
    v_and_b32 v120, 7, v127
    v_lshl_add_u32 v124, v120, 10, v121
    s_lshl_b32 s38, s21, 7
    v_mul_u32_u24 v120, 1040, v120
    s_add_u32 s36, s38, 91136
    v_add3_u32 v120, v120, v121, s36
    s_mul_i32 s36, s21, 5184
    s_add_u32 s36, s36, 49664
    v_add_u32 v121, s36, v121
    v_mul_u32_u24 v122, 144, v123
    v_add_u32 v122, v122, v121
    v_lshrrev_b32 v123, 3, v123
    v_mul_u32_u24 v123, 144, v123
    v_add_u32 v121, v123, v121
    s_lshl_b32 s36, s21, 11
    v_add_u32 v123, s36, v126
    s_barrier
    s_mov_b32 s36, 0
    buffer_load_dwordx4 v[0:3], v126, s[12:15], s36 offen offset:0
    buffer_load_dwordx4 v[4:7], v126, s[12:15], s36 offen offset:1024
    buffer_load_dwordx4 v[8:11], v126, s[12:15], s36 offen offset:2048
    buffer_load_dwordx4 v[12:15], v126, s[12:15], s36 offen offset:3072
    s_mov_b32 s36, 4096
    buffer_load_dwordx4 v[16:19], v126, s[12:15], s36 offen offset:0
    buffer_load_dwordx4 v[20:23], v126, s[12:15], s36 offen offset:1024
    buffer_load_dwordx4 v[24:27], v126, s[12:15], s36 offen offset:2048
    buffer_load_dwordx4 v[28:31], v126, s[12:15], s36 offen offset:3072
    s_mov_b32 s36, 8192
    buffer_load_dwordx4 v[32:35], v126, s[12:15], s36 offen offset:0
    buffer_load_dwordx4 v[36:39], v126, s[12:15], s36 offen offset:1024
    buffer_load_dwordx4 v[40:43], v126, s[12:15], s36 offen offset:2048
    buffer_load_dwordx4 v[44:47], v126, s[12:15], s36 offen offset:3072
    s_mov_b32 s36, 12288
    buffer_load_dwordx4 v[48:51], v126, s[12:15], s36 offen offset:0
    buffer_load_dwordx4 v[52:55], v126, s[12:15], s36 offen offset:1024
    buffer_load_dwordx4 v[56:59], v126, s[12:15], s36 offen offset:2048
    buffer_load_dwordx4 v[60:63], v126, s[12:15], s36 offen offset:3072
    v_mov_b32 v64, 99456
    v_mov_b32 v65, 1
    s_mov_b64 exec, 1
    ds_add_u32 v64, v65 offset:4
    s_mov_b64 exec, -1
L_joint_kernel_tw:
    ds_read_b32 v65, v64 offset:0
    s_waitcnt lgkmcnt(0)
    v_readfirstlane_b32 s37, v65
    s_cmp_ge_u32 s37, 8
    s_cbranch_scc1 L_joint_kernel_tw_d
    s_sleep 1
    s_branch L_joint_kernel_tw
L_joint_kernel_tw_d:
    ds_read_b128 v[80:83], v125 offset:32768
    ds_read_b128 v[84:87], v125 offset:41216
    ds_read_b128 v[88:91], v125 offset:32832
    ds_read_b128 v[92:95], v125 offset:41280
    ds_read_b128 v[96:99], v125 offset:32896
    ds_read_b128 v[100:103], v125 offset:41344
    ds_read_b128 v[104:107], v125 offset:32960
    ds_read_b128 v[108:111], v125 offset:41408
    s_setprio 0
    s_waitcnt vmcnt(14) lgkmcnt(7)
    v_mfma_f32_16x16x32_bf16 v[64:67], v[0:3], v[80:83], 0
    v_mfma_f32_16x16x32_bf16 v[68:71], v[4:7], v[80:83], 0
    ds_read_b128 v[80:83], v125 offset:33024
    s_waitcnt lgkmcnt(7)
    v_mfma_f32_16x16x32_bf16 v[72:75], v[0:3], v[84:87], 0
    v_mfma_f32_16x16x32_bf16 v[76:79], v[4:7], v[84:87], 0
    ds_read_b128 v[84:87], v125 offset:41472
    s_waitcnt vmcnt(12) lgkmcnt(7)
    v_mfma_f32_16x16x32_bf16 v[64:67], v[8:11], v[88:91], v[64:67]
    v_mfma_f32_16x16x32_bf16 v[68:71], v[12:15], v[88:91], v[68:71]
    ds_read_b128 v[88:91], v125 offset:33088
    s_waitcnt lgkmcnt(7)
    v_mfma_f32_16x16x32_bf16 v[72:75], v[8:11], v[92:95], v[72:75]
    v_mfma_f32_16x16x32_bf16 v[76:79], v[12:15], v[92:95], v[76:79]
    ds_read_b128 v[92:95], v125 offset:41536
    s_waitcnt vmcnt(10) lgkmcnt(7)
    v_mfma_f32_16x16x32_bf16 v[64:67], v[16:19], v[96:99], v[64:67]
    v_mfma_f32_16x16x32_bf16 v[68:71], v[20:23], v[96:99], v[68:71]
    ds_read_b128 v[96:99], v125 offset:33152
    s_waitcnt lgkmcnt(7)
    v_mfma_f32_16x16x32_bf16 v[72:75], v[16:19], v[100:103], v[72:75]
    v_mfma_f32_16x16x32_bf16 v[76:79], v[20:23], v[100:103], v[76:79]
    ds_read_b128 v[100:103], v125 offset:41600
    s_waitcnt vmcnt(8) lgkmcnt(7)
    v_mfma_f32_16x16x32_bf16 v[64:67], v[24:27], v[104:107], v[64:67]
    v_mfma_f32_16x16x32_bf16 v[68:71], v[28:31], v[104:107], v[68:71]
    ds_read_b128 v[104:107], v125 offset:33216
    s_waitcnt lgkmcnt(7)
    v_mfma_f32_16x16x32_bf16 v[72:75], v[24:27], v[108:111], v[72:75]
    v_mfma_f32_16x16x32_bf16 v[76:79], v[28:31], v[108:111], v[76:79]
    ds_read_b128 v[108:111], v125 offset:41664
    s_waitcnt vmcnt(6) lgkmcnt(7)
    v_mfma_f32_16x16x32_bf16 v[64:67], v[32:35], v[80:83], v[64:67]
    v_mfma_f32_16x16x32_bf16 v[68:71], v[36:39], v[80:83], v[68:71]
    ds_read_b128 v[112:115], v120 offset:0
    s_waitcnt lgkmcnt(7)
    v_mfma_f32_16x16x32_bf16 v[72:75], v[32:35], v[84:87], v[72:75]
    v_mfma_f32_16x16x32_bf16 v[76:79], v[36:39], v[84:87], v[76:79]
    ds_read_b128 v[116:119], v120 offset:16
    s_waitcnt vmcnt(4) lgkmcnt(7)
    v_mfma_f32_16x16x32_bf16 v[64:67], v[40:43], v[88:91], v[64:67]
    v_mfma_f32_16x16x32_bf16 v[68:71], v[44:47], v[88:91], v[68:71]
    s_waitcnt lgkmcnt(6)
    v_mfma_f32_16x16x32_bf16 v[72:75], v[40:43], v[92:95], v[72:75]
    v_mfma_f32_16x16x32_bf16 v[76:79], v[44:47], v[92:95], v[76:79]
    s_waitcnt vmcnt(2) lgkmcnt(5)
    v_mfma_f32_16x16x32_bf16 v[64:67], v[48:51], v[96:99], v[64:67]
    v_mfma_f32_16x16x32_bf16 v[68:71], v[52:55], v[96:99], v[68:71]
    s_waitcnt lgkmcnt(4)
    v_mfma_f32_16x16x32_bf16 v[72:75], v[48:51], v[100:103], v[72:75]
    v_mfma_f32_16x16x32_bf16 v[76:79], v[52:55], v[100:103], v[76:79]
    s_waitcnt vmcnt(0) lgkmcnt(3)
    v_mfma_f32_16x16x32_bf16 v[64:67], v[56:59], v[104:107], v[64:67]
    v_mfma_f32_16x16x32_bf16 v[68:71], v[60:63], v[104:107], v[68:71]
    s_waitcnt lgkmcnt(2)
    v_mfma_f32_16x16x32_bf16 v[72:75], v[56:59], v[108:111], v[72:75]
    v_mfma_f32_16x16x32_bf16 v[76:79], v[60:63], v[108:111], v[76:79]
    s_mov_b32 s46, 0xffff0000
    s_mov_b32 s48, 0x4038aa3b
    s_mov_b32 s49, s48
    s_nop 3
    v_mov_b32 v28, 0
    s_waitcnt lgkmcnt(0)
    v_cvt_pk_bf16_f32 v24, v64, v68
    v_cvt_pk_bf16_f32 v25, v65, v69
    v_cvt_pk_bf16_f32 v26, v66, v70
    v_cvt_pk_bf16_f32 v27, v67, v71
    v_lshlrev_b32 v80, 16, v24
    v_and_b32 v81, s46, v24
    v_lshlrev_b32 v82, 16, v25
    v_and_b32 v83, s46, v25
    v_lshlrev_b32 v84, 16, v26
    v_and_b32 v85, s46, v26
    v_lshlrev_b32 v86, 16, v27
    v_and_b32 v87, s46, v27
    v_pk_mul_f32 v[80:81], v[80:81], s[48:49]
    v_pk_mul_f32 v[82:83], v[82:83], s[48:49]
    v_pk_mul_f32 v[84:85], v[84:85], s[48:49]
    v_pk_mul_f32 v[86:87], v[86:87], s[48:49]
    v_exp_f32 v96, v80
    v_exp_f32 v97, v81
    v_exp_f32 v98, v82
    v_exp_f32 v99, v83
    v_max3_f32 v28, |v80|, |v81|, v28
    v_max3_f32 v28, |v82|, |v83|, v28
    ds_write_b128 v122, v[96:99] offset:0
    v_exp_f32 v100, v84
    v_exp_f32 v101, v85
    v_exp_f32 v102, v86
    v_exp_f32 v103, v87
    v_max3_f32 v28, |v84|, |v85|, v28
    v_max3_f32 v28, |v86|, |v87|, v28
    ds_write_b128 v122, v[100:103] offset:16
    v_cvt_pk_bf16_f32 v24, v72, v76
    v_cvt_pk_bf16_f32 v25, v73, v77
    v_cvt_pk_bf16_f32 v26, v74, v78
    v_cvt_pk_bf16_f32 v27, v75, v79
    v_lshlrev_b32 v88, 16, v24
    v_and_b32 v89, s46, v24
    v_lshlrev_b32 v90, 16, v25
    v_and_b32 v91, s46, v25
    v_lshlrev_b32 v92, 16, v26
    v_and_b32 v93, s46, v26
    v_lshlrev_b32 v94, 16, v27
    v_and_b32 v95, s46, v27
    v_pk_mul_f32 v[88:89], v[88:89], s[48:49]
    v_pk_mul_f32 v[90:91], v[90:91], s[48:49]
    v_pk_mul_f32 v[92:93], v[92:93], s[48:49]
    v_pk_mul_f32 v[94:95], v[94:95], s[48:49]
    v_exp_f32 v104, v88
    v_exp_f32 v105, v89
    v_exp_f32 v106, v90
    v_exp_f32 v107, v91
    v_max3_f32 v28, |v88|, |v89|, v28
    v_max3_f32 v28, |v90|, |v91|, v28
    ds_write_b128 v122, v[104:107] offset:2304
    v_exp_f32 v108, v92
    v_exp_f32 v109, v93
    v_exp_f32 v110, v94
    v_exp_f32 v111, v95
    v_max3_f32 v28, |v92|, |v93|, v28
    v_max3_f32 v28, |v94|, |v95|, v28
    ds_write_b128 v122, v[108:111] offset:2320
    v_cmp_lt_f32 vcc, 0x42f00000, v28
    s_mov_b32 s22, 4
    s_or_b32 s44, s44, vcc_lo
    s_or_b32 s44, s44, vcc_hi
    s_cmp_lg_u32 s44, 0
    s_cbranch_scc1 L_joint_kernel_tslow
    ds_read_b128 v[32:35], v121 offset:0
    ds_read_b128 v[36:39], v121 offset:16
    ds_read_b128 v[40:43], v121 offset:288
    ds_read_b128 v[44:47], v121 offset:304
    v_add_u32 v121, 576, v121
    s_waitcnt vmcnt(0) lgkmcnt(0)
L_joint_kernel_tloop1:
    v_fma_f32 v48, v112, v32, 1.0
    v_fma_f32 v49, v113, v33, 1.0
    v_fma_f32 v50, v114, v34, 1.0
    v_fma_f32 v51, v115, v35, 1.0
    v_fma_f32 v52, v116, v36, 1.0
    v_fma_f32 v53, v117, v37, 1.0
    v_fma_f32 v54, v118, v38, 1.0
    v_fma_f32 v55, v119, v39, 1.0
    v_fma_f32 v56, v112, v40, 1.0
    v_fma_f32 v57, v113, v41, 1.0
    v_fma_f32 v58, v114, v42, 1.0
    v_fma_f32 v59, v115, v43, 1.0
    v_fma_f32 v60, v116, v44, 1.0
    v_fma_f32 v61, v117, v45, 1.0
    v_fma_f32 v62, v118, v46, 1.0
    v_fma_f32 v63, v119, v47, 1.0
    ds_read_b128 v[32:35], v121 offset:0
    ds_read_b128 v[36:39], v121 offset:16
    ds_read_b128 v[40:43], v121 offset:288
    ds_read_b128 v[44:47], v121 offset:304
    v_add_u32 v121, 576, v121
    v_rcp_f32 v48, v48
    v_rcp_f32 v49, v49
    v_rcp_f32 v50, v50
    v_rcp_f32 v51, v51
    v_rcp_f32 v52, v52
    v_rcp_f32 v53, v53
    v_rcp_f32 v54, v54
    v_rcp_f32 v55, v55
    v_fma_f32 v48, v48, -2.0, 1.0
    v_fma_f32 v49, v49, -2.0, 1.0
    v_fma_f32 v50, v50, -2.0, 1.0
    v_fma_f32 v51, v51, -2.0, 1.0
    v_fma_f32 v52, v52, -2.0, 1.0
    v_fma_f32 v53, v53, -2.0, 1.0
    v_fma_f32 v54, v54, -2.0, 1.0
    v_fma_f32 v55, v55, -2.0, 1.0
    v_cvt_pk_bf16_f32 v64, v48, v49
    v_cvt_pk_bf16_f32 v65, v50, v51
    v_cvt_pk_bf16_f32 v66, v52, v53
    v_cvt_pk_bf16_f32 v67, v54, v55
    ds_write_b128 v123, v[64:67] offset:0
    v_rcp_f32 v56, v56
    v_rcp_f32 v57, v57
    v_rcp_f32 v58, v58
    v_rcp_f32 v59, v59
    v_rcp_f32 v60, v60
    v_rcp_f32 v61, v61
    v_rcp_f32 v62, v62
    v_rcp_f32 v63, v63
    v_fma_f32 v56, v56, -2.0, 1.0
    v_fma_f32 v57, v57, -2.0, 1.0
    v_fma_f32 v58, v58, -2.0, 1.0
    v_fma_f32 v59, v59, -2.0, 1.0
    v_fma_f32 v60, v60, -2.0, 1.0
    v_fma_f32 v61, v61, -2.0, 1.0
    v_fma_f32 v62, v62, -2.0, 1.0
    v_fma_f32 v63, v63, -2.0, 1.0
    v_cvt_pk_bf16_f32 v68, v56, v57
    v_cvt_pk_bf16_f32 v69, v58, v59
    v_cvt_pk_bf16_f32 v70, v60, v61
    v_cvt_pk_bf16_f32 v71, v62, v63
    ds_write_b128 v123, v[68:71] offset:1024
    s_waitcnt lgkmcnt(0)
    s_barrier
    v_fma_f32 v48, v112, v32, 1.0
    v_fma_f32 v49, v113, v33, 1.0
    v_fma_f32 v50, v114, v34, 1.0
    v_fma_f32 v51, v115, v35, 1.0
    v_fma_f32 v52, v116, v36, 1.0
    v_fma_f32 v53, v117, v37, 1.0
    v_fma_f32 v54, v118, v38, 1.0
    v_fma_f32 v55, v119, v39, 1.0
    v_fma_f32 v56, v112, v40, 1.0
    v_fma_f32 v57, v113, v41, 1.0
    v_fma_f32 v58, v114, v42, 1.0
    v_fma_f32 v59, v115, v43, 1.0
    v_fma_f32 v60, v116, v44, 1.0
    v_fma_f32 v61, v117, v45, 1.0
    v_fma_f32 v62, v118, v46, 1.0
    v_fma_f32 v63, v119, v47, 1.0
    ds_read_b128 v[32:35], v121 offset:0
    ds_read_b128 v[36:39], v121 offset:16
    ds_read_b128 v[40:43], v121 offset:288
    ds_read_b128 v[44:47], v121 offset:304
    v_add_u32 v121, 576, v121
    v_rcp_f32 v48, v48
    v_rcp_f32 v49, v49
    v_rcp_f32 v50, v50
    v_rcp_f32 v51, v51
    v_rcp_f32 v52, v52
    v_rcp_f32 v53, v53
    v_rcp_f32 v54, v54
    v_rcp_f32 v55, v55
    v_fma_f32 v48, v48, -2.0, 1.0
    v_fma_f32 v49, v49, -2.0, 1.0
    v_fma_f32 v50, v50, -2.0, 1.0
    v_fma_f32 v51, v51, -2.0, 1.0
    v_fma_f32 v52, v52, -2.0, 1.0
    v_fma_f32 v53, v53, -2.0, 1.0
    v_fma_f32 v54, v54, -2.0, 1.0
    v_fma_f32 v55, v55, -2.0, 1.0
    v_cvt_pk_bf16_f32 v64, v48, v49
    v_cvt_pk_bf16_f32 v65, v50, v51
    v_cvt_pk_bf16_f32 v66, v52, v53
    v_cvt_pk_bf16_f32 v67, v54, v55
    ds_write_b128 v123, v[64:67] offset:16384
    v_rcp_f32 v56, v56
    v_rcp_f32 v57, v57
    v_rcp_f32 v58, v58
    v_rcp_f32 v59, v59
    v_rcp_f32 v60, v60
    v_rcp_f32 v61, v61
    v_rcp_f32 v62, v62
    v_rcp_f32 v63, v63
    v_fma_f32 v56, v56, -2.0, 1.0
    v_fma_f32 v57, v57, -2.0, 1.0
    v_fma_f32 v58, v58, -2.0, 1.0
    v_fma_f32 v59, v59, -2.0, 1.0
    v_fma_f32 v60, v60, -2.0, 1.0
    v_fma_f32 v61, v61, -2.0, 1.0
    v_fma_f32 v62, v62, -2.0, 1.0
    v_fma_f32 v63, v63, -2.0, 1.0
    v_cvt_pk_bf16_f32 v68, v56, v57
    v_cvt_pk_bf16_f32 v69, v58, v59
    v_cvt_pk_bf16_f32 v70, v60, v61
    v_cvt_pk_bf16_f32 v71, v62, v63
    ds_write_b128 v123, v[68:71] offset:17408
    s_waitcnt lgkmcnt(0)
    s_barrier
    s_sub_u32 s22, s22, 1
    s_cmp_lg_u32 s22, 0
    s_cbranch_scc1 L_joint_kernel_tloop1
    s_branch L_joint_kernel_fin
L_joint_kernel_tslow:
    buffer_load_dwordx4 v[112:115], v124, s[40:43], s38 offen offset:0
    buffer_load_dwordx4 v[116:119], v124, s[40:43], s38 offen offset:16
    ds_write_b128 v122, v[80:83] offset:0
    ds_write_b128 v122, v[84:87] offset:16
    ds_write_b128 v122, v[88:91] offset:2304
    ds_write_b128 v122, v[92:95] offset:2320
    ds_read_b128 v[32:35], v121 offset:0
    ds_read_b128 v[36:39], v121 offset:16
    ds_read_b128 v[40:43], v121 offset:288
    ds_read_b128 v[44:47], v121 offset:304
    v_add_u32 v121, 576, v121
    s_waitcnt vmcnt(0) lgkmcnt(0)
L_joint_kernel_tloop0:
    v_add_f32 v48, v112, v32
    v_add_f32 v49, v113, v33
    v_add_f32 v50, v114, v34
    v_add_f32 v51, v115, v35
    v_add_f32 v52, v116, v36
    v_add_f32 v53, v117, v37
    v_add_f32 v54, v118, v38
    v_add_f32 v55, v119, v39
    v_add_f32 v56, v112, v40
    v_add_f32 v57, v113, v41
    v_add_f32 v58, v114, v42
    v_add_f32 v59, v115, v43
    v_add_f32 v60, v116, v44
    v_add_f32 v61, v117, v45
    v_add_f32 v62, v118, v46
    v_add_f32 v63, v119, v47
    ds_read_b128 v[32:35], v121 offset:0
    ds_read_b128 v[36:39], v121 offset:16
    ds_read_b128 v[40:43], v121 offset:288
    ds_read_b128 v[44:47], v121 offset:304
    v_add_u32 v121, 576, v121
    v_exp_f32 v48, v48
    v_exp_f32 v49, v49
    v_exp_f32 v50, v50
    v_exp_f32 v51, v51
    v_exp_f32 v52, v52
    v_exp_f32 v53, v53
    v_exp_f32 v54, v54
    v_exp_f32 v55, v55
    v_add_f32 v48, 1.0, v48
    v_add_f32 v49, 1.0, v49
    v_add_f32 v50, 1.0, v50
    v_add_f32 v51, 1.0, v51
    v_add_f32 v52, 1.0, v52
    v_add_f32 v53, 1.0, v53
    v_add_f32 v54, 1.0, v54
    v_add_f32 v55, 1.0, v55
    v_rcp_f32 v48, v48
    v_rcp_f32 v49, v49
    v_rcp_f32 v50, v50
    v_rcp_f32 v51, v51
    v_rcp_f32 v52, v52
    v_rcp_f32 v53, v53
    v_rcp_f32 v54, v54
    v_rcp_f32 v55, v55
    v_fma_f32 v48, v48, -2.0, 1.0
    v_fma_f32 v49, v49, -2.0, 1.0
    v_fma_f32 v50, v50, -2.0, 1.0
    v_fma_f32 v51, v51, -2.0, 1.0
    v_fma_f32 v52, v52, -2.0, 1.0
    v_fma_f32 v53, v53, -2.0, 1.0
    v_fma_f32 v54, v54, -2.0, 1.0
    v_fma_f32 v55, v55, -2.0, 1.0
    v_cvt_pk_bf16_f32 v64, v48, v49
    v_cvt_pk_bf16_f32 v65, v50, v51
    v_cvt_pk_bf16_f32 v66, v52, v53
    v_cvt_pk_bf16_f32 v67, v54, v55
    ds_write_b128 v123, v[64:67] offset:0
    v_exp_f32 v56, v56
    v_exp_f32 v57, v57
    v_exp_f32 v58, v58
    v_exp_f32 v59, v59
    v_exp_f32 v60, v60
    v_exp_f32 v61, v61
    v_exp_f32 v62, v62
    v_exp_f32 v63, v63
    v_add_f32 v56, 1.0, v56
    v_add_f32 v57, 1.0, v57
    v_add_f32 v58, 1.0, v58
    v_add_f32 v59, 1.0, v59
    v_add_f32 v60, 1.0, v60
    v_add_f32 v61, 1.0, v61
    v_add_f32 v62, 1.0, v62
    v_add_f32 v63, 1.0, v63
    v_rcp_f32 v56, v56
    v_rcp_f32 v57, v57
    v_rcp_f32 v58, v58
    v_rcp_f32 v59, v59
    v_rcp_f32 v60, v60
    v_rcp_f32 v61, v61
    v_rcp_f32 v62, v62
    v_rcp_f32 v63, v63
    v_fma_f32 v56, v56, -2.0, 1.0
    v_fma_f32 v57, v57, -2.0, 1.0
    v_fma_f32 v58, v58, -2.0, 1.0
    v_fma_f32 v59, v59, -2.0, 1.0
    v_fma_f32 v60, v60, -2.0, 1.0
    v_fma_f32 v61, v61, -2.0, 1.0
    v_fma_f32 v62, v62, -2.0, 1.0
    v_fma_f32 v63, v63, -2.0, 1.0
    v_cvt_pk_bf16_f32 v68, v56, v57
    v_cvt_pk_bf16_f32 v69, v58, v59
    v_cvt_pk_bf16_f32 v70, v60, v61
    v_cvt_pk_bf16_f32 v71, v62, v63
    ds_write_b128 v123, v[68:71] offset:1024
    s_waitcnt lgkmcnt(0)
    s_barrier
    v_add_f32 v48, v112, v32
    v_add_f32 v49, v113, v33
    v_add_f32 v50, v114, v34
    v_add_f32 v51, v115, v35
    v_add_f32 v52, v116, v36
    v_add_f32 v53, v117, v37
    v_add_f32 v54, v118, v38
    v_add_f32 v55, v119, v39
    v_add_f32 v56, v112, v40
    v_add_f32 v57, v113, v41
    v_add_f32 v58, v114, v42
    v_add_f32 v59, v115, v43
    v_add_f32 v60, v116, v44
    v_add_f32 v61, v117, v45
    v_add_f32 v62, v118, v46
    v_add_f32 v63, v119, v47
    ds_read_b128 v[32:35], v121 offset:0
    ds_read_b128 v[36:39], v121 offset:16
    ds_read_b128 v[40:43], v121 offset:288
    ds_read_b128 v[44:47], v121 offset:304
    v_add_u32 v121, 576, v121
    v_exp_f32 v48, v48
    v_exp_f32 v49, v49
    v_exp_f32 v50, v50
    v_exp_f32 v51, v51
    v_exp_f32 v52, v52
    v_exp_f32 v53, v53
    v_exp_f32 v54, v54
    v_exp_f32 v55, v55
    v_add_f32 v48, 1.0, v48
    v_add_f32 v49, 1.0, v49
    v_add_f32 v50, 1.0, v50
    v_add_f32 v51, 1.0, v51
    v_add_f32 v52, 1.0, v52
    v_add_f32 v53, 1.0, v53
    v_add_f32 v54, 1.0, v54
    v_add_f32 v55, 1.0, v55
    v_rcp_f32 v48, v48
    v_rcp_f32 v49, v49
    v_rcp_f32 v50, v50
    v_rcp_f32 v51, v51
    v_rcp_f32 v52, v52
    v_rcp_f32 v53, v53
    v_rcp_f32 v54, v54
    v_rcp_f32 v55, v55
    v_fma_f32 v48, v48, -2.0, 1.0
    v_fma_f32 v49, v49, -2.0, 1.0
    v_fma_f32 v50, v50, -2.0, 1.0
    v_fma_f32 v51, v51, -2.0, 1.0
    v_fma_f32 v52, v52, -2.0, 1.0
    v_fma_f32 v53, v53, -2.0, 1.0
    v_fma_f32 v54, v54, -2.0, 1.0
    v_fma_f32 v55, v55, -2.0, 1.0
    v_cvt_pk_bf16_f32 v64, v48, v49
    v_cvt_pk_bf16_f32 v65, v50, v51
    v_cvt_pk_bf16_f32 v66, v52, v53
    v_cvt_pk_bf16_f32 v67, v54, v55
    ds_write_b128 v123, v[64:67] offset:16384
    v_exp_f32 v56, v56
    v_exp_f32 v57, v57
    v_exp_f32 v58, v58
    v_exp_f32 v59, v59
    v_exp_f32 v60, v60
    v_exp_f32 v61, v61
    v_exp_f32 v62, v62
    v_exp_f32 v63, v63
    v_add_f32 v56, 1.0, v56
    v_add_f32 v57, 1.0, v57
    v_add_f32 v58, 1.0, v58
    v_add_f32 v59, 1.0, v59
    v_add_f32 v60, 1.0, v60
    v_add_f32 v61, 1.0, v61
    v_add_f32 v62, 1.0, v62
    v_add_f32 v63, 1.0, v63
    v_rcp_f32 v56, v56
    v_rcp_f32 v57, v57
    v_rcp_f32 v58, v58
    v_rcp_f32 v59, v59
    v_rcp_f32 v60, v60
    v_rcp_f32 v61, v61
    v_rcp_f32 v62, v62
    v_rcp_f32 v63, v63
    v_fma_f32 v56, v56, -2.0, 1.0
    v_fma_f32 v57, v57, -2.0, 1.0
    v_fma_f32 v58, v58, -2.0, 1.0
    v_fma_f32 v59, v59, -2.0, 1.0
    v_fma_f32 v60, v60, -2.0, 1.0
    v_fma_f32 v61, v61, -2.0, 1.0
    v_fma_f32 v62, v62, -2.0, 1.0
    v_fma_f32 v63, v63, -2.0, 1.0
    v_cvt_pk_bf16_f32 v68, v56, v57
    v_cvt_pk_bf16_f32 v69, v58, v59
    v_cvt_pk_bf16_f32 v70, v60, v61
    v_cvt_pk_bf16_f32 v71, v62, v63
    ds_write_b128 v123, v[68:71] offset:17408
    s_waitcnt lgkmcnt(0)
    s_barrier
    s_sub_u32 s22, s22, 1
    s_cmp_lg_u32 s22, 0
    s_cbranch_scc1 L_joint_kernel_tloop0
L_joint_kernel_fin:
L_joint_kernel_done:
    s_endpgm
.section .rodata,"a"
.p2align 6
.amdhsa_kernel prep_kernel
  .amdhsa_next_free_vgpr 128
  .amdhsa_next_free_sgpr 102
  .amdhsa_accum_offset 128
  .amdhsa_group_segment_fixed_size 0
  .amdhsa_kernarg_size 80
  .amdhsa_user_sgpr_count 2
  .amdhsa_user_sgpr_kernarg_segment_ptr 1
  .amdhsa_system_sgpr_workgroup_id_x 1
.end_amdhsa_kernel
.p2align 6
.amdhsa_kernel conv1_kernel
  .amdhsa_next_free_vgpr 128
  .amdhsa_next_free_sgpr 102
  .amdhsa_accum_offset 128
  .amdhsa_group_segment_fixed_size 0
  .amdhsa_kernarg_size 80
  .amdhsa_user_sgpr_count 2
  .amdhsa_user_sgpr_kernarg_segment_ptr 1
  .amdhsa_system_sgpr_workgroup_id_x 1
.end_amdhsa_kernel
.p2align 6
.amdhsa_kernel conv2_kernel
  .amdhsa_next_free_vgpr 128
  .amdhsa_next_free_sgpr 102
  .amdhsa_accum_offset 128
  .amdhsa_group_segment_fixed_size 0
  .amdhsa_kernarg_size 80
  .amdhsa_user_sgpr_count 2
  .amdhsa_user_sgpr_kernarg_segment_ptr 1
  .amdhsa_system_sgpr_workgroup_id_x 1
.end_amdhsa_kernel
.p2align 6
.amdhsa_kernel joint_kernel
  .amdhsa_next_free_vgpr 128
  .amdhsa_next_free_sgpr 102
  .amdhsa_accum_offset 128
  .amdhsa_group_segment_fixed_size 0
  .amdhsa_kernarg_size 80
  .amdhsa_user_sgpr_count 2
  .amdhsa_user_sgpr_kernarg_segment_ptr 1
  .amdhsa_system_sgpr_workgroup_id_x 1
.end_amdhsa_kernel
```

```asm
; @launch kernel=prep_kernel grid=(268,1,1) block=(256,1,1) lds=4096
; @launch kernel=conv1_kernel grid=(256,1,1) block=(1024,1,1) lds=162816
; @launch kernel=conv2_kernel grid=(256,1,1) block=(1024,1,1) lds=162816
; @launch kernel=joint_kernel grid=(250,1,1) block=(1024,1,1) lds=99472
.amdgcn_target "amdgcn-amd-amdhsa--gfx950"
.text
.globl prep_kernel
.p2align 8
.type prep_kernel,@function
prep_kernel:
    s_cmp_ge_u32 s2, 268
    s_cbranch_scc1 L_prep_kernel_done
    s_mov_b32 s3, s2
    s_load_dwordx16 s[44:59], s[0:1], 0
    s_sub_u32 s2, s2, 12
    v_readfirstlane_b32 s40, v0
    s_lshr_b32 s40, s40, 6
    s_lshl_b32 s21, s2, 2
    s_add_u32 s20, s40, s21
    v_and_b32 v1, 63, v0
    s_load_dwordx2 s[8:9], s[0:1], 8
    s_load_dwordx2 s[30:31], s[0:1], 72
    s_lshr_b32 s22, s20, 8
    s_bfe_u32 s23, s20, 0x40004
    s_bfe_u32 s24, s20, 0x30001
    s_and_b32 s21, s20, 1
    v_lshrrev_b32 v2, 4, v1
    v_lshlrev_b32 v2, 12, v2
    v_and_b32 v3, 15, v1
    v_lshl_add_u32 v2, v3, 2, v2
    s_lshl_b32 s26, s22, 3
    s_lshr_b32 s27, s23, 3
    s_add_u32 s26, s26, s27
    s_lshl_b32 s26, s26, 17
    s_and_b32 s27, s23, 7
    s_lshl_b32 s27, s27, 14
    s_add_u32 s26, s26, s27
    s_lshl_b32 s27, s24, 6
    s_add_u32 s26, s26, s27
    s_mov_b32 s10, 4063232
    s_mov_b32 s11, 0x00020000
    s_lshr_b32 s41, s3, 2
    s_and_b32 s42, s3, 3
    s_lshl_b32 s42, s42, 1
    s_and_b32 s43, s40, 1
    s_add_u32 s42, s42, s43
    s_lshr_b32 s43, s40, 1
    s_lshl_b32 s4, s43, 16
    s_lshl_b32 s5, s42, 6
    s_add_u32 s4, s4, s5
    s_cmp_lt_u32 s3, 12
    s_cselect_b32 s26, s4, s26
    s_cselect_b32 s10, 131072, s10
    s_mov_b32 s5, 262144
    s_cselect_b32 s5, 16384, s5
    s_add_u32 s37, s26, s5
    s_add_u32 s38, s37, s5
    s_add_u32 s39, s38, s5
    s_waitcnt lgkmcnt(0)
    s_cmp_eq_u32 s41, 0
    s_cselect_b32 s8, s52, s8
    s_cselect_b32 s9, s53, s9
    s_cmp_eq_u32 s41, 1
    s_cselect_b32 s8, s56, s8
    s_cselect_b32 s9, s57, s9
    s_cmp_eq_u32 s41, 2
    s_cselect_b32 s8, s54, s8
    s_cselect_b32 s9, s55, s9
    buffer_load_dword v16, v2, s[8:11], s26 offen offset:0
    buffer_load_dword v17, v2, s[8:11], s26 offen offset:512
    buffer_load_dword v24, v2, s[8:11], s37 offen offset:0
    buffer_load_dword v25, v2, s[8:11], s37 offen offset:512
    buffer_load_dword v32, v2, s[8:11], s38 offen offset:0
    buffer_load_dword v33, v2, s[8:11], s38 offen offset:512
    buffer_load_dword v40, v2, s[8:11], s39 offen offset:0
    buffer_load_dword v41, v2, s[8:11], s39 offen offset:512
    buffer_load_dword v18, v2, s[8:11], s26 offen offset:1024
    buffer_load_dword v19, v2, s[8:11], s26 offen offset:1536
    buffer_load_dword v26, v2, s[8:11], s37 offen offset:1024
    buffer_load_dword v27, v2, s[8:11], s37 offen offset:1536
    buffer_load_dword v34, v2, s[8:11], s38 offen offset:1024
    buffer_load_dword v35, v2, s[8:11], s38 offen offset:1536
    buffer_load_dword v42, v2, s[8:11], s39 offen offset:1024
    buffer_load_dword v43, v2, s[8:11], s39 offen offset:1536
    buffer_load_dword v20, v2, s[8:11], s26 offen offset:2048
    buffer_load_dword v21, v2, s[8:11], s26 offen offset:2560
    buffer_load_dword v28, v2, s[8:11], s37 offen offset:2048
    buffer_load_dword v29, v2, s[8:11], s37 offen offset:2560
    buffer_load_dword v36, v2, s[8:11], s38 offen offset:2048
    buffer_load_dword v37, v2, s[8:11], s38 offen offset:2560
    buffer_load_dword v44, v2, s[8:11], s39 offen offset:2048
    buffer_load_dword v45, v2, s[8:11], s39 offen offset:2560
    buffer_load_dword v22, v2, s[8:11], s26 offen offset:3072
    buffer_load_dword v23, v2, s[8:11], s26 offen offset:3584
    buffer_load_dword v30, v2, s[8:11], s37 offen offset:3072
    buffer_load_dword v31, v2, s[8:11], s37 offen offset:3584
    buffer_load_dword v38, v2, s[8:11], s38 offen offset:3072
    buffer_load_dword v39, v2, s[8:11], s38 offen offset:3584
    buffer_load_dword v46, v2, s[8:11], s39 offen offset:3072
    buffer_load_dword v47, v2, s[8:11], s39 offen offset:3584
    s_cmp_lt_u32 s3, 12
    s_cbranch_scc1 L_prep_kernel_small
    s_add_u32 s12, s30, 0
    s_addc_u32 s13, s31, 0
    s_mov_b32 s14, 7340032
    s_mov_b32 s15, 0x00020000
    v_lshlrev_b32 v4, 4, v1
    s_lshl_b32 s27, s24, 4
    s_add_u32 s27, s27, s23
    s_mul_i32 s27, s27, 57344
    s_lshl_b32 s28, s22, 11
    s_add_u32 s27, s27, s28
    s_lshl_b32 s28, s21, 10
    s_add_u32 s27, s27, s28
    s_cmp_eq_u32 s21, 0
    s_mov_b32 s32, 0x07060302
    s_cselect_b32 s32, 0x05040100, s32
    s_mov_b32 s33, 0x03020c0c
    s_cselect_b32 s33, 0x01000c0c, s33
    s_mov_b32 s35, 0x3d2aaaab
    s_mov_b32 s36, 0x3c638e39
    s_waitcnt vmcnt(24)
    v_perm_b32 v72, v17, v16, s32
    v_perm_b32 v48, v41, v40, s32
    v_perm_b32 v76, v76, v40, s33
    v_perm_b32 v84, v84, v41, s33
    v_perm_b32 v77, v77, v32, s33
    v_perm_b32 v85, v85, v33, s33
    v_perm_b32 v78, v78, v24, s33
    v_perm_b32 v86, v86, v25, s33
    v_perm_b32 v79, v79, v16, s33
    v_perm_b32 v87, v87, v17, s33
    v_add_f32 v80, v76, v78
    v_add_f32 v88, v84, v86
    v_add_f32 v81, v77, v79
    v_add_f32 v89, v85, v87
    v_fma_f32 v82, v78, 4.0, v76
    v_fma_f32 v90, v86, 4.0, v84
    v_fma_f32 v83, v79, 4.0, v77
    v_fma_f32 v91, v87, 4.0, v85
    v_add_f32 v77, v80, v81
    v_add_f32 v85, v88, v89
    v_sub_f32 v78, v80, v81
    v_sub_f32 v86, v88, v89
    v_fma_f32 v79, v83, 2.0, v82
    v_fma_f32 v87, v91, 2.0, v90
    v_fma_f32 v82, v83, -2.0, v82
    v_fma_f32 v90, v91, -2.0, v90
    v_fmamk_f32 v80, v76, 0x41700000, v82
    v_fmamk_f32 v88, v84, 0x41700000, v90
    v_fmamk_f32 v80, v81, 0x41200000, v80
    v_fmamk_f32 v88, v89, 0x41200000, v88
    v_mul_f32 v77, 0.5, v77
    v_mul_f32 v85, 0.5, v85
    v_mul_f32 v78, 0.5, v78
    v_mul_f32 v86, 0.5, v86
    v_mul_f32 v79, s35, v79
    v_mul_f32 v87, s35, v87
    v_mul_f32 v82, s35, v82
    v_mul_f32 v90, s35, v90
    v_mul_f32 v80, s36, v80
    v_mul_f32 v88, s36, v88
    v_cvt_pk_bf16_f32 v52, v77, v85
    v_cvt_pk_bf16_f32 v56, v78, v86
    v_cvt_pk_bf16_f32 v60, v79, v87
    v_cvt_pk_bf16_f32 v64, v82, v90
    v_cvt_pk_bf16_f32 v68, v80, v88
    s_waitcnt vmcnt(16)
    v_perm_b32 v73, v19, v18, s32
    v_perm_b32 v49, v43, v42, s32
    v_perm_b32 v76, v76, v42, s33
    v_perm_b32 v84, v84, v43, s33
    v_perm_b32 v77, v77, v34, s33
    v_perm_b32 v85, v85, v35, s33
    v_perm_b32 v78, v78, v26, s33
    v_perm_b32 v86, v86, v27, s33
    v_perm_b32 v79, v79, v18, s33
    v_perm_b32 v87, v87, v19, s33
    v_add_f32 v80, v76, v78
    v_add_f32 v88, v84, v86
    v_add_f32 v81, v77, v79
    v_add_f32 v89, v85, v87
    v_fma_f32 v82, v78, 4.0, v76
    v_fma_f32 v90, v86, 4.0, v84
    v_fma_f32 v83, v79, 4.0, v77
    v_fma_f32 v91, v87, 4.0, v85
    v_add_f32 v77, v80, v81
    v_add_f32 v85, v88, v89
    v_sub_f32 v78, v80, v81
    v_sub_f32 v86, v88, v89
    v_fma_f32 v79, v83, 2.0, v82
    v_fma_f32 v87, v91, 2.0, v90
    v_fma_f32 v82, v83, -2.0, v82
    v_fma_f32 v90, v91, -2.0, v90
    v_fmamk_f32 v80, v76, 0x41700000, v82
    v_fmamk_f32 v88, v84, 0x41700000, v90
    v_fmamk_f32 v80, v81, 0x41200000, v80
    v_fmamk_f32 v88, v89, 0x41200000, v88
    v_mul_f32 v77, 0.5, v77
    v_mul_f32 v85, 0.5, v85
    v_mul_f32 v78, 0.5, v78
    v_mul_f32 v86, 0.5, v86
    v_mul_f32 v79, s35, v79
    v_mul_f32 v87, s35, v87
    v_mul_f32 v82, s35, v82
    v_mul_f32 v90, s35, v90
    v_mul_f32 v80, s36, v80
    v_mul_f32 v88, s36, v88
    v_cvt_pk_bf16_f32 v53, v77, v85
    v_cvt_pk_bf16_f32 v57, v78, v86
    v_cvt_pk_bf16_f32 v61, v79, v87
    v_cvt_pk_bf16_f32 v65, v82, v90
    v_cvt_pk_bf16_f32 v69, v80, v88
    s_waitcnt vmcnt(8)
    v_perm_b32 v74, v21, v20, s32
    v_perm_b32 v50, v45, v44, s32
    v_perm_b32 v76, v76, v44, s33
    v_perm_b32 v84, v84, v45, s33
    v_perm_b32 v77, v77, v36, s33
    v_perm_b32 v85, v85, v37, s33
    v_perm_b32 v78, v78, v28, s33
    v_perm_b32 v86, v86, v29, s33
    v_perm_b32 v79, v79, v20, s33
    v_perm_b32 v87, v87, v21, s33
    v_add_f32 v80, v76, v78
    v_add_f32 v88, v84, v86
    v_add_f32 v81, v77, v79
    v_add_f32 v89, v85, v87
    v_fma_f32 v82, v78, 4.0, v76
    v_fma_f32 v90, v86, 4.0, v84
    v_fma_f32 v83, v79, 4.0, v77
    v_fma_f32 v91, v87, 4.0, v85
    v_add_f32 v77, v80, v81
    v_add_f32 v85, v88, v89
    v_sub_f32 v78, v80, v81
    v_sub_f32 v86, v88, v89
    v_fma_f32 v79, v83, 2.0, v82
    v_fma_f32 v87, v91, 2.0, v90
    v_fma_f32 v82, v83, -2.0, v82
    v_fma_f32 v90, v91, -2.0, v90
    v_fmamk_f32 v80, v76, 0x41700000, v82
    v_fmamk_f32 v88, v84, 0x41700000, v90
    v_fmamk_f32 v80, v81, 0x41200000, v80
    v_fmamk_f32 v88, v89, 0x41200000, v88
    v_mul_f32 v77, 0.5, v77
    v_mul_f32 v85, 0.5, v85
    v_mul_f32 v78, 0.5, v78
    v_mul_f32 v86, 0.5, v86
    v_mul_f32 v79, s35, v79
    v_mul_f32 v87, s35, v87
    v_mul_f32 v82, s35, v82
    v_mul_f32 v90, s35, v90
    v_mul_f32 v80, s36, v80
    v_mul_f32 v88, s36, v88
    v_cvt_pk_bf16_f32 v54, v77, v85
    v_cvt_pk_bf16_f32 v58, v78, v86
    v_cvt_pk_bf16_f32 v62, v79, v87
    v_cvt_pk_bf16_f32 v66, v82, v90
    v_cvt_pk_bf16_f32 v70, v80, v88
    s_waitcnt vmcnt(0)
    s_cmp_ge_u32 s3, 44
    s_cbranch_scc1 L_prep_kernel_ncw
    s_getpc_b64 s[62:63]
L_prep_kernel_pc:
    s_and_b32 s64, s3, 8
    s_lshl_b32 s64, s64, 12
    v_lshlrev_b32 v120, 7, v0
    v_add_u32 v120, s64, v120
    v_min_u32 v120, L_joint_kernel_done-L_prep_kernel_pc, v120
    v_mov_b32 v121, s63
    v_add_co_u32 v120, vcc, s62, v120
    s_nop 1
    v_addc_co_u32 v121, vcc, 0, v121, vcc
    global_load_dword v122, v[120:121], off
L_prep_kernel_ncw:
    v_perm_b32 v75, v23, v22, s32
    v_perm_b32 v51, v47, v46, s32
    v_perm_b32 v76, v76, v46, s33
    v_perm_b32 v84, v84, v47, s33
    v_perm_b32 v77, v77, v38, s33
    v_perm_b32 v85, v85, v39, s33
    v_perm_b32 v78, v78, v30, s33
    v_perm_b32 v86, v86, v31, s33
    v_perm_b32 v79, v79, v22, s33
    v_perm_b32 v87, v87, v23, s33
    v_add_f32 v80, v76, v78
    v_add_f32 v88, v84, v86
    v_add_f32 v81, v77, v79
    v_add_f32 v89, v85, v87
    v_fma_f32 v82, v78, 4.0, v76
    v_fma_f32 v90, v86, 4.0, v84
    v_fma_f32 v83, v79, 4.0, v77
    v_fma_f32 v91, v87, 4.0, v85
    v_add_f32 v77, v80, v81
    v_add_f32 v85, v88, v89
    v_sub_f32 v78, v80, v81
    v_sub_f32 v86, v88, v89
    v_fma_f32 v79, v83, 2.0, v82
    v_fma_f32 v87, v91, 2.0, v90
    v_fma_f32 v82, v83, -2.0, v82
    v_fma_f32 v90, v91, -2.0, v90
    v_fmamk_f32 v80, v76, 0x41700000, v82
    v_fmamk_f32 v88, v84, 0x41700000, v90
    v_fmamk_f32 v80, v81, 0x41200000, v80
    v_fmamk_f32 v88, v89, 0x41200000, v88
    v_mul_f32 v77, 0.5, v77
    v_mul_f32 v85, 0.5, v85
    v_mul_f32 v78, 0.5, v78
    v_mul_f32 v86, 0.5, v86
    v_mul_f32 v79, s35, v79
    v_mul_f32 v87, s35, v87
    v_mul_f32 v82, s35, v82
    v_mul_f32 v90, s35, v90
    v_mul_f32 v80, s36, v80
    v_mul_f32 v88, s36, v88
    v_cvt_pk_bf16_f32 v55, v77, v85
    v_cvt_pk_bf16_f32 v59, v78, v86
    v_cvt_pk_bf16_f32 v63, v79, v87
    v_cvt_pk_bf16_f32 v67, v82, v90
    v_cvt_pk_bf16_f32 v71, v80, v88
    s_add_u32 s28, s27, 49152
    buffer_store_dwordx4 v[72:75], v4, s[12:15], s28 offen sc1
    s_add_u32 s28, s27, 0
    buffer_store_dwordx4 v[48:51], v4, s[12:15], s28 offen sc1
    s_add_u32 s28, s27, 8192
    buffer_store_dwordx4 v[52:55], v4, s[12:15], s28 offen sc1
    s_add_u32 s28, s27, 16384
    buffer_store_dwordx4 v[56:59], v4, s[12:15], s28 offen sc1
    s_add_u32 s28, s27, 24576
    buffer_store_dwordx4 v[60:63], v4, s[12:15], s28 offen sc1
    s_add_u32 s28, s27, 32768
    buffer_store_dwordx4 v[64:67], v4, s[12:15], s28 offen sc1
    s_add_u32 s28, s27, 40960
    buffer_store_dwordx4 v[68:71], v4, s[12:15], s28 offen sc1
L_prep_kernel_done:
    s_endpgm
L_prep_kernel_small:
    s_mov_b32 s16, s50
    s_mov_b32 s17, s51
    s_mov_b32 s18, 8192
    s_mov_b32 s19, 0x00020000
    v_lshrrev_b32 v2, 4, v1
    v_lshlrev_b32 v6, 9, v3
    v_lshl_add_u32 v6, v2, 4, v6
    s_lshl_b32 s24, s43, 8
    s_cmp_eq_u32 s41, 2
    s_cselect_b32 s24, s24, 0x100000
    buffer_load_dwordx4 v[80:83], v6, s[16:19], s24 offen offset:0
    buffer_load_dwordx4 v[84:87], v6, s[16:19], s24 offen offset:64
    buffer_load_dwordx4 v[88:91], v6, s[16:19], s24 offen offset:128
    buffer_load_dwordx4 v[92:95], v6, s[16:19], s24 offen offset:192
    s_lshl_b32 s24, s41, 17
    s_add_u32 s24, s24, 44040192
    s_add_u32 s12, s30, s24
    s_addc_u32 s13, s31, 0
    s_mov_b32 s14, 131072
    s_mov_b32 s15, 0x00020000
    s_mov_b32 s32, 0x05040100
    s_mov_b32 s33, 0x07060302
    v_lshlrev_b32 v4, 4, v1
    s_lshl_b32 s24, s42, 14
    s_lshl_b32 s25, s43, 13
    s_add_u32 s24, s24, s25
    s_add_u32 s25, s24, 4096
    s_waitcnt vmcnt(4)
    v_perm_b32 v48, v17, v16, s32
    v_perm_b32 v49, v19, v18, s32
    v_perm_b32 v50, v21, v20, s32
    v_perm_b32 v51, v23, v22, s32
    v_perm_b32 v52, v17, v16, s33
    v_perm_b32 v53, v19, v18, s33
    v_perm_b32 v54, v21, v20, s33
    v_perm_b32 v55, v23, v22, s33
    v_perm_b32 v56, v25, v24, s32
    v_perm_b32 v57, v27, v26, s32
    v_perm_b32 v58, v29, v28, s32
    v_perm_b32 v59, v31, v30, s32
    v_perm_b32 v60, v25, v24, s33
    v_perm_b32 v61, v27, v26, s33
    v_perm_b32 v62, v29, v28, s33
    v_perm_b32 v63, v31, v30, s33
    v_perm_b32 v64, v33, v32, s32
    v_perm_b32 v65, v35, v34, s32
    v_perm_b32 v66, v37, v36, s32
    v_perm_b32 v67, v39, v38, s32
    v_perm_b32 v68, v33, v32, s33
    v_perm_b32 v69, v35, v34, s33
    v_perm_b32 v70, v37, v36, s33
    v_perm_b32 v71, v39, v38, s33
    v_perm_b32 v72, v41, v40, s32
    v_perm_b32 v73, v43, v42, s32
    v_perm_b32 v74, v45, v44, s32
    v_perm_b32 v75, v47, v46, s32
    v_perm_b32 v76, v41, v40, s33
    v_perm_b32 v77, v43, v42, s33
    v_perm_b32 v78, v45, v44, s33
    v_perm_b32 v79, v47, v46, s33
    s_cmp_eq_u32 s41, 2
    s_cbranch_scc1 L_prep_kernel_ge
    buffer_store_dwordx4 v[48:51], v4, s[12:15], s24 offen offset:0 sc1
    buffer_store_dwordx4 v[52:55], v4, s[12:15], s24 offen offset:1024 sc1
    buffer_store_dwordx4 v[56:59], v4, s[12:15], s24 offen offset:2048 sc1
    buffer_store_dwordx4 v[60:63], v4, s[12:15], s24 offen offset:3072 sc1
    buffer_store_dwordx4 v[64:67], v4, s[12:15], s25 offen offset:0 sc1
    buffer_store_dwordx4 v[68:71], v4, s[12:15], s25 offen offset:1024 sc1
    buffer_store_dwordx4 v[72:75], v4, s[12:15], s25 offen offset:2048 sc1
    buffer_store_dwordx4 v[76:79], v4, s[12:15], s25 offen offset:3072 sc1
    s_endpgm
L_prep_kernel_ge:
    s_waitcnt vmcnt(0)
    v_mfma_f32_16x16x32_bf16 v[96:99], v[48:51], v[80:83], 0
    v_mfma_f32_16x16x32_bf16 v[100:103], v[52:55], v[80:83], 0
    v_mfma_f32_16x16x32_bf16 v[96:99], v[56:59], v[84:87], v[96:99]
    v_mfma_f32_16x16x32_bf16 v[100:103], v[60:63], v[84:87], v[100:103]
    v_mfma_f32_16x16x32_bf16 v[96:99], v[64:67], v[88:91], v[96:99]
    v_mfma_f32_16x16x32_bf16 v[100:103], v[68:71], v[88:91], v[100:103]
    v_mfma_f32_16x16x32_bf16 v[96:99], v[72:75], v[92:95], v[96:99]
    v_mfma_f32_16x16x32_bf16 v[100:103], v[76:79], v[92:95], v[100:103]
    s_and_b32 s24, s40, 1
    s_lshl_b32 s24, s24, 11
    v_add_u32 v7, s24, v4
    s_mov_b32 s14, 16384
    v_lshlrev_b32 v8, 10, v3
    v_lshl_add_u32 v8, v2, 5, v8
    s_lshl_b32 s24, s42, 7
    s_mov_b32 s34, 0xffff0000
    s_mov_b32 s35, 0x4038aa3b
    s_cmp_eq_u32 s43, 0
    s_cbranch_scc1 L_prep_kernel_ge0
    ds_write_b128 v7, v[96:99]
    ds_write_b128 v7, v[100:103] offset:1024
    s_waitcnt lgkmcnt(0)
    s_barrier
    s_endpgm
L_prep_kernel_ge0:
    s_barrier
    ds_read_b128 v[16:19], v7
    ds_read_b128 v[20:23], v7 offset:1024
    s_waitcnt lgkmcnt(0)
    v_add_f32 v16, v16, v96
    v_add_f32 v17, v17, v97
    v_add_f32 v18, v18, v98
    v_add_f32 v19, v19, v99
    v_add_f32 v20, v20, v100
    v_add_f32 v21, v21, v101
    v_add_f32 v22, v22, v102
    v_add_f32 v23, v23, v103
    v_cvt_pk_bf16_f32 v48, v16, v20
    v_cvt_pk_bf16_f32 v49, v17, v21
    v_cvt_pk_bf16_f32 v50, v18, v22
    v_cvt_pk_bf16_f32 v51, v19, v23
    v_lshlrev_b32 v56, 16, v48
    v_and_b32 v57, s34, v48
    v_lshlrev_b32 v58, 16, v49
    v_and_b32 v59, s34, v49
    v_lshlrev_b32 v60, 16, v50
    v_and_b32 v61, s34, v50
    v_lshlrev_b32 v62, 16, v51
    v_and_b32 v63, s34, v51
    v_mul_f32 v56, s35, v56
    v_mul_f32 v57, s35, v57
    v_mul_f32 v58, s35, v58
    v_mul_f32 v59, s35, v59
    v_mul_f32 v60, s35, v60
    v_mul_f32 v61, s35, v61
    v_mul_f32 v62, s35, v62
    v_mul_f32 v63, s35, v63
    buffer_store_dwordx4 v[56:59], v8, s[12:15], s24 offen sc1
    buffer_store_dwordx4 v[60:63], v8, s[12:15], s24 offen offset:16 sc1
    v_exp_f32 v64, v56
    v_exp_f32 v65, v57
    v_exp_f32 v66, v58
    v_exp_f32 v67, v59
    v_exp_f32 v68, v60
    v_exp_f32 v69, v61
    v_exp_f32 v70, v62
    v_exp_f32 v71, v63
    v_max3_f32 v72, |v56|, |v57|, |v58|
    v_max3_f32 v72, |v59|, |v60|, v72
    v_max3_f32 v72, |v61|, |v62|, v72
    v_max_f32 v72, |v63|, v72
    s_add_u32 s12, s12, 16384
    s_addc_u32 s13, s13, 0
    v_cmp_lt_f32 vcc, 0x42f00000, v72
    buffer_store_dwordx4 v[64:67], v8, s[12:15], s24 offen sc1
    buffer_store_dwordx4 v[68:71], v8, s[12:15], s24 offen offset:16 sc1
    s_add_u32 s12, s12, 16384
    s_addc_u32 s13, s13, 0
    s_or_b32 s26, vcc_lo, vcc_hi
    s_lshl_b32 s24, s42, 2
    v_mov_b32 v73, s26
    v_mov_b32 v74, 0
    buffer_store_dword v73, v74, s[12:15], s24 offen sc1
    s_endpgm
.globl conv1_kernel
.p2align 8
.type conv1_kernel,@function
conv1_kernel:
    s_cmp_ge_u32 s2, 256
    s_cbranch_scc1 L_conv1_kernel_done
    s_load_dwordx2 s[4:5], s[0:1], 0
    s_load_dwordx2 s[30:31], s[0:1], 72
    v_readfirstlane_b32 s20, v0
    s_lshr_b32 s20, s20, 6
    s_xor_b32 s20, s20, 8
    s_and_b32 s36, s2, 0
    s_lshl_b32 s36, s36, 3
    s_bfe_u32 s37, s2, 196611
    s_or_b32 s29, s36, s37
    s_bfe_u32 s36, s2, 196608
    s_lshl_b32 s36, s36, 2
    s_lshr_b32 s37, s2, 6
    s_or_b32 s36, s36, s37
    s_mov_b32 s33, 0
    s_and_b32 s34, s36, 15
    s_lshr_b32 s35, s36, 4
    s_mul_i32 s21, s34, 500
    s_and_b32 s32, s20, 3
    v_and_b32 v127, 63, v0
    v_lshrrev_b32 v5, 2, v127
    v_and_b32 v6, 3, v127
    s_and_b32 s42, s20, 7
    v_lshlrev_b32 v7, 15, v5
    v_lshl_add_u32 v7, v6, 4, v7
    s_lshl_b32 s41, s21, 10
    s_sub_u32 s41, s41, 7680
    s_lshl_b32 s37, s42, 12
    s_add_u32 s37, s37, s41
    v_add_u32 v7, s37, v7
    s_mul_i32 s36, s35, 8192000
    s_mov_b32 s10, 8192000
    s_mov_b32 s11, 0x00020000
    s_mov_b32 s25, 0xffff0000
    s_mov_b32 s47, s36
    s_cmp_ge_u32 s20, 8
    s_cbranch_scc1 L_conv1_kernel_helper
    s_add_u32 s37, s41, 524288
    v_lshl_add_u32 v108, v127, 4, s37
    v_add_u32 v109, 1024, v108
    v_add_u32 v110, 2048, v108
    s_waitcnt lgkmcnt(0)
    s_add_u32 s8, s4, s47
    s_addc_u32 s9, s5, 0
    s_lshl_b32 s36, s29, 4
    s_lshl_b32 s37, s33, 3
    s_add_u32 s36, s36, s37
    s_mul_i32 s36, s36, 57344
    s_add_u32 s36, s36, 0
    s_add_u32 s12, s30, s36
    s_addc_u32 s13, s31, 0
    s_mov_b32 s14, 917504
    s_mov_b32 s15, 0x00020000
    s_mul_i32 s36, s35, 4194304
    s_add_u32 s36, s36, 18874368
    s_add_u32 s16, s30, s36
    s_addc_u32 s17, s31, 0
    s_mov_b32 s18, 4194304
    s_mov_b32 s19, 0x00020000
    v_and_b32 v10, 15, v127
    v_lshrrev_b32 v11, 4, v127
    v_add_u32 v8, 0, v10
    v_and_b32 v16, 4, v8
    v_lshrrev_b32 v16, 1, v16
    v_xor_b32 v16, v11, v16
    v_lshlrev_b32 v16, 4, v16
    v_lshl_add_u32 v8, v8, 6, v16
    v_add_u32 v9, 1, v10
    v_and_b32 v16, 4, v9
    v_lshrrev_b32 v16, 1, v16
    v_xor_b32 v16, v11, v16
    v_lshlrev_b32 v16, 4, v16
    v_lshl_add_u32 v9, v9, 6, v16
    s_lshr_b32 s38, s32, 1
    s_and_b32 s39, s32, 1
    s_add_u32 s40, s38, 4
    s_lshl_b32 s43, s39, 10
    s_cmp_lt_u32 s20, 4
    s_cselect_b32 s40, s20, s40
    s_cselect_b32 s36, 0, s43
    s_lshl_b32 s37, s40, 13
    s_add_u32 s37, s37, s36
    v_lshl_add_u32 v125, v127, 4, s37
    s_mul_i32 s37, s40, 16384
    v_add_u32 v120, s37, v8
    v_add_u32 v121, s37, v9
    s_lshl_b32 s37, s40, 10
    s_add_u32 s37, s37, 115712
    v_lshl_add_u32 v16, v11, 4, s37
    v_cmp_eq_u32 vcc, 15, v10
    v_mov_b32 v17, 8192
    v_mov_b32 v18, 4294959104
    v_mov_b32 v19, 64
    v_cndmask_b32 v122, v121, v16, vcc
    v_cndmask_b32 v123, v17, v19, vcc
    v_cndmask_b32 v124, v18, v19, vcc
    v_lshl_add_u32 v126, v127, 4, s37
    s_mov_b32 s44, 0x3f800000
    s_mov_b32 s45, 0x00000000
    s_mov_b32 s46, 0x00000000
    s_cmp_eq_u32 s40, 1
    s_cselect_b32 s45, 0x3f800000, s45
    s_cselect_b32 s46, 0x3f800000, s46
    s_cmp_eq_u32 s40, 2
    s_cselect_b32 s45, 0xbf800000, s45
    s_cselect_b32 s46, 0x3f800000, s46
    s_cmp_eq_u32 s40, 3
    s_cselect_b32 s45, 0x40000000, s45
    s_cselect_b32 s46, 0x40800000, s46
    s_cmp_eq_u32 s40, 4
    s_cselect_b32 s45, 0xc0000000, s45
    s_cselect_b32 s46, 0x40800000, s46
    s_cmp_eq_u32 s40, 5
    s_cselect_b32 s44, 0x41800000, s44
    s_cselect_b32 s45, 0x41000000, s45
    s_cselect_b32 s46, 0x40800000, s46
    s_cmp_ge_u32 s20, 4
    s_cbranch_scc1 L_conv1_kernel_m2
    v_mov_b32 v0, 0
    v_mov_b32 v1, 0
    v_mov_b32 v2, 0
    v_mov_b32 v3, 0
    v_mov_b32 v4, 0
    v_mov_b32 v5, 0
    v_mov_b32 v6, 0
    v_mov_b32 v7, 0
    v_mov_b32 v8, 0
    v_mov_b32 v9, 0
    v_mov_b32 v10, 0
    v_mov_b32 v11, 0
    v_mov_b32 v12, 0
    v_mov_b32 v13, 0
    v_mov_b32 v14, 0
    v_mov_b32 v15, 0
    v_mov_b32 v16, 0
    v_mov_b32 v17, 0
    v_mov_b32 v18, 0
    v_mov_b32 v19, 0
    v_mov_b32 v20, 0
    v_mov_b32 v21, 0
    v_mov_b32 v22, 0
    v_mov_b32 v23, 0
    v_mov_b32 v24, 0
    v_mov_b32 v25, 0
    v_mov_b32 v26, 0
    v_mov_b32 v27, 0
    v_mov_b32 v28, 0
    v_mov_b32 v29, 0
    v_mov_b32 v30, 0
    v_mov_b32 v31, 0
    v_mov_b32 v32, 0
    v_mov_b32 v33, 0
    v_mov_b32 v34, 0
    v_mov_b32 v35, 0
    v_mov_b32 v36, 0
    v_mov_b32 v37, 0
    v_mov_b32 v38, 0
    v_mov_b32 v39, 0
    v_mov_b32 v40, 0
    v_mov_b32 v41, 0
    v_mov_b32 v42, 0
    v_mov_b32 v43, 0
    v_mov_b32 v44, 0
    v_mov_b32 v45, 0
    v_mov_b32 v46, 0
    v_mov_b32 v47, 0
    v_mov_b32 v48, 0
    v_mov_b32 v49, 0
    v_mov_b32 v50, 0
    v_mov_b32 v51, 0
    v_mov_b32 v52, 0
    v_mov_b32 v53, 0
    v_mov_b32 v54, 0
    v_mov_b32 v55, 0
    v_mov_b32 v56, 0
    v_mov_b32 v57, 0
    v_mov_b32 v58, 0
    v_mov_b32 v59, 0
    v_mov_b32 v60, 0
    v_mov_b32 v61, 0
    v_mov_b32 v62, 0
    v_mov_b32 v63, 0
    buffer_load_dwordx4 v[96:99], v108, s[8:11], 0 offen
    buffer_load_dwordx4 v[100:103], v109, s[8:11], 0 offen
    buffer_load_dwordx4 v[104:107], v110, s[8:11], 0 offen
    s_mov_b32 s23, 0
    s_mov_b32 s26, 4096
    buffer_load_dwordx4 v[64:67], v125, s[12:15], s23 offen offset:0
    buffer_load_dwordx4 v[68:71], v125, s[12:15], s23 offen offset:1024
    buffer_load_dwordx4 v[72:75], v125, s[12:15], s23 offen offset:2048
    buffer_load_dwordx4 v[76:79], v125, s[12:15], s23 offen offset:3072
    buffer_load_dwordx4 v[80:83], v125, s[12:15], s26 offen offset:0
    buffer_load_dwordx4 v[84:87], v125, s[12:15], s26 offen offset:1024
    buffer_load_dwordx4 v[88:91], v125, s[12:15], s26 offen offset:2048
    buffer_load_dwordx4 v[92:95], v125, s[12:15], s26 offen offset:3072
    s_mov_b32 s23, 57344
    s_mov_b32 s26, 61440
    s_waitcnt vmcnt(8)
    v_lshlrev_b32 v108, 16, v96
    v_and_b32 v111, s25, v96
    v_lshlrev_b32 v109, 16, v100
    v_and_b32 v112, s25, v100
    v_lshlrev_b32 v110, 16, v104
    v_and_b32 v113, s25, v104
    v_mul_f32 v114, s44, v108
    v_mul_f32 v115, s44, v111
    v_fmac_f32 v114, s45, v109
    v_fmac_f32 v115, s45, v112
    v_fmac_f32 v114, s46, v110
    v_fmac_f32 v115, s46, v113
    v_cvt_pk_bf16_f32 v96, v114, v115
    v_lshlrev_b32 v108, 16, v97
    v_and_b32 v111, s25, v97
    v_lshlrev_b32 v109, 16, v101
    v_and_b32 v112, s25, v101
    v_lshlrev_b32 v110, 16, v105
    v_and_b32 v113, s25, v105
    v_mul_f32 v114, s44, v108
    v_mul_f32 v115, s44, v111
    v_fmac_f32 v114, s45, v109
    v_fmac_f32 v115, s45, v112
    v_fmac_f32 v114, s46, v110
    v_fmac_f32 v115, s46, v113
    v_cvt_pk_bf16_f32 v97, v114, v115
    v_lshlrev_b32 v108, 16, v98
    v_and_b32 v111, s25, v98
    v_lshlrev_b32 v109, 16, v102
    v_and_b32 v112, s25, v102
    v_lshlrev_b32 v110, 16, v106
    v_and_b32 v113, s25, v106
    v_mul_f32 v114, s44, v108
    v_mul_f32 v115, s44, v111
    v_fmac_f32 v114, s45, v109
    v_fmac_f32 v115, s45, v112
    v_fmac_f32 v114, s46, v110
    v_fmac_f32 v115, s46, v113
    v_cvt_pk_bf16_f32 v98, v114, v115
    v_lshlrev_b32 v108, 16, v99
    v_and_b32 v111, s25, v99
    v_lshlrev_b32 v109, 16, v103
    v_and_b32 v112, s25, v103
    v_lshlrev_b32 v110, 16, v107
    v_and_b32 v113, s25, v107
    v_mul_f32 v114, s44, v108
    v_mul_f32 v115, s44, v111
    v_fmac_f32 v114, s45, v109
    v_fmac_f32 v115, s45, v112
    v_fmac_f32 v114, s46, v110
    v_fmac_f32 v115, s46, v113
    v_cvt_pk_bf16_f32 v99, v114, v115
    ds_write_b128 v126, v[96:99]
    s_waitcnt lgkmcnt(0)
    s_barrier
    s_mov_b32 s22, 8
    s_setprio 2
L_conv1_kernel_mloop1:
    ds_read_b128 v[96:99], v120 offset:0
    ds_read_b128 v[100:103], v120 offset:1024
    ds_read_b128 v[104:107], v120 offset:2048
    ds_read_b128 v[108:111], v120 offset:3072
    ds_read_b128 v[112:115], v120 offset:4096
    ds_read_b128 v[116:119], v120 offset:5120
    s_waitcnt vmcnt(6) lgkmcnt(5)
    v_mfma_f32_16x16x32_bf16 v[0:3], v[64:67], v[96:99], v[0:3]
    v_mfma_f32_16x16x32_bf16 v[32:35], v[68:71], v[96:99], v[32:35]
    ds_read_b128 v[96:99], v120 offset:6144
    s_waitcnt vmcnt(4) lgkmcnt(5)
    v_mfma_f32_16x16x32_bf16 v[4:7], v[64:67], v[100:103], v[4:7]
    v_mfma_f32_16x16x32_bf16 v[36:39], v[68:71], v[100:103], v[36:39]
    v_mfma_f32_16x16x32_bf16 v[0:3], v[72:75], v[100:103], v[0:3]
    v_mfma_f32_16x16x32_bf16 v[32:35], v[76:79], v[100:103], v[32:35]
    ds_read_b128 v[100:103], v120 offset:7168
    s_waitcnt vmcnt(2) lgkmcnt(5)
    v_mfma_f32_16x16x32_bf16 v[8:11], v[64:67], v[104:107], v[8:11]
    v_mfma_f32_16x16x32_bf16 v[40:43], v[68:71], v[104:107], v[40:43]
    v_mfma_f32_16x16x32_bf16 v[4:7], v[72:75], v[104:107], v[4:7]
    v_mfma_f32_16x16x32_bf16 v[36:39], v[76:79], v[104:107], v[36:39]
    v_mfma_f32_16x16x32_bf16 v[0:3], v[80:83], v[104:107], v[0:3]
    v_mfma_f32_16x16x32_bf16 v[32:35], v[84:87], v[104:107], v[32:35]
    ds_read_b128 v[104:107], v122 offset:0
    v_add_u32 v122, v123, v122
    s_waitcnt vmcnt(0) lgkmcnt(5)
    v_mfma_f32_16x16x32_bf16 v[12:15], v[64:67], v[108:111], v[12:15]
    v_mfma_f32_16x16x32_bf16 v[44:47], v[68:71], v[108:111], v[44:47]
    v_mfma_f32_16x16x32_bf16 v[8:11], v[72:75], v[108:111], v[8:11]
    v_mfma_f32_16x16x32_bf16 v[40:43], v[76:79], v[108:111], v[40:43]
    v_mfma_f32_16x16x32_bf16 v[4:7], v[80:83], v[108:111], v[4:7]
    v_mfma_f32_16x16x32_bf16 v[36:39], v[84:87], v[108:111], v[36:39]
    v_mfma_f32_16x16x32_bf16 v[0:3], v[88:91], v[108:111], v[0:3]
    v_mfma_f32_16x16x32_bf16 v[32:35], v[92:95], v[108:111], v[32:35]
    ds_read_b128 v[108:111], v121 offset:1024
    s_waitcnt lgkmcnt(5)
    v_mfma_f32_16x16x32_bf16 v[16:19], v[64:67], v[112:115], v[16:19]
    v_mfma_f32_16x16x32_bf16 v[48:51], v[68:71], v[112:115], v[48:51]
    v_mfma_f32_16x16x32_bf16 v[12:15], v[72:75], v[112:115], v[12:15]
    v_mfma_f32_16x16x32_bf16 v[44:47], v[76:79], v[112:115], v[44:47]
    v_mfma_f32_16x16x32_bf16 v[8:11], v[80:83], v[112:115], v[8:11]
    v_mfma_f32_16x16x32_bf16 v[40:43], v[84:87], v[112:115], v[40:43]
    v_mfma_f32_16x16x32_bf16 v[4:7], v[88:91], v[112:115], v[4:7]
    v_mfma_f32_16x16x32_bf16 v[36:39], v[92:95], v[112:115], v[36:39]
    ds_read_b128 v[112:115], v121 offset:2048
    s_waitcnt lgkmcnt(5)
    v_mfma_f32_16x16x32_bf16 v[20:23], v[64:67], v[116:119], v[20:23]
    v_mfma_f32_16x16x32_bf16 v[52:55], v[68:71], v[116:119], v[52:55]
    v_mfma_f32_16x16x32_bf16 v[16:19], v[72:75], v[116:119], v[16:19]
    v_mfma_f32_16x16x32_bf16 v[48:51], v[76:79], v[116:119], v[48:51]
    v_mfma_f32_16x16x32_bf16 v[12:15], v[80:83], v[116:119], v[12:15]
    v_mfma_f32_16x16x32_bf16 v[44:47], v[84:87], v[116:119], v[44:47]
    v_mfma_f32_16x16x32_bf16 v[8:11], v[88:91], v[116:119], v[8:11]
    v_mfma_f32_16x16x32_bf16 v[40:43], v[92:95], v[116:119], v[40:43]
    s_waitcnt lgkmcnt(4)
    v_mfma_f32_16x16x32_bf16 v[24:27], v[64:67], v[96:99], v[24:27]
    v_mfma_f32_16x16x32_bf16 v[56:59], v[68:71], v[96:99], v[56:59]
    v_mfma_f32_16x16x32_bf16 v[20:23], v[72:75], v[96:99], v[20:23]
    v_mfma_f32_16x16x32_bf16 v[52:55], v[76:79], v[96:99], v[52:55]
    v_mfma_f32_16x16x32_bf16 v[16:19], v[80:83], v[96:99], v[16:19]
    v_mfma_f32_16x16x32_bf16 v[48:51], v[84:87], v[96:99], v[48:51]
    v_mfma_f32_16x16x32_bf16 v[12:15], v[88:91], v[96:99], v[12:15]
    v_mfma_f32_16x16x32_bf16 v[44:47], v[92:95], v[96:99], v[44:47]
    s_waitcnt lgkmcnt(3)
    v_mfma_f32_16x16x32_bf16 v[28:31], v[64:67], v[100:103], v[28:31]
    v_mfma_f32_16x16x32_bf16 v[60:63], v[68:71], v[100:103], v[60:63]
    v_mfma_f32_16x16x32_bf16 v[24:27], v[72:75], v[100:103], v[24:27]
    v_mfma_f32_16x16x32_bf16 v[56:59], v[76:79], v[100:103], v[56:59]
    v_mfma_f32_16x16x32_bf16 v[20:23], v[80:83], v[100:103], v[20:23]
    v_mfma_f32_16x16x32_bf16 v[52:55], v[84:87], v[100:103], v[52:55]
    v_mfma_f32_16x16x32_bf16 v[16:19], v[88:91], v[100:103], v[16:19]
    v_mfma_f32_16x16x32_bf16 v[48:51], v[92:95], v[100:103], v[48:51]
    buffer_load_dwordx4 v[64:67], v125, s[12:15], s23 offen offset:0
    buffer_load_dwordx4 v[68:71], v125, s[12:15], s23 offen offset:1024
    s_waitcnt lgkmcnt(2)
    v_mfma_f32_16x16x32_bf16 v[28:31], v[72:75], v[104:107], v[28:31]
    v_mfma_f32_16x16x32_bf16 v[60:63], v[76:79], v[104:107], v[60:63]
    v_mfma_f32_16x16x32_bf16 v[24:27], v[80:83], v[104:107], v[24:27]
    v_mfma_f32_16x16x32_bf16 v[56:59], v[84:87], v[104:107], v[56:59]
    v_mfma_f32_16x16x32_bf16 v[20:23], v[88:91], v[104:107], v[20:23]
    v_mfma_f32_16x16x32_bf16 v[52:55], v[92:95], v[104:107], v[52:55]
    buffer_load_dwordx4 v[72:75], v125, s[12:15], s23 offen offset:2048
    buffer_load_dwordx4 v[76:79], v125, s[12:15], s23 offen offset:3072
    s_waitcnt lgkmcnt(1)
    v_mfma_f32_16x16x32_bf16 v[28:31], v[80:83], v[108:111], v[28:31]
    v_mfma_f32_16x16x32_bf16 v[60:63], v[84:87], v[108:111], v[60:63]
    v_mfma_f32_16x16x32_bf16 v[24:27], v[88:91], v[108:111], v[24:27]
    v_mfma_f32_16x16x32_bf16 v[56:59], v[92:95], v[108:111], v[56:59]
    buffer_load_dwordx4 v[80:83], v125, s[12:15], s26 offen offset:0
    buffer_load_dwordx4 v[84:87], v125, s[12:15], s26 offen offset:1024
    s_waitcnt lgkmcnt(0)
    v_mfma_f32_16x16x32_bf16 v[28:31], v[88:91], v[112:115], v[28:31]
    v_mfma_f32_16x16x32_bf16 v[60:63], v[92:95], v[112:115], v[60:63]
    buffer_load_dwordx4 v[88:91], v125, s[12:15], s26 offen offset:2048
    buffer_load_dwordx4 v[92:95], v125, s[12:15], s26 offen offset:3072
    s_add_u32 s23, s23, 57344
    s_add_u32 s26, s26, 57344
    s_barrier
    s_sub_u32 s22, s22, 1
    s_cmp_eq_u32 s22, 0
    s_cbranch_scc1 L_conv1_kernel_mlast1
    ds_read_b128 v[96:99], v120 offset:8192
    ds_read_b128 v[100:103], v120 offset:9216
    ds_read_b128 v[104:107], v120 offset:10240
    ds_read_b128 v[108:111], v120 offset:11264
    ds_read_b128 v[112:115], v120 offset:12288
    ds_read_b128 v[116:119], v120 offset:13312
    s_waitcnt vmcnt(6) lgkmcnt(5)
    v_mfma_f32_16x16x32_bf16 v[0:3], v[64:67], v[96:99], v[0:3]
    v_mfma_f32_16x16x32_bf16 v[32:35], v[68:71], v[96:99], v[32:35]
    ds_read_b128 v[96:99], v120 offset:14336
    s_waitcnt vmcnt(4) lgkmcnt(5)
    v_mfma_f32_16x16x32_bf16 v[4:7], v[64:67], v[100:103], v[4:7]
    v_mfma_f32_16x16x32_bf16 v[36:39], v[68:71], v[100:103], v[36:39]
    v_mfma_f32_16x16x32_bf16 v[0:3], v[72:75], v[100:103], v[0:3]
    v_mfma_f32_16x16x32_bf16 v[32:35], v[76:79], v[100:103], v[32:35]
    ds_read_b128 v[100:103], v120 offset:15360
    s_waitcnt vmcnt(2) lgkmcnt(5)
    v_mfma_f32_16x16x32_bf16 v[8:11], v[64:67], v[104:107], v[8:11]
    v_mfma_f32_16x16x32_bf16 v[40:43], v[68:71], v[104:107], v[40:43]
    v_mfma_f32_16x16x32_bf16 v[4:7], v[72:75], v[104:107], v[4:7]
    v_mfma_f32_16x16x32_bf16 v[36:39], v[76:79], v[104:107], v[36:39]
    v_mfma_f32_16x16x32_bf16 v[0:3], v[80:83], v[104:107], v[0:3]
    v_mfma_f32_16x16x32_bf16 v[32:35], v[84:87], v[104:107], v[32:35]
    ds_read_b128 v[104:107], v122 offset:0
    v_add_u32 v122, v124, v122
    s_waitcnt vmcnt(0) lgkmcnt(5)
    v_mfma_f32_16x16x32_bf16 v[12:15], v[64:67], v[108:111], v[12:15]
    v_mfma_f32_16x16x32_bf16 v[44:47], v[68:71], v[108:111], v[44:47]
    v_mfma_f32_16x16x32_bf16 v[8:11], v[72:75], v[108:111], v[8:11]
    v_mfma_f32_16x16x32_bf16 v[40:43], v[76:79], v[108:111], v[40:43]
    v_mfma_f32_16x16x32_bf16 v[4:7], v[80:83], v[108:111], v[4:7]
    v_mfma_f32_16x16x32_bf16 v[36:39], v[84:87], v[108:111], v[36:39]
    v_mfma_f32_16x16x32_bf16 v[0:3], v[88:91], v[108:111], v[0:3]
    v_mfma_f32_16x16x32_bf16 v[32:35], v[92:95], v[108:111], v[32:35]
    ds_read_b128 v[108:111], v121 offset:9216
    s_waitcnt lgkmcnt(5)
    v_mfma_f32_16x16x32_bf16 v[16:19], v[64:67], v[112:115], v[16:19]
    v_mfma_f32_16x16x32_bf16 v[48:51], v[68:71], v[112:115], v[48:51]
    v_mfma_f32_16x16x32_bf16 v[12:15], v[72:75], v[112:115], v[12:15]
    v_mfma_f32_16x16x32_bf16 v[44:47], v[76:79], v[112:115], v[44:47]
    v_mfma_f32_16x16x32_bf16 v[8:11], v[80:83], v[112:115], v[8:11]
    v_mfma_f32_16x16x32_bf16 v[40:43], v[84:87], v[112:115], v[40:43]
    v_mfma_f32_16x16x32_bf16 v[4:7], v[88:91], v[112:115], v[4:7]
    v_mfma_f32_16x16x32_bf16 v[36:39], v[92:95], v[112:115], v[36:39]
    ds_read_b128 v[112:115], v121 offset:10240
    s_waitcnt lgkmcnt(5)
    v_mfma_f32_16x16x32_bf16 v[20:23], v[64:67], v[116:119], v[20:23]
    v_mfma_f32_16x16x32_bf16 v[52:55], v[68:71], v[116:119], v[52:55]
    v_mfma_f32_16x16x32_bf16 v[16:19], v[72:75], v[116:119], v[16:19]
    v_mfma_f32_16x16x32_bf16 v[48:51], v[76:79], v[116:119], v[48:51]
    v_mfma_f32_16x16x32_bf16 v[12:15], v[80:83], v[116:119], v[12:15]
    v_mfma_f32_16x16x32_bf16 v[44:47], v[84:87], v[116:119], v[44:47]
    v_mfma_f32_16x16x32_bf16 v[8:11], v[88:91], v[116:119], v[8:11]
    v_mfma_f32_16x16x32_bf16 v[40:43], v[92:95], v[116:119], v[40:43]
    s_waitcnt lgkmcnt(4)
    v_mfma_f32_16x16x32_bf16 v[24:27], v[64:67], v[96:99], v[24:27]
    v_mfma_f32_16x16x32_bf16 v[56:59], v[68:71], v[96:99], v[56:59]
    v_mfma_f32_16x16x32_bf16 v[20:23], v[72:75], v[96:99], v[20:23]
    v_mfma_f32_16x16x32_bf16 v[52:55], v[76:79], v[96:99], v[52:55]
    v_mfma_f32_16x16x32_bf16 v[16:19], v[80:83], v[96:99], v[16:19]
    v_mfma_f32_16x16x32_bf16 v[48:51], v[84:87], v[96:99], v[48:51]
    v_mfma_f32_16x16x32_bf16 v[12:15], v[88:91], v[96:99], v[12:15]
    v_mfma_f32_16x16x32_bf16 v[44:47], v[92:95], v[96:99], v[44:47]
    s_waitcnt lgkmcnt(3)
    v_mfma_f32_16x16x32_bf16 v[28:31], v[64:67], v[100:103], v[28:31]
    v_mfma_f32_16x16x32_bf16 v[60:63], v[68:71], v[100:103], v[60:63]
    v_mfma_f32_16x16x32_bf16 v[24:27], v[72:75], v[100:103], v[24:27]
    v_mfma_f32_16x16x32_bf16 v[56:59], v[76:79], v[100:103], v[56:59]
    v_mfma_f32_16x16x32_bf16 v[20:23], v[80:83], v[100:103], v[20:23]
    v_mfma_f32_16x16x32_bf16 v[52:55], v[84:87], v[100:103], v[52:55]
    v_mfma_f32_16x16x32_bf16 v[16:19], v[88:91], v[100:103], v[16:19]
    v_mfma_f32_16x16x32_bf16 v[48:51], v[92:95], v[100:103], v[48:51]
    buffer_load_dwordx4 v[64:67], v125, s[12:15], s23 offen offset:0
    buffer_load_dwordx4 v[68:71], v125, s[12:15], s23 offen offset:1024
    s_waitcnt lgkmcnt(2)
    v_mfma_f32_16x16x32_bf16 v[28:31], v[72:75], v[104:107], v[28:31]
    v_mfma_f32_16x16x32_bf16 v[60:63], v[76:79], v[104:107], v[60:63]
    v_mfma_f32_16x16x32_bf16 v[24:27], v[80:83], v[104:107], v[24:27]
    v_mfma_f32_16x16x32_bf16 v[56:59], v[84:87], v[104:107], v[56:59]
    v_mfma_f32_16x16x32_bf16 v[20:23], v[88:91], v[104:107], v[20:23]
    v_mfma_f32_16x16x32_bf16 v[52:55], v[92:95], v[104:107], v[52:55]
    buffer_load_dwordx4 v[72:75], v125, s[12:15], s23 offen offset:2048
    buffer_load_dwordx4 v[76:79], v125, s[12:15], s23 offen offset:3072
    s_waitcnt lgkmcnt(1)
    v_mfma_f32_16x16x32_bf16 v[28:31], v[80:83], v[108:111], v[28:31]
    v_mfma_f32_16x16x32_bf16 v[60:63], v[84:87], v[108:111], v[60:63]
    v_mfma_f32_16x16x32_bf16 v[24:27], v[88:91], v[108:111], v[24:27]
    v_mfma_f32_16x16x32_bf16 v[56:59], v[92:95], v[108:111], v[56:59]
    buffer_load_dwordx4 v[80:83], v125, s[12:15], s26 offen offset:0
    buffer_load_dwordx4 v[84:87], v125, s[12:15], s26 offen offset:1024
    s_waitcnt lgkmcnt(0)
    v_mfma_f32_16x16x32_bf16 v[28:31], v[88:91], v[112:115], v[28:31]
    v_mfma_f32_16x16x32_bf16 v[60:63], v[92:95], v[112:115], v[60:63]
    buffer_load_dwordx4 v[88:91], v125, s[12:15], s26 offen offset:2048
    buffer_load_dwordx4 v[92:95], v125, s[12:15], s26 offen offset:3072
    s_add_u32 s23, s23, 57344
    s_add_u32 s26, s26, 57344
    s_barrier
    s_branch L_conv1_kernel_mloop1
L_conv1_kernel_mlast1:
    v_and_b32 v125, 15, v127
    v_and_b32 v126, 7, v127
    v_lshlrev_b32 v126, 4, v126
    v_lshl_add_u32 v125, v125, 7, v126
    v_lshrrev_b32 v126, 4, v127
    v_lshl_add_u32 v125, v126, 11, v125
    s_lshl_b32 s36, s20, 14
    s_add_u32 s37, s36, 8192
    v_add_u32 v126, s37, v125
    v_add_u32 v125, s36, v125
    ds_read_b128 v[96:99], v120 offset:8192
    ds_read_b128 v[100:103], v120 offset:9216
    ds_read_b128 v[104:107], v120 offset:10240
    ds_read_b128 v[108:111], v120 offset:11264
    ds_read_b128 v[112:115], v120 offset:12288
    ds_read_b128 v[116:119], v120 offset:13312
    s_waitcnt vmcnt(6) lgkmcnt(5)
    v_mfma_f32_16x16x32_bf16 v[0:3], v[64:67], v[96:99], v[0:3]
    v_mfma_f32_16x16x32_bf16 v[32:35], v[68:71], v[96:99], v[32:35]
    ds_read_b128 v[96:99], v120 offset:14336
    s_waitcnt vmcnt(4) lgkmcnt(5)
    v_mfma_f32_16x16x32_bf16 v[4:7], v[64:67], v[100:103], v[4:7]
    v_mfma_f32_16x16x32_bf16 v[36:39], v[68:71], v[100:103], v[36:39]
    v_mfma_f32_16x16x32_bf16 v[0:3], v[72:75], v[100:103], v[0:3]
    v_mfma_f32_16x16x32_bf16 v[32:35], v[76:79], v[100:103], v[32:35]
    ds_read_b128 v[100:103], v120 offset:15360
    s_waitcnt vmcnt(2) lgkmcnt(5)
    v_mfma_f32_16x16x32_bf16 v[8:11], v[64:67], v[104:107], v[8:11]
    v_mfma_f32_16x16x32_bf16 v[40:43], v[68:71], v[104:107], v[40:43]
    v_mfma_f32_16x16x32_bf16 v[4:7], v[72:75], v[104:107], v[4:7]
    v_mfma_f32_16x16x32_bf16 v[36:39], v[76:79], v[104:107], v[36:39]
    v_mfma_f32_16x16x32_bf16 v[0:3], v[80:83], v[104:107], v[0:3]
    v_mfma_f32_16x16x32_bf16 v[32:35], v[84:87], v[104:107], v[32:35]
    ds_read_b128 v[104:107], v122 offset:0
    s_waitcnt vmcnt(0) lgkmcnt(5)
    v_mfma_f32_16x16x32_bf16 v[12:15], v[64:67], v[108:111], v[12:15]
    v_mfma_f32_16x16x32_bf16 v[44:47], v[68:71], v[108:111], v[44:47]
    v_mfma_f32_16x16x32_bf16 v[8:11], v[72:75], v[108:111], v[8:11]
    v_mfma_f32_16x16x32_bf16 v[40:43], v[76:79], v[108:111], v[40:43]
    v_mfma_f32_16x16x32_bf16 v[4:7], v[80:83], v[108:111], v[4:7]
    v_mfma_f32_16x16x32_bf16 v[36:39], v[84:87], v[108:111], v[36:39]
    v_mfma_f32_16x16x32_bf16 v[0:3], v[88:91], v[108:111], v[0:3]
    v_mfma_f32_16x16x32_bf16 v[32:35], v[92:95], v[108:111], v[32:35]
    ds_read_b128 v[108:111], v121 offset:9216
    s_waitcnt lgkmcnt(5)
    v_mfma_f32_16x16x32_bf16 v[16:19], v[64:67], v[112:115], v[16:19]
    v_mfma_f32_16x16x32_bf16 v[48:51], v[68:71], v[112:115], v[48:51]
    v_mfma_f32_16x16x32_bf16 v[12:15], v[72:75], v[112:115], v[12:15]
    v_mfma_f32_16x16x32_bf16 v[44:47], v[76:79], v[112:115], v[44:47]
    v_mfma_f32_16x16x32_bf16 v[8:11], v[80:83], v[112:115], v[8:11]
    v_mfma_f32_16x16x32_bf16 v[40:43], v[84:87], v[112:115], v[40:43]
    v_mfma_f32_16x16x32_bf16 v[4:7], v[88:91], v[112:115], v[4:7]
    v_mfma_f32_16x16x32_bf16 v[36:39], v[92:95], v[112:115], v[36:39]
    ds_read_b128 v[112:115], v121 offset:10240
    v_xor_b32 v123, 0, v125
    ds_write_b128 v123, v[0:3]
    s_waitcnt lgkmcnt(6)
    v_mfma_f32_16x16x32_bf16 v[20:23], v[64:67], v[116:119], v[20:23]
    v_mfma_f32_16x16x32_bf16 v[52:55], v[68:71], v[116:119], v[52:55]
    v_mfma_f32_16x16x32_bf16 v[16:19], v[72:75], v[116:119], v[16:19]
    v_mfma_f32_16x16x32_bf16 v[48:51], v[76:79], v[116:119], v[48:51]
    v_mfma_f32_16x16x32_bf16 v[12:15], v[80:83], v[116:119], v[12:15]
    v_mfma_f32_16x16x32_bf16 v[44:47], v[84:87], v[116:119], v[44:47]
    v_mfma_f32_16x16x32_bf16 v[8:11], v[88:91], v[116:119], v[8:11]
    v_mfma_f32_16x16x32_bf16 v[40:43], v[92:95], v[116:119], v[40:43]
    v_xor_b32 v124, 16, v125
    ds_write_b128 v124, v[4:7]
    s_waitcnt lgkmcnt(2)
    v_mfma_f32_16x16x32_bf16 v[24:27], v[64:67], v[96:99], v[24:27]
    v_mfma_f32_16x16x32_bf16 v[56:59], v[68:71], v[96:99], v[56:59]
    v_mfma_f32_16x16x32_bf16 v[20:23], v[72:75], v[96:99], v[20:23]
    v_mfma_f32_16x16x32_bf16 v[52:55], v[76:79], v[96:99], v[52:55]
    v_mfma_f32_16x16x32_bf16 v[16:19], v[80:83], v[96:99], v[16:19]
    v_mfma_f32_16x16x32_bf16 v[48:51], v[84:87], v[96:99], v[48:51]
    v_mfma_f32_16x16x32_bf16 v[12:15], v[88:91], v[96:99], v[12:15]
    v_mfma_f32_16x16x32_bf16 v[44:47], v[92:95], v[96:99], v[44:47]
    v_xor_b32 v123, 32, v125
    ds_write_b128 v123, v[8:11]
    v_xor_b32 v124, 0, v126
    ds_write_b128 v124, v[32:35]
    v_mfma_f32_16x16x32_bf16 v[28:31], v[64:67], v[100:103], v[28:31]
    v_mfma_f32_16x16x32_bf16 v[60:63], v[68:71], v[100:103], v[60:63]
    v_mfma_f32_16x16x32_bf16 v[24:27], v[72:75], v[100:103], v[24:27]
    v_mfma_f32_16x16x32_bf16 v[56:59], v[76:79], v[100:103], v[56:59]
    v_mfma_f32_16x16x32_bf16 v[20:23], v[80:83], v[100:103], v[20:23]
    v_mfma_f32_16x16x32_bf16 v[52:55], v[84:87], v[100:103], v[52:55]
    v_mfma_f32_16x16x32_bf16 v[16:19], v[88:91], v[100:103], v[16:19]
    v_mfma_f32_16x16x32_bf16 v[48:51], v[92:95], v[100:103], v[48:51]
    v_xor_b32 v123, 16, v126
    ds_write_b128 v123, v[36:39]
    v_xor_b32 v124, 32, v126
    ds_write_b128 v124, v[40:43]
    v_mfma_f32_16x16x32_bf16 v[28:31], v[72:75], v[104:107], v[28:31]
    v_mfma_f32_16x16x32_bf16 v[60:63], v[76:79], v[104:107], v[60:63]
    v_mfma_f32_16x16x32_bf16 v[24:27], v[80:83], v[104:107], v[24:27]
    v_mfma_f32_16x16x32_bf16 v[56:59], v[84:87], v[104:107], v[56:59]
    v_mfma_f32_16x16x32_bf16 v[20:23], v[88:91], v[104:107], v[20:23]
    v_mfma_f32_16x16x32_bf16 v[52:55], v[92:95], v[104:107], v[52:55]
    v_xor_b32 v124, 48, v125
    ds_write_b128 v124, v[12:15]
    v_xor_b32 v123, 48, v126
    ds_write_b128 v123, v[44:47]
    v_mfma_f32_16x16x32_bf16 v[28:31], v[80:83], v[108:111], v[28:31]
    v_mfma_f32_16x16x32_bf16 v[60:63], v[84:87], v[108:111], v[60:63]
    v_mfma_f32_16x16x32_bf16 v[24:27], v[88:91], v[108:111], v[24:27]
    v_mfma_f32_16x16x32_bf16 v[56:59], v[92:95], v[108:111], v[56:59]
    v_xor_b32 v123, 64, v125
    ds_write_b128 v123, v[16:19]
    v_xor_b32 v124, 64, v126
    ds_write_b128 v124, v[48:51]
    v_mfma_f32_16x16x32_bf16 v[28:31], v[88:91], v[112:115], v[28:31]
    v_mfma_f32_16x16x32_bf16 v[60:63], v[92:95], v[112:115], v[60:63]
    v_xor_b32 v124, 80, v125
    ds_write_b128 v124, v[20:23]
    v_xor_b32 v123, 80, v126
    ds_write_b128 v123, v[52:55]
    v_and_b32 v108, 15, v127
    v_lshrrev_b32 v109, 4, v127
    v_lshrrev_b32 v110, 3, v108
    s_lshl_b32 s36, s20, 1
    v_add_u32 v110, s36, v110
    v_xor_b32 v111, v110, v108
    v_and_b32 v111, 7, v111
    v_lshlrev_b32 v111, 4, v111
    v_xor_b32 v123, 96, v125
    ds_write_b128 v123, v[24:27]
    v_lshl_add_u32 v111, v110, 7, v111
    v_lshl_add_u32 v120, v109, 11, v111
    v_add_u32 v121, 65536, v120
    v_add_u32 v64, 131072, v120
    s_lshl_b32 s36, s20, 9
    s_add_u32 s36, s36, 115712
    v_lshl_add_u32 v127, v109, 7, s36
    s_lshl_b32 s36, s20, 4
    v_add_u32 v108, s36, v108
    v_lshlrev_b32 v110, 6, v108
    v_lshl_add_u32 v110, v109, 4, v110
    s_mul_i32 s36, s29, 524288
    v_xor_b32 v124, 96, v126
    ds_write_b128 v124, v[56:59]
    s_lshl_b32 s37, s21, 4
    s_add_u32 s36, s36, s37
    v_add_u32 v110, s36, v110
    v_mov_b32 v111, 2130706432
    v_cmp_gt_u32 vcc, 125, v108
    s_mov_b32 s4, 0xbeaaaaab
    s_mov_b32 s5, s4
    s_mov_b32 s6, 0x3e800000
    s_mov_b32 s7, s6
    s_mov_b32 s8, 0xc0a00000
    s_mov_b32 s9, s8
    s_mov_b32 s10, 0xc0638e39
    v_xor_b32 v124, 112, v125
    ds_write_b128 v124, v[28:31]
    s_mov_b32 s11, s10
    s_mov_b32 s12, 0xbf638e39
    s_mov_b32 s13, s12
    s_mov_b32 s14, 0xbe638e39
    s_mov_b32 s15, s14
    s_mov_b32 s22, 0xbd638e39
    s_mov_b32 s23, s22
    s_mov_b32 s24, 0x3ff1c71c
    s_mov_b32 s25, s24
    s_mov_b32 s26, 0xbf2aaaab
    s_mov_b32 s27, s26
    s_mov_b32 s32, 0x3ecccccd
    v_xor_b32 v123, 112, v126
    s_waitcnt lgkmcnt(8)
    ds_write_b128 v123, v[60:63]
    s_mov_b32 s33, s32
    s_mov_b32 s34, 0xbd888889
    s_mov_b32 s35, s34
    s_mov_b32 s38, 0xbe4ccccd
    s_mov_b32 s39, s38
    s_mov_b32 s40, 0xbdd2d3e8
    s_mov_b32 s41, s40
    s_mov_b32 s42, 0x3f800000
    s_mov_b32 s43, s42
    s_setprio 0
    s_branch L_conv1_kernel_epi
L_conv1_kernel_m2:
    s_mul_i32 s37, s38, 2176
    s_add_u32 s37, s37, 98304
    v_add_u32 v116, s37, v8
    v_add_u32 v118, s37, v9
    v_add_u32 v117, 104832, v8
    s_cmp_eq_u32 s38, 0
    s_cbranch_scc1 L_conv1_kernel_hh0
    v_add_u32 v117, 98304, v9
L_conv1_kernel_hh0:
    s_lshl_b32 s37, s38, 12
    s_add_u32 s37, s37, s43
    s_add_u32 s37, s37, 49152
    v_lshl_add_u32 v119, v127, 4, s37
    v_mov_b32 v0, 0
    v_mov_b32 v1, 0
    v_mov_b32 v2, 0
    v_mov_b32 v3, 0
    v_mov_b32 v4, 0
    v_mov_b32 v5, 0
    v_mov_b32 v6, 0
    v_mov_b32 v7, 0
    v_mov_b32 v8, 0
    v_mov_b32 v9, 0
    v_mov_b32 v10, 0
    v_mov_b32 v11, 0
    v_mov_b32 v12, 0
    v_mov_b32 v13, 0
    v_mov_b32 v14, 0
    v_mov_b32 v15, 0
    v_mov_b32 v16, 0
    v_mov_b32 v17, 0
    v_mov_b32 v18, 0
    v_mov_b32 v19, 0
    v_mov_b32 v20, 0
    v_mov_b32 v21, 0
    v_mov_b32 v22, 0
    v_mov_b32 v23, 0
    v_mov_b32 v24, 0
    v_mov_b32 v25, 0
    v_mov_b32 v26, 0
    v_mov_b32 v27, 0
    v_mov_b32 v28, 0
    v_mov_b32 v29, 0
    v_mov_b32 v30, 0
    v_mov_b32 v31, 0
    v_mov_b32 v32, 0
    v_mov_b32 v33, 0
    v_mov_b32 v34, 0
    v_mov_b32 v35, 0
    v_mov_b32 v36, 0
    v_mov_b32 v37, 0
    v_mov_b32 v38, 0
    v_mov_b32 v39, 0
    v_mov_b32 v40, 0
    v_mov_b32 v41, 0
    v_mov_b32 v42, 0
    v_mov_b32 v43, 0
    v_mov_b32 v44, 0
    v_mov_b32 v45, 0
    v_mov_b32 v46, 0
    v_mov_b32 v47, 0
    v_mov_b32 v48, 0
    v_mov_b32 v49, 0
    v_mov_b32 v50, 0
    v_mov_b32 v51, 0
    v_mov_b32 v52, 0
    v_mov_b32 v53, 0
    v_mov_b32 v54, 0
    v_mov_b32 v55, 0
    v_mov_b32 v56, 0
    v_mov_b32 v57, 0
    v_mov_b32 v58, 0
    v_mov_b32 v59, 0
    v_mov_b32 v60, 0
    v_mov_b32 v61, 0
    v_mov_b32 v62, 0
    v_mov_b32 v63, 0
    buffer_load_dwordx4 v[96:99], v108, s[8:11], 0 offen
    buffer_load_dwordx4 v[100:103], v109, s[8:11], 0 offen
    buffer_load_dwordx4 v[104:107], v110, s[8:11], 0 offen
    s_mov_b32 s23, 0
    s_mov_b32 s26, 4096
    buffer_load_dwordx4 v[64:67], v125, s[12:15], s23 offen offset:0
    buffer_load_dwordx4 v[68:71], v125, s[12:15], s23 offen offset:2048
    buffer_load_dwordx4 v[80:83], v119, s[12:15], s23 offen offset:0
    buffer_load_dwordx4 v[72:75], v125, s[12:15], s26 offen offset:0
    buffer_load_dwordx4 v[84:87], v119, s[12:15], s23 offen offset:2048
    buffer_load_dwordx4 v[76:79], v125, s[12:15], s26 offen offset:2048
    s_mov_b32 s23, 57344
    s_mov_b32 s26, 61440
    s_waitcnt vmcnt(6)
    v_lshlrev_b32 v108, 16, v96
    v_and_b32 v111, s25, v96
    v_lshlrev_b32 v109, 16, v100
    v_and_b32 v112, s25, v100
    v_lshlrev_b32 v110, 16, v104
    v_and_b32 v113, s25, v104
    v_mul_f32 v114, s44, v108
    v_mul_f32 v115, s44, v111
    v_fmac_f32 v114, s45, v109
    v_fmac_f32 v115, s45, v112
    v_fmac_f32 v114, s46, v110
    v_fmac_f32 v115, s46, v113
    v_cvt_pk_bf16_f32 v96, v114, v115
    v_lshlrev_b32 v108, 16, v97
    v_and_b32 v111, s25, v97
    v_lshlrev_b32 v109, 16, v101
    v_and_b32 v112, s25, v101
    v_lshlrev_b32 v110, 16, v105
    v_and_b32 v113, s25, v105
    v_mul_f32 v114, s44, v108
    v_mul_f32 v115, s44, v111
    v_fmac_f32 v114, s45, v109
    v_fmac_f32 v115, s45, v112
    v_fmac_f32 v114, s46, v110
    v_fmac_f32 v115, s46, v113
    v_cvt_pk_bf16_f32 v97, v114, v115
    v_lshlrev_b32 v108, 16, v98
    v_and_b32 v111, s25, v98
    v_lshlrev_b32 v109, 16, v102
    v_and_b32 v112, s25, v102
    v_lshlrev_b32 v110, 16, v106
    v_and_b32 v113, s25, v106
    v_mul_f32 v114, s44, v108
    v_mul_f32 v115, s44, v111
    v_fmac_f32 v114, s45, v109
    v_fmac_f32 v115, s45, v112
    v_fmac_f32 v114, s46, v110
    v_fmac_f32 v115, s46, v113
    v_cvt_pk_bf16_f32 v98, v114, v115
    v_lshlrev_b32 v108, 16, v99
    v_and_b32 v111, s25, v99
    v_lshlrev_b32 v109, 16, v103
    v_and_b32 v112, s25, v103
    v_lshlrev_b32 v110, 16, v107
    v_and_b32 v113, s25, v107
    v_mul_f32 v114, s44, v108
    v_mul_f32 v115, s44, v111
    v_fmac_f32 v114, s45, v109
    v_fmac_f32 v115, s45, v112
    v_fmac_f32 v114, s46, v110
    v_fmac_f32 v115, s46, v113
    v_cvt_pk_bf16_f32 v99, v114, v115
    ds_write_b128 v126, v[96:99]
    v_and_b32 v111, 15, v127
    v_lshlrev_b32 v111, 2, v111
    v_add_u32 v111, 99328, v111
    ds_write_b32 v111, v0
    ds_write_b32 v111, v0 offset:8704
    s_waitcnt lgkmcnt(0)
    s_barrier
    s_mov_b32 s22, 8
    s_setprio 2
L_conv1_kernel_mloop2:
    ds_read_b128 v[88:91], v120 offset:0
    ds_read_b128 v[92:95], v120 offset:1024
    ds_read_b128 v[96:99], v116 offset:0
    ds_read_b128 v[100:103], v120 offset:2048
    ds_read_b128 v[104:107], v116 offset:1088
    ds_read_b128 v[108:111], v120 offset:3072
    ds_read_b128 v[112:115], v116 offset:2176
    s_waitcnt vmcnt(5) lgkmcnt(6)
    v_mfma_f32_16x16x32_bf16 v[0:3], v[64:67], v[88:91], v[0:3]
    ds_read_b128 v[88:91], v120 offset:4096
    s_waitcnt vmcnt(4) lgkmcnt(6)
    v_mfma_f32_16x16x32_bf16 v[4:7], v[64:67], v[92:95], v[4:7]
    v_mfma_f32_16x16x32_bf16 v[0:3], v[68:71], v[92:95], v[0:3]
    ds_read_b128 v[92:95], v116 offset:3264
    s_waitcnt vmcnt(3) lgkmcnt(6)
    v_mfma_f32_16x16x32_bf16 v[32:35], v[80:83], v[96:99], v[32:35]
    ds_read_b128 v[96:99], v120 offset:5120
    s_waitcnt vmcnt(2) lgkmcnt(6)
    v_mfma_f32_16x16x32_bf16 v[8:11], v[64:67], v[100:103], v[8:11]
    v_mfma_f32_16x16x32_bf16 v[4:7], v[68:71], v[100:103], v[4:7]
    v_mfma_f32_16x16x32_bf16 v[0:3], v[72:75], v[100:103], v[0:3]
    ds_read_b128 v[100:103], v116 offset:4352
    s_waitcnt vmcnt(1) lgkmcnt(6)
    v_mfma_f32_16x16x32_bf16 v[36:39], v[80:83], v[104:107], v[36:39]
    v_mfma_f32_16x16x32_bf16 v[32:35], v[84:87], v[104:107], v[32:35]
    ds_read_b128 v[104:107], v120 offset:6144
    s_waitcnt vmcnt(0) lgkmcnt(6)
    v_mfma_f32_16x16x32_bf16 v[12:15], v[64:67], v[108:111], v[12:15]
    v_mfma_f32_16x16x32_bf16 v[8:11], v[68:71], v[108:111], v[8:11]
    v_mfma_f32_16x16x32_bf16 v[4:7], v[72:75], v[108:111], v[4:7]
    v_mfma_f32_16x16x32_bf16 v[0:3], v[76:79], v[108:111], v[0:3]
    ds_read_b128 v[108:111], v116 offset:5440
    s_waitcnt lgkmcnt(6)
    v_mfma_f32_16x16x32_bf16 v[40:43], v[80:83], v[112:115], v[40:43]
    v_mfma_f32_16x16x32_bf16 v[36:39], v[84:87], v[112:115], v[36:39]
    ds_read_b128 v[112:115], v120 offset:7168
    s_waitcnt lgkmcnt(6)
    v_mfma_f32_16x16x32_bf16 v[16:19], v[64:67], v[88:91], v[16:19]
    v_mfma_f32_16x16x32_bf16 v[12:15], v[68:71], v[88:91], v[12:15]
    v_mfma_f32_16x16x32_bf16 v[8:11], v[72:75], v[88:91], v[8:11]
    v_mfma_f32_16x16x32_bf16 v[4:7], v[76:79], v[88:91], v[4:7]
    ds_read_b128 v[88:91], v117 offset:0
    s_waitcnt lgkmcnt(6)
    v_mfma_f32_16x16x32_bf16 v[44:47], v[80:83], v[92:95], v[44:47]
    v_mfma_f32_16x16x32_bf16 v[40:43], v[84:87], v[92:95], v[40:43]
    ds_read_b128 v[92:95], v122 offset:0
    v_add_u32 v122, v123, v122
    s_waitcnt lgkmcnt(6)
    v_mfma_f32_16x16x32_bf16 v[20:23], v[64:67], v[96:99], v[20:23]
    v_mfma_f32_16x16x32_bf16 v[16:19], v[68:71], v[96:99], v[16:19]
    v_mfma_f32_16x16x32_bf16 v[12:15], v[72:75], v[96:99], v[12:15]
    v_mfma_f32_16x16x32_bf16 v[8:11], v[76:79], v[96:99], v[8:11]
    ds_read_b128 v[96:99], v117 offset:1088
    s_waitcnt lgkmcnt(6)
    v_mfma_f32_16x16x32_bf16 v[48:51], v[80:83], v[100:103], v[48:51]
    v_mfma_f32_16x16x32_bf16 v[44:47], v[84:87], v[100:103], v[44:47]
    ds_read_b128 v[100:103], v121 offset:1024
    s_waitcnt lgkmcnt(6)
    v_mfma_f32_16x16x32_bf16 v[24:27], v[64:67], v[104:107], v[24:27]
    v_mfma_f32_16x16x32_bf16 v[20:23], v[68:71], v[104:107], v[20:23]
    v_mfma_f32_16x16x32_bf16 v[16:19], v[72:75], v[104:107], v[16:19]
    v_mfma_f32_16x16x32_bf16 v[12:15], v[76:79], v[104:107], v[12:15]
    ds_read_b128 v[104:107], v118 offset:0
    s_waitcnt lgkmcnt(6)
    v_mfma_f32_16x16x32_bf16 v[52:55], v[80:83], v[108:111], v[52:55]
    v_mfma_f32_16x16x32_bf16 v[48:51], v[84:87], v[108:111], v[48:51]
    ds_read_b128 v[108:111], v121 offset:2048
    s_waitcnt lgkmcnt(6)
    v_mfma_f32_16x16x32_bf16 v[28:31], v[64:67], v[112:115], v[28:31]
    v_mfma_f32_16x16x32_bf16 v[24:27], v[68:71], v[112:115], v[24:27]
    v_mfma_f32_16x16x32_bf16 v[20:23], v[72:75], v[112:115], v[20:23]
    v_mfma_f32_16x16x32_bf16 v[16:19], v[76:79], v[112:115], v[16:19]
    buffer_load_dwordx4 v[64:67], v125, s[12:15], s23 offen offset:0
    s_waitcnt lgkmcnt(5)
    v_mfma_f32_16x16x32_bf16 v[56:59], v[80:83], v[88:91], v[56:59]
    v_mfma_f32_16x16x32_bf16 v[52:55], v[84:87], v[88:91], v[52:55]
    s_waitcnt lgkmcnt(0)
    s_barrier
    v_mfma_f32_16x16x32_bf16 v[28:31], v[68:71], v[92:95], v[28:31]
    v_mfma_f32_16x16x32_bf16 v[24:27], v[72:75], v[92:95], v[24:27]
    v_mfma_f32_16x16x32_bf16 v[20:23], v[76:79], v[92:95], v[20:23]
    buffer_load_dwordx4 v[68:71], v125, s[12:15], s23 offen offset:2048
    v_mfma_f32_16x16x32_bf16 v[60:63], v[80:83], v[96:99], v[60:63]
    v_mfma_f32_16x16x32_bf16 v[56:59], v[84:87], v[96:99], v[56:59]
    buffer_load_dwordx4 v[80:83], v119, s[12:15], s23 offen offset:0
    v_mfma_f32_16x16x32_bf16 v[28:31], v[72:75], v[100:103], v[28:31]
    v_mfma_f32_16x16x32_bf16 v[24:27], v[76:79], v[100:103], v[24:27]
    buffer_load_dwordx4 v[72:75], v125, s[12:15], s26 offen offset:0
    v_mfma_f32_16x16x32_bf16 v[60:63], v[84:87], v[104:107], v[60:63]
    buffer_load_dwordx4 v[84:87], v119, s[12:15], s23 offen offset:2048
    v_mfma_f32_16x16x32_bf16 v[28:31], v[76:79], v[108:111], v[28:31]
    buffer_load_dwordx4 v[76:79], v125, s[12:15], s26 offen offset:2048
    s_add_u32 s23, s23, 57344
    s_add_u32 s26, s26, 57344
    s_sub_u32 s22, s22, 1
    s_cmp_eq_u32 s22, 0
    s_cbranch_scc1 L_conv1_kernel_mlast2
    ds_read_b128 v[88:91], v120 offset:8192
    ds_read_b128 v[92:95], v120 offset:9216
    ds_read_b128 v[96:99], v116 offset:8704
    ds_read_b128 v[100:103], v120 offset:10240
    ds_read_b128 v[104:107], v116 offset:9792
    ds_read_b128 v[108:111], v120 offset:11264
    ds_read_b128 v[112:115], v116 offset:10880
    s_waitcnt vmcnt(5) lgkmcnt(6)
    v_mfma_f32_16x16x32_bf16 v[0:3], v[64:67], v[88:91], v[0:3]
    ds_read_b128 v[88:91], v120 offset:12288
    s_waitcnt vmcnt(4) lgkmcnt(6)
    v_mfma_f32_16x16x32_bf16 v[4:7], v[64:67], v[92:95], v[4:7]
    v_mfma_f32_16x16x32_bf16 v[0:3], v[68:71], v[92:95], v[0:3]
    ds_read_b128 v[92:95], v116 offset:11968
    s_waitcnt vmcnt(3) lgkmcnt(6)
    v_mfma_f32_16x16x32_bf16 v[32:35], v[80:83], v[96:99], v[32:35]
    ds_read_b128 v[96:99], v120 offset:13312
    s_waitcnt vmcnt(2) lgkmcnt(6)
    v_mfma_f32_16x16x32_bf16 v[8:11], v[64:67], v[100:103], v[8:11]
    v_mfma_f32_16x16x32_bf16 v[4:7], v[68:71], v[100:103], v[4:7]
    v_mfma_f32_16x16x32_bf16 v[0:3], v[72:75], v[100:103], v[0:3]
    ds_read_b128 v[100:103], v116 offset:13056
    s_waitcnt vmcnt(1) lgkmcnt(6)
    v_mfma_f32_16x16x32_bf16 v[36:39], v[80:83], v[104:107], v[36:39]
    v_mfma_f32_16x16x32_bf16 v[32:35], v[84:87], v[104:107], v[32:35]
    ds_read_b128 v[104:107], v120 offset:14336
    s_waitcnt vmcnt(0) lgkmcnt(6)
    v_mfma_f32_16x16x32_bf16 v[12:15], v[64:67], v[108:111], v[12:15]
    v_mfma_f32_16x16x32_bf16 v[8:11], v[68:71], v[108:111], v[8:11]
    v_mfma_f32_16x16x32_bf16 v[4:7], v[72:75], v[108:111], v[4:7]
    v_mfma_f32_16x16x32_bf16 v[0:3], v[76:79], v[108:111], v[0:3]
    ds_read_b128 v[108:111], v116 offset:14144
    s_waitcnt lgkmcnt(6)
    v_mfma_f32_16x16x32_bf16 v[40:43], v[80:83], v[112:115], v[40:43]
    v_mfma_f32_16x16x32_bf16 v[36:39], v[84:87], v[112:115], v[36:39]
    ds_read_b128 v[112:115], v120 offset:15360
    s_waitcnt lgkmcnt(6)
    v_mfma_f32_16x16x32_bf16 v[16:19], v[64:67], v[88:91], v[16:19]
    v_mfma_f32_16x16x32_bf16 v[12:15], v[68:71], v[88:91], v[12:15]
    v_mfma_f32_16x16x32_bf16 v[8:11], v[72:75], v[88:91], v[8:11]
    v_mfma_f32_16x16x32_bf16 v[4:7], v[76:79], v[88:91], v[4:7]
    ds_read_b128 v[88:91], v117 offset:8704
    s_waitcnt lgkmcnt(6)
    v_mfma_f32_16x16x32_bf16 v[44:47], v[80:83], v[92:95], v[44:47]
    v_mfma_f32_16x16x32_bf16 v[40:43], v[84:87], v[92:95], v[40:43]
    ds_read_b128 v[92:95], v122 offset:0
    v_add_u32 v122, v124, v122
    s_waitcnt lgkmcnt(6)
    v_mfma_f32_16x16x32_bf16 v[20:23], v[64:67], v[96:99], v[20:23]
    v_mfma_f32_16x16x32_bf16 v[16:19], v[68:71], v[96:99], v[16:19]
    v_mfma_f32_16x16x32_bf16 v[12:15], v[72:75], v[96:99], v[12:15]
    v_mfma_f32_16x16x32_bf16 v[8:11], v[76:79], v[96:99], v[8:11]
    ds_read_b128 v[96:99], v117 offset:9792
    s_waitcnt lgkmcnt(6)
    v_mfma_f32_16x16x32_bf16 v[48:51], v[80:83], v[100:103], v[48:51]
    v_mfma_f32_16x16x32_bf16 v[44:47], v[84:87], v[100:103], v[44:47]
    ds_read_b128 v[100:103], v121 offset:9216
    s_waitcnt lgkmcnt(6)
    v_mfma_f32_16x16x32_bf16 v[24:27], v[64:67], v[104:107], v[24:27]
    v_mfma_f32_16x16x32_bf16 v[20:23], v[68:71], v[104:107], v[20:23]
    v_mfma_f32_16x16x32_bf16 v[16:19], v[72:75], v[104:107], v[16:19]
    v_mfma_f32_16x16x32_bf16 v[12:15], v[76:79], v[104:107], v[12:15]
    ds_read_b128 v[104:107], v118 offset:8704
    s_waitcnt lgkmcnt(6)
    v_mfma_f32_16x16x32_bf16 v[52:55], v[80:83], v[108:111], v[52:55]
    v_mfma_f32_16x16x32_bf16 v[48:51], v[84:87], v[108:111], v[48:51]
    ds_read_b128 v[108:111], v121 offset:10240
    s_waitcnt lgkmcnt(6)
    v_mfma_f32_16x16x32_bf16 v[28:31], v[64:67], v[112:115], v[28:31]
    v_mfma_f32_16x16x32_bf16 v[24:27], v[68:71], v[112:115], v[24:27]
    v_mfma_f32_16x16x32_bf16 v[20:23], v[72:75], v[112:115], v[20:23]
    v_mfma_f32_16x16x32_bf16 v[16:19], v[76:79], v[112:115], v[16:19]
    buffer_load_dwordx4 v[64:67], v125, s[12:15], s23 offen offset:0
    s_waitcnt lgkmcnt(5)
    v_mfma_f32_16x16x32_bf16 v[56:59], v[80:83], v[88:91], v[56:59]
    v_mfma_f32_16x16x32_bf16 v[52:55], v[84:87], v[88:91], v[52:55]
    s_waitcnt lgkmcnt(0)
    s_barrier
    v_mfma_f32_16x16x32_bf16 v[28:31], v[68:71], v[92:95], v[28:31]
    v_mfma_f32_16x16x32_bf16 v[24:27], v[72:75], v[92:95], v[24:27]
    v_mfma_f32_16x16x32_bf16 v[20:23], v[76:79], v[92:95], v[20:23]
    buffer_load_dwordx4 v[68:71], v125, s[12:15], s23 offen offset:2048
    v_mfma_f32_16x16x32_bf16 v[60:63], v[80:83], v[96:99], v[60:63]
    v_mfma_f32_16x16x32_bf16 v[56:59], v[84:87], v[96:99], v[56:59]
    buffer_load_dwordx4 v[80:83], v119, s[12:15], s23 offen offset:0
    v_mfma_f32_16x16x32_bf16 v[28:31], v[72:75], v[100:103], v[28:31]
    v_mfma_f32_16x16x32_bf16 v[24:27], v[76:79], v[100:103], v[24:27]
    buffer_load_dwordx4 v[72:75], v125, s[12:15], s26 offen offset:0
    v_mfma_f32_16x16x32_bf16 v[60:63], v[84:87], v[104:107], v[60:63]
    buffer_load_dwordx4 v[84:87], v119, s[12:15], s23 offen offset:2048
    v_mfma_f32_16x16x32_bf16 v[28:31], v[76:79], v[108:111], v[28:31]
    buffer_load_dwordx4 v[76:79], v125, s[12:15], s26 offen offset:2048
    s_add_u32 s23, s23, 57344
    s_add_u32 s26, s26, 57344
    s_branch L_conv1_kernel_mloop2
L_conv1_kernel_mlast2:
    v_and_b32 v125, 15, v127
    v_and_b32 v126, 7, v127
    v_lshlrev_b32 v126, 4, v126
    v_lshl_add_u32 v125, v125, 7, v126
    v_lshrrev_b32 v126, 4, v127
    v_lshl_add_u32 v125, v126, 11, v125
    s_mov_b32 s36, 65536
    s_cmp_eq_u32 s32, 1
    s_cselect_b32 s36, 121856, s36
    s_cmp_eq_u32 s32, 2
    s_cselect_b32 s36, 81920, s36
    s_cmp_eq_u32 s32, 3
    s_cselect_b32 s36, 130048, s36
    s_mov_b32 s37, 98304
    s_cmp_eq_u32 s32, 1
    s_cselect_b32 s37, 138240, s37
    s_cmp_eq_u32 s32, 2
    s_cselect_b32 s37, 146432, s37
    s_cmp_eq_u32 s32, 3
    s_cselect_b32 s37, 154624, s37
    v_add_u32 v126, s37, v125
    v_add_u32 v125, s36, v125
    ds_read_b128 v[88:91], v120 offset:8192
    ds_read_b128 v[92:95], v120 offset:9216
    ds_read_b128 v[96:99], v116 offset:8704
    ds_read_b128 v[100:103], v120 offset:10240
    ds_read_b128 v[104:107], v116 offset:9792
    ds_read_b128 v[108:111], v120 offset:11264
    ds_read_b128 v[112:115], v116 offset:10880
    s_waitcnt vmcnt(5) lgkmcnt(6)
    v_mfma_f32_16x16x32_bf16 v[0:3], v[64:67], v[88:91], v[0:3]
    ds_read_b128 v[88:91], v120 offset:12288
    s_waitcnt vmcnt(4) lgkmcnt(6)
    v_mfma_f32_16x16x32_bf16 v[4:7], v[64:67], v[92:95], v[4:7]
    v_mfma_f32_16x16x32_bf16 v[0:3], v[68:71], v[92:95], v[0:3]
    ds_read_b128 v[92:95], v116 offset:11968
    s_waitcnt vmcnt(3) lgkmcnt(6)
    v_mfma_f32_16x16x32_bf16 v[32:35], v[80:83], v[96:99], v[32:35]
    ds_read_b128 v[96:99], v120 offset:13312
    s_waitcnt vmcnt(2) lgkmcnt(6)
    v_mfma_f32_16x16x32_bf16 v[8:11], v[64:67], v[100:103], v[8:11]
    v_mfma_f32_16x16x32_bf16 v[4:7], v[68:71], v[100:103], v[4:7]
    v_mfma_f32_16x16x32_bf16 v[0:3], v[72:75], v[100:103], v[0:3]
    ds_read_b128 v[100:103], v116 offset:13056
    s_waitcnt vmcnt(1) lgkmcnt(6)
    v_mfma_f32_16x16x32_bf16 v[36:39], v[80:83], v[104:107], v[36:39]
    v_mfma_f32_16x16x32_bf16 v[32:35], v[84:87], v[104:107], v[32:35]
    ds_read_b128 v[104:107], v120 offset:14336
    s_waitcnt vmcnt(0) lgkmcnt(6)
    v_mfma_f32_16x16x32_bf16 v[12:15], v[64:67], v[108:111], v[12:15]
    v_mfma_f32_16x16x32_bf16 v[8:11], v[68:71], v[108:111], v[8:11]
    v_mfma_f32_16x16x32_bf16 v[4:7], v[72:75], v[108:111], v[4:7]
    v_mfma_f32_16x16x32_bf16 v[0:3], v[76:79], v[108:111], v[0:3]
    ds_read_b128 v[108:111], v116 offset:14144
    s_waitcnt lgkmcnt(6)
    v_mfma_f32_16x16x32_bf16 v[40:43], v[80:83], v[112:115], v[40:43]
    v_mfma_f32_16x16x32_bf16 v[36:39], v[84:87], v[112:115], v[36:39]
    ds_read_b128 v[112:115], v120 offset:15360
    s_waitcnt lgkmcnt(6)
    v_mfma_f32_16x16x32_bf16 v[16:19], v[64:67], v[88:91], v[16:19]
    v_mfma_f32_16x16x32_bf16 v[12:15], v[68:71], v[88:91], v[12:15]
    v_mfma_f32_16x16x32_bf16 v[8:11], v[72:75], v[88:91], v[8:11]
    v_mfma_f32_16x16x32_bf16 v[4:7], v[76:79], v[88:91], v[4:7]
    ds_read_b128 v[88:91], v117 offset:8704
    v_xor_b32 v124, 0, v126
    ds_write_b128 v124, v[32:35]
    s_waitcnt lgkmcnt(7)
    v_mfma_f32_16x16x32_bf16 v[44:47], v[80:83], v[92:95], v[44:47]
    v_mfma_f32_16x16x32_bf16 v[40:43], v[84:87], v[92:95], v[40:43]
    ds_read_b128 v[92:95], v122 offset:0
    v_xor_b32 v123, 0, v125
    ds_write_b128 v123, v[0:3]
    s_waitcnt lgkmcnt(8)
    v_mfma_f32_16x16x32_bf16 v[20:23], v[64:67], v[96:99], v[20:23]
    v_mfma_f32_16x16x32_bf16 v[16:19], v[68:71], v[96:99], v[16:19]
    v_mfma_f32_16x16x32_bf16 v[12:15], v[72:75], v[96:99], v[12:15]
    v_mfma_f32_16x16x32_bf16 v[8:11], v[76:79], v[96:99], v[8:11]
    ds_read_b128 v[96:99], v117 offset:9792
    v_xor_b32 v123, 16, v126
    ds_write_b128 v123, v[36:39]
    s_waitcnt lgkmcnt(9)
    v_mfma_f32_16x16x32_bf16 v[48:51], v[80:83], v[100:103], v[48:51]
    v_mfma_f32_16x16x32_bf16 v[44:47], v[84:87], v[100:103], v[44:47]
    ds_read_b128 v[100:103], v121 offset:9216
    v_xor_b32 v124, 16, v125
    ds_write_b128 v124, v[4:7]
    s_waitcnt lgkmcnt(10)
    v_mfma_f32_16x16x32_bf16 v[24:27], v[64:67], v[104:107], v[24:27]
    v_mfma_f32_16x16x32_bf16 v[20:23], v[68:71], v[104:107], v[20:23]
    v_mfma_f32_16x16x32_bf16 v[16:19], v[72:75], v[104:107], v[16:19]
    v_mfma_f32_16x16x32_bf16 v[12:15], v[76:79], v[104:107], v[12:15]
    ds_read_b128 v[104:107], v118 offset:8704
    v_xor_b32 v124, 32, v126
    ds_write_b128 v124, v[40:43]
    s_waitcnt lgkmcnt(11)
    v_mfma_f32_16x16x32_bf16 v[52:55], v[80:83], v[108:111], v[52:55]
    v_mfma_f32_16x16x32_bf16 v[48:51], v[84:87], v[108:111], v[48:51]
    ds_read_b128 v[108:111], v121 offset:10240
    v_xor_b32 v123, 32, v125
    ds_write_b128 v123, v[8:11]
    s_waitcnt lgkmcnt(12)
    v_mfma_f32_16x16x32_bf16 v[28:31], v[64:67], v[112:115], v[28:31]
    v_mfma_f32_16x16x32_bf16 v[24:27], v[68:71], v[112:115], v[24:27]
    v_mfma_f32_16x16x32_bf16 v[20:23], v[72:75], v[112:115], v[20:23]
    v_mfma_f32_16x16x32_bf16 v[16:19], v[76:79], v[112:115], v[16:19]
    v_xor_b32 v123, 48, v126
    ds_write_b128 v123, v[44:47]
    s_waitcnt lgkmcnt(12)
    v_mfma_f32_16x16x32_bf16 v[56:59], v[80:83], v[88:91], v[56:59]
    v_mfma_f32_16x16x32_bf16 v[52:55], v[84:87], v[88:91], v[52:55]
    v_xor_b32 v124, 48, v125
    ds_write_b128 v124, v[12:15]
    s_waitcnt lgkmcnt(11)
    v_mfma_f32_16x16x32_bf16 v[28:31], v[68:71], v[92:95], v[28:31]
    v_mfma_f32_16x16x32_bf16 v[24:27], v[72:75], v[92:95], v[24:27]
    v_mfma_f32_16x16x32_bf16 v[20:23], v[76:79], v[92:95], v[20:23]
    v_xor_b32 v124, 64, v126
    ds_write_b128 v124, v[48:51]
    s_waitcnt lgkmcnt(10)
    v_mfma_f32_16x16x32_bf16 v[60:63], v[80:83], v[96:99], v[60:63]
    v_mfma_f32_16x16x32_bf16 v[56:59], v[84:87], v[96:99], v[56:59]
    v_xor_b32 v123, 64, v125
    ds_write_b128 v123, v[16:19]
    s_waitcnt lgkmcnt(9)
    v_mfma_f32_16x16x32_bf16 v[28:31], v[72:75], v[100:103], v[28:31]
    v_mfma_f32_16x16x32_bf16 v[24:27], v[76:79], v[100:103], v[24:27]
    v_xor_b32 v123, 80, v126
    ds_write_b128 v123, v[52:55]
    s_waitcnt lgkmcnt(8)
    v_mfma_f32_16x16x32_bf16 v[60:63], v[84:87], v[104:107], v[60:63]
    v_xor_b32 v124, 80, v125
    ds_write_b128 v124, v[20:23]
    s_waitcnt lgkmcnt(7)
    v_mfma_f32_16x16x32_bf16 v[28:31], v[76:79], v[108:111], v[28:31]
    v_xor_b32 v124, 96, v126
    ds_write_b128 v124, v[56:59]
    v_and_b32 v108, 15, v127
    v_lshrrev_b32 v109, 4, v127
    v_lshrrev_b32 v110, 3, v108
    s_lshl_b32 s36, s20, 1
    v_add_u32 v110, s36, v110
    v_xor_b32 v111, v110, v108
    v_and_b32 v111, 7, v111
    v_lshlrev_b32 v111, 4, v111
    v_xor_b32 v123, 96, v125
    ds_write_b128 v123, v[24:27]
    v_lshl_add_u32 v111, v110, 7, v111
    v_lshl_add_u32 v120, v109, 11, v111
    v_add_u32 v121, 65536, v120
    v_add_u32 v64, 131072, v120
    s_lshl_b32 s36, s20, 9
    s_add_u32 s36, s36, 115712
    v_lshl_add_u32 v127, v109, 7, s36
    s_lshl_b32 s36, s20, 4
    v_add_u32 v108, s36, v108
    v_lshlrev_b32 v110, 6, v108
    v_lshl_add_u32 v110, v109, 4, v110
    s_mul_i32 s36, s29, 524288
    v_xor_b32 v123, 112, v126
    ds_write_b128 v123, v[60:63]
    s_lshl_b32 s37, s21, 4
    s_add_u32 s36, s36, s37
    v_add_u32 v110, s36, v110
    v_mov_b32 v111, 2130706432
    v_cmp_gt_u32 vcc, 125, v108
    s_mov_b32 s4, 0xbeaaaaab
    s_mov_b32 s5, s4
    s_mov_b32 s6, 0x3e800000
    s_mov_b32 s7, s6
    s_mov_b32 s8, 0xc0a00000
    s_mov_b32 s9, s8
    s_mov_b32 s10, 0xc0638e39
    v_xor_b32 v124, 112, v125
    ds_write_b128 v124, v[28:31]
    s_mov_b32 s11, s10
    s_mov_b32 s12, 0xbf638e39
    s_mov_b32 s13, s12
    s_mov_b32 s14, 0xbe638e39
    s_mov_b32 s15, s14
    s_mov_b32 s22, 0xbd638e39
    s_mov_b32 s23, s22
    s_mov_b32 s24, 0x3ff1c71c
    s_mov_b32 s25, s24
    s_mov_b32 s26, 0xbf2aaaab
    s_mov_b32 s27, s26
    s_mov_b32 s32, 0x3ecccccd
    s_mov_b32 s33, s32
    s_mov_b32 s34, 0xbd888889
    s_mov_b32 s35, s34
    s_mov_b32 s38, 0xbe4ccccd
    s_mov_b32 s39, s38
    s_mov_b32 s40, 0xbdd2d3e8
    s_mov_b32 s41, s40
    s_mov_b32 s42, 0x3f800000
    s_mov_b32 s43, s42
    s_setprio 0
    s_branch L_conv1_kernel_epi
L_conv1_kernel_helper:
    s_setprio 3
    v_add_u32 v92, 0, v7
    v_add_u32 v93, 1024, v7
    v_add_u32 v94, 2048, v7
    v_add_u32 v95, 3072, v7
    v_and_b32 v76, 4, v5
    v_lshrrev_b32 v76, 1, v76
    v_xor_b32 v76, v6, v76
    v_lshlrev_b32 v76, 4, v76
    v_lshl_add_u32 v76, v5, 6, v76
    s_mov_b32 s24, 0
    s_mov_b32 s27, 524288
    s_waitcnt lgkmcnt(0)
    s_add_u32 s8, s4, s47
    s_addc_u32 s9, s5, 0
    buffer_load_dwordx4 v[0:3], v92, s[8:11], s24 offen offset:0
    buffer_load_dwordx4 v[16:19], v92, s[8:11], s24 offen offset:64
    v_add_u32 v92, 128, v92
    buffer_load_dwordx4 v[4:7], v93, s[8:11], s24 offen offset:0
    buffer_load_dwordx4 v[20:23], v93, s[8:11], s24 offen offset:64
    v_add_u32 v93, 128, v93
    buffer_load_dwordx4 v[8:11], v94, s[8:11], s24 offen offset:0
    buffer_load_dwordx4 v[24:27], v94, s[8:11], s24 offen offset:64
    v_add_u32 v94, 128, v94
    buffer_load_dwordx4 v[12:15], v95, s[8:11], s24 offen offset:0
    buffer_load_dwordx4 v[28:31], v95, s[8:11], s24 offen offset:64
    v_add_u32 v95, 128, v95
    s_mul_i32 s36, s42, 1024
    v_add_u32 v96, s36, v76
    v_add_u32 v97, 65536, v96
    s_mul_i32 s36, s42, 1088
    s_add_u32 s36, s36, 98304
    v_add_u32 v98, s36, v76
    s_waitcnt vmcnt(0)
    s_mov_b32 s28, 0
    s_mov_b32 s22, 4
    s_cmp_ge_u32 s20, 12
    s_cbranch_scc1 L_conv1_kernel_h2
    ds_write_b128 v96, v[0:3] offset:0
    ds_write_b128 v98, v[12:15] offset:0
    v_lshlrev_b32 v76, 16, v0
    v_and_b32 v84, s25, v0
    v_lshlrev_b32 v77, 16, v4
    v_and_b32 v85, s25, v4
    v_lshlrev_b32 v78, 16, v8
    v_and_b32 v86, s25, v8
    v_lshlrev_b32 v79, 16, v12
    v_and_b32 v87, s25, v12
    v_add_f32 v80, v76, v78
    v_add_f32 v88, v84, v86
    v_add_f32 v81, v77, v79
    v_add_f32 v89, v85, v87
    v_fma_f32 v82, v78, 4.0, v76
    v_fma_f32 v90, v86, 4.0, v84
    v_fma_f32 v83, v79, 4.0, v77
    v_fma_f32 v91, v87, 4.0, v85
    v_add_f32 v77, v80, v81
    v_add_f32 v85, v88, v89
    v_sub_f32 v78, v80, v81
    v_sub_f32 v86, v88, v89
    v_fma_f32 v79, v83, 2.0, v82
    v_fma_f32 v87, v91, 2.0, v90
    v_fma_f32 v82, v83, -2.0, v82
    v_fma_f32 v90, v91, -2.0, v90
    v_fmamk_f32 v80, v76, 0x41700000, v82
    v_fmamk_f32 v88, v84, 0x41700000, v90
    v_fmamk_f32 v80, v81, 0x41200000, v80
    v_fmamk_f32 v88, v89, 0x41200000, v88
    v_cvt_pk_bf16_f32 v4, v77, v85
    v_cvt_pk_bf16_f32 v8, v78, v86
    v_cvt_pk_bf16_f32 v64, v79, v87
    v_cvt_pk_bf16_f32 v68, v82, v90
    v_cvt_pk_bf16_f32 v72, v80, v88
    v_lshlrev_b32 v76, 16, v1
    v_and_b32 v84, s25, v1
    v_lshlrev_b32 v77, 16, v5
    v_and_b32 v85, s25, v5
    v_lshlrev_b32 v78, 16, v9
    v_and_b32 v86, s25, v9
    v_lshlrev_b32 v79, 16, v13
    v_and_b32 v87, s25, v13
    v_add_f32 v80, v76, v78
    v_add_f32 v88, v84, v86
    v_add_f32 v81, v77, v79
    v_add_f32 v89, v85, v87
    v_fma_f32 v82, v78, 4.0, v76
    v_fma_f32 v90, v86, 4.0, v84
    v_fma_f32 v83, v79, 4.0, v77
    v_fma_f32 v91, v87, 4.0, v85
    v_add_f32 v77, v80, v81
    v_add_f32 v85, v88, v89
    v_sub_f32 v78, v80, v81
    v_sub_f32 v86, v88, v89
    v_fma_f32 v79, v83, 2.0, v82
    v_fma_f32 v87, v91, 2.0, v90
    v_fma_f32 v82, v83, -2.0, v82
    v_fma_f32 v90, v91, -2.0, v90
    v_fmamk_f32 v80, v76, 0x41700000, v82
    v_fmamk_f32 v88, v84, 0x41700000, v90
    v_fmamk_f32 v80, v81, 0x41200000, v80
    v_fmamk_f32 v88, v89, 0x41200000, v88
    v_cvt_pk_bf16_f32 v5, v77, v85
    v_cvt_pk_bf16_f32 v9, v78, v86
    v_cvt_pk_bf16_f32 v65, v79, v87
    v_cvt_pk_bf16_f32 v69, v82, v90
    v_cvt_pk_bf16_f32 v73, v80, v88
    v_lshlrev_b32 v76, 16, v2
    v_and_b32 v84, s25, v2
    v_lshlrev_b32 v77, 16, v6
    v_and_b32 v85, s25, v6
    v_lshlrev_b32 v78, 16, v10
    v_and_b32 v86, s25, v10
    v_lshlrev_b32 v79, 16, v14
    v_and_b32 v87, s25, v14
    v_add_f32 v80, v76, v78
    v_add_f32 v88, v84, v86
    v_add_f32 v81, v77, v79
    v_add_f32 v89, v85, v87
    v_fma_f32 v82, v78, 4.0, v76
    v_fma_f32 v90, v86, 4.0, v84
    v_fma_f32 v83, v79, 4.0, v77
    v_fma_f32 v91, v87, 4.0, v85
    v_add_f32 v77, v80, v81
    v_add_f32 v85, v88, v89
    v_sub_f32 v78, v80, v81
    v_sub_f32 v86, v88, v89
    v_fma_f32 v79, v83, 2.0, v82
    v_fma_f32 v87, v91, 2.0, v90
    v_fma_f32 v82, v83, -2.0, v82
    v_fma_f32 v90, v91, -2.0, v90
    v_fmamk_f32 v80, v76, 0x41700000, v82
    v_fmamk_f32 v88, v84, 0x41700000, v90
    v_fmamk_f32 v80, v81, 0x41200000, v80
    v_fmamk_f32 v88, v89, 0x41200000, v88
    v_cvt_pk_bf16_f32 v6, v77, v85
    v_cvt_pk_bf16_f32 v10, v78, v86
    v_cvt_pk_bf16_f32 v66, v79, v87
    v_cvt_pk_bf16_f32 v70, v82, v90
    v_cvt_pk_bf16_f32 v74, v80, v88
    v_lshlrev_b32 v76, 16, v3
    v_and_b32 v84, s25, v3
    v_lshlrev_b32 v77, 16, v7
    v_and_b32 v85, s25, v7
    v_lshlrev_b32 v78, 16, v11
    v_and_b32 v86, s25, v11
    v_lshlrev_b32 v79, 16, v15
    v_and_b32 v87, s25, v15
    v_add_f32 v80, v76, v78
    v_add_f32 v88, v84, v86
    v_add_f32 v81, v77, v79
    v_add_f32 v89, v85, v87
    v_fma_f32 v82, v78, 4.0, v76
    v_fma_f32 v90, v86, 4.0, v84
    v_fma_f32 v83, v79, 4.0, v77
    v_fma_f32 v91, v87, 4.0, v85
    v_add_f32 v77, v80, v81
    v_add_f32 v85, v88, v89
    v_sub_f32 v78, v80, v81
    v_sub_f32 v86, v88, v89
    v_fma_f32 v79, v83, 2.0, v82
    v_fma_f32 v87, v91, 2.0, v90
    v_fma_f32 v82, v83, -2.0, v82
    v_fma_f32 v90, v91, -2.0, v90
    v_fmamk_f32 v80, v76, 0x41700000, v82
    v_fmamk_f32 v88, v84, 0x41700000, v90
    v_fmamk_f32 v80, v81, 0x41200000, v80
    v_fmamk_f32 v88, v89, 0x41200000, v88
    v_cvt_pk_bf16_f32 v7, v77, v85
    v_cvt_pk_bf16_f32 v11, v78, v86
    v_cvt_pk_bf16_f32 v67, v79, v87
    v_cvt_pk_bf16_f32 v71, v82, v90
    v_cvt_pk_bf16_f32 v75, v80, v88
    ds_write_b128 v96, v[64:67] offset:49152
    ds_write_b128 v97, v[68:71] offset:0
    ds_write_b128 v97, v[72:75] offset:16384
    ds_write_b128 v96, v[4:7] offset:16384
    ds_write_b128 v96, v[8:11] offset:32768
    s_waitcnt vmcnt(0)
    s_waitcnt lgkmcnt(0)
    s_barrier
    buffer_load_dwordx4 v[32:35], v92, s[8:11], s24 offen offset:0
    buffer_load_dwordx4 v[48:51], v92, s[8:11], s24 offen offset:64
    v_add_u32 v92, 128, v92
    buffer_load_dwordx4 v[36:39], v93, s[8:11], s24 offen offset:0
    buffer_load_dwordx4 v[52:55], v93, s[8:11], s24 offen offset:64
    v_add_u32 v93, 128, v93
    s_setprio 1
L_conv1_kernel_hloop1:
    s_cmp_lt_u32 s28, 13
    s_cselect_b32 s24, 0, 2130706432
    v_lshlrev_b32 v76, 16, v16
    v_and_b32 v84, s25, v16
    v_lshlrev_b32 v77, 16, v20
    v_and_b32 v85, s25, v20
    v_lshlrev_b32 v78, 16, v24
    v_and_b32 v86, s25, v24
    v_lshlrev_b32 v79, 16, v28
    v_and_b32 v87, s25, v28
    v_add_f32 v80, v76, v78
    v_add_f32 v88, v84, v86
    v_add_f32 v81, v77, v79
    v_add_f32 v89, v85, v87
    v_fma_f32 v82, v78, 4.0, v76
    buffer_load_dwordx4 v[40:43], v94, s[8:11], s24 offen offset:0
    buffer_load_dwordx4 v[56:59], v94, s[8:11], s24 offen offset:64
    v_add_u32 v94, 128, v94
    v_fma_f32 v90, v86, 4.0, v84
    v_fma_f32 v83, v79, 4.0, v77
    v_fma_f32 v91, v87, 4.0, v85
    v_add_f32 v77, v80, v81
    v_add_f32 v85, v88, v89
    v_sub_f32 v78, v80, v81
    v_sub_f32 v86, v88, v89
    v_fma_f32 v79, v83, 2.0, v82
    v_fma_f32 v87, v91, 2.0, v90
    v_fma_f32 v82, v83, -2.0, v82
    v_fma_f32 v90, v91, -2.0, v90
    v_fmamk_f32 v80, v76, 0x41700000, v82
    v_fmamk_f32 v88, v84, 0x41700000, v90
    v_fmamk_f32 v80, v81, 0x41200000, v80
    v_fmamk_f32 v88, v89, 0x41200000, v88
    v_cvt_pk_bf16_f32 v20, v77, v85
    v_cvt_pk_bf16_f32 v24, v78, v86
    v_cvt_pk_bf16_f32 v64, v79, v87
    v_cvt_pk_bf16_f32 v68, v82, v90
    v_cvt_pk_bf16_f32 v72, v80, v88
    v_lshlrev_b32 v76, 16, v17
    v_and_b32 v84, s25, v17
    v_lshlrev_b32 v77, 16, v21
    v_and_b32 v85, s25, v21
    v_lshlrev_b32 v78, 16, v25
    v_and_b32 v86, s25, v25
    v_lshlrev_b32 v79, 16, v29
    v_and_b32 v87, s25, v29
    v_add_f32 v80, v76, v78
    v_add_f32 v88, v84, v86
    v_add_f32 v81, v77, v79
    v_add_f32 v89, v85, v87
    v_fma_f32 v82, v78, 4.0, v76
    v_fma_f32 v90, v86, 4.0, v84
    v_fma_f32 v83, v79, 4.0, v77
    v_fma_f32 v91, v87, 4.0, v85
    v_add_f32 v77, v80, v81
    v_add_f32 v85, v88, v89
    v_sub_f32 v78, v80, v81
    v_sub_f32 v86, v88, v89
    v_fma_f32 v79, v83, 2.0, v82
    v_fma_f32 v87, v91, 2.0, v90
    v_fma_f32 v82, v83, -2.0, v82
    v_fma_f32 v90, v91, -2.0, v90
    v_fmamk_f32 v80, v76, 0x41700000, v82
    v_fmamk_f32 v88, v84, 0x41700000, v90
    v_fmamk_f32 v80, v81, 0x41200000, v80
    v_fmamk_f32 v88, v89, 0x41200000, v88
    v_cvt_pk_bf16_f32 v21, v77, v85
    v_cvt_pk_bf16_f32 v25, v78, v86
    v_cvt_pk_bf16_f32 v65, v79, v87
    v_cvt_pk_bf16_f32 v69, v82, v90
    v_cvt_pk_bf16_f32 v73, v80, v88
    buffer_load_dwordx4 v[44:47], v95, s[8:11], s24 offen offset:0
    buffer_load_dwordx4 v[60:63], v95, s[8:11], s24 offen offset:64
    v_add_u32 v95, 128, v95
    v_lshlrev_b32 v76, 16, v18
    v_and_b32 v84, s25, v18
    v_lshlrev_b32 v77, 16, v22
    v_and_b32 v85, s25, v22
    v_lshlrev_b32 v78, 16, v26
    v_and_b32 v86, s25, v26
    v_lshlrev_b32 v79, 16, v30
    v_and_b32 v87, s25, v30
    v_add_f32 v80, v76, v78
    v_add_f32 v88, v84, v86
    v_add_f32 v81, v77, v79
    v_add_f32 v89, v85, v87
    v_fma_f32 v82, v78, 4.0, v76
    v_fma_f32 v90, v86, 4.0, v84
    v_fma_f32 v83, v79, 4.0, v77
    v_fma_f32 v91, v87, 4.0, v85
    v_add_f32 v77, v80, v81
    v_add_f32 v85, v88, v89
    v_sub_f32 v78, v80, v81
    v_sub_f32 v86, v88, v89
    v_fma_f32 v79, v83, 2.0, v82
    v_fma_f32 v87, v91, 2.0, v90
    v_fma_f32 v82, v83, -2.0, v82
    v_fma_f32 v90, v91, -2.0, v90
    v_fmamk_f32 v80, v76, 0x41700000, v82
    v_fmamk_f32 v88, v84, 0x41700000, v90
    v_fmamk_f32 v80, v81, 0x41200000, v80
    v_fmamk_f32 v88, v89, 0x41200000, v88
    v_cvt_pk_bf16_f32 v22, v77, v85
    v_cvt_pk_bf16_f32 v26, v78, v86
    v_cvt_pk_bf16_f32 v66, v79, v87
    v_cvt_pk_bf16_f32 v70, v82, v90
    v_cvt_pk_bf16_f32 v74, v80, v88
    v_lshlrev_b32 v76, 16, v19
    v_and_b32 v84, s25, v19
    v_lshlrev_b32 v77, 16, v23
    v_and_b32 v85, s25, v23
    v_lshlrev_b32 v78, 16, v27
    v_and_b32 v86, s25, v27
    v_lshlrev_b32 v79, 16, v31
    v_and_b32 v87, s25, v31
    v_add_f32 v80, v76, v78
    v_add_f32 v88, v84, v86
    v_add_f32 v81, v77, v79
    v_add_f32 v89, v85, v87
    v_fma_f32 v82, v78, 4.0, v76
    v_fma_f32 v90, v86, 4.0, v84
    v_fma_f32 v83, v79, 4.0, v77
    v_fma_f32 v91, v87, 4.0, v85
    v_add_f32 v77, v80, v81
    v_add_f32 v85, v88, v89
    v_sub_f32 v78, v80, v81
    v_sub_f32 v86, v88, v89
    v_fma_f32 v79, v83, 2.0, v82
    v_fma_f32 v87, v91, 2.0, v90
    v_fma_f32 v82, v83, -2.0, v82
    v_fma_f32 v90, v91, -2.0, v90
    v_fmamk_f32 v80, v76, 0x41700000, v82
    v_fmamk_f32 v88, v84, 0x41700000, v90
    v_fmamk_f32 v80, v81, 0x41200000, v80
    v_fmamk_f32 v88, v89, 0x41200000, v88
    v_cvt_pk_bf16_f32 v23, v77, v85
    v_cvt_pk_bf16_f32 v27, v78, v86
    v_cvt_pk_bf16_f32 v67, v79, v87
    v_cvt_pk_bf16_f32 v71, v82, v90
    v_cvt_pk_bf16_f32 v75, v80, v88
    ds_write_b128 v96, v[64:67] offset:57344
    ds_write_b128 v97, v[68:71] offset:8192
    ds_write_b128 v97, v[72:75] offset:24576
    ds_write_b128 v96, v[16:19] offset:8192
    ds_write_b128 v96, v[20:23] offset:24576
    ds_write_b128 v96, v[24:27] offset:40960
    ds_write_b128 v98, v[28:31] offset:8704
    s_add_u32 s28, s28, 1
    s_waitcnt lgkmcnt(0)
    s_barrier
    s_cmp_lt_u32 s28, 13
    s_cselect_b32 s24, 0, 2130706432
    s_waitcnt vmcnt(0)
    v_lshlrev_b32 v76, 16, v32
    v_and_b32 v84, s25, v32
    v_lshlrev_b32 v77, 16, v36
    v_and_b32 v85, s25, v36
    v_lshlrev_b32 v78, 16, v40
    v_and_b32 v86, s25, v40
    v_lshlrev_b32 v79, 16, v44
    v_and_b32 v87, s25, v44
    v_add_f32 v80, v76, v78
    v_add_f32 v88, v84, v86
    v_add_f32 v81, v77, v79
    v_add_f32 v89, v85, v87
    v_fma_f32 v82, v78, 4.0, v76
    v_fma_f32 v90, v86, 4.0, v84
    v_fma_f32 v83, v79, 4.0, v77
    v_fma_f32 v91, v87, 4.0, v85
    v_add_f32 v77, v80, v81
    v_add_f32 v85, v88, v89
    v_sub_f32 v78, v80, v81
    v_sub_f32 v86, v88, v89
    v_fma_f32 v79, v83, 2.0, v82
    v_fma_f32 v87, v91, 2.0, v90
    v_fma_f32 v82, v83, -2.0, v82
    v_fma_f32 v90, v91, -2.0, v90
    v_fmamk_f32 v80, v76, 0x41700000, v82
    v_fmamk_f32 v88, v84, 0x41700000, v90
    v_fmamk_f32 v80, v81, 0x41200000, v80
    v_fmamk_f32 v88, v89, 0x41200000, v88
    v_cvt_pk_bf16_f32 v36, v77, v85
    v_cvt_pk_bf16_f32 v40, v78, v86
    v_cvt_pk_bf16_f32 v64, v79, v87
    v_cvt_pk_bf16_f32 v68, v82, v90
    v_cvt_pk_bf16_f32 v72, v80, v88
    v_lshlrev_b32 v76, 16, v33
    v_and_b32 v84, s25, v33
    v_lshlrev_b32 v77, 16, v37
    v_and_b32 v85, s25, v37
    v_lshlrev_b32 v78, 16, v41
    v_and_b32 v86, s25, v41
    buffer_load_dwordx4 v[0:3], v92, s[8:11], s24 offen offset:0
    buffer_load_dwordx4 v[16:19], v92, s[8:11], s24 offen offset:64
    v_add_u32 v92, 128, v92
    v_lshlrev_b32 v79, 16, v45
    v_and_b32 v87, s25, v45
    v_add_f32 v80, v76, v78
    v_add_f32 v88, v84, v86
    v_add_f32 v81, v77, v79
    v_add_f32 v89, v85, v87
    v_fma_f32 v82, v78, 4.0, v76
    v_fma_f32 v90, v86, 4.0, v84
    v_fma_f32 v83, v79, 4.0, v77
    v_fma_f32 v91, v87, 4.0, v85
    v_add_f32 v77, v80, v81
    v_add_f32 v85, v88, v89
    v_sub_f32 v78, v80, v81
    v_sub_f32 v86, v88, v89
    v_fma_f32 v79, v83, 2.0, v82
    v_fma_f32 v87, v91, 2.0, v90
    v_fma_f32 v82, v83, -2.0, v82
    v_fma_f32 v90, v91, -2.0, v90
    v_fmamk_f32 v80, v76, 0x41700000, v82
    v_fmamk_f32 v88, v84, 0x41700000, v90
    v_fmamk_f32 v80, v81, 0x41200000, v80
    v_fmamk_f32 v88, v89, 0x41200000, v88
    v_cvt_pk_bf16_f32 v37, v77, v85
    v_cvt_pk_bf16_f32 v41, v78, v86
    v_cvt_pk_bf16_f32 v65, v79, v87
    v_cvt_pk_bf16_f32 v69, v82, v90
    v_cvt_pk_bf16_f32 v73, v80, v88
    v_lshlrev_b32 v76, 16, v34
    v_and_b32 v84, s25, v34
    v_lshlrev_b32 v77, 16, v38
    v_and_b32 v85, s25, v38
    v_lshlrev_b32 v78, 16, v42
    v_and_b32 v86, s25, v42
    v_lshlrev_b32 v79, 16, v46
    v_and_b32 v87, s25, v46
    v_add_f32 v80, v76, v78
    v_add_f32 v88, v84, v86
    v_add_f32 v81, v77, v79
    v_add_f32 v89, v85, v87
    v_fma_f32 v82, v78, 4.0, v76
    v_fma_f32 v90, v86, 4.0, v84
    v_fma_f32 v83, v79, 4.0, v77
    v_fma_f32 v91, v87, 4.0, v85
    v_add_f32 v77, v80, v81
    v_add_f32 v85, v88, v89
    v_sub_f32 v78, v80, v81
    v_sub_f32 v86, v88, v89
    v_fma_f32 v79, v83, 2.0, v82
    v_fma_f32 v87, v91, 2.0, v90
    v_fma_f32 v82, v83, -2.0, v82
    v_fma_f32 v90, v91, -2.0, v90
    v_fmamk_f32 v80, v76, 0x41700000, v82
    v_fmamk_f32 v88, v84, 0x41700000, v90
    buffer_load_dwordx4 v[4:7], v93, s[8:11], s24 offen offset:0
    buffer_load_dwordx4 v[20:23], v93, s[8:11], s24 offen offset:64
    v_add_u32 v93, 128, v93
    v_fmamk_f32 v80, v81, 0x41200000, v80
    v_fmamk_f32 v88, v89, 0x41200000, v88
    v_cvt_pk_bf16_f32 v38, v77, v85
    v_cvt_pk_bf16_f32 v42, v78, v86
    v_cvt_pk_bf16_f32 v66, v79, v87
    v_cvt_pk_bf16_f32 v70, v82, v90
    v_cvt_pk_bf16_f32 v74, v80, v88
    v_lshlrev_b32 v76, 16, v35
    v_and_b32 v84, s25, v35
    v_lshlrev_b32 v77, 16, v39
    v_and_b32 v85, s25, v39
    v_lshlrev_b32 v78, 16, v43
    v_and_b32 v86, s25, v43
    v_lshlrev_b32 v79, 16, v47
    v_and_b32 v87, s25, v47
    v_add_f32 v80, v76, v78
    v_add_f32 v88, v84, v86
    v_add_f32 v81, v77, v79
    v_add_f32 v89, v85, v87
    v_fma_f32 v82, v78, 4.0, v76
    v_fma_f32 v90, v86, 4.0, v84
    v_fma_f32 v83, v79, 4.0, v77
    v_fma_f32 v91, v87, 4.0, v85
    v_add_f32 v77, v80, v81
    v_add_f32 v85, v88, v89
    v_sub_f32 v78, v80, v81
    v_sub_f32 v86, v88, v89
    v_fma_f32 v79, v83, 2.0, v82
    v_fma_f32 v87, v91, 2.0, v90
    v_fma_f32 v82, v83, -2.0, v82
    v_fma_f32 v90, v91, -2.0, v90
    v_fmamk_f32 v80, v76, 0x41700000, v82
    v_fmamk_f32 v88, v84, 0x41700000, v90
    v_fmamk_f32 v80, v81, 0x41200000, v80
    v_fmamk_f32 v88, v89, 0x41200000, v88
    v_cvt_pk_bf16_f32 v39, v77, v85
    v_cvt_pk_bf16_f32 v43, v78, v86
    v_cvt_pk_bf16_f32 v67, v79, v87
    v_cvt_pk_bf16_f32 v71, v82, v90
    v_cvt_pk_bf16_f32 v75, v80, v88
    ds_write_b128 v96, v[64:67] offset:49152
    ds_write_b128 v97, v[68:71] offset:0
    ds_write_b128 v97, v[72:75] offset:16384
    ds_write_b128 v96, v[32:35] offset:0
    ds_write_b128 v96, v[36:39] offset:16384
    ds_write_b128 v96, v[40:43] offset:32768
    ds_write_b128 v98, v[44:47] offset:0
    s_add_u32 s28, s28, 1
    s_waitcnt lgkmcnt(0)
    s_barrier
    s_cmp_lt_u32 s28, 13
    s_cselect_b32 s24, 0, 2130706432
    v_lshlrev_b32 v76, 16, v48
    v_and_b32 v84, s25, v48
    v_lshlrev_b32 v77, 16, v52
    v_and_b32 v85, s25, v52
    v_lshlrev_b32 v78, 16, v56
    v_and_b32 v86, s25, v56
    v_lshlrev_b32 v79, 16, v60
    v_and_b32 v87, s25, v60
    v_add_f32 v80, v76, v78
    v_add_f32 v88, v84, v86
    v_add_f32 v81, v77, v79
    v_add_f32 v89, v85, v87
    v_fma_f32 v82, v78, 4.0, v76
    buffer_load_dwordx4 v[8:11], v94, s[8:11], s24 offen offset:0
    buffer_load_dwordx4 v[24:27], v94, s[8:11], s24 offen offset:64
    v_add_u32 v94, 128, v94
    v_fma_f32 v90, v86, 4.0, v84
    v_fma_f32 v83, v79, 4.0, v77
    v_fma_f32 v91, v87, 4.0, v85
    v_add_f32 v77, v80, v81
    v_add_f32 v85, v88, v89
    v_sub_f32 v78, v80, v81
    v_sub_f32 v86, v88, v89
    v_fma_f32 v79, v83, 2.0, v82
    v_fma_f32 v87, v91, 2.0, v90
    v_fma_f32 v82, v83, -2.0, v82
    v_fma_f32 v90, v91, -2.0, v90
    v_fmamk_f32 v80, v76, 0x41700000, v82
    v_fmamk_f32 v88, v84, 0x41700000, v90
    v_fmamk_f32 v80, v81, 0x41200000, v80
    v_fmamk_f32 v88, v89, 0x41200000, v88
    v_cvt_pk_bf16_f32 v52, v77, v85
    v_cvt_pk_bf16_f32 v56, v78, v86
    v_cvt_pk_bf16_f32 v64, v79, v87
    v_cvt_pk_bf16_f32 v68, v82, v90
    v_cvt_pk_bf16_f32 v72, v80, v88
    v_lshlrev_b32 v76, 16, v49
    v_and_b32 v84, s25, v49
    v_lshlrev_b32 v77, 16, v53
    v_and_b32 v85, s25, v53
    v_lshlrev_b32 v78, 16, v57
    v_and_b32 v86, s25, v57
    v_lshlrev_b32 v79, 16, v61
    v_and_b32 v87, s25, v61
    v_add_f32 v80, v76, v78
    v_add_f32 v88, v84, v86
    v_add_f32 v81, v77, v79
    v_add_f32 v89, v85, v87
    v_fma_f32 v82, v78, 4.0, v76
    v_fma_f32 v90, v86, 4.0, v84
    v_fma_f32 v83, v79, 4.0, v77
    v_fma_f32 v91, v87, 4.0, v85
    v_add_f32 v77, v80, v81
    v_add_f32 v85, v88, v89
    v_sub_f32 v78, v80, v81
    v_sub_f32 v86, v88, v89
    v_fma_f32 v79, v83, 2.0, v82
    v_fma_f32 v87, v91, 2.0, v90
    v_fma_f32 v82, v83, -2.0, v82
    v_fma_f32 v90, v91, -2.0, v90
    v_fmamk_f32 v80, v76, 0x41700000, v82
    v_fmamk_f32 v88, v84, 0x41700000, v90
    v_fmamk_f32 v80, v81, 0x41200000, v80
    v_fmamk_f32 v88, v89, 0x41200000, v88
    v_cvt_pk_bf16_f32 v53, v77, v85
    v_cvt_pk_bf16_f32 v57, v78, v86
    v_cvt_pk_bf16_f32 v65, v79, v87
    v_cvt_pk_bf16_f32 v69, v82, v90
    v_cvt_pk_bf16_f32 v73, v80, v88
    buffer_load_dwordx4 v[12:15], v95, s[8:11], s24 offen offset:0
    buffer_load_dwordx4 v[28:31], v95, s[8:11], s24 offen offset:64
    v_add_u32 v95, 128, v95
    v_lshlrev_b32 v76, 16, v50
    v_and_b32 v84, s25, v50
    v_lshlrev_b32 v77, 16, v54
    v_and_b32 v85, s25, v54
    v_lshlrev_b32 v78, 16, v58
    v_and_b32 v86, s25, v58
    v_lshlrev_b32 v79, 16, v62
    v_and_b32 v87, s25, v62
    v_add_f32 v80, v76, v78
    v_add_f32 v88, v84, v86
    v_add_f32 v81, v77, v79
    v_add_f32 v89, v85, v87
    v_fma_f32 v82, v78, 4.0, v76
    v_fma_f32 v90, v86, 4.0, v84
    v_fma_f32 v83, v79, 4.0, v77
    v_fma_f32 v91, v87, 4.0, v85
    v_add_f32 v77, v80, v81
    v_add_f32 v85, v88, v89
    v_sub_f32 v78, v80, v81
    v_sub_f32 v86, v88, v89
    v_fma_f32 v79, v83, 2.0, v82
    v_fma_f32 v87, v91, 2.0, v90
    v_fma_f32 v82, v83, -2.0, v82
    v_fma_f32 v90, v91, -2.0, v90
    v_fmamk_f32 v80, v76, 0x41700000, v82
    v_fmamk_f32 v88, v84, 0x41700000, v90
    v_fmamk_f32 v80, v81, 0x41200000, v80
    v_fmamk_f32 v88, v89, 0x41200000, v88
    v_cvt_pk_bf16_f32 v54, v77, v85
    v_cvt_pk_bf16_f32 v58, v78, v86
    v_cvt_pk_bf16_f32 v66, v79, v87
    v_cvt_pk_bf16_f32 v70, v82, v90
    v_cvt_pk_bf16_f32 v74, v80, v88
    v_lshlrev_b32 v76, 16, v51
    v_and_b32 v84, s25, v51
    v_lshlrev_b32 v77, 16, v55
    v_and_b32 v85, s25, v55
    v_lshlrev_b32 v78, 16, v59
    v_and_b32 v86, s25, v59
    v_lshlrev_b32 v79, 16, v63
    v_and_b32 v87, s25, v63
    v_add_f32 v80, v76, v78
    v_add_f32 v88, v84, v86
    v_add_f32 v81, v77, v79
    v_add_f32 v89, v85, v87
    v_fma_f32 v82, v78, 4.0, v76
    v_fma_f32 v90, v86, 4.0, v84
    v_fma_f32 v83, v79, 4.0, v77
    v_fma_f32 v91, v87, 4.0, v85
    v_add_f32 v77, v80, v81
    v_add_f32 v85, v88, v89
    v_sub_f32 v78, v80, v81
    v_sub_f32 v86, v88, v89
    v_fma_f32 v79, v83, 2.0, v82
    v_fma_f32 v87, v91, 2.0, v90
    v_fma_f32 v82, v83, -2.0, v82
    v_fma_f32 v90, v91, -2.0, v90
    v_fmamk_f32 v80, v76, 0x41700000, v82
    v_fmamk_f32 v88, v84, 0x41700000, v90
    v_fmamk_f32 v80, v81, 0x41200000, v80
    v_fmamk_f32 v88, v89, 0x41200000, v88
    v_cvt_pk_bf16_f32 v55, v77, v85
    v_cvt_pk_bf16_f32 v59, v78, v86
    v_cvt_pk_bf16_f32 v67, v79, v87
    v_cvt_pk_bf16_f32 v71, v82, v90
    v_cvt_pk_bf16_f32 v75, v80, v88
    ds_write_b128 v96, v[64:67] offset:57344
    ds_write_b128 v97, v[68:71] offset:8192
    ds_write_b128 v97, v[72:75] offset:24576
    ds_write_b128 v96, v[48:51] offset:8192
    ds_write_b128 v96, v[52:55] offset:24576
    ds_write_b128 v96, v[56:59] offset:40960
    ds_write_b128 v98, v[60:63] offset:8704
    s_add_u32 s28, s28, 1
    s_waitcnt lgkmcnt(0)
    s_barrier
    s_cmp_eq_u32 s22, 1
    s_cbranch_scc1 L_conv1_kernel_hlast1
    s_cmp_lt_u32 s28, 13
    s_cselect_b32 s24, 0, 2130706432
    s_waitcnt vmcnt(0)
    v_lshlrev_b32 v76, 16, v0
    v_and_b32 v84, s25, v0
    v_lshlrev_b32 v77, 16, v4
    v_and_b32 v85, s25, v4
    v_lshlrev_b32 v78, 16, v8
    v_and_b32 v86, s25, v8
    v_lshlrev_b32 v79, 16, v12
    v_and_b32 v87, s25, v12
    v_add_f32 v80, v76, v78
    v_add_f32 v88, v84, v86
    v_add_f32 v81, v77, v79
    v_add_f32 v89, v85, v87
    v_fma_f32 v82, v78, 4.0, v76
    v_fma_f32 v90, v86, 4.0, v84
    v_fma_f32 v83, v79, 4.0, v77
    v_fma_f32 v91, v87, 4.0, v85
    v_add_f32 v77, v80, v81
    v_add_f32 v85, v88, v89
    v_sub_f32 v78, v80, v81
    v_sub_f32 v86, v88, v89
    v_fma_f32 v79, v83, 2.0, v82
    v_fma_f32 v87, v91, 2.0, v90
    v_fma_f32 v82, v83, -2.0, v82
    v_fma_f32 v90, v91, -2.0, v90
    v_fmamk_f32 v80, v76, 0x41700000, v82
    v_fmamk_f32 v88, v84, 0x41700000, v90
    v_fmamk_f32 v80, v81, 0x41200000, v80
    v_fmamk_f32 v88, v89, 0x41200000, v88
    v_cvt_pk_bf16_f32 v4, v77, v85
    v_cvt_pk_bf16_f32 v8, v78, v86
    v_cvt_pk_bf16_f32 v64, v79, v87
    v_cvt_pk_bf16_f32 v68, v82, v90
    v_cvt_pk_bf16_f32 v72, v80, v88
    v_lshlrev_b32 v76, 16, v1
    v_and_b32 v84, s25, v1
    v_lshlrev_b32 v77, 16, v5
    v_and_b32 v85, s25, v5
    v_lshlrev_b32 v78, 16, v9
    v_and_b32 v86, s25, v9
    buffer_load_dwordx4 v[32:35], v92, s[8:11], s24 offen offset:0
    buffer_load_dwordx4 v[48:51], v92, s[8:11], s24 offen offset:64
    v_add_u32 v92, 128, v92
    v_lshlrev_b32 v79, 16, v13
    v_and_b32 v87, s25, v13
    v_add_f32 v80, v76, v78
    v_add_f32 v88, v84, v86
    v_add_f32 v81, v77, v79
    v_add_f32 v89, v85, v87
    v_fma_f32 v82, v78, 4.0, v76
    v_fma_f32 v90, v86, 4.0, v84
    v_fma_f32 v83, v79, 4.0, v77
    v_fma_f32 v91, v87, 4.0, v85
    v_add_f32 v77, v80, v81
    v_add_f32 v85, v88, v89
    v_sub_f32 v78, v80, v81
    v_sub_f32 v86, v88, v89
    v_fma_f32 v79, v83, 2.0, v82
    v_fma_f32 v87, v91, 2.0, v90
    v_fma_f32 v82, v83, -2.0, v82
    v_fma_f32 v90, v91, -2.0, v90
    v_fmamk_f32 v80, v76, 0x41700000, v82
    v_fmamk_f32 v88, v84, 0x41700000, v90
    v_fmamk_f32 v80, v81, 0x41200000, v80
    v_fmamk_f32 v88, v89, 0x41200000, v88
    v_cvt_pk_bf16_f32 v5, v77, v85
    v_cvt_pk_bf16_f32 v9, v78, v86
    v_cvt_pk_bf16_f32 v65, v79, v87
    v_cvt_pk_bf16_f32 v69, v82, v90
    v_cvt_pk_bf16_f32 v73, v80, v88
    v_lshlrev_b32 v76, 16, v2
    v_and_b32 v84, s25, v2
    v_lshlrev_b32 v77, 16, v6
    v_and_b32 v85, s25, v6
    v_lshlrev_b32 v78, 16, v10
    v_and_b32 v86, s25, v10
    v_lshlrev_b32 v79, 16, v14
    v_and_b32 v87, s25, v14
    v_add_f32 v80, v76, v78
    v_add_f32 v88, v84, v86
    v_add_f32 v81, v77, v79
    v_add_f32 v89, v85, v87
    v_fma_f32 v82, v78, 4.0, v76
    v_fma_f32 v90, v86, 4.0, v84
    v_fma_f32 v83, v79, 4.0, v77
    v_fma_f32 v91, v87, 4.0, v85
    v_add_f32 v77, v80, v81
    v_add_f32 v85, v88, v89
    v_sub_f32 v78, v80, v81
    v_sub_f32 v86, v88, v89
    v_fma_f32 v79, v83, 2.0, v82
    v_fma_f32 v87, v91, 2.0, v90
    v_fma_f32 v82, v83, -2.0, v82
    v_fma_f32 v90, v91, -2.0, v90
    v_fmamk_f32 v80, v76, 0x41700000, v82
    v_fmamk_f32 v88, v84, 0x41700000, v90
    buffer_load_dwordx4 v[36:39], v93, s[8:11], s24 offen offset:0
    buffer_load_dwordx4 v[52:55], v93, s[8:11], s24 offen offset:64
    v_add_u32 v93, 128, v93
    v_fmamk_f32 v80, v81, 0x41200000, v80
    v_fmamk_f32 v88, v89, 0x41200000, v88
    v_cvt_pk_bf16_f32 v6, v77, v85
    v_cvt_pk_bf16_f32 v10, v78, v86
    v_cvt_pk_bf16_f32 v66, v79, v87
    v_cvt_pk_bf16_f32 v70, v82, v90
    v_cvt_pk_bf16_f32 v74, v80, v88
    v_lshlrev_b32 v76, 16, v3
    v_and_b32 v84, s25, v3
    v_lshlrev_b32 v77, 16, v7
    v_and_b32 v85, s25, v7
    v_lshlrev_b32 v78, 16, v11
    v_and_b32 v86, s25, v11
    v_lshlrev_b32 v79, 16, v15
    v_and_b32 v87, s25, v15
    v_add_f32 v80, v76, v78
    v_add_f32 v88, v84, v86
    v_add_f32 v81, v77, v79
    v_add_f32 v89, v85, v87
    v_fma_f32 v82, v78, 4.0, v76
    v_fma_f32 v90, v86, 4.0, v84
    v_fma_f32 v83, v79, 4.0, v77
    v_fma_f32 v91, v87, 4.0, v85
    v_add_f32 v77, v80, v81
    v_add_f32 v85, v88, v89
    v_sub_f32 v78, v80, v81
    v_sub_f32 v86, v88, v89
    v_fma_f32 v79, v83, 2.0, v82
    v_fma_f32 v87, v91, 2.0, v90
    v_fma_f32 v82, v83, -2.0, v82
    v_fma_f32 v90, v91, -2.0, v90
    v_fmamk_f32 v80, v76, 0x41700000, v82
    v_fmamk_f32 v88, v84, 0x41700000, v90
    v_fmamk_f32 v80, v81, 0x41200000, v80
    v_fmamk_f32 v88, v89, 0x41200000, v88
    v_cvt_pk_bf16_f32 v7, v77, v85
    v_cvt_pk_bf16_f32 v11, v78, v86
    v_cvt_pk_bf16_f32 v67, v79, v87
    v_cvt_pk_bf16_f32 v71, v82, v90
    v_cvt_pk_bf16_f32 v75, v80, v88
    ds_write_b128 v96, v[64:67] offset:49152
    ds_write_b128 v97, v[68:71] offset:0
    ds_write_b128 v97, v[72:75] offset:16384
    ds_write_b128 v96, v[0:3] offset:0
    ds_write_b128 v96, v[4:7] offset:16384
    ds_write_b128 v96, v[8:11] offset:32768
    ds_write_b128 v98, v[12:15] offset:0
    s_add_u32 s28, s28, 1
    s_waitcnt lgkmcnt(0)
    s_barrier
    s_sub_u32 s22, s22, 1
    s_branch L_conv1_kernel_hloop1
L_conv1_kernel_hlast1:
    s_branch L_conv1_kernel_end
L_conv1_kernel_h2:
    ds_write_b128 v96, v[0:3] offset:0
    ds_write_b128 v98, v[12:15] offset:0
    v_lshlrev_b32 v76, 16, v0
    v_and_b32 v84, s25, v0
    v_lshlrev_b32 v77, 16, v4
    v_and_b32 v85, s25, v4
    v_lshlrev_b32 v78, 16, v8
    v_and_b32 v86, s25, v8
    v_lshlrev_b32 v79, 16, v12
    v_and_b32 v87, s25, v12
    v_add_f32 v80, v76, v78
    v_add_f32 v88, v84, v86
    v_add_f32 v81, v77, v79
    v_add_f32 v89, v85, v87
    v_fma_f32 v82, v78, 4.0, v76
    v_fma_f32 v90, v86, 4.0, v84
    v_fma_f32 v83, v79, 4.0, v77
    v_fma_f32 v91, v87, 4.0, v85
    v_add_f32 v77, v80, v81
    v_add_f32 v85, v88, v89
    v_sub_f32 v78, v80, v81
    v_sub_f32 v86, v88, v89
    v_fma_f32 v79, v83, 2.0, v82
    v_fma_f32 v87, v91, 2.0, v90
    v_fma_f32 v82, v83, -2.0, v82
    v_fma_f32 v90, v91, -2.0, v90
    v_fmamk_f32 v80, v76, 0x41700000, v82
    v_fmamk_f32 v88, v84, 0x41700000, v90
    v_fmamk_f32 v80, v81, 0x41200000, v80
    v_fmamk_f32 v88, v89, 0x41200000, v88
    v_cvt_pk_bf16_f32 v4, v77, v85
    v_cvt_pk_bf16_f32 v8, v78, v86
    v_cvt_pk_bf16_f32 v64, v79, v87
    v_cvt_pk_bf16_f32 v68, v82, v90
    v_cvt_pk_bf16_f32 v72, v80, v88
    v_lshlrev_b32 v76, 16, v1
    v_and_b32 v84, s25, v1
    v_lshlrev_b32 v77, 16, v5
    v_and_b32 v85, s25, v5
    v_lshlrev_b32 v78, 16, v9
    v_and_b32 v86, s25, v9
    v_lshlrev_b32 v79, 16, v13
    v_and_b32 v87, s25, v13
    v_add_f32 v80, v76, v78
    v_add_f32 v88, v84, v86
    v_add_f32 v81, v77, v79
    v_add_f32 v89, v85, v87
    v_fma_f32 v82, v78, 4.0, v76
    v_fma_f32 v90, v86, 4.0, v84
    v_fma_f32 v83, v79, 4.0, v77
    v_fma_f32 v91, v87, 4.0, v85
    v_add_f32 v77, v80, v81
    v_add_f32 v85, v88, v89
    v_sub_f32 v78, v80, v81
    v_sub_f32 v86, v88, v89
    v_fma_f32 v79, v83, 2.0, v82
    v_fma_f32 v87, v91, 2.0, v90
    v_fma_f32 v82, v83, -2.0, v82
    v_fma_f32 v90, v91, -2.0, v90
    v_fmamk_f32 v80, v76, 0x41700000, v82
    v_fmamk_f32 v88, v84, 0x41700000, v90
    v_fmamk_f32 v80, v81, 0x41200000, v80
    v_fmamk_f32 v88, v89, 0x41200000, v88
    v_cvt_pk_bf16_f32 v5, v77, v85
    v_cvt_pk_bf16_f32 v9, v78, v86
    v_cvt_pk_bf16_f32 v65, v79, v87
    v_cvt_pk_bf16_f32 v69, v82, v90
    v_cvt_pk_bf16_f32 v73, v80, v88
    v_lshlrev_b32 v76, 16, v2
    v_and_b32 v84, s25, v2
    v_lshlrev_b32 v77, 16, v6
    v_and_b32 v85, s25, v6
    v_lshlrev_b32 v78, 16, v10
    v_and_b32 v86, s25, v10
    v_lshlrev_b32 v79, 16, v14
    v_and_b32 v87, s25, v14
    v_add_f32 v80, v76, v78
    v_add_f32 v88, v84, v86
    v_add_f32 v81, v77, v79
    v_add_f32 v89, v85, v87
    v_fma_f32 v82, v78, 4.0, v76
    v_fma_f32 v90, v86, 4.0, v84
    v_fma_f32 v83, v79, 4.0, v77
    v_fma_f32 v91, v87, 4.0, v85
    v_add_f32 v77, v80, v81
    v_add_f32 v85, v88, v89
    v_sub_f32 v78, v80, v81
    v_sub_f32 v86, v88, v89
    v_fma_f32 v79, v83, 2.0, v82
    v_fma_f32 v87, v91, 2.0, v90
    v_fma_f32 v82, v83, -2.0, v82
    v_fma_f32 v90, v91, -2.0, v90
    v_fmamk_f32 v80, v76, 0x41700000, v82
    v_fmamk_f32 v88, v84, 0x41700000, v90
    v_fmamk_f32 v80, v81, 0x41200000, v80
    v_fmamk_f32 v88, v89, 0x41200000, v88
    v_cvt_pk_bf16_f32 v6, v77, v85
    v_cvt_pk_bf16_f32 v10, v78, v86
    v_cvt_pk_bf16_f32 v66, v79, v87
    v_cvt_pk_bf16_f32 v70, v82, v90
    v_cvt_pk_bf16_f32 v74, v80, v88
    v_lshlrev_b32 v76, 16, v3
    v_and_b32 v84, s25, v3
    v_lshlrev_b32 v77, 16, v7
    v_and_b32 v85, s25, v7
    v_lshlrev_b32 v78, 16, v11
    v_and_b32 v86, s25, v11
    v_lshlrev_b32 v79, 16, v15
    v_and_b32 v87, s25, v15
    v_add_f32 v80, v76, v78
    v_add_f32 v88, v84, v86
    v_add_f32 v81, v77, v79
    v_add_f32 v89, v85, v87
    v_fma_f32 v82, v78, 4.0, v76
    v_fma_f32 v90, v86, 4.0, v84
    v_fma_f32 v83, v79, 4.0, v77
    v_fma_f32 v91, v87, 4.0, v85
    v_add_f32 v77, v80, v81
    v_add_f32 v85, v88, v89
    v_sub_f32 v78, v80, v81
    v_sub_f32 v86, v88, v89
    v_fma_f32 v79, v83, 2.0, v82
    v_fma_f32 v87, v91, 2.0, v90
    v_fma_f32 v82, v83, -2.0, v82
    v_fma_f32 v90, v91, -2.0, v90
    v_fmamk_f32 v80, v76, 0x41700000, v82
    v_fmamk_f32 v88, v84, 0x41700000, v90
    v_fmamk_f32 v80, v81, 0x41200000, v80
    v_fmamk_f32 v88, v89, 0x41200000, v88
    v_cvt_pk_bf16_f32 v7, v77, v85
    v_cvt_pk_bf16_f32 v11, v78, v86
    v_cvt_pk_bf16_f32 v67, v79, v87
    v_cvt_pk_bf16_f32 v71, v82, v90
    v_cvt_pk_bf16_f32 v75, v80, v88
    ds_write_b128 v96, v[64:67] offset:49152
    ds_write_b128 v97, v[68:71] offset:0
    ds_write_b128 v97, v[72:75] offset:16384
    ds_write_b128 v96, v[4:7] offset:16384
    ds_write_b128 v96, v[8:11] offset:32768
    s_waitcnt vmcnt(0)
    s_waitcnt lgkmcnt(0)
    s_barrier
    buffer_load_dwordx4 v[32:35], v92, s[8:11], s24 offen offset:0
    buffer_load_dwordx4 v[48:51], v92, s[8:11], s24 offen offset:64
    v_add_u32 v92, 128, v92
    buffer_load_dwordx4 v[36:39], v93, s[8:11], s24 offen offset:0
    buffer_load_dwordx4 v[52:55], v93, s[8:11], s24 offen offset:64
    v_add_u32 v93, 128, v93
    buffer_load_dwordx4 v[40:43], v94, s[8:11], s24 offen offset:0
    buffer_load_dwordx4 v[56:59], v94, s[8:11], s24 offen offset:64
    v_add_u32 v94, 128, v94
    buffer_load_dwordx4 v[44:47], v95, s[8:11], s24 offen offset:0
    buffer_load_dwordx4 v[60:63], v95, s[8:11], s24 offen offset:64
    v_add_u32 v95, 128, v95
    s_setprio 0
    v_lshlrev_b32 v76, 16, v16
    v_and_b32 v84, s25, v16
    v_lshlrev_b32 v77, 16, v20
    v_and_b32 v85, s25, v20
    v_lshlrev_b32 v78, 16, v24
    v_and_b32 v86, s25, v24
    v_lshlrev_b32 v79, 16, v28
    v_and_b32 v87, s25, v28
    v_add_f32 v80, v76, v78
    v_add_f32 v88, v84, v86
    v_add_f32 v81, v77, v79
    v_add_f32 v89, v85, v87
    v_fma_f32 v82, v78, 4.0, v76
    v_fma_f32 v90, v86, 4.0, v84
    v_fma_f32 v83, v79, 4.0, v77
    v_fma_f32 v91, v87, 4.0, v85
    v_add_f32 v77, v80, v81
    v_add_f32 v85, v88, v89
    v_sub_f32 v78, v80, v81
    v_sub_f32 v86, v88, v89
    v_fma_f32 v79, v83, 2.0, v82
    v_fma_f32 v87, v91, 2.0, v90
    v_fma_f32 v82, v83, -2.0, v82
    v_fma_f32 v90, v91, -2.0, v90
    v_fmamk_f32 v80, v76, 0x41700000, v82
    v_fmamk_f32 v88, v84, 0x41700000, v90
    v_fmamk_f32 v80, v81, 0x41200000, v80
    v_fmamk_f32 v88, v89, 0x41200000, v88
    v_cvt_pk_bf16_f32 v20, v77, v85
    v_cvt_pk_bf16_f32 v24, v78, v86
    v_cvt_pk_bf16_f32 v64, v79, v87
    v_cvt_pk_bf16_f32 v68, v82, v90
    v_cvt_pk_bf16_f32 v72, v80, v88
    v_lshlrev_b32 v76, 16, v17
    v_and_b32 v84, s25, v17
    v_lshlrev_b32 v77, 16, v21
    v_and_b32 v85, s25, v21
    v_lshlrev_b32 v78, 16, v25
    v_and_b32 v86, s25, v25
    v_lshlrev_b32 v79, 16, v29
    v_and_b32 v87, s25, v29
    v_add_f32 v80, v76, v78
    v_add_f32 v88, v84, v86
    v_add_f32 v81, v77, v79
    v_add_f32 v89, v85, v87
    v_fma_f32 v82, v78, 4.0, v76
    v_fma_f32 v90, v86, 4.0, v84
    v_fma_f32 v83, v79, 4.0, v77
    v_fma_f32 v91, v87, 4.0, v85
    v_add_f32 v77, v80, v81
    v_add_f32 v85, v88, v89
    v_sub_f32 v78, v80, v81
    v_sub_f32 v86, v88, v89
    v_fma_f32 v79, v83, 2.0, v82
    v_fma_f32 v87, v91, 2.0, v90
    v_fma_f32 v82, v83, -2.0, v82
    v_fma_f32 v90, v91, -2.0, v90
    v_fmamk_f32 v80, v76, 0x41700000, v82
    v_fmamk_f32 v88, v84, 0x41700000, v90
    v_fmamk_f32 v80, v81, 0x41200000, v80
    v_fmamk_f32 v88, v89, 0x41200000, v88
    v_cvt_pk_bf16_f32 v21, v77, v85
    v_cvt_pk_bf16_f32 v25, v78, v86
    v_cvt_pk_bf16_f32 v65, v79, v87
    v_cvt_pk_bf16_f32 v69, v82, v90
    v_cvt_pk_bf16_f32 v73, v80, v88
    v_lshlrev_b32 v76, 16, v18
    v_and_b32 v84, s25, v18
    v_lshlrev_b32 v77, 16, v22
    v_and_b32 v85, s25, v22
    v_lshlrev_b32 v78, 16, v26
    v_and_b32 v86, s25, v26
    v_lshlrev_b32 v79, 16, v30
    v_and_b32 v87, s25, v30
    v_add_f32 v80, v76, v78
    v_add_f32 v88, v84, v86
    v_add_f32 v81, v77, v79
    v_add_f32 v89, v85, v87
    v_fma_f32 v82, v78, 4.0, v76
    v_fma_f32 v90, v86, 4.0, v84
    v_fma_f32 v83, v79, 4.0, v77
    v_fma_f32 v91, v87, 4.0, v85
    v_add_f32 v77, v80, v81
    v_add_f32 v85, v88, v89
    v_sub_f32 v78, v80, v81
    v_sub_f32 v86, v88, v89
    v_fma_f32 v79, v83, 2.0, v82
    v_fma_f32 v87, v91, 2.0, v90
    v_fma_f32 v82, v83, -2.0, v82
    v_fma_f32 v90, v91, -2.0, v90
    v_fmamk_f32 v80, v76, 0x41700000, v82
    v_fmamk_f32 v88, v84, 0x41700000, v90
    v_fmamk_f32 v80, v81, 0x41200000, v80
    v_fmamk_f32 v88, v89, 0x41200000, v88
    v_cvt_pk_bf16_f32 v22, v77, v85
    v_cvt_pk_bf16_f32 v26, v78, v86
    v_cvt_pk_bf16_f32 v66, v79, v87
    v_cvt_pk_bf16_f32 v70, v82, v90
    v_cvt_pk_bf16_f32 v74, v80, v88
    v_lshlrev_b32 v76, 16, v19
    v_and_b32 v84, s25, v19
    v_lshlrev_b32 v77, 16, v23
    v_and_b32 v85, s25, v23
    v_lshlrev_b32 v78, 16, v27
    v_and_b32 v86, s25, v27
    v_lshlrev_b32 v79, 16, v31
    v_and_b32 v87, s25, v31
    v_add_f32 v80, v76, v78
    v_add_f32 v88, v84, v86
    v_add_f32 v81, v77, v79
    v_add_f32 v89, v85, v87
    v_fma_f32 v82, v78, 4.0, v76
    v_fma_f32 v90, v86, 4.0, v84
    v_fma_f32 v83, v79, 4.0, v77
    v_fma_f32 v91, v87, 4.0, v85
    v_add_f32 v77, v80, v81
    v_add_f32 v85, v88, v89
    v_sub_f32 v78, v80, v81
    v_sub_f32 v86, v88, v89
    v_fma_f32 v79, v83, 2.0, v82
    v_fma_f32 v87, v91, 2.0, v90
    v_fma_f32 v82, v83, -2.0, v82
    v_fma_f32 v90, v91, -2.0, v90
    v_fmamk_f32 v80, v76, 0x41700000, v82
    v_fmamk_f32 v88, v84, 0x41700000, v90
    v_fmamk_f32 v80, v81, 0x41200000, v80
    v_fmamk_f32 v88, v89, 0x41200000, v88
    v_cvt_pk_bf16_f32 v23, v77, v85
    v_cvt_pk_bf16_f32 v27, v78, v86
    v_cvt_pk_bf16_f32 v67, v79, v87
    v_cvt_pk_bf16_f32 v71, v82, v90
    v_cvt_pk_bf16_f32 v75, v80, v88
L_conv1_kernel_hloop2:
    s_cmp_lt_u32 s28, 12
    s_cselect_b32 s24, 0, 2130706432
    ds_write_b128 v96, v[64:67] offset:57344
    ds_write_b128 v97, v[68:71] offset:8192
    ds_write_b128 v97, v[72:75] offset:24576
    ds_write_b128 v96, v[16:19] offset:8192
    ds_write_b128 v96, v[20:23] offset:24576
    ds_write_b128 v96, v[24:27] offset:40960
    ds_write_b128 v98, v[28:31] offset:8704
    s_waitcnt vmcnt(0)
    buffer_load_dwordx4 v[0:3], v92, s[8:11], s24 offen offset:0
    buffer_load_dwordx4 v[16:19], v92, s[8:11], s24 offen offset:64
    v_add_u32 v92, 128, v92
    buffer_load_dwordx4 v[4:7], v93, s[8:11], s24 offen offset:0
    buffer_load_dwordx4 v[20:23], v93, s[8:11], s24 offen offset:64
    v_add_u32 v93, 128, v93
    v_lshlrev_b32 v76, 16, v32
    v_and_b32 v84, s25, v32
    v_lshlrev_b32 v77, 16, v36
    v_and_b32 v85, s25, v36
    v_lshlrev_b32 v78, 16, v40
    v_and_b32 v86, s25, v40
    v_lshlrev_b32 v79, 16, v44
    v_and_b32 v87, s25, v44
    v_add_f32 v80, v76, v78
    v_add_f32 v88, v84, v86
    v_add_f32 v81, v77, v79
    v_add_f32 v89, v85, v87
    v_fma_f32 v82, v78, 4.0, v76
    v_fma_f32 v90, v86, 4.0, v84
    v_fma_f32 v83, v79, 4.0, v77
    v_fma_f32 v91, v87, 4.0, v85
    v_add_f32 v77, v80, v81
    v_add_f32 v85, v88, v89
    v_sub_f32 v78, v80, v81
    v_sub_f32 v86, v88, v89
    v_fma_f32 v79, v83, 2.0, v82
    v_fma_f32 v87, v91, 2.0, v90
    v_fma_f32 v82, v83, -2.0, v82
    v_fma_f32 v90, v91, -2.0, v90
    v_fmamk_f32 v80, v76, 0x41700000, v82
    v_fmamk_f32 v88, v84, 0x41700000, v90
    v_fmamk_f32 v80, v81, 0x41200000, v80
    v_fmamk_f32 v88, v89, 0x41200000, v88
    v_cvt_pk_bf16_f32 v36, v77, v85
    v_cvt_pk_bf16_f32 v40, v78, v86
    v_cvt_pk_bf16_f32 v64, v79, v87
    v_cvt_pk_bf16_f32 v68, v82, v90
    v_cvt_pk_bf16_f32 v72, v80, v88
    v_lshlrev_b32 v76, 16, v33
    v_and_b32 v84, s25, v33
    v_lshlrev_b32 v77, 16, v37
    v_and_b32 v85, s25, v37
    v_lshlrev_b32 v78, 16, v41
    v_and_b32 v86, s25, v41
    v_lshlrev_b32 v79, 16, v45
    v_and_b32 v87, s25, v45
    v_add_f32 v80, v76, v78
    v_add_f32 v88, v84, v86
    v_add_f32 v81, v77, v79
    v_add_f32 v89, v85, v87
    v_fma_f32 v82, v78, 4.0, v76
    v_fma_f32 v90, v86, 4.0, v84
    v_fma_f32 v83, v79, 4.0, v77
    v_fma_f32 v91, v87, 4.0, v85
    v_add_f32 v77, v80, v81
    v_add_f32 v85, v88, v89
    v_sub_f32 v78, v80, v81
    v_sub_f32 v86, v88, v89
    v_fma_f32 v79, v83, 2.0, v82
    v_fma_f32 v87, v91, 2.0, v90
    v_fma_f32 v82, v83, -2.0, v82
    v_fma_f32 v90, v91, -2.0, v90
    v_fmamk_f32 v80, v76, 0x41700000, v82
    v_fmamk_f32 v88, v84, 0x41700000, v90
    v_fmamk_f32 v80, v81, 0x41200000, v80
    v_fmamk_f32 v88, v89, 0x41200000, v88
    v_cvt_pk_bf16_f32 v37, v77, v85
    v_cvt_pk_bf16_f32 v41, v78, v86
    v_cvt_pk_bf16_f32 v65, v79, v87
    v_cvt_pk_bf16_f32 v69, v82, v90
    v_cvt_pk_bf16_f32 v73, v80, v88
    v_lshlrev_b32 v76, 16, v34
    v_and_b32 v84, s25, v34
    v_lshlrev_b32 v77, 16, v38
    v_and_b32 v85, s25, v38
    v_lshlrev_b32 v78, 16, v42
    v_and_b32 v86, s25, v42
    v_lshlrev_b32 v79, 16, v46
    v_and_b32 v87, s25, v46
    v_add_f32 v80, v76, v78
    v_add_f32 v88, v84, v86
    v_add_f32 v81, v77, v79
    v_add_f32 v89, v85, v87
    v_fma_f32 v82, v78, 4.0, v76
    v_fma_f32 v90, v86, 4.0, v84
    v_fma_f32 v83, v79, 4.0, v77
    v_fma_f32 v91, v87, 4.0, v85
    v_add_f32 v77, v80, v81
    v_add_f32 v85, v88, v89
    v_sub_f32 v78, v80, v81
    v_sub_f32 v86, v88, v89
    v_fma_f32 v79, v83, 2.0, v82
    v_fma_f32 v87, v91, 2.0, v90
    v_fma_f32 v82, v83, -2.0, v82
    v_fma_f32 v90, v91, -2.0, v90
    v_fmamk_f32 v80, v76, 0x41700000, v82
    v_fmamk_f32 v88, v84, 0x41700000, v90
    v_fmamk_f32 v80, v81, 0x41200000, v80
    v_fmamk_f32 v88, v89, 0x41200000, v88
    v_cvt_pk_bf16_f32 v38, v77, v85
    v_cvt_pk_bf16_f32 v42, v78, v86
    v_cvt_pk_bf16_f32 v66, v79, v87
    v_cvt_pk_bf16_f32 v70, v82, v90
    v_cvt_pk_bf16_f32 v74, v80, v88
    v_lshlrev_b32 v76, 16, v35
    v_and_b32 v84, s25, v35
    v_lshlrev_b32 v77, 16, v39
    v_and_b32 v85, s25, v39
    v_lshlrev_b32 v78, 16, v43
    v_and_b32 v86, s25, v43
    v_lshlrev_b32 v79, 16, v47
    v_and_b32 v87, s25, v47
    v_add_f32 v80, v76, v78
    v_add_f32 v88, v84, v86
    v_add_f32 v81, v77, v79
    v_add_f32 v89, v85, v87
    v_fma_f32 v82, v78, 4.0, v76
    v_fma_f32 v90, v86, 4.0, v84
    v_fma_f32 v83, v79, 4.0, v77
    v_fma_f32 v91, v87, 4.0, v85
    v_add_f32 v77, v80, v81
    v_add_f32 v85, v88, v89
    v_sub_f32 v78, v80, v81
    v_sub_f32 v86, v88, v89
    v_fma_f32 v79, v83, 2.0, v82
    v_fma_f32 v87, v91, 2.0, v90
    v_fma_f32 v82, v83, -2.0, v82
    v_fma_f32 v90, v91, -2.0, v90
    v_fmamk_f32 v80, v76, 0x41700000, v82
    v_fmamk_f32 v88, v84, 0x41700000, v90
    v_fmamk_f32 v80, v81, 0x41200000, v80
    v_fmamk_f32 v88, v89, 0x41200000, v88
    v_cvt_pk_bf16_f32 v39, v77, v85
    v_cvt_pk_bf16_f32 v43, v78, v86
    v_cvt_pk_bf16_f32 v67, v79, v87
    v_cvt_pk_bf16_f32 v71, v82, v90
    v_cvt_pk_bf16_f32 v75, v80, v88
    s_add_u32 s28, s28, 1
    s_waitcnt lgkmcnt(0)
    s_barrier
    s_cmp_lt_u32 s28, 12
    s_cselect_b32 s24, 0, 2130706432
    ds_write_b128 v96, v[64:67] offset:49152
    ds_write_b128 v97, v[68:71] offset:0
    ds_write_b128 v97, v[72:75] offset:16384
    ds_write_b128 v96, v[32:35] offset:0
    ds_write_b128 v96, v[36:39] offset:16384
    ds_write_b128 v96, v[40:43] offset:32768
    ds_write_b128 v98, v[44:47] offset:0
    buffer_load_dwordx4 v[8:11], v94, s[8:11], s24 offen offset:0
    buffer_load_dwordx4 v[24:27], v94, s[8:11], s24 offen offset:64
    v_add_u32 v94, 128, v94
    buffer_load_dwordx4 v[12:15], v95, s[8:11], s24 offen offset:0
    buffer_load_dwordx4 v[28:31], v95, s[8:11], s24 offen offset:64
    v_add_u32 v95, 128, v95
    v_lshlrev_b32 v76, 16, v48
    v_and_b32 v84, s25, v48
    v_lshlrev_b32 v77, 16, v52
    v_and_b32 v85, s25, v52
    v_lshlrev_b32 v78, 16, v56
    v_and_b32 v86, s25, v56
    v_lshlrev_b32 v79, 16, v60
    v_and_b32 v87, s25, v60
    v_add_f32 v80, v76, v78
    v_add_f32 v88, v84, v86
    v_add_f32 v81, v77, v79
    v_add_f32 v89, v85, v87
    v_fma_f32 v82, v78, 4.0, v76
    v_fma_f32 v90, v86, 4.0, v84
    v_fma_f32 v83, v79, 4.0, v77
    v_fma_f32 v91, v87, 4.0, v85
    v_add_f32 v77, v80, v81
    v_add_f32 v85, v88, v89
    v_sub_f32 v78, v80, v81
    v_sub_f32 v86, v88, v89
    v_fma_f32 v79, v83, 2.0, v82
    v_fma_f32 v87, v91, 2.0, v90
    v_fma_f32 v82, v83, -2.0, v82
    v_fma_f32 v90, v91, -2.0, v90
    v_fmamk_f32 v80, v76, 0x41700000, v82
    v_fmamk_f32 v88, v84, 0x41700000, v90
    v_fmamk_f32 v80, v81, 0x41200000, v80
    v_fmamk_f32 v88, v89, 0x41200000, v88
    v_cvt_pk_bf16_f32 v52, v77, v85
    v_cvt_pk_bf16_f32 v56, v78, v86
    v_cvt_pk_bf16_f32 v64, v79, v87
    v_cvt_pk_bf16_f32 v68, v82, v90
    v_cvt_pk_bf16_f32 v72, v80, v88
    v_lshlrev_b32 v76, 16, v49
    v_and_b32 v84, s25, v49
    v_lshlrev_b32 v77, 16, v53
    v_and_b32 v85, s25, v53
    v_lshlrev_b32 v78, 16, v57
    v_and_b32 v86, s25, v57
    v_lshlrev_b32 v79, 16, v61
    v_and_b32 v87, s25, v61
    v_add_f32 v80, v76, v78
    v_add_f32 v88, v84, v86
    v_add_f32 v81, v77, v79
    v_add_f32 v89, v85, v87
    v_fma_f32 v82, v78, 4.0, v76
    v_fma_f32 v90, v86, 4.0, v84
    v_fma_f32 v83, v79, 4.0, v77
    v_fma_f32 v91, v87, 4.0, v85
    v_add_f32 v77, v80, v81
    v_add_f32 v85, v88, v89
    v_sub_f32 v78, v80, v81
    v_sub_f32 v86, v88, v89
    v_fma_f32 v79, v83, 2.0, v82
    v_fma_f32 v87, v91, 2.0, v90
    v_fma_f32 v82, v83, -2.0, v82
    v_fma_f32 v90, v91, -2.0, v90
    v_fmamk_f32 v80, v76, 0x41700000, v82
    v_fmamk_f32 v88, v84, 0x41700000, v90
    v_fmamk_f32 v80, v81, 0x41200000, v80
    v_fmamk_f32 v88, v89, 0x41200000, v88
    v_cvt_pk_bf16_f32 v53, v77, v85
    v_cvt_pk_bf16_f32 v57, v78, v86
    v_cvt_pk_bf16_f32 v65, v79, v87
    v_cvt_pk_bf16_f32 v69, v82, v90
    v_cvt_pk_bf16_f32 v73, v80, v88
    v_lshlrev_b32 v76, 16, v50
    v_and_b32 v84, s25, v50
    v_lshlrev_b32 v77, 16, v54
    v_and_b32 v85, s25, v54
    v_lshlrev_b32 v78, 16, v58
    v_and_b32 v86, s25, v58
    v_lshlrev_b32 v79, 16, v62
    v_and_b32 v87, s25, v62
    v_add_f32 v80, v76, v78
    v_add_f32 v88, v84, v86
    v_add_f32 v81, v77, v79
    v_add_f32 v89, v85, v87
    v_fma_f32 v82, v78, 4.0, v76
    v_fma_f32 v90, v86, 4.0, v84
    v_fma_f32 v83, v79, 4.0, v77
    v_fma_f32 v91, v87, 4.0, v85
    v_add_f32 v77, v80, v81
    v_add_f32 v85, v88, v89
    v_sub_f32 v78, v80, v81
    v_sub_f32 v86, v88, v89
    v_fma_f32 v79, v83, 2.0, v82
    v_fma_f32 v87, v91, 2.0, v90
    v_fma_f32 v82, v83, -2.0, v82
    v_fma_f32 v90, v91, -2.0, v90
    v_fmamk_f32 v80, v76, 0x41700000, v82
    v_fmamk_f32 v88, v84, 0x41700000, v90
    v_fmamk_f32 v80, v81, 0x41200000, v80
    v_fmamk_f32 v88, v89, 0x41200000, v88
    v_cvt_pk_bf16_f32 v54, v77, v85
    v_cvt_pk_bf16_f32 v58, v78, v86
    v_cvt_pk_bf16_f32 v66, v79, v87
    v_cvt_pk_bf16_f32 v70, v82, v90
    v_cvt_pk_bf16_f32 v74, v80, v88
    v_lshlrev_b32 v76, 16, v51
    v_and_b32 v84, s25, v51
    v_lshlrev_b32 v77, 16, v55
    v_and_b32 v85, s25, v55
    v_lshlrev_b32 v78, 16, v59
    v_and_b32 v86, s25, v59
    v_lshlrev_b32 v79, 16, v63
    v_and_b32 v87, s25, v63
    v_add_f32 v80, v76, v78
    v_add_f32 v88, v84, v86
    v_add_f32 v81, v77, v79
    v_add_f32 v89, v85, v87
    v_fma_f32 v82, v78, 4.0, v76
    v_fma_f32 v90, v86, 4.0, v84
    v_fma_f32 v83, v79, 4.0, v77
    v_fma_f32 v91, v87, 4.0, v85
    v_add_f32 v77, v80, v81
    v_add_f32 v85, v88, v89
    v_sub_f32 v78, v80, v81
    v_sub_f32 v86, v88, v89
    v_fma_f32 v79, v83, 2.0, v82
    v_fma_f32 v87, v91, 2.0, v90
    v_fma_f32 v82, v83, -2.0, v82
    v_fma_f32 v90, v91, -2.0, v90
    v_fmamk_f32 v80, v76, 0x41700000, v82
    v_fmamk_f32 v88, v84, 0x41700000, v90
    v_fmamk_f32 v80, v81, 0x41200000, v80
    v_fmamk_f32 v88, v89, 0x41200000, v88
    v_cvt_pk_bf16_f32 v55, v77, v85
    v_cvt_pk_bf16_f32 v59, v78, v86
    v_cvt_pk_bf16_f32 v67, v79, v87
    v_cvt_pk_bf16_f32 v71, v82, v90
    v_cvt_pk_bf16_f32 v75, v80, v88
    s_add_u32 s28, s28, 1
    s_waitcnt lgkmcnt(0)
    s_barrier
    s_cmp_eq_u32 s22, 1
    s_cbranch_scc1 L_conv1_kernel_hlast2
    s_cmp_lt_u32 s28, 12
    s_cselect_b32 s24, 0, 2130706432
    ds_write_b128 v96, v[64:67] offset:57344
    ds_write_b128 v97, v[68:71] offset:8192
    ds_write_b128 v97, v[72:75] offset:24576
    ds_write_b128 v96, v[48:51] offset:8192
    ds_write_b128 v96, v[52:55] offset:24576
    ds_write_b128 v96, v[56:59] offset:40960
    ds_write_b128 v98, v[60:63] offset:8704
    s_waitcnt vmcnt(0)
    buffer_load_dwordx4 v[32:35], v92, s[8:11], s24 offen offset:0
    buffer_load_dwordx4 v[48:51], v92, s[8:11], s24 offen offset:64
    v_add_u32 v92, 128, v92
    buffer_load_dwordx4 v[36:39], v93, s[8:11], s24 offen offset:0
    buffer_load_dwordx4 v[52:55], v93, s[8:11], s24 offen offset:64
    v_add_u32 v93, 128, v93
    v_lshlrev_b32 v76, 16, v0
    v_and_b32 v84, s25, v0
    v_lshlrev_b32 v77, 16, v4
    v_and_b32 v85, s25, v4
    v_lshlrev_b32 v78, 16, v8
    v_and_b32 v86, s25, v8
    v_lshlrev_b32 v79, 16, v12
    v_and_b32 v87, s25, v12
    v_add_f32 v80, v76, v78
    v_add_f32 v88, v84, v86
    v_add_f32 v81, v77, v79
    v_add_f32 v89, v85, v87
    v_fma_f32 v82, v78, 4.0, v76
    v_fma_f32 v90, v86, 4.0, v84
    v_fma_f32 v83, v79, 4.0, v77
    v_fma_f32 v91, v87, 4.0, v85
    v_add_f32 v77, v80, v81
    v_add_f32 v85, v88, v89
    v_sub_f32 v78, v80, v81
    v_sub_f32 v86, v88, v89
    v_fma_f32 v79, v83, 2.0, v82
    v_fma_f32 v87, v91, 2.0, v90
    v_fma_f32 v82, v83, -2.0, v82
    v_fma_f32 v90, v91, -2.0, v90
    v_fmamk_f32 v80, v76, 0x41700000, v82
    v_fmamk_f32 v88, v84, 0x41700000, v90
    v_fmamk_f32 v80, v81, 0x41200000, v80
    v_fmamk_f32 v88, v89, 0x41200000, v88
    v_cvt_pk_bf16_f32 v4, v77, v85
    v_cvt_pk_bf16_f32 v8, v78, v86
    v_cvt_pk_bf16_f32 v64, v79, v87
    v_cvt_pk_bf16_f32 v68, v82, v90
    v_cvt_pk_bf16_f32 v72, v80, v88
    v_lshlrev_b32 v76, 16, v1
    v_and_b32 v84, s25, v1
    v_lshlrev_b32 v77, 16, v5
    v_and_b32 v85, s25, v5
    v_lshlrev_b32 v78, 16, v9
    v_and_b32 v86, s25, v9
    v_lshlrev_b32 v79, 16, v13
    v_and_b32 v87, s25, v13
    v_add_f32 v80, v76, v78
    v_add_f32 v88, v84, v86
    v_add_f32 v81, v77, v79
    v_add_f32 v89, v85, v87
    v_fma_f32 v82, v78, 4.0, v76
    v_fma_f32 v90, v86, 4.0, v84
    v_fma_f32 v83, v79, 4.0, v77
    v_fma_f32 v91, v87, 4.0, v85
    v_add_f32 v77, v80, v81
    v_add_f32 v85, v88, v89
    v_sub_f32 v78, v80, v81
    v_sub_f32 v86, v88, v89
    v_fma_f32 v79, v83, 2.0, v82
    v_fma_f32 v87, v91, 2.0, v90
    v_fma_f32 v82, v83, -2.0, v82
    v_fma_f32 v90, v91, -2.0, v90
    v_fmamk_f32 v80, v76, 0x41700000, v82
    v_fmamk_f32 v88, v84, 0x41700000, v90
    v_fmamk_f32 v80, v81, 0x41200000, v80
    v_fmamk_f32 v88, v89, 0x41200000, v88
    v_cvt_pk_bf16_f32 v5, v77, v85
    v_cvt_pk_bf16_f32 v9, v78, v86
    v_cvt_pk_bf16_f32 v65, v79, v87
    v_cvt_pk_bf16_f32 v69, v82, v90
    v_cvt_pk_bf16_f32 v73, v80, v88
    v_lshlrev_b32 v76, 16, v2
    v_and_b32 v84, s25, v2
    v_lshlrev_b32 v77, 16, v6
    v_and_b32 v85, s25, v6
    v_lshlrev_b32 v78, 16, v10
    v_and_b32 v86, s25, v10
    v_lshlrev_b32 v79, 16, v14
    v_and_b32 v87, s25, v14
    v_add_f32 v80, v76, v78
    v_add_f32 v88, v84, v86
    v_add_f32 v81, v77, v79
    v_add_f32 v89, v85, v87
    v_fma_f32 v82, v78, 4.0, v76
    v_fma_f32 v90, v86, 4.0, v84
    v_fma_f32 v83, v79, 4.0, v77
    v_fma_f32 v91, v87, 4.0, v85
    v_add_f32 v77, v80, v81
    v_add_f32 v85, v88, v89
    v_sub_f32 v78, v80, v81
    v_sub_f32 v86, v88, v89
    v_fma_f32 v79, v83, 2.0, v82
    v_fma_f32 v87, v91, 2.0, v90
    v_fma_f32 v82, v83, -2.0, v82
    v_fma_f32 v90, v91, -2.0, v90
    v_fmamk_f32 v80, v76, 0x41700000, v82
    v_fmamk_f32 v88, v84, 0x41700000, v90
    v_fmamk_f32 v80, v81, 0x41200000, v80
    v_fmamk_f32 v88, v89, 0x41200000, v88
    v_cvt_pk_bf16_f32 v6, v77, v85
    v_cvt_pk_bf16_f32 v10, v78, v86
    v_cvt_pk_bf16_f32 v66, v79, v87
    v_cvt_pk_bf16_f32 v70, v82, v90
    v_cvt_pk_bf16_f32 v74, v80, v88
    v_lshlrev_b32 v76, 16, v3
    v_and_b32 v84, s25, v3
    v_lshlrev_b32 v77, 16, v7
    v_and_b32 v85, s25, v7
    v_lshlrev_b32 v78, 16, v11
    v_and_b32 v86, s25, v11
    v_lshlrev_b32 v79, 16, v15
    v_and_b32 v87, s25, v15
    v_add_f32 v80, v76, v78
    v_add_f32 v88, v84, v86
    v_add_f32 v81, v77, v79
    v_add_f32 v89, v85, v87
    v_fma_f32 v82, v78, 4.0, v76
    v_fma_f32 v90, v86, 4.0, v84
    v_fma_f32 v83, v79, 4.0, v77
    v_fma_f32 v91, v87, 4.0, v85
    v_add_f32 v77, v80, v81
    v_add_f32 v85, v88, v89
    v_sub_f32 v78, v80, v81
    v_sub_f32 v86, v88, v89
    v_fma_f32 v79, v83, 2.0, v82
    v_fma_f32 v87, v91, 2.0, v90
    v_fma_f32 v82, v83, -2.0, v82
    v_fma_f32 v90, v91, -2.0, v90
    v_fmamk_f32 v80, v76, 0x41700000, v82
    v_fmamk_f32 v88, v84, 0x41700000, v90
    v_fmamk_f32 v80, v81, 0x41200000, v80
    v_fmamk_f32 v88, v89, 0x41200000, v88
    v_cvt_pk_bf16_f32 v7, v77, v85
    v_cvt_pk_bf16_f32 v11, v78, v86
    v_cvt_pk_bf16_f32 v67, v79, v87
    v_cvt_pk_bf16_f32 v71, v82, v90
    v_cvt_pk_bf16_f32 v75, v80, v88
    s_add_u32 s28, s28, 1
    s_waitcnt lgkmcnt(0)
    s_barrier
    s_cmp_lt_u32 s28, 12
    s_cselect_b32 s24, 0, 2130706432
    ds_write_b128 v96, v[64:67] offset:49152
    ds_write_b128 v97, v[68:71] offset:0
    ds_write_b128 v97, v[72:75] offset:16384
    ds_write_b128 v96, v[0:3] offset:0
    ds_write_b128 v96, v[4:7] offset:16384
    ds_write_b128 v96, v[8:11] offset:32768
    ds_write_b128 v98, v[12:15] offset:0
    buffer_load_dwordx4 v[40:43], v94, s[8:11], s24 offen offset:0
    buffer_load_dwordx4 v[56:59], v94, s[8:11], s24 offen offset:64
    v_add_u32 v94, 128, v94
    buffer_load_dwordx4 v[44:47], v95, s[8:11], s24 offen offset:0
    buffer_load_dwordx4 v[60:63], v95, s[8:11], s24 offen offset:64
    v_add_u32 v95, 128, v95
    v_lshlrev_b32 v76, 16, v16
    v_and_b32 v84, s25, v16
    v_lshlrev_b32 v77, 16, v20
    v_and_b32 v85, s25, v20
    v_lshlrev_b32 v78, 16, v24
    v_and_b32 v86, s25, v24
    v_lshlrev_b32 v79, 16, v28
    v_and_b32 v87, s25, v28
    v_add_f32 v80, v76, v78
    v_add_f32 v88, v84, v86
    v_add_f32 v81, v77, v79
    v_add_f32 v89, v85, v87
    v_fma_f32 v82, v78, 4.0, v76
    v_fma_f32 v90, v86, 4.0, v84
    v_fma_f32 v83, v79, 4.0, v77
    v_fma_f32 v91, v87, 4.0, v85
    v_add_f32 v77, v80, v81
    v_add_f32 v85, v88, v89
    v_sub_f32 v78, v80, v81
    v_sub_f32 v86, v88, v89
    v_fma_f32 v79, v83, 2.0, v82
    v_fma_f32 v87, v91, 2.0, v90
    v_fma_f32 v82, v83, -2.0, v82
    v_fma_f32 v90, v91, -2.0, v90
    v_fmamk_f32 v80, v76, 0x41700000, v82
    v_fmamk_f32 v88, v84, 0x41700000, v90
    v_fmamk_f32 v80, v81, 0x41200000, v80
    v_fmamk_f32 v88, v89, 0x41200000, v88
    v_cvt_pk_bf16_f32 v20, v77, v85
    v_cvt_pk_bf16_f32 v24, v78, v86
    v_cvt_pk_bf16_f32 v64, v79, v87
    v_cvt_pk_bf16_f32 v68, v82, v90
    v_cvt_pk_bf16_f32 v72, v80, v88
    v_lshlrev_b32 v76, 16, v17
    v_and_b32 v84, s25, v17
    v_lshlrev_b32 v77, 16, v21
    v_and_b32 v85, s25, v21
    v_lshlrev_b32 v78, 16, v25
    v_and_b32 v86, s25, v25
    v_lshlrev_b32 v79, 16, v29
    v_and_b32 v87, s25, v29
    v_add_f32 v80, v76, v78
    v_add_f32 v88, v84, v86
    v_add_f32 v81, v77, v79
    v_add_f32 v89, v85, v87
    v_fma_f32 v82, v78, 4.0, v76
    v_fma_f32 v90, v86, 4.0, v84
    v_fma_f32 v83, v79, 4.0, v77
    v_fma_f32 v91, v87, 4.0, v85
    v_add_f32 v77, v80, v81
    v_add_f32 v85, v88, v89
    v_sub_f32 v78, v80, v81
    v_sub_f32 v86, v88, v89
    v_fma_f32 v79, v83, 2.0, v82
    v_fma_f32 v87, v91, 2.0, v90
    v_fma_f32 v82, v83, -2.0, v82
    v_fma_f32 v90, v91, -2.0, v90
    v_fmamk_f32 v80, v76, 0x41700000, v82
    v_fmamk_f32 v88, v84, 0x41700000, v90
    v_fmamk_f32 v80, v81, 0x41200000, v80
    v_fmamk_f32 v88, v89, 0x41200000, v88
    v_cvt_pk_bf16_f32 v21, v77, v85
    v_cvt_pk_bf16_f32 v25, v78, v86
    v_cvt_pk_bf16_f32 v65, v79, v87
    v_cvt_pk_bf16_f32 v69, v82, v90
    v_cvt_pk_bf16_f32 v73, v80, v88
    v_lshlrev_b32 v76, 16, v18
    v_and_b32 v84, s25, v18
    v_lshlrev_b32 v77, 16, v22
    v_and_b32 v85, s25, v22
    v_lshlrev_b32 v78, 16, v26
    v_and_b32 v86, s25, v26
    v_lshlrev_b32 v79, 16, v30
    v_and_b32 v87, s25, v30
    v_add_f32 v80, v76, v78
    v_add_f32 v88, v84, v86
    v_add_f32 v81, v77, v79
    v_add_f32 v89, v85, v87
    v_fma_f32 v82, v78, 4.0, v76
    v_fma_f32 v90, v86, 4.0, v84
    v_fma_f32 v83, v79, 4.0, v77
    v_fma_f32 v91, v87, 4.0, v85
    v_add_f32 v77, v80, v81
    v_add_f32 v85, v88, v89
    v_sub_f32 v78, v80, v81
    v_sub_f32 v86, v88, v89
    v_fma_f32 v79, v83, 2.0, v82
    v_fma_f32 v87, v91, 2.0, v90
    v_fma_f32 v82, v83, -2.0, v82
    v_fma_f32 v90, v91, -2.0, v90
    v_fmamk_f32 v80, v76, 0x41700000, v82
    v_fmamk_f32 v88, v84, 0x41700000, v90
    v_fmamk_f32 v80, v81, 0x41200000, v80
    v_fmamk_f32 v88, v89, 0x41200000, v88
    v_cvt_pk_bf16_f32 v22, v77, v85
    v_cvt_pk_bf16_f32 v26, v78, v86
    v_cvt_pk_bf16_f32 v66, v79, v87
    v_cvt_pk_bf16_f32 v70, v82, v90
    v_cvt_pk_bf16_f32 v74, v80, v88
    v_lshlrev_b32 v76, 16, v19
    v_and_b32 v84, s25, v19
    v_lshlrev_b32 v77, 16, v23
    v_and_b32 v85, s25, v23
    v_lshlrev_b32 v78, 16, v27
    v_and_b32 v86, s25, v27
    v_lshlrev_b32 v79, 16, v31
    v_and_b32 v87, s25, v31
    v_add_f32 v80, v76, v78
    v_add_f32 v88, v84, v86
    v_add_f32 v81, v77, v79
    v_add_f32 v89, v85, v87
    v_fma_f32 v82, v78, 4.0, v76
    v_fma_f32 v90, v86, 4.0, v84
    v_fma_f32 v83, v79, 4.0, v77
    v_fma_f32 v91, v87, 4.0, v85
    v_add_f32 v77, v80, v81
    v_add_f32 v85, v88, v89
    v_sub_f32 v78, v80, v81
    v_sub_f32 v86, v88, v89
    v_fma_f32 v79, v83, 2.0, v82
    v_fma_f32 v87, v91, 2.0, v90
    v_fma_f32 v82, v83, -2.0, v82
    v_fma_f32 v90, v91, -2.0, v90
    v_fmamk_f32 v80, v76, 0x41700000, v82
    v_fmamk_f32 v88, v84, 0x41700000, v90
    v_fmamk_f32 v80, v81, 0x41200000, v80
    v_fmamk_f32 v88, v89, 0x41200000, v88
    v_cvt_pk_bf16_f32 v23, v77, v85
    v_cvt_pk_bf16_f32 v27, v78, v86
    v_cvt_pk_bf16_f32 v67, v79, v87
    v_cvt_pk_bf16_f32 v71, v82, v90
    v_cvt_pk_bf16_f32 v75, v80, v88
    s_add_u32 s28, s28, 1
    s_waitcnt lgkmcnt(0)
    s_barrier
    s_sub_u32 s22, s22, 1
    s_branch L_conv1_kernel_hloop2
L_conv1_kernel_hlast2:
    s_waitcnt vmcnt(0)
    s_mov_b32 s58, s20
    s_lshl_b32 s20, s2, 2
    s_add_u32 s20, s20, s32
    v_mov_b32 v1, v127
    s_load_dwordx2 s[8:9], s[0:1], 16
    s_lshr_b32 s22, s20, 8
    s_bfe_u32 s23, s20, 0x40004
    s_bfe_u32 s24, s20, 0x30001
    s_and_b32 s21, s20, 1
    v_lshrrev_b32 v2, 4, v1
    v_lshlrev_b32 v2, 12, v2
    v_and_b32 v3, 15, v1
    v_lshl_add_u32 v2, v3, 2, v2
    s_lshl_b32 s26, s22, 3
    s_lshr_b32 s27, s23, 3
    s_add_u32 s26, s26, s27
    s_lshl_b32 s26, s26, 17
    s_and_b32 s27, s23, 7
    s_lshl_b32 s27, s27, 14
    s_add_u32 s26, s26, s27
    s_lshl_b32 s27, s24, 6
    s_add_u32 s26, s26, s27
    s_mov_b32 s10, 4063232
    s_mov_b32 s11, 0x00020000
    s_add_u32 s37, s26, 262144
    s_add_u32 s38, s26, 524288
    s_add_u32 s39, s26, 786432
    s_waitcnt lgkmcnt(0)
    buffer_load_dword v16, v2, s[8:11], s26 offen offset:0
    buffer_load_dword v17, v2, s[8:11], s26 offen offset:512
    buffer_load_dword v24, v2, s[8:11], s37 offen offset:0
    buffer_load_dword v25, v2, s[8:11], s37 offen offset:512
    buffer_load_dword v32, v2, s[8:11], s38 offen offset:0
    buffer_load_dword v33, v2, s[8:11], s38 offen offset:512
    buffer_load_dword v40, v2, s[8:11], s39 offen offset:0
    buffer_load_dword v41, v2, s[8:11], s39 offen offset:512
    buffer_load_dword v18, v2, s[8:11], s26 offen offset:1024
    buffer_load_dword v19, v2, s[8:11], s26 offen offset:1536
    buffer_load_dword v26, v2, s[8:11], s37 offen offset:1024
    buffer_load_dword v27, v2, s[8:11], s37 offen offset:1536
    buffer_load_dword v34, v2, s[8:11], s38 offen offset:1024
    buffer_load_dword v35, v2, s[8:11], s38 offen offset:1536
    buffer_load_dword v42, v2, s[8:11], s39 offen offset:1024
    buffer_load_dword v43, v2, s[8:11], s39 offen offset:1536
    buffer_load_dword v20, v2, s[8:11], s26 offen offset:2048
    buffer_load_dword v21, v2, s[8:11], s26 offen offset:2560
    buffer_load_dword v28, v2, s[8:11], s37 offen offset:2048
    buffer_load_dword v29, v2, s[8:11], s37 offen offset:2560
    buffer_load_dword v36, v2, s[8:11], s38 offen offset:2048
    buffer_load_dword v37, v2, s[8:11], s38 offen offset:2560
    buffer_load_dword v44, v2, s[8:11], s39 offen offset:2048
    buffer_load_dword v45, v2, s[8:11], s39 offen offset:2560
    buffer_load_dword v22, v2, s[8:11], s26 offen offset:3072
    buffer_load_dword v23, v2, s[8:11], s26 offen offset:3584
    buffer_load_dword v30, v2, s[8:11], s37 offen offset:3072
    buffer_load_dword v31, v2, s[8:11], s37 offen offset:3584
    buffer_load_dword v38, v2, s[8:11], s38 offen offset:3072
    buffer_load_dword v39, v2, s[8:11], s38 offen offset:3584
    buffer_load_dword v46, v2, s[8:11], s39 offen offset:3072
    buffer_load_dword v47, v2, s[8:11], s39 offen offset:3584
    s_add_u32 s12, s30, 9437184
    s_addc_u32 s13, s31, 0
    s_mov_b32 s14, 7340032
    s_mov_b32 s15, 0x00020000
    v_lshlrev_b32 v4, 4, v1
    s_lshl_b32 s27, s24, 4
    s_add_u32 s27, s27, s23
    s_mul_i32 s27, s27, 57344
    s_lshl_b32 s28, s22, 11
    s_add_u32 s27, s27, s28
    s_lshl_b32 s28, s21, 10
    s_add_u32 s27, s27, s28
    s_cmp_eq_u32 s21, 0
    s_mov_b32 s32, 0x07060302
    s_cselect_b32 s32, 0x05040100, s32
    s_mov_b32 s33, 0x03020c0c
    s_cselect_b32 s33, 0x01000c0c, s33
    s_mov_b32 s35, 0x3d2aaaab
    s_mov_b32 s36, 0x3c638e39
    s_mov_b32 s25, 0xffff0000
    ds_write_b128 v96, v[64:67] offset:57344
    ds_write_b128 v97, v[68:71] offset:8192
    ds_write_b128 v97, v[72:75] offset:24576
    ds_write_b128 v96, v[48:51] offset:8192
    ds_write_b128 v96, v[52:55] offset:24576
    ds_write_b128 v96, v[56:59] offset:40960
    ds_write_b128 v98, v[60:63] offset:8704
    s_waitcnt lgkmcnt(0)
    s_barrier
    s_waitcnt vmcnt(24)
    v_perm_b32 v72, v17, v16, s32
    v_perm_b32 v48, v41, v40, s32
    v_perm_b32 v76, v76, v40, s33
    v_perm_b32 v84, v84, v41, s33
    v_perm_b32 v77, v77, v32, s33
    v_perm_b32 v85, v85, v33, s33
    v_perm_b32 v78, v78, v24, s33
    v_perm_b32 v86, v86, v25, s33
    v_perm_b32 v79, v79, v16, s33
    v_perm_b32 v87, v87, v17, s33
    v_add_f32 v80, v76, v78
    v_add_f32 v88, v84, v86
    v_add_f32 v81, v77, v79
    v_add_f32 v89, v85, v87
    v_fma_f32 v82, v78, 4.0, v76
    v_fma_f32 v90, v86, 4.0, v84
    v_fma_f32 v83, v79, 4.0, v77
    v_fma_f32 v91, v87, 4.0, v85
    v_add_f32 v77, v80, v81
    v_add_f32 v85, v88, v89
    v_sub_f32 v78, v80, v81
    v_sub_f32 v86, v88, v89
    v_fma_f32 v79, v83, 2.0, v82
    v_fma_f32 v87, v91, 2.0, v90
    v_fma_f32 v82, v83, -2.0, v82
    v_fma_f32 v90, v91, -2.0, v90
    v_fmamk_f32 v80, v76, 0x41700000, v82
    v_fmamk_f32 v88, v84, 0x41700000, v90
    v_fmamk_f32 v80, v81, 0x41200000, v80
    v_fmamk_f32 v88, v89, 0x41200000, v88
    v_mul_f32 v77, 0.5, v77
    v_mul_f32 v85, 0.5, v85
    v_mul_f32 v78, 0.5, v78
    v_mul_f32 v86, 0.5, v86
    v_mul_f32 v79, s35, v79
    v_mul_f32 v87, s35, v87
    v_mul_f32 v82, s35, v82
    v_mul_f32 v90, s35, v90
    v_mul_f32 v80, s36, v80
    v_mul_f32 v88, s36, v88
    v_cvt_pk_bf16_f32 v52, v77, v85
    v_cvt_pk_bf16_f32 v56, v78, v86
    v_cvt_pk_bf16_f32 v60, v79, v87
    v_cvt_pk_bf16_f32 v64, v82, v90
    v_cvt_pk_bf16_f32 v68, v80, v88
    s_waitcnt vmcnt(16)
    v_perm_b32 v73, v19, v18, s32
    v_perm_b32 v49, v43, v42, s32
    v_perm_b32 v76, v76, v42, s33
    v_perm_b32 v84, v84, v43, s33
    v_perm_b32 v77, v77, v34, s33
    v_perm_b32 v85, v85, v35, s33
    v_perm_b32 v78, v78, v26, s33
    v_perm_b32 v86, v86, v27, s33
    v_perm_b32 v79, v79, v18, s33
    v_perm_b32 v87, v87, v19, s33
    v_add_f32 v80, v76, v78
    v_add_f32 v88, v84, v86
    v_add_f32 v81, v77, v79
    v_add_f32 v89, v85, v87
    v_fma_f32 v82, v78, 4.0, v76
    v_fma_f32 v90, v86, 4.0, v84
    v_fma_f32 v83, v79, 4.0, v77
    v_fma_f32 v91, v87, 4.0, v85
    v_add_f32 v77, v80, v81
    v_add_f32 v85, v88, v89
    v_sub_f32 v78, v80, v81
    v_sub_f32 v86, v88, v89
    v_fma_f32 v79, v83, 2.0, v82
    v_fma_f32 v87, v91, 2.0, v90
    v_fma_f32 v82, v83, -2.0, v82
    v_fma_f32 v90, v91, -2.0, v90
    v_fmamk_f32 v80, v76, 0x41700000, v82
    v_fmamk_f32 v88, v84, 0x41700000, v90
    v_fmamk_f32 v80, v81, 0x41200000, v80
    v_fmamk_f32 v88, v89, 0x41200000, v88
    v_mul_f32 v77, 0.5, v77
    v_mul_f32 v85, 0.5, v85
    v_mul_f32 v78, 0.5, v78
    v_mul_f32 v86, 0.5, v86
    v_mul_f32 v79, s35, v79
    v_mul_f32 v87, s35, v87
    v_mul_f32 v82, s35, v82
    v_mul_f32 v90, s35, v90
    v_mul_f32 v80, s36, v80
    v_mul_f32 v88, s36, v88
    v_cvt_pk_bf16_f32 v53, v77, v85
    v_cvt_pk_bf16_f32 v57, v78, v86
    v_cvt_pk_bf16_f32 v61, v79, v87
    v_cvt_pk_bf16_f32 v65, v82, v90
    v_cvt_pk_bf16_f32 v69, v80, v88
    s_waitcnt vmcnt(8)
    v_perm_b32 v74, v21, v20, s32
    v_perm_b32 v50, v45, v44, s32
    v_perm_b32 v76, v76, v44, s33
    v_perm_b32 v84, v84, v45, s33
    v_perm_b32 v77, v77, v36, s33
    v_perm_b32 v85, v85, v37, s33
    v_perm_b32 v78, v78, v28, s33
    v_perm_b32 v86, v86, v29, s33
    v_perm_b32 v79, v79, v20, s33
    v_perm_b32 v87, v87, v21, s33
    v_add_f32 v80, v76, v78
    v_add_f32 v88, v84, v86
    v_add_f32 v81, v77, v79
    v_add_f32 v89, v85, v87
    v_fma_f32 v82, v78, 4.0, v76
    v_fma_f32 v90, v86, 4.0, v84
    v_fma_f32 v83, v79, 4.0, v77
    v_fma_f32 v91, v87, 4.0, v85
    v_add_f32 v77, v80, v81
    v_add_f32 v85, v88, v89
    v_sub_f32 v78, v80, v81
    v_sub_f32 v86, v88, v89
    v_fma_f32 v79, v83, 2.0, v82
    v_fma_f32 v87, v91, 2.0, v90
    v_fma_f32 v82, v83, -2.0, v82
    v_fma_f32 v90, v91, -2.0, v90
    v_fmamk_f32 v80, v76, 0x41700000, v82
    v_fmamk_f32 v88, v84, 0x41700000, v90
    v_fmamk_f32 v80, v81, 0x41200000, v80
    v_fmamk_f32 v88, v89, 0x41200000, v88
    v_mul_f32 v77, 0.5, v77
    v_mul_f32 v85, 0.5, v85
    v_mul_f32 v78, 0.5, v78
    v_mul_f32 v86, 0.5, v86
    v_mul_f32 v79, s35, v79
    v_mul_f32 v87, s35, v87
    v_mul_f32 v82, s35, v82
    v_mul_f32 v90, s35, v90
    v_mul_f32 v80, s36, v80
    v_mul_f32 v88, s36, v88
    v_cvt_pk_bf16_f32 v54, v77, v85
    v_cvt_pk_bf16_f32 v58, v78, v86
    v_cvt_pk_bf16_f32 v62, v79, v87
    v_cvt_pk_bf16_f32 v66, v82, v90
    v_cvt_pk_bf16_f32 v70, v80, v88
    s_waitcnt vmcnt(0)
    v_perm_b32 v75, v23, v22, s32
    v_perm_b32 v51, v47, v46, s32
    v_perm_b32 v76, v76, v46, s33
    v_perm_b32 v84, v84, v47, s33
    v_perm_b32 v77, v77, v38, s33
    v_perm_b32 v85, v85, v39, s33
    v_perm_b32 v78, v78, v30, s33
    v_perm_b32 v86, v86, v31, s33
    v_perm_b32 v79, v79, v22, s33
    v_perm_b32 v87, v87, v23, s33
    v_add_f32 v80, v76, v78
    v_add_f32 v88, v84, v86
    v_add_f32 v81, v77, v79
    v_add_f32 v89, v85, v87
    v_fma_f32 v82, v78, 4.0, v76
    v_fma_f32 v90, v86, 4.0, v84
    v_fma_f32 v83, v79, 4.0, v77
    v_fma_f32 v91, v87, 4.0, v85
    v_add_f32 v77, v80, v81
    v_add_f32 v85, v88, v89
    v_sub_f32 v78, v80, v81
    v_sub_f32 v86, v88, v89
    v_fma_f32 v79, v83, 2.0, v82
    v_fma_f32 v87, v91, 2.0, v90
    v_fma_f32 v82, v83, -2.0, v82
    v_fma_f32 v90, v91, -2.0, v90
    v_fmamk_f32 v80, v76, 0x41700000, v82
    v_fmamk_f32 v88, v84, 0x41700000, v90
    v_fmamk_f32 v80, v81, 0x41200000, v80
    v_fmamk_f32 v88, v89, 0x41200000, v88
    v_mul_f32 v77, 0.5, v77
    v_mul_f32 v85, 0.5, v85
    v_mul_f32 v78, 0.5, v78
    v_mul_f32 v86, 0.5, v86
    v_mul_f32 v79, s35, v79
    v_mul_f32 v87, s35, v87
    v_mul_f32 v82, s35, v82
    v_mul_f32 v90, s35, v90
    v_mul_f32 v80, s36, v80
    v_mul_f32 v88, s36, v88
    v_cvt_pk_bf16_f32 v55, v77, v85
    v_cvt_pk_bf16_f32 v59, v78, v86
    v_cvt_pk_bf16_f32 v63, v79, v87
    v_cvt_pk_bf16_f32 v67, v82, v90
    v_cvt_pk_bf16_f32 v71, v80, v88
    s_add_u32 s28, s27, 49152
    buffer_store_dwordx4 v[72:75], v4, s[12:15], s28 offen sc1
    s_add_u32 s28, s27, 0
    buffer_store_dwordx4 v[48:51], v4, s[12:15], s28 offen sc1
    s_add_u32 s28, s27, 8192
    buffer_store_dwordx4 v[52:55], v4, s[12:15], s28 offen sc1
    s_add_u32 s28, s27, 16384
    buffer_store_dwordx4 v[56:59], v4, s[12:15], s28 offen sc1
    s_add_u32 s28, s27, 24576
    buffer_store_dwordx4 v[60:63], v4, s[12:15], s28 offen sc1
    s_add_u32 s28, s27, 32768
    buffer_store_dwordx4 v[64:67], v4, s[12:15], s28 offen sc1
    s_add_u32 s28, s27, 40960
    buffer_store_dwordx4 v[68:71], v4, s[12:15], s28 offen sc1
    s_mov_b32 s20, s58
    s_branch L_conv1_kernel_end
L_conv1_kernel_epi:
    s_waitcnt lgkmcnt(0)
    s_barrier
    v_cndmask_b32 v122, v111, v110, vcc
    ds_read_b128 v[0:3], v120 offset:0
    ds_read_b128 v[4:7], v120 offset:16384
    ds_read_b128 v[8:11], v120 offset:32768
    ds_read_b128 v[12:15], v120 offset:49152
    ds_read_b128 v[16:19], v121 offset:0
    ds_read_b128 v[20:23], v121 offset:16384
    ds_read_b128 v[24:27], v121 offset:32768
    ds_read_b128 v[28:31], v64 offset:15360
    ds_read_b128 v[32:35], v120 offset:8192
    ds_read_b128 v[36:39], v120 offset:24576
    ds_read_b128 v[40:43], v120 offset:40960
    ds_read_b128 v[44:47], v120 offset:57344
    ds_read_b128 v[48:51], v121 offset:56320
    ds_read_b128 v[52:55], v121 offset:64512
    ds_read_b128 v[56:59], v64 offset:7168
    s_waitcnt lgkmcnt(7)
    ds_read_b128 v[60:63], v64 offset:23552
    s_waitcnt lgkmcnt(8)
    v_pk_add_f32 v[88:89], v[24:25], v[28:29]
    v_pk_add_f32 v[90:91], v[26:27], v[30:31]
    v_pk_add_f32 v[24:25], v[4:5], v[8:9]
    v_pk_add_f32 v[26:27], v[6:7], v[10:11]
    v_pk_add_f32 v[4:5], v[4:5], v[8:9] neg_lo:[0,1] neg_hi:[0,1]
    v_pk_add_f32 v[6:7], v[6:7], v[10:11] neg_lo:[0,1] neg_hi:[0,1]
    v_pk_add_f32 v[72:73], v[12:13], v[16:17]
    v_pk_add_f32 v[74:75], v[14:15], v[18:19]
    v_pk_add_f32 v[12:13], v[12:13], v[16:17] neg_lo:[0,1] neg_hi:[0,1]
    v_pk_add_f32 v[14:15], v[14:15], v[18:19] neg_lo:[0,1] neg_hi:[0,1]
    v_pk_fma_f32 v[72:73], v[24:25], s[4:5], v[72:73]
    v_pk_fma_f32 v[74:75], v[26:27], s[4:5], v[74:75]
    v_pk_fma_f32 v[20:21], v[0:1], s[10:11], v[20:21]
    v_pk_fma_f32 v[22:23], v[2:3], s[10:11], v[22:23]
    v_pk_fma_f32 v[72:73], v[0:1], s[6:7], v[72:73]
    v_pk_fma_f32 v[74:75], v[2:3], s[6:7], v[74:75]
    v_pk_add_f32 v[24:25], v[24:25], v[0:1] neg_lo:[0,1] neg_hi:[0,1]
    v_pk_add_f32 v[26:27], v[26:27], v[2:3] neg_lo:[0,1] neg_hi:[0,1]
    v_pk_fma_f32 v[72:73], v[88:89], s[8:9], v[72:73]
    v_pk_fma_f32 v[74:75], v[90:91], s[8:9], v[74:75]
    v_pk_add_f32 v[24:25], v[24:25], v[88:89] neg_lo:[0,1] neg_hi:[0,1]
    v_pk_add_f32 v[26:27], v[26:27], v[90:91] neg_lo:[0,1] neg_hi:[0,1]
    v_pk_fma_f32 v[20:21], v[88:89], s[22:23], v[20:21]
    v_pk_fma_f32 v[22:23], v[90:91], s[22:23], v[22:23]
    v_pk_add_f32 v[8:9], v[24:25], v[72:73] neg_lo:[0,1] neg_hi:[0,1]
    v_pk_add_f32 v[10:11], v[26:27], v[74:75] neg_lo:[0,1] neg_hi:[0,1]
    v_pk_fma_f32 v[20:21], v[72:73], s[14:15], v[20:21]
    v_pk_fma_f32 v[22:23], v[74:75], s[14:15], v[22:23]
    v_pk_mul_f32 v[80:81], v[12:13], s[32:33]
    v_pk_mul_f32 v[82:83], v[14:15], s[32:33]
    v_pk_fma_f32 v[20:21], v[8:9], s[12:13], v[20:21]
    v_pk_fma_f32 v[22:23], v[10:11], s[12:13], v[22:23]
    v_pk_fma_f32 v[80:81], v[4:5], s[34:35], v[80:81]
    v_pk_fma_f32 v[82:83], v[6:7], s[34:35], v[82:83]
    v_pk_fma_f32 v[64:65], v[4:5], s[24:25], v[20:21] neg_lo:[0,0,1] neg_hi:[0,0,1]
    v_pk_fma_f32 v[66:67], v[6:7], s[24:25], v[22:23] neg_lo:[0,0,1] neg_hi:[0,0,1]
    v_pk_fma_f32 v[64:65], v[12:13], s[26:27], v[64:65]
    v_pk_fma_f32 v[66:67], v[14:15], s[26:27], v[66:67]
    v_pk_fma_f32 v[80:81], v[64:65], s[38:39], v[80:81]
    v_pk_fma_f32 v[82:83], v[66:67], s[38:39], v[82:83]
    v_pk_add_f32 v[4:5], v[4:5], v[64:65] neg_lo:[0,1] neg_hi:[0,1]
    v_pk_add_f32 v[6:7], v[6:7], v[66:67] neg_lo:[0,1] neg_hi:[0,1]
    v_pk_add_f32 v[4:5], v[4:5], v[80:81] neg_lo:[0,1] neg_hi:[0,1]
    v_pk_add_f32 v[6:7], v[6:7], v[82:83] neg_lo:[0,1] neg_hi:[0,1]
    s_waitcnt lgkmcnt(0)
    v_pk_add_f32 v[92:93], v[56:57], v[60:61]
    v_pk_add_f32 v[94:95], v[58:59], v[62:63]
    v_pk_add_f32 v[56:57], v[36:37], v[40:41]
    v_pk_add_f32 v[58:59], v[38:39], v[42:43]
    v_pk_add_f32 v[36:37], v[36:37], v[40:41] neg_lo:[0,1] neg_hi:[0,1]
    v_pk_add_f32 v[38:39], v[38:39], v[42:43] neg_lo:[0,1] neg_hi:[0,1]
    v_pk_add_f32 v[76:77], v[44:45], v[48:49]
    v_pk_add_f32 v[78:79], v[46:47], v[50:51]
    v_pk_add_f32 v[44:45], v[44:45], v[48:49] neg_lo:[0,1] neg_hi:[0,1]
    v_pk_add_f32 v[46:47], v[46:47], v[50:51] neg_lo:[0,1] neg_hi:[0,1]
    v_pk_fma_f32 v[76:77], v[56:57], s[4:5], v[76:77]
    v_pk_fma_f32 v[78:79], v[58:59], s[4:5], v[78:79]
    v_pk_fma_f32 v[52:53], v[32:33], s[10:11], v[52:53]
    v_pk_fma_f32 v[54:55], v[34:35], s[10:11], v[54:55]
    v_pk_fma_f32 v[76:77], v[32:33], s[6:7], v[76:77]
    v_pk_fma_f32 v[78:79], v[34:35], s[6:7], v[78:79]
    v_pk_add_f32 v[56:57], v[56:57], v[32:33] neg_lo:[0,1] neg_hi:[0,1]
    v_pk_add_f32 v[58:59], v[58:59], v[34:35] neg_lo:[0,1] neg_hi:[0,1]
    v_pk_fma_f32 v[76:77], v[92:93], s[8:9], v[76:77]
    v_pk_fma_f32 v[78:79], v[94:95], s[8:9], v[78:79]
    v_pk_add_f32 v[56:57], v[56:57], v[92:93] neg_lo:[0,1] neg_hi:[0,1]
    v_pk_add_f32 v[58:59], v[58:59], v[94:95] neg_lo:[0,1] neg_hi:[0,1]
    v_pk_fma_f32 v[52:53], v[92:93], s[22:23], v[52:53]
    v_pk_fma_f32 v[54:55], v[94:95], s[22:23], v[54:55]
    v_pk_add_f32 v[40:41], v[56:57], v[76:77] neg_lo:[0,1] neg_hi:[0,1]
    v_pk_add_f32 v[42:43], v[58:59], v[78:79] neg_lo:[0,1] neg_hi:[0,1]
    v_pk_fma_f32 v[52:53], v[76:77], s[14:15], v[52:53]
    v_pk_fma_f32 v[54:55], v[78:79], s[14:15], v[54:55]
    v_pk_mul_f32 v[84:85], v[44:45], s[32:33]
    v_pk_mul_f32 v[86:87], v[46:47], s[32:33]
    v_pk_fma_f32 v[52:53], v[40:41], s[12:13], v[52:53]
    v_pk_fma_f32 v[54:55], v[42:43], s[12:13], v[54:55]
    v_pk_fma_f32 v[84:85], v[36:37], s[34:35], v[84:85]
    v_pk_fma_f32 v[86:87], v[38:39], s[34:35], v[86:87]
    v_pk_fma_f32 v[68:69], v[36:37], s[24:25], v[52:53] neg_lo:[0,0,1] neg_hi:[0,0,1]
    v_pk_fma_f32 v[70:71], v[38:39], s[24:25], v[54:55] neg_lo:[0,0,1] neg_hi:[0,0,1]
    v_pk_fma_f32 v[68:69], v[44:45], s[26:27], v[68:69]
    v_pk_fma_f32 v[70:71], v[46:47], s[26:27], v[70:71]
    v_pk_fma_f32 v[84:85], v[68:69], s[38:39], v[84:85]
    v_pk_fma_f32 v[86:87], v[70:71], s[38:39], v[86:87]
    v_pk_add_f32 v[36:37], v[36:37], v[68:69] neg_lo:[0,1] neg_hi:[0,1]
    v_pk_add_f32 v[38:39], v[38:39], v[70:71] neg_lo:[0,1] neg_hi:[0,1]
    v_pk_add_f32 v[36:37], v[36:37], v[84:85] neg_lo:[0,1] neg_hi:[0,1]
    v_pk_add_f32 v[38:39], v[38:39], v[86:87] neg_lo:[0,1] neg_hi:[0,1]
    s_mov_b32 s36, 0x00010001
    s_mov_b32 s37, 0x00010001
    s_mov_b64 exec, s[36:37]
    ds_write_b128 v127, v[0:3] offset:0
    ds_write_b128 v127, v[32:35] offset:16
    ds_write_b128 v127, v[4:7] offset:32
    ds_write_b128 v127, v[36:39] offset:48
    ds_write_b128 v127, v[8:11] offset:64
    ds_write_b128 v127, v[40:43] offset:80
    s_mov_b64 exec, -1
    v_mov_b32 v44, 0xc0135761
    v_mov_b32 v45, v44
    v_pk_mul_f32 v[16:17], v[64:65], v[64:65]
    v_pk_mul_f32 v[18:19], v[66:67], v[66:67]
    v_pk_mul_f32 v[20:21], v[68:69], v[68:69]
    v_pk_mul_f32 v[22:23], v[70:71], v[70:71]
    v_pk_fma_f32 v[16:17], v[16:17], s[40:41], v[44:45]
    v_pk_fma_f32 v[18:19], v[18:19], s[40:41], v[44:45]
    v_pk_fma_f32 v[20:21], v[20:21], s[40:41], v[44:45]
    v_pk_fma_f32 v[22:23], v[22:23], s[40:41], v[44:45]
    v_pk_mul_f32 v[16:17], v[16:17], v[64:65]
    v_pk_mul_f32 v[18:19], v[18:19], v[66:67]
    v_pk_mul_f32 v[20:21], v[20:21], v[68:69]
    v_pk_mul_f32 v[22:23], v[22:23], v[70:71]
    v_exp_f32 v16, v16
    v_exp_f32 v17, v17
    v_exp_f32 v18, v18
    v_exp_f32 v19, v19
    v_exp_f32 v20, v20
    v_exp_f32 v21, v21
    v_exp_f32 v22, v22
    v_exp_f32 v23, v23
    v_pk_add_f32 v[16:17], v[16:17], s[42:43]
    v_pk_add_f32 v[18:19], v[18:19], s[42:43]
    v_pk_add_f32 v[20:21], v[20:21], s[42:43]
    v_pk_add_f32 v[22:23], v[22:23], s[42:43]
    v_rcp_f32 v16, v16
    v_rcp_f32 v17, v17
    v_rcp_f32 v18, v18
    v_rcp_f32 v19, v19
    v_rcp_f32 v20, v20
    v_rcp_f32 v21, v21
    v_rcp_f32 v22, v22
    v_rcp_f32 v23, v23
    v_pk_mul_f32 v[64:65], v[64:65], v[16:17]
    v_pk_mul_f32 v[66:67], v[66:67], v[18:19]
    v_pk_mul_f32 v[68:69], v[68:69], v[20:21]
    v_pk_mul_f32 v[70:71], v[70:71], v[22:23]
    v_cvt_pk_bf16_f32 v48, v64, v68
    v_cvt_pk_bf16_f32 v49, v65, v69
    v_cvt_pk_bf16_f32 v50, v66, v70
    v_cvt_pk_bf16_f32 v51, v67, v71
    s_mov_b32 s44, 393280
    buffer_store_dwordx4 v[48:51], v122, s[16:19], s44 offen sc1
    s_waitcnt lgkmcnt(0)
    s_barrier
    ds_read_b128 v[96:99], v127 offset:512
    ds_read_b128 v[100:103], v127 offset:528
    ds_read_b128 v[104:107], v127 offset:544
    ds_read_b128 v[108:111], v127 offset:560
    ds_read_b128 v[112:115], v127 offset:576
    ds_read_b128 v[116:119], v127 offset:592
    s_waitcnt lgkmcnt(4)
    v_mov_b32_dpp v96, v0 row_shl:1 row_mask:0xf bank_mask:0xf
    v_mov_b32_dpp v97, v1 row_shl:1 row_mask:0xf bank_mask:0xf
    v_mov_b32_dpp v98, v2 row_shl:1 row_mask:0xf bank_mask:0xf
    v_mov_b32_dpp v99, v3 row_shl:1 row_mask:0xf bank_mask:0xf
    v_mov_b32_dpp v100, v32 row_shl:1 row_mask:0xf bank_mask:0xf
    v_mov_b32_dpp v101, v33 row_shl:1 row_mask:0xf bank_mask:0xf
    v_mov_b32_dpp v102, v34 row_shl:1 row_mask:0xf bank_mask:0xf
    v_mov_b32_dpp v103, v35 row_shl:1 row_mask:0xf bank_mask:0xf
    v_pk_add_f32 v[72:73], v[72:73], v[96:97]
    v_pk_add_f32 v[74:75], v[74:75], v[98:99]
    v_pk_add_f32 v[76:77], v[76:77], v[100:101]
    v_pk_add_f32 v[78:79], v[78:79], v[102:103]
    v_pk_mul_f32 v[24:25], v[72:73], v[72:73]
    v_pk_mul_f32 v[26:27], v[74:75], v[74:75]
    v_pk_mul_f32 v[28:29], v[76:77], v[76:77]
    v_pk_mul_f32 v[30:31], v[78:79], v[78:79]
    v_pk_fma_f32 v[24:25], v[24:25], s[40:41], v[44:45]
    v_pk_fma_f32 v[26:27], v[26:27], s[40:41], v[44:45]
    v_pk_fma_f32 v[28:29], v[28:29], s[40:41], v[44:45]
    v_pk_fma_f32 v[30:31], v[30:31], s[40:41], v[44:45]
    v_pk_mul_f32 v[24:25], v[24:25], v[72:73]
    v_pk_mul_f32 v[26:27], v[26:27], v[74:75]
    v_pk_mul_f32 v[28:29], v[28:29], v[76:77]
    v_pk_mul_f32 v[30:31], v[30:31], v[78:79]
    v_exp_f32 v24, v24
    v_exp_f32 v25, v25
    v_exp_f32 v26, v26
    v_exp_f32 v27, v27
    v_exp_f32 v28, v28
    v_exp_f32 v29, v29
    v_exp_f32 v30, v30
    v_exp_f32 v31, v31
    v_pk_add_f32 v[24:25], v[24:25], s[42:43]
    v_pk_add_f32 v[26:27], v[26:27], s[42:43]
    v_pk_add_f32 v[28:29], v[28:29], s[42:43]
    v_pk_add_f32 v[30:31], v[30:31], s[42:43]
    v_rcp_f32 v24, v24
    v_rcp_f32 v25, v25
    v_rcp_f32 v26, v26
    v_rcp_f32 v27, v27
    v_rcp_f32 v28, v28
    v_rcp_f32 v29, v29
    v_rcp_f32 v30, v30
    v_rcp_f32 v31, v31
    v_pk_mul_f32 v[72:73], v[72:73], v[24:25]
    v_pk_mul_f32 v[74:75], v[74:75], v[26:27]
    v_pk_mul_f32 v[76:77], v[76:77], v[28:29]
    v_pk_mul_f32 v[78:79], v[78:79], v[30:31]
    v_cvt_pk_bf16_f32 v52, v72, v76
    v_cvt_pk_bf16_f32 v53, v73, v77
    v_cvt_pk_bf16_f32 v54, v74, v78
    v_cvt_pk_bf16_f32 v55, v75, v79
    s_mov_b32 s44, 128
    buffer_store_dwordx4 v[52:55], v122, s[16:19], s44 offen sc1
    s_waitcnt lgkmcnt(2)
    v_mov_b32_dpp v104, v4 row_shl:1 row_mask:0xf bank_mask:0xf
    v_mov_b32_dpp v105, v5 row_shl:1 row_mask:0xf bank_mask:0xf
    v_mov_b32_dpp v106, v6 row_shl:1 row_mask:0xf bank_mask:0xf
    v_mov_b32_dpp v107, v7 row_shl:1 row_mask:0xf bank_mask:0xf
    v_mov_b32_dpp v108, v36 row_shl:1 row_mask:0xf bank_mask:0xf
    v_mov_b32_dpp v109, v37 row_shl:1 row_mask:0xf bank_mask:0xf
    v_mov_b32_dpp v110, v38 row_shl:1 row_mask:0xf bank_mask:0xf
    v_mov_b32_dpp v111, v39 row_shl:1 row_mask:0xf bank_mask:0xf
    v_pk_add_f32 v[80:81], v[80:81], v[104:105]
    v_pk_add_f32 v[82:83], v[82:83], v[106:107]
    v_pk_add_f32 v[84:85], v[84:85], v[108:109]
    v_pk_add_f32 v[86:87], v[86:87], v[110:111]
    v_pk_mul_f32 v[16:17], v[80:81], v[80:81]
    v_pk_mul_f32 v[18:19], v[82:83], v[82:83]
    v_pk_mul_f32 v[20:21], v[84:85], v[84:85]
    v_pk_mul_f32 v[22:23], v[86:87], v[86:87]
    v_pk_fma_f32 v[16:17], v[16:17], s[40:41], v[44:45]
    v_pk_fma_f32 v[18:19], v[18:19], s[40:41], v[44:45]
    v_pk_fma_f32 v[20:21], v[20:21], s[40:41], v[44:45]
    v_pk_fma_f32 v[22:23], v[22:23], s[40:41], v[44:45]
    v_pk_mul_f32 v[16:17], v[16:17], v[80:81]
    v_pk_mul_f32 v[18:19], v[18:19], v[82:83]
    v_pk_mul_f32 v[20:21], v[20:21], v[84:85]
    v_pk_mul_f32 v[22:23], v[22:23], v[86:87]
    v_exp_f32 v16, v16
    v_exp_f32 v17, v17
    v_exp_f32 v18, v18
    v_exp_f32 v19, v19
    v_exp_f32 v20, v20
    v_exp_f32 v21, v21
    v_exp_f32 v22, v22
    v_exp_f32 v23, v23
    v_pk_add_f32 v[16:17], v[16:17], s[42:43]
    v_pk_add_f32 v[18:19], v[18:19], s[42:43]
    v_pk_add_f32 v[20:21], v[20:21], s[42:43]
    v_pk_add_f32 v[22:23], v[22:23], s[42:43]
    v_rcp_f32 v16, v16
    v_rcp_f32 v17, v17
    v_rcp_f32 v18, v18
    v_rcp_f32 v19, v19
    v_rcp_f32 v20, v20
    v_rcp_f32 v21, v21
    v_rcp_f32 v22, v22
    v_rcp_f32 v23, v23
    v_pk_mul_f32 v[80:81], v[80:81], v[16:17]
    v_pk_mul_f32 v[82:83], v[82:83], v[18:19]
    v_pk_mul_f32 v[84:85], v[84:85], v[20:21]
    v_pk_mul_f32 v[86:87], v[86:87], v[22:23]
    v_cvt_pk_bf16_f32 v56, v80, v84
    v_cvt_pk_bf16_f32 v57, v81, v85
    v_cvt_pk_bf16_f32 v58, v82, v86
    v_cvt_pk_bf16_f32 v59, v83, v87
    s_mov_b32 s44, 131200
    buffer_store_dwordx4 v[56:59], v122, s[16:19], s44 offen sc1
    s_waitcnt lgkmcnt(0)
    v_mov_b32_dpp v112, v8 row_shl:1 row_mask:0xf bank_mask:0xf
    v_mov_b32_dpp v113, v9 row_shl:1 row_mask:0xf bank_mask:0xf
    v_mov_b32_dpp v114, v10 row_shl:1 row_mask:0xf bank_mask:0xf
    v_mov_b32_dpp v115, v11 row_shl:1 row_mask:0xf bank_mask:0xf
    v_mov_b32_dpp v116, v40 row_shl:1 row_mask:0xf bank_mask:0xf
    v_mov_b32_dpp v117, v41 row_shl:1 row_mask:0xf bank_mask:0xf
    v_mov_b32_dpp v118, v42 row_shl:1 row_mask:0xf bank_mask:0xf
    v_mov_b32_dpp v119, v43 row_shl:1 row_mask:0xf bank_mask:0xf
    v_pk_add_f32 v[88:89], v[88:89], v[112:113]
    v_pk_add_f32 v[90:91], v[90:91], v[114:115]
    v_pk_add_f32 v[92:93], v[92:93], v[116:117]
    v_pk_add_f32 v[94:95], v[94:95], v[118:119]
    v_pk_mul_f32 v[24:25], v[88:89], v[88:89]
    v_pk_mul_f32 v[26:27], v[90:91], v[90:91]
    v_pk_mul_f32 v[28:29], v[92:93], v[92:93]
    v_pk_mul_f32 v[30:31], v[94:95], v[94:95]
    v_pk_fma_f32 v[24:25], v[24:25], s[40:41], v[44:45]
    v_pk_fma_f32 v[26:27], v[26:27], s[40:41], v[44:45]
    v_pk_fma_f32 v[28:29], v[28:29], s[40:41], v[44:45]
    v_pk_fma_f32 v[30:31], v[30:31], s[40:41], v[44:45]
    v_pk_mul_f32 v[24:25], v[24:25], v[88:89]
    v_pk_mul_f32 v[26:27], v[26:27], v[90:91]
    v_pk_mul_f32 v[28:29], v[28:29], v[92:93]
    v_pk_mul_f32 v[30:31], v[30:31], v[94:95]
    v_exp_f32 v24, v24
    v_exp_f32 v25, v25
    v_exp_f32 v26, v26
    v_exp_f32 v27, v27
    v_exp_f32 v28, v28
    v_exp_f32 v29, v29
    v_exp_f32 v30, v30
    v_exp_f32 v31, v31
    v_pk_add_f32 v[24:25], v[24:25], s[42:43]
    v_pk_add_f32 v[26:27], v[26:27], s[42:43]
    v_pk_add_f32 v[28:29], v[28:29], s[42:43]
    v_pk_add_f32 v[30:31], v[30:31], s[42:43]
    v_rcp_f32 v24, v24
    v_rcp_f32 v25, v25
    v_rcp_f32 v26, v26
    v_rcp_f32 v27, v27
    v_rcp_f32 v28, v28
    v_rcp_f32 v29, v29
    v_rcp_f32 v30, v30
    v_rcp_f32 v31, v31
    v_pk_mul_f32 v[88:89], v[88:89], v[24:25]
    v_pk_mul_f32 v[90:91], v[90:91], v[26:27]
    v_pk_mul_f32 v[92:93], v[92:93], v[28:29]
    v_pk_mul_f32 v[94:95], v[94:95], v[30:31]
    v_cvt_pk_bf16_f32 v60, v88, v92
    v_cvt_pk_bf16_f32 v61, v89, v93
    v_cvt_pk_bf16_f32 v62, v90, v94
    v_cvt_pk_bf16_f32 v63, v91, v95
    s_mov_b32 s44, 262272
    buffer_store_dwordx4 v[60:63], v122, s[16:19], s44 offen sc1
L_conv1_kernel_end:
L_conv1_kernel_done:
    s_endpgm
.globl conv2_kernel
.p2align 8
.type conv2_kernel,@function
conv2_kernel:
    s_cmp_ge_u32 s2, 256
    s_cbranch_scc1 L_conv2_kernel_done
    s_load_dwordx2 s[4:5], s[0:1], 72
    s_load_dwordx2 s[30:31], s[0:1], 72
    v_readfirstlane_b32 s20, v0
    s_lshr_b32 s20, s20, 6
    s_xor_b32 s20, s20, 8
    s_and_b32 s36, s2, 0
    s_lshl_b32 s36, s36, 3
    s_bfe_u32 s37, s2, 196611
    s_or_b32 s29, s36, s37
    s_bfe_u32 s36, s2, 196608
    s_lshl_b32 s36, s36, 2
    s_lshr_b32 s37, s2, 6
    s_or_b32 s36, s36, s37
    s_lshr_b32 s33, s36, 4
    s_and_b32 s34, s36, 7
    s_bfe_u32 s35, s36, 0x10003
    s_mul_i32 s21, s34, 500
    s_and_b32 s32, s20, 3
    v_and_b32 v127, 63, v0
    v_lshrrev_b32 v5, 2, v127
    v_and_b32 v6, 3, v127
    s_and_b32 s42, s20, 7
    s_lshr_b32 s41, s21, 2
    s_sub_u32 s41, s41, 1
    s_add_u32 s37, s41, s42
    v_lshl_add_u32 v7, v5, 3, s37
    s_mul_i32 s36, s35, 4194304
    s_add_u32 s36, s36, 18874368
    s_mov_b32 s10, 4194304
    s_mov_b32 s11, 0x00020000
    s_mov_b32 s25, 0xffff0000
    s_mov_b32 s47, s36
    s_cmp_ge_u32 s20, 8
    s_cbranch_scc1 L_conv2_kernel_helper
    s_add_u32 s37, s41, 128
    v_mov_b32 v16, s37
    v_mul_u32_u24 v17, 524288, v5
    v_lshl_add_u32 v17, v6, 4, v17
    s_add_u32 s37, s33, 4294967289
    v_lshl_add_u32 v18, v16, 3, s37
    v_cmp_gt_u32 vcc, 8000, v18
    s_mul_i32 s37, s33, 131072
    s_add_u32 s37, s37, 0
    v_lshl_add_u32 v108, v16, 7, s37
    v_add_u32 v108, v108, v17
    v_mov_b32 v18, 2130706432
    v_cndmask_b32 v108, v18, v108, vcc
    s_add_u32 s37, s33, 4294967291
    v_lshl_add_u32 v18, v16, 3, s37
    v_cmp_gt_u32 vcc, 8000, v18
    s_mul_i32 s37, s33, 131072
    s_add_u32 s37, s37, 262144
    v_lshl_add_u32 v109, v16, 7, s37
    v_add_u32 v109, v109, v17
    v_mov_b32 v18, 2130706432
    v_cndmask_b32 v109, v18, v109, vcc
    s_add_u32 s37, s33, 4294967293
    v_lshl_add_u32 v18, v16, 3, s37
    v_cmp_gt_u32 vcc, 8000, v18
    s_mul_i32 s37, s33, 131072
    s_add_u32 s37, s37, 64
    v_lshl_add_u32 v110, v16, 7, s37
    v_add_u32 v110, v110, v17
    v_mov_b32 v18, 2130706432
    v_cndmask_b32 v110, v18, v110, vcc
    s_waitcnt lgkmcnt(0)
    s_add_u32 s8, s4, s47
    s_addc_u32 s9, s5, 0
    s_lshl_b32 s36, s29, 4
    s_lshl_b32 s37, s33, 3
    s_add_u32 s36, s36, s37
    s_mul_i32 s36, s36, 57344
    s_add_u32 s36, s36, 9437184
    s_add_u32 s12, s30, s36
    s_addc_u32 s13, s31, 0
    s_mov_b32 s14, 458752
    s_mov_b32 s15, 0x00020000
    s_mul_i32 s36, s35, 2097152
    s_add_u32 s36, s36, 27262976
    s_mul_i32 s37, s33, 8388608
    s_add_u32 s36, s36, s37
    s_add_u32 s16, s30, s36
    s_addc_u32 s17, s31, 0
    s_mov_b32 s18, 2097152
    s_mov_b32 s19, 0x00020000
    v_and_b32 v10, 15, v127
    v_lshrrev_b32 v11, 4, v127
    v_add_u32 v8, 0, v10
    v_and_b32 v16, 4, v8
    v_lshrrev_b32 v16, 1, v16
    v_xor_b32 v16, v11, v16
    v_lshlrev_b32 v16, 4, v16
    v_lshl_add_u32 v8, v8, 6, v16
    v_add_u32 v9, 1, v10
    v_and_b32 v16, 4, v9
    v_lshrrev_b32 v16, 1, v16
    v_xor_b32 v16, v11, v16
    v_lshlrev_b32 v16, 4, v16
    v_lshl_add_u32 v9, v9, 6, v16
    s_lshr_b32 s38, s32, 1
    s_and_b32 s39, s32, 1
    s_add_u32 s40, s38, 4
    s_lshl_b32 s43, s39, 10
    s_cmp_lt_u32 s20, 4
    s_cselect_b32 s40, s20, s40
    s_cselect_b32 s36, 0, s43
    s_lshl_b32 s37, s40, 13
    s_add_u32 s37, s37, s36
    v_lshl_add_u32 v125, v127, 4, s37
    s_mul_i32 s37, s40, 16384
    v_add_u32 v120, s37, v8
    v_add_u32 v121, s37, v9
    s_lshl_b32 s37, s40, 10
    s_add_u32 s37, s37, 115712
    v_lshl_add_u32 v16, v11, 4, s37
    v_cmp_eq_u32 vcc, 15, v10
    v_mov_b32 v17, 8192
    v_mov_b32 v18, 4294959104
    v_mov_b32 v19, 64
    v_cndmask_b32 v122, v121, v16, vcc
    v_cndmask_b32 v123, v17, v19, vcc
    v_cndmask_b32 v124, v18, v19, vcc
    v_lshl_add_u32 v126, v127, 4, s37
    s_mov_b32 s44, 0x3f800000
    s_mov_b32 s45, 0x00000000
    s_mov_b32 s46, 0x00000000
    s_cmp_eq_u32 s40, 1
    s_cselect_b32 s45, 0x3f800000, s45
    s_cselect_b32 s46, 0x3f800000, s46
    s_cmp_eq_u32 s40, 2
    s_cselect_b32 s45, 0xbf800000, s45
    s_cselect_b32 s46, 0x3f800000, s46
    s_cmp_eq_u32 s40, 3
    s_cselect_b32 s45, 0x40000000, s45
    s_cselect_b32 s46, 0x40800000, s46
    s_cmp_eq_u32 s40, 4
    s_cselect_b32 s45, 0xc0000000, s45
    s_cselect_b32 s46, 0x40800000, s46
    s_cmp_eq_u32 s40, 5
    s_cselect_b32 s44, 0x41800000, s44
    s_cselect_b32 s45, 0x41000000, s45
    s_cselect_b32 s46, 0x40800000, s46
    s_cmp_ge_u32 s20, 4
    s_cbranch_scc1 L_conv2_kernel_m2
    v_mov_b32 v0, 0
    v_mov_b32 v1, 0
    v_mov_b32 v2, 0
    v_mov_b32 v3, 0
    v_mov_b32 v4, 0
    v_mov_b32 v5, 0
    v_mov_b32 v6, 0
    v_mov_b32 v7, 0
    v_mov_b32 v8, 0
    v_mov_b32 v9, 0
    v_mov_b32 v10, 0
    v_mov_b32 v11, 0
    v_mov_b32 v12, 0
    v_mov_b32 v13, 0
    v_mov_b32 v14, 0
    v_mov_b32 v15, 0
    v_mov_b32 v16, 0
    v_mov_b32 v17, 0
    v_mov_b32 v18, 0
    v_mov_b32 v19, 0
    v_mov_b32 v20, 0
    v_mov_b32 v21, 0
    v_mov_b32 v22, 0
    v_mov_b32 v23, 0
    v_mov_b32 v24, 0
    v_mov_b32 v25, 0
    v_mov_b32 v26, 0
    v_mov_b32 v27, 0
    v_mov_b32 v28, 0
    v_mov_b32 v29, 0
    v_mov_b32 v30, 0
    v_mov_b32 v31, 0
    v_mov_b32 v32, 0
    v_mov_b32 v33, 0
    v_mov_b32 v34, 0
    v_mov_b32 v35, 0
    v_mov_b32 v36, 0
    v_mov_b32 v37, 0
    v_mov_b32 v38, 0
    v_mov_b32 v39, 0
    v_mov_b32 v40, 0
    v_mov_b32 v41, 0
    v_mov_b32 v42, 0
    v_mov_b32 v43, 0
    v_mov_b32 v44, 0
    v_mov_b32 v45, 0
    v_mov_b32 v46, 0
    v_mov_b32 v47, 0
    v_mov_b32 v48, 0
    v_mov_b32 v49, 0
    v_mov_b32 v50, 0
    v_mov_b32 v51, 0
    v_mov_b32 v52, 0
    v_mov_b32 v53, 0
    v_mov_b32 v54, 0
    v_mov_b32 v55, 0
    v_mov_b32 v56, 0
    v_mov_b32 v57, 0
    v_mov_b32 v58, 0
    v_mov_b32 v59, 0
    v_mov_b32 v60, 0
    v_mov_b32 v61, 0
    v_mov_b32 v62, 0
    v_mov_b32 v63, 0
    buffer_load_dwordx4 v[96:99], v108, s[8:11], 0 offen
    buffer_load_dwordx4 v[100:103], v109, s[8:11], 0 offen
    buffer_load_dwordx4 v[104:107], v110, s[8:11], 0 offen
    s_mov_b32 s23, 0
    s_mov_b32 s26, 4096
    buffer_load_dwordx4 v[64:67], v125, s[12:15], s23 offen offset:0
    buffer_load_dwordx4 v[68:71], v125, s[12:15], s23 offen offset:1024
    buffer_load_dwordx4 v[72:75], v125, s[12:15], s23 offen offset:2048
    buffer_load_dwordx4 v[76:79], v125, s[12:15], s23 offen offset:3072
    buffer_load_dwordx4 v[80:83], v125, s[12:15], s26 offen offset:0
    buffer_load_dwordx4 v[84:87], v125, s[12:15], s26 offen offset:1024
    buffer_load_dwordx4 v[88:91], v125, s[12:15], s26 offen offset:2048
    buffer_load_dwordx4 v[92:95], v125, s[12:15], s26 offen offset:3072
    s_mov_b32 s23, 57344
    s_mov_b32 s26, 61440
    s_waitcnt vmcnt(8)
    v_lshlrev_b32 v108, 16, v96
    v_and_b32 v111, s25, v96
    v_lshlrev_b32 v109, 16, v100
    v_and_b32 v112, s25, v100
    v_lshlrev_b32 v110, 16, v104
    v_and_b32 v113, s25, v104
    v_mul_f32 v114, s44, v108
    v_mul_f32 v115, s44, v111
    v_fmac_f32 v114, s45, v109
    v_fmac_f32 v115, s45, v112
    v_fmac_f32 v114, s46, v110
    v_fmac_f32 v115, s46, v113
    v_cvt_pk_bf16_f32 v96, v114, v115
    v_lshlrev_b32 v108, 16, v97
    v_and_b32 v111, s25, v97
    v_lshlrev_b32 v109, 16, v101
    v_and_b32 v112, s25, v101
    v_lshlrev_b32 v110, 16, v105
    v_and_b32 v113, s25, v105
    v_mul_f32 v114, s44, v108
    v_mul_f32 v115, s44, v111
    v_fmac_f32 v114, s45, v109
    v_fmac_f32 v115, s45, v112
    v_fmac_f32 v114, s46, v110
    v_fmac_f32 v115, s46, v113
    v_cvt_pk_bf16_f32 v97, v114, v115
    v_lshlrev_b32 v108, 16, v98
    v_and_b32 v111, s25, v98
    v_lshlrev_b32 v109, 16, v102
    v_and_b32 v112, s25, v102
    v_lshlrev_b32 v110, 16, v106
    v_and_b32 v113, s25, v106
    v_mul_f32 v114, s44, v108
    v_mul_f32 v115, s44, v111
    v_fmac_f32 v114, s45, v109
    v_fmac_f32 v115, s45, v112
    v_fmac_f32 v114, s46, v110
    v_fmac_f32 v115, s46, v113
    v_cvt_pk_bf16_f32 v98, v114, v115
    v_lshlrev_b32 v108, 16, v99
    v_and_b32 v111, s25, v99
    v_lshlrev_b32 v109, 16, v103
    v_and_b32 v112, s25, v103
    v_lshlrev_b32 v110, 16, v107
    v_and_b32 v113, s25, v107
    v_mul_f32 v114, s44, v108
    v_mul_f32 v115, s44, v111
    v_fmac_f32 v114, s45, v109
    v_fmac_f32 v115, s45, v112
    v_fmac_f32 v114, s46, v110
    v_fmac_f32 v115, s46, v113
    v_cvt_pk_bf16_f32 v99, v114, v115
    ds_write_b128 v126, v[96:99]
    s_waitcnt lgkmcnt(0)
    s_barrier
    s_mov_b32 s22, 4
    s_setprio 2
L_conv2_kernel_mloop1:
    ds_read_b128 v[96:99], v120 offset:0
    ds_read_b128 v[100:103], v120 offset:1024
    ds_read_b128 v[104:107], v120 offset:2048
    ds_read_b128 v[108:111], v120 offset:3072
    ds_read_b128 v[112:115], v120 offset:4096
    ds_read_b128 v[116:119], v120 offset:5120
    s_waitcnt vmcnt(6) lgkmcnt(5)
    v_mfma_f32_16x16x32_bf16 v[0:3], v[64:67], v[96:99], v[0:3]
    v_mfma_f32_16x16x32_bf16 v[32:35], v[68:71], v[96:99], v[32:35]
    ds_read_b128 v[96:99], v120 offset:6144
    s_waitcnt vmcnt(4) lgkmcnt(5)
    v_mfma_f32_16x16x32_bf16 v[4:7], v[64:67], v[100:103], v[4:7]
    v_mfma_f32_16x16x32_bf16 v[36:39], v[68:71], v[100:103], v[36:39]
    v_mfma_f32_16x16x32_bf16 v[0:3], v[72:75], v[100:103], v[0:3]
    v_mfma_f32_16x16x32_bf16 v[32:35], v[76:79], v[100:103], v[32:35]
    ds_read_b128 v[100:103], v120 offset:7168
    s_waitcnt vmcnt(2) lgkmcnt(5)
    v_mfma_f32_16x16x32_bf16 v[8:11], v[64:67], v[104:107], v[8:11]
    v_mfma_f32_16x16x32_bf16 v[40:43], v[68:71], v[104:107], v[40:43]
    v_mfma_f32_16x16x32_bf16 v[4:7], v[72:75], v[104:107], v[4:7]
    v_mfma_f32_16x16x32_bf16 v[36:39], v[76:79], v[104:107], v[36:39]
    v_mfma_f32_16x16x32_bf16 v[0:3], v[80:83], v[104:107], v[0:3]
    v_mfma_f32_16x16x32_bf16 v[32:35], v[84:87], v[104:107], v[32:35]
    ds_read_b128 v[104:107], v122 offset:0
    v_add_u32 v122, v123, v122
    s_waitcnt vmcnt(0) lgkmcnt(5)
    v_mfma_f32_16x16x32_bf16 v[12:15], v[64:67], v[108:111], v[12:15]
    v_mfma_f32_16x16x32_bf16 v[44:47], v[68:71], v[108:111], v[44:47]
    v_mfma_f32_16x16x32_bf16 v[8:11], v[72:75], v[108:111], v[8:11]
    v_mfma_f32_16x16x32_bf16 v[40:43], v[76:79], v[108:111], v[40:43]
    v_mfma_f32_16x16x32_bf16 v[4:7], v[80:83], v[108:111], v[4:7]
    v_mfma_f32_16x16x32_bf16 v[36:39], v[84:87], v[108:111], v[36:39]
    v_mfma_f32_16x16x32_bf16 v[0:3], v[88:91], v[108:111], v[0:3]
    v_mfma_f32_16x16x32_bf16 v[32:35], v[92:95], v[108:111], v[32:35]
    ds_read_b128 v[108:111], v121 offset:1024
    s_waitcnt lgkmcnt(5)
    v_mfma_f32_16x16x32_bf16 v[16:19], v[64:67], v[112:115], v[16:19]
    v_mfma_f32_16x16x32_bf16 v[48:51], v[68:71], v[112:115], v[48:51]
    v_mfma_f32_16x16x32_bf16 v[12:15], v[72:75], v[112:115], v[12:15]
    v_mfma_f32_16x16x32_bf16 v[44:47], v[76:79], v[112:115], v[44:47]
    v_mfma_f32_16x16x32_bf16 v[8:11], v[80:83], v[112:115], v[8:11]
    v_mfma_f32_16x16x32_bf16 v[40:43], v[84:87], v[112:115], v[40:43]
    v_mfma_f32_16x16x32_bf16 v[4:7], v[88:91], v[112:115], v[4:7]
    v_mfma_f32_16x16x32_bf16 v[36:39], v[92:95], v[112:115], v[36:39]
    ds_read_b128 v[112:115], v121 offset:2048
    s_waitcnt lgkmcnt(5)
    v_mfma_f32_16x16x32_bf16 v[20:23], v[64:67], v[116:119], v[20:23]
    v_mfma_f32_16x16x32_bf16 v[52:55], v[68:71], v[116:119], v[52:55]
    v_mfma_f32_16x16x32_bf16 v[16:19], v[72:75], v[116:119], v[16:19]
    v_mfma_f32_16x16x32_bf16 v[48:51], v[76:79], v[116:119], v[48:51]
    v_mfma_f32_16x16x32_bf16 v[12:15], v[80:83], v[116:119], v[12:15]
    v_mfma_f32_16x16x32_bf16 v[44:47], v[84:87], v[116:119], v[44:47]
    v_mfma_f32_16x16x32_bf16 v[8:11], v[88:91], v[116:119], v[8:11]
    v_mfma_f32_16x16x32_bf16 v[40:43], v[92:95], v[116:119], v[40:43]
    s_waitcnt lgkmcnt(4)
    v_mfma_f32_16x16x32_bf16 v[24:27], v[64:67], v[96:99], v[24:27]
    v_mfma_f32_16x16x32_bf16 v[56:59], v[68:71], v[96:99], v[56:59]
    v_mfma_f32_16x16x32_bf16 v[20:23], v[72:75], v[96:99], v[20:23]
    v_mfma_f32_16x16x32_bf16 v[52:55], v[76:79], v[96:99], v[52:55]
    v_mfma_f32_16x16x32_bf16 v[16:19], v[80:83], v[96:99], v[16:19]
    v_mfma_f32_16x16x32_bf16 v[48:51], v[84:87], v[96:99], v[48:51]
    v_mfma_f32_16x16x32_bf16 v[12:15], v[88:91], v[96:99], v[12:15]
    v_mfma_f32_16x16x32_bf16 v[44:47], v[92:95], v[96:99], v[44:47]
    s_waitcnt lgkmcnt(3)
    v_mfma_f32_16x16x32_bf16 v[28:31], v[64:67], v[100:103], v[28:31]
    v_mfma_f32_16x16x32_bf16 v[60:63], v[68:71], v[100:103], v[60:63]
    v_mfma_f32_16x16x32_bf16 v[24:27], v[72:75], v[100:103], v[24:27]
    v_mfma_f32_16x16x32_bf16 v[56:59], v[76:79], v[100:103], v[56:59]
    v_mfma_f32_16x16x32_bf16 v[20:23], v[80:83], v[100:103], v[20:23]
    v_mfma_f32_16x16x32_bf16 v[52:55], v[84:87], v[100:103], v[52:55]
    v_mfma_f32_16x16x32_bf16 v[16:19], v[88:91], v[100:103], v[16:19]
    v_mfma_f32_16x16x32_bf16 v[48:51], v[92:95], v[100:103], v[48:51]
    buffer_load_dwordx4 v[64:67], v125, s[12:15], s23 offen offset:0
    buffer_load_dwordx4 v[68:71], v125, s[12:15], s23 offen offset:1024
    s_waitcnt lgkmcnt(2)
    v_mfma_f32_16x16x32_bf16 v[28:31], v[72:75], v[104:107], v[28:31]
    v_mfma_f32_16x16x32_bf16 v[60:63], v[76:79], v[104:107], v[60:63]
    v_mfma_f32_16x16x32_bf16 v[24:27], v[80:83], v[104:107], v[24:27]
    v_mfma_f32_16x16x32_bf16 v[56:59], v[84:87], v[104:107], v[56:59]
    v_mfma_f32_16x16x32_bf16 v[20:23], v[88:91], v[104:107], v[20:23]
    v_mfma_f32_16x16x32_bf16 v[52:55], v[92:95], v[104:107], v[52:55]
    buffer_load_dwordx4 v[72:75], v125, s[12:15], s23 offen offset:2048
    buffer_load_dwordx4 v[76:79], v125, s[12:15], s23 offen offset:3072
    s_waitcnt lgkmcnt(1)
    v_mfma_f32_16x16x32_bf16 v[28:31], v[80:83], v[108:111], v[28:31]
    v_mfma_f32_16x16x32_bf16 v[60:63], v[84:87], v[108:111], v[60:63]
    v_mfma_f32_16x16x32_bf16 v[24:27], v[88:91], v[108:111], v[24:27]
    v_mfma_f32_16x16x32_bf16 v[56:59], v[92:95], v[108:111], v[56:59]
    buffer_load_dwordx4 v[80:83], v125, s[12:15], s26 offen offset:0
    buffer_load_dwordx4 v[84:87], v125, s[12:15], s26 offen offset:1024
    s_waitcnt lgkmcnt(0)
    v_mfma_f32_16x16x32_bf16 v[28:31], v[88:91], v[112:115], v[28:31]
    v_mfma_f32_16x16x32_bf16 v[60:63], v[92:95], v[112:115], v[60:63]
    buffer_load_dwordx4 v[88:91], v125, s[12:15], s26 offen offset:2048
    buffer_load_dwordx4 v[92:95], v125, s[12:15], s26 offen offset:3072
    s_add_u32 s23, s23, 57344
    s_add_u32 s26, s26, 57344
    s_barrier
    s_sub_u32 s22, s22, 1
    s_cmp_eq_u32 s22, 0
    s_cbranch_scc1 L_conv2_kernel_mlast1
    ds_read_b128 v[96:99], v120 offset:8192
    ds_read_b128 v[100:103], v120 offset:9216
    ds_read_b128 v[104:107], v120 offset:10240
    ds_read_b128 v[108:111], v120 offset:11264
    ds_read_b128 v[112:115], v120 offset:12288
    ds_read_b128 v[116:119], v120 offset:13312
    s_waitcnt vmcnt(6) lgkmcnt(5)
    v_mfma_f32_16x16x32_bf16 v[0:3], v[64:67], v[96:99], v[0:3]
    v_mfma_f32_16x16x32_bf16 v[32:35], v[68:71], v[96:99], v[32:35]
    ds_read_b128 v[96:99], v120 offset:14336
    s_waitcnt vmcnt(4) lgkmcnt(5)
    v_mfma_f32_16x16x32_bf16 v[4:7], v[64:67], v[100:103], v[4:7]
    v_mfma_f32_16x16x32_bf16 v[36:39], v[68:71], v[100:103], v[36:39]
    v_mfma_f32_16x16x32_bf16 v[0:3], v[72:75], v[100:103], v[0:3]
    v_mfma_f32_16x16x32_bf16 v[32:35], v[76:79], v[100:103], v[32:35]
    ds_read_b128 v[100:103], v120 offset:15360
    s_waitcnt vmcnt(2) lgkmcnt(5)
    v_mfma_f32_16x16x32_bf16 v[8:11], v[64:67], v[104:107], v[8:11]
    v_mfma_f32_16x16x32_bf16 v[40:43], v[68:71], v[104:107], v[40:43]
    v_mfma_f32_16x16x32_bf16 v[4:7], v[72:75], v[104:107], v[4:7]
    v_mfma_f32_16x16x32_bf16 v[36:39], v[76:79], v[104:107], v[36:39]
    v_mfma_f32_16x16x32_bf16 v[0:3], v[80:83], v[104:107], v[0:3]
    v_mfma_f32_16x16x32_bf16 v[32:35], v[84:87], v[104:107], v[32:35]
    ds_read_b128 v[104:107], v122 offset:0
    v_add_u32 v122, v124, v122
    s_waitcnt vmcnt(0) lgkmcnt(5)
    v_mfma_f32_16x16x32_bf16 v[12:15], v[64:67], v[108:111], v[12:15]
    v_mfma_f32_16x16x32_bf16 v[44:47], v[68:71], v[108:111], v[44:47]
    v_mfma_f32_16x16x32_bf16 v[8:11], v[72:75], v[108:111], v[8:11]
    v_mfma_f32_16x16x32_bf16 v[40:43], v[76:79], v[108:111], v[40:43]
    v_mfma_f32_16x16x32_bf16 v[4:7], v[80:83], v[108:111], v[4:7]
    v_mfma_f32_16x16x32_bf16 v[36:39], v[84:87], v[108:111], v[36:39]
    v_mfma_f32_16x16x32_bf16 v[0:3], v[88:91], v[108:111], v[0:3]
    v_mfma_f32_16x16x32_bf16 v[32:35], v[92:95], v[108:111], v[32:35]
    ds_read_b128 v[108:111], v121 offset:9216
    s_waitcnt lgkmcnt(5)
    v_mfma_f32_16x16x32_bf16 v[16:19], v[64:67], v[112:115], v[16:19]
    v_mfma_f32_16x16x32_bf16 v[48:51], v[68:71], v[112:115], v[48:51]
    v_mfma_f32_16x16x32_bf16 v[12:15], v[72:75], v[112:115], v[12:15]
    v_mfma_f32_16x16x32_bf16 v[44:47], v[76:79], v[112:115], v[44:47]
    v_mfma_f32_16x16x32_bf16 v[8:11], v[80:83], v[112:115], v[8:11]
    v_mfma_f32_16x16x32_bf16 v[40:43], v[84:87], v[112:115], v[40:43]
    v_mfma_f32_16x16x32_bf16 v[4:7], v[88:91], v[112:115], v[4:7]
    v_mfma_f32_16x16x32_bf16 v[36:39], v[92:95], v[112:115], v[36:39]
    ds_read_b128 v[112:115], v121 offset:10240
    s_waitcnt lgkmcnt(5)
    v_mfma_f32_16x16x32_bf16 v[20:23], v[64:67], v[116:119], v[20:23]
    v_mfma_f32_16x16x32_bf16 v[52:55], v[68:71], v[116:119], v[52:55]
    v_mfma_f32_16x16x32_bf16 v[16:19], v[72:75], v[116:119], v[16:19]
    v_mfma_f32_16x16x32_bf16 v[48:51], v[76:79], v[116:119], v[48:51]
    v_mfma_f32_16x16x32_bf16 v[12:15], v[80:83], v[116:119], v[12:15]
    v_mfma_f32_16x16x32_bf16 v[44:47], v[84:87], v[116:119], v[44:47]
    v_mfma_f32_16x16x32_bf16 v[8:11], v[88:91], v[116:119], v[8:11]
    v_mfma_f32_16x16x32_bf16 v[40:43], v[92:95], v[116:119], v[40:43]
    s_waitcnt lgkmcnt(4)
    v_mfma_f32_16x16x32_bf16 v[24:27], v[64:67], v[96:99], v[24:27]
    v_mfma_f32_16x16x32_bf16 v[56:59], v[68:71], v[96:99], v[56:59]
    v_mfma_f32_16x16x32_bf16 v[20:23], v[72:75], v[96:99], v[20:23]
    v_mfma_f32_16x16x32_bf16 v[52:55], v[76:79], v[96:99], v[52:55]
    v_mfma_f32_16x16x32_bf16 v[16:19], v[80:83], v[96:99], v[16:19]
    v_mfma_f32_16x16x32_bf16 v[48:51], v[84:87], v[96:99], v[48:51]
    v_mfma_f32_16x16x32_bf16 v[12:15], v[88:91], v[96:99], v[12:15]
    v_mfma_f32_16x16x32_bf16 v[44:47], v[92:95], v[96:99], v[44:47]
    s_waitcnt lgkmcnt(3)
    v_mfma_f32_16x16x32_bf16 v[28:31], v[64:67], v[100:103], v[28:31]
    v_mfma_f32_16x16x32_bf16 v[60:63], v[68:71], v[100:103], v[60:63]
    v_mfma_f32_16x16x32_bf16 v[24:27], v[72:75], v[100:103], v[24:27]
    v_mfma_f32_16x16x32_bf16 v[56:59], v[76:79], v[100:103], v[56:59]
    v_mfma_f32_16x16x32_bf16 v[20:23], v[80:83], v[100:103], v[20:23]
    v_mfma_f32_16x16x32_bf16 v[52:55], v[84:87], v[100:103], v[52:55]
    v_mfma_f32_16x16x32_bf16 v[16:19], v[88:91], v[100:103], v[16:19]
    v_mfma_f32_16x16x32_bf16 v[48:51], v[92:95], v[100:103], v[48:51]
    buffer_load_dwordx4 v[64:67], v125, s[12:15], s23 offen offset:0
    buffer_load_dwordx4 v[68:71], v125, s[12:15], s23 offen offset:1024
    s_waitcnt lgkmcnt(2)
    v_mfma_f32_16x16x32_bf16 v[28:31], v[72:75], v[104:107], v[28:31]
    v_mfma_f32_16x16x32_bf16 v[60:63], v[76:79], v[104:107], v[60:63]
    v_mfma_f32_16x16x32_bf16 v[24:27], v[80:83], v[104:107], v[24:27]
    v_mfma_f32_16x16x32_bf16 v[56:59], v[84:87], v[104:107], v[56:59]
    v_mfma_f32_16x16x32_bf16 v[20:23], v[88:91], v[104:107], v[20:23]
    v_mfma_f32_16x16x32_bf16 v[52:55], v[92:95], v[104:107], v[52:55]
    buffer_load_dwordx4 v[72:75], v125, s[12:15], s23 offen offset:2048
    buffer_load_dwordx4 v[76:79], v125, s[12:15], s23 offen offset:3072
    s_waitcnt lgkmcnt(1)
    v_mfma_f32_16x16x32_bf16 v[28:31], v[80:83], v[108:111], v[28:31]
    v_mfma_f32_16x16x32_bf16 v[60:63], v[84:87], v[108:111], v[60:63]
    v_mfma_f32_16x16x32_bf16 v[24:27], v[88:91], v[108:111], v[24:27]
    v_mfma_f32_16x16x32_bf16 v[56:59], v[92:95], v[108:111], v[56:59]
    buffer_load_dwordx4 v[80:83], v125, s[12:15], s26 offen offset:0
    buffer_load_dwordx4 v[84:87], v125, s[12:15], s26 offen offset:1024
    s_waitcnt lgkmcnt(0)
    v_mfma_f32_16x16x32_bf16 v[28:31], v[88:91], v[112:115], v[28:31]
    v_mfma_f32_16x16x32_bf16 v[60:63], v[92:95], v[112:115], v[60:63]
    buffer_load_dwordx4 v[88:91], v125, s[12:15], s26 offen offset:2048
    buffer_load_dwordx4 v[92:95], v125, s[12:15], s26 offen offset:3072
    s_add_u32 s23, s23, 57344
    s_add_u32 s26, s26, 57344
    s_barrier
    s_branch L_conv2_kernel_mloop1
L_conv2_kernel_mlast1:
    v_and_b32 v125, 15, v127
    v_and_b32 v126, 7, v127
    v_lshlrev_b32 v126, 4, v126
    v_lshl_add_u32 v125, v125, 7, v126
    v_lshrrev_b32 v126, 4, v127
    v_lshl_add_u32 v125, v126, 11, v125
    s_lshl_b32 s36, s20, 14
    s_add_u32 s37, s36, 8192
    v_add_u32 v126, s37, v125
    v_add_u32 v125, s36, v125
    ds_read_b128 v[96:99], v120 offset:8192
    ds_read_b128 v[100:103], v120 offset:9216
    ds_read_b128 v[104:107], v120 offset:10240
    ds_read_b128 v[108:111], v120 offset:11264
    ds_read_b128 v[112:115], v120 offset:12288
    ds_read_b128 v[116:119], v120 offset:13312
    s_waitcnt vmcnt(6) lgkmcnt(5)
    v_mfma_f32_16x16x32_bf16 v[0:3], v[64:67], v[96:99], v[0:3]
    v_mfma_f32_16x16x32_bf16 v[32:35], v[68:71], v[96:99], v[32:35]
    ds_read_b128 v[96:99], v120 offset:14336
    s_waitcnt vmcnt(4) lgkmcnt(5)
    v_mfma_f32_16x16x32_bf16 v[4:7], v[64:67], v[100:103], v[4:7]
    v_mfma_f32_16x16x32_bf16 v[36:39], v[68:71], v[100:103], v[36:39]
    v_mfma_f32_16x16x32_bf16 v[0:3], v[72:75], v[100:103], v[0:3]
    v_mfma_f32_16x16x32_bf16 v[32:35], v[76:79], v[100:103], v[32:35]
    ds_read_b128 v[100:103], v120 offset:15360
    s_waitcnt vmcnt(2) lgkmcnt(5)
    v_mfma_f32_16x16x32_bf16 v[8:11], v[64:67], v[104:107], v[8:11]
    v_mfma_f32_16x16x32_bf16 v[40:43], v[68:71], v[104:107], v[40:43]
    v_mfma_f32_16x16x32_bf16 v[4:7], v[72:75], v[104:107], v[4:7]
    v_mfma_f32_16x16x32_bf16 v[36:39], v[76:79], v[104:107], v[36:39]
    v_mfma_f32_16x16x32_bf16 v[0:3], v[80:83], v[104:107], v[0:3]
    v_mfma_f32_16x16x32_bf16 v[32:35], v[84:87], v[104:107], v[32:35]
    ds_read_b128 v[104:107], v122 offset:0
    s_waitcnt vmcnt(0) lgkmcnt(5)
    v_mfma_f32_16x16x32_bf16 v[12:15], v[64:67], v[108:111], v[12:15]
    v_mfma_f32_16x16x32_bf16 v[44:47], v[68:71], v[108:111], v[44:47]
    v_mfma_f32_16x16x32_bf16 v[8:11], v[72:75], v[108:111], v[8:11]
    v_mfma_f32_16x16x32_bf16 v[40:43], v[76:79], v[108:111], v[40:43]
    v_mfma_f32_16x16x32_bf16 v[4:7], v[80:83], v[108:111], v[4:7]
    v_mfma_f32_16x16x32_bf16 v[36:39], v[84:87], v[108:111], v[36:39]
    v_mfma_f32_16x16x32_bf16 v[0:3], v[88:91], v[108:111], v[0:3]
    v_mfma_f32_16x16x32_bf16 v[32:35], v[92:95], v[108:111], v[32:35]
    ds_read_b128 v[108:111], v121 offset:9216
    s_waitcnt lgkmcnt(5)
    v_mfma_f32_16x16x32_bf16 v[16:19], v[64:67], v[112:115], v[16:19]
    v_mfma_f32_16x16x32_bf16 v[48:51], v[68:71], v[112:115], v[48:51]
    v_mfma_f32_16x16x32_bf16 v[12:15], v[72:75], v[112:115], v[12:15]
    v_mfma_f32_16x16x32_bf16 v[44:47], v[76:79], v[112:115], v[44:47]
    v_mfma_f32_16x16x32_bf16 v[8:11], v[80:83], v[112:115], v[8:11]
    v_mfma_f32_16x16x32_bf16 v[40:43], v[84:87], v[112:115], v[40:43]
    v_mfma_f32_16x16x32_bf16 v[4:7], v[88:91], v[112:115], v[4:7]
    v_mfma_f32_16x16x32_bf16 v[36:39], v[92:95], v[112:115], v[36:39]
    ds_read_b128 v[112:115], v121 offset:10240
    v_xor_b32 v123, 0, v125
    ds_write_b128 v123, v[0:3]
    s_waitcnt lgkmcnt(6)
    v_mfma_f32_16x16x32_bf16 v[20:23], v[64:67], v[116:119], v[20:23]
    v_mfma_f32_16x16x32_bf16 v[52:55], v[68:71], v[116:119], v[52:55]
    v_mfma_f32_16x16x32_bf16 v[16:19], v[72:75], v[116:119], v[16:19]
    v_mfma_f32_16x16x32_bf16 v[48:51], v[76:79], v[116:119], v[48:51]
    v_mfma_f32_16x16x32_bf16 v[12:15], v[80:83], v[116:119], v[12:15]
    v_mfma_f32_16x16x32_bf16 v[44:47], v[84:87], v[116:119], v[44:47]
    v_mfma_f32_16x16x32_bf16 v[8:11], v[88:91], v[116:119], v[8:11]
    v_mfma_f32_16x16x32_bf16 v[40:43], v[92:95], v[116:119], v[40:43]
    v_xor_b32 v124, 16, v125
    ds_write_b128 v124, v[4:7]
    s_waitcnt lgkmcnt(2)
    v_mfma_f32_16x16x32_bf16 v[24:27], v[64:67], v[96:99], v[24:27]
    v_mfma_f32_16x16x32_bf16 v[56:59], v[68:71], v[96:99], v[56:59]
    v_mfma_f32_16x16x32_bf16 v[20:23], v[72:75], v[96:99], v[20:23]
    v_mfma_f32_16x16x32_bf16 v[52:55], v[76:79], v[96:99], v[52:55]
    v_mfma_f32_16x16x32_bf16 v[16:19], v[80:83], v[96:99], v[16:19]
    v_mfma_f32_16x16x32_bf16 v[48:51], v[84:87], v[96:99], v[48:51]
    v_mfma_f32_16x16x32_bf16 v[12:15], v[88:91], v[96:99], v[12:15]
    v_mfma_f32_16x16x32_bf16 v[44:47], v[92:95], v[96:99], v[44:47]
    v_xor_b32 v123, 32, v125
    ds_write_b128 v123, v[8:11]
    v_xor_b32 v124, 0, v126
    ds_write_b128 v124, v[32:35]
    v_mfma_f32_16x16x32_bf16 v[28:31], v[64:67], v[100:103], v[28:31]
    v_mfma_f32_16x16x32_bf16 v[60:63], v[68:71], v[100:103], v[60:63]
    v_mfma_f32_16x16x32_bf16 v[24:27], v[72:75], v[100:103], v[24:27]
    v_mfma_f32_16x16x32_bf16 v[56:59], v[76:79], v[100:103], v[56:59]
    v_mfma_f32_16x16x32_bf16 v[20:23], v[80:83], v[100:103], v[20:23]
    v_mfma_f32_16x16x32_bf16 v[52:55], v[84:87], v[100:103], v[52:55]
    v_mfma_f32_16x16x32_bf16 v[16:19], v[88:91], v[100:103], v[16:19]
    v_mfma_f32_16x16x32_bf16 v[48:51], v[92:95], v[100:103], v[48:51]
    v_xor_b32 v123, 16, v126
    ds_write_b128 v123, v[36:39]
    v_xor_b32 v124, 32, v126
    ds_write_b128 v124, v[40:43]
    v_mfma_f32_16x16x32_bf16 v[28:31], v[72:75], v[104:107], v[28:31]
    v_mfma_f32_16x16x32_bf16 v[60:63], v[76:79], v[104:107], v[60:63]
    v_mfma_f32_16x16x32_bf16 v[24:27], v[80:83], v[104:107], v[24:27]
    v_mfma_f32_16x16x32_bf16 v[56:59], v[84:87], v[104:107], v[56:59]
    v_mfma_f32_16x16x32_bf16 v[20:23], v[88:91], v[104:107], v[20:23]
    v_mfma_f32_16x16x32_bf16 v[52:55], v[92:95], v[104:107], v[52:55]
    v_xor_b32 v124, 48, v125
    ds_write_b128 v124, v[12:15]
    v_xor_b32 v123, 48, v126
    ds_write_b128 v123, v[44:47]
    v_mfma_f32_16x16x32_bf16 v[28:31], v[80:83], v[108:111], v[28:31]
    v_mfma_f32_16x16x32_bf16 v[60:63], v[84:87], v[108:111], v[60:63]
    v_mfma_f32_16x16x32_bf16 v[24:27], v[88:91], v[108:111], v[24:27]
    v_mfma_f32_16x16x32_bf16 v[56:59], v[92:95], v[108:111], v[56:59]
    v_xor_b32 v123, 64, v125
    ds_write_b128 v123, v[16:19]
    v_xor_b32 v124, 64, v126
    ds_write_b128 v124, v[48:51]
    v_mfma_f32_16x16x32_bf16 v[28:31], v[88:91], v[112:115], v[28:31]
    v_mfma_f32_16x16x32_bf16 v[60:63], v[92:95], v[112:115], v[60:63]
    v_xor_b32 v124, 80, v125
    ds_write_b128 v124, v[20:23]
    v_xor_b32 v123, 80, v126
    ds_write_b128 v123, v[52:55]
    v_and_b32 v108, 15, v127
    v_lshrrev_b32 v109, 4, v127
    v_lshrrev_b32 v110, 3, v108
    s_lshl_b32 s36, s20, 1
    v_add_u32 v110, s36, v110
    v_xor_b32 v111, v110, v108
    v_and_b32 v111, 7, v111
    v_lshlrev_b32 v111, 4, v111
    v_xor_b32 v123, 96, v125
    ds_write_b128 v123, v[24:27]
    v_lshl_add_u32 v111, v110, 7, v111
    v_lshl_add_u32 v120, v109, 11, v111
    v_add_u32 v121, 65536, v120
    v_add_u32 v64, 131072, v120
    s_lshl_b32 s36, s20, 9
    s_add_u32 s36, s36, 115712
    v_lshl_add_u32 v127, v109, 7, s36
    s_lshl_b32 s36, s20, 4
    v_add_u32 v108, s36, v108
    v_lshlrev_b32 v110, 6, v108
    v_lshl_add_u32 v110, v109, 4, v110
    s_mul_i32 s36, s29, 262144
    v_xor_b32 v124, 96, v126
    ds_write_b128 v124, v[56:59]
    s_lshl_b32 s37, s21, 4
    s_add_u32 s36, s36, s37
    v_add_u32 v110, s36, v110
    v_mov_b32 v111, 2130706432
    v_cmp_gt_u32 vcc, 125, v108
    s_mov_b32 s4, 0xbeaaaaab
    s_mov_b32 s5, s4
    s_mov_b32 s6, 0x3e800000
    s_mov_b32 s7, s6
    s_mov_b32 s8, 0xc0a00000
    s_mov_b32 s9, s8
    s_mov_b32 s10, 0xc0638e39
    v_xor_b32 v124, 112, v125
    ds_write_b128 v124, v[28:31]
    s_mov_b32 s11, s10
    s_mov_b32 s12, 0xbf638e39
    s_mov_b32 s13, s12
    s_mov_b32 s14, 0xbe638e39
    s_mov_b32 s15, s14
    s_mov_b32 s22, 0xbd638e39
    s_mov_b32 s23, s22
    s_mov_b32 s24, 0x3ff1c71c
    s_mov_b32 s25, s24
    s_mov_b32 s26, 0xbf2aaaab
    s_mov_b32 s27, s26
    s_mov_b32 s32, 0x3ecccccd
    v_xor_b32 v123, 112, v126
    s_waitcnt lgkmcnt(8)
    ds_write_b128 v123, v[60:63]
    s_mov_b32 s33, s32
    s_mov_b32 s34, 0xbd888889
    s_mov_b32 s35, s34
    s_mov_b32 s38, 0xbe4ccccd
    s_mov_b32 s39, s38
    s_mov_b32 s40, 0xbdd2d3e8
    s_mov_b32 s41, s40
    s_mov_b32 s42, 0x3f800000
    s_mov_b32 s43, s42
    s_setprio 0
    s_branch L_conv2_kernel_epi
L_conv2_kernel_m2:
    s_mul_i32 s37, s38, 2176
    s_add_u32 s37, s37, 98304
    v_add_u32 v116, s37, v8
    v_add_u32 v118, s37, v9
    v_add_u32 v117, 104832, v8
    s_cmp_eq_u32 s38, 0
    s_cbranch_scc1 L_conv2_kernel_hh0
    v_add_u32 v117, 98304, v9
L_conv2_kernel_hh0:
    s_lshl_b32 s37, s38, 12
    s_add_u32 s37, s37, s43
    s_add_u32 s37, s37, 49152
    v_lshl_add_u32 v119, v127, 4, s37
    v_mov_b32 v0, 0
    v_mov_b32 v1, 0
    v_mov_b32 v2, 0
    v_mov_b32 v3, 0
    v_mov_b32 v4, 0
    v_mov_b32 v5, 0
    v_mov_b32 v6, 0
    v_mov_b32 v7, 0
    v_mov_b32 v8, 0
    v_mov_b32 v9, 0
    v_mov_b32 v10, 0
    v_mov_b32 v11, 0
    v_mov_b32 v12, 0
    v_mov_b32 v13, 0
    v_mov_b32 v14, 0
    v_mov_b32 v15, 0
    v_mov_b32 v16, 0
    v_mov_b32 v17, 0
    v_mov_b32 v18, 0
    v_mov_b32 v19, 0
    v_mov_b32 v20, 0
    v_mov_b32 v21, 0
    v_mov_b32 v22, 0
    v_mov_b32 v23, 0
    v_mov_b32 v24, 0
    v_mov_b32 v25, 0
    v_mov_b32 v26, 0
    v_mov_b32 v27, 0
    v_mov_b32 v28, 0
    v_mov_b32 v29, 0
    v_mov_b32 v30, 0
    v_mov_b32 v31, 0
    v_mov_b32 v32, 0
    v_mov_b32 v33, 0
    v_mov_b32 v34, 0
    v_mov_b32 v35, 0
    v_mov_b32 v36, 0
    v_mov_b32 v37, 0
    v_mov_b32 v38, 0
    v_mov_b32 v39, 0
    v_mov_b32 v40, 0
    v_mov_b32 v41, 0
    v_mov_b32 v42, 0
    v_mov_b32 v43, 0
    v_mov_b32 v44, 0
    v_mov_b32 v45, 0
    v_mov_b32 v46, 0
    v_mov_b32 v47, 0
    v_mov_b32 v48, 0
    v_mov_b32 v49, 0
    v_mov_b32 v50, 0
    v_mov_b32 v51, 0
    v_mov_b32 v52, 0
    v_mov_b32 v53, 0
    v_mov_b32 v54, 0
    v_mov_b32 v55, 0
    v_mov_b32 v56, 0
    v_mov_b32 v57, 0
    v_mov_b32 v58, 0
    v_mov_b32 v59, 0
    v_mov_b32 v60, 0
    v_mov_b32 v61, 0
    v_mov_b32 v62, 0
    v_mov_b32 v63, 0
    buffer_load_dwordx4 v[96:99], v108, s[8:11], 0 offen
    buffer_load_dwordx4 v[100:103], v109, s[8:11], 0 offen
    buffer_load_dwordx4 v[104:107], v110, s[8:11], 0 offen
    s_mov_b32 s23, 0
    s_mov_b32 s26, 4096
    buffer_load_dwordx4 v[64:67], v125, s[12:15], s23 offen offset:0
    buffer_load_dwordx4 v[68:71], v125, s[12:15], s23 offen offset:2048
    buffer_load_dwordx4 v[80:83], v119, s[12:15], s23 offen offset:0
    buffer_load_dwordx4 v[72:75], v125, s[12:15], s26 offen offset:0
    buffer_load_dwordx4 v[84:87], v119, s[12:15], s23 offen offset:2048
    buffer_load_dwordx4 v[76:79], v125, s[12:15], s26 offen offset:2048
    s_mov_b32 s23, 57344
    s_mov_b32 s26, 61440
    s_waitcnt vmcnt(6)
    v_lshlrev_b32 v108, 16, v96
    v_and_b32 v111, s25, v96
    v_lshlrev_b32 v109, 16, v100
    v_and_b32 v112, s25, v100
    v_lshlrev_b32 v110, 16, v104
    v_and_b32 v113, s25, v104
    v_mul_f32 v114, s44, v108
    v_mul_f32 v115, s44, v111
    v_fmac_f32 v114, s45, v109
    v_fmac_f32 v115, s45, v112
    v_fmac_f32 v114, s46, v110
    v_fmac_f32 v115, s46, v113
    v_cvt_pk_bf16_f32 v96, v114, v115
    v_lshlrev_b32 v108, 16, v97
    v_and_b32 v111, s25, v97
    v_lshlrev_b32 v109, 16, v101
    v_and_b32 v112, s25, v101
    v_lshlrev_b32 v110, 16, v105
    v_and_b32 v113, s25, v105
    v_mul_f32 v114, s44, v108
    v_mul_f32 v115, s44, v111
    v_fmac_f32 v114, s45, v109
    v_fmac_f32 v115, s45, v112
    v_fmac_f32 v114, s46, v110
    v_fmac_f32 v115, s46, v113
    v_cvt_pk_bf16_f32 v97, v114, v115
    v_lshlrev_b32 v108, 16, v98
    v_and_b32 v111, s25, v98
    v_lshlrev_b32 v109, 16, v102
    v_and_b32 v112, s25, v102
    v_lshlrev_b32 v110, 16, v106
    v_and_b32 v113, s25, v106
    v_mul_f32 v114, s44, v108
    v_mul_f32 v115, s44, v111
    v_fmac_f32 v114, s45, v109
    v_fmac_f32 v115, s45, v112
    v_fmac_f32 v114, s46, v110
    v_fmac_f32 v115, s46, v113
    v_cvt_pk_bf16_f32 v98, v114, v115
    v_lshlrev_b32 v108, 16, v99
    v_and_b32 v111, s25, v99
    v_lshlrev_b32 v109, 16, v103
    v_and_b32 v112, s25, v103
    v_lshlrev_b32 v110, 16, v107
    v_and_b32 v113, s25, v107
    v_mul_f32 v114, s44, v108
    v_mul_f32 v115, s44, v111
    v_fmac_f32 v114, s45, v109
    v_fmac_f32 v115, s45, v112
    v_fmac_f32 v114, s46, v110
    v_fmac_f32 v115, s46, v113
    v_cvt_pk_bf16_f32 v99, v114, v115
    ds_write_b128 v126, v[96:99]
    v_and_b32 v111, 15, v127
    v_lshlrev_b32 v111, 2, v111
    v_add_u32 v111, 99328, v111
    ds_write_b32 v111, v0
    ds_write_b32 v111, v0 offset:8704
    s_waitcnt lgkmcnt(0)
    s_barrier
    s_mov_b32 s22, 4
    s_setprio 2
L_conv2_kernel_mloop2:
    ds_read_b128 v[88:91], v120 offset:0
    ds_read_b128 v[92:95], v120 offset:1024
    ds_read_b128 v[96:99], v116 offset:0
    ds_read_b128 v[100:103], v120 offset:2048
    ds_read_b128 v[104:107], v116 offset:1088
    ds_read_b128 v[108:111], v120 offset:3072
    ds_read_b128 v[112:115], v116 offset:2176
    s_waitcnt vmcnt(5) lgkmcnt(6)
    v_mfma_f32_16x16x32_bf16 v[0:3], v[64:67], v[88:91], v[0:3]
    ds_read_b128 v[88:91], v120 offset:4096
    s_waitcnt vmcnt(4) lgkmcnt(6)
    v_mfma_f32_16x16x32_bf16 v[4:7], v[64:67], v[92:95], v[4:7]
    v_mfma_f32_16x16x32_bf16 v[0:3], v[68:71], v[92:95], v[0:3]
    ds_read_b128 v[92:95], v116 offset:3264
    s_waitcnt vmcnt(3) lgkmcnt(6)
    v_mfma_f32_16x16x32_bf16 v[32:35], v[80:83], v[96:99], v[32:35]
    ds_read_b128 v[96:99], v120 offset:5120
    s_waitcnt vmcnt(2) lgkmcnt(6)
    v_mfma_f32_16x16x32_bf16 v[8:11], v[64:67], v[100:103], v[8:11]
    v_mfma_f32_16x16x32_bf16 v[4:7], v[68:71], v[100:103], v[4:7]
    v_mfma_f32_16x16x32_bf16 v[0:3], v[72:75], v[100:103], v[0:3]
    ds_read_b128 v[100:103], v116 offset:4352
    s_waitcnt vmcnt(1) lgkmcnt(6)
    v_mfma_f32_16x16x32_bf16 v[36:39], v[80:83], v[104:107], v[36:39]
    v_mfma_f32_16x16x32_bf16 v[32:35], v[84:87], v[104:107], v[32:35]
    ds_read_b128 v[104:107], v120 offset:6144
    s_waitcnt vmcnt(0) lgkmcnt(6)
    v_mfma_f32_16x16x32_bf16 v[12:15], v[64:67], v[108:111], v[12:15]
    v_mfma_f32_16x16x32_bf16 v[8:11], v[68:71], v[108:111], v[8:11]
    v_mfma_f32_16x16x32_bf16 v[4:7], v[72:75], v[108:111], v[4:7]
    v_mfma_f32_16x16x32_bf16 v[0:3], v[76:79], v[108:111], v[0:3]
    ds_read_b128 v[108:111], v116 offset:5440
    s_waitcnt lgkmcnt(6)
    v_mfma_f32_16x16x32_bf16 v[40:43], v[80:83], v[112:115], v[40:43]
    v_mfma_f32_16x16x32_bf16 v[36:39], v[84:87], v[112:115], v[36:39]
    ds_read_b128 v[112:115], v120 offset:7168
    s_waitcnt lgkmcnt(6)
    v_mfma_f32_16x16x32_bf16 v[16:19], v[64:67], v[88:91], v[16:19]
    v_mfma_f32_16x16x32_bf16 v[12:15], v[68:71], v[88:91], v[12:15]
    v_mfma_f32_16x16x32_bf16 v[8:11], v[72:75], v[88:91], v[8:11]
    v_mfma_f32_16x16x32_bf16 v[4:7], v[76:79], v[88:91], v[4:7]
    ds_read_b128 v[88:91], v117 offset:0
    s_waitcnt lgkmcnt(6)
    v_mfma_f32_16x16x32_bf16 v[44:47], v[80:83], v[92:95], v[44:47]
    v_mfma_f32_16x16x32_bf16 v[40:43], v[84:87], v[92:95], v[40:43]
    ds_read_b128 v[92:95], v122 offset:0
    v_add_u32 v122, v123, v122
    s_waitcnt lgkmcnt(6)
    v_mfma_f32_16x16x32_bf16 v[20:23], v[64:67], v[96:99], v[20:23]
    v_mfma_f32_16x16x32_bf16 v[16:19], v[68:71], v[96:99], v[16:19]
    v_mfma_f32_16x16x32_bf16 v[12:15], v[72:75], v[96:99], v[12:15]
    v_mfma_f32_16x16x32_bf16 v[8:11], v[76:79], v[96:99], v[8:11]
    ds_read_b128 v[96:99], v117 offset:1088
    s_waitcnt lgkmcnt(6)
    v_mfma_f32_16x16x32_bf16 v[48:51], v[80:83], v[100:103], v[48:51]
    v_mfma_f32_16x16x32_bf16 v[44:47], v[84:87], v[100:103], v[44:47]
    ds_read_b128 v[100:103], v121 offset:1024
    s_waitcnt lgkmcnt(6)
    v_mfma_f32_16x16x32_bf16 v[24:27], v[64:67], v[104:107], v[24:27]
    v_mfma_f32_16x16x32_bf16 v[20:23], v[68:71], v[104:107], v[20:23]
    v_mfma_f32_16x16x32_bf16 v[16:19], v[72:75], v[104:107], v[16:19]
    v_mfma_f32_16x16x32_bf16 v[12:15], v[76:79], v[104:107], v[12:15]
    ds_read_b128 v[104:107], v118 offset:0
    s_waitcnt lgkmcnt(6)
    v_mfma_f32_16x16x32_bf16 v[52:55], v[80:83], v[108:111], v[52:55]
    v_mfma_f32_16x16x32_bf16 v[48:51], v[84:87], v[108:111], v[48:51]
    ds_read_b128 v[108:111], v121 offset:2048
    s_waitcnt lgkmcnt(6)
    v_mfma_f32_16x16x32_bf16 v[28:31], v[64:67], v[112:115], v[28:31]
    v_mfma_f32_16x16x32_bf16 v[24:27], v[68:71], v[112:115], v[24:27]
    v_mfma_f32_16x16x32_bf16 v[20:23], v[72:75], v[112:115], v[20:23]
    v_mfma_f32_16x16x32_bf16 v[16:19], v[76:79], v[112:115], v[16:19]
    buffer_load_dwordx4 v[64:67], v125, s[12:15], s23 offen offset:0
    s_waitcnt lgkmcnt(5)
    v_mfma_f32_16x16x32_bf16 v[56:59], v[80:83], v[88:91], v[56:59]
    v_mfma_f32_16x16x32_bf16 v[52:55], v[84:87], v[88:91], v[52:55]
    s_waitcnt lgkmcnt(0)
    s_barrier
    v_mfma_f32_16x16x32_bf16 v[28:31], v[68:71], v[92:95], v[28:31]
    v_mfma_f32_16x16x32_bf16 v[24:27], v[72:75], v[92:95], v[24:27]
    v_mfma_f32_16x16x32_bf16 v[20:23], v[76:79], v[92:95], v[20:23]
    buffer_load_dwordx4 v[68:71], v125, s[12:15], s23 offen offset:2048
    v_mfma_f32_16x16x32_bf16 v[60:63], v[80:83], v[96:99], v[60:63]
    v_mfma_f32_16x16x32_bf16 v[56:59], v[84:87], v[96:99], v[56:59]
    buffer_load_dwordx4 v[80:83], v119, s[12:15], s23 offen offset:0
    v_mfma_f32_16x16x32_bf16 v[28:31], v[72:75], v[100:103], v[28:31]
    v_mfma_f32_16x16x32_bf16 v[24:27], v[76:79], v[100:103], v[24:27]
    buffer_load_dwordx4 v[72:75], v125, s[12:15], s26 offen offset:0
    v_mfma_f32_16x16x32_bf16 v[60:63], v[84:87], v[104:107], v[60:63]
    buffer_load_dwordx4 v[84:87], v119, s[12:15], s23 offen offset:2048
    v_mfma_f32_16x16x32_bf16 v[28:31], v[76:79], v[108:111], v[28:31]
    buffer_load_dwordx4 v[76:79], v125, s[12:15], s26 offen offset:2048
    s_add_u32 s23, s23, 57344
    s_add_u32 s26, s26, 57344
    s_sub_u32 s22, s22, 1
    s_cmp_eq_u32 s22, 0
    s_cbranch_scc1 L_conv2_kernel_mlast2
    ds_read_b128 v[88:91], v120 offset:8192
    ds_read_b128 v[92:95], v120 offset:9216
    ds_read_b128 v[96:99], v116 offset:8704
    ds_read_b128 v[100:103], v120 offset:10240
    ds_read_b128 v[104:107], v116 offset:9792
    ds_read_b128 v[108:111], v120 offset:11264
    ds_read_b128 v[112:115], v116 offset:10880
    s_waitcnt vmcnt(5) lgkmcnt(6)
    v_mfma_f32_16x16x32_bf16 v[0:3], v[64:67], v[88:91], v[0:3]
    ds_read_b128 v[88:91], v120 offset:12288
    s_waitcnt vmcnt(4) lgkmcnt(6)
    v_mfma_f32_16x16x32_bf16 v[4:7], v[64:67], v[92:95], v[4:7]
    v_mfma_f32_16x16x32_bf16 v[0:3], v[68:71], v[92:95], v[0:3]
    ds_read_b128 v[92:95], v116 offset:11968
    s_waitcnt vmcnt(3) lgkmcnt(6)
    v_mfma_f32_16x16x32_bf16 v[32:35], v[80:83], v[96:99], v[32:35]
    ds_read_b128 v[96:99], v120 offset:13312
    s_waitcnt vmcnt(2) lgkmcnt(6)
    v_mfma_f32_16x16x32_bf16 v[8:11], v[64:67], v[100:103], v[8:11]
    v_mfma_f32_16x16x32_bf16 v[4:7], v[68:71], v[100:103], v[4:7]
    v_mfma_f32_16x16x32_bf16 v[0:3], v[72:75], v[100:103], v[0:3]
    ds_read_b128 v[100:103], v116 offset:13056
    s_waitcnt vmcnt(1) lgkmcnt(6)
    v_mfma_f32_16x16x32_bf16 v[36:39], v[80:83], v[104:107], v[36:39]
    v_mfma_f32_16x16x32_bf16 v[32:35], v[84:87], v[104:107], v[32:35]
    ds_read_b128 v[104:107], v120 offset:14336
    s_waitcnt vmcnt(0) lgkmcnt(6)
    v_mfma_f32_16x16x32_bf16 v[12:15], v[64:67], v[108:111], v[12:15]
    v_mfma_f32_16x16x32_bf16 v[8:11], v[68:71], v[108:111], v[8:11]
    v_mfma_f32_16x16x32_bf16 v[4:7], v[72:75], v[108:111], v[4:7]
    v_mfma_f32_16x16x32_bf16 v[0:3], v[76:79], v[108:111], v[0:3]
    ds_read_b128 v[108:111], v116 offset:14144
    s_waitcnt lgkmcnt(6)
    v_mfma_f32_16x16x32_bf16 v[40:43], v[80:83], v[112:115], v[40:43]
    v_mfma_f32_16x16x32_bf16 v[36:39], v[84:87], v[112:115], v[36:39]
    ds_read_b128 v[112:115], v120 offset:15360
    s_waitcnt lgkmcnt(6)
    v_mfma_f32_16x16x32_bf16 v[16:19], v[64:67], v[88:91], v[16:19]
    v_mfma_f32_16x16x32_bf16 v[12:15], v[68:71], v[88:91], v[12:15]
    v_mfma_f32_16x16x32_bf16 v[8:11], v[72:75], v[88:91], v[8:11]
    v_mfma_f32_16x16x32_bf16 v[4:7], v[76:79], v[88:91], v[4:7]
    ds_read_b128 v[88:91], v117 offset:8704
    s_waitcnt lgkmcnt(6)
    v_mfma_f32_16x16x32_bf16 v[44:47], v[80:83], v[92:95], v[44:47]
    v_mfma_f32_16x16x32_bf16 v[40:43], v[84:87], v[92:95], v[40:43]
    ds_read_b128 v[92:95], v122 offset:0
    v_add_u32 v122, v124, v122
    s_waitcnt lgkmcnt(6)
    v_mfma_f32_16x16x32_bf16 v[20:23], v[64:67], v[96:99], v[20:23]
    v_mfma_f32_16x16x32_bf16 v[16:19], v[68:71], v[96:99], v[16:19]
    v_mfma_f32_16x16x32_bf16 v[12:15], v[72:75], v[96:99], v[12:15]
    v_mfma_f32_16x16x32_bf16 v[8:11], v[76:79], v[96:99], v[8:11]
    ds_read_b128 v[96:99], v117 offset:9792
    s_waitcnt lgkmcnt(6)
    v_mfma_f32_16x16x32_bf16 v[48:51], v[80:83], v[100:103], v[48:51]
    v_mfma_f32_16x16x32_bf16 v[44:47], v[84:87], v[100:103], v[44:47]
    ds_read_b128 v[100:103], v121 offset:9216
    s_waitcnt lgkmcnt(6)
    v_mfma_f32_16x16x32_bf16 v[24:27], v[64:67], v[104:107], v[24:27]
    v_mfma_f32_16x16x32_bf16 v[20:23], v[68:71], v[104:107], v[20:23]
    v_mfma_f32_16x16x32_bf16 v[16:19], v[72:75], v[104:107], v[16:19]
    v_mfma_f32_16x16x32_bf16 v[12:15], v[76:79], v[104:107], v[12:15]
    ds_read_b128 v[104:107], v118 offset:8704
    s_waitcnt lgkmcnt(6)
    v_mfma_f32_16x16x32_bf16 v[52:55], v[80:83], v[108:111], v[52:55]
    v_mfma_f32_16x16x32_bf16 v[48:51], v[84:87], v[108:111], v[48:51]
    ds_read_b128 v[108:111], v121 offset:10240
    s_waitcnt lgkmcnt(6)
    v_mfma_f32_16x16x32_bf16 v[28:31], v[64:67], v[112:115], v[28:31]
    v_mfma_f32_16x16x32_bf16 v[24:27], v[68:71], v[112:115], v[24:27]
    v_mfma_f32_16x16x32_bf16 v[20:23], v[72:75], v[112:115], v[20:23]
    v_mfma_f32_16x16x32_bf16 v[16:19], v[76:79], v[112:115], v[16:19]
    buffer_load_dwordx4 v[64:67], v125, s[12:15], s23 offen offset:0
    s_waitcnt lgkmcnt(5)
    v_mfma_f32_16x16x32_bf16 v[56:59], v[80:83], v[88:91], v[56:59]
    v_mfma_f32_16x16x32_bf16 v[52:55], v[84:87], v[88:91], v[52:55]
    s_waitcnt lgkmcnt(0)
    s_barrier
    v_mfma_f32_16x16x32_bf16 v[28:31], v[68:71], v[92:95], v[28:31]
    v_mfma_f32_16x16x32_bf16 v[24:27], v[72:75], v[92:95], v[24:27]
    v_mfma_f32_16x16x32_bf16 v[20:23], v[76:79], v[92:95], v[20:23]
    buffer_load_dwordx4 v[68:71], v125, s[12:15], s23 offen offset:2048
    v_mfma_f32_16x16x32_bf16 v[60:63], v[80:83], v[96:99], v[60:63]
    v_mfma_f32_16x16x32_bf16 v[56:59], v[84:87], v[96:99], v[56:59]
    buffer_load_dwordx4 v[80:83], v119, s[12:15], s23 offen offset:0
    v_mfma_f32_16x16x32_bf16 v[28:31], v[72:75], v[100:103], v[28:31]
    v_mfma_f32_16x16x32_bf16 v[24:27], v[76:79], v[100:103], v[24:27]
    buffer_load_dwordx4 v[72:75], v125, s[12:15], s26 offen offset:0
    v_mfma_f32_16x16x32_bf16 v[60:63], v[84:87], v[104:107], v[60:63]
    buffer_load_dwordx4 v[84:87], v119, s[12:15], s23 offen offset:2048
    v_mfma_f32_16x16x32_bf16 v[28:31], v[76:79], v[108:111], v[28:31]
    buffer_load_dwordx4 v[76:79], v125, s[12:15], s26 offen offset:2048
    s_add_u32 s23, s23, 57344
    s_add_u32 s26, s26, 57344
    s_branch L_conv2_kernel_mloop2
L_conv2_kernel_mlast2:
    v_and_b32 v125, 15, v127
    v_and_b32 v126, 7, v127
    v_lshlrev_b32 v126, 4, v126
    v_lshl_add_u32 v125, v125, 7, v126
    v_lshrrev_b32 v126, 4, v127
    v_lshl_add_u32 v125, v126, 11, v125
    s_mov_b32 s36, 65536
    s_cmp_eq_u32 s32, 1
    s_cselect_b32 s36, 121856, s36
    s_cmp_eq_u32 s32, 2
    s_cselect_b32 s36, 81920, s36
    s_cmp_eq_u32 s32, 3
    s_cselect_b32 s36, 130048, s36
    s_mov_b32 s37, 98304
    s_cmp_eq_u32 s32, 1
    s_cselect_b32 s37, 138240, s37
    s_cmp_eq_u32 s32, 2
    s_cselect_b32 s37, 146432, s37
    s_cmp_eq_u32 s32, 3
    s_cselect_b32 s37, 154624, s37
    v_add_u32 v126, s37, v125
    v_add_u32 v125, s36, v125
    ds_read_b128 v[88:91], v120 offset:8192
    ds_read_b128 v[92:95], v120 offset:9216
    ds_read_b128 v[96:99], v116 offset:8704
    ds_read_b128 v[100:103], v120 offset:10240
    ds_read_b128 v[104:107], v116 offset:9792
    ds_read_b128 v[108:111], v120 offset:11264
    ds_read_b128 v[112:115], v116 offset:10880
    s_waitcnt vmcnt(5) lgkmcnt(6)
    v_mfma_f32_16x16x32_bf16 v[0:3], v[64:67], v[88:91], v[0:3]
    ds_read_b128 v[88:91], v120 offset:12288
    s_waitcnt vmcnt(4) lgkmcnt(6)
    v_mfma_f32_16x16x32_bf16 v[4:7], v[64:67], v[92:95], v[4:7]
    v_mfma_f32_16x16x32_bf16 v[0:3], v[68:71], v[92:95], v[0:3]
    ds_read_b128 v[92:95], v116 offset:11968
    s_waitcnt vmcnt(3) lgkmcnt(6)
    v_mfma_f32_16x16x32_bf16 v[32:35], v[80:83], v[96:99], v[32:35]
    ds_read_b128 v[96:99], v120 offset:13312
    s_waitcnt vmcnt(2) lgkmcnt(6)
    v_mfma_f32_16x16x32_bf16 v[8:11], v[64:67], v[100:103], v[8:11]
    v_mfma_f32_16x16x32_bf16 v[4:7], v[68:71], v[100:103], v[4:7]
    v_mfma_f32_16x16x32_bf16 v[0:3], v[72:75], v[100:103], v[0:3]
    ds_read_b128 v[100:103], v116 offset:13056
    s_waitcnt vmcnt(1) lgkmcnt(6)
    v_mfma_f32_16x16x32_bf16 v[36:39], v[80:83], v[104:107], v[36:39]
    v_mfma_f32_16x16x32_bf16 v[32:35], v[84:87], v[104:107], v[32:35]
    ds_read_b128 v[104:107], v120 offset:14336
    s_waitcnt vmcnt(0) lgkmcnt(6)
    v_mfma_f32_16x16x32_bf16 v[12:15], v[64:67], v[108:111], v[12:15]
    v_mfma_f32_16x16x32_bf16 v[8:11], v[68:71], v[108:111], v[8:11]
    v_mfma_f32_16x16x32_bf16 v[4:7], v[72:75], v[108:111], v[4:7]
    v_mfma_f32_16x16x32_bf16 v[0:3], v[76:79], v[108:111], v[0:3]
    ds_read_b128 v[108:111], v116 offset:14144
    s_waitcnt lgkmcnt(6)
    v_mfma_f32_16x16x32_bf16 v[40:43], v[80:83], v[112:115], v[40:43]
    v_mfma_f32_16x16x32_bf16 v[36:39], v[84:87], v[112:115], v[36:39]
    ds_read_b128 v[112:115], v120 offset:15360
    s_waitcnt lgkmcnt(6)
    v_mfma_f32_16x16x32_bf16 v[16:19], v[64:67], v[88:91], v[16:19]
    v_mfma_f32_16x16x32_bf16 v[12:15], v[68:71], v[88:91], v[12:15]
    v_mfma_f32_16x16x32_bf16 v[8:11], v[72:75], v[88:91], v[8:11]
    v_mfma_f32_16x16x32_bf16 v[4:7], v[76:79], v[88:91], v[4:7]
    ds_read_b128 v[88:91], v117 offset:8704
    v_xor_b32 v124, 0, v126
    ds_write_b128 v124, v[32:35]
    s_waitcnt lgkmcnt(7)
    v_mfma_f32_16x16x32_bf16 v[44:47], v[80:83], v[92:95], v[44:47]
    v_mfma_f32_16x16x32_bf16 v[40:43], v[84:87], v[92:95], v[40:43]
    ds_read_b128 v[92:95], v122 offset:0
    v_xor_b32 v123, 0, v125
    ds_write_b128 v123, v[0:3]
    s_waitcnt lgkmcnt(8)
    v_mfma_f32_16x16x32_bf16 v[20:23], v[64:67], v[96:99], v[20:23]
    v_mfma_f32_16x16x32_bf16 v[16:19], v[68:71], v[96:99], v[16:19]
    v_mfma_f32_16x16x32_bf16 v[12:15], v[72:75], v[96:99], v[12:15]
    v_mfma_f32_16x16x32_bf16 v[8:11], v[76:79], v[96:99], v[8:11]
    ds_read_b128 v[96:99], v117 offset:9792
    v_xor_b32 v123, 16, v126
    ds_write_b128 v123, v[36:39]
    s_waitcnt lgkmcnt(9)
    v_mfma_f32_16x16x32_bf16 v[48:51], v[80:83], v[100:103], v[48:51]
    v_mfma_f32_16x16x32_bf16 v[44:47], v[84:87], v[100:103], v[44:47]
    ds_read_b128 v[100:103], v121 offset:9216
    v_xor_b32 v124, 16, v125
    ds_write_b128 v124, v[4:7]
    s_waitcnt lgkmcnt(10)
    v_mfma_f32_16x16x32_bf16 v[24:27], v[64:67], v[104:107], v[24:27]
    v_mfma_f32_16x16x32_bf16 v[20:23], v[68:71], v[104:107], v[20:23]
    v_mfma_f32_16x16x32_bf16 v[16:19], v[72:75], v[104:107], v[16:19]
    v_mfma_f32_16x16x32_bf16 v[12:15], v[76:79], v[104:107], v[12:15]
    ds_read_b128 v[104:107], v118 offset:8704
    v_xor_b32 v124, 32, v126
    ds_write_b128 v124, v[40:43]
    s_waitcnt lgkmcnt(11)
    v_mfma_f32_16x16x32_bf16 v[52:55], v[80:83], v[108:111], v[52:55]
    v_mfma_f32_16x16x32_bf16 v[48:51], v[84:87], v[108:111], v[48:51]
    ds_read_b128 v[108:111], v121 offset:10240
    v_xor_b32 v123, 32, v125
    ds_write_b128 v123, v[8:11]
    s_waitcnt lgkmcnt(12)
    v_mfma_f32_16x16x32_bf16 v[28:31], v[64:67], v[112:115], v[28:31]
    v_mfma_f32_16x16x32_bf16 v[24:27], v[68:71], v[112:115], v[24:27]
    v_mfma_f32_16x16x32_bf16 v[20:23], v[72:75], v[112:115], v[20:23]
    v_mfma_f32_16x16x32_bf16 v[16:19], v[76:79], v[112:115], v[16:19]
    v_xor_b32 v123, 48, v126
    ds_write_b128 v123, v[44:47]
    s_waitcnt lgkmcnt(12)
    v_mfma_f32_16x16x32_bf16 v[56:59], v[80:83], v[88:91], v[56:59]
    v_mfma_f32_16x16x32_bf16 v[52:55], v[84:87], v[88:91], v[52:55]
    v_xor_b32 v124, 48, v125
    ds_write_b128 v124, v[12:15]
    s_waitcnt lgkmcnt(11)
    v_mfma_f32_16x16x32_bf16 v[28:31], v[68:71], v[92:95], v[28:31]
    v_mfma_f32_16x16x32_bf16 v[24:27], v[72:75], v[92:95], v[24:27]
    v_mfma_f32_16x16x32_bf16 v[20:23], v[76:79], v[92:95], v[20:23]
    v_xor_b32 v124, 64, v126
    ds_write_b128 v124, v[48:51]
    s_waitcnt lgkmcnt(10)
    v_mfma_f32_16x16x32_bf16 v[60:63], v[80:83], v[96:99], v[60:63]
    v_mfma_f32_16x16x32_bf16 v[56:59], v[84:87], v[96:99], v[56:59]
    v_xor_b32 v123, 64, v125
    ds_write_b128 v123, v[16:19]
    s_waitcnt lgkmcnt(9)
    v_mfma_f32_16x16x32_bf16 v[28:31], v[72:75], v[100:103], v[28:31]
    v_mfma_f32_16x16x32_bf16 v[24:27], v[76:79], v[100:103], v[24:27]
    v_xor_b32 v123, 80, v126
    ds_write_b128 v123, v[52:55]
    s_waitcnt lgkmcnt(8)
    v_mfma_f32_16x16x32_bf16 v[60:63], v[84:87], v[104:107], v[60:63]
    v_xor_b32 v124, 80, v125
    ds_write_b128 v124, v[20:23]
    s_waitcnt lgkmcnt(7)
    v_mfma_f32_16x16x32_bf16 v[28:31], v[76:79], v[108:111], v[28:31]
    v_xor_b32 v124, 96, v126
    ds_write_b128 v124, v[56:59]
    v_and_b32 v108, 15, v127
    v_lshrrev_b32 v109, 4, v127
    v_lshrrev_b32 v110, 3, v108
    s_lshl_b32 s36, s20, 1
    v_add_u32 v110, s36, v110
    v_xor_b32 v111, v110, v108
    v_and_b32 v111, 7, v111
    v_lshlrev_b32 v111, 4, v111
    v_xor_b32 v123, 96, v125
    ds_write_b128 v123, v[24:27]
    v_lshl_add_u32 v111, v110, 7, v111
    v_lshl_add_u32 v120, v109, 11, v111
    v_add_u32 v121, 65536, v120
    v_add_u32 v64, 131072, v120
    s_lshl_b32 s36, s20, 9
    s_add_u32 s36, s36, 115712
    v_lshl_add_u32 v127, v109, 7, s36
    s_lshl_b32 s36, s20, 4
    v_add_u32 v108, s36, v108
    v_lshlrev_b32 v110, 6, v108
    v_lshl_add_u32 v110, v109, 4, v110
    s_mul_i32 s36, s29, 262144
    v_xor_b32 v123, 112, v126
    ds_write_b128 v123, v[60:63]
    s_lshl_b32 s37, s21, 4
    s_add_u32 s36, s36, s37
    v_add_u32 v110, s36, v110
    v_mov_b32 v111, 2130706432
    v_cmp_gt_u32 vcc, 125, v108
    s_mov_b32 s4, 0xbeaaaaab
    s_mov_b32 s5, s4
    s_mov_b32 s6, 0x3e800000
    s_mov_b32 s7, s6
    s_mov_b32 s8, 0xc0a00000
    s_mov_b32 s9, s8
    s_mov_b32 s10, 0xc0638e39
    v_xor_b32 v124, 112, v125
    ds_write_b128 v124, v[28:31]
    s_mov_b32 s11, s10
    s_mov_b32 s12, 0xbf638e39
    s_mov_b32 s13, s12
    s_mov_b32 s14, 0xbe638e39
    s_mov_b32 s15, s14
    s_mov_b32 s22, 0xbd638e39
    s_mov_b32 s23, s22
    s_mov_b32 s24, 0x3ff1c71c
    s_mov_b32 s25, s24
    s_mov_b32 s26, 0xbf2aaaab
    s_mov_b32 s27, s26
    s_mov_b32 s32, 0x3ecccccd
    s_mov_b32 s33, s32
    s_mov_b32 s34, 0xbd888889
    s_mov_b32 s35, s34
    s_mov_b32 s38, 0xbe4ccccd
    s_mov_b32 s39, s38
    s_mov_b32 s40, 0xbdd2d3e8
    s_mov_b32 s41, s40
    s_mov_b32 s42, 0x3f800000
    s_mov_b32 s43, s42
    s_setprio 0
    s_branch L_conv2_kernel_epi
L_conv2_kernel_helper:
    s_setprio 3
    v_lshlrev_b32 v8, 4, v6
    s_add_u32 s37, s33, 4294967289
    v_lshl_add_u32 v9, v7, 3, s37
    v_cmp_gt_u32 vcc, 8000, v9
    s_mul_i32 s37, s33, 131072
    s_add_u32 s37, s37, 0
    v_lshl_add_u32 v92, v7, 7, s37
    v_add_u32 v92, v92, v8
    v_mov_b32 v9, 2130706432
    v_cndmask_b32 v92, v9, v92, vcc
    s_add_u32 s37, s33, 4294967291
    v_lshl_add_u32 v9, v7, 3, s37
    v_cmp_gt_u32 vcc, 8000, v9
    s_mul_i32 s37, s33, 131072
    s_add_u32 s37, s37, 262144
    v_lshl_add_u32 v93, v7, 7, s37
    v_add_u32 v93, v93, v8
    v_mov_b32 v9, 2130706432
    v_cndmask_b32 v93, v9, v93, vcc
    s_add_u32 s37, s33, 4294967293
    v_lshl_add_u32 v9, v7, 3, s37
    v_cmp_gt_u32 vcc, 8000, v9
    s_mul_i32 s37, s33, 131072
    s_add_u32 s37, s37, 64
    v_lshl_add_u32 v94, v7, 7, s37
    v_add_u32 v94, v94, v8
    v_mov_b32 v9, 2130706432
    v_cndmask_b32 v94, v9, v94, vcc
    s_add_u32 s37, s33, 4294967295
    v_lshl_add_u32 v9, v7, 3, s37
    v_cmp_gt_u32 vcc, 8000, v9
    s_mul_i32 s37, s33, 131072
    s_add_u32 s37, s37, 262208
    v_lshl_add_u32 v95, v7, 7, s37
    v_add_u32 v95, v95, v8
    v_mov_b32 v9, 2130706432
    v_cndmask_b32 v95, v9, v95, vcc
    v_and_b32 v76, 4, v5
    v_lshrrev_b32 v76, 1, v76
    v_xor_b32 v76, v6, v76
    v_lshlrev_b32 v76, 4, v76
    v_lshl_add_u32 v76, v5, 6, v76
    s_mov_b32 s24, 0
    s_mov_b32 s27, 524288
    s_waitcnt lgkmcnt(0)
    s_add_u32 s8, s4, s47
    s_addc_u32 s9, s5, 0
    buffer_load_dwordx4 v[0:3], v92, s[8:11], s24 offen
    buffer_load_dwordx4 v[8:11], v94, s[8:11], s24 offen
    buffer_load_dwordx4 v[4:7], v93, s[8:11], s24 offen
    buffer_load_dwordx4 v[12:15], v95, s[8:11], s24 offen
    buffer_load_dwordx4 v[16:19], v92, s[8:11], s27 offen
    buffer_load_dwordx4 v[24:27], v94, s[8:11], s27 offen
    buffer_load_dwordx4 v[20:23], v93, s[8:11], s27 offen
    buffer_load_dwordx4 v[28:31], v95, s[8:11], s27 offen
    s_mul_i32 s36, s42, 1024
    v_add_u32 v96, s36, v76
    v_add_u32 v97, 65536, v96
    s_mul_i32 s36, s42, 1088
    s_add_u32 s36, s36, 98304
    v_add_u32 v98, s36, v76
    s_waitcnt vmcnt(0)
    s_mov_b32 s28, 0
    s_mov_b32 s22, 2
    s_cmp_ge_u32 s20, 12
    s_cbranch_scc1 L_conv2_kernel_h2
    ds_write_b128 v96, v[0:3] offset:0
    ds_write_b128 v98, v[12:15] offset:0
    v_lshlrev_b32 v76, 16, v0
    v_and_b32 v84, s25, v0
    v_lshlrev_b32 v77, 16, v4
    v_and_b32 v85, s25, v4
    v_lshlrev_b32 v78, 16, v8
    v_and_b32 v86, s25, v8
    v_lshlrev_b32 v79, 16, v12
    v_and_b32 v87, s25, v12
    v_add_f32 v80, v76, v78
    v_add_f32 v88, v84, v86
    v_add_f32 v81, v77, v79
    v_add_f32 v89, v85, v87
    v_fma_f32 v82, v78, 4.0, v76
    v_fma_f32 v90, v86, 4.0, v84
    v_fma_f32 v83, v79, 4.0, v77
    v_fma_f32 v91, v87, 4.0, v85
    v_add_f32 v77, v80, v81
    v_add_f32 v85, v88, v89
    v_sub_f32 v78, v80, v81
    v_sub_f32 v86, v88, v89
    v_fma_f32 v79, v83, 2.0, v82
    v_fma_f32 v87, v91, 2.0, v90
    v_fma_f32 v82, v83, -2.0, v82
    v_fma_f32 v90, v91, -2.0, v90
    v_fmamk_f32 v80, v76, 0x41700000, v82
    v_fmamk_f32 v88, v84, 0x41700000, v90
    v_fmamk_f32 v80, v81, 0x41200000, v80
    v_fmamk_f32 v88, v89, 0x41200000, v88
    v_cvt_pk_bf16_f32 v4, v77, v85
    v_cvt_pk_bf16_f32 v8, v78, v86
    v_cvt_pk_bf16_f32 v64, v79, v87
    v_cvt_pk_bf16_f32 v68, v82, v90
    v_cvt_pk_bf16_f32 v72, v80, v88
    v_lshlrev_b32 v76, 16, v1
    v_and_b32 v84, s25, v1
    v_lshlrev_b32 v77, 16, v5
    v_and_b32 v85, s25, v5
    v_lshlrev_b32 v78, 16, v9
    v_and_b32 v86, s25, v9
    v_lshlrev_b32 v79, 16, v13
    v_and_b32 v87, s25, v13
    v_add_f32 v80, v76, v78
    v_add_f32 v88, v84, v86
    v_add_f32 v81, v77, v79
    v_add_f32 v89, v85, v87
    v_fma_f32 v82, v78, 4.0, v76
    v_fma_f32 v90, v86, 4.0, v84
    v_fma_f32 v83, v79, 4.0, v77
    v_fma_f32 v91, v87, 4.0, v85
    v_add_f32 v77, v80, v81
    v_add_f32 v85, v88, v89
    v_sub_f32 v78, v80, v81
    v_sub_f32 v86, v88, v89
    v_fma_f32 v79, v83, 2.0, v82
    v_fma_f32 v87, v91, 2.0, v90
    v_fma_f32 v82, v83, -2.0, v82
    v_fma_f32 v90, v91, -2.0, v90
    v_fmamk_f32 v80, v76, 0x41700000, v82
    v_fmamk_f32 v88, v84, 0x41700000, v90
    v_fmamk_f32 v80, v81, 0x41200000, v80
    v_fmamk_f32 v88, v89, 0x41200000, v88
    v_cvt_pk_bf16_f32 v5, v77, v85
    v_cvt_pk_bf16_f32 v9, v78, v86
    v_cvt_pk_bf16_f32 v65, v79, v87
    v_cvt_pk_bf16_f32 v69, v82, v90
    v_cvt_pk_bf16_f32 v73, v80, v88
    v_lshlrev_b32 v76, 16, v2
    v_and_b32 v84, s25, v2
    v_lshlrev_b32 v77, 16, v6
    v_and_b32 v85, s25, v6
    v_lshlrev_b32 v78, 16, v10
    v_and_b32 v86, s25, v10
    v_lshlrev_b32 v79, 16, v14
    v_and_b32 v87, s25, v14
    v_add_f32 v80, v76, v78
    v_add_f32 v88, v84, v86
    v_add_f32 v81, v77, v79
    v_add_f32 v89, v85, v87
    v_fma_f32 v82, v78, 4.0, v76
    v_fma_f32 v90, v86, 4.0, v84
    v_fma_f32 v83, v79, 4.0, v77
    v_fma_f32 v91, v87, 4.0, v85
    v_add_f32 v77, v80, v81
    v_add_f32 v85, v88, v89
    v_sub_f32 v78, v80, v81
    v_sub_f32 v86, v88, v89
    v_fma_f32 v79, v83, 2.0, v82
    v_fma_f32 v87, v91, 2.0, v90
    v_fma_f32 v82, v83, -2.0, v82
    v_fma_f32 v90, v91, -2.0, v90
    v_fmamk_f32 v80, v76, 0x41700000, v82
    v_fmamk_f32 v88, v84, 0x41700000, v90
    v_fmamk_f32 v80, v81, 0x41200000, v80
    v_fmamk_f32 v88, v89, 0x41200000, v88
    v_cvt_pk_bf16_f32 v6, v77, v85
    v_cvt_pk_bf16_f32 v10, v78, v86
    v_cvt_pk_bf16_f32 v66, v79, v87
    v_cvt_pk_bf16_f32 v70, v82, v90
    v_cvt_pk_bf16_f32 v74, v80, v88
    v_lshlrev_b32 v76, 16, v3
    v_and_b32 v84, s25, v3
    v_lshlrev_b32 v77, 16, v7
    v_and_b32 v85, s25, v7
    v_lshlrev_b32 v78, 16, v11
    v_and_b32 v86, s25, v11
    v_lshlrev_b32 v79, 16, v15
    v_and_b32 v87, s25, v15
    v_add_f32 v80, v76, v78
    v_add_f32 v88, v84, v86
    v_add_f32 v81, v77, v79
    v_add_f32 v89, v85, v87
    v_fma_f32 v82, v78, 4.0, v76
    v_fma_f32 v90, v86, 4.0, v84
    v_fma_f32 v83, v79, 4.0, v77
    v_fma_f32 v91, v87, 4.0, v85
    v_add_f32 v77, v80, v81
    v_add_f32 v85, v88, v89
    v_sub_f32 v78, v80, v81
    v_sub_f32 v86, v88, v89
    v_fma_f32 v79, v83, 2.0, v82
    v_fma_f32 v87, v91, 2.0, v90
    v_fma_f32 v82, v83, -2.0, v82
    v_fma_f32 v90, v91, -2.0, v90
    v_fmamk_f32 v80, v76, 0x41700000, v82
    v_fmamk_f32 v88, v84, 0x41700000, v90
    v_fmamk_f32 v80, v81, 0x41200000, v80
    v_fmamk_f32 v88, v89, 0x41200000, v88
    v_cvt_pk_bf16_f32 v7, v77, v85
    v_cvt_pk_bf16_f32 v11, v78, v86
    v_cvt_pk_bf16_f32 v67, v79, v87
    v_cvt_pk_bf16_f32 v71, v82, v90
    v_cvt_pk_bf16_f32 v75, v80, v88
    ds_write_b128 v96, v[64:67] offset:49152
    ds_write_b128 v97, v[68:71] offset:0
    ds_write_b128 v97, v[72:75] offset:16384
    ds_write_b128 v96, v[4:7] offset:16384
    ds_write_b128 v96, v[8:11] offset:32768
    s_waitcnt vmcnt(0)
    s_mov_b32 s24, 1048576
    s_mov_b32 s27, 1572864
    s_waitcnt lgkmcnt(0)
    s_barrier
    buffer_load_dwordx4 v[32:35], v92, s[8:11], s24 offen
    buffer_load_dwordx4 v[40:43], v94, s[8:11], s24 offen
    buffer_load_dwordx4 v[36:39], v93, s[8:11], s24 offen
    buffer_load_dwordx4 v[44:47], v95, s[8:11], s24 offen
    s_setprio 1
L_conv2_kernel_hloop1:
    v_lshlrev_b32 v76, 16, v16
    v_and_b32 v84, s25, v16
    v_lshlrev_b32 v77, 16, v20
    v_and_b32 v85, s25, v20
    v_lshlrev_b32 v78, 16, v24
    v_and_b32 v86, s25, v24
    v_lshlrev_b32 v79, 16, v28
    v_and_b32 v87, s25, v28
    v_add_f32 v80, v76, v78
    v_add_f32 v88, v84, v86
    v_add_f32 v81, v77, v79
    v_add_f32 v89, v85, v87
    v_fma_f32 v82, v78, 4.0, v76
    buffer_load_dwordx4 v[48:51], v92, s[8:11], s27 offen
    buffer_load_dwordx4 v[56:59], v94, s[8:11], s27 offen
    v_fma_f32 v90, v86, 4.0, v84
    v_fma_f32 v83, v79, 4.0, v77
    v_fma_f32 v91, v87, 4.0, v85
    v_add_f32 v77, v80, v81
    v_add_f32 v85, v88, v89
    v_sub_f32 v78, v80, v81
    v_sub_f32 v86, v88, v89
    v_fma_f32 v79, v83, 2.0, v82
    v_fma_f32 v87, v91, 2.0, v90
    v_fma_f32 v82, v83, -2.0, v82
    v_fma_f32 v90, v91, -2.0, v90
    v_fmamk_f32 v80, v76, 0x41700000, v82
    v_fmamk_f32 v88, v84, 0x41700000, v90
    v_fmamk_f32 v80, v81, 0x41200000, v80
    v_fmamk_f32 v88, v89, 0x41200000, v88
    v_cvt_pk_bf16_f32 v20, v77, v85
    v_cvt_pk_bf16_f32 v24, v78, v86
    v_cvt_pk_bf16_f32 v64, v79, v87
    v_cvt_pk_bf16_f32 v68, v82, v90
    v_cvt_pk_bf16_f32 v72, v80, v88
    v_lshlrev_b32 v76, 16, v17
    v_and_b32 v84, s25, v17
    v_lshlrev_b32 v77, 16, v21
    v_and_b32 v85, s25, v21
    v_lshlrev_b32 v78, 16, v25
    v_and_b32 v86, s25, v25
    v_lshlrev_b32 v79, 16, v29
    v_and_b32 v87, s25, v29
    v_add_f32 v80, v76, v78
    v_add_f32 v88, v84, v86
    v_add_f32 v81, v77, v79
    v_add_f32 v89, v85, v87
    v_fma_f32 v82, v78, 4.0, v76
    v_fma_f32 v90, v86, 4.0, v84
    v_fma_f32 v83, v79, 4.0, v77
    v_fma_f32 v91, v87, 4.0, v85
    v_add_f32 v77, v80, v81
    v_add_f32 v85, v88, v89
    v_sub_f32 v78, v80, v81
    v_sub_f32 v86, v88, v89
    v_fma_f32 v79, v83, 2.0, v82
    v_fma_f32 v87, v91, 2.0, v90
    v_fma_f32 v82, v83, -2.0, v82
    v_fma_f32 v90, v91, -2.0, v90
    v_fmamk_f32 v80, v76, 0x41700000, v82
    v_fmamk_f32 v88, v84, 0x41700000, v90
    v_fmamk_f32 v80, v81, 0x41200000, v80
    v_fmamk_f32 v88, v89, 0x41200000, v88
    v_cvt_pk_bf16_f32 v21, v77, v85
    v_cvt_pk_bf16_f32 v25, v78, v86
    v_cvt_pk_bf16_f32 v65, v79, v87
    v_cvt_pk_bf16_f32 v69, v82, v90
    v_cvt_pk_bf16_f32 v73, v80, v88
    buffer_load_dwordx4 v[52:55], v93, s[8:11], s27 offen
    buffer_load_dwordx4 v[60:63], v95, s[8:11], s27 offen
    v_lshlrev_b32 v76, 16, v18
    v_and_b32 v84, s25, v18
    v_lshlrev_b32 v77, 16, v22
    v_and_b32 v85, s25, v22
    v_lshlrev_b32 v78, 16, v26
    v_and_b32 v86, s25, v26
    v_lshlrev_b32 v79, 16, v30
    v_and_b32 v87, s25, v30
    v_add_f32 v80, v76, v78
    v_add_f32 v88, v84, v86
    v_add_f32 v81, v77, v79
    v_add_f32 v89, v85, v87
    v_fma_f32 v82, v78, 4.0, v76
    v_fma_f32 v90, v86, 4.0, v84
    v_fma_f32 v83, v79, 4.0, v77
    v_fma_f32 v91, v87, 4.0, v85
    v_add_f32 v77, v80, v81
    v_add_f32 v85, v88, v89
    v_sub_f32 v78, v80, v81
    v_sub_f32 v86, v88, v89
    v_fma_f32 v79, v83, 2.0, v82
    v_fma_f32 v87, v91, 2.0, v90
    v_fma_f32 v82, v83, -2.0, v82
    v_fma_f32 v90, v91, -2.0, v90
    v_fmamk_f32 v80, v76, 0x41700000, v82
    v_fmamk_f32 v88, v84, 0x41700000, v90
    v_fmamk_f32 v80, v81, 0x41200000, v80
    v_fmamk_f32 v88, v89, 0x41200000, v88
    v_cvt_pk_bf16_f32 v22, v77, v85
    v_cvt_pk_bf16_f32 v26, v78, v86
    v_cvt_pk_bf16_f32 v66, v79, v87
    v_cvt_pk_bf16_f32 v70, v82, v90
    v_cvt_pk_bf16_f32 v74, v80, v88
    v_lshlrev_b32 v76, 16, v19
    v_and_b32 v84, s25, v19
    v_lshlrev_b32 v77, 16, v23
    v_and_b32 v85, s25, v23
    v_lshlrev_b32 v78, 16, v27
    v_and_b32 v86, s25, v27
    v_lshlrev_b32 v79, 16, v31
    v_and_b32 v87, s25, v31
    v_add_f32 v80, v76, v78
    v_add_f32 v88, v84, v86
    v_add_f32 v81, v77, v79
    v_add_f32 v89, v85, v87
    v_fma_f32 v82, v78, 4.0, v76
    v_fma_f32 v90, v86, 4.0, v84
    v_fma_f32 v83, v79, 4.0, v77
    v_fma_f32 v91, v87, 4.0, v85
    v_add_f32 v77, v80, v81
    v_add_f32 v85, v88, v89
    v_sub_f32 v78, v80, v81
    v_sub_f32 v86, v88, v89
    v_fma_f32 v79, v83, 2.0, v82
    v_fma_f32 v87, v91, 2.0, v90
    v_fma_f32 v82, v83, -2.0, v82
    v_fma_f32 v90, v91, -2.0, v90
    v_fmamk_f32 v80, v76, 0x41700000, v82
    v_fmamk_f32 v88, v84, 0x41700000, v90
    v_fmamk_f32 v80, v81, 0x41200000, v80
    v_fmamk_f32 v88, v89, 0x41200000, v88
    v_cvt_pk_bf16_f32 v23, v77, v85
    v_cvt_pk_bf16_f32 v27, v78, v86
    v_cvt_pk_bf16_f32 v67, v79, v87
    v_cvt_pk_bf16_f32 v71, v82, v90
    v_cvt_pk_bf16_f32 v75, v80, v88
    ds_write_b128 v96, v[64:67] offset:57344
    ds_write_b128 v97, v[68:71] offset:8192
    ds_write_b128 v97, v[72:75] offset:24576
    ds_write_b128 v96, v[16:19] offset:8192
    ds_write_b128 v96, v[20:23] offset:24576
    ds_write_b128 v96, v[24:27] offset:40960
    ds_write_b128 v98, v[28:31] offset:8704
    s_add_u32 s28, s28, 1
    s_waitcnt lgkmcnt(0)
    s_barrier
    s_add_u32 s24, s24, 1048576
    s_add_u32 s27, s27, 1048576
    s_waitcnt vmcnt(0)
    v_lshlrev_b32 v76, 16, v32
    v_and_b32 v84, s25, v32
    v_lshlrev_b32 v77, 16, v36
    v_and_b32 v85, s25, v36
    v_lshlrev_b32 v78, 16, v40
    v_and_b32 v86, s25, v40
    v_lshlrev_b32 v79, 16, v44
    v_and_b32 v87, s25, v44
    v_add_f32 v80, v76, v78
    v_add_f32 v88, v84, v86
    v_add_f32 v81, v77, v79
    v_add_f32 v89, v85, v87
    v_fma_f32 v82, v78, 4.0, v76
    v_fma_f32 v90, v86, 4.0, v84
    v_fma_f32 v83, v79, 4.0, v77
    v_fma_f32 v91, v87, 4.0, v85
    v_add_f32 v77, v80, v81
    v_add_f32 v85, v88, v89
    v_sub_f32 v78, v80, v81
    v_sub_f32 v86, v88, v89
    v_fma_f32 v79, v83, 2.0, v82
    v_fma_f32 v87, v91, 2.0, v90
    v_fma_f32 v82, v83, -2.0, v82
    v_fma_f32 v90, v91, -2.0, v90
    v_fmamk_f32 v80, v76, 0x41700000, v82
    v_fmamk_f32 v88, v84, 0x41700000, v90
    v_fmamk_f32 v80, v81, 0x41200000, v80
    v_fmamk_f32 v88, v89, 0x41200000, v88
    v_cvt_pk_bf16_f32 v36, v77, v85
    v_cvt_pk_bf16_f32 v40, v78, v86
    v_cvt_pk_bf16_f32 v64, v79, v87
    v_cvt_pk_bf16_f32 v68, v82, v90
    v_cvt_pk_bf16_f32 v72, v80, v88
    v_lshlrev_b32 v76, 16, v33
    v_and_b32 v84, s25, v33
    v_lshlrev_b32 v77, 16, v37
    v_and_b32 v85, s25, v37
    v_lshlrev_b32 v78, 16, v41
    v_and_b32 v86, s25, v41
    buffer_load_dwordx4 v[0:3], v92, s[8:11], s24 offen
    buffer_load_dwordx4 v[8:11], v94, s[8:11], s24 offen
    v_lshlrev_b32 v79, 16, v45
    v_and_b32 v87, s25, v45
    v_add_f32 v80, v76, v78
    v_add_f32 v88, v84, v86
    v_add_f32 v81, v77, v79
    v_add_f32 v89, v85, v87
    v_fma_f32 v82, v78, 4.0, v76
    v_fma_f32 v90, v86, 4.0, v84
    v_fma_f32 v83, v79, 4.0, v77
    v_fma_f32 v91, v87, 4.0, v85
    v_add_f32 v77, v80, v81
    v_add_f32 v85, v88, v89
    v_sub_f32 v78, v80, v81
    v_sub_f32 v86, v88, v89
    v_fma_f32 v79, v83, 2.0, v82
    v_fma_f32 v87, v91, 2.0, v90
    v_fma_f32 v82, v83, -2.0, v82
    v_fma_f32 v90, v91, -2.0, v90
    v_fmamk_f32 v80, v76, 0x41700000, v82
    v_fmamk_f32 v88, v84, 0x41700000, v90
    v_fmamk_f32 v80, v81, 0x41200000, v80
    v_fmamk_f32 v88, v89, 0x41200000, v88
    v_cvt_pk_bf16_f32 v37, v77, v85
    v_cvt_pk_bf16_f32 v41, v78, v86
    v_cvt_pk_bf16_f32 v65, v79, v87
    v_cvt_pk_bf16_f32 v69, v82, v90
    v_cvt_pk_bf16_f32 v73, v80, v88
    v_lshlrev_b32 v76, 16, v34
    v_and_b32 v84, s25, v34
    v_lshlrev_b32 v77, 16, v38
    v_and_b32 v85, s25, v38
    v_lshlrev_b32 v78, 16, v42
    v_and_b32 v86, s25, v42
    v_lshlrev_b32 v79, 16, v46
    v_and_b32 v87, s25, v46
    v_add_f32 v80, v76, v78
    v_add_f32 v88, v84, v86
    v_add_f32 v81, v77, v79
    v_add_f32 v89, v85, v87
    v_fma_f32 v82, v78, 4.0, v76
    v_fma_f32 v90, v86, 4.0, v84
    v_fma_f32 v83, v79, 4.0, v77
    v_fma_f32 v91, v87, 4.0, v85
    v_add_f32 v77, v80, v81
    v_add_f32 v85, v88, v89
    v_sub_f32 v78, v80, v81
    v_sub_f32 v86, v88, v89
    v_fma_f32 v79, v83, 2.0, v82
    v_fma_f32 v87, v91, 2.0, v90
    v_fma_f32 v82, v83, -2.0, v82
    v_fma_f32 v90, v91, -2.0, v90
    v_fmamk_f32 v80, v76, 0x41700000, v82
    v_fmamk_f32 v88, v84, 0x41700000, v90
    buffer_load_dwordx4 v[4:7], v93, s[8:11], s24 offen
    buffer_load_dwordx4 v[12:15], v95, s[8:11], s24 offen
    v_fmamk_f32 v80, v81, 0x41200000, v80
    v_fmamk_f32 v88, v89, 0x41200000, v88
    v_cvt_pk_bf16_f32 v38, v77, v85
    v_cvt_pk_bf16_f32 v42, v78, v86
    v_cvt_pk_bf16_f32 v66, v79, v87
    v_cvt_pk_bf16_f32 v70, v82, v90
    v_cvt_pk_bf16_f32 v74, v80, v88
    v_lshlrev_b32 v76, 16, v35
    v_and_b32 v84, s25, v35
    v_lshlrev_b32 v77, 16, v39
    v_and_b32 v85, s25, v39
    v_lshlrev_b32 v78, 16, v43
    v_and_b32 v86, s25, v43
    v_lshlrev_b32 v79, 16, v47
    v_and_b32 v87, s25, v47
    v_add_f32 v80, v76, v78
    v_add_f32 v88, v84, v86
    v_add_f32 v81, v77, v79
    v_add_f32 v89, v85, v87
    v_fma_f32 v82, v78, 4.0, v76
    v_fma_f32 v90, v86, 4.0, v84
    v_fma_f32 v83, v79, 4.0, v77
    v_fma_f32 v91, v87, 4.0, v85
    v_add_f32 v77, v80, v81
    v_add_f32 v85, v88, v89
    v_sub_f32 v78, v80, v81
    v_sub_f32 v86, v88, v89
    v_fma_f32 v79, v83, 2.0, v82
    v_fma_f32 v87, v91, 2.0, v90
    v_fma_f32 v82, v83, -2.0, v82
    v_fma_f32 v90, v91, -2.0, v90
    v_fmamk_f32 v80, v76, 0x41700000, v82
    v_fmamk_f32 v88, v84, 0x41700000, v90
    v_fmamk_f32 v80, v81, 0x41200000, v80
    v_fmamk_f32 v88, v89, 0x41200000, v88
    v_cvt_pk_bf16_f32 v39, v77, v85
    v_cvt_pk_bf16_f32 v43, v78, v86
    v_cvt_pk_bf16_f32 v67, v79, v87
    v_cvt_pk_bf16_f32 v71, v82, v90
    v_cvt_pk_bf16_f32 v75, v80, v88
    ds_write_b128 v96, v[64:67] offset:49152
    ds_write_b128 v97, v[68:71] offset:0
    ds_write_b128 v97, v[72:75] offset:16384
    ds_write_b128 v96, v[32:35] offset:0
    ds_write_b128 v96, v[36:39] offset:16384
    ds_write_b128 v96, v[40:43] offset:32768
    ds_write_b128 v98, v[44:47] offset:0
    s_add_u32 s28, s28, 1
    s_waitcnt lgkmcnt(0)
    s_barrier
    v_lshlrev_b32 v76, 16, v48
    v_and_b32 v84, s25, v48
    v_lshlrev_b32 v77, 16, v52
    v_and_b32 v85, s25, v52
    v_lshlrev_b32 v78, 16, v56
    v_and_b32 v86, s25, v56
    v_lshlrev_b32 v79, 16, v60
    v_and_b32 v87, s25, v60
    v_add_f32 v80, v76, v78
    v_add_f32 v88, v84, v86
    v_add_f32 v81, v77, v79
    v_add_f32 v89, v85, v87
    v_fma_f32 v82, v78, 4.0, v76
    buffer_load_dwordx4 v[16:19], v92, s[8:11], s27 offen
    buffer_load_dwordx4 v[24:27], v94, s[8:11], s27 offen
    v_fma_f32 v90, v86, 4.0, v84
    v_fma_f32 v83, v79, 4.0, v77
    v_fma_f32 v91, v87, 4.0, v85
    v_add_f32 v77, v80, v81
    v_add_f32 v85, v88, v89
    v_sub_f32 v78, v80, v81
    v_sub_f32 v86, v88, v89
    v_fma_f32 v79, v83, 2.0, v82
    v_fma_f32 v87, v91, 2.0, v90
    v_fma_f32 v82, v83, -2.0, v82
    v_fma_f32 v90, v91, -2.0, v90
    v_fmamk_f32 v80, v76, 0x41700000, v82
    v_fmamk_f32 v88, v84, 0x41700000, v90
    v_fmamk_f32 v80, v81, 0x41200000, v80
    v_fmamk_f32 v88, v89, 0x41200000, v88
    v_cvt_pk_bf16_f32 v52, v77, v85
    v_cvt_pk_bf16_f32 v56, v78, v86
    v_cvt_pk_bf16_f32 v64, v79, v87
    v_cvt_pk_bf16_f32 v68, v82, v90
    v_cvt_pk_bf16_f32 v72, v80, v88
    v_lshlrev_b32 v76, 16, v49
    v_and_b32 v84, s25, v49
    v_lshlrev_b32 v77, 16, v53
    v_and_b32 v85, s25, v53
    v_lshlrev_b32 v78, 16, v57
    v_and_b32 v86, s25, v57
    v_lshlrev_b32 v79, 16, v61
    v_and_b32 v87, s25, v61
    v_add_f32 v80, v76, v78
    v_add_f32 v88, v84, v86
    v_add_f32 v81, v77, v79
    v_add_f32 v89, v85, v87
    v_fma_f32 v82, v78, 4.0, v76
    v_fma_f32 v90, v86, 4.0, v84
    v_fma_f32 v83, v79, 4.0, v77
    v_fma_f32 v91, v87, 4.0, v85
    v_add_f32 v77, v80, v81
    v_add_f32 v85, v88, v89
    v_sub_f32 v78, v80, v81
    v_sub_f32 v86, v88, v89
    v_fma_f32 v79, v83, 2.0, v82
    v_fma_f32 v87, v91, 2.0, v90
    v_fma_f32 v82, v83, -2.0, v82
    v_fma_f32 v90, v91, -2.0, v90
    v_fmamk_f32 v80, v76, 0x41700000, v82
    v_fmamk_f32 v88, v84, 0x41700000, v90
    v_fmamk_f32 v80, v81, 0x41200000, v80
    v_fmamk_f32 v88, v89, 0x41200000, v88
    v_cvt_pk_bf16_f32 v53, v77, v85
    v_cvt_pk_bf16_f32 v57, v78, v86
    v_cvt_pk_bf16_f32 v65, v79, v87
    v_cvt_pk_bf16_f32 v69, v82, v90
    v_cvt_pk_bf16_f32 v73, v80, v88
    buffer_load_dwordx4 v[20:23], v93, s[8:11], s27 offen
    buffer_load_dwordx4 v[28:31], v95, s[8:11], s27 offen
    v_lshlrev_b32 v76, 16, v50
    v_and_b32 v84, s25, v50
    v_lshlrev_b32 v77, 16, v54
    v_and_b32 v85, s25, v54
    v_lshlrev_b32 v78, 16, v58
    v_and_b32 v86, s25, v58
    v_lshlrev_b32 v79, 16, v62
    v_and_b32 v87, s25, v62
    v_add_f32 v80, v76, v78
    v_add_f32 v88, v84, v86
    v_add_f32 v81, v77, v79
    v_add_f32 v89, v85, v87
    v_fma_f32 v82, v78, 4.0, v76
    v_fma_f32 v90, v86, 4.0, v84
    v_fma_f32 v83, v79, 4.0, v77
    v_fma_f32 v91, v87, 4.0, v85
    v_add_f32 v77, v80, v81
    v_add_f32 v85, v88, v89
    v_sub_f32 v78, v80, v81
    v_sub_f32 v86, v88, v89
    v_fma_f32 v79, v83, 2.0, v82
    v_fma_f32 v87, v91, 2.0, v90
    v_fma_f32 v82, v83, -2.0, v82
    v_fma_f32 v90, v91, -2.0, v90
    v_fmamk_f32 v80, v76, 0x41700000, v82
    v_fmamk_f32 v88, v84, 0x41700000, v90
    v_fmamk_f32 v80, v81, 0x41200000, v80
    v_fmamk_f32 v88, v89, 0x41200000, v88
    v_cvt_pk_bf16_f32 v54, v77, v85
    v_cvt_pk_bf16_f32 v58, v78, v86
    v_cvt_pk_bf16_f32 v66, v79, v87
    v_cvt_pk_bf16_f32 v70, v82, v90
    v_cvt_pk_bf16_f32 v74, v80, v88
    v_lshlrev_b32 v76, 16, v51
    v_and_b32 v84, s25, v51
    v_lshlrev_b32 v77, 16, v55
    v_and_b32 v85, s25, v55
    v_lshlrev_b32 v78, 16, v59
    v_and_b32 v86, s25, v59
    v_lshlrev_b32 v79, 16, v63
    v_and_b32 v87, s25, v63
    v_add_f32 v80, v76, v78
    v_add_f32 v88, v84, v86
    v_add_f32 v81, v77, v79
    v_add_f32 v89, v85, v87
    v_fma_f32 v82, v78, 4.0, v76
    v_fma_f32 v90, v86, 4.0, v84
    v_fma_f32 v83, v79, 4.0, v77
    v_fma_f32 v91, v87, 4.0, v85
    v_add_f32 v77, v80, v81
    v_add_f32 v85, v88, v89
    v_sub_f32 v78, v80, v81
    v_sub_f32 v86, v88, v89
    v_fma_f32 v79, v83, 2.0, v82
    v_fma_f32 v87, v91, 2.0, v90
    v_fma_f32 v82, v83, -2.0, v82
    v_fma_f32 v90, v91, -2.0, v90
    v_fmamk_f32 v80, v76, 0x41700000, v82
    v_fmamk_f32 v88, v84, 0x41700000, v90
    v_fmamk_f32 v80, v81, 0x41200000, v80
    v_fmamk_f32 v88, v89, 0x41200000, v88
    v_cvt_pk_bf16_f32 v55, v77, v85
    v_cvt_pk_bf16_f32 v59, v78, v86
    v_cvt_pk_bf16_f32 v67, v79, v87
    v_cvt_pk_bf16_f32 v71, v82, v90
    v_cvt_pk_bf16_f32 v75, v80, v88
    ds_write_b128 v96, v[64:67] offset:57344
    ds_write_b128 v97, v[68:71] offset:8192
    ds_write_b128 v97, v[72:75] offset:24576
    ds_write_b128 v96, v[48:51] offset:8192
    ds_write_b128 v96, v[52:55] offset:24576
    ds_write_b128 v96, v[56:59] offset:40960
    ds_write_b128 v98, v[60:63] offset:8704
    s_add_u32 s28, s28, 1
    s_waitcnt lgkmcnt(0)
    s_barrier
    s_cmp_eq_u32 s22, 1
    s_cbranch_scc1 L_conv2_kernel_hlast1
    s_add_u32 s24, s24, 1048576
    s_add_u32 s27, s27, 1048576
    s_waitcnt vmcnt(0)
    v_lshlrev_b32 v76, 16, v0
    v_and_b32 v84, s25, v0
    v_lshlrev_b32 v77, 16, v4
    v_and_b32 v85, s25, v4
    v_lshlrev_b32 v78, 16, v8
    v_and_b32 v86, s25, v8
    v_lshlrev_b32 v79, 16, v12
    v_and_b32 v87, s25, v12
    v_add_f32 v80, v76, v78
    v_add_f32 v88, v84, v86
    v_add_f32 v81, v77, v79
    v_add_f32 v89, v85, v87
    v_fma_f32 v82, v78, 4.0, v76
    v_fma_f32 v90, v86, 4.0, v84
    v_fma_f32 v83, v79, 4.0, v77
    v_fma_f32 v91, v87, 4.0, v85
    v_add_f32 v77, v80, v81
    v_add_f32 v85, v88, v89
    v_sub_f32 v78, v80, v81
    v_sub_f32 v86, v88, v89
    v_fma_f32 v79, v83, 2.0, v82
    v_fma_f32 v87, v91, 2.0, v90
    v_fma_f32 v82, v83, -2.0, v82
    v_fma_f32 v90, v91, -2.0, v90
    v_fmamk_f32 v80, v76, 0x41700000, v82
    v_fmamk_f32 v88, v84, 0x41700000, v90
    v_fmamk_f32 v80, v81, 0x41200000, v80
    v_fmamk_f32 v88, v89, 0x41200000, v88
    v_cvt_pk_bf16_f32 v4, v77, v85
    v_cvt_pk_bf16_f32 v8, v78, v86
    v_cvt_pk_bf16_f32 v64, v79, v87
    v_cvt_pk_bf16_f32 v68, v82, v90
    v_cvt_pk_bf16_f32 v72, v80, v88
    v_lshlrev_b32 v76, 16, v1
    v_and_b32 v84, s25, v1
    v_lshlrev_b32 v77, 16, v5
    v_and_b32 v85, s25, v5
    v_lshlrev_b32 v78, 16, v9
    v_and_b32 v86, s25, v9
    buffer_load_dwordx4 v[32:35], v92, s[8:11], s24 offen
    buffer_load_dwordx4 v[40:43], v94, s[8:11], s24 offen
    v_lshlrev_b32 v79, 16, v13
    v_and_b32 v87, s25, v13
    v_add_f32 v80, v76, v78
    v_add_f32 v88, v84, v86
    v_add_f32 v81, v77, v79
    v_add_f32 v89, v85, v87
    v_fma_f32 v82, v78, 4.0, v76
    v_fma_f32 v90, v86, 4.0, v84
    v_fma_f32 v83, v79, 4.0, v77
    v_fma_f32 v91, v87, 4.0, v85
    v_add_f32 v77, v80, v81
    v_add_f32 v85, v88, v89
    v_sub_f32 v78, v80, v81
    v_sub_f32 v86, v88, v89
    v_fma_f32 v79, v83, 2.0, v82
    v_fma_f32 v87, v91, 2.0, v90
    v_fma_f32 v82, v83, -2.0, v82
    v_fma_f32 v90, v91, -2.0, v90
    v_fmamk_f32 v80, v76, 0x41700000, v82
    v_fmamk_f32 v88, v84, 0x41700000, v90
    v_fmamk_f32 v80, v81, 0x41200000, v80
    v_fmamk_f32 v88, v89, 0x41200000, v88
    v_cvt_pk_bf16_f32 v5, v77, v85
    v_cvt_pk_bf16_f32 v9, v78, v86
    v_cvt_pk_bf16_f32 v65, v79, v87
    v_cvt_pk_bf16_f32 v69, v82, v90
    v_cvt_pk_bf16_f32 v73, v80, v88
    v_lshlrev_b32 v76, 16, v2
    v_and_b32 v84, s25, v2
    v_lshlrev_b32 v77, 16, v6
    v_and_b32 v85, s25, v6
    v_lshlrev_b32 v78, 16, v10
    v_and_b32 v86, s25, v10
    v_lshlrev_b32 v79, 16, v14
    v_and_b32 v87, s25, v14
    v_add_f32 v80, v76, v78
    v_add_f32 v88, v84, v86
    v_add_f32 v81, v77, v79
    v_add_f32 v89, v85, v87
    v_fma_f32 v82, v78, 4.0, v76
    v_fma_f32 v90, v86, 4.0, v84
    v_fma_f32 v83, v79, 4.0, v77
    v_fma_f32 v91, v87, 4.0, v85
    v_add_f32 v77, v80, v81
    v_add_f32 v85, v88, v89
    v_sub_f32 v78, v80, v81
    v_sub_f32 v86, v88, v89
    v_fma_f32 v79, v83, 2.0, v82
    v_fma_f32 v87, v91, 2.0, v90
    v_fma_f32 v82, v83, -2.0, v82
    v_fma_f32 v90, v91, -2.0, v90
    v_fmamk_f32 v80, v76, 0x41700000, v82
    v_fmamk_f32 v88, v84, 0x41700000, v90
    buffer_load_dwordx4 v[36:39], v93, s[8:11], s24 offen
    buffer_load_dwordx4 v[44:47], v95, s[8:11], s24 offen
    v_fmamk_f32 v80, v81, 0x41200000, v80
    v_fmamk_f32 v88, v89, 0x41200000, v88
    v_cvt_pk_bf16_f32 v6, v77, v85
    v_cvt_pk_bf16_f32 v10, v78, v86
    v_cvt_pk_bf16_f32 v66, v79, v87
    v_cvt_pk_bf16_f32 v70, v82, v90
    v_cvt_pk_bf16_f32 v74, v80, v88
    v_lshlrev_b32 v76, 16, v3
    v_and_b32 v84, s25, v3
    v_lshlrev_b32 v77, 16, v7
    v_and_b32 v85, s25, v7
    v_lshlrev_b32 v78, 16, v11
    v_and_b32 v86, s25, v11
    v_lshlrev_b32 v79, 16, v15
    v_and_b32 v87, s25, v15
    v_add_f32 v80, v76, v78
    v_add_f32 v88, v84, v86
    v_add_f32 v81, v77, v79
    v_add_f32 v89, v85, v87
    v_fma_f32 v82, v78, 4.0, v76
    v_fma_f32 v90, v86, 4.0, v84
    v_fma_f32 v83, v79, 4.0, v77
    v_fma_f32 v91, v87, 4.0, v85
    v_add_f32 v77, v80, v81
    v_add_f32 v85, v88, v89
    v_sub_f32 v78, v80, v81
    v_sub_f32 v86, v88, v89
    v_fma_f32 v79, v83, 2.0, v82
    v_fma_f32 v87, v91, 2.0, v90
    v_fma_f32 v82, v83, -2.0, v82
    v_fma_f32 v90, v91, -2.0, v90
    v_fmamk_f32 v80, v76, 0x41700000, v82
    v_fmamk_f32 v88, v84, 0x41700000, v90
    v_fmamk_f32 v80, v81, 0x41200000, v80
    v_fmamk_f32 v88, v89, 0x41200000, v88
    v_cvt_pk_bf16_f32 v7, v77, v85
    v_cvt_pk_bf16_f32 v11, v78, v86
    v_cvt_pk_bf16_f32 v67, v79, v87
    v_cvt_pk_bf16_f32 v71, v82, v90
    v_cvt_pk_bf16_f32 v75, v80, v88
    ds_write_b128 v96, v[64:67] offset:49152
    ds_write_b128 v97, v[68:71] offset:0
    ds_write_b128 v97, v[72:75] offset:16384
    ds_write_b128 v96, v[0:3] offset:0
    ds_write_b128 v96, v[4:7] offset:16384
    ds_write_b128 v96, v[8:11] offset:32768
    ds_write_b128 v98, v[12:15] offset:0
    s_add_u32 s28, s28, 1
    s_waitcnt lgkmcnt(0)
    s_barrier
    s_sub_u32 s22, s22, 1
    s_branch L_conv2_kernel_hloop1
L_conv2_kernel_hlast1:
    s_branch L_conv2_kernel_end
L_conv2_kernel_h2:
    ds_write_b128 v96, v[0:3] offset:0
    ds_write_b128 v98, v[12:15] offset:0
    v_lshlrev_b32 v76, 16, v0
    v_and_b32 v84, s25, v0
    v_lshlrev_b32 v77, 16, v4
    v_and_b32 v85, s25, v4
    v_lshlrev_b32 v78, 16, v8
    v_and_b32 v86, s25, v8
    v_lshlrev_b32 v79, 16, v12
    v_and_b32 v87, s25, v12
    v_add_f32 v80, v76, v78
    v_add_f32 v88, v84, v86
    v_add_f32 v81, v77, v79
    v_add_f32 v89, v85, v87
    v_fma_f32 v82, v78, 4.0, v76
    v_fma_f32 v90, v86, 4.0, v84
    v_fma_f32 v83, v79, 4.0, v77
    v_fma_f32 v91, v87, 4.0, v85
    v_add_f32 v77, v80, v81
    v_add_f32 v85, v88, v89
    v_sub_f32 v78, v80, v81
    v_sub_f32 v86, v88, v89
    v_fma_f32 v79, v83, 2.0, v82
    v_fma_f32 v87, v91, 2.0, v90
    v_fma_f32 v82, v83, -2.0, v82
    v_fma_f32 v90, v91, -2.0, v90
    v_fmamk_f32 v80, v76, 0x41700000, v82
    v_fmamk_f32 v88, v84, 0x41700000, v90
    v_fmamk_f32 v80, v81, 0x41200000, v80
    v_fmamk_f32 v88, v89, 0x41200000, v88
    v_cvt_pk_bf16_f32 v4, v77, v85
    v_cvt_pk_bf16_f32 v8, v78, v86
    v_cvt_pk_bf16_f32 v64, v79, v87
    v_cvt_pk_bf16_f32 v68, v82, v90
    v_cvt_pk_bf16_f32 v72, v80, v88
    v_lshlrev_b32 v76, 16, v1
    v_and_b32 v84, s25, v1
    v_lshlrev_b32 v77, 16, v5
    v_and_b32 v85, s25, v5
    v_lshlrev_b32 v78, 16, v9
    v_and_b32 v86, s25, v9
    v_lshlrev_b32 v79, 16, v13
    v_and_b32 v87, s25, v13
    v_add_f32 v80, v76, v78
    v_add_f32 v88, v84, v86
    v_add_f32 v81, v77, v79
    v_add_f32 v89, v85, v87
    v_fma_f32 v82, v78, 4.0, v76
    v_fma_f32 v90, v86, 4.0, v84
    v_fma_f32 v83, v79, 4.0, v77
    v_fma_f32 v91, v87, 4.0, v85
    v_add_f32 v77, v80, v81
    v_add_f32 v85, v88, v89
    v_sub_f32 v78, v80, v81
    v_sub_f32 v86, v88, v89
    v_fma_f32 v79, v83, 2.0, v82
    v_fma_f32 v87, v91, 2.0, v90
    v_fma_f32 v82, v83, -2.0, v82
    v_fma_f32 v90, v91, -2.0, v90
    v_fmamk_f32 v80, v76, 0x41700000, v82
    v_fmamk_f32 v88, v84, 0x41700000, v90
    v_fmamk_f32 v80, v81, 0x41200000, v80
    v_fmamk_f32 v88, v89, 0x41200000, v88
    v_cvt_pk_bf16_f32 v5, v77, v85
    v_cvt_pk_bf16_f32 v9, v78, v86
    v_cvt_pk_bf16_f32 v65, v79, v87
    v_cvt_pk_bf16_f32 v69, v82, v90
    v_cvt_pk_bf16_f32 v73, v80, v88
    v_lshlrev_b32 v76, 16, v2
    v_and_b32 v84, s25, v2
    v_lshlrev_b32 v77, 16, v6
    v_and_b32 v85, s25, v6
    v_lshlrev_b32 v78, 16, v10
    v_and_b32 v86, s25, v10
    v_lshlrev_b32 v79, 16, v14
    v_and_b32 v87, s25, v14
    v_add_f32 v80, v76, v78
    v_add_f32 v88, v84, v86
    v_add_f32 v81, v77, v79
    v_add_f32 v89, v85, v87
    v_fma_f32 v82, v78, 4.0, v76
    v_fma_f32 v90, v86, 4.0, v84
    v_fma_f32 v83, v79, 4.0, v77
    v_fma_f32 v91, v87, 4.0, v85
    v_add_f32 v77, v80, v81
    v_add_f32 v85, v88, v89
    v_sub_f32 v78, v80, v81
    v_sub_f32 v86, v88, v89
    v_fma_f32 v79, v83, 2.0, v82
    v_fma_f32 v87, v91, 2.0, v90
    v_fma_f32 v82, v83, -2.0, v82
    v_fma_f32 v90, v91, -2.0, v90
    v_fmamk_f32 v80, v76, 0x41700000, v82
    v_fmamk_f32 v88, v84, 0x41700000, v90
    v_fmamk_f32 v80, v81, 0x41200000, v80
    v_fmamk_f32 v88, v89, 0x41200000, v88
    v_cvt_pk_bf16_f32 v6, v77, v85
    v_cvt_pk_bf16_f32 v10, v78, v86
    v_cvt_pk_bf16_f32 v66, v79, v87
    v_cvt_pk_bf16_f32 v70, v82, v90
    v_cvt_pk_bf16_f32 v74, v80, v88
    v_lshlrev_b32 v76, 16, v3
    v_and_b32 v84, s25, v3
    v_lshlrev_b32 v77, 16, v7
    v_and_b32 v85, s25, v7
    v_lshlrev_b32 v78, 16, v11
    v_and_b32 v86, s25, v11
    v_lshlrev_b32 v79, 16, v15
    v_and_b32 v87, s25, v15
    v_add_f32 v80, v76, v78
    v_add_f32 v88, v84, v86
    v_add_f32 v81, v77, v79
    v_add_f32 v89, v85, v87
    v_fma_f32 v82, v78, 4.0, v76
    v_fma_f32 v90, v86, 4.0, v84
    v_fma_f32 v83, v79, 4.0, v77
    v_fma_f32 v91, v87, 4.0, v85
    v_add_f32 v77, v80, v81
    v_add_f32 v85, v88, v89
    v_sub_f32 v78, v80, v81
    v_sub_f32 v86, v88, v89
    v_fma_f32 v79, v83, 2.0, v82
    v_fma_f32 v87, v91, 2.0, v90
    v_fma_f32 v82, v83, -2.0, v82
    v_fma_f32 v90, v91, -2.0, v90
    v_fmamk_f32 v80, v76, 0x41700000, v82
    v_fmamk_f32 v88, v84, 0x41700000, v90
    v_fmamk_f32 v80, v81, 0x41200000, v80
    v_fmamk_f32 v88, v89, 0x41200000, v88
    v_cvt_pk_bf16_f32 v7, v77, v85
    v_cvt_pk_bf16_f32 v11, v78, v86
    v_cvt_pk_bf16_f32 v67, v79, v87
    v_cvt_pk_bf16_f32 v71, v82, v90
    v_cvt_pk_bf16_f32 v75, v80, v88
    ds_write_b128 v96, v[64:67] offset:49152
    ds_write_b128 v97, v[68:71] offset:0
    ds_write_b128 v97, v[72:75] offset:16384
    ds_write_b128 v96, v[4:7] offset:16384
    ds_write_b128 v96, v[8:11] offset:32768
    s_waitcnt vmcnt(0)
    s_mov_b32 s24, 1048576
    s_mov_b32 s27, 1572864
    s_waitcnt lgkmcnt(0)
    s_barrier
    buffer_load_dwordx4 v[32:35], v92, s[8:11], s24 offen
    buffer_load_dwordx4 v[40:43], v94, s[8:11], s24 offen
    buffer_load_dwordx4 v[36:39], v93, s[8:11], s24 offen
    buffer_load_dwordx4 v[44:47], v95, s[8:11], s24 offen
    buffer_load_dwordx4 v[48:51], v92, s[8:11], s27 offen
    buffer_load_dwordx4 v[56:59], v94, s[8:11], s27 offen
    buffer_load_dwordx4 v[52:55], v93, s[8:11], s27 offen
    buffer_load_dwordx4 v[60:63], v95, s[8:11], s27 offen
    s_setprio 0
    v_lshlrev_b32 v76, 16, v16
    v_and_b32 v84, s25, v16
    v_lshlrev_b32 v77, 16, v20
    v_and_b32 v85, s25, v20
    v_lshlrev_b32 v78, 16, v24
    v_and_b32 v86, s25, v24
    v_lshlrev_b32 v79, 16, v28
    v_and_b32 v87, s25, v28
    v_add_f32 v80, v76, v78
    v_add_f32 v88, v84, v86
    v_add_f32 v81, v77, v79
    v_add_f32 v89, v85, v87
    v_fma_f32 v82, v78, 4.0, v76
    v_fma_f32 v90, v86, 4.0, v84
    v_fma_f32 v83, v79, 4.0, v77
    v_fma_f32 v91, v87, 4.0, v85
    v_add_f32 v77, v80, v81
    v_add_f32 v85, v88, v89
    v_sub_f32 v78, v80, v81
    v_sub_f32 v86, v88, v89
    v_fma_f32 v79, v83, 2.0, v82
    v_fma_f32 v87, v91, 2.0, v90
    v_fma_f32 v82, v83, -2.0, v82
    v_fma_f32 v90, v91, -2.0, v90
    v_fmamk_f32 v80, v76, 0x41700000, v82
    v_fmamk_f32 v88, v84, 0x41700000, v90
    v_fmamk_f32 v80, v81, 0x41200000, v80
    v_fmamk_f32 v88, v89, 0x41200000, v88
    v_cvt_pk_bf16_f32 v20, v77, v85
    v_cvt_pk_bf16_f32 v24, v78, v86
    v_cvt_pk_bf16_f32 v64, v79, v87
    v_cvt_pk_bf16_f32 v68, v82, v90
    v_cvt_pk_bf16_f32 v72, v80, v88
    v_lshlrev_b32 v76, 16, v17
    v_and_b32 v84, s25, v17
    v_lshlrev_b32 v77, 16, v21
    v_and_b32 v85, s25, v21
    v_lshlrev_b32 v78, 16, v25
    v_and_b32 v86, s25, v25
    v_lshlrev_b32 v79, 16, v29
    v_and_b32 v87, s25, v29
    v_add_f32 v80, v76, v78
    v_add_f32 v88, v84, v86
    v_add_f32 v81, v77, v79
    v_add_f32 v89, v85, v87
    v_fma_f32 v82, v78, 4.0, v76
    v_fma_f32 v90, v86, 4.0, v84
    v_fma_f32 v83, v79, 4.0, v77
    v_fma_f32 v91, v87, 4.0, v85
    v_add_f32 v77, v80, v81
    v_add_f32 v85, v88, v89
    v_sub_f32 v78, v80, v81
    v_sub_f32 v86, v88, v89
    v_fma_f32 v79, v83, 2.0, v82
    v_fma_f32 v87, v91, 2.0, v90
    v_fma_f32 v82, v83, -2.0, v82
    v_fma_f32 v90, v91, -2.0, v90
    v_fmamk_f32 v80, v76, 0x41700000, v82
    v_fmamk_f32 v88, v84, 0x41700000, v90
    v_fmamk_f32 v80, v81, 0x41200000, v80
    v_fmamk_f32 v88, v89, 0x41200000, v88
    v_cvt_pk_bf16_f32 v21, v77, v85
    v_cvt_pk_bf16_f32 v25, v78, v86
    v_cvt_pk_bf16_f32 v65, v79, v87
    v_cvt_pk_bf16_f32 v69, v82, v90
    v_cvt_pk_bf16_f32 v73, v80, v88
    v_lshlrev_b32 v76, 16, v18
    v_and_b32 v84, s25, v18
    v_lshlrev_b32 v77, 16, v22
    v_and_b32 v85, s25, v22
    v_lshlrev_b32 v78, 16, v26
    v_and_b32 v86, s25, v26
    v_lshlrev_b32 v79, 16, v30
    v_and_b32 v87, s25, v30
    v_add_f32 v80, v76, v78
    v_add_f32 v88, v84, v86
    v_add_f32 v81, v77, v79
    v_add_f32 v89, v85, v87
    v_fma_f32 v82, v78, 4.0, v76
    v_fma_f32 v90, v86, 4.0, v84
    v_fma_f32 v83, v79, 4.0, v77
    v_fma_f32 v91, v87, 4.0, v85
    v_add_f32 v77, v80, v81
    v_add_f32 v85, v88, v89
    v_sub_f32 v78, v80, v81
    v_sub_f32 v86, v88, v89
    v_fma_f32 v79, v83, 2.0, v82
    v_fma_f32 v87, v91, 2.0, v90
    v_fma_f32 v82, v83, -2.0, v82
    v_fma_f32 v90, v91, -2.0, v90
    v_fmamk_f32 v80, v76, 0x41700000, v82
    v_fmamk_f32 v88, v84, 0x41700000, v90
    v_fmamk_f32 v80, v81, 0x41200000, v80
    v_fmamk_f32 v88, v89, 0x41200000, v88
    v_cvt_pk_bf16_f32 v22, v77, v85
    v_cvt_pk_bf16_f32 v26, v78, v86
    v_cvt_pk_bf16_f32 v66, v79, v87
    v_cvt_pk_bf16_f32 v70, v82, v90
    v_cvt_pk_bf16_f32 v74, v80, v88
    v_lshlrev_b32 v76, 16, v19
    v_and_b32 v84, s25, v19
    v_lshlrev_b32 v77, 16, v23
    v_and_b32 v85, s25, v23
    v_lshlrev_b32 v78, 16, v27
    v_and_b32 v86, s25, v27
    v_lshlrev_b32 v79, 16, v31
    v_and_b32 v87, s25, v31
    v_add_f32 v80, v76, v78
    v_add_f32 v88, v84, v86
    v_add_f32 v81, v77, v79
    v_add_f32 v89, v85, v87
    v_fma_f32 v82, v78, 4.0, v76
    v_fma_f32 v90, v86, 4.0, v84
    v_fma_f32 v83, v79, 4.0, v77
    v_fma_f32 v91, v87, 4.0, v85
    v_add_f32 v77, v80, v81
    v_add_f32 v85, v88, v89
    v_sub_f32 v78, v80, v81
    v_sub_f32 v86, v88, v89
    v_fma_f32 v79, v83, 2.0, v82
    v_fma_f32 v87, v91, 2.0, v90
    v_fma_f32 v82, v83, -2.0, v82
    v_fma_f32 v90, v91, -2.0, v90
    v_fmamk_f32 v80, v76, 0x41700000, v82
    v_fmamk_f32 v88, v84, 0x41700000, v90
    v_fmamk_f32 v80, v81, 0x41200000, v80
    v_fmamk_f32 v88, v89, 0x41200000, v88
    v_cvt_pk_bf16_f32 v23, v77, v85
    v_cvt_pk_bf16_f32 v27, v78, v86
    v_cvt_pk_bf16_f32 v67, v79, v87
    v_cvt_pk_bf16_f32 v71, v82, v90
    v_cvt_pk_bf16_f32 v75, v80, v88
L_conv2_kernel_hloop2:
    s_add_u32 s24, s24, 1048576
    s_add_u32 s27, s27, 1048576
    ds_write_b128 v96, v[64:67] offset:57344
    ds_write_b128 v97, v[68:71] offset:8192
    ds_write_b128 v97, v[72:75] offset:24576
    ds_write_b128 v96, v[16:19] offset:8192
    ds_write_b128 v96, v[20:23] offset:24576
    ds_write_b128 v96, v[24:27] offset:40960
    ds_write_b128 v98, v[28:31] offset:8704
    s_waitcnt vmcnt(0)
    buffer_load_dwordx4 v[0:3], v92, s[8:11], s24 offen
    buffer_load_dwordx4 v[8:11], v94, s[8:11], s24 offen
    buffer_load_dwordx4 v[4:7], v93, s[8:11], s24 offen
    buffer_load_dwordx4 v[12:15], v95, s[8:11], s24 offen
    v_lshlrev_b32 v76, 16, v32
    v_and_b32 v84, s25, v32
    v_lshlrev_b32 v77, 16, v36
    v_and_b32 v85, s25, v36
    v_lshlrev_b32 v78, 16, v40
    v_and_b32 v86, s25, v40
    v_lshlrev_b32 v79, 16, v44
    v_and_b32 v87, s25, v44
    v_add_f32 v80, v76, v78
    v_add_f32 v88, v84, v86
    v_add_f32 v81, v77, v79
    v_add_f32 v89, v85, v87
    v_fma_f32 v82, v78, 4.0, v76
    v_fma_f32 v90, v86, 4.0, v84
    v_fma_f32 v83, v79, 4.0, v77
    v_fma_f32 v91, v87, 4.0, v85
    v_add_f32 v77, v80, v81
    v_add_f32 v85, v88, v89
    v_sub_f32 v78, v80, v81
    v_sub_f32 v86, v88, v89
    v_fma_f32 v79, v83, 2.0, v82
    v_fma_f32 v87, v91, 2.0, v90
    v_fma_f32 v82, v83, -2.0, v82
    v_fma_f32 v90, v91, -2.0, v90
    v_fmamk_f32 v80, v76, 0x41700000, v82
    v_fmamk_f32 v88, v84, 0x41700000, v90
    v_fmamk_f32 v80, v81, 0x41200000, v80
    v_fmamk_f32 v88, v89, 0x41200000, v88
    v_cvt_pk_bf16_f32 v36, v77, v85
    v_cvt_pk_bf16_f32 v40, v78, v86
    v_cvt_pk_bf16_f32 v64, v79, v87
    v_cvt_pk_bf16_f32 v68, v82, v90
    v_cvt_pk_bf16_f32 v72, v80, v88
    v_lshlrev_b32 v76, 16, v33
    v_and_b32 v84, s25, v33
    v_lshlrev_b32 v77, 16, v37
    v_and_b32 v85, s25, v37
    v_lshlrev_b32 v78, 16, v41
    v_and_b32 v86, s25, v41
    v_lshlrev_b32 v79, 16, v45
    v_and_b32 v87, s25, v45
    v_add_f32 v80, v76, v78
    v_add_f32 v88, v84, v86
    v_add_f32 v81, v77, v79
    v_add_f32 v89, v85, v87
    v_fma_f32 v82, v78, 4.0, v76
    v_fma_f32 v90, v86, 4.0, v84
    v_fma_f32 v83, v79, 4.0, v77
    v_fma_f32 v91, v87, 4.0, v85
    v_add_f32 v77, v80, v81
    v_add_f32 v85, v88, v89
    v_sub_f32 v78, v80, v81
    v_sub_f32 v86, v88, v89
    v_fma_f32 v79, v83, 2.0, v82
    v_fma_f32 v87, v91, 2.0, v90
    v_fma_f32 v82, v83, -2.0, v82
    v_fma_f32 v90, v91, -2.0, v90
    v_fmamk_f32 v80, v76, 0x41700000, v82
    v_fmamk_f32 v88, v84, 0x41700000, v90
    v_fmamk_f32 v80, v81, 0x41200000, v80
    v_fmamk_f32 v88, v89, 0x41200000, v88
    v_cvt_pk_bf16_f32 v37, v77, v85
    v_cvt_pk_bf16_f32 v41, v78, v86
    v_cvt_pk_bf16_f32 v65, v79, v87
    v_cvt_pk_bf16_f32 v69, v82, v90
    v_cvt_pk_bf16_f32 v73, v80, v88
    v_lshlrev_b32 v76, 16, v34
    v_and_b32 v84, s25, v34
    v_lshlrev_b32 v77, 16, v38
    v_and_b32 v85, s25, v38
    v_lshlrev_b32 v78, 16, v42
    v_and_b32 v86, s25, v42
    v_lshlrev_b32 v79, 16, v46
    v_and_b32 v87, s25, v46
    v_add_f32 v80, v76, v78
    v_add_f32 v88, v84, v86
    v_add_f32 v81, v77, v79
    v_add_f32 v89, v85, v87
    v_fma_f32 v82, v78, 4.0, v76
    v_fma_f32 v90, v86, 4.0, v84
    v_fma_f32 v83, v79, 4.0, v77
    v_fma_f32 v91, v87, 4.0, v85
    v_add_f32 v77, v80, v81
    v_add_f32 v85, v88, v89
    v_sub_f32 v78, v80, v81
    v_sub_f32 v86, v88, v89
    v_fma_f32 v79, v83, 2.0, v82
    v_fma_f32 v87, v91, 2.0, v90
    v_fma_f32 v82, v83, -2.0, v82
    v_fma_f32 v90, v91, -2.0, v90
    v_fmamk_f32 v80, v76, 0x41700000, v82
    v_fmamk_f32 v88, v84, 0x41700000, v90
    v_fmamk_f32 v80, v81, 0x41200000, v80
    v_fmamk_f32 v88, v89, 0x41200000, v88
    v_cvt_pk_bf16_f32 v38, v77, v85
    v_cvt_pk_bf16_f32 v42, v78, v86
    v_cvt_pk_bf16_f32 v66, v79, v87
    v_cvt_pk_bf16_f32 v70, v82, v90
    v_cvt_pk_bf16_f32 v74, v80, v88
    v_lshlrev_b32 v76, 16, v35
    v_and_b32 v84, s25, v35
    v_lshlrev_b32 v77, 16, v39
    v_and_b32 v85, s25, v39
    v_lshlrev_b32 v78, 16, v43
    v_and_b32 v86, s25, v43
    v_lshlrev_b32 v79, 16, v47
    v_and_b32 v87, s25, v47
    v_add_f32 v80, v76, v78
    v_add_f32 v88, v84, v86
    v_add_f32 v81, v77, v79
    v_add_f32 v89, v85, v87
    v_fma_f32 v82, v78, 4.0, v76
    v_fma_f32 v90, v86, 4.0, v84
    v_fma_f32 v83, v79, 4.0, v77
    v_fma_f32 v91, v87, 4.0, v85
    v_add_f32 v77, v80, v81
    v_add_f32 v85, v88, v89
    v_sub_f32 v78, v80, v81
    v_sub_f32 v86, v88, v89
    v_fma_f32 v79, v83, 2.0, v82
    v_fma_f32 v87, v91, 2.0, v90
    v_fma_f32 v82, v83, -2.0, v82
    v_fma_f32 v90, v91, -2.0, v90
    v_fmamk_f32 v80, v76, 0x41700000, v82
    v_fmamk_f32 v88, v84, 0x41700000, v90
    v_fmamk_f32 v80, v81, 0x41200000, v80
    v_fmamk_f32 v88, v89, 0x41200000, v88
    v_cvt_pk_bf16_f32 v39, v77, v85
    v_cvt_pk_bf16_f32 v43, v78, v86
    v_cvt_pk_bf16_f32 v67, v79, v87
    v_cvt_pk_bf16_f32 v71, v82, v90
    v_cvt_pk_bf16_f32 v75, v80, v88
    s_add_u32 s28, s28, 1
    s_waitcnt lgkmcnt(0)
    s_barrier
    ds_write_b128 v96, v[64:67] offset:49152
    ds_write_b128 v97, v[68:71] offset:0
    ds_write_b128 v97, v[72:75] offset:16384
    ds_write_b128 v96, v[32:35] offset:0
    ds_write_b128 v96, v[36:39] offset:16384
    ds_write_b128 v96, v[40:43] offset:32768
    ds_write_b128 v98, v[44:47] offset:0
    buffer_load_dwordx4 v[16:19], v92, s[8:11], s27 offen
    buffer_load_dwordx4 v[24:27], v94, s[8:11], s27 offen
    buffer_load_dwordx4 v[20:23], v93, s[8:11], s27 offen
    buffer_load_dwordx4 v[28:31], v95, s[8:11], s27 offen
    v_lshlrev_b32 v76, 16, v48
    v_and_b32 v84, s25, v48
    v_lshlrev_b32 v77, 16, v52
    v_and_b32 v85, s25, v52
    v_lshlrev_b32 v78, 16, v56
    v_and_b32 v86, s25, v56
    v_lshlrev_b32 v79, 16, v60
    v_and_b32 v87, s25, v60
    v_add_f32 v80, v76, v78
    v_add_f32 v88, v84, v86
    v_add_f32 v81, v77, v79
    v_add_f32 v89, v85, v87
    v_fma_f32 v82, v78, 4.0, v76
    v_fma_f32 v90, v86, 4.0, v84
    v_fma_f32 v83, v79, 4.0, v77
    v_fma_f32 v91, v87, 4.0, v85
    v_add_f32 v77, v80, v81
    v_add_f32 v85, v88, v89
    v_sub_f32 v78, v80, v81
    v_sub_f32 v86, v88, v89
    v_fma_f32 v79, v83, 2.0, v82
    v_fma_f32 v87, v91, 2.0, v90
    v_fma_f32 v82, v83, -2.0, v82
    v_fma_f32 v90, v91, -2.0, v90
    v_fmamk_f32 v80, v76, 0x41700000, v82
    v_fmamk_f32 v88, v84, 0x41700000, v90
    v_fmamk_f32 v80, v81, 0x41200000, v80
    v_fmamk_f32 v88, v89, 0x41200000, v88
    v_cvt_pk_bf16_f32 v52, v77, v85
    v_cvt_pk_bf16_f32 v56, v78, v86
    v_cvt_pk_bf16_f32 v64, v79, v87
    v_cvt_pk_bf16_f32 v68, v82, v90
    v_cvt_pk_bf16_f32 v72, v80, v88
    v_lshlrev_b32 v76, 16, v49
    v_and_b32 v84, s25, v49
    v_lshlrev_b32 v77, 16, v53
    v_and_b32 v85, s25, v53
    v_lshlrev_b32 v78, 16, v57
    v_and_b32 v86, s25, v57
    v_lshlrev_b32 v79, 16, v61
    v_and_b32 v87, s25, v61
    v_add_f32 v80, v76, v78
    v_add_f32 v88, v84, v86
    v_add_f32 v81, v77, v79
    v_add_f32 v89, v85, v87
    v_fma_f32 v82, v78, 4.0, v76
    v_fma_f32 v90, v86, 4.0, v84
    v_fma_f32 v83, v79, 4.0, v77
    v_fma_f32 v91, v87, 4.0, v85
    v_add_f32 v77, v80, v81
    v_add_f32 v85, v88, v89
    v_sub_f32 v78, v80, v81
    v_sub_f32 v86, v88, v89
    v_fma_f32 v79, v83, 2.0, v82
    v_fma_f32 v87, v91, 2.0, v90
    v_fma_f32 v82, v83, -2.0, v82
    v_fma_f32 v90, v91, -2.0, v90
    v_fmamk_f32 v80, v76, 0x41700000, v82
    v_fmamk_f32 v88, v84, 0x41700000, v90
    v_fmamk_f32 v80, v81, 0x41200000, v80
    v_fmamk_f32 v88, v89, 0x41200000, v88
    v_cvt_pk_bf16_f32 v53, v77, v85
    v_cvt_pk_bf16_f32 v57, v78, v86
    v_cvt_pk_bf16_f32 v65, v79, v87
    v_cvt_pk_bf16_f32 v69, v82, v90
    v_cvt_pk_bf16_f32 v73, v80, v88
    v_lshlrev_b32 v76, 16, v50
    v_and_b32 v84, s25, v50
    v_lshlrev_b32 v77, 16, v54
    v_and_b32 v85, s25, v54
    v_lshlrev_b32 v78, 16, v58
    v_and_b32 v86, s25, v58
    v_lshlrev_b32 v79, 16, v62
    v_and_b32 v87, s25, v62
    v_add_f32 v80, v76, v78
    v_add_f32 v88, v84, v86
    v_add_f32 v81, v77, v79
    v_add_f32 v89, v85, v87
    v_fma_f32 v82, v78, 4.0, v76
    v_fma_f32 v90, v86, 4.0, v84
    v_fma_f32 v83, v79, 4.0, v77
    v_fma_f32 v91, v87, 4.0, v85
    v_add_f32 v77, v80, v81
    v_add_f32 v85, v88, v89
    v_sub_f32 v78, v80, v81
    v_sub_f32 v86, v88, v89
    v_fma_f32 v79, v83, 2.0, v82
    v_fma_f32 v87, v91, 2.0, v90
    v_fma_f32 v82, v83, -2.0, v82
    v_fma_f32 v90, v91, -2.0, v90
    v_fmamk_f32 v80, v76, 0x41700000, v82
    v_fmamk_f32 v88, v84, 0x41700000, v90
    v_fmamk_f32 v80, v81, 0x41200000, v80
    v_fmamk_f32 v88, v89, 0x41200000, v88
    v_cvt_pk_bf16_f32 v54, v77, v85
    v_cvt_pk_bf16_f32 v58, v78, v86
    v_cvt_pk_bf16_f32 v66, v79, v87
    v_cvt_pk_bf16_f32 v70, v82, v90
    v_cvt_pk_bf16_f32 v74, v80, v88
    v_lshlrev_b32 v76, 16, v51
    v_and_b32 v84, s25, v51
    v_lshlrev_b32 v77, 16, v55
    v_and_b32 v85, s25, v55
    v_lshlrev_b32 v78, 16, v59
    v_and_b32 v86, s25, v59
    v_lshlrev_b32 v79, 16, v63
    v_and_b32 v87, s25, v63
    v_add_f32 v80, v76, v78
    v_add_f32 v88, v84, v86
    v_add_f32 v81, v77, v79
    v_add_f32 v89, v85, v87
    v_fma_f32 v82, v78, 4.0, v76
    v_fma_f32 v90, v86, 4.0, v84
    v_fma_f32 v83, v79, 4.0, v77
    v_fma_f32 v91, v87, 4.0, v85
    v_add_f32 v77, v80, v81
    v_add_f32 v85, v88, v89
    v_sub_f32 v78, v80, v81
    v_sub_f32 v86, v88, v89
    v_fma_f32 v79, v83, 2.0, v82
    v_fma_f32 v87, v91, 2.0, v90
    v_fma_f32 v82, v83, -2.0, v82
    v_fma_f32 v90, v91, -2.0, v90
    v_fmamk_f32 v80, v76, 0x41700000, v82
    v_fmamk_f32 v88, v84, 0x41700000, v90
    v_fmamk_f32 v80, v81, 0x41200000, v80
    v_fmamk_f32 v88, v89, 0x41200000, v88
    v_cvt_pk_bf16_f32 v55, v77, v85
    v_cvt_pk_bf16_f32 v59, v78, v86
    v_cvt_pk_bf16_f32 v67, v79, v87
    v_cvt_pk_bf16_f32 v71, v82, v90
    v_cvt_pk_bf16_f32 v75, v80, v88
    s_add_u32 s28, s28, 1
    s_waitcnt lgkmcnt(0)
    s_barrier
    s_cmp_eq_u32 s22, 1
    s_cbranch_scc1 L_conv2_kernel_hlast2
    s_add_u32 s24, s24, 1048576
    s_add_u32 s27, s27, 1048576
    ds_write_b128 v96, v[64:67] offset:57344
    ds_write_b128 v97, v[68:71] offset:8192
    ds_write_b128 v97, v[72:75] offset:24576
    ds_write_b128 v96, v[48:51] offset:8192
    ds_write_b128 v96, v[52:55] offset:24576
    ds_write_b128 v96, v[56:59] offset:40960
    ds_write_b128 v98, v[60:63] offset:8704
    s_waitcnt vmcnt(0)
    buffer_load_dwordx4 v[32:35], v92, s[8:11], s24 offen
    buffer_load_dwordx4 v[40:43], v94, s[8:11], s24 offen
    buffer_load_dwordx4 v[36:39], v93, s[8:11], s24 offen
    buffer_load_dwordx4 v[44:47], v95, s[8:11], s24 offen
    v_lshlrev_b32 v76, 16, v0
    v_and_b32 v84, s25, v0
    v_lshlrev_b32 v77, 16, v4
    v_and_b32 v85, s25, v4
    v_lshlrev_b32 v78, 16, v8
    v_and_b32 v86, s25, v8
    v_lshlrev_b32 v79, 16, v12
    v_and_b32 v87, s25, v12
    v_add_f32 v80, v76, v78
    v_add_f32 v88, v84, v86
    v_add_f32 v81, v77, v79
    v_add_f32 v89, v85, v87
    v_fma_f32 v82, v78, 4.0, v76
    v_fma_f32 v90, v86, 4.0, v84
    v_fma_f32 v83, v79, 4.0, v77
    v_fma_f32 v91, v87, 4.0, v85
    v_add_f32 v77, v80, v81
    v_add_f32 v85, v88, v89
    v_sub_f32 v78, v80, v81
    v_sub_f32 v86, v88, v89
    v_fma_f32 v79, v83, 2.0, v82
    v_fma_f32 v87, v91, 2.0, v90
    v_fma_f32 v82, v83, -2.0, v82
    v_fma_f32 v90, v91, -2.0, v90
    v_fmamk_f32 v80, v76, 0x41700000, v82
    v_fmamk_f32 v88, v84, 0x41700000, v90
    v_fmamk_f32 v80, v81, 0x41200000, v80
    v_fmamk_f32 v88, v89, 0x41200000, v88
    v_cvt_pk_bf16_f32 v4, v77, v85
    v_cvt_pk_bf16_f32 v8, v78, v86
    v_cvt_pk_bf16_f32 v64, v79, v87
    v_cvt_pk_bf16_f32 v68, v82, v90
    v_cvt_pk_bf16_f32 v72, v80, v88
    v_lshlrev_b32 v76, 16, v1
    v_and_b32 v84, s25, v1
    v_lshlrev_b32 v77, 16, v5
    v_and_b32 v85, s25, v5
    v_lshlrev_b32 v78, 16, v9
    v_and_b32 v86, s25, v9
    v_lshlrev_b32 v79, 16, v13
    v_and_b32 v87, s25, v13
    v_add_f32 v80, v76, v78
    v_add_f32 v88, v84, v86
    v_add_f32 v81, v77, v79
    v_add_f32 v89, v85, v87
    v_fma_f32 v82, v78, 4.0, v76
    v_fma_f32 v90, v86, 4.0, v84
    v_fma_f32 v83, v79, 4.0, v77
    v_fma_f32 v91, v87, 4.0, v85
    v_add_f32 v77, v80, v81
    v_add_f32 v85, v88, v89
    v_sub_f32 v78, v80, v81
    v_sub_f32 v86, v88, v89
    v_fma_f32 v79, v83, 2.0, v82
    v_fma_f32 v87, v91, 2.0, v90
    v_fma_f32 v82, v83, -2.0, v82
    v_fma_f32 v90, v91, -2.0, v90
    v_fmamk_f32 v80, v76, 0x41700000, v82
    v_fmamk_f32 v88, v84, 0x41700000, v90
    v_fmamk_f32 v80, v81, 0x41200000, v80
    v_fmamk_f32 v88, v89, 0x41200000, v88
    v_cvt_pk_bf16_f32 v5, v77, v85
    v_cvt_pk_bf16_f32 v9, v78, v86
    v_cvt_pk_bf16_f32 v65, v79, v87
    v_cvt_pk_bf16_f32 v69, v82, v90
    v_cvt_pk_bf16_f32 v73, v80, v88
    v_lshlrev_b32 v76, 16, v2
    v_and_b32 v84, s25, v2
    v_lshlrev_b32 v77, 16, v6
    v_and_b32 v85, s25, v6
    v_lshlrev_b32 v78, 16, v10
    v_and_b32 v86, s25, v10
    v_lshlrev_b32 v79, 16, v14
    v_and_b32 v87, s25, v14
    v_add_f32 v80, v76, v78
    v_add_f32 v88, v84, v86
    v_add_f32 v81, v77, v79
    v_add_f32 v89, v85, v87
    v_fma_f32 v82, v78, 4.0, v76
    v_fma_f32 v90, v86, 4.0, v84
    v_fma_f32 v83, v79, 4.0, v77
    v_fma_f32 v91, v87, 4.0, v85
    v_add_f32 v77, v80, v81
    v_add_f32 v85, v88, v89
    v_sub_f32 v78, v80, v81
    v_sub_f32 v86, v88, v89
    v_fma_f32 v79, v83, 2.0, v82
    v_fma_f32 v87, v91, 2.0, v90
    v_fma_f32 v82, v83, -2.0, v82
    v_fma_f32 v90, v91, -2.0, v90
    v_fmamk_f32 v80, v76, 0x41700000, v82
    v_fmamk_f32 v88, v84, 0x41700000, v90
    v_fmamk_f32 v80, v81, 0x41200000, v80
    v_fmamk_f32 v88, v89, 0x41200000, v88
    v_cvt_pk_bf16_f32 v6, v77, v85
    v_cvt_pk_bf16_f32 v10, v78, v86
    v_cvt_pk_bf16_f32 v66, v79, v87
    v_cvt_pk_bf16_f32 v70, v82, v90
    v_cvt_pk_bf16_f32 v74, v80, v88
    v_lshlrev_b32 v76, 16, v3
    v_and_b32 v84, s25, v3
    v_lshlrev_b32 v77, 16, v7
    v_and_b32 v85, s25, v7
    v_lshlrev_b32 v78, 16, v11
    v_and_b32 v86, s25, v11
    v_lshlrev_b32 v79, 16, v15
    v_and_b32 v87, s25, v15
    v_add_f32 v80, v76, v78
    v_add_f32 v88, v84, v86
    v_add_f32 v81, v77, v79
    v_add_f32 v89, v85, v87
    v_fma_f32 v82, v78, 4.0, v76
    v_fma_f32 v90, v86, 4.0, v84
    v_fma_f32 v83, v79, 4.0, v77
    v_fma_f32 v91, v87, 4.0, v85
    v_add_f32 v77, v80, v81
    v_add_f32 v85, v88, v89
    v_sub_f32 v78, v80, v81
    v_sub_f32 v86, v88, v89
    v_fma_f32 v79, v83, 2.0, v82
    v_fma_f32 v87, v91, 2.0, v90
    v_fma_f32 v82, v83, -2.0, v82
    v_fma_f32 v90, v91, -2.0, v90
    v_fmamk_f32 v80, v76, 0x41700000, v82
    v_fmamk_f32 v88, v84, 0x41700000, v90
    v_fmamk_f32 v80, v81, 0x41200000, v80
    v_fmamk_f32 v88, v89, 0x41200000, v88
    v_cvt_pk_bf16_f32 v7, v77, v85
    v_cvt_pk_bf16_f32 v11, v78, v86
    v_cvt_pk_bf16_f32 v67, v79, v87
    v_cvt_pk_bf16_f32 v71, v82, v90
    v_cvt_pk_bf16_f32 v75, v80, v88
    s_add_u32 s28, s28, 1
    s_waitcnt lgkmcnt(0)
    s_barrier
    ds_write_b128 v96, v[64:67] offset:49152
    ds_write_b128 v97, v[68:71] offset:0
    ds_write_b128 v97, v[72:75] offset:16384
    ds_write_b128 v96, v[0:3] offset:0
    ds_write_b128 v96, v[4:7] offset:16384
    ds_write_b128 v96, v[8:11] offset:32768
    ds_write_b128 v98, v[12:15] offset:0
    buffer_load_dwordx4 v[48:51], v92, s[8:11], s27 offen
    buffer_load_dwordx4 v[56:59], v94, s[8:11], s27 offen
    buffer_load_dwordx4 v[52:55], v93, s[8:11], s27 offen
    buffer_load_dwordx4 v[60:63], v95, s[8:11], s27 offen
    v_lshlrev_b32 v76, 16, v16
    v_and_b32 v84, s25, v16
    v_lshlrev_b32 v77, 16, v20
    v_and_b32 v85, s25, v20
    v_lshlrev_b32 v78, 16, v24
    v_and_b32 v86, s25, v24
    v_lshlrev_b32 v79, 16, v28
    v_and_b32 v87, s25, v28
    v_add_f32 v80, v76, v78
    v_add_f32 v88, v84, v86
    v_add_f32 v81, v77, v79
    v_add_f32 v89, v85, v87
    v_fma_f32 v82, v78, 4.0, v76
    v_fma_f32 v90, v86, 4.0, v84
    v_fma_f32 v83, v79, 4.0, v77
    v_fma_f32 v91, v87, 4.0, v85
    v_add_f32 v77, v80, v81
    v_add_f32 v85, v88, v89
    v_sub_f32 v78, v80, v81
    v_sub_f32 v86, v88, v89
    v_fma_f32 v79, v83, 2.0, v82
    v_fma_f32 v87, v91, 2.0, v90
    v_fma_f32 v82, v83, -2.0, v82
    v_fma_f32 v90, v91, -2.0, v90
    v_fmamk_f32 v80, v76, 0x41700000, v82
    v_fmamk_f32 v88, v84, 0x41700000, v90
    v_fmamk_f32 v80, v81, 0x41200000, v80
    v_fmamk_f32 v88, v89, 0x41200000, v88
    v_cvt_pk_bf16_f32 v20, v77, v85
    v_cvt_pk_bf16_f32 v24, v78, v86
    v_cvt_pk_bf16_f32 v64, v79, v87
    v_cvt_pk_bf16_f32 v68, v82, v90
    v_cvt_pk_bf16_f32 v72, v80, v88
    v_lshlrev_b32 v76, 16, v17
    v_and_b32 v84, s25, v17
    v_lshlrev_b32 v77, 16, v21
    v_and_b32 v85, s25, v21
    v_lshlrev_b32 v78, 16, v25
    v_and_b32 v86, s25, v25
    v_lshlrev_b32 v79, 16, v29
    v_and_b32 v87, s25, v29
    v_add_f32 v80, v76, v78
    v_add_f32 v88, v84, v86
    v_add_f32 v81, v77, v79
    v_add_f32 v89, v85, v87
    v_fma_f32 v82, v78, 4.0, v76
    v_fma_f32 v90, v86, 4.0, v84
    v_fma_f32 v83, v79, 4.0, v77
    v_fma_f32 v91, v87, 4.0, v85
    v_add_f32 v77, v80, v81
    v_add_f32 v85, v88, v89
    v_sub_f32 v78, v80, v81
    v_sub_f32 v86, v88, v89
    v_fma_f32 v79, v83, 2.0, v82
    v_fma_f32 v87, v91, 2.0, v90
    v_fma_f32 v82, v83, -2.0, v82
    v_fma_f32 v90, v91, -2.0, v90
    v_fmamk_f32 v80, v76, 0x41700000, v82
    v_fmamk_f32 v88, v84, 0x41700000, v90
    v_fmamk_f32 v80, v81, 0x41200000, v80
    v_fmamk_f32 v88, v89, 0x41200000, v88
    v_cvt_pk_bf16_f32 v21, v77, v85
    v_cvt_pk_bf16_f32 v25, v78, v86
    v_cvt_pk_bf16_f32 v65, v79, v87
    v_cvt_pk_bf16_f32 v69, v82, v90
    v_cvt_pk_bf16_f32 v73, v80, v88
    v_lshlrev_b32 v76, 16, v18
    v_and_b32 v84, s25, v18
    v_lshlrev_b32 v77, 16, v22
    v_and_b32 v85, s25, v22
    v_lshlrev_b32 v78, 16, v26
    v_and_b32 v86, s25, v26
    v_lshlrev_b32 v79, 16, v30
    v_and_b32 v87, s25, v30
    v_add_f32 v80, v76, v78
    v_add_f32 v88, v84, v86
    v_add_f32 v81, v77, v79
    v_add_f32 v89, v85, v87
    v_fma_f32 v82, v78, 4.0, v76
    v_fma_f32 v90, v86, 4.0, v84
    v_fma_f32 v83, v79, 4.0, v77
    v_fma_f32 v91, v87, 4.0, v85
    v_add_f32 v77, v80, v81
    v_add_f32 v85, v88, v89
    v_sub_f32 v78, v80, v81
    v_sub_f32 v86, v88, v89
    v_fma_f32 v79, v83, 2.0, v82
    v_fma_f32 v87, v91, 2.0, v90
    v_fma_f32 v82, v83, -2.0, v82
    v_fma_f32 v90, v91, -2.0, v90
    v_fmamk_f32 v80, v76, 0x41700000, v82
    v_fmamk_f32 v88, v84, 0x41700000, v90
    v_fmamk_f32 v80, v81, 0x41200000, v80
    v_fmamk_f32 v88, v89, 0x41200000, v88
    v_cvt_pk_bf16_f32 v22, v77, v85
    v_cvt_pk_bf16_f32 v26, v78, v86
    v_cvt_pk_bf16_f32 v66, v79, v87
    v_cvt_pk_bf16_f32 v70, v82, v90
    v_cvt_pk_bf16_f32 v74, v80, v88
    v_lshlrev_b32 v76, 16, v19
    v_and_b32 v84, s25, v19
    v_lshlrev_b32 v77, 16, v23
    v_and_b32 v85, s25, v23
    v_lshlrev_b32 v78, 16, v27
    v_and_b32 v86, s25, v27
    v_lshlrev_b32 v79, 16, v31
    v_and_b32 v87, s25, v31
    v_add_f32 v80, v76, v78
    v_add_f32 v88, v84, v86
    v_add_f32 v81, v77, v79
    v_add_f32 v89, v85, v87
    v_fma_f32 v82, v78, 4.0, v76
    v_fma_f32 v90, v86, 4.0, v84
    v_fma_f32 v83, v79, 4.0, v77
    v_fma_f32 v91, v87, 4.0, v85
    v_add_f32 v77, v80, v81
    v_add_f32 v85, v88, v89
    v_sub_f32 v78, v80, v81
    v_sub_f32 v86, v88, v89
    v_fma_f32 v79, v83, 2.0, v82
    v_fma_f32 v87, v91, 2.0, v90
    v_fma_f32 v82, v83, -2.0, v82
    v_fma_f32 v90, v91, -2.0, v90
    v_fmamk_f32 v80, v76, 0x41700000, v82
    v_fmamk_f32 v88, v84, 0x41700000, v90
    v_fmamk_f32 v80, v81, 0x41200000, v80
    v_fmamk_f32 v88, v89, 0x41200000, v88
    v_cvt_pk_bf16_f32 v23, v77, v85
    v_cvt_pk_bf16_f32 v27, v78, v86
    v_cvt_pk_bf16_f32 v67, v79, v87
    v_cvt_pk_bf16_f32 v71, v82, v90
    v_cvt_pk_bf16_f32 v75, v80, v88
    s_add_u32 s28, s28, 1
    s_waitcnt lgkmcnt(0)
    s_barrier
    s_sub_u32 s22, s22, 1
    s_branch L_conv2_kernel_hloop2
L_conv2_kernel_hlast2:
    s_mov_b32 s25, 0xffff0000
    ds_write_b128 v96, v[64:67] offset:57344
    ds_write_b128 v97, v[68:71] offset:8192
    ds_write_b128 v97, v[72:75] offset:24576
    ds_write_b128 v96, v[48:51] offset:8192
    ds_write_b128 v96, v[52:55] offset:24576
    ds_write_b128 v96, v[56:59] offset:40960
    ds_write_b128 v98, v[60:63] offset:8704
    s_waitcnt lgkmcnt(0)
    s_barrier
    s_branch L_conv2_kernel_end
L_conv2_kernel_epi:
    s_waitcnt lgkmcnt(0)
    s_barrier
    v_cndmask_b32 v122, v111, v110, vcc
    ds_read_b128 v[0:3], v120 offset:0
    ds_read_b128 v[4:7], v120 offset:16384
    ds_read_b128 v[8:11], v120 offset:32768
    ds_read_b128 v[12:15], v120 offset:49152
    ds_read_b128 v[16:19], v121 offset:0
    ds_read_b128 v[20:23], v121 offset:16384
    ds_read_b128 v[24:27], v121 offset:32768
    ds_read_b128 v[28:31], v64 offset:15360
    ds_read_b128 v[32:35], v120 offset:8192
    ds_read_b128 v[36:39], v120 offset:24576
    ds_read_b128 v[40:43], v120 offset:40960
    ds_read_b128 v[44:47], v120 offset:57344
    ds_read_b128 v[48:51], v121 offset:56320
    ds_read_b128 v[52:55], v121 offset:64512
    ds_read_b128 v[56:59], v64 offset:7168
    s_waitcnt lgkmcnt(7)
    ds_read_b128 v[60:63], v64 offset:23552
    s_waitcnt lgkmcnt(8)
    v_pk_add_f32 v[88:89], v[24:25], v[28:29]
    v_pk_add_f32 v[90:91], v[26:27], v[30:31]
    v_pk_add_f32 v[24:25], v[4:5], v[8:9]
    v_pk_add_f32 v[26:27], v[6:7], v[10:11]
    v_pk_add_f32 v[4:5], v[4:5], v[8:9] neg_lo:[0,1] neg_hi:[0,1]
    v_pk_add_f32 v[6:7], v[6:7], v[10:11] neg_lo:[0,1] neg_hi:[0,1]
    v_pk_add_f32 v[72:73], v[12:13], v[16:17]
    v_pk_add_f32 v[74:75], v[14:15], v[18:19]
    v_pk_add_f32 v[12:13], v[12:13], v[16:17] neg_lo:[0,1] neg_hi:[0,1]
    v_pk_add_f32 v[14:15], v[14:15], v[18:19] neg_lo:[0,1] neg_hi:[0,1]
    v_pk_fma_f32 v[72:73], v[24:25], s[4:5], v[72:73]
    v_pk_fma_f32 v[74:75], v[26:27], s[4:5], v[74:75]
    v_pk_fma_f32 v[20:21], v[0:1], s[10:11], v[20:21]
    v_pk_fma_f32 v[22:23], v[2:3], s[10:11], v[22:23]
    v_pk_fma_f32 v[72:73], v[0:1], s[6:7], v[72:73]
    v_pk_fma_f32 v[74:75], v[2:3], s[6:7], v[74:75]
    v_pk_add_f32 v[24:25], v[24:25], v[0:1] neg_lo:[0,1] neg_hi:[0,1]
    v_pk_add_f32 v[26:27], v[26:27], v[2:3] neg_lo:[0,1] neg_hi:[0,1]
    v_pk_fma_f32 v[72:73], v[88:89], s[8:9], v[72:73]
    v_pk_fma_f32 v[74:75], v[90:91], s[8:9], v[74:75]
    v_pk_add_f32 v[24:25], v[24:25], v[88:89] neg_lo:[0,1] neg_hi:[0,1]
    v_pk_add_f32 v[26:27], v[26:27], v[90:91] neg_lo:[0,1] neg_hi:[0,1]
    v_pk_fma_f32 v[20:21], v[88:89], s[22:23], v[20:21]
    v_pk_fma_f32 v[22:23], v[90:91], s[22:23], v[22:23]
    v_pk_add_f32 v[8:9], v[24:25], v[72:73] neg_lo:[0,1] neg_hi:[0,1]
    v_pk_add_f32 v[10:11], v[26:27], v[74:75] neg_lo:[0,1] neg_hi:[0,1]
    v_pk_fma_f32 v[20:21], v[72:73], s[14:15], v[20:21]
    v_pk_fma_f32 v[22:23], v[74:75], s[14:15], v[22:23]
    v_pk_mul_f32 v[80:81], v[12:13], s[32:33]
    v_pk_mul_f32 v[82:83], v[14:15], s[32:33]
    v_pk_fma_f32 v[20:21], v[8:9], s[12:13], v[20:21]
    v_pk_fma_f32 v[22:23], v[10:11], s[12:13], v[22:23]
    v_pk_fma_f32 v[80:81], v[4:5], s[34:35], v[80:81]
    v_pk_fma_f32 v[82:83], v[6:7], s[34:35], v[82:83]
    v_pk_fma_f32 v[64:65], v[4:5], s[24:25], v[20:21] neg_lo:[0,0,1] neg_hi:[0,0,1]
    v_pk_fma_f32 v[66:67], v[6:7], s[24:25], v[22:23] neg_lo:[0,0,1] neg_hi:[0,0,1]
    v_pk_fma_f32 v[64:65], v[12:13], s[26:27], v[64:65]
    v_pk_fma_f32 v[66:67], v[14:15], s[26:27], v[66:67]
    v_pk_fma_f32 v[80:81], v[64:65], s[38:39], v[80:81]
    v_pk_fma_f32 v[82:83], v[66:67], s[38:39], v[82:83]
    v_pk_add_f32 v[4:5], v[4:5], v[64:65] neg_lo:[0,1] neg_hi:[0,1]
    v_pk_add_f32 v[6:7], v[6:7], v[66:67] neg_lo:[0,1] neg_hi:[0,1]
    v_pk_add_f32 v[4:5], v[4:5], v[80:81] neg_lo:[0,1] neg_hi:[0,1]
    v_pk_add_f32 v[6:7], v[6:7], v[82:83] neg_lo:[0,1] neg_hi:[0,1]
    s_waitcnt lgkmcnt(0)
    v_pk_add_f32 v[92:93], v[56:57], v[60:61]
    v_pk_add_f32 v[94:95], v[58:59], v[62:63]
    v_pk_add_f32 v[56:57], v[36:37], v[40:41]
    v_pk_add_f32 v[58:59], v[38:39], v[42:43]
    v_pk_add_f32 v[36:37], v[36:37], v[40:41] neg_lo:[0,1] neg_hi:[0,1]
    v_pk_add_f32 v[38:39], v[38:39], v[42:43] neg_lo:[0,1] neg_hi:[0,1]
    v_pk_add_f32 v[76:77], v[44:45], v[48:49]
    v_pk_add_f32 v[78:79], v[46:47], v[50:51]
    v_pk_add_f32 v[44:45], v[44:45], v[48:49] neg_lo:[0,1] neg_hi:[0,1]
    v_pk_add_f32 v[46:47], v[46:47], v[50:51] neg_lo:[0,1] neg_hi:[0,1]
    v_pk_fma_f32 v[76:77], v[56:57], s[4:5], v[76:77]
    v_pk_fma_f32 v[78:79], v[58:59], s[4:5], v[78:79]
    v_pk_fma_f32 v[52:53], v[32:33], s[10:11], v[52:53]
    v_pk_fma_f32 v[54:55], v[34:35], s[10:11], v[54:55]
    v_pk_fma_f32 v[76:77], v[32:33], s[6:7], v[76:77]
    v_pk_fma_f32 v[78:79], v[34:35], s[6:7], v[78:79]
    v_pk_add_f32 v[56:57], v[56:57], v[32:33] neg_lo:[0,1] neg_hi:[0,1]
    v_pk_add_f32 v[58:59], v[58:59], v[34:35] neg_lo:[0,1] neg_hi:[0,1]
    v_pk_fma_f32 v[76:77], v[92:93], s[8:9], v[76:77]
    v_pk_fma_f32 v[78:79], v[94:95], s[8:9], v[78:79]
    v_pk_add_f32 v[56:57], v[56:57], v[92:93] neg_lo:[0,1] neg_hi:[0,1]
    v_pk_add_f32 v[58:59], v[58:59], v[94:95] neg_lo:[0,1] neg_hi:[0,1]
    v_pk_fma_f32 v[52:53], v[92:93], s[22:23], v[52:53]
    v_pk_fma_f32 v[54:55], v[94:95], s[22:23], v[54:55]
    v_pk_add_f32 v[40:41], v[56:57], v[76:77] neg_lo:[0,1] neg_hi:[0,1]
    v_pk_add_f32 v[42:43], v[58:59], v[78:79] neg_lo:[0,1] neg_hi:[0,1]
    v_pk_fma_f32 v[52:53], v[76:77], s[14:15], v[52:53]
    v_pk_fma_f32 v[54:55], v[78:79], s[14:15], v[54:55]
    v_pk_mul_f32 v[84:85], v[44:45], s[32:33]
    v_pk_mul_f32 v[86:87], v[46:47], s[32:33]
    v_pk_fma_f32 v[52:53], v[40:41], s[12:13], v[52:53]
    v_pk_fma_f32 v[54:55], v[42:43], s[12:13], v[54:55]
    v_pk_fma_f32 v[84:85], v[36:37], s[34:35], v[84:85]
    v_pk_fma_f32 v[86:87], v[38:39], s[34:35], v[86:87]
    v_pk_fma_f32 v[68:69], v[36:37], s[24:25], v[52:53] neg_lo:[0,0,1] neg_hi:[0,0,1]
    v_pk_fma_f32 v[70:71], v[38:39], s[24:25], v[54:55] neg_lo:[0,0,1] neg_hi:[0,0,1]
    v_pk_fma_f32 v[68:69], v[44:45], s[26:27], v[68:69]
    v_pk_fma_f32 v[70:71], v[46:47], s[26:27], v[70:71]
    v_pk_fma_f32 v[84:85], v[68:69], s[38:39], v[84:85]
    v_pk_fma_f32 v[86:87], v[70:71], s[38:39], v[86:87]
    v_pk_add_f32 v[36:37], v[36:37], v[68:69] neg_lo:[0,1] neg_hi:[0,1]
    v_pk_add_f32 v[38:39], v[38:39], v[70:71] neg_lo:[0,1] neg_hi:[0,1]
    v_pk_add_f32 v[36:37], v[36:37], v[84:85] neg_lo:[0,1] neg_hi:[0,1]
    v_pk_add_f32 v[38:39], v[38:39], v[86:87] neg_lo:[0,1] neg_hi:[0,1]
    s_mov_b32 s36, 0x00010001
    s_mov_b32 s37, 0x00010001
    s_mov_b64 exec, s[36:37]
    ds_write_b128 v127, v[0:3] offset:0
    ds_write_b128 v127, v[32:35] offset:16
    ds_write_b128 v127, v[4:7] offset:32
    ds_write_b128 v127, v[36:39] offset:48
    ds_write_b128 v127, v[8:11] offset:64
    ds_write_b128 v127, v[40:43] offset:80
    s_mov_b64 exec, -1
    v_mov_b32 v44, 0xc0135761
    v_mov_b32 v45, v44
    v_cvt_pk_bf16_f32 v48, v64, v68
    v_cvt_pk_bf16_f32 v49, v65, v69
    v_cvt_pk_bf16_f32 v50, v66, v70
    v_cvt_pk_bf16_f32 v51, v67, v71
    s_mov_b32 s44, 0
    buffer_store_dwordx4 v[48:51], v122, s[16:19], s44 offen sc1
    s_waitcnt lgkmcnt(0)
    s_barrier
    ds_read_b128 v[96:99], v127 offset:512
    ds_read_b128 v[100:103], v127 offset:528
    ds_read_b128 v[104:107], v127 offset:544
    ds_read_b128 v[108:111], v127 offset:560
    ds_read_b128 v[112:115], v127 offset:576
    ds_read_b128 v[116:119], v127 offset:592
    s_waitcnt lgkmcnt(4)
    v_mov_b32_dpp v96, v0 row_shl:1 row_mask:0xf bank_mask:0xf
    v_mov_b32_dpp v97, v1 row_shl:1 row_mask:0xf bank_mask:0xf
    v_mov_b32_dpp v98, v2 row_shl:1 row_mask:0xf bank_mask:0xf
    v_mov_b32_dpp v99, v3 row_shl:1 row_mask:0xf bank_mask:0xf
    v_mov_b32_dpp v100, v32 row_shl:1 row_mask:0xf bank_mask:0xf
    v_mov_b32_dpp v101, v33 row_shl:1 row_mask:0xf bank_mask:0xf
    v_mov_b32_dpp v102, v34 row_shl:1 row_mask:0xf bank_mask:0xf
    v_mov_b32_dpp v103, v35 row_shl:1 row_mask:0xf bank_mask:0xf
    v_pk_add_f32 v[72:73], v[72:73], v[96:97]
    v_pk_add_f32 v[74:75], v[74:75], v[98:99]
    v_pk_add_f32 v[76:77], v[76:77], v[100:101]
    v_pk_add_f32 v[78:79], v[78:79], v[102:103]
    v_cvt_pk_bf16_f32 v52, v72, v76
    v_cvt_pk_bf16_f32 v53, v73, v77
    v_cvt_pk_bf16_f32 v54, v74, v78
    v_cvt_pk_bf16_f32 v55, v75, v79
    s_mov_b32 s44, 65536
    buffer_store_dwordx4 v[52:55], v122, s[16:19], s44 offen sc1
    s_waitcnt lgkmcnt(2)
    v_mov_b32_dpp v104, v4 row_shl:1 row_mask:0xf bank_mask:0xf
    v_mov_b32_dpp v105, v5 row_shl:1 row_mask:0xf bank_mask:0xf
    v_mov_b32_dpp v106, v6 row_shl:1 row_mask:0xf bank_mask:0xf
    v_mov_b32_dpp v107, v7 row_shl:1 row_mask:0xf bank_mask:0xf
    v_mov_b32_dpp v108, v36 row_shl:1 row_mask:0xf bank_mask:0xf
    v_mov_b32_dpp v109, v37 row_shl:1 row_mask:0xf bank_mask:0xf
    v_mov_b32_dpp v110, v38 row_shl:1 row_mask:0xf bank_mask:0xf
    v_mov_b32_dpp v111, v39 row_shl:1 row_mask:0xf bank_mask:0xf
    v_pk_add_f32 v[80:81], v[80:81], v[104:105]
    v_pk_add_f32 v[82:83], v[82:83], v[106:107]
    v_pk_add_f32 v[84:85], v[84:85], v[108:109]
    v_pk_add_f32 v[86:87], v[86:87], v[110:111]
    v_cvt_pk_bf16_f32 v56, v80, v84
    v_cvt_pk_bf16_f32 v57, v81, v85
    v_cvt_pk_bf16_f32 v58, v82, v86
    v_cvt_pk_bf16_f32 v59, v83, v87
    s_mov_b32 s44, 131072
    buffer_store_dwordx4 v[56:59], v122, s[16:19], s44 offen sc1
    s_waitcnt lgkmcnt(0)
    v_mov_b32_dpp v112, v8 row_shl:1 row_mask:0xf bank_mask:0xf
    v_mov_b32_dpp v113, v9 row_shl:1 row_mask:0xf bank_mask:0xf
    v_mov_b32_dpp v114, v10 row_shl:1 row_mask:0xf bank_mask:0xf
    v_mov_b32_dpp v115, v11 row_shl:1 row_mask:0xf bank_mask:0xf
    v_mov_b32_dpp v116, v40 row_shl:1 row_mask:0xf bank_mask:0xf
    v_mov_b32_dpp v117, v41 row_shl:1 row_mask:0xf bank_mask:0xf
    v_mov_b32_dpp v118, v42 row_shl:1 row_mask:0xf bank_mask:0xf
    v_mov_b32_dpp v119, v43 row_shl:1 row_mask:0xf bank_mask:0xf
    v_pk_add_f32 v[88:89], v[88:89], v[112:113]
    v_pk_add_f32 v[90:91], v[90:91], v[114:115]
    v_pk_add_f32 v[92:93], v[92:93], v[116:117]
    v_pk_add_f32 v[94:95], v[94:95], v[118:119]
    v_cvt_pk_bf16_f32 v60, v88, v92
    v_cvt_pk_bf16_f32 v61, v89, v93
    v_cvt_pk_bf16_f32 v62, v90, v94
    v_cvt_pk_bf16_f32 v63, v91, v95
    s_mov_b32 s44, 196608
    buffer_store_dwordx4 v[60:63], v122, s[16:19], s44 offen sc1
L_conv2_kernel_end:
L_conv2_kernel_done:
    s_endpgm
.globl joint_kernel
.p2align 8
.type joint_kernel,@function
joint_kernel:
    s_cmp_ge_u32 s2, 250
    s_cbranch_scc1 L_joint_kernel_done
    s_load_dwordx2 s[28:29], s[0:1], 56
    s_load_dwordx2 s[30:31], s[0:1], 72
    v_readfirstlane_b32 s20, v0
    s_lshr_b32 s20, s20, 6
    s_and_b32 s21, s20, 7
    v_and_b32 v127, 63, v0
    v_lshlrev_b32 v126, 4, v127
    s_cmp_ge_u32 s20, 8
    s_mov_b32 s33, 44171264
    s_cselect_b32 s33, 44040192, s33
    s_lshl_b32 s36, s21, 14
    s_add_u32 s33, s33, s36
    s_mov_b32 s14, 16384
    s_mov_b32 s15, 0x00020000
    s_lshl_b32 s35, s2, 9
    s_cmp_ge_u32 s2, 125
    s_cselect_b32 s36, 2033152, 0
    s_cselect_b32 s34, 8192, 0
    s_add_u32 s35, s35, s36
    s_add_u32 s34, s34, 44302336
    s_mov_b32 s10, 12582912
    s_mov_b32 s11, 0x00020000
    s_mov_b32 s42, 24576
    s_mov_b32 s43, 0x00020000
    s_waitcnt lgkmcnt(0)
    s_add_u32 s12, s30, s33
    s_addc_u32 s13, s31, 0
    s_add_u32 s40, s30, s34
    s_addc_u32 s41, s31, 0
    s_cmp_ge_u32 s20, 8
    s_cbranch_scc1 L_joint_kernel_T
    s_add_u32 s8, s30, 27262976
    s_addc_u32 s9, s31, 0
    v_mov_b32 v0, 99456
    v_mov_b32 v2, 0
    v_mov_b32 v3, 0
    ds_write_b64 v0, v[2:3]
    v_lshrrev_b32 v124, 5, v127
    v_and_b32 v123, 0x1ff, v126
    v_mul_u32_u24 v125, 65536, v124
    v_add_u32 v123, v125, v123
    s_mul_i32 s36, s21, 262144
    s_add_u32 s36, s36, s35
    s_add_u32 s37, s36, 8388608
    buffer_load_dwordx4 v[64:67], v123, s[8:11], s36 offen
    buffer_load_dwordx4 v[72:75], v123, s[8:11], s37 offen
    s_add_u32 s36, s36, 131072
    s_add_u32 s37, s36, 8388608
    buffer_load_dwordx4 v[68:71], v123, s[8:11], s36 offen
    buffer_load_dwordx4 v[76:79], v123, s[8:11], s37 offen
    s_lshl_b32 s38, s21, 10
    s_add_u32 s38, s38, 16384
    buffer_load_dwordx4 v[80:83], v126, s[40:43], s38 offen
    s_waitcnt lgkmcnt(0)
    s_barrier
    s_lshl_b32 s35, s2, 17
    s_add_u32 s16, s28, s35
    s_addc_u32 s17, s29, 0
    s_mov_b32 s18, 131072
    s_mov_b32 s19, 0x00020000
    s_mov_b32 s46, 0xbdd2d3e8
    s_mov_b32 s47, s46
    v_mov_b32 v120, 0xc0135761
    v_mov_b32 v121, v120
    s_mov_b32 s48, 1.0
    s_mov_b32 s49, 1.0
    v_bfe_u32 v123, v127, 2, 3
    v_lshl_add_u32 v124, v123, 2, v124
    v_mul_u32_u24 v124, 528, v124
    v_and_b32 v123, 0x30, v126
    s_lshl_b32 s36, s21, 6
    v_add3_u32 v124, v124, v123, s36
    s_mov_b32 s45, 0xffff0000
    s_mul_i32 s36, s21, 1040
    s_add_u32 s36, s36, 91136
    v_add_u32 v123, s36, v126
    s_mov_b32 s22, 2
    s_waitcnt vmcnt(3)
L_joint_kernel_floop:
    v_lshlrev_b32 v88, 16, v64
    v_and_b32 v89, s45, v64
    v_lshlrev_b32 v96, 16, v72
    v_and_b32 v97, s45, v72
    v_lshlrev_b32 v90, 16, v65
    v_and_b32 v91, s45, v65
    v_lshlrev_b32 v98, 16, v73
    v_and_b32 v99, s45, v73
    v_lshlrev_b32 v92, 16, v66
    v_and_b32 v93, s45, v66
    v_lshlrev_b32 v100, 16, v74
    v_and_b32 v101, s45, v74
    v_lshlrev_b32 v94, 16, v67
    v_and_b32 v95, s45, v67
    v_lshlrev_b32 v102, 16, v75
    v_and_b32 v103, s45, v75
    v_pk_add_f32 v[88:89], v[88:89], v[96:97]
    v_pk_add_f32 v[90:91], v[90:91], v[98:99]
    v_pk_add_f32 v[92:93], v[92:93], v[100:101]
    v_pk_add_f32 v[94:95], v[94:95], v[102:103]
    v_pk_mul_f32 v[96:97], v[88:89], v[88:89]
    v_pk_mul_f32 v[98:99], v[90:91], v[90:91]
    v_pk_mul_f32 v[100:101], v[92:93], v[92:93]
    v_pk_mul_f32 v[102:103], v[94:95], v[94:95]
    v_pk_fma_f32 v[96:97], v[96:97], s[46:47], v[120:121]
    v_pk_fma_f32 v[98:99], v[98:99], s[46:47], v[120:121]
    v_pk_fma_f32 v[100:101], v[100:101], s[46:47], v[120:121]
    v_pk_fma_f32 v[102:103], v[102:103], s[46:47], v[120:121]
    v_pk_mul_f32 v[96:97], v[96:97], v[88:89]
    v_pk_mul_f32 v[98:99], v[98:99], v[90:91]
    v_pk_mul_f32 v[100:101], v[100:101], v[92:93]
    v_pk_mul_f32 v[102:103], v[102:103], v[94:95]
    v_exp_f32 v96, v96
    v_exp_f32 v97, v97
    v_exp_f32 v98, v98
    v_exp_f32 v99, v99
    v_exp_f32 v100, v100
    v_exp_f32 v101, v101
    v_exp_f32 v102, v102
    v_exp_f32 v103, v103
    v_pk_add_f32 v[96:97], v[96:97], s[48:49]
    v_pk_add_f32 v[98:99], v[98:99], s[48:49]
    v_pk_add_f32 v[100:101], v[100:101], s[48:49]
    v_pk_add_f32 v[102:103], v[102:103], s[48:49]
    v_rcp_f32 v96, v96
    v_rcp_f32 v97, v97
    v_rcp_f32 v98, v98
    v_rcp_f32 v99, v99
    v_rcp_f32 v100, v100
    v_rcp_f32 v101, v101
    v_rcp_f32 v102, v102
    v_rcp_f32 v103, v103
    v_pk_mul_f32 v[88:89], v[88:89], v[96:97]
    v_pk_mul_f32 v[90:91], v[90:91], v[98:99]
    v_pk_mul_f32 v[92:93], v[92:93], v[100:101]
    v_pk_mul_f32 v[94:95], v[94:95], v[102:103]
    v_cvt_pk_bf16_f32 v104, v88, v89
    v_cvt_pk_bf16_f32 v105, v90, v91
    v_cvt_pk_bf16_f32 v106, v92, v93
    v_cvt_pk_bf16_f32 v107, v94, v95
    ds_write_b128 v124, v[104:107] offset:32768
    s_waitcnt vmcnt(0)
    v_pk_mov_b32 v[64:65], v[68:69], v[68:69] op_sel:[0,1]
    v_pk_mov_b32 v[72:73], v[76:77], v[76:77] op_sel:[0,1]
    v_pk_mov_b32 v[66:67], v[70:71], v[70:71] op_sel:[0,1]
    v_pk_mov_b32 v[74:75], v[78:79], v[78:79] op_sel:[0,1]
    v_add_u32 v124, 1056, v124
    s_sub_u32 s22, s22, 1
    s_cmp_lg_u32 s22, 0
    s_cbranch_scc1 L_joint_kernel_floop
    ds_write_b128 v123, v[80:83]
    s_waitcnt lgkmcnt(0)
    v_mov_b32 v120, 99456
    v_mov_b32 v121, 1
    s_mov_b64 exec, 1
    ds_add_u32 v120, v121 offset:0
    s_mov_b64 exec, -1
L_joint_kernel_ow:
    ds_read_b32 v121, v120 offset:4
    s_waitcnt lgkmcnt(0)
    v_readfirstlane_b32 s37, v121
    s_cmp_ge_u32 s37, 8
    s_cbranch_scc1 L_joint_kernel_ow_d
    s_sleep 1
    s_branch L_joint_kernel_ow
L_joint_kernel_ow_d:
    s_mov_b32 s36, 0
    buffer_load_dwordx4 v[0:3], v126, s[12:15], s36 offen offset:0
    buffer_load_dwordx4 v[4:7], v126, s[12:15], s36 offen offset:1024
    buffer_load_dwordx4 v[8:11], v126, s[12:15], s36 offen offset:2048
    buffer_load_dwordx4 v[12:15], v126, s[12:15], s36 offen offset:3072
    s_mov_b32 s36, 4096
    buffer_load_dwordx4 v[16:19], v126, s[12:15], s36 offen offset:0
    buffer_load_dwordx4 v[20:23], v126, s[12:15], s36 offen offset:1024
    buffer_load_dwordx4 v[24:27], v126, s[12:15], s36 offen offset:2048
    buffer_load_dwordx4 v[28:31], v126, s[12:15], s36 offen offset:3072
    s_mov_b32 s36, 8192
    buffer_load_dwordx4 v[32:35], v126, s[12:15], s36 offen offset:0
    buffer_load_dwordx4 v[36:39], v126, s[12:15], s36 offen offset:1024
    buffer_load_dwordx4 v[40:43], v126, s[12:15], s36 offen offset:2048
    buffer_load_dwordx4 v[44:47], v126, s[12:15], s36 offen offset:3072
    s_mov_b32 s36, 12288
    buffer_load_dwordx4 v[48:51], v126, s[12:15], s36 offen offset:0
    buffer_load_dwordx4 v[52:55], v126, s[12:15], s36 offen offset:1024
    buffer_load_dwordx4 v[56:59], v126, s[12:15], s36 offen offset:2048
    buffer_load_dwordx4 v[60:63], v126, s[12:15], s36 offen offset:3072
    v_lshrrev_b32 v125, 4, v127
    v_lshlrev_b32 v125, 11, v125
    v_and_b32 v124, 15, v127
    v_lshl_add_u32 v125, v124, 2, v125
    s_lshl_b32 s36, s21, 6
    v_add_u32 v125, s36, v125
    s_mov_b32 s44, 8192
    s_setprio 1
    s_barrier
    ds_read_b128 v[96:99], v126 offset:0
    ds_read_b128 v[100:103], v126 offset:1024
    ds_read_b128 v[104:107], v126 offset:2048
    ds_read_b128 v[108:111], v126 offset:3072
    s_waitcnt vmcnt(14) lgkmcnt(3)
    v_mfma_f32_16x16x32_bf16 v[64:67], v[96:99], v[0:3], 0
    v_mfma_f32_16x16x32_bf16 v[68:71], v[96:99], v[4:7], 0
    ds_read_b128 v[96:99], v126 offset:4096
    s_waitcnt lgkmcnt(3)
    v_mfma_f32_16x16x32_bf16 v[72:75], v[100:103], v[0:3], 0
    v_mfma_f32_16x16x32_bf16 v[76:79], v[100:103], v[4:7], 0
    ds_read_b128 v[100:103], v126 offset:5120
    s_waitcnt vmcnt(12) lgkmcnt(3)
    v_mfma_f32_16x16x32_bf16 v[64:67], v[104:107], v[8:11], v[64:67]
    v_mfma_f32_16x16x32_bf16 v[68:71], v[104:107], v[12:15], v[68:71]
    ds_read_b128 v[104:107], v126 offset:6144
    s_waitcnt lgkmcnt(3)
    v_mfma_f32_16x16x32_bf16 v[72:75], v[108:111], v[8:11], v[72:75]
    v_mfma_f32_16x16x32_bf16 v[76:79], v[108:111], v[12:15], v[76:79]
    ds_read_b128 v[108:111], v126 offset:7168
    s_waitcnt vmcnt(10) lgkmcnt(3)
    v_mfma_f32_16x16x32_bf16 v[64:67], v[96:99], v[16:19], v[64:67]
    v_mfma_f32_16x16x32_bf16 v[68:71], v[96:99], v[20:23], v[68:71]
    ds_read_b128 v[96:99], v126 offset:8192
    s_waitcnt lgkmcnt(3)
    v_mfma_f32_16x16x32_bf16 v[72:75], v[100:103], v[16:19], v[72:75]
    v_mfma_f32_16x16x32_bf16 v[76:79], v[100:103], v[20:23], v[76:79]
    ds_read_b128 v[100:103], v126 offset:9216
    s_waitcnt vmcnt(8) lgkmcnt(3)
    v_mfma_f32_16x16x32_bf16 v[64:67], v[104:107], v[24:27], v[64:67]
    v_mfma_f32_16x16x32_bf16 v[68:71], v[104:107], v[28:31], v[68:71]
    ds_read_b128 v[104:107], v126 offset:10240
    s_waitcnt lgkmcnt(3)
    v_mfma_f32_16x16x32_bf16 v[72:75], v[108:111], v[24:27], v[72:75]
    v_mfma_f32_16x16x32_bf16 v[76:79], v[108:111], v[28:31], v[76:79]
    ds_read_b128 v[108:111], v126 offset:11264
    s_waitcnt vmcnt(6) lgkmcnt(3)
    v_mfma_f32_16x16x32_bf16 v[64:67], v[96:99], v[32:35], v[64:67]
    v_mfma_f32_16x16x32_bf16 v[68:71], v[96:99], v[36:39], v[68:71]
    ds_read_b128 v[96:99], v126 offset:12288
    s_waitcnt lgkmcnt(3)
    v_mfma_f32_16x16x32_bf16 v[72:75], v[100:103], v[32:35], v[72:75]
    v_mfma_f32_16x16x32_bf16 v[76:79], v[100:103], v[36:39], v[76:79]
    ds_read_b128 v[100:103], v126 offset:13312
    s_waitcnt vmcnt(4) lgkmcnt(3)
    v_mfma_f32_16x16x32_bf16 v[64:67], v[104:107], v[40:43], v[64:67]
    v_mfma_f32_16x16x32_bf16 v[68:71], v[104:107], v[44:47], v[68:71]
    ds_read_b128 v[104:107], v126 offset:14336
    s_waitcnt lgkmcnt(3)
    v_mfma_f32_16x16x32_bf16 v[72:75], v[108:111], v[40:43], v[72:75]
    v_mfma_f32_16x16x32_bf16 v[76:79], v[108:111], v[44:47], v[76:79]
    ds_read_b128 v[108:111], v126 offset:15360
    s_waitcnt vmcnt(2) lgkmcnt(3)
    v_mfma_f32_16x16x32_bf16 v[64:67], v[96:99], v[48:51], v[64:67]
    v_mfma_f32_16x16x32_bf16 v[68:71], v[96:99], v[52:55], v[68:71]
    s_waitcnt lgkmcnt(0)
    s_barrier
    ds_read_b128 v[96:99], v126 offset:16384
    v_mfma_f32_16x16x32_bf16 v[72:75], v[100:103], v[48:51], v[72:75]
    v_mfma_f32_16x16x32_bf16 v[76:79], v[100:103], v[52:55], v[76:79]
    ds_read_b128 v[100:103], v126 offset:17408
    s_waitcnt vmcnt(0)
    v_mfma_f32_16x16x32_bf16 v[64:67], v[104:107], v[56:59], v[64:67]
    v_mfma_f32_16x16x32_bf16 v[68:71], v[104:107], v[60:63], v[68:71]
    ds_read_b128 v[104:107], v126 offset:18432
    v_mfma_f32_16x16x32_bf16 v[72:75], v[108:111], v[56:59], v[72:75]
    v_mfma_f32_16x16x32_bf16 v[76:79], v[108:111], v[60:63], v[76:79]
    ds_read_b128 v[108:111], v126 offset:19456
    s_mov_b32 s22, 4
L_joint_kernel_oloop:
    s_waitcnt lgkmcnt(3)
    v_mfma_f32_16x16x32_bf16 v[80:83], v[96:99], v[0:3], 0
    v_mfma_f32_16x16x32_bf16 v[84:87], v[96:99], v[4:7], 0
    ds_read_b128 v[96:99], v126 offset:20480
    s_waitcnt lgkmcnt(3)
    v_mfma_f32_16x16x32_bf16 v[88:91], v[100:103], v[0:3], 0
    v_mfma_f32_16x16x32_bf16 v[92:95], v[100:103], v[4:7], 0
    ds_read_b128 v[100:103], v126 offset:21504
    s_waitcnt lgkmcnt(3)
    v_mfma_f32_16x16x32_bf16 v[80:83], v[104:107], v[8:11], v[80:83]
    v_mfma_f32_16x16x32_bf16 v[84:87], v[104:107], v[12:15], v[84:87]
    ds_read_b128 v[104:107], v126 offset:22528
    s_waitcnt lgkmcnt(3)
    v_mfma_f32_16x16x32_bf16 v[88:91], v[108:111], v[8:11], v[88:91]
    v_cvt_pk_bf16_f32 v112, v64, v68
    v_mfma_f32_16x16x32_bf16 v[92:95], v[108:111], v[12:15], v[92:95]
    buffer_store_dword v112, v125, s[16:19], 0 offen offset:0 nt
    ds_read_b128 v[108:111], v126 offset:23552
    s_waitcnt lgkmcnt(3)
    v_mfma_f32_16x16x32_bf16 v[80:83], v[96:99], v[16:19], v[80:83]
    v_cvt_pk_bf16_f32 v113, v65, v69
    v_mfma_f32_16x16x32_bf16 v[84:87], v[96:99], v[20:23], v[84:87]
    buffer_store_dword v113, v125, s[16:19], 0 offen offset:512 nt
    ds_read_b128 v[96:99], v126 offset:24576
    s_waitcnt lgkmcnt(3)
    v_mfma_f32_16x16x32_bf16 v[88:91], v[100:103], v[16:19], v[88:91]
    v_cvt_pk_bf16_f32 v114, v66, v70
    v_mfma_f32_16x16x32_bf16 v[92:95], v[100:103], v[20:23], v[92:95]
    buffer_store_dword v114, v125, s[16:19], 0 offen offset:1024 nt
    ds_read_b128 v[100:103], v126 offset:25600
    s_waitcnt lgkmcnt(3)
    v_mfma_f32_16x16x32_bf16 v[80:83], v[104:107], v[24:27], v[80:83]
    v_cvt_pk_bf16_f32 v115, v67, v71
    v_mfma_f32_16x16x32_bf16 v[84:87], v[104:107], v[28:31], v[84:87]
    buffer_store_dword v115, v125, s[16:19], 0 offen offset:1536 nt
    ds_read_b128 v[104:107], v126 offset:26624
    s_waitcnt lgkmcnt(3)
    v_mfma_f32_16x16x32_bf16 v[88:91], v[108:111], v[24:27], v[88:91]
    v_cvt_pk_bf16_f32 v116, v72, v76
    v_mfma_f32_16x16x32_bf16 v[92:95], v[108:111], v[28:31], v[92:95]
    buffer_store_dword v116, v125, s[16:19], s44 offen offset:0 nt
    ds_read_b128 v[108:111], v126 offset:27648
    s_waitcnt lgkmcnt(3)
    v_mfma_f32_16x16x32_bf16 v[80:83], v[96:99], v[32:35], v[80:83]
    v_cvt_pk_bf16_f32 v117, v73, v77
    v_mfma_f32_16x16x32_bf16 v[84:87], v[96:99], v[36:39], v[84:87]
    buffer_store_dword v117, v125, s[16:19], s44 offen offset:512 nt
    ds_read_b128 v[96:99], v126 offset:28672
    s_waitcnt lgkmcnt(3)
    v_mfma_f32_16x16x32_bf16 v[88:91], v[100:103], v[32:35], v[88:91]
    v_cvt_pk_bf16_f32 v118, v74, v78
    v_mfma_f32_16x16x32_bf16 v[92:95], v[100:103], v[36:39], v[92:95]
    buffer_store_dword v118, v125, s[16:19], s44 offen offset:1024 nt
    ds_read_b128 v[100:103], v126 offset:29696
    s_waitcnt lgkmcnt(3)
    v_mfma_f32_16x16x32_bf16 v[80:83], v[104:107], v[40:43], v[80:83]
    v_cvt_pk_bf16_f32 v119, v75, v79
    v_mfma_f32_16x16x32_bf16 v[84:87], v[104:107], v[44:47], v[84:87]
    buffer_store_dword v119, v125, s[16:19], s44 offen offset:1536 nt
    ds_read_b128 v[104:107], v126 offset:30720
    s_waitcnt lgkmcnt(3)
    v_mfma_f32_16x16x32_bf16 v[88:91], v[108:111], v[40:43], v[88:91]
    v_add_u32 v125, 16384, v125
    v_mfma_f32_16x16x32_bf16 v[92:95], v[108:111], v[44:47], v[92:95]
    ds_read_b128 v[108:111], v126 offset:31744
    s_waitcnt lgkmcnt(3)
    v_mfma_f32_16x16x32_bf16 v[80:83], v[96:99], v[48:51], v[80:83]
    v_mfma_f32_16x16x32_bf16 v[84:87], v[96:99], v[52:55], v[84:87]
    s_waitcnt lgkmcnt(0)
    s_barrier
    ds_read_b128 v[96:99], v126 offset:0
    v_mfma_f32_16x16x32_bf16 v[88:91], v[100:103], v[48:51], v[88:91]
    v_mfma_f32_16x16x32_bf16 v[92:95], v[100:103], v[52:55], v[92:95]
    ds_read_b128 v[100:103], v126 offset:1024
    v_mfma_f32_16x16x32_bf16 v[80:83], v[104:107], v[56:59], v[80:83]
    v_mfma_f32_16x16x32_bf16 v[84:87], v[104:107], v[60:63], v[84:87]
    ds_read_b128 v[104:107], v126 offset:2048
    v_mfma_f32_16x16x32_bf16 v[88:91], v[108:111], v[56:59], v[88:91]
    v_mfma_f32_16x16x32_bf16 v[92:95], v[108:111], v[60:63], v[92:95]
    ds_read_b128 v[108:111], v126 offset:3072
    s_sub_u32 s22, s22, 1
    s_cmp_eq_u32 s22, 0
    s_cbranch_scc1 L_joint_kernel_oend
    s_waitcnt lgkmcnt(3)
    v_mfma_f32_16x16x32_bf16 v[64:67], v[96:99], v[0:3], 0
    v_mfma_f32_16x16x32_bf16 v[68:71], v[96:99], v[4:7], 0
    ds_read_b128 v[96:99], v126 offset:4096
    s_waitcnt lgkmcnt(3)
    v_mfma_f32_16x16x32_bf16 v[72:75], v[100:103], v[0:3], 0
    v_mfma_f32_16x16x32_bf16 v[76:79], v[100:103], v[4:7], 0
    ds_read_b128 v[100:103], v126 offset:5120
    s_waitcnt lgkmcnt(3)
    v_mfma_f32_16x16x32_bf16 v[64:67], v[104:107], v[8:11], v[64:67]
    v_mfma_f32_16x16x32_bf16 v[68:71], v[104:107], v[12:15], v[68:71]
    ds_read_b128 v[104:107], v126 offset:6144
    s_waitcnt lgkmcnt(3)
    v_mfma_f32_16x16x32_bf16 v[72:75], v[108:111], v[8:11], v[72:75]
    v_cvt_pk_bf16_f32 v112, v80, v84
    v_mfma_f32_16x16x32_bf16 v[76:79], v[108:111], v[12:15], v[76:79]
    buffer_store_dword v112, v125, s[16:19], 0 offen offset:0 nt
    ds_read_b128 v[108:111], v126 offset:7168
    s_waitcnt lgkmcnt(3)
    v_mfma_f32_16x16x32_bf16 v[64:67], v[96:99], v[16:19], v[64:67]
    v_cvt_pk_bf16_f32 v113, v81, v85
    v_mfma_f32_16x16x32_bf16 v[68:71], v[96:99], v[20:23], v[68:71]
    buffer_store_dword v113, v125, s[16:19], 0 offen offset:512 nt
    ds_read_b128 v[96:99], v126 offset:8192
    s_waitcnt lgkmcnt(3)
    v_mfma_f32_16x16x32_bf16 v[72:75], v[100:103], v[16:19], v[72:75]
    v_cvt_pk_bf16_f32 v114, v82, v86
    v_mfma_f32_16x16x32_bf16 v[76:79], v[100:103], v[20:23], v[76:79]
    buffer_store_dword v114, v125, s[16:19], 0 offen offset:1024 nt
    ds_read_b128 v[100:103], v126 offset:9216
    s_waitcnt lgkmcnt(3)
    v_mfma_f32_16x16x32_bf16 v[64:67], v[104:107], v[24:27], v[64:67]
    v_cvt_pk_bf16_f32 v115, v83, v87
    v_mfma_f32_16x16x32_bf16 v[68:71], v[104:107], v[28:31], v[68:71]
    buffer_store_dword v115, v125, s[16:19], 0 offen offset:1536 nt
    ds_read_b128 v[104:107], v126 offset:10240
    s_waitcnt lgkmcnt(3)
    v_mfma_f32_16x16x32_bf16 v[72:75], v[108:111], v[24:27], v[72:75]
    v_cvt_pk_bf16_f32 v116, v88, v92
    v_mfma_f32_16x16x32_bf16 v[76:79], v[108:111], v[28:31], v[76:79]
    buffer_store_dword v116, v125, s[16:19], s44 offen offset:0 nt
    ds_read_b128 v[108:111], v126 offset:11264
    s_waitcnt lgkmcnt(3)
    v_mfma_f32_16x16x32_bf16 v[64:67], v[96:99], v[32:35], v[64:67]
    v_cvt_pk_bf16_f32 v117, v89, v93
    v_mfma_f32_16x16x32_bf16 v[68:71], v[96:99], v[36:39], v[68:71]
    buffer_store_dword v117, v125, s[16:19], s44 offen offset:512 nt
    ds_read_b128 v[96:99], v126 offset:12288
    s_waitcnt lgkmcnt(3)
    v_mfma_f32_16x16x32_bf16 v[72:75], v[100:103], v[32:35], v[72:75]
    v_cvt_pk_bf16_f32 v118, v90, v94
    v_mfma_f32_16x16x32_bf16 v[76:79], v[100:103], v[36:39], v[76:79]
    buffer_store_dword v118, v125, s[16:19], s44 offen offset:1024 nt
    ds_read_b128 v[100:103], v126 offset:13312
    s_waitcnt lgkmcnt(3)
    v_mfma_f32_16x16x32_bf16 v[64:67], v[104:107], v[40:43], v[64:67]
    v_cvt_pk_bf16_f32 v119, v91, v95
    v_mfma_f32_16x16x32_bf16 v[68:71], v[104:107], v[44:47], v[68:71]
    buffer_store_dword v119, v125, s[16:19], s44 offen offset:1536 nt
    ds_read_b128 v[104:107], v126 offset:14336
    s_waitcnt lgkmcnt(3)
    v_mfma_f32_16x16x32_bf16 v[72:75], v[108:111], v[40:43], v[72:75]
    v_add_u32 v125, 16384, v125
    v_mfma_f32_16x16x32_bf16 v[76:79], v[108:111], v[44:47], v[76:79]
    ds_read_b128 v[108:111], v126 offset:15360
    s_waitcnt lgkmcnt(3)
    v_mfma_f32_16x16x32_bf16 v[64:67], v[96:99], v[48:51], v[64:67]
    v_mfma_f32_16x16x32_bf16 v[68:71], v[96:99], v[52:55], v[68:71]
    s_waitcnt lgkmcnt(0)
    s_barrier
    ds_read_b128 v[96:99], v126 offset:16384
    v_mfma_f32_16x16x32_bf16 v[72:75], v[100:103], v[48:51], v[72:75]
    v_mfma_f32_16x16x32_bf16 v[76:79], v[100:103], v[52:55], v[76:79]
    ds_read_b128 v[100:103], v126 offset:17408
    v_mfma_f32_16x16x32_bf16 v[64:67], v[104:107], v[56:59], v[64:67]
    v_mfma_f32_16x16x32_bf16 v[68:71], v[104:107], v[60:63], v[68:71]
    ds_read_b128 v[104:107], v126 offset:18432
    v_mfma_f32_16x16x32_bf16 v[72:75], v[108:111], v[56:59], v[72:75]
    v_mfma_f32_16x16x32_bf16 v[76:79], v[108:111], v[60:63], v[76:79]
    ds_read_b128 v[108:111], v126 offset:19456
    s_waitcnt vmcnt(32)
    s_branch L_joint_kernel_oloop
L_joint_kernel_oend:
    s_nop 7
    v_cvt_pk_bf16_f32 v112, v80, v84
    buffer_store_dword v112, v125, s[16:19], 0 offen offset:0 nt
    v_cvt_pk_bf16_f32 v113, v81, v85
    buffer_store_dword v113, v125, s[16:19], 0 offen offset:512 nt
    v_cvt_pk_bf16_f32 v114, v82, v86
    buffer_store_dword v114, v125, s[16:19], 0 offen offset:1024 nt
    v_cvt_pk_bf16_f32 v115, v83, v87
    buffer_store_dword v115, v125, s[16:19], 0 offen offset:1536 nt
    v_cvt_pk_bf16_f32 v116, v88, v92
    buffer_store_dword v116, v125, s[16:19], s44 offen offset:0 nt
    v_cvt_pk_bf16_f32 v117, v89, v93
    buffer_store_dword v117, v125, s[16:19], s44 offen offset:512 nt
    v_cvt_pk_bf16_f32 v118, v90, v94
    buffer_store_dword v118, v125, s[16:19], s44 offen offset:1024 nt
    v_cvt_pk_bf16_f32 v119, v91, v95
    buffer_store_dword v119, v125, s[16:19], s44 offen offset:1536 nt
    v_add_u32 v125, 16384, v125
    s_branch L_joint_kernel_fin
L_joint_kernel_T:
    s_setprio 3
    s_lshl_b32 s36, s21, 2
    s_add_u32 s36, s36, 44335104
    s_add_u32 s36, s30, s36
    s_addc_u32 s37, s31, 0
    s_load_dword s44, s[36:37], 0
    v_and_b32 v123, 15, v127
    v_lshrrev_b32 v121, 4, v127
    v_mul_u32_u24 v125, 528, v123
    v_lshl_add_u32 v125, v121, 4, v125
    v_lshlrev_b32 v121, 5, v121
    v_and_b32 v120, 7, v127
    v_lshl_add_u32 v124, v120, 10, v121
    s_lshl_b32 s38, s21, 7
    v_mul_u32_u24 v120, 1040, v120
    s_add_u32 s36, s38, 91136
    v_add3_u32 v120, v120, v121, s36
    s_mul_i32 s36, s21, 5184
    s_add_u32 s36, s36, 49664
    v_add_u32 v121, s36, v121
    v_mul_u32_u24 v122, 144, v123
    v_add_u32 v122, v122, v121
    v_lshrrev_b32 v123, 3, v123
    v_mul_u32_u24 v123, 144, v123
    v_add_u32 v121, v123, v121
    s_lshl_b32 s36, s21, 11
    v_add_u32 v123, s36, v126
    s_barrier
    s_mov_b32 s36, 0
    buffer_load_dwordx4 v[0:3], v126, s[12:15], s36 offen offset:0
    buffer_load_dwordx4 v[4:7], v126, s[12:15], s36 offen offset:1024
    buffer_load_dwordx4 v[8:11], v126, s[12:15], s36 offen offset:2048
    buffer_load_dwordx4 v[12:15], v126, s[12:15], s36 offen offset:3072
    s_mov_b32 s36, 4096
    buffer_load_dwordx4 v[16:19], v126, s[12:15], s36 offen offset:0
    buffer_load_dwordx4 v[20:23], v126, s[12:15], s36 offen offset:1024
    buffer_load_dwordx4 v[24:27], v126, s[12:15], s36 offen offset:2048
    buffer_load_dwordx4 v[28:31], v126, s[12:15], s36 offen offset:3072
    s_mov_b32 s36, 8192
    buffer_load_dwordx4 v[32:35], v126, s[12:15], s36 offen offset:0
    buffer_load_dwordx4 v[36:39], v126, s[12:15], s36 offen offset:1024
    buffer_load_dwordx4 v[40:43], v126, s[12:15], s36 offen offset:2048
    buffer_load_dwordx4 v[44:47], v126, s[12:15], s36 offen offset:3072
    s_mov_b32 s36, 12288
    buffer_load_dwordx4 v[48:51], v126, s[12:15], s36 offen offset:0
    buffer_load_dwordx4 v[52:55], v126, s[12:15], s36 offen offset:1024
    buffer_load_dwordx4 v[56:59], v126, s[12:15], s36 offen offset:2048
    buffer_load_dwordx4 v[60:63], v126, s[12:15], s36 offen offset:3072
    v_mov_b32 v64, 99456
    v_mov_b32 v65, 1
    s_mov_b64 exec, 1
    ds_add_u32 v64, v65 offset:4
    s_mov_b64 exec, -1
L_joint_kernel_tw:
    ds_read_b32 v65, v64 offset:0
    s_waitcnt lgkmcnt(0)
    v_readfirstlane_b32 s37, v65
    s_cmp_ge_u32 s37, 8
    s_cbranch_scc1 L_joint_kernel_tw_d
    s_sleep 1
    s_branch L_joint_kernel_tw
L_joint_kernel_tw_d:
    ds_read_b128 v[80:83], v125 offset:32768
    ds_read_b128 v[84:87], v125 offset:41216
    ds_read_b128 v[88:91], v125 offset:32832
    ds_read_b128 v[92:95], v125 offset:41280
    ds_read_b128 v[96:99], v125 offset:32896
    ds_read_b128 v[100:103], v125 offset:41344
    ds_read_b128 v[104:107], v125 offset:32960
    ds_read_b128 v[108:111], v125 offset:41408
    s_setprio 0
    s_waitcnt vmcnt(14) lgkmcnt(7)
    v_mfma_f32_16x16x32_bf16 v[64:67], v[0:3], v[80:83], 0
    v_mfma_f32_16x16x32_bf16 v[68:71], v[4:7], v[80:83], 0
    ds_read_b128 v[80:83], v125 offset:33024
    s_waitcnt lgkmcnt(7)
    v_mfma_f32_16x16x32_bf16 v[72:75], v[0:3], v[84:87], 0
    v_mfma_f32_16x16x32_bf16 v[76:79], v[4:7], v[84:87], 0
    ds_read_b128 v[84:87], v125 offset:41472
    s_waitcnt vmcnt(12) lgkmcnt(7)
    v_mfma_f32_16x16x32_bf16 v[64:67], v[8:11], v[88:91], v[64:67]
    v_mfma_f32_16x16x32_bf16 v[68:71], v[12:15], v[88:91], v[68:71]
    ds_read_b128 v[88:91], v125 offset:33088
    s_waitcnt lgkmcnt(7)
    v_mfma_f32_16x16x32_bf16 v[72:75], v[8:11], v[92:95], v[72:75]
    v_mfma_f32_16x16x32_bf16 v[76:79], v[12:15], v[92:95], v[76:79]
    ds_read_b128 v[92:95], v125 offset:41536
    s_waitcnt vmcnt(10) lgkmcnt(7)
    v_mfma_f32_16x16x32_bf16 v[64:67], v[16:19], v[96:99], v[64:67]
    v_mfma_f32_16x16x32_bf16 v[68:71], v[20:23], v[96:99], v[68:71]
    ds_read_b128 v[96:99], v125 offset:33152
    s_waitcnt lgkmcnt(7)
    v_mfma_f32_16x16x32_bf16 v[72:75], v[16:19], v[100:103], v[72:75]
    v_mfma_f32_16x16x32_bf16 v[76:79], v[20:23], v[100:103], v[76:79]
    ds_read_b128 v[100:103], v125 offset:41600
    s_waitcnt vmcnt(8) lgkmcnt(7)
    v_mfma_f32_16x16x32_bf16 v[64:67], v[24:27], v[104:107], v[64:67]
    v_mfma_f32_16x16x32_bf16 v[68:71], v[28:31], v[104:107], v[68:71]
    ds_read_b128 v[104:107], v125 offset:33216
    s_waitcnt lgkmcnt(7)
    v_mfma_f32_16x16x32_bf16 v[72:75], v[24:27], v[108:111], v[72:75]
    v_mfma_f32_16x16x32_bf16 v[76:79], v[28:31], v[108:111], v[76:79]
    ds_read_b128 v[108:111], v125 offset:41664
    s_waitcnt vmcnt(6) lgkmcnt(7)
    v_mfma_f32_16x16x32_bf16 v[64:67], v[32:35], v[80:83], v[64:67]
    v_mfma_f32_16x16x32_bf16 v[68:71], v[36:39], v[80:83], v[68:71]
    ds_read_b128 v[112:115], v120 offset:0
    s_waitcnt lgkmcnt(7)
    v_mfma_f32_16x16x32_bf16 v[72:75], v[32:35], v[84:87], v[72:75]
    v_mfma_f32_16x16x32_bf16 v[76:79], v[36:39], v[84:87], v[76:79]
    ds_read_b128 v[116:119], v120 offset:16
    s_waitcnt vmcnt(4) lgkmcnt(7)
    v_mfma_f32_16x16x32_bf16 v[64:67], v[40:43], v[88:91], v[64:67]
    v_mfma_f32_16x16x32_bf16 v[68:71], v[44:47], v[88:91], v[68:71]
    s_waitcnt lgkmcnt(6)
    v_mfma_f32_16x16x32_bf16 v[72:75], v[40:43], v[92:95], v[72:75]
    v_mfma_f32_16x16x32_bf16 v[76:79], v[44:47], v[92:95], v[76:79]
    s_waitcnt vmcnt(2) lgkmcnt(5)
    v_mfma_f32_16x16x32_bf16 v[64:67], v[48:51], v[96:99], v[64:67]
    v_mfma_f32_16x16x32_bf16 v[68:71], v[52:55], v[96:99], v[68:71]
    s_waitcnt lgkmcnt(4)
    v_mfma_f32_16x16x32_bf16 v[72:75], v[48:51], v[100:103], v[72:75]
    v_mfma_f32_16x16x32_bf16 v[76:79], v[52:55], v[100:103], v[76:79]
    s_waitcnt vmcnt(0) lgkmcnt(3)
    v_mfma_f32_16x16x32_bf16 v[64:67], v[56:59], v[104:107], v[64:67]
    v_mfma_f32_16x16x32_bf16 v[68:71], v[60:63], v[104:107], v[68:71]
    s_waitcnt lgkmcnt(2)
    v_mfma_f32_16x16x32_bf16 v[72:75], v[56:59], v[108:111], v[72:75]
    v_mfma_f32_16x16x32_bf16 v[76:79], v[60:63], v[108:111], v[76:79]
    s_mov_b32 s46, 0xffff0000
    s_mov_b32 s48, 0x4038aa3b
    s_mov_b32 s49, s48
    s_nop 3
    v_mov_b32 v28, 0
    s_waitcnt lgkmcnt(0)
    v_cvt_pk_bf16_f32 v24, v64, v68
    v_cvt_pk_bf16_f32 v25, v65, v69
    v_cvt_pk_bf16_f32 v26, v66, v70
    v_cvt_pk_bf16_f32 v27, v67, v71
    v_lshlrev_b32 v80, 16, v24
    v_and_b32 v81, s46, v24
    v_lshlrev_b32 v82, 16, v25
    v_and_b32 v83, s46, v25
    v_lshlrev_b32 v84, 16, v26
    v_and_b32 v85, s46, v26
    v_lshlrev_b32 v86, 16, v27
    v_and_b32 v87, s46, v27
    v_pk_mul_f32 v[80:81], v[80:81], s[48:49]
    v_pk_mul_f32 v[82:83], v[82:83], s[48:49]
    v_pk_mul_f32 v[84:85], v[84:85], s[48:49]
    v_pk_mul_f32 v[86:87], v[86:87], s[48:49]
    v_exp_f32 v96, v80
    v_exp_f32 v97, v81
    v_exp_f32 v98, v82
    v_exp_f32 v99, v83
    v_max3_f32 v28, |v80|, |v81|, v28
    v_max3_f32 v28, |v82|, |v83|, v28
    ds_write_b128 v122, v[96:99] offset:0
    v_exp_f32 v100, v84
    v_exp_f32 v101, v85
    v_exp_f32 v102, v86
    v_exp_f32 v103, v87
    v_max3_f32 v28, |v84|, |v85|, v28
    v_max3_f32 v28, |v86|, |v87|, v28
    ds_write_b128 v122, v[100:103] offset:16
    v_cvt_pk_bf16_f32 v24, v72, v76
    v_cvt_pk_bf16_f32 v25, v73, v77
    v_cvt_pk_bf16_f32 v26, v74, v78
    v_cvt_pk_bf16_f32 v27, v75, v79
    v_lshlrev_b32 v88, 16, v24
    v_and_b32 v89, s46, v24
    v_lshlrev_b32 v90, 16, v25
    v_and_b32 v91, s46, v25
    v_lshlrev_b32 v92, 16, v26
    v_and_b32 v93, s46, v26
    v_lshlrev_b32 v94, 16, v27
    v_and_b32 v95, s46, v27
    v_pk_mul_f32 v[88:89], v[88:89], s[48:49]
    v_pk_mul_f32 v[90:91], v[90:91], s[48:49]
    v_pk_mul_f32 v[92:93], v[92:93], s[48:49]
    v_pk_mul_f32 v[94:95], v[94:95], s[48:49]
    v_exp_f32 v104, v88
    v_exp_f32 v105, v89
    v_exp_f32 v106, v90
    v_exp_f32 v107, v91
    v_max3_f32 v28, |v88|, |v89|, v28
    v_max3_f32 v28, |v90|, |v91|, v28
    ds_write_b128 v122, v[104:107] offset:2304
    v_exp_f32 v108, v92
    v_exp_f32 v109, v93
    v_exp_f32 v110, v94
    v_exp_f32 v111, v95
    v_max3_f32 v28, |v92|, |v93|, v28
    v_max3_f32 v28, |v94|, |v95|, v28
    ds_write_b128 v122, v[108:111] offset:2320
    v_cmp_lt_f32 vcc, 0x42f00000, v28
    s_mov_b32 s22, 4
    s_or_b32 s44, s44, vcc_lo
    s_or_b32 s44, s44, vcc_hi
    s_cmp_lg_u32 s44, 0
    s_cbranch_scc1 L_joint_kernel_tslow
    ds_read_b128 v[32:35], v121 offset:0
    ds_read_b128 v[36:39], v121 offset:16
    ds_read_b128 v[40:43], v121 offset:288
    ds_read_b128 v[44:47], v121 offset:304
    v_add_u32 v121, 576, v121
    s_waitcnt vmcnt(0) lgkmcnt(0)
L_joint_kernel_tloop1:
    v_fma_f32 v48, v112, v32, 1.0
    v_fma_f32 v49, v113, v33, 1.0
    v_fma_f32 v50, v114, v34, 1.0
    v_fma_f32 v51, v115, v35, 1.0
    v_fma_f32 v52, v116, v36, 1.0
    v_fma_f32 v53, v117, v37, 1.0
    v_fma_f32 v54, v118, v38, 1.0
    v_fma_f32 v55, v119, v39, 1.0
    v_fma_f32 v56, v112, v40, 1.0
    v_fma_f32 v57, v113, v41, 1.0
    v_fma_f32 v58, v114, v42, 1.0
    v_fma_f32 v59, v115, v43, 1.0
    v_fma_f32 v60, v116, v44, 1.0
    v_fma_f32 v61, v117, v45, 1.0
    v_fma_f32 v62, v118, v46, 1.0
    v_fma_f32 v63, v119, v47, 1.0
    ds_read_b128 v[32:35], v121 offset:0
    ds_read_b128 v[36:39], v121 offset:16
    ds_read_b128 v[40:43], v121 offset:288
    ds_read_b128 v[44:47], v121 offset:304
    v_add_u32 v121, 576, v121
    v_rcp_f32 v48, v48
    v_rcp_f32 v49, v49
    v_rcp_f32 v50, v50
    v_rcp_f32 v51, v51
    v_rcp_f32 v52, v52
    v_rcp_f32 v53, v53
    v_rcp_f32 v54, v54
    v_rcp_f32 v55, v55
    v_fma_f32 v48, v48, -2.0, 1.0
    v_fma_f32 v49, v49, -2.0, 1.0
    v_fma_f32 v50, v50, -2.0, 1.0
    v_fma_f32 v51, v51, -2.0, 1.0
    v_fma_f32 v52, v52, -2.0, 1.0
    v_fma_f32 v53, v53, -2.0, 1.0
    v_fma_f32 v54, v54, -2.0, 1.0
    v_fma_f32 v55, v55, -2.0, 1.0
    v_cvt_pk_bf16_f32 v64, v48, v49
    v_cvt_pk_bf16_f32 v65, v50, v51
    v_cvt_pk_bf16_f32 v66, v52, v53
    v_cvt_pk_bf16_f32 v67, v54, v55
    ds_write_b128 v123, v[64:67] offset:0
    v_rcp_f32 v56, v56
    v_rcp_f32 v57, v57
    v_rcp_f32 v58, v58
    v_rcp_f32 v59, v59
    v_rcp_f32 v60, v60
    v_rcp_f32 v61, v61
    v_rcp_f32 v62, v62
    v_rcp_f32 v63, v63
    v_fma_f32 v56, v56, -2.0, 1.0
    v_fma_f32 v57, v57, -2.0, 1.0
    v_fma_f32 v58, v58, -2.0, 1.0
    v_fma_f32 v59, v59, -2.0, 1.0
    v_fma_f32 v60, v60, -2.0, 1.0
    v_fma_f32 v61, v61, -2.0, 1.0
    v_fma_f32 v62, v62, -2.0, 1.0
    v_fma_f32 v63, v63, -2.0, 1.0
    v_cvt_pk_bf16_f32 v68, v56, v57
    v_cvt_pk_bf16_f32 v69, v58, v59
    v_cvt_pk_bf16_f32 v70, v60, v61
    v_cvt_pk_bf16_f32 v71, v62, v63
    ds_write_b128 v123, v[68:71] offset:1024
    s_waitcnt lgkmcnt(0)
    s_barrier
    v_fma_f32 v48, v112, v32, 1.0
    v_fma_f32 v49, v113, v33, 1.0
    v_fma_f32 v50, v114, v34, 1.0
    v_fma_f32 v51, v115, v35, 1.0
    v_fma_f32 v52, v116, v36, 1.0
    v_fma_f32 v53, v117, v37, 1.0
    v_fma_f32 v54, v118, v38, 1.0
    v_fma_f32 v55, v119, v39, 1.0
    v_fma_f32 v56, v112, v40, 1.0
    v_fma_f32 v57, v113, v41, 1.0
    v_fma_f32 v58, v114, v42, 1.0
    v_fma_f32 v59, v115, v43, 1.0
    v_fma_f32 v60, v116, v44, 1.0
    v_fma_f32 v61, v117, v45, 1.0
    v_fma_f32 v62, v118, v46, 1.0
    v_fma_f32 v63, v119, v47, 1.0
    ds_read_b128 v[32:35], v121 offset:0
    ds_read_b128 v[36:39], v121 offset:16
    ds_read_b128 v[40:43], v121 offset:288
    ds_read_b128 v[44:47], v121 offset:304
    v_add_u32 v121, 576, v121
    v_rcp_f32 v48, v48
    v_rcp_f32 v49, v49
    v_rcp_f32 v50, v50
    v_rcp_f32 v51, v51
    v_rcp_f32 v52, v52
    v_rcp_f32 v53, v53
    v_rcp_f32 v54, v54
    v_rcp_f32 v55, v55
    v_fma_f32 v48, v48, -2.0, 1.0
    v_fma_f32 v49, v49, -2.0, 1.0
    v_fma_f32 v50, v50, -2.0, 1.0
    v_fma_f32 v51, v51, -2.0, 1.0
    v_fma_f32 v52, v52, -2.0, 1.0
    v_fma_f32 v53, v53, -2.0, 1.0
    v_fma_f32 v54, v54, -2.0, 1.0
    v_fma_f32 v55, v55, -2.0, 1.0
    v_cvt_pk_bf16_f32 v64, v48, v49
    v_cvt_pk_bf16_f32 v65, v50, v51
    v_cvt_pk_bf16_f32 v66, v52, v53
    v_cvt_pk_bf16_f32 v67, v54, v55
    ds_write_b128 v123, v[64:67] offset:16384
    v_rcp_f32 v56, v56
    v_rcp_f32 v57, v57
    v_rcp_f32 v58, v58
    v_rcp_f32 v59, v59
    v_rcp_f32 v60, v60
    v_rcp_f32 v61, v61
    v_rcp_f32 v62, v62
    v_rcp_f32 v63, v63
    v_fma_f32 v56, v56, -2.0, 1.0
    v_fma_f32 v57, v57, -2.0, 1.0
    v_fma_f32 v58, v58, -2.0, 1.0
    v_fma_f32 v59, v59, -2.0, 1.0
    v_fma_f32 v60, v60, -2.0, 1.0
    v_fma_f32 v61, v61, -2.0, 1.0
    v_fma_f32 v62, v62, -2.0, 1.0
    v_fma_f32 v63, v63, -2.0, 1.0
    v_cvt_pk_bf16_f32 v68, v56, v57
    v_cvt_pk_bf16_f32 v69, v58, v59
    v_cvt_pk_bf16_f32 v70, v60, v61
    v_cvt_pk_bf16_f32 v71, v62, v63
    ds_write_b128 v123, v[68:71] offset:17408
    s_waitcnt lgkmcnt(0)
    s_barrier
    s_sub_u32 s22, s22, 1
    s_cmp_lg_u32 s22, 0
    s_cbranch_scc1 L_joint_kernel_tloop1
    s_branch L_joint_kernel_fin
L_joint_kernel_tslow:
    buffer_load_dwordx4 v[112:115], v124, s[40:43], s38 offen offset:0
    buffer_load_dwordx4 v[116:119], v124, s[40:43], s38 offen offset:16
    ds_write_b128 v122, v[80:83] offset:0
    ds_write_b128 v122, v[84:87] offset:16
    ds_write_b128 v122, v[88:91] offset:2304
    ds_write_b128 v122, v[92:95] offset:2320
    ds_read_b128 v[32:35], v121 offset:0
    ds_read_b128 v[36:39], v121 offset:16
    ds_read_b128 v[40:43], v121 offset:288
    ds_read_b128 v[44:47], v121 offset:304
    v_add_u32 v121, 576, v121
    s_waitcnt vmcnt(0) lgkmcnt(0)
L_joint_kernel_tloop0:
    v_add_f32 v48, v112, v32
    v_add_f32 v49, v113, v33
    v_add_f32 v50, v114, v34
    v_add_f32 v51, v115, v35
    v_add_f32 v52, v116, v36
    v_add_f32 v53, v117, v37
    v_add_f32 v54, v118, v38
    v_add_f32 v55, v119, v39
    v_add_f32 v56, v112, v40
    v_add_f32 v57, v113, v41
    v_add_f32 v58, v114, v42
    v_add_f32 v59, v115, v43
    v_add_f32 v60, v116, v44
    v_add_f32 v61, v117, v45
    v_add_f32 v62, v118, v46
    v_add_f32 v63, v119, v47
    ds_read_b128 v[32:35], v121 offset:0
    ds_read_b128 v[36:39], v121 offset:16
    ds_read_b128 v[40:43], v121 offset:288
    ds_read_b128 v[44:47], v121 offset:304
    v_add_u32 v121, 576, v121
    v_exp_f32 v48, v48
    v_exp_f32 v49, v49
    v_exp_f32 v50, v50
    v_exp_f32 v51, v51
    v_exp_f32 v52, v52
    v_exp_f32 v53, v53
    v_exp_f32 v54, v54
    v_exp_f32 v55, v55
    v_add_f32 v48, 1.0, v48
    v_add_f32 v49, 1.0, v49
    v_add_f32 v50, 1.0, v50
    v_add_f32 v51, 1.0, v51
    v_add_f32 v52, 1.0, v52
    v_add_f32 v53, 1.0, v53
    v_add_f32 v54, 1.0, v54
    v_add_f32 v55, 1.0, v55
    v_rcp_f32 v48, v48
    v_rcp_f32 v49, v49
    v_rcp_f32 v50, v50
    v_rcp_f32 v51, v51
    v_rcp_f32 v52, v52
    v_rcp_f32 v53, v53
    v_rcp_f32 v54, v54
    v_rcp_f32 v55, v55
    v_fma_f32 v48, v48, -2.0, 1.0
    v_fma_f32 v49, v49, -2.0, 1.0
    v_fma_f32 v50, v50, -2.0, 1.0
    v_fma_f32 v51, v51, -2.0, 1.0
    v_fma_f32 v52, v52, -2.0, 1.0
    v_fma_f32 v53, v53, -2.0, 1.0
    v_fma_f32 v54, v54, -2.0, 1.0
    v_fma_f32 v55, v55, -2.0, 1.0
    v_cvt_pk_bf16_f32 v64, v48, v49
    v_cvt_pk_bf16_f32 v65, v50, v51
    v_cvt_pk_bf16_f32 v66, v52, v53
    v_cvt_pk_bf16_f32 v67, v54, v55
    ds_write_b128 v123, v[64:67] offset:0
    v_exp_f32 v56, v56
    v_exp_f32 v57, v57
    v_exp_f32 v58, v58
    v_exp_f32 v59, v59
    v_exp_f32 v60, v60
    v_exp_f32 v61, v61
    v_exp_f32 v62, v62
    v_exp_f32 v63, v63
    v_add_f32 v56, 1.0, v56
    v_add_f32 v57, 1.0, v57
    v_add_f32 v58, 1.0, v58
    v_add_f32 v59, 1.0, v59
    v_add_f32 v60, 1.0, v60
    v_add_f32 v61, 1.0, v61
    v_add_f32 v62, 1.0, v62
    v_add_f32 v63, 1.0, v63
    v_rcp_f32 v56, v56
    v_rcp_f32 v57, v57
    v_rcp_f32 v58, v58
    v_rcp_f32 v59, v59
    v_rcp_f32 v60, v60
    v_rcp_f32 v61, v61
    v_rcp_f32 v62, v62
    v_rcp_f32 v63, v63
    v_fma_f32 v56, v56, -2.0, 1.0
    v_fma_f32 v57, v57, -2.0, 1.0
    v_fma_f32 v58, v58, -2.0, 1.0
    v_fma_f32 v59, v59, -2.0, 1.0
    v_fma_f32 v60, v60, -2.0, 1.0
    v_fma_f32 v61, v61, -2.0, 1.0
    v_fma_f32 v62, v62, -2.0, 1.0
    v_fma_f32 v63, v63, -2.0, 1.0
    v_cvt_pk_bf16_f32 v68, v56, v57
    v_cvt_pk_bf16_f32 v69, v58, v59
    v_cvt_pk_bf16_f32 v70, v60, v61
    v_cvt_pk_bf16_f32 v71, v62, v63
    ds_write_b128 v123, v[68:71] offset:1024
    s_waitcnt lgkmcnt(0)
    s_barrier
    v_add_f32 v48, v112, v32
    v_add_f32 v49, v113, v33
    v_add_f32 v50, v114, v34
    v_add_f32 v51, v115, v35
    v_add_f32 v52, v116, v36
    v_add_f32 v53, v117, v37
    v_add_f32 v54, v118, v38
    v_add_f32 v55, v119, v39
    v_add_f32 v56, v112, v40
    v_add_f32 v57, v113, v41
    v_add_f32 v58, v114, v42
    v_add_f32 v59, v115, v43
    v_add_f32 v60, v116, v44
    v_add_f32 v61, v117, v45
    v_add_f32 v62, v118, v46
    v_add_f32 v63, v119, v47
    ds_read_b128 v[32:35], v121 offset:0
    ds_read_b128 v[36:39], v121 offset:16
    ds_read_b128 v[40:43], v121 offset:288
    ds_read_b128 v[44:47], v121 offset:304
    v_add_u32 v121, 576, v121
    v_exp_f32 v48, v48
    v_exp_f32 v49, v49
    v_exp_f32 v50, v50
    v_exp_f32 v51, v51
    v_exp_f32 v52, v52
    v_exp_f32 v53, v53
    v_exp_f32 v54, v54
    v_exp_f32 v55, v55
    v_add_f32 v48, 1.0, v48
    v_add_f32 v49, 1.0, v49
    v_add_f32 v50, 1.0, v50
    v_add_f32 v51, 1.0, v51
    v_add_f32 v52, 1.0, v52
    v_add_f32 v53, 1.0, v53
    v_add_f32 v54, 1.0, v54
    v_add_f32 v55, 1.0, v55
    v_rcp_f32 v48, v48
    v_rcp_f32 v49, v49
    v_rcp_f32 v50, v50
    v_rcp_f32 v51, v51
    v_rcp_f32 v52, v52
    v_rcp_f32 v53, v53
    v_rcp_f32 v54, v54
    v_rcp_f32 v55, v55
    v_fma_f32 v48, v48, -2.0, 1.0
    v_fma_f32 v49, v49, -2.0, 1.0
    v_fma_f32 v50, v50, -2.0, 1.0
    v_fma_f32 v51, v51, -2.0, 1.0
    v_fma_f32 v52, v52, -2.0, 1.0
    v_fma_f32 v53, v53, -2.0, 1.0
    v_fma_f32 v54, v54, -2.0, 1.0
    v_fma_f32 v55, v55, -2.0, 1.0
    v_cvt_pk_bf16_f32 v64, v48, v49
    v_cvt_pk_bf16_f32 v65, v50, v51
    v_cvt_pk_bf16_f32 v66, v52, v53
    v_cvt_pk_bf16_f32 v67, v54, v55
    ds_write_b128 v123, v[64:67] offset:16384
    v_exp_f32 v56, v56
    v_exp_f32 v57, v57
    v_exp_f32 v58, v58
    v_exp_f32 v59, v59
    v_exp_f32 v60, v60
    v_exp_f32 v61, v61
    v_exp_f32 v62, v62
    v_exp_f32 v63, v63
    v_add_f32 v56, 1.0, v56
    v_add_f32 v57, 1.0, v57
    v_add_f32 v58, 1.0, v58
    v_add_f32 v59, 1.0, v59
    v_add_f32 v60, 1.0, v60
    v_add_f32 v61, 1.0, v61
    v_add_f32 v62, 1.0, v62
    v_add_f32 v63, 1.0, v63
    v_rcp_f32 v56, v56
    v_rcp_f32 v57, v57
    v_rcp_f32 v58, v58
    v_rcp_f32 v59, v59
    v_rcp_f32 v60, v60
    v_rcp_f32 v61, v61
    v_rcp_f32 v62, v62
    v_rcp_f32 v63, v63
    v_fma_f32 v56, v56, -2.0, 1.0
    v_fma_f32 v57, v57, -2.0, 1.0
    v_fma_f32 v58, v58, -2.0, 1.0
    v_fma_f32 v59, v59, -2.0, 1.0
    v_fma_f32 v60, v60, -2.0, 1.0
    v_fma_f32 v61, v61, -2.0, 1.0
    v_fma_f32 v62, v62, -2.0, 1.0
    v_fma_f32 v63, v63, -2.0, 1.0
    v_cvt_pk_bf16_f32 v68, v56, v57
    v_cvt_pk_bf16_f32 v69, v58, v59
    v_cvt_pk_bf16_f32 v70, v60, v61
    v_cvt_pk_bf16_f32 v71, v62, v63
    ds_write_b128 v123, v[68:71] offset:17408
    s_waitcnt lgkmcnt(0)
    s_barrier
    s_sub_u32 s22, s22, 1
    s_cmp_lg_u32 s22, 0
    s_cbranch_scc1 L_joint_kernel_tloop0
L_joint_kernel_fin:
L_joint_kernel_done:
    s_endpgm
.section .rodata,"a"
.p2align 6
.amdhsa_kernel prep_kernel
  .amdhsa_next_free_vgpr 128
  .amdhsa_next_free_sgpr 102
  .amdhsa_accum_offset 128
  .amdhsa_group_segment_fixed_size 0
  .amdhsa_kernarg_size 80
  .amdhsa_user_sgpr_count 2
  .amdhsa_user_sgpr_kernarg_segment_ptr 1
  .amdhsa_system_sgpr_workgroup_id_x 1
.end_amdhsa_kernel
.p2align 6
.amdhsa_kernel conv1_kernel
  .amdhsa_next_free_vgpr 128
  .amdhsa_next_free_sgpr 102
  .amdhsa_accum_offset 128
  .amdhsa_group_segment_fixed_size 0
  .amdhsa_kernarg_size 80
  .amdhsa_user_sgpr_count 2
  .amdhsa_user_sgpr_kernarg_segment_ptr 1
  .amdhsa_system_sgpr_workgroup_id_x 1
.end_amdhsa_kernel
.p2align 6
.amdhsa_kernel conv2_kernel
  .amdhsa_next_free_vgpr 128
  .amdhsa_next_free_sgpr 102
  .amdhsa_accum_offset 128
  .amdhsa_group_segment_fixed_size 0
  .amdhsa_kernarg_size 80
  .amdhsa_user_sgpr_count 2
  .amdhsa_user_sgpr_kernarg_segment_ptr 1
  .amdhsa_system_sgpr_workgroup_id_x 1
.end_amdhsa_kernel
.p2align 6
.amdhsa_kernel joint_kernel
  .amdhsa_next_free_vgpr 128
  .amdhsa_next_free_sgpr 102
  .amdhsa_accum_offset 128
  .amdhsa_group_segment_fixed_size 0
  .amdhsa_kernarg_size 80
  .amdhsa_user_sgpr_count 2
  .amdhsa_user_sgpr_kernarg_segment_ptr 1
  .amdhsa_system_sgpr_workgroup_id_x 1
.end_amdhsa_kernel
```

```asm
; @launch kernel=prep_kernel grid=(256,1,1) block=(384,1,1) lds=4096
; @launch kernel=conv1_kernel grid=(256,1,1) block=(1024,1,1) lds=162816
; @launch kernel=conv2_kernel grid=(256,1,1) block=(1024,1,1) lds=162816
; @launch kernel=joint_kernel grid=(250,1,1) block=(1024,1,1) lds=99472
.amdgcn_target "amdgcn-amd-amdhsa--gfx950"
.text
.globl prep_kernel
.p2align 8
.type prep_kernel,@function
prep_kernel:
    s_cmp_ge_u32 s2, 256
    s_cbranch_scc1 L_prep_kernel_done
    s_mov_b32 s3, s2
    s_load_dwordx16 s[44:59], s[0:1], 0
    s_load_dwordx2 s[30:31], s[0:1], 72
    v_readfirstlane_b32 s40, v0
    s_lshr_b32 s40, s40, 6
    v_and_b32 v1, 63, v0
    s_cmp_lt_u32 s40, 4
    s_cbranch_scc1 L_prep_kernel_w
    s_cmp_ge_u32 s2, 24
    s_cbranch_scc1 L_prep_kernel_done
    s_lshr_b32 s41, s2, 3
    s_and_b32 s42, s2, 7
    s_sub_u32 s43, s40, 4
    s_lshl_b32 s26, s43, 16
    s_lshl_b32 s5, s42, 6
    s_add_u32 s26, s26, s5
    s_mov_b32 s10, 131072
    s_mov_b32 s11, 0x00020000
    v_lshrrev_b32 v2, 4, v1
    v_lshlrev_b32 v2, 12, v2
    v_and_b32 v3, 15, v1
    v_lshl_add_u32 v2, v3, 2, v2
    v_mov_b32 v9, 0
    ds_write_b32 v9, v9 offset:2048
    s_waitcnt lgkmcnt(0)
    s_cmp_eq_u32 s41, 1
    s_cselect_b32 s8, s56, s52
    s_cselect_b32 s9, s57, s53
    s_cmp_eq_u32 s41, 2
    s_cselect_b32 s8, s54, s8
    s_cselect_b32 s9, s55, s9
    s_barrier
    s_cmp_lg_u32 s41, 2
    s_cbranch_scc1 L_prep_kernel_nog
    s_mov_b32 s16, s50
    s_mov_b32 s17, s51
    s_mov_b32 s18, 8192
    s_mov_b32 s19, 0x00020000
    v_and_b32 v6, 0x30, v1
    v_lshl_add_u32 v6, v3, 9, v6
    s_lshl_b32 s6, s43, 8
    buffer_load_dwordx4 v[80:83], v6, s[16:19], s6 offen offset:0
    buffer_load_dwordx4 v[84:87], v6, s[16:19], s6 offen offset:64
    buffer_load_dwordx4 v[88:91], v6, s[16:19], s6 offen offset:128
    buffer_load_dwordx4 v[92:95], v6, s[16:19], s6 offen offset:192
L_prep_kernel_nog:
    buffer_load_dword v16, v2, s[8:11], s26 offen offset:0
    buffer_load_dword v17, v2, s[8:11], s26 offen offset:512
    buffer_load_dword v18, v2, s[8:11], s26 offen offset:1024
    buffer_load_dword v19, v2, s[8:11], s26 offen offset:1536
    buffer_load_dword v20, v2, s[8:11], s26 offen offset:2048
    buffer_load_dword v21, v2, s[8:11], s26 offen offset:2560
    buffer_load_dword v22, v2, s[8:11], s26 offen offset:3072
    buffer_load_dword v23, v2, s[8:11], s26 offen offset:3584
    s_add_u32 s26, s26, 16384
    buffer_load_dword v24, v2, s[8:11], s26 offen offset:0
    buffer_load_dword v25, v2, s[8:11], s26 offen offset:512
    buffer_load_dword v26, v2, s[8:11], s26 offen offset:1024
    buffer_load_dword v27, v2, s[8:11], s26 offen offset:1536
    buffer_load_dword v28, v2, s[8:11], s26 offen offset:2048
    buffer_load_dword v29, v2, s[8:11], s26 offen offset:2560
    buffer_load_dword v30, v2, s[8:11], s26 offen offset:3072
    buffer_load_dword v31, v2, s[8:11], s26 offen offset:3584
    s_add_u32 s26, s26, 16384
    buffer_load_dword v32, v2, s[8:11], s26 offen offset:0
    buffer_load_dword v33, v2, s[8:11], s26 offen offset:512
    buffer_load_dword v34, v2, s[8:11], s26 offen offset:1024
    buffer_load_dword v35, v2, s[8:11], s26 offen offset:1536
    buffer_load_dword v36, v2, s[8:11], s26 offen offset:2048
    buffer_load_dword v37, v2, s[8:11], s26 offen offset:2560
    buffer_load_dword v38, v2, s[8:11], s26 offen offset:3072
    buffer_load_dword v39, v2, s[8:11], s26 offen offset:3584
    s_add_u32 s26, s26, 16384
    buffer_load_dword v40, v2, s[8:11], s26 offen offset:0
    buffer_load_dword v41, v2, s[8:11], s26 offen offset:512
    buffer_load_dword v42, v2, s[8:11], s26 offen offset:1024
    buffer_load_dword v43, v2, s[8:11], s26 offen offset:1536
    buffer_load_dword v44, v2, s[8:11], s26 offen offset:2048
    buffer_load_dword v45, v2, s[8:11], s26 offen offset:2560
    buffer_load_dword v46, v2, s[8:11], s26 offen offset:3072
    buffer_load_dword v47, v2, s[8:11], s26 offen offset:3584
    s_branch L_prep_kernel_small
L_prep_kernel_w:
    s_lshl_b32 s21, s2, 2
    s_add_u32 s20, s40, s21
    s_load_dwordx2 s[8:9], s[0:1], 8
    s_lshr_b32 s22, s20, 8
    s_bfe_u32 s23, s20, 0x40004
    s_bfe_u32 s24, s20, 0x30001
    s_and_b32 s21, s20, 1
    v_lshrrev_b32 v5, 4, v1
    v_lshlrev_b32 v2, 11, v5
    v_and_b32 v3, 15, v1
    v_lshl_add_u32 v2, v3, 2, v2
    s_lshl_b32 s26, s22, 3
    s_lshr_b32 s27, s23, 3
    s_add_u32 s26, s26, s27
    s_lshl_b32 s26, s26, 17
    s_and_b32 s27, s23, 7
    s_lshl_b32 s27, s27, 1
    s_add_u32 s27, s27, s21
    s_lshl_b32 s27, s27, 13
    s_add_u32 s26, s26, s27
    s_lshl_b32 s27, s24, 6
    s_add_u32 s26, s26, s27
    s_mov_b32 s10, 4063232
    s_mov_b32 s11, 0x00020000
    s_add_u32 s37, s26, 262144
    s_add_u32 s38, s26, 524288
    s_add_u32 s39, s26, 786432
    s_mov_b32 s14, 7340032
    s_mov_b32 s15, 0x00020000
    v_lshrrev_b32 v4, 1, v5
    v_lshlrev_b32 v4, 8, v4
    v_lshl_add_u32 v4, v3, 4, v4
    v_and_b32 v5, 1, v5
    v_lshl_add_u32 v4, v5, 3, v4
    s_lshl_b32 s27, s24, 4
    s_add_u32 s27, s27, s23
    s_mul_i32 s27, s27, 57344
    s_lshl_b32 s28, s22, 11
    s_add_u32 s27, s27, s28
    s_lshl_b32 s28, s21, 9
    s_add_u32 s27, s27, s28
    s_mov_b32 s32, 0x05040100
    s_mov_b32 s33, 0x07060302
    s_mov_b32 s34, 0xffff0000
    s_mov_b32 s35, 0x3d2aaaab
    s_mov_b32 s40, 0x3c638e39
    s_waitcnt lgkmcnt(0)
    buffer_load_dword v16, v2, s[8:11], s26 offen offset:0
    buffer_load_dword v17, v2, s[8:11], s26 offen offset:512
    buffer_load_dword v20, v2, s[8:11], s37 offen offset:0
    buffer_load_dword v21, v2, s[8:11], s37 offen offset:512
    buffer_load_dword v24, v2, s[8:11], s38 offen offset:0
    buffer_load_dword v25, v2, s[8:11], s38 offen offset:512
    buffer_load_dword v28, v2, s[8:11], s39 offen offset:0
    buffer_load_dword v29, v2, s[8:11], s39 offen offset:512
    buffer_load_dword v18, v2, s[8:11], s26 offen offset:1024
    buffer_load_dword v19, v2, s[8:11], s26 offen offset:1536
    buffer_load_dword v22, v2, s[8:11], s37 offen offset:1024
    buffer_load_dword v23, v2, s[8:11], s37 offen offset:1536
    buffer_load_dword v26, v2, s[8:11], s38 offen offset:1024
    buffer_load_dword v27, v2, s[8:11], s38 offen offset:1536
    buffer_load_dword v30, v2, s[8:11], s39 offen offset:1024
    buffer_load_dword v31, v2, s[8:11], s39 offen offset:1536
    s_barrier
    s_add_u32 s12, s30, 0
    s_addc_u32 s13, s31, 0
    s_waitcnt vmcnt(8)
    v_perm_b32 v100, v17, v16, s32
    v_perm_b32 v76, v29, v28, s32
    v_lshlrev_b32 v104, 16, v28
    v_lshlrev_b32 v112, 16, v29
    v_lshlrev_b32 v105, 16, v24
    v_lshlrev_b32 v113, 16, v25
    v_lshlrev_b32 v106, 16, v20
    v_lshlrev_b32 v114, 16, v21
    v_lshlrev_b32 v107, 16, v16
    v_lshlrev_b32 v115, 16, v17
    v_add_f32 v108, v104, v106
    v_add_f32 v116, v112, v114
    v_add_f32 v109, v105, v107
    v_add_f32 v117, v113, v115
    v_fma_f32 v110, v106, 4.0, v104
    v_fma_f32 v118, v114, 4.0, v112
    v_fma_f32 v111, v107, 4.0, v105
    v_fma_f32 v119, v115, 4.0, v113
    v_add_f32 v105, v108, v109
    v_add_f32 v113, v116, v117
    v_sub_f32 v106, v108, v109
    v_sub_f32 v114, v116, v117
    v_fma_f32 v107, v111, 2.0, v110
    v_fma_f32 v115, v119, 2.0, v118
    v_fma_f32 v110, v111, -2.0, v110
    v_fma_f32 v118, v119, -2.0, v118
    v_fmamk_f32 v108, v104, 0x41700000, v110
    v_fmamk_f32 v116, v112, 0x41700000, v118
    v_fmamk_f32 v108, v109, 0x41200000, v108
    v_fmamk_f32 v116, v117, 0x41200000, v116
    v_mul_f32 v105, 0.5, v105
    v_mul_f32 v113, 0.5, v113
    v_mul_f32 v106, 0.5, v106
    v_mul_f32 v114, 0.5, v114
    v_mul_f32 v107, s35, v107
    v_mul_f32 v115, s35, v115
    v_mul_f32 v110, s35, v110
    v_mul_f32 v118, s35, v118
    v_mul_f32 v108, s40, v108
    v_mul_f32 v116, s40, v116
    v_cvt_pk_bf16_f32 v80, v105, v113
    v_cvt_pk_bf16_f32 v84, v106, v114
    v_cvt_pk_bf16_f32 v88, v107, v115
    v_cvt_pk_bf16_f32 v92, v110, v118
    v_cvt_pk_bf16_f32 v96, v108, v116
    v_perm_b32 v102, v17, v16, s33
    v_perm_b32 v78, v29, v28, s33
    v_and_b32 v104, s34, v28
    v_and_b32 v112, s34, v29
    v_and_b32 v105, s34, v24
    v_and_b32 v113, s34, v25
    v_and_b32 v106, s34, v20
    v_and_b32 v114, s34, v21
    v_and_b32 v107, s34, v16
    v_and_b32 v115, s34, v17
    v_add_f32 v108, v104, v106
    v_add_f32 v116, v112, v114
    v_add_f32 v109, v105, v107
    v_add_f32 v117, v113, v115
    v_fma_f32 v110, v106, 4.0, v104
    v_fma_f32 v118, v114, 4.0, v112
    v_fma_f32 v111, v107, 4.0, v105
    v_fma_f32 v119, v115, 4.0, v113
    v_add_f32 v105, v108, v109
    v_add_f32 v113, v116, v117
    v_sub_f32 v106, v108, v109
    v_sub_f32 v114, v116, v117
    v_fma_f32 v107, v111, 2.0, v110
    v_fma_f32 v115, v119, 2.0, v118
    v_fma_f32 v110, v111, -2.0, v110
    v_fma_f32 v118, v119, -2.0, v118
    v_fmamk_f32 v108, v104, 0x41700000, v110
    v_fmamk_f32 v116, v112, 0x41700000, v118
    v_fmamk_f32 v108, v109, 0x41200000, v108
    v_fmamk_f32 v116, v117, 0x41200000, v116
    v_mul_f32 v105, 0.5, v105
    v_mul_f32 v113, 0.5, v113
    v_mul_f32 v106, 0.5, v106
    v_mul_f32 v114, 0.5, v114
    v_mul_f32 v107, s35, v107
    v_mul_f32 v115, s35, v115
    v_mul_f32 v110, s35, v110
    v_mul_f32 v118, s35, v118
    v_mul_f32 v108, s40, v108
    v_mul_f32 v116, s40, v116
    v_cvt_pk_bf16_f32 v82, v105, v113
    v_cvt_pk_bf16_f32 v86, v106, v114
    v_cvt_pk_bf16_f32 v90, v107, v115
    v_cvt_pk_bf16_f32 v94, v110, v118
    v_cvt_pk_bf16_f32 v98, v108, v116
    s_waitcnt vmcnt(0)
    s_cmp_lt_u32 s3, 224
    s_cbranch_scc1 L_prep_kernel_ncw
    s_getpc_b64 s[62:63]
L_prep_kernel_pc:
    s_and_b32 s64, s3, 8
    s_lshl_b32 s64, s64, 12
    v_lshlrev_b32 v120, 7, v0
    v_add_u32 v120, s64, v120
    v_min_u32 v120, L_joint_kernel_done-L_prep_kernel_pc, v120
    v_mov_b32 v121, s63
    v_add_co_u32 v120, vcc, s62, v120
    s_nop 1
    v_addc_co_u32 v121, vcc, 0, v121, vcc
    global_load_dword v122, v[120:121], off
L_prep_kernel_ncw:
    v_perm_b32 v101, v19, v18, s32
    v_perm_b32 v77, v31, v30, s32
    v_lshlrev_b32 v104, 16, v30
    v_lshlrev_b32 v112, 16, v31
    v_lshlrev_b32 v105, 16, v26
    v_lshlrev_b32 v113, 16, v27
    v_lshlrev_b32 v106, 16, v22
    v_lshlrev_b32 v114, 16, v23
    v_lshlrev_b32 v107, 16, v18
    v_lshlrev_b32 v115, 16, v19
    v_add_f32 v108, v104, v106
    v_add_f32 v116, v112, v114
    v_add_f32 v109, v105, v107
    v_add_f32 v117, v113, v115
    v_fma_f32 v110, v106, 4.0, v104
    v_fma_f32 v118, v114, 4.0, v112
    v_fma_f32 v111, v107, 4.0, v105
    v_fma_f32 v119, v115, 4.0, v113
    v_add_f32 v105, v108, v109
    v_add_f32 v113, v116, v117
    v_sub_f32 v106, v108, v109
    v_sub_f32 v114, v116, v117
    v_fma_f32 v107, v111, 2.0, v110
    v_fma_f32 v115, v119, 2.0, v118
    v_fma_f32 v110, v111, -2.0, v110
    v_fma_f32 v118, v119, -2.0, v118
    v_fmamk_f32 v108, v104, 0x41700000, v110
    v_fmamk_f32 v116, v112, 0x41700000, v118
    v_fmamk_f32 v108, v109, 0x41200000, v108
    v_fmamk_f32 v116, v117, 0x41200000, v116
    v_mul_f32 v105, 0.5, v105
    v_mul_f32 v113, 0.5, v113
    v_mul_f32 v106, 0.5, v106
    v_mul_f32 v114, 0.5, v114
    v_mul_f32 v107, s35, v107
    v_mul_f32 v115, s35, v115
    v_mul_f32 v110, s35, v110
    v_mul_f32 v118, s35, v118
    v_mul_f32 v108, s40, v108
    v_mul_f32 v116, s40, v116
    v_cvt_pk_bf16_f32 v81, v105, v113
    v_cvt_pk_bf16_f32 v85, v106, v114
    v_cvt_pk_bf16_f32 v89, v107, v115
    v_cvt_pk_bf16_f32 v93, v110, v118
    v_cvt_pk_bf16_f32 v97, v108, v116
    s_add_u32 s28, s27, 0
    buffer_store_dwordx2 v[76:77], v4, s[12:15], s28 offen offset:0 sc1
    s_add_u32 s28, s27, 8192
    buffer_store_dwordx2 v[80:81], v4, s[12:15], s28 offen offset:0 sc1
    s_add_u32 s28, s27, 16384
    buffer_store_dwordx2 v[84:85], v4, s[12:15], s28 offen offset:0 sc1
    s_add_u32 s28, s27, 24576
    buffer_store_dwordx2 v[88:89], v4, s[12:15], s28 offen offset:0 sc1
    s_add_u32 s28, s27, 32768
    buffer_store_dwordx2 v[92:93], v4, s[12:15], s28 offen offset:0 sc1
    s_add_u32 s28, s27, 40960
    buffer_store_dwordx2 v[96:97], v4, s[12:15], s28 offen offset:0 sc1
    s_add_u32 s28, s27, 49152
    buffer_store_dwordx2 v[100:101], v4, s[12:15], s28 offen offset:0 sc1
    v_perm_b32 v103, v19, v18, s33
    v_perm_b32 v79, v31, v30, s33
    v_and_b32 v104, s34, v30
    v_and_b32 v112, s34, v31
    v_and_b32 v105, s34, v26
    v_and_b32 v113, s34, v27
    v_and_b32 v106, s34, v22
    v_and_b32 v114, s34, v23
    v_and_b32 v107, s34, v18
    v_and_b32 v115, s34, v19
    v_add_f32 v108, v104, v106
    v_add_f32 v116, v112, v114
    v_add_f32 v109, v105, v107
    v_add_f32 v117, v113, v115
    v_fma_f32 v110, v106, 4.0, v104
    v_fma_f32 v118, v114, 4.0, v112
    v_fma_f32 v111, v107, 4.0, v105
    v_fma_f32 v119, v115, 4.0, v113
    v_add_f32 v105, v108, v109
    v_add_f32 v113, v116, v117
    v_sub_f32 v106, v108, v109
    v_sub_f32 v114, v116, v117
    v_fma_f32 v107, v111, 2.0, v110
    v_fma_f32 v115, v119, 2.0, v118
    v_fma_f32 v110, v111, -2.0, v110
    v_fma_f32 v118, v119, -2.0, v118
    v_fmamk_f32 v108, v104, 0x41700000, v110
    v_fmamk_f32 v116, v112, 0x41700000, v118
    v_fmamk_f32 v108, v109, 0x41200000, v108
    v_fmamk_f32 v116, v117, 0x41200000, v116
    v_mul_f32 v105, 0.5, v105
    v_mul_f32 v113, 0.5, v113
    v_mul_f32 v106, 0.5, v106
    v_mul_f32 v114, 0.5, v114
    v_mul_f32 v107, s35, v107
    v_mul_f32 v115, s35, v115
    v_mul_f32 v110, s35, v110
    v_mul_f32 v118, s35, v118
    v_mul_f32 v108, s40, v108
    v_mul_f32 v116, s40, v116
    v_cvt_pk_bf16_f32 v83, v105, v113
    v_cvt_pk_bf16_f32 v87, v106, v114
    v_cvt_pk_bf16_f32 v91, v107, v115
    v_cvt_pk_bf16_f32 v95, v110, v118
    v_cvt_pk_bf16_f32 v99, v108, v116
    s_add_u32 s28, s27, 0
    buffer_store_dwordx2 v[78:79], v4, s[12:15], s28 offen offset:1024 sc1
    s_add_u32 s28, s27, 8192
    buffer_store_dwordx2 v[82:83], v4, s[12:15], s28 offen offset:1024 sc1
    s_add_u32 s28, s27, 16384
    buffer_store_dwordx2 v[86:87], v4, s[12:15], s28 offen offset:1024 sc1
    s_add_u32 s28, s27, 24576
    buffer_store_dwordx2 v[90:91], v4, s[12:15], s28 offen offset:1024 sc1
    s_add_u32 s28, s27, 32768
    buffer_store_dwordx2 v[94:95], v4, s[12:15], s28 offen offset:1024 sc1
    s_add_u32 s28, s27, 40960
    buffer_store_dwordx2 v[98:99], v4, s[12:15], s28 offen offset:1024 sc1
    s_add_u32 s28, s27, 49152
    buffer_store_dwordx2 v[102:103], v4, s[12:15], s28 offen offset:1024 sc1
L_prep_kernel_done:
    s_endpgm
L_prep_kernel_small:
    v_lshrrev_b32 v2, 4, v1
    s_lshl_b32 s24, s41, 17
    s_add_u32 s24, s24, 44040192
    s_add_u32 s12, s30, s24
    s_addc_u32 s13, s31, 0
    s_mov_b32 s14, 131072
    s_mov_b32 s15, 0x00020000
    s_mov_b32 s32, 0x05040100
    s_mov_b32 s33, 0x07060302
    v_lshlrev_b32 v4, 4, v1
    s_lshl_b32 s24, s42, 14
    s_lshl_b32 s25, s43, 13
    s_add_u32 s24, s24, s25
    s_add_u32 s25, s24, 4096
    s_waitcnt vmcnt(0)
    v_perm_b32 v48, v17, v16, s32
    v_perm_b32 v49, v19, v18, s32
    v_perm_b32 v50, v21, v20, s32
    v_perm_b32 v51, v23, v22, s32
    v_perm_b32 v52, v17, v16, s33
    v_perm_b32 v53, v19, v18, s33
    v_perm_b32 v54, v21, v20, s33
    v_perm_b32 v55, v23, v22, s33
    v_perm_b32 v56, v25, v24, s32
    v_perm_b32 v57, v27, v26, s32
    v_perm_b32 v58, v29, v28, s32
    v_perm_b32 v59, v31, v30, s32
    v_perm_b32 v60, v25, v24, s33
    v_perm_b32 v61, v27, v26, s33
    v_perm_b32 v62, v29, v28, s33
    v_perm_b32 v63, v31, v30, s33
    v_perm_b32 v64, v33, v32, s32
    v_perm_b32 v65, v35, v34, s32
    v_perm_b32 v66, v37, v36, s32
    v_perm_b32 v67, v39, v38, s32
    v_perm_b32 v68, v33, v32, s33
    v_perm_b32 v69, v35, v34, s33
    v_perm_b32 v70, v37, v36, s33
    v_perm_b32 v71, v39, v38, s33
    v_perm_b32 v72, v41, v40, s32
    v_perm_b32 v73, v43, v42, s32
    v_perm_b32 v74, v45, v44, s32
    v_perm_b32 v75, v47, v46, s32
    v_perm_b32 v76, v41, v40, s33
    v_perm_b32 v77, v43, v42, s33
    v_perm_b32 v78, v45, v44, s33
    v_perm_b32 v79, v47, v46, s33
    s_cmp_eq_u32 s41, 2
    s_cbranch_scc1 L_prep_kernel_ge
    buffer_store_dwordx4 v[48:51], v4, s[12:15], s24 offen offset:0 sc1
    buffer_store_dwordx4 v[52:55], v4, s[12:15], s24 offen offset:1024 sc1
    buffer_store_dwordx4 v[56:59], v4, s[12:15], s24 offen offset:2048 sc1
    buffer_store_dwordx4 v[60:63], v4, s[12:15], s24 offen offset:3072 sc1
    buffer_store_dwordx4 v[64:67], v4, s[12:15], s25 offen offset:0 sc1
    buffer_store_dwordx4 v[68:71], v4, s[12:15], s25 offen offset:1024 sc1
    buffer_store_dwordx4 v[72:75], v4, s[12:15], s25 offen offset:2048 sc1
    buffer_store_dwordx4 v[76:79], v4, s[12:15], s25 offen offset:3072 sc1
    s_endpgm
L_prep_kernel_ge:
    v_mfma_f32_16x16x32_bf16 v[96:99], v[48:51], v[80:83], 0
    v_mfma_f32_16x16x32_bf16 v[100:103], v[52:55], v[80:83], 0
    v_mfma_f32_16x16x32_bf16 v[96:99], v[56:59], v[84:87], v[96:99]
    v_mfma_f32_16x16x32_bf16 v[100:103], v[60:63], v[84:87], v[100:103]
    v_mfma_f32_16x16x32_bf16 v[96:99], v[64:67], v[88:91], v[96:99]
    v_mfma_f32_16x16x32_bf16 v[100:103], v[68:71], v[88:91], v[100:103]
    v_mfma_f32_16x16x32_bf16 v[96:99], v[72:75], v[92:95], v[96:99]
    v_mfma_f32_16x16x32_bf16 v[100:103], v[76:79], v[92:95], v[100:103]
    v_mov_b32 v7, v4
    v_mov_b32 v10, 1
    s_nop 0
    s_mov_b32 s14, 16384
    v_lshlrev_b32 v8, 10, v3
    v_lshl_add_u32 v8, v2, 5, v8
    s_lshl_b32 s24, s42, 7
    s_mov_b32 s34, 0xffff0000
    s_mov_b32 s35, 0x4038aa3b
    s_cmp_eq_u32 s43, 0
    s_cbranch_scc1 L_prep_kernel_ge0
    ds_write_b128 v7, v[96:99]
    ds_write_b128 v7, v[100:103] offset:1024
    ds_write_b32 v9, v10 offset:2048
    s_endpgm
L_prep_kernel_ge0:
    ds_read_b32 v10, v9 offset:2048
    s_waitcnt lgkmcnt(0)
    v_readfirstlane_b32 s27, v10
    s_cmp_eq_u32 s27, 0
    s_cbranch_scc1 L_prep_kernel_ge0
    ds_read_b128 v[16:19], v7
    ds_read_b128 v[20:23], v7 offset:1024
    s_waitcnt lgkmcnt(0)
    v_add_f32 v16, v16, v96
    v_add_f32 v17, v17, v97
    v_add_f32 v18, v18, v98
    v_add_f32 v19, v19, v99
    v_add_f32 v20, v20, v100
    v_add_f32 v21, v21, v101
    v_add_f32 v22, v22, v102
    v_add_f32 v23, v23, v103
    v_cvt_pk_bf16_f32 v48, v16, v20
    v_cvt_pk_bf16_f32 v49, v17, v21
    v_cvt_pk_bf16_f32 v50, v18, v22
    v_cvt_pk_bf16_f32 v51, v19, v23
    v_lshlrev_b32 v56, 16, v48
    v_and_b32 v57, s34, v48
    v_lshlrev_b32 v58, 16, v49
    v_and_b32 v59, s34, v49
    v_lshlrev_b32 v60, 16, v50
    v_and_b32 v61, s34, v50
    v_lshlrev_b32 v62, 16, v51
    v_and_b32 v63, s34, v51
    v_mul_f32 v56, s35, v56
    v_mul_f32 v57, s35, v57
    v_mul_f32 v58, s35, v58
    v_mul_f32 v59, s35, v59
    v_mul_f32 v60, s35, v60
    v_mul_f32 v61, s35, v61
    v_mul_f32 v62, s35, v62
    v_mul_f32 v63, s35, v63
    buffer_store_dwordx4 v[56:59], v8, s[12:15], s24 offen sc1
    buffer_store_dwordx4 v[60:63], v8, s[12:15], s24 offen offset:16 sc1
    v_exp_f32 v64, v56
    v_exp_f32 v65, v57
    v_exp_f32 v66, v58
    v_exp_f32 v67, v59
    v_exp_f32 v68, v60
    v_exp_f32 v69, v61
    v_exp_f32 v70, v62
    v_exp_f32 v71, v63
    v_max3_f32 v72, |v56|, |v57|, |v58|
    v_max3_f32 v72, |v59|, |v60|, v72
    v_max3_f32 v72, |v61|, |v62|, v72
    v_max_f32 v72, |v63|, v72
    s_add_u32 s12, s12, 16384
    s_addc_u32 s13, s13, 0
    v_cmp_lt_f32 vcc, 0x42f00000, v72
    buffer_store_dwordx4 v[64:67], v8, s[12:15], s24 offen sc1
    buffer_store_dwordx4 v[68:71], v8, s[12:15], s24 offen offset:16 sc1
    s_add_u32 s12, s12, 16384
    s_addc_u32 s13, s13, 0
    s_or_b32 s26, vcc_lo, vcc_hi
    s_lshl_b32 s24, s42, 2
    v_mov_b32 v73, s26
    v_mov_b32 v74, 0
    buffer_store_dword v73, v74, s[12:15], s24 offen sc1
L_prep_kernel_last:
    s_endpgm
.globl conv1_kernel
.p2align 8
.type conv1_kernel,@function
conv1_kernel:
    s_cmp_ge_u32 s2, 256
    s_cbranch_scc1 L_conv1_kernel_done
    s_load_dwordx2 s[4:5], s[0:1], 0
    s_load_dwordx2 s[30:31], s[0:1], 72
    v_readfirstlane_b32 s20, v0
    s_lshr_b32 s20, s20, 6
    s_xor_b32 s20, s20, 8
    s_and_b32 s36, s2, 0
    s_lshl_b32 s36, s36, 3
    s_bfe_u32 s37, s2, 196611
    s_or_b32 s29, s36, s37
    s_bfe_u32 s36, s2, 196608
    s_lshl_b32 s36, s36, 2
    s_lshr_b32 s37, s2, 6
    s_or_b32 s36, s36, s37
    s_mov_b32 s33, 0
    s_and_b32 s34, s36, 15
    s_lshr_b32 s35, s36, 4
    s_mul_i32 s21, s34, 500
    s_and_b32 s32, s20, 3
    v_and_b32 v127, 63, v0
    v_lshrrev_b32 v5, 2, v127
    v_and_b32 v6, 3, v127
    s_and_b32 s42, s20, 7
    v_lshlrev_b32 v7, 15, v5
    v_lshl_add_u32 v7, v6, 4, v7
    s_lshl_b32 s41, s21, 10
    s_sub_u32 s41, s41, 7680
    s_lshl_b32 s37, s42, 12
    s_add_u32 s37, s37, s41
    v_add_u32 v7, s37, v7
    s_mul_i32 s36, s35, 8192000
    s_mov_b32 s10, 8192000
    s_mov_b32 s11, 0x00020000
    s_mov_b32 s25, 0xffff0000
    s_mov_b32 s47, s36
    s_cmp_ge_u32 s20, 8
    s_cbranch_scc1 L_conv1_kernel_helper
    s_add_u32 s37, s41, 524288
    v_lshl_add_u32 v108, v127, 4, s37
    v_add_u32 v109, 1024, v108
    v_add_u32 v110, 2048, v108
    s_waitcnt lgkmcnt(0)
    s_add_u32 s8, s4, s47
    s_addc_u32 s9, s5, 0
    s_lshl_b32 s36, s29, 4
    s_lshl_b32 s37, s33, 3
    s_add_u32 s36, s36, s37
    s_mul_i32 s36, s36, 57344
    s_add_u32 s36, s36, 0
    s_add_u32 s12, s30, s36
    s_addc_u32 s13, s31, 0
    s_mov_b32 s14, 917504
    s_mov_b32 s15, 0x00020000
    s_mul_i32 s36, s35, 4194304
    s_add_u32 s36, s36, 18874368
    s_add_u32 s16, s30, s36
    s_addc_u32 s17, s31, 0
    s_mov_b32 s18, 4194304
    s_mov_b32 s19, 0x00020000
    v_and_b32 v10, 15, v127
    v_lshrrev_b32 v11, 4, v127
    v_add_u32 v8, 0, v10
    v_and_b32 v16, 4, v8
    v_lshrrev_b32 v16, 1, v16
    v_xor_b32 v16, v11, v16
    v_lshlrev_b32 v16, 4, v16
    v_lshl_add_u32 v8, v8, 6, v16
    v_add_u32 v9, 1, v10
    v_and_b32 v16, 4, v9
    v_lshrrev_b32 v16, 1, v16
    v_xor_b32 v16, v11, v16
    v_lshlrev_b32 v16, 4, v16
    v_lshl_add_u32 v9, v9, 6, v16
    s_lshr_b32 s38, s32, 1
    s_and_b32 s39, s32, 1
    s_add_u32 s40, s38, 4
    s_lshl_b32 s43, s39, 10
    s_cmp_lt_u32 s20, 4
    s_cselect_b32 s40, s20, s40
    s_cselect_b32 s36, 0, s43
    s_lshl_b32 s37, s40, 13
    s_add_u32 s37, s37, s36
    v_lshl_add_u32 v125, v127, 4, s37
    s_mul_i32 s37, s40, 16384
    v_add_u32 v120, s37, v8
    v_add_u32 v121, s37, v9
    s_lshl_b32 s37, s40, 10
    s_add_u32 s37, s37, 115712
    v_lshl_add_u32 v16, v11, 4, s37
    v_cmp_eq_u32 vcc, 15, v10
    v_mov_b32 v17, 8192
    v_mov_b32 v18, 4294959104
    v_mov_b32 v19, 64
    v_cndmask_b32 v122, v121, v16, vcc
    v_cndmask_b32 v123, v17, v19, vcc
    v_cndmask_b32 v124, v18, v19, vcc
    v_lshl_add_u32 v126, v127, 4, s37
    s_mov_b32 s44, 0x3f800000
    s_mov_b32 s45, 0x00000000
    s_mov_b32 s46, 0x00000000
    s_cmp_eq_u32 s40, 1
    s_cselect_b32 s45, 0x3f800000, s45
    s_cselect_b32 s46, 0x3f800000, s46
    s_cmp_eq_u32 s40, 2
    s_cselect_b32 s45, 0xbf800000, s45
    s_cselect_b32 s46, 0x3f800000, s46
    s_cmp_eq_u32 s40, 3
    s_cselect_b32 s45, 0x40000000, s45
    s_cselect_b32 s46, 0x40800000, s46
    s_cmp_eq_u32 s40, 4
    s_cselect_b32 s45, 0xc0000000, s45
    s_cselect_b32 s46, 0x40800000, s46
    s_cmp_eq_u32 s40, 5
    s_cselect_b32 s44, 0x41800000, s44
    s_cselect_b32 s45, 0x41000000, s45
    s_cselect_b32 s46, 0x40800000, s46
    s_cmp_ge_u32 s20, 4
    s_cbranch_scc1 L_conv1_kernel_m2
    v_mov_b32 v0, 0
    v_mov_b32 v1, 0
    v_mov_b32 v2, 0
    v_mov_b32 v3, 0
    v_mov_b32 v4, 0
    v_mov_b32 v5, 0
    v_mov_b32 v6, 0
    v_mov_b32 v7, 0
    v_mov_b32 v8, 0
    v_mov_b32 v9, 0
    v_mov_b32 v10, 0
    v_mov_b32 v11, 0
    v_mov_b32 v12, 0
    v_mov_b32 v13, 0
    v_mov_b32 v14, 0
    v_mov_b32 v15, 0
    v_mov_b32 v16, 0
    v_mov_b32 v17, 0
    v_mov_b32 v18, 0
    v_mov_b32 v19, 0
    v_mov_b32 v20, 0
    v_mov_b32 v21, 0
    v_mov_b32 v22, 0
    v_mov_b32 v23, 0
    v_mov_b32 v24, 0
    v_mov_b32 v25, 0
    v_mov_b32 v26, 0
    v_mov_b32 v27, 0
    v_mov_b32 v28, 0
    v_mov_b32 v29, 0
    v_mov_b32 v30, 0
    v_mov_b32 v31, 0
    v_mov_b32 v32, 0
    v_mov_b32 v33, 0
    v_mov_b32 v34, 0
    v_mov_b32 v35, 0
    v_mov_b32 v36, 0
    v_mov_b32 v37, 0
    v_mov_b32 v38, 0
    v_mov_b32 v39, 0
    v_mov_b32 v40, 0
    v_mov_b32 v41, 0
    v_mov_b32 v42, 0
    v_mov_b32 v43, 0
    v_mov_b32 v44, 0
    v_mov_b32 v45, 0
    v_mov_b32 v46, 0
    v_mov_b32 v47, 0
    v_mov_b32 v48, 0
    v_mov_b32 v49, 0
    v_mov_b32 v50, 0
    v_mov_b32 v51, 0
    v_mov_b32 v52, 0
    v_mov_b32 v53, 0
    v_mov_b32 v54, 0
    v_mov_b32 v55, 0
    v_mov_b32 v56, 0
    v_mov_b32 v57, 0
    v_mov_b32 v58, 0
    v_mov_b32 v59, 0
    v_mov_b32 v60, 0
    v_mov_b32 v61, 0
    v_mov_b32 v62, 0
    v_mov_b32 v63, 0
    buffer_load_dwordx4 v[96:99], v108, s[8:11], 0 offen
    buffer_load_dwordx4 v[100:103], v109, s[8:11], 0 offen
    buffer_load_dwordx4 v[104:107], v110, s[8:11], 0 offen
    s_mov_b32 s23, 0
    s_mov_b32 s26, 4096
    buffer_load_dwordx4 v[64:67], v125, s[12:15], s23 offen offset:0
    buffer_load_dwordx4 v[68:71], v125, s[12:15], s23 offen offset:1024
    buffer_load_dwordx4 v[72:75], v125, s[12:15], s23 offen offset:2048
    buffer_load_dwordx4 v[76:79], v125, s[12:15], s23 offen offset:3072
    buffer_load_dwordx4 v[80:83], v125, s[12:15], s26 offen offset:0
    buffer_load_dwordx4 v[84:87], v125, s[12:15], s26 offen offset:1024
    buffer_load_dwordx4 v[88:91], v125, s[12:15], s26 offen offset:2048
    buffer_load_dwordx4 v[92:95], v125, s[12:15], s26 offen offset:3072
    s_mov_b32 s23, 57344
    s_mov_b32 s26, 61440
    s_waitcnt vmcnt(8)
    v_lshlrev_b32 v108, 16, v96
    v_and_b32 v111, s25, v96
    v_lshlrev_b32 v109, 16, v100
    v_and_b32 v112, s25, v100
    v_lshlrev_b32 v110, 16, v104
    v_and_b32 v113, s25, v104
    v_mul_f32 v114, s44, v108
    v_mul_f32 v115, s44, v111
    v_fmac_f32 v114, s45, v109
    v_fmac_f32 v115, s45, v112
    v_fmac_f32 v114, s46, v110
    v_fmac_f32 v115, s46, v113
    v_cvt_pk_bf16_f32 v96, v114, v115
    v_lshlrev_b32 v108, 16, v97
    v_and_b32 v111, s25, v97
    v_lshlrev_b32 v109, 16, v101
    v_and_b32 v112, s25, v101
    v_lshlrev_b32 v110, 16, v105
    v_and_b32 v113, s25, v105
    v_mul_f32 v114, s44, v108
    v_mul_f32 v115, s44, v111
    v_fmac_f32 v114, s45, v109
    v_fmac_f32 v115, s45, v112
    v_fmac_f32 v114, s46, v110
    v_fmac_f32 v115, s46, v113
    v_cvt_pk_bf16_f32 v97, v114, v115
    v_lshlrev_b32 v108, 16, v98
    v_and_b32 v111, s25, v98
    v_lshlrev_b32 v109, 16, v102
    v_and_b32 v112, s25, v102
    v_lshlrev_b32 v110, 16, v106
    v_and_b32 v113, s25, v106
    v_mul_f32 v114, s44, v108
    v_mul_f32 v115, s44, v111
    v_fmac_f32 v114, s45, v109
    v_fmac_f32 v115, s45, v112
    v_fmac_f32 v114, s46, v110
    v_fmac_f32 v115, s46, v113
    v_cvt_pk_bf16_f32 v98, v114, v115
    v_lshlrev_b32 v108, 16, v99
    v_and_b32 v111, s25, v99
    v_lshlrev_b32 v109, 16, v103
    v_and_b32 v112, s25, v103
    v_lshlrev_b32 v110, 16, v107
    v_and_b32 v113, s25, v107
    v_mul_f32 v114, s44, v108
    v_mul_f32 v115, s44, v111
    v_fmac_f32 v114, s45, v109
    v_fmac_f32 v115, s45, v112
    v_fmac_f32 v114, s46, v110
    v_fmac_f32 v115, s46, v113
    v_cvt_pk_bf16_f32 v99, v114, v115
    ds_write_b128 v126, v[96:99]
    s_waitcnt lgkmcnt(0)
    s_barrier
    s_mov_b32 s22, 8
    s_setprio 2
L_conv1_kernel_mloop1:
    ds_read_b128 v[96:99], v120 offset:0
    ds_read_b128 v[100:103], v120 offset:1024
    ds_read_b128 v[104:107], v120 offset:2048
    ds_read_b128 v[108:111], v120 offset:3072
    ds_read_b128 v[112:115], v120 offset:4096
    ds_read_b128 v[116:119], v120 offset:5120
    s_waitcnt vmcnt(6) lgkmcnt(5)
    v_mfma_f32_16x16x32_bf16 v[0:3], v[64:67], v[96:99], v[0:3]
    v_mfma_f32_16x16x32_bf16 v[32:35], v[68:71], v[96:99], v[32:35]
    ds_read_b128 v[96:99], v120 offset:6144
    s_waitcnt vmcnt(4) lgkmcnt(5)
    v_mfma_f32_16x16x32_bf16 v[4:7], v[64:67], v[100:103], v[4:7]
    v_mfma_f32_16x16x32_bf16 v[36:39], v[68:71], v[100:103], v[36:39]
    v_mfma_f32_16x16x32_bf16 v[0:3], v[72:75], v[100:103], v[0:3]
    v_mfma_f32_16x16x32_bf16 v[32:35], v[76:79], v[100:103], v[32:35]
    ds_read_b128 v[100:103], v120 offset:7168
    s_waitcnt vmcnt(2) lgkmcnt(5)
    v_mfma_f32_16x16x32_bf16 v[8:11], v[64:67], v[104:107], v[8:11]
    v_mfma_f32_16x16x32_bf16 v[40:43], v[68:71], v[104:107], v[40:43]
    v_mfma_f32_16x16x32_bf16 v[4:7], v[72:75], v[104:107], v[4:7]
    v_mfma_f32_16x16x32_bf16 v[36:39], v[76:79], v[104:107], v[36:39]
    v_mfma_f32_16x16x32_bf16 v[0:3], v[80:83], v[104:107], v[0:3]
    v_mfma_f32_16x16x32_bf16 v[32:35], v[84:87], v[104:107], v[32:35]
    ds_read_b128 v[104:107], v122 offset:0
    v_add_u32 v122, v123, v122
    s_waitcnt vmcnt(0) lgkmcnt(5)
    v_mfma_f32_16x16x32_bf16 v[12:15], v[64:67], v[108:111], v[12:15]
    v_mfma_f32_16x16x32_bf16 v[44:47], v[68:71], v[108:111], v[44:47]
    v_mfma_f32_16x16x32_bf16 v[8:11], v[72:75], v[108:111], v[8:11]
    v_mfma_f32_16x16x32_bf16 v[40:43], v[76:79], v[108:111], v[40:43]
    v_mfma_f32_16x16x32_bf16 v[4:7], v[80:83], v[108:111], v[4:7]
    v_mfma_f32_16x16x32_bf16 v[36:39], v[84:87], v[108:111], v[36:39]
    v_mfma_f32_16x16x32_bf16 v[0:3], v[88:91], v[108:111], v[0:3]
    v_mfma_f32_16x16x32_bf16 v[32:35], v[92:95], v[108:111], v[32:35]
    ds_read_b128 v[108:111], v121 offset:1024
    s_waitcnt lgkmcnt(5)
    v_mfma_f32_16x16x32_bf16 v[16:19], v[64:67], v[112:115], v[16:19]
    v_mfma_f32_16x16x32_bf16 v[48:51], v[68:71], v[112:115], v[48:51]
    v_mfma_f32_16x16x32_bf16 v[12:15], v[72:75], v[112:115], v[12:15]
    v_mfma_f32_16x16x32_bf16 v[44:47], v[76:79], v[112:115], v[44:47]
    v_mfma_f32_16x16x32_bf16 v[8:11], v[80:83], v[112:115], v[8:11]
    v_mfma_f32_16x16x32_bf16 v[40:43], v[84:87], v[112:115], v[40:43]
    v_mfma_f32_16x16x32_bf16 v[4:7], v[88:91], v[112:115], v[4:7]
    v_mfma_f32_16x16x32_bf16 v[36:39], v[92:95], v[112:115], v[36:39]
    ds_read_b128 v[112:115], v121 offset:2048
    s_waitcnt lgkmcnt(5)
    v_mfma_f32_16x16x32_bf16 v[20:23], v[64:67], v[116:119], v[20:23]
    v_mfma_f32_16x16x32_bf16 v[52:55], v[68:71], v[116:119], v[52:55]
    v_mfma_f32_16x16x32_bf16 v[16:19], v[72:75], v[116:119], v[16:19]
    v_mfma_f32_16x16x32_bf16 v[48:51], v[76:79], v[116:119], v[48:51]
    v_mfma_f32_16x16x32_bf16 v[12:15], v[80:83], v[116:119], v[12:15]
    v_mfma_f32_16x16x32_bf16 v[44:47], v[84:87], v[116:119], v[44:47]
    v_mfma_f32_16x16x32_bf16 v[8:11], v[88:91], v[116:119], v[8:11]
    v_mfma_f32_16x16x32_bf16 v[40:43], v[92:95], v[116:119], v[40:43]
    s_waitcnt lgkmcnt(4)
    v_mfma_f32_16x16x32_bf16 v[24:27], v[64:67], v[96:99], v[24:27]
    v_mfma_f32_16x16x32_bf16 v[56:59], v[68:71], v[96:99], v[56:59]
    v_mfma_f32_16x16x32_bf16 v[20:23], v[72:75], v[96:99], v[20:23]
    v_mfma_f32_16x16x32_bf16 v[52:55], v[76:79], v[96:99], v[52:55]
    v_mfma_f32_16x16x32_bf16 v[16:19], v[80:83], v[96:99], v[16:19]
    v_mfma_f32_16x16x32_bf16 v[48:51], v[84:87], v[96:99], v[48:51]
    v_mfma_f32_16x16x32_bf16 v[12:15], v[88:91], v[96:99], v[12:15]
    v_mfma_f32_16x16x32_bf16 v[44:47], v[92:95], v[96:99], v[44:47]
    s_waitcnt lgkmcnt(3)
    v_mfma_f32_16x16x32_bf16 v[28:31], v[64:67], v[100:103], v[28:31]
    v_mfma_f32_16x16x32_bf16 v[60:63], v[68:71], v[100:103], v[60:63]
    v_mfma_f32_16x16x32_bf16 v[24:27], v[72:75], v[100:103], v[24:27]
    v_mfma_f32_16x16x32_bf16 v[56:59], v[76:79], v[100:103], v[56:59]
    v_mfma_f32_16x16x32_bf16 v[20:23], v[80:83], v[100:103], v[20:23]
    v_mfma_f32_16x16x32_bf16 v[52:55], v[84:87], v[100:103], v[52:55]
    v_mfma_f32_16x16x32_bf16 v[16:19], v[88:91], v[100:103], v[16:19]
    v_mfma_f32_16x16x32_bf16 v[48:51], v[92:95], v[100:103], v[48:51]
    buffer_load_dwordx4 v[64:67], v125, s[12:15], s23 offen offset:0
    buffer_load_dwordx4 v[68:71], v125, s[12:15], s23 offen offset:1024
    s_waitcnt lgkmcnt(2)
    v_mfma_f32_16x16x32_bf16 v[28:31], v[72:75], v[104:107], v[28:31]
    v_mfma_f32_16x16x32_bf16 v[60:63], v[76:79], v[104:107], v[60:63]
    v_mfma_f32_16x16x32_bf16 v[24:27], v[80:83], v[104:107], v[24:27]
    v_mfma_f32_16x16x32_bf16 v[56:59], v[84:87], v[104:107], v[56:59]
    v_mfma_f32_16x16x32_bf16 v[20:23], v[88:91], v[104:107], v[20:23]
    v_mfma_f32_16x16x32_bf16 v[52:55], v[92:95], v[104:107], v[52:55]
    buffer_load_dwordx4 v[72:75], v125, s[12:15], s23 offen offset:2048
    buffer_load_dwordx4 v[76:79], v125, s[12:15], s23 offen offset:3072
    s_waitcnt lgkmcnt(1)
    v_mfma_f32_16x16x32_bf16 v[28:31], v[80:83], v[108:111], v[28:31]
    v_mfma_f32_16x16x32_bf16 v[60:63], v[84:87], v[108:111], v[60:63]
    v_mfma_f32_16x16x32_bf16 v[24:27], v[88:91], v[108:111], v[24:27]
    v_mfma_f32_16x16x32_bf16 v[56:59], v[92:95], v[108:111], v[56:59]
    buffer_load_dwordx4 v[80:83], v125, s[12:15], s26 offen offset:0
    buffer_load_dwordx4 v[84:87], v125, s[12:15], s26 offen offset:1024
    s_waitcnt lgkmcnt(0)
    v_mfma_f32_16x16x32_bf16 v[28:31], v[88:91], v[112:115], v[28:31]
    v_mfma_f32_16x16x32_bf16 v[60:63], v[92:95], v[112:115], v[60:63]
    buffer_load_dwordx4 v[88:91], v125, s[12:15], s26 offen offset:2048
    buffer_load_dwordx4 v[92:95], v125, s[12:15], s26 offen offset:3072
    s_add_u32 s23, s23, 57344
    s_add_u32 s26, s26, 57344
    s_barrier
    s_sub_u32 s22, s22, 1
    s_cmp_eq_u32 s22, 0
    s_cbranch_scc1 L_conv1_kernel_mlast1
    ds_read_b128 v[96:99], v120 offset:8192
    ds_read_b128 v[100:103], v120 offset:9216
    ds_read_b128 v[104:107], v120 offset:10240
    ds_read_b128 v[108:111], v120 offset:11264
    ds_read_b128 v[112:115], v120 offset:12288
    ds_read_b128 v[116:119], v120 offset:13312
    s_waitcnt vmcnt(6) lgkmcnt(5)
    v_mfma_f32_16x16x32_bf16 v[0:3], v[64:67], v[96:99], v[0:3]
    v_mfma_f32_16x16x32_bf16 v[32:35], v[68:71], v[96:99], v[32:35]
    ds_read_b128 v[96:99], v120 offset:14336
    s_waitcnt vmcnt(4) lgkmcnt(5)
    v_mfma_f32_16x16x32_bf16 v[4:7], v[64:67], v[100:103], v[4:7]
    v_mfma_f32_16x16x32_bf16 v[36:39], v[68:71], v[100:103], v[36:39]
    v_mfma_f32_16x16x32_bf16 v[0:3], v[72:75], v[100:103], v[0:3]
    v_mfma_f32_16x16x32_bf16 v[32:35], v[76:79], v[100:103], v[32:35]
    ds_read_b128 v[100:103], v120 offset:15360
    s_waitcnt vmcnt(2) lgkmcnt(5)
    v_mfma_f32_16x16x32_bf16 v[8:11], v[64:67], v[104:107], v[8:11]
    v_mfma_f32_16x16x32_bf16 v[40:43], v[68:71], v[104:107], v[40:43]
    v_mfma_f32_16x16x32_bf16 v[4:7], v[72:75], v[104:107], v[4:7]
    v_mfma_f32_16x16x32_bf16 v[36:39], v[76:79], v[104:107], v[36:39]
    v_mfma_f32_16x16x32_bf16 v[0:3], v[80:83], v[104:107], v[0:3]
    v_mfma_f32_16x16x32_bf16 v[32:35], v[84:87], v[104:107], v[32:35]
    ds_read_b128 v[104:107], v122 offset:0
    v_add_u32 v122, v124, v122
    s_waitcnt vmcnt(0) lgkmcnt(5)
    v_mfma_f32_16x16x32_bf16 v[12:15], v[64:67], v[108:111], v[12:15]
    v_mfma_f32_16x16x32_bf16 v[44:47], v[68:71], v[108:111], v[44:47]
    v_mfma_f32_16x16x32_bf16 v[8:11], v[72:75], v[108:111], v[8:11]
    v_mfma_f32_16x16x32_bf16 v[40:43], v[76:79], v[108:111], v[40:43]
    v_mfma_f32_16x16x32_bf16 v[4:7], v[80:83], v[108:111], v[4:7]
    v_mfma_f32_16x16x32_bf16 v[36:39], v[84:87], v[108:111], v[36:39]
    v_mfma_f32_16x16x32_bf16 v[0:3], v[88:91], v[108:111], v[0:3]
    v_mfma_f32_16x16x32_bf16 v[32:35], v[92:95], v[108:111], v[32:35]
    ds_read_b128 v[108:111], v121 offset:9216
    s_waitcnt lgkmcnt(5)
    v_mfma_f32_16x16x32_bf16 v[16:19], v[64:67], v[112:115], v[16:19]
    v_mfma_f32_16x16x32_bf16 v[48:51], v[68:71], v[112:115], v[48:51]
    v_mfma_f32_16x16x32_bf16 v[12:15], v[72:75], v[112:115], v[12:15]
    v_mfma_f32_16x16x32_bf16 v[44:47], v[76:79], v[112:115], v[44:47]
    v_mfma_f32_16x16x32_bf16 v[8:11], v[80:83], v[112:115], v[8:11]
    v_mfma_f32_16x16x32_bf16 v[40:43], v[84:87], v[112:115], v[40:43]
    v_mfma_f32_16x16x32_bf16 v[4:7], v[88:91], v[112:115], v[4:7]
    v_mfma_f32_16x16x32_bf16 v[36:39], v[92:95], v[112:115], v[36:39]
    ds_read_b128 v[112:115], v121 offset:10240
    s_waitcnt lgkmcnt(5)
    v_mfma_f32_16x16x32_bf16 v[20:23], v[64:67], v[116:119], v[20:23]
    v_mfma_f32_16x16x32_bf16 v[52:55], v[68:71], v[116:119], v[52:55]
    v_mfma_f32_16x16x32_bf16 v[16:19], v[72:75], v[116:119], v[16:19]
    v_mfma_f32_16x16x32_bf16 v[48:51], v[76:79], v[116:119], v[48:51]
    v_mfma_f32_16x16x32_bf16 v[12:15], v[80:83], v[116:119], v[12:15]
    v_mfma_f32_16x16x32_bf16 v[44:47], v[84:87], v[116:119], v[44:47]
    v_mfma_f32_16x16x32_bf16 v[8:11], v[88:91], v[116:119], v[8:11]
    v_mfma_f32_16x16x32_bf16 v[40:43], v[92:95], v[116:119], v[40:43]
    s_waitcnt lgkmcnt(4)
    v_mfma_f32_16x16x32_bf16 v[24:27], v[64:67], v[96:99], v[24:27]
    v_mfma_f32_16x16x32_bf16 v[56:59], v[68:71], v[96:99], v[56:59]
    v_mfma_f32_16x16x32_bf16 v[20:23], v[72:75], v[96:99], v[20:23]
    v_mfma_f32_16x16x32_bf16 v[52:55], v[76:79], v[96:99], v[52:55]
    v_mfma_f32_16x16x32_bf16 v[16:19], v[80:83], v[96:99], v[16:19]
    v_mfma_f32_16x16x32_bf16 v[48:51], v[84:87], v[96:99], v[48:51]
    v_mfma_f32_16x16x32_bf16 v[12:15], v[88:91], v[96:99], v[12:15]
    v_mfma_f32_16x16x32_bf16 v[44:47], v[92:95], v[96:99], v[44:47]
    s_waitcnt lgkmcnt(3)
    v_mfma_f32_16x16x32_bf16 v[28:31], v[64:67], v[100:103], v[28:31]
    v_mfma_f32_16x16x32_bf16 v[60:63], v[68:71], v[100:103], v[60:63]
    v_mfma_f32_16x16x32_bf16 v[24:27], v[72:75], v[100:103], v[24:27]
    v_mfma_f32_16x16x32_bf16 v[56:59], v[76:79], v[100:103], v[56:59]
    v_mfma_f32_16x16x32_bf16 v[20:23], v[80:83], v[100:103], v[20:23]
    v_mfma_f32_16x16x32_bf16 v[52:55], v[84:87], v[100:103], v[52:55]
    v_mfma_f32_16x16x32_bf16 v[16:19], v[88:91], v[100:103], v[16:19]
    v_mfma_f32_16x16x32_bf16 v[48:51], v[92:95], v[100:103], v[48:51]
    buffer_load_dwordx4 v[64:67], v125, s[12:15], s23 offen offset:0
    buffer_load_dwordx4 v[68:71], v125, s[12:15], s23 offen offset:1024
    s_waitcnt lgkmcnt(2)
    v_mfma_f32_16x16x32_bf16 v[28:31], v[72:75], v[104:107], v[28:31]
    v_mfma_f32_16x16x32_bf16 v[60:63], v[76:79], v[104:107], v[60:63]
    v_mfma_f32_16x16x32_bf16 v[24:27], v[80:83], v[104:107], v[24:27]
    v_mfma_f32_16x16x32_bf16 v[56:59], v[84:87], v[104:107], v[56:59]
    v_mfma_f32_16x16x32_bf16 v[20:23], v[88:91], v[104:107], v[20:23]
    v_mfma_f32_16x16x32_bf16 v[52:55], v[92:95], v[104:107], v[52:55]
    buffer_load_dwordx4 v[72:75], v125, s[12:15], s23 offen offset:2048
    buffer_load_dwordx4 v[76:79], v125, s[12:15], s23 offen offset:3072
    s_waitcnt lgkmcnt(1)
    v_mfma_f32_16x16x32_bf16 v[28:31], v[80:83], v[108:111], v[28:31]
    v_mfma_f32_16x16x32_bf16 v[60:63], v[84:87], v[108:111], v[60:63]
    v_mfma_f32_16x16x32_bf16 v[24:27], v[88:91], v[108:111], v[24:27]
    v_mfma_f32_16x16x32_bf16 v[56:59], v[92:95], v[108:111], v[56:59]
    buffer_load_dwordx4 v[80:83], v125, s[12:15], s26 offen offset:0
    buffer_load_dwordx4 v[84:87], v125, s[12:15], s26 offen offset:1024
    s_waitcnt lgkmcnt(0)
    v_mfma_f32_16x16x32_bf16 v[28:31], v[88:91], v[112:115], v[28:31]
    v_mfma_f32_16x16x32_bf16 v[60:63], v[92:95], v[112:115], v[60:63]
    buffer_load_dwordx4 v[88:91], v125, s[12:15], s26 offen offset:2048
    buffer_load_dwordx4 v[92:95], v125, s[12:15], s26 offen offset:3072
    s_add_u32 s23, s23, 57344
    s_add_u32 s26, s26, 57344
    s_barrier
    s_branch L_conv1_kernel_mloop1
L_conv1_kernel_mlast1:
    v_and_b32 v125, 15, v127
    v_and_b32 v126, 7, v127
    v_lshlrev_b32 v126, 4, v126
    v_lshl_add_u32 v125, v125, 7, v126
    v_lshrrev_b32 v126, 4, v127
    v_lshl_add_u32 v125, v126, 11, v125
    s_lshl_b32 s36, s20, 14
    s_add_u32 s37, s36, 8192
    v_add_u32 v126, s37, v125
    v_add_u32 v125, s36, v125
    ds_read_b128 v[96:99], v120 offset:8192
    ds_read_b128 v[100:103], v120 offset:9216
    ds_read_b128 v[104:107], v120 offset:10240
    ds_read_b128 v[108:111], v120 offset:11264
    ds_read_b128 v[112:115], v120 offset:12288
    ds_read_b128 v[116:119], v120 offset:13312
    s_waitcnt vmcnt(6) lgkmcnt(5)
    v_mfma_f32_16x16x32_bf16 v[0:3], v[64:67], v[96:99], v[0:3]
    v_mfma_f32_16x16x32_bf16 v[32:35], v[68:71], v[96:99], v[32:35]
    ds_read_b128 v[96:99], v120 offset:14336
    s_waitcnt vmcnt(4) lgkmcnt(5)
    v_mfma_f32_16x16x32_bf16 v[4:7], v[64:67], v[100:103], v[4:7]
    v_mfma_f32_16x16x32_bf16 v[36:39], v[68:71], v[100:103], v[36:39]
    v_mfma_f32_16x16x32_bf16 v[0:3], v[72:75], v[100:103], v[0:3]
    v_mfma_f32_16x16x32_bf16 v[32:35], v[76:79], v[100:103], v[32:35]
    ds_read_b128 v[100:103], v120 offset:15360
    s_waitcnt vmcnt(2) lgkmcnt(5)
    v_mfma_f32_16x16x32_bf16 v[8:11], v[64:67], v[104:107], v[8:11]
    v_mfma_f32_16x16x32_bf16 v[40:43], v[68:71], v[104:107], v[40:43]
    v_mfma_f32_16x16x32_bf16 v[4:7], v[72:75], v[104:107], v[4:7]
    v_mfma_f32_16x16x32_bf16 v[36:39], v[76:79], v[104:107], v[36:39]
    v_mfma_f32_16x16x32_bf16 v[0:3], v[80:83], v[104:107], v[0:3]
    v_mfma_f32_16x16x32_bf16 v[32:35], v[84:87], v[104:107], v[32:35]
    ds_read_b128 v[104:107], v122 offset:0
    s_waitcnt vmcnt(0) lgkmcnt(5)
    v_mfma_f32_16x16x32_bf16 v[12:15], v[64:67], v[108:111], v[12:15]
    v_mfma_f32_16x16x32_bf16 v[44:47], v[68:71], v[108:111], v[44:47]
    v_mfma_f32_16x16x32_bf16 v[8:11], v[72:75], v[108:111], v[8:11]
    v_mfma_f32_16x16x32_bf16 v[40:43], v[76:79], v[108:111], v[40:43]
    v_mfma_f32_16x16x32_bf16 v[4:7], v[80:83], v[108:111], v[4:7]
    v_mfma_f32_16x16x32_bf16 v[36:39], v[84:87], v[108:111], v[36:39]
    v_mfma_f32_16x16x32_bf16 v[0:3], v[88:91], v[108:111], v[0:3]
    v_mfma_f32_16x16x32_bf16 v[32:35], v[92:95], v[108:111], v[32:35]
    ds_read_b128 v[108:111], v121 offset:9216
    s_waitcnt lgkmcnt(5)
    v_mfma_f32_16x16x32_bf16 v[16:19], v[64:67], v[112:115], v[16:19]
    v_mfma_f32_16x16x32_bf16 v[48:51], v[68:71], v[112:115], v[48:51]
    v_mfma_f32_16x16x32_bf16 v[12:15], v[72:75], v[112:115], v[12:15]
    v_mfma_f32_16x16x32_bf16 v[44:47], v[76:79], v[112:115], v[44:47]
    v_mfma_f32_16x16x32_bf16 v[8:11], v[80:83], v[112:115], v[8:11]
    v_mfma_f32_16x16x32_bf16 v[40:43], v[84:87], v[112:115], v[40:43]
    v_mfma_f32_16x16x32_bf16 v[4:7], v[88:91], v[112:115], v[4:7]
    v_mfma_f32_16x16x32_bf16 v[36:39], v[92:95], v[112:115], v[36:39]
    ds_read_b128 v[112:115], v121 offset:10240
    v_xor_b32 v123, 0, v125
    ds_write_b128 v123, v[0:3]
    s_waitcnt lgkmcnt(6)
    v_mfma_f32_16x16x32_bf16 v[20:23], v[64:67], v[116:119], v[20:23]
    v_mfma_f32_16x16x32_bf16 v[52:55], v[68:71], v[116:119], v[52:55]
    v_mfma_f32_16x16x32_bf16 v[16:19], v[72:75], v[116:119], v[16:19]
    v_mfma_f32_16x16x32_bf16 v[48:51], v[76:79], v[116:119], v[48:51]
    v_mfma_f32_16x16x32_bf16 v[12:15], v[80:83], v[116:119], v[12:15]
    v_mfma_f32_16x16x32_bf16 v[44:47], v[84:87], v[116:119], v[44:47]
    v_mfma_f32_16x16x32_bf16 v[8:11], v[88:91], v[116:119], v[8:11]
    v_mfma_f32_16x16x32_bf16 v[40:43], v[92:95], v[116:119], v[40:43]
    v_xor_b32 v124, 16, v125
    ds_write_b128 v124, v[4:7]
    s_waitcnt lgkmcnt(2)
    v_mfma_f32_16x16x32_bf16 v[24:27], v[64:67], v[96:99], v[24:27]
    v_mfma_f32_16x16x32_bf16 v[56:59], v[68:71], v[96:99], v[56:59]
    v_mfma_f32_16x16x32_bf16 v[20:23], v[72:75], v[96:99], v[20:23]
    v_mfma_f32_16x16x32_bf16 v[52:55], v[76:79], v[96:99], v[52:55]
    v_mfma_f32_16x16x32_bf16 v[16:19], v[80:83], v[96:99], v[16:19]
    v_mfma_f32_16x16x32_bf16 v[48:51], v[84:87], v[96:99], v[48:51]
    v_mfma_f32_16x16x32_bf16 v[12:15], v[88:91], v[96:99], v[12:15]
    v_mfma_f32_16x16x32_bf16 v[44:47], v[92:95], v[96:99], v[44:47]
    v_xor_b32 v123, 32, v125
    ds_write_b128 v123, v[8:11]
    v_xor_b32 v124, 0, v126
    ds_write_b128 v124, v[32:35]
    v_mfma_f32_16x16x32_bf16 v[28:31], v[64:67], v[100:103], v[28:31]
    v_mfma_f32_16x16x32_bf16 v[60:63], v[68:71], v[100:103], v[60:63]
    v_mfma_f32_16x16x32_bf16 v[24:27], v[72:75], v[100:103], v[24:27]
    v_mfma_f32_16x16x32_bf16 v[56:59], v[76:79], v[100:103], v[56:59]
    v_mfma_f32_16x16x32_bf16 v[20:23], v[80:83], v[100:103], v[20:23]
    v_mfma_f32_16x16x32_bf16 v[52:55], v[84:87], v[100:103], v[52:55]
    v_mfma_f32_16x16x32_bf16 v[16:19], v[88:91], v[100:103], v[16:19]
    v_mfma_f32_16x16x32_bf16 v[48:51], v[92:95], v[100:103], v[48:51]
    v_xor_b32 v123, 16, v126
    ds_write_b128 v123, v[36:39]
    v_xor_b32 v124, 32, v126
    ds_write_b128 v124, v[40:43]
    v_mfma_f32_16x16x32_bf16 v[28:31], v[72:75], v[104:107], v[28:31]
    v_mfma_f32_16x16x32_bf16 v[60:63], v[76:79], v[104:107], v[60:63]
    v_mfma_f32_16x16x32_bf16 v[24:27], v[80:83], v[104:107], v[24:27]
    v_mfma_f32_16x16x32_bf16 v[56:59], v[84:87], v[104:107], v[56:59]
    v_mfma_f32_16x16x32_bf16 v[20:23], v[88:91], v[104:107], v[20:23]
    v_mfma_f32_16x16x32_bf16 v[52:55], v[92:95], v[104:107], v[52:55]
    v_xor_b32 v124, 48, v125
    ds_write_b128 v124, v[12:15]
    v_xor_b32 v123, 48, v126
    ds_write_b128 v123, v[44:47]
    v_mfma_f32_16x16x32_bf16 v[28:31], v[80:83], v[108:111], v[28:31]
    v_mfma_f32_16x16x32_bf16 v[60:63], v[84:87], v[108:111], v[60:63]
    v_mfma_f32_16x16x32_bf16 v[24:27], v[88:91], v[108:111], v[24:27]
    v_mfma_f32_16x16x32_bf16 v[56:59], v[92:95], v[108:111], v[56:59]
    v_xor_b32 v123, 64, v125
    ds_write_b128 v123, v[16:19]
    v_xor_b32 v124, 64, v126
    ds_write_b128 v124, v[48:51]
    v_mfma_f32_16x16x32_bf16 v[28:31], v[88:91], v[112:115], v[28:31]
    v_mfma_f32_16x16x32_bf16 v[60:63], v[92:95], v[112:115], v[60:63]
    v_xor_b32 v124, 80, v125
    ds_write_b128 v124, v[20:23]
    v_xor_b32 v123, 80, v126
    ds_write_b128 v123, v[52:55]
    v_and_b32 v108, 15, v127
    v_lshrrev_b32 v109, 4, v127
    v_lshrrev_b32 v110, 3, v108
    s_lshl_b32 s36, s20, 1
    v_add_u32 v110, s36, v110
    v_xor_b32 v111, v110, v108
    v_and_b32 v111, 7, v111
    v_lshlrev_b32 v111, 4, v111
    v_xor_b32 v123, 96, v125
    ds_write_b128 v123, v[24:27]
    v_lshl_add_u32 v111, v110, 7, v111
    v_lshl_add_u32 v120, v109, 11, v111
    v_add_u32 v121, 65536, v120
    v_add_u32 v64, 131072, v120
    s_lshl_b32 s36, s20, 9
    s_add_u32 s36, s36, 115712
    v_lshl_add_u32 v127, v109, 7, s36
    s_lshl_b32 s36, s20, 4
    v_add_u32 v108, s36, v108
    v_lshlrev_b32 v110, 6, v108
    v_lshl_add_u32 v110, v109, 4, v110
    s_mul_i32 s36, s29, 524288
    v_xor_b32 v124, 96, v126
    ds_write_b128 v124, v[56:59]
    s_lshl_b32 s37, s21, 4
    s_add_u32 s36, s36, s37
    v_add_u32 v110, s36, v110
    v_mov_b32 v111, 2130706432
    v_cmp_gt_u32 vcc, 125, v108
    s_mov_b32 s4, 0xbeaaaaab
    s_mov_b32 s5, s4
    s_mov_b32 s6, 0x3e800000
    s_mov_b32 s7, s6
    s_mov_b32 s8, 0xc0a00000
    s_mov_b32 s9, s8
    s_mov_b32 s10, 0xc0638e39
    v_xor_b32 v124, 112, v125
    ds_write_b128 v124, v[28:31]
    s_mov_b32 s11, s10
    s_mov_b32 s12, 0xbf638e39
    s_mov_b32 s13, s12
    s_mov_b32 s14, 0xbe638e39
    s_mov_b32 s15, s14
    s_mov_b32 s22, 0xbd638e39
    s_mov_b32 s23, s22
    s_mov_b32 s24, 0x3ff1c71c
    s_mov_b32 s25, s24
    s_mov_b32 s26, 0xbf2aaaab
    s_mov_b32 s27, s26
    s_mov_b32 s32, 0x3ecccccd
    v_xor_b32 v123, 112, v126
    s_waitcnt lgkmcnt(8)
    ds_write_b128 v123, v[60:63]
    s_mov_b32 s33, s32
    s_mov_b32 s34, 0xbd888889
    s_mov_b32 s35, s34
    s_mov_b32 s38, 0xbe4ccccd
    s_mov_b32 s39, s38
    s_mov_b32 s40, 0xbdd2d3e8
    s_mov_b32 s41, s40
    s_mov_b32 s42, 0x3f800000
    s_mov_b32 s43, s42
    s_setprio 0
    s_branch L_conv1_kernel_epi
L_conv1_kernel_m2:
    s_mul_i32 s37, s38, 2176
    s_add_u32 s37, s37, 98304
    v_add_u32 v116, s37, v8
    v_add_u32 v118, s37, v9
    v_add_u32 v117, 104832, v8
    s_cmp_eq_u32 s38, 0
    s_cbranch_scc1 L_conv1_kernel_hh0
    v_add_u32 v117, 98304, v9
L_conv1_kernel_hh0:
    s_lshl_b32 s37, s38, 12
    s_add_u32 s37, s37, s43
    s_add_u32 s37, s37, 49152
    v_lshl_add_u32 v119, v127, 4, s37
    v_mov_b32 v0, 0
    v_mov_b32 v1, 0
    v_mov_b32 v2, 0
    v_mov_b32 v3, 0
    v_mov_b32 v4, 0
    v_mov_b32 v5, 0
    v_mov_b32 v6, 0
    v_mov_b32 v7, 0
    v_mov_b32 v8, 0
    v_mov_b32 v9, 0
    v_mov_b32 v10, 0
    v_mov_b32 v11, 0
    v_mov_b32 v12, 0
    v_mov_b32 v13, 0
    v_mov_b32 v14, 0
    v_mov_b32 v15, 0
    v_mov_b32 v16, 0
    v_mov_b32 v17, 0
    v_mov_b32 v18, 0
    v_mov_b32 v19, 0
    v_mov_b32 v20, 0
    v_mov_b32 v21, 0
    v_mov_b32 v22, 0
    v_mov_b32 v23, 0
    v_mov_b32 v24, 0
    v_mov_b32 v25, 0
    v_mov_b32 v26, 0
    v_mov_b32 v27, 0
    v_mov_b32 v28, 0
    v_mov_b32 v29, 0
    v_mov_b32 v30, 0
    v_mov_b32 v31, 0
    v_mov_b32 v32, 0
    v_mov_b32 v33, 0
    v_mov_b32 v34, 0
    v_mov_b32 v35, 0
    v_mov_b32 v36, 0
    v_mov_b32 v37, 0
    v_mov_b32 v38, 0
    v_mov_b32 v39, 0
    v_mov_b32 v40, 0
    v_mov_b32 v41, 0
    v_mov_b32 v42, 0
    v_mov_b32 v43, 0
    v_mov_b32 v44, 0
    v_mov_b32 v45, 0
    v_mov_b32 v46, 0
    v_mov_b32 v47, 0
    v_mov_b32 v48, 0
    v_mov_b32 v49, 0
    v_mov_b32 v50, 0
    v_mov_b32 v51, 0
    v_mov_b32 v52, 0
    v_mov_b32 v53, 0
    v_mov_b32 v54, 0
    v_mov_b32 v55, 0
    v_mov_b32 v56, 0
    v_mov_b32 v57, 0
    v_mov_b32 v58, 0
    v_mov_b32 v59, 0
    v_mov_b32 v60, 0
    v_mov_b32 v61, 0
    v_mov_b32 v62, 0
    v_mov_b32 v63, 0
    buffer_load_dwordx4 v[96:99], v108, s[8:11], 0 offen
    buffer_load_dwordx4 v[100:103], v109, s[8:11], 0 offen
    buffer_load_dwordx4 v[104:107], v110, s[8:11], 0 offen
    s_mov_b32 s23, 0
    s_mov_b32 s26, 4096
    buffer_load_dwordx4 v[64:67], v125, s[12:15], s23 offen offset:0
    buffer_load_dwordx4 v[68:71], v125, s[12:15], s23 offen offset:2048
    buffer_load_dwordx4 v[80:83], v119, s[12:15], s23 offen offset:0
    buffer_load_dwordx4 v[72:75], v125, s[12:15], s26 offen offset:0
    buffer_load_dwordx4 v[84:87], v119, s[12:15], s23 offen offset:2048
    buffer_load_dwordx4 v[76:79], v125, s[12:15], s26 offen offset:2048
    s_mov_b32 s23, 57344
    s_mov_b32 s26, 61440
    s_waitcnt vmcnt(6)
    v_lshlrev_b32 v108, 16, v96
    v_and_b32 v111, s25, v96
    v_lshlrev_b32 v109, 16, v100
    v_and_b32 v112, s25, v100
    v_lshlrev_b32 v110, 16, v104
    v_and_b32 v113, s25, v104
    v_mul_f32 v114, s44, v108
    v_mul_f32 v115, s44, v111
    v_fmac_f32 v114, s45, v109
    v_fmac_f32 v115, s45, v112
    v_fmac_f32 v114, s46, v110
    v_fmac_f32 v115, s46, v113
    v_cvt_pk_bf16_f32 v96, v114, v115
    v_lshlrev_b32 v108, 16, v97
    v_and_b32 v111, s25, v97
    v_lshlrev_b32 v109, 16, v101
    v_and_b32 v112, s25, v101
    v_lshlrev_b32 v110, 16, v105
    v_and_b32 v113, s25, v105
    v_mul_f32 v114, s44, v108
    v_mul_f32 v115, s44, v111
    v_fmac_f32 v114, s45, v109
    v_fmac_f32 v115, s45, v112
    v_fmac_f32 v114, s46, v110
    v_fmac_f32 v115, s46, v113
    v_cvt_pk_bf16_f32 v97, v114, v115
    v_lshlrev_b32 v108, 16, v98
    v_and_b32 v111, s25, v98
    v_lshlrev_b32 v109, 16, v102
    v_and_b32 v112, s25, v102
    v_lshlrev_b32 v110, 16, v106
    v_and_b32 v113, s25, v106
    v_mul_f32 v114, s44, v108
    v_mul_f32 v115, s44, v111
    v_fmac_f32 v114, s45, v109
    v_fmac_f32 v115, s45, v112
    v_fmac_f32 v114, s46, v110
    v_fmac_f32 v115, s46, v113
    v_cvt_pk_bf16_f32 v98, v114, v115
    v_lshlrev_b32 v108, 16, v99
    v_and_b32 v111, s25, v99
    v_lshlrev_b32 v109, 16, v103
    v_and_b32 v112, s25, v103
    v_lshlrev_b32 v110, 16, v107
    v_and_b32 v113, s25, v107
    v_mul_f32 v114, s44, v108
    v_mul_f32 v115, s44, v111
    v_fmac_f32 v114, s45, v109
    v_fmac_f32 v115, s45, v112
    v_fmac_f32 v114, s46, v110
    v_fmac_f32 v115, s46, v113
    v_cvt_pk_bf16_f32 v99, v114, v115
    ds_write_b128 v126, v[96:99]
    v_and_b32 v111, 15, v127
    v_lshlrev_b32 v111, 2, v111
    v_add_u32 v111, 99328, v111
    ds_write_b32 v111, v0
    ds_write_b32 v111, v0 offset:8704
    s_waitcnt lgkmcnt(0)
    s_barrier
    s_mov_b32 s22, 8
    s_setprio 2
L_conv1_kernel_mloop2:
    ds_read_b128 v[88:91], v120 offset:0
    ds_read_b128 v[92:95], v120 offset:1024
    ds_read_b128 v[96:99], v116 offset:0
    ds_read_b128 v[100:103], v120 offset:2048
    ds_read_b128 v[104:107], v116 offset:1088
    ds_read_b128 v[108:111], v120 offset:3072
    ds_read_b128 v[112:115], v116 offset:2176
    s_waitcnt vmcnt(5) lgkmcnt(6)
    v_mfma_f32_16x16x32_bf16 v[0:3], v[64:67], v[88:91], v[0:3]
    ds_read_b128 v[88:91], v120 offset:4096
    s_waitcnt vmcnt(4) lgkmcnt(6)
    v_mfma_f32_16x16x32_bf16 v[4:7], v[64:67], v[92:95], v[4:7]
    v_mfma_f32_16x16x32_bf16 v[0:3], v[68:71], v[92:95], v[0:3]
    ds_read_b128 v[92:95], v116 offset:3264
    s_waitcnt vmcnt(3) lgkmcnt(6)
    v_mfma_f32_16x16x32_bf16 v[32:35], v[80:83], v[96:99], v[32:35]
    ds_read_b128 v[96:99], v120 offset:5120
    s_waitcnt vmcnt(2) lgkmcnt(6)
    v_mfma_f32_16x16x32_bf16 v[8:11], v[64:67], v[100:103], v[8:11]
    v_mfma_f32_16x16x32_bf16 v[4:7], v[68:71], v[100:103], v[4:7]
    v_mfma_f32_16x16x32_bf16 v[0:3], v[72:75], v[100:103], v[0:3]
    ds_read_b128 v[100:103], v116 offset:4352
    s_waitcnt vmcnt(1) lgkmcnt(6)
    v_mfma_f32_16x16x32_bf16 v[36:39], v[80:83], v[104:107], v[36:39]
    v_mfma_f32_16x16x32_bf16 v[32:35], v[84:87], v[104:107], v[32:35]
    ds_read_b128 v[104:107], v120 offset:6144
    s_waitcnt vmcnt(0) lgkmcnt(6)
    v_mfma_f32_16x16x32_bf16 v[12:15], v[64:67], v[108:111], v[12:15]
    v_mfma_f32_16x16x32_bf16 v[8:11], v[68:71], v[108:111], v[8:11]
    v_mfma_f32_16x16x32_bf16 v[4:7], v[72:75], v[108:111], v[4:7]
    v_mfma_f32_16x16x32_bf16 v[0:3], v[76:79], v[108:111], v[0:3]
    ds_read_b128 v[108:111], v116 offset:5440
    s_waitcnt lgkmcnt(6)
    v_mfma_f32_16x16x32_bf16 v[40:43], v[80:83], v[112:115], v[40:43]
    v_mfma_f32_16x16x32_bf16 v[36:39], v[84:87], v[112:115], v[36:39]
    ds_read_b128 v[112:115], v120 offset:7168
    s_waitcnt lgkmcnt(6)
    v_mfma_f32_16x16x32_bf16 v[16:19], v[64:67], v[88:91], v[16:19]
    v_mfma_f32_16x16x32_bf16 v[12:15], v[68:71], v[88:91], v[12:15]
    v_mfma_f32_16x16x32_bf16 v[8:11], v[72:75], v[88:91], v[8:11]
    v_mfma_f32_16x16x32_bf16 v[4:7], v[76:79], v[88:91], v[4:7]
    ds_read_b128 v[88:91], v117 offset:0
    s_waitcnt lgkmcnt(6)
    v_mfma_f32_16x16x32_bf16 v[44:47], v[80:83], v[92:95], v[44:47]
    v_mfma_f32_16x16x32_bf16 v[40:43], v[84:87], v[92:95], v[40:43]
    ds_read_b128 v[92:95], v122 offset:0
    v_add_u32 v122, v123, v122
    s_waitcnt lgkmcnt(6)
    v_mfma_f32_16x16x32_bf16 v[20:23], v[64:67], v[96:99], v[20:23]
    v_mfma_f32_16x16x32_bf16 v[16:19], v[68:71], v[96:99], v[16:19]
    v_mfma_f32_16x16x32_bf16 v[12:15], v[72:75], v[96:99], v[12:15]
    v_mfma_f32_16x16x32_bf16 v[8:11], v[76:79], v[96:99], v[8:11]
    ds_read_b128 v[96:99], v117 offset:1088
    s_waitcnt lgkmcnt(6)
    v_mfma_f32_16x16x32_bf16 v[48:51], v[80:83], v[100:103], v[48:51]
    v_mfma_f32_16x16x32_bf16 v[44:47], v[84:87], v[100:103], v[44:47]
    ds_read_b128 v[100:103], v121 offset:1024
    s_waitcnt lgkmcnt(6)
    v_mfma_f32_16x16x32_bf16 v[24:27], v[64:67], v[104:107], v[24:27]
    v_mfma_f32_16x16x32_bf16 v[20:23], v[68:71], v[104:107], v[20:23]
    v_mfma_f32_16x16x32_bf16 v[16:19], v[72:75], v[104:107], v[16:19]
    v_mfma_f32_16x16x32_bf16 v[12:15], v[76:79], v[104:107], v[12:15]
    ds_read_b128 v[104:107], v118 offset:0
    s_waitcnt lgkmcnt(6)
    v_mfma_f32_16x16x32_bf16 v[52:55], v[80:83], v[108:111], v[52:55]
    v_mfma_f32_16x16x32_bf16 v[48:51], v[84:87], v[108:111], v[48:51]
    ds_read_b128 v[108:111], v121 offset:2048
    s_waitcnt lgkmcnt(6)
    v_mfma_f32_16x16x32_bf16 v[28:31], v[64:67], v[112:115], v[28:31]
    v_mfma_f32_16x16x32_bf16 v[24:27], v[68:71], v[112:115], v[24:27]
    v_mfma_f32_16x16x32_bf16 v[20:23], v[72:75], v[112:115], v[20:23]
    v_mfma_f32_16x16x32_bf16 v[16:19], v[76:79], v[112:115], v[16:19]
    buffer_load_dwordx4 v[64:67], v125, s[12:15], s23 offen offset:0
    s_waitcnt lgkmcnt(5)
    v_mfma_f32_16x16x32_bf16 v[56:59], v[80:83], v[88:91], v[56:59]
    v_mfma_f32_16x16x32_bf16 v[52:55], v[84:87], v[88:91], v[52:55]
    s_waitcnt lgkmcnt(0)
    s_barrier
    v_mfma_f32_16x16x32_bf16 v[28:31], v[68:71], v[92:95], v[28:31]
    v_mfma_f32_16x16x32_bf16 v[24:27], v[72:75], v[92:95], v[24:27]
    v_mfma_f32_16x16x32_bf16 v[20:23], v[76:79], v[92:95], v[20:23]
    buffer_load_dwordx4 v[68:71], v125, s[12:15], s23 offen offset:2048
    v_mfma_f32_16x16x32_bf16 v[60:63], v[80:83], v[96:99], v[60:63]
    v_mfma_f32_16x16x32_bf16 v[56:59], v[84:87], v[96:99], v[56:59]
    buffer_load_dwordx4 v[80:83], v119, s[12:15], s23 offen offset:0
    v_mfma_f32_16x16x32_bf16 v[28:31], v[72:75], v[100:103], v[28:31]
    v_mfma_f32_16x16x32_bf16 v[24:27], v[76:79], v[100:103], v[24:27]
    buffer_load_dwordx4 v[72:75], v125, s[12:15], s26 offen offset:0
    v_mfma_f32_16x16x32_bf16 v[60:63], v[84:87], v[104:107], v[60:63]
    buffer_load_dwordx4 v[84:87], v119, s[12:15], s23 offen offset:2048
    v_mfma_f32_16x16x32_bf16 v[28:31], v[76:79], v[108:111], v[28:31]
    buffer_load_dwordx4 v[76:79], v125, s[12:15], s26 offen offset:2048
    s_add_u32 s23, s23, 57344
    s_add_u32 s26, s26, 57344
    s_sub_u32 s22, s22, 1
    s_cmp_eq_u32 s22, 0
    s_cbranch_scc1 L_conv1_kernel_mlast2
    ds_read_b128 v[88:91], v120 offset:8192
    ds_read_b128 v[92:95], v120 offset:9216
    ds_read_b128 v[96:99], v116 offset:8704
    ds_read_b128 v[100:103], v120 offset:10240
    ds_read_b128 v[104:107], v116 offset:9792
    ds_read_b128 v[108:111], v120 offset:11264
    ds_read_b128 v[112:115], v116 offset:10880
    s_waitcnt vmcnt(5) lgkmcnt(6)
    v_mfma_f32_16x16x32_bf16 v[0:3], v[64:67], v[88:91], v[0:3]
    ds_read_b128 v[88:91], v120 offset:12288
    s_waitcnt vmcnt(4) lgkmcnt(6)
    v_mfma_f32_16x16x32_bf16 v[4:7], v[64:67], v[92:95], v[4:7]
    v_mfma_f32_16x16x32_bf16 v[0:3], v[68:71], v[92:95], v[0:3]
    ds_read_b128 v[92:95], v116 offset:11968
    s_waitcnt vmcnt(3) lgkmcnt(6)
    v_mfma_f32_16x16x32_bf16 v[32:35], v[80:83], v[96:99], v[32:35]
    ds_read_b128 v[96:99], v120 offset:13312
    s_waitcnt vmcnt(2) lgkmcnt(6)
    v_mfma_f32_16x16x32_bf16 v[8:11], v[64:67], v[100:103], v[8:11]
    v_mfma_f32_16x16x32_bf16 v[4:7], v[68:71], v[100:103], v[4:7]
    v_mfma_f32_16x16x32_bf16 v[0:3], v[72:75], v[100:103], v[0:3]
    ds_read_b128 v[100:103], v116 offset:13056
    s_waitcnt vmcnt(1) lgkmcnt(6)
    v_mfma_f32_16x16x32_bf16 v[36:39], v[80:83], v[104:107], v[36:39]
    v_mfma_f32_16x16x32_bf16 v[32:35], v[84:87], v[104:107], v[32:35]
    ds_read_b128 v[104:107], v120 offset:14336
    s_waitcnt vmcnt(0) lgkmcnt(6)
    v_mfma_f32_16x16x32_bf16 v[12:15], v[64:67], v[108:111], v[12:15]
    v_mfma_f32_16x16x32_bf16 v[8:11], v[68:71], v[108:111], v[8:11]
    v_mfma_f32_16x16x32_bf16 v[4:7], v[72:75], v[108:111], v[4:7]
    v_mfma_f32_16x16x32_bf16 v[0:3], v[76:79], v[108:111], v[0:3]
    ds_read_b128 v[108:111], v116 offset:14144
    s_waitcnt lgkmcnt(6)
    v_mfma_f32_16x16x32_bf16 v[40:43], v[80:83], v[112:115], v[40:43]
    v_mfma_f32_16x16x32_bf16 v[36:39], v[84:87], v[112:115], v[36:39]
    ds_read_b128 v[112:115], v120 offset:15360
    s_waitcnt lgkmcnt(6)
    v_mfma_f32_16x16x32_bf16 v[16:19], v[64:67], v[88:91], v[16:19]
    v_mfma_f32_16x16x32_bf16 v[12:15], v[68:71], v[88:91], v[12:15]
    v_mfma_f32_16x16x32_bf16 v[8:11], v[72:75], v[88:91], v[8:11]
    v_mfma_f32_16x16x32_bf16 v[4:7], v[76:79], v[88:91], v[4:7]
    ds_read_b128 v[88:91], v117 offset:8704
    s_waitcnt lgkmcnt(6)
    v_mfma_f32_16x16x32_bf16 v[44:47], v[80:83], v[92:95], v[44:47]
    v_mfma_f32_16x16x32_bf16 v[40:43], v[84:87], v[92:95], v[40:43]
    ds_read_b128 v[92:95], v122 offset:0
    v_add_u32 v122, v124, v122
    s_waitcnt lgkmcnt(6)
    v_mfma_f32_16x16x32_bf16 v[20:23], v[64:67], v[96:99], v[20:23]
    v_mfma_f32_16x16x32_bf16 v[16:19], v[68:71], v[96:99], v[16:19]
    v_mfma_f32_16x16x32_bf16 v[12:15], v[72:75], v[96:99], v[12:15]
    v_mfma_f32_16x16x32_bf16 v[8:11], v[76:79], v[96:99], v[8:11]
    ds_read_b128 v[96:99], v117 offset:9792
    s_waitcnt lgkmcnt(6)
    v_mfma_f32_16x16x32_bf16 v[48:51], v[80:83], v[100:103], v[48:51]
    v_mfma_f32_16x16x32_bf16 v[44:47], v[84:87], v[100:103], v[44:47]
    ds_read_b128 v[100:103], v121 offset:9216
    s_waitcnt lgkmcnt(6)
    v_mfma_f32_16x16x32_bf16 v[24:27], v[64:67], v[104:107], v[24:27]
    v_mfma_f32_16x16x32_bf16 v[20:23], v[68:71], v[104:107], v[20:23]
    v_mfma_f32_16x16x32_bf16 v[16:19], v[72:75], v[104:107], v[16:19]
    v_mfma_f32_16x16x32_bf16 v[12:15], v[76:79], v[104:107], v[12:15]
    ds_read_b128 v[104:107], v118 offset:8704
    s_waitcnt lgkmcnt(6)
    v_mfma_f32_16x16x32_bf16 v[52:55], v[80:83], v[108:111], v[52:55]
    v_mfma_f32_16x16x32_bf16 v[48:51], v[84:87], v[108:111], v[48:51]
    ds_read_b128 v[108:111], v121 offset:10240
    s_waitcnt lgkmcnt(6)
    v_mfma_f32_16x16x32_bf16 v[28:31], v[64:67], v[112:115], v[28:31]
    v_mfma_f32_16x16x32_bf16 v[24:27], v[68:71], v[112:115], v[24:27]
    v_mfma_f32_16x16x32_bf16 v[20:23], v[72:75], v[112:115], v[20:23]
    v_mfma_f32_16x16x32_bf16 v[16:19], v[76:79], v[112:115], v[16:19]
    buffer_load_dwordx4 v[64:67], v125, s[12:15], s23 offen offset:0
    s_waitcnt lgkmcnt(5)
    v_mfma_f32_16x16x32_bf16 v[56:59], v[80:83], v[88:91], v[56:59]
    v_mfma_f32_16x16x32_bf16 v[52:55], v[84:87], v[88:91], v[52:55]
    s_waitcnt lgkmcnt(0)
    s_barrier
    v_mfma_f32_16x16x32_bf16 v[28:31], v[68:71], v[92:95], v[28:31]
    v_mfma_f32_16x16x32_bf16 v[24:27], v[72:75], v[92:95], v[24:27]
    v_mfma_f32_16x16x32_bf16 v[20:23], v[76:79], v[92:95], v[20:23]
    buffer_load_dwordx4 v[68:71], v125, s[12:15], s23 offen offset:2048
    v_mfma_f32_16x16x32_bf16 v[60:63], v[80:83], v[96:99], v[60:63]
    v_mfma_f32_16x16x32_bf16 v[56:59], v[84:87], v[96:99], v[56:59]
    buffer_load_dwordx4 v[80:83], v119, s[12:15], s23 offen offset:0
    v_mfma_f32_16x16x32_bf16 v[28:31], v[72:75], v[100:103], v[28:31]
    v_mfma_f32_16x16x32_bf16 v[24:27], v[76:79], v[100:103], v[24:27]
    buffer_load_dwordx4 v[72:75], v125, s[12:15], s26 offen offset:0
    v_mfma_f32_16x16x32_bf16 v[60:63], v[84:87], v[104:107], v[60:63]
    buffer_load_dwordx4 v[84:87], v119, s[12:15], s23 offen offset:2048
    v_mfma_f32_16x16x32_bf16 v[28:31], v[76:79], v[108:111], v[28:31]
    buffer_load_dwordx4 v[76:79], v125, s[12:15], s26 offen offset:2048
    s_add_u32 s23, s23, 57344
    s_add_u32 s26, s26, 57344
    s_branch L_conv1_kernel_mloop2
L_conv1_kernel_mlast2:
    v_and_b32 v125, 15, v127
    v_and_b32 v126, 7, v127
    v_lshlrev_b32 v126, 4, v126
    v_lshl_add_u32 v125, v125, 7, v126
    v_lshrrev_b32 v126, 4, v127
    v_lshl_add_u32 v125, v126, 11, v125
    s_mov_b32 s36, 65536
    s_cmp_eq_u32 s32, 1
    s_cselect_b32 s36, 121856, s36
    s_cmp_eq_u32 s32, 2
    s_cselect_b32 s36, 81920, s36
    s_cmp_eq_u32 s32, 3
    s_cselect_b32 s36, 130048, s36
    s_mov_b32 s37, 98304
    s_cmp_eq_u32 s32, 1
    s_cselect_b32 s37, 138240, s37
    s_cmp_eq_u32 s32, 2
    s_cselect_b32 s37, 146432, s37
    s_cmp_eq_u32 s32, 3
    s_cselect_b32 s37, 154624, s37
    v_add_u32 v126, s37, v125
    v_add_u32 v125, s36, v125
    ds_read_b128 v[88:91], v120 offset:8192
    ds_read_b128 v[92:95], v120 offset:9216
    ds_read_b128 v[96:99], v116 offset:8704
    ds_read_b128 v[100:103], v120 offset:10240
    ds_read_b128 v[104:107], v116 offset:9792
    ds_read_b128 v[108:111], v120 offset:11264
    ds_read_b128 v[112:115], v116 offset:10880
    s_waitcnt vmcnt(5) lgkmcnt(6)
    v_mfma_f32_16x16x32_bf16 v[0:3], v[64:67], v[88:91], v[0:3]
    ds_read_b128 v[88:91], v120 offset:12288
    s_waitcnt vmcnt(4) lgkmcnt(6)
    v_mfma_f32_16x16x32_bf16 v[4:7], v[64:67], v[92:95], v[4:7]
    v_mfma_f32_16x16x32_bf16 v[0:3], v[68:71], v[92:95], v[0:3]
    ds_read_b128 v[92:95], v116 offset:11968
    s_waitcnt vmcnt(3) lgkmcnt(6)
    v_mfma_f32_16x16x32_bf16 v[32:35], v[80:83], v[96:99], v[32:35]
    ds_read_b128 v[96:99], v120 offset:13312
    s_waitcnt vmcnt(2) lgkmcnt(6)
    v_mfma_f32_16x16x32_bf16 v[8:11], v[64:67], v[100:103], v[8:11]
    v_mfma_f32_16x16x32_bf16 v[4:7], v[68:71], v[100:103], v[4:7]
    v_mfma_f32_16x16x32_bf16 v[0:3], v[72:75], v[100:103], v[0:3]
    ds_read_b128 v[100:103], v116 offset:13056
    s_waitcnt vmcnt(1) lgkmcnt(6)
    v_mfma_f32_16x16x32_bf16 v[36:39], v[80:83], v[104:107], v[36:39]
    v_mfma_f32_16x16x32_bf16 v[32:35], v[84:87], v[104:107], v[32:35]
    ds_read_b128 v[104:107], v120 offset:14336
    s_waitcnt vmcnt(0) lgkmcnt(6)
    v_mfma_f32_16x16x32_bf16 v[12:15], v[64:67], v[108:111], v[12:15]
    v_mfma_f32_16x16x32_bf16 v[8:11], v[68:71], v[108:111], v[8:11]
    v_mfma_f32_16x16x32_bf16 v[4:7], v[72:75], v[108:111], v[4:7]
    v_mfma_f32_16x16x32_bf16 v[0:3], v[76:79], v[108:111], v[0:3]
    ds_read_b128 v[108:111], v116 offset:14144
    s_waitcnt lgkmcnt(6)
    v_mfma_f32_16x16x32_bf16 v[40:43], v[80:83], v[112:115], v[40:43]
    v_mfma_f32_16x16x32_bf16 v[36:39], v[84:87], v[112:115], v[36:39]
    ds_read_b128 v[112:115], v120 offset:15360
    s_waitcnt lgkmcnt(6)
    v_mfma_f32_16x16x32_bf16 v[16:19], v[64:67], v[88:91], v[16:19]
    v_mfma_f32_16x16x32_bf16 v[12:15], v[68:71], v[88:91], v[12:15]
    v_mfma_f32_16x16x32_bf16 v[8:11], v[72:75], v[88:91], v[8:11]
    v_mfma_f32_16x16x32_bf16 v[4:7], v[76:79], v[88:91], v[4:7]
    ds_read_b128 v[88:91], v117 offset:8704
    v_xor_b32 v124, 0, v126
    ds_write_b128 v124, v[32:35]
    s_waitcnt lgkmcnt(7)
    v_mfma_f32_16x16x32_bf16 v[44:47], v[80:83], v[92:95], v[44:47]
    v_mfma_f32_16x16x32_bf16 v[40:43], v[84:87], v[92:95], v[40:43]
    ds_read_b128 v[92:95], v122 offset:0
    v_xor_b32 v123, 0, v125
    ds_write_b128 v123, v[0:3]
    s_waitcnt lgkmcnt(8)
    v_mfma_f32_16x16x32_bf16 v[20:23], v[64:67], v[96:99], v[20:23]
    v_mfma_f32_16x16x32_bf16 v[16:19], v[68:71], v[96:99], v[16:19]
    v_mfma_f32_16x16x32_bf16 v[12:15], v[72:75], v[96:99], v[12:15]
    v_mfma_f32_16x16x32_bf16 v[8:11], v[76:79], v[96:99], v[8:11]
    ds_read_b128 v[96:99], v117 offset:9792
    v_xor_b32 v123, 16, v126
    ds_write_b128 v123, v[36:39]
    s_waitcnt lgkmcnt(9)
    v_mfma_f32_16x16x32_bf16 v[48:51], v[80:83], v[100:103], v[48:51]
    v_mfma_f32_16x16x32_bf16 v[44:47], v[84:87], v[100:103], v[44:47]
    ds_read_b128 v[100:103], v121 offset:9216
    v_xor_b32 v124, 16, v125
    ds_write_b128 v124, v[4:7]
    s_waitcnt lgkmcnt(10)
    v_mfma_f32_16x16x32_bf16 v[24:27], v[64:67], v[104:107], v[24:27]
    v_mfma_f32_16x16x32_bf16 v[20:23], v[68:71], v[104:107], v[20:23]
    v_mfma_f32_16x16x32_bf16 v[16:19], v[72:75], v[104:107], v[16:19]
    v_mfma_f32_16x16x32_bf16 v[12:15], v[76:79], v[104:107], v[12:15]
    ds_read_b128 v[104:107], v118 offset:8704
    v_xor_b32 v124, 32, v126
    ds_write_b128 v124, v[40:43]
    s_waitcnt lgkmcnt(11)
    v_mfma_f32_16x16x32_bf16 v[52:55], v[80:83], v[108:111], v[52:55]
    v_mfma_f32_16x16x32_bf16 v[48:51], v[84:87], v[108:111], v[48:51]
    ds_read_b128 v[108:111], v121 offset:10240
    v_xor_b32 v123, 32, v125
    ds_write_b128 v123, v[8:11]
    s_waitcnt lgkmcnt(12)
    v_mfma_f32_16x16x32_bf16 v[28:31], v[64:67], v[112:115], v[28:31]
    v_mfma_f32_16x16x32_bf16 v[24:27], v[68:71], v[112:115], v[24:27]
    v_mfma_f32_16x16x32_bf16 v[20:23], v[72:75], v[112:115], v[20:23]
    v_mfma_f32_16x16x32_bf16 v[16:19], v[76:79], v[112:115], v[16:19]
    v_xor_b32 v123, 48, v126
    ds_write_b128 v123, v[44:47]
    s_waitcnt lgkmcnt(12)
    v_mfma_f32_16x16x32_bf16 v[56:59], v[80:83], v[88:91], v[56:59]
    v_mfma_f32_16x16x32_bf16 v[52:55], v[84:87], v[88:91], v[52:55]
    v_xor_b32 v124, 48, v125
    ds_write_b128 v124, v[12:15]
    s_waitcnt lgkmcnt(11)
    v_mfma_f32_16x16x32_bf16 v[28:31], v[68:71], v[92:95], v[28:31]
    v_mfma_f32_16x16x32_bf16 v[24:27], v[72:75], v[92:95], v[24:27]
    v_mfma_f32_16x16x32_bf16 v[20:23], v[76:79], v[92:95], v[20:23]
    v_xor_b32 v124, 64, v126
    ds_write_b128 v124, v[48:51]
    s_waitcnt lgkmcnt(10)
    v_mfma_f32_16x16x32_bf16 v[60:63], v[80:83], v[96:99], v[60:63]
    v_mfma_f32_16x16x32_bf16 v[56:59], v[84:87], v[96:99], v[56:59]
    v_xor_b32 v123, 64, v125
    ds_write_b128 v123, v[16:19]
    s_waitcnt lgkmcnt(9)
    v_mfma_f32_16x16x32_bf16 v[28:31], v[72:75], v[100:103], v[28:31]
    v_mfma_f32_16x16x32_bf16 v[24:27], v[76:79], v[100:103], v[24:27]
    v_xor_b32 v123, 80, v126
    ds_write_b128 v123, v[52:55]
    s_waitcnt lgkmcnt(8)
    v_mfma_f32_16x16x32_bf16 v[60:63], v[84:87], v[104:107], v[60:63]
    v_xor_b32 v124, 80, v125
    ds_write_b128 v124, v[20:23]
    s_waitcnt lgkmcnt(7)
    v_mfma_f32_16x16x32_bf16 v[28:31], v[76:79], v[108:111], v[28:31]
    v_xor_b32 v124, 96, v126
    ds_write_b128 v124, v[56:59]
    v_and_b32 v108, 15, v127
    v_lshrrev_b32 v109, 4, v127
    v_lshrrev_b32 v110, 3, v108
    s_lshl_b32 s36, s20, 1
    v_add_u32 v110, s36, v110
    v_xor_b32 v111, v110, v108
    v_and_b32 v111, 7, v111
    v_lshlrev_b32 v111, 4, v111
    v_xor_b32 v123, 96, v125
    ds_write_b128 v123, v[24:27]
    v_lshl_add_u32 v111, v110, 7, v111
    v_lshl_add_u32 v120, v109, 11, v111
    v_add_u32 v121, 65536, v120
    v_add_u32 v64, 131072, v120
    s_lshl_b32 s36, s20, 9
    s_add_u32 s36, s36, 115712
    v_lshl_add_u32 v127, v109, 7, s36
    s_lshl_b32 s36, s20, 4
    v_add_u32 v108, s36, v108
    v_lshlrev_b32 v110, 6, v108
    v_lshl_add_u32 v110, v109, 4, v110
    s_mul_i32 s36, s29, 524288
    v_xor_b32 v123, 112, v126
    ds_write_b128 v123, v[60:63]
    s_lshl_b32 s37, s21, 4
    s_add_u32 s36, s36, s37
    v_add_u32 v110, s36, v110
    v_mov_b32 v111, 2130706432
    v_cmp_gt_u32 vcc, 125, v108
    s_mov_b32 s4, 0xbeaaaaab
    s_mov_b32 s5, s4
    s_mov_b32 s6, 0x3e800000
    s_mov_b32 s7, s6
    s_mov_b32 s8, 0xc0a00000
    s_mov_b32 s9, s8
    s_mov_b32 s10, 0xc0638e39
    v_xor_b32 v124, 112, v125
    ds_write_b128 v124, v[28:31]
    s_mov_b32 s11, s10
    s_mov_b32 s12, 0xbf638e39
    s_mov_b32 s13, s12
    s_mov_b32 s14, 0xbe638e39
    s_mov_b32 s15, s14
    s_mov_b32 s22, 0xbd638e39
    s_mov_b32 s23, s22
    s_mov_b32 s24, 0x3ff1c71c
    s_mov_b32 s25, s24
    s_mov_b32 s26, 0xbf2aaaab
    s_mov_b32 s27, s26
    s_mov_b32 s32, 0x3ecccccd
    s_mov_b32 s33, s32
    s_mov_b32 s34, 0xbd888889
    s_mov_b32 s35, s34
    s_mov_b32 s38, 0xbe4ccccd
    s_mov_b32 s39, s38
    s_mov_b32 s40, 0xbdd2d3e8
    s_mov_b32 s41, s40
    s_mov_b32 s42, 0x3f800000
    s_mov_b32 s43, s42
    s_setprio 0
    s_branch L_conv1_kernel_epi
L_conv1_kernel_helper:
    s_setprio 3
    v_add_u32 v92, 0, v7
    v_add_u32 v93, 1024, v7
    v_add_u32 v94, 2048, v7
    v_add_u32 v95, 3072, v7
    v_and_b32 v76, 4, v5
    v_lshrrev_b32 v76, 1, v76
    v_xor_b32 v76, v6, v76
    v_lshlrev_b32 v76, 4, v76
    v_lshl_add_u32 v76, v5, 6, v76
    s_mov_b32 s24, 0
    s_mov_b32 s27, 524288
    s_waitcnt lgkmcnt(0)
    s_add_u32 s8, s4, s47
    s_addc_u32 s9, s5, 0
    buffer_load_dwordx4 v[0:3], v92, s[8:11], s24 offen offset:0
    buffer_load_dwordx4 v[16:19], v92, s[8:11], s24 offen offset:64
    v_add_u32 v92, 128, v92
    buffer_load_dwordx4 v[4:7], v93, s[8:11], s24 offen offset:0
    buffer_load_dwordx4 v[20:23], v93, s[8:11], s24 offen offset:64
    v_add_u32 v93, 128, v93
    buffer_load_dwordx4 v[8:11], v94, s[8:11], s24 offen offset:0
    buffer_load_dwordx4 v[24:27], v94, s[8:11], s24 offen offset:64
    v_add_u32 v94, 128, v94
    buffer_load_dwordx4 v[12:15], v95, s[8:11], s24 offen offset:0
    buffer_load_dwordx4 v[28:31], v95, s[8:11], s24 offen offset:64
    v_add_u32 v95, 128, v95
    s_mul_i32 s36, s42, 1024
    v_add_u32 v96, s36, v76
    v_add_u32 v97, 65536, v96
    s_mul_i32 s36, s42, 1088
    s_add_u32 s36, s36, 98304
    v_add_u32 v98, s36, v76
    s_waitcnt vmcnt(0)
    s_mov_b32 s28, 0
    s_mov_b32 s22, 4
    s_cmp_ge_u32 s20, 12
    s_cbranch_scc1 L_conv1_kernel_h2
    ds_write_b128 v96, v[0:3] offset:0
    ds_write_b128 v98, v[12:15] offset:0
    v_lshlrev_b32 v76, 16, v0
    v_and_b32 v84, s25, v0
    v_lshlrev_b32 v77, 16, v4
    v_and_b32 v85, s25, v4
    v_lshlrev_b32 v78, 16, v8
    v_and_b32 v86, s25, v8
    v_lshlrev_b32 v79, 16, v12
    v_and_b32 v87, s25, v12
    v_add_f32 v80, v76, v78
    v_add_f32 v88, v84, v86
    v_add_f32 v81, v77, v79
    v_add_f32 v89, v85, v87
    v_fma_f32 v82, v78, 4.0, v76
    v_fma_f32 v90, v86, 4.0, v84
    v_fma_f32 v83, v79, 4.0, v77
    v_fma_f32 v91, v87, 4.0, v85
    v_add_f32 v77, v80, v81
    v_add_f32 v85, v88, v89
    v_sub_f32 v78, v80, v81
    v_sub_f32 v86, v88, v89
    v_fma_f32 v79, v83, 2.0, v82
    v_fma_f32 v87, v91, 2.0, v90
    v_fma_f32 v82, v83, -2.0, v82
    v_fma_f32 v90, v91, -2.0, v90
    v_fmamk_f32 v80, v76, 0x41700000, v82
    v_fmamk_f32 v88, v84, 0x41700000, v90
    v_fmamk_f32 v80, v81, 0x41200000, v80
    v_fmamk_f32 v88, v89, 0x41200000, v88
    v_cvt_pk_bf16_f32 v4, v77, v85
    v_cvt_pk_bf16_f32 v8, v78, v86
    v_cvt_pk_bf16_f32 v64, v79, v87
    v_cvt_pk_bf16_f32 v68, v82, v90
    v_cvt_pk_bf16_f32 v72, v80, v88
    v_lshlrev_b32 v76, 16, v1
    v_and_b32 v84, s25, v1
    v_lshlrev_b32 v77, 16, v5
    v_and_b32 v85, s25, v5
    v_lshlrev_b32 v78, 16, v9
    v_and_b32 v86, s25, v9
    v_lshlrev_b32 v79, 16, v13
    v_and_b32 v87, s25, v13
    v_add_f32 v80, v76, v78
    v_add_f32 v88, v84, v86
    v_add_f32 v81, v77, v79
    v_add_f32 v89, v85, v87
    v_fma_f32 v82, v78, 4.0, v76
    v_fma_f32 v90, v86, 4.0, v84
    v_fma_f32 v83, v79, 4.0, v77
    v_fma_f32 v91, v87, 4.0, v85
    v_add_f32 v77, v80, v81
    v_add_f32 v85, v88, v89
    v_sub_f32 v78, v80, v81
    v_sub_f32 v86, v88, v89
    v_fma_f32 v79, v83, 2.0, v82
    v_fma_f32 v87, v91, 2.0, v90
    v_fma_f32 v82, v83, -2.0, v82
    v_fma_f32 v90, v91, -2.0, v90
    v_fmamk_f32 v80, v76, 0x41700000, v82
    v_fmamk_f32 v88, v84, 0x41700000, v90
    v_fmamk_f32 v80, v81, 0x41200000, v80
    v_fmamk_f32 v88, v89, 0x41200000, v88
    v_cvt_pk_bf16_f32 v5, v77, v85
    v_cvt_pk_bf16_f32 v9, v78, v86
    v_cvt_pk_bf16_f32 v65, v79, v87
    v_cvt_pk_bf16_f32 v69, v82, v90
    v_cvt_pk_bf16_f32 v73, v80, v88
    v_lshlrev_b32 v76, 16, v2
    v_and_b32 v84, s25, v2
    v_lshlrev_b32 v77, 16, v6
    v_and_b32 v85, s25, v6
    v_lshlrev_b32 v78, 16, v10
    v_and_b32 v86, s25, v10
    v_lshlrev_b32 v79, 16, v14
    v_and_b32 v87, s25, v14
    v_add_f32 v80, v76, v78
    v_add_f32 v88, v84, v86
    v_add_f32 v81, v77, v79
    v_add_f32 v89, v85, v87
    v_fma_f32 v82, v78, 4.0, v76
    v_fma_f32 v90, v86, 4.0, v84
    v_fma_f32 v83, v79, 4.0, v77
    v_fma_f32 v91, v87, 4.0, v85
    v_add_f32 v77, v80, v81
    v_add_f32 v85, v88, v89
    v_sub_f32 v78, v80, v81
    v_sub_f32 v86, v88, v89
    v_fma_f32 v79, v83, 2.0, v82
    v_fma_f32 v87, v91, 2.0, v90
    v_fma_f32 v82, v83, -2.0, v82
    v_fma_f32 v90, v91, -2.0, v90
    v_fmamk_f32 v80, v76, 0x41700000, v82
    v_fmamk_f32 v88, v84, 0x41700000, v90
    v_fmamk_f32 v80, v81, 0x41200000, v80
    v_fmamk_f32 v88, v89, 0x41200000, v88
    v_cvt_pk_bf16_f32 v6, v77, v85
    v_cvt_pk_bf16_f32 v10, v78, v86
    v_cvt_pk_bf16_f32 v66, v79, v87
    v_cvt_pk_bf16_f32 v70, v82, v90
    v_cvt_pk_bf16_f32 v74, v80, v88
    v_lshlrev_b32 v76, 16, v3
    v_and_b32 v84, s25, v3
    v_lshlrev_b32 v77, 16, v7
    v_and_b32 v85, s25, v7
    v_lshlrev_b32 v78, 16, v11
    v_and_b32 v86, s25, v11
    v_lshlrev_b32 v79, 16, v15
    v_and_b32 v87, s25, v15
    v_add_f32 v80, v76, v78
    v_add_f32 v88, v84, v86
    v_add_f32 v81, v77, v79
    v_add_f32 v89, v85, v87
    v_fma_f32 v82, v78, 4.0, v76
    v_fma_f32 v90, v86, 4.0, v84
    v_fma_f32 v83, v79, 4.0, v77
    v_fma_f32 v91, v87, 4.0, v85
    v_add_f32 v77, v80, v81
    v_add_f32 v85, v88, v89
    v_sub_f32 v78, v80, v81
    v_sub_f32 v86, v88, v89
    v_fma_f32 v79, v83, 2.0, v82
    v_fma_f32 v87, v91, 2.0, v90
    v_fma_f32 v82, v83, -2.0, v82
    v_fma_f32 v90, v91, -2.0, v90
    v_fmamk_f32 v80, v76, 0x41700000, v82
    v_fmamk_f32 v88, v84, 0x41700000, v90
    v_fmamk_f32 v80, v81, 0x41200000, v80
    v_fmamk_f32 v88, v89, 0x41200000, v88
    v_cvt_pk_bf16_f32 v7, v77, v85
    v_cvt_pk_bf16_f32 v11, v78, v86
    v_cvt_pk_bf16_f32 v67, v79, v87
    v_cvt_pk_bf16_f32 v71, v82, v90
    v_cvt_pk_bf16_f32 v75, v80, v88
    ds_write_b128 v96, v[64:67] offset:49152
    ds_write_b128 v97, v[68:71] offset:0
    ds_write_b128 v97, v[72:75] offset:16384
    ds_write_b128 v96, v[4:7] offset:16384
    ds_write_b128 v96, v[8:11] offset:32768
    s_waitcnt vmcnt(0)
    s_waitcnt lgkmcnt(0)
    s_barrier
    buffer_load_dwordx4 v[32:35], v92, s[8:11], s24 offen offset:0
    buffer_load_dwordx4 v[48:51], v92, s[8:11], s24 offen offset:64
    v_add_u32 v92, 128, v92
    buffer_load_dwordx4 v[36:39], v93, s[8:11], s24 offen offset:0
    buffer_load_dwordx4 v[52:55], v93, s[8:11], s24 offen offset:64
    v_add_u32 v93, 128, v93
    s_setprio 1
L_conv1_kernel_hloop1:
    s_cmp_lt_u32 s28, 13
    s_cselect_b32 s24, 0, 2130706432
    v_lshlrev_b32 v76, 16, v16
    v_and_b32 v84, s25, v16
    v_lshlrev_b32 v77, 16, v20
    v_and_b32 v85, s25, v20
    v_lshlrev_b32 v78, 16, v24
    v_and_b32 v86, s25, v24
    v_lshlrev_b32 v79, 16, v28
    v_and_b32 v87, s25, v28
    v_add_f32 v80, v76, v78
    v_add_f32 v88, v84, v86
    v_add_f32 v81, v77, v79
    v_add_f32 v89, v85, v87
    v_fma_f32 v82, v78, 4.0, v76
    buffer_load_dwordx4 v[40:43], v94, s[8:11], s24 offen offset:0
    buffer_load_dwordx4 v[56:59], v94, s[8:11], s24 offen offset:64
    v_add_u32 v94, 128, v94
    v_fma_f32 v90, v86, 4.0, v84
    v_fma_f32 v83, v79, 4.0, v77
    v_fma_f32 v91, v87, 4.0, v85
    v_add_f32 v77, v80, v81
    v_add_f32 v85, v88, v89
    v_sub_f32 v78, v80, v81
    v_sub_f32 v86, v88, v89
    v_fma_f32 v79, v83, 2.0, v82
    v_fma_f32 v87, v91, 2.0, v90
    v_fma_f32 v82, v83, -2.0, v82
    v_fma_f32 v90, v91, -2.0, v90
    v_fmamk_f32 v80, v76, 0x41700000, v82
    v_fmamk_f32 v88, v84, 0x41700000, v90
    v_fmamk_f32 v80, v81, 0x41200000, v80
    v_fmamk_f32 v88, v89, 0x41200000, v88
    v_cvt_pk_bf16_f32 v20, v77, v85
    v_cvt_pk_bf16_f32 v24, v78, v86
    v_cvt_pk_bf16_f32 v64, v79, v87
    v_cvt_pk_bf16_f32 v68, v82, v90
    v_cvt_pk_bf16_f32 v72, v80, v88
    v_lshlrev_b32 v76, 16, v17
    v_and_b32 v84, s25, v17
    v_lshlrev_b32 v77, 16, v21
    v_and_b32 v85, s25, v21
    v_lshlrev_b32 v78, 16, v25
    v_and_b32 v86, s25, v25
    v_lshlrev_b32 v79, 16, v29
    v_and_b32 v87, s25, v29
    v_add_f32 v80, v76, v78
    v_add_f32 v88, v84, v86
    v_add_f32 v81, v77, v79
    v_add_f32 v89, v85, v87
    v_fma_f32 v82, v78, 4.0, v76
    v_fma_f32 v90, v86, 4.0, v84
    v_fma_f32 v83, v79, 4.0, v77
    v_fma_f32 v91, v87, 4.0, v85
    v_add_f32 v77, v80, v81
    v_add_f32 v85, v88, v89
    v_sub_f32 v78, v80, v81
    v_sub_f32 v86, v88, v89
    v_fma_f32 v79, v83, 2.0, v82
    v_fma_f32 v87, v91, 2.0, v90
    v_fma_f32 v82, v83, -2.0, v82
    v_fma_f32 v90, v91, -2.0, v90
    v_fmamk_f32 v80, v76, 0x41700000, v82
    v_fmamk_f32 v88, v84, 0x41700000, v90
    v_fmamk_f32 v80, v81, 0x41200000, v80
    v_fmamk_f32 v88, v89, 0x41200000, v88
    v_cvt_pk_bf16_f32 v21, v77, v85
    v_cvt_pk_bf16_f32 v25, v78, v86
    v_cvt_pk_bf16_f32 v65, v79, v87
    v_cvt_pk_bf16_f32 v69, v82, v90
    v_cvt_pk_bf16_f32 v73, v80, v88
    buffer_load_dwordx4 v[44:47], v95, s[8:11], s24 offen offset:0
    buffer_load_dwordx4 v[60:63], v95, s[8:11], s24 offen offset:64
    v_add_u32 v95, 128, v95
    v_lshlrev_b32 v76, 16, v18
    v_and_b32 v84, s25, v18
    v_lshlrev_b32 v77, 16, v22
    v_and_b32 v85, s25, v22
    v_lshlrev_b32 v78, 16, v26
    v_and_b32 v86, s25, v26
    v_lshlrev_b32 v79, 16, v30
    v_and_b32 v87, s25, v30
    v_add_f32 v80, v76, v78
    v_add_f32 v88, v84, v86
    v_add_f32 v81, v77, v79
    v_add_f32 v89, v85, v87
    v_fma_f32 v82, v78, 4.0, v76
    v_fma_f32 v90, v86, 4.0, v84
    v_fma_f32 v83, v79, 4.0, v77
    v_fma_f32 v91, v87, 4.0, v85
    v_add_f32 v77, v80, v81
    v_add_f32 v85, v88, v89
    v_sub_f32 v78, v80, v81
    v_sub_f32 v86, v88, v89
    v_fma_f32 v79, v83, 2.0, v82
    v_fma_f32 v87, v91, 2.0, v90
    v_fma_f32 v82, v83, -2.0, v82
    v_fma_f32 v90, v91, -2.0, v90
    v_fmamk_f32 v80, v76, 0x41700000, v82
    v_fmamk_f32 v88, v84, 0x41700000, v90
    v_fmamk_f32 v80, v81, 0x41200000, v80
    v_fmamk_f32 v88, v89, 0x41200000, v88
    v_cvt_pk_bf16_f32 v22, v77, v85
    v_cvt_pk_bf16_f32 v26, v78, v86
    v_cvt_pk_bf16_f32 v66, v79, v87
    v_cvt_pk_bf16_f32 v70, v82, v90
    v_cvt_pk_bf16_f32 v74, v80, v88
    v_lshlrev_b32 v76, 16, v19
    v_and_b32 v84, s25, v19
    v_lshlrev_b32 v77, 16, v23
    v_and_b32 v85, s25, v23
    v_lshlrev_b32 v78, 16, v27
    v_and_b32 v86, s25, v27
    v_lshlrev_b32 v79, 16, v31
    v_and_b32 v87, s25, v31
    v_add_f32 v80, v76, v78
    v_add_f32 v88, v84, v86
    v_add_f32 v81, v77, v79
    v_add_f32 v89, v85, v87
    v_fma_f32 v82, v78, 4.0, v76
    v_fma_f32 v90, v86, 4.0, v84
    v_fma_f32 v83, v79, 4.0, v77
    v_fma_f32 v91, v87, 4.0, v85
    v_add_f32 v77, v80, v81
    v_add_f32 v85, v88, v89
    v_sub_f32 v78, v80, v81
    v_sub_f32 v86, v88, v89
    v_fma_f32 v79, v83, 2.0, v82
    v_fma_f32 v87, v91, 2.0, v90
    v_fma_f32 v82, v83, -2.0, v82
    v_fma_f32 v90, v91, -2.0, v90
    v_fmamk_f32 v80, v76, 0x41700000, v82
    v_fmamk_f32 v88, v84, 0x41700000, v90
    v_fmamk_f32 v80, v81, 0x41200000, v80
    v_fmamk_f32 v88, v89, 0x41200000, v88
    v_cvt_pk_bf16_f32 v23, v77, v85
    v_cvt_pk_bf16_f32 v27, v78, v86
    v_cvt_pk_bf16_f32 v67, v79, v87
    v_cvt_pk_bf16_f32 v71, v82, v90
    v_cvt_pk_bf16_f32 v75, v80, v88
    ds_write_b128 v96, v[64:67] offset:57344
    ds_write_b128 v97, v[68:71] offset:8192
    ds_write_b128 v97, v[72:75] offset:24576
    ds_write_b128 v96, v[16:19] offset:8192
    ds_write_b128 v96, v[20:23] offset:24576
    ds_write_b128 v96, v[24:27] offset:40960
    ds_write_b128 v98, v[28:31] offset:8704
    s_add_u32 s28, s28, 1
    s_waitcnt lgkmcnt(0)
    s_barrier
    s_cmp_lt_u32 s28, 13
    s_cselect_b32 s24, 0, 2130706432
    s_waitcnt vmcnt(0)
    v_lshlrev_b32 v76, 16, v32
    v_and_b32 v84, s25, v32
    v_lshlrev_b32 v77, 16, v36
    v_and_b32 v85, s25, v36
    v_lshlrev_b32 v78, 16, v40
    v_and_b32 v86, s25, v40
    v_lshlrev_b32 v79, 16, v44
    v_and_b32 v87, s25, v44
    v_add_f32 v80, v76, v78
    v_add_f32 v88, v84, v86
    v_add_f32 v81, v77, v79
    v_add_f32 v89, v85, v87
    v_fma_f32 v82, v78, 4.0, v76
    v_fma_f32 v90, v86, 4.0, v84
    v_fma_f32 v83, v79, 4.0, v77
    v_fma_f32 v91, v87, 4.0, v85
    v_add_f32 v77, v80, v81
    v_add_f32 v85, v88, v89
    v_sub_f32 v78, v80, v81
    v_sub_f32 v86, v88, v89
    v_fma_f32 v79, v83, 2.0, v82
    v_fma_f32 v87, v91, 2.0, v90
    v_fma_f32 v82, v83, -2.0, v82
    v_fma_f32 v90, v91, -2.0, v90
    v_fmamk_f32 v80, v76, 0x41700000, v82
    v_fmamk_f32 v88, v84, 0x41700000, v90
    v_fmamk_f32 v80, v81, 0x41200000, v80
    v_fmamk_f32 v88, v89, 0x41200000, v88
    v_cvt_pk_bf16_f32 v36, v77, v85
    v_cvt_pk_bf16_f32 v40, v78, v86
    v_cvt_pk_bf16_f32 v64, v79, v87
    v_cvt_pk_bf16_f32 v68, v82, v90
    v_cvt_pk_bf16_f32 v72, v80, v88
    v_lshlrev_b32 v76, 16, v33
    v_and_b32 v84, s25, v33
    v_lshlrev_b32 v77, 16, v37
    v_and_b32 v85, s25, v37
    v_lshlrev_b32 v78, 16, v41
    v_and_b32 v86, s25, v41
    buffer_load_dwordx4 v[0:3], v92, s[8:11], s24 offen offset:0
    buffer_load_dwordx4 v[16:19], v92, s[8:11], s24 offen offset:64
    v_add_u32 v92, 128, v92
    v_lshlrev_b32 v79, 16, v45
    v_and_b32 v87, s25, v45
    v_add_f32 v80, v76, v78
    v_add_f32 v88, v84, v86
    v_add_f32 v81, v77, v79
    v_add_f32 v89, v85, v87
    v_fma_f32 v82, v78, 4.0, v76
    v_fma_f32 v90, v86, 4.0, v84
    v_fma_f32 v83, v79, 4.0, v77
    v_fma_f32 v91, v87, 4.0, v85
    v_add_f32 v77, v80, v81
    v_add_f32 v85, v88, v89
    v_sub_f32 v78, v80, v81
    v_sub_f32 v86, v88, v89
    v_fma_f32 v79, v83, 2.0, v82
    v_fma_f32 v87, v91, 2.0, v90
    v_fma_f32 v82, v83, -2.0, v82
    v_fma_f32 v90, v91, -2.0, v90
    v_fmamk_f32 v80, v76, 0x41700000, v82
    v_fmamk_f32 v88, v84, 0x41700000, v90
    v_fmamk_f32 v80, v81, 0x41200000, v80
    v_fmamk_f32 v88, v89, 0x41200000, v88
    v_cvt_pk_bf16_f32 v37, v77, v85
    v_cvt_pk_bf16_f32 v41, v78, v86
    v_cvt_pk_bf16_f32 v65, v79, v87
    v_cvt_pk_bf16_f32 v69, v82, v90
    v_cvt_pk_bf16_f32 v73, v80, v88
    v_lshlrev_b32 v76, 16, v34
    v_and_b32 v84, s25, v34
    v_lshlrev_b32 v77, 16, v38
    v_and_b32 v85, s25, v38
    v_lshlrev_b32 v78, 16, v42
    v_and_b32 v86, s25, v42
    v_lshlrev_b32 v79, 16, v46
    v_and_b32 v87, s25, v46
    v_add_f32 v80, v76, v78
    v_add_f32 v88, v84, v86
    v_add_f32 v81, v77, v79
    v_add_f32 v89, v85, v87
    v_fma_f32 v82, v78, 4.0, v76
    v_fma_f32 v90, v86, 4.0, v84
    v_fma_f32 v83, v79, 4.0, v77
    v_fma_f32 v91, v87, 4.0, v85
    v_add_f32 v77, v80, v81
    v_add_f32 v85, v88, v89
    v_sub_f32 v78, v80, v81
    v_sub_f32 v86, v88, v89
    v_fma_f32 v79, v83, 2.0, v82
    v_fma_f32 v87, v91, 2.0, v90
    v_fma_f32 v82, v83, -2.0, v82
    v_fma_f32 v90, v91, -2.0, v90
    v_fmamk_f32 v80, v76, 0x41700000, v82
    v_fmamk_f32 v88, v84, 0x41700000, v90
    buffer_load_dwordx4 v[4:7], v93, s[8:11], s24 offen offset:0
    buffer_load_dwordx4 v[20:23], v93, s[8:11], s24 offen offset:64
    v_add_u32 v93, 128, v93
    v_fmamk_f32 v80, v81, 0x41200000, v80
    v_fmamk_f32 v88, v89, 0x41200000, v88
    v_cvt_pk_bf16_f32 v38, v77, v85
    v_cvt_pk_bf16_f32 v42, v78, v86
    v_cvt_pk_bf16_f32 v66, v79, v87
    v_cvt_pk_bf16_f32 v70, v82, v90
    v_cvt_pk_bf16_f32 v74, v80, v88
    v_lshlrev_b32 v76, 16, v35
    v_and_b32 v84, s25, v35
    v_lshlrev_b32 v77, 16, v39
    v_and_b32 v85, s25, v39
    v_lshlrev_b32 v78, 16, v43
    v_and_b32 v86, s25, v43
    v_lshlrev_b32 v79, 16, v47
    v_and_b32 v87, s25, v47
    v_add_f32 v80, v76, v78
    v_add_f32 v88, v84, v86
    v_add_f32 v81, v77, v79
    v_add_f32 v89, v85, v87
    v_fma_f32 v82, v78, 4.0, v76
    v_fma_f32 v90, v86, 4.0, v84
    v_fma_f32 v83, v79, 4.0, v77
    v_fma_f32 v91, v87, 4.0, v85
    v_add_f32 v77, v80, v81
    v_add_f32 v85, v88, v89
    v_sub_f32 v78, v80, v81
    v_sub_f32 v86, v88, v89
    v_fma_f32 v79, v83, 2.0, v82
    v_fma_f32 v87, v91, 2.0, v90
    v_fma_f32 v82, v83, -2.0, v82
    v_fma_f32 v90, v91, -2.0, v90
    v_fmamk_f32 v80, v76, 0x41700000, v82
    v_fmamk_f32 v88, v84, 0x41700000, v90
    v_fmamk_f32 v80, v81, 0x41200000, v80
    v_fmamk_f32 v88, v89, 0x41200000, v88
    v_cvt_pk_bf16_f32 v39, v77, v85
    v_cvt_pk_bf16_f32 v43, v78, v86
    v_cvt_pk_bf16_f32 v67, v79, v87
    v_cvt_pk_bf16_f32 v71, v82, v90
    v_cvt_pk_bf16_f32 v75, v80, v88
    ds_write_b128 v96, v[64:67] offset:49152
    ds_write_b128 v97, v[68:71] offset:0
    ds_write_b128 v97, v[72:75] offset:16384
    ds_write_b128 v96, v[32:35] offset:0
    ds_write_b128 v96, v[36:39] offset:16384
    ds_write_b128 v96, v[40:43] offset:32768
    ds_write_b128 v98, v[44:47] offset:0
    s_add_u32 s28, s28, 1
    s_waitcnt lgkmcnt(0)
    s_barrier
    s_cmp_lt_u32 s28, 13
    s_cselect_b32 s24, 0, 2130706432
    v_lshlrev_b32 v76, 16, v48
    v_and_b32 v84, s25, v48
    v_lshlrev_b32 v77, 16, v52
    v_and_b32 v85, s25, v52
    v_lshlrev_b32 v78, 16, v56
    v_and_b32 v86, s25, v56
    v_lshlrev_b32 v79, 16, v60
    v_and_b32 v87, s25, v60
    v_add_f32 v80, v76, v78
    v_add_f32 v88, v84, v86
    v_add_f32 v81, v77, v79
    v_add_f32 v89, v85, v87
    v_fma_f32 v82, v78, 4.0, v76
    buffer_load_dwordx4 v[8:11], v94, s[8:11], s24 offen offset:0
    buffer_load_dwordx4 v[24:27], v94, s[8:11], s24 offen offset:64
    v_add_u32 v94, 128, v94
    v_fma_f32 v90, v86, 4.0, v84
    v_fma_f32 v83, v79, 4.0, v77
    v_fma_f32 v91, v87, 4.0, v85
    v_add_f32 v77, v80, v81
    v_add_f32 v85, v88, v89
    v_sub_f32 v78, v80, v81
    v_sub_f32 v86, v88, v89
    v_fma_f32 v79, v83, 2.0, v82
    v_fma_f32 v87, v91, 2.0, v90
    v_fma_f32 v82, v83, -2.0, v82
    v_fma_f32 v90, v91, -2.0, v90
    v_fmamk_f32 v80, v76, 0x41700000, v82
    v_fmamk_f32 v88, v84, 0x41700000, v90
    v_fmamk_f32 v80, v81, 0x41200000, v80
    v_fmamk_f32 v88, v89, 0x41200000, v88
    v_cvt_pk_bf16_f32 v52, v77, v85
    v_cvt_pk_bf16_f32 v56, v78, v86
    v_cvt_pk_bf16_f32 v64, v79, v87
    v_cvt_pk_bf16_f32 v68, v82, v90
    v_cvt_pk_bf16_f32 v72, v80, v88
    v_lshlrev_b32 v76, 16, v49
    v_and_b32 v84, s25, v49
    v_lshlrev_b32 v77, 16, v53
    v_and_b32 v85, s25, v53
    v_lshlrev_b32 v78, 16, v57
    v_and_b32 v86, s25, v57
    v_lshlrev_b32 v79, 16, v61
    v_and_b32 v87, s25, v61
    v_add_f32 v80, v76, v78
    v_add_f32 v88, v84, v86
    v_add_f32 v81, v77, v79
    v_add_f32 v89, v85, v87
    v_fma_f32 v82, v78, 4.0, v76
    v_fma_f32 v90, v86, 4.0, v84
    v_fma_f32 v83, v79, 4.0, v77
    v_fma_f32 v91, v87, 4.0, v85
    v_add_f32 v77, v80, v81
    v_add_f32 v85, v88, v89
    v_sub_f32 v78, v80, v81
    v_sub_f32 v86, v88, v89
    v_fma_f32 v79, v83, 2.0, v82
    v_fma_f32 v87, v91, 2.0, v90
    v_fma_f32 v82, v83, -2.0, v82
    v_fma_f32 v90, v91, -2.0, v90
    v_fmamk_f32 v80, v76, 0x41700000, v82
    v_fmamk_f32 v88, v84, 0x41700000, v90
    v_fmamk_f32 v80, v81, 0x41200000, v80
    v_fmamk_f32 v88, v89, 0x41200000, v88
    v_cvt_pk_bf16_f32 v53, v77, v85
    v_cvt_pk_bf16_f32 v57, v78, v86
    v_cvt_pk_bf16_f32 v65, v79, v87
    v_cvt_pk_bf16_f32 v69, v82, v90
    v_cvt_pk_bf16_f32 v73, v80, v88
    buffer_load_dwordx4 v[12:15], v95, s[8:11], s24 offen offset:0
    buffer_load_dwordx4 v[28:31], v95, s[8:11], s24 offen offset:64
    v_add_u32 v95, 128, v95
    v_lshlrev_b32 v76, 16, v50
    v_and_b32 v84, s25, v50
    v_lshlrev_b32 v77, 16, v54
    v_and_b32 v85, s25, v54
    v_lshlrev_b32 v78, 16, v58
    v_and_b32 v86, s25, v58
    v_lshlrev_b32 v79, 16, v62
    v_and_b32 v87, s25, v62
    v_add_f32 v80, v76, v78
    v_add_f32 v88, v84, v86
    v_add_f32 v81, v77, v79
    v_add_f32 v89, v85, v87
    v_fma_f32 v82, v78, 4.0, v76
    v_fma_f32 v90, v86, 4.0, v84
    v_fma_f32 v83, v79, 4.0, v77
    v_fma_f32 v91, v87, 4.0, v85
    v_add_f32 v77, v80, v81
    v_add_f32 v85, v88, v89
    v_sub_f32 v78, v80, v81
    v_sub_f32 v86, v88, v89
    v_fma_f32 v79, v83, 2.0, v82
    v_fma_f32 v87, v91, 2.0, v90
    v_fma_f32 v82, v83, -2.0, v82
    v_fma_f32 v90, v91, -2.0, v90
    v_fmamk_f32 v80, v76, 0x41700000, v82
    v_fmamk_f32 v88, v84, 0x41700000, v90
    v_fmamk_f32 v80, v81, 0x41200000, v80
    v_fmamk_f32 v88, v89, 0x41200000, v88
    v_cvt_pk_bf16_f32 v54, v77, v85
    v_cvt_pk_bf16_f32 v58, v78, v86
    v_cvt_pk_bf16_f32 v66, v79, v87
    v_cvt_pk_bf16_f32 v70, v82, v90
    v_cvt_pk_bf16_f32 v74, v80, v88
    v_lshlrev_b32 v76, 16, v51
    v_and_b32 v84, s25, v51
    v_lshlrev_b32 v77, 16, v55
    v_and_b32 v85, s25, v55
    v_lshlrev_b32 v78, 16, v59
    v_and_b32 v86, s25, v59
    v_lshlrev_b32 v79, 16, v63
    v_and_b32 v87, s25, v63
    v_add_f32 v80, v76, v78
    v_add_f32 v88, v84, v86
    v_add_f32 v81, v77, v79
    v_add_f32 v89, v85, v87
    v_fma_f32 v82, v78, 4.0, v76
    v_fma_f32 v90, v86, 4.0, v84
    v_fma_f32 v83, v79, 4.0, v77
    v_fma_f32 v91, v87, 4.0, v85
    v_add_f32 v77, v80, v81
    v_add_f32 v85, v88, v89
    v_sub_f32 v78, v80, v81
    v_sub_f32 v86, v88, v89
    v_fma_f32 v79, v83, 2.0, v82
    v_fma_f32 v87, v91, 2.0, v90
    v_fma_f32 v82, v83, -2.0, v82
    v_fma_f32 v90, v91, -2.0, v90
    v_fmamk_f32 v80, v76, 0x41700000, v82
    v_fmamk_f32 v88, v84, 0x41700000, v90
    v_fmamk_f32 v80, v81, 0x41200000, v80
    v_fmamk_f32 v88, v89, 0x41200000, v88
    v_cvt_pk_bf16_f32 v55, v77, v85
    v_cvt_pk_bf16_f32 v59, v78, v86
    v_cvt_pk_bf16_f32 v67, v79, v87
    v_cvt_pk_bf16_f32 v71, v82, v90
    v_cvt_pk_bf16_f32 v75, v80, v88
    ds_write_b128 v96, v[64:67] offset:57344
    ds_write_b128 v97, v[68:71] offset:8192
    ds_write_b128 v97, v[72:75] offset:24576
    ds_write_b128 v96, v[48:51] offset:8192
    ds_write_b128 v96, v[52:55] offset:24576
    ds_write_b128 v96, v[56:59] offset:40960
    ds_write_b128 v98, v[60:63] offset:8704
    s_add_u32 s28, s28, 1
    s_waitcnt lgkmcnt(0)
    s_barrier
    s_cmp_eq_u32 s22, 1
    s_cbranch_scc1 L_conv1_kernel_hlast1
    s_cmp_lt_u32 s28, 13
    s_cselect_b32 s24, 0, 2130706432
    s_waitcnt vmcnt(0)
    v_lshlrev_b32 v76, 16, v0
    v_and_b32 v84, s25, v0
    v_lshlrev_b32 v77, 16, v4
    v_and_b32 v85, s25, v4
    v_lshlrev_b32 v78, 16, v8
    v_and_b32 v86, s25, v8
    v_lshlrev_b32 v79, 16, v12
    v_and_b32 v87, s25, v12
    v_add_f32 v80, v76, v78
    v_add_f32 v88, v84, v86
    v_add_f32 v81, v77, v79
    v_add_f32 v89, v85, v87
    v_fma_f32 v82, v78, 4.0, v76
    v_fma_f32 v90, v86, 4.0, v84
    v_fma_f32 v83, v79, 4.0, v77
    v_fma_f32 v91, v87, 4.0, v85
    v_add_f32 v77, v80, v81
    v_add_f32 v85, v88, v89
    v_sub_f32 v78, v80, v81
    v_sub_f32 v86, v88, v89
    v_fma_f32 v79, v83, 2.0, v82
    v_fma_f32 v87, v91, 2.0, v90
    v_fma_f32 v82, v83, -2.0, v82
    v_fma_f32 v90, v91, -2.0, v90
    v_fmamk_f32 v80, v76, 0x41700000, v82
    v_fmamk_f32 v88, v84, 0x41700000, v90
    v_fmamk_f32 v80, v81, 0x41200000, v80
    v_fmamk_f32 v88, v89, 0x41200000, v88
    v_cvt_pk_bf16_f32 v4, v77, v85
    v_cvt_pk_bf16_f32 v8, v78, v86
    v_cvt_pk_bf16_f32 v64, v79, v87
    v_cvt_pk_bf16_f32 v68, v82, v90
    v_cvt_pk_bf16_f32 v72, v80, v88
    v_lshlrev_b32 v76, 16, v1
    v_and_b32 v84, s25, v1
    v_lshlrev_b32 v77, 16, v5
    v_and_b32 v85, s25, v5
    v_lshlrev_b32 v78, 16, v9
    v_and_b32 v86, s25, v9
    buffer_load_dwordx4 v[32:35], v92, s[8:11], s24 offen offset:0
    buffer_load_dwordx4 v[48:51], v92, s[8:11], s24 offen offset:64
    v_add_u32 v92, 128, v92
    v_lshlrev_b32 v79, 16, v13
    v_and_b32 v87, s25, v13
    v_add_f32 v80, v76, v78
    v_add_f32 v88, v84, v86
    v_add_f32 v81, v77, v79
    v_add_f32 v89, v85, v87
    v_fma_f32 v82, v78, 4.0, v76
    v_fma_f32 v90, v86, 4.0, v84
    v_fma_f32 v83, v79, 4.0, v77
    v_fma_f32 v91, v87, 4.0, v85
    v_add_f32 v77, v80, v81
    v_add_f32 v85, v88, v89
    v_sub_f32 v78, v80, v81
    v_sub_f32 v86, v88, v89
    v_fma_f32 v79, v83, 2.0, v82
    v_fma_f32 v87, v91, 2.0, v90
    v_fma_f32 v82, v83, -2.0, v82
    v_fma_f32 v90, v91, -2.0, v90
    v_fmamk_f32 v80, v76, 0x41700000, v82
    v_fmamk_f32 v88, v84, 0x41700000, v90
    v_fmamk_f32 v80, v81, 0x41200000, v80
    v_fmamk_f32 v88, v89, 0x41200000, v88
    v_cvt_pk_bf16_f32 v5, v77, v85
    v_cvt_pk_bf16_f32 v9, v78, v86
    v_cvt_pk_bf16_f32 v65, v79, v87
    v_cvt_pk_bf16_f32 v69, v82, v90
    v_cvt_pk_bf16_f32 v73, v80, v88
    v_lshlrev_b32 v76, 16, v2
    v_and_b32 v84, s25, v2
    v_lshlrev_b32 v77, 16, v6
    v_and_b32 v85, s25, v6
    v_lshlrev_b32 v78, 16, v10
    v_and_b32 v86, s25, v10
    v_lshlrev_b32 v79, 16, v14
    v_and_b32 v87, s25, v14
    v_add_f32 v80, v76, v78
    v_add_f32 v88, v84, v86
    v_add_f32 v81, v77, v79
    v_add_f32 v89, v85, v87
    v_fma_f32 v82, v78, 4.0, v76
    v_fma_f32 v90, v86, 4.0, v84
    v_fma_f32 v83, v79, 4.0, v77
    v_fma_f32 v91, v87, 4.0, v85
    v_add_f32 v77, v80, v81
    v_add_f32 v85, v88, v89
    v_sub_f32 v78, v80, v81
    v_sub_f32 v86, v88, v89
    v_fma_f32 v79, v83, 2.0, v82
    v_fma_f32 v87, v91, 2.0, v90
    v_fma_f32 v82, v83, -2.0, v82
    v_fma_f32 v90, v91, -2.0, v90
    v_fmamk_f32 v80, v76, 0x41700000, v82
    v_fmamk_f32 v88, v84, 0x41700000, v90
    buffer_load_dwordx4 v[36:39], v93, s[8:11], s24 offen offset:0
    buffer_load_dwordx4 v[52:55], v93, s[8:11], s24 offen offset:64
    v_add_u32 v93, 128, v93
    v_fmamk_f32 v80, v81, 0x41200000, v80
    v_fmamk_f32 v88, v89, 0x41200000, v88
    v_cvt_pk_bf16_f32 v6, v77, v85
    v_cvt_pk_bf16_f32 v10, v78, v86
    v_cvt_pk_bf16_f32 v66, v79, v87
    v_cvt_pk_bf16_f32 v70, v82, v90
    v_cvt_pk_bf16_f32 v74, v80, v88
    v_lshlrev_b32 v76, 16, v3
    v_and_b32 v84, s25, v3
    v_lshlrev_b32 v77, 16, v7
    v_and_b32 v85, s25, v7
    v_lshlrev_b32 v78, 16, v11
    v_and_b32 v86, s25, v11
    v_lshlrev_b32 v79, 16, v15
    v_and_b32 v87, s25, v15
    v_add_f32 v80, v76, v78
    v_add_f32 v88, v84, v86
    v_add_f32 v81, v77, v79
    v_add_f32 v89, v85, v87
    v_fma_f32 v82, v78, 4.0, v76
    v_fma_f32 v90, v86, 4.0, v84
    v_fma_f32 v83, v79, 4.0, v77
    v_fma_f32 v91, v87, 4.0, v85
    v_add_f32 v77, v80, v81
    v_add_f32 v85, v88, v89
    v_sub_f32 v78, v80, v81
    v_sub_f32 v86, v88, v89
    v_fma_f32 v79, v83, 2.0, v82
    v_fma_f32 v87, v91, 2.0, v90
    v_fma_f32 v82, v83, -2.0, v82
    v_fma_f32 v90, v91, -2.0, v90
    v_fmamk_f32 v80, v76, 0x41700000, v82
    v_fmamk_f32 v88, v84, 0x41700000, v90
    v_fmamk_f32 v80, v81, 0x41200000, v80
    v_fmamk_f32 v88, v89, 0x41200000, v88
    v_cvt_pk_bf16_f32 v7, v77, v85
    v_cvt_pk_bf16_f32 v11, v78, v86
    v_cvt_pk_bf16_f32 v67, v79, v87
    v_cvt_pk_bf16_f32 v71, v82, v90
    v_cvt_pk_bf16_f32 v75, v80, v88
    ds_write_b128 v96, v[64:67] offset:49152
    ds_write_b128 v97, v[68:71] offset:0
    ds_write_b128 v97, v[72:75] offset:16384
    ds_write_b128 v96, v[0:3] offset:0
    ds_write_b128 v96, v[4:7] offset:16384
    ds_write_b128 v96, v[8:11] offset:32768
    ds_write_b128 v98, v[12:15] offset:0
    s_add_u32 s28, s28, 1
    s_waitcnt lgkmcnt(0)
    s_barrier
    s_sub_u32 s22, s22, 1
    s_branch L_conv1_kernel_hloop1
L_conv1_kernel_hlast1:
    s_branch L_conv1_kernel_end
L_conv1_kernel_h2:
    ds_write_b128 v96, v[0:3] offset:0
    ds_write_b128 v98, v[12:15] offset:0
    v_lshlrev_b32 v76, 16, v0
    v_and_b32 v84, s25, v0
    v_lshlrev_b32 v77, 16, v4
    v_and_b32 v85, s25, v4
    v_lshlrev_b32 v78, 16, v8
    v_and_b32 v86, s25, v8
    v_lshlrev_b32 v79, 16, v12
    v_and_b32 v87, s25, v12
    v_add_f32 v80, v76, v78
    v_add_f32 v88, v84, v86
    v_add_f32 v81, v77, v79
    v_add_f32 v89, v85, v87
    v_fma_f32 v82, v78, 4.0, v76
    v_fma_f32 v90, v86, 4.0, v84
    v_fma_f32 v83, v79, 4.0, v77
    v_fma_f32 v91, v87, 4.0, v85
    v_add_f32 v77, v80, v81
    v_add_f32 v85, v88, v89
    v_sub_f32 v78, v80, v81
    v_sub_f32 v86, v88, v89
    v_fma_f32 v79, v83, 2.0, v82
    v_fma_f32 v87, v91, 2.0, v90
    v_fma_f32 v82, v83, -2.0, v82
    v_fma_f32 v90, v91, -2.0, v90
    v_fmamk_f32 v80, v76, 0x41700000, v82
    v_fmamk_f32 v88, v84, 0x41700000, v90
    v_fmamk_f32 v80, v81, 0x41200000, v80
    v_fmamk_f32 v88, v89, 0x41200000, v88
    v_cvt_pk_bf16_f32 v4, v77, v85
    v_cvt_pk_bf16_f32 v8, v78, v86
    v_cvt_pk_bf16_f32 v64, v79, v87
    v_cvt_pk_bf16_f32 v68, v82, v90
    v_cvt_pk_bf16_f32 v72, v80, v88
    v_lshlrev_b32 v76, 16, v1
    v_and_b32 v84, s25, v1
    v_lshlrev_b32 v77, 16, v5
    v_and_b32 v85, s25, v5
    v_lshlrev_b32 v78, 16, v9
    v_and_b32 v86, s25, v9
    v_lshlrev_b32 v79, 16, v13
    v_and_b32 v87, s25, v13
    v_add_f32 v80, v76, v78
    v_add_f32 v88, v84, v86
    v_add_f32 v81, v77, v79
    v_add_f32 v89, v85, v87
    v_fma_f32 v82, v78, 4.0, v76
    v_fma_f32 v90, v86, 4.0, v84
    v_fma_f32 v83, v79, 4.0, v77
    v_fma_f32 v91, v87, 4.0, v85
    v_add_f32 v77, v80, v81
    v_add_f32 v85, v88, v89
    v_sub_f32 v78, v80, v81
    v_sub_f32 v86, v88, v89
    v_fma_f32 v79, v83, 2.0, v82
    v_fma_f32 v87, v91, 2.0, v90
    v_fma_f32 v82, v83, -2.0, v82
    v_fma_f32 v90, v91, -2.0, v90
    v_fmamk_f32 v80, v76, 0x41700000, v82
    v_fmamk_f32 v88, v84, 0x41700000, v90
    v_fmamk_f32 v80, v81, 0x41200000, v80
    v_fmamk_f32 v88, v89, 0x41200000, v88
    v_cvt_pk_bf16_f32 v5, v77, v85
    v_cvt_pk_bf16_f32 v9, v78, v86
    v_cvt_pk_bf16_f32 v65, v79, v87
    v_cvt_pk_bf16_f32 v69, v82, v90
    v_cvt_pk_bf16_f32 v73, v80, v88
    v_lshlrev_b32 v76, 16, v2
    v_and_b32 v84, s25, v2
    v_lshlrev_b32 v77, 16, v6
    v_and_b32 v85, s25, v6
    v_lshlrev_b32 v78, 16, v10
    v_and_b32 v86, s25, v10
    v_lshlrev_b32 v79, 16, v14
    v_and_b32 v87, s25, v14
    v_add_f32 v80, v76, v78
    v_add_f32 v88, v84, v86
    v_add_f32 v81, v77, v79
    v_add_f32 v89, v85, v87
    v_fma_f32 v82, v78, 4.0, v76
    v_fma_f32 v90, v86, 4.0, v84
    v_fma_f32 v83, v79, 4.0, v77
    v_fma_f32 v91, v87, 4.0, v85
    v_add_f32 v77, v80, v81
    v_add_f32 v85, v88, v89
    v_sub_f32 v78, v80, v81
    v_sub_f32 v86, v88, v89
    v_fma_f32 v79, v83, 2.0, v82
    v_fma_f32 v87, v91, 2.0, v90
    v_fma_f32 v82, v83, -2.0, v82
    v_fma_f32 v90, v91, -2.0, v90
    v_fmamk_f32 v80, v76, 0x41700000, v82
    v_fmamk_f32 v88, v84, 0x41700000, v90
    v_fmamk_f32 v80, v81, 0x41200000, v80
    v_fmamk_f32 v88, v89, 0x41200000, v88
    v_cvt_pk_bf16_f32 v6, v77, v85
    v_cvt_pk_bf16_f32 v10, v78, v86
    v_cvt_pk_bf16_f32 v66, v79, v87
    v_cvt_pk_bf16_f32 v70, v82, v90
    v_cvt_pk_bf16_f32 v74, v80, v88
    v_lshlrev_b32 v76, 16, v3
    v_and_b32 v84, s25, v3
    v_lshlrev_b32 v77, 16, v7
    v_and_b32 v85, s25, v7
    v_lshlrev_b32 v78, 16, v11
    v_and_b32 v86, s25, v11
    v_lshlrev_b32 v79, 16, v15
    v_and_b32 v87, s25, v15
    v_add_f32 v80, v76, v78
    v_add_f32 v88, v84, v86
    v_add_f32 v81, v77, v79
    v_add_f32 v89, v85, v87
    v_fma_f32 v82, v78, 4.0, v76
    v_fma_f32 v90, v86, 4.0, v84
    v_fma_f32 v83, v79, 4.0, v77
    v_fma_f32 v91, v87, 4.0, v85
    v_add_f32 v77, v80, v81
    v_add_f32 v85, v88, v89
    v_sub_f32 v78, v80, v81
    v_sub_f32 v86, v88, v89
    v_fma_f32 v79, v83, 2.0, v82
    v_fma_f32 v87, v91, 2.0, v90
    v_fma_f32 v82, v83, -2.0, v82
    v_fma_f32 v90, v91, -2.0, v90
    v_fmamk_f32 v80, v76, 0x41700000, v82
    v_fmamk_f32 v88, v84, 0x41700000, v90
    v_fmamk_f32 v80, v81, 0x41200000, v80
    v_fmamk_f32 v88, v89, 0x41200000, v88
    v_cvt_pk_bf16_f32 v7, v77, v85
    v_cvt_pk_bf16_f32 v11, v78, v86
    v_cvt_pk_bf16_f32 v67, v79, v87
    v_cvt_pk_bf16_f32 v71, v82, v90
    v_cvt_pk_bf16_f32 v75, v80, v88
    ds_write_b128 v96, v[64:67] offset:49152
    ds_write_b128 v97, v[68:71] offset:0
    ds_write_b128 v97, v[72:75] offset:16384
    ds_write_b128 v96, v[4:7] offset:16384
    ds_write_b128 v96, v[8:11] offset:32768
    s_waitcnt vmcnt(0)
    s_waitcnt lgkmcnt(0)
    s_barrier
    buffer_load_dwordx4 v[32:35], v92, s[8:11], s24 offen offset:0
    buffer_load_dwordx4 v[48:51], v92, s[8:11], s24 offen offset:64
    v_add_u32 v92, 128, v92
    buffer_load_dwordx4 v[36:39], v93, s[8:11], s24 offen offset:0
    buffer_load_dwordx4 v[52:55], v93, s[8:11], s24 offen offset:64
    v_add_u32 v93, 128, v93
    buffer_load_dwordx4 v[40:43], v94, s[8:11], s24 offen offset:0
    buffer_load_dwordx4 v[56:59], v94, s[8:11], s24 offen offset:64
    v_add_u32 v94, 128, v94
    buffer_load_dwordx4 v[44:47], v95, s[8:11], s24 offen offset:0
    buffer_load_dwordx4 v[60:63], v95, s[8:11], s24 offen offset:64
    v_add_u32 v95, 128, v95
    s_setprio 0
    v_lshlrev_b32 v76, 16, v16
    v_and_b32 v84, s25, v16
    v_lshlrev_b32 v77, 16, v20
    v_and_b32 v85, s25, v20
    v_lshlrev_b32 v78, 16, v24
    v_and_b32 v86, s25, v24
    v_lshlrev_b32 v79, 16, v28
    v_and_b32 v87, s25, v28
    v_add_f32 v80, v76, v78
    v_add_f32 v88, v84, v86
    v_add_f32 v81, v77, v79
    v_add_f32 v89, v85, v87
    v_fma_f32 v82, v78, 4.0, v76
    v_fma_f32 v90, v86, 4.0, v84
    v_fma_f32 v83, v79, 4.0, v77
    v_fma_f32 v91, v87, 4.0, v85
    v_add_f32 v77, v80, v81
    v_add_f32 v85, v88, v89
    v_sub_f32 v78, v80, v81
    v_sub_f32 v86, v88, v89
    v_fma_f32 v79, v83, 2.0, v82
    v_fma_f32 v87, v91, 2.0, v90
    v_fma_f32 v82, v83, -2.0, v82
    v_fma_f32 v90, v91, -2.0, v90
    v_fmamk_f32 v80, v76, 0x41700000, v82
    v_fmamk_f32 v88, v84, 0x41700000, v90
    v_fmamk_f32 v80, v81, 0x41200000, v80
    v_fmamk_f32 v88, v89, 0x41200000, v88
    v_cvt_pk_bf16_f32 v20, v77, v85
    v_cvt_pk_bf16_f32 v24, v78, v86
    v_cvt_pk_bf16_f32 v64, v79, v87
    v_cvt_pk_bf16_f32 v68, v82, v90
    v_cvt_pk_bf16_f32 v72, v80, v88
    v_lshlrev_b32 v76, 16, v17
    v_and_b32 v84, s25, v17
    v_lshlrev_b32 v77, 16, v21
    v_and_b32 v85, s25, v21
    v_lshlrev_b32 v78, 16, v25
    v_and_b32 v86, s25, v25
    v_lshlrev_b32 v79, 16, v29
    v_and_b32 v87, s25, v29
    v_add_f32 v80, v76, v78
    v_add_f32 v88, v84, v86
    v_add_f32 v81, v77, v79
    v_add_f32 v89, v85, v87
    v_fma_f32 v82, v78, 4.0, v76
    v_fma_f32 v90, v86, 4.0, v84
    v_fma_f32 v83, v79, 4.0, v77
    v_fma_f32 v91, v87, 4.0, v85
    v_add_f32 v77, v80, v81
    v_add_f32 v85, v88, v89
    v_sub_f32 v78, v80, v81
    v_sub_f32 v86, v88, v89
    v_fma_f32 v79, v83, 2.0, v82
    v_fma_f32 v87, v91, 2.0, v90
    v_fma_f32 v82, v83, -2.0, v82
    v_fma_f32 v90, v91, -2.0, v90
    v_fmamk_f32 v80, v76, 0x41700000, v82
    v_fmamk_f32 v88, v84, 0x41700000, v90
    v_fmamk_f32 v80, v81, 0x41200000, v80
    v_fmamk_f32 v88, v89, 0x41200000, v88
    v_cvt_pk_bf16_f32 v21, v77, v85
    v_cvt_pk_bf16_f32 v25, v78, v86
    v_cvt_pk_bf16_f32 v65, v79, v87
    v_cvt_pk_bf16_f32 v69, v82, v90
    v_cvt_pk_bf16_f32 v73, v80, v88
    v_lshlrev_b32 v76, 16, v18
    v_and_b32 v84, s25, v18
    v_lshlrev_b32 v77, 16, v22
    v_and_b32 v85, s25, v22
    v_lshlrev_b32 v78, 16, v26
    v_and_b32 v86, s25, v26
    v_lshlrev_b32 v79, 16, v30
    v_and_b32 v87, s25, v30
    v_add_f32 v80, v76, v78
    v_add_f32 v88, v84, v86
    v_add_f32 v81, v77, v79
    v_add_f32 v89, v85, v87
    v_fma_f32 v82, v78, 4.0, v76
    v_fma_f32 v90, v86, 4.0, v84
    v_fma_f32 v83, v79, 4.0, v77
    v_fma_f32 v91, v87, 4.0, v85
    v_add_f32 v77, v80, v81
    v_add_f32 v85, v88, v89
    v_sub_f32 v78, v80, v81
    v_sub_f32 v86, v88, v89
    v_fma_f32 v79, v83, 2.0, v82
    v_fma_f32 v87, v91, 2.0, v90
    v_fma_f32 v82, v83, -2.0, v82
    v_fma_f32 v90, v91, -2.0, v90
    v_fmamk_f32 v80, v76, 0x41700000, v82
    v_fmamk_f32 v88, v84, 0x41700000, v90
    v_fmamk_f32 v80, v81, 0x41200000, v80
    v_fmamk_f32 v88, v89, 0x41200000, v88
    v_cvt_pk_bf16_f32 v22, v77, v85
    v_cvt_pk_bf16_f32 v26, v78, v86
    v_cvt_pk_bf16_f32 v66, v79, v87
    v_cvt_pk_bf16_f32 v70, v82, v90
    v_cvt_pk_bf16_f32 v74, v80, v88
    v_lshlrev_b32 v76, 16, v19
    v_and_b32 v84, s25, v19
    v_lshlrev_b32 v77, 16, v23
    v_and_b32 v85, s25, v23
    v_lshlrev_b32 v78, 16, v27
    v_and_b32 v86, s25, v27
    v_lshlrev_b32 v79, 16, v31
    v_and_b32 v87, s25, v31
    v_add_f32 v80, v76, v78
    v_add_f32 v88, v84, v86
    v_add_f32 v81, v77, v79
    v_add_f32 v89, v85, v87
    v_fma_f32 v82, v78, 4.0, v76
    v_fma_f32 v90, v86, 4.0, v84
    v_fma_f32 v83, v79, 4.0, v77
    v_fma_f32 v91, v87, 4.0, v85
    v_add_f32 v77, v80, v81
    v_add_f32 v85, v88, v89
    v_sub_f32 v78, v80, v81
    v_sub_f32 v86, v88, v89
    v_fma_f32 v79, v83, 2.0, v82
    v_fma_f32 v87, v91, 2.0, v90
    v_fma_f32 v82, v83, -2.0, v82
    v_fma_f32 v90, v91, -2.0, v90
    v_fmamk_f32 v80, v76, 0x41700000, v82
    v_fmamk_f32 v88, v84, 0x41700000, v90
    v_fmamk_f32 v80, v81, 0x41200000, v80
    v_fmamk_f32 v88, v89, 0x41200000, v88
    v_cvt_pk_bf16_f32 v23, v77, v85
    v_cvt_pk_bf16_f32 v27, v78, v86
    v_cvt_pk_bf16_f32 v67, v79, v87
    v_cvt_pk_bf16_f32 v71, v82, v90
    v_cvt_pk_bf16_f32 v75, v80, v88
L_conv1_kernel_hloop2:
    s_cmp_lt_u32 s28, 12
    s_cselect_b32 s24, 0, 2130706432
    ds_write_b128 v96, v[64:67] offset:57344
    ds_write_b128 v97, v[68:71] offset:8192
    ds_write_b128 v97, v[72:75] offset:24576
    ds_write_b128 v96, v[16:19] offset:8192
    ds_write_b128 v96, v[20:23] offset:24576
    ds_write_b128 v96, v[24:27] offset:40960
    ds_write_b128 v98, v[28:31] offset:8704
    s_waitcnt vmcnt(0)
    buffer_load_dwordx4 v[0:3], v92, s[8:11], s24 offen offset:0
    buffer_load_dwordx4 v[16:19], v92, s[8:11], s24 offen offset:64
    v_add_u32 v92, 128, v92
    buffer_load_dwordx4 v[4:7], v93, s[8:11], s24 offen offset:0
    buffer_load_dwordx4 v[20:23], v93, s[8:11], s24 offen offset:64
    v_add_u32 v93, 128, v93
    v_lshlrev_b32 v76, 16, v32
    v_and_b32 v84, s25, v32
    v_lshlrev_b32 v77, 16, v36
    v_and_b32 v85, s25, v36
    v_lshlrev_b32 v78, 16, v40
    v_and_b32 v86, s25, v40
    v_lshlrev_b32 v79, 16, v44
    v_and_b32 v87, s25, v44
    v_add_f32 v80, v76, v78
    v_add_f32 v88, v84, v86
    v_add_f32 v81, v77, v79
    v_add_f32 v89, v85, v87
    v_fma_f32 v82, v78, 4.0, v76
    v_fma_f32 v90, v86, 4.0, v84
    v_fma_f32 v83, v79, 4.0, v77
    v_fma_f32 v91, v87, 4.0, v85
    v_add_f32 v77, v80, v81
    v_add_f32 v85, v88, v89
    v_sub_f32 v78, v80, v81
    v_sub_f32 v86, v88, v89
    v_fma_f32 v79, v83, 2.0, v82
    v_fma_f32 v87, v91, 2.0, v90
    v_fma_f32 v82, v83, -2.0, v82
    v_fma_f32 v90, v91, -2.0, v90
    v_fmamk_f32 v80, v76, 0x41700000, v82
    v_fmamk_f32 v88, v84, 0x41700000, v90
    v_fmamk_f32 v80, v81, 0x41200000, v80
    v_fmamk_f32 v88, v89, 0x41200000, v88
    v_cvt_pk_bf16_f32 v36, v77, v85
    v_cvt_pk_bf16_f32 v40, v78, v86
    v_cvt_pk_bf16_f32 v64, v79, v87
    v_cvt_pk_bf16_f32 v68, v82, v90
    v_cvt_pk_bf16_f32 v72, v80, v88
    v_lshlrev_b32 v76, 16, v33
    v_and_b32 v84, s25, v33
    v_lshlrev_b32 v77, 16, v37
    v_and_b32 v85, s25, v37
    v_lshlrev_b32 v78, 16, v41
    v_and_b32 v86, s25, v41
    v_lshlrev_b32 v79, 16, v45
    v_and_b32 v87, s25, v45
    v_add_f32 v80, v76, v78
    v_add_f32 v88, v84, v86
    v_add_f32 v81, v77, v79
    v_add_f32 v89, v85, v87
    v_fma_f32 v82, v78, 4.0, v76
    v_fma_f32 v90, v86, 4.0, v84
    v_fma_f32 v83, v79, 4.0, v77
    v_fma_f32 v91, v87, 4.0, v85
    v_add_f32 v77, v80, v81
    v_add_f32 v85, v88, v89
    v_sub_f32 v78, v80, v81
    v_sub_f32 v86, v88, v89
    v_fma_f32 v79, v83, 2.0, v82
    v_fma_f32 v87, v91, 2.0, v90
    v_fma_f32 v82, v83, -2.0, v82
    v_fma_f32 v90, v91, -2.0, v90
    v_fmamk_f32 v80, v76, 0x41700000, v82
    v_fmamk_f32 v88, v84, 0x41700000, v90
    v_fmamk_f32 v80, v81, 0x41200000, v80
    v_fmamk_f32 v88, v89, 0x41200000, v88
    v_cvt_pk_bf16_f32 v37, v77, v85
    v_cvt_pk_bf16_f32 v41, v78, v86
    v_cvt_pk_bf16_f32 v65, v79, v87
    v_cvt_pk_bf16_f32 v69, v82, v90
    v_cvt_pk_bf16_f32 v73, v80, v88
    v_lshlrev_b32 v76, 16, v34
    v_and_b32 v84, s25, v34
    v_lshlrev_b32 v77, 16, v38
    v_and_b32 v85, s25, v38
    v_lshlrev_b32 v78, 16, v42
    v_and_b32 v86, s25, v42
    v_lshlrev_b32 v79, 16, v46
    v_and_b32 v87, s25, v46
    v_add_f32 v80, v76, v78
    v_add_f32 v88, v84, v86
    v_add_f32 v81, v77, v79
    v_add_f32 v89, v85, v87
    v_fma_f32 v82, v78, 4.0, v76
    v_fma_f32 v90, v86, 4.0, v84
    v_fma_f32 v83, v79, 4.0, v77
    v_fma_f32 v91, v87, 4.0, v85
    v_add_f32 v77, v80, v81
    v_add_f32 v85, v88, v89
    v_sub_f32 v78, v80, v81
    v_sub_f32 v86, v88, v89
    v_fma_f32 v79, v83, 2.0, v82
    v_fma_f32 v87, v91, 2.0, v90
    v_fma_f32 v82, v83, -2.0, v82
    v_fma_f32 v90, v91, -2.0, v90
    v_fmamk_f32 v80, v76, 0x41700000, v82
    v_fmamk_f32 v88, v84, 0x41700000, v90
    v_fmamk_f32 v80, v81, 0x41200000, v80
    v_fmamk_f32 v88, v89, 0x41200000, v88
    v_cvt_pk_bf16_f32 v38, v77, v85
    v_cvt_pk_bf16_f32 v42, v78, v86
    v_cvt_pk_bf16_f32 v66, v79, v87
    v_cvt_pk_bf16_f32 v70, v82, v90
    v_cvt_pk_bf16_f32 v74, v80, v88
    v_lshlrev_b32 v76, 16, v35
    v_and_b32 v84, s25, v35
    v_lshlrev_b32 v77, 16, v39
    v_and_b32 v85, s25, v39
    v_lshlrev_b32 v78, 16, v43
    v_and_b32 v86, s25, v43
    v_lshlrev_b32 v79, 16, v47
    v_and_b32 v87, s25, v47
    v_add_f32 v80, v76, v78
    v_add_f32 v88, v84, v86
    v_add_f32 v81, v77, v79
    v_add_f32 v89, v85, v87
    v_fma_f32 v82, v78, 4.0, v76
    v_fma_f32 v90, v86, 4.0, v84
    v_fma_f32 v83, v79, 4.0, v77
    v_fma_f32 v91, v87, 4.0, v85
    v_add_f32 v77, v80, v81
    v_add_f32 v85, v88, v89
    v_sub_f32 v78, v80, v81
    v_sub_f32 v86, v88, v89
    v_fma_f32 v79, v83, 2.0, v82
    v_fma_f32 v87, v91, 2.0, v90
    v_fma_f32 v82, v83, -2.0, v82
    v_fma_f32 v90, v91, -2.0, v90
    v_fmamk_f32 v80, v76, 0x41700000, v82
    v_fmamk_f32 v88, v84, 0x41700000, v90
    v_fmamk_f32 v80, v81, 0x41200000, v80
    v_fmamk_f32 v88, v89, 0x41200000, v88
    v_cvt_pk_bf16_f32 v39, v77, v85
    v_cvt_pk_bf16_f32 v43, v78, v86
    v_cvt_pk_bf16_f32 v67, v79, v87
    v_cvt_pk_bf16_f32 v71, v82, v90
    v_cvt_pk_bf16_f32 v75, v80, v88
    s_add_u32 s28, s28, 1
    s_waitcnt lgkmcnt(0)
    s_barrier
    s_cmp_lt_u32 s28, 12
    s_cselect_b32 s24, 0, 2130706432
    ds_write_b128 v96, v[64:67] offset:49152
    ds_write_b128 v97, v[68:71] offset:0
    ds_write_b128 v97, v[72:75] offset:16384
    ds_write_b128 v96, v[32:35] offset:0
    ds_write_b128 v96, v[36:39] offset:16384
    ds_write_b128 v96, v[40:43] offset:32768
    ds_write_b128 v98, v[44:47] offset:0
    buffer_load_dwordx4 v[8:11], v94, s[8:11], s24 offen offset:0
    buffer_load_dwordx4 v[24:27], v94, s[8:11], s24 offen offset:64
    v_add_u32 v94, 128, v94
    buffer_load_dwordx4 v[12:15], v95, s[8:11], s24 offen offset:0
    buffer_load_dwordx4 v[28:31], v95, s[8:11], s24 offen offset:64
    v_add_u32 v95, 128, v95
    v_lshlrev_b32 v76, 16, v48
    v_and_b32 v84, s25, v48
    v_lshlrev_b32 v77, 16, v52
    v_and_b32 v85, s25, v52
    v_lshlrev_b32 v78, 16, v56
    v_and_b32 v86, s25, v56
    v_lshlrev_b32 v79, 16, v60
    v_and_b32 v87, s25, v60
    v_add_f32 v80, v76, v78
    v_add_f32 v88, v84, v86
    v_add_f32 v81, v77, v79
    v_add_f32 v89, v85, v87
    v_fma_f32 v82, v78, 4.0, v76
    v_fma_f32 v90, v86, 4.0, v84
    v_fma_f32 v83, v79, 4.0, v77
    v_fma_f32 v91, v87, 4.0, v85
    v_add_f32 v77, v80, v81
    v_add_f32 v85, v88, v89
    v_sub_f32 v78, v80, v81
    v_sub_f32 v86, v88, v89
    v_fma_f32 v79, v83, 2.0, v82
    v_fma_f32 v87, v91, 2.0, v90
    v_fma_f32 v82, v83, -2.0, v82
    v_fma_f32 v90, v91, -2.0, v90
    v_fmamk_f32 v80, v76, 0x41700000, v82
    v_fmamk_f32 v88, v84, 0x41700000, v90
    v_fmamk_f32 v80, v81, 0x41200000, v80
    v_fmamk_f32 v88, v89, 0x41200000, v88
    v_cvt_pk_bf16_f32 v52, v77, v85
    v_cvt_pk_bf16_f32 v56, v78, v86
    v_cvt_pk_bf16_f32 v64, v79, v87
    v_cvt_pk_bf16_f32 v68, v82, v90
    v_cvt_pk_bf16_f32 v72, v80, v88
    v_lshlrev_b32 v76, 16, v49
    v_and_b32 v84, s25, v49
    v_lshlrev_b32 v77, 16, v53
    v_and_b32 v85, s25, v53
    v_lshlrev_b32 v78, 16, v57
    v_and_b32 v86, s25, v57
    v_lshlrev_b32 v79, 16, v61
    v_and_b32 v87, s25, v61
    v_add_f32 v80, v76, v78
    v_add_f32 v88, v84, v86
    v_add_f32 v81, v77, v79
    v_add_f32 v89, v85, v87
    v_fma_f32 v82, v78, 4.0, v76
    v_fma_f32 v90, v86, 4.0, v84
    v_fma_f32 v83, v79, 4.0, v77
    v_fma_f32 v91, v87, 4.0, v85
    v_add_f32 v77, v80, v81
    v_add_f32 v85, v88, v89
    v_sub_f32 v78, v80, v81
    v_sub_f32 v86, v88, v89
    v_fma_f32 v79, v83, 2.0, v82
    v_fma_f32 v87, v91, 2.0, v90
    v_fma_f32 v82, v83, -2.0, v82
    v_fma_f32 v90, v91, -2.0, v90
    v_fmamk_f32 v80, v76, 0x41700000, v82
    v_fmamk_f32 v88, v84, 0x41700000, v90
    v_fmamk_f32 v80, v81, 0x41200000, v80
    v_fmamk_f32 v88, v89, 0x41200000, v88
    v_cvt_pk_bf16_f32 v53, v77, v85
    v_cvt_pk_bf16_f32 v57, v78, v86
    v_cvt_pk_bf16_f32 v65, v79, v87
    v_cvt_pk_bf16_f32 v69, v82, v90
    v_cvt_pk_bf16_f32 v73, v80, v88
    v_lshlrev_b32 v76, 16, v50
    v_and_b32 v84, s25, v50
    v_lshlrev_b32 v77, 16, v54
    v_and_b32 v85, s25, v54
    v_lshlrev_b32 v78, 16, v58
    v_and_b32 v86, s25, v58
    v_lshlrev_b32 v79, 16, v62
    v_and_b32 v87, s25, v62
    v_add_f32 v80, v76, v78
    v_add_f32 v88, v84, v86
    v_add_f32 v81, v77, v79
    v_add_f32 v89, v85, v87
    v_fma_f32 v82, v78, 4.0, v76
    v_fma_f32 v90, v86, 4.0, v84
    v_fma_f32 v83, v79, 4.0, v77
    v_fma_f32 v91, v87, 4.0, v85
    v_add_f32 v77, v80, v81
    v_add_f32 v85, v88, v89
    v_sub_f32 v78, v80, v81
    v_sub_f32 v86, v88, v89
    v_fma_f32 v79, v83, 2.0, v82
    v_fma_f32 v87, v91, 2.0, v90
    v_fma_f32 v82, v83, -2.0, v82
    v_fma_f32 v90, v91, -2.0, v90
    v_fmamk_f32 v80, v76, 0x41700000, v82
    v_fmamk_f32 v88, v84, 0x41700000, v90
    v_fmamk_f32 v80, v81, 0x41200000, v80
    v_fmamk_f32 v88, v89, 0x41200000, v88
    v_cvt_pk_bf16_f32 v54, v77, v85
    v_cvt_pk_bf16_f32 v58, v78, v86
    v_cvt_pk_bf16_f32 v66, v79, v87
    v_cvt_pk_bf16_f32 v70, v82, v90
    v_cvt_pk_bf16_f32 v74, v80, v88
    v_lshlrev_b32 v76, 16, v51
    v_and_b32 v84, s25, v51
    v_lshlrev_b32 v77, 16, v55
    v_and_b32 v85, s25, v55
    v_lshlrev_b32 v78, 16, v59
    v_and_b32 v86, s25, v59
    v_lshlrev_b32 v79, 16, v63
    v_and_b32 v87, s25, v63
    v_add_f32 v80, v76, v78
    v_add_f32 v88, v84, v86
    v_add_f32 v81, v77, v79
    v_add_f32 v89, v85, v87
    v_fma_f32 v82, v78, 4.0, v76
    v_fma_f32 v90, v86, 4.0, v84
    v_fma_f32 v83, v79, 4.0, v77
    v_fma_f32 v91, v87, 4.0, v85
    v_add_f32 v77, v80, v81
    v_add_f32 v85, v88, v89
    v_sub_f32 v78, v80, v81
    v_sub_f32 v86, v88, v89
    v_fma_f32 v79, v83, 2.0, v82
    v_fma_f32 v87, v91, 2.0, v90
    v_fma_f32 v82, v83, -2.0, v82
    v_fma_f32 v90, v91, -2.0, v90
    v_fmamk_f32 v80, v76, 0x41700000, v82
    v_fmamk_f32 v88, v84, 0x41700000, v90
    v_fmamk_f32 v80, v81, 0x41200000, v80
    v_fmamk_f32 v88, v89, 0x41200000, v88
    v_cvt_pk_bf16_f32 v55, v77, v85
    v_cvt_pk_bf16_f32 v59, v78, v86
    v_cvt_pk_bf16_f32 v67, v79, v87
    v_cvt_pk_bf16_f32 v71, v82, v90
    v_cvt_pk_bf16_f32 v75, v80, v88
    s_add_u32 s28, s28, 1
    s_waitcnt lgkmcnt(0)
    s_barrier
    s_cmp_eq_u32 s22, 1
    s_cbranch_scc1 L_conv1_kernel_hlast2
    s_cmp_lt_u32 s28, 12
    s_cselect_b32 s24, 0, 2130706432
    ds_write_b128 v96, v[64:67] offset:57344
    ds_write_b128 v97, v[68:71] offset:8192
    ds_write_b128 v97, v[72:75] offset:24576
    ds_write_b128 v96, v[48:51] offset:8192
    ds_write_b128 v96, v[52:55] offset:24576
    ds_write_b128 v96, v[56:59] offset:40960
    ds_write_b128 v98, v[60:63] offset:8704
    s_waitcnt vmcnt(0)
    buffer_load_dwordx4 v[32:35], v92, s[8:11], s24 offen offset:0
    buffer_load_dwordx4 v[48:51], v92, s[8:11], s24 offen offset:64
    v_add_u32 v92, 128, v92
    buffer_load_dwordx4 v[36:39], v93, s[8:11], s24 offen offset:0
    buffer_load_dwordx4 v[52:55], v93, s[8:11], s24 offen offset:64
    v_add_u32 v93, 128, v93
    v_lshlrev_b32 v76, 16, v0
    v_and_b32 v84, s25, v0
    v_lshlrev_b32 v77, 16, v4
    v_and_b32 v85, s25, v4
    v_lshlrev_b32 v78, 16, v8
    v_and_b32 v86, s25, v8
    v_lshlrev_b32 v79, 16, v12
    v_and_b32 v87, s25, v12
    v_add_f32 v80, v76, v78
    v_add_f32 v88, v84, v86
    v_add_f32 v81, v77, v79
    v_add_f32 v89, v85, v87
    v_fma_f32 v82, v78, 4.0, v76
    v_fma_f32 v90, v86, 4.0, v84
    v_fma_f32 v83, v79, 4.0, v77
    v_fma_f32 v91, v87, 4.0, v85
    v_add_f32 v77, v80, v81
    v_add_f32 v85, v88, v89
    v_sub_f32 v78, v80, v81
    v_sub_f32 v86, v88, v89
    v_fma_f32 v79, v83, 2.0, v82
    v_fma_f32 v87, v91, 2.0, v90
    v_fma_f32 v82, v83, -2.0, v82
    v_fma_f32 v90, v91, -2.0, v90
    v_fmamk_f32 v80, v76, 0x41700000, v82
    v_fmamk_f32 v88, v84, 0x41700000, v90
    v_fmamk_f32 v80, v81, 0x41200000, v80
    v_fmamk_f32 v88, v89, 0x41200000, v88
    v_cvt_pk_bf16_f32 v4, v77, v85
    v_cvt_pk_bf16_f32 v8, v78, v86
    v_cvt_pk_bf16_f32 v64, v79, v87
    v_cvt_pk_bf16_f32 v68, v82, v90
    v_cvt_pk_bf16_f32 v72, v80, v88
    v_lshlrev_b32 v76, 16, v1
    v_and_b32 v84, s25, v1
    v_lshlrev_b32 v77, 16, v5
    v_and_b32 v85, s25, v5
    v_lshlrev_b32 v78, 16, v9
    v_and_b32 v86, s25, v9
    v_lshlrev_b32 v79, 16, v13
    v_and_b32 v87, s25, v13
    v_add_f32 v80, v76, v78
    v_add_f32 v88, v84, v86
    v_add_f32 v81, v77, v79
    v_add_f32 v89, v85, v87
    v_fma_f32 v82, v78, 4.0, v76
    v_fma_f32 v90, v86, 4.0, v84
    v_fma_f32 v83, v79, 4.0, v77
    v_fma_f32 v91, v87, 4.0, v85
    v_add_f32 v77, v80, v81
    v_add_f32 v85, v88, v89
    v_sub_f32 v78, v80, v81
    v_sub_f32 v86, v88, v89
    v_fma_f32 v79, v83, 2.0, v82
    v_fma_f32 v87, v91, 2.0, v90
    v_fma_f32 v82, v83, -2.0, v82
    v_fma_f32 v90, v91, -2.0, v90
    v_fmamk_f32 v80, v76, 0x41700000, v82
    v_fmamk_f32 v88, v84, 0x41700000, v90
    v_fmamk_f32 v80, v81, 0x41200000, v80
    v_fmamk_f32 v88, v89, 0x41200000, v88
    v_cvt_pk_bf16_f32 v5, v77, v85
    v_cvt_pk_bf16_f32 v9, v78, v86
    v_cvt_pk_bf16_f32 v65, v79, v87
    v_cvt_pk_bf16_f32 v69, v82, v90
    v_cvt_pk_bf16_f32 v73, v80, v88
    v_lshlrev_b32 v76, 16, v2
    v_and_b32 v84, s25, v2
    v_lshlrev_b32 v77, 16, v6
    v_and_b32 v85, s25, v6
    v_lshlrev_b32 v78, 16, v10
    v_and_b32 v86, s25, v10
    v_lshlrev_b32 v79, 16, v14
    v_and_b32 v87, s25, v14
    v_add_f32 v80, v76, v78
    v_add_f32 v88, v84, v86
    v_add_f32 v81, v77, v79
    v_add_f32 v89, v85, v87
    v_fma_f32 v82, v78, 4.0, v76
    v_fma_f32 v90, v86, 4.0, v84
    v_fma_f32 v83, v79, 4.0, v77
    v_fma_f32 v91, v87, 4.0, v85
    v_add_f32 v77, v80, v81
    v_add_f32 v85, v88, v89
    v_sub_f32 v78, v80, v81
    v_sub_f32 v86, v88, v89
    v_fma_f32 v79, v83, 2.0, v82
    v_fma_f32 v87, v91, 2.0, v90
    v_fma_f32 v82, v83, -2.0, v82
    v_fma_f32 v90, v91, -2.0, v90
    v_fmamk_f32 v80, v76, 0x41700000, v82
    v_fmamk_f32 v88, v84, 0x41700000, v90
    v_fmamk_f32 v80, v81, 0x41200000, v80
    v_fmamk_f32 v88, v89, 0x41200000, v88
    v_cvt_pk_bf16_f32 v6, v77, v85
    v_cvt_pk_bf16_f32 v10, v78, v86
    v_cvt_pk_bf16_f32 v66, v79, v87
    v_cvt_pk_bf16_f32 v70, v82, v90
    v_cvt_pk_bf16_f32 v74, v80, v88
    v_lshlrev_b32 v76, 16, v3
    v_and_b32 v84, s25, v3
    v_lshlrev_b32 v77, 16, v7
    v_and_b32 v85, s25, v7
    v_lshlrev_b32 v78, 16, v11
    v_and_b32 v86, s25, v11
    v_lshlrev_b32 v79, 16, v15
    v_and_b32 v87, s25, v15
    v_add_f32 v80, v76, v78
    v_add_f32 v88, v84, v86
    v_add_f32 v81, v77, v79
    v_add_f32 v89, v85, v87
    v_fma_f32 v82, v78, 4.0, v76
    v_fma_f32 v90, v86, 4.0, v84
    v_fma_f32 v83, v79, 4.0, v77
    v_fma_f32 v91, v87, 4.0, v85
    v_add_f32 v77, v80, v81
    v_add_f32 v85, v88, v89
    v_sub_f32 v78, v80, v81
    v_sub_f32 v86, v88, v89
    v_fma_f32 v79, v83, 2.0, v82
    v_fma_f32 v87, v91, 2.0, v90
    v_fma_f32 v82, v83, -2.0, v82
    v_fma_f32 v90, v91, -2.0, v90
    v_fmamk_f32 v80, v76, 0x41700000, v82
    v_fmamk_f32 v88, v84, 0x41700000, v90
    v_fmamk_f32 v80, v81, 0x41200000, v80
    v_fmamk_f32 v88, v89, 0x41200000, v88
    v_cvt_pk_bf16_f32 v7, v77, v85
    v_cvt_pk_bf16_f32 v11, v78, v86
    v_cvt_pk_bf16_f32 v67, v79, v87
    v_cvt_pk_bf16_f32 v71, v82, v90
    v_cvt_pk_bf16_f32 v75, v80, v88
    s_add_u32 s28, s28, 1
    s_waitcnt lgkmcnt(0)
    s_barrier
    s_cmp_lt_u32 s28, 12
    s_cselect_b32 s24, 0, 2130706432
    ds_write_b128 v96, v[64:67] offset:49152
    ds_write_b128 v97, v[68:71] offset:0
    ds_write_b128 v97, v[72:75] offset:16384
    ds_write_b128 v96, v[0:3] offset:0
    ds_write_b128 v96, v[4:7] offset:16384
    ds_write_b128 v96, v[8:11] offset:32768
    ds_write_b128 v98, v[12:15] offset:0
    buffer_load_dwordx4 v[40:43], v94, s[8:11], s24 offen offset:0
    buffer_load_dwordx4 v[56:59], v94, s[8:11], s24 offen offset:64
    v_add_u32 v94, 128, v94
    buffer_load_dwordx4 v[44:47], v95, s[8:11], s24 offen offset:0
    buffer_load_dwordx4 v[60:63], v95, s[8:11], s24 offen offset:64
    v_add_u32 v95, 128, v95
    v_lshlrev_b32 v76, 16, v16
    v_and_b32 v84, s25, v16
    v_lshlrev_b32 v77, 16, v20
    v_and_b32 v85, s25, v20
    v_lshlrev_b32 v78, 16, v24
    v_and_b32 v86, s25, v24
    v_lshlrev_b32 v79, 16, v28
    v_and_b32 v87, s25, v28
    v_add_f32 v80, v76, v78
    v_add_f32 v88, v84, v86
    v_add_f32 v81, v77, v79
    v_add_f32 v89, v85, v87
    v_fma_f32 v82, v78, 4.0, v76
    v_fma_f32 v90, v86, 4.0, v84
    v_fma_f32 v83, v79, 4.0, v77
    v_fma_f32 v91, v87, 4.0, v85
    v_add_f32 v77, v80, v81
    v_add_f32 v85, v88, v89
    v_sub_f32 v78, v80, v81
    v_sub_f32 v86, v88, v89
    v_fma_f32 v79, v83, 2.0, v82
    v_fma_f32 v87, v91, 2.0, v90
    v_fma_f32 v82, v83, -2.0, v82
    v_fma_f32 v90, v91, -2.0, v90
    v_fmamk_f32 v80, v76, 0x41700000, v82
    v_fmamk_f32 v88, v84, 0x41700000, v90
    v_fmamk_f32 v80, v81, 0x41200000, v80
    v_fmamk_f32 v88, v89, 0x41200000, v88
    v_cvt_pk_bf16_f32 v20, v77, v85
    v_cvt_pk_bf16_f32 v24, v78, v86
    v_cvt_pk_bf16_f32 v64, v79, v87
    v_cvt_pk_bf16_f32 v68, v82, v90
    v_cvt_pk_bf16_f32 v72, v80, v88
    v_lshlrev_b32 v76, 16, v17
    v_and_b32 v84, s25, v17
    v_lshlrev_b32 v77, 16, v21
    v_and_b32 v85, s25, v21
    v_lshlrev_b32 v78, 16, v25
    v_and_b32 v86, s25, v25
    v_lshlrev_b32 v79, 16, v29
    v_and_b32 v87, s25, v29
    v_add_f32 v80, v76, v78
    v_add_f32 v88, v84, v86
    v_add_f32 v81, v77, v79
    v_add_f32 v89, v85, v87
    v_fma_f32 v82, v78, 4.0, v76
    v_fma_f32 v90, v86, 4.0, v84
    v_fma_f32 v83, v79, 4.0, v77
    v_fma_f32 v91, v87, 4.0, v85
    v_add_f32 v77, v80, v81
    v_add_f32 v85, v88, v89
    v_sub_f32 v78, v80, v81
    v_sub_f32 v86, v88, v89
    v_fma_f32 v79, v83, 2.0, v82
    v_fma_f32 v87, v91, 2.0, v90
    v_fma_f32 v82, v83, -2.0, v82
    v_fma_f32 v90, v91, -2.0, v90
    v_fmamk_f32 v80, v76, 0x41700000, v82
    v_fmamk_f32 v88, v84, 0x41700000, v90
    v_fmamk_f32 v80, v81, 0x41200000, v80
    v_fmamk_f32 v88, v89, 0x41200000, v88
    v_cvt_pk_bf16_f32 v21, v77, v85
    v_cvt_pk_bf16_f32 v25, v78, v86
    v_cvt_pk_bf16_f32 v65, v79, v87
    v_cvt_pk_bf16_f32 v69, v82, v90
    v_cvt_pk_bf16_f32 v73, v80, v88
    v_lshlrev_b32 v76, 16, v18
    v_and_b32 v84, s25, v18
    v_lshlrev_b32 v77, 16, v22
    v_and_b32 v85, s25, v22
    v_lshlrev_b32 v78, 16, v26
    v_and_b32 v86, s25, v26
    v_lshlrev_b32 v79, 16, v30
    v_and_b32 v87, s25, v30
    v_add_f32 v80, v76, v78
    v_add_f32 v88, v84, v86
    v_add_f32 v81, v77, v79
    v_add_f32 v89, v85, v87
    v_fma_f32 v82, v78, 4.0, v76
    v_fma_f32 v90, v86, 4.0, v84
    v_fma_f32 v83, v79, 4.0, v77
    v_fma_f32 v91, v87, 4.0, v85
    v_add_f32 v77, v80, v81
    v_add_f32 v85, v88, v89
    v_sub_f32 v78, v80, v81
    v_sub_f32 v86, v88, v89
    v_fma_f32 v79, v83, 2.0, v82
    v_fma_f32 v87, v91, 2.0, v90
    v_fma_f32 v82, v83, -2.0, v82
    v_fma_f32 v90, v91, -2.0, v90
    v_fmamk_f32 v80, v76, 0x41700000, v82
    v_fmamk_f32 v88, v84, 0x41700000, v90
    v_fmamk_f32 v80, v81, 0x41200000, v80
    v_fmamk_f32 v88, v89, 0x41200000, v88
    v_cvt_pk_bf16_f32 v22, v77, v85
    v_cvt_pk_bf16_f32 v26, v78, v86
    v_cvt_pk_bf16_f32 v66, v79, v87
    v_cvt_pk_bf16_f32 v70, v82, v90
    v_cvt_pk_bf16_f32 v74, v80, v88
    v_lshlrev_b32 v76, 16, v19
    v_and_b32 v84, s25, v19
    v_lshlrev_b32 v77, 16, v23
    v_and_b32 v85, s25, v23
    v_lshlrev_b32 v78, 16, v27
    v_and_b32 v86, s25, v27
    v_lshlrev_b32 v79, 16, v31
    v_and_b32 v87, s25, v31
    v_add_f32 v80, v76, v78
    v_add_f32 v88, v84, v86
    v_add_f32 v81, v77, v79
    v_add_f32 v89, v85, v87
    v_fma_f32 v82, v78, 4.0, v76
    v_fma_f32 v90, v86, 4.0, v84
    v_fma_f32 v83, v79, 4.0, v77
    v_fma_f32 v91, v87, 4.0, v85
    v_add_f32 v77, v80, v81
    v_add_f32 v85, v88, v89
    v_sub_f32 v78, v80, v81
    v_sub_f32 v86, v88, v89
    v_fma_f32 v79, v83, 2.0, v82
    v_fma_f32 v87, v91, 2.0, v90
    v_fma_f32 v82, v83, -2.0, v82
    v_fma_f32 v90, v91, -2.0, v90
    v_fmamk_f32 v80, v76, 0x41700000, v82
    v_fmamk_f32 v88, v84, 0x41700000, v90
    v_fmamk_f32 v80, v81, 0x41200000, v80
    v_fmamk_f32 v88, v89, 0x41200000, v88
    v_cvt_pk_bf16_f32 v23, v77, v85
    v_cvt_pk_bf16_f32 v27, v78, v86
    v_cvt_pk_bf16_f32 v67, v79, v87
    v_cvt_pk_bf16_f32 v71, v82, v90
    v_cvt_pk_bf16_f32 v75, v80, v88
    s_add_u32 s28, s28, 1
    s_waitcnt lgkmcnt(0)
    s_barrier
    s_sub_u32 s22, s22, 1
    s_branch L_conv1_kernel_hloop2
L_conv1_kernel_hlast2:
    s_waitcnt vmcnt(0)
    s_mov_b32 s58, s20
    s_lshl_b32 s20, s2, 2
    s_add_u32 s20, s20, s32
    v_mov_b32 v1, v127
    s_load_dwordx2 s[8:9], s[0:1], 16
    s_lshr_b32 s22, s20, 8
    s_bfe_u32 s23, s20, 0x40004
    s_bfe_u32 s24, s20, 0x30001
    s_and_b32 s21, s20, 1
    v_lshrrev_b32 v2, 4, v1
    v_lshlrev_b32 v2, 12, v2
    v_and_b32 v3, 15, v1
    v_lshl_add_u32 v2, v3, 2, v2
    s_lshl_b32 s26, s22, 3
    s_lshr_b32 s27, s23, 3
    s_add_u32 s26, s26, s27
    s_lshl_b32 s26, s26, 17
    s_and_b32 s27, s23, 7
    s_lshl_b32 s27, s27, 14
    s_add_u32 s26, s26, s27
    s_lshl_b32 s27, s24, 6
    s_add_u32 s26, s26, s27
    s_mov_b32 s10, 4063232
    s_mov_b32 s11, 0x00020000
    s_add_u32 s37, s26, 262144
    s_add_u32 s38, s26, 524288
    s_add_u32 s39, s26, 786432
    s_waitcnt lgkmcnt(0)
    buffer_load_dword v16, v2, s[8:11], s26 offen offset:0
    buffer_load_dword v17, v2, s[8:11], s26 offen offset:512
    buffer_load_dword v24, v2, s[8:11], s37 offen offset:0
    buffer_load_dword v25, v2, s[8:11], s37 offen offset:512
    buffer_load_dword v32, v2, s[8:11], s38 offen offset:0
    buffer_load_dword v33, v2, s[8:11], s38 offen offset:512
    buffer_load_dword v40, v2, s[8:11], s39 offen offset:0
    buffer_load_dword v41, v2, s[8:11], s39 offen offset:512
    buffer_load_dword v18, v2, s[8:11], s26 offen offset:1024
    buffer_load_dword v19, v2, s[8:11], s26 offen offset:1536
    buffer_load_dword v26, v2, s[8:11], s37 offen offset:1024
    buffer_load_dword v27, v2, s[8:11], s37 offen offset:1536
    buffer_load_dword v34, v2, s[8:11], s38 offen offset:1024
    buffer_load_dword v35, v2, s[8:11], s38 offen offset:1536
    buffer_load_dword v42, v2, s[8:11], s39 offen offset:1024
    buffer_load_dword v43, v2, s[8:11], s39 offen offset:1536
    buffer_load_dword v20, v2, s[8:11], s26 offen offset:2048
    buffer_load_dword v21, v2, s[8:11], s26 offen offset:2560
    buffer_load_dword v28, v2, s[8:11], s37 offen offset:2048
    buffer_load_dword v29, v2, s[8:11], s37 offen offset:2560
    buffer_load_dword v36, v2, s[8:11], s38 offen offset:2048
    buffer_load_dword v37, v2, s[8:11], s38 offen offset:2560
    buffer_load_dword v44, v2, s[8:11], s39 offen offset:2048
    buffer_load_dword v45, v2, s[8:11], s39 offen offset:2560
    buffer_load_dword v22, v2, s[8:11], s26 offen offset:3072
    buffer_load_dword v23, v2, s[8:11], s26 offen offset:3584
    buffer_load_dword v30, v2, s[8:11], s37 offen offset:3072
    buffer_load_dword v31, v2, s[8:11], s37 offen offset:3584
    buffer_load_dword v38, v2, s[8:11], s38 offen offset:3072
    buffer_load_dword v39, v2, s[8:11], s38 offen offset:3584
    buffer_load_dword v46, v2, s[8:11], s39 offen offset:3072
    buffer_load_dword v47, v2, s[8:11], s39 offen offset:3584
    s_add_u32 s12, s30, 9437184
    s_addc_u32 s13, s31, 0
    s_mov_b32 s14, 7340032
    s_mov_b32 s15, 0x00020000
    v_lshlrev_b32 v4, 4, v1
    s_lshl_b32 s27, s24, 4
    s_add_u32 s27, s27, s23
    s_mul_i32 s27, s27, 57344
    s_lshl_b32 s28, s22, 11
    s_add_u32 s27, s27, s28
    s_lshl_b32 s28, s21, 10
    s_add_u32 s27, s27, s28
    s_cmp_eq_u32 s21, 0
    s_mov_b32 s32, 0x07060302
    s_cselect_b32 s32, 0x05040100, s32
    s_mov_b32 s33, 0x03020c0c
    s_cselect_b32 s33, 0x01000c0c, s33
    s_mov_b32 s35, 0x3d2aaaab
    s_mov_b32 s36, 0x3c638e39
    s_mov_b32 s25, 0xffff0000
    ds_write_b128 v96, v[64:67] offset:57344
    ds_write_b128 v97, v[68:71] offset:8192
    ds_write_b128 v97, v[72:75] offset:24576
    ds_write_b128 v96, v[48:51] offset:8192
    ds_write_b128 v96, v[52:55] offset:24576
    ds_write_b128 v96, v[56:59] offset:40960
    ds_write_b128 v98, v[60:63] offset:8704
    s_waitcnt lgkmcnt(0)
    s_barrier
    s_waitcnt vmcnt(24)
    v_perm_b32 v72, v17, v16, s32
    v_perm_b32 v48, v41, v40, s32
    v_perm_b32 v76, v76, v40, s33
    v_perm_b32 v84, v84, v41, s33
    v_perm_b32 v77, v77, v32, s33
    v_perm_b32 v85, v85, v33, s33
    v_perm_b32 v78, v78, v24, s33
    v_perm_b32 v86, v86, v25, s33
    v_perm_b32 v79, v79, v16, s33
    v_perm_b32 v87, v87, v17, s33
    v_add_f32 v80, v76, v78
    v_add_f32 v88, v84, v86
    v_add_f32 v81, v77, v79
    v_add_f32 v89, v85, v87
    v_fma_f32 v82, v78, 4.0, v76
    v_fma_f32 v90, v86, 4.0, v84
    v_fma_f32 v83, v79, 4.0, v77
    v_fma_f32 v91, v87, 4.0, v85
    v_add_f32 v77, v80, v81
    v_add_f32 v85, v88, v89
    v_sub_f32 v78, v80, v81
    v_sub_f32 v86, v88, v89
    v_fma_f32 v79, v83, 2.0, v82
    v_fma_f32 v87, v91, 2.0, v90
    v_fma_f32 v82, v83, -2.0, v82
    v_fma_f32 v90, v91, -2.0, v90
    v_fmamk_f32 v80, v76, 0x41700000, v82
    v_fmamk_f32 v88, v84, 0x41700000, v90
    v_fmamk_f32 v80, v81, 0x41200000, v80
    v_fmamk_f32 v88, v89, 0x41200000, v88
    v_mul_f32 v77, 0.5, v77
    v_mul_f32 v85, 0.5, v85
    v_mul_f32 v78, 0.5, v78
    v_mul_f32 v86, 0.5, v86
    v_mul_f32 v79, s35, v79
    v_mul_f32 v87, s35, v87
    v_mul_f32 v82, s35, v82
    v_mul_f32 v90, s35, v90
    v_mul_f32 v80, s36, v80
    v_mul_f32 v88, s36, v88
    v_cvt_pk_bf16_f32 v52, v77, v85
    v_cvt_pk_bf16_f32 v56, v78, v86
    v_cvt_pk_bf16_f32 v60, v79, v87
    v_cvt_pk_bf16_f32 v64, v82, v90
    v_cvt_pk_bf16_f32 v68, v80, v88
    s_waitcnt vmcnt(16)
    v_perm_b32 v73, v19, v18, s32
    v_perm_b32 v49, v43, v42, s32
    v_perm_b32 v76, v76, v42, s33
    v_perm_b32 v84, v84, v43, s33
    v_perm_b32 v77, v77, v34, s33
    v_perm_b32 v85, v85, v35, s33
    v_perm_b32 v78, v78, v26, s33
    v_perm_b32 v86, v86, v27, s33
    v_perm_b32 v79, v79, v18, s33
    v_perm_b32 v87, v87, v19, s33
    v_add_f32 v80, v76, v78
    v_add_f32 v88, v84, v86
    v_add_f32 v81, v77, v79
    v_add_f32 v89, v85, v87
    v_fma_f32 v82, v78, 4.0, v76
    v_fma_f32 v90, v86, 4.0, v84
    v_fma_f32 v83, v79, 4.0, v77
    v_fma_f32 v91, v87, 4.0, v85
    v_add_f32 v77, v80, v81
    v_add_f32 v85, v88, v89
    v_sub_f32 v78, v80, v81
    v_sub_f32 v86, v88, v89
    v_fma_f32 v79, v83, 2.0, v82
    v_fma_f32 v87, v91, 2.0, v90
    v_fma_f32 v82, v83, -2.0, v82
    v_fma_f32 v90, v91, -2.0, v90
    v_fmamk_f32 v80, v76, 0x41700000, v82
    v_fmamk_f32 v88, v84, 0x41700000, v90
    v_fmamk_f32 v80, v81, 0x41200000, v80
    v_fmamk_f32 v88, v89, 0x41200000, v88
    v_mul_f32 v77, 0.5, v77
    v_mul_f32 v85, 0.5, v85
    v_mul_f32 v78, 0.5, v78
    v_mul_f32 v86, 0.5, v86
    v_mul_f32 v79, s35, v79
    v_mul_f32 v87, s35, v87
    v_mul_f32 v82, s35, v82
    v_mul_f32 v90, s35, v90
    v_mul_f32 v80, s36, v80
    v_mul_f32 v88, s36, v88
    v_cvt_pk_bf16_f32 v53, v77, v85
    v_cvt_pk_bf16_f32 v57, v78, v86
    v_cvt_pk_bf16_f32 v61, v79, v87
    v_cvt_pk_bf16_f32 v65, v82, v90
    v_cvt_pk_bf16_f32 v69, v80, v88
    s_waitcnt vmcnt(8)
    v_perm_b32 v74, v21, v20, s32
    v_perm_b32 v50, v45, v44, s32
    v_perm_b32 v76, v76, v44, s33
    v_perm_b32 v84, v84, v45, s33
    v_perm_b32 v77, v77, v36, s33
    v_perm_b32 v85, v85, v37, s33
    v_perm_b32 v78, v78, v28, s33
    v_perm_b32 v86, v86, v29, s33
    v_perm_b32 v79, v79, v20, s33
    v_perm_b32 v87, v87, v21, s33
    v_add_f32 v80, v76, v78
    v_add_f32 v88, v84, v86
    v_add_f32 v81, v77, v79
    v_add_f32 v89, v85, v87
    v_fma_f32 v82, v78, 4.0, v76
    v_fma_f32 v90, v86, 4.0, v84
    v_fma_f32 v83, v79, 4.0, v77
    v_fma_f32 v91, v87, 4.0, v85
    v_add_f32 v77, v80, v81
    v_add_f32 v85, v88, v89
    v_sub_f32 v78, v80, v81
    v_sub_f32 v86, v88, v89
    v_fma_f32 v79, v83, 2.0, v82
    v_fma_f32 v87, v91, 2.0, v90
    v_fma_f32 v82, v83, -2.0, v82
    v_fma_f32 v90, v91, -2.0, v90
    v_fmamk_f32 v80, v76, 0x41700000, v82
    v_fmamk_f32 v88, v84, 0x41700000, v90
    v_fmamk_f32 v80, v81, 0x41200000, v80
    v_fmamk_f32 v88, v89, 0x41200000, v88
    v_mul_f32 v77, 0.5, v77
    v_mul_f32 v85, 0.5, v85
    v_mul_f32 v78, 0.5, v78
    v_mul_f32 v86, 0.5, v86
    v_mul_f32 v79, s35, v79
    v_mul_f32 v87, s35, v87
    v_mul_f32 v82, s35, v82
    v_mul_f32 v90, s35, v90
    v_mul_f32 v80, s36, v80
    v_mul_f32 v88, s36, v88
    v_cvt_pk_bf16_f32 v54, v77, v85
    v_cvt_pk_bf16_f32 v58, v78, v86
    v_cvt_pk_bf16_f32 v62, v79, v87
    v_cvt_pk_bf16_f32 v66, v82, v90
    v_cvt_pk_bf16_f32 v70, v80, v88
    s_waitcnt vmcnt(0)
    v_perm_b32 v75, v23, v22, s32
    v_perm_b32 v51, v47, v46, s32
    v_perm_b32 v76, v76, v46, s33
    v_perm_b32 v84, v84, v47, s33
    v_perm_b32 v77, v77, v38, s33
    v_perm_b32 v85, v85, v39, s33
    v_perm_b32 v78, v78, v30, s33
    v_perm_b32 v86, v86, v31, s33
    v_perm_b32 v79, v79, v22, s33
    v_perm_b32 v87, v87, v23, s33
    v_add_f32 v80, v76, v78
    v_add_f32 v88, v84, v86
    v_add_f32 v81, v77, v79
    v_add_f32 v89, v85, v87
    v_fma_f32 v82, v78, 4.0, v76
    v_fma_f32 v90, v86, 4.0, v84
    v_fma_f32 v83, v79, 4.0, v77
    v_fma_f32 v91, v87, 4.0, v85
    v_add_f32 v77, v80, v81
    v_add_f32 v85, v88, v89
    v_sub_f32 v78, v80, v81
    v_sub_f32 v86, v88, v89
    v_fma_f32 v79, v83, 2.0, v82
    v_fma_f32 v87, v91, 2.0, v90
    v_fma_f32 v82, v83, -2.0, v82
    v_fma_f32 v90, v91, -2.0, v90
    v_fmamk_f32 v80, v76, 0x41700000, v82
    v_fmamk_f32 v88, v84, 0x41700000, v90
    v_fmamk_f32 v80, v81, 0x41200000, v80
    v_fmamk_f32 v88, v89, 0x41200000, v88
    v_mul_f32 v77, 0.5, v77
    v_mul_f32 v85, 0.5, v85
    v_mul_f32 v78, 0.5, v78
    v_mul_f32 v86, 0.5, v86
    v_mul_f32 v79, s35, v79
    v_mul_f32 v87, s35, v87
    v_mul_f32 v82, s35, v82
    v_mul_f32 v90, s35, v90
    v_mul_f32 v80, s36, v80
    v_mul_f32 v88, s36, v88
    v_cvt_pk_bf16_f32 v55, v77, v85
    v_cvt_pk_bf16_f32 v59, v78, v86
    v_cvt_pk_bf16_f32 v63, v79, v87
    v_cvt_pk_bf16_f32 v67, v82, v90
    v_cvt_pk_bf16_f32 v71, v80, v88
    s_add_u32 s28, s27, 49152
    buffer_store_dwordx4 v[72:75], v4, s[12:15], s28 offen sc1
    s_add_u32 s28, s27, 0
    buffer_store_dwordx4 v[48:51], v4, s[12:15], s28 offen sc1
    s_add_u32 s28, s27, 8192
    buffer_store_dwordx4 v[52:55], v4, s[12:15], s28 offen sc1
    s_add_u32 s28, s27, 16384
    buffer_store_dwordx4 v[56:59], v4, s[12:15], s28 offen sc1
    s_add_u32 s28, s27, 24576
    buffer_store_dwordx4 v[60:63], v4, s[12:15], s28 offen sc1
    s_add_u32 s28, s27, 32768
    buffer_store_dwordx4 v[64:67], v4, s[12:15], s28 offen sc1
    s_add_u32 s28, s27, 40960
    buffer_store_dwordx4 v[68:71], v4, s[12:15], s28 offen sc1
    s_mov_b32 s20, s58
    s_branch L_conv1_kernel_end
L_conv1_kernel_epi:
    s_waitcnt lgkmcnt(0)
    s_barrier
    v_cndmask_b32 v122, v111, v110, vcc
    ds_read_b128 v[0:3], v120 offset:0
    ds_read_b128 v[4:7], v120 offset:16384
    ds_read_b128 v[8:11], v120 offset:32768
    ds_read_b128 v[12:15], v120 offset:49152
    ds_read_b128 v[16:19], v121 offset:0
    ds_read_b128 v[20:23], v121 offset:16384
    ds_read_b128 v[24:27], v121 offset:32768
    ds_read_b128 v[28:31], v64 offset:15360
    ds_read_b128 v[32:35], v120 offset:8192
    ds_read_b128 v[36:39], v120 offset:24576
    ds_read_b128 v[40:43], v120 offset:40960
    ds_read_b128 v[44:47], v120 offset:57344
    ds_read_b128 v[48:51], v121 offset:56320
    ds_read_b128 v[52:55], v121 offset:64512
    ds_read_b128 v[56:59], v64 offset:7168
    s_waitcnt lgkmcnt(7)
    ds_read_b128 v[60:63], v64 offset:23552
    s_waitcnt lgkmcnt(8)
    v_pk_add_f32 v[88:89], v[24:25], v[28:29]
    v_pk_add_f32 v[90:91], v[26:27], v[30:31]
    v_pk_add_f32 v[24:25], v[4:5], v[8:9]
    v_pk_add_f32 v[26:27], v[6:7], v[10:11]
    v_pk_add_f32 v[4:5], v[4:5], v[8:9] neg_lo:[0,1] neg_hi:[0,1]
    v_pk_add_f32 v[6:7], v[6:7], v[10:11] neg_lo:[0,1] neg_hi:[0,1]
    v_pk_add_f32 v[72:73], v[12:13], v[16:17]
    v_pk_add_f32 v[74:75], v[14:15], v[18:19]
    v_pk_add_f32 v[12:13], v[12:13], v[16:17] neg_lo:[0,1] neg_hi:[0,1]
    v_pk_add_f32 v[14:15], v[14:15], v[18:19] neg_lo:[0,1] neg_hi:[0,1]
    v_pk_fma_f32 v[72:73], v[24:25], s[4:5], v[72:73]
    v_pk_fma_f32 v[74:75], v[26:27], s[4:5], v[74:75]
    v_pk_fma_f32 v[20:21], v[0:1], s[10:11], v[20:21]
    v_pk_fma_f32 v[22:23], v[2:3], s[10:11], v[22:23]
    v_pk_fma_f32 v[72:73], v[0:1], s[6:7], v[72:73]
    v_pk_fma_f32 v[74:75], v[2:3], s[6:7], v[74:75]
    v_pk_add_f32 v[24:25], v[24:25], v[0:1] neg_lo:[0,1] neg_hi:[0,1]
    v_pk_add_f32 v[26:27], v[26:27], v[2:3] neg_lo:[0,1] neg_hi:[0,1]
    v_pk_fma_f32 v[72:73], v[88:89], s[8:9], v[72:73]
    v_pk_fma_f32 v[74:75], v[90:91], s[8:9], v[74:75]
    v_pk_add_f32 v[24:25], v[24:25], v[88:89] neg_lo:[0,1] neg_hi:[0,1]
    v_pk_add_f32 v[26:27], v[26:27], v[90:91] neg_lo:[0,1] neg_hi:[0,1]
    v_pk_fma_f32 v[20:21], v[88:89], s[22:23], v[20:21]
    v_pk_fma_f32 v[22:23], v[90:91], s[22:23], v[22:23]
    v_pk_add_f32 v[8:9], v[24:25], v[72:73] neg_lo:[0,1] neg_hi:[0,1]
    v_pk_add_f32 v[10:11], v[26:27], v[74:75] neg_lo:[0,1] neg_hi:[0,1]
    v_pk_fma_f32 v[20:21], v[72:73], s[14:15], v[20:21]
    v_pk_fma_f32 v[22:23], v[74:75], s[14:15], v[22:23]
    v_pk_mul_f32 v[80:81], v[12:13], s[32:33]
    v_pk_mul_f32 v[82:83], v[14:15], s[32:33]
    v_pk_fma_f32 v[20:21], v[8:9], s[12:13], v[20:21]
    v_pk_fma_f32 v[22:23], v[10:11], s[12:13], v[22:23]
    v_pk_fma_f32 v[80:81], v[4:5], s[34:35], v[80:81]
    v_pk_fma_f32 v[82:83], v[6:7], s[34:35], v[82:83]
    v_pk_fma_f32 v[64:65], v[4:5], s[24:25], v[20:21] neg_lo:[0,0,1] neg_hi:[0,0,1]
    v_pk_fma_f32 v[66:67], v[6:7], s[24:25], v[22:23] neg_lo:[0,0,1] neg_hi:[0,0,1]
    v_pk_fma_f32 v[64:65], v[12:13], s[26:27], v[64:65]
    v_pk_fma_f32 v[66:67], v[14:15], s[26:27], v[66:67]
    v_pk_fma_f32 v[80:81], v[64:65], s[38:39], v[80:81]
    v_pk_fma_f32 v[82:83], v[66:67], s[38:39], v[82:83]
    v_pk_add_f32 v[4:5], v[4:5], v[64:65] neg_lo:[0,1] neg_hi:[0,1]
    v_pk_add_f32 v[6:7], v[6:7], v[66:67] neg_lo:[0,1] neg_hi:[0,1]
    v_pk_add_f32 v[4:5], v[4:5], v[80:81] neg_lo:[0,1] neg_hi:[0,1]
    v_pk_add_f32 v[6:7], v[6:7], v[82:83] neg_lo:[0,1] neg_hi:[0,1]
    s_waitcnt lgkmcnt(0)
    v_pk_add_f32 v[92:93], v[56:57], v[60:61]
    v_pk_add_f32 v[94:95], v[58:59], v[62:63]
    v_pk_add_f32 v[56:57], v[36:37], v[40:41]
    v_pk_add_f32 v[58:59], v[38:39], v[42:43]
    v_pk_add_f32 v[36:37], v[36:37], v[40:41] neg_lo:[0,1] neg_hi:[0,1]
    v_pk_add_f32 v[38:39], v[38:39], v[42:43] neg_lo:[0,1] neg_hi:[0,1]
    v_pk_add_f32 v[76:77], v[44:45], v[48:49]
    v_pk_add_f32 v[78:79], v[46:47], v[50:51]
    v_pk_add_f32 v[44:45], v[44:45], v[48:49] neg_lo:[0,1] neg_hi:[0,1]
    v_pk_add_f32 v[46:47], v[46:47], v[50:51] neg_lo:[0,1] neg_hi:[0,1]
    v_pk_fma_f32 v[76:77], v[56:57], s[4:5], v[76:77]
    v_pk_fma_f32 v[78:79], v[58:59], s[4:5], v[78:79]
    v_pk_fma_f32 v[52:53], v[32:33], s[10:11], v[52:53]
    v_pk_fma_f32 v[54:55], v[34:35], s[10:11], v[54:55]
    v_pk_fma_f32 v[76:77], v[32:33], s[6:7], v[76:77]
    v_pk_fma_f32 v[78:79], v[34:35], s[6:7], v[78:79]
    v_pk_add_f32 v[56:57], v[56:57], v[32:33] neg_lo:[0,1] neg_hi:[0,1]
    v_pk_add_f32 v[58:59], v[58:59], v[34:35] neg_lo:[0,1] neg_hi:[0,1]
    v_pk_fma_f32 v[76:77], v[92:93], s[8:9], v[76:77]
    v_pk_fma_f32 v[78:79], v[94:95], s[8:9], v[78:79]
    v_pk_add_f32 v[56:57], v[56:57], v[92:93] neg_lo:[0,1] neg_hi:[0,1]
    v_pk_add_f32 v[58:59], v[58:59], v[94:95] neg_lo:[0,1] neg_hi:[0,1]
    v_pk_fma_f32 v[52:53], v[92:93], s[22:23], v[52:53]
    v_pk_fma_f32 v[54:55], v[94:95], s[22:23], v[54:55]
    v_pk_add_f32 v[40:41], v[56:57], v[76:77] neg_lo:[0,1] neg_hi:[0,1]
    v_pk_add_f32 v[42:43], v[58:59], v[78:79] neg_lo:[0,1] neg_hi:[0,1]
    v_pk_fma_f32 v[52:53], v[76:77], s[14:15], v[52:53]
    v_pk_fma_f32 v[54:55], v[78:79], s[14:15], v[54:55]
    v_pk_mul_f32 v[84:85], v[44:45], s[32:33]
    v_pk_mul_f32 v[86:87], v[46:47], s[32:33]
    v_pk_fma_f32 v[52:53], v[40:41], s[12:13], v[52:53]
    v_pk_fma_f32 v[54:55], v[42:43], s[12:13], v[54:55]
    v_pk_fma_f32 v[84:85], v[36:37], s[34:35], v[84:85]
    v_pk_fma_f32 v[86:87], v[38:39], s[34:35], v[86:87]
    v_pk_fma_f32 v[68:69], v[36:37], s[24:25], v[52:53] neg_lo:[0,0,1] neg_hi:[0,0,1]
    v_pk_fma_f32 v[70:71], v[38:39], s[24:25], v[54:55] neg_lo:[0,0,1] neg_hi:[0,0,1]
    v_pk_fma_f32 v[68:69], v[44:45], s[26:27], v[68:69]
    v_pk_fma_f32 v[70:71], v[46:47], s[26:27], v[70:71]
    v_pk_fma_f32 v[84:85], v[68:69], s[38:39], v[84:85]
    v_pk_fma_f32 v[86:87], v[70:71], s[38:39], v[86:87]
    v_pk_add_f32 v[36:37], v[36:37], v[68:69] neg_lo:[0,1] neg_hi:[0,1]
    v_pk_add_f32 v[38:39], v[38:39], v[70:71] neg_lo:[0,1] neg_hi:[0,1]
    v_pk_add_f32 v[36:37], v[36:37], v[84:85] neg_lo:[0,1] neg_hi:[0,1]
    v_pk_add_f32 v[38:39], v[38:39], v[86:87] neg_lo:[0,1] neg_hi:[0,1]
    s_mov_b32 s36, 0x00010001
    s_mov_b32 s37, 0x00010001
    s_mov_b64 exec, s[36:37]
    ds_write_b128 v127, v[0:3] offset:0
    ds_write_b128 v127, v[32:35] offset:16
    ds_write_b128 v127, v[4:7] offset:32
    ds_write_b128 v127, v[36:39] offset:48
    ds_write_b128 v127, v[8:11] offset:64
    ds_write_b128 v127, v[40:43] offset:80
    s_mov_b64 exec, -1
    v_mov_b32 v44, 0xc0135761
    v_mov_b32 v45, v44
    v_pk_mul_f32 v[16:17], v[64:65], v[64:65]
    v_pk_mul_f32 v[18:19], v[66:67], v[66:67]
    v_pk_mul_f32 v[20:21], v[68:69], v[68:69]
    v_pk_mul_f32 v[22:23], v[70:71], v[70:71]
    v_pk_fma_f32 v[16:17], v[16:17], s[40:41], v[44:45]
    v_pk_fma_f32 v[18:19], v[18:19], s[40:41], v[44:45]
    v_pk_fma_f32 v[20:21], v[20:21], s[40:41], v[44:45]
    v_pk_fma_f32 v[22:23], v[22:23], s[40:41], v[44:45]
    v_pk_mul_f32 v[16:17], v[16:17], v[64:65]
    v_pk_mul_f32 v[18:19], v[18:19], v[66:67]
    v_pk_mul_f32 v[20:21], v[20:21], v[68:69]
    v_pk_mul_f32 v[22:23], v[22:23], v[70:71]
    v_exp_f32 v16, v16
    v_exp_f32 v17, v17
    v_exp_f32 v18, v18
    v_exp_f32 v19, v19
    v_exp_f32 v20, v20
    v_exp_f32 v21, v21
    v_exp_f32 v22, v22
    v_exp_f32 v23, v23
    v_pk_add_f32 v[16:17], v[16:17], s[42:43]
    v_pk_add_f32 v[18:19], v[18:19], s[42:43]
    v_pk_add_f32 v[20:21], v[20:21], s[42:43]
    v_pk_add_f32 v[22:23], v[22:23], s[42:43]
    v_rcp_f32 v16, v16
    v_rcp_f32 v17, v17
    v_rcp_f32 v18, v18
    v_rcp_f32 v19, v19
    v_rcp_f32 v20, v20
    v_rcp_f32 v21, v21
    v_rcp_f32 v22, v22
    v_rcp_f32 v23, v23
    v_pk_mul_f32 v[64:65], v[64:65], v[16:17]
    v_pk_mul_f32 v[66:67], v[66:67], v[18:19]
    v_pk_mul_f32 v[68:69], v[68:69], v[20:21]
    v_pk_mul_f32 v[70:71], v[70:71], v[22:23]
    v_cvt_pk_bf16_f32 v48, v64, v68
    v_cvt_pk_bf16_f32 v49, v65, v69
    v_cvt_pk_bf16_f32 v50, v66, v70
    v_cvt_pk_bf16_f32 v51, v67, v71
    s_mov_b32 s44, 393280
    buffer_store_dwordx4 v[48:51], v122, s[16:19], s44 offen sc1
    s_waitcnt lgkmcnt(0)
    s_barrier
    ds_read_b128 v[96:99], v127 offset:512
    ds_read_b128 v[100:103], v127 offset:528
    ds_read_b128 v[104:107], v127 offset:544
    ds_read_b128 v[108:111], v127 offset:560
    ds_read_b128 v[112:115], v127 offset:576
    ds_read_b128 v[116:119], v127 offset:592
    s_waitcnt lgkmcnt(4)
    v_mov_b32_dpp v96, v0 row_shl:1 row_mask:0xf bank_mask:0xf
    v_mov_b32_dpp v97, v1 row_shl:1 row_mask:0xf bank_mask:0xf
    v_mov_b32_dpp v98, v2 row_shl:1 row_mask:0xf bank_mask:0xf
    v_mov_b32_dpp v99, v3 row_shl:1 row_mask:0xf bank_mask:0xf
    v_mov_b32_dpp v100, v32 row_shl:1 row_mask:0xf bank_mask:0xf
    v_mov_b32_dpp v101, v33 row_shl:1 row_mask:0xf bank_mask:0xf
    v_mov_b32_dpp v102, v34 row_shl:1 row_mask:0xf bank_mask:0xf
    v_mov_b32_dpp v103, v35 row_shl:1 row_mask:0xf bank_mask:0xf
    v_pk_add_f32 v[72:73], v[72:73], v[96:97]
    v_pk_add_f32 v[74:75], v[74:75], v[98:99]
    v_pk_add_f32 v[76:77], v[76:77], v[100:101]
    v_pk_add_f32 v[78:79], v[78:79], v[102:103]
    v_pk_mul_f32 v[24:25], v[72:73], v[72:73]
    v_pk_mul_f32 v[26:27], v[74:75], v[74:75]
    v_pk_mul_f32 v[28:29], v[76:77], v[76:77]
    v_pk_mul_f32 v[30:31], v[78:79], v[78:79]
    v_pk_fma_f32 v[24:25], v[24:25], s[40:41], v[44:45]
    v_pk_fma_f32 v[26:27], v[26:27], s[40:41], v[44:45]
    v_pk_fma_f32 v[28:29], v[28:29], s[40:41], v[44:45]
    v_pk_fma_f32 v[30:31], v[30:31], s[40:41], v[44:45]
    v_pk_mul_f32 v[24:25], v[24:25], v[72:73]
    v_pk_mul_f32 v[26:27], v[26:27], v[74:75]
    v_pk_mul_f32 v[28:29], v[28:29], v[76:77]
    v_pk_mul_f32 v[30:31], v[30:31], v[78:79]
    v_exp_f32 v24, v24
    v_exp_f32 v25, v25
    v_exp_f32 v26, v26
    v_exp_f32 v27, v27
    v_exp_f32 v28, v28
    v_exp_f32 v29, v29
    v_exp_f32 v30, v30
    v_exp_f32 v31, v31
    v_pk_add_f32 v[24:25], v[24:25], s[42:43]
    v_pk_add_f32 v[26:27], v[26:27], s[42:43]
    v_pk_add_f32 v[28:29], v[28:29], s[42:43]
    v_pk_add_f32 v[30:31], v[30:31], s[42:43]
    v_rcp_f32 v24, v24
    v_rcp_f32 v25, v25
    v_rcp_f32 v26, v26
    v_rcp_f32 v27, v27
    v_rcp_f32 v28, v28
    v_rcp_f32 v29, v29
    v_rcp_f32 v30, v30
    v_rcp_f32 v31, v31
    v_pk_mul_f32 v[72:73], v[72:73], v[24:25]
    v_pk_mul_f32 v[74:75], v[74:75], v[26:27]
    v_pk_mul_f32 v[76:77], v[76:77], v[28:29]
    v_pk_mul_f32 v[78:79], v[78:79], v[30:31]
    v_cvt_pk_bf16_f32 v52, v72, v76
    v_cvt_pk_bf16_f32 v53, v73, v77
    v_cvt_pk_bf16_f32 v54, v74, v78
    v_cvt_pk_bf16_f32 v55, v75, v79
    s_mov_b32 s44, 128
    buffer_store_dwordx4 v[52:55], v122, s[16:19], s44 offen sc1
    s_waitcnt lgkmcnt(2)
    v_mov_b32_dpp v104, v4 row_shl:1 row_mask:0xf bank_mask:0xf
    v_mov_b32_dpp v105, v5 row_shl:1 row_mask:0xf bank_mask:0xf
    v_mov_b32_dpp v106, v6 row_shl:1 row_mask:0xf bank_mask:0xf
    v_mov_b32_dpp v107, v7 row_shl:1 row_mask:0xf bank_mask:0xf
    v_mov_b32_dpp v108, v36 row_shl:1 row_mask:0xf bank_mask:0xf
    v_mov_b32_dpp v109, v37 row_shl:1 row_mask:0xf bank_mask:0xf
    v_mov_b32_dpp v110, v38 row_shl:1 row_mask:0xf bank_mask:0xf
    v_mov_b32_dpp v111, v39 row_shl:1 row_mask:0xf bank_mask:0xf
    v_pk_add_f32 v[80:81], v[80:81], v[104:105]
    v_pk_add_f32 v[82:83], v[82:83], v[106:107]
    v_pk_add_f32 v[84:85], v[84:85], v[108:109]
    v_pk_add_f32 v[86:87], v[86:87], v[110:111]
    v_pk_mul_f32 v[16:17], v[80:81], v[80:81]
    v_pk_mul_f32 v[18:19], v[82:83], v[82:83]
    v_pk_mul_f32 v[20:21], v[84:85], v[84:85]
    v_pk_mul_f32 v[22:23], v[86:87], v[86:87]
    v_pk_fma_f32 v[16:17], v[16:17], s[40:41], v[44:45]
    v_pk_fma_f32 v[18:19], v[18:19], s[40:41], v[44:45]
    v_pk_fma_f32 v[20:21], v[20:21], s[40:41], v[44:45]
    v_pk_fma_f32 v[22:23], v[22:23], s[40:41], v[44:45]
    v_pk_mul_f32 v[16:17], v[16:17], v[80:81]
    v_pk_mul_f32 v[18:19], v[18:19], v[82:83]
    v_pk_mul_f32 v[20:21], v[20:21], v[84:85]
    v_pk_mul_f32 v[22:23], v[22:23], v[86:87]
    v_exp_f32 v16, v16
    v_exp_f32 v17, v17
    v_exp_f32 v18, v18
    v_exp_f32 v19, v19
    v_exp_f32 v20, v20
    v_exp_f32 v21, v21
    v_exp_f32 v22, v22
    v_exp_f32 v23, v23
    v_pk_add_f32 v[16:17], v[16:17], s[42:43]
    v_pk_add_f32 v[18:19], v[18:19], s[42:43]
    v_pk_add_f32 v[20:21], v[20:21], s[42:43]
    v_pk_add_f32 v[22:23], v[22:23], s[42:43]
    v_rcp_f32 v16, v16
    v_rcp_f32 v17, v17
    v_rcp_f32 v18, v18
    v_rcp_f32 v19, v19
    v_rcp_f32 v20, v20
    v_rcp_f32 v21, v21
    v_rcp_f32 v22, v22
    v_rcp_f32 v23, v23
    v_pk_mul_f32 v[80:81], v[80:81], v[16:17]
    v_pk_mul_f32 v[82:83], v[82:83], v[18:19]
    v_pk_mul_f32 v[84:85], v[84:85], v[20:21]
    v_pk_mul_f32 v[86:87], v[86:87], v[22:23]
    v_cvt_pk_bf16_f32 v56, v80, v84
    v_cvt_pk_bf16_f32 v57, v81, v85
    v_cvt_pk_bf16_f32 v58, v82, v86
    v_cvt_pk_bf16_f32 v59, v83, v87
    s_mov_b32 s44, 131200
    buffer_store_dwordx4 v[56:59], v122, s[16:19], s44 offen sc1
    s_waitcnt lgkmcnt(0)
    v_mov_b32_dpp v112, v8 row_shl:1 row_mask:0xf bank_mask:0xf
    v_mov_b32_dpp v113, v9 row_shl:1 row_mask:0xf bank_mask:0xf
    v_mov_b32_dpp v114, v10 row_shl:1 row_mask:0xf bank_mask:0xf
    v_mov_b32_dpp v115, v11 row_shl:1 row_mask:0xf bank_mask:0xf
    v_mov_b32_dpp v116, v40 row_shl:1 row_mask:0xf bank_mask:0xf
    v_mov_b32_dpp v117, v41 row_shl:1 row_mask:0xf bank_mask:0xf
    v_mov_b32_dpp v118, v42 row_shl:1 row_mask:0xf bank_mask:0xf
    v_mov_b32_dpp v119, v43 row_shl:1 row_mask:0xf bank_mask:0xf
    v_pk_add_f32 v[88:89], v[88:89], v[112:113]
    v_pk_add_f32 v[90:91], v[90:91], v[114:115]
    v_pk_add_f32 v[92:93], v[92:93], v[116:117]
    v_pk_add_f32 v[94:95], v[94:95], v[118:119]
    v_pk_mul_f32 v[24:25], v[88:89], v[88:89]
    v_pk_mul_f32 v[26:27], v[90:91], v[90:91]
    v_pk_mul_f32 v[28:29], v[92:93], v[92:93]
    v_pk_mul_f32 v[30:31], v[94:95], v[94:95]
    v_pk_fma_f32 v[24:25], v[24:25], s[40:41], v[44:45]
    v_pk_fma_f32 v[26:27], v[26:27], s[40:41], v[44:45]
    v_pk_fma_f32 v[28:29], v[28:29], s[40:41], v[44:45]
    v_pk_fma_f32 v[30:31], v[30:31], s[40:41], v[44:45]
    v_pk_mul_f32 v[24:25], v[24:25], v[88:89]
    v_pk_mul_f32 v[26:27], v[26:27], v[90:91]
    v_pk_mul_f32 v[28:29], v[28:29], v[92:93]
    v_pk_mul_f32 v[30:31], v[30:31], v[94:95]
    v_exp_f32 v24, v24
    v_exp_f32 v25, v25
    v_exp_f32 v26, v26
    v_exp_f32 v27, v27
    v_exp_f32 v28, v28
    v_exp_f32 v29, v29
    v_exp_f32 v30, v30
    v_exp_f32 v31, v31
    v_pk_add_f32 v[24:25], v[24:25], s[42:43]
    v_pk_add_f32 v[26:27], v[26:27], s[42:43]
    v_pk_add_f32 v[28:29], v[28:29], s[42:43]
    v_pk_add_f32 v[30:31], v[30:31], s[42:43]
    v_rcp_f32 v24, v24
    v_rcp_f32 v25, v25
    v_rcp_f32 v26, v26
    v_rcp_f32 v27, v27
    v_rcp_f32 v28, v28
    v_rcp_f32 v29, v29
    v_rcp_f32 v30, v30
    v_rcp_f32 v31, v31
    v_pk_mul_f32 v[88:89], v[88:89], v[24:25]
    v_pk_mul_f32 v[90:91], v[90:91], v[26:27]
    v_pk_mul_f32 v[92:93], v[92:93], v[28:29]
    v_pk_mul_f32 v[94:95], v[94:95], v[30:31]
    v_cvt_pk_bf16_f32 v60, v88, v92
    v_cvt_pk_bf16_f32 v61, v89, v93
    v_cvt_pk_bf16_f32 v62, v90, v94
    v_cvt_pk_bf16_f32 v63, v91, v95
    s_mov_b32 s44, 262272
    buffer_store_dwordx4 v[60:63], v122, s[16:19], s44 offen sc1
L_conv1_kernel_end:
L_conv1_kernel_done:
    s_endpgm
.globl conv2_kernel
.p2align 8
.type conv2_kernel,@function
conv2_kernel:
    s_cmp_ge_u32 s2, 256
    s_cbranch_scc1 L_conv2_kernel_done
    s_load_dwordx2 s[4:5], s[0:1], 72
    s_load_dwordx2 s[30:31], s[0:1], 72
    v_readfirstlane_b32 s20, v0
    s_lshr_b32 s20, s20, 6
    s_xor_b32 s20, s20, 8
    s_and_b32 s36, s2, 0
    s_lshl_b32 s36, s36, 3
    s_bfe_u32 s37, s2, 196611
    s_or_b32 s29, s36, s37
    s_bfe_u32 s36, s2, 196608
    s_lshl_b32 s36, s36, 2
    s_lshr_b32 s37, s2, 6
    s_or_b32 s36, s36, s37
    s_lshr_b32 s33, s36, 4
    s_and_b32 s34, s36, 7
    s_bfe_u32 s35, s36, 0x10003
    s_mul_i32 s21, s34, 500
    s_and_b32 s32, s20, 3
    v_and_b32 v127, 63, v0
    v_lshrrev_b32 v5, 2, v127
    v_and_b32 v6, 3, v127
    s_and_b32 s42, s20, 7
    s_lshr_b32 s41, s21, 2
    s_sub_u32 s41, s41, 1
    s_add_u32 s37, s41, s42
    v_lshl_add_u32 v7, v5, 3, s37
    s_mul_i32 s36, s35, 4194304
    s_add_u32 s36, s36, 18874368
    s_mov_b32 s10, 4194304
    s_mov_b32 s11, 0x00020000
    s_mov_b32 s25, 0xffff0000
    s_mov_b32 s47, s36
    s_cmp_ge_u32 s20, 8
    s_cbranch_scc1 L_conv2_kernel_helper
    s_add_u32 s37, s41, 128
    v_mov_b32 v16, s37
    v_mul_u32_u24 v17, 524288, v5
    v_lshl_add_u32 v17, v6, 4, v17
    s_add_u32 s37, s33, 4294967289
    v_lshl_add_u32 v18, v16, 3, s37
    v_cmp_gt_u32 vcc, 8000, v18
    s_mul_i32 s37, s33, 131072
    s_add_u32 s37, s37, 0
    v_lshl_add_u32 v108, v16, 7, s37
    v_add_u32 v108, v108, v17
    v_mov_b32 v18, 2130706432
    v_cndmask_b32 v108, v18, v108, vcc
    s_add_u32 s37, s33, 4294967291
    v_lshl_add_u32 v18, v16, 3, s37
    v_cmp_gt_u32 vcc, 8000, v18
    s_mul_i32 s37, s33, 131072
    s_add_u32 s37, s37, 262144
    v_lshl_add_u32 v109, v16, 7, s37
    v_add_u32 v109, v109, v17
    v_mov_b32 v18, 2130706432
    v_cndmask_b32 v109, v18, v109, vcc
    s_add_u32 s37, s33, 4294967293
    v_lshl_add_u32 v18, v16, 3, s37
    v_cmp_gt_u32 vcc, 8000, v18
    s_mul_i32 s37, s33, 131072
    s_add_u32 s37, s37, 64
    v_lshl_add_u32 v110, v16, 7, s37
    v_add_u32 v110, v110, v17
    v_mov_b32 v18, 2130706432
    v_cndmask_b32 v110, v18, v110, vcc
    s_waitcnt lgkmcnt(0)
    s_add_u32 s8, s4, s47
    s_addc_u32 s9, s5, 0
    s_lshl_b32 s36, s29, 4
    s_lshl_b32 s37, s33, 3
    s_add_u32 s36, s36, s37
    s_mul_i32 s36, s36, 57344
    s_add_u32 s36, s36, 9437184
    s_add_u32 s12, s30, s36
    s_addc_u32 s13, s31, 0
    s_mov_b32 s14, 458752
    s_mov_b32 s15, 0x00020000
    s_mul_i32 s36, s35, 2097152
    s_add_u32 s36, s36, 27262976
    s_mul_i32 s37, s33, 8388608
    s_add_u32 s36, s36, s37
    s_add_u32 s16, s30, s36
    s_addc_u32 s17, s31, 0
    s_mov_b32 s18, 2097152
    s_mov_b32 s19, 0x00020000
    v_and_b32 v10, 15, v127
    v_lshrrev_b32 v11, 4, v127
    v_add_u32 v8, 0, v10
    v_and_b32 v16, 4, v8
    v_lshrrev_b32 v16, 1, v16
    v_xor_b32 v16, v11, v16
    v_lshlrev_b32 v16, 4, v16
    v_lshl_add_u32 v8, v8, 6, v16
    v_add_u32 v9, 1, v10
    v_and_b32 v16, 4, v9
    v_lshrrev_b32 v16, 1, v16
    v_xor_b32 v16, v11, v16
    v_lshlrev_b32 v16, 4, v16
    v_lshl_add_u32 v9, v9, 6, v16
    s_lshr_b32 s38, s32, 1
    s_and_b32 s39, s32, 1
    s_add_u32 s40, s38, 4
    s_lshl_b32 s43, s39, 10
    s_cmp_lt_u32 s20, 4
    s_cselect_b32 s40, s20, s40
    s_cselect_b32 s36, 0, s43
    s_lshl_b32 s37, s40, 13
    s_add_u32 s37, s37, s36
    v_lshl_add_u32 v125, v127, 4, s37
    s_mul_i32 s37, s40, 16384
    v_add_u32 v120, s37, v8
    v_add_u32 v121, s37, v9
    s_lshl_b32 s37, s40, 10
    s_add_u32 s37, s37, 115712
    v_lshl_add_u32 v16, v11, 4, s37
    v_cmp_eq_u32 vcc, 15, v10
    v_mov_b32 v17, 8192
    v_mov_b32 v18, 4294959104
    v_mov_b32 v19, 64
    v_cndmask_b32 v122, v121, v16, vcc
    v_cndmask_b32 v123, v17, v19, vcc
    v_cndmask_b32 v124, v18, v19, vcc
    v_lshl_add_u32 v126, v127, 4, s37
    s_mov_b32 s44, 0x3f800000
    s_mov_b32 s45, 0x00000000
    s_mov_b32 s46, 0x00000000
    s_cmp_eq_u32 s40, 1
    s_cselect_b32 s45, 0x3f800000, s45
    s_cselect_b32 s46, 0x3f800000, s46
    s_cmp_eq_u32 s40, 2
    s_cselect_b32 s45, 0xbf800000, s45
    s_cselect_b32 s46, 0x3f800000, s46
    s_cmp_eq_u32 s40, 3
    s_cselect_b32 s45, 0x40000000, s45
    s_cselect_b32 s46, 0x40800000, s46
    s_cmp_eq_u32 s40, 4
    s_cselect_b32 s45, 0xc0000000, s45
    s_cselect_b32 s46, 0x40800000, s46
    s_cmp_eq_u32 s40, 5
    s_cselect_b32 s44, 0x41800000, s44
    s_cselect_b32 s45, 0x41000000, s45
    s_cselect_b32 s46, 0x40800000, s46
    s_cmp_ge_u32 s20, 4
    s_cbranch_scc1 L_conv2_kernel_m2
    v_mov_b32 v0, 0
    v_mov_b32 v1, 0
    v_mov_b32 v2, 0
    v_mov_b32 v3, 0
    v_mov_b32 v4, 0
    v_mov_b32 v5, 0
    v_mov_b32 v6, 0
    v_mov_b32 v7, 0
    v_mov_b32 v8, 0
    v_mov_b32 v9, 0
    v_mov_b32 v10, 0
    v_mov_b32 v11, 0
    v_mov_b32 v12, 0
    v_mov_b32 v13, 0
    v_mov_b32 v14, 0
    v_mov_b32 v15, 0
    v_mov_b32 v16, 0
    v_mov_b32 v17, 0
    v_mov_b32 v18, 0
    v_mov_b32 v19, 0
    v_mov_b32 v20, 0
    v_mov_b32 v21, 0
    v_mov_b32 v22, 0
    v_mov_b32 v23, 0
    v_mov_b32 v24, 0
    v_mov_b32 v25, 0
    v_mov_b32 v26, 0
    v_mov_b32 v27, 0
    v_mov_b32 v28, 0
    v_mov_b32 v29, 0
    v_mov_b32 v30, 0
    v_mov_b32 v31, 0
    v_mov_b32 v32, 0
    v_mov_b32 v33, 0
    v_mov_b32 v34, 0
    v_mov_b32 v35, 0
    v_mov_b32 v36, 0
    v_mov_b32 v37, 0
    v_mov_b32 v38, 0
    v_mov_b32 v39, 0
    v_mov_b32 v40, 0
    v_mov_b32 v41, 0
    v_mov_b32 v42, 0
    v_mov_b32 v43, 0
    v_mov_b32 v44, 0
    v_mov_b32 v45, 0
    v_mov_b32 v46, 0
    v_mov_b32 v47, 0
    v_mov_b32 v48, 0
    v_mov_b32 v49, 0
    v_mov_b32 v50, 0
    v_mov_b32 v51, 0
    v_mov_b32 v52, 0
    v_mov_b32 v53, 0
    v_mov_b32 v54, 0
    v_mov_b32 v55, 0
    v_mov_b32 v56, 0
    v_mov_b32 v57, 0
    v_mov_b32 v58, 0
    v_mov_b32 v59, 0
    v_mov_b32 v60, 0
    v_mov_b32 v61, 0
    v_mov_b32 v62, 0
    v_mov_b32 v63, 0
    buffer_load_dwordx4 v[96:99], v108, s[8:11], 0 offen
    buffer_load_dwordx4 v[100:103], v109, s[8:11], 0 offen
    buffer_load_dwordx4 v[104:107], v110, s[8:11], 0 offen
    s_mov_b32 s23, 0
    s_mov_b32 s26, 4096
    buffer_load_dwordx4 v[64:67], v125, s[12:15], s23 offen offset:0
    buffer_load_dwordx4 v[68:71], v125, s[12:15], s23 offen offset:1024
    buffer_load_dwordx4 v[72:75], v125, s[12:15], s23 offen offset:2048
    buffer_load_dwordx4 v[76:79], v125, s[12:15], s23 offen offset:3072
    buffer_load_dwordx4 v[80:83], v125, s[12:15], s26 offen offset:0
    buffer_load_dwordx4 v[84:87], v125, s[12:15], s26 offen offset:1024
    buffer_load_dwordx4 v[88:91], v125, s[12:15], s26 offen offset:2048
    buffer_load_dwordx4 v[92:95], v125, s[12:15], s26 offen offset:3072
    s_mov_b32 s23, 57344
    s_mov_b32 s26, 61440
    s_waitcnt vmcnt(8)
    v_lshlrev_b32 v108, 16, v96
    v_and_b32 v111, s25, v96
    v_lshlrev_b32 v109, 16, v100
    v_and_b32 v112, s25, v100
    v_lshlrev_b32 v110, 16, v104
    v_and_b32 v113, s25, v104
    v_mul_f32 v114, s44, v108
    v_mul_f32 v115, s44, v111
    v_fmac_f32 v114, s45, v109
    v_fmac_f32 v115, s45, v112
    v_fmac_f32 v114, s46, v110
    v_fmac_f32 v115, s46, v113
    v_cvt_pk_bf16_f32 v96, v114, v115
    v_lshlrev_b32 v108, 16, v97
    v_and_b32 v111, s25, v97
    v_lshlrev_b32 v109, 16, v101
    v_and_b32 v112, s25, v101
    v_lshlrev_b32 v110, 16, v105
    v_and_b32 v113, s25, v105
    v_mul_f32 v114, s44, v108
    v_mul_f32 v115, s44, v111
    v_fmac_f32 v114, s45, v109
    v_fmac_f32 v115, s45, v112
    v_fmac_f32 v114, s46, v110
    v_fmac_f32 v115, s46, v113
    v_cvt_pk_bf16_f32 v97, v114, v115
    v_lshlrev_b32 v108, 16, v98
    v_and_b32 v111, s25, v98
    v_lshlrev_b32 v109, 16, v102
    v_and_b32 v112, s25, v102
    v_lshlrev_b32 v110, 16, v106
    v_and_b32 v113, s25, v106
    v_mul_f32 v114, s44, v108
    v_mul_f32 v115, s44, v111
    v_fmac_f32 v114, s45, v109
    v_fmac_f32 v115, s45, v112
    v_fmac_f32 v114, s46, v110
    v_fmac_f32 v115, s46, v113
    v_cvt_pk_bf16_f32 v98, v114, v115
    v_lshlrev_b32 v108, 16, v99
    v_and_b32 v111, s25, v99
    v_lshlrev_b32 v109, 16, v103
    v_and_b32 v112, s25, v103
    v_lshlrev_b32 v110, 16, v107
    v_and_b32 v113, s25, v107
    v_mul_f32 v114, s44, v108
    v_mul_f32 v115, s44, v111
    v_fmac_f32 v114, s45, v109
    v_fmac_f32 v115, s45, v112
    v_fmac_f32 v114, s46, v110
    v_fmac_f32 v115, s46, v113
    v_cvt_pk_bf16_f32 v99, v114, v115
    ds_write_b128 v126, v[96:99]
    s_waitcnt lgkmcnt(0)
    s_barrier
    s_mov_b32 s22, 4
    s_setprio 2
L_conv2_kernel_mloop1:
    ds_read_b128 v[96:99], v120 offset:0
    ds_read_b128 v[100:103], v120 offset:1024
    ds_read_b128 v[104:107], v120 offset:2048
    ds_read_b128 v[108:111], v120 offset:3072
    ds_read_b128 v[112:115], v120 offset:4096
    ds_read_b128 v[116:119], v120 offset:5120
    s_waitcnt vmcnt(6) lgkmcnt(5)
    v_mfma_f32_16x16x32_bf16 v[0:3], v[64:67], v[96:99], v[0:3]
    v_mfma_f32_16x16x32_bf16 v[32:35], v[68:71], v[96:99], v[32:35]
    ds_read_b128 v[96:99], v120 offset:6144
    s_waitcnt vmcnt(4) lgkmcnt(5)
    v_mfma_f32_16x16x32_bf16 v[4:7], v[64:67], v[100:103], v[4:7]
    v_mfma_f32_16x16x32_bf16 v[36:39], v[68:71], v[100:103], v[36:39]
    v_mfma_f32_16x16x32_bf16 v[0:3], v[72:75], v[100:103], v[0:3]
    v_mfma_f32_16x16x32_bf16 v[32:35], v[76:79], v[100:103], v[32:35]
    ds_read_b128 v[100:103], v120 offset:7168
    s_waitcnt vmcnt(2) lgkmcnt(5)
    v_mfma_f32_16x16x32_bf16 v[8:11], v[64:67], v[104:107], v[8:11]
    v_mfma_f32_16x16x32_bf16 v[40:43], v[68:71], v[104:107], v[40:43]
    v_mfma_f32_16x16x32_bf16 v[4:7], v[72:75], v[104:107], v[4:7]
    v_mfma_f32_16x16x32_bf16 v[36:39], v[76:79], v[104:107], v[36:39]
    v_mfma_f32_16x16x32_bf16 v[0:3], v[80:83], v[104:107], v[0:3]
    v_mfma_f32_16x16x32_bf16 v[32:35], v[84:87], v[104:107], v[32:35]
    ds_read_b128 v[104:107], v122 offset:0
    v_add_u32 v122, v123, v122
    s_waitcnt vmcnt(0) lgkmcnt(5)
    v_mfma_f32_16x16x32_bf16 v[12:15], v[64:67], v[108:111], v[12:15]
    v_mfma_f32_16x16x32_bf16 v[44:47], v[68:71], v[108:111], v[44:47]
    v_mfma_f32_16x16x32_bf16 v[8:11], v[72:75], v[108:111], v[8:11]
    v_mfma_f32_16x16x32_bf16 v[40:43], v[76:79], v[108:111], v[40:43]
    v_mfma_f32_16x16x32_bf16 v[4:7], v[80:83], v[108:111], v[4:7]
    v_mfma_f32_16x16x32_bf16 v[36:39], v[84:87], v[108:111], v[36:39]
    v_mfma_f32_16x16x32_bf16 v[0:3], v[88:91], v[108:111], v[0:3]
    v_mfma_f32_16x16x32_bf16 v[32:35], v[92:95], v[108:111], v[32:35]
    ds_read_b128 v[108:111], v121 offset:1024
    s_waitcnt lgkmcnt(5)
    v_mfma_f32_16x16x32_bf16 v[16:19], v[64:67], v[112:115], v[16:19]
    v_mfma_f32_16x16x32_bf16 v[48:51], v[68:71], v[112:115], v[48:51]
    v_mfma_f32_16x16x32_bf16 v[12:15], v[72:75], v[112:115], v[12:15]
    v_mfma_f32_16x16x32_bf16 v[44:47], v[76:79], v[112:115], v[44:47]
    v_mfma_f32_16x16x32_bf16 v[8:11], v[80:83], v[112:115], v[8:11]
    v_mfma_f32_16x16x32_bf16 v[40:43], v[84:87], v[112:115], v[40:43]
    v_mfma_f32_16x16x32_bf16 v[4:7], v[88:91], v[112:115], v[4:7]
    v_mfma_f32_16x16x32_bf16 v[36:39], v[92:95], v[112:115], v[36:39]
    ds_read_b128 v[112:115], v121 offset:2048
    s_waitcnt lgkmcnt(5)
    v_mfma_f32_16x16x32_bf16 v[20:23], v[64:67], v[116:119], v[20:23]
    v_mfma_f32_16x16x32_bf16 v[52:55], v[68:71], v[116:119], v[52:55]
    v_mfma_f32_16x16x32_bf16 v[16:19], v[72:75], v[116:119], v[16:19]
    v_mfma_f32_16x16x32_bf16 v[48:51], v[76:79], v[116:119], v[48:51]
    v_mfma_f32_16x16x32_bf16 v[12:15], v[80:83], v[116:119], v[12:15]
    v_mfma_f32_16x16x32_bf16 v[44:47], v[84:87], v[116:119], v[44:47]
    v_mfma_f32_16x16x32_bf16 v[8:11], v[88:91], v[116:119], v[8:11]
    v_mfma_f32_16x16x32_bf16 v[40:43], v[92:95], v[116:119], v[40:43]
    s_waitcnt lgkmcnt(4)
    v_mfma_f32_16x16x32_bf16 v[24:27], v[64:67], v[96:99], v[24:27]
    v_mfma_f32_16x16x32_bf16 v[56:59], v[68:71], v[96:99], v[56:59]
    v_mfma_f32_16x16x32_bf16 v[20:23], v[72:75], v[96:99], v[20:23]
    v_mfma_f32_16x16x32_bf16 v[52:55], v[76:79], v[96:99], v[52:55]
    v_mfma_f32_16x16x32_bf16 v[16:19], v[80:83], v[96:99], v[16:19]
    v_mfma_f32_16x16x32_bf16 v[48:51], v[84:87], v[96:99], v[48:51]
    v_mfma_f32_16x16x32_bf16 v[12:15], v[88:91], v[96:99], v[12:15]
    v_mfma_f32_16x16x32_bf16 v[44:47], v[92:95], v[96:99], v[44:47]
    s_waitcnt lgkmcnt(3)
    v_mfma_f32_16x16x32_bf16 v[28:31], v[64:67], v[100:103], v[28:31]
    v_mfma_f32_16x16x32_bf16 v[60:63], v[68:71], v[100:103], v[60:63]
    v_mfma_f32_16x16x32_bf16 v[24:27], v[72:75], v[100:103], v[24:27]
    v_mfma_f32_16x16x32_bf16 v[56:59], v[76:79], v[100:103], v[56:59]
    v_mfma_f32_16x16x32_bf16 v[20:23], v[80:83], v[100:103], v[20:23]
    v_mfma_f32_16x16x32_bf16 v[52:55], v[84:87], v[100:103], v[52:55]
    v_mfma_f32_16x16x32_bf16 v[16:19], v[88:91], v[100:103], v[16:19]
    v_mfma_f32_16x16x32_bf16 v[48:51], v[92:95], v[100:103], v[48:51]
    buffer_load_dwordx4 v[64:67], v125, s[12:15], s23 offen offset:0
    buffer_load_dwordx4 v[68:71], v125, s[12:15], s23 offen offset:1024
    s_waitcnt lgkmcnt(2)
    v_mfma_f32_16x16x32_bf16 v[28:31], v[72:75], v[104:107], v[28:31]
    v_mfma_f32_16x16x32_bf16 v[60:63], v[76:79], v[104:107], v[60:63]
    v_mfma_f32_16x16x32_bf16 v[24:27], v[80:83], v[104:107], v[24:27]
    v_mfma_f32_16x16x32_bf16 v[56:59], v[84:87], v[104:107], v[56:59]
    v_mfma_f32_16x16x32_bf16 v[20:23], v[88:91], v[104:107], v[20:23]
    v_mfma_f32_16x16x32_bf16 v[52:55], v[92:95], v[104:107], v[52:55]
    buffer_load_dwordx4 v[72:75], v125, s[12:15], s23 offen offset:2048
    buffer_load_dwordx4 v[76:79], v125, s[12:15], s23 offen offset:3072
    s_waitcnt lgkmcnt(1)
    v_mfma_f32_16x16x32_bf16 v[28:31], v[80:83], v[108:111], v[28:31]
    v_mfma_f32_16x16x32_bf16 v[60:63], v[84:87], v[108:111], v[60:63]
    v_mfma_f32_16x16x32_bf16 v[24:27], v[88:91], v[108:111], v[24:27]
    v_mfma_f32_16x16x32_bf16 v[56:59], v[92:95], v[108:111], v[56:59]
    buffer_load_dwordx4 v[80:83], v125, s[12:15], s26 offen offset:0
    buffer_load_dwordx4 v[84:87], v125, s[12:15], s26 offen offset:1024
    s_waitcnt lgkmcnt(0)
    v_mfma_f32_16x16x32_bf16 v[28:31], v[88:91], v[112:115], v[28:31]
    v_mfma_f32_16x16x32_bf16 v[60:63], v[92:95], v[112:115], v[60:63]
    buffer_load_dwordx4 v[88:91], v125, s[12:15], s26 offen offset:2048
    buffer_load_dwordx4 v[92:95], v125, s[12:15], s26 offen offset:3072
    s_add_u32 s23, s23, 57344
    s_add_u32 s26, s26, 57344
    s_barrier
    s_sub_u32 s22, s22, 1
    s_cmp_eq_u32 s22, 0
    s_cbranch_scc1 L_conv2_kernel_mlast1
    ds_read_b128 v[96:99], v120 offset:8192
    ds_read_b128 v[100:103], v120 offset:9216
    ds_read_b128 v[104:107], v120 offset:10240
    ds_read_b128 v[108:111], v120 offset:11264
    ds_read_b128 v[112:115], v120 offset:12288
    ds_read_b128 v[116:119], v120 offset:13312
    s_waitcnt vmcnt(6) lgkmcnt(5)
    v_mfma_f32_16x16x32_bf16 v[0:3], v[64:67], v[96:99], v[0:3]
    v_mfma_f32_16x16x32_bf16 v[32:35], v[68:71], v[96:99], v[32:35]
    ds_read_b128 v[96:99], v120 offset:14336
    s_waitcnt vmcnt(4) lgkmcnt(5)
    v_mfma_f32_16x16x32_bf16 v[4:7], v[64:67], v[100:103], v[4:7]
    v_mfma_f32_16x16x32_bf16 v[36:39], v[68:71], v[100:103], v[36:39]
    v_mfma_f32_16x16x32_bf16 v[0:3], v[72:75], v[100:103], v[0:3]
    v_mfma_f32_16x16x32_bf16 v[32:35], v[76:79], v[100:103], v[32:35]
    ds_read_b128 v[100:103], v120 offset:15360
    s_waitcnt vmcnt(2) lgkmcnt(5)
    v_mfma_f32_16x16x32_bf16 v[8:11], v[64:67], v[104:107], v[8:11]
    v_mfma_f32_16x16x32_bf16 v[40:43], v[68:71], v[104:107], v[40:43]
    v_mfma_f32_16x16x32_bf16 v[4:7], v[72:75], v[104:107], v[4:7]
    v_mfma_f32_16x16x32_bf16 v[36:39], v[76:79], v[104:107], v[36:39]
    v_mfma_f32_16x16x32_bf16 v[0:3], v[80:83], v[104:107], v[0:3]
    v_mfma_f32_16x16x32_bf16 v[32:35], v[84:87], v[104:107], v[32:35]
    ds_read_b128 v[104:107], v122 offset:0
    v_add_u32 v122, v124, v122
    s_waitcnt vmcnt(0) lgkmcnt(5)
    v_mfma_f32_16x16x32_bf16 v[12:15], v[64:67], v[108:111], v[12:15]
    v_mfma_f32_16x16x32_bf16 v[44:47], v[68:71], v[108:111], v[44:47]
    v_mfma_f32_16x16x32_bf16 v[8:11], v[72:75], v[108:111], v[8:11]
    v_mfma_f32_16x16x32_bf16 v[40:43], v[76:79], v[108:111], v[40:43]
    v_mfma_f32_16x16x32_bf16 v[4:7], v[80:83], v[108:111], v[4:7]
    v_mfma_f32_16x16x32_bf16 v[36:39], v[84:87], v[108:111], v[36:39]
    v_mfma_f32_16x16x32_bf16 v[0:3], v[88:91], v[108:111], v[0:3]
    v_mfma_f32_16x16x32_bf16 v[32:35], v[92:95], v[108:111], v[32:35]
    ds_read_b128 v[108:111], v121 offset:9216
    s_waitcnt lgkmcnt(5)
    v_mfma_f32_16x16x32_bf16 v[16:19], v[64:67], v[112:115], v[16:19]
    v_mfma_f32_16x16x32_bf16 v[48:51], v[68:71], v[112:115], v[48:51]
    v_mfma_f32_16x16x32_bf16 v[12:15], v[72:75], v[112:115], v[12:15]
    v_mfma_f32_16x16x32_bf16 v[44:47], v[76:79], v[112:115], v[44:47]
    v_mfma_f32_16x16x32_bf16 v[8:11], v[80:83], v[112:115], v[8:11]
    v_mfma_f32_16x16x32_bf16 v[40:43], v[84:87], v[112:115], v[40:43]
    v_mfma_f32_16x16x32_bf16 v[4:7], v[88:91], v[112:115], v[4:7]
    v_mfma_f32_16x16x32_bf16 v[36:39], v[92:95], v[112:115], v[36:39]
    ds_read_b128 v[112:115], v121 offset:10240
    s_waitcnt lgkmcnt(5)
    v_mfma_f32_16x16x32_bf16 v[20:23], v[64:67], v[116:119], v[20:23]
    v_mfma_f32_16x16x32_bf16 v[52:55], v[68:71], v[116:119], v[52:55]
    v_mfma_f32_16x16x32_bf16 v[16:19], v[72:75], v[116:119], v[16:19]
    v_mfma_f32_16x16x32_bf16 v[48:51], v[76:79], v[116:119], v[48:51]
    v_mfma_f32_16x16x32_bf16 v[12:15], v[80:83], v[116:119], v[12:15]
    v_mfma_f32_16x16x32_bf16 v[44:47], v[84:87], v[116:119], v[44:47]
    v_mfma_f32_16x16x32_bf16 v[8:11], v[88:91], v[116:119], v[8:11]
    v_mfma_f32_16x16x32_bf16 v[40:43], v[92:95], v[116:119], v[40:43]
    s_waitcnt lgkmcnt(4)
    v_mfma_f32_16x16x32_bf16 v[24:27], v[64:67], v[96:99], v[24:27]
    v_mfma_f32_16x16x32_bf16 v[56:59], v[68:71], v[96:99], v[56:59]
    v_mfma_f32_16x16x32_bf16 v[20:23], v[72:75], v[96:99], v[20:23]
    v_mfma_f32_16x16x32_bf16 v[52:55], v[76:79], v[96:99], v[52:55]
    v_mfma_f32_16x16x32_bf16 v[16:19], v[80:83], v[96:99], v[16:19]
    v_mfma_f32_16x16x32_bf16 v[48:51], v[84:87], v[96:99], v[48:51]
    v_mfma_f32_16x16x32_bf16 v[12:15], v[88:91], v[96:99], v[12:15]
    v_mfma_f32_16x16x32_bf16 v[44:47], v[92:95], v[96:99], v[44:47]
    s_waitcnt lgkmcnt(3)
    v_mfma_f32_16x16x32_bf16 v[28:31], v[64:67], v[100:103], v[28:31]
    v_mfma_f32_16x16x32_bf16 v[60:63], v[68:71], v[100:103], v[60:63]
    v_mfma_f32_16x16x32_bf16 v[24:27], v[72:75], v[100:103], v[24:27]
    v_mfma_f32_16x16x32_bf16 v[56:59], v[76:79], v[100:103], v[56:59]
    v_mfma_f32_16x16x32_bf16 v[20:23], v[80:83], v[100:103], v[20:23]
    v_mfma_f32_16x16x32_bf16 v[52:55], v[84:87], v[100:103], v[52:55]
    v_mfma_f32_16x16x32_bf16 v[16:19], v[88:91], v[100:103], v[16:19]
    v_mfma_f32_16x16x32_bf16 v[48:51], v[92:95], v[100:103], v[48:51]
    buffer_load_dwordx4 v[64:67], v125, s[12:15], s23 offen offset:0
    buffer_load_dwordx4 v[68:71], v125, s[12:15], s23 offen offset:1024
    s_waitcnt lgkmcnt(2)
    v_mfma_f32_16x16x32_bf16 v[28:31], v[72:75], v[104:107], v[28:31]
    v_mfma_f32_16x16x32_bf16 v[60:63], v[76:79], v[104:107], v[60:63]
    v_mfma_f32_16x16x32_bf16 v[24:27], v[80:83], v[104:107], v[24:27]
    v_mfma_f32_16x16x32_bf16 v[56:59], v[84:87], v[104:107], v[56:59]
    v_mfma_f32_16x16x32_bf16 v[20:23], v[88:91], v[104:107], v[20:23]
    v_mfma_f32_16x16x32_bf16 v[52:55], v[92:95], v[104:107], v[52:55]
    buffer_load_dwordx4 v[72:75], v125, s[12:15], s23 offen offset:2048
    buffer_load_dwordx4 v[76:79], v125, s[12:15], s23 offen offset:3072
    s_waitcnt lgkmcnt(1)
    v_mfma_f32_16x16x32_bf16 v[28:31], v[80:83], v[108:111], v[28:31]
    v_mfma_f32_16x16x32_bf16 v[60:63], v[84:87], v[108:111], v[60:63]
    v_mfma_f32_16x16x32_bf16 v[24:27], v[88:91], v[108:111], v[24:27]
    v_mfma_f32_16x16x32_bf16 v[56:59], v[92:95], v[108:111], v[56:59]
    buffer_load_dwordx4 v[80:83], v125, s[12:15], s26 offen offset:0
    buffer_load_dwordx4 v[84:87], v125, s[12:15], s26 offen offset:1024
    s_waitcnt lgkmcnt(0)
    v_mfma_f32_16x16x32_bf16 v[28:31], v[88:91], v[112:115], v[28:31]
    v_mfma_f32_16x16x32_bf16 v[60:63], v[92:95], v[112:115], v[60:63]
    buffer_load_dwordx4 v[88:91], v125, s[12:15], s26 offen offset:2048
    buffer_load_dwordx4 v[92:95], v125, s[12:15], s26 offen offset:3072
    s_add_u32 s23, s23, 57344
    s_add_u32 s26, s26, 57344
    s_barrier
    s_branch L_conv2_kernel_mloop1
L_conv2_kernel_mlast1:
    v_and_b32 v125, 15, v127
    v_and_b32 v126, 7, v127
    v_lshlrev_b32 v126, 4, v126
    v_lshl_add_u32 v125, v125, 7, v126
    v_lshrrev_b32 v126, 4, v127
    v_lshl_add_u32 v125, v126, 11, v125
    s_lshl_b32 s36, s20, 14
    s_add_u32 s37, s36, 8192
    v_add_u32 v126, s37, v125
    v_add_u32 v125, s36, v125
    ds_read_b128 v[96:99], v120 offset:8192
    ds_read_b128 v[100:103], v120 offset:9216
    ds_read_b128 v[104:107], v120 offset:10240
    ds_read_b128 v[108:111], v120 offset:11264
    ds_read_b128 v[112:115], v120 offset:12288
    ds_read_b128 v[116:119], v120 offset:13312
    s_waitcnt vmcnt(6) lgkmcnt(5)
    v_mfma_f32_16x16x32_bf16 v[0:3], v[64:67], v[96:99], v[0:3]
    v_mfma_f32_16x16x32_bf16 v[32:35], v[68:71], v[96:99], v[32:35]
    ds_read_b128 v[96:99], v120 offset:14336
    s_waitcnt vmcnt(4) lgkmcnt(5)
    v_mfma_f32_16x16x32_bf16 v[4:7], v[64:67], v[100:103], v[4:7]
    v_mfma_f32_16x16x32_bf16 v[36:39], v[68:71], v[100:103], v[36:39]
    v_mfma_f32_16x16x32_bf16 v[0:3], v[72:75], v[100:103], v[0:3]
    v_mfma_f32_16x16x32_bf16 v[32:35], v[76:79], v[100:103], v[32:35]
    ds_read_b128 v[100:103], v120 offset:15360
    s_waitcnt vmcnt(2) lgkmcnt(5)
    v_mfma_f32_16x16x32_bf16 v[8:11], v[64:67], v[104:107], v[8:11]
    v_mfma_f32_16x16x32_bf16 v[40:43], v[68:71], v[104:107], v[40:43]
    v_mfma_f32_16x16x32_bf16 v[4:7], v[72:75], v[104:107], v[4:7]
    v_mfma_f32_16x16x32_bf16 v[36:39], v[76:79], v[104:107], v[36:39]
    v_mfma_f32_16x16x32_bf16 v[0:3], v[80:83], v[104:107], v[0:3]
    v_mfma_f32_16x16x32_bf16 v[32:35], v[84:87], v[104:107], v[32:35]
    ds_read_b128 v[104:107], v122 offset:0
    s_waitcnt vmcnt(0) lgkmcnt(5)
    v_mfma_f32_16x16x32_bf16 v[12:15], v[64:67], v[108:111], v[12:15]
    v_mfma_f32_16x16x32_bf16 v[44:47], v[68:71], v[108:111], v[44:47]
    v_mfma_f32_16x16x32_bf16 v[8:11], v[72:75], v[108:111], v[8:11]
    v_mfma_f32_16x16x32_bf16 v[40:43], v[76:79], v[108:111], v[40:43]
    v_mfma_f32_16x16x32_bf16 v[4:7], v[80:83], v[108:111], v[4:7]
    v_mfma_f32_16x16x32_bf16 v[36:39], v[84:87], v[108:111], v[36:39]
    v_mfma_f32_16x16x32_bf16 v[0:3], v[88:91], v[108:111], v[0:3]
    v_mfma_f32_16x16x32_bf16 v[32:35], v[92:95], v[108:111], v[32:35]
    ds_read_b128 v[108:111], v121 offset:9216
    s_waitcnt lgkmcnt(5)
    v_mfma_f32_16x16x32_bf16 v[16:19], v[64:67], v[112:115], v[16:19]
    v_mfma_f32_16x16x32_bf16 v[48:51], v[68:71], v[112:115], v[48:51]
    v_mfma_f32_16x16x32_bf16 v[12:15], v[72:75], v[112:115], v[12:15]
    v_mfma_f32_16x16x32_bf16 v[44:47], v[76:79], v[112:115], v[44:47]
    v_mfma_f32_16x16x32_bf16 v[8:11], v[80:83], v[112:115], v[8:11]
    v_mfma_f32_16x16x32_bf16 v[40:43], v[84:87], v[112:115], v[40:43]
    v_mfma_f32_16x16x32_bf16 v[4:7], v[88:91], v[112:115], v[4:7]
    v_mfma_f32_16x16x32_bf16 v[36:39], v[92:95], v[112:115], v[36:39]
    ds_read_b128 v[112:115], v121 offset:10240
    v_xor_b32 v123, 0, v125
    ds_write_b128 v123, v[0:3]
    s_waitcnt lgkmcnt(6)
    v_mfma_f32_16x16x32_bf16 v[20:23], v[64:67], v[116:119], v[20:23]
    v_mfma_f32_16x16x32_bf16 v[52:55], v[68:71], v[116:119], v[52:55]
    v_mfma_f32_16x16x32_bf16 v[16:19], v[72:75], v[116:119], v[16:19]
    v_mfma_f32_16x16x32_bf16 v[48:51], v[76:79], v[116:119], v[48:51]
    v_mfma_f32_16x16x32_bf16 v[12:15], v[80:83], v[116:119], v[12:15]
    v_mfma_f32_16x16x32_bf16 v[44:47], v[84:87], v[116:119], v[44:47]
    v_mfma_f32_16x16x32_bf16 v[8:11], v[88:91], v[116:119], v[8:11]
    v_mfma_f32_16x16x32_bf16 v[40:43], v[92:95], v[116:119], v[40:43]
    v_xor_b32 v124, 16, v125
    ds_write_b128 v124, v[4:7]
    s_waitcnt lgkmcnt(2)
    v_mfma_f32_16x16x32_bf16 v[24:27], v[64:67], v[96:99], v[24:27]
    v_mfma_f32_16x16x32_bf16 v[56:59], v[68:71], v[96:99], v[56:59]
    v_mfma_f32_16x16x32_bf16 v[20:23], v[72:75], v[96:99], v[20:23]
    v_mfma_f32_16x16x32_bf16 v[52:55], v[76:79], v[96:99], v[52:55]
    v_mfma_f32_16x16x32_bf16 v[16:19], v[80:83], v[96:99], v[16:19]
    v_mfma_f32_16x16x32_bf16 v[48:51], v[84:87], v[96:99], v[48:51]
    v_mfma_f32_16x16x32_bf16 v[12:15], v[88:91], v[96:99], v[12:15]
    v_mfma_f32_16x16x32_bf16 v[44:47], v[92:95], v[96:99], v[44:47]
    v_xor_b32 v123, 32, v125
    ds_write_b128 v123, v[8:11]
    v_xor_b32 v124, 0, v126
    ds_write_b128 v124, v[32:35]
    v_mfma_f32_16x16x32_bf16 v[28:31], v[64:67], v[100:103], v[28:31]
    v_mfma_f32_16x16x32_bf16 v[60:63], v[68:71], v[100:103], v[60:63]
    v_mfma_f32_16x16x32_bf16 v[24:27], v[72:75], v[100:103], v[24:27]
    v_mfma_f32_16x16x32_bf16 v[56:59], v[76:79], v[100:103], v[56:59]
    v_mfma_f32_16x16x32_bf16 v[20:23], v[80:83], v[100:103], v[20:23]
    v_mfma_f32_16x16x32_bf16 v[52:55], v[84:87], v[100:103], v[52:55]
    v_mfma_f32_16x16x32_bf16 v[16:19], v[88:91], v[100:103], v[16:19]
    v_mfma_f32_16x16x32_bf16 v[48:51], v[92:95], v[100:103], v[48:51]
    v_xor_b32 v123, 16, v126
    ds_write_b128 v123, v[36:39]
    v_xor_b32 v124, 32, v126
    ds_write_b128 v124, v[40:43]
    v_mfma_f32_16x16x32_bf16 v[28:31], v[72:75], v[104:107], v[28:31]
    v_mfma_f32_16x16x32_bf16 v[60:63], v[76:79], v[104:107], v[60:63]
    v_mfma_f32_16x16x32_bf16 v[24:27], v[80:83], v[104:107], v[24:27]
    v_mfma_f32_16x16x32_bf16 v[56:59], v[84:87], v[104:107], v[56:59]
    v_mfma_f32_16x16x32_bf16 v[20:23], v[88:91], v[104:107], v[20:23]
    v_mfma_f32_16x16x32_bf16 v[52:55], v[92:95], v[104:107], v[52:55]
    v_xor_b32 v124, 48, v125
    ds_write_b128 v124, v[12:15]
    v_xor_b32 v123, 48, v126
    ds_write_b128 v123, v[44:47]
    v_mfma_f32_16x16x32_bf16 v[28:31], v[80:83], v[108:111], v[28:31]
    v_mfma_f32_16x16x32_bf16 v[60:63], v[84:87], v[108:111], v[60:63]
    v_mfma_f32_16x16x32_bf16 v[24:27], v[88:91], v[108:111], v[24:27]
    v_mfma_f32_16x16x32_bf16 v[56:59], v[92:95], v[108:111], v[56:59]
    v_xor_b32 v123, 64, v125
    ds_write_b128 v123, v[16:19]
    v_xor_b32 v124, 64, v126
    ds_write_b128 v124, v[48:51]
    v_mfma_f32_16x16x32_bf16 v[28:31], v[88:91], v[112:115], v[28:31]
    v_mfma_f32_16x16x32_bf16 v[60:63], v[92:95], v[112:115], v[60:63]
    v_xor_b32 v124, 80, v125
    ds_write_b128 v124, v[20:23]
    v_xor_b32 v123, 80, v126
    ds_write_b128 v123, v[52:55]
    v_and_b32 v108, 15, v127
    v_lshrrev_b32 v109, 4, v127
    v_lshrrev_b32 v110, 3, v108
    s_lshl_b32 s36, s20, 1
    v_add_u32 v110, s36, v110
    v_xor_b32 v111, v110, v108
    v_and_b32 v111, 7, v111
    v_lshlrev_b32 v111, 4, v111
    v_xor_b32 v123, 96, v125
    ds_write_b128 v123, v[24:27]
    v_lshl_add_u32 v111, v110, 7, v111
    v_lshl_add_u32 v120, v109, 11, v111
    v_add_u32 v121, 65536, v120
    v_add_u32 v64, 131072, v120
    s_lshl_b32 s36, s20, 9
    s_add_u32 s36, s36, 115712
    v_lshl_add_u32 v127, v109, 7, s36
    s_lshl_b32 s36, s20, 4
    v_add_u32 v108, s36, v108
    v_lshlrev_b32 v110, 6, v108
    v_lshl_add_u32 v110, v109, 4, v110
    s_mul_i32 s36, s29, 262144
    v_xor_b32 v124, 96, v126
    ds_write_b128 v124, v[56:59]
    s_lshl_b32 s37, s21, 4
    s_add_u32 s36, s36, s37
    v_add_u32 v110, s36, v110
    v_mov_b32 v111, 2130706432
    v_cmp_gt_u32 vcc, 125, v108
    s_mov_b32 s4, 0xbeaaaaab
    s_mov_b32 s5, s4
    s_mov_b32 s6, 0x3e800000
    s_mov_b32 s7, s6
    s_mov_b32 s8, 0xc0a00000
    s_mov_b32 s9, s8
    s_mov_b32 s10, 0xc0638e39
    v_xor_b32 v124, 112, v125
    ds_write_b128 v124, v[28:31]
    s_mov_b32 s11, s10
    s_mov_b32 s12, 0xbf638e39
    s_mov_b32 s13, s12
    s_mov_b32 s14, 0xbe638e39
    s_mov_b32 s15, s14
    s_mov_b32 s22, 0xbd638e39
    s_mov_b32 s23, s22
    s_mov_b32 s24, 0x3ff1c71c
    s_mov_b32 s25, s24
    s_mov_b32 s26, 0xbf2aaaab
    s_mov_b32 s27, s26
    s_mov_b32 s32, 0x3ecccccd
    v_xor_b32 v123, 112, v126
    s_waitcnt lgkmcnt(8)
    ds_write_b128 v123, v[60:63]
    s_mov_b32 s33, s32
    s_mov_b32 s34, 0xbd888889
    s_mov_b32 s35, s34
    s_mov_b32 s38, 0xbe4ccccd
    s_mov_b32 s39, s38
    s_mov_b32 s40, 0xbdd2d3e8
    s_mov_b32 s41, s40
    s_mov_b32 s42, 0x3f800000
    s_mov_b32 s43, s42
    s_setprio 0
    s_branch L_conv2_kernel_epi
L_conv2_kernel_m2:
    s_mul_i32 s37, s38, 2176
    s_add_u32 s37, s37, 98304
    v_add_u32 v116, s37, v8
    v_add_u32 v118, s37, v9
    v_add_u32 v117, 104832, v8
    s_cmp_eq_u32 s38, 0
    s_cbranch_scc1 L_conv2_kernel_hh0
    v_add_u32 v117, 98304, v9
L_conv2_kernel_hh0:
    s_lshl_b32 s37, s38, 12
    s_add_u32 s37, s37, s43
    s_add_u32 s37, s37, 49152
    v_lshl_add_u32 v119, v127, 4, s37
    v_mov_b32 v0, 0
    v_mov_b32 v1, 0
    v_mov_b32 v2, 0
    v_mov_b32 v3, 0
    v_mov_b32 v4, 0
    v_mov_b32 v5, 0
    v_mov_b32 v6, 0
    v_mov_b32 v7, 0
    v_mov_b32 v8, 0
    v_mov_b32 v9, 0
    v_mov_b32 v10, 0
    v_mov_b32 v11, 0
    v_mov_b32 v12, 0
    v_mov_b32 v13, 0
    v_mov_b32 v14, 0
    v_mov_b32 v15, 0
    v_mov_b32 v16, 0
    v_mov_b32 v17, 0
    v_mov_b32 v18, 0
    v_mov_b32 v19, 0
    v_mov_b32 v20, 0
    v_mov_b32 v21, 0
    v_mov_b32 v22, 0
    v_mov_b32 v23, 0
    v_mov_b32 v24, 0
    v_mov_b32 v25, 0
    v_mov_b32 v26, 0
    v_mov_b32 v27, 0
    v_mov_b32 v28, 0
    v_mov_b32 v29, 0
    v_mov_b32 v30, 0
    v_mov_b32 v31, 0
    v_mov_b32 v32, 0
    v_mov_b32 v33, 0
    v_mov_b32 v34, 0
    v_mov_b32 v35, 0
    v_mov_b32 v36, 0
    v_mov_b32 v37, 0
    v_mov_b32 v38, 0
    v_mov_b32 v39, 0
    v_mov_b32 v40, 0
    v_mov_b32 v41, 0
    v_mov_b32 v42, 0
    v_mov_b32 v43, 0
    v_mov_b32 v44, 0
    v_mov_b32 v45, 0
    v_mov_b32 v46, 0
    v_mov_b32 v47, 0
    v_mov_b32 v48, 0
    v_mov_b32 v49, 0
    v_mov_b32 v50, 0
    v_mov_b32 v51, 0
    v_mov_b32 v52, 0
    v_mov_b32 v53, 0
    v_mov_b32 v54, 0
    v_mov_b32 v55, 0
    v_mov_b32 v56, 0
    v_mov_b32 v57, 0
    v_mov_b32 v58, 0
    v_mov_b32 v59, 0
    v_mov_b32 v60, 0
    v_mov_b32 v61, 0
    v_mov_b32 v62, 0
    v_mov_b32 v63, 0
    buffer_load_dwordx4 v[96:99], v108, s[8:11], 0 offen
    buffer_load_dwordx4 v[100:103], v109, s[8:11], 0 offen
    buffer_load_dwordx4 v[104:107], v110, s[8:11], 0 offen
    s_mov_b32 s23, 0
    s_mov_b32 s26, 4096
    buffer_load_dwordx4 v[64:67], v125, s[12:15], s23 offen offset:0
    buffer_load_dwordx4 v[68:71], v125, s[12:15], s23 offen offset:2048
    buffer_load_dwordx4 v[80:83], v119, s[12:15], s23 offen offset:0
    buffer_load_dwordx4 v[72:75], v125, s[12:15], s26 offen offset:0
    buffer_load_dwordx4 v[84:87], v119, s[12:15], s23 offen offset:2048
    buffer_load_dwordx4 v[76:79], v125, s[12:15], s26 offen offset:2048
    s_mov_b32 s23, 57344
    s_mov_b32 s26, 61440
    s_waitcnt vmcnt(6)
    v_lshlrev_b32 v108, 16, v96
    v_and_b32 v111, s25, v96
    v_lshlrev_b32 v109, 16, v100
    v_and_b32 v112, s25, v100
    v_lshlrev_b32 v110, 16, v104
    v_and_b32 v113, s25, v104
    v_mul_f32 v114, s44, v108
    v_mul_f32 v115, s44, v111
    v_fmac_f32 v114, s45, v109
    v_fmac_f32 v115, s45, v112
    v_fmac_f32 v114, s46, v110
    v_fmac_f32 v115, s46, v113
    v_cvt_pk_bf16_f32 v96, v114, v115
    v_lshlrev_b32 v108, 16, v97
    v_and_b32 v111, s25, v97
    v_lshlrev_b32 v109, 16, v101
    v_and_b32 v112, s25, v101
    v_lshlrev_b32 v110, 16, v105
    v_and_b32 v113, s25, v105
    v_mul_f32 v114, s44, v108
    v_mul_f32 v115, s44, v111
    v_fmac_f32 v114, s45, v109
    v_fmac_f32 v115, s45, v112
    v_fmac_f32 v114, s46, v110
    v_fmac_f32 v115, s46, v113
    v_cvt_pk_bf16_f32 v97, v114, v115
    v_lshlrev_b32 v108, 16, v98
    v_and_b32 v111, s25, v98
    v_lshlrev_b32 v109, 16, v102
    v_and_b32 v112, s25, v102
    v_lshlrev_b32 v110, 16, v106
    v_and_b32 v113, s25, v106
    v_mul_f32 v114, s44, v108
    v_mul_f32 v115, s44, v111
    v_fmac_f32 v114, s45, v109
    v_fmac_f32 v115, s45, v112
    v_fmac_f32 v114, s46, v110
    v_fmac_f32 v115, s46, v113
    v_cvt_pk_bf16_f32 v98, v114, v115
    v_lshlrev_b32 v108, 16, v99
    v_and_b32 v111, s25, v99
    v_lshlrev_b32 v109, 16, v103
    v_and_b32 v112, s25, v103
    v_lshlrev_b32 v110, 16, v107
    v_and_b32 v113, s25, v107
    v_mul_f32 v114, s44, v108
    v_mul_f32 v115, s44, v111
    v_fmac_f32 v114, s45, v109
    v_fmac_f32 v115, s45, v112
    v_fmac_f32 v114, s46, v110
    v_fmac_f32 v115, s46, v113
    v_cvt_pk_bf16_f32 v99, v114, v115
    ds_write_b128 v126, v[96:99]
    v_and_b32 v111, 15, v127
    v_lshlrev_b32 v111, 2, v111
    v_add_u32 v111, 99328, v111
    ds_write_b32 v111, v0
    ds_write_b32 v111, v0 offset:8704
    s_waitcnt lgkmcnt(0)
    s_barrier
    s_mov_b32 s22, 4
    s_setprio 2
L_conv2_kernel_mloop2:
    ds_read_b128 v[88:91], v120 offset:0
    ds_read_b128 v[92:95], v120 offset:1024
    ds_read_b128 v[96:99], v116 offset:0
    ds_read_b128 v[100:103], v120 offset:2048
    ds_read_b128 v[104:107], v116 offset:1088
    ds_read_b128 v[108:111], v120 offset:3072
    ds_read_b128 v[112:115], v116 offset:2176
    s_waitcnt vmcnt(5) lgkmcnt(6)
    v_mfma_f32_16x16x32_bf16 v[0:3], v[64:67], v[88:91], v[0:3]
    ds_read_b128 v[88:91], v120 offset:4096
    s_waitcnt vmcnt(4) lgkmcnt(6)
    v_mfma_f32_16x16x32_bf16 v[4:7], v[64:67], v[92:95], v[4:7]
    v_mfma_f32_16x16x32_bf16 v[0:3], v[68:71], v[92:95], v[0:3]
    ds_read_b128 v[92:95], v116 offset:3264
    s_waitcnt vmcnt(3) lgkmcnt(6)
    v_mfma_f32_16x16x32_bf16 v[32:35], v[80:83], v[96:99], v[32:35]
    ds_read_b128 v[96:99], v120 offset:5120
    s_waitcnt vmcnt(2) lgkmcnt(6)
    v_mfma_f32_16x16x32_bf16 v[8:11], v[64:67], v[100:103], v[8:11]
    v_mfma_f32_16x16x32_bf16 v[4:7], v[68:71], v[100:103], v[4:7]
    v_mfma_f32_16x16x32_bf16 v[0:3], v[72:75], v[100:103], v[0:3]
    ds_read_b128 v[100:103], v116 offset:4352
    s_waitcnt vmcnt(1) lgkmcnt(6)
    v_mfma_f32_16x16x32_bf16 v[36:39], v[80:83], v[104:107], v[36:39]
    v_mfma_f32_16x16x32_bf16 v[32:35], v[84:87], v[104:107], v[32:35]
    ds_read_b128 v[104:107], v120 offset:6144
    s_waitcnt vmcnt(0) lgkmcnt(6)
    v_mfma_f32_16x16x32_bf16 v[12:15], v[64:67], v[108:111], v[12:15]
    v_mfma_f32_16x16x32_bf16 v[8:11], v[68:71], v[108:111], v[8:11]
    v_mfma_f32_16x16x32_bf16 v[4:7], v[72:75], v[108:111], v[4:7]
    v_mfma_f32_16x16x32_bf16 v[0:3], v[76:79], v[108:111], v[0:3]
    ds_read_b128 v[108:111], v116 offset:5440
    s_waitcnt lgkmcnt(6)
    v_mfma_f32_16x16x32_bf16 v[40:43], v[80:83], v[112:115], v[40:43]
    v_mfma_f32_16x16x32_bf16 v[36:39], v[84:87], v[112:115], v[36:39]
    ds_read_b128 v[112:115], v120 offset:7168
    s_waitcnt lgkmcnt(6)
    v_mfma_f32_16x16x32_bf16 v[16:19], v[64:67], v[88:91], v[16:19]
    v_mfma_f32_16x16x32_bf16 v[12:15], v[68:71], v[88:91], v[12:15]
    v_mfma_f32_16x16x32_bf16 v[8:11], v[72:75], v[88:91], v[8:11]
    v_mfma_f32_16x16x32_bf16 v[4:7], v[76:79], v[88:91], v[4:7]
    ds_read_b128 v[88:91], v117 offset:0
    s_waitcnt lgkmcnt(6)
    v_mfma_f32_16x16x32_bf16 v[44:47], v[80:83], v[92:95], v[44:47]
    v_mfma_f32_16x16x32_bf16 v[40:43], v[84:87], v[92:95], v[40:43]
    ds_read_b128 v[92:95], v122 offset:0
    v_add_u32 v122, v123, v122
    s_waitcnt lgkmcnt(6)
    v_mfma_f32_16x16x32_bf16 v[20:23], v[64:67], v[96:99], v[20:23]
    v_mfma_f32_16x16x32_bf16 v[16:19], v[68:71], v[96:99], v[16:19]
    v_mfma_f32_16x16x32_bf16 v[12:15], v[72:75], v[96:99], v[12:15]
    v_mfma_f32_16x16x32_bf16 v[8:11], v[76:79], v[96:99], v[8:11]
    ds_read_b128 v[96:99], v117 offset:1088
    s_waitcnt lgkmcnt(6)
    v_mfma_f32_16x16x32_bf16 v[48:51], v[80:83], v[100:103], v[48:51]
    v_mfma_f32_16x16x32_bf16 v[44:47], v[84:87], v[100:103], v[44:47]
    ds_read_b128 v[100:103], v121 offset:1024
    s_waitcnt lgkmcnt(6)
    v_mfma_f32_16x16x32_bf16 v[24:27], v[64:67], v[104:107], v[24:27]
    v_mfma_f32_16x16x32_bf16 v[20:23], v[68:71], v[104:107], v[20:23]
    v_mfma_f32_16x16x32_bf16 v[16:19], v[72:75], v[104:107], v[16:19]
    v_mfma_f32_16x16x32_bf16 v[12:15], v[76:79], v[104:107], v[12:15]
    ds_read_b128 v[104:107], v118 offset:0
    s_waitcnt lgkmcnt(6)
    v_mfma_f32_16x16x32_bf16 v[52:55], v[80:83], v[108:111], v[52:55]
    v_mfma_f32_16x16x32_bf16 v[48:51], v[84:87], v[108:111], v[48:51]
    ds_read_b128 v[108:111], v121 offset:2048
    s_waitcnt lgkmcnt(6)
    v_mfma_f32_16x16x32_bf16 v[28:31], v[64:67], v[112:115], v[28:31]
    v_mfma_f32_16x16x32_bf16 v[24:27], v[68:71], v[112:115], v[24:27]
    v_mfma_f32_16x16x32_bf16 v[20:23], v[72:75], v[112:115], v[20:23]
    v_mfma_f32_16x16x32_bf16 v[16:19], v[76:79], v[112:115], v[16:19]
    buffer_load_dwordx4 v[64:67], v125, s[12:15], s23 offen offset:0
    s_waitcnt lgkmcnt(5)
    v_mfma_f32_16x16x32_bf16 v[56:59], v[80:83], v[88:91], v[56:59]
    v_mfma_f32_16x16x32_bf16 v[52:55], v[84:87], v[88:91], v[52:55]
    s_waitcnt lgkmcnt(0)
    s_barrier
    v_mfma_f32_16x16x32_bf16 v[28:31], v[68:71], v[92:95], v[28:31]
    v_mfma_f32_16x16x32_bf16 v[24:27], v[72:75], v[92:95], v[24:27]
    v_mfma_f32_16x16x32_bf16 v[20:23], v[76:79], v[92:95], v[20:23]
    buffer_load_dwordx4 v[68:71], v125, s[12:15], s23 offen offset:2048
    v_mfma_f32_16x16x32_bf16 v[60:63], v[80:83], v[96:99], v[60:63]
    v_mfma_f32_16x16x32_bf16 v[56:59], v[84:87], v[96:99], v[56:59]
    buffer_load_dwordx4 v[80:83], v119, s[12:15], s23 offen offset:0
    v_mfma_f32_16x16x32_bf16 v[28:31], v[72:75], v[100:103], v[28:31]
    v_mfma_f32_16x16x32_bf16 v[24:27], v[76:79], v[100:103], v[24:27]
    buffer_load_dwordx4 v[72:75], v125, s[12:15], s26 offen offset:0
    v_mfma_f32_16x16x32_bf16 v[60:63], v[84:87], v[104:107], v[60:63]
    buffer_load_dwordx4 v[84:87], v119, s[12:15], s23 offen offset:2048
    v_mfma_f32_16x16x32_bf16 v[28:31], v[76:79], v[108:111], v[28:31]
    buffer_load_dwordx4 v[76:79], v125, s[12:15], s26 offen offset:2048
    s_add_u32 s23, s23, 57344
    s_add_u32 s26, s26, 57344
    s_sub_u32 s22, s22, 1
    s_cmp_eq_u32 s22, 0
    s_cbranch_scc1 L_conv2_kernel_mlast2
    ds_read_b128 v[88:91], v120 offset:8192
    ds_read_b128 v[92:95], v120 offset:9216
    ds_read_b128 v[96:99], v116 offset:8704
    ds_read_b128 v[100:103], v120 offset:10240
    ds_read_b128 v[104:107], v116 offset:9792
    ds_read_b128 v[108:111], v120 offset:11264
    ds_read_b128 v[112:115], v116 offset:10880
    s_waitcnt vmcnt(5) lgkmcnt(6)
    v_mfma_f32_16x16x32_bf16 v[0:3], v[64:67], v[88:91], v[0:3]
    ds_read_b128 v[88:91], v120 offset:12288
    s_waitcnt vmcnt(4) lgkmcnt(6)
    v_mfma_f32_16x16x32_bf16 v[4:7], v[64:67], v[92:95], v[4:7]
    v_mfma_f32_16x16x32_bf16 v[0:3], v[68:71], v[92:95], v[0:3]
    ds_read_b128 v[92:95], v116 offset:11968
    s_waitcnt vmcnt(3) lgkmcnt(6)
    v_mfma_f32_16x16x32_bf16 v[32:35], v[80:83], v[96:99], v[32:35]
    ds_read_b128 v[96:99], v120 offset:13312
    s_waitcnt vmcnt(2) lgkmcnt(6)
    v_mfma_f32_16x16x32_bf16 v[8:11], v[64:67], v[100:103], v[8:11]
    v_mfma_f32_16x16x32_bf16 v[4:7], v[68:71], v[100:103], v[4:7]
    v_mfma_f32_16x16x32_bf16 v[0:3], v[72:75], v[100:103], v[0:3]
    ds_read_b128 v[100:103], v116 offset:13056
    s_waitcnt vmcnt(1) lgkmcnt(6)
    v_mfma_f32_16x16x32_bf16 v[36:39], v[80:83], v[104:107], v[36:39]
    v_mfma_f32_16x16x32_bf16 v[32:35], v[84:87], v[104:107], v[32:35]
    ds_read_b128 v[104:107], v120 offset:14336
    s_waitcnt vmcnt(0) lgkmcnt(6)
    v_mfma_f32_16x16x32_bf16 v[12:15], v[64:67], v[108:111], v[12:15]
    v_mfma_f32_16x16x32_bf16 v[8:11], v[68:71], v[108:111], v[8:11]
    v_mfma_f32_16x16x32_bf16 v[4:7], v[72:75], v[108:111], v[4:7]
    v_mfma_f32_16x16x32_bf16 v[0:3], v[76:79], v[108:111], v[0:3]
    ds_read_b128 v[108:111], v116 offset:14144
    s_waitcnt lgkmcnt(6)
    v_mfma_f32_16x16x32_bf16 v[40:43], v[80:83], v[112:115], v[40:43]
    v_mfma_f32_16x16x32_bf16 v[36:39], v[84:87], v[112:115], v[36:39]
    ds_read_b128 v[112:115], v120 offset:15360
    s_waitcnt lgkmcnt(6)
    v_mfma_f32_16x16x32_bf16 v[16:19], v[64:67], v[88:91], v[16:19]
    v_mfma_f32_16x16x32_bf16 v[12:15], v[68:71], v[88:91], v[12:15]
    v_mfma_f32_16x16x32_bf16 v[8:11], v[72:75], v[88:91], v[8:11]
    v_mfma_f32_16x16x32_bf16 v[4:7], v[76:79], v[88:91], v[4:7]
    ds_read_b128 v[88:91], v117 offset:8704
    s_waitcnt lgkmcnt(6)
    v_mfma_f32_16x16x32_bf16 v[44:47], v[80:83], v[92:95], v[44:47]
    v_mfma_f32_16x16x32_bf16 v[40:43], v[84:87], v[92:95], v[40:43]
    ds_read_b128 v[92:95], v122 offset:0
    v_add_u32 v122, v124, v122
    s_waitcnt lgkmcnt(6)
    v_mfma_f32_16x16x32_bf16 v[20:23], v[64:67], v[96:99], v[20:23]
    v_mfma_f32_16x16x32_bf16 v[16:19], v[68:71], v[96:99], v[16:19]
    v_mfma_f32_16x16x32_bf16 v[12:15], v[72:75], v[96:99], v[12:15]
    v_mfma_f32_16x16x32_bf16 v[8:11], v[76:79], v[96:99], v[8:11]
    ds_read_b128 v[96:99], v117 offset:9792
    s_waitcnt lgkmcnt(6)
    v_mfma_f32_16x16x32_bf16 v[48:51], v[80:83], v[100:103], v[48:51]
    v_mfma_f32_16x16x32_bf16 v[44:47], v[84:87], v[100:103], v[44:47]
    ds_read_b128 v[100:103], v121 offset:9216
    s_waitcnt lgkmcnt(6)
    v_mfma_f32_16x16x32_bf16 v[24:27], v[64:67], v[104:107], v[24:27]
    v_mfma_f32_16x16x32_bf16 v[20:23], v[68:71], v[104:107], v[20:23]
    v_mfma_f32_16x16x32_bf16 v[16:19], v[72:75], v[104:107], v[16:19]
    v_mfma_f32_16x16x32_bf16 v[12:15], v[76:79], v[104:107], v[12:15]
    ds_read_b128 v[104:107], v118 offset:8704
    s_waitcnt lgkmcnt(6)
    v_mfma_f32_16x16x32_bf16 v[52:55], v[80:83], v[108:111], v[52:55]
    v_mfma_f32_16x16x32_bf16 v[48:51], v[84:87], v[108:111], v[48:51]
    ds_read_b128 v[108:111], v121 offset:10240
    s_waitcnt lgkmcnt(6)
    v_mfma_f32_16x16x32_bf16 v[28:31], v[64:67], v[112:115], v[28:31]
    v_mfma_f32_16x16x32_bf16 v[24:27], v[68:71], v[112:115], v[24:27]
    v_mfma_f32_16x16x32_bf16 v[20:23], v[72:75], v[112:115], v[20:23]
    v_mfma_f32_16x16x32_bf16 v[16:19], v[76:79], v[112:115], v[16:19]
    buffer_load_dwordx4 v[64:67], v125, s[12:15], s23 offen offset:0
    s_waitcnt lgkmcnt(5)
    v_mfma_f32_16x16x32_bf16 v[56:59], v[80:83], v[88:91], v[56:59]
    v_mfma_f32_16x16x32_bf16 v[52:55], v[84:87], v[88:91], v[52:55]
    s_waitcnt lgkmcnt(0)
    s_barrier
    v_mfma_f32_16x16x32_bf16 v[28:31], v[68:71], v[92:95], v[28:31]
    v_mfma_f32_16x16x32_bf16 v[24:27], v[72:75], v[92:95], v[24:27]
    v_mfma_f32_16x16x32_bf16 v[20:23], v[76:79], v[92:95], v[20:23]
    buffer_load_dwordx4 v[68:71], v125, s[12:15], s23 offen offset:2048
    v_mfma_f32_16x16x32_bf16 v[60:63], v[80:83], v[96:99], v[60:63]
    v_mfma_f32_16x16x32_bf16 v[56:59], v[84:87], v[96:99], v[56:59]
    buffer_load_dwordx4 v[80:83], v119, s[12:15], s23 offen offset:0
    v_mfma_f32_16x16x32_bf16 v[28:31], v[72:75], v[100:103], v[28:31]
    v_mfma_f32_16x16x32_bf16 v[24:27], v[76:79], v[100:103], v[24:27]
    buffer_load_dwordx4 v[72:75], v125, s[12:15], s26 offen offset:0
    v_mfma_f32_16x16x32_bf16 v[60:63], v[84:87], v[104:107], v[60:63]
    buffer_load_dwordx4 v[84:87], v119, s[12:15], s23 offen offset:2048
    v_mfma_f32_16x16x32_bf16 v[28:31], v[76:79], v[108:111], v[28:31]
    buffer_load_dwordx4 v[76:79], v125, s[12:15], s26 offen offset:2048
    s_add_u32 s23, s23, 57344
    s_add_u32 s26, s26, 57344
    s_branch L_conv2_kernel_mloop2
L_conv2_kernel_mlast2:
    v_and_b32 v125, 15, v127
    v_and_b32 v126, 7, v127
    v_lshlrev_b32 v126, 4, v126
    v_lshl_add_u32 v125, v125, 7, v126
    v_lshrrev_b32 v126, 4, v127
    v_lshl_add_u32 v125, v126, 11, v125
    s_mov_b32 s36, 65536
    s_cmp_eq_u32 s32, 1
    s_cselect_b32 s36, 121856, s36
    s_cmp_eq_u32 s32, 2
    s_cselect_b32 s36, 81920, s36
    s_cmp_eq_u32 s32, 3
    s_cselect_b32 s36, 130048, s36
    s_mov_b32 s37, 98304
    s_cmp_eq_u32 s32, 1
    s_cselect_b32 s37, 138240, s37
    s_cmp_eq_u32 s32, 2
    s_cselect_b32 s37, 146432, s37
    s_cmp_eq_u32 s32, 3
    s_cselect_b32 s37, 154624, s37
    v_add_u32 v126, s37, v125
    v_add_u32 v125, s36, v125
    ds_read_b128 v[88:91], v120 offset:8192
    ds_read_b128 v[92:95], v120 offset:9216
    ds_read_b128 v[96:99], v116 offset:8704
    ds_read_b128 v[100:103], v120 offset:10240
    ds_read_b128 v[104:107], v116 offset:9792
    ds_read_b128 v[108:111], v120 offset:11264
    ds_read_b128 v[112:115], v116 offset:10880
    s_waitcnt vmcnt(5) lgkmcnt(6)
    v_mfma_f32_16x16x32_bf16 v[0:3], v[64:67], v[88:91], v[0:3]
    ds_read_b128 v[88:91], v120 offset:12288
    s_waitcnt vmcnt(4) lgkmcnt(6)
    v_mfma_f32_16x16x32_bf16 v[4:7], v[64:67], v[92:95], v[4:7]
    v_mfma_f32_16x16x32_bf16 v[0:3], v[68:71], v[92:95], v[0:3]
    ds_read_b128 v[92:95], v116 offset:11968
    s_waitcnt vmcnt(3) lgkmcnt(6)
    v_mfma_f32_16x16x32_bf16 v[32:35], v[80:83], v[96:99], v[32:35]
    ds_read_b128 v[96:99], v120 offset:13312
    s_waitcnt vmcnt(2) lgkmcnt(6)
    v_mfma_f32_16x16x32_bf16 v[8:11], v[64:67], v[100:103], v[8:11]
    v_mfma_f32_16x16x32_bf16 v[4:7], v[68:71], v[100:103], v[4:7]
    v_mfma_f32_16x16x32_bf16 v[0:3], v[72:75], v[100:103], v[0:3]
    ds_read_b128 v[100:103], v116 offset:13056
    s_waitcnt vmcnt(1) lgkmcnt(6)
    v_mfma_f32_16x16x32_bf16 v[36:39], v[80:83], v[104:107], v[36:39]
    v_mfma_f32_16x16x32_bf16 v[32:35], v[84:87], v[104:107], v[32:35]
    ds_read_b128 v[104:107], v120 offset:14336
    s_waitcnt vmcnt(0) lgkmcnt(6)
    v_mfma_f32_16x16x32_bf16 v[12:15], v[64:67], v[108:111], v[12:15]
    v_mfma_f32_16x16x32_bf16 v[8:11], v[68:71], v[108:111], v[8:11]
    v_mfma_f32_16x16x32_bf16 v[4:7], v[72:75], v[108:111], v[4:7]
    v_mfma_f32_16x16x32_bf16 v[0:3], v[76:79], v[108:111], v[0:3]
    ds_read_b128 v[108:111], v116 offset:14144
    s_waitcnt lgkmcnt(6)
    v_mfma_f32_16x16x32_bf16 v[40:43], v[80:83], v[112:115], v[40:43]
    v_mfma_f32_16x16x32_bf16 v[36:39], v[84:87], v[112:115], v[36:39]
    ds_read_b128 v[112:115], v120 offset:15360
    s_waitcnt lgkmcnt(6)
    v_mfma_f32_16x16x32_bf16 v[16:19], v[64:67], v[88:91], v[16:19]
    v_mfma_f32_16x16x32_bf16 v[12:15], v[68:71], v[88:91], v[12:15]
    v_mfma_f32_16x16x32_bf16 v[8:11], v[72:75], v[88:91], v[8:11]
    v_mfma_f32_16x16x32_bf16 v[4:7], v[76:79], v[88:91], v[4:7]
    ds_read_b128 v[88:91], v117 offset:8704
    v_xor_b32 v124, 0, v126
    ds_write_b128 v124, v[32:35]
    s_waitcnt lgkmcnt(7)
    v_mfma_f32_16x16x32_bf16 v[44:47], v[80:83], v[92:95], v[44:47]
    v_mfma_f32_16x16x32_bf16 v[40:43], v[84:87], v[92:95], v[40:43]
    ds_read_b128 v[92:95], v122 offset:0
    v_xor_b32 v123, 0, v125
    ds_write_b128 v123, v[0:3]
    s_waitcnt lgkmcnt(8)
    v_mfma_f32_16x16x32_bf16 v[20:23], v[64:67], v[96:99], v[20:23]
    v_mfma_f32_16x16x32_bf16 v[16:19], v[68:71], v[96:99], v[16:19]
    v_mfma_f32_16x16x32_bf16 v[12:15], v[72:75], v[96:99], v[12:15]
    v_mfma_f32_16x16x32_bf16 v[8:11], v[76:79], v[96:99], v[8:11]
    ds_read_b128 v[96:99], v117 offset:9792
    v_xor_b32 v123, 16, v126
    ds_write_b128 v123, v[36:39]
    s_waitcnt lgkmcnt(9)
    v_mfma_f32_16x16x32_bf16 v[48:51], v[80:83], v[100:103], v[48:51]
    v_mfma_f32_16x16x32_bf16 v[44:47], v[84:87], v[100:103], v[44:47]
    ds_read_b128 v[100:103], v121 offset:9216
    v_xor_b32 v124, 16, v125
    ds_write_b128 v124, v[4:7]
    s_waitcnt lgkmcnt(10)
    v_mfma_f32_16x16x32_bf16 v[24:27], v[64:67], v[104:107], v[24:27]
    v_mfma_f32_16x16x32_bf16 v[20:23], v[68:71], v[104:107], v[20:23]
    v_mfma_f32_16x16x32_bf16 v[16:19], v[72:75], v[104:107], v[16:19]
    v_mfma_f32_16x16x32_bf16 v[12:15], v[76:79], v[104:107], v[12:15]
    ds_read_b128 v[104:107], v118 offset:8704
    v_xor_b32 v124, 32, v126
    ds_write_b128 v124, v[40:43]
    s_waitcnt lgkmcnt(11)
    v_mfma_f32_16x16x32_bf16 v[52:55], v[80:83], v[108:111], v[52:55]
    v_mfma_f32_16x16x32_bf16 v[48:51], v[84:87], v[108:111], v[48:51]
    ds_read_b128 v[108:111], v121 offset:10240
    v_xor_b32 v123, 32, v125
    ds_write_b128 v123, v[8:11]
    s_waitcnt lgkmcnt(12)
    v_mfma_f32_16x16x32_bf16 v[28:31], v[64:67], v[112:115], v[28:31]
    v_mfma_f32_16x16x32_bf16 v[24:27], v[68:71], v[112:115], v[24:27]
    v_mfma_f32_16x16x32_bf16 v[20:23], v[72:75], v[112:115], v[20:23]
    v_mfma_f32_16x16x32_bf16 v[16:19], v[76:79], v[112:115], v[16:19]
    v_xor_b32 v123, 48, v126
    ds_write_b128 v123, v[44:47]
    s_waitcnt lgkmcnt(12)
    v_mfma_f32_16x16x32_bf16 v[56:59], v[80:83], v[88:91], v[56:59]
    v_mfma_f32_16x16x32_bf16 v[52:55], v[84:87], v[88:91], v[52:55]
    v_xor_b32 v124, 48, v125
    ds_write_b128 v124, v[12:15]
    s_waitcnt lgkmcnt(11)
    v_mfma_f32_16x16x32_bf16 v[28:31], v[68:71], v[92:95], v[28:31]
    v_mfma_f32_16x16x32_bf16 v[24:27], v[72:75], v[92:95], v[24:27]
    v_mfma_f32_16x16x32_bf16 v[20:23], v[76:79], v[92:95], v[20:23]
    v_xor_b32 v124, 64, v126
    ds_write_b128 v124, v[48:51]
    s_waitcnt lgkmcnt(10)
    v_mfma_f32_16x16x32_bf16 v[60:63], v[80:83], v[96:99], v[60:63]
    v_mfma_f32_16x16x32_bf16 v[56:59], v[84:87], v[96:99], v[56:59]
    v_xor_b32 v123, 64, v125
    ds_write_b128 v123, v[16:19]
    s_waitcnt lgkmcnt(9)
    v_mfma_f32_16x16x32_bf16 v[28:31], v[72:75], v[100:103], v[28:31]
    v_mfma_f32_16x16x32_bf16 v[24:27], v[76:79], v[100:103], v[24:27]
    v_xor_b32 v123, 80, v126
    ds_write_b128 v123, v[52:55]
    s_waitcnt lgkmcnt(8)
    v_mfma_f32_16x16x32_bf16 v[60:63], v[84:87], v[104:107], v[60:63]
    v_xor_b32 v124, 80, v125
    ds_write_b128 v124, v[20:23]
    s_waitcnt lgkmcnt(7)
    v_mfma_f32_16x16x32_bf16 v[28:31], v[76:79], v[108:111], v[28:31]
    v_xor_b32 v124, 96, v126
    ds_write_b128 v124, v[56:59]
    v_and_b32 v108, 15, v127
    v_lshrrev_b32 v109, 4, v127
    v_lshrrev_b32 v110, 3, v108
    s_lshl_b32 s36, s20, 1
    v_add_u32 v110, s36, v110
    v_xor_b32 v111, v110, v108
    v_and_b32 v111, 7, v111
    v_lshlrev_b32 v111, 4, v111
    v_xor_b32 v123, 96, v125
    ds_write_b128 v123, v[24:27]
    v_lshl_add_u32 v111, v110, 7, v111
    v_lshl_add_u32 v120, v109, 11, v111
    v_add_u32 v121, 65536, v120
    v_add_u32 v64, 131072, v120
    s_lshl_b32 s36, s20, 9
    s_add_u32 s36, s36, 115712
    v_lshl_add_u32 v127, v109, 7, s36
    s_lshl_b32 s36, s20, 4
    v_add_u32 v108, s36, v108
    v_lshlrev_b32 v110, 6, v108
    v_lshl_add_u32 v110, v109, 4, v110
    s_mul_i32 s36, s29, 262144
    v_xor_b32 v123, 112, v126
    ds_write_b128 v123, v[60:63]
    s_lshl_b32 s37, s21, 4
    s_add_u32 s36, s36, s37
    v_add_u32 v110, s36, v110
    v_mov_b32 v111, 2130706432
    v_cmp_gt_u32 vcc, 125, v108
    s_mov_b32 s4, 0xbeaaaaab
    s_mov_b32 s5, s4
    s_mov_b32 s6, 0x3e800000
    s_mov_b32 s7, s6
    s_mov_b32 s8, 0xc0a00000
    s_mov_b32 s9, s8
    s_mov_b32 s10, 0xc0638e39
    v_xor_b32 v124, 112, v125
    ds_write_b128 v124, v[28:31]
    s_mov_b32 s11, s10
    s_mov_b32 s12, 0xbf638e39
    s_mov_b32 s13, s12
    s_mov_b32 s14, 0xbe638e39
    s_mov_b32 s15, s14
    s_mov_b32 s22, 0xbd638e39
    s_mov_b32 s23, s22
    s_mov_b32 s24, 0x3ff1c71c
    s_mov_b32 s25, s24
    s_mov_b32 s26, 0xbf2aaaab
    s_mov_b32 s27, s26
    s_mov_b32 s32, 0x3ecccccd
    s_mov_b32 s33, s32
    s_mov_b32 s34, 0xbd888889
    s_mov_b32 s35, s34
    s_mov_b32 s38, 0xbe4ccccd
    s_mov_b32 s39, s38
    s_mov_b32 s40, 0xbdd2d3e8
    s_mov_b32 s41, s40
    s_mov_b32 s42, 0x3f800000
    s_mov_b32 s43, s42
    s_setprio 0
    s_branch L_conv2_kernel_epi
L_conv2_kernel_helper:
    s_setprio 3
    v_lshlrev_b32 v8, 4, v6
    s_add_u32 s37, s33, 4294967289
    v_lshl_add_u32 v9, v7, 3, s37
    v_cmp_gt_u32 vcc, 8000, v9
    s_mul_i32 s37, s33, 131072
    s_add_u32 s37, s37, 0
    v_lshl_add_u32 v92, v7, 7, s37
    v_add_u32 v92, v92, v8
    v_mov_b32 v9, 2130706432
    v_cndmask_b32 v92, v9, v92, vcc
    s_add_u32 s37, s33, 4294967291
    v_lshl_add_u32 v9, v7, 3, s37
    v_cmp_gt_u32 vcc, 8000, v9
    s_mul_i32 s37, s33, 131072
    s_add_u32 s37, s37, 262144
    v_lshl_add_u32 v93, v7, 7, s37
    v_add_u32 v93, v93, v8
    v_mov_b32 v9, 2130706432
    v_cndmask_b32 v93, v9, v93, vcc
    s_add_u32 s37, s33, 4294967293
    v_lshl_add_u32 v9, v7, 3, s37
    v_cmp_gt_u32 vcc, 8000, v9
    s_mul_i32 s37, s33, 131072
    s_add_u32 s37, s37, 64
    v_lshl_add_u32 v94, v7, 7, s37
    v_add_u32 v94, v94, v8
    v_mov_b32 v9, 2130706432
    v_cndmask_b32 v94, v9, v94, vcc
    s_add_u32 s37, s33, 4294967295
    v_lshl_add_u32 v9, v7, 3, s37
    v_cmp_gt_u32 vcc, 8000, v9
    s_mul_i32 s37, s33, 131072
    s_add_u32 s37, s37, 262208
    v_lshl_add_u32 v95, v7, 7, s37
    v_add_u32 v95, v95, v8
    v_mov_b32 v9, 2130706432
    v_cndmask_b32 v95, v9, v95, vcc
    v_and_b32 v76, 4, v5
    v_lshrrev_b32 v76, 1, v76
    v_xor_b32 v76, v6, v76
    v_lshlrev_b32 v76, 4, v76
    v_lshl_add_u32 v76, v5, 6, v76
    s_mov_b32 s24, 0
    s_mov_b32 s27, 524288
    s_waitcnt lgkmcnt(0)
    s_add_u32 s8, s4, s47
    s_addc_u32 s9, s5, 0
    buffer_load_dwordx4 v[0:3], v92, s[8:11], s24 offen
    buffer_load_dwordx4 v[8:11], v94, s[8:11], s24 offen
    buffer_load_dwordx4 v[4:7], v93, s[8:11], s24 offen
    buffer_load_dwordx4 v[12:15], v95, s[8:11], s24 offen
    buffer_load_dwordx4 v[16:19], v92, s[8:11], s27 offen
    buffer_load_dwordx4 v[24:27], v94, s[8:11], s27 offen
    buffer_load_dwordx4 v[20:23], v93, s[8:11], s27 offen
    buffer_load_dwordx4 v[28:31], v95, s[8:11], s27 offen
    s_mul_i32 s36, s42, 1024
    v_add_u32 v96, s36, v76
    v_add_u32 v97, 65536, v96
    s_mul_i32 s36, s42, 1088
    s_add_u32 s36, s36, 98304
    v_add_u32 v98, s36, v76
    s_waitcnt vmcnt(0)
    s_mov_b32 s28, 0
    s_mov_b32 s22, 2
    s_cmp_ge_u32 s20, 12
    s_cbranch_scc1 L_conv2_kernel_h2
    ds_write_b128 v96, v[0:3] offset:0
    ds_write_b128 v98, v[12:15] offset:0
    v_lshlrev_b32 v76, 16, v0
    v_and_b32 v84, s25, v0
    v_lshlrev_b32 v77, 16, v4
    v_and_b32 v85, s25, v4
    v_lshlrev_b32 v78, 16, v8
    v_and_b32 v86, s25, v8
    v_lshlrev_b32 v79, 16, v12
    v_and_b32 v87, s25, v12
    v_add_f32 v80, v76, v78
    v_add_f32 v88, v84, v86
    v_add_f32 v81, v77, v79
    v_add_f32 v89, v85, v87
    v_fma_f32 v82, v78, 4.0, v76
    v_fma_f32 v90, v86, 4.0, v84
    v_fma_f32 v83, v79, 4.0, v77
    v_fma_f32 v91, v87, 4.0, v85
    v_add_f32 v77, v80, v81
    v_add_f32 v85, v88, v89
    v_sub_f32 v78, v80, v81
    v_sub_f32 v86, v88, v89
    v_fma_f32 v79, v83, 2.0, v82
    v_fma_f32 v87, v91, 2.0, v90
    v_fma_f32 v82, v83, -2.0, v82
    v_fma_f32 v90, v91, -2.0, v90
    v_fmamk_f32 v80, v76, 0x41700000, v82
    v_fmamk_f32 v88, v84, 0x41700000, v90
    v_fmamk_f32 v80, v81, 0x41200000, v80
    v_fmamk_f32 v88, v89, 0x41200000, v88
    v_cvt_pk_bf16_f32 v4, v77, v85
    v_cvt_pk_bf16_f32 v8, v78, v86
    v_cvt_pk_bf16_f32 v64, v79, v87
    v_cvt_pk_bf16_f32 v68, v82, v90
    v_cvt_pk_bf16_f32 v72, v80, v88
    v_lshlrev_b32 v76, 16, v1
    v_and_b32 v84, s25, v1
    v_lshlrev_b32 v77, 16, v5
    v_and_b32 v85, s25, v5
    v_lshlrev_b32 v78, 16, v9
    v_and_b32 v86, s25, v9
    v_lshlrev_b32 v79, 16, v13
    v_and_b32 v87, s25, v13
    v_add_f32 v80, v76, v78
    v_add_f32 v88, v84, v86
    v_add_f32 v81, v77, v79
    v_add_f32 v89, v85, v87
    v_fma_f32 v82, v78, 4.0, v76
    v_fma_f32 v90, v86, 4.0, v84
    v_fma_f32 v83, v79, 4.0, v77
    v_fma_f32 v91, v87, 4.0, v85
    v_add_f32 v77, v80, v81
    v_add_f32 v85, v88, v89
    v_sub_f32 v78, v80, v81
    v_sub_f32 v86, v88, v89
    v_fma_f32 v79, v83, 2.0, v82
    v_fma_f32 v87, v91, 2.0, v90
    v_fma_f32 v82, v83, -2.0, v82
    v_fma_f32 v90, v91, -2.0, v90
    v_fmamk_f32 v80, v76, 0x41700000, v82
    v_fmamk_f32 v88, v84, 0x41700000, v90
    v_fmamk_f32 v80, v81, 0x41200000, v80
    v_fmamk_f32 v88, v89, 0x41200000, v88
    v_cvt_pk_bf16_f32 v5, v77, v85
    v_cvt_pk_bf16_f32 v9, v78, v86
    v_cvt_pk_bf16_f32 v65, v79, v87
    v_cvt_pk_bf16_f32 v69, v82, v90
    v_cvt_pk_bf16_f32 v73, v80, v88
    v_lshlrev_b32 v76, 16, v2
    v_and_b32 v84, s25, v2
    v_lshlrev_b32 v77, 16, v6
    v_and_b32 v85, s25, v6
    v_lshlrev_b32 v78, 16, v10
    v_and_b32 v86, s25, v10
    v_lshlrev_b32 v79, 16, v14
    v_and_b32 v87, s25, v14
    v_add_f32 v80, v76, v78
    v_add_f32 v88, v84, v86
    v_add_f32 v81, v77, v79
    v_add_f32 v89, v85, v87
    v_fma_f32 v82, v78, 4.0, v76
    v_fma_f32 v90, v86, 4.0, v84
    v_fma_f32 v83, v79, 4.0, v77
    v_fma_f32 v91, v87, 4.0, v85
    v_add_f32 v77, v80, v81
    v_add_f32 v85, v88, v89
    v_sub_f32 v78, v80, v81
    v_sub_f32 v86, v88, v89
    v_fma_f32 v79, v83, 2.0, v82
    v_fma_f32 v87, v91, 2.0, v90
    v_fma_f32 v82, v83, -2.0, v82
    v_fma_f32 v90, v91, -2.0, v90
    v_fmamk_f32 v80, v76, 0x41700000, v82
    v_fmamk_f32 v88, v84, 0x41700000, v90
    v_fmamk_f32 v80, v81, 0x41200000, v80
    v_fmamk_f32 v88, v89, 0x41200000, v88
    v_cvt_pk_bf16_f32 v6, v77, v85
    v_cvt_pk_bf16_f32 v10, v78, v86
    v_cvt_pk_bf16_f32 v66, v79, v87
    v_cvt_pk_bf16_f32 v70, v82, v90
    v_cvt_pk_bf16_f32 v74, v80, v88
    v_lshlrev_b32 v76, 16, v3
    v_and_b32 v84, s25, v3
    v_lshlrev_b32 v77, 16, v7
    v_and_b32 v85, s25, v7
    v_lshlrev_b32 v78, 16, v11
    v_and_b32 v86, s25, v11
    v_lshlrev_b32 v79, 16, v15
    v_and_b32 v87, s25, v15
    v_add_f32 v80, v76, v78
    v_add_f32 v88, v84, v86
    v_add_f32 v81, v77, v79
    v_add_f32 v89, v85, v87
    v_fma_f32 v82, v78, 4.0, v76
    v_fma_f32 v90, v86, 4.0, v84
    v_fma_f32 v83, v79, 4.0, v77
    v_fma_f32 v91, v87, 4.0, v85
    v_add_f32 v77, v80, v81
    v_add_f32 v85, v88, v89
    v_sub_f32 v78, v80, v81
    v_sub_f32 v86, v88, v89
    v_fma_f32 v79, v83, 2.0, v82
    v_fma_f32 v87, v91, 2.0, v90
    v_fma_f32 v82, v83, -2.0, v82
    v_fma_f32 v90, v91, -2.0, v90
    v_fmamk_f32 v80, v76, 0x41700000, v82
    v_fmamk_f32 v88, v84, 0x41700000, v90
    v_fmamk_f32 v80, v81, 0x41200000, v80
    v_fmamk_f32 v88, v89, 0x41200000, v88
    v_cvt_pk_bf16_f32 v7, v77, v85
    v_cvt_pk_bf16_f32 v11, v78, v86
    v_cvt_pk_bf16_f32 v67, v79, v87
    v_cvt_pk_bf16_f32 v71, v82, v90
    v_cvt_pk_bf16_f32 v75, v80, v88
    ds_write_b128 v96, v[64:67] offset:49152
    ds_write_b128 v97, v[68:71] offset:0
    ds_write_b128 v97, v[72:75] offset:16384
    ds_write_b128 v96, v[4:7] offset:16384
    ds_write_b128 v96, v[8:11] offset:32768
    s_waitcnt vmcnt(0)
    s_mov_b32 s24, 1048576
    s_mov_b32 s27, 1572864
    s_waitcnt lgkmcnt(0)
    s_barrier
    buffer_load_dwordx4 v[32:35], v92, s[8:11], s24 offen
    buffer_load_dwordx4 v[40:43], v94, s[8:11], s24 offen
    buffer_load_dwordx4 v[36:39], v93, s[8:11], s24 offen
    buffer_load_dwordx4 v[44:47], v95, s[8:11], s24 offen
    s_setprio 1
L_conv2_kernel_hloop1:
    v_lshlrev_b32 v76, 16, v16
    v_and_b32 v84, s25, v16
    v_lshlrev_b32 v77, 16, v20
    v_and_b32 v85, s25, v20
    v_lshlrev_b32 v78, 16, v24
    v_and_b32 v86, s25, v24
    v_lshlrev_b32 v79, 16, v28
    v_and_b32 v87, s25, v28
    v_add_f32 v80, v76, v78
    v_add_f32 v88, v84, v86
    v_add_f32 v81, v77, v79
    v_add_f32 v89, v85, v87
    v_fma_f32 v82, v78, 4.0, v76
    buffer_load_dwordx4 v[48:51], v92, s[8:11], s27 offen
    buffer_load_dwordx4 v[56:59], v94, s[8:11], s27 offen
    v_fma_f32 v90, v86, 4.0, v84
    v_fma_f32 v83, v79, 4.0, v77
    v_fma_f32 v91, v87, 4.0, v85
    v_add_f32 v77, v80, v81
    v_add_f32 v85, v88, v89
    v_sub_f32 v78, v80, v81
    v_sub_f32 v86, v88, v89
    v_fma_f32 v79, v83, 2.0, v82
    v_fma_f32 v87, v91, 2.0, v90
    v_fma_f32 v82, v83, -2.0, v82
    v_fma_f32 v90, v91, -2.0, v90
    v_fmamk_f32 v80, v76, 0x41700000, v82
    v_fmamk_f32 v88, v84, 0x41700000, v90
    v_fmamk_f32 v80, v81, 0x41200000, v80
    v_fmamk_f32 v88, v89, 0x41200000, v88
    v_cvt_pk_bf16_f32 v20, v77, v85
    v_cvt_pk_bf16_f32 v24, v78, v86
    v_cvt_pk_bf16_f32 v64, v79, v87
    v_cvt_pk_bf16_f32 v68, v82, v90
    v_cvt_pk_bf16_f32 v72, v80, v88
    v_lshlrev_b32 v76, 16, v17
    v_and_b32 v84, s25, v17
    v_lshlrev_b32 v77, 16, v21
    v_and_b32 v85, s25, v21
    v_lshlrev_b32 v78, 16, v25
    v_and_b32 v86, s25, v25
    v_lshlrev_b32 v79, 16, v29
    v_and_b32 v87, s25, v29
    v_add_f32 v80, v76, v78
    v_add_f32 v88, v84, v86
    v_add_f32 v81, v77, v79
    v_add_f32 v89, v85, v87
    v_fma_f32 v82, v78, 4.0, v76
    v_fma_f32 v90, v86, 4.0, v84
    v_fma_f32 v83, v79, 4.0, v77
    v_fma_f32 v91, v87, 4.0, v85
    v_add_f32 v77, v80, v81
    v_add_f32 v85, v88, v89
    v_sub_f32 v78, v80, v81
    v_sub_f32 v86, v88, v89
    v_fma_f32 v79, v83, 2.0, v82
    v_fma_f32 v87, v91, 2.0, v90
    v_fma_f32 v82, v83, -2.0, v82
    v_fma_f32 v90, v91, -2.0, v90
    v_fmamk_f32 v80, v76, 0x41700000, v82
    v_fmamk_f32 v88, v84, 0x41700000, v90
    v_fmamk_f32 v80, v81, 0x41200000, v80
    v_fmamk_f32 v88, v89, 0x41200000, v88
    v_cvt_pk_bf16_f32 v21, v77, v85
    v_cvt_pk_bf16_f32 v25, v78, v86
    v_cvt_pk_bf16_f32 v65, v79, v87
    v_cvt_pk_bf16_f32 v69, v82, v90
    v_cvt_pk_bf16_f32 v73, v80, v88
    buffer_load_dwordx4 v[52:55], v93, s[8:11], s27 offen
    buffer_load_dwordx4 v[60:63], v95, s[8:11], s27 offen
    v_lshlrev_b32 v76, 16, v18
    v_and_b32 v84, s25, v18
    v_lshlrev_b32 v77, 16, v22
    v_and_b32 v85, s25, v22
    v_lshlrev_b32 v78, 16, v26
    v_and_b32 v86, s25, v26
    v_lshlrev_b32 v79, 16, v30
    v_and_b32 v87, s25, v30
    v_add_f32 v80, v76, v78
    v_add_f32 v88, v84, v86
    v_add_f32 v81, v77, v79
    v_add_f32 v89, v85, v87
    v_fma_f32 v82, v78, 4.0, v76
    v_fma_f32 v90, v86, 4.0, v84
    v_fma_f32 v83, v79, 4.0, v77
    v_fma_f32 v91, v87, 4.0, v85
    v_add_f32 v77, v80, v81
    v_add_f32 v85, v88, v89
    v_sub_f32 v78, v80, v81
    v_sub_f32 v86, v88, v89
    v_fma_f32 v79, v83, 2.0, v82
    v_fma_f32 v87, v91, 2.0, v90
    v_fma_f32 v82, v83, -2.0, v82
    v_fma_f32 v90, v91, -2.0, v90
    v_fmamk_f32 v80, v76, 0x41700000, v82
    v_fmamk_f32 v88, v84, 0x41700000, v90
    v_fmamk_f32 v80, v81, 0x41200000, v80
    v_fmamk_f32 v88, v89, 0x41200000, v88
    v_cvt_pk_bf16_f32 v22, v77, v85
    v_cvt_pk_bf16_f32 v26, v78, v86
    v_cvt_pk_bf16_f32 v66, v79, v87
    v_cvt_pk_bf16_f32 v70, v82, v90
    v_cvt_pk_bf16_f32 v74, v80, v88
    v_lshlrev_b32 v76, 16, v19
    v_and_b32 v84, s25, v19
    v_lshlrev_b32 v77, 16, v23
    v_and_b32 v85, s25, v23
    v_lshlrev_b32 v78, 16, v27
    v_and_b32 v86, s25, v27
    v_lshlrev_b32 v79, 16, v31
    v_and_b32 v87, s25, v31
    v_add_f32 v80, v76, v78
    v_add_f32 v88, v84, v86
    v_add_f32 v81, v77, v79
    v_add_f32 v89, v85, v87
    v_fma_f32 v82, v78, 4.0, v76
    v_fma_f32 v90, v86, 4.0, v84
    v_fma_f32 v83, v79, 4.0, v77
    v_fma_f32 v91, v87, 4.0, v85
    v_add_f32 v77, v80, v81
    v_add_f32 v85, v88, v89
    v_sub_f32 v78, v80, v81
    v_sub_f32 v86, v88, v89
    v_fma_f32 v79, v83, 2.0, v82
    v_fma_f32 v87, v91, 2.0, v90
    v_fma_f32 v82, v83, -2.0, v82
    v_fma_f32 v90, v91, -2.0, v90
    v_fmamk_f32 v80, v76, 0x41700000, v82
    v_fmamk_f32 v88, v84, 0x41700000, v90
    v_fmamk_f32 v80, v81, 0x41200000, v80
    v_fmamk_f32 v88, v89, 0x41200000, v88
    v_cvt_pk_bf16_f32 v23, v77, v85
    v_cvt_pk_bf16_f32 v27, v78, v86
    v_cvt_pk_bf16_f32 v67, v79, v87
    v_cvt_pk_bf16_f32 v71, v82, v90
    v_cvt_pk_bf16_f32 v75, v80, v88
    ds_write_b128 v96, v[64:67] offset:57344
    ds_write_b128 v97, v[68:71] offset:8192
    ds_write_b128 v97, v[72:75] offset:24576
    ds_write_b128 v96, v[16:19] offset:8192
    ds_write_b128 v96, v[20:23] offset:24576
    ds_write_b128 v96, v[24:27] offset:40960
    ds_write_b128 v98, v[28:31] offset:8704
    s_add_u32 s28, s28, 1
    s_waitcnt lgkmcnt(0)
    s_barrier
    s_add_u32 s24, s24, 1048576
    s_add_u32 s27, s27, 1048576
    s_waitcnt vmcnt(0)
    v_lshlrev_b32 v76, 16, v32
    v_and_b32 v84, s25, v32
    v_lshlrev_b32 v77, 16, v36
    v_and_b32 v85, s25, v36
    v_lshlrev_b32 v78, 16, v40
    v_and_b32 v86, s25, v40
    v_lshlrev_b32 v79, 16, v44
    v_and_b32 v87, s25, v44
    v_add_f32 v80, v76, v78
    v_add_f32 v88, v84, v86
    v_add_f32 v81, v77, v79
    v_add_f32 v89, v85, v87
    v_fma_f32 v82, v78, 4.0, v76
    v_fma_f32 v90, v86, 4.0, v84
    v_fma_f32 v83, v79, 4.0, v77
    v_fma_f32 v91, v87, 4.0, v85
    v_add_f32 v77, v80, v81
    v_add_f32 v85, v88, v89
    v_sub_f32 v78, v80, v81
    v_sub_f32 v86, v88, v89
    v_fma_f32 v79, v83, 2.0, v82
    v_fma_f32 v87, v91, 2.0, v90
    v_fma_f32 v82, v83, -2.0, v82
    v_fma_f32 v90, v91, -2.0, v90
    v_fmamk_f32 v80, v76, 0x41700000, v82
    v_fmamk_f32 v88, v84, 0x41700000, v90
    v_fmamk_f32 v80, v81, 0x41200000, v80
    v_fmamk_f32 v88, v89, 0x41200000, v88
    v_cvt_pk_bf16_f32 v36, v77, v85
    v_cvt_pk_bf16_f32 v40, v78, v86
    v_cvt_pk_bf16_f32 v64, v79, v87
    v_cvt_pk_bf16_f32 v68, v82, v90
    v_cvt_pk_bf16_f32 v72, v80, v88
    v_lshlrev_b32 v76, 16, v33
    v_and_b32 v84, s25, v33
    v_lshlrev_b32 v77, 16, v37
    v_and_b32 v85, s25, v37
    v_lshlrev_b32 v78, 16, v41
    v_and_b32 v86, s25, v41
    buffer_load_dwordx4 v[0:3], v92, s[8:11], s24 offen
    buffer_load_dwordx4 v[8:11], v94, s[8:11], s24 offen
    v_lshlrev_b32 v79, 16, v45
    v_and_b32 v87, s25, v45
    v_add_f32 v80, v76, v78
    v_add_f32 v88, v84, v86
    v_add_f32 v81, v77, v79
    v_add_f32 v89, v85, v87
    v_fma_f32 v82, v78, 4.0, v76
    v_fma_f32 v90, v86, 4.0, v84
    v_fma_f32 v83, v79, 4.0, v77
    v_fma_f32 v91, v87, 4.0, v85
    v_add_f32 v77, v80, v81
    v_add_f32 v85, v88, v89
    v_sub_f32 v78, v80, v81
    v_sub_f32 v86, v88, v89
    v_fma_f32 v79, v83, 2.0, v82
    v_fma_f32 v87, v91, 2.0, v90
    v_fma_f32 v82, v83, -2.0, v82
    v_fma_f32 v90, v91, -2.0, v90
    v_fmamk_f32 v80, v76, 0x41700000, v82
    v_fmamk_f32 v88, v84, 0x41700000, v90
    v_fmamk_f32 v80, v81, 0x41200000, v80
    v_fmamk_f32 v88, v89, 0x41200000, v88
    v_cvt_pk_bf16_f32 v37, v77, v85
    v_cvt_pk_bf16_f32 v41, v78, v86
    v_cvt_pk_bf16_f32 v65, v79, v87
    v_cvt_pk_bf16_f32 v69, v82, v90
    v_cvt_pk_bf16_f32 v73, v80, v88
    v_lshlrev_b32 v76, 16, v34
    v_and_b32 v84, s25, v34
    v_lshlrev_b32 v77, 16, v38
    v_and_b32 v85, s25, v38
    v_lshlrev_b32 v78, 16, v42
    v_and_b32 v86, s25, v42
    v_lshlrev_b32 v79, 16, v46
    v_and_b32 v87, s25, v46
    v_add_f32 v80, v76, v78
    v_add_f32 v88, v84, v86
    v_add_f32 v81, v77, v79
    v_add_f32 v89, v85, v87
    v_fma_f32 v82, v78, 4.0, v76
    v_fma_f32 v90, v86, 4.0, v84
    v_fma_f32 v83, v79, 4.0, v77
    v_fma_f32 v91, v87, 4.0, v85
    v_add_f32 v77, v80, v81
    v_add_f32 v85, v88, v89
    v_sub_f32 v78, v80, v81
    v_sub_f32 v86, v88, v89
    v_fma_f32 v79, v83, 2.0, v82
    v_fma_f32 v87, v91, 2.0, v90
    v_fma_f32 v82, v83, -2.0, v82
    v_fma_f32 v90, v91, -2.0, v90
    v_fmamk_f32 v80, v76, 0x41700000, v82
    v_fmamk_f32 v88, v84, 0x41700000, v90
    buffer_load_dwordx4 v[4:7], v93, s[8:11], s24 offen
    buffer_load_dwordx4 v[12:15], v95, s[8:11], s24 offen
    v_fmamk_f32 v80, v81, 0x41200000, v80
    v_fmamk_f32 v88, v89, 0x41200000, v88
    v_cvt_pk_bf16_f32 v38, v77, v85
    v_cvt_pk_bf16_f32 v42, v78, v86
    v_cvt_pk_bf16_f32 v66, v79, v87
    v_cvt_pk_bf16_f32 v70, v82, v90
    v_cvt_pk_bf16_f32 v74, v80, v88
    v_lshlrev_b32 v76, 16, v35
    v_and_b32 v84, s25, v35
    v_lshlrev_b32 v77, 16, v39
    v_and_b32 v85, s25, v39
    v_lshlrev_b32 v78, 16, v43
    v_and_b32 v86, s25, v43
    v_lshlrev_b32 v79, 16, v47
    v_and_b32 v87, s25, v47
    v_add_f32 v80, v76, v78
    v_add_f32 v88, v84, v86
    v_add_f32 v81, v77, v79
    v_add_f32 v89, v85, v87
    v_fma_f32 v82, v78, 4.0, v76
    v_fma_f32 v90, v86, 4.0, v84
    v_fma_f32 v83, v79, 4.0, v77
    v_fma_f32 v91, v87, 4.0, v85
    v_add_f32 v77, v80, v81
    v_add_f32 v85, v88, v89
    v_sub_f32 v78, v80, v81
    v_sub_f32 v86, v88, v89
    v_fma_f32 v79, v83, 2.0, v82
    v_fma_f32 v87, v91, 2.0, v90
    v_fma_f32 v82, v83, -2.0, v82
    v_fma_f32 v90, v91, -2.0, v90
    v_fmamk_f32 v80, v76, 0x41700000, v82
    v_fmamk_f32 v88, v84, 0x41700000, v90
    v_fmamk_f32 v80, v81, 0x41200000, v80
    v_fmamk_f32 v88, v89, 0x41200000, v88
    v_cvt_pk_bf16_f32 v39, v77, v85
    v_cvt_pk_bf16_f32 v43, v78, v86
    v_cvt_pk_bf16_f32 v67, v79, v87
    v_cvt_pk_bf16_f32 v71, v82, v90
    v_cvt_pk_bf16_f32 v75, v80, v88
    ds_write_b128 v96, v[64:67] offset:49152
    ds_write_b128 v97, v[68:71] offset:0
    ds_write_b128 v97, v[72:75] offset:16384
    ds_write_b128 v96, v[32:35] offset:0
    ds_write_b128 v96, v[36:39] offset:16384
    ds_write_b128 v96, v[40:43] offset:32768
    ds_write_b128 v98, v[44:47] offset:0
    s_add_u32 s28, s28, 1
    s_waitcnt lgkmcnt(0)
    s_barrier
    v_lshlrev_b32 v76, 16, v48
    v_and_b32 v84, s25, v48
    v_lshlrev_b32 v77, 16, v52
    v_and_b32 v85, s25, v52
    v_lshlrev_b32 v78, 16, v56
    v_and_b32 v86, s25, v56
    v_lshlrev_b32 v79, 16, v60
    v_and_b32 v87, s25, v60
    v_add_f32 v80, v76, v78
    v_add_f32 v88, v84, v86
    v_add_f32 v81, v77, v79
    v_add_f32 v89, v85, v87
    v_fma_f32 v82, v78, 4.0, v76
    buffer_load_dwordx4 v[16:19], v92, s[8:11], s27 offen
    buffer_load_dwordx4 v[24:27], v94, s[8:11], s27 offen
    v_fma_f32 v90, v86, 4.0, v84
    v_fma_f32 v83, v79, 4.0, v77
    v_fma_f32 v91, v87, 4.0, v85
    v_add_f32 v77, v80, v81
    v_add_f32 v85, v88, v89
    v_sub_f32 v78, v80, v81
    v_sub_f32 v86, v88, v89
    v_fma_f32 v79, v83, 2.0, v82
    v_fma_f32 v87, v91, 2.0, v90
    v_fma_f32 v82, v83, -2.0, v82
    v_fma_f32 v90, v91, -2.0, v90
    v_fmamk_f32 v80, v76, 0x41700000, v82
    v_fmamk_f32 v88, v84, 0x41700000, v90
    v_fmamk_f32 v80, v81, 0x41200000, v80
    v_fmamk_f32 v88, v89, 0x41200000, v88
    v_cvt_pk_bf16_f32 v52, v77, v85
    v_cvt_pk_bf16_f32 v56, v78, v86
    v_cvt_pk_bf16_f32 v64, v79, v87
    v_cvt_pk_bf16_f32 v68, v82, v90
    v_cvt_pk_bf16_f32 v72, v80, v88
    v_lshlrev_b32 v76, 16, v49
    v_and_b32 v84, s25, v49
    v_lshlrev_b32 v77, 16, v53
    v_and_b32 v85, s25, v53
    v_lshlrev_b32 v78, 16, v57
    v_and_b32 v86, s25, v57
    v_lshlrev_b32 v79, 16, v61
    v_and_b32 v87, s25, v61
    v_add_f32 v80, v76, v78
    v_add_f32 v88, v84, v86
    v_add_f32 v81, v77, v79
    v_add_f32 v89, v85, v87
    v_fma_f32 v82, v78, 4.0, v76
    v_fma_f32 v90, v86, 4.0, v84
    v_fma_f32 v83, v79, 4.0, v77
    v_fma_f32 v91, v87, 4.0, v85
    v_add_f32 v77, v80, v81
    v_add_f32 v85, v88, v89
    v_sub_f32 v78, v80, v81
    v_sub_f32 v86, v88, v89
    v_fma_f32 v79, v83, 2.0, v82
    v_fma_f32 v87, v91, 2.0, v90
    v_fma_f32 v82, v83, -2.0, v82
    v_fma_f32 v90, v91, -2.0, v90
    v_fmamk_f32 v80, v76, 0x41700000, v82
    v_fmamk_f32 v88, v84, 0x41700000, v90
    v_fmamk_f32 v80, v81, 0x41200000, v80
    v_fmamk_f32 v88, v89, 0x41200000, v88
    v_cvt_pk_bf16_f32 v53, v77, v85
    v_cvt_pk_bf16_f32 v57, v78, v86
    v_cvt_pk_bf16_f32 v65, v79, v87
    v_cvt_pk_bf16_f32 v69, v82, v90
    v_cvt_pk_bf16_f32 v73, v80, v88
    buffer_load_dwordx4 v[20:23], v93, s[8:11], s27 offen
    buffer_load_dwordx4 v[28:31], v95, s[8:11], s27 offen
    v_lshlrev_b32 v76, 16, v50
    v_and_b32 v84, s25, v50
    v_lshlrev_b32 v77, 16, v54
    v_and_b32 v85, s25, v54
    v_lshlrev_b32 v78, 16, v58
    v_and_b32 v86, s25, v58
    v_lshlrev_b32 v79, 16, v62
    v_and_b32 v87, s25, v62
    v_add_f32 v80, v76, v78
    v_add_f32 v88, v84, v86
    v_add_f32 v81, v77, v79
    v_add_f32 v89, v85, v87
    v_fma_f32 v82, v78, 4.0, v76
    v_fma_f32 v90, v86, 4.0, v84
    v_fma_f32 v83, v79, 4.0, v77
    v_fma_f32 v91, v87, 4.0, v85
    v_add_f32 v77, v80, v81
    v_add_f32 v85, v88, v89
    v_sub_f32 v78, v80, v81
    v_sub_f32 v86, v88, v89
    v_fma_f32 v79, v83, 2.0, v82
    v_fma_f32 v87, v91, 2.0, v90
    v_fma_f32 v82, v83, -2.0, v82
    v_fma_f32 v90, v91, -2.0, v90
    v_fmamk_f32 v80, v76, 0x41700000, v82
    v_fmamk_f32 v88, v84, 0x41700000, v90
    v_fmamk_f32 v80, v81, 0x41200000, v80
    v_fmamk_f32 v88, v89, 0x41200000, v88
    v_cvt_pk_bf16_f32 v54, v77, v85
    v_cvt_pk_bf16_f32 v58, v78, v86
    v_cvt_pk_bf16_f32 v66, v79, v87
    v_cvt_pk_bf16_f32 v70, v82, v90
    v_cvt_pk_bf16_f32 v74, v80, v88
    v_lshlrev_b32 v76, 16, v51
    v_and_b32 v84, s25, v51
    v_lshlrev_b32 v77, 16, v55
    v_and_b32 v85, s25, v55
    v_lshlrev_b32 v78, 16, v59
    v_and_b32 v86, s25, v59
    v_lshlrev_b32 v79, 16, v63
    v_and_b32 v87, s25, v63
    v_add_f32 v80, v76, v78
    v_add_f32 v88, v84, v86
    v_add_f32 v81, v77, v79
    v_add_f32 v89, v85, v87
    v_fma_f32 v82, v78, 4.0, v76
    v_fma_f32 v90, v86, 4.0, v84
    v_fma_f32 v83, v79, 4.0, v77
    v_fma_f32 v91, v87, 4.0, v85
    v_add_f32 v77, v80, v81
    v_add_f32 v85, v88, v89
    v_sub_f32 v78, v80, v81
    v_sub_f32 v86, v88, v89
    v_fma_f32 v79, v83, 2.0, v82
    v_fma_f32 v87, v91, 2.0, v90
    v_fma_f32 v82, v83, -2.0, v82
    v_fma_f32 v90, v91, -2.0, v90
    v_fmamk_f32 v80, v76, 0x41700000, v82
    v_fmamk_f32 v88, v84, 0x41700000, v90
    v_fmamk_f32 v80, v81, 0x41200000, v80
    v_fmamk_f32 v88, v89, 0x41200000, v88
    v_cvt_pk_bf16_f32 v55, v77, v85
    v_cvt_pk_bf16_f32 v59, v78, v86
    v_cvt_pk_bf16_f32 v67, v79, v87
    v_cvt_pk_bf16_f32 v71, v82, v90
    v_cvt_pk_bf16_f32 v75, v80, v88
    ds_write_b128 v96, v[64:67] offset:57344
    ds_write_b128 v97, v[68:71] offset:8192
    ds_write_b128 v97, v[72:75] offset:24576
    ds_write_b128 v96, v[48:51] offset:8192
    ds_write_b128 v96, v[52:55] offset:24576
    ds_write_b128 v96, v[56:59] offset:40960
    ds_write_b128 v98, v[60:63] offset:8704
    s_add_u32 s28, s28, 1
    s_waitcnt lgkmcnt(0)
    s_barrier
    s_cmp_eq_u32 s22, 1
    s_cbranch_scc1 L_conv2_kernel_hlast1
    s_add_u32 s24, s24, 1048576
    s_add_u32 s27, s27, 1048576
    s_waitcnt vmcnt(0)
    v_lshlrev_b32 v76, 16, v0
    v_and_b32 v84, s25, v0
    v_lshlrev_b32 v77, 16, v4
    v_and_b32 v85, s25, v4
    v_lshlrev_b32 v78, 16, v8
    v_and_b32 v86, s25, v8
    v_lshlrev_b32 v79, 16, v12
    v_and_b32 v87, s25, v12
    v_add_f32 v80, v76, v78
    v_add_f32 v88, v84, v86
    v_add_f32 v81, v77, v79
    v_add_f32 v89, v85, v87
    v_fma_f32 v82, v78, 4.0, v76
    v_fma_f32 v90, v86, 4.0, v84
    v_fma_f32 v83, v79, 4.0, v77
    v_fma_f32 v91, v87, 4.0, v85
    v_add_f32 v77, v80, v81
    v_add_f32 v85, v88, v89
    v_sub_f32 v78, v80, v81
    v_sub_f32 v86, v88, v89
    v_fma_f32 v79, v83, 2.0, v82
    v_fma_f32 v87, v91, 2.0, v90
    v_fma_f32 v82, v83, -2.0, v82
    v_fma_f32 v90, v91, -2.0, v90
    v_fmamk_f32 v80, v76, 0x41700000, v82
    v_fmamk_f32 v88, v84, 0x41700000, v90
    v_fmamk_f32 v80, v81, 0x41200000, v80
    v_fmamk_f32 v88, v89, 0x41200000, v88
    v_cvt_pk_bf16_f32 v4, v77, v85
    v_cvt_pk_bf16_f32 v8, v78, v86
    v_cvt_pk_bf16_f32 v64, v79, v87
    v_cvt_pk_bf16_f32 v68, v82, v90
    v_cvt_pk_bf16_f32 v72, v80, v88
    v_lshlrev_b32 v76, 16, v1
    v_and_b32 v84, s25, v1
    v_lshlrev_b32 v77, 16, v5
    v_and_b32 v85, s25, v5
    v_lshlrev_b32 v78, 16, v9
    v_and_b32 v86, s25, v9
    buffer_load_dwordx4 v[32:35], v92, s[8:11], s24 offen
    buffer_load_dwordx4 v[40:43], v94, s[8:11], s24 offen
    v_lshlrev_b32 v79, 16, v13
    v_and_b32 v87, s25, v13
    v_add_f32 v80, v76, v78
    v_add_f32 v88, v84, v86
    v_add_f32 v81, v77, v79
    v_add_f32 v89, v85, v87
    v_fma_f32 v82, v78, 4.0, v76
    v_fma_f32 v90, v86, 4.0, v84
    v_fma_f32 v83, v79, 4.0, v77
    v_fma_f32 v91, v87, 4.0, v85
    v_add_f32 v77, v80, v81
    v_add_f32 v85, v88, v89
    v_sub_f32 v78, v80, v81
    v_sub_f32 v86, v88, v89
    v_fma_f32 v79, v83, 2.0, v82
    v_fma_f32 v87, v91, 2.0, v90
    v_fma_f32 v82, v83, -2.0, v82
    v_fma_f32 v90, v91, -2.0, v90
    v_fmamk_f32 v80, v76, 0x41700000, v82
    v_fmamk_f32 v88, v84, 0x41700000, v90
    v_fmamk_f32 v80, v81, 0x41200000, v80
    v_fmamk_f32 v88, v89, 0x41200000, v88
    v_cvt_pk_bf16_f32 v5, v77, v85
    v_cvt_pk_bf16_f32 v9, v78, v86
    v_cvt_pk_bf16_f32 v65, v79, v87
    v_cvt_pk_bf16_f32 v69, v82, v90
    v_cvt_pk_bf16_f32 v73, v80, v88
    v_lshlrev_b32 v76, 16, v2
    v_and_b32 v84, s25, v2
    v_lshlrev_b32 v77, 16, v6
    v_and_b32 v85, s25, v6
    v_lshlrev_b32 v78, 16, v10
    v_and_b32 v86, s25, v10
    v_lshlrev_b32 v79, 16, v14
    v_and_b32 v87, s25, v14
    v_add_f32 v80, v76, v78
    v_add_f32 v88, v84, v86
    v_add_f32 v81, v77, v79
    v_add_f32 v89, v85, v87
    v_fma_f32 v82, v78, 4.0, v76
    v_fma_f32 v90, v86, 4.0, v84
    v_fma_f32 v83, v79, 4.0, v77
    v_fma_f32 v91, v87, 4.0, v85
    v_add_f32 v77, v80, v81
    v_add_f32 v85, v88, v89
    v_sub_f32 v78, v80, v81
    v_sub_f32 v86, v88, v89
    v_fma_f32 v79, v83, 2.0, v82
    v_fma_f32 v87, v91, 2.0, v90
    v_fma_f32 v82, v83, -2.0, v82
    v_fma_f32 v90, v91, -2.0, v90
    v_fmamk_f32 v80, v76, 0x41700000, v82
    v_fmamk_f32 v88, v84, 0x41700000, v90
    buffer_load_dwordx4 v[36:39], v93, s[8:11], s24 offen
    buffer_load_dwordx4 v[44:47], v95, s[8:11], s24 offen
    v_fmamk_f32 v80, v81, 0x41200000, v80
    v_fmamk_f32 v88, v89, 0x41200000, v88
    v_cvt_pk_bf16_f32 v6, v77, v85
    v_cvt_pk_bf16_f32 v10, v78, v86
    v_cvt_pk_bf16_f32 v66, v79, v87
    v_cvt_pk_bf16_f32 v70, v82, v90
    v_cvt_pk_bf16_f32 v74, v80, v88
    v_lshlrev_b32 v76, 16, v3
    v_and_b32 v84, s25, v3
    v_lshlrev_b32 v77, 16, v7
    v_and_b32 v85, s25, v7
    v_lshlrev_b32 v78, 16, v11
    v_and_b32 v86, s25, v11
    v_lshlrev_b32 v79, 16, v15
    v_and_b32 v87, s25, v15
    v_add_f32 v80, v76, v78
    v_add_f32 v88, v84, v86
    v_add_f32 v81, v77, v79
    v_add_f32 v89, v85, v87
    v_fma_f32 v82, v78, 4.0, v76
    v_fma_f32 v90, v86, 4.0, v84
    v_fma_f32 v83, v79, 4.0, v77
    v_fma_f32 v91, v87, 4.0, v85
    v_add_f32 v77, v80, v81
    v_add_f32 v85, v88, v89
    v_sub_f32 v78, v80, v81
    v_sub_f32 v86, v88, v89
    v_fma_f32 v79, v83, 2.0, v82
    v_fma_f32 v87, v91, 2.0, v90
    v_fma_f32 v82, v83, -2.0, v82
    v_fma_f32 v90, v91, -2.0, v90
    v_fmamk_f32 v80, v76, 0x41700000, v82
    v_fmamk_f32 v88, v84, 0x41700000, v90
    v_fmamk_f32 v80, v81, 0x41200000, v80
    v_fmamk_f32 v88, v89, 0x41200000, v88
    v_cvt_pk_bf16_f32 v7, v77, v85
    v_cvt_pk_bf16_f32 v11, v78, v86
    v_cvt_pk_bf16_f32 v67, v79, v87
    v_cvt_pk_bf16_f32 v71, v82, v90
    v_cvt_pk_bf16_f32 v75, v80, v88
    ds_write_b128 v96, v[64:67] offset:49152
    ds_write_b128 v97, v[68:71] offset:0
    ds_write_b128 v97, v[72:75] offset:16384
    ds_write_b128 v96, v[0:3] offset:0
    ds_write_b128 v96, v[4:7] offset:16384
    ds_write_b128 v96, v[8:11] offset:32768
    ds_write_b128 v98, v[12:15] offset:0
    s_add_u32 s28, s28, 1
    s_waitcnt lgkmcnt(0)
    s_barrier
    s_sub_u32 s22, s22, 1
    s_branch L_conv2_kernel_hloop1
L_conv2_kernel_hlast1:
    s_branch L_conv2_kernel_end
L_conv2_kernel_h2:
    ds_write_b128 v96, v[0:3] offset:0
    ds_write_b128 v98, v[12:15] offset:0
    v_lshlrev_b32 v76, 16, v0
    v_and_b32 v84, s25, v0
    v_lshlrev_b32 v77, 16, v4
    v_and_b32 v85, s25, v4
    v_lshlrev_b32 v78, 16, v8
    v_and_b32 v86, s25, v8
    v_lshlrev_b32 v79, 16, v12
    v_and_b32 v87, s25, v12
    v_add_f32 v80, v76, v78
    v_add_f32 v88, v84, v86
    v_add_f32 v81, v77, v79
    v_add_f32 v89, v85, v87
    v_fma_f32 v82, v78, 4.0, v76
    v_fma_f32 v90, v86, 4.0, v84
    v_fma_f32 v83, v79, 4.0, v77
    v_fma_f32 v91, v87, 4.0, v85
    v_add_f32 v77, v80, v81
    v_add_f32 v85, v88, v89
    v_sub_f32 v78, v80, v81
    v_sub_f32 v86, v88, v89
    v_fma_f32 v79, v83, 2.0, v82
    v_fma_f32 v87, v91, 2.0, v90
    v_fma_f32 v82, v83, -2.0, v82
    v_fma_f32 v90, v91, -2.0, v90
    v_fmamk_f32 v80, v76, 0x41700000, v82
    v_fmamk_f32 v88, v84, 0x41700000, v90
    v_fmamk_f32 v80, v81, 0x41200000, v80
    v_fmamk_f32 v88, v89, 0x41200000, v88
    v_cvt_pk_bf16_f32 v4, v77, v85
    v_cvt_pk_bf16_f32 v8, v78, v86
    v_cvt_pk_bf16_f32 v64, v79, v87
    v_cvt_pk_bf16_f32 v68, v82, v90
    v_cvt_pk_bf16_f32 v72, v80, v88
    v_lshlrev_b32 v76, 16, v1
    v_and_b32 v84, s25, v1
    v_lshlrev_b32 v77, 16, v5
    v_and_b32 v85, s25, v5
    v_lshlrev_b32 v78, 16, v9
    v_and_b32 v86, s25, v9
    v_lshlrev_b32 v79, 16, v13
    v_and_b32 v87, s25, v13
    v_add_f32 v80, v76, v78
    v_add_f32 v88, v84, v86
    v_add_f32 v81, v77, v79
    v_add_f32 v89, v85, v87
    v_fma_f32 v82, v78, 4.0, v76
    v_fma_f32 v90, v86, 4.0, v84
    v_fma_f32 v83, v79, 4.0, v77
    v_fma_f32 v91, v87, 4.0, v85
    v_add_f32 v77, v80, v81
    v_add_f32 v85, v88, v89
    v_sub_f32 v78, v80, v81
    v_sub_f32 v86, v88, v89
    v_fma_f32 v79, v83, 2.0, v82
    v_fma_f32 v87, v91, 2.0, v90
    v_fma_f32 v82, v83, -2.0, v82
    v_fma_f32 v90, v91, -2.0, v90
    v_fmamk_f32 v80, v76, 0x41700000, v82
    v_fmamk_f32 v88, v84, 0x41700000, v90
    v_fmamk_f32 v80, v81, 0x41200000, v80
    v_fmamk_f32 v88, v89, 0x41200000, v88
    v_cvt_pk_bf16_f32 v5, v77, v85
    v_cvt_pk_bf16_f32 v9, v78, v86
    v_cvt_pk_bf16_f32 v65, v79, v87
    v_cvt_pk_bf16_f32 v69, v82, v90
    v_cvt_pk_bf16_f32 v73, v80, v88
    v_lshlrev_b32 v76, 16, v2
    v_and_b32 v84, s25, v2
    v_lshlrev_b32 v77, 16, v6
    v_and_b32 v85, s25, v6
    v_lshlrev_b32 v78, 16, v10
    v_and_b32 v86, s25, v10
    v_lshlrev_b32 v79, 16, v14
    v_and_b32 v87, s25, v14
    v_add_f32 v80, v76, v78
    v_add_f32 v88, v84, v86
    v_add_f32 v81, v77, v79
    v_add_f32 v89, v85, v87
    v_fma_f32 v82, v78, 4.0, v76
    v_fma_f32 v90, v86, 4.0, v84
    v_fma_f32 v83, v79, 4.0, v77
    v_fma_f32 v91, v87, 4.0, v85
    v_add_f32 v77, v80, v81
    v_add_f32 v85, v88, v89
    v_sub_f32 v78, v80, v81
    v_sub_f32 v86, v88, v89
    v_fma_f32 v79, v83, 2.0, v82
    v_fma_f32 v87, v91, 2.0, v90
    v_fma_f32 v82, v83, -2.0, v82
    v_fma_f32 v90, v91, -2.0, v90
    v_fmamk_f32 v80, v76, 0x41700000, v82
    v_fmamk_f32 v88, v84, 0x41700000, v90
    v_fmamk_f32 v80, v81, 0x41200000, v80
    v_fmamk_f32 v88, v89, 0x41200000, v88
    v_cvt_pk_bf16_f32 v6, v77, v85
    v_cvt_pk_bf16_f32 v10, v78, v86
    v_cvt_pk_bf16_f32 v66, v79, v87
    v_cvt_pk_bf16_f32 v70, v82, v90
    v_cvt_pk_bf16_f32 v74, v80, v88
    v_lshlrev_b32 v76, 16, v3
    v_and_b32 v84, s25, v3
    v_lshlrev_b32 v77, 16, v7
    v_and_b32 v85, s25, v7
    v_lshlrev_b32 v78, 16, v11
    v_and_b32 v86, s25, v11
    v_lshlrev_b32 v79, 16, v15
    v_and_b32 v87, s25, v15
    v_add_f32 v80, v76, v78
    v_add_f32 v88, v84, v86
    v_add_f32 v81, v77, v79
    v_add_f32 v89, v85, v87
    v_fma_f32 v82, v78, 4.0, v76
    v_fma_f32 v90, v86, 4.0, v84
    v_fma_f32 v83, v79, 4.0, v77
    v_fma_f32 v91, v87, 4.0, v85
    v_add_f32 v77, v80, v81
    v_add_f32 v85, v88, v89
    v_sub_f32 v78, v80, v81
    v_sub_f32 v86, v88, v89
    v_fma_f32 v79, v83, 2.0, v82
    v_fma_f32 v87, v91, 2.0, v90
    v_fma_f32 v82, v83, -2.0, v82
    v_fma_f32 v90, v91, -2.0, v90
    v_fmamk_f32 v80, v76, 0x41700000, v82
    v_fmamk_f32 v88, v84, 0x41700000, v90
    v_fmamk_f32 v80, v81, 0x41200000, v80
    v_fmamk_f32 v88, v89, 0x41200000, v88
    v_cvt_pk_bf16_f32 v7, v77, v85
    v_cvt_pk_bf16_f32 v11, v78, v86
    v_cvt_pk_bf16_f32 v67, v79, v87
    v_cvt_pk_bf16_f32 v71, v82, v90
    v_cvt_pk_bf16_f32 v75, v80, v88
    ds_write_b128 v96, v[64:67] offset:49152
    ds_write_b128 v97, v[68:71] offset:0
    ds_write_b128 v97, v[72:75] offset:16384
    ds_write_b128 v96, v[4:7] offset:16384
    ds_write_b128 v96, v[8:11] offset:32768
    s_waitcnt vmcnt(0)
    s_mov_b32 s24, 1048576
    s_mov_b32 s27, 1572864
    s_waitcnt lgkmcnt(0)
    s_barrier
    buffer_load_dwordx4 v[32:35], v92, s[8:11], s24 offen
    buffer_load_dwordx4 v[40:43], v94, s[8:11], s24 offen
    buffer_load_dwordx4 v[36:39], v93, s[8:11], s24 offen
    buffer_load_dwordx4 v[44:47], v95, s[8:11], s24 offen
    buffer_load_dwordx4 v[48:51], v92, s[8:11], s27 offen
    buffer_load_dwordx4 v[56:59], v94, s[8:11], s27 offen
    buffer_load_dwordx4 v[52:55], v93, s[8:11], s27 offen
    buffer_load_dwordx4 v[60:63], v95, s[8:11], s27 offen
    s_setprio 0
    v_lshlrev_b32 v76, 16, v16
    v_and_b32 v84, s25, v16
    v_lshlrev_b32 v77, 16, v20
    v_and_b32 v85, s25, v20
    v_lshlrev_b32 v78, 16, v24
    v_and_b32 v86, s25, v24
    v_lshlrev_b32 v79, 16, v28
    v_and_b32 v87, s25, v28
    v_add_f32 v80, v76, v78
    v_add_f32 v88, v84, v86
    v_add_f32 v81, v77, v79
    v_add_f32 v89, v85, v87
    v_fma_f32 v82, v78, 4.0, v76
    v_fma_f32 v90, v86, 4.0, v84
    v_fma_f32 v83, v79, 4.0, v77
    v_fma_f32 v91, v87, 4.0, v85
    v_add_f32 v77, v80, v81
    v_add_f32 v85, v88, v89
    v_sub_f32 v78, v80, v81
    v_sub_f32 v86, v88, v89
    v_fma_f32 v79, v83, 2.0, v82
    v_fma_f32 v87, v91, 2.0, v90
    v_fma_f32 v82, v83, -2.0, v82
    v_fma_f32 v90, v91, -2.0, v90
    v_fmamk_f32 v80, v76, 0x41700000, v82
    v_fmamk_f32 v88, v84, 0x41700000, v90
    v_fmamk_f32 v80, v81, 0x41200000, v80
    v_fmamk_f32 v88, v89, 0x41200000, v88
    v_cvt_pk_bf16_f32 v20, v77, v85
    v_cvt_pk_bf16_f32 v24, v78, v86
    v_cvt_pk_bf16_f32 v64, v79, v87
    v_cvt_pk_bf16_f32 v68, v82, v90
    v_cvt_pk_bf16_f32 v72, v80, v88
    v_lshlrev_b32 v76, 16, v17
    v_and_b32 v84, s25, v17
    v_lshlrev_b32 v77, 16, v21
    v_and_b32 v85, s25, v21
    v_lshlrev_b32 v78, 16, v25
    v_and_b32 v86, s25, v25
    v_lshlrev_b32 v79, 16, v29
    v_and_b32 v87, s25, v29
    v_add_f32 v80, v76, v78
    v_add_f32 v88, v84, v86
    v_add_f32 v81, v77, v79
    v_add_f32 v89, v85, v87
    v_fma_f32 v82, v78, 4.0, v76
    v_fma_f32 v90, v86, 4.0, v84
    v_fma_f32 v83, v79, 4.0, v77
    v_fma_f32 v91, v87, 4.0, v85
    v_add_f32 v77, v80, v81
    v_add_f32 v85, v88, v89
    v_sub_f32 v78, v80, v81
    v_sub_f32 v86, v88, v89
    v_fma_f32 v79, v83, 2.0, v82
    v_fma_f32 v87, v91, 2.0, v90
    v_fma_f32 v82, v83, -2.0, v82
    v_fma_f32 v90, v91, -2.0, v90
    v_fmamk_f32 v80, v76, 0x41700000, v82
    v_fmamk_f32 v88, v84, 0x41700000, v90
    v_fmamk_f32 v80, v81, 0x41200000, v80
    v_fmamk_f32 v88, v89, 0x41200000, v88
    v_cvt_pk_bf16_f32 v21, v77, v85
    v_cvt_pk_bf16_f32 v25, v78, v86
    v_cvt_pk_bf16_f32 v65, v79, v87
    v_cvt_pk_bf16_f32 v69, v82, v90
    v_cvt_pk_bf16_f32 v73, v80, v88
    v_lshlrev_b32 v76, 16, v18
    v_and_b32 v84, s25, v18
    v_lshlrev_b32 v77, 16, v22
    v_and_b32 v85, s25, v22
    v_lshlrev_b32 v78, 16, v26
    v_and_b32 v86, s25, v26
    v_lshlrev_b32 v79, 16, v30
    v_and_b32 v87, s25, v30
    v_add_f32 v80, v76, v78
    v_add_f32 v88, v84, v86
    v_add_f32 v81, v77, v79
    v_add_f32 v89, v85, v87
    v_fma_f32 v82, v78, 4.0, v76
    v_fma_f32 v90, v86, 4.0, v84
    v_fma_f32 v83, v79, 4.0, v77
    v_fma_f32 v91, v87, 4.0, v85
    v_add_f32 v77, v80, v81
    v_add_f32 v85, v88, v89
    v_sub_f32 v78, v80, v81
    v_sub_f32 v86, v88, v89
    v_fma_f32 v79, v83, 2.0, v82
    v_fma_f32 v87, v91, 2.0, v90
    v_fma_f32 v82, v83, -2.0, v82
    v_fma_f32 v90, v91, -2.0, v90
    v_fmamk_f32 v80, v76, 0x41700000, v82
    v_fmamk_f32 v88, v84, 0x41700000, v90
    v_fmamk_f32 v80, v81, 0x41200000, v80
    v_fmamk_f32 v88, v89, 0x41200000, v88
    v_cvt_pk_bf16_f32 v22, v77, v85
    v_cvt_pk_bf16_f32 v26, v78, v86
    v_cvt_pk_bf16_f32 v66, v79, v87
    v_cvt_pk_bf16_f32 v70, v82, v90
    v_cvt_pk_bf16_f32 v74, v80, v88
    v_lshlrev_b32 v76, 16, v19
    v_and_b32 v84, s25, v19
    v_lshlrev_b32 v77, 16, v23
    v_and_b32 v85, s25, v23
    v_lshlrev_b32 v78, 16, v27
    v_and_b32 v86, s25, v27
    v_lshlrev_b32 v79, 16, v31
    v_and_b32 v87, s25, v31
    v_add_f32 v80, v76, v78
    v_add_f32 v88, v84, v86
    v_add_f32 v81, v77, v79
    v_add_f32 v89, v85, v87
    v_fma_f32 v82, v78, 4.0, v76
    v_fma_f32 v90, v86, 4.0, v84
    v_fma_f32 v83, v79, 4.0, v77
    v_fma_f32 v91, v87, 4.0, v85
    v_add_f32 v77, v80, v81
    v_add_f32 v85, v88, v89
    v_sub_f32 v78, v80, v81
    v_sub_f32 v86, v88, v89
    v_fma_f32 v79, v83, 2.0, v82
    v_fma_f32 v87, v91, 2.0, v90
    v_fma_f32 v82, v83, -2.0, v82
    v_fma_f32 v90, v91, -2.0, v90
    v_fmamk_f32 v80, v76, 0x41700000, v82
    v_fmamk_f32 v88, v84, 0x41700000, v90
    v_fmamk_f32 v80, v81, 0x41200000, v80
    v_fmamk_f32 v88, v89, 0x41200000, v88
    v_cvt_pk_bf16_f32 v23, v77, v85
    v_cvt_pk_bf16_f32 v27, v78, v86
    v_cvt_pk_bf16_f32 v67, v79, v87
    v_cvt_pk_bf16_f32 v71, v82, v90
    v_cvt_pk_bf16_f32 v75, v80, v88
L_conv2_kernel_hloop2:
    s_add_u32 s24, s24, 1048576
    s_add_u32 s27, s27, 1048576
    ds_write_b128 v96, v[64:67] offset:57344
    ds_write_b128 v97, v[68:71] offset:8192
    ds_write_b128 v97, v[72:75] offset:24576
    ds_write_b128 v96, v[16:19] offset:8192
    ds_write_b128 v96, v[20:23] offset:24576
    ds_write_b128 v96, v[24:27] offset:40960
    ds_write_b128 v98, v[28:31] offset:8704
    s_waitcnt vmcnt(0)
    buffer_load_dwordx4 v[0:3], v92, s[8:11], s24 offen
    buffer_load_dwordx4 v[8:11], v94, s[8:11], s24 offen
    buffer_load_dwordx4 v[4:7], v93, s[8:11], s24 offen
    buffer_load_dwordx4 v[12:15], v95, s[8:11], s24 offen
    v_lshlrev_b32 v76, 16, v32
    v_and_b32 v84, s25, v32
    v_lshlrev_b32 v77, 16, v36
    v_and_b32 v85, s25, v36
    v_lshlrev_b32 v78, 16, v40
    v_and_b32 v86, s25, v40
    v_lshlrev_b32 v79, 16, v44
    v_and_b32 v87, s25, v44
    v_add_f32 v80, v76, v78
    v_add_f32 v88, v84, v86
    v_add_f32 v81, v77, v79
    v_add_f32 v89, v85, v87
    v_fma_f32 v82, v78, 4.0, v76
    v_fma_f32 v90, v86, 4.0, v84
    v_fma_f32 v83, v79, 4.0, v77
    v_fma_f32 v91, v87, 4.0, v85
    v_add_f32 v77, v80, v81
    v_add_f32 v85, v88, v89
    v_sub_f32 v78, v80, v81
    v_sub_f32 v86, v88, v89
    v_fma_f32 v79, v83, 2.0, v82
    v_fma_f32 v87, v91, 2.0, v90
    v_fma_f32 v82, v83, -2.0, v82
    v_fma_f32 v90, v91, -2.0, v90
    v_fmamk_f32 v80, v76, 0x41700000, v82
    v_fmamk_f32 v88, v84, 0x41700000, v90
    v_fmamk_f32 v80, v81, 0x41200000, v80
    v_fmamk_f32 v88, v89, 0x41200000, v88
    v_cvt_pk_bf16_f32 v36, v77, v85
    v_cvt_pk_bf16_f32 v40, v78, v86
    v_cvt_pk_bf16_f32 v64, v79, v87
    v_cvt_pk_bf16_f32 v68, v82, v90
    v_cvt_pk_bf16_f32 v72, v80, v88
    v_lshlrev_b32 v76, 16, v33
    v_and_b32 v84, s25, v33
    v_lshlrev_b32 v77, 16, v37
    v_and_b32 v85, s25, v37
    v_lshlrev_b32 v78, 16, v41
    v_and_b32 v86, s25, v41
    v_lshlrev_b32 v79, 16, v45
    v_and_b32 v87, s25, v45
    v_add_f32 v80, v76, v78
    v_add_f32 v88, v84, v86
    v_add_f32 v81, v77, v79
    v_add_f32 v89, v85, v87
    v_fma_f32 v82, v78, 4.0, v76
    v_fma_f32 v90, v86, 4.0, v84
    v_fma_f32 v83, v79, 4.0, v77
    v_fma_f32 v91, v87, 4.0, v85
    v_add_f32 v77, v80, v81
    v_add_f32 v85, v88, v89
    v_sub_f32 v78, v80, v81
    v_sub_f32 v86, v88, v89
    v_fma_f32 v79, v83, 2.0, v82
    v_fma_f32 v87, v91, 2.0, v90
    v_fma_f32 v82, v83, -2.0, v82
    v_fma_f32 v90, v91, -2.0, v90
    v_fmamk_f32 v80, v76, 0x41700000, v82
    v_fmamk_f32 v88, v84, 0x41700000, v90
    v_fmamk_f32 v80, v81, 0x41200000, v80
    v_fmamk_f32 v88, v89, 0x41200000, v88
    v_cvt_pk_bf16_f32 v37, v77, v85
    v_cvt_pk_bf16_f32 v41, v78, v86
    v_cvt_pk_bf16_f32 v65, v79, v87
    v_cvt_pk_bf16_f32 v69, v82, v90
    v_cvt_pk_bf16_f32 v73, v80, v88
    v_lshlrev_b32 v76, 16, v34
    v_and_b32 v84, s25, v34
    v_lshlrev_b32 v77, 16, v38
    v_and_b32 v85, s25, v38
    v_lshlrev_b32 v78, 16, v42
    v_and_b32 v86, s25, v42
    v_lshlrev_b32 v79, 16, v46
    v_and_b32 v87, s25, v46
    v_add_f32 v80, v76, v78
    v_add_f32 v88, v84, v86
    v_add_f32 v81, v77, v79
    v_add_f32 v89, v85, v87
    v_fma_f32 v82, v78, 4.0, v76
    v_fma_f32 v90, v86, 4.0, v84
    v_fma_f32 v83, v79, 4.0, v77
    v_fma_f32 v91, v87, 4.0, v85
    v_add_f32 v77, v80, v81
    v_add_f32 v85, v88, v89
    v_sub_f32 v78, v80, v81
    v_sub_f32 v86, v88, v89
    v_fma_f32 v79, v83, 2.0, v82
    v_fma_f32 v87, v91, 2.0, v90
    v_fma_f32 v82, v83, -2.0, v82
    v_fma_f32 v90, v91, -2.0, v90
    v_fmamk_f32 v80, v76, 0x41700000, v82
    v_fmamk_f32 v88, v84, 0x41700000, v90
    v_fmamk_f32 v80, v81, 0x41200000, v80
    v_fmamk_f32 v88, v89, 0x41200000, v88
    v_cvt_pk_bf16_f32 v38, v77, v85
    v_cvt_pk_bf16_f32 v42, v78, v86
    v_cvt_pk_bf16_f32 v66, v79, v87
    v_cvt_pk_bf16_f32 v70, v82, v90
    v_cvt_pk_bf16_f32 v74, v80, v88
    v_lshlrev_b32 v76, 16, v35
    v_and_b32 v84, s25, v35
    v_lshlrev_b32 v77, 16, v39
    v_and_b32 v85, s25, v39
    v_lshlrev_b32 v78, 16, v43
    v_and_b32 v86, s25, v43
    v_lshlrev_b32 v79, 16, v47
    v_and_b32 v87, s25, v47
    v_add_f32 v80, v76, v78
    v_add_f32 v88, v84, v86
    v_add_f32 v81, v77, v79
    v_add_f32 v89, v85, v87
    v_fma_f32 v82, v78, 4.0, v76
    v_fma_f32 v90, v86, 4.0, v84
    v_fma_f32 v83, v79, 4.0, v77
    v_fma_f32 v91, v87, 4.0, v85
    v_add_f32 v77, v80, v81
    v_add_f32 v85, v88, v89
    v_sub_f32 v78, v80, v81
    v_sub_f32 v86, v88, v89
    v_fma_f32 v79, v83, 2.0, v82
    v_fma_f32 v87, v91, 2.0, v90
    v_fma_f32 v82, v83, -2.0, v82
    v_fma_f32 v90, v91, -2.0, v90
    v_fmamk_f32 v80, v76, 0x41700000, v82
    v_fmamk_f32 v88, v84, 0x41700000, v90
    v_fmamk_f32 v80, v81, 0x41200000, v80
    v_fmamk_f32 v88, v89, 0x41200000, v88
    v_cvt_pk_bf16_f32 v39, v77, v85
    v_cvt_pk_bf16_f32 v43, v78, v86
    v_cvt_pk_bf16_f32 v67, v79, v87
    v_cvt_pk_bf16_f32 v71, v82, v90
    v_cvt_pk_bf16_f32 v75, v80, v88
    s_add_u32 s28, s28, 1
    s_waitcnt lgkmcnt(0)
    s_barrier
    ds_write_b128 v96, v[64:67] offset:49152
    ds_write_b128 v97, v[68:71] offset:0
    ds_write_b128 v97, v[72:75] offset:16384
    ds_write_b128 v96, v[32:35] offset:0
    ds_write_b128 v96, v[36:39] offset:16384
    ds_write_b128 v96, v[40:43] offset:32768
    ds_write_b128 v98, v[44:47] offset:0
    buffer_load_dwordx4 v[16:19], v92, s[8:11], s27 offen
    buffer_load_dwordx4 v[24:27], v94, s[8:11], s27 offen
    buffer_load_dwordx4 v[20:23], v93, s[8:11], s27 offen
    buffer_load_dwordx4 v[28:31], v95, s[8:11], s27 offen
    v_lshlrev_b32 v76, 16, v48
    v_and_b32 v84, s25, v48
    v_lshlrev_b32 v77, 16, v52
    v_and_b32 v85, s25, v52
    v_lshlrev_b32 v78, 16, v56
    v_and_b32 v86, s25, v56
    v_lshlrev_b32 v79, 16, v60
    v_and_b32 v87, s25, v60
    v_add_f32 v80, v76, v78
    v_add_f32 v88, v84, v86
    v_add_f32 v81, v77, v79
    v_add_f32 v89, v85, v87
    v_fma_f32 v82, v78, 4.0, v76
    v_fma_f32 v90, v86, 4.0, v84
    v_fma_f32 v83, v79, 4.0, v77
    v_fma_f32 v91, v87, 4.0, v85
    v_add_f32 v77, v80, v81
    v_add_f32 v85, v88, v89
    v_sub_f32 v78, v80, v81
    v_sub_f32 v86, v88, v89
    v_fma_f32 v79, v83, 2.0, v82
    v_fma_f32 v87, v91, 2.0, v90
    v_fma_f32 v82, v83, -2.0, v82
    v_fma_f32 v90, v91, -2.0, v90
    v_fmamk_f32 v80, v76, 0x41700000, v82
    v_fmamk_f32 v88, v84, 0x41700000, v90
    v_fmamk_f32 v80, v81, 0x41200000, v80
    v_fmamk_f32 v88, v89, 0x41200000, v88
    v_cvt_pk_bf16_f32 v52, v77, v85
    v_cvt_pk_bf16_f32 v56, v78, v86
    v_cvt_pk_bf16_f32 v64, v79, v87
    v_cvt_pk_bf16_f32 v68, v82, v90
    v_cvt_pk_bf16_f32 v72, v80, v88
    v_lshlrev_b32 v76, 16, v49
    v_and_b32 v84, s25, v49
    v_lshlrev_b32 v77, 16, v53
    v_and_b32 v85, s25, v53
    v_lshlrev_b32 v78, 16, v57
    v_and_b32 v86, s25, v57
    v_lshlrev_b32 v79, 16, v61
    v_and_b32 v87, s25, v61
    v_add_f32 v80, v76, v78
    v_add_f32 v88, v84, v86
    v_add_f32 v81, v77, v79
    v_add_f32 v89, v85, v87
    v_fma_f32 v82, v78, 4.0, v76
    v_fma_f32 v90, v86, 4.0, v84
    v_fma_f32 v83, v79, 4.0, v77
    v_fma_f32 v91, v87, 4.0, v85
    v_add_f32 v77, v80, v81
    v_add_f32 v85, v88, v89
    v_sub_f32 v78, v80, v81
    v_sub_f32 v86, v88, v89
    v_fma_f32 v79, v83, 2.0, v82
    v_fma_f32 v87, v91, 2.0, v90
    v_fma_f32 v82, v83, -2.0, v82
    v_fma_f32 v90, v91, -2.0, v90
    v_fmamk_f32 v80, v76, 0x41700000, v82
    v_fmamk_f32 v88, v84, 0x41700000, v90
    v_fmamk_f32 v80, v81, 0x41200000, v80
    v_fmamk_f32 v88, v89, 0x41200000, v88
    v_cvt_pk_bf16_f32 v53, v77, v85
    v_cvt_pk_bf16_f32 v57, v78, v86
    v_cvt_pk_bf16_f32 v65, v79, v87
    v_cvt_pk_bf16_f32 v69, v82, v90
    v_cvt_pk_bf16_f32 v73, v80, v88
    v_lshlrev_b32 v76, 16, v50
    v_and_b32 v84, s25, v50
    v_lshlrev_b32 v77, 16, v54
    v_and_b32 v85, s25, v54
    v_lshlrev_b32 v78, 16, v58
    v_and_b32 v86, s25, v58
    v_lshlrev_b32 v79, 16, v62
    v_and_b32 v87, s25, v62
    v_add_f32 v80, v76, v78
    v_add_f32 v88, v84, v86
    v_add_f32 v81, v77, v79
    v_add_f32 v89, v85, v87
    v_fma_f32 v82, v78, 4.0, v76
    v_fma_f32 v90, v86, 4.0, v84
    v_fma_f32 v83, v79, 4.0, v77
    v_fma_f32 v91, v87, 4.0, v85
    v_add_f32 v77, v80, v81
    v_add_f32 v85, v88, v89
    v_sub_f32 v78, v80, v81
    v_sub_f32 v86, v88, v89
    v_fma_f32 v79, v83, 2.0, v82
    v_fma_f32 v87, v91, 2.0, v90
    v_fma_f32 v82, v83, -2.0, v82
    v_fma_f32 v90, v91, -2.0, v90
    v_fmamk_f32 v80, v76, 0x41700000, v82
    v_fmamk_f32 v88, v84, 0x41700000, v90
    v_fmamk_f32 v80, v81, 0x41200000, v80
    v_fmamk_f32 v88, v89, 0x41200000, v88
    v_cvt_pk_bf16_f32 v54, v77, v85
    v_cvt_pk_bf16_f32 v58, v78, v86
    v_cvt_pk_bf16_f32 v66, v79, v87
    v_cvt_pk_bf16_f32 v70, v82, v90
    v_cvt_pk_bf16_f32 v74, v80, v88
    v_lshlrev_b32 v76, 16, v51
    v_and_b32 v84, s25, v51
    v_lshlrev_b32 v77, 16, v55
    v_and_b32 v85, s25, v55
    v_lshlrev_b32 v78, 16, v59
    v_and_b32 v86, s25, v59
    v_lshlrev_b32 v79, 16, v63
    v_and_b32 v87, s25, v63
    v_add_f32 v80, v76, v78
    v_add_f32 v88, v84, v86
    v_add_f32 v81, v77, v79
    v_add_f32 v89, v85, v87
    v_fma_f32 v82, v78, 4.0, v76
    v_fma_f32 v90, v86, 4.0, v84
    v_fma_f32 v83, v79, 4.0, v77
    v_fma_f32 v91, v87, 4.0, v85
    v_add_f32 v77, v80, v81
    v_add_f32 v85, v88, v89
    v_sub_f32 v78, v80, v81
    v_sub_f32 v86, v88, v89
    v_fma_f32 v79, v83, 2.0, v82
    v_fma_f32 v87, v91, 2.0, v90
    v_fma_f32 v82, v83, -2.0, v82
    v_fma_f32 v90, v91, -2.0, v90
    v_fmamk_f32 v80, v76, 0x41700000, v82
    v_fmamk_f32 v88, v84, 0x41700000, v90
    v_fmamk_f32 v80, v81, 0x41200000, v80
    v_fmamk_f32 v88, v89, 0x41200000, v88
    v_cvt_pk_bf16_f32 v55, v77, v85
    v_cvt_pk_bf16_f32 v59, v78, v86
    v_cvt_pk_bf16_f32 v67, v79, v87
    v_cvt_pk_bf16_f32 v71, v82, v90
    v_cvt_pk_bf16_f32 v75, v80, v88
    s_add_u32 s28, s28, 1
    s_waitcnt lgkmcnt(0)
    s_barrier
    s_cmp_eq_u32 s22, 1
    s_cbranch_scc1 L_conv2_kernel_hlast2
    s_add_u32 s24, s24, 1048576
    s_add_u32 s27, s27, 1048576
    ds_write_b128 v96, v[64:67] offset:57344
    ds_write_b128 v97, v[68:71] offset:8192
    ds_write_b128 v97, v[72:75] offset:24576
    ds_write_b128 v96, v[48:51] offset:8192
    ds_write_b128 v96, v[52:55] offset:24576
    ds_write_b128 v96, v[56:59] offset:40960
    ds_write_b128 v98, v[60:63] offset:8704
    s_waitcnt vmcnt(0)
    buffer_load_dwordx4 v[32:35], v92, s[8:11], s24 offen
    buffer_load_dwordx4 v[40:43], v94, s[8:11], s24 offen
    buffer_load_dwordx4 v[36:39], v93, s[8:11], s24 offen
    buffer_load_dwordx4 v[44:47], v95, s[8:11], s24 offen
    v_lshlrev_b32 v76, 16, v0
    v_and_b32 v84, s25, v0
    v_lshlrev_b32 v77, 16, v4
    v_and_b32 v85, s25, v4
    v_lshlrev_b32 v78, 16, v8
    v_and_b32 v86, s25, v8
    v_lshlrev_b32 v79, 16, v12
    v_and_b32 v87, s25, v12
    v_add_f32 v80, v76, v78
    v_add_f32 v88, v84, v86
    v_add_f32 v81, v77, v79
    v_add_f32 v89, v85, v87
    v_fma_f32 v82, v78, 4.0, v76
    v_fma_f32 v90, v86, 4.0, v84
    v_fma_f32 v83, v79, 4.0, v77
    v_fma_f32 v91, v87, 4.0, v85
    v_add_f32 v77, v80, v81
    v_add_f32 v85, v88, v89
    v_sub_f32 v78, v80, v81
    v_sub_f32 v86, v88, v89
    v_fma_f32 v79, v83, 2.0, v82
    v_fma_f32 v87, v91, 2.0, v90
    v_fma_f32 v82, v83, -2.0, v82
    v_fma_f32 v90, v91, -2.0, v90
    v_fmamk_f32 v80, v76, 0x41700000, v82
    v_fmamk_f32 v88, v84, 0x41700000, v90
    v_fmamk_f32 v80, v81, 0x41200000, v80
    v_fmamk_f32 v88, v89, 0x41200000, v88
    v_cvt_pk_bf16_f32 v4, v77, v85
    v_cvt_pk_bf16_f32 v8, v78, v86
    v_cvt_pk_bf16_f32 v64, v79, v87
    v_cvt_pk_bf16_f32 v68, v82, v90
    v_cvt_pk_bf16_f32 v72, v80, v88
    v_lshlrev_b32 v76, 16, v1
    v_and_b32 v84, s25, v1
    v_lshlrev_b32 v77, 16, v5
    v_and_b32 v85, s25, v5
    v_lshlrev_b32 v78, 16, v9
    v_and_b32 v86, s25, v9
    v_lshlrev_b32 v79, 16, v13
    v_and_b32 v87, s25, v13
    v_add_f32 v80, v76, v78
    v_add_f32 v88, v84, v86
    v_add_f32 v81, v77, v79
    v_add_f32 v89, v85, v87
    v_fma_f32 v82, v78, 4.0, v76
    v_fma_f32 v90, v86, 4.0, v84
    v_fma_f32 v83, v79, 4.0, v77
    v_fma_f32 v91, v87, 4.0, v85
    v_add_f32 v77, v80, v81
    v_add_f32 v85, v88, v89
    v_sub_f32 v78, v80, v81
    v_sub_f32 v86, v88, v89
    v_fma_f32 v79, v83, 2.0, v82
    v_fma_f32 v87, v91, 2.0, v90
    v_fma_f32 v82, v83, -2.0, v82
    v_fma_f32 v90, v91, -2.0, v90
    v_fmamk_f32 v80, v76, 0x41700000, v82
    v_fmamk_f32 v88, v84, 0x41700000, v90
    v_fmamk_f32 v80, v81, 0x41200000, v80
    v_fmamk_f32 v88, v89, 0x41200000, v88
    v_cvt_pk_bf16_f32 v5, v77, v85
    v_cvt_pk_bf16_f32 v9, v78, v86
    v_cvt_pk_bf16_f32 v65, v79, v87
    v_cvt_pk_bf16_f32 v69, v82, v90
    v_cvt_pk_bf16_f32 v73, v80, v88
    v_lshlrev_b32 v76, 16, v2
    v_and_b32 v84, s25, v2
    v_lshlrev_b32 v77, 16, v6
    v_and_b32 v85, s25, v6
    v_lshlrev_b32 v78, 16, v10
    v_and_b32 v86, s25, v10
    v_lshlrev_b32 v79, 16, v14
    v_and_b32 v87, s25, v14
    v_add_f32 v80, v76, v78
    v_add_f32 v88, v84, v86
    v_add_f32 v81, v77, v79
    v_add_f32 v89, v85, v87
    v_fma_f32 v82, v78, 4.0, v76
    v_fma_f32 v90, v86, 4.0, v84
    v_fma_f32 v83, v79, 4.0, v77
    v_fma_f32 v91, v87, 4.0, v85
    v_add_f32 v77, v80, v81
    v_add_f32 v85, v88, v89
    v_sub_f32 v78, v80, v81
    v_sub_f32 v86, v88, v89
    v_fma_f32 v79, v83, 2.0, v82
    v_fma_f32 v87, v91, 2.0, v90
    v_fma_f32 v82, v83, -2.0, v82
    v_fma_f32 v90, v91, -2.0, v90
    v_fmamk_f32 v80, v76, 0x41700000, v82
    v_fmamk_f32 v88, v84, 0x41700000, v90
    v_fmamk_f32 v80, v81, 0x41200000, v80
    v_fmamk_f32 v88, v89, 0x41200000, v88
    v_cvt_pk_bf16_f32 v6, v77, v85
    v_cvt_pk_bf16_f32 v10, v78, v86
    v_cvt_pk_bf16_f32 v66, v79, v87
    v_cvt_pk_bf16_f32 v70, v82, v90
    v_cvt_pk_bf16_f32 v74, v80, v88
    v_lshlrev_b32 v76, 16, v3
    v_and_b32 v84, s25, v3
    v_lshlrev_b32 v77, 16, v7
    v_and_b32 v85, s25, v7
    v_lshlrev_b32 v78, 16, v11
    v_and_b32 v86, s25, v11
    v_lshlrev_b32 v79, 16, v15
    v_and_b32 v87, s25, v15
    v_add_f32 v80, v76, v78
    v_add_f32 v88, v84, v86
    v_add_f32 v81, v77, v79
    v_add_f32 v89, v85, v87
    v_fma_f32 v82, v78, 4.0, v76
    v_fma_f32 v90, v86, 4.0, v84
    v_fma_f32 v83, v79, 4.0, v77
    v_fma_f32 v91, v87, 4.0, v85
    v_add_f32 v77, v80, v81
    v_add_f32 v85, v88, v89
    v_sub_f32 v78, v80, v81
    v_sub_f32 v86, v88, v89
    v_fma_f32 v79, v83, 2.0, v82
    v_fma_f32 v87, v91, 2.0, v90
    v_fma_f32 v82, v83, -2.0, v82
    v_fma_f32 v90, v91, -2.0, v90
    v_fmamk_f32 v80, v76, 0x41700000, v82
    v_fmamk_f32 v88, v84, 0x41700000, v90
    v_fmamk_f32 v80, v81, 0x41200000, v80
    v_fmamk_f32 v88, v89, 0x41200000, v88
    v_cvt_pk_bf16_f32 v7, v77, v85
    v_cvt_pk_bf16_f32 v11, v78, v86
    v_cvt_pk_bf16_f32 v67, v79, v87
    v_cvt_pk_bf16_f32 v71, v82, v90
    v_cvt_pk_bf16_f32 v75, v80, v88
    s_add_u32 s28, s28, 1
    s_waitcnt lgkmcnt(0)
    s_barrier
    ds_write_b128 v96, v[64:67] offset:49152
    ds_write_b128 v97, v[68:71] offset:0
    ds_write_b128 v97, v[72:75] offset:16384
    ds_write_b128 v96, v[0:3] offset:0
    ds_write_b128 v96, v[4:7] offset:16384
    ds_write_b128 v96, v[8:11] offset:32768
    ds_write_b128 v98, v[12:15] offset:0
    buffer_load_dwordx4 v[48:51], v92, s[8:11], s27 offen
    buffer_load_dwordx4 v[56:59], v94, s[8:11], s27 offen
    buffer_load_dwordx4 v[52:55], v93, s[8:11], s27 offen
    buffer_load_dwordx4 v[60:63], v95, s[8:11], s27 offen
    v_lshlrev_b32 v76, 16, v16
    v_and_b32 v84, s25, v16
    v_lshlrev_b32 v77, 16, v20
    v_and_b32 v85, s25, v20
    v_lshlrev_b32 v78, 16, v24
    v_and_b32 v86, s25, v24
    v_lshlrev_b32 v79, 16, v28
    v_and_b32 v87, s25, v28
    v_add_f32 v80, v76, v78
    v_add_f32 v88, v84, v86
    v_add_f32 v81, v77, v79
    v_add_f32 v89, v85, v87
    v_fma_f32 v82, v78, 4.0, v76
    v_fma_f32 v90, v86, 4.0, v84
    v_fma_f32 v83, v79, 4.0, v77
    v_fma_f32 v91, v87, 4.0, v85
    v_add_f32 v77, v80, v81
    v_add_f32 v85, v88, v89
    v_sub_f32 v78, v80, v81
    v_sub_f32 v86, v88, v89
    v_fma_f32 v79, v83, 2.0, v82
    v_fma_f32 v87, v91, 2.0, v90
    v_fma_f32 v82, v83, -2.0, v82
    v_fma_f32 v90, v91, -2.0, v90
    v_fmamk_f32 v80, v76, 0x41700000, v82
    v_fmamk_f32 v88, v84, 0x41700000, v90
    v_fmamk_f32 v80, v81, 0x41200000, v80
    v_fmamk_f32 v88, v89, 0x41200000, v88
    v_cvt_pk_bf16_f32 v20, v77, v85
    v_cvt_pk_bf16_f32 v24, v78, v86
    v_cvt_pk_bf16_f32 v64, v79, v87
    v_cvt_pk_bf16_f32 v68, v82, v90
    v_cvt_pk_bf16_f32 v72, v80, v88
    v_lshlrev_b32 v76, 16, v17
    v_and_b32 v84, s25, v17
    v_lshlrev_b32 v77, 16, v21
    v_and_b32 v85, s25, v21
    v_lshlrev_b32 v78, 16, v25
    v_and_b32 v86, s25, v25
    v_lshlrev_b32 v79, 16, v29
    v_and_b32 v87, s25, v29
    v_add_f32 v80, v76, v78
    v_add_f32 v88, v84, v86
    v_add_f32 v81, v77, v79
    v_add_f32 v89, v85, v87
    v_fma_f32 v82, v78, 4.0, v76
    v_fma_f32 v90, v86, 4.0, v84
    v_fma_f32 v83, v79, 4.0, v77
    v_fma_f32 v91, v87, 4.0, v85
    v_add_f32 v77, v80, v81
    v_add_f32 v85, v88, v89
    v_sub_f32 v78, v80, v81
    v_sub_f32 v86, v88, v89
    v_fma_f32 v79, v83, 2.0, v82
    v_fma_f32 v87, v91, 2.0, v90
    v_fma_f32 v82, v83, -2.0, v82
    v_fma_f32 v90, v91, -2.0, v90
    v_fmamk_f32 v80, v76, 0x41700000, v82
    v_fmamk_f32 v88, v84, 0x41700000, v90
    v_fmamk_f32 v80, v81, 0x41200000, v80
    v_fmamk_f32 v88, v89, 0x41200000, v88
    v_cvt_pk_bf16_f32 v21, v77, v85
    v_cvt_pk_bf16_f32 v25, v78, v86
    v_cvt_pk_bf16_f32 v65, v79, v87
    v_cvt_pk_bf16_f32 v69, v82, v90
    v_cvt_pk_bf16_f32 v73, v80, v88
    v_lshlrev_b32 v76, 16, v18
    v_and_b32 v84, s25, v18
    v_lshlrev_b32 v77, 16, v22
    v_and_b32 v85, s25, v22
    v_lshlrev_b32 v78, 16, v26
    v_and_b32 v86, s25, v26
    v_lshlrev_b32 v79, 16, v30
    v_and_b32 v87, s25, v30
    v_add_f32 v80, v76, v78
    v_add_f32 v88, v84, v86
    v_add_f32 v81, v77, v79
    v_add_f32 v89, v85, v87
    v_fma_f32 v82, v78, 4.0, v76
    v_fma_f32 v90, v86, 4.0, v84
    v_fma_f32 v83, v79, 4.0, v77
    v_fma_f32 v91, v87, 4.0, v85
    v_add_f32 v77, v80, v81
    v_add_f32 v85, v88, v89
    v_sub_f32 v78, v80, v81
    v_sub_f32 v86, v88, v89
    v_fma_f32 v79, v83, 2.0, v82
    v_fma_f32 v87, v91, 2.0, v90
    v_fma_f32 v82, v83, -2.0, v82
    v_fma_f32 v90, v91, -2.0, v90
    v_fmamk_f32 v80, v76, 0x41700000, v82
    v_fmamk_f32 v88, v84, 0x41700000, v90
    v_fmamk_f32 v80, v81, 0x41200000, v80
    v_fmamk_f32 v88, v89, 0x41200000, v88
    v_cvt_pk_bf16_f32 v22, v77, v85
    v_cvt_pk_bf16_f32 v26, v78, v86
    v_cvt_pk_bf16_f32 v66, v79, v87
    v_cvt_pk_bf16_f32 v70, v82, v90
    v_cvt_pk_bf16_f32 v74, v80, v88
    v_lshlrev_b32 v76, 16, v19
    v_and_b32 v84, s25, v19
    v_lshlrev_b32 v77, 16, v23
    v_and_b32 v85, s25, v23
    v_lshlrev_b32 v78, 16, v27
    v_and_b32 v86, s25, v27
    v_lshlrev_b32 v79, 16, v31
    v_and_b32 v87, s25, v31
    v_add_f32 v80, v76, v78
    v_add_f32 v88, v84, v86
    v_add_f32 v81, v77, v79
    v_add_f32 v89, v85, v87
    v_fma_f32 v82, v78, 4.0, v76
    v_fma_f32 v90, v86, 4.0, v84
    v_fma_f32 v83, v79, 4.0, v77
    v_fma_f32 v91, v87, 4.0, v85
    v_add_f32 v77, v80, v81
    v_add_f32 v85, v88, v89
    v_sub_f32 v78, v80, v81
    v_sub_f32 v86, v88, v89
    v_fma_f32 v79, v83, 2.0, v82
    v_fma_f32 v87, v91, 2.0, v90
    v_fma_f32 v82, v83, -2.0, v82
    v_fma_f32 v90, v91, -2.0, v90
    v_fmamk_f32 v80, v76, 0x41700000, v82
    v_fmamk_f32 v88, v84, 0x41700000, v90
    v_fmamk_f32 v80, v81, 0x41200000, v80
    v_fmamk_f32 v88, v89, 0x41200000, v88
    v_cvt_pk_bf16_f32 v23, v77, v85
    v_cvt_pk_bf16_f32 v27, v78, v86
    v_cvt_pk_bf16_f32 v67, v79, v87
    v_cvt_pk_bf16_f32 v71, v82, v90
    v_cvt_pk_bf16_f32 v75, v80, v88
    s_add_u32 s28, s28, 1
    s_waitcnt lgkmcnt(0)
    s_barrier
    s_sub_u32 s22, s22, 1
    s_branch L_conv2_kernel_hloop2
L_conv2_kernel_hlast2:
    s_mov_b32 s25, 0xffff0000
    ds_write_b128 v96, v[64:67] offset:57344
    ds_write_b128 v97, v[68:71] offset:8192
    ds_write_b128 v97, v[72:75] offset:24576
    ds_write_b128 v96, v[48:51] offset:8192
    ds_write_b128 v96, v[52:55] offset:24576
    ds_write_b128 v96, v[56:59] offset:40960
    ds_write_b128 v98, v[60:63] offset:8704
    s_waitcnt lgkmcnt(0)
    s_barrier
    s_branch L_conv2_kernel_end
L_conv2_kernel_epi:
    s_waitcnt lgkmcnt(0)
    s_barrier
    v_cndmask_b32 v122, v111, v110, vcc
    ds_read_b128 v[0:3], v120 offset:0
    ds_read_b128 v[4:7], v120 offset:16384
    ds_read_b128 v[8:11], v120 offset:32768
    ds_read_b128 v[12:15], v120 offset:49152
    ds_read_b128 v[16:19], v121 offset:0
    ds_read_b128 v[20:23], v121 offset:16384
    ds_read_b128 v[24:27], v121 offset:32768
    ds_read_b128 v[28:31], v64 offset:15360
    ds_read_b128 v[32:35], v120 offset:8192
    ds_read_b128 v[36:39], v120 offset:24576
    ds_read_b128 v[40:43], v120 offset:40960
    ds_read_b128 v[44:47], v120 offset:57344
    ds_read_b128 v[48:51], v121 offset:56320
    ds_read_b128 v[52:55], v121 offset:64512
    ds_read_b128 v[56:59], v64 offset:7168
    s_waitcnt lgkmcnt(7)
    ds_read_b128 v[60:63], v64 offset:23552
    s_waitcnt lgkmcnt(8)
    v_pk_add_f32 v[88:89], v[24:25], v[28:29]
    v_pk_add_f32 v[90:91], v[26:27], v[30:31]
    v_pk_add_f32 v[24:25], v[4:5], v[8:9]
    v_pk_add_f32 v[26:27], v[6:7], v[10:11]
    v_pk_add_f32 v[4:5], v[4:5], v[8:9] neg_lo:[0,1] neg_hi:[0,1]
    v_pk_add_f32 v[6:7], v[6:7], v[10:11] neg_lo:[0,1] neg_hi:[0,1]
    v_pk_add_f32 v[72:73], v[12:13], v[16:17]
    v_pk_add_f32 v[74:75], v[14:15], v[18:19]
    v_pk_add_f32 v[12:13], v[12:13], v[16:17] neg_lo:[0,1] neg_hi:[0,1]
    v_pk_add_f32 v[14:15], v[14:15], v[18:19] neg_lo:[0,1] neg_hi:[0,1]
    v_pk_fma_f32 v[72:73], v[24:25], s[4:5], v[72:73]
    v_pk_fma_f32 v[74:75], v[26:27], s[4:5], v[74:75]
    v_pk_fma_f32 v[20:21], v[0:1], s[10:11], v[20:21]
    v_pk_fma_f32 v[22:23], v[2:3], s[10:11], v[22:23]
    v_pk_fma_f32 v[72:73], v[0:1], s[6:7], v[72:73]
    v_pk_fma_f32 v[74:75], v[2:3], s[6:7], v[74:75]
    v_pk_add_f32 v[24:25], v[24:25], v[0:1] neg_lo:[0,1] neg_hi:[0,1]
    v_pk_add_f32 v[26:27], v[26:27], v[2:3] neg_lo:[0,1] neg_hi:[0,1]
    v_pk_fma_f32 v[72:73], v[88:89], s[8:9], v[72:73]
    v_pk_fma_f32 v[74:75], v[90:91], s[8:9], v[74:75]
    v_pk_add_f32 v[24:25], v[24:25], v[88:89] neg_lo:[0,1] neg_hi:[0,1]
    v_pk_add_f32 v[26:27], v[26:27], v[90:91] neg_lo:[0,1] neg_hi:[0,1]
    v_pk_fma_f32 v[20:21], v[88:89], s[22:23], v[20:21]
    v_pk_fma_f32 v[22:23], v[90:91], s[22:23], v[22:23]
    v_pk_add_f32 v[8:9], v[24:25], v[72:73] neg_lo:[0,1] neg_hi:[0,1]
    v_pk_add_f32 v[10:11], v[26:27], v[74:75] neg_lo:[0,1] neg_hi:[0,1]
    v_pk_fma_f32 v[20:21], v[72:73], s[14:15], v[20:21]
    v_pk_fma_f32 v[22:23], v[74:75], s[14:15], v[22:23]
    v_pk_mul_f32 v[80:81], v[12:13], s[32:33]
    v_pk_mul_f32 v[82:83], v[14:15], s[32:33]
    v_pk_fma_f32 v[20:21], v[8:9], s[12:13], v[20:21]
    v_pk_fma_f32 v[22:23], v[10:11], s[12:13], v[22:23]
    v_pk_fma_f32 v[80:81], v[4:5], s[34:35], v[80:81]
    v_pk_fma_f32 v[82:83], v[6:7], s[34:35], v[82:83]
    v_pk_fma_f32 v[64:65], v[4:5], s[24:25], v[20:21] neg_lo:[0,0,1] neg_hi:[0,0,1]
    v_pk_fma_f32 v[66:67], v[6:7], s[24:25], v[22:23] neg_lo:[0,0,1] neg_hi:[0,0,1]
    v_pk_fma_f32 v[64:65], v[12:13], s[26:27], v[64:65]
    v_pk_fma_f32 v[66:67], v[14:15], s[26:27], v[66:67]
    v_pk_fma_f32 v[80:81], v[64:65], s[38:39], v[80:81]
    v_pk_fma_f32 v[82:83], v[66:67], s[38:39], v[82:83]
    v_pk_add_f32 v[4:5], v[4:5], v[64:65] neg_lo:[0,1] neg_hi:[0,1]
    v_pk_add_f32 v[6:7], v[6:7], v[66:67] neg_lo:[0,1] neg_hi:[0,1]
    v_pk_add_f32 v[4:5], v[4:5], v[80:81] neg_lo:[0,1] neg_hi:[0,1]
    v_pk_add_f32 v[6:7], v[6:7], v[82:83] neg_lo:[0,1] neg_hi:[0,1]
    s_waitcnt lgkmcnt(0)
    v_pk_add_f32 v[92:93], v[56:57], v[60:61]
    v_pk_add_f32 v[94:95], v[58:59], v[62:63]
    v_pk_add_f32 v[56:57], v[36:37], v[40:41]
    v_pk_add_f32 v[58:59], v[38:39], v[42:43]
    v_pk_add_f32 v[36:37], v[36:37], v[40:41] neg_lo:[0,1] neg_hi:[0,1]
    v_pk_add_f32 v[38:39], v[38:39], v[42:43] neg_lo:[0,1] neg_hi:[0,1]
    v_pk_add_f32 v[76:77], v[44:45], v[48:49]
    v_pk_add_f32 v[78:79], v[46:47], v[50:51]
    v_pk_add_f32 v[44:45], v[44:45], v[48:49] neg_lo:[0,1] neg_hi:[0,1]
    v_pk_add_f32 v[46:47], v[46:47], v[50:51] neg_lo:[0,1] neg_hi:[0,1]
    v_pk_fma_f32 v[76:77], v[56:57], s[4:5], v[76:77]
    v_pk_fma_f32 v[78:79], v[58:59], s[4:5], v[78:79]
    v_pk_fma_f32 v[52:53], v[32:33], s[10:11], v[52:53]
    v_pk_fma_f32 v[54:55], v[34:35], s[10:11], v[54:55]
    v_pk_fma_f32 v[76:77], v[32:33], s[6:7], v[76:77]
    v_pk_fma_f32 v[78:79], v[34:35], s[6:7], v[78:79]
    v_pk_add_f32 v[56:57], v[56:57], v[32:33] neg_lo:[0,1] neg_hi:[0,1]
    v_pk_add_f32 v[58:59], v[58:59], v[34:35] neg_lo:[0,1] neg_hi:[0,1]
    v_pk_fma_f32 v[76:77], v[92:93], s[8:9], v[76:77]
    v_pk_fma_f32 v[78:79], v[94:95], s[8:9], v[78:79]
    v_pk_add_f32 v[56:57], v[56:57], v[92:93] neg_lo:[0,1] neg_hi:[0,1]
    v_pk_add_f32 v[58:59], v[58:59], v[94:95] neg_lo:[0,1] neg_hi:[0,1]
    v_pk_fma_f32 v[52:53], v[92:93], s[22:23], v[52:53]
    v_pk_fma_f32 v[54:55], v[94:95], s[22:23], v[54:55]
    v_pk_add_f32 v[40:41], v[56:57], v[76:77] neg_lo:[0,1] neg_hi:[0,1]
    v_pk_add_f32 v[42:43], v[58:59], v[78:79] neg_lo:[0,1] neg_hi:[0,1]
    v_pk_fma_f32 v[52:53], v[76:77], s[14:15], v[52:53]
    v_pk_fma_f32 v[54:55], v[78:79], s[14:15], v[54:55]
    v_pk_mul_f32 v[84:85], v[44:45], s[32:33]
    v_pk_mul_f32 v[86:87], v[46:47], s[32:33]
    v_pk_fma_f32 v[52:53], v[40:41], s[12:13], v[52:53]
    v_pk_fma_f32 v[54:55], v[42:43], s[12:13], v[54:55]
    v_pk_fma_f32 v[84:85], v[36:37], s[34:35], v[84:85]
    v_pk_fma_f32 v[86:87], v[38:39], s[34:35], v[86:87]
    v_pk_fma_f32 v[68:69], v[36:37], s[24:25], v[52:53] neg_lo:[0,0,1] neg_hi:[0,0,1]
    v_pk_fma_f32 v[70:71], v[38:39], s[24:25], v[54:55] neg_lo:[0,0,1] neg_hi:[0,0,1]
    v_pk_fma_f32 v[68:69], v[44:45], s[26:27], v[68:69]
    v_pk_fma_f32 v[70:71], v[46:47], s[26:27], v[70:71]
    v_pk_fma_f32 v[84:85], v[68:69], s[38:39], v[84:85]
    v_pk_fma_f32 v[86:87], v[70:71], s[38:39], v[86:87]
    v_pk_add_f32 v[36:37], v[36:37], v[68:69] neg_lo:[0,1] neg_hi:[0,1]
    v_pk_add_f32 v[38:39], v[38:39], v[70:71] neg_lo:[0,1] neg_hi:[0,1]
    v_pk_add_f32 v[36:37], v[36:37], v[84:85] neg_lo:[0,1] neg_hi:[0,1]
    v_pk_add_f32 v[38:39], v[38:39], v[86:87] neg_lo:[0,1] neg_hi:[0,1]
    s_mov_b32 s36, 0x00010001
    s_mov_b32 s37, 0x00010001
    s_mov_b64 exec, s[36:37]
    ds_write_b128 v127, v[0:3] offset:0
    ds_write_b128 v127, v[32:35] offset:16
    ds_write_b128 v127, v[4:7] offset:32
    ds_write_b128 v127, v[36:39] offset:48
    ds_write_b128 v127, v[8:11] offset:64
    ds_write_b128 v127, v[40:43] offset:80
    s_mov_b64 exec, -1
    v_mov_b32 v44, 0xc0135761
    v_mov_b32 v45, v44
    v_cvt_pk_bf16_f32 v48, v64, v68
    v_cvt_pk_bf16_f32 v49, v65, v69
    v_cvt_pk_bf16_f32 v50, v66, v70
    v_cvt_pk_bf16_f32 v51, v67, v71
    s_mov_b32 s44, 0
    buffer_store_dwordx4 v[48:51], v122, s[16:19], s44 offen sc1
    s_waitcnt lgkmcnt(0)
    s_barrier
    ds_read_b128 v[96:99], v127 offset:512
    ds_read_b128 v[100:103], v127 offset:528
    ds_read_b128 v[104:107], v127 offset:544
    ds_read_b128 v[108:111], v127 offset:560
    ds_read_b128 v[112:115], v127 offset:576
    ds_read_b128 v[116:119], v127 offset:592
    s_waitcnt lgkmcnt(4)
    v_mov_b32_dpp v96, v0 row_shl:1 row_mask:0xf bank_mask:0xf
    v_mov_b32_dpp v97, v1 row_shl:1 row_mask:0xf bank_mask:0xf
    v_mov_b32_dpp v98, v2 row_shl:1 row_mask:0xf bank_mask:0xf
    v_mov_b32_dpp v99, v3 row_shl:1 row_mask:0xf bank_mask:0xf
    v_mov_b32_dpp v100, v32 row_shl:1 row_mask:0xf bank_mask:0xf
    v_mov_b32_dpp v101, v33 row_shl:1 row_mask:0xf bank_mask:0xf
    v_mov_b32_dpp v102, v34 row_shl:1 row_mask:0xf bank_mask:0xf
    v_mov_b32_dpp v103, v35 row_shl:1 row_mask:0xf bank_mask:0xf
    v_pk_add_f32 v[72:73], v[72:73], v[96:97]
    v_pk_add_f32 v[74:75], v[74:75], v[98:99]
    v_pk_add_f32 v[76:77], v[76:77], v[100:101]
    v_pk_add_f32 v[78:79], v[78:79], v[102:103]
    v_cvt_pk_bf16_f32 v52, v72, v76
    v_cvt_pk_bf16_f32 v53, v73, v77
    v_cvt_pk_bf16_f32 v54, v74, v78
    v_cvt_pk_bf16_f32 v55, v75, v79
    s_mov_b32 s44, 65536
    buffer_store_dwordx4 v[52:55], v122, s[16:19], s44 offen sc1
    s_waitcnt lgkmcnt(2)
    v_mov_b32_dpp v104, v4 row_shl:1 row_mask:0xf bank_mask:0xf
    v_mov_b32_dpp v105, v5 row_shl:1 row_mask:0xf bank_mask:0xf
    v_mov_b32_dpp v106, v6 row_shl:1 row_mask:0xf bank_mask:0xf
    v_mov_b32_dpp v107, v7 row_shl:1 row_mask:0xf bank_mask:0xf
    v_mov_b32_dpp v108, v36 row_shl:1 row_mask:0xf bank_mask:0xf
    v_mov_b32_dpp v109, v37 row_shl:1 row_mask:0xf bank_mask:0xf
    v_mov_b32_dpp v110, v38 row_shl:1 row_mask:0xf bank_mask:0xf
    v_mov_b32_dpp v111, v39 row_shl:1 row_mask:0xf bank_mask:0xf
    v_pk_add_f32 v[80:81], v[80:81], v[104:105]
    v_pk_add_f32 v[82:83], v[82:83], v[106:107]
    v_pk_add_f32 v[84:85], v[84:85], v[108:109]
    v_pk_add_f32 v[86:87], v[86:87], v[110:111]
    v_cvt_pk_bf16_f32 v56, v80, v84
    v_cvt_pk_bf16_f32 v57, v81, v85
    v_cvt_pk_bf16_f32 v58, v82, v86
    v_cvt_pk_bf16_f32 v59, v83, v87
    s_mov_b32 s44, 131072
    buffer_store_dwordx4 v[56:59], v122, s[16:19], s44 offen sc1
    s_waitcnt lgkmcnt(0)
    v_mov_b32_dpp v112, v8 row_shl:1 row_mask:0xf bank_mask:0xf
    v_mov_b32_dpp v113, v9 row_shl:1 row_mask:0xf bank_mask:0xf
    v_mov_b32_dpp v114, v10 row_shl:1 row_mask:0xf bank_mask:0xf
    v_mov_b32_dpp v115, v11 row_shl:1 row_mask:0xf bank_mask:0xf
    v_mov_b32_dpp v116, v40 row_shl:1 row_mask:0xf bank_mask:0xf
    v_mov_b32_dpp v117, v41 row_shl:1 row_mask:0xf bank_mask:0xf
    v_mov_b32_dpp v118, v42 row_shl:1 row_mask:0xf bank_mask:0xf
    v_mov_b32_dpp v119, v43 row_shl:1 row_mask:0xf bank_mask:0xf
    v_pk_add_f32 v[88:89], v[88:89], v[112:113]
    v_pk_add_f32 v[90:91], v[90:91], v[114:115]
    v_pk_add_f32 v[92:93], v[92:93], v[116:117]
    v_pk_add_f32 v[94:95], v[94:95], v[118:119]
    v_cvt_pk_bf16_f32 v60, v88, v92
    v_cvt_pk_bf16_f32 v61, v89, v93
    v_cvt_pk_bf16_f32 v62, v90, v94
    v_cvt_pk_bf16_f32 v63, v91, v95
    s_mov_b32 s44, 196608
    buffer_store_dwordx4 v[60:63], v122, s[16:19], s44 offen sc1
L_conv2_kernel_end:
L_conv2_kernel_done:
    s_endpgm
.globl joint_kernel
.p2align 8
.type joint_kernel,@function
joint_kernel:
    s_cmp_ge_u32 s2, 250
    s_cbranch_scc1 L_joint_kernel_done
    s_load_dwordx2 s[28:29], s[0:1], 56
    s_load_dwordx2 s[30:31], s[0:1], 72
    v_readfirstlane_b32 s20, v0
    s_lshr_b32 s20, s20, 6
    s_and_b32 s21, s20, 7
    v_and_b32 v127, 63, v0
    v_lshlrev_b32 v126, 4, v127
    s_cmp_ge_u32 s20, 8
    s_mov_b32 s33, 44171264
    s_cselect_b32 s33, 44040192, s33
    s_lshl_b32 s36, s21, 14
    s_add_u32 s33, s33, s36
    s_mov_b32 s14, 16384
    s_mov_b32 s15, 0x00020000
    s_lshl_b32 s35, s2, 9
    s_cmp_ge_u32 s2, 125
    s_cselect_b32 s36, 2033152, 0
    s_cselect_b32 s34, 8192, 0
    s_add_u32 s35, s35, s36
    s_add_u32 s34, s34, 44302336
    s_mov_b32 s10, 12582912
    s_mov_b32 s11, 0x00020000
    s_mov_b32 s42, 24576
    s_mov_b32 s43, 0x00020000
    s_waitcnt lgkmcnt(0)
    s_add_u32 s12, s30, s33
    s_addc_u32 s13, s31, 0
    s_add_u32 s40, s30, s34
    s_addc_u32 s41, s31, 0
    s_cmp_ge_u32 s20, 8
    s_cbranch_scc1 L_joint_kernel_T
    s_add_u32 s8, s30, 27262976
    s_addc_u32 s9, s31, 0
    v_mov_b32 v0, 99456
    v_mov_b32 v2, 0
    v_mov_b32 v3, 0
    ds_write_b64 v0, v[2:3]
    v_lshrrev_b32 v124, 5, v127
    v_and_b32 v123, 0x1ff, v126
    v_mul_u32_u24 v125, 65536, v124
    v_add_u32 v123, v125, v123
    s_mul_i32 s36, s21, 262144
    s_add_u32 s36, s36, s35
    s_add_u32 s37, s36, 8388608
    buffer_load_dwordx4 v[64:67], v123, s[8:11], s36 offen
    buffer_load_dwordx4 v[72:75], v123, s[8:11], s37 offen
    s_add_u32 s36, s36, 131072
    s_add_u32 s37, s36, 8388608
    buffer_load_dwordx4 v[68:71], v123, s[8:11], s36 offen
    buffer_load_dwordx4 v[76:79], v123, s[8:11], s37 offen
    s_lshl_b32 s38, s21, 10
    s_add_u32 s38, s38, 16384
    buffer_load_dwordx4 v[80:83], v126, s[40:43], s38 offen
    s_waitcnt lgkmcnt(0)
    s_barrier
    s_lshl_b32 s35, s2, 17
    s_add_u32 s16, s28, s35
    s_addc_u32 s17, s29, 0
    s_mov_b32 s18, 131072
    s_mov_b32 s19, 0x00020000
    s_mov_b32 s46, 0xbdd2d3e8
    s_mov_b32 s47, s46
    v_mov_b32 v120, 0xc0135761
    v_mov_b32 v121, v120
    s_mov_b32 s48, 1.0
    s_mov_b32 s49, 1.0
    v_bfe_u32 v123, v127, 2, 3
    v_lshl_add_u32 v124, v123, 2, v124
    v_mul_u32_u24 v124, 528, v124
    v_and_b32 v123, 0x30, v126
    s_lshl_b32 s36, s21, 6
    v_add3_u32 v124, v124, v123, s36
    s_mov_b32 s45, 0xffff0000
    s_mul_i32 s36, s21, 1040
    s_add_u32 s36, s36, 91136
    v_add_u32 v123, s36, v126
    s_mov_b32 s22, 2
    s_waitcnt vmcnt(3)
L_joint_kernel_floop:
    v_lshlrev_b32 v88, 16, v64
    v_and_b32 v89, s45, v64
    v_lshlrev_b32 v96, 16, v72
    v_and_b32 v97, s45, v72
    v_lshlrev_b32 v90, 16, v65
    v_and_b32 v91, s45, v65
    v_lshlrev_b32 v98, 16, v73
    v_and_b32 v99, s45, v73
    v_lshlrev_b32 v92, 16, v66
    v_and_b32 v93, s45, v66
    v_lshlrev_b32 v100, 16, v74
    v_and_b32 v101, s45, v74
    v_lshlrev_b32 v94, 16, v67
    v_and_b32 v95, s45, v67
    v_lshlrev_b32 v102, 16, v75
    v_and_b32 v103, s45, v75
    v_pk_add_f32 v[88:89], v[88:89], v[96:97]
    v_pk_add_f32 v[90:91], v[90:91], v[98:99]
    v_pk_add_f32 v[92:93], v[92:93], v[100:101]
    v_pk_add_f32 v[94:95], v[94:95], v[102:103]
    v_pk_mul_f32 v[96:97], v[88:89], v[88:89]
    v_pk_mul_f32 v[98:99], v[90:91], v[90:91]
    v_pk_mul_f32 v[100:101], v[92:93], v[92:93]
    v_pk_mul_f32 v[102:103], v[94:95], v[94:95]
    v_pk_fma_f32 v[96:97], v[96:97], s[46:47], v[120:121]
    v_pk_fma_f32 v[98:99], v[98:99], s[46:47], v[120:121]
    v_pk_fma_f32 v[100:101], v[100:101], s[46:47], v[120:121]
    v_pk_fma_f32 v[102:103], v[102:103], s[46:47], v[120:121]
    v_pk_mul_f32 v[96:97], v[96:97], v[88:89]
    v_pk_mul_f32 v[98:99], v[98:99], v[90:91]
    v_pk_mul_f32 v[100:101], v[100:101], v[92:93]
    v_pk_mul_f32 v[102:103], v[102:103], v[94:95]
    v_exp_f32 v96, v96
    v_exp_f32 v97, v97
    v_exp_f32 v98, v98
    v_exp_f32 v99, v99
    v_exp_f32 v100, v100
    v_exp_f32 v101, v101
    v_exp_f32 v102, v102
    v_exp_f32 v103, v103
    v_pk_add_f32 v[96:97], v[96:97], s[48:49]
    v_pk_add_f32 v[98:99], v[98:99], s[48:49]
    v_pk_add_f32 v[100:101], v[100:101], s[48:49]
    v_pk_add_f32 v[102:103], v[102:103], s[48:49]
    v_rcp_f32 v96, v96
    v_rcp_f32 v97, v97
    v_rcp_f32 v98, v98
    v_rcp_f32 v99, v99
    v_rcp_f32 v100, v100
    v_rcp_f32 v101, v101
    v_rcp_f32 v102, v102
    v_rcp_f32 v103, v103
    v_pk_mul_f32 v[88:89], v[88:89], v[96:97]
    v_pk_mul_f32 v[90:91], v[90:91], v[98:99]
    v_pk_mul_f32 v[92:93], v[92:93], v[100:101]
    v_pk_mul_f32 v[94:95], v[94:95], v[102:103]
    v_cvt_pk_bf16_f32 v104, v88, v89
    v_cvt_pk_bf16_f32 v105, v90, v91
    v_cvt_pk_bf16_f32 v106, v92, v93
    v_cvt_pk_bf16_f32 v107, v94, v95
    ds_write_b128 v124, v[104:107] offset:32768
    s_waitcnt vmcnt(0)
    v_pk_mov_b32 v[64:65], v[68:69], v[68:69] op_sel:[0,1]
    v_pk_mov_b32 v[72:73], v[76:77], v[76:77] op_sel:[0,1]
    v_pk_mov_b32 v[66:67], v[70:71], v[70:71] op_sel:[0,1]
    v_pk_mov_b32 v[74:75], v[78:79], v[78:79] op_sel:[0,1]
    v_add_u32 v124, 1056, v124
    s_sub_u32 s22, s22, 1
    s_cmp_lg_u32 s22, 0
    s_cbranch_scc1 L_joint_kernel_floop
    ds_write_b128 v123, v[80:83]
    s_waitcnt lgkmcnt(0)
    v_mov_b32 v120, 99456
    v_mov_b32 v121, 1
    s_mov_b64 exec, 1
    ds_add_u32 v120, v121 offset:0
    s_mov_b64 exec, -1
L_joint_kernel_ow:
    ds_read_b32 v121, v120 offset:4
    s_waitcnt lgkmcnt(0)
    v_readfirstlane_b32 s37, v121
    s_cmp_ge_u32 s37, 8
    s_cbranch_scc1 L_joint_kernel_ow_d
    s_sleep 1
    s_branch L_joint_kernel_ow
L_joint_kernel_ow_d:
    s_mov_b32 s36, 0
    buffer_load_dwordx4 v[0:3], v126, s[12:15], s36 offen offset:0
    buffer_load_dwordx4 v[4:7], v126, s[12:15], s36 offen offset:1024
    buffer_load_dwordx4 v[8:11], v126, s[12:15], s36 offen offset:2048
    buffer_load_dwordx4 v[12:15], v126, s[12:15], s36 offen offset:3072
    s_mov_b32 s36, 4096
    buffer_load_dwordx4 v[16:19], v126, s[12:15], s36 offen offset:0
    buffer_load_dwordx4 v[20:23], v126, s[12:15], s36 offen offset:1024
    buffer_load_dwordx4 v[24:27], v126, s[12:15], s36 offen offset:2048
    buffer_load_dwordx4 v[28:31], v126, s[12:15], s36 offen offset:3072
    s_mov_b32 s36, 8192
    buffer_load_dwordx4 v[32:35], v126, s[12:15], s36 offen offset:0
    buffer_load_dwordx4 v[36:39], v126, s[12:15], s36 offen offset:1024
    buffer_load_dwordx4 v[40:43], v126, s[12:15], s36 offen offset:2048
    buffer_load_dwordx4 v[44:47], v126, s[12:15], s36 offen offset:3072
    s_mov_b32 s36, 12288
    buffer_load_dwordx4 v[48:51], v126, s[12:15], s36 offen offset:0
    buffer_load_dwordx4 v[52:55], v126, s[12:15], s36 offen offset:1024
    buffer_load_dwordx4 v[56:59], v126, s[12:15], s36 offen offset:2048
    buffer_load_dwordx4 v[60:63], v126, s[12:15], s36 offen offset:3072
    v_lshrrev_b32 v125, 4, v127
    v_lshlrev_b32 v125, 11, v125
    v_and_b32 v124, 15, v127
    v_lshl_add_u32 v125, v124, 2, v125
    s_lshl_b32 s36, s21, 6
    v_add_u32 v125, s36, v125
    s_mov_b32 s44, 8192
    s_setprio 1
    s_barrier
    ds_read_b128 v[96:99], v126 offset:0
    ds_read_b128 v[100:103], v126 offset:1024
    ds_read_b128 v[104:107], v126 offset:2048
    ds_read_b128 v[108:111], v126 offset:3072
    s_waitcnt vmcnt(14) lgkmcnt(3)
    v_mfma_f32_16x16x32_bf16 v[64:67], v[96:99], v[0:3], 0
    v_mfma_f32_16x16x32_bf16 v[68:71], v[96:99], v[4:7], 0
    ds_read_b128 v[96:99], v126 offset:4096
    s_waitcnt lgkmcnt(3)
    v_mfma_f32_16x16x32_bf16 v[72:75], v[100:103], v[0:3], 0
    v_mfma_f32_16x16x32_bf16 v[76:79], v[100:103], v[4:7], 0
    ds_read_b128 v[100:103], v126 offset:5120
    s_waitcnt vmcnt(12) lgkmcnt(3)
    v_mfma_f32_16x16x32_bf16 v[64:67], v[104:107], v[8:11], v[64:67]
    v_mfma_f32_16x16x32_bf16 v[68:71], v[104:107], v[12:15], v[68:71]
    ds_read_b128 v[104:107], v126 offset:6144
    s_waitcnt lgkmcnt(3)
    v_mfma_f32_16x16x32_bf16 v[72:75], v[108:111], v[8:11], v[72:75]
    v_mfma_f32_16x16x32_bf16 v[76:79], v[108:111], v[12:15], v[76:79]
    ds_read_b128 v[108:111], v126 offset:7168
    s_waitcnt vmcnt(10) lgkmcnt(3)
    v_mfma_f32_16x16x32_bf16 v[64:67], v[96:99], v[16:19], v[64:67]
    v_mfma_f32_16x16x32_bf16 v[68:71], v[96:99], v[20:23], v[68:71]
    ds_read_b128 v[96:99], v126 offset:8192
    s_waitcnt lgkmcnt(3)
    v_mfma_f32_16x16x32_bf16 v[72:75], v[100:103], v[16:19], v[72:75]
    v_mfma_f32_16x16x32_bf16 v[76:79], v[100:103], v[20:23], v[76:79]
    ds_read_b128 v[100:103], v126 offset:9216
    s_waitcnt vmcnt(8) lgkmcnt(3)
    v_mfma_f32_16x16x32_bf16 v[64:67], v[104:107], v[24:27], v[64:67]
    v_mfma_f32_16x16x32_bf16 v[68:71], v[104:107], v[28:31], v[68:71]
    ds_read_b128 v[104:107], v126 offset:10240
    s_waitcnt lgkmcnt(3)
    v_mfma_f32_16x16x32_bf16 v[72:75], v[108:111], v[24:27], v[72:75]
    v_mfma_f32_16x16x32_bf16 v[76:79], v[108:111], v[28:31], v[76:79]
    ds_read_b128 v[108:111], v126 offset:11264
    s_waitcnt vmcnt(6) lgkmcnt(3)
    v_mfma_f32_16x16x32_bf16 v[64:67], v[96:99], v[32:35], v[64:67]
    v_mfma_f32_16x16x32_bf16 v[68:71], v[96:99], v[36:39], v[68:71]
    ds_read_b128 v[96:99], v126 offset:12288
    s_waitcnt lgkmcnt(3)
    v_mfma_f32_16x16x32_bf16 v[72:75], v[100:103], v[32:35], v[72:75]
    v_mfma_f32_16x16x32_bf16 v[76:79], v[100:103], v[36:39], v[76:79]
    ds_read_b128 v[100:103], v126 offset:13312
    s_waitcnt vmcnt(4) lgkmcnt(3)
    v_mfma_f32_16x16x32_bf16 v[64:67], v[104:107], v[40:43], v[64:67]
    v_mfma_f32_16x16x32_bf16 v[68:71], v[104:107], v[44:47], v[68:71]
    ds_read_b128 v[104:107], v126 offset:14336
    s_waitcnt lgkmcnt(3)
    v_mfma_f32_16x16x32_bf16 v[72:75], v[108:111], v[40:43], v[72:75]
    v_mfma_f32_16x16x32_bf16 v[76:79], v[108:111], v[44:47], v[76:79]
    ds_read_b128 v[108:111], v126 offset:15360
    s_waitcnt vmcnt(2) lgkmcnt(3)
    v_mfma_f32_16x16x32_bf16 v[64:67], v[96:99], v[48:51], v[64:67]
    v_mfma_f32_16x16x32_bf16 v[68:71], v[96:99], v[52:55], v[68:71]
    s_waitcnt lgkmcnt(0)
    s_barrier
    ds_read_b128 v[96:99], v126 offset:16384
    v_mfma_f32_16x16x32_bf16 v[72:75], v[100:103], v[48:51], v[72:75]
    v_mfma_f32_16x16x32_bf16 v[76:79], v[100:103], v[52:55], v[76:79]
    ds_read_b128 v[100:103], v126 offset:17408
    s_waitcnt vmcnt(0)
    v_mfma_f32_16x16x32_bf16 v[64:67], v[104:107], v[56:59], v[64:67]
    v_mfma_f32_16x16x32_bf16 v[68:71], v[104:107], v[60:63], v[68:71]
    ds_read_b128 v[104:107], v126 offset:18432
    v_mfma_f32_16x16x32_bf16 v[72:75], v[108:111], v[56:59], v[72:75]
    v_mfma_f32_16x16x32_bf16 v[76:79], v[108:111], v[60:63], v[76:79]
    ds_read_b128 v[108:111], v126 offset:19456
    s_mov_b32 s22, 4
L_joint_kernel_oloop:
    s_waitcnt lgkmcnt(3)
    v_mfma_f32_16x16x32_bf16 v[80:83], v[96:99], v[0:3], 0
    v_mfma_f32_16x16x32_bf16 v[84:87], v[96:99], v[4:7], 0
    ds_read_b128 v[96:99], v126 offset:20480
    s_waitcnt lgkmcnt(3)
    v_mfma_f32_16x16x32_bf16 v[88:91], v[100:103], v[0:3], 0
    v_mfma_f32_16x16x32_bf16 v[92:95], v[100:103], v[4:7], 0
    ds_read_b128 v[100:103], v126 offset:21504
    s_waitcnt lgkmcnt(3)
    v_mfma_f32_16x16x32_bf16 v[80:83], v[104:107], v[8:11], v[80:83]
    v_mfma_f32_16x16x32_bf16 v[84:87], v[104:107], v[12:15], v[84:87]
    ds_read_b128 v[104:107], v126 offset:22528
    s_waitcnt lgkmcnt(3)
    v_mfma_f32_16x16x32_bf16 v[88:91], v[108:111], v[8:11], v[88:91]
    v_cvt_pk_bf16_f32 v112, v64, v68
    v_mfma_f32_16x16x32_bf16 v[92:95], v[108:111], v[12:15], v[92:95]
    buffer_store_dword v112, v125, s[16:19], 0 offen offset:0 nt
    ds_read_b128 v[108:111], v126 offset:23552
    s_waitcnt lgkmcnt(3)
    v_mfma_f32_16x16x32_bf16 v[80:83], v[96:99], v[16:19], v[80:83]
    v_cvt_pk_bf16_f32 v113, v65, v69
    v_mfma_f32_16x16x32_bf16 v[84:87], v[96:99], v[20:23], v[84:87]
    buffer_store_dword v113, v125, s[16:19], 0 offen offset:512 nt
    ds_read_b128 v[96:99], v126 offset:24576
    s_waitcnt lgkmcnt(3)
    v_mfma_f32_16x16x32_bf16 v[88:91], v[100:103], v[16:19], v[88:91]
    v_cvt_pk_bf16_f32 v114, v66, v70
    v_mfma_f32_16x16x32_bf16 v[92:95], v[100:103], v[20:23], v[92:95]
    buffer_store_dword v114, v125, s[16:19], 0 offen offset:1024 nt
    ds_read_b128 v[100:103], v126 offset:25600
    s_waitcnt lgkmcnt(3)
    v_mfma_f32_16x16x32_bf16 v[80:83], v[104:107], v[24:27], v[80:83]
    v_cvt_pk_bf16_f32 v115, v67, v71
    v_mfma_f32_16x16x32_bf16 v[84:87], v[104:107], v[28:31], v[84:87]
    buffer_store_dword v115, v125, s[16:19], 0 offen offset:1536 nt
    ds_read_b128 v[104:107], v126 offset:26624
    s_waitcnt lgkmcnt(3)
    v_mfma_f32_16x16x32_bf16 v[88:91], v[108:111], v[24:27], v[88:91]
    v_cvt_pk_bf16_f32 v116, v72, v76
    v_mfma_f32_16x16x32_bf16 v[92:95], v[108:111], v[28:31], v[92:95]
    buffer_store_dword v116, v125, s[16:19], s44 offen offset:0 nt
    ds_read_b128 v[108:111], v126 offset:27648
    s_waitcnt lgkmcnt(3)
    v_mfma_f32_16x16x32_bf16 v[80:83], v[96:99], v[32:35], v[80:83]
    v_cvt_pk_bf16_f32 v117, v73, v77
    v_mfma_f32_16x16x32_bf16 v[84:87], v[96:99], v[36:39], v[84:87]
    buffer_store_dword v117, v125, s[16:19], s44 offen offset:512 nt
    ds_read_b128 v[96:99], v126 offset:28672
    s_waitcnt lgkmcnt(3)
    v_mfma_f32_16x16x32_bf16 v[88:91], v[100:103], v[32:35], v[88:91]
    v_cvt_pk_bf16_f32 v118, v74, v78
    v_mfma_f32_16x16x32_bf16 v[92:95], v[100:103], v[36:39], v[92:95]
    buffer_store_dword v118, v125, s[16:19], s44 offen offset:1024 nt
    ds_read_b128 v[100:103], v126 offset:29696
    s_waitcnt lgkmcnt(3)
    v_mfma_f32_16x16x32_bf16 v[80:83], v[104:107], v[40:43], v[80:83]
    v_cvt_pk_bf16_f32 v119, v75, v79
    v_mfma_f32_16x16x32_bf16 v[84:87], v[104:107], v[44:47], v[84:87]
    buffer_store_dword v119, v125, s[16:19], s44 offen offset:1536 nt
    ds_read_b128 v[104:107], v126 offset:30720
    s_waitcnt lgkmcnt(3)
    v_mfma_f32_16x16x32_bf16 v[88:91], v[108:111], v[40:43], v[88:91]
    v_add_u32 v125, 16384, v125
    v_mfma_f32_16x16x32_bf16 v[92:95], v[108:111], v[44:47], v[92:95]
    ds_read_b128 v[108:111], v126 offset:31744
    s_waitcnt lgkmcnt(3)
    v_mfma_f32_16x16x32_bf16 v[80:83], v[96:99], v[48:51], v[80:83]
    v_mfma_f32_16x16x32_bf16 v[84:87], v[96:99], v[52:55], v[84:87]
    s_waitcnt lgkmcnt(0)
    s_barrier
    ds_read_b128 v[96:99], v126 offset:0
    v_mfma_f32_16x16x32_bf16 v[88:91], v[100:103], v[48:51], v[88:91]
    v_mfma_f32_16x16x32_bf16 v[92:95], v[100:103], v[52:55], v[92:95]
    ds_read_b128 v[100:103], v126 offset:1024
    v_mfma_f32_16x16x32_bf16 v[80:83], v[104:107], v[56:59], v[80:83]
    v_mfma_f32_16x16x32_bf16 v[84:87], v[104:107], v[60:63], v[84:87]
    ds_read_b128 v[104:107], v126 offset:2048
    v_mfma_f32_16x16x32_bf16 v[88:91], v[108:111], v[56:59], v[88:91]
    v_mfma_f32_16x16x32_bf16 v[92:95], v[108:111], v[60:63], v[92:95]
    ds_read_b128 v[108:111], v126 offset:3072
    s_sub_u32 s22, s22, 1
    s_cmp_eq_u32 s22, 0
    s_cbranch_scc1 L_joint_kernel_oend
    s_waitcnt lgkmcnt(3)
    v_mfma_f32_16x16x32_bf16 v[64:67], v[96:99], v[0:3], 0
    v_mfma_f32_16x16x32_bf16 v[68:71], v[96:99], v[4:7], 0
    ds_read_b128 v[96:99], v126 offset:4096
    s_waitcnt lgkmcnt(3)
    v_mfma_f32_16x16x32_bf16 v[72:75], v[100:103], v[0:3], 0
    v_mfma_f32_16x16x32_bf16 v[76:79], v[100:103], v[4:7], 0
    ds_read_b128 v[100:103], v126 offset:5120
    s_waitcnt lgkmcnt(3)
    v_mfma_f32_16x16x32_bf16 v[64:67], v[104:107], v[8:11], v[64:67]
    v_mfma_f32_16x16x32_bf16 v[68:71], v[104:107], v[12:15], v[68:71]
    ds_read_b128 v[104:107], v126 offset:6144
    s_waitcnt lgkmcnt(3)
    v_mfma_f32_16x16x32_bf16 v[72:75], v[108:111], v[8:11], v[72:75]
    v_cvt_pk_bf16_f32 v112, v80, v84
    v_mfma_f32_16x16x32_bf16 v[76:79], v[108:111], v[12:15], v[76:79]
    buffer_store_dword v112, v125, s[16:19], 0 offen offset:0 nt
    ds_read_b128 v[108:111], v126 offset:7168
    s_waitcnt lgkmcnt(3)
    v_mfma_f32_16x16x32_bf16 v[64:67], v[96:99], v[16:19], v[64:67]
    v_cvt_pk_bf16_f32 v113, v81, v85
    v_mfma_f32_16x16x32_bf16 v[68:71], v[96:99], v[20:23], v[68:71]
    buffer_store_dword v113, v125, s[16:19], 0 offen offset:512 nt
    ds_read_b128 v[96:99], v126 offset:8192
    s_waitcnt lgkmcnt(3)
    v_mfma_f32_16x16x32_bf16 v[72:75], v[100:103], v[16:19], v[72:75]
    v_cvt_pk_bf16_f32 v114, v82, v86
    v_mfma_f32_16x16x32_bf16 v[76:79], v[100:103], v[20:23], v[76:79]
    buffer_store_dword v114, v125, s[16:19], 0 offen offset:1024 nt
    ds_read_b128 v[100:103], v126 offset:9216
    s_waitcnt lgkmcnt(3)
    v_mfma_f32_16x16x32_bf16 v[64:67], v[104:107], v[24:27], v[64:67]
    v_cvt_pk_bf16_f32 v115, v83, v87
    v_mfma_f32_16x16x32_bf16 v[68:71], v[104:107], v[28:31], v[68:71]
    buffer_store_dword v115, v125, s[16:19], 0 offen offset:1536 nt
    ds_read_b128 v[104:107], v126 offset:10240
    s_waitcnt lgkmcnt(3)
    v_mfma_f32_16x16x32_bf16 v[72:75], v[108:111], v[24:27], v[72:75]
    v_cvt_pk_bf16_f32 v116, v88, v92
    v_mfma_f32_16x16x32_bf16 v[76:79], v[108:111], v[28:31], v[76:79]
    buffer_store_dword v116, v125, s[16:19], s44 offen offset:0 nt
    ds_read_b128 v[108:111], v126 offset:11264
    s_waitcnt lgkmcnt(3)
    v_mfma_f32_16x16x32_bf16 v[64:67], v[96:99], v[32:35], v[64:67]
    v_cvt_pk_bf16_f32 v117, v89, v93
    v_mfma_f32_16x16x32_bf16 v[68:71], v[96:99], v[36:39], v[68:71]
    buffer_store_dword v117, v125, s[16:19], s44 offen offset:512 nt
    ds_read_b128 v[96:99], v126 offset:12288
    s_waitcnt lgkmcnt(3)
    v_mfma_f32_16x16x32_bf16 v[72:75], v[100:103], v[32:35], v[72:75]
    v_cvt_pk_bf16_f32 v118, v90, v94
    v_mfma_f32_16x16x32_bf16 v[76:79], v[100:103], v[36:39], v[76:79]
    buffer_store_dword v118, v125, s[16:19], s44 offen offset:1024 nt
    ds_read_b128 v[100:103], v126 offset:13312
    s_waitcnt lgkmcnt(3)
    v_mfma_f32_16x16x32_bf16 v[64:67], v[104:107], v[40:43], v[64:67]
    v_cvt_pk_bf16_f32 v119, v91, v95
    v_mfma_f32_16x16x32_bf16 v[68:71], v[104:107], v[44:47], v[68:71]
    buffer_store_dword v119, v125, s[16:19], s44 offen offset:1536 nt
    ds_read_b128 v[104:107], v126 offset:14336
    s_waitcnt lgkmcnt(3)
    v_mfma_f32_16x16x32_bf16 v[72:75], v[108:111], v[40:43], v[72:75]
    v_add_u32 v125, 16384, v125
    v_mfma_f32_16x16x32_bf16 v[76:79], v[108:111], v[44:47], v[76:79]
    ds_read_b128 v[108:111], v126 offset:15360
    s_waitcnt lgkmcnt(3)
    v_mfma_f32_16x16x32_bf16 v[64:67], v[96:99], v[48:51], v[64:67]
    v_mfma_f32_16x16x32_bf16 v[68:71], v[96:99], v[52:55], v[68:71]
    s_waitcnt lgkmcnt(0)
    s_barrier
    ds_read_b128 v[96:99], v126 offset:16384
    v_mfma_f32_16x16x32_bf16 v[72:75], v[100:103], v[48:51], v[72:75]
    v_mfma_f32_16x16x32_bf16 v[76:79], v[100:103], v[52:55], v[76:79]
    ds_read_b128 v[100:103], v126 offset:17408
    v_mfma_f32_16x16x32_bf16 v[64:67], v[104:107], v[56:59], v[64:67]
    v_mfma_f32_16x16x32_bf16 v[68:71], v[104:107], v[60:63], v[68:71]
    ds_read_b128 v[104:107], v126 offset:18432
    v_mfma_f32_16x16x32_bf16 v[72:75], v[108:111], v[56:59], v[72:75]
    v_mfma_f32_16x16x32_bf16 v[76:79], v[108:111], v[60:63], v[76:79]
    ds_read_b128 v[108:111], v126 offset:19456
    s_waitcnt vmcnt(32)
    s_branch L_joint_kernel_oloop
L_joint_kernel_oend:
    s_nop 7
    v_cvt_pk_bf16_f32 v112, v80, v84
    buffer_store_dword v112, v125, s[16:19], 0 offen offset:0 nt
    v_cvt_pk_bf16_f32 v113, v81, v85
    buffer_store_dword v113, v125, s[16:19], 0 offen offset:512 nt
    v_cvt_pk_bf16_f32 v114, v82, v86
    buffer_store_dword v114, v125, s[16:19], 0 offen offset:1024 nt
    v_cvt_pk_bf16_f32 v115, v83, v87
    buffer_store_dword v115, v125, s[16:19], 0 offen offset:1536 nt
    v_cvt_pk_bf16_f32 v116, v88, v92
    buffer_store_dword v116, v125, s[16:19], s44 offen offset:0 nt
    v_cvt_pk_bf16_f32 v117, v89, v93
    buffer_store_dword v117, v125, s[16:19], s44 offen offset:512 nt
    v_cvt_pk_bf16_f32 v118, v90, v94
    buffer_store_dword v118, v125, s[16:19], s44 offen offset:1024 nt
    v_cvt_pk_bf16_f32 v119, v91, v95
    buffer_store_dword v119, v125, s[16:19], s44 offen offset:1536 nt
    v_add_u32 v125, 16384, v125
    s_branch L_joint_kernel_fin
L_joint_kernel_T:
    s_setprio 3
    s_lshl_b32 s36, s21, 2
    s_add_u32 s36, s36, 44335104
    s_add_u32 s36, s30, s36
    s_addc_u32 s37, s31, 0
    s_load_dword s44, s[36:37], 0
    v_and_b32 v123, 15, v127
    v_lshrrev_b32 v121, 4, v127
    v_mul_u32_u24 v125, 528, v123
    v_lshl_add_u32 v125, v121, 4, v125
    v_lshlrev_b32 v121, 5, v121
    v_and_b32 v120, 7, v127
    v_lshl_add_u32 v124, v120, 10, v121
    s_lshl_b32 s38, s21, 7
    v_mul_u32_u24 v120, 1040, v120
    s_add_u32 s36, s38, 91136
    v_add3_u32 v120, v120, v121, s36
    s_mul_i32 s36, s21, 5184
    s_add_u32 s36, s36, 49664
    v_add_u32 v121, s36, v121
    v_mul_u32_u24 v122, 144, v123
    v_add_u32 v122, v122, v121
    v_lshrrev_b32 v123, 3, v123
    v_mul_u32_u24 v123, 144, v123
    v_add_u32 v121, v123, v121
    s_lshl_b32 s36, s21, 11
    v_add_u32 v123, s36, v126
    s_barrier
    s_mov_b32 s36, 0
    buffer_load_dwordx4 v[0:3], v126, s[12:15], s36 offen offset:0
    buffer_load_dwordx4 v[4:7], v126, s[12:15], s36 offen offset:1024
    buffer_load_dwordx4 v[8:11], v126, s[12:15], s36 offen offset:2048
    buffer_load_dwordx4 v[12:15], v126, s[12:15], s36 offen offset:3072
    s_mov_b32 s36, 4096
    buffer_load_dwordx4 v[16:19], v126, s[12:15], s36 offen offset:0
    buffer_load_dwordx4 v[20:23], v126, s[12:15], s36 offen offset:1024
    buffer_load_dwordx4 v[24:27], v126, s[12:15], s36 offen offset:2048
    buffer_load_dwordx4 v[28:31], v126, s[12:15], s36 offen offset:3072
    s_mov_b32 s36, 8192
    buffer_load_dwordx4 v[32:35], v126, s[12:15], s36 offen offset:0
    buffer_load_dwordx4 v[36:39], v126, s[12:15], s36 offen offset:1024
    buffer_load_dwordx4 v[40:43], v126, s[12:15], s36 offen offset:2048
    buffer_load_dwordx4 v[44:47], v126, s[12:15], s36 offen offset:3072
    s_mov_b32 s36, 12288
    buffer_load_dwordx4 v[48:51], v126, s[12:15], s36 offen offset:0
    buffer_load_dwordx4 v[52:55], v126, s[12:15], s36 offen offset:1024
    buffer_load_dwordx4 v[56:59], v126, s[12:15], s36 offen offset:2048
    buffer_load_dwordx4 v[60:63], v126, s[12:15], s36 offen offset:3072
    v_mov_b32 v64, 99456
    v_mov_b32 v65, 1
    s_mov_b64 exec, 1
    ds_add_u32 v64, v65 offset:4
    s_mov_b64 exec, -1
L_joint_kernel_tw:
    ds_read_b32 v65, v64 offset:0
    s_waitcnt lgkmcnt(0)
    v_readfirstlane_b32 s37, v65
    s_cmp_ge_u32 s37, 8
    s_cbranch_scc1 L_joint_kernel_tw_d
    s_sleep 1
    s_branch L_joint_kernel_tw
L_joint_kernel_tw_d:
    ds_read_b128 v[80:83], v125 offset:32768
    ds_read_b128 v[84:87], v125 offset:41216
    ds_read_b128 v[88:91], v125 offset:32832
    ds_read_b128 v[92:95], v125 offset:41280
    ds_read_b128 v[96:99], v125 offset:32896
    ds_read_b128 v[100:103], v125 offset:41344
    ds_read_b128 v[104:107], v125 offset:32960
    ds_read_b128 v[108:111], v125 offset:41408
    s_setprio 0
    s_waitcnt vmcnt(14) lgkmcnt(7)
    v_mfma_f32_16x16x32_bf16 v[64:67], v[0:3], v[80:83], 0
    v_mfma_f32_16x16x32_bf16 v[68:71], v[4:7], v[80:83], 0
    ds_read_b128 v[80:83], v125 offset:33024
    s_waitcnt lgkmcnt(7)
    v_mfma_f32_16x16x32_bf16 v[72:75], v[0:3], v[84:87], 0
    v_mfma_f32_16x16x32_bf16 v[76:79], v[4:7], v[84:87], 0
    ds_read_b128 v[84:87], v125 offset:41472
    s_waitcnt vmcnt(12) lgkmcnt(7)
    v_mfma_f32_16x16x32_bf16 v[64:67], v[8:11], v[88:91], v[64:67]
    v_mfma_f32_16x16x32_bf16 v[68:71], v[12:15], v[88:91], v[68:71]
    ds_read_b128 v[88:91], v125 offset:33088
    s_waitcnt lgkmcnt(7)
    v_mfma_f32_16x16x32_bf16 v[72:75], v[8:11], v[92:95], v[72:75]
    v_mfma_f32_16x16x32_bf16 v[76:79], v[12:15], v[92:95], v[76:79]
    ds_read_b128 v[92:95], v125 offset:41536
    s_waitcnt vmcnt(10) lgkmcnt(7)
    v_mfma_f32_16x16x32_bf16 v[64:67], v[16:19], v[96:99], v[64:67]
    v_mfma_f32_16x16x32_bf16 v[68:71], v[20:23], v[96:99], v[68:71]
    ds_read_b128 v[96:99], v125 offset:33152
    s_waitcnt lgkmcnt(7)
    v_mfma_f32_16x16x32_bf16 v[72:75], v[16:19], v[100:103], v[72:75]
    v_mfma_f32_16x16x32_bf16 v[76:79], v[20:23], v[100:103], v[76:79]
    ds_read_b128 v[100:103], v125 offset:41600
    s_waitcnt vmcnt(8) lgkmcnt(7)
    v_mfma_f32_16x16x32_bf16 v[64:67], v[24:27], v[104:107], v[64:67]
    v_mfma_f32_16x16x32_bf16 v[68:71], v[28:31], v[104:107], v[68:71]
    ds_read_b128 v[104:107], v125 offset:33216
    s_waitcnt lgkmcnt(7)
    v_mfma_f32_16x16x32_bf16 v[72:75], v[24:27], v[108:111], v[72:75]
    v_mfma_f32_16x16x32_bf16 v[76:79], v[28:31], v[108:111], v[76:79]
    ds_read_b128 v[108:111], v125 offset:41664
    s_waitcnt vmcnt(6) lgkmcnt(7)
    v_mfma_f32_16x16x32_bf16 v[64:67], v[32:35], v[80:83], v[64:67]
    v_mfma_f32_16x16x32_bf16 v[68:71], v[36:39], v[80:83], v[68:71]
    ds_read_b128 v[112:115], v120 offset:0
    s_waitcnt lgkmcnt(7)
    v_mfma_f32_16x16x32_bf16 v[72:75], v[32:35], v[84:87], v[72:75]
    v_mfma_f32_16x16x32_bf16 v[76:79], v[36:39], v[84:87], v[76:79]
    ds_read_b128 v[116:119], v120 offset:16
    s_waitcnt vmcnt(4) lgkmcnt(7)
    v_mfma_f32_16x16x32_bf16 v[64:67], v[40:43], v[88:91], v[64:67]
    v_mfma_f32_16x16x32_bf16 v[68:71], v[44:47], v[88:91], v[68:71]
    s_waitcnt lgkmcnt(6)
    v_mfma_f32_16x16x32_bf16 v[72:75], v[40:43], v[92:95], v[72:75]
    v_mfma_f32_16x16x32_bf16 v[76:79], v[44:47], v[92:95], v[76:79]
    s_waitcnt vmcnt(2) lgkmcnt(5)
    v_mfma_f32_16x16x32_bf16 v[64:67], v[48:51], v[96:99], v[64:67]
    v_mfma_f32_16x16x32_bf16 v[68:71], v[52:55], v[96:99], v[68:71]
    s_waitcnt lgkmcnt(4)
    v_mfma_f32_16x16x32_bf16 v[72:75], v[48:51], v[100:103], v[72:75]
    v_mfma_f32_16x16x32_bf16 v[76:79], v[52:55], v[100:103], v[76:79]
    s_waitcnt vmcnt(0) lgkmcnt(3)
    v_mfma_f32_16x16x32_bf16 v[64:67], v[56:59], v[104:107], v[64:67]
    v_mfma_f32_16x16x32_bf16 v[68:71], v[60:63], v[104:107], v[68:71]
    s_waitcnt lgkmcnt(2)
    v_mfma_f32_16x16x32_bf16 v[72:75], v[56:59], v[108:111], v[72:75]
    v_mfma_f32_16x16x32_bf16 v[76:79], v[60:63], v[108:111], v[76:79]
    s_mov_b32 s46, 0xffff0000
    s_mov_b32 s48, 0x4038aa3b
    s_mov_b32 s49, s48
    s_nop 3
    v_mov_b32 v28, 0
    s_waitcnt lgkmcnt(0)
    v_cvt_pk_bf16_f32 v24, v64, v68
    v_cvt_pk_bf16_f32 v25, v65, v69
    v_cvt_pk_bf16_f32 v26, v66, v70
    v_cvt_pk_bf16_f32 v27, v67, v71
    v_lshlrev_b32 v80, 16, v24
    v_and_b32 v81, s46, v24
    v_lshlrev_b32 v82, 16, v25
    v_and_b32 v83, s46, v25
    v_lshlrev_b32 v84, 16, v26
    v_and_b32 v85, s46, v26
    v_lshlrev_b32 v86, 16, v27
    v_and_b32 v87, s46, v27
    v_pk_mul_f32 v[80:81], v[80:81], s[48:49]
    v_pk_mul_f32 v[82:83], v[82:83], s[48:49]
    v_pk_mul_f32 v[84:85], v[84:85], s[48:49]
    v_pk_mul_f32 v[86:87], v[86:87], s[48:49]
    v_exp_f32 v96, v80
    v_exp_f32 v97, v81
    v_exp_f32 v98, v82
    v_exp_f32 v99, v83
    v_max3_f32 v28, |v80|, |v81|, v28
    v_max3_f32 v28, |v82|, |v83|, v28
    ds_write_b128 v122, v[96:99] offset:0
    v_exp_f32 v100, v84
    v_exp_f32 v101, v85
    v_exp_f32 v102, v86
    v_exp_f32 v103, v87
    v_max3_f32 v28, |v84|, |v85|, v28
    v_max3_f32 v28, |v86|, |v87|, v28
    ds_write_b128 v122, v[100:103] offset:16
    v_cvt_pk_bf16_f32 v24, v72, v76
    v_cvt_pk_bf16_f32 v25, v73, v77
    v_cvt_pk_bf16_f32 v26, v74, v78
    v_cvt_pk_bf16_f32 v27, v75, v79
    v_lshlrev_b32 v88, 16, v24
    v_and_b32 v89, s46, v24
    v_lshlrev_b32 v90, 16, v25
    v_and_b32 v91, s46, v25
    v_lshlrev_b32 v92, 16, v26
    v_and_b32 v93, s46, v26
    v_lshlrev_b32 v94, 16, v27
    v_and_b32 v95, s46, v27
    v_pk_mul_f32 v[88:89], v[88:89], s[48:49]
    v_pk_mul_f32 v[90:91], v[90:91], s[48:49]
    v_pk_mul_f32 v[92:93], v[92:93], s[48:49]
    v_pk_mul_f32 v[94:95], v[94:95], s[48:49]
    v_exp_f32 v104, v88
    v_exp_f32 v105, v89
    v_exp_f32 v106, v90
    v_exp_f32 v107, v91
    v_max3_f32 v28, |v88|, |v89|, v28
    v_max3_f32 v28, |v90|, |v91|, v28
    ds_write_b128 v122, v[104:107] offset:2304
    v_exp_f32 v108, v92
    v_exp_f32 v109, v93
    v_exp_f32 v110, v94
    v_exp_f32 v111, v95
    v_max3_f32 v28, |v92|, |v93|, v28
    v_max3_f32 v28, |v94|, |v95|, v28
    ds_write_b128 v122, v[108:111] offset:2320
    v_cmp_lt_f32 vcc, 0x42f00000, v28
    s_mov_b32 s22, 4
    s_or_b32 s44, s44, vcc_lo
    s_or_b32 s44, s44, vcc_hi
    s_cmp_lg_u32 s44, 0
    s_cbranch_scc1 L_joint_kernel_tslow
    ds_read_b128 v[32:35], v121 offset:0
    ds_read_b128 v[36:39], v121 offset:16
    ds_read_b128 v[40:43], v121 offset:288
    ds_read_b128 v[44:47], v121 offset:304
    v_add_u32 v121, 576, v121
    s_waitcnt vmcnt(0) lgkmcnt(0)
L_joint_kernel_tloop1:
    v_fma_f32 v48, v112, v32, 1.0
    v_fma_f32 v49, v113, v33, 1.0
    v_fma_f32 v50, v114, v34, 1.0
    v_fma_f32 v51, v115, v35, 1.0
    v_fma_f32 v52, v116, v36, 1.0
    v_fma_f32 v53, v117, v37, 1.0
    v_fma_f32 v54, v118, v38, 1.0
    v_fma_f32 v55, v119, v39, 1.0
    v_fma_f32 v56, v112, v40, 1.0
    v_fma_f32 v57, v113, v41, 1.0
    v_fma_f32 v58, v114, v42, 1.0
    v_fma_f32 v59, v115, v43, 1.0
    v_fma_f32 v60, v116, v44, 1.0
    v_fma_f32 v61, v117, v45, 1.0
    v_fma_f32 v62, v118, v46, 1.0
    v_fma_f32 v63, v119, v47, 1.0
    ds_read_b128 v[32:35], v121 offset:0
    ds_read_b128 v[36:39], v121 offset:16
    ds_read_b128 v[40:43], v121 offset:288
    ds_read_b128 v[44:47], v121 offset:304
    v_add_u32 v121, 576, v121
    v_rcp_f32 v48, v48
    v_rcp_f32 v49, v49
    v_rcp_f32 v50, v50
    v_rcp_f32 v51, v51
    v_rcp_f32 v52, v52
    v_rcp_f32 v53, v53
    v_rcp_f32 v54, v54
    v_rcp_f32 v55, v55
    v_fma_f32 v48, v48, -2.0, 1.0
    v_fma_f32 v49, v49, -2.0, 1.0
    v_fma_f32 v50, v50, -2.0, 1.0
    v_fma_f32 v51, v51, -2.0, 1.0
    v_fma_f32 v52, v52, -2.0, 1.0
    v_fma_f32 v53, v53, -2.0, 1.0
    v_fma_f32 v54, v54, -2.0, 1.0
    v_fma_f32 v55, v55, -2.0, 1.0
    v_cvt_pk_bf16_f32 v64, v48, v49
    v_cvt_pk_bf16_f32 v65, v50, v51
    v_cvt_pk_bf16_f32 v66, v52, v53
    v_cvt_pk_bf16_f32 v67, v54, v55
    ds_write_b128 v123, v[64:67] offset:0
    v_rcp_f32 v56, v56
    v_rcp_f32 v57, v57
    v_rcp_f32 v58, v58
    v_rcp_f32 v59, v59
    v_rcp_f32 v60, v60
    v_rcp_f32 v61, v61
    v_rcp_f32 v62, v62
    v_rcp_f32 v63, v63
    v_fma_f32 v56, v56, -2.0, 1.0
    v_fma_f32 v57, v57, -2.0, 1.0
    v_fma_f32 v58, v58, -2.0, 1.0
    v_fma_f32 v59, v59, -2.0, 1.0
    v_fma_f32 v60, v60, -2.0, 1.0
    v_fma_f32 v61, v61, -2.0, 1.0
    v_fma_f32 v62, v62, -2.0, 1.0
    v_fma_f32 v63, v63, -2.0, 1.0
    v_cvt_pk_bf16_f32 v68, v56, v57
    v_cvt_pk_bf16_f32 v69, v58, v59
    v_cvt_pk_bf16_f32 v70, v60, v61
    v_cvt_pk_bf16_f32 v71, v62, v63
    ds_write_b128 v123, v[68:71] offset:1024
    s_waitcnt lgkmcnt(0)
    s_barrier
    v_fma_f32 v48, v112, v32, 1.0
    v_fma_f32 v49, v113, v33, 1.0
    v_fma_f32 v50, v114, v34, 1.0
    v_fma_f32 v51, v115, v35, 1.0
    v_fma_f32 v52, v116, v36, 1.0
    v_fma_f32 v53, v117, v37, 1.0
    v_fma_f32 v54, v118, v38, 1.0
    v_fma_f32 v55, v119, v39, 1.0
    v_fma_f32 v56, v112, v40, 1.0
    v_fma_f32 v57, v113, v41, 1.0
    v_fma_f32 v58, v114, v42, 1.0
    v_fma_f32 v59, v115, v43, 1.0
    v_fma_f32 v60, v116, v44, 1.0
    v_fma_f32 v61, v117, v45, 1.0
    v_fma_f32 v62, v118, v46, 1.0
    v_fma_f32 v63, v119, v47, 1.0
    ds_read_b128 v[32:35], v121 offset:0
    ds_read_b128 v[36:39], v121 offset:16
    ds_read_b128 v[40:43], v121 offset:288
    ds_read_b128 v[44:47], v121 offset:304
    v_add_u32 v121, 576, v121
    v_rcp_f32 v48, v48
    v_rcp_f32 v49, v49
    v_rcp_f32 v50, v50
    v_rcp_f32 v51, v51
    v_rcp_f32 v52, v52
    v_rcp_f32 v53, v53
    v_rcp_f32 v54, v54
    v_rcp_f32 v55, v55
    v_fma_f32 v48, v48, -2.0, 1.0
    v_fma_f32 v49, v49, -2.0, 1.0
    v_fma_f32 v50, v50, -2.0, 1.0
    v_fma_f32 v51, v51, -2.0, 1.0
    v_fma_f32 v52, v52, -2.0, 1.0
    v_fma_f32 v53, v53, -2.0, 1.0
    v_fma_f32 v54, v54, -2.0, 1.0
    v_fma_f32 v55, v55, -2.0, 1.0
    v_cvt_pk_bf16_f32 v64, v48, v49
    v_cvt_pk_bf16_f32 v65, v50, v51
    v_cvt_pk_bf16_f32 v66, v52, v53
    v_cvt_pk_bf16_f32 v67, v54, v55
    ds_write_b128 v123, v[64:67] offset:16384
    v_rcp_f32 v56, v56
    v_rcp_f32 v57, v57
    v_rcp_f32 v58, v58
    v_rcp_f32 v59, v59
    v_rcp_f32 v60, v60
    v_rcp_f32 v61, v61
    v_rcp_f32 v62, v62
    v_rcp_f32 v63, v63
    v_fma_f32 v56, v56, -2.0, 1.0
    v_fma_f32 v57, v57, -2.0, 1.0
    v_fma_f32 v58, v58, -2.0, 1.0
    v_fma_f32 v59, v59, -2.0, 1.0
    v_fma_f32 v60, v60, -2.0, 1.0
    v_fma_f32 v61, v61, -2.0, 1.0
    v_fma_f32 v62, v62, -2.0, 1.0
    v_fma_f32 v63, v63, -2.0, 1.0
    v_cvt_pk_bf16_f32 v68, v56, v57
    v_cvt_pk_bf16_f32 v69, v58, v59
    v_cvt_pk_bf16_f32 v70, v60, v61
    v_cvt_pk_bf16_f32 v71, v62, v63
    ds_write_b128 v123, v[68:71] offset:17408
    s_waitcnt lgkmcnt(0)
    s_barrier
    s_sub_u32 s22, s22, 1
    s_cmp_lg_u32 s22, 0
    s_cbranch_scc1 L_joint_kernel_tloop1
    s_branch L_joint_kernel_fin
L_joint_kernel_tslow:
    buffer_load_dwordx4 v[112:115], v124, s[40:43], s38 offen offset:0
    buffer_load_dwordx4 v[116:119], v124, s[40:43], s38 offen offset:16
    ds_write_b128 v122, v[80:83] offset:0
    ds_write_b128 v122, v[84:87] offset:16
    ds_write_b128 v122, v[88:91] offset:2304
    ds_write_b128 v122, v[92:95] offset:2320
    ds_read_b128 v[32:35], v121 offset:0
    ds_read_b128 v[36:39], v121 offset:16
    ds_read_b128 v[40:43], v121 offset:288
    ds_read_b128 v[44:47], v121 offset:304
    v_add_u32 v121, 576, v121
    s_waitcnt vmcnt(0) lgkmcnt(0)
L_joint_kernel_tloop0:
    v_add_f32 v48, v112, v32
    v_add_f32 v49, v113, v33
    v_add_f32 v50, v114, v34
    v_add_f32 v51, v115, v35
    v_add_f32 v52, v116, v36
    v_add_f32 v53, v117, v37
    v_add_f32 v54, v118, v38
    v_add_f32 v55, v119, v39
    v_add_f32 v56, v112, v40
    v_add_f32 v57, v113, v41
    v_add_f32 v58, v114, v42
    v_add_f32 v59, v115, v43
    v_add_f32 v60, v116, v44
    v_add_f32 v61, v117, v45
    v_add_f32 v62, v118, v46
    v_add_f32 v63, v119, v47
    ds_read_b128 v[32:35], v121 offset:0
    ds_read_b128 v[36:39], v121 offset:16
    ds_read_b128 v[40:43], v121 offset:288
    ds_read_b128 v[44:47], v121 offset:304
    v_add_u32 v121, 576, v121
    v_exp_f32 v48, v48
    v_exp_f32 v49, v49
    v_exp_f32 v50, v50
    v_exp_f32 v51, v51
    v_exp_f32 v52, v52
    v_exp_f32 v53, v53
    v_exp_f32 v54, v54
    v_exp_f32 v55, v55
    v_add_f32 v48, 1.0, v48
    v_add_f32 v49, 1.0, v49
    v_add_f32 v50, 1.0, v50
    v_add_f32 v51, 1.0, v51
    v_add_f32 v52, 1.0, v52
    v_add_f32 v53, 1.0, v53
    v_add_f32 v54, 1.0, v54
    v_add_f32 v55, 1.0, v55
    v_rcp_f32 v48, v48
    v_rcp_f32 v49, v49
    v_rcp_f32 v50, v50
    v_rcp_f32 v51, v51
    v_rcp_f32 v52, v52
    v_rcp_f32 v53, v53
    v_rcp_f32 v54, v54
    v_rcp_f32 v55, v55
    v_fma_f32 v48, v48, -2.0, 1.0
    v_fma_f32 v49, v49, -2.0, 1.0
    v_fma_f32 v50, v50, -2.0, 1.0
    v_fma_f32 v51, v51, -2.0, 1.0
    v_fma_f32 v52, v52, -2.0, 1.0
    v_fma_f32 v53, v53, -2.0, 1.0
    v_fma_f32 v54, v54, -2.0, 1.0
    v_fma_f32 v55, v55, -2.0, 1.0
    v_cvt_pk_bf16_f32 v64, v48, v49
    v_cvt_pk_bf16_f32 v65, v50, v51
    v_cvt_pk_bf16_f32 v66, v52, v53
    v_cvt_pk_bf16_f32 v67, v54, v55
    ds_write_b128 v123, v[64:67] offset:0
    v_exp_f32 v56, v56
    v_exp_f32 v57, v57
    v_exp_f32 v58, v58
    v_exp_f32 v59, v59
    v_exp_f32 v60, v60
    v_exp_f32 v61, v61
    v_exp_f32 v62, v62
    v_exp_f32 v63, v63
    v_add_f32 v56, 1.0, v56
    v_add_f32 v57, 1.0, v57
    v_add_f32 v58, 1.0, v58
    v_add_f32 v59, 1.0, v59
    v_add_f32 v60, 1.0, v60
    v_add_f32 v61, 1.0, v61
    v_add_f32 v62, 1.0, v62
    v_add_f32 v63, 1.0, v63
    v_rcp_f32 v56, v56
    v_rcp_f32 v57, v57
    v_rcp_f32 v58, v58
    v_rcp_f32 v59, v59
    v_rcp_f32 v60, v60
    v_rcp_f32 v61, v61
    v_rcp_f32 v62, v62
    v_rcp_f32 v63, v63
    v_fma_f32 v56, v56, -2.0, 1.0
    v_fma_f32 v57, v57, -2.0, 1.0
    v_fma_f32 v58, v58, -2.0, 1.0
    v_fma_f32 v59, v59, -2.0, 1.0
    v_fma_f32 v60, v60, -2.0, 1.0
    v_fma_f32 v61, v61, -2.0, 1.0
    v_fma_f32 v62, v62, -2.0, 1.0
    v_fma_f32 v63, v63, -2.0, 1.0
    v_cvt_pk_bf16_f32 v68, v56, v57
    v_cvt_pk_bf16_f32 v69, v58, v59
    v_cvt_pk_bf16_f32 v70, v60, v61
    v_cvt_pk_bf16_f32 v71, v62, v63
    ds_write_b128 v123, v[68:71] offset:1024
    s_waitcnt lgkmcnt(0)
    s_barrier
    v_add_f32 v48, v112, v32
    v_add_f32 v49, v113, v33
    v_add_f32 v50, v114, v34
    v_add_f32 v51, v115, v35
    v_add_f32 v52, v116, v36
    v_add_f32 v53, v117, v37
    v_add_f32 v54, v118, v38
    v_add_f32 v55, v119, v39
    v_add_f32 v56, v112, v40
    v_add_f32 v57, v113, v41
    v_add_f32 v58, v114, v42
    v_add_f32 v59, v115, v43
    v_add_f32 v60, v116, v44
    v_add_f32 v61, v117, v45
    v_add_f32 v62, v118, v46
    v_add_f32 v63, v119, v47
    ds_read_b128 v[32:35], v121 offset:0
    ds_read_b128 v[36:39], v121 offset:16
    ds_read_b128 v[40:43], v121 offset:288
    ds_read_b128 v[44:47], v121 offset:304
    v_add_u32 v121, 576, v121
    v_exp_f32 v48, v48
    v_exp_f32 v49, v49
    v_exp_f32 v50, v50
    v_exp_f32 v51, v51
    v_exp_f32 v52, v52
    v_exp_f32 v53, v53
    v_exp_f32 v54, v54
    v_exp_f32 v55, v55
    v_add_f32 v48, 1.0, v48
    v_add_f32 v49, 1.0, v49
    v_add_f32 v50, 1.0, v50
    v_add_f32 v51, 1.0, v51
    v_add_f32 v52, 1.0, v52
    v_add_f32 v53, 1.0, v53
    v_add_f32 v54, 1.0, v54
    v_add_f32 v55, 1.0, v55
    v_rcp_f32 v48, v48
    v_rcp_f32 v49, v49
    v_rcp_f32 v50, v50
    v_rcp_f32 v51, v51
    v_rcp_f32 v52, v52
    v_rcp_f32 v53, v53
    v_rcp_f32 v54, v54
    v_rcp_f32 v55, v55
    v_fma_f32 v48, v48, -2.0, 1.0
    v_fma_f32 v49, v49, -2.0, 1.0
    v_fma_f32 v50, v50, -2.0, 1.0
    v_fma_f32 v51, v51, -2.0, 1.0
    v_fma_f32 v52, v52, -2.0, 1.0
    v_fma_f32 v53, v53, -2.0, 1.0
    v_fma_f32 v54, v54, -2.0, 1.0
    v_fma_f32 v55, v55, -2.0, 1.0
    v_cvt_pk_bf16_f32 v64, v48, v49
    v_cvt_pk_bf16_f32 v65, v50, v51
    v_cvt_pk_bf16_f32 v66, v52, v53
    v_cvt_pk_bf16_f32 v67, v54, v55
    ds_write_b128 v123, v[64:67] offset:16384
    v_exp_f32 v56, v56
    v_exp_f32 v57, v57
    v_exp_f32 v58, v58
    v_exp_f32 v59, v59
    v_exp_f32 v60, v60
    v_exp_f32 v61, v61
    v_exp_f32 v62, v62
    v_exp_f32 v63, v63
    v_add_f32 v56, 1.0, v56
    v_add_f32 v57, 1.0, v57
    v_add_f32 v58, 1.0, v58
    v_add_f32 v59, 1.0, v59
    v_add_f32 v60, 1.0, v60
    v_add_f32 v61, 1.0, v61
    v_add_f32 v62, 1.0, v62
    v_add_f32 v63, 1.0, v63
    v_rcp_f32 v56, v56
    v_rcp_f32 v57, v57
    v_rcp_f32 v58, v58
    v_rcp_f32 v59, v59
    v_rcp_f32 v60, v60
    v_rcp_f32 v61, v61
    v_rcp_f32 v62, v62
    v_rcp_f32 v63, v63
    v_fma_f32 v56, v56, -2.0, 1.0
    v_fma_f32 v57, v57, -2.0, 1.0
    v_fma_f32 v58, v58, -2.0, 1.0
    v_fma_f32 v59, v59, -2.0, 1.0
    v_fma_f32 v60, v60, -2.0, 1.0
    v_fma_f32 v61, v61, -2.0, 1.0
    v_fma_f32 v62, v62, -2.0, 1.0
    v_fma_f32 v63, v63, -2.0, 1.0
    v_cvt_pk_bf16_f32 v68, v56, v57
    v_cvt_pk_bf16_f32 v69, v58, v59
    v_cvt_pk_bf16_f32 v70, v60, v61
    v_cvt_pk_bf16_f32 v71, v62, v63
    ds_write_b128 v123, v[68:71] offset:17408
    s_waitcnt lgkmcnt(0)
    s_barrier
    s_sub_u32 s22, s22, 1
    s_cmp_lg_u32 s22, 0
    s_cbranch_scc1 L_joint_kernel_tloop0
L_joint_kernel_fin:
L_joint_kernel_done:
    s_endpgm
.section .rodata,"a"
.p2align 6
.amdhsa_kernel prep_kernel
  .amdhsa_next_free_vgpr 128
  .amdhsa_next_free_sgpr 102
  .amdhsa_accum_offset 128
  .amdhsa_group_segment_fixed_size 0
  .amdhsa_kernarg_size 80
  .amdhsa_user_sgpr_count 2
  .amdhsa_user_sgpr_kernarg_segment_ptr 1
  .amdhsa_system_sgpr_workgroup_id_x 1
.end_amdhsa_kernel
.p2align 6
.amdhsa_kernel conv1_kernel
  .amdhsa_next_free_vgpr 128
  .amdhsa_next_free_sgpr 102
  .amdhsa_accum_offset 128
  .amdhsa_group_segment_fixed_size 0
  .amdhsa_kernarg_size 80
  .amdhsa_user_sgpr_count 2
  .amdhsa_user_sgpr_kernarg_segment_ptr 1
  .amdhsa_system_sgpr_workgroup_id_x 1
.end_amdhsa_kernel
.p2align 6
.amdhsa_kernel conv2_kernel
  .amdhsa_next_free_vgpr 128
  .amdhsa_next_free_sgpr 102
  .amdhsa_accum_offset 128
  .amdhsa_group_segment_fixed_size 0
  .amdhsa_kernarg_size 80
  .amdhsa_user_sgpr_count 2
  .amdhsa_user_sgpr_kernarg_segment_ptr 1
  .amdhsa_system_sgpr_workgroup_id_x 1
.end_amdhsa_kernel
.p2align 6
.amdhsa_kernel joint_kernel
  .amdhsa_next_free_vgpr 128
  .amdhsa_next_free_sgpr 102
  .amdhsa_accum_offset 128
  .amdhsa_group_segment_fixed_size 0
  .amdhsa_kernarg_size 80
  .amdhsa_user_sgpr_count 2
  .amdhsa_user_sgpr_kernarg_segment_ptr 1
  .amdhsa_system_sgpr_workgroup_id_x 1
.end_amdhsa_kernel
```

```asm
; @launch kernel=prep_kernel grid=(256,1,1) block=(384,1,1) lds=4096
; @launch kernel=conv1_kernel grid=(256,1,1) block=(1024,1,1) lds=162816
; @launch kernel=conv2_kernel grid=(256,1,1) block=(1024,1,1) lds=162816
; @launch kernel=joint_kernel grid=(250,1,1) block=(1024,1,1) lds=99472
.amdgcn_target "amdgcn-amd-amdhsa--gfx950"
.text
.globl prep_kernel
.p2align 8
.type prep_kernel,@function
prep_kernel:
    s_cmp_ge_u32 s2, 256
    s_cbranch_scc1 L_prep_kernel_done
    s_mov_b32 s3, s2
    s_load_dwordx16 s[44:59], s[0:1], 0
    s_load_dwordx2 s[30:31], s[0:1], 72
    v_readfirstlane_b32 s40, v0
    s_lshr_b32 s40, s40, 6
    v_and_b32 v1, 63, v0
    s_cmp_lt_u32 s40, 4
    s_cbranch_scc1 L_prep_kernel_w
    s_cmp_ge_u32 s2, 24
    s_cbranch_scc1 L_prep_kernel_done
    s_lshr_b32 s41, s2, 3
    s_and_b32 s42, s2, 7
    s_sub_u32 s43, s40, 4
    s_lshl_b32 s26, s43, 16
    s_lshl_b32 s5, s42, 6
    s_add_u32 s26, s26, s5
    s_mov_b32 s10, 131072
    s_mov_b32 s11, 0x00020000
    v_lshrrev_b32 v2, 4, v1
    v_lshlrev_b32 v2, 12, v2
    v_and_b32 v3, 15, v1
    v_lshl_add_u32 v2, v3, 2, v2
    v_mov_b32 v9, 0
    ds_write_b32 v9, v9 offset:2048
    s_waitcnt lgkmcnt(0)
    s_cmp_eq_u32 s41, 1
    s_cselect_b32 s8, s56, s52
    s_cselect_b32 s9, s57, s53
    s_cmp_eq_u32 s41, 2
    s_cselect_b32 s8, s54, s8
    s_cselect_b32 s9, s55, s9
    s_barrier
    s_cmp_lg_u32 s41, 2
    s_cbranch_scc1 L_prep_kernel_nog
    s_mov_b32 s16, s50
    s_mov_b32 s17, s51
    s_mov_b32 s18, 8192
    s_mov_b32 s19, 0x00020000
    v_and_b32 v6, 0x30, v1
    v_lshl_add_u32 v6, v3, 9, v6
    s_lshl_b32 s6, s43, 8
    buffer_load_dwordx4 v[80:83], v6, s[16:19], s6 offen offset:0
    buffer_load_dwordx4 v[84:87], v6, s[16:19], s6 offen offset:64
    buffer_load_dwordx4 v[88:91], v6, s[16:19], s6 offen offset:128
    buffer_load_dwordx4 v[92:95], v6, s[16:19], s6 offen offset:192
L_prep_kernel_nog:
    buffer_load_dword v16, v2, s[8:11], s26 offen offset:0
    buffer_load_dword v17, v2, s[8:11], s26 offen offset:512
    buffer_load_dword v18, v2, s[8:11], s26 offen offset:1024
    buffer_load_dword v19, v2, s[8:11], s26 offen offset:1536
    buffer_load_dword v20, v2, s[8:11], s26 offen offset:2048
    buffer_load_dword v21, v2, s[8:11], s26 offen offset:2560
    buffer_load_dword v22, v2, s[8:11], s26 offen offset:3072
    buffer_load_dword v23, v2, s[8:11], s26 offen offset:3584
    s_add_u32 s26, s26, 16384
    buffer_load_dword v24, v2, s[8:11], s26 offen offset:0
    buffer_load_dword v25, v2, s[8:11], s26 offen offset:512
    buffer_load_dword v26, v2, s[8:11], s26 offen offset:1024
    buffer_load_dword v27, v2, s[8:11], s26 offen offset:1536
    buffer_load_dword v28, v2, s[8:11], s26 offen offset:2048
    buffer_load_dword v29, v2, s[8:11], s26 offen offset:2560
    buffer_load_dword v30, v2, s[8:11], s26 offen offset:3072
    buffer_load_dword v31, v2, s[8:11], s26 offen offset:3584
    s_add_u32 s26, s26, 16384
    buffer_load_dword v32, v2, s[8:11], s26 offen offset:0
    buffer_load_dword v33, v2, s[8:11], s26 offen offset:512
    buffer_load_dword v34, v2, s[8:11], s26 offen offset:1024
    buffer_load_dword v35, v2, s[8:11], s26 offen offset:1536
    buffer_load_dword v36, v2, s[8:11], s26 offen offset:2048
    buffer_load_dword v37, v2, s[8:11], s26 offen offset:2560
    buffer_load_dword v38, v2, s[8:11], s26 offen offset:3072
    buffer_load_dword v39, v2, s[8:11], s26 offen offset:3584
    s_add_u32 s26, s26, 16384
    buffer_load_dword v40, v2, s[8:11], s26 offen offset:0
    buffer_load_dword v41, v2, s[8:11], s26 offen offset:512
    buffer_load_dword v42, v2, s[8:11], s26 offen offset:1024
    buffer_load_dword v43, v2, s[8:11], s26 offen offset:1536
    buffer_load_dword v44, v2, s[8:11], s26 offen offset:2048
    buffer_load_dword v45, v2, s[8:11], s26 offen offset:2560
    buffer_load_dword v46, v2, s[8:11], s26 offen offset:3072
    buffer_load_dword v47, v2, s[8:11], s26 offen offset:3584
    s_branch L_prep_kernel_small
L_prep_kernel_w:
    s_lshl_b32 s21, s2, 2
    s_add_u32 s20, s40, s21
    s_load_dwordx2 s[8:9], s[0:1], 8
    s_lshr_b32 s22, s20, 8
    s_bfe_u32 s23, s20, 0x40004
    s_bfe_u32 s24, s20, 0x30001
    s_and_b32 s21, s20, 1
    v_lshrrev_b32 v5, 4, v1
    v_lshlrev_b32 v2, 11, v5
    v_and_b32 v3, 15, v1
    v_lshl_add_u32 v2, v3, 2, v2
    s_lshl_b32 s26, s22, 3
    s_lshr_b32 s27, s23, 3
    s_add_u32 s26, s26, s27
    s_lshl_b32 s26, s26, 17
    s_and_b32 s27, s23, 7
    s_lshl_b32 s27, s27, 1
    s_add_u32 s27, s27, s21
    s_lshl_b32 s27, s27, 13
    s_add_u32 s26, s26, s27
    s_lshl_b32 s27, s24, 6
    s_add_u32 s26, s26, s27
    s_mov_b32 s10, 4063232
    s_mov_b32 s11, 0x00020000
    s_add_u32 s37, s26, 262144
    s_add_u32 s38, s26, 524288
    s_add_u32 s39, s26, 786432
    s_mov_b32 s14, 7340032
    s_mov_b32 s15, 0x00020000
    v_lshrrev_b32 v4, 1, v5
    v_lshlrev_b32 v4, 8, v4
    v_lshl_add_u32 v4, v3, 4, v4
    v_and_b32 v5, 1, v5
    v_lshl_add_u32 v4, v5, 10, v4
    s_lshl_b32 s27, s24, 4
    s_add_u32 s27, s27, s23
    s_mul_i32 s27, s27, 57344
    s_lshl_b32 s28, s22, 11
    s_add_u32 s27, s27, s28
    s_lshl_b32 s28, s21, 9
    s_add_u32 s27, s27, s28
    s_mov_b32 s32, 0x05040100
    s_mov_b32 s33, 0x07060302
    s_mov_b32 s34, 0xffff0000
    s_mov_b32 s35, 0x3d2aaaab
    s_mov_b32 s40, 0x3c638e39
    s_waitcnt lgkmcnt(0)
    buffer_load_dword v16, v2, s[8:11], s26 offen offset:0
    buffer_load_dword v17, v2, s[8:11], s26 offen offset:512
    buffer_load_dword v20, v2, s[8:11], s37 offen offset:0
    buffer_load_dword v21, v2, s[8:11], s37 offen offset:512
    buffer_load_dword v24, v2, s[8:11], s38 offen offset:0
    buffer_load_dword v25, v2, s[8:11], s38 offen offset:512
    buffer_load_dword v28, v2, s[8:11], s39 offen offset:0
    buffer_load_dword v29, v2, s[8:11], s39 offen offset:512
    buffer_load_dword v18, v2, s[8:11], s26 offen offset:1024
    buffer_load_dword v19, v2, s[8:11], s26 offen offset:1536
    buffer_load_dword v22, v2, s[8:11], s37 offen offset:1024
    buffer_load_dword v23, v2, s[8:11], s37 offen offset:1536
    buffer_load_dword v26, v2, s[8:11], s38 offen offset:1024
    buffer_load_dword v27, v2, s[8:11], s38 offen offset:1536
    buffer_load_dword v30, v2, s[8:11], s39 offen offset:1024
    buffer_load_dword v31, v2, s[8:11], s39 offen offset:1536
    s_barrier
    s_add_u32 s12, s30, 0
    s_addc_u32 s13, s31, 0
    s_waitcnt vmcnt(8)
    v_perm_b32 v100, v17, v16, s32
    v_perm_b32 v76, v29, v28, s32
    v_lshlrev_b32 v104, 16, v28
    v_lshlrev_b32 v112, 16, v29
    v_lshlrev_b32 v105, 16, v24
    v_lshlrev_b32 v113, 16, v25
    v_lshlrev_b32 v106, 16, v20
    v_lshlrev_b32 v114, 16, v21
    v_lshlrev_b32 v107, 16, v16
    v_lshlrev_b32 v115, 16, v17
    v_add_f32 v108, v104, v106
    v_add_f32 v116, v112, v114
    v_add_f32 v109, v105, v107
    v_add_f32 v117, v113, v115
    v_fma_f32 v110, v106, 4.0, v104
    v_fma_f32 v118, v114, 4.0, v112
    v_fma_f32 v111, v107, 4.0, v105
    v_fma_f32 v119, v115, 4.0, v113
    v_add_f32 v105, v108, v109
    v_add_f32 v113, v116, v117
    v_sub_f32 v106, v108, v109
    v_sub_f32 v114, v116, v117
    v_fma_f32 v107, v111, 2.0, v110
    v_fma_f32 v115, v119, 2.0, v118
    v_fma_f32 v110, v111, -2.0, v110
    v_fma_f32 v118, v119, -2.0, v118
    v_fmamk_f32 v108, v104, 0x41700000, v110
    v_fmamk_f32 v116, v112, 0x41700000, v118
    v_fmamk_f32 v108, v109, 0x41200000, v108
    v_fmamk_f32 v116, v117, 0x41200000, v116
    v_mul_f32 v105, 0.5, v105
    v_mul_f32 v113, 0.5, v113
    v_mul_f32 v106, 0.5, v106
    v_mul_f32 v114, 0.5, v114
    v_mul_f32 v107, s35, v107
    v_mul_f32 v115, s35, v115
    v_mul_f32 v110, s35, v110
    v_mul_f32 v118, s35, v118
    v_mul_f32 v108, s40, v108
    v_mul_f32 v116, s40, v116
    v_cvt_pk_bf16_f32 v80, v105, v113
    v_cvt_pk_bf16_f32 v84, v106, v114
    v_cvt_pk_bf16_f32 v88, v107, v115
    v_cvt_pk_bf16_f32 v92, v110, v118
    v_cvt_pk_bf16_f32 v96, v108, v116
    v_perm_b32 v102, v17, v16, s33
    v_perm_b32 v78, v29, v28, s33
    v_and_b32 v104, s34, v28
    v_and_b32 v112, s34, v29
    v_and_b32 v105, s34, v24
    v_and_b32 v113, s34, v25
    v_and_b32 v106, s34, v20
    v_and_b32 v114, s34, v21
    v_and_b32 v107, s34, v16
    v_and_b32 v115, s34, v17
    v_add_f32 v108, v104, v106
    v_add_f32 v116, v112, v114
    v_add_f32 v109, v105, v107
    v_add_f32 v117, v113, v115
    v_fma_f32 v110, v106, 4.0, v104
    v_fma_f32 v118, v114, 4.0, v112
    v_fma_f32 v111, v107, 4.0, v105
    v_fma_f32 v119, v115, 4.0, v113
    v_add_f32 v105, v108, v109
    v_add_f32 v113, v116, v117
    v_sub_f32 v106, v108, v109
    v_sub_f32 v114, v116, v117
    v_fma_f32 v107, v111, 2.0, v110
    v_fma_f32 v115, v119, 2.0, v118
    v_fma_f32 v110, v111, -2.0, v110
    v_fma_f32 v118, v119, -2.0, v118
    v_fmamk_f32 v108, v104, 0x41700000, v110
    v_fmamk_f32 v116, v112, 0x41700000, v118
    v_fmamk_f32 v108, v109, 0x41200000, v108
    v_fmamk_f32 v116, v117, 0x41200000, v116
    v_mul_f32 v105, 0.5, v105
    v_mul_f32 v113, 0.5, v113
    v_mul_f32 v106, 0.5, v106
    v_mul_f32 v114, 0.5, v114
    v_mul_f32 v107, s35, v107
    v_mul_f32 v115, s35, v115
    v_mul_f32 v110, s35, v110
    v_mul_f32 v118, s35, v118
    v_mul_f32 v108, s40, v108
    v_mul_f32 v116, s40, v116
    v_cvt_pk_bf16_f32 v82, v105, v113
    v_cvt_pk_bf16_f32 v86, v106, v114
    v_cvt_pk_bf16_f32 v90, v107, v115
    v_cvt_pk_bf16_f32 v94, v110, v118
    v_cvt_pk_bf16_f32 v98, v108, v116
    s_waitcnt vmcnt(0)
    s_cmp_lt_u32 s3, 224
    s_cbranch_scc1 L_prep_kernel_ncw
    s_getpc_b64 s[62:63]
L_prep_kernel_pc:
    s_and_b32 s64, s3, 8
    s_lshl_b32 s64, s64, 12
    v_lshlrev_b32 v120, 7, v0
    v_add_u32 v120, s64, v120
    v_min_u32 v120, L_joint_kernel_done-L_prep_kernel_pc, v120
    v_mov_b32 v121, s63
    v_add_co_u32 v120, vcc, s62, v120
    s_nop 1
    v_addc_co_u32 v121, vcc, 0, v121, vcc
    global_load_dword v122, v[120:121], off
L_prep_kernel_ncw:
    v_perm_b32 v101, v19, v18, s32
    v_perm_b32 v77, v31, v30, s32
    v_lshlrev_b32 v104, 16, v30
    v_lshlrev_b32 v112, 16, v31
    v_lshlrev_b32 v105, 16, v26
    v_lshlrev_b32 v113, 16, v27
    v_lshlrev_b32 v106, 16, v22
    v_lshlrev_b32 v114, 16, v23
    v_lshlrev_b32 v107, 16, v18
    v_lshlrev_b32 v115, 16, v19
    v_add_f32 v108, v104, v106
    v_add_f32 v116, v112, v114
    v_add_f32 v109, v105, v107
    v_add_f32 v117, v113, v115
    v_fma_f32 v110, v106, 4.0, v104
    v_fma_f32 v118, v114, 4.0, v112
    v_fma_f32 v111, v107, 4.0, v105
    v_fma_f32 v119, v115, 4.0, v113
    v_add_f32 v105, v108, v109
    v_add_f32 v113, v116, v117
    v_sub_f32 v106, v108, v109
    v_sub_f32 v114, v116, v117
    v_fma_f32 v107, v111, 2.0, v110
    v_fma_f32 v115, v119, 2.0, v118
    v_fma_f32 v110, v111, -2.0, v110
    v_fma_f32 v118, v119, -2.0, v118
    v_fmamk_f32 v108, v104, 0x41700000, v110
    v_fmamk_f32 v116, v112, 0x41700000, v118
    v_fmamk_f32 v108, v109, 0x41200000, v108
    v_fmamk_f32 v116, v117, 0x41200000, v116
    v_mul_f32 v105, 0.5, v105
    v_mul_f32 v113, 0.5, v113
    v_mul_f32 v106, 0.5, v106
    v_mul_f32 v114, 0.5, v114
    v_mul_f32 v107, s35, v107
    v_mul_f32 v115, s35, v115
    v_mul_f32 v110, s35, v110
    v_mul_f32 v118, s35, v118
    v_mul_f32 v108, s40, v108
    v_mul_f32 v116, s40, v116
    v_cvt_pk_bf16_f32 v81, v105, v113
    v_cvt_pk_bf16_f32 v85, v106, v114
    v_cvt_pk_bf16_f32 v89, v107, v115
    v_cvt_pk_bf16_f32 v93, v110, v118
    v_cvt_pk_bf16_f32 v97, v108, v116
    v_perm_b32 v103, v19, v18, s33
    v_perm_b32 v79, v31, v30, s33
    v_and_b32 v104, s34, v30
    v_and_b32 v112, s34, v31
    v_and_b32 v105, s34, v26
    v_and_b32 v113, s34, v27
    v_and_b32 v106, s34, v22
    v_and_b32 v114, s34, v23
    v_and_b32 v107, s34, v18
    v_and_b32 v115, s34, v19
    v_add_f32 v108, v104, v106
    v_add_f32 v116, v112, v114
    v_add_f32 v109, v105, v107
    v_add_f32 v117, v113, v115
    v_fma_f32 v110, v106, 4.0, v104
    v_fma_f32 v118, v114, 4.0, v112
    v_fma_f32 v111, v107, 4.0, v105
    v_fma_f32 v119, v115, 4.0, v113
    v_add_f32 v105, v108, v109
    v_add_f32 v113, v116, v117
    v_sub_f32 v106, v108, v109
    v_sub_f32 v114, v116, v117
    v_fma_f32 v107, v111, 2.0, v110
    v_fma_f32 v115, v119, 2.0, v118
    v_fma_f32 v110, v111, -2.0, v110
    v_fma_f32 v118, v119, -2.0, v118
    v_fmamk_f32 v108, v104, 0x41700000, v110
    v_fmamk_f32 v116, v112, 0x41700000, v118
    v_fmamk_f32 v108, v109, 0x41200000, v108
    v_fmamk_f32 v116, v117, 0x41200000, v116
    v_mul_f32 v105, 0.5, v105
    v_mul_f32 v113, 0.5, v113
    v_mul_f32 v106, 0.5, v106
    v_mul_f32 v114, 0.5, v114
    v_mul_f32 v107, s35, v107
    v_mul_f32 v115, s35, v115
    v_mul_f32 v110, s35, v110
    v_mul_f32 v118, s35, v118
    v_mul_f32 v108, s40, v108
    v_mul_f32 v116, s40, v116
    v_cvt_pk_bf16_f32 v83, v105, v113
    v_cvt_pk_bf16_f32 v87, v106, v114
    v_cvt_pk_bf16_f32 v91, v107, v115
    v_cvt_pk_bf16_f32 v95, v110, v118
    v_cvt_pk_bf16_f32 v99, v108, v116
    v_permlane16_swap_b32 v100, v102
    v_permlane16_swap_b32 v101, v103
    s_add_u32 s28, s27, 49152
    buffer_store_dwordx4 v[100:103], v4, s[12:15], s28 offen sc1
    v_permlane16_swap_b32 v76, v78
    v_permlane16_swap_b32 v77, v79
    s_add_u32 s28, s27, 0
    buffer_store_dwordx4 v[76:79], v4, s[12:15], s28 offen sc1
    v_permlane16_swap_b32 v80, v82
    v_permlane16_swap_b32 v81, v83
    s_add_u32 s28, s27, 8192
    buffer_store_dwordx4 v[80:83], v4, s[12:15], s28 offen sc1
    v_permlane16_swap_b32 v84, v86
    v_permlane16_swap_b32 v85, v87
    s_add_u32 s28, s27, 16384
    buffer_store_dwordx4 v[84:87], v4, s[12:15], s28 offen sc1
    v_permlane16_swap_b32 v88, v90
    v_permlane16_swap_b32 v89, v91
    s_add_u32 s28, s27, 24576
    buffer_store_dwordx4 v[88:91], v4, s[12:15], s28 offen sc1
    v_permlane16_swap_b32 v92, v94
    v_permlane16_swap_b32 v93, v95
    s_add_u32 s28, s27, 32768
    buffer_store_dwordx4 v[92:95], v4, s[12:15], s28 offen sc1
    v_permlane16_swap_b32 v96, v98
    v_permlane16_swap_b32 v97, v99
    s_add_u32 s28, s27, 40960
    buffer_store_dwordx4 v[96:99], v4, s[12:15], s28 offen sc1
L_prep_kernel_done:
    s_endpgm
L_prep_kernel_small:
    v_lshrrev_b32 v2, 4, v1
    s_lshl_b32 s24, s41, 17
    s_add_u32 s24, s24, 44040192
    s_add_u32 s12, s30, s24
    s_addc_u32 s13, s31, 0
    s_mov_b32 s14, 131072
    s_mov_b32 s15, 0x00020000
    s_mov_b32 s32, 0x05040100
    s_mov_b32 s33, 0x07060302
    v_lshlrev_b32 v4, 4, v1
    s_lshl_b32 s24, s42, 14
    s_lshl_b32 s25, s43, 13
    s_add_u32 s24, s24, s25
    s_add_u32 s25, s24, 4096
    s_waitcnt vmcnt(0)
    v_perm_b32 v48, v17, v16, s32
    v_perm_b32 v49, v19, v18, s32
    v_perm_b32 v50, v21, v20, s32
    v_perm_b32 v51, v23, v22, s32
    v_perm_b32 v52, v17, v16, s33
    v_perm_b32 v53, v19, v18, s33
    v_perm_b32 v54, v21, v20, s33
    v_perm_b32 v55, v23, v22, s33
    v_perm_b32 v56, v25, v24, s32
    v_perm_b32 v57, v27, v26, s32
    v_perm_b32 v58, v29, v28, s32
    v_perm_b32 v59, v31, v30, s32
    v_perm_b32 v60, v25, v24, s33
    v_perm_b32 v61, v27, v26, s33
    v_perm_b32 v62, v29, v28, s33
    v_perm_b32 v63, v31, v30, s33
    v_perm_b32 v64, v33, v32, s32
    v_perm_b32 v65, v35, v34, s32
    v_perm_b32 v66, v37, v36, s32
    v_perm_b32 v67, v39, v38, s32
    v_perm_b32 v68, v33, v32, s33
    v_perm_b32 v69, v35, v34, s33
    v_perm_b32 v70, v37, v36, s33
    v_perm_b32 v71, v39, v38, s33
    v_perm_b32 v72, v41, v40, s32
    v_perm_b32 v73, v43, v42, s32
    v_perm_b32 v74, v45, v44, s32
    v_perm_b32 v75, v47, v46, s32
    v_perm_b32 v76, v41, v40, s33
    v_perm_b32 v77, v43, v42, s33
    v_perm_b32 v78, v45, v44, s33
    v_perm_b32 v79, v47, v46, s33
    s_cmp_eq_u32 s41, 2
    s_cbranch_scc1 L_prep_kernel_ge
    buffer_store_dwordx4 v[48:51], v4, s[12:15], s24 offen offset:0 sc1
    buffer_store_dwordx4 v[52:55], v4, s[12:15], s24 offen offset:1024 sc1
    buffer_store_dwordx4 v[56:59], v4, s[12:15], s24 offen offset:2048 sc1
    buffer_store_dwordx4 v[60:63], v4, s[12:15], s24 offen offset:3072 sc1
    buffer_store_dwordx4 v[64:67], v4, s[12:15], s25 offen offset:0 sc1
    buffer_store_dwordx4 v[68:71], v4, s[12:15], s25 offen offset:1024 sc1
    buffer_store_dwordx4 v[72:75], v4, s[12:15], s25 offen offset:2048 sc1
    buffer_store_dwordx4 v[76:79], v4, s[12:15], s25 offen offset:3072 sc1
    s_endpgm
L_prep_kernel_ge:
    v_mfma_f32_16x16x32_bf16 v[96:99], v[48:51], v[80:83], 0
    v_mfma_f32_16x16x32_bf16 v[100:103], v[52:55], v[80:83], 0
    v_mfma_f32_16x16x32_bf16 v[96:99], v[56:59], v[84:87], v[96:99]
    v_mfma_f32_16x16x32_bf16 v[100:103], v[60:63], v[84:87], v[100:103]
    v_mfma_f32_16x16x32_bf16 v[96:99], v[64:67], v[88:91], v[96:99]
    v_mfma_f32_16x16x32_bf16 v[100:103], v[68:71], v[88:91], v[100:103]
    v_mfma_f32_16x16x32_bf16 v[96:99], v[72:75], v[92:95], v[96:99]
    v_mfma_f32_16x16x32_bf16 v[100:103], v[76:79], v[92:95], v[100:103]
    v_mov_b32 v7, v4
    v_mov_b32 v10, 1
    s_nop 0
    s_mov_b32 s14, 16384
    v_lshlrev_b32 v8, 10, v3
    v_lshl_add_u32 v8, v2, 5, v8
    s_lshl_b32 s24, s42, 7
    s_mov_b32 s34, 0xffff0000
    s_mov_b32 s35, 0x4038aa3b
    s_cmp_eq_u32 s43, 0
    s_cbranch_scc1 L_prep_kernel_ge0
    ds_write_b128 v7, v[96:99]
    ds_write_b128 v7, v[100:103] offset:1024
    ds_write_b32 v9, v10 offset:2048
    s_endpgm
L_prep_kernel_ge0:
    ds_read_b32 v10, v9 offset:2048
    s_waitcnt lgkmcnt(0)
    v_readfirstlane_b32 s27, v10
    s_cmp_eq_u32 s27, 0
    s_cbranch_scc1 L_prep_kernel_ge0
    ds_read_b128 v[16:19], v7
    ds_read_b128 v[20:23], v7 offset:1024
    s_waitcnt lgkmcnt(0)
    v_add_f32 v16, v16, v96
    v_add_f32 v17, v17, v97
    v_add_f32 v18, v18, v98
    v_add_f32 v19, v19, v99
    v_add_f32 v20, v20, v100
    v_add_f32 v21, v21, v101
    v_add_f32 v22, v22, v102
    v_add_f32 v23, v23, v103
    v_cvt_pk_bf16_f32 v48, v16, v20
    v_cvt_pk_bf16_f32 v49, v17, v21
    v_cvt_pk_bf16_f32 v50, v18, v22
    v_cvt_pk_bf16_f32 v51, v19, v23
    v_lshlrev_b32 v56, 16, v48
    v_and_b32 v57, s34, v48
    v_lshlrev_b32 v58, 16, v49
    v_and_b32 v59, s34, v49
    v_lshlrev_b32 v60, 16, v50
    v_and_b32 v61, s34, v50
    v_lshlrev_b32 v62, 16, v51
    v_and_b32 v63, s34, v51
    v_mul_f32 v56, s35, v56
    v_mul_f32 v57, s35, v57
    v_mul_f32 v58, s35, v58
    v_mul_f32 v59, s35, v59
    v_mul_f32 v60, s35, v60
    v_mul_f32 v61, s35, v61
    v_mul_f32 v62, s35, v62
    v_mul_f32 v63, s35, v63
    buffer_store_dwordx4 v[56:59], v8, s[12:15], s24 offen sc1
    buffer_store_dwordx4 v[60:63], v8, s[12:15], s24 offen offset:16 sc1
    v_exp_f32 v64, v56
    v_exp_f32 v65, v57
    v_exp_f32 v66, v58
    v_exp_f32 v67, v59
    v_exp_f32 v68, v60
    v_exp_f32 v69, v61
    v_exp_f32 v70, v62
    v_exp_f32 v71, v63
    v_max3_f32 v72, |v56|, |v57|, |v58|
    v_max3_f32 v72, |v59|, |v60|, v72
    v_max3_f32 v72, |v61|, |v62|, v72
    v_max_f32 v72, |v63|, v72
    s_add_u32 s12, s12, 16384
    s_addc_u32 s13, s13, 0
    v_cmp_lt_f32 vcc, 0x42f00000, v72
    buffer_store_dwordx4 v[64:67], v8, s[12:15], s24 offen sc1
    buffer_store_dwordx4 v[68:71], v8, s[12:15], s24 offen offset:16 sc1
    s_add_u32 s12, s12, 16384
    s_addc_u32 s13, s13, 0
    s_or_b32 s26, vcc_lo, vcc_hi
    s_lshl_b32 s24, s42, 2
    v_mov_b32 v73, s26
    v_mov_b32 v74, 0
    buffer_store_dword v73, v74, s[12:15], s24 offen sc1
L_prep_kernel_last:
    s_endpgm
.globl conv1_kernel
.p2align 8
.type conv1_kernel,@function
conv1_kernel:
    s_cmp_ge_u32 s2, 256
    s_cbranch_scc1 L_conv1_kernel_done
    s_load_dwordx2 s[4:5], s[0:1], 0
    s_load_dwordx2 s[30:31], s[0:1], 72
    v_readfirstlane_b32 s20, v0
    s_lshr_b32 s20, s20, 6
    s_xor_b32 s20, s20, 8
    s_and_b32 s36, s2, 0
    s_lshl_b32 s36, s36, 3
    s_bfe_u32 s37, s2, 196611
    s_or_b32 s29, s36, s37
    s_bfe_u32 s36, s2, 196608
    s_lshl_b32 s36, s36, 2
    s_lshr_b32 s37, s2, 6
    s_or_b32 s36, s36, s37
    s_mov_b32 s33, 0
    s_and_b32 s34, s36, 15
    s_lshr_b32 s35, s36, 4
    s_mul_i32 s21, s34, 500
    s_and_b32 s32, s20, 3
    v_and_b32 v127, 63, v0
    v_lshrrev_b32 v5, 2, v127
    v_and_b32 v6, 3, v127
    s_and_b32 s42, s20, 7
    v_lshlrev_b32 v7, 15, v5
    v_lshl_add_u32 v7, v6, 4, v7
    s_lshl_b32 s41, s21, 10
    s_sub_u32 s41, s41, 7680
    s_lshl_b32 s37, s42, 12
    s_add_u32 s37, s37, s41
    v_add_u32 v7, s37, v7
    s_mul_i32 s36, s35, 8192000
    s_mov_b32 s10, 8192000
    s_mov_b32 s11, 0x00020000
    s_mov_b32 s25, 0xffff0000
    s_mov_b32 s47, s36
    s_cmp_ge_u32 s20, 8
    s_cbranch_scc1 L_conv1_kernel_helper
    s_add_u32 s37, s41, 524288
    v_lshl_add_u32 v108, v127, 4, s37
    v_add_u32 v109, 1024, v108
    v_add_u32 v110, 2048, v108
    s_waitcnt lgkmcnt(0)
    s_add_u32 s8, s4, s47
    s_addc_u32 s9, s5, 0
    s_lshl_b32 s36, s29, 4
    s_lshl_b32 s37, s33, 3
    s_add_u32 s36, s36, s37
    s_mul_i32 s36, s36, 57344
    s_add_u32 s36, s36, 0
    s_add_u32 s12, s30, s36
    s_addc_u32 s13, s31, 0
    s_mov_b32 s14, 917504
    s_mov_b32 s15, 0x00020000
    s_mul_i32 s36, s35, 4194304
    s_add_u32 s36, s36, 18874368
    s_add_u32 s16, s30, s36
    s_addc_u32 s17, s31, 0
    s_mov_b32 s18, 4194304
    s_mov_b32 s19, 0x00020000
    v_and_b32 v10, 15, v127
    v_lshrrev_b32 v11, 4, v127
    v_add_u32 v8, 0, v10
    v_and_b32 v16, 4, v8
    v_lshrrev_b32 v16, 1, v16
    v_xor_b32 v16, v11, v16
    v_lshlrev_b32 v16, 4, v16
    v_lshl_add_u32 v8, v8, 6, v16
    v_add_u32 v9, 1, v10
    v_and_b32 v16, 4, v9
    v_lshrrev_b32 v16, 1, v16
    v_xor_b32 v16, v11, v16
    v_lshlrev_b32 v16, 4, v16
    v_lshl_add_u32 v9, v9, 6, v16
    s_lshr_b32 s38, s32, 1
    s_and_b32 s39, s32, 1
    s_add_u32 s40, s38, 4
    s_lshl_b32 s43, s39, 10
    s_cmp_lt_u32 s20, 4
    s_cselect_b32 s40, s20, s40
    s_cselect_b32 s36, 0, s43
    s_lshl_b32 s37, s40, 13
    s_add_u32 s37, s37, s36
    v_lshl_add_u32 v125, v127, 4, s37
    s_mul_i32 s37, s40, 16384
    v_add_u32 v120, s37, v8
    v_add_u32 v121, s37, v9
    s_lshl_b32 s37, s40, 10
    s_add_u32 s37, s37, 115712
    v_lshl_add_u32 v16, v11, 4, s37
    v_cmp_eq_u32 vcc, 15, v10
    v_mov_b32 v17, 8192
    v_mov_b32 v18, 4294959104
    v_mov_b32 v19, 64
    v_cndmask_b32 v122, v121, v16, vcc
    v_cndmask_b32 v123, v17, v19, vcc
    v_cndmask_b32 v124, v18, v19, vcc
    v_lshl_add_u32 v126, v127, 4, s37
    s_mov_b32 s44, 0x3f800000
    s_mov_b32 s45, 0x00000000
    s_mov_b32 s46, 0x00000000
    s_cmp_eq_u32 s40, 1
    s_cselect_b32 s45, 0x3f800000, s45
    s_cselect_b32 s46, 0x3f800000, s46
    s_cmp_eq_u32 s40, 2
    s_cselect_b32 s45, 0xbf800000, s45
    s_cselect_b32 s46, 0x3f800000, s46
    s_cmp_eq_u32 s40, 3
    s_cselect_b32 s45, 0x40000000, s45
    s_cselect_b32 s46, 0x40800000, s46
    s_cmp_eq_u32 s40, 4
    s_cselect_b32 s45, 0xc0000000, s45
    s_cselect_b32 s46, 0x40800000, s46
    s_cmp_eq_u32 s40, 5
    s_cselect_b32 s44, 0x41800000, s44
    s_cselect_b32 s45, 0x41000000, s45
    s_cselect_b32 s46, 0x40800000, s46
    s_cmp_ge_u32 s20, 4
    s_cbranch_scc1 L_conv1_kernel_m2
    v_mov_b32 v0, 0
    v_mov_b32 v1, 0
    v_mov_b32 v2, 0
    v_mov_b32 v3, 0
    v_mov_b32 v4, 0
    v_mov_b32 v5, 0
    v_mov_b32 v6, 0
    v_mov_b32 v7, 0
    v_mov_b32 v8, 0
    v_mov_b32 v9, 0
    v_mov_b32 v10, 0
    v_mov_b32 v11, 0
    v_mov_b32 v12, 0
    v_mov_b32 v13, 0
    v_mov_b32 v14, 0
    v_mov_b32 v15, 0
    v_mov_b32 v16, 0
    v_mov_b32 v17, 0
    v_mov_b32 v18, 0
    v_mov_b32 v19, 0
    v_mov_b32 v20, 0
    v_mov_b32 v21, 0
    v_mov_b32 v22, 0
    v_mov_b32 v23, 0
    v_mov_b32 v24, 0
    v_mov_b32 v25, 0
    v_mov_b32 v26, 0
    v_mov_b32 v27, 0
    v_mov_b32 v28, 0
    v_mov_b32 v29, 0
    v_mov_b32 v30, 0
    v_mov_b32 v31, 0
    v_mov_b32 v32, 0
    v_mov_b32 v33, 0
    v_mov_b32 v34, 0
    v_mov_b32 v35, 0
    v_mov_b32 v36, 0
    v_mov_b32 v37, 0
    v_mov_b32 v38, 0
    v_mov_b32 v39, 0
    v_mov_b32 v40, 0
    v_mov_b32 v41, 0
    v_mov_b32 v42, 0
    v_mov_b32 v43, 0
    v_mov_b32 v44, 0
    v_mov_b32 v45, 0
    v_mov_b32 v46, 0
    v_mov_b32 v47, 0
    v_mov_b32 v48, 0
    v_mov_b32 v49, 0
    v_mov_b32 v50, 0
    v_mov_b32 v51, 0
    v_mov_b32 v52, 0
    v_mov_b32 v53, 0
    v_mov_b32 v54, 0
    v_mov_b32 v55, 0
    v_mov_b32 v56, 0
    v_mov_b32 v57, 0
    v_mov_b32 v58, 0
    v_mov_b32 v59, 0
    v_mov_b32 v60, 0
    v_mov_b32 v61, 0
    v_mov_b32 v62, 0
    v_mov_b32 v63, 0
    buffer_load_dwordx4 v[96:99], v108, s[8:11], 0 offen
    buffer_load_dwordx4 v[100:103], v109, s[8:11], 0 offen
    buffer_load_dwordx4 v[104:107], v110, s[8:11], 0 offen
    s_mov_b32 s23, 0
    s_mov_b32 s26, 4096
    buffer_load_dwordx4 v[64:67], v125, s[12:15], s23 offen offset:0
    buffer_load_dwordx4 v[68:71], v125, s[12:15], s23 offen offset:1024
    buffer_load_dwordx4 v[72:75], v125, s[12:15], s23 offen offset:2048
    buffer_load_dwordx4 v[76:79], v125, s[12:15], s23 offen offset:3072
    buffer_load_dwordx4 v[80:83], v125, s[12:15], s26 offen offset:0
    buffer_load_dwordx4 v[84:87], v125, s[12:15], s26 offen offset:1024
    buffer_load_dwordx4 v[88:91], v125, s[12:15], s26 offen offset:2048
    buffer_load_dwordx4 v[92:95], v125, s[12:15], s26 offen offset:3072
    s_mov_b32 s23, 57344
    s_mov_b32 s26, 61440
    s_waitcnt vmcnt(8)
    v_lshlrev_b32 v108, 16, v96
    v_and_b32 v111, s25, v96
    v_lshlrev_b32 v109, 16, v100
    v_and_b32 v112, s25, v100
    v_lshlrev_b32 v110, 16, v104
    v_and_b32 v113, s25, v104
    v_mul_f32 v114, s44, v108
    v_mul_f32 v115, s44, v111
    v_fmac_f32 v114, s45, v109
    v_fmac_f32 v115, s45, v112
    v_fmac_f32 v114, s46, v110
    v_fmac_f32 v115, s46, v113
    v_cvt_pk_bf16_f32 v96, v114, v115
    v_lshlrev_b32 v108, 16, v97
    v_and_b32 v111, s25, v97
    v_lshlrev_b32 v109, 16, v101
    v_and_b32 v112, s25, v101
    v_lshlrev_b32 v110, 16, v105
    v_and_b32 v113, s25, v105
    v_mul_f32 v114, s44, v108
    v_mul_f32 v115, s44, v111
    v_fmac_f32 v114, s45, v109
    v_fmac_f32 v115, s45, v112
    v_fmac_f32 v114, s46, v110
    v_fmac_f32 v115, s46, v113
    v_cvt_pk_bf16_f32 v97, v114, v115
    v_lshlrev_b32 v108, 16, v98
    v_and_b32 v111, s25, v98
    v_lshlrev_b32 v109, 16, v102
    v_and_b32 v112, s25, v102
    v_lshlrev_b32 v110, 16, v106
    v_and_b32 v113, s25, v106
    v_mul_f32 v114, s44, v108
    v_mul_f32 v115, s44, v111
    v_fmac_f32 v114, s45, v109
    v_fmac_f32 v115, s45, v112
    v_fmac_f32 v114, s46, v110
    v_fmac_f32 v115, s46, v113
    v_cvt_pk_bf16_f32 v98, v114, v115
    v_lshlrev_b32 v108, 16, v99
    v_and_b32 v111, s25, v99
    v_lshlrev_b32 v109, 16, v103
    v_and_b32 v112, s25, v103
    v_lshlrev_b32 v110, 16, v107
    v_and_b32 v113, s25, v107
    v_mul_f32 v114, s44, v108
    v_mul_f32 v115, s44, v111
    v_fmac_f32 v114, s45, v109
    v_fmac_f32 v115, s45, v112
    v_fmac_f32 v114, s46, v110
    v_fmac_f32 v115, s46, v113
    v_cvt_pk_bf16_f32 v99, v114, v115
    ds_write_b128 v126, v[96:99]
    s_waitcnt lgkmcnt(0)
    s_barrier
    s_mov_b32 s22, 8
    s_setprio 2
L_conv1_kernel_mloop1:
    ds_read_b128 v[96:99], v120 offset:0
    ds_read_b128 v[100:103], v120 offset:1024
    ds_read_b128 v[104:107], v120 offset:2048
    ds_read_b128 v[108:111], v120 offset:3072
    ds_read_b128 v[112:115], v120 offset:4096
    ds_read_b128 v[116:119], v120 offset:5120
    s_waitcnt vmcnt(6) lgkmcnt(5)
    v_mfma_f32_16x16x32_bf16 v[0:3], v[64:67], v[96:99], v[0:3]
    v_mfma_f32_16x16x32_bf16 v[32:35], v[68:71], v[96:99], v[32:35]
    ds_read_b128 v[96:99], v120 offset:6144
    s_waitcnt vmcnt(4) lgkmcnt(5)
    v_mfma_f32_16x16x32_bf16 v[4:7], v[64:67], v[100:103], v[4:7]
    v_mfma_f32_16x16x32_bf16 v[36:39], v[68:71], v[100:103], v[36:39]
    v_mfma_f32_16x16x32_bf16 v[0:3], v[72:75], v[100:103], v[0:3]
    v_mfma_f32_16x16x32_bf16 v[32:35], v[76:79], v[100:103], v[32:35]
    ds_read_b128 v[100:103], v120 offset:7168
    s_waitcnt vmcnt(2) lgkmcnt(5)
    v_mfma_f32_16x16x32_bf16 v[8:11], v[64:67], v[104:107], v[8:11]
    v_mfma_f32_16x16x32_bf16 v[40:43], v[68:71], v[104:107], v[40:43]
    v_mfma_f32_16x16x32_bf16 v[4:7], v[72:75], v[104:107], v[4:7]
    v_mfma_f32_16x16x32_bf16 v[36:39], v[76:79], v[104:107], v[36:39]
    v_mfma_f32_16x16x32_bf16 v[0:3], v[80:83], v[104:107], v[0:3]
    v_mfma_f32_16x16x32_bf16 v[32:35], v[84:87], v[104:107], v[32:35]
    ds_read_b128 v[104:107], v122 offset:0
    v_add_u32 v122, v123, v122
    s_waitcnt vmcnt(0) lgkmcnt(5)
    v_mfma_f32_16x16x32_bf16 v[12:15], v[64:67], v[108:111], v[12:15]
    v_mfma_f32_16x16x32_bf16 v[44:47], v[68:71], v[108:111], v[44:47]
    v_mfma_f32_16x16x32_bf16 v[8:11], v[72:75], v[108:111], v[8:11]
    v_mfma_f32_16x16x32_bf16 v[40:43], v[76:79], v[108:111], v[40:43]
    v_mfma_f32_16x16x32_bf16 v[4:7], v[80:83], v[108:111], v[4:7]
    v_mfma_f32_16x16x32_bf16 v[36:39], v[84:87], v[108:111], v[36:39]
    v_mfma_f32_16x16x32_bf16 v[0:3], v[88:91], v[108:111], v[0:3]
    v_mfma_f32_16x16x32_bf16 v[32:35], v[92:95], v[108:111], v[32:35]
    ds_read_b128 v[108:111], v121 offset:1024
    s_waitcnt lgkmcnt(5)
    v_mfma_f32_16x16x32_bf16 v[16:19], v[64:67], v[112:115], v[16:19]
    v_mfma_f32_16x16x32_bf16 v[48:51], v[68:71], v[112:115], v[48:51]
    v_mfma_f32_16x16x32_bf16 v[12:15], v[72:75], v[112:115], v[12:15]
    v_mfma_f32_16x16x32_bf16 v[44:47], v[76:79], v[112:115], v[44:47]
    v_mfma_f32_16x16x32_bf16 v[8:11], v[80:83], v[112:115], v[8:11]
    v_mfma_f32_16x16x32_bf16 v[40:43], v[84:87], v[112:115], v[40:43]
    v_mfma_f32_16x16x32_bf16 v[4:7], v[88:91], v[112:115], v[4:7]
    v_mfma_f32_16x16x32_bf16 v[36:39], v[92:95], v[112:115], v[36:39]
    ds_read_b128 v[112:115], v121 offset:2048
    s_waitcnt lgkmcnt(5)
    v_mfma_f32_16x16x32_bf16 v[20:23], v[64:67], v[116:119], v[20:23]
    v_mfma_f32_16x16x32_bf16 v[52:55], v[68:71], v[116:119], v[52:55]
    v_mfma_f32_16x16x32_bf16 v[16:19], v[72:75], v[116:119], v[16:19]
    v_mfma_f32_16x16x32_bf16 v[48:51], v[76:79], v[116:119], v[48:51]
    v_mfma_f32_16x16x32_bf16 v[12:15], v[80:83], v[116:119], v[12:15]
    v_mfma_f32_16x16x32_bf16 v[44:47], v[84:87], v[116:119], v[44:47]
    v_mfma_f32_16x16x32_bf16 v[8:11], v[88:91], v[116:119], v[8:11]
    v_mfma_f32_16x16x32_bf16 v[40:43], v[92:95], v[116:119], v[40:43]
    s_waitcnt lgkmcnt(4)
    v_mfma_f32_16x16x32_bf16 v[24:27], v[64:67], v[96:99], v[24:27]
    v_mfma_f32_16x16x32_bf16 v[56:59], v[68:71], v[96:99], v[56:59]
    v_mfma_f32_16x16x32_bf16 v[20:23], v[72:75], v[96:99], v[20:23]
    v_mfma_f32_16x16x32_bf16 v[52:55], v[76:79], v[96:99], v[52:55]
    v_mfma_f32_16x16x32_bf16 v[16:19], v[80:83], v[96:99], v[16:19]
    v_mfma_f32_16x16x32_bf16 v[48:51], v[84:87], v[96:99], v[48:51]
    v_mfma_f32_16x16x32_bf16 v[12:15], v[88:91], v[96:99], v[12:15]
    v_mfma_f32_16x16x32_bf16 v[44:47], v[92:95], v[96:99], v[44:47]
    s_waitcnt lgkmcnt(3)
    v_mfma_f32_16x16x32_bf16 v[28:31], v[64:67], v[100:103], v[28:31]
    v_mfma_f32_16x16x32_bf16 v[60:63], v[68:71], v[100:103], v[60:63]
    v_mfma_f32_16x16x32_bf16 v[24:27], v[72:75], v[100:103], v[24:27]
    v_mfma_f32_16x16x32_bf16 v[56:59], v[76:79], v[100:103], v[56:59]
    v_mfma_f32_16x16x32_bf16 v[20:23], v[80:83], v[100:103], v[20:23]
    v_mfma_f32_16x16x32_bf16 v[52:55], v[84:87], v[100:103], v[52:55]
    v_mfma_f32_16x16x32_bf16 v[16:19], v[88:91], v[100:103], v[16:19]
    v_mfma_f32_16x16x32_bf16 v[48:51], v[92:95], v[100:103], v[48:51]
    buffer_load_dwordx4 v[64:67], v125, s[12:15], s23 offen offset:0
    buffer_load_dwordx4 v[68:71], v125, s[12:15], s23 offen offset:1024
    s_waitcnt lgkmcnt(2)
    v_mfma_f32_16x16x32_bf16 v[28:31], v[72:75], v[104:107], v[28:31]
    v_mfma_f32_16x16x32_bf16 v[60:63], v[76:79], v[104:107], v[60:63]
    v_mfma_f32_16x16x32_bf16 v[24:27], v[80:83], v[104:107], v[24:27]
    v_mfma_f32_16x16x32_bf16 v[56:59], v[84:87], v[104:107], v[56:59]
    v_mfma_f32_16x16x32_bf16 v[20:23], v[88:91], v[104:107], v[20:23]
    v_mfma_f32_16x16x32_bf16 v[52:55], v[92:95], v[104:107], v[52:55]
    buffer_load_dwordx4 v[72:75], v125, s[12:15], s23 offen offset:2048
    buffer_load_dwordx4 v[76:79], v125, s[12:15], s23 offen offset:3072
    s_waitcnt lgkmcnt(1)
    v_mfma_f32_16x16x32_bf16 v[28:31], v[80:83], v[108:111], v[28:31]
    v_mfma_f32_16x16x32_bf16 v[60:63], v[84:87], v[108:111], v[60:63]
    v_mfma_f32_16x16x32_bf16 v[24:27], v[88:91], v[108:111], v[24:27]
    v_mfma_f32_16x16x32_bf16 v[56:59], v[92:95], v[108:111], v[56:59]
    buffer_load_dwordx4 v[80:83], v125, s[12:15], s26 offen offset:0
    buffer_load_dwordx4 v[84:87], v125, s[12:15], s26 offen offset:1024
    s_waitcnt lgkmcnt(0)
    v_mfma_f32_16x16x32_bf16 v[28:31], v[88:91], v[112:115], v[28:31]
    v_mfma_f32_16x16x32_bf16 v[60:63], v[92:95], v[112:115], v[60:63]
    buffer_load_dwordx4 v[88:91], v125, s[12:15], s26 offen offset:2048
    buffer_load_dwordx4 v[92:95], v125, s[12:15], s26 offen offset:3072
    s_add_u32 s23, s23, 57344
    s_add_u32 s26, s26, 57344
    s_barrier
    s_sub_u32 s22, s22, 1
    s_cmp_eq_u32 s22, 0
    s_cbranch_scc1 L_conv1_kernel_mlast1
    ds_read_b128 v[96:99], v120 offset:8192
    ds_read_b128 v[100:103], v120 offset:9216
    ds_read_b128 v[104:107], v120 offset:10240
    ds_read_b128 v[108:111], v120 offset:11264
    ds_read_b128 v[112:115], v120 offset:12288
    ds_read_b128 v[116:119], v120 offset:13312
    s_waitcnt vmcnt(6) lgkmcnt(5)
    v_mfma_f32_16x16x32_bf16 v[0:3], v[64:67], v[96:99], v[0:3]
    v_mfma_f32_16x16x32_bf16 v[32:35], v[68:71], v[96:99], v[32:35]
    ds_read_b128 v[96:99], v120 offset:14336
    s_waitcnt vmcnt(4) lgkmcnt(5)
    v_mfma_f32_16x16x32_bf16 v[4:7], v[64:67], v[100:103], v[4:7]
    v_mfma_f32_16x16x32_bf16 v[36:39], v[68:71], v[100:103], v[36:39]
    v_mfma_f32_16x16x32_bf16 v[0:3], v[72:75], v[100:103], v[0:3]
    v_mfma_f32_16x16x32_bf16 v[32:35], v[76:79], v[100:103], v[32:35]
    ds_read_b128 v[100:103], v120 offset:15360
    s_waitcnt vmcnt(2) lgkmcnt(5)
    v_mfma_f32_16x16x32_bf16 v[8:11], v[64:67], v[104:107], v[8:11]
    v_mfma_f32_16x16x32_bf16 v[40:43], v[68:71], v[104:107], v[40:43]
    v_mfma_f32_16x16x32_bf16 v[4:7], v[72:75], v[104:107], v[4:7]
    v_mfma_f32_16x16x32_bf16 v[36:39], v[76:79], v[104:107], v[36:39]
    v_mfma_f32_16x16x32_bf16 v[0:3], v[80:83], v[104:107], v[0:3]
    v_mfma_f32_16x16x32_bf16 v[32:35], v[84:87], v[104:107], v[32:35]
    ds_read_b128 v[104:107], v122 offset:0
    v_add_u32 v122, v124, v122
    s_waitcnt vmcnt(0) lgkmcnt(5)
    v_mfma_f32_16x16x32_bf16 v[12:15], v[64:67], v[108:111], v[12:15]
    v_mfma_f32_16x16x32_bf16 v[44:47], v[68:71], v[108:111], v[44:47]
    v_mfma_f32_16x16x32_bf16 v[8:11], v[72:75], v[108:111], v[8:11]
    v_mfma_f32_16x16x32_bf16 v[40:43], v[76:79], v[108:111], v[40:43]
    v_mfma_f32_16x16x32_bf16 v[4:7], v[80:83], v[108:111], v[4:7]
    v_mfma_f32_16x16x32_bf16 v[36:39], v[84:87], v[108:111], v[36:39]
    v_mfma_f32_16x16x32_bf16 v[0:3], v[88:91], v[108:111], v[0:3]
    v_mfma_f32_16x16x32_bf16 v[32:35], v[92:95], v[108:111], v[32:35]
    ds_read_b128 v[108:111], v121 offset:9216
    s_waitcnt lgkmcnt(5)
    v_mfma_f32_16x16x32_bf16 v[16:19], v[64:67], v[112:115], v[16:19]
    v_mfma_f32_16x16x32_bf16 v[48:51], v[68:71], v[112:115], v[48:51]
    v_mfma_f32_16x16x32_bf16 v[12:15], v[72:75], v[112:115], v[12:15]
    v_mfma_f32_16x16x32_bf16 v[44:47], v[76:79], v[112:115], v[44:47]
    v_mfma_f32_16x16x32_bf16 v[8:11], v[80:83], v[112:115], v[8:11]
    v_mfma_f32_16x16x32_bf16 v[40:43], v[84:87], v[112:115], v[40:43]
    v_mfma_f32_16x16x32_bf16 v[4:7], v[88:91], v[112:115], v[4:7]
    v_mfma_f32_16x16x32_bf16 v[36:39], v[92:95], v[112:115], v[36:39]
    ds_read_b128 v[112:115], v121 offset:10240
    s_waitcnt lgkmcnt(5)
    v_mfma_f32_16x16x32_bf16 v[20:23], v[64:67], v[116:119], v[20:23]
    v_mfma_f32_16x16x32_bf16 v[52:55], v[68:71], v[116:119], v[52:55]
    v_mfma_f32_16x16x32_bf16 v[16:19], v[72:75], v[116:119], v[16:19]
    v_mfma_f32_16x16x32_bf16 v[48:51], v[76:79], v[116:119], v[48:51]
    v_mfma_f32_16x16x32_bf16 v[12:15], v[80:83], v[116:119], v[12:15]
    v_mfma_f32_16x16x32_bf16 v[44:47], v[84:87], v[116:119], v[44:47]
    v_mfma_f32_16x16x32_bf16 v[8:11], v[88:91], v[116:119], v[8:11]
    v_mfma_f32_16x16x32_bf16 v[40:43], v[92:95], v[116:119], v[40:43]
    s_waitcnt lgkmcnt(4)
    v_mfma_f32_16x16x32_bf16 v[24:27], v[64:67], v[96:99], v[24:27]
    v_mfma_f32_16x16x32_bf16 v[56:59], v[68:71], v[96:99], v[56:59]
    v_mfma_f32_16x16x32_bf16 v[20:23], v[72:75], v[96:99], v[20:23]
    v_mfma_f32_16x16x32_bf16 v[52:55], v[76:79], v[96:99], v[52:55]
    v_mfma_f32_16x16x32_bf16 v[16:19], v[80:83], v[96:99], v[16:19]
    v_mfma_f32_16x16x32_bf16 v[48:51], v[84:87], v[96:99], v[48:51]
    v_mfma_f32_16x16x32_bf16 v[12:15], v[88:91], v[96:99], v[12:15]
    v_mfma_f32_16x16x32_bf16 v[44:47], v[92:95], v[96:99], v[44:47]
    s_waitcnt lgkmcnt(3)
    v_mfma_f32_16x16x32_bf16 v[28:31], v[64:67], v[100:103], v[28:31]
    v_mfma_f32_16x16x32_bf16 v[60:63], v[68:71], v[100:103], v[60:63]
    v_mfma_f32_16x16x32_bf16 v[24:27], v[72:75], v[100:103], v[24:27]
    v_mfma_f32_16x16x32_bf16 v[56:59], v[76:79], v[100:103], v[56:59]
    v_mfma_f32_16x16x32_bf16 v[20:23], v[80:83], v[100:103], v[20:23]
    v_mfma_f32_16x16x32_bf16 v[52:55], v[84:87], v[100:103], v[52:55]
    v_mfma_f32_16x16x32_bf16 v[16:19], v[88:91], v[100:103], v[16:19]
    v_mfma_f32_16x16x32_bf16 v[48:51], v[92:95], v[100:103], v[48:51]
    buffer_load_dwordx4 v[64:67], v125, s[12:15], s23 offen offset:0
    buffer_load_dwordx4 v[68:71], v125, s[12:15], s23 offen offset:1024
    s_waitcnt lgkmcnt(2)
    v_mfma_f32_16x16x32_bf16 v[28:31], v[72:75], v[104:107], v[28:31]
    v_mfma_f32_16x16x32_bf16 v[60:63], v[76:79], v[104:107], v[60:63]
    v_mfma_f32_16x16x32_bf16 v[24:27], v[80:83], v[104:107], v[24:27]
    v_mfma_f32_16x16x32_bf16 v[56:59], v[84:87], v[104:107], v[56:59]
    v_mfma_f32_16x16x32_bf16 v[20:23], v[88:91], v[104:107], v[20:23]
    v_mfma_f32_16x16x32_bf16 v[52:55], v[92:95], v[104:107], v[52:55]
    buffer_load_dwordx4 v[72:75], v125, s[12:15], s23 offen offset:2048
    buffer_load_dwordx4 v[76:79], v125, s[12:15], s23 offen offset:3072
    s_waitcnt lgkmcnt(1)
    v_mfma_f32_16x16x32_bf16 v[28:31], v[80:83], v[108:111], v[28:31]
    v_mfma_f32_16x16x32_bf16 v[60:63], v[84:87], v[108:111], v[60:63]
    v_mfma_f32_16x16x32_bf16 v[24:27], v[88:91], v[108:111], v[24:27]
    v_mfma_f32_16x16x32_bf16 v[56:59], v[92:95], v[108:111], v[56:59]
    buffer_load_dwordx4 v[80:83], v125, s[12:15], s26 offen offset:0
    buffer_load_dwordx4 v[84:87], v125, s[12:15], s26 offen offset:1024
    s_waitcnt lgkmcnt(0)
    v_mfma_f32_16x16x32_bf16 v[28:31], v[88:91], v[112:115], v[28:31]
    v_mfma_f32_16x16x32_bf16 v[60:63], v[92:95], v[112:115], v[60:63]
    buffer_load_dwordx4 v[88:91], v125, s[12:15], s26 offen offset:2048
    buffer_load_dwordx4 v[92:95], v125, s[12:15], s26 offen offset:3072
    s_add_u32 s23, s23, 57344
    s_add_u32 s26, s26, 57344
    s_barrier
    s_branch L_conv1_kernel_mloop1
L_conv1_kernel_mlast1:
    v_and_b32 v125, 15, v127
    v_and_b32 v126, 7, v127
    v_lshlrev_b32 v126, 4, v126
    v_lshl_add_u32 v125, v125, 7, v126
    v_lshrrev_b32 v126, 4, v127
    v_lshl_add_u32 v125, v126, 11, v125
    s_lshl_b32 s36, s20, 14
    s_add_u32 s37, s36, 8192
    v_add_u32 v126, s37, v125
    v_add_u32 v125, s36, v125
    ds_read_b128 v[96:99], v120 offset:8192
    ds_read_b128 v[100:103], v120 offset:9216
    ds_read_b128 v[104:107], v120 offset:10240
    ds_read_b128 v[108:111], v120 offset:11264
    ds_read_b128 v[112:115], v120 offset:12288
    ds_read_b128 v[116:119], v120 offset:13312
    s_waitcnt vmcnt(6) lgkmcnt(5)
    v_mfma_f32_16x16x32_bf16 v[0:3], v[64:67], v[96:99], v[0:3]
    v_mfma_f32_16x16x32_bf16 v[32:35], v[68:71], v[96:99], v[32:35]
    ds_read_b128 v[96:99], v120 offset:14336
    s_waitcnt vmcnt(4) lgkmcnt(5)
    v_mfma_f32_16x16x32_bf16 v[4:7], v[64:67], v[100:103], v[4:7]
    v_mfma_f32_16x16x32_bf16 v[36:39], v[68:71], v[100:103], v[36:39]
    v_mfma_f32_16x16x32_bf16 v[0:3], v[72:75], v[100:103], v[0:3]
    v_mfma_f32_16x16x32_bf16 v[32:35], v[76:79], v[100:103], v[32:35]
    ds_read_b128 v[100:103], v120 offset:15360
    s_waitcnt vmcnt(2) lgkmcnt(5)
    v_mfma_f32_16x16x32_bf16 v[8:11], v[64:67], v[104:107], v[8:11]
    v_mfma_f32_16x16x32_bf16 v[40:43], v[68:71], v[104:107], v[40:43]
    v_mfma_f32_16x16x32_bf16 v[4:7], v[72:75], v[104:107], v[4:7]
    v_mfma_f32_16x16x32_bf16 v[36:39], v[76:79], v[104:107], v[36:39]
    v_mfma_f32_16x16x32_bf16 v[0:3], v[80:83], v[104:107], v[0:3]
    v_mfma_f32_16x16x32_bf16 v[32:35], v[84:87], v[104:107], v[32:35]
    ds_read_b128 v[104:107], v122 offset:0
    s_waitcnt vmcnt(0) lgkmcnt(5)
    v_mfma_f32_16x16x32_bf16 v[12:15], v[64:67], v[108:111], v[12:15]
    v_mfma_f32_16x16x32_bf16 v[44:47], v[68:71], v[108:111], v[44:47]
    v_mfma_f32_16x16x32_bf16 v[8:11], v[72:75], v[108:111], v[8:11]
    v_mfma_f32_16x16x32_bf16 v[40:43], v[76:79], v[108:111], v[40:43]
    v_mfma_f32_16x16x32_bf16 v[4:7], v[80:83], v[108:111], v[4:7]
    v_mfma_f32_16x16x32_bf16 v[36:39], v[84:87], v[108:111], v[36:39]
    v_mfma_f32_16x16x32_bf16 v[0:3], v[88:91], v[108:111], v[0:3]
    v_mfma_f32_16x16x32_bf16 v[32:35], v[92:95], v[108:111], v[32:35]
    ds_read_b128 v[108:111], v121 offset:9216
    s_waitcnt lgkmcnt(5)
    v_mfma_f32_16x16x32_bf16 v[16:19], v[64:67], v[112:115], v[16:19]
    v_mfma_f32_16x16x32_bf16 v[48:51], v[68:71], v[112:115], v[48:51]
    v_mfma_f32_16x16x32_bf16 v[12:15], v[72:75], v[112:115], v[12:15]
    v_mfma_f32_16x16x32_bf16 v[44:47], v[76:79], v[112:115], v[44:47]
    v_mfma_f32_16x16x32_bf16 v[8:11], v[80:83], v[112:115], v[8:11]
    v_mfma_f32_16x16x32_bf16 v[40:43], v[84:87], v[112:115], v[40:43]
    v_mfma_f32_16x16x32_bf16 v[4:7], v[88:91], v[112:115], v[4:7]
    v_mfma_f32_16x16x32_bf16 v[36:39], v[92:95], v[112:115], v[36:39]
    ds_read_b128 v[112:115], v121 offset:10240
    v_xor_b32 v123, 0, v125
    ds_write_b128 v123, v[0:3]
    s_waitcnt lgkmcnt(6)
    v_mfma_f32_16x16x32_bf16 v[20:23], v[64:67], v[116:119], v[20:23]
    v_mfma_f32_16x16x32_bf16 v[52:55], v[68:71], v[116:119], v[52:55]
    v_mfma_f32_16x16x32_bf16 v[16:19], v[72:75], v[116:119], v[16:19]
    v_mfma_f32_16x16x32_bf16 v[48:51], v[76:79], v[116:119], v[48:51]
    v_mfma_f32_16x16x32_bf16 v[12:15], v[80:83], v[116:119], v[12:15]
    v_mfma_f32_16x16x32_bf16 v[44:47], v[84:87], v[116:119], v[44:47]
    v_mfma_f32_16x16x32_bf16 v[8:11], v[88:91], v[116:119], v[8:11]
    v_mfma_f32_16x16x32_bf16 v[40:43], v[92:95], v[116:119], v[40:43]
    v_xor_b32 v124, 16, v125
    ds_write_b128 v124, v[4:7]
    s_waitcnt lgkmcnt(2)
    v_mfma_f32_16x16x32_bf16 v[24:27], v[64:67], v[96:99], v[24:27]
    v_mfma_f32_16x16x32_bf16 v[56:59], v[68:71], v[96:99], v[56:59]
    v_mfma_f32_16x16x32_bf16 v[20:23], v[72:75], v[96:99], v[20:23]
    v_mfma_f32_16x16x32_bf16 v[52:55], v[76:79], v[96:99], v[52:55]
    v_mfma_f32_16x16x32_bf16 v[16:19], v[80:83], v[96:99], v[16:19]
    v_mfma_f32_16x16x32_bf16 v[48:51], v[84:87], v[96:99], v[48:51]
    v_mfma_f32_16x16x32_bf16 v[12:15], v[88:91], v[96:99], v[12:15]
    v_mfma_f32_16x16x32_bf16 v[44:47], v[92:95], v[96:99], v[44:47]
    v_xor_b32 v123, 32, v125
    ds_write_b128 v123, v[8:11]
    v_xor_b32 v124, 0, v126
    ds_write_b128 v124, v[32:35]
    v_mfma_f32_16x16x32_bf16 v[28:31], v[64:67], v[100:103], v[28:31]
    v_mfma_f32_16x16x32_bf16 v[60:63], v[68:71], v[100:103], v[60:63]
    v_mfma_f32_16x16x32_bf16 v[24:27], v[72:75], v[100:103], v[24:27]
    v_mfma_f32_16x16x32_bf16 v[56:59], v[76:79], v[100:103], v[56:59]
    v_mfma_f32_16x16x32_bf16 v[20:23], v[80:83], v[100:103], v[20:23]
    v_mfma_f32_16x16x32_bf16 v[52:55], v[84:87], v[100:103], v[52:55]
    v_mfma_f32_16x16x32_bf16 v[16:19], v[88:91], v[100:103], v[16:19]
    v_mfma_f32_16x16x32_bf16 v[48:51], v[92:95], v[100:103], v[48:51]
    v_xor_b32 v123, 16, v126
    ds_write_b128 v123, v[36:39]
    v_xor_b32 v124, 32, v126
    ds_write_b128 v124, v[40:43]
    v_mfma_f32_16x16x32_bf16 v[28:31], v[72:75], v[104:107], v[28:31]
    v_mfma_f32_16x16x32_bf16 v[60:63], v[76:79], v[104:107], v[60:63]
    v_mfma_f32_16x16x32_bf16 v[24:27], v[80:83], v[104:107], v[24:27]
    v_mfma_f32_16x16x32_bf16 v[56:59], v[84:87], v[104:107], v[56:59]
    v_mfma_f32_16x16x32_bf16 v[20:23], v[88:91], v[104:107], v[20:23]
    v_mfma_f32_16x16x32_bf16 v[52:55], v[92:95], v[104:107], v[52:55]
    v_xor_b32 v124, 48, v125
    ds_write_b128 v124, v[12:15]
    v_xor_b32 v123, 48, v126
    ds_write_b128 v123, v[44:47]
    v_mfma_f32_16x16x32_bf16 v[28:31], v[80:83], v[108:111], v[28:31]
    v_mfma_f32_16x16x32_bf16 v[60:63], v[84:87], v[108:111], v[60:63]
    v_mfma_f32_16x16x32_bf16 v[24:27], v[88:91], v[108:111], v[24:27]
    v_mfma_f32_16x16x32_bf16 v[56:59], v[92:95], v[108:111], v[56:59]
    v_xor_b32 v123, 64, v125
    ds_write_b128 v123, v[16:19]
    v_xor_b32 v124, 64, v126
    ds_write_b128 v124, v[48:51]
    v_mfma_f32_16x16x32_bf16 v[28:31], v[88:91], v[112:115], v[28:31]
    v_mfma_f32_16x16x32_bf16 v[60:63], v[92:95], v[112:115], v[60:63]
    v_xor_b32 v124, 80, v125
    ds_write_b128 v124, v[20:23]
    v_xor_b32 v123, 80, v126
    ds_write_b128 v123, v[52:55]
    v_and_b32 v108, 15, v127
    v_lshrrev_b32 v109, 4, v127
    v_lshrrev_b32 v110, 3, v108
    s_lshl_b32 s36, s20, 1
    v_add_u32 v110, s36, v110
    v_xor_b32 v111, v110, v108
    v_and_b32 v111, 7, v111
    v_lshlrev_b32 v111, 4, v111
    v_xor_b32 v123, 96, v125
    ds_write_b128 v123, v[24:27]
    v_lshl_add_u32 v111, v110, 7, v111
    v_lshl_add_u32 v120, v109, 11, v111
    v_add_u32 v121, 65536, v120
    v_add_u32 v64, 131072, v120
    s_lshl_b32 s36, s20, 9
    s_add_u32 s36, s36, 115712
    v_lshl_add_u32 v127, v109, 7, s36
    s_lshl_b32 s36, s20, 4
    v_add_u32 v108, s36, v108
    v_lshlrev_b32 v110, 6, v108
    v_lshl_add_u32 v110, v109, 4, v110
    s_mul_i32 s36, s29, 524288
    v_xor_b32 v124, 96, v126
    ds_write_b128 v124, v[56:59]
    s_lshl_b32 s37, s21, 4
    s_add_u32 s36, s36, s37
    v_add_u32 v110, s36, v110
    v_mov_b32 v111, 2130706432
    v_cmp_gt_u32 vcc, 125, v108
    s_mov_b32 s4, 0xbeaaaaab
    s_mov_b32 s5, s4
    s_mov_b32 s6, 0x3e800000
    s_mov_b32 s7, s6
    s_mov_b32 s8, 0xc0a00000
    s_mov_b32 s9, s8
    s_mov_b32 s10, 0xc0638e39
    v_xor_b32 v124, 112, v125
    ds_write_b128 v124, v[28:31]
    s_mov_b32 s11, s10
    s_mov_b32 s12, 0xbf638e39
    s_mov_b32 s13, s12
    s_mov_b32 s14, 0xbe638e39
    s_mov_b32 s15, s14
    s_mov_b32 s22, 0xbd638e39
    s_mov_b32 s23, s22
    s_mov_b32 s24, 0x3ff1c71c
    s_mov_b32 s25, s24
    s_mov_b32 s26, 0xbf2aaaab
    s_mov_b32 s27, s26
    s_mov_b32 s32, 0x3ecccccd
    v_xor_b32 v123, 112, v126
    s_waitcnt lgkmcnt(8)
    ds_write_b128 v123, v[60:63]
    s_mov_b32 s33, s32
    s_mov_b32 s34, 0xbd888889
    s_mov_b32 s35, s34
    s_mov_b32 s38, 0xbe4ccccd
    s_mov_b32 s39, s38
    s_mov_b32 s40, 0xbdd2d3e8
    s_mov_b32 s41, s40
    s_mov_b32 s42, 0x3f800000
    s_mov_b32 s43, s42
    s_setprio 0
    s_branch L_conv1_kernel_epi
L_conv1_kernel_m2:
    s_mul_i32 s37, s38, 2176
    s_add_u32 s37, s37, 98304
    v_add_u32 v116, s37, v8
    v_add_u32 v118, s37, v9
    v_add_u32 v117, 104832, v8
    s_cmp_eq_u32 s38, 0
    s_cbranch_scc1 L_conv1_kernel_hh0
    v_add_u32 v117, 98304, v9
L_conv1_kernel_hh0:
    s_lshl_b32 s37, s38, 12
    s_add_u32 s37, s37, s43
    s_add_u32 s37, s37, 49152
    v_lshl_add_u32 v119, v127, 4, s37
    v_mov_b32 v0, 0
    v_mov_b32 v1, 0
    v_mov_b32 v2, 0
    v_mov_b32 v3, 0
    v_mov_b32 v4, 0
    v_mov_b32 v5, 0
    v_mov_b32 v6, 0
    v_mov_b32 v7, 0
    v_mov_b32 v8, 0
    v_mov_b32 v9, 0
    v_mov_b32 v10, 0
    v_mov_b32 v11, 0
    v_mov_b32 v12, 0
    v_mov_b32 v13, 0
    v_mov_b32 v14, 0
    v_mov_b32 v15, 0
    v_mov_b32 v16, 0
    v_mov_b32 v17, 0
    v_mov_b32 v18, 0
    v_mov_b32 v19, 0
    v_mov_b32 v20, 0
    v_mov_b32 v21, 0
    v_mov_b32 v22, 0
    v_mov_b32 v23, 0
    v_mov_b32 v24, 0
    v_mov_b32 v25, 0
    v_mov_b32 v26, 0
    v_mov_b32 v27, 0
    v_mov_b32 v28, 0
    v_mov_b32 v29, 0
    v_mov_b32 v30, 0
    v_mov_b32 v31, 0
    v_mov_b32 v32, 0
    v_mov_b32 v33, 0
    v_mov_b32 v34, 0
    v_mov_b32 v35, 0
    v_mov_b32 v36, 0
    v_mov_b32 v37, 0
    v_mov_b32 v38, 0
    v_mov_b32 v39, 0
    v_mov_b32 v40, 0
    v_mov_b32 v41, 0
    v_mov_b32 v42, 0
    v_mov_b32 v43, 0
    v_mov_b32 v44, 0
    v_mov_b32 v45, 0
    v_mov_b32 v46, 0
    v_mov_b32 v47, 0
    v_mov_b32 v48, 0
    v_mov_b32 v49, 0
    v_mov_b32 v50, 0
    v_mov_b32 v51, 0
    v_mov_b32 v52, 0
    v_mov_b32 v53, 0
    v_mov_b32 v54, 0
    v_mov_b32 v55, 0
    v_mov_b32 v56, 0
    v_mov_b32 v57, 0
    v_mov_b32 v58, 0
    v_mov_b32 v59, 0
    v_mov_b32 v60, 0
    v_mov_b32 v61, 0
    v_mov_b32 v62, 0
    v_mov_b32 v63, 0
    buffer_load_dwordx4 v[96:99], v108, s[8:11], 0 offen
    buffer_load_dwordx4 v[100:103], v109, s[8:11], 0 offen
    buffer_load_dwordx4 v[104:107], v110, s[8:11], 0 offen
    s_mov_b32 s23, 0
    s_mov_b32 s26, 4096
    buffer_load_dwordx4 v[64:67], v125, s[12:15], s23 offen offset:0
    buffer_load_dwordx4 v[68:71], v125, s[12:15], s23 offen offset:2048
    buffer_load_dwordx4 v[80:83], v119, s[12:15], s23 offen offset:0
    buffer_load_dwordx4 v[72:75], v125, s[12:15], s26 offen offset:0
    buffer_load_dwordx4 v[84:87], v119, s[12:15], s23 offen offset:2048
    buffer_load_dwordx4 v[76:79], v125, s[12:15], s26 offen offset:2048
    s_mov_b32 s23, 57344
    s_mov_b32 s26, 61440
    s_waitcnt vmcnt(6)
    v_lshlrev_b32 v108, 16, v96
    v_and_b32 v111, s25, v96
    v_lshlrev_b32 v109, 16, v100
    v_and_b32 v112, s25, v100
    v_lshlrev_b32 v110, 16, v104
    v_and_b32 v113, s25, v104
    v_mul_f32 v114, s44, v108
    v_mul_f32 v115, s44, v111
    v_fmac_f32 v114, s45, v109
    v_fmac_f32 v115, s45, v112
    v_fmac_f32 v114, s46, v110
    v_fmac_f32 v115, s46, v113
    v_cvt_pk_bf16_f32 v96, v114, v115
    v_lshlrev_b32 v108, 16, v97
    v_and_b32 v111, s25, v97
    v_lshlrev_b32 v109, 16, v101
    v_and_b32 v112, s25, v101
    v_lshlrev_b32 v110, 16, v105
    v_and_b32 v113, s25, v105
    v_mul_f32 v114, s44, v108
    v_mul_f32 v115, s44, v111
    v_fmac_f32 v114, s45, v109
    v_fmac_f32 v115, s45, v112
    v_fmac_f32 v114, s46, v110
    v_fmac_f32 v115, s46, v113
    v_cvt_pk_bf16_f32 v97, v114, v115
    v_lshlrev_b32 v108, 16, v98
    v_and_b32 v111, s25, v98
    v_lshlrev_b32 v109, 16, v102
    v_and_b32 v112, s25, v102
    v_lshlrev_b32 v110, 16, v106
    v_and_b32 v113, s25, v106
    v_mul_f32 v114, s44, v108
    v_mul_f32 v115, s44, v111
    v_fmac_f32 v114, s45, v109
    v_fmac_f32 v115, s45, v112
    v_fmac_f32 v114, s46, v110
    v_fmac_f32 v115, s46, v113
    v_cvt_pk_bf16_f32 v98, v114, v115
    v_lshlrev_b32 v108, 16, v99
    v_and_b32 v111, s25, v99
    v_lshlrev_b32 v109, 16, v103
    v_and_b32 v112, s25, v103
    v_lshlrev_b32 v110, 16, v107
    v_and_b32 v113, s25, v107
    v_mul_f32 v114, s44, v108
    v_mul_f32 v115, s44, v111
    v_fmac_f32 v114, s45, v109
    v_fmac_f32 v115, s45, v112
    v_fmac_f32 v114, s46, v110
    v_fmac_f32 v115, s46, v113
    v_cvt_pk_bf16_f32 v99, v114, v115
    ds_write_b128 v126, v[96:99]
    v_and_b32 v111, 15, v127
    v_lshlrev_b32 v111, 2, v111
    v_add_u32 v111, 99328, v111
    ds_write_b32 v111, v0
    ds_write_b32 v111, v0 offset:8704
    s_waitcnt lgkmcnt(0)
    s_barrier
    s_mov_b32 s22, 8
    s_setprio 2
L_conv1_kernel_mloop2:
    ds_read_b128 v[88:91], v120 offset:0
    ds_read_b128 v[92:95], v120 offset:1024
    ds_read_b128 v[96:99], v116 offset:0
    ds_read_b128 v[100:103], v120 offset:2048
    ds_read_b128 v[104:107], v116 offset:1088
    ds_read_b128 v[108:111], v120 offset:3072
    ds_read_b128 v[112:115], v116 offset:2176
    s_waitcnt vmcnt(5) lgkmcnt(6)
    v_mfma_f32_16x16x32_bf16 v[0:3], v[64:67], v[88:91], v[0:3]
    ds_read_b128 v[88:91], v120 offset:4096
    s_waitcnt vmcnt(4) lgkmcnt(6)
    v_mfma_f32_16x16x32_bf16 v[4:7], v[64:67], v[92:95], v[4:7]
    v_mfma_f32_16x16x32_bf16 v[0:3], v[68:71], v[92:95], v[0:3]
    ds_read_b128 v[92:95], v116 offset:3264
    s_waitcnt vmcnt(3) lgkmcnt(6)
    v_mfma_f32_16x16x32_bf16 v[32:35], v[80:83], v[96:99], v[32:35]
    ds_read_b128 v[96:99], v120 offset:5120
    s_waitcnt vmcnt(2) lgkmcnt(6)
    v_mfma_f32_16x16x32_bf16 v[8:11], v[64:67], v[100:103], v[8:11]
    v_mfma_f32_16x16x32_bf16 v[4:7], v[68:71], v[100:103], v[4:7]
    v_mfma_f32_16x16x32_bf16 v[0:3], v[72:75], v[100:103], v[0:3]
    ds_read_b128 v[100:103], v116 offset:4352
    s_waitcnt vmcnt(1) lgkmcnt(6)
    v_mfma_f32_16x16x32_bf16 v[36:39], v[80:83], v[104:107], v[36:39]
    v_mfma_f32_16x16x32_bf16 v[32:35], v[84:87], v[104:107], v[32:35]
    ds_read_b128 v[104:107], v120 offset:6144
    s_waitcnt vmcnt(0) lgkmcnt(6)
    v_mfma_f32_16x16x32_bf16 v[12:15], v[64:67], v[108:111], v[12:15]
    v_mfma_f32_16x16x32_bf16 v[8:11], v[68:71], v[108:111], v[8:11]
    v_mfma_f32_16x16x32_bf16 v[4:7], v[72:75], v[108:111], v[4:7]
    v_mfma_f32_16x16x32_bf16 v[0:3], v[76:79], v[108:111], v[0:3]
    ds_read_b128 v[108:111], v116 offset:5440
    s_waitcnt lgkmcnt(6)
    v_mfma_f32_16x16x32_bf16 v[40:43], v[80:83], v[112:115], v[40:43]
    v_mfma_f32_16x16x32_bf16 v[36:39], v[84:87], v[112:115], v[36:39]
    ds_read_b128 v[112:115], v120 offset:7168
    s_waitcnt lgkmcnt(6)
    v_mfma_f32_16x16x32_bf16 v[16:19], v[64:67], v[88:91], v[16:19]
    v_mfma_f32_16x16x32_bf16 v[12:15], v[68:71], v[88:91], v[12:15]
    v_mfma_f32_16x16x32_bf16 v[8:11], v[72:75], v[88:91], v[8:11]
    v_mfma_f32_16x16x32_bf16 v[4:7], v[76:79], v[88:91], v[4:7]
    ds_read_b128 v[88:91], v117 offset:0
    s_waitcnt lgkmcnt(6)
    v_mfma_f32_16x16x32_bf16 v[44:47], v[80:83], v[92:95], v[44:47]
    v_mfma_f32_16x16x32_bf16 v[40:43], v[84:87], v[92:95], v[40:43]
    ds_read_b128 v[92:95], v122 offset:0
    v_add_u32 v122, v123, v122
    s_waitcnt lgkmcnt(6)
    v_mfma_f32_16x16x32_bf16 v[20:23], v[64:67], v[96:99], v[20:23]
    v_mfma_f32_16x16x32_bf16 v[16:19], v[68:71], v[96:99], v[16:19]
    v_mfma_f32_16x16x32_bf16 v[12:15], v[72:75], v[96:99], v[12:15]
    v_mfma_f32_16x16x32_bf16 v[8:11], v[76:79], v[96:99], v[8:11]
    ds_read_b128 v[96:99], v117 offset:1088
    s_waitcnt lgkmcnt(6)
    v_mfma_f32_16x16x32_bf16 v[48:51], v[80:83], v[100:103], v[48:51]
    v_mfma_f32_16x16x32_bf16 v[44:47], v[84:87], v[100:103], v[44:47]
    ds_read_b128 v[100:103], v121 offset:1024
    s_waitcnt lgkmcnt(6)
    v_mfma_f32_16x16x32_bf16 v[24:27], v[64:67], v[104:107], v[24:27]
    v_mfma_f32_16x16x32_bf16 v[20:23], v[68:71], v[104:107], v[20:23]
    v_mfma_f32_16x16x32_bf16 v[16:19], v[72:75], v[104:107], v[16:19]
    v_mfma_f32_16x16x32_bf16 v[12:15], v[76:79], v[104:107], v[12:15]
    ds_read_b128 v[104:107], v118 offset:0
    s_waitcnt lgkmcnt(6)
    v_mfma_f32_16x16x32_bf16 v[52:55], v[80:83], v[108:111], v[52:55]
    v_mfma_f32_16x16x32_bf16 v[48:51], v[84:87], v[108:111], v[48:51]
    ds_read_b128 v[108:111], v121 offset:2048
    s_waitcnt lgkmcnt(6)
    v_mfma_f32_16x16x32_bf16 v[28:31], v[64:67], v[112:115], v[28:31]
    v_mfma_f32_16x16x32_bf16 v[24:27], v[68:71], v[112:115], v[24:27]
    v_mfma_f32_16x16x32_bf16 v[20:23], v[72:75], v[112:115], v[20:23]
    v_mfma_f32_16x16x32_bf16 v[16:19], v[76:79], v[112:115], v[16:19]
    buffer_load_dwordx4 v[64:67], v125, s[12:15], s23 offen offset:0
    s_waitcnt lgkmcnt(5)
    v_mfma_f32_16x16x32_bf16 v[56:59], v[80:83], v[88:91], v[56:59]
    v_mfma_f32_16x16x32_bf16 v[52:55], v[84:87], v[88:91], v[52:55]
    s_waitcnt lgkmcnt(0)
    s_barrier
    v_mfma_f32_16x16x32_bf16 v[28:31], v[68:71], v[92:95], v[28:31]
    v_mfma_f32_16x16x32_bf16 v[24:27], v[72:75], v[92:95], v[24:27]
    v_mfma_f32_16x16x32_bf16 v[20:23], v[76:79], v[92:95], v[20:23]
    buffer_load_dwordx4 v[68:71], v125, s[12:15], s23 offen offset:2048
    v_mfma_f32_16x16x32_bf16 v[60:63], v[80:83], v[96:99], v[60:63]
    v_mfma_f32_16x16x32_bf16 v[56:59], v[84:87], v[96:99], v[56:59]
    buffer_load_dwordx4 v[80:83], v119, s[12:15], s23 offen offset:0
    v_mfma_f32_16x16x32_bf16 v[28:31], v[72:75], v[100:103], v[28:31]
    v_mfma_f32_16x16x32_bf16 v[24:27], v[76:79], v[100:103], v[24:27]
    buffer_load_dwordx4 v[72:75], v125, s[12:15], s26 offen offset:0
    v_mfma_f32_16x16x32_bf16 v[60:63], v[84:87], v[104:107], v[60:63]
    buffer_load_dwordx4 v[84:87], v119, s[12:15], s23 offen offset:2048
    v_mfma_f32_16x16x32_bf16 v[28:31], v[76:79], v[108:111], v[28:31]
    buffer_load_dwordx4 v[76:79], v125, s[12:15], s26 offen offset:2048
    s_add_u32 s23, s23, 57344
    s_add_u32 s26, s26, 57344
    s_sub_u32 s22, s22, 1
    s_cmp_eq_u32 s22, 0
    s_cbranch_scc1 L_conv1_kernel_mlast2
    ds_read_b128 v[88:91], v120 offset:8192
    ds_read_b128 v[92:95], v120 offset:9216
    ds_read_b128 v[96:99], v116 offset:8704
    ds_read_b128 v[100:103], v120 offset:10240
    ds_read_b128 v[104:107], v116 offset:9792
    ds_read_b128 v[108:111], v120 offset:11264
    ds_read_b128 v[112:115], v116 offset:10880
    s_waitcnt vmcnt(5) lgkmcnt(6)
    v_mfma_f32_16x16x32_bf16 v[0:3], v[64:67], v[88:91], v[0:3]
    ds_read_b128 v[88:91], v120 offset:12288
    s_waitcnt vmcnt(4) lgkmcnt(6)
    v_mfma_f32_16x16x32_bf16 v[4:7], v[64:67], v[92:95], v[4:7]
    v_mfma_f32_16x16x32_bf16 v[0:3], v[68:71], v[92:95], v[0:3]
    ds_read_b128 v[92:95], v116 offset:11968
    s_waitcnt vmcnt(3) lgkmcnt(6)
    v_mfma_f32_16x16x32_bf16 v[32:35], v[80:83], v[96:99], v[32:35]
    ds_read_b128 v[96:99], v120 offset:13312
    s_waitcnt vmcnt(2) lgkmcnt(6)
    v_mfma_f32_16x16x32_bf16 v[8:11], v[64:67], v[100:103], v[8:11]
    v_mfma_f32_16x16x32_bf16 v[4:7], v[68:71], v[100:103], v[4:7]
    v_mfma_f32_16x16x32_bf16 v[0:3], v[72:75], v[100:103], v[0:3]
    ds_read_b128 v[100:103], v116 offset:13056
    s_waitcnt vmcnt(1) lgkmcnt(6)
    v_mfma_f32_16x16x32_bf16 v[36:39], v[80:83], v[104:107], v[36:39]
    v_mfma_f32_16x16x32_bf16 v[32:35], v[84:87], v[104:107], v[32:35]
    ds_read_b128 v[104:107], v120 offset:14336
    s_waitcnt vmcnt(0) lgkmcnt(6)
    v_mfma_f32_16x16x32_bf16 v[12:15], v[64:67], v[108:111], v[12:15]
    v_mfma_f32_16x16x32_bf16 v[8:11], v[68:71], v[108:111], v[8:11]
    v_mfma_f32_16x16x32_bf16 v[4:7], v[72:75], v[108:111], v[4:7]
    v_mfma_f32_16x16x32_bf16 v[0:3], v[76:79], v[108:111], v[0:3]
    ds_read_b128 v[108:111], v116 offset:14144
    s_waitcnt lgkmcnt(6)
    v_mfma_f32_16x16x32_bf16 v[40:43], v[80:83], v[112:115], v[40:43]
    v_mfma_f32_16x16x32_bf16 v[36:39], v[84:87], v[112:115], v[36:39]
    ds_read_b128 v[112:115], v120 offset:15360
    s_waitcnt lgkmcnt(6)
    v_mfma_f32_16x16x32_bf16 v[16:19], v[64:67], v[88:91], v[16:19]
    v_mfma_f32_16x16x32_bf16 v[12:15], v[68:71], v[88:91], v[12:15]
    v_mfma_f32_16x16x32_bf16 v[8:11], v[72:75], v[88:91], v[8:11]
    v_mfma_f32_16x16x32_bf16 v[4:7], v[76:79], v[88:91], v[4:7]
    ds_read_b128 v[88:91], v117 offset:8704
    s_waitcnt lgkmcnt(6)
    v_mfma_f32_16x16x32_bf16 v[44:47], v[80:83], v[92:95], v[44:47]
    v_mfma_f32_16x16x32_bf16 v[40:43], v[84:87], v[92:95], v[40:43]
    ds_read_b128 v[92:95], v122 offset:0
    v_add_u32 v122, v124, v122
    s_waitcnt lgkmcnt(6)
    v_mfma_f32_16x16x32_bf16 v[20:23], v[64:67], v[96:99], v[20:23]
    v_mfma_f32_16x16x32_bf16 v[16:19], v[68:71], v[96:99], v[16:19]
    v_mfma_f32_16x16x32_bf16 v[12:15], v[72:75], v[96:99], v[12:15]
    v_mfma_f32_16x16x32_bf16 v[8:11], v[76:79], v[96:99], v[8:11]
    ds_read_b128 v[96:99], v117 offset:9792
    s_waitcnt lgkmcnt(6)
    v_mfma_f32_16x16x32_bf16 v[48:51], v[80:83], v[100:103], v[48:51]
    v_mfma_f32_16x16x32_bf16 v[44:47], v[84:87], v[100:103], v[44:47]
    ds_read_b128 v[100:103], v121 offset:9216
    s_waitcnt lgkmcnt(6)
    v_mfma_f32_16x16x32_bf16 v[24:27], v[64:67], v[104:107], v[24:27]
    v_mfma_f32_16x16x32_bf16 v[20:23], v[68:71], v[104:107], v[20:23]
    v_mfma_f32_16x16x32_bf16 v[16:19], v[72:75], v[104:107], v[16:19]
    v_mfma_f32_16x16x32_bf16 v[12:15], v[76:79], v[104:107], v[12:15]
    ds_read_b128 v[104:107], v118 offset:8704
    s_waitcnt lgkmcnt(6)
    v_mfma_f32_16x16x32_bf16 v[52:55], v[80:83], v[108:111], v[52:55]
    v_mfma_f32_16x16x32_bf16 v[48:51], v[84:87], v[108:111], v[48:51]
    ds_read_b128 v[108:111], v121 offset:10240
    s_waitcnt lgkmcnt(6)
    v_mfma_f32_16x16x32_bf16 v[28:31], v[64:67], v[112:115], v[28:31]
    v_mfma_f32_16x16x32_bf16 v[24:27], v[68:71], v[112:115], v[24:27]
    v_mfma_f32_16x16x32_bf16 v[20:23], v[72:75], v[112:115], v[20:23]
    v_mfma_f32_16x16x32_bf16 v[16:19], v[76:79], v[112:115], v[16:19]
    buffer_load_dwordx4 v[64:67], v125, s[12:15], s23 offen offset:0
    s_waitcnt lgkmcnt(5)
    v_mfma_f32_16x16x32_bf16 v[56:59], v[80:83], v[88:91], v[56:59]
    v_mfma_f32_16x16x32_bf16 v[52:55], v[84:87], v[88:91], v[52:55]
    s_waitcnt lgkmcnt(0)
    s_barrier
    v_mfma_f32_16x16x32_bf16 v[28:31], v[68:71], v[92:95], v[28:31]
    v_mfma_f32_16x16x32_bf16 v[24:27], v[72:75], v[92:95], v[24:27]
    v_mfma_f32_16x16x32_bf16 v[20:23], v[76:79], v[92:95], v[20:23]
    buffer_load_dwordx4 v[68:71], v125, s[12:15], s23 offen offset:2048
    v_mfma_f32_16x16x32_bf16 v[60:63], v[80:83], v[96:99], v[60:63]
    v_mfma_f32_16x16x32_bf16 v[56:59], v[84:87], v[96:99], v[56:59]
    buffer_load_dwordx4 v[80:83], v119, s[12:15], s23 offen offset:0
    v_mfma_f32_16x16x32_bf16 v[28:31], v[72:75], v[100:103], v[28:31]
    v_mfma_f32_16x16x32_bf16 v[24:27], v[76:79], v[100:103], v[24:27]
    buffer_load_dwordx4 v[72:75], v125, s[12:15], s26 offen offset:0
    v_mfma_f32_16x16x32_bf16 v[60:63], v[84:87], v[104:107], v[60:63]
    buffer_load_dwordx4 v[84:87], v119, s[12:15], s23 offen offset:2048
    v_mfma_f32_16x16x32_bf16 v[28:31], v[76:79], v[108:111], v[28:31]
    buffer_load_dwordx4 v[76:79], v125, s[12:15], s26 offen offset:2048
    s_add_u32 s23, s23, 57344
    s_add_u32 s26, s26, 57344
    s_branch L_conv1_kernel_mloop2
L_conv1_kernel_mlast2:
    v_and_b32 v125, 15, v127
    v_and_b32 v126, 7, v127
    v_lshlrev_b32 v126, 4, v126
    v_lshl_add_u32 v125, v125, 7, v126
    v_lshrrev_b32 v126, 4, v127
    v_lshl_add_u32 v125, v126, 11, v125
    s_mov_b32 s36, 65536
    s_cmp_eq_u32 s32, 1
    s_cselect_b32 s36, 121856, s36
    s_cmp_eq_u32 s32, 2
    s_cselect_b32 s36, 81920, s36
    s_cmp_eq_u32 s32, 3
    s_cselect_b32 s36, 130048, s36
    s_mov_b32 s37, 98304
    s_cmp_eq_u32 s32, 1
    s_cselect_b32 s37, 138240, s37
    s_cmp_eq_u32 s32, 2
    s_cselect_b32 s37, 146432, s37
    s_cmp_eq_u32 s32, 3
    s_cselect_b32 s37, 154624, s37
    v_add_u32 v126, s37, v125
    v_add_u32 v125, s36, v125
    ds_read_b128 v[88:91], v120 offset:8192
    ds_read_b128 v[92:95], v120 offset:9216
    ds_read_b128 v[96:99], v116 offset:8704
    ds_read_b128 v[100:103], v120 offset:10240
    ds_read_b128 v[104:107], v116 offset:9792
    ds_read_b128 v[108:111], v120 offset:11264
    ds_read_b128 v[112:115], v116 offset:10880
    s_waitcnt vmcnt(5) lgkmcnt(6)
    v_mfma_f32_16x16x32_bf16 v[0:3], v[64:67], v[88:91], v[0:3]
    ds_read_b128 v[88:91], v120 offset:12288
    s_waitcnt vmcnt(4) lgkmcnt(6)
    v_mfma_f32_16x16x32_bf16 v[4:7], v[64:67], v[92:95], v[4:7]
    v_mfma_f32_16x16x32_bf16 v[0:3], v[68:71], v[92:95], v[0:3]
    ds_read_b128 v[92:95], v116 offset:11968
    s_waitcnt vmcnt(3) lgkmcnt(6)
    v_mfma_f32_16x16x32_bf16 v[32:35], v[80:83], v[96:99], v[32:35]
    ds_read_b128 v[96:99], v120 offset:13312
    s_waitcnt vmcnt(2) lgkmcnt(6)
    v_mfma_f32_16x16x32_bf16 v[8:11], v[64:67], v[100:103], v[8:11]
    v_mfma_f32_16x16x32_bf16 v[4:7], v[68:71], v[100:103], v[4:7]
    v_mfma_f32_16x16x32_bf16 v[0:3], v[72:75], v[100:103], v[0:3]
    ds_read_b128 v[100:103], v116 offset:13056
    s_waitcnt vmcnt(1) lgkmcnt(6)
    v_mfma_f32_16x16x32_bf16 v[36:39], v[80:83], v[104:107], v[36:39]
    v_mfma_f32_16x16x32_bf16 v[32:35], v[84:87], v[104:107], v[32:35]
    ds_read_b128 v[104:107], v120 offset:14336
    s_waitcnt vmcnt(0) lgkmcnt(6)
    v_mfma_f32_16x16x32_bf16 v[12:15], v[64:67], v[108:111], v[12:15]
    v_mfma_f32_16x16x32_bf16 v[8:11], v[68:71], v[108:111], v[8:11]
    v_mfma_f32_16x16x32_bf16 v[4:7], v[72:75], v[108:111], v[4:7]
    v_mfma_f32_16x16x32_bf16 v[0:3], v[76:79], v[108:111], v[0:3]
    ds_read_b128 v[108:111], v116 offset:14144
    s_waitcnt lgkmcnt(6)
    v_mfma_f32_16x16x32_bf16 v[40:43], v[80:83], v[112:115], v[40:43]
    v_mfma_f32_16x16x32_bf16 v[36:39], v[84:87], v[112:115], v[36:39]
    ds_read_b128 v[112:115], v120 offset:15360
    s_waitcnt lgkmcnt(6)
    v_mfma_f32_16x16x32_bf16 v[16:19], v[64:67], v[88:91], v[16:19]
    v_mfma_f32_16x16x32_bf16 v[12:15], v[68:71], v[88:91], v[12:15]
    v_mfma_f32_16x16x32_bf16 v[8:11], v[72:75], v[88:91], v[8:11]
    v_mfma_f32_16x16x32_bf16 v[4:7], v[76:79], v[88:91], v[4:7]
    ds_read_b128 v[88:91], v117 offset:8704
    v_xor_b32 v124, 0, v126
    ds_write_b128 v124, v[32:35]
    s_waitcnt lgkmcnt(7)
    v_mfma_f32_16x16x32_bf16 v[44:47], v[80:83], v[92:95], v[44:47]
    v_mfma_f32_16x16x32_bf16 v[40:43], v[84:87], v[92:95], v[40:43]
    ds_read_b128 v[92:95], v122 offset:0
    v_xor_b32 v123, 0, v125
    ds_write_b128 v123, v[0:3]
    s_waitcnt lgkmcnt(8)
    v_mfma_f32_16x16x32_bf16 v[20:23], v[64:67], v[96:99], v[20:23]
    v_mfma_f32_16x16x32_bf16 v[16:19], v[68:71], v[96:99], v[16:19]
    v_mfma_f32_16x16x32_bf16 v[12:15], v[72:75], v[96:99], v[12:15]
    v_mfma_f32_16x16x32_bf16 v[8:11], v[76:79], v[96:99], v[8:11]
    ds_read_b128 v[96:99], v117 offset:9792
    v_xor_b32 v123, 16, v126
    ds_write_b128 v123, v[36:39]
    s_waitcnt lgkmcnt(9)
    v_mfma_f32_16x16x32_bf16 v[48:51], v[80:83], v[100:103], v[48:51]
    v_mfma_f32_16x16x32_bf16 v[44:47], v[84:87], v[100:103], v[44:47]
    ds_read_b128 v[100:103], v121 offset:9216
    v_xor_b32 v124, 16, v125
    ds_write_b128 v124, v[4:7]
    s_waitcnt lgkmcnt(10)
    v_mfma_f32_16x16x32_bf16 v[24:27], v[64:67], v[104:107], v[24:27]
    v_mfma_f32_16x16x32_bf16 v[20:23], v[68:71], v[104:107], v[20:23]
    v_mfma_f32_16x16x32_bf16 v[16:19], v[72:75], v[104:107], v[16:19]
    v_mfma_f32_16x16x32_bf16 v[12:15], v[76:79], v[104:107], v[12:15]
    ds_read_b128 v[104:107], v118 offset:8704
    v_xor_b32 v124, 32, v126
    ds_write_b128 v124, v[40:43]
    s_waitcnt lgkmcnt(11)
    v_mfma_f32_16x16x32_bf16 v[52:55], v[80:83], v[108:111], v[52:55]
    v_mfma_f32_16x16x32_bf16 v[48:51], v[84:87], v[108:111], v[48:51]
    ds_read_b128 v[108:111], v121 offset:10240
    v_xor_b32 v123, 32, v125
    ds_write_b128 v123, v[8:11]
    s_waitcnt lgkmcnt(12)
    v_mfma_f32_16x16x32_bf16 v[28:31], v[64:67], v[112:115], v[28:31]
    v_mfma_f32_16x16x32_bf16 v[24:27], v[68:71], v[112:115], v[24:27]
    v_mfma_f32_16x16x32_bf16 v[20:23], v[72:75], v[112:115], v[20:23]
    v_mfma_f32_16x16x32_bf16 v[16:19], v[76:79], v[112:115], v[16:19]
    v_xor_b32 v123, 48, v126
    ds_write_b128 v123, v[44:47]
    s_waitcnt lgkmcnt(12)
    v_mfma_f32_16x16x32_bf16 v[56:59], v[80:83], v[88:91], v[56:59]
    v_mfma_f32_16x16x32_bf16 v[52:55], v[84:87], v[88:91], v[52:55]
    v_xor_b32 v124, 48, v125
    ds_write_b128 v124, v[12:15]
    s_waitcnt lgkmcnt(11)
    v_mfma_f32_16x16x32_bf16 v[28:31], v[68:71], v[92:95], v[28:31]
    v_mfma_f32_16x16x32_bf16 v[24:27], v[72:75], v[92:95], v[24:27]
    v_mfma_f32_16x16x32_bf16 v[20:23], v[76:79], v[92:95], v[20:23]
    v_xor_b32 v124, 64, v126
    ds_write_b128 v124, v[48:51]
    s_waitcnt lgkmcnt(10)
    v_mfma_f32_16x16x32_bf16 v[60:63], v[80:83], v[96:99], v[60:63]
    v_mfma_f32_16x16x32_bf16 v[56:59], v[84:87], v[96:99], v[56:59]
    v_xor_b32 v123, 64, v125
    ds_write_b128 v123, v[16:19]
    s_waitcnt lgkmcnt(9)
    v_mfma_f32_16x16x32_bf16 v[28:31], v[72:75], v[100:103], v[28:31]
    v_mfma_f32_16x16x32_bf16 v[24:27], v[76:79], v[100:103], v[24:27]
    v_xor_b32 v123, 80, v126
    ds_write_b128 v123, v[52:55]
    s_waitcnt lgkmcnt(8)
    v_mfma_f32_16x16x32_bf16 v[60:63], v[84:87], v[104:107], v[60:63]
    v_xor_b32 v124, 80, v125
    ds_write_b128 v124, v[20:23]
    s_waitcnt lgkmcnt(7)
    v_mfma_f32_16x16x32_bf16 v[28:31], v[76:79], v[108:111], v[28:31]
    v_xor_b32 v124, 96, v126
    ds_write_b128 v124, v[56:59]
    v_and_b32 v108, 15, v127
    v_lshrrev_b32 v109, 4, v127
    v_lshrrev_b32 v110, 3, v108
    s_lshl_b32 s36, s20, 1
    v_add_u32 v110, s36, v110
    v_xor_b32 v111, v110, v108
    v_and_b32 v111, 7, v111
    v_lshlrev_b32 v111, 4, v111
    v_xor_b32 v123, 96, v125
    ds_write_b128 v123, v[24:27]
    v_lshl_add_u32 v111, v110, 7, v111
    v_lshl_add_u32 v120, v109, 11, v111
    v_add_u32 v121, 65536, v120
    v_add_u32 v64, 131072, v120
    s_lshl_b32 s36, s20, 9
    s_add_u32 s36, s36, 115712
    v_lshl_add_u32 v127, v109, 7, s36
    s_lshl_b32 s36, s20, 4
    v_add_u32 v108, s36, v108
    v_lshlrev_b32 v110, 6, v108
    v_lshl_add_u32 v110, v109, 4, v110
    s_mul_i32 s36, s29, 524288
    v_xor_b32 v123, 112, v126
    ds_write_b128 v123, v[60:63]
    s_lshl_b32 s37, s21, 4
    s_add_u32 s36, s36, s37
    v_add_u32 v110, s36, v110
    v_mov_b32 v111, 2130706432
    v_cmp_gt_u32 vcc, 125, v108
    s_mov_b32 s4, 0xbeaaaaab
    s_mov_b32 s5, s4
    s_mov_b32 s6, 0x3e800000
    s_mov_b32 s7, s6
    s_mov_b32 s8, 0xc0a00000
    s_mov_b32 s9, s8
    s_mov_b32 s10, 0xc0638e39
    v_xor_b32 v124, 112, v125
    ds_write_b128 v124, v[28:31]
    s_mov_b32 s11, s10
    s_mov_b32 s12, 0xbf638e39
    s_mov_b32 s13, s12
    s_mov_b32 s14, 0xbe638e39
    s_mov_b32 s15, s14
    s_mov_b32 s22, 0xbd638e39
    s_mov_b32 s23, s22
    s_mov_b32 s24, 0x3ff1c71c
    s_mov_b32 s25, s24
    s_mov_b32 s26, 0xbf2aaaab
    s_mov_b32 s27, s26
    s_mov_b32 s32, 0x3ecccccd
    s_mov_b32 s33, s32
    s_mov_b32 s34, 0xbd888889
    s_mov_b32 s35, s34
    s_mov_b32 s38, 0xbe4ccccd
    s_mov_b32 s39, s38
    s_mov_b32 s40, 0xbdd2d3e8
    s_mov_b32 s41, s40
    s_mov_b32 s42, 0x3f800000
    s_mov_b32 s43, s42
    s_setprio 0
    s_branch L_conv1_kernel_epi
L_conv1_kernel_helper:
    s_setprio 3
    v_add_u32 v92, 0, v7
    v_add_u32 v93, 1024, v7
    v_add_u32 v94, 2048, v7
    v_add_u32 v95, 3072, v7
    v_and_b32 v76, 4, v5
    v_lshrrev_b32 v76, 1, v76
    v_xor_b32 v76, v6, v76
    v_lshlrev_b32 v76, 4, v76
    v_lshl_add_u32 v76, v5, 6, v76
    s_mov_b32 s24, 0
    s_mov_b32 s27, 524288
    s_waitcnt lgkmcnt(0)
    s_add_u32 s8, s4, s47
    s_addc_u32 s9, s5, 0
    buffer_load_dwordx4 v[0:3], v92, s[8:11], s24 offen offset:0
    buffer_load_dwordx4 v[16:19], v92, s[8:11], s24 offen offset:64
    v_add_u32 v92, 128, v92
    buffer_load_dwordx4 v[4:7], v93, s[8:11], s24 offen offset:0
    buffer_load_dwordx4 v[20:23], v93, s[8:11], s24 offen offset:64
    v_add_u32 v93, 128, v93
    buffer_load_dwordx4 v[8:11], v94, s[8:11], s24 offen offset:0
    buffer_load_dwordx4 v[24:27], v94, s[8:11], s24 offen offset:64
    v_add_u32 v94, 128, v94
    buffer_load_dwordx4 v[12:15], v95, s[8:11], s24 offen offset:0
    buffer_load_dwordx4 v[28:31], v95, s[8:11], s24 offen offset:64
    v_add_u32 v95, 128, v95
    s_mul_i32 s36, s42, 1024
    v_add_u32 v96, s36, v76
    v_add_u32 v97, 65536, v96
    s_mul_i32 s36, s42, 1088
    s_add_u32 s36, s36, 98304
    v_add_u32 v98, s36, v76
    s_waitcnt vmcnt(0)
    s_mov_b32 s28, 0
    s_mov_b32 s22, 4
    s_cmp_ge_u32 s20, 12
    s_cbranch_scc1 L_conv1_kernel_h2
    ds_write_b128 v96, v[0:3] offset:0
    ds_write_b128 v98, v[12:15] offset:0
    v_lshlrev_b32 v76, 16, v0
    v_and_b32 v84, s25, v0
    v_lshlrev_b32 v77, 16, v4
    v_and_b32 v85, s25, v4
    v_lshlrev_b32 v78, 16, v8
    v_and_b32 v86, s25, v8
    v_lshlrev_b32 v79, 16, v12
    v_and_b32 v87, s25, v12
    v_add_f32 v80, v76, v78
    v_add_f32 v88, v84, v86
    v_add_f32 v81, v77, v79
    v_add_f32 v89, v85, v87
    v_fma_f32 v82, v78, 4.0, v76
    v_fma_f32 v90, v86, 4.0, v84
    v_fma_f32 v83, v79, 4.0, v77
    v_fma_f32 v91, v87, 4.0, v85
    v_add_f32 v77, v80, v81
    v_add_f32 v85, v88, v89
    v_sub_f32 v78, v80, v81
    v_sub_f32 v86, v88, v89
    v_fma_f32 v79, v83, 2.0, v82
    v_fma_f32 v87, v91, 2.0, v90
    v_fma_f32 v82, v83, -2.0, v82
    v_fma_f32 v90, v91, -2.0, v90
    v_fmamk_f32 v80, v76, 0x41700000, v82
    v_fmamk_f32 v88, v84, 0x41700000, v90
    v_fmamk_f32 v80, v81, 0x41200000, v80
    v_fmamk_f32 v88, v89, 0x41200000, v88
    v_cvt_pk_bf16_f32 v4, v77, v85
    v_cvt_pk_bf16_f32 v8, v78, v86
    v_cvt_pk_bf16_f32 v64, v79, v87
    v_cvt_pk_bf16_f32 v68, v82, v90
    v_cvt_pk_bf16_f32 v72, v80, v88
    v_lshlrev_b32 v76, 16, v1
    v_and_b32 v84, s25, v1
    v_lshlrev_b32 v77, 16, v5
    v_and_b32 v85, s25, v5
    v_lshlrev_b32 v78, 16, v9
    v_and_b32 v86, s25, v9
    v_lshlrev_b32 v79, 16, v13
    v_and_b32 v87, s25, v13
    v_add_f32 v80, v76, v78
    v_add_f32 v88, v84, v86
    v_add_f32 v81, v77, v79
    v_add_f32 v89, v85, v87
    v_fma_f32 v82, v78, 4.0, v76
    v_fma_f32 v90, v86, 4.0, v84
    v_fma_f32 v83, v79, 4.0, v77
    v_fma_f32 v91, v87, 4.0, v85
    v_add_f32 v77, v80, v81
    v_add_f32 v85, v88, v89
    v_sub_f32 v78, v80, v81
    v_sub_f32 v86, v88, v89
    v_fma_f32 v79, v83, 2.0, v82
    v_fma_f32 v87, v91, 2.0, v90
    v_fma_f32 v82, v83, -2.0, v82
    v_fma_f32 v90, v91, -2.0, v90
    v_fmamk_f32 v80, v76, 0x41700000, v82
    v_fmamk_f32 v88, v84, 0x41700000, v90
    v_fmamk_f32 v80, v81, 0x41200000, v80
    v_fmamk_f32 v88, v89, 0x41200000, v88
    v_cvt_pk_bf16_f32 v5, v77, v85
    v_cvt_pk_bf16_f32 v9, v78, v86
    v_cvt_pk_bf16_f32 v65, v79, v87
    v_cvt_pk_bf16_f32 v69, v82, v90
    v_cvt_pk_bf16_f32 v73, v80, v88
    v_lshlrev_b32 v76, 16, v2
    v_and_b32 v84, s25, v2
    v_lshlrev_b32 v77, 16, v6
    v_and_b32 v85, s25, v6
    v_lshlrev_b32 v78, 16, v10
    v_and_b32 v86, s25, v10
    v_lshlrev_b32 v79, 16, v14
    v_and_b32 v87, s25, v14
    v_add_f32 v80, v76, v78
    v_add_f32 v88, v84, v86
    v_add_f32 v81, v77, v79
    v_add_f32 v89, v85, v87
    v_fma_f32 v82, v78, 4.0, v76
    v_fma_f32 v90, v86, 4.0, v84
    v_fma_f32 v83, v79, 4.0, v77
    v_fma_f32 v91, v87, 4.0, v85
    v_add_f32 v77, v80, v81
    v_add_f32 v85, v88, v89
    v_sub_f32 v78, v80, v81
    v_sub_f32 v86, v88, v89
    v_fma_f32 v79, v83, 2.0, v82
    v_fma_f32 v87, v91, 2.0, v90
    v_fma_f32 v82, v83, -2.0, v82
    v_fma_f32 v90, v91, -2.0, v90
    v_fmamk_f32 v80, v76, 0x41700000, v82
    v_fmamk_f32 v88, v84, 0x41700000, v90
    v_fmamk_f32 v80, v81, 0x41200000, v80
    v_fmamk_f32 v88, v89, 0x41200000, v88
    v_cvt_pk_bf16_f32 v6, v77, v85
    v_cvt_pk_bf16_f32 v10, v78, v86
    v_cvt_pk_bf16_f32 v66, v79, v87
    v_cvt_pk_bf16_f32 v70, v82, v90
    v_cvt_pk_bf16_f32 v74, v80, v88
    v_lshlrev_b32 v76, 16, v3
    v_and_b32 v84, s25, v3
    v_lshlrev_b32 v77, 16, v7
    v_and_b32 v85, s25, v7
    v_lshlrev_b32 v78, 16, v11
    v_and_b32 v86, s25, v11
    v_lshlrev_b32 v79, 16, v15
    v_and_b32 v87, s25, v15
    v_add_f32 v80, v76, v78
    v_add_f32 v88, v84, v86
    v_add_f32 v81, v77, v79
    v_add_f32 v89, v85, v87
    v_fma_f32 v82, v78, 4.0, v76
    v_fma_f32 v90, v86, 4.0, v84
    v_fma_f32 v83, v79, 4.0, v77
    v_fma_f32 v91, v87, 4.0, v85
    v_add_f32 v77, v80, v81
    v_add_f32 v85, v88, v89
    v_sub_f32 v78, v80, v81
    v_sub_f32 v86, v88, v89
    v_fma_f32 v79, v83, 2.0, v82
    v_fma_f32 v87, v91, 2.0, v90
    v_fma_f32 v82, v83, -2.0, v82
    v_fma_f32 v90, v91, -2.0, v90
    v_fmamk_f32 v80, v76, 0x41700000, v82
    v_fmamk_f32 v88, v84, 0x41700000, v90
    v_fmamk_f32 v80, v81, 0x41200000, v80
    v_fmamk_f32 v88, v89, 0x41200000, v88
    v_cvt_pk_bf16_f32 v7, v77, v85
    v_cvt_pk_bf16_f32 v11, v78, v86
    v_cvt_pk_bf16_f32 v67, v79, v87
    v_cvt_pk_bf16_f32 v71, v82, v90
    v_cvt_pk_bf16_f32 v75, v80, v88
    ds_write_b128 v96, v[64:67] offset:49152
    ds_write_b128 v97, v[68:71] offset:0
    ds_write_b128 v97, v[72:75] offset:16384
    ds_write_b128 v96, v[4:7] offset:16384
    ds_write_b128 v96, v[8:11] offset:32768
    s_waitcnt vmcnt(0)
    s_waitcnt lgkmcnt(0)
    s_barrier
    buffer_load_dwordx4 v[32:35], v92, s[8:11], s24 offen offset:0
    buffer_load_dwordx4 v[48:51], v92, s[8:11], s24 offen offset:64
    v_add_u32 v92, 128, v92
    buffer_load_dwordx4 v[36:39], v93, s[8:11], s24 offen offset:0
    buffer_load_dwordx4 v[52:55], v93, s[8:11], s24 offen offset:64
    v_add_u32 v93, 128, v93
    s_setprio 1
L_conv1_kernel_hloop1:
    s_cmp_lt_u32 s28, 13
    s_cselect_b32 s24, 0, 2130706432
    v_lshlrev_b32 v76, 16, v16
    v_and_b32 v84, s25, v16
    v_lshlrev_b32 v77, 16, v20
    v_and_b32 v85, s25, v20
    v_lshlrev_b32 v78, 16, v24
    v_and_b32 v86, s25, v24
    v_lshlrev_b32 v79, 16, v28
    v_and_b32 v87, s25, v28
    v_add_f32 v80, v76, v78
    v_add_f32 v88, v84, v86
    v_add_f32 v81, v77, v79
    v_add_f32 v89, v85, v87
    v_fma_f32 v82, v78, 4.0, v76
    buffer_load_dwordx4 v[40:43], v94, s[8:11], s24 offen offset:0
    buffer_load_dwordx4 v[56:59], v94, s[8:11], s24 offen offset:64
    v_add_u32 v94, 128, v94
    v_fma_f32 v90, v86, 4.0, v84
    v_fma_f32 v83, v79, 4.0, v77
    v_fma_f32 v91, v87, 4.0, v85
    v_add_f32 v77, v80, v81
    v_add_f32 v85, v88, v89
    v_sub_f32 v78, v80, v81
    v_sub_f32 v86, v88, v89
    v_fma_f32 v79, v83, 2.0, v82
    v_fma_f32 v87, v91, 2.0, v90
    v_fma_f32 v82, v83, -2.0, v82
    v_fma_f32 v90, v91, -2.0, v90
    v_fmamk_f32 v80, v76, 0x41700000, v82
    v_fmamk_f32 v88, v84, 0x41700000, v90
    v_fmamk_f32 v80, v81, 0x41200000, v80
    v_fmamk_f32 v88, v89, 0x41200000, v88
    v_cvt_pk_bf16_f32 v20, v77, v85
    v_cvt_pk_bf16_f32 v24, v78, v86
    v_cvt_pk_bf16_f32 v64, v79, v87
    v_cvt_pk_bf16_f32 v68, v82, v90
    v_cvt_pk_bf16_f32 v72, v80, v88
    v_lshlrev_b32 v76, 16, v17
    v_and_b32 v84, s25, v17
    v_lshlrev_b32 v77, 16, v21
    v_and_b32 v85, s25, v21
    v_lshlrev_b32 v78, 16, v25
    v_and_b32 v86, s25, v25
    v_lshlrev_b32 v79, 16, v29
    v_and_b32 v87, s25, v29
    v_add_f32 v80, v76, v78
    v_add_f32 v88, v84, v86
    v_add_f32 v81, v77, v79
    v_add_f32 v89, v85, v87
    v_fma_f32 v82, v78, 4.0, v76
    v_fma_f32 v90, v86, 4.0, v84
    v_fma_f32 v83, v79, 4.0, v77
    v_fma_f32 v91, v87, 4.0, v85
    v_add_f32 v77, v80, v81
    v_add_f32 v85, v88, v89
    v_sub_f32 v78, v80, v81
    v_sub_f32 v86, v88, v89
    v_fma_f32 v79, v83, 2.0, v82
    v_fma_f32 v87, v91, 2.0, v90
    v_fma_f32 v82, v83, -2.0, v82
    v_fma_f32 v90, v91, -2.0, v90
    v_fmamk_f32 v80, v76, 0x41700000, v82
    v_fmamk_f32 v88, v84, 0x41700000, v90
    v_fmamk_f32 v80, v81, 0x41200000, v80
    v_fmamk_f32 v88, v89, 0x41200000, v88
    v_cvt_pk_bf16_f32 v21, v77, v85
    v_cvt_pk_bf16_f32 v25, v78, v86
    v_cvt_pk_bf16_f32 v65, v79, v87
    v_cvt_pk_bf16_f32 v69, v82, v90
    v_cvt_pk_bf16_f32 v73, v80, v88
    buffer_load_dwordx4 v[44:47], v95, s[8:11], s24 offen offset:0
    buffer_load_dwordx4 v[60:63], v95, s[8:11], s24 offen offset:64
    v_add_u32 v95, 128, v95
    v_lshlrev_b32 v76, 16, v18
    v_and_b32 v84, s25, v18
    v_lshlrev_b32 v77, 16, v22
    v_and_b32 v85, s25, v22
    v_lshlrev_b32 v78, 16, v26
    v_and_b32 v86, s25, v26
    v_lshlrev_b32 v79, 16, v30
    v_and_b32 v87, s25, v30
    v_add_f32 v80, v76, v78
    v_add_f32 v88, v84, v86
    v_add_f32 v81, v77, v79
    v_add_f32 v89, v85, v87
    v_fma_f32 v82, v78, 4.0, v76
    v_fma_f32 v90, v86, 4.0, v84
    v_fma_f32 v83, v79, 4.0, v77
    v_fma_f32 v91, v87, 4.0, v85
    v_add_f32 v77, v80, v81
    v_add_f32 v85, v88, v89
    v_sub_f32 v78, v80, v81
    v_sub_f32 v86, v88, v89
    v_fma_f32 v79, v83, 2.0, v82
    v_fma_f32 v87, v91, 2.0, v90
    v_fma_f32 v82, v83, -2.0, v82
    v_fma_f32 v90, v91, -2.0, v90
    v_fmamk_f32 v80, v76, 0x41700000, v82
    v_fmamk_f32 v88, v84, 0x41700000, v90
    v_fmamk_f32 v80, v81, 0x41200000, v80
    v_fmamk_f32 v88, v89, 0x41200000, v88
    v_cvt_pk_bf16_f32 v22, v77, v85
    v_cvt_pk_bf16_f32 v26, v78, v86
    v_cvt_pk_bf16_f32 v66, v79, v87
    v_cvt_pk_bf16_f32 v70, v82, v90
    v_cvt_pk_bf16_f32 v74, v80, v88
    v_lshlrev_b32 v76, 16, v19
    v_and_b32 v84, s25, v19
    v_lshlrev_b32 v77, 16, v23
    v_and_b32 v85, s25, v23
    v_lshlrev_b32 v78, 16, v27
    v_and_b32 v86, s25, v27
    v_lshlrev_b32 v79, 16, v31
    v_and_b32 v87, s25, v31
    v_add_f32 v80, v76, v78
    v_add_f32 v88, v84, v86
    v_add_f32 v81, v77, v79
    v_add_f32 v89, v85, v87
    v_fma_f32 v82, v78, 4.0, v76
    v_fma_f32 v90, v86, 4.0, v84
    v_fma_f32 v83, v79, 4.0, v77
    v_fma_f32 v91, v87, 4.0, v85
    v_add_f32 v77, v80, v81
    v_add_f32 v85, v88, v89
    v_sub_f32 v78, v80, v81
    v_sub_f32 v86, v88, v89
    v_fma_f32 v79, v83, 2.0, v82
    v_fma_f32 v87, v91, 2.0, v90
    v_fma_f32 v82, v83, -2.0, v82
    v_fma_f32 v90, v91, -2.0, v90
    v_fmamk_f32 v80, v76, 0x41700000, v82
    v_fmamk_f32 v88, v84, 0x41700000, v90
    v_fmamk_f32 v80, v81, 0x41200000, v80
    v_fmamk_f32 v88, v89, 0x41200000, v88
    v_cvt_pk_bf16_f32 v23, v77, v85
    v_cvt_pk_bf16_f32 v27, v78, v86
    v_cvt_pk_bf16_f32 v67, v79, v87
    v_cvt_pk_bf16_f32 v71, v82, v90
    v_cvt_pk_bf16_f32 v75, v80, v88
    ds_write_b128 v96, v[64:67] offset:57344
    ds_write_b128 v97, v[68:71] offset:8192
    ds_write_b128 v97, v[72:75] offset:24576
    ds_write_b128 v96, v[16:19] offset:8192
    ds_write_b128 v96, v[20:23] offset:24576
    ds_write_b128 v96, v[24:27] offset:40960
    ds_write_b128 v98, v[28:31] offset:8704
    s_add_u32 s28, s28, 1
    s_waitcnt lgkmcnt(0)
    s_barrier
    s_cmp_lt_u32 s28, 13
    s_cselect_b32 s24, 0, 2130706432
    s_waitcnt vmcnt(0)
    v_lshlrev_b32 v76, 16, v32
    v_and_b32 v84, s25, v32
    v_lshlrev_b32 v77, 16, v36
    v_and_b32 v85, s25, v36
    v_lshlrev_b32 v78, 16, v40
    v_and_b32 v86, s25, v40
    v_lshlrev_b32 v79, 16, v44
    v_and_b32 v87, s25, v44
    v_add_f32 v80, v76, v78
    v_add_f32 v88, v84, v86
    v_add_f32 v81, v77, v79
    v_add_f32 v89, v85, v87
    v_fma_f32 v82, v78, 4.0, v76
    v_fma_f32 v90, v86, 4.0, v84
    v_fma_f32 v83, v79, 4.0, v77
    v_fma_f32 v91, v87, 4.0, v85
    v_add_f32 v77, v80, v81
    v_add_f32 v85, v88, v89
    v_sub_f32 v78, v80, v81
    v_sub_f32 v86, v88, v89
    v_fma_f32 v79, v83, 2.0, v82
    v_fma_f32 v87, v91, 2.0, v90
    v_fma_f32 v82, v83, -2.0, v82
    v_fma_f32 v90, v91, -2.0, v90
    v_fmamk_f32 v80, v76, 0x41700000, v82
    v_fmamk_f32 v88, v84, 0x41700000, v90
    v_fmamk_f32 v80, v81, 0x41200000, v80
    v_fmamk_f32 v88, v89, 0x41200000, v88
    v_cvt_pk_bf16_f32 v36, v77, v85
    v_cvt_pk_bf16_f32 v40, v78, v86
    v_cvt_pk_bf16_f32 v64, v79, v87
    v_cvt_pk_bf16_f32 v68, v82, v90
    v_cvt_pk_bf16_f32 v72, v80, v88
    v_lshlrev_b32 v76, 16, v33
    v_and_b32 v84, s25, v33
    v_lshlrev_b32 v77, 16, v37
    v_and_b32 v85, s25, v37
    v_lshlrev_b32 v78, 16, v41
    v_and_b32 v86, s25, v41
    buffer_load_dwordx4 v[0:3], v92, s[8:11], s24 offen offset:0
    buffer_load_dwordx4 v[16:19], v92, s[8:11], s24 offen offset:64
    v_add_u32 v92, 128, v92
    v_lshlrev_b32 v79, 16, v45
    v_and_b32 v87, s25, v45
    v_add_f32 v80, v76, v78
    v_add_f32 v88, v84, v86
    v_add_f32 v81, v77, v79
    v_add_f32 v89, v85, v87
    v_fma_f32 v82, v78, 4.0, v76
    v_fma_f32 v90, v86, 4.0, v84
    v_fma_f32 v83, v79, 4.0, v77
    v_fma_f32 v91, v87, 4.0, v85
    v_add_f32 v77, v80, v81
    v_add_f32 v85, v88, v89
    v_sub_f32 v78, v80, v81
    v_sub_f32 v86, v88, v89
    v_fma_f32 v79, v83, 2.0, v82
    v_fma_f32 v87, v91, 2.0, v90
    v_fma_f32 v82, v83, -2.0, v82
    v_fma_f32 v90, v91, -2.0, v90
    v_fmamk_f32 v80, v76, 0x41700000, v82
    v_fmamk_f32 v88, v84, 0x41700000, v90
    v_fmamk_f32 v80, v81, 0x41200000, v80
    v_fmamk_f32 v88, v89, 0x41200000, v88
    v_cvt_pk_bf16_f32 v37, v77, v85
    v_cvt_pk_bf16_f32 v41, v78, v86
    v_cvt_pk_bf16_f32 v65, v79, v87
    v_cvt_pk_bf16_f32 v69, v82, v90
    v_cvt_pk_bf16_f32 v73, v80, v88
    v_lshlrev_b32 v76, 16, v34
    v_and_b32 v84, s25, v34
    v_lshlrev_b32 v77, 16, v38
    v_and_b32 v85, s25, v38
    v_lshlrev_b32 v78, 16, v42
    v_and_b32 v86, s25, v42
    v_lshlrev_b32 v79, 16, v46
    v_and_b32 v87, s25, v46
    v_add_f32 v80, v76, v78
    v_add_f32 v88, v84, v86
    v_add_f32 v81, v77, v79
    v_add_f32 v89, v85, v87
    v_fma_f32 v82, v78, 4.0, v76
    v_fma_f32 v90, v86, 4.0, v84
    v_fma_f32 v83, v79, 4.0, v77
    v_fma_f32 v91, v87, 4.0, v85
    v_add_f32 v77, v80, v81
    v_add_f32 v85, v88, v89
    v_sub_f32 v78, v80, v81
    v_sub_f32 v86, v88, v89
    v_fma_f32 v79, v83, 2.0, v82
    v_fma_f32 v87, v91, 2.0, v90
    v_fma_f32 v82, v83, -2.0, v82
    v_fma_f32 v90, v91, -2.0, v90
    v_fmamk_f32 v80, v76, 0x41700000, v82
    v_fmamk_f32 v88, v84, 0x41700000, v90
    buffer_load_dwordx4 v[4:7], v93, s[8:11], s24 offen offset:0
    buffer_load_dwordx4 v[20:23], v93, s[8:11], s24 offen offset:64
    v_add_u32 v93, 128, v93
    v_fmamk_f32 v80, v81, 0x41200000, v80
    v_fmamk_f32 v88, v89, 0x41200000, v88
    v_cvt_pk_bf16_f32 v38, v77, v85
    v_cvt_pk_bf16_f32 v42, v78, v86
    v_cvt_pk_bf16_f32 v66, v79, v87
    v_cvt_pk_bf16_f32 v70, v82, v90
    v_cvt_pk_bf16_f32 v74, v80, v88
    v_lshlrev_b32 v76, 16, v35
    v_and_b32 v84, s25, v35
    v_lshlrev_b32 v77, 16, v39
    v_and_b32 v85, s25, v39
    v_lshlrev_b32 v78, 16, v43
    v_and_b32 v86, s25, v43
    v_lshlrev_b32 v79, 16, v47
    v_and_b32 v87, s25, v47
    v_add_f32 v80, v76, v78
    v_add_f32 v88, v84, v86
    v_add_f32 v81, v77, v79
    v_add_f32 v89, v85, v87
    v_fma_f32 v82, v78, 4.0, v76
    v_fma_f32 v90, v86, 4.0, v84
    v_fma_f32 v83, v79, 4.0, v77
    v_fma_f32 v91, v87, 4.0, v85
    v_add_f32 v77, v80, v81
    v_add_f32 v85, v88, v89
    v_sub_f32 v78, v80, v81
    v_sub_f32 v86, v88, v89
    v_fma_f32 v79, v83, 2.0, v82
    v_fma_f32 v87, v91, 2.0, v90
    v_fma_f32 v82, v83, -2.0, v82
    v_fma_f32 v90, v91, -2.0, v90
    v_fmamk_f32 v80, v76, 0x41700000, v82
    v_fmamk_f32 v88, v84, 0x41700000, v90
    v_fmamk_f32 v80, v81, 0x41200000, v80
    v_fmamk_f32 v88, v89, 0x41200000, v88
    v_cvt_pk_bf16_f32 v39, v77, v85
    v_cvt_pk_bf16_f32 v43, v78, v86
    v_cvt_pk_bf16_f32 v67, v79, v87
    v_cvt_pk_bf16_f32 v71, v82, v90
    v_cvt_pk_bf16_f32 v75, v80, v88
    ds_write_b128 v96, v[64:67] offset:49152
    ds_write_b128 v97, v[68:71] offset:0
    ds_write_b128 v97, v[72:75] offset:16384
    ds_write_b128 v96, v[32:35] offset:0
    ds_write_b128 v96, v[36:39] offset:16384
    ds_write_b128 v96, v[40:43] offset:32768
    ds_write_b128 v98, v[44:47] offset:0
    s_add_u32 s28, s28, 1
    s_waitcnt lgkmcnt(0)
    s_barrier
    s_cmp_lt_u32 s28, 13
    s_cselect_b32 s24, 0, 2130706432
    v_lshlrev_b32 v76, 16, v48
    v_and_b32 v84, s25, v48
    v_lshlrev_b32 v77, 16, v52
    v_and_b32 v85, s25, v52
    v_lshlrev_b32 v78, 16, v56
    v_and_b32 v86, s25, v56
    v_lshlrev_b32 v79, 16, v60
    v_and_b32 v87, s25, v60
    v_add_f32 v80, v76, v78
    v_add_f32 v88, v84, v86
    v_add_f32 v81, v77, v79
    v_add_f32 v89, v85, v87
    v_fma_f32 v82, v78, 4.0, v76
    buffer_load_dwordx4 v[8:11], v94, s[8:11], s24 offen offset:0
    buffer_load_dwordx4 v[24:27], v94, s[8:11], s24 offen offset:64
    v_add_u32 v94, 128, v94
    v_fma_f32 v90, v86, 4.0, v84
    v_fma_f32 v83, v79, 4.0, v77
    v_fma_f32 v91, v87, 4.0, v85
    v_add_f32 v77, v80, v81
    v_add_f32 v85, v88, v89
    v_sub_f32 v78, v80, v81
    v_sub_f32 v86, v88, v89
    v_fma_f32 v79, v83, 2.0, v82
    v_fma_f32 v87, v91, 2.0, v90
    v_fma_f32 v82, v83, -2.0, v82
    v_fma_f32 v90, v91, -2.0, v90
    v_fmamk_f32 v80, v76, 0x41700000, v82
    v_fmamk_f32 v88, v84, 0x41700000, v90
    v_fmamk_f32 v80, v81, 0x41200000, v80
    v_fmamk_f32 v88, v89, 0x41200000, v88
    v_cvt_pk_bf16_f32 v52, v77, v85
    v_cvt_pk_bf16_f32 v56, v78, v86
    v_cvt_pk_bf16_f32 v64, v79, v87
    v_cvt_pk_bf16_f32 v68, v82, v90
    v_cvt_pk_bf16_f32 v72, v80, v88
    v_lshlrev_b32 v76, 16, v49
    v_and_b32 v84, s25, v49
    v_lshlrev_b32 v77, 16, v53
    v_and_b32 v85, s25, v53
    v_lshlrev_b32 v78, 16, v57
    v_and_b32 v86, s25, v57
    v_lshlrev_b32 v79, 16, v61
    v_and_b32 v87, s25, v61
    v_add_f32 v80, v76, v78
    v_add_f32 v88, v84, v86
    v_add_f32 v81, v77, v79
    v_add_f32 v89, v85, v87
    v_fma_f32 v82, v78, 4.0, v76
    v_fma_f32 v90, v86, 4.0, v84
    v_fma_f32 v83, v79, 4.0, v77
    v_fma_f32 v91, v87, 4.0, v85
    v_add_f32 v77, v80, v81
    v_add_f32 v85, v88, v89
    v_sub_f32 v78, v80, v81
    v_sub_f32 v86, v88, v89
    v_fma_f32 v79, v83, 2.0, v82
    v_fma_f32 v87, v91, 2.0, v90
    v_fma_f32 v82, v83, -2.0, v82
    v_fma_f32 v90, v91, -2.0, v90
    v_fmamk_f32 v80, v76, 0x41700000, v82
    v_fmamk_f32 v88, v84, 0x41700000, v90
    v_fmamk_f32 v80, v81, 0x41200000, v80
    v_fmamk_f32 v88, v89, 0x41200000, v88
    v_cvt_pk_bf16_f32 v53, v77, v85
    v_cvt_pk_bf16_f32 v57, v78, v86
    v_cvt_pk_bf16_f32 v65, v79, v87
    v_cvt_pk_bf16_f32 v69, v82, v90
    v_cvt_pk_bf16_f32 v73, v80, v88
    buffer_load_dwordx4 v[12:15], v95, s[8:11], s24 offen offset:0
    buffer_load_dwordx4 v[28:31], v95, s[8:11], s24 offen offset:64
    v_add_u32 v95, 128, v95
    v_lshlrev_b32 v76, 16, v50
    v_and_b32 v84, s25, v50
    v_lshlrev_b32 v77, 16, v54
    v_and_b32 v85, s25, v54
    v_lshlrev_b32 v78, 16, v58
    v_and_b32 v86, s25, v58
    v_lshlrev_b32 v79, 16, v62
    v_and_b32 v87, s25, v62
    v_add_f32 v80, v76, v78
    v_add_f32 v88, v84, v86
    v_add_f32 v81, v77, v79
    v_add_f32 v89, v85, v87
    v_fma_f32 v82, v78, 4.0, v76
    v_fma_f32 v90, v86, 4.0, v84
    v_fma_f32 v83, v79, 4.0, v77
    v_fma_f32 v91, v87, 4.0, v85
    v_add_f32 v77, v80, v81
    v_add_f32 v85, v88, v89
    v_sub_f32 v78, v80, v81
    v_sub_f32 v86, v88, v89
    v_fma_f32 v79, v83, 2.0, v82
    v_fma_f32 v87, v91, 2.0, v90
    v_fma_f32 v82, v83, -2.0, v82
    v_fma_f32 v90, v91, -2.0, v90
    v_fmamk_f32 v80, v76, 0x41700000, v82
    v_fmamk_f32 v88, v84, 0x41700000, v90
    v_fmamk_f32 v80, v81, 0x41200000, v80
    v_fmamk_f32 v88, v89, 0x41200000, v88
    v_cvt_pk_bf16_f32 v54, v77, v85
    v_cvt_pk_bf16_f32 v58, v78, v86
    v_cvt_pk_bf16_f32 v66, v79, v87
    v_cvt_pk_bf16_f32 v70, v82, v90
    v_cvt_pk_bf16_f32 v74, v80, v88
    v_lshlrev_b32 v76, 16, v51
    v_and_b32 v84, s25, v51
    v_lshlrev_b32 v77, 16, v55
    v_and_b32 v85, s25, v55
    v_lshlrev_b32 v78, 16, v59
    v_and_b32 v86, s25, v59
    v_lshlrev_b32 v79, 16, v63
    v_and_b32 v87, s25, v63
    v_add_f32 v80, v76, v78
    v_add_f32 v88, v84, v86
    v_add_f32 v81, v77, v79
    v_add_f32 v89, v85, v87
    v_fma_f32 v82, v78, 4.0, v76
    v_fma_f32 v90, v86, 4.0, v84
    v_fma_f32 v83, v79, 4.0, v77
    v_fma_f32 v91, v87, 4.0, v85
    v_add_f32 v77, v80, v81
    v_add_f32 v85, v88, v89
    v_sub_f32 v78, v80, v81
    v_sub_f32 v86, v88, v89
    v_fma_f32 v79, v83, 2.0, v82
    v_fma_f32 v87, v91, 2.0, v90
    v_fma_f32 v82, v83, -2.0, v82
    v_fma_f32 v90, v91, -2.0, v90
    v_fmamk_f32 v80, v76, 0x41700000, v82
    v_fmamk_f32 v88, v84, 0x41700000, v90
    v_fmamk_f32 v80, v81, 0x41200000, v80
    v_fmamk_f32 v88, v89, 0x41200000, v88
    v_cvt_pk_bf16_f32 v55, v77, v85
    v_cvt_pk_bf16_f32 v59, v78, v86
    v_cvt_pk_bf16_f32 v67, v79, v87
    v_cvt_pk_bf16_f32 v71, v82, v90
    v_cvt_pk_bf16_f32 v75, v80, v88
    ds_write_b128 v96, v[64:67] offset:57344
    ds_write_b128 v97, v[68:71] offset:8192
    ds_write_b128 v97, v[72:75] offset:24576
    ds_write_b128 v96, v[48:51] offset:8192
    ds_write_b128 v96, v[52:55] offset:24576
    ds_write_b128 v96, v[56:59] offset:40960
    ds_write_b128 v98, v[60:63] offset:8704
    s_add_u32 s28, s28, 1
    s_waitcnt lgkmcnt(0)
    s_barrier
    s_cmp_eq_u32 s22, 1
    s_cbranch_scc1 L_conv1_kernel_hlast1
    s_cmp_lt_u32 s28, 13
    s_cselect_b32 s24, 0, 2130706432
    s_waitcnt vmcnt(0)
    v_lshlrev_b32 v76, 16, v0
    v_and_b32 v84, s25, v0
    v_lshlrev_b32 v77, 16, v4
    v_and_b32 v85, s25, v4
    v_lshlrev_b32 v78, 16, v8
    v_and_b32 v86, s25, v8
    v_lshlrev_b32 v79, 16, v12
    v_and_b32 v87, s25, v12
    v_add_f32 v80, v76, v78
    v_add_f32 v88, v84, v86
    v_add_f32 v81, v77, v79
    v_add_f32 v89, v85, v87
    v_fma_f32 v82, v78, 4.0, v76
    v_fma_f32 v90, v86, 4.0, v84
    v_fma_f32 v83, v79, 4.0, v77
    v_fma_f32 v91, v87, 4.0, v85
    v_add_f32 v77, v80, v81
    v_add_f32 v85, v88, v89
    v_sub_f32 v78, v80, v81
    v_sub_f32 v86, v88, v89
    v_fma_f32 v79, v83, 2.0, v82
    v_fma_f32 v87, v91, 2.0, v90
    v_fma_f32 v82, v83, -2.0, v82
    v_fma_f32 v90, v91, -2.0, v90
    v_fmamk_f32 v80, v76, 0x41700000, v82
    v_fmamk_f32 v88, v84, 0x41700000, v90
    v_fmamk_f32 v80, v81, 0x41200000, v80
    v_fmamk_f32 v88, v89, 0x41200000, v88
    v_cvt_pk_bf16_f32 v4, v77, v85
    v_cvt_pk_bf16_f32 v8, v78, v86
    v_cvt_pk_bf16_f32 v64, v79, v87
    v_cvt_pk_bf16_f32 v68, v82, v90
    v_cvt_pk_bf16_f32 v72, v80, v88
    v_lshlrev_b32 v76, 16, v1
    v_and_b32 v84, s25, v1
    v_lshlrev_b32 v77, 16, v5
    v_and_b32 v85, s25, v5
    v_lshlrev_b32 v78, 16, v9
    v_and_b32 v86, s25, v9
    buffer_load_dwordx4 v[32:35], v92, s[8:11], s24 offen offset:0
    buffer_load_dwordx4 v[48:51], v92, s[8:11], s24 offen offset:64
    v_add_u32 v92, 128, v92
    v_lshlrev_b32 v79, 16, v13
    v_and_b32 v87, s25, v13
    v_add_f32 v80, v76, v78
    v_add_f32 v88, v84, v86
    v_add_f32 v81, v77, v79
    v_add_f32 v89, v85, v87
    v_fma_f32 v82, v78, 4.0, v76
    v_fma_f32 v90, v86, 4.0, v84
    v_fma_f32 v83, v79, 4.0, v77
    v_fma_f32 v91, v87, 4.0, v85
    v_add_f32 v77, v80, v81
    v_add_f32 v85, v88, v89
    v_sub_f32 v78, v80, v81
    v_sub_f32 v86, v88, v89
    v_fma_f32 v79, v83, 2.0, v82
    v_fma_f32 v87, v91, 2.0, v90
    v_fma_f32 v82, v83, -2.0, v82
    v_fma_f32 v90, v91, -2.0, v90
    v_fmamk_f32 v80, v76, 0x41700000, v82
    v_fmamk_f32 v88, v84, 0x41700000, v90
    v_fmamk_f32 v80, v81, 0x41200000, v80
    v_fmamk_f32 v88, v89, 0x41200000, v88
    v_cvt_pk_bf16_f32 v5, v77, v85
    v_cvt_pk_bf16_f32 v9, v78, v86
    v_cvt_pk_bf16_f32 v65, v79, v87
    v_cvt_pk_bf16_f32 v69, v82, v90
    v_cvt_pk_bf16_f32 v73, v80, v88
    v_lshlrev_b32 v76, 16, v2
    v_and_b32 v84, s25, v2
    v_lshlrev_b32 v77, 16, v6
    v_and_b32 v85, s25, v6
    v_lshlrev_b32 v78, 16, v10
    v_and_b32 v86, s25, v10
    v_lshlrev_b32 v79, 16, v14
    v_and_b32 v87, s25, v14
    v_add_f32 v80, v76, v78
    v_add_f32 v88, v84, v86
    v_add_f32 v81, v77, v79
    v_add_f32 v89, v85, v87
    v_fma_f32 v82, v78, 4.0, v76
    v_fma_f32 v90, v86, 4.0, v84
    v_fma_f32 v83, v79, 4.0, v77
    v_fma_f32 v91, v87, 4.0, v85
    v_add_f32 v77, v80, v81
    v_add_f32 v85, v88, v89
    v_sub_f32 v78, v80, v81
    v_sub_f32 v86, v88, v89
    v_fma_f32 v79, v83, 2.0, v82
    v_fma_f32 v87, v91, 2.0, v90
    v_fma_f32 v82, v83, -2.0, v82
    v_fma_f32 v90, v91, -2.0, v90
    v_fmamk_f32 v80, v76, 0x41700000, v82
    v_fmamk_f32 v88, v84, 0x41700000, v90
    buffer_load_dwordx4 v[36:39], v93, s[8:11], s24 offen offset:0
    buffer_load_dwordx4 v[52:55], v93, s[8:11], s24 offen offset:64
    v_add_u32 v93, 128, v93
    v_fmamk_f32 v80, v81, 0x41200000, v80
    v_fmamk_f32 v88, v89, 0x41200000, v88
    v_cvt_pk_bf16_f32 v6, v77, v85
    v_cvt_pk_bf16_f32 v10, v78, v86
    v_cvt_pk_bf16_f32 v66, v79, v87
    v_cvt_pk_bf16_f32 v70, v82, v90
    v_cvt_pk_bf16_f32 v74, v80, v88
    v_lshlrev_b32 v76, 16, v3
    v_and_b32 v84, s25, v3
    v_lshlrev_b32 v77, 16, v7
    v_and_b32 v85, s25, v7
    v_lshlrev_b32 v78, 16, v11
    v_and_b32 v86, s25, v11
    v_lshlrev_b32 v79, 16, v15
    v_and_b32 v87, s25, v15
    v_add_f32 v80, v76, v78
    v_add_f32 v88, v84, v86
    v_add_f32 v81, v77, v79
    v_add_f32 v89, v85, v87
    v_fma_f32 v82, v78, 4.0, v76
    v_fma_f32 v90, v86, 4.0, v84
    v_fma_f32 v83, v79, 4.0, v77
    v_fma_f32 v91, v87, 4.0, v85
    v_add_f32 v77, v80, v81
    v_add_f32 v85, v88, v89
    v_sub_f32 v78, v80, v81
    v_sub_f32 v86, v88, v89
    v_fma_f32 v79, v83, 2.0, v82
    v_fma_f32 v87, v91, 2.0, v90
    v_fma_f32 v82, v83, -2.0, v82
    v_fma_f32 v90, v91, -2.0, v90
    v_fmamk_f32 v80, v76, 0x41700000, v82
    v_fmamk_f32 v88, v84, 0x41700000, v90
    v_fmamk_f32 v80, v81, 0x41200000, v80
    v_fmamk_f32 v88, v89, 0x41200000, v88
    v_cvt_pk_bf16_f32 v7, v77, v85
    v_cvt_pk_bf16_f32 v11, v78, v86
    v_cvt_pk_bf16_f32 v67, v79, v87
    v_cvt_pk_bf16_f32 v71, v82, v90
    v_cvt_pk_bf16_f32 v75, v80, v88
    ds_write_b128 v96, v[64:67] offset:49152
    ds_write_b128 v97, v[68:71] offset:0
    ds_write_b128 v97, v[72:75] offset:16384
    ds_write_b128 v96, v[0:3] offset:0
    ds_write_b128 v96, v[4:7] offset:16384
    ds_write_b128 v96, v[8:11] offset:32768
    ds_write_b128 v98, v[12:15] offset:0
    s_add_u32 s28, s28, 1
    s_waitcnt lgkmcnt(0)
    s_barrier
    s_sub_u32 s22, s22, 1
    s_branch L_conv1_kernel_hloop1
L_conv1_kernel_hlast1:
    s_branch L_conv1_kernel_end
L_conv1_kernel_h2:
    s_load_dwordx2 s[48:49], s[0:1], 16
    ds_write_b128 v96, v[0:3] offset:0
    ds_write_b128 v98, v[12:15] offset:0
    v_lshlrev_b32 v76, 16, v0
    v_and_b32 v84, s25, v0
    v_lshlrev_b32 v77, 16, v4
    v_and_b32 v85, s25, v4
    v_lshlrev_b32 v78, 16, v8
    v_and_b32 v86, s25, v8
    v_lshlrev_b32 v79, 16, v12
    v_and_b32 v87, s25, v12
    v_add_f32 v80, v76, v78
    v_add_f32 v88, v84, v86
    v_add_f32 v81, v77, v79
    v_add_f32 v89, v85, v87
    v_fma_f32 v82, v78, 4.0, v76
    v_fma_f32 v90, v86, 4.0, v84
    v_fma_f32 v83, v79, 4.0, v77
    v_fma_f32 v91, v87, 4.0, v85
    v_add_f32 v77, v80, v81
    v_add_f32 v85, v88, v89
    v_sub_f32 v78, v80, v81
    v_sub_f32 v86, v88, v89
    v_fma_f32 v79, v83, 2.0, v82
    v_fma_f32 v87, v91, 2.0, v90
    v_fma_f32 v82, v83, -2.0, v82
    v_fma_f32 v90, v91, -2.0, v90
    v_fmamk_f32 v80, v76, 0x41700000, v82
    v_fmamk_f32 v88, v84, 0x41700000, v90
    v_fmamk_f32 v80, v81, 0x41200000, v80
    v_fmamk_f32 v88, v89, 0x41200000, v88
    v_cvt_pk_bf16_f32 v4, v77, v85
    v_cvt_pk_bf16_f32 v8, v78, v86
    v_cvt_pk_bf16_f32 v64, v79, v87
    v_cvt_pk_bf16_f32 v68, v82, v90
    v_cvt_pk_bf16_f32 v72, v80, v88
    v_lshlrev_b32 v76, 16, v1
    v_and_b32 v84, s25, v1
    v_lshlrev_b32 v77, 16, v5
    v_and_b32 v85, s25, v5
    v_lshlrev_b32 v78, 16, v9
    v_and_b32 v86, s25, v9
    v_lshlrev_b32 v79, 16, v13
    v_and_b32 v87, s25, v13
    v_add_f32 v80, v76, v78
    v_add_f32 v88, v84, v86
    v_add_f32 v81, v77, v79
    v_add_f32 v89, v85, v87
    v_fma_f32 v82, v78, 4.0, v76
    v_fma_f32 v90, v86, 4.0, v84
    v_fma_f32 v83, v79, 4.0, v77
    v_fma_f32 v91, v87, 4.0, v85
    v_add_f32 v77, v80, v81
    v_add_f32 v85, v88, v89
    v_sub_f32 v78, v80, v81
    v_sub_f32 v86, v88, v89
    v_fma_f32 v79, v83, 2.0, v82
    v_fma_f32 v87, v91, 2.0, v90
    v_fma_f32 v82, v83, -2.0, v82
    v_fma_f32 v90, v91, -2.0, v90
    v_fmamk_f32 v80, v76, 0x41700000, v82
    v_fmamk_f32 v88, v84, 0x41700000, v90
    v_fmamk_f32 v80, v81, 0x41200000, v80
    v_fmamk_f32 v88, v89, 0x41200000, v88
    v_cvt_pk_bf16_f32 v5, v77, v85
    v_cvt_pk_bf16_f32 v9, v78, v86
    v_cvt_pk_bf16_f32 v65, v79, v87
    v_cvt_pk_bf16_f32 v69, v82, v90
    v_cvt_pk_bf16_f32 v73, v80, v88
    v_lshlrev_b32 v76, 16, v2
    v_and_b32 v84, s25, v2
    v_lshlrev_b32 v77, 16, v6
    v_and_b32 v85, s25, v6
    v_lshlrev_b32 v78, 16, v10
    v_and_b32 v86, s25, v10
    v_lshlrev_b32 v79, 16, v14
    v_and_b32 v87, s25, v14
    v_add_f32 v80, v76, v78
    v_add_f32 v88, v84, v86
    v_add_f32 v81, v77, v79
    v_add_f32 v89, v85, v87
    v_fma_f32 v82, v78, 4.0, v76
    v_fma_f32 v90, v86, 4.0, v84
    v_fma_f32 v83, v79, 4.0, v77
    v_fma_f32 v91, v87, 4.0, v85
    v_add_f32 v77, v80, v81
    v_add_f32 v85, v88, v89
    v_sub_f32 v78, v80, v81
    v_sub_f32 v86, v88, v89
    v_fma_f32 v79, v83, 2.0, v82
    v_fma_f32 v87, v91, 2.0, v90
    v_fma_f32 v82, v83, -2.0, v82
    v_fma_f32 v90, v91, -2.0, v90
    v_fmamk_f32 v80, v76, 0x41700000, v82
    v_fmamk_f32 v88, v84, 0x41700000, v90
    v_fmamk_f32 v80, v81, 0x41200000, v80
    v_fmamk_f32 v88, v89, 0x41200000, v88
    v_cvt_pk_bf16_f32 v6, v77, v85
    v_cvt_pk_bf16_f32 v10, v78, v86
    v_cvt_pk_bf16_f32 v66, v79, v87
    v_cvt_pk_bf16_f32 v70, v82, v90
    v_cvt_pk_bf16_f32 v74, v80, v88
    v_lshlrev_b32 v76, 16, v3
    v_and_b32 v84, s25, v3
    v_lshlrev_b32 v77, 16, v7
    v_and_b32 v85, s25, v7
    v_lshlrev_b32 v78, 16, v11
    v_and_b32 v86, s25, v11
    v_lshlrev_b32 v79, 16, v15
    v_and_b32 v87, s25, v15
    v_add_f32 v80, v76, v78
    v_add_f32 v88, v84, v86
    v_add_f32 v81, v77, v79
    v_add_f32 v89, v85, v87
    v_fma_f32 v82, v78, 4.0, v76
    v_fma_f32 v90, v86, 4.0, v84
    v_fma_f32 v83, v79, 4.0, v77
    v_fma_f32 v91, v87, 4.0, v85
    v_add_f32 v77, v80, v81
    v_add_f32 v85, v88, v89
    v_sub_f32 v78, v80, v81
    v_sub_f32 v86, v88, v89
    v_fma_f32 v79, v83, 2.0, v82
    v_fma_f32 v87, v91, 2.0, v90
    v_fma_f32 v82, v83, -2.0, v82
    v_fma_f32 v90, v91, -2.0, v90
    v_fmamk_f32 v80, v76, 0x41700000, v82
    v_fmamk_f32 v88, v84, 0x41700000, v90
    v_fmamk_f32 v80, v81, 0x41200000, v80
    v_fmamk_f32 v88, v89, 0x41200000, v88
    v_cvt_pk_bf16_f32 v7, v77, v85
    v_cvt_pk_bf16_f32 v11, v78, v86
    v_cvt_pk_bf16_f32 v67, v79, v87
    v_cvt_pk_bf16_f32 v71, v82, v90
    v_cvt_pk_bf16_f32 v75, v80, v88
    ds_write_b128 v96, v[64:67] offset:49152
    ds_write_b128 v97, v[68:71] offset:0
    ds_write_b128 v97, v[72:75] offset:16384
    ds_write_b128 v96, v[4:7] offset:16384
    ds_write_b128 v96, v[8:11] offset:32768
    s_waitcnt vmcnt(0)
    s_waitcnt lgkmcnt(0)
    s_barrier
    buffer_load_dwordx4 v[32:35], v92, s[8:11], s24 offen offset:0
    buffer_load_dwordx4 v[48:51], v92, s[8:11], s24 offen offset:64
    v_add_u32 v92, 128, v92
    buffer_load_dwordx4 v[36:39], v93, s[8:11], s24 offen offset:0
    buffer_load_dwordx4 v[52:55], v93, s[8:11], s24 offen offset:64
    v_add_u32 v93, 128, v93
    buffer_load_dwordx4 v[40:43], v94, s[8:11], s24 offen offset:0
    buffer_load_dwordx4 v[56:59], v94, s[8:11], s24 offen offset:64
    v_add_u32 v94, 128, v94
    buffer_load_dwordx4 v[44:47], v95, s[8:11], s24 offen offset:0
    buffer_load_dwordx4 v[60:63], v95, s[8:11], s24 offen offset:64
    v_add_u32 v95, 128, v95
    s_setprio 0
    v_lshlrev_b32 v76, 16, v16
    v_and_b32 v84, s25, v16
    v_lshlrev_b32 v77, 16, v20
    v_and_b32 v85, s25, v20
    v_lshlrev_b32 v78, 16, v24
    v_and_b32 v86, s25, v24
    v_lshlrev_b32 v79, 16, v28
    v_and_b32 v87, s25, v28
    v_add_f32 v80, v76, v78
    v_add_f32 v88, v84, v86
    v_add_f32 v81, v77, v79
    v_add_f32 v89, v85, v87
    v_fma_f32 v82, v78, 4.0, v76
    v_fma_f32 v90, v86, 4.0, v84
    v_fma_f32 v83, v79, 4.0, v77
    v_fma_f32 v91, v87, 4.0, v85
    v_add_f32 v77, v80, v81
    v_add_f32 v85, v88, v89
    v_sub_f32 v78, v80, v81
    v_sub_f32 v86, v88, v89
    v_fma_f32 v79, v83, 2.0, v82
    v_fma_f32 v87, v91, 2.0, v90
    v_fma_f32 v82, v83, -2.0, v82
    v_fma_f32 v90, v91, -2.0, v90
    v_fmamk_f32 v80, v76, 0x41700000, v82
    v_fmamk_f32 v88, v84, 0x41700000, v90
    v_fmamk_f32 v80, v81, 0x41200000, v80
    v_fmamk_f32 v88, v89, 0x41200000, v88
    v_cvt_pk_bf16_f32 v20, v77, v85
    v_cvt_pk_bf16_f32 v24, v78, v86
    v_cvt_pk_bf16_f32 v64, v79, v87
    v_cvt_pk_bf16_f32 v68, v82, v90
    v_cvt_pk_bf16_f32 v72, v80, v88
    v_lshlrev_b32 v76, 16, v17
    v_and_b32 v84, s25, v17
    v_lshlrev_b32 v77, 16, v21
    v_and_b32 v85, s25, v21
    v_lshlrev_b32 v78, 16, v25
    v_and_b32 v86, s25, v25
    v_lshlrev_b32 v79, 16, v29
    v_and_b32 v87, s25, v29
    v_add_f32 v80, v76, v78
    v_add_f32 v88, v84, v86
    v_add_f32 v81, v77, v79
    v_add_f32 v89, v85, v87
    v_fma_f32 v82, v78, 4.0, v76
    v_fma_f32 v90, v86, 4.0, v84
    v_fma_f32 v83, v79, 4.0, v77
    v_fma_f32 v91, v87, 4.0, v85
    v_add_f32 v77, v80, v81
    v_add_f32 v85, v88, v89
    v_sub_f32 v78, v80, v81
    v_sub_f32 v86, v88, v89
    v_fma_f32 v79, v83, 2.0, v82
    v_fma_f32 v87, v91, 2.0, v90
    v_fma_f32 v82, v83, -2.0, v82
    v_fma_f32 v90, v91, -2.0, v90
    v_fmamk_f32 v80, v76, 0x41700000, v82
    v_fmamk_f32 v88, v84, 0x41700000, v90
    v_fmamk_f32 v80, v81, 0x41200000, v80
    v_fmamk_f32 v88, v89, 0x41200000, v88
    v_cvt_pk_bf16_f32 v21, v77, v85
    v_cvt_pk_bf16_f32 v25, v78, v86
    v_cvt_pk_bf16_f32 v65, v79, v87
    v_cvt_pk_bf16_f32 v69, v82, v90
    v_cvt_pk_bf16_f32 v73, v80, v88
    v_lshlrev_b32 v76, 16, v18
    v_and_b32 v84, s25, v18
    v_lshlrev_b32 v77, 16, v22
    v_and_b32 v85, s25, v22
    v_lshlrev_b32 v78, 16, v26
    v_and_b32 v86, s25, v26
    v_lshlrev_b32 v79, 16, v30
    v_and_b32 v87, s25, v30
    v_add_f32 v80, v76, v78
    v_add_f32 v88, v84, v86
    v_add_f32 v81, v77, v79
    v_add_f32 v89, v85, v87
    v_fma_f32 v82, v78, 4.0, v76
    v_fma_f32 v90, v86, 4.0, v84
    v_fma_f32 v83, v79, 4.0, v77
    v_fma_f32 v91, v87, 4.0, v85
    v_add_f32 v77, v80, v81
    v_add_f32 v85, v88, v89
    v_sub_f32 v78, v80, v81
    v_sub_f32 v86, v88, v89
    v_fma_f32 v79, v83, 2.0, v82
    v_fma_f32 v87, v91, 2.0, v90
    v_fma_f32 v82, v83, -2.0, v82
    v_fma_f32 v90, v91, -2.0, v90
    v_fmamk_f32 v80, v76, 0x41700000, v82
    v_fmamk_f32 v88, v84, 0x41700000, v90
    v_fmamk_f32 v80, v81, 0x41200000, v80
    v_fmamk_f32 v88, v89, 0x41200000, v88
    v_cvt_pk_bf16_f32 v22, v77, v85
    v_cvt_pk_bf16_f32 v26, v78, v86
    v_cvt_pk_bf16_f32 v66, v79, v87
    v_cvt_pk_bf16_f32 v70, v82, v90
    v_cvt_pk_bf16_f32 v74, v80, v88
    v_lshlrev_b32 v76, 16, v19
    v_and_b32 v84, s25, v19
    v_lshlrev_b32 v77, 16, v23
    v_and_b32 v85, s25, v23
    v_lshlrev_b32 v78, 16, v27
    v_and_b32 v86, s25, v27
    v_lshlrev_b32 v79, 16, v31
    v_and_b32 v87, s25, v31
    v_add_f32 v80, v76, v78
    v_add_f32 v88, v84, v86
    v_add_f32 v81, v77, v79
    v_add_f32 v89, v85, v87
    v_fma_f32 v82, v78, 4.0, v76
    v_fma_f32 v90, v86, 4.0, v84
    v_fma_f32 v83, v79, 4.0, v77
    v_fma_f32 v91, v87, 4.0, v85
    v_add_f32 v77, v80, v81
    v_add_f32 v85, v88, v89
    v_sub_f32 v78, v80, v81
    v_sub_f32 v86, v88, v89
    v_fma_f32 v79, v83, 2.0, v82
    v_fma_f32 v87, v91, 2.0, v90
    v_fma_f32 v82, v83, -2.0, v82
    v_fma_f32 v90, v91, -2.0, v90
    v_fmamk_f32 v80, v76, 0x41700000, v82
    v_fmamk_f32 v88, v84, 0x41700000, v90
    v_fmamk_f32 v80, v81, 0x41200000, v80
    v_fmamk_f32 v88, v89, 0x41200000, v88
    v_cvt_pk_bf16_f32 v23, v77, v85
    v_cvt_pk_bf16_f32 v27, v78, v86
    v_cvt_pk_bf16_f32 v67, v79, v87
    v_cvt_pk_bf16_f32 v71, v82, v90
    v_cvt_pk_bf16_f32 v75, v80, v88
L_conv1_kernel_hloop2:
    s_cmp_lt_u32 s28, 12
    s_cselect_b32 s24, 0, 2130706432
    ds_write_b128 v96, v[64:67] offset:57344
    ds_write_b128 v97, v[68:71] offset:8192
    ds_write_b128 v97, v[72:75] offset:24576
    ds_write_b128 v96, v[16:19] offset:8192
    ds_write_b128 v96, v[20:23] offset:24576
    ds_write_b128 v96, v[24:27] offset:40960
    ds_write_b128 v98, v[28:31] offset:8704
    s_waitcnt vmcnt(0)
    buffer_load_dwordx4 v[0:3], v92, s[8:11], s24 offen offset:0
    buffer_load_dwordx4 v[16:19], v92, s[8:11], s24 offen offset:64
    v_add_u32 v92, 128, v92
    buffer_load_dwordx4 v[4:7], v93, s[8:11], s24 offen offset:0
    buffer_load_dwordx4 v[20:23], v93, s[8:11], s24 offen offset:64
    v_add_u32 v93, 128, v93
    v_lshlrev_b32 v76, 16, v32
    v_and_b32 v84, s25, v32
    v_lshlrev_b32 v77, 16, v36
    v_and_b32 v85, s25, v36
    v_lshlrev_b32 v78, 16, v40
    v_and_b32 v86, s25, v40
    v_lshlrev_b32 v79, 16, v44
    v_and_b32 v87, s25, v44
    v_add_f32 v80, v76, v78
    v_add_f32 v88, v84, v86
    v_add_f32 v81, v77, v79
    v_add_f32 v89, v85, v87
    v_fma_f32 v82, v78, 4.0, v76
    v_fma_f32 v90, v86, 4.0, v84
    v_fma_f32 v83, v79, 4.0, v77
    v_fma_f32 v91, v87, 4.0, v85
    v_add_f32 v77, v80, v81
    v_add_f32 v85, v88, v89
    v_sub_f32 v78, v80, v81
    v_sub_f32 v86, v88, v89
    v_fma_f32 v79, v83, 2.0, v82
    v_fma_f32 v87, v91, 2.0, v90
    v_fma_f32 v82, v83, -2.0, v82
    v_fma_f32 v90, v91, -2.0, v90
    v_fmamk_f32 v80, v76, 0x41700000, v82
    v_fmamk_f32 v88, v84, 0x41700000, v90
    v_fmamk_f32 v80, v81, 0x41200000, v80
    v_fmamk_f32 v88, v89, 0x41200000, v88
    v_cvt_pk_bf16_f32 v36, v77, v85
    v_cvt_pk_bf16_f32 v40, v78, v86
    v_cvt_pk_bf16_f32 v64, v79, v87
    v_cvt_pk_bf16_f32 v68, v82, v90
    v_cvt_pk_bf16_f32 v72, v80, v88
    v_lshlrev_b32 v76, 16, v33
    v_and_b32 v84, s25, v33
    v_lshlrev_b32 v77, 16, v37
    v_and_b32 v85, s25, v37
    v_lshlrev_b32 v78, 16, v41
    v_and_b32 v86, s25, v41
    v_lshlrev_b32 v79, 16, v45
    v_and_b32 v87, s25, v45
    v_add_f32 v80, v76, v78
    v_add_f32 v88, v84, v86
    v_add_f32 v81, v77, v79
    v_add_f32 v89, v85, v87
    v_fma_f32 v82, v78, 4.0, v76
    v_fma_f32 v90, v86, 4.0, v84
    v_fma_f32 v83, v79, 4.0, v77
    v_fma_f32 v91, v87, 4.0, v85
    v_add_f32 v77, v80, v81
    v_add_f32 v85, v88, v89
    v_sub_f32 v78, v80, v81
    v_sub_f32 v86, v88, v89
    v_fma_f32 v79, v83, 2.0, v82
    v_fma_f32 v87, v91, 2.0, v90
    v_fma_f32 v82, v83, -2.0, v82
    v_fma_f32 v90, v91, -2.0, v90
    v_fmamk_f32 v80, v76, 0x41700000, v82
    v_fmamk_f32 v88, v84, 0x41700000, v90
    v_fmamk_f32 v80, v81, 0x41200000, v80
    v_fmamk_f32 v88, v89, 0x41200000, v88
    v_cvt_pk_bf16_f32 v37, v77, v85
    v_cvt_pk_bf16_f32 v41, v78, v86
    v_cvt_pk_bf16_f32 v65, v79, v87
    v_cvt_pk_bf16_f32 v69, v82, v90
    v_cvt_pk_bf16_f32 v73, v80, v88
    v_lshlrev_b32 v76, 16, v34
    v_and_b32 v84, s25, v34
    v_lshlrev_b32 v77, 16, v38
    v_and_b32 v85, s25, v38
    v_lshlrev_b32 v78, 16, v42
    v_and_b32 v86, s25, v42
    v_lshlrev_b32 v79, 16, v46
    v_and_b32 v87, s25, v46
    v_add_f32 v80, v76, v78
    v_add_f32 v88, v84, v86
    v_add_f32 v81, v77, v79
    v_add_f32 v89, v85, v87
    v_fma_f32 v82, v78, 4.0, v76
    v_fma_f32 v90, v86, 4.0, v84
    v_fma_f32 v83, v79, 4.0, v77
    v_fma_f32 v91, v87, 4.0, v85
    v_add_f32 v77, v80, v81
    v_add_f32 v85, v88, v89
    v_sub_f32 v78, v80, v81
    v_sub_f32 v86, v88, v89
    v_fma_f32 v79, v83, 2.0, v82
    v_fma_f32 v87, v91, 2.0, v90
    v_fma_f32 v82, v83, -2.0, v82
    v_fma_f32 v90, v91, -2.0, v90
    v_fmamk_f32 v80, v76, 0x41700000, v82
    v_fmamk_f32 v88, v84, 0x41700000, v90
    v_fmamk_f32 v80, v81, 0x41200000, v80
    v_fmamk_f32 v88, v89, 0x41200000, v88
    v_cvt_pk_bf16_f32 v38, v77, v85
    v_cvt_pk_bf16_f32 v42, v78, v86
    v_cvt_pk_bf16_f32 v66, v79, v87
    v_cvt_pk_bf16_f32 v70, v82, v90
    v_cvt_pk_bf16_f32 v74, v80, v88
    v_lshlrev_b32 v76, 16, v35
    v_and_b32 v84, s25, v35
    v_lshlrev_b32 v77, 16, v39
    v_and_b32 v85, s25, v39
    v_lshlrev_b32 v78, 16, v43
    v_and_b32 v86, s25, v43
    v_lshlrev_b32 v79, 16, v47
    v_and_b32 v87, s25, v47
    v_add_f32 v80, v76, v78
    v_add_f32 v88, v84, v86
    v_add_f32 v81, v77, v79
    v_add_f32 v89, v85, v87
    v_fma_f32 v82, v78, 4.0, v76
    v_fma_f32 v90, v86, 4.0, v84
    v_fma_f32 v83, v79, 4.0, v77
    v_fma_f32 v91, v87, 4.0, v85
    v_add_f32 v77, v80, v81
    v_add_f32 v85, v88, v89
    v_sub_f32 v78, v80, v81
    v_sub_f32 v86, v88, v89
    v_fma_f32 v79, v83, 2.0, v82
    v_fma_f32 v87, v91, 2.0, v90
    v_fma_f32 v82, v83, -2.0, v82
    v_fma_f32 v90, v91, -2.0, v90
    v_fmamk_f32 v80, v76, 0x41700000, v82
    v_fmamk_f32 v88, v84, 0x41700000, v90
    v_fmamk_f32 v80, v81, 0x41200000, v80
    v_fmamk_f32 v88, v89, 0x41200000, v88
    v_cvt_pk_bf16_f32 v39, v77, v85
    v_cvt_pk_bf16_f32 v43, v78, v86
    v_cvt_pk_bf16_f32 v67, v79, v87
    v_cvt_pk_bf16_f32 v71, v82, v90
    v_cvt_pk_bf16_f32 v75, v80, v88
    s_add_u32 s28, s28, 1
    s_waitcnt lgkmcnt(0)
    s_barrier
    s_cmp_lt_u32 s28, 12
    s_cselect_b32 s24, 0, 2130706432
    ds_write_b128 v96, v[64:67] offset:49152
    ds_write_b128 v97, v[68:71] offset:0
    ds_write_b128 v97, v[72:75] offset:16384
    ds_write_b128 v96, v[32:35] offset:0
    ds_write_b128 v96, v[36:39] offset:16384
    ds_write_b128 v96, v[40:43] offset:32768
    ds_write_b128 v98, v[44:47] offset:0
    buffer_load_dwordx4 v[8:11], v94, s[8:11], s24 offen offset:0
    buffer_load_dwordx4 v[24:27], v94, s[8:11], s24 offen offset:64
    v_add_u32 v94, 128, v94
    buffer_load_dwordx4 v[12:15], v95, s[8:11], s24 offen offset:0
    buffer_load_dwordx4 v[28:31], v95, s[8:11], s24 offen offset:64
    v_add_u32 v95, 128, v95
    v_lshlrev_b32 v76, 16, v48
    v_and_b32 v84, s25, v48
    v_lshlrev_b32 v77, 16, v52
    v_and_b32 v85, s25, v52
    v_lshlrev_b32 v78, 16, v56
    v_and_b32 v86, s25, v56
    v_lshlrev_b32 v79, 16, v60
    v_and_b32 v87, s25, v60
    v_add_f32 v80, v76, v78
    v_add_f32 v88, v84, v86
    v_add_f32 v81, v77, v79
    v_add_f32 v89, v85, v87
    v_fma_f32 v82, v78, 4.0, v76
    v_fma_f32 v90, v86, 4.0, v84
    v_fma_f32 v83, v79, 4.0, v77
    v_fma_f32 v91, v87, 4.0, v85
    v_add_f32 v77, v80, v81
    v_add_f32 v85, v88, v89
    v_sub_f32 v78, v80, v81
    v_sub_f32 v86, v88, v89
    v_fma_f32 v79, v83, 2.0, v82
    v_fma_f32 v87, v91, 2.0, v90
    v_fma_f32 v82, v83, -2.0, v82
    v_fma_f32 v90, v91, -2.0, v90
    v_fmamk_f32 v80, v76, 0x41700000, v82
    v_fmamk_f32 v88, v84, 0x41700000, v90
    v_fmamk_f32 v80, v81, 0x41200000, v80
    v_fmamk_f32 v88, v89, 0x41200000, v88
    v_cvt_pk_bf16_f32 v52, v77, v85
    v_cvt_pk_bf16_f32 v56, v78, v86
    v_cvt_pk_bf16_f32 v64, v79, v87
    v_cvt_pk_bf16_f32 v68, v82, v90
    v_cvt_pk_bf16_f32 v72, v80, v88
    v_lshlrev_b32 v76, 16, v49
    v_and_b32 v84, s25, v49
    v_lshlrev_b32 v77, 16, v53
    v_and_b32 v85, s25, v53
    v_lshlrev_b32 v78, 16, v57
    v_and_b32 v86, s25, v57
    v_lshlrev_b32 v79, 16, v61
    v_and_b32 v87, s25, v61
    v_add_f32 v80, v76, v78
    v_add_f32 v88, v84, v86
    v_add_f32 v81, v77, v79
    v_add_f32 v89, v85, v87
    v_fma_f32 v82, v78, 4.0, v76
    v_fma_f32 v90, v86, 4.0, v84
    v_fma_f32 v83, v79, 4.0, v77
    v_fma_f32 v91, v87, 4.0, v85
    v_add_f32 v77, v80, v81
    v_add_f32 v85, v88, v89
    v_sub_f32 v78, v80, v81
    v_sub_f32 v86, v88, v89
    v_fma_f32 v79, v83, 2.0, v82
    v_fma_f32 v87, v91, 2.0, v90
    v_fma_f32 v82, v83, -2.0, v82
    v_fma_f32 v90, v91, -2.0, v90
    v_fmamk_f32 v80, v76, 0x41700000, v82
    v_fmamk_f32 v88, v84, 0x41700000, v90
    v_fmamk_f32 v80, v81, 0x41200000, v80
    v_fmamk_f32 v88, v89, 0x41200000, v88
    v_cvt_pk_bf16_f32 v53, v77, v85
    v_cvt_pk_bf16_f32 v57, v78, v86
    v_cvt_pk_bf16_f32 v65, v79, v87
    v_cvt_pk_bf16_f32 v69, v82, v90
    v_cvt_pk_bf16_f32 v73, v80, v88
    v_lshlrev_b32 v76, 16, v50
    v_and_b32 v84, s25, v50
    v_lshlrev_b32 v77, 16, v54
    v_and_b32 v85, s25, v54
    v_lshlrev_b32 v78, 16, v58
    v_and_b32 v86, s25, v58
    v_lshlrev_b32 v79, 16, v62
    v_and_b32 v87, s25, v62
    v_add_f32 v80, v76, v78
    v_add_f32 v88, v84, v86
    v_add_f32 v81, v77, v79
    v_add_f32 v89, v85, v87
    v_fma_f32 v82, v78, 4.0, v76
    v_fma_f32 v90, v86, 4.0, v84
    v_fma_f32 v83, v79, 4.0, v77
    v_fma_f32 v91, v87, 4.0, v85
    v_add_f32 v77, v80, v81
    v_add_f32 v85, v88, v89
    v_sub_f32 v78, v80, v81
    v_sub_f32 v86, v88, v89
    v_fma_f32 v79, v83, 2.0, v82
    v_fma_f32 v87, v91, 2.0, v90
    v_fma_f32 v82, v83, -2.0, v82
    v_fma_f32 v90, v91, -2.0, v90
    v_fmamk_f32 v80, v76, 0x41700000, v82
    v_fmamk_f32 v88, v84, 0x41700000, v90
    v_fmamk_f32 v80, v81, 0x41200000, v80
    v_fmamk_f32 v88, v89, 0x41200000, v88
    v_cvt_pk_bf16_f32 v54, v77, v85
    v_cvt_pk_bf16_f32 v58, v78, v86
    v_cvt_pk_bf16_f32 v66, v79, v87
    v_cvt_pk_bf16_f32 v70, v82, v90
    v_cvt_pk_bf16_f32 v74, v80, v88
    v_lshlrev_b32 v76, 16, v51
    v_and_b32 v84, s25, v51
    v_lshlrev_b32 v77, 16, v55
    v_and_b32 v85, s25, v55
    v_lshlrev_b32 v78, 16, v59
    v_and_b32 v86, s25, v59
    v_lshlrev_b32 v79, 16, v63
    v_and_b32 v87, s25, v63
    v_add_f32 v80, v76, v78
    v_add_f32 v88, v84, v86
    v_add_f32 v81, v77, v79
    v_add_f32 v89, v85, v87
    v_fma_f32 v82, v78, 4.0, v76
    v_fma_f32 v90, v86, 4.0, v84
    v_fma_f32 v83, v79, 4.0, v77
    v_fma_f32 v91, v87, 4.0, v85
    v_add_f32 v77, v80, v81
    v_add_f32 v85, v88, v89
    v_sub_f32 v78, v80, v81
    v_sub_f32 v86, v88, v89
    v_fma_f32 v79, v83, 2.0, v82
    v_fma_f32 v87, v91, 2.0, v90
    v_fma_f32 v82, v83, -2.0, v82
    v_fma_f32 v90, v91, -2.0, v90
    v_fmamk_f32 v80, v76, 0x41700000, v82
    v_fmamk_f32 v88, v84, 0x41700000, v90
    v_fmamk_f32 v80, v81, 0x41200000, v80
    v_fmamk_f32 v88, v89, 0x41200000, v88
    v_cvt_pk_bf16_f32 v55, v77, v85
    v_cvt_pk_bf16_f32 v59, v78, v86
    v_cvt_pk_bf16_f32 v67, v79, v87
    v_cvt_pk_bf16_f32 v71, v82, v90
    v_cvt_pk_bf16_f32 v75, v80, v88
    s_add_u32 s28, s28, 1
    s_waitcnt lgkmcnt(0)
    s_barrier
    s_cmp_eq_u32 s22, 1
    s_cbranch_scc1 L_conv1_kernel_hlast2
    s_cmp_lt_u32 s28, 12
    s_cselect_b32 s24, 0, 2130706432
    ds_write_b128 v96, v[64:67] offset:57344
    ds_write_b128 v97, v[68:71] offset:8192
    ds_write_b128 v97, v[72:75] offset:24576
    ds_write_b128 v96, v[48:51] offset:8192
    ds_write_b128 v96, v[52:55] offset:24576
    ds_write_b128 v96, v[56:59] offset:40960
    ds_write_b128 v98, v[60:63] offset:8704
    s_waitcnt vmcnt(0)
    buffer_load_dwordx4 v[32:35], v92, s[8:11], s24 offen offset:0
    buffer_load_dwordx4 v[48:51], v92, s[8:11], s24 offen offset:64
    v_add_u32 v92, 128, v92
    buffer_load_dwordx4 v[36:39], v93, s[8:11], s24 offen offset:0
    buffer_load_dwordx4 v[52:55], v93, s[8:11], s24 offen offset:64
    v_add_u32 v93, 128, v93
    v_lshlrev_b32 v76, 16, v0
    v_and_b32 v84, s25, v0
    v_lshlrev_b32 v77, 16, v4
    v_and_b32 v85, s25, v4
    v_lshlrev_b32 v78, 16, v8
    v_and_b32 v86, s25, v8
    v_lshlrev_b32 v79, 16, v12
    v_and_b32 v87, s25, v12
    v_add_f32 v80, v76, v78
    v_add_f32 v88, v84, v86
    v_add_f32 v81, v77, v79
    v_add_f32 v89, v85, v87
    v_fma_f32 v82, v78, 4.0, v76
    v_fma_f32 v90, v86, 4.0, v84
    v_fma_f32 v83, v79, 4.0, v77
    v_fma_f32 v91, v87, 4.0, v85
    v_add_f32 v77, v80, v81
    v_add_f32 v85, v88, v89
    v_sub_f32 v78, v80, v81
    v_sub_f32 v86, v88, v89
    v_fma_f32 v79, v83, 2.0, v82
    v_fma_f32 v87, v91, 2.0, v90
    v_fma_f32 v82, v83, -2.0, v82
    v_fma_f32 v90, v91, -2.0, v90
    v_fmamk_f32 v80, v76, 0x41700000, v82
    v_fmamk_f32 v88, v84, 0x41700000, v90
    v_fmamk_f32 v80, v81, 0x41200000, v80
    v_fmamk_f32 v88, v89, 0x41200000, v88
    v_cvt_pk_bf16_f32 v4, v77, v85
    v_cvt_pk_bf16_f32 v8, v78, v86
    v_cvt_pk_bf16_f32 v64, v79, v87
    v_cvt_pk_bf16_f32 v68, v82, v90
    v_cvt_pk_bf16_f32 v72, v80, v88
    v_lshlrev_b32 v76, 16, v1
    v_and_b32 v84, s25, v1
    v_lshlrev_b32 v77, 16, v5
    v_and_b32 v85, s25, v5
    v_lshlrev_b32 v78, 16, v9
    v_and_b32 v86, s25, v9
    v_lshlrev_b32 v79, 16, v13
    v_and_b32 v87, s25, v13
    v_add_f32 v80, v76, v78
    v_add_f32 v88, v84, v86
    v_add_f32 v81, v77, v79
    v_add_f32 v89, v85, v87
    v_fma_f32 v82, v78, 4.0, v76
    v_fma_f32 v90, v86, 4.0, v84
    v_fma_f32 v83, v79, 4.0, v77
    v_fma_f32 v91, v87, 4.0, v85
    v_add_f32 v77, v80, v81
    v_add_f32 v85, v88, v89
    v_sub_f32 v78, v80, v81
    v_sub_f32 v86, v88, v89
    v_fma_f32 v79, v83, 2.0, v82
    v_fma_f32 v87, v91, 2.0, v90
    v_fma_f32 v82, v83, -2.0, v82
    v_fma_f32 v90, v91, -2.0, v90
    v_fmamk_f32 v80, v76, 0x41700000, v82
    v_fmamk_f32 v88, v84, 0x41700000, v90
    v_fmamk_f32 v80, v81, 0x41200000, v80
    v_fmamk_f32 v88, v89, 0x41200000, v88
    v_cvt_pk_bf16_f32 v5, v77, v85
    v_cvt_pk_bf16_f32 v9, v78, v86
    v_cvt_pk_bf16_f32 v65, v79, v87
    v_cvt_pk_bf16_f32 v69, v82, v90
    v_cvt_pk_bf16_f32 v73, v80, v88
    v_lshlrev_b32 v76, 16, v2
    v_and_b32 v84, s25, v2
    v_lshlrev_b32 v77, 16, v6
    v_and_b32 v85, s25, v6
    v_lshlrev_b32 v78, 16, v10
    v_and_b32 v86, s25, v10
    v_lshlrev_b32 v79, 16, v14
    v_and_b32 v87, s25, v14
    v_add_f32 v80, v76, v78
    v_add_f32 v88, v84, v86
    v_add_f32 v81, v77, v79
    v_add_f32 v89, v85, v87
    v_fma_f32 v82, v78, 4.0, v76
    v_fma_f32 v90, v86, 4.0, v84
    v_fma_f32 v83, v79, 4.0, v77
    v_fma_f32 v91, v87, 4.0, v85
    v_add_f32 v77, v80, v81
    v_add_f32 v85, v88, v89
    v_sub_f32 v78, v80, v81
    v_sub_f32 v86, v88, v89
    v_fma_f32 v79, v83, 2.0, v82
    v_fma_f32 v87, v91, 2.0, v90
    v_fma_f32 v82, v83, -2.0, v82
    v_fma_f32 v90, v91, -2.0, v90
    v_fmamk_f32 v80, v76, 0x41700000, v82
    v_fmamk_f32 v88, v84, 0x41700000, v90
    v_fmamk_f32 v80, v81, 0x41200000, v80
    v_fmamk_f32 v88, v89, 0x41200000, v88
    v_cvt_pk_bf16_f32 v6, v77, v85
    v_cvt_pk_bf16_f32 v10, v78, v86
    v_cvt_pk_bf16_f32 v66, v79, v87
    v_cvt_pk_bf16_f32 v70, v82, v90
    v_cvt_pk_bf16_f32 v74, v80, v88
    v_lshlrev_b32 v76, 16, v3
    v_and_b32 v84, s25, v3
    v_lshlrev_b32 v77, 16, v7
    v_and_b32 v85, s25, v7
    v_lshlrev_b32 v78, 16, v11
    v_and_b32 v86, s25, v11
    v_lshlrev_b32 v79, 16, v15
    v_and_b32 v87, s25, v15
    v_add_f32 v80, v76, v78
    v_add_f32 v88, v84, v86
    v_add_f32 v81, v77, v79
    v_add_f32 v89, v85, v87
    v_fma_f32 v82, v78, 4.0, v76
    v_fma_f32 v90, v86, 4.0, v84
    v_fma_f32 v83, v79, 4.0, v77
    v_fma_f32 v91, v87, 4.0, v85
    v_add_f32 v77, v80, v81
    v_add_f32 v85, v88, v89
    v_sub_f32 v78, v80, v81
    v_sub_f32 v86, v88, v89
    v_fma_f32 v79, v83, 2.0, v82
    v_fma_f32 v87, v91, 2.0, v90
    v_fma_f32 v82, v83, -2.0, v82
    v_fma_f32 v90, v91, -2.0, v90
    v_fmamk_f32 v80, v76, 0x41700000, v82
    v_fmamk_f32 v88, v84, 0x41700000, v90
    v_fmamk_f32 v80, v81, 0x41200000, v80
    v_fmamk_f32 v88, v89, 0x41200000, v88
    v_cvt_pk_bf16_f32 v7, v77, v85
    v_cvt_pk_bf16_f32 v11, v78, v86
    v_cvt_pk_bf16_f32 v67, v79, v87
    v_cvt_pk_bf16_f32 v71, v82, v90
    v_cvt_pk_bf16_f32 v75, v80, v88
    s_add_u32 s28, s28, 1
    s_waitcnt lgkmcnt(0)
    s_barrier
    s_cmp_lt_u32 s28, 12
    s_cselect_b32 s24, 0, 2130706432
    ds_write_b128 v96, v[64:67] offset:49152
    ds_write_b128 v97, v[68:71] offset:0
    ds_write_b128 v97, v[72:75] offset:16384
    ds_write_b128 v96, v[0:3] offset:0
    ds_write_b128 v96, v[4:7] offset:16384
    ds_write_b128 v96, v[8:11] offset:32768
    ds_write_b128 v98, v[12:15] offset:0
    buffer_load_dwordx4 v[40:43], v94, s[8:11], s24 offen offset:0
    buffer_load_dwordx4 v[56:59], v94, s[8:11], s24 offen offset:64
    v_add_u32 v94, 128, v94
    buffer_load_dwordx4 v[44:47], v95, s[8:11], s24 offen offset:0
    buffer_load_dwordx4 v[60:63], v95, s[8:11], s24 offen offset:64
    v_add_u32 v95, 128, v95
    v_lshlrev_b32 v76, 16, v16
    v_and_b32 v84, s25, v16
    v_lshlrev_b32 v77, 16, v20
    v_and_b32 v85, s25, v20
    v_lshlrev_b32 v78, 16, v24
    v_and_b32 v86, s25, v24
    v_lshlrev_b32 v79, 16, v28
    v_and_b32 v87, s25, v28
    v_add_f32 v80, v76, v78
    v_add_f32 v88, v84, v86
    v_add_f32 v81, v77, v79
    v_add_f32 v89, v85, v87
    v_fma_f32 v82, v78, 4.0, v76
    v_fma_f32 v90, v86, 4.0, v84
    v_fma_f32 v83, v79, 4.0, v77
    v_fma_f32 v91, v87, 4.0, v85
    v_add_f32 v77, v80, v81
    v_add_f32 v85, v88, v89
    v_sub_f32 v78, v80, v81
    v_sub_f32 v86, v88, v89
    v_fma_f32 v79, v83, 2.0, v82
    v_fma_f32 v87, v91, 2.0, v90
    v_fma_f32 v82, v83, -2.0, v82
    v_fma_f32 v90, v91, -2.0, v90
    v_fmamk_f32 v80, v76, 0x41700000, v82
    v_fmamk_f32 v88, v84, 0x41700000, v90
    v_fmamk_f32 v80, v81, 0x41200000, v80
    v_fmamk_f32 v88, v89, 0x41200000, v88
    v_cvt_pk_bf16_f32 v20, v77, v85
    v_cvt_pk_bf16_f32 v24, v78, v86
    v_cvt_pk_bf16_f32 v64, v79, v87
    v_cvt_pk_bf16_f32 v68, v82, v90
    v_cvt_pk_bf16_f32 v72, v80, v88
    v_lshlrev_b32 v76, 16, v17
    v_and_b32 v84, s25, v17
    v_lshlrev_b32 v77, 16, v21
    v_and_b32 v85, s25, v21
    v_lshlrev_b32 v78, 16, v25
    v_and_b32 v86, s25, v25
    v_lshlrev_b32 v79, 16, v29
    v_and_b32 v87, s25, v29
    v_add_f32 v80, v76, v78
    v_add_f32 v88, v84, v86
    v_add_f32 v81, v77, v79
    v_add_f32 v89, v85, v87
    v_fma_f32 v82, v78, 4.0, v76
    v_fma_f32 v90, v86, 4.0, v84
    v_fma_f32 v83, v79, 4.0, v77
    v_fma_f32 v91, v87, 4.0, v85
    v_add_f32 v77, v80, v81
    v_add_f32 v85, v88, v89
    v_sub_f32 v78, v80, v81
    v_sub_f32 v86, v88, v89
    v_fma_f32 v79, v83, 2.0, v82
    v_fma_f32 v87, v91, 2.0, v90
    v_fma_f32 v82, v83, -2.0, v82
    v_fma_f32 v90, v91, -2.0, v90
    v_fmamk_f32 v80, v76, 0x41700000, v82
    v_fmamk_f32 v88, v84, 0x41700000, v90
    v_fmamk_f32 v80, v81, 0x41200000, v80
    v_fmamk_f32 v88, v89, 0x41200000, v88
    v_cvt_pk_bf16_f32 v21, v77, v85
    v_cvt_pk_bf16_f32 v25, v78, v86
    v_cvt_pk_bf16_f32 v65, v79, v87
    v_cvt_pk_bf16_f32 v69, v82, v90
    v_cvt_pk_bf16_f32 v73, v80, v88
    v_lshlrev_b32 v76, 16, v18
    v_and_b32 v84, s25, v18
    v_lshlrev_b32 v77, 16, v22
    v_and_b32 v85, s25, v22
    v_lshlrev_b32 v78, 16, v26
    v_and_b32 v86, s25, v26
    v_lshlrev_b32 v79, 16, v30
    v_and_b32 v87, s25, v30
    v_add_f32 v80, v76, v78
    v_add_f32 v88, v84, v86
    v_add_f32 v81, v77, v79
    v_add_f32 v89, v85, v87
    v_fma_f32 v82, v78, 4.0, v76
    v_fma_f32 v90, v86, 4.0, v84
    v_fma_f32 v83, v79, 4.0, v77
    v_fma_f32 v91, v87, 4.0, v85
    v_add_f32 v77, v80, v81
    v_add_f32 v85, v88, v89
    v_sub_f32 v78, v80, v81
    v_sub_f32 v86, v88, v89
    v_fma_f32 v79, v83, 2.0, v82
    v_fma_f32 v87, v91, 2.0, v90
    v_fma_f32 v82, v83, -2.0, v82
    v_fma_f32 v90, v91, -2.0, v90
    v_fmamk_f32 v80, v76, 0x41700000, v82
    v_fmamk_f32 v88, v84, 0x41700000, v90
    v_fmamk_f32 v80, v81, 0x41200000, v80
    v_fmamk_f32 v88, v89, 0x41200000, v88
    v_cvt_pk_bf16_f32 v22, v77, v85
    v_cvt_pk_bf16_f32 v26, v78, v86
    v_cvt_pk_bf16_f32 v66, v79, v87
    v_cvt_pk_bf16_f32 v70, v82, v90
    v_cvt_pk_bf16_f32 v74, v80, v88
    v_lshlrev_b32 v76, 16, v19
    v_and_b32 v84, s25, v19
    v_lshlrev_b32 v77, 16, v23
    v_and_b32 v85, s25, v23
    v_lshlrev_b32 v78, 16, v27
    v_and_b32 v86, s25, v27
    v_lshlrev_b32 v79, 16, v31
    v_and_b32 v87, s25, v31
    v_add_f32 v80, v76, v78
    v_add_f32 v88, v84, v86
    v_add_f32 v81, v77, v79
    v_add_f32 v89, v85, v87
    v_fma_f32 v82, v78, 4.0, v76
    v_fma_f32 v90, v86, 4.0, v84
    v_fma_f32 v83, v79, 4.0, v77
    v_fma_f32 v91, v87, 4.0, v85
    v_add_f32 v77, v80, v81
    v_add_f32 v85, v88, v89
    v_sub_f32 v78, v80, v81
    v_sub_f32 v86, v88, v89
    v_fma_f32 v79, v83, 2.0, v82
    v_fma_f32 v87, v91, 2.0, v90
    v_fma_f32 v82, v83, -2.0, v82
    v_fma_f32 v90, v91, -2.0, v90
    v_fmamk_f32 v80, v76, 0x41700000, v82
    v_fmamk_f32 v88, v84, 0x41700000, v90
    v_fmamk_f32 v80, v81, 0x41200000, v80
    v_fmamk_f32 v88, v89, 0x41200000, v88
    v_cvt_pk_bf16_f32 v23, v77, v85
    v_cvt_pk_bf16_f32 v27, v78, v86
    v_cvt_pk_bf16_f32 v67, v79, v87
    v_cvt_pk_bf16_f32 v71, v82, v90
    v_cvt_pk_bf16_f32 v75, v80, v88
    s_add_u32 s28, s28, 1
    s_waitcnt lgkmcnt(0)
    s_barrier
    s_sub_u32 s22, s22, 1
    s_branch L_conv1_kernel_hloop2
L_conv1_kernel_hlast2:
    s_waitcnt vmcnt(0)
    s_mov_b32 s58, s20
    s_lshl_b32 s20, s2, 2
    s_add_u32 s20, s20, s32
    v_mov_b32 v1, v127
    s_load_dwordx2 s[8:9], s[0:1], 16
    s_lshr_b32 s22, s20, 8
    s_bfe_u32 s23, s20, 0x40004
    s_bfe_u32 s24, s20, 0x30001
    s_and_b32 s21, s20, 1
    v_lshrrev_b32 v2, 4, v1
    v_lshlrev_b32 v2, 12, v2
    v_and_b32 v3, 15, v1
    v_lshl_add_u32 v2, v3, 2, v2
    s_lshl_b32 s26, s22, 3
    s_lshr_b32 s27, s23, 3
    s_add_u32 s26, s26, s27
    s_lshl_b32 s26, s26, 17
    s_and_b32 s27, s23, 7
    s_lshl_b32 s27, s27, 14
    s_add_u32 s26, s26, s27
    s_lshl_b32 s27, s24, 6
    s_add_u32 s26, s26, s27
    s_mov_b32 s10, 4063232
    s_mov_b32 s11, 0x00020000
    s_add_u32 s37, s26, 262144
    s_add_u32 s38, s26, 524288
    s_add_u32 s39, s26, 786432
    s_waitcnt lgkmcnt(0)
    buffer_load_dword v16, v2, s[8:11], s26 offen offset:0
    buffer_load_dword v17, v2, s[8:11], s26 offen offset:512
    buffer_load_dword v24, v2, s[8:11], s37 offen offset:0
    buffer_load_dword v25, v2, s[8:11], s37 offen offset:512
    buffer_load_dword v32, v2, s[8:11], s38 offen offset:0
    buffer_load_dword v33, v2, s[8:11], s38 offen offset:512
    buffer_load_dword v40, v2, s[8:11], s39 offen offset:0
    buffer_load_dword v41, v2, s[8:11], s39 offen offset:512
    buffer_load_dword v18, v2, s[8:11], s26 offen offset:1024
    buffer_load_dword v19, v2, s[8:11], s26 offen offset:1536
    buffer_load_dword v26, v2, s[8:11], s37 offen offset:1024
    buffer_load_dword v27, v2, s[8:11], s37 offen offset:1536
    buffer_load_dword v34, v2, s[8:11], s38 offen offset:1024
    buffer_load_dword v35, v2, s[8:11], s38 offen offset:1536
    buffer_load_dword v42, v2, s[8:11], s39 offen offset:1024
    buffer_load_dword v43, v2, s[8:11], s39 offen offset:1536
    buffer_load_dword v20, v2, s[8:11], s26 offen offset:2048
    buffer_load_dword v21, v2, s[8:11], s26 offen offset:2560
    buffer_load_dword v28, v2, s[8:11], s37 offen offset:2048
    buffer_load_dword v29, v2, s[8:11], s37 offen offset:2560
    buffer_load_dword v36, v2, s[8:11], s38 offen offset:2048
    buffer_load_dword v37, v2, s[8:11], s38 offen offset:2560
    buffer_load_dword v44, v2, s[8:11], s39 offen offset:2048
    buffer_load_dword v45, v2, s[8:11], s39 offen offset:2560
    buffer_load_dword v22, v2, s[8:11], s26 offen offset:3072
    buffer_load_dword v23, v2, s[8:11], s26 offen offset:3584
    buffer_load_dword v30, v2, s[8:11], s37 offen offset:3072
    buffer_load_dword v31, v2, s[8:11], s37 offen offset:3584
    buffer_load_dword v38, v2, s[8:11], s38 offen offset:3072
    buffer_load_dword v39, v2, s[8:11], s38 offen offset:3584
    buffer_load_dword v46, v2, s[8:11], s39 offen offset:3072
    buffer_load_dword v47, v2, s[8:11], s39 offen offset:3584
    s_add_u32 s12, s30, 9437184
    s_addc_u32 s13, s31, 0
    s_mov_b32 s14, 7340032
    s_mov_b32 s15, 0x00020000
    v_lshlrev_b32 v4, 4, v1
    s_lshl_b32 s27, s24, 4
    s_add_u32 s27, s27, s23
    s_mul_i32 s27, s27, 57344
    s_lshl_b32 s28, s22, 11
    s_add_u32 s27, s27, s28
    s_lshl_b32 s28, s21, 10
    s_add_u32 s27, s27, s28
    s_cmp_eq_u32 s21, 0
    s_mov_b32 s32, 0x07060302
    s_cselect_b32 s32, 0x05040100, s32
    s_mov_b32 s33, 0x03020c0c
    s_cselect_b32 s33, 0x01000c0c, s33
    s_mov_b32 s35, 0x3d2aaaab
    s_mov_b32 s36, 0x3c638e39
    s_mov_b32 s25, 0xffff0000
    ds_write_b128 v96, v[64:67] offset:57344
    ds_write_b128 v97, v[68:71] offset:8192
    ds_write_b128 v97, v[72:75] offset:24576
    ds_write_b128 v96, v[48:51] offset:8192
    ds_write_b128 v96, v[52:55] offset:24576
    ds_write_b128 v96, v[56:59] offset:40960
    ds_write_b128 v98, v[60:63] offset:8704
    s_waitcnt lgkmcnt(0)
    s_barrier
    s_waitcnt vmcnt(24)
    v_perm_b32 v72, v17, v16, s32
    v_perm_b32 v48, v41, v40, s32
    v_perm_b32 v76, v76, v40, s33
    v_perm_b32 v84, v84, v41, s33
    v_perm_b32 v77, v77, v32, s33
    v_perm_b32 v85, v85, v33, s33
    v_perm_b32 v78, v78, v24, s33
    v_perm_b32 v86, v86, v25, s33
    v_perm_b32 v79, v79, v16, s33
    v_perm_b32 v87, v87, v17, s33
    v_add_f32 v80, v76, v78
    v_add_f32 v88, v84, v86
    v_add_f32 v81, v77, v79
    v_add_f32 v89, v85, v87
    v_fma_f32 v82, v78, 4.0, v76
    v_fma_f32 v90, v86, 4.0, v84
    v_fma_f32 v83, v79, 4.0, v77
    v_fma_f32 v91, v87, 4.0, v85
    v_add_f32 v77, v80, v81
    v_add_f32 v85, v88, v89
    v_sub_f32 v78, v80, v81
    v_sub_f32 v86, v88, v89
    v_fma_f32 v79, v83, 2.0, v82
    v_fma_f32 v87, v91, 2.0, v90
    v_fma_f32 v82, v83, -2.0, v82
    v_fma_f32 v90, v91, -2.0, v90
    v_fmamk_f32 v80, v76, 0x41700000, v82
    v_fmamk_f32 v88, v84, 0x41700000, v90
    v_fmamk_f32 v80, v81, 0x41200000, v80
    v_fmamk_f32 v88, v89, 0x41200000, v88
    v_mul_f32 v77, 0.5, v77
    v_mul_f32 v85, 0.5, v85
    v_mul_f32 v78, 0.5, v78
    v_mul_f32 v86, 0.5, v86
    v_mul_f32 v79, s35, v79
    v_mul_f32 v87, s35, v87
    v_mul_f32 v82, s35, v82
    v_mul_f32 v90, s35, v90
    v_mul_f32 v80, s36, v80
    v_mul_f32 v88, s36, v88
    v_cvt_pk_bf16_f32 v52, v77, v85
    v_cvt_pk_bf16_f32 v56, v78, v86
    v_cvt_pk_bf16_f32 v60, v79, v87
    v_cvt_pk_bf16_f32 v64, v82, v90
    v_cvt_pk_bf16_f32 v68, v80, v88
    s_waitcnt vmcnt(16)
    v_perm_b32 v73, v19, v18, s32
    v_perm_b32 v49, v43, v42, s32
    v_perm_b32 v76, v76, v42, s33
    v_perm_b32 v84, v84, v43, s33
    v_perm_b32 v77, v77, v34, s33
    v_perm_b32 v85, v85, v35, s33
    v_perm_b32 v78, v78, v26, s33
    v_perm_b32 v86, v86, v27, s33
    v_perm_b32 v79, v79, v18, s33
    v_perm_b32 v87, v87, v19, s33
    v_add_f32 v80, v76, v78
    v_add_f32 v88, v84, v86
    v_add_f32 v81, v77, v79
    v_add_f32 v89, v85, v87
    v_fma_f32 v82, v78, 4.0, v76
    v_fma_f32 v90, v86, 4.0, v84
    v_fma_f32 v83, v79, 4.0, v77
    v_fma_f32 v91, v87, 4.0, v85
    v_add_f32 v77, v80, v81
    v_add_f32 v85, v88, v89
    v_sub_f32 v78, v80, v81
    v_sub_f32 v86, v88, v89
    v_fma_f32 v79, v83, 2.0, v82
    v_fma_f32 v87, v91, 2.0, v90
    v_fma_f32 v82, v83, -2.0, v82
    v_fma_f32 v90, v91, -2.0, v90
    v_fmamk_f32 v80, v76, 0x41700000, v82
    v_fmamk_f32 v88, v84, 0x41700000, v90
    v_fmamk_f32 v80, v81, 0x41200000, v80
    v_fmamk_f32 v88, v89, 0x41200000, v88
    v_mul_f32 v77, 0.5, v77
    v_mul_f32 v85, 0.5, v85
    v_mul_f32 v78, 0.5, v78
    v_mul_f32 v86, 0.5, v86
    v_mul_f32 v79, s35, v79
    v_mul_f32 v87, s35, v87
    v_mul_f32 v82, s35, v82
    v_mul_f32 v90, s35, v90
    v_mul_f32 v80, s36, v80
    v_mul_f32 v88, s36, v88
    v_cvt_pk_bf16_f32 v53, v77, v85
    v_cvt_pk_bf16_f32 v57, v78, v86
    v_cvt_pk_bf16_f32 v61, v79, v87
    v_cvt_pk_bf16_f32 v65, v82, v90
    v_cvt_pk_bf16_f32 v69, v80, v88
    s_waitcnt vmcnt(8)
    v_perm_b32 v74, v21, v20, s32
    v_perm_b32 v50, v45, v44, s32
    v_perm_b32 v76, v76, v44, s33
    v_perm_b32 v84, v84, v45, s33
    v_perm_b32 v77, v77, v36, s33
    v_perm_b32 v85, v85, v37, s33
    v_perm_b32 v78, v78, v28, s33
    v_perm_b32 v86, v86, v29, s33
    v_perm_b32 v79, v79, v20, s33
    v_perm_b32 v87, v87, v21, s33
    v_add_f32 v80, v76, v78
    v_add_f32 v88, v84, v86
    v_add_f32 v81, v77, v79
    v_add_f32 v89, v85, v87
    v_fma_f32 v82, v78, 4.0, v76
    v_fma_f32 v90, v86, 4.0, v84
    v_fma_f32 v83, v79, 4.0, v77
    v_fma_f32 v91, v87, 4.0, v85
    v_add_f32 v77, v80, v81
    v_add_f32 v85, v88, v89
    v_sub_f32 v78, v80, v81
    v_sub_f32 v86, v88, v89
    v_fma_f32 v79, v83, 2.0, v82
    v_fma_f32 v87, v91, 2.0, v90
    v_fma_f32 v82, v83, -2.0, v82
    v_fma_f32 v90, v91, -2.0, v90
    v_fmamk_f32 v80, v76, 0x41700000, v82
    v_fmamk_f32 v88, v84, 0x41700000, v90
    v_fmamk_f32 v80, v81, 0x41200000, v80
    v_fmamk_f32 v88, v89, 0x41200000, v88
    v_mul_f32 v77, 0.5, v77
    v_mul_f32 v85, 0.5, v85
    v_mul_f32 v78, 0.5, v78
    v_mul_f32 v86, 0.5, v86
    v_mul_f32 v79, s35, v79
    v_mul_f32 v87, s35, v87
    v_mul_f32 v82, s35, v82
    v_mul_f32 v90, s35, v90
    v_mul_f32 v80, s36, v80
    v_mul_f32 v88, s36, v88
    v_cvt_pk_bf16_f32 v54, v77, v85
    v_cvt_pk_bf16_f32 v58, v78, v86
    v_cvt_pk_bf16_f32 v62, v79, v87
    v_cvt_pk_bf16_f32 v66, v82, v90
    v_cvt_pk_bf16_f32 v70, v80, v88
    s_waitcnt vmcnt(0)
    v_perm_b32 v75, v23, v22, s32
    v_perm_b32 v51, v47, v46, s32
    v_perm_b32 v76, v76, v46, s33
    v_perm_b32 v84, v84, v47, s33
    v_perm_b32 v77, v77, v38, s33
    v_perm_b32 v85, v85, v39, s33
    v_perm_b32 v78, v78, v30, s33
    v_perm_b32 v86, v86, v31, s33
    v_perm_b32 v79, v79, v22, s33
    v_perm_b32 v87, v87, v23, s33
    v_add_f32 v80, v76, v78
    v_add_f32 v88, v84, v86
    v_add_f32 v81, v77, v79
    v_add_f32 v89, v85, v87
    v_fma_f32 v82, v78, 4.0, v76
    v_fma_f32 v90, v86, 4.0, v84
    v_fma_f32 v83, v79, 4.0, v77
    v_fma_f32 v91, v87, 4.0, v85
    v_add_f32 v77, v80, v81
    v_add_f32 v85, v88, v89
    v_sub_f32 v78, v80, v81
    v_sub_f32 v86, v88, v89
    v_fma_f32 v79, v83, 2.0, v82
    v_fma_f32 v87, v91, 2.0, v90
    v_fma_f32 v82, v83, -2.0, v82
    v_fma_f32 v90, v91, -2.0, v90
    v_fmamk_f32 v80, v76, 0x41700000, v82
    v_fmamk_f32 v88, v84, 0x41700000, v90
    v_fmamk_f32 v80, v81, 0x41200000, v80
    v_fmamk_f32 v88, v89, 0x41200000, v88
    v_mul_f32 v77, 0.5, v77
    v_mul_f32 v85, 0.5, v85
    v_mul_f32 v78, 0.5, v78
    v_mul_f32 v86, 0.5, v86
    v_mul_f32 v79, s35, v79
    v_mul_f32 v87, s35, v87
    v_mul_f32 v82, s35, v82
    v_mul_f32 v90, s35, v90
    v_mul_f32 v80, s36, v80
    v_mul_f32 v88, s36, v88
    v_cvt_pk_bf16_f32 v55, v77, v85
    v_cvt_pk_bf16_f32 v59, v78, v86
    v_cvt_pk_bf16_f32 v63, v79, v87
    v_cvt_pk_bf16_f32 v67, v82, v90
    v_cvt_pk_bf16_f32 v71, v80, v88
    s_add_u32 s28, s27, 49152
    buffer_store_dwordx4 v[72:75], v4, s[12:15], s28 offen sc1
    s_add_u32 s28, s27, 0
    buffer_store_dwordx4 v[48:51], v4, s[12:15], s28 offen sc1
    s_add_u32 s28, s27, 8192
    buffer_store_dwordx4 v[52:55], v4, s[12:15], s28 offen sc1
    s_add_u32 s28, s27, 16384
    buffer_store_dwordx4 v[56:59], v4, s[12:15], s28 offen sc1
    s_add_u32 s28, s27, 24576
    buffer_store_dwordx4 v[60:63], v4, s[12:15], s28 offen sc1
    s_add_u32 s28, s27, 32768
    buffer_store_dwordx4 v[64:67], v4, s[12:15], s28 offen sc1
    s_add_u32 s28, s27, 40960
    buffer_store_dwordx4 v[68:71], v4, s[12:15], s28 offen sc1
    s_mov_b32 s20, s58
    s_branch L_conv1_kernel_end
L_conv1_kernel_epi:
    s_waitcnt lgkmcnt(0)
    s_barrier
    v_cndmask_b32 v122, v111, v110, vcc
    ds_read_b128 v[0:3], v120 offset:0
    ds_read_b128 v[4:7], v120 offset:16384
    ds_read_b128 v[8:11], v120 offset:32768
    ds_read_b128 v[12:15], v120 offset:49152
    ds_read_b128 v[16:19], v121 offset:0
    ds_read_b128 v[20:23], v121 offset:16384
    ds_read_b128 v[24:27], v121 offset:32768
    ds_read_b128 v[28:31], v64 offset:15360
    ds_read_b128 v[32:35], v120 offset:8192
    ds_read_b128 v[36:39], v120 offset:24576
    ds_read_b128 v[40:43], v120 offset:40960
    ds_read_b128 v[44:47], v120 offset:57344
    ds_read_b128 v[48:51], v121 offset:56320
    ds_read_b128 v[52:55], v121 offset:64512
    ds_read_b128 v[56:59], v64 offset:7168
    s_waitcnt lgkmcnt(7)
    ds_read_b128 v[60:63], v64 offset:23552
    s_waitcnt lgkmcnt(8)
    v_pk_add_f32 v[88:89], v[24:25], v[28:29]
    v_pk_add_f32 v[90:91], v[26:27], v[30:31]
    v_pk_add_f32 v[24:25], v[4:5], v[8:9]
    v_pk_add_f32 v[26:27], v[6:7], v[10:11]
    v_pk_add_f32 v[4:5], v[4:5], v[8:9] neg_lo:[0,1] neg_hi:[0,1]
    v_pk_add_f32 v[6:7], v[6:7], v[10:11] neg_lo:[0,1] neg_hi:[0,1]
    v_pk_add_f32 v[72:73], v[12:13], v[16:17]
    v_pk_add_f32 v[74:75], v[14:15], v[18:19]
    v_pk_add_f32 v[12:13], v[12:13], v[16:17] neg_lo:[0,1] neg_hi:[0,1]
    v_pk_add_f32 v[14:15], v[14:15], v[18:19] neg_lo:[0,1] neg_hi:[0,1]
    v_pk_fma_f32 v[72:73], v[24:25], s[4:5], v[72:73]
    v_pk_fma_f32 v[74:75], v[26:27], s[4:5], v[74:75]
    v_pk_fma_f32 v[20:21], v[0:1], s[10:11], v[20:21]
    v_pk_fma_f32 v[22:23], v[2:3], s[10:11], v[22:23]
    v_pk_fma_f32 v[72:73], v[0:1], s[6:7], v[72:73]
    v_pk_fma_f32 v[74:75], v[2:3], s[6:7], v[74:75]
    v_pk_add_f32 v[24:25], v[24:25], v[0:1] neg_lo:[0,1] neg_hi:[0,1]
    v_pk_add_f32 v[26:27], v[26:27], v[2:3] neg_lo:[0,1] neg_hi:[0,1]
    v_pk_fma_f32 v[72:73], v[88:89], s[8:9], v[72:73]
    v_pk_fma_f32 v[74:75], v[90:91], s[8:9], v[74:75]
    v_pk_add_f32 v[24:25], v[24:25], v[88:89] neg_lo:[0,1] neg_hi:[0,1]
    v_pk_add_f32 v[26:27], v[26:27], v[90:91] neg_lo:[0,1] neg_hi:[0,1]
    v_pk_fma_f32 v[20:21], v[88:89], s[22:23], v[20:21]
    v_pk_fma_f32 v[22:23], v[90:91], s[22:23], v[22:23]
    v_pk_add_f32 v[8:9], v[24:25], v[72:73] neg_lo:[0,1] neg_hi:[0,1]
    v_pk_add_f32 v[10:11], v[26:27], v[74:75] neg_lo:[0,1] neg_hi:[0,1]
    v_pk_fma_f32 v[20:21], v[72:73], s[14:15], v[20:21]
    v_pk_fma_f32 v[22:23], v[74:75], s[14:15], v[22:23]
    v_pk_mul_f32 v[80:81], v[12:13], s[32:33]
    v_pk_mul_f32 v[82:83], v[14:15], s[32:33]
    v_pk_fma_f32 v[20:21], v[8:9], s[12:13], v[20:21]
    v_pk_fma_f32 v[22:23], v[10:11], s[12:13], v[22:23]
    v_pk_fma_f32 v[80:81], v[4:5], s[34:35], v[80:81]
    v_pk_fma_f32 v[82:83], v[6:7], s[34:35], v[82:83]
    v_pk_fma_f32 v[64:65], v[4:5], s[24:25], v[20:21] neg_lo:[0,0,1] neg_hi:[0,0,1]
    v_pk_fma_f32 v[66:67], v[6:7], s[24:25], v[22:23] neg_lo:[0,0,1] neg_hi:[0,0,1]
    v_pk_fma_f32 v[64:65], v[12:13], s[26:27], v[64:65]
    v_pk_fma_f32 v[66:67], v[14:15], s[26:27], v[66:67]
    v_pk_fma_f32 v[80:81], v[64:65], s[38:39], v[80:81]
    v_pk_fma_f32 v[82:83], v[66:67], s[38:39], v[82:83]
    v_pk_add_f32 v[4:5], v[4:5], v[64:65] neg_lo:[0,1] neg_hi:[0,1]
    v_pk_add_f32 v[6:7], v[6:7], v[66:67] neg_lo:[0,1] neg_hi:[0,1]
    v_pk_add_f32 v[4:5], v[4:5], v[80:81] neg_lo:[0,1] neg_hi:[0,1]
    v_pk_add_f32 v[6:7], v[6:7], v[82:83] neg_lo:[0,1] neg_hi:[0,1]
    s_waitcnt lgkmcnt(0)
    v_pk_add_f32 v[92:93], v[56:57], v[60:61]
    v_pk_add_f32 v[94:95], v[58:59], v[62:63]
    v_pk_add_f32 v[56:57], v[36:37], v[40:41]
    v_pk_add_f32 v[58:59], v[38:39], v[42:43]
    v_pk_add_f32 v[36:37], v[36:37], v[40:41] neg_lo:[0,1] neg_hi:[0,1]
    v_pk_add_f32 v[38:39], v[38:39], v[42:43] neg_lo:[0,1] neg_hi:[0,1]
    v_pk_add_f32 v[76:77], v[44:45], v[48:49]
    v_pk_add_f32 v[78:79], v[46:47], v[50:51]
    v_pk_add_f32 v[44:45], v[44:45], v[48:49] neg_lo:[0,1] neg_hi:[0,1]
    v_pk_add_f32 v[46:47], v[46:47], v[50:51] neg_lo:[0,1] neg_hi:[0,1]
    v_pk_fma_f32 v[76:77], v[56:57], s[4:5], v[76:77]
    v_pk_fma_f32 v[78:79], v[58:59], s[4:5], v[78:79]
    v_pk_fma_f32 v[52:53], v[32:33], s[10:11], v[52:53]
    v_pk_fma_f32 v[54:55], v[34:35], s[10:11], v[54:55]
    v_pk_fma_f32 v[76:77], v[32:33], s[6:7], v[76:77]
    v_pk_fma_f32 v[78:79], v[34:35], s[6:7], v[78:79]
    v_pk_add_f32 v[56:57], v[56:57], v[32:33] neg_lo:[0,1] neg_hi:[0,1]
    v_pk_add_f32 v[58:59], v[58:59], v[34:35] neg_lo:[0,1] neg_hi:[0,1]
    v_pk_fma_f32 v[76:77], v[92:93], s[8:9], v[76:77]
    v_pk_fma_f32 v[78:79], v[94:95], s[8:9], v[78:79]
    v_pk_add_f32 v[56:57], v[56:57], v[92:93] neg_lo:[0,1] neg_hi:[0,1]
    v_pk_add_f32 v[58:59], v[58:59], v[94:95] neg_lo:[0,1] neg_hi:[0,1]
    v_pk_fma_f32 v[52:53], v[92:93], s[22:23], v[52:53]
    v_pk_fma_f32 v[54:55], v[94:95], s[22:23], v[54:55]
    v_pk_add_f32 v[40:41], v[56:57], v[76:77] neg_lo:[0,1] neg_hi:[0,1]
    v_pk_add_f32 v[42:43], v[58:59], v[78:79] neg_lo:[0,1] neg_hi:[0,1]
    v_pk_fma_f32 v[52:53], v[76:77], s[14:15], v[52:53]
    v_pk_fma_f32 v[54:55], v[78:79], s[14:15], v[54:55]
    v_pk_mul_f32 v[84:85], v[44:45], s[32:33]
    v_pk_mul_f32 v[86:87], v[46:47], s[32:33]
    v_pk_fma_f32 v[52:53], v[40:41], s[12:13], v[52:53]
    v_pk_fma_f32 v[54:55], v[42:43], s[12:13], v[54:55]
    v_pk_fma_f32 v[84:85], v[36:37], s[34:35], v[84:85]
    v_pk_fma_f32 v[86:87], v[38:39], s[34:35], v[86:87]
    v_pk_fma_f32 v[68:69], v[36:37], s[24:25], v[52:53] neg_lo:[0,0,1] neg_hi:[0,0,1]
    v_pk_fma_f32 v[70:71], v[38:39], s[24:25], v[54:55] neg_lo:[0,0,1] neg_hi:[0,0,1]
    v_pk_fma_f32 v[68:69], v[44:45], s[26:27], v[68:69]
    v_pk_fma_f32 v[70:71], v[46:47], s[26:27], v[70:71]
    v_pk_fma_f32 v[84:85], v[68:69], s[38:39], v[84:85]
    v_pk_fma_f32 v[86:87], v[70:71], s[38:39], v[86:87]
    v_pk_add_f32 v[36:37], v[36:37], v[68:69] neg_lo:[0,1] neg_hi:[0,1]
    v_pk_add_f32 v[38:39], v[38:39], v[70:71] neg_lo:[0,1] neg_hi:[0,1]
    v_pk_add_f32 v[36:37], v[36:37], v[84:85] neg_lo:[0,1] neg_hi:[0,1]
    v_pk_add_f32 v[38:39], v[38:39], v[86:87] neg_lo:[0,1] neg_hi:[0,1]
    s_mov_b32 s36, 0x00010001
    s_mov_b32 s37, 0x00010001
    s_mov_b64 exec, s[36:37]
    ds_write_b128 v127, v[0:3] offset:0
    ds_write_b128 v127, v[32:35] offset:16
    ds_write_b128 v127, v[4:7] offset:32
    ds_write_b128 v127, v[36:39] offset:48
    ds_write_b128 v127, v[8:11] offset:64
    ds_write_b128 v127, v[40:43] offset:80
    s_mov_b64 exec, -1
    v_mov_b32 v44, 0xc0135761
    v_mov_b32 v45, v44
    v_pk_mul_f32 v[16:17], v[64:65], v[64:65]
    v_pk_mul_f32 v[18:19], v[66:67], v[66:67]
    v_pk_mul_f32 v[20:21], v[68:69], v[68:69]
    v_pk_mul_f32 v[22:23], v[70:71], v[70:71]
    v_pk_fma_f32 v[16:17], v[16:17], s[40:41], v[44:45]
    v_pk_fma_f32 v[18:19], v[18:19], s[40:41], v[44:45]
    v_pk_fma_f32 v[20:21], v[20:21], s[40:41], v[44:45]
    v_pk_fma_f32 v[22:23], v[22:23], s[40:41], v[44:45]
    v_pk_mul_f32 v[16:17], v[16:17], v[64:65]
    v_pk_mul_f32 v[18:19], v[18:19], v[66:67]
    v_pk_mul_f32 v[20:21], v[20:21], v[68:69]
    v_pk_mul_f32 v[22:23], v[22:23], v[70:71]
    v_exp_f32 v16, v16
    v_exp_f32 v17, v17
    v_exp_f32 v18, v18
    v_exp_f32 v19, v19
    v_exp_f32 v20, v20
    v_exp_f32 v21, v21
    v_exp_f32 v22, v22
    v_exp_f32 v23, v23
    v_pk_add_f32 v[16:17], v[16:17], s[42:43]
    v_pk_add_f32 v[18:19], v[18:19], s[42:43]
    v_pk_add_f32 v[20:21], v[20:21], s[42:43]
    v_pk_add_f32 v[22:23], v[22:23], s[42:43]
    v_rcp_f32 v16, v16
    v_rcp_f32 v17, v17
    v_rcp_f32 v18, v18
    v_rcp_f32 v19, v19
    v_rcp_f32 v20, v20
    v_rcp_f32 v21, v21
    v_rcp_f32 v22, v22
    v_rcp_f32 v23, v23
    v_pk_mul_f32 v[64:65], v[64:65], v[16:17]
    v_pk_mul_f32 v[66:67], v[66:67], v[18:19]
    v_pk_mul_f32 v[68:69], v[68:69], v[20:21]
    v_pk_mul_f32 v[70:71], v[70:71], v[22:23]
    v_cvt_pk_bf16_f32 v48, v64, v68
    v_cvt_pk_bf16_f32 v49, v65, v69
    v_cvt_pk_bf16_f32 v50, v66, v70
    v_cvt_pk_bf16_f32 v51, v67, v71
    s_mov_b32 s44, 393280
    buffer_store_dwordx4 v[48:51], v122, s[16:19], s44 offen sc1
    s_waitcnt lgkmcnt(0)
    s_barrier
    ds_read_b128 v[96:99], v127 offset:512
    ds_read_b128 v[100:103], v127 offset:528
    ds_read_b128 v[104:107], v127 offset:544
    ds_read_b128 v[108:111], v127 offset:560
    ds_read_b128 v[112:115], v127 offset:576
    ds_read_b128 v[116:119], v127 offset:592
    s_waitcnt lgkmcnt(4)
    v_mov_b32_dpp v96, v0 row_shl:1 row_mask:0xf bank_mask:0xf
    v_mov_b32_dpp v97, v1 row_shl:1 row_mask:0xf bank_mask:0xf
    v_mov_b32_dpp v98, v2 row_shl:1 row_mask:0xf bank_mask:0xf
    v_mov_b32_dpp v99, v3 row_shl:1 row_mask:0xf bank_mask:0xf
    v_mov_b32_dpp v100, v32 row_shl:1 row_mask:0xf bank_mask:0xf
    v_mov_b32_dpp v101, v33 row_shl:1 row_mask:0xf bank_mask:0xf
    v_mov_b32_dpp v102, v34 row_shl:1 row_mask:0xf bank_mask:0xf
    v_mov_b32_dpp v103, v35 row_shl:1 row_mask:0xf bank_mask:0xf
    v_pk_add_f32 v[72:73], v[72:73], v[96:97]
    v_pk_add_f32 v[74:75], v[74:75], v[98:99]
    v_pk_add_f32 v[76:77], v[76:77], v[100:101]
    v_pk_add_f32 v[78:79], v[78:79], v[102:103]
    v_pk_mul_f32 v[24:25], v[72:73], v[72:73]
    v_pk_mul_f32 v[26:27], v[74:75], v[74:75]
    v_pk_mul_f32 v[28:29], v[76:77], v[76:77]
    v_pk_mul_f32 v[30:31], v[78:79], v[78:79]
    v_pk_fma_f32 v[24:25], v[24:25], s[40:41], v[44:45]
    v_pk_fma_f32 v[26:27], v[26:27], s[40:41], v[44:45]
    v_pk_fma_f32 v[28:29], v[28:29], s[40:41], v[44:45]
    v_pk_fma_f32 v[30:31], v[30:31], s[40:41], v[44:45]
    v_pk_mul_f32 v[24:25], v[24:25], v[72:73]
    v_pk_mul_f32 v[26:27], v[26:27], v[74:75]
    v_pk_mul_f32 v[28:29], v[28:29], v[76:77]
    v_pk_mul_f32 v[30:31], v[30:31], v[78:79]
    v_exp_f32 v24, v24
    v_exp_f32 v25, v25
    v_exp_f32 v26, v26
    v_exp_f32 v27, v27
    v_exp_f32 v28, v28
    v_exp_f32 v29, v29
    v_exp_f32 v30, v30
    v_exp_f32 v31, v31
    v_pk_add_f32 v[24:25], v[24:25], s[42:43]
    v_pk_add_f32 v[26:27], v[26:27], s[42:43]
    v_pk_add_f32 v[28:29], v[28:29], s[42:43]
    v_pk_add_f32 v[30:31], v[30:31], s[42:43]
    v_rcp_f32 v24, v24
    v_rcp_f32 v25, v25
    v_rcp_f32 v26, v26
    v_rcp_f32 v27, v27
    v_rcp_f32 v28, v28
    v_rcp_f32 v29, v29
    v_rcp_f32 v30, v30
    v_rcp_f32 v31, v31
    v_pk_mul_f32 v[72:73], v[72:73], v[24:25]
    v_pk_mul_f32 v[74:75], v[74:75], v[26:27]
    v_pk_mul_f32 v[76:77], v[76:77], v[28:29]
    v_pk_mul_f32 v[78:79], v[78:79], v[30:31]
    v_cvt_pk_bf16_f32 v52, v72, v76
    v_cvt_pk_bf16_f32 v53, v73, v77
    v_cvt_pk_bf16_f32 v54, v74, v78
    v_cvt_pk_bf16_f32 v55, v75, v79
    s_mov_b32 s44, 128
    buffer_store_dwordx4 v[52:55], v122, s[16:19], s44 offen sc1
    s_waitcnt lgkmcnt(2)
    v_mov_b32_dpp v104, v4 row_shl:1 row_mask:0xf bank_mask:0xf
    v_mov_b32_dpp v105, v5 row_shl:1 row_mask:0xf bank_mask:0xf
    v_mov_b32_dpp v106, v6 row_shl:1 row_mask:0xf bank_mask:0xf
    v_mov_b32_dpp v107, v7 row_shl:1 row_mask:0xf bank_mask:0xf
    v_mov_b32_dpp v108, v36 row_shl:1 row_mask:0xf bank_mask:0xf
    v_mov_b32_dpp v109, v37 row_shl:1 row_mask:0xf bank_mask:0xf
    v_mov_b32_dpp v110, v38 row_shl:1 row_mask:0xf bank_mask:0xf
    v_mov_b32_dpp v111, v39 row_shl:1 row_mask:0xf bank_mask:0xf
    v_pk_add_f32 v[80:81], v[80:81], v[104:105]
    v_pk_add_f32 v[82:83], v[82:83], v[106:107]
    v_pk_add_f32 v[84:85], v[84:85], v[108:109]
    v_pk_add_f32 v[86:87], v[86:87], v[110:111]
    v_pk_mul_f32 v[16:17], v[80:81], v[80:81]
    v_pk_mul_f32 v[18:19], v[82:83], v[82:83]
    v_pk_mul_f32 v[20:21], v[84:85], v[84:85]
    v_pk_mul_f32 v[22:23], v[86:87], v[86:87]
    v_pk_fma_f32 v[16:17], v[16:17], s[40:41], v[44:45]
    v_pk_fma_f32 v[18:19], v[18:19], s[40:41], v[44:45]
    v_pk_fma_f32 v[20:21], v[20:21], s[40:41], v[44:45]
    v_pk_fma_f32 v[22:23], v[22:23], s[40:41], v[44:45]
    v_pk_mul_f32 v[16:17], v[16:17], v[80:81]
    v_pk_mul_f32 v[18:19], v[18:19], v[82:83]
    v_pk_mul_f32 v[20:21], v[20:21], v[84:85]
    v_pk_mul_f32 v[22:23], v[22:23], v[86:87]
    v_exp_f32 v16, v16
    v_exp_f32 v17, v17
    v_exp_f32 v18, v18
    v_exp_f32 v19, v19
    v_exp_f32 v20, v20
    v_exp_f32 v21, v21
    v_exp_f32 v22, v22
    v_exp_f32 v23, v23
    v_pk_add_f32 v[16:17], v[16:17], s[42:43]
    v_pk_add_f32 v[18:19], v[18:19], s[42:43]
    v_pk_add_f32 v[20:21], v[20:21], s[42:43]
    v_pk_add_f32 v[22:23], v[22:23], s[42:43]
    v_rcp_f32 v16, v16
    v_rcp_f32 v17, v17
    v_rcp_f32 v18, v18
    v_rcp_f32 v19, v19
    v_rcp_f32 v20, v20
    v_rcp_f32 v21, v21
    v_rcp_f32 v22, v22
    v_rcp_f32 v23, v23
    v_pk_mul_f32 v[80:81], v[80:81], v[16:17]
    v_pk_mul_f32 v[82:83], v[82:83], v[18:19]
    v_pk_mul_f32 v[84:85], v[84:85], v[20:21]
    v_pk_mul_f32 v[86:87], v[86:87], v[22:23]
    v_cvt_pk_bf16_f32 v56, v80, v84
    v_cvt_pk_bf16_f32 v57, v81, v85
    v_cvt_pk_bf16_f32 v58, v82, v86
    v_cvt_pk_bf16_f32 v59, v83, v87
    s_mov_b32 s44, 131200
    buffer_store_dwordx4 v[56:59], v122, s[16:19], s44 offen sc1
    s_waitcnt lgkmcnt(0)
    v_mov_b32_dpp v112, v8 row_shl:1 row_mask:0xf bank_mask:0xf
    v_mov_b32_dpp v113, v9 row_shl:1 row_mask:0xf bank_mask:0xf
    v_mov_b32_dpp v114, v10 row_shl:1 row_mask:0xf bank_mask:0xf
    v_mov_b32_dpp v115, v11 row_shl:1 row_mask:0xf bank_mask:0xf
    v_mov_b32_dpp v116, v40 row_shl:1 row_mask:0xf bank_mask:0xf
    v_mov_b32_dpp v117, v41 row_shl:1 row_mask:0xf bank_mask:0xf
    v_mov_b32_dpp v118, v42 row_shl:1 row_mask:0xf bank_mask:0xf
    v_mov_b32_dpp v119, v43 row_shl:1 row_mask:0xf bank_mask:0xf
    v_pk_add_f32 v[88:89], v[88:89], v[112:113]
    v_pk_add_f32 v[90:91], v[90:91], v[114:115]
    v_pk_add_f32 v[92:93], v[92:93], v[116:117]
    v_pk_add_f32 v[94:95], v[94:95], v[118:119]
    v_pk_mul_f32 v[24:25], v[88:89], v[88:89]
    v_pk_mul_f32 v[26:27], v[90:91], v[90:91]
    v_pk_mul_f32 v[28:29], v[92:93], v[92:93]
    v_pk_mul_f32 v[30:31], v[94:95], v[94:95]
    v_pk_fma_f32 v[24:25], v[24:25], s[40:41], v[44:45]
    v_pk_fma_f32 v[26:27], v[26:27], s[40:41], v[44:45]
    v_pk_fma_f32 v[28:29], v[28:29], s[40:41], v[44:45]
    v_pk_fma_f32 v[30:31], v[30:31], s[40:41], v[44:45]
    v_pk_mul_f32 v[24:25], v[24:25], v[88:89]
    v_pk_mul_f32 v[26:27], v[26:27], v[90:91]
    v_pk_mul_f32 v[28:29], v[28:29], v[92:93]
    v_pk_mul_f32 v[30:31], v[30:31], v[94:95]
    v_exp_f32 v24, v24
    v_exp_f32 v25, v25
    v_exp_f32 v26, v26
    v_exp_f32 v27, v27
    v_exp_f32 v28, v28
    v_exp_f32 v29, v29
    v_exp_f32 v30, v30
    v_exp_f32 v31, v31
    v_pk_add_f32 v[24:25], v[24:25], s[42:43]
    v_pk_add_f32 v[26:27], v[26:27], s[42:43]
    v_pk_add_f32 v[28:29], v[28:29], s[42:43]
    v_pk_add_f32 v[30:31], v[30:31], s[42:43]
    v_rcp_f32 v24, v24
    v_rcp_f32 v25, v25
    v_rcp_f32 v26, v26
    v_rcp_f32 v27, v27
    v_rcp_f32 v28, v28
    v_rcp_f32 v29, v29
    v_rcp_f32 v30, v30
    v_rcp_f32 v31, v31
    v_pk_mul_f32 v[88:89], v[88:89], v[24:25]
    v_pk_mul_f32 v[90:91], v[90:91], v[26:27]
    v_pk_mul_f32 v[92:93], v[92:93], v[28:29]
    v_pk_mul_f32 v[94:95], v[94:95], v[30:31]
    v_cvt_pk_bf16_f32 v60, v88, v92
    v_cvt_pk_bf16_f32 v61, v89, v93
    v_cvt_pk_bf16_f32 v62, v90, v94
    v_cvt_pk_bf16_f32 v63, v91, v95
    s_mov_b32 s44, 262272
    buffer_store_dwordx4 v[60:63], v122, s[16:19], s44 offen sc1
L_conv1_kernel_end:
L_conv1_kernel_done:
    s_endpgm
.globl conv2_kernel
.p2align 8
.type conv2_kernel,@function
conv2_kernel:
    s_cmp_ge_u32 s2, 256
    s_cbranch_scc1 L_conv2_kernel_done
    s_load_dwordx2 s[4:5], s[0:1], 72
    s_load_dwordx2 s[30:31], s[0:1], 72
    v_readfirstlane_b32 s20, v0
    s_lshr_b32 s20, s20, 6
    s_xor_b32 s20, s20, 8
    s_and_b32 s36, s2, 0
    s_lshl_b32 s36, s36, 3
    s_bfe_u32 s37, s2, 196611
    s_or_b32 s29, s36, s37
    s_bfe_u32 s36, s2, 196608
    s_lshl_b32 s36, s36, 2
    s_lshr_b32 s37, s2, 6
    s_or_b32 s36, s36, s37
    s_lshr_b32 s33, s36, 4
    s_and_b32 s34, s36, 7
    s_bfe_u32 s35, s36, 0x10003
    s_mul_i32 s21, s34, 500
    s_and_b32 s32, s20, 3
    v_and_b32 v127, 63, v0
    v_lshrrev_b32 v5, 2, v127
    v_and_b32 v6, 3, v127
    s_and_b32 s42, s20, 7
    s_lshr_b32 s41, s21, 2
    s_sub_u32 s41, s41, 1
    s_add_u32 s37, s41, s42
    v_lshl_add_u32 v7, v5, 3, s37
    s_mul_i32 s36, s35, 4194304
    s_add_u32 s36, s36, 18874368
    s_mov_b32 s10, 4194304
    s_mov_b32 s11, 0x00020000
    s_mov_b32 s25, 0xffff0000
    s_mov_b32 s47, s36
    s_cmp_ge_u32 s20, 8
    s_cbranch_scc1 L_conv2_kernel_helper
    s_add_u32 s37, s41, 128
    v_mov_b32 v16, s37
    v_mul_u32_u24 v17, 524288, v5
    v_lshl_add_u32 v17, v6, 4, v17
    s_add_u32 s37, s33, 4294967289
    v_lshl_add_u32 v18, v16, 3, s37
    v_cmp_gt_u32 vcc, 8000, v18
    s_mul_i32 s37, s33, 131072
    s_add_u32 s37, s37, 0
    v_lshl_add_u32 v108, v16, 7, s37
    v_add_u32 v108, v108, v17
    v_mov_b32 v18, 2130706432
    v_cndmask_b32 v108, v18, v108, vcc
    s_add_u32 s37, s33, 4294967291
    v_lshl_add_u32 v18, v16, 3, s37
    v_cmp_gt_u32 vcc, 8000, v18
    s_mul_i32 s37, s33, 131072
    s_add_u32 s37, s37, 262144
    v_lshl_add_u32 v109, v16, 7, s37
    v_add_u32 v109, v109, v17
    v_mov_b32 v18, 2130706432
    v_cndmask_b32 v109, v18, v109, vcc
    s_add_u32 s37, s33, 4294967293
    v_lshl_add_u32 v18, v16, 3, s37
    v_cmp_gt_u32 vcc, 8000, v18
    s_mul_i32 s37, s33, 131072
    s_add_u32 s37, s37, 64
    v_lshl_add_u32 v110, v16, 7, s37
    v_add_u32 v110, v110, v17
    v_mov_b32 v18, 2130706432
    v_cndmask_b32 v110, v18, v110, vcc
    s_waitcnt lgkmcnt(0)
    s_add_u32 s8, s4, s47
    s_addc_u32 s9, s5, 0
    s_lshl_b32 s36, s29, 4
    s_lshl_b32 s37, s33, 3
    s_add_u32 s36, s36, s37
    s_mul_i32 s36, s36, 57344
    s_add_u32 s36, s36, 9437184
    s_add_u32 s12, s30, s36
    s_addc_u32 s13, s31, 0
    s_mov_b32 s14, 458752
    s_mov_b32 s15, 0x00020000
    s_mul_i32 s36, s35, 2097152
    s_add_u32 s36, s36, 27262976
    s_mul_i32 s37, s33, 8388608
    s_add_u32 s36, s36, s37
    s_add_u32 s16, s30, s36
    s_addc_u32 s17, s31, 0
    s_mov_b32 s18, 2097152
    s_mov_b32 s19, 0x00020000
    v_and_b32 v10, 15, v127
    v_lshrrev_b32 v11, 4, v127
    v_add_u32 v8, 0, v10
    v_and_b32 v16, 4, v8
    v_lshrrev_b32 v16, 1, v16
    v_xor_b32 v16, v11, v16
    v_lshlrev_b32 v16, 4, v16
    v_lshl_add_u32 v8, v8, 6, v16
    v_add_u32 v9, 1, v10
    v_and_b32 v16, 4, v9
    v_lshrrev_b32 v16, 1, v16
    v_xor_b32 v16, v11, v16
    v_lshlrev_b32 v16, 4, v16
    v_lshl_add_u32 v9, v9, 6, v16
    s_lshr_b32 s38, s32, 1
    s_and_b32 s39, s32, 1
    s_add_u32 s40, s38, 4
    s_lshl_b32 s43, s39, 10
    s_cmp_lt_u32 s20, 4
    s_cselect_b32 s40, s20, s40
    s_cselect_b32 s36, 0, s43
    s_lshl_b32 s37, s40, 13
    s_add_u32 s37, s37, s36
    v_lshl_add_u32 v125, v127, 4, s37
    s_mul_i32 s37, s40, 16384
    v_add_u32 v120, s37, v8
    v_add_u32 v121, s37, v9
    s_lshl_b32 s37, s40, 10
    s_add_u32 s37, s37, 115712
    v_lshl_add_u32 v16, v11, 4, s37
    v_cmp_eq_u32 vcc, 15, v10
    v_mov_b32 v17, 8192
    v_mov_b32 v18, 4294959104
    v_mov_b32 v19, 64
    v_cndmask_b32 v122, v121, v16, vcc
    v_cndmask_b32 v123, v17, v19, vcc
    v_cndmask_b32 v124, v18, v19, vcc
    v_lshl_add_u32 v126, v127, 4, s37
    s_mov_b32 s44, 0x3f800000
    s_mov_b32 s45, 0x00000000
    s_mov_b32 s46, 0x00000000
    s_cmp_eq_u32 s40, 1
    s_cselect_b32 s45, 0x3f800000, s45
    s_cselect_b32 s46, 0x3f800000, s46
    s_cmp_eq_u32 s40, 2
    s_cselect_b32 s45, 0xbf800000, s45
    s_cselect_b32 s46, 0x3f800000, s46
    s_cmp_eq_u32 s40, 3
    s_cselect_b32 s45, 0x40000000, s45
    s_cselect_b32 s46, 0x40800000, s46
    s_cmp_eq_u32 s40, 4
    s_cselect_b32 s45, 0xc0000000, s45
    s_cselect_b32 s46, 0x40800000, s46
    s_cmp_eq_u32 s40, 5
    s_cselect_b32 s44, 0x41800000, s44
    s_cselect_b32 s45, 0x41000000, s45
    s_cselect_b32 s46, 0x40800000, s46
    s_cmp_ge_u32 s20, 4
    s_cbranch_scc1 L_conv2_kernel_m2
    v_mov_b32 v0, 0
    v_mov_b32 v1, 0
    v_mov_b32 v2, 0
    v_mov_b32 v3, 0
    v_mov_b32 v4, 0
    v_mov_b32 v5, 0
    v_mov_b32 v6, 0
    v_mov_b32 v7, 0
    v_mov_b32 v8, 0
    v_mov_b32 v9, 0
    v_mov_b32 v10, 0
    v_mov_b32 v11, 0
    v_mov_b32 v12, 0
    v_mov_b32 v13, 0
    v_mov_b32 v14, 0
    v_mov_b32 v15, 0
    v_mov_b32 v16, 0
    v_mov_b32 v17, 0
    v_mov_b32 v18, 0
    v_mov_b32 v19, 0
    v_mov_b32 v20, 0
    v_mov_b32 v21, 0
    v_mov_b32 v22, 0
    v_mov_b32 v23, 0
    v_mov_b32 v24, 0
    v_mov_b32 v25, 0
    v_mov_b32 v26, 0
    v_mov_b32 v27, 0
    v_mov_b32 v28, 0
    v_mov_b32 v29, 0
    v_mov_b32 v30, 0
    v_mov_b32 v31, 0
    v_mov_b32 v32, 0
    v_mov_b32 v33, 0
    v_mov_b32 v34, 0
    v_mov_b32 v35, 0
    v_mov_b32 v36, 0
    v_mov_b32 v37, 0
    v_mov_b32 v38, 0
    v_mov_b32 v39, 0
    v_mov_b32 v40, 0
    v_mov_b32 v41, 0
    v_mov_b32 v42, 0
    v_mov_b32 v43, 0
    v_mov_b32 v44, 0
    v_mov_b32 v45, 0
    v_mov_b32 v46, 0
    v_mov_b32 v47, 0
    v_mov_b32 v48, 0
    v_mov_b32 v49, 0
    v_mov_b32 v50, 0
    v_mov_b32 v51, 0
    v_mov_b32 v52, 0
    v_mov_b32 v53, 0
    v_mov_b32 v54, 0
    v_mov_b32 v55, 0
    v_mov_b32 v56, 0
    v_mov_b32 v57, 0
    v_mov_b32 v58, 0
    v_mov_b32 v59, 0
    v_mov_b32 v60, 0
    v_mov_b32 v61, 0
    v_mov_b32 v62, 0
    v_mov_b32 v63, 0
    buffer_load_dwordx4 v[96:99], v108, s[8:11], 0 offen
    buffer_load_dwordx4 v[100:103], v109, s[8:11], 0 offen
    buffer_load_dwordx4 v[104:107], v110, s[8:11], 0 offen
    s_mov_b32 s23, 0
    s_mov_b32 s26, 4096
    buffer_load_dwordx4 v[64:67], v125, s[12:15], s23 offen offset:0
    buffer_load_dwordx4 v[68:71], v125, s[12:15], s23 offen offset:1024
    buffer_load_dwordx4 v[72:75], v125, s[12:15], s23 offen offset:2048
    buffer_load_dwordx4 v[76:79], v125, s[12:15], s23 offen offset:3072
    buffer_load_dwordx4 v[80:83], v125, s[12:15], s26 offen offset:0
    buffer_load_dwordx4 v[84:87], v125, s[12:15], s26 offen offset:1024
    buffer_load_dwordx4 v[88:91], v125, s[12:15], s26 offen offset:2048
    buffer_load_dwordx4 v[92:95], v125, s[12:15], s26 offen offset:3072
    s_mov_b32 s23, 57344
    s_mov_b32 s26, 61440
    s_waitcnt vmcnt(8)
    v_lshlrev_b32 v108, 16, v96
    v_and_b32 v111, s25, v96
    v_lshlrev_b32 v109, 16, v100
    v_and_b32 v112, s25, v100
    v_lshlrev_b32 v110, 16, v104
    v_and_b32 v113, s25, v104
    v_mul_f32 v114, s44, v108
    v_mul_f32 v115, s44, v111
    v_fmac_f32 v114, s45, v109
    v_fmac_f32 v115, s45, v112
    v_fmac_f32 v114, s46, v110
    v_fmac_f32 v115, s46, v113
    v_cvt_pk_bf16_f32 v96, v114, v115
    v_lshlrev_b32 v108, 16, v97
    v_and_b32 v111, s25, v97
    v_lshlrev_b32 v109, 16, v101
    v_and_b32 v112, s25, v101
    v_lshlrev_b32 v110, 16, v105
    v_and_b32 v113, s25, v105
    v_mul_f32 v114, s44, v108
    v_mul_f32 v115, s44, v111
    v_fmac_f32 v114, s45, v109
    v_fmac_f32 v115, s45, v112
    v_fmac_f32 v114, s46, v110
    v_fmac_f32 v115, s46, v113
    v_cvt_pk_bf16_f32 v97, v114, v115
    v_lshlrev_b32 v108, 16, v98
    v_and_b32 v111, s25, v98
    v_lshlrev_b32 v109, 16, v102
    v_and_b32 v112, s25, v102
    v_lshlrev_b32 v110, 16, v106
    v_and_b32 v113, s25, v106
    v_mul_f32 v114, s44, v108
    v_mul_f32 v115, s44, v111
    v_fmac_f32 v114, s45, v109
    v_fmac_f32 v115, s45, v112
    v_fmac_f32 v114, s46, v110
    v_fmac_f32 v115, s46, v113
    v_cvt_pk_bf16_f32 v98, v114, v115
    v_lshlrev_b32 v108, 16, v99
    v_and_b32 v111, s25, v99
    v_lshlrev_b32 v109, 16, v103
    v_and_b32 v112, s25, v103
    v_lshlrev_b32 v110, 16, v107
    v_and_b32 v113, s25, v107
    v_mul_f32 v114, s44, v108
    v_mul_f32 v115, s44, v111
    v_fmac_f32 v114, s45, v109
    v_fmac_f32 v115, s45, v112
    v_fmac_f32 v114, s46, v110
    v_fmac_f32 v115, s46, v113
    v_cvt_pk_bf16_f32 v99, v114, v115
    ds_write_b128 v126, v[96:99]
    s_waitcnt lgkmcnt(0)
    s_barrier
    s_mov_b32 s22, 4
    s_setprio 2
L_conv2_kernel_mloop1:
    ds_read_b128 v[96:99], v120 offset:0
    ds_read_b128 v[100:103], v120 offset:1024
    ds_read_b128 v[104:107], v120 offset:2048
    ds_read_b128 v[108:111], v120 offset:3072
    ds_read_b128 v[112:115], v120 offset:4096
    ds_read_b128 v[116:119], v120 offset:5120
    s_waitcnt vmcnt(6) lgkmcnt(5)
    v_mfma_f32_16x16x32_bf16 v[0:3], v[64:67], v[96:99], v[0:3]
    v_mfma_f32_16x16x32_bf16 v[32:35], v[68:71], v[96:99], v[32:35]
    ds_read_b128 v[96:99], v120 offset:6144
    s_waitcnt vmcnt(4) lgkmcnt(5)
    v_mfma_f32_16x16x32_bf16 v[4:7], v[64:67], v[100:103], v[4:7]
    v_mfma_f32_16x16x32_bf16 v[36:39], v[68:71], v[100:103], v[36:39]
    v_mfma_f32_16x16x32_bf16 v[0:3], v[72:75], v[100:103], v[0:3]
    v_mfma_f32_16x16x32_bf16 v[32:35], v[76:79], v[100:103], v[32:35]
    ds_read_b128 v[100:103], v120 offset:7168
    s_waitcnt vmcnt(2) lgkmcnt(5)
    v_mfma_f32_16x16x32_bf16 v[8:11], v[64:67], v[104:107], v[8:11]
    v_mfma_f32_16x16x32_bf16 v[40:43], v[68:71], v[104:107], v[40:43]
    v_mfma_f32_16x16x32_bf16 v[4:7], v[72:75], v[104:107], v[4:7]
    v_mfma_f32_16x16x32_bf16 v[36:39], v[76:79], v[104:107], v[36:39]
    v_mfma_f32_16x16x32_bf16 v[0:3], v[80:83], v[104:107], v[0:3]
    v_mfma_f32_16x16x32_bf16 v[32:35], v[84:87], v[104:107], v[32:35]
    ds_read_b128 v[104:107], v122 offset:0
    v_add_u32 v122, v123, v122
    s_waitcnt vmcnt(0) lgkmcnt(5)
    v_mfma_f32_16x16x32_bf16 v[12:15], v[64:67], v[108:111], v[12:15]
    v_mfma_f32_16x16x32_bf16 v[44:47], v[68:71], v[108:111], v[44:47]
    v_mfma_f32_16x16x32_bf16 v[8:11], v[72:75], v[108:111], v[8:11]
    v_mfma_f32_16x16x32_bf16 v[40:43], v[76:79], v[108:111], v[40:43]
    v_mfma_f32_16x16x32_bf16 v[4:7], v[80:83], v[108:111], v[4:7]
    v_mfma_f32_16x16x32_bf16 v[36:39], v[84:87], v[108:111], v[36:39]
    v_mfma_f32_16x16x32_bf16 v[0:3], v[88:91], v[108:111], v[0:3]
    v_mfma_f32_16x16x32_bf16 v[32:35], v[92:95], v[108:111], v[32:35]
    ds_read_b128 v[108:111], v121 offset:1024
    s_waitcnt lgkmcnt(5)
    v_mfma_f32_16x16x32_bf16 v[16:19], v[64:67], v[112:115], v[16:19]
    v_mfma_f32_16x16x32_bf16 v[48:51], v[68:71], v[112:115], v[48:51]
    v_mfma_f32_16x16x32_bf16 v[12:15], v[72:75], v[112:115], v[12:15]
    v_mfma_f32_16x16x32_bf16 v[44:47], v[76:79], v[112:115], v[44:47]
    v_mfma_f32_16x16x32_bf16 v[8:11], v[80:83], v[112:115], v[8:11]
    v_mfma_f32_16x16x32_bf16 v[40:43], v[84:87], v[112:115], v[40:43]
    v_mfma_f32_16x16x32_bf16 v[4:7], v[88:91], v[112:115], v[4:7]
    v_mfma_f32_16x16x32_bf16 v[36:39], v[92:95], v[112:115], v[36:39]
    ds_read_b128 v[112:115], v121 offset:2048
    s_waitcnt lgkmcnt(5)
    v_mfma_f32_16x16x32_bf16 v[20:23], v[64:67], v[116:119], v[20:23]
    v_mfma_f32_16x16x32_bf16 v[52:55], v[68:71], v[116:119], v[52:55]
    v_mfma_f32_16x16x32_bf16 v[16:19], v[72:75], v[116:119], v[16:19]
    v_mfma_f32_16x16x32_bf16 v[48:51], v[76:79], v[116:119], v[48:51]
    v_mfma_f32_16x16x32_bf16 v[12:15], v[80:83], v[116:119], v[12:15]
    v_mfma_f32_16x16x32_bf16 v[44:47], v[84:87], v[116:119], v[44:47]
    v_mfma_f32_16x16x32_bf16 v[8:11], v[88:91], v[116:119], v[8:11]
    v_mfma_f32_16x16x32_bf16 v[40:43], v[92:95], v[116:119], v[40:43]
    s_waitcnt lgkmcnt(4)
    v_mfma_f32_16x16x32_bf16 v[24:27], v[64:67], v[96:99], v[24:27]
    v_mfma_f32_16x16x32_bf16 v[56:59], v[68:71], v[96:99], v[56:59]
    v_mfma_f32_16x16x32_bf16 v[20:23], v[72:75], v[96:99], v[20:23]
    v_mfma_f32_16x16x32_bf16 v[52:55], v[76:79], v[96:99], v[52:55]
    v_mfma_f32_16x16x32_bf16 v[16:19], v[80:83], v[96:99], v[16:19]
    v_mfma_f32_16x16x32_bf16 v[48:51], v[84:87], v[96:99], v[48:51]
    v_mfma_f32_16x16x32_bf16 v[12:15], v[88:91], v[96:99], v[12:15]
    v_mfma_f32_16x16x32_bf16 v[44:47], v[92:95], v[96:99], v[44:47]
    s_waitcnt lgkmcnt(3)
    v_mfma_f32_16x16x32_bf16 v[28:31], v[64:67], v[100:103], v[28:31]
    v_mfma_f32_16x16x32_bf16 v[60:63], v[68:71], v[100:103], v[60:63]
    v_mfma_f32_16x16x32_bf16 v[24:27], v[72:75], v[100:103], v[24:27]
    v_mfma_f32_16x16x32_bf16 v[56:59], v[76:79], v[100:103], v[56:59]
    v_mfma_f32_16x16x32_bf16 v[20:23], v[80:83], v[100:103], v[20:23]
    v_mfma_f32_16x16x32_bf16 v[52:55], v[84:87], v[100:103], v[52:55]
    v_mfma_f32_16x16x32_bf16 v[16:19], v[88:91], v[100:103], v[16:19]
    v_mfma_f32_16x16x32_bf16 v[48:51], v[92:95], v[100:103], v[48:51]
    buffer_load_dwordx4 v[64:67], v125, s[12:15], s23 offen offset:0
    buffer_load_dwordx4 v[68:71], v125, s[12:15], s23 offen offset:1024
    s_waitcnt lgkmcnt(2)
    v_mfma_f32_16x16x32_bf16 v[28:31], v[72:75], v[104:107], v[28:31]
    v_mfma_f32_16x16x32_bf16 v[60:63], v[76:79], v[104:107], v[60:63]
    v_mfma_f32_16x16x32_bf16 v[24:27], v[80:83], v[104:107], v[24:27]
    v_mfma_f32_16x16x32_bf16 v[56:59], v[84:87], v[104:107], v[56:59]
    v_mfma_f32_16x16x32_bf16 v[20:23], v[88:91], v[104:107], v[20:23]
    v_mfma_f32_16x16x32_bf16 v[52:55], v[92:95], v[104:107], v[52:55]
    buffer_load_dwordx4 v[72:75], v125, s[12:15], s23 offen offset:2048
    buffer_load_dwordx4 v[76:79], v125, s[12:15], s23 offen offset:3072
    s_waitcnt lgkmcnt(1)
    v_mfma_f32_16x16x32_bf16 v[28:31], v[80:83], v[108:111], v[28:31]
    v_mfma_f32_16x16x32_bf16 v[60:63], v[84:87], v[108:111], v[60:63]
    v_mfma_f32_16x16x32_bf16 v[24:27], v[88:91], v[108:111], v[24:27]
    v_mfma_f32_16x16x32_bf16 v[56:59], v[92:95], v[108:111], v[56:59]
    buffer_load_dwordx4 v[80:83], v125, s[12:15], s26 offen offset:0
    buffer_load_dwordx4 v[84:87], v125, s[12:15], s26 offen offset:1024
    s_waitcnt lgkmcnt(0)
    v_mfma_f32_16x16x32_bf16 v[28:31], v[88:91], v[112:115], v[28:31]
    v_mfma_f32_16x16x32_bf16 v[60:63], v[92:95], v[112:115], v[60:63]
    buffer_load_dwordx4 v[88:91], v125, s[12:15], s26 offen offset:2048
    buffer_load_dwordx4 v[92:95], v125, s[12:15], s26 offen offset:3072
    s_add_u32 s23, s23, 57344
    s_add_u32 s26, s26, 57344
    s_barrier
    s_sub_u32 s22, s22, 1
    s_cmp_eq_u32 s22, 0
    s_cbranch_scc1 L_conv2_kernel_mlast1
    ds_read_b128 v[96:99], v120 offset:8192
    ds_read_b128 v[100:103], v120 offset:9216
    ds_read_b128 v[104:107], v120 offset:10240
    ds_read_b128 v[108:111], v120 offset:11264
    ds_read_b128 v[112:115], v120 offset:12288
    ds_read_b128 v[116:119], v120 offset:13312
    s_waitcnt vmcnt(6) lgkmcnt(5)
    v_mfma_f32_16x16x32_bf16 v[0:3], v[64:67], v[96:99], v[0:3]
    v_mfma_f32_16x16x32_bf16 v[32:35], v[68:71], v[96:99], v[32:35]
    ds_read_b128 v[96:99], v120 offset:14336
    s_waitcnt vmcnt(4) lgkmcnt(5)
    v_mfma_f32_16x16x32_bf16 v[4:7], v[64:67], v[100:103], v[4:7]
    v_mfma_f32_16x16x32_bf16 v[36:39], v[68:71], v[100:103], v[36:39]
    v_mfma_f32_16x16x32_bf16 v[0:3], v[72:75], v[100:103], v[0:3]
    v_mfma_f32_16x16x32_bf16 v[32:35], v[76:79], v[100:103], v[32:35]
    ds_read_b128 v[100:103], v120 offset:15360
    s_waitcnt vmcnt(2) lgkmcnt(5)
    v_mfma_f32_16x16x32_bf16 v[8:11], v[64:67], v[104:107], v[8:11]
    v_mfma_f32_16x16x32_bf16 v[40:43], v[68:71], v[104:107], v[40:43]
    v_mfma_f32_16x16x32_bf16 v[4:7], v[72:75], v[104:107], v[4:7]
    v_mfma_f32_16x16x32_bf16 v[36:39], v[76:79], v[104:107], v[36:39]
    v_mfma_f32_16x16x32_bf16 v[0:3], v[80:83], v[104:107], v[0:3]
    v_mfma_f32_16x16x32_bf16 v[32:35], v[84:87], v[104:107], v[32:35]
    ds_read_b128 v[104:107], v122 offset:0
    v_add_u32 v122, v124, v122
    s_waitcnt vmcnt(0) lgkmcnt(5)
    v_mfma_f32_16x16x32_bf16 v[12:15], v[64:67], v[108:111], v[12:15]
    v_mfma_f32_16x16x32_bf16 v[44:47], v[68:71], v[108:111], v[44:47]
    v_mfma_f32_16x16x32_bf16 v[8:11], v[72:75], v[108:111], v[8:11]
    v_mfma_f32_16x16x32_bf16 v[40:43], v[76:79], v[108:111], v[40:43]
    v_mfma_f32_16x16x32_bf16 v[4:7], v[80:83], v[108:111], v[4:7]
    v_mfma_f32_16x16x32_bf16 v[36:39], v[84:87], v[108:111], v[36:39]
    v_mfma_f32_16x16x32_bf16 v[0:3], v[88:91], v[108:111], v[0:3]
    v_mfma_f32_16x16x32_bf16 v[32:35], v[92:95], v[108:111], v[32:35]
    ds_read_b128 v[108:111], v121 offset:9216
    s_waitcnt lgkmcnt(5)
    v_mfma_f32_16x16x32_bf16 v[16:19], v[64:67], v[112:115], v[16:19]
    v_mfma_f32_16x16x32_bf16 v[48:51], v[68:71], v[112:115], v[48:51]
    v_mfma_f32_16x16x32_bf16 v[12:15], v[72:75], v[112:115], v[12:15]
    v_mfma_f32_16x16x32_bf16 v[44:47], v[76:79], v[112:115], v[44:47]
    v_mfma_f32_16x16x32_bf16 v[8:11], v[80:83], v[112:115], v[8:11]
    v_mfma_f32_16x16x32_bf16 v[40:43], v[84:87], v[112:115], v[40:43]
    v_mfma_f32_16x16x32_bf16 v[4:7], v[88:91], v[112:115], v[4:7]
    v_mfma_f32_16x16x32_bf16 v[36:39], v[92:95], v[112:115], v[36:39]
    ds_read_b128 v[112:115], v121 offset:10240
    s_waitcnt lgkmcnt(5)
    v_mfma_f32_16x16x32_bf16 v[20:23], v[64:67], v[116:119], v[20:23]
    v_mfma_f32_16x16x32_bf16 v[52:55], v[68:71], v[116:119], v[52:55]
    v_mfma_f32_16x16x32_bf16 v[16:19], v[72:75], v[116:119], v[16:19]
    v_mfma_f32_16x16x32_bf16 v[48:51], v[76:79], v[116:119], v[48:51]
    v_mfma_f32_16x16x32_bf16 v[12:15], v[80:83], v[116:119], v[12:15]
    v_mfma_f32_16x16x32_bf16 v[44:47], v[84:87], v[116:119], v[44:47]
    v_mfma_f32_16x16x32_bf16 v[8:11], v[88:91], v[116:119], v[8:11]
    v_mfma_f32_16x16x32_bf16 v[40:43], v[92:95], v[116:119], v[40:43]
    s_waitcnt lgkmcnt(4)
    v_mfma_f32_16x16x32_bf16 v[24:27], v[64:67], v[96:99], v[24:27]
    v_mfma_f32_16x16x32_bf16 v[56:59], v[68:71], v[96:99], v[56:59]
    v_mfma_f32_16x16x32_bf16 v[20:23], v[72:75], v[96:99], v[20:23]
    v_mfma_f32_16x16x32_bf16 v[52:55], v[76:79], v[96:99], v[52:55]
    v_mfma_f32_16x16x32_bf16 v[16:19], v[80:83], v[96:99], v[16:19]
    v_mfma_f32_16x16x32_bf16 v[48:51], v[84:87], v[96:99], v[48:51]
    v_mfma_f32_16x16x32_bf16 v[12:15], v[88:91], v[96:99], v[12:15]
    v_mfma_f32_16x16x32_bf16 v[44:47], v[92:95], v[96:99], v[44:47]
    s_waitcnt lgkmcnt(3)
    v_mfma_f32_16x16x32_bf16 v[28:31], v[64:67], v[100:103], v[28:31]
    v_mfma_f32_16x16x32_bf16 v[60:63], v[68:71], v[100:103], v[60:63]
    v_mfma_f32_16x16x32_bf16 v[24:27], v[72:75], v[100:103], v[24:27]
    v_mfma_f32_16x16x32_bf16 v[56:59], v[76:79], v[100:103], v[56:59]
    v_mfma_f32_16x16x32_bf16 v[20:23], v[80:83], v[100:103], v[20:23]
    v_mfma_f32_16x16x32_bf16 v[52:55], v[84:87], v[100:103], v[52:55]
    v_mfma_f32_16x16x32_bf16 v[16:19], v[88:91], v[100:103], v[16:19]
    v_mfma_f32_16x16x32_bf16 v[48:51], v[92:95], v[100:103], v[48:51]
    buffer_load_dwordx4 v[64:67], v125, s[12:15], s23 offen offset:0
    buffer_load_dwordx4 v[68:71], v125, s[12:15], s23 offen offset:1024
    s_waitcnt lgkmcnt(2)
    v_mfma_f32_16x16x32_bf16 v[28:31], v[72:75], v[104:107], v[28:31]
    v_mfma_f32_16x16x32_bf16 v[60:63], v[76:79], v[104:107], v[60:63]
    v_mfma_f32_16x16x32_bf16 v[24:27], v[80:83], v[104:107], v[24:27]
    v_mfma_f32_16x16x32_bf16 v[56:59], v[84:87], v[104:107], v[56:59]
    v_mfma_f32_16x16x32_bf16 v[20:23], v[88:91], v[104:107], v[20:23]
    v_mfma_f32_16x16x32_bf16 v[52:55], v[92:95], v[104:107], v[52:55]
    buffer_load_dwordx4 v[72:75], v125, s[12:15], s23 offen offset:2048
    buffer_load_dwordx4 v[76:79], v125, s[12:15], s23 offen offset:3072
    s_waitcnt lgkmcnt(1)
    v_mfma_f32_16x16x32_bf16 v[28:31], v[80:83], v[108:111], v[28:31]
    v_mfma_f32_16x16x32_bf16 v[60:63], v[84:87], v[108:111], v[60:63]
    v_mfma_f32_16x16x32_bf16 v[24:27], v[88:91], v[108:111], v[24:27]
    v_mfma_f32_16x16x32_bf16 v[56:59], v[92:95], v[108:111], v[56:59]
    buffer_load_dwordx4 v[80:83], v125, s[12:15], s26 offen offset:0
    buffer_load_dwordx4 v[84:87], v125, s[12:15], s26 offen offset:1024
    s_waitcnt lgkmcnt(0)
    v_mfma_f32_16x16x32_bf16 v[28:31], v[88:91], v[112:115], v[28:31]
    v_mfma_f32_16x16x32_bf16 v[60:63], v[92:95], v[112:115], v[60:63]
    buffer_load_dwordx4 v[88:91], v125, s[12:15], s26 offen offset:2048
    buffer_load_dwordx4 v[92:95], v125, s[12:15], s26 offen offset:3072
    s_add_u32 s23, s23, 57344
    s_add_u32 s26, s26, 57344
    s_barrier
    s_branch L_conv2_kernel_mloop1
L_conv2_kernel_mlast1:
    v_and_b32 v125, 15, v127
    v_and_b32 v126, 7, v127
    v_lshlrev_b32 v126, 4, v126
    v_lshl_add_u32 v125, v125, 7, v126
    v_lshrrev_b32 v126, 4, v127
    v_lshl_add_u32 v125, v126, 11, v125
    s_lshl_b32 s36, s20, 14
    s_add_u32 s37, s36, 8192
    v_add_u32 v126, s37, v125
    v_add_u32 v125, s36, v125
    ds_read_b128 v[96:99], v120 offset:8192
    ds_read_b128 v[100:103], v120 offset:9216
    ds_read_b128 v[104:107], v120 offset:10240
    ds_read_b128 v[108:111], v120 offset:11264
    ds_read_b128 v[112:115], v120 offset:12288
    ds_read_b128 v[116:119], v120 offset:13312
    s_waitcnt vmcnt(6) lgkmcnt(5)
    v_mfma_f32_16x16x32_bf16 v[0:3], v[64:67], v[96:99], v[0:3]
    v_mfma_f32_16x16x32_bf16 v[32:35], v[68:71], v[96:99], v[32:35]
    ds_read_b128 v[96:99], v120 offset:14336
    s_waitcnt vmcnt(4) lgkmcnt(5)
    v_mfma_f32_16x16x32_bf16 v[4:7], v[64:67], v[100:103], v[4:7]
    v_mfma_f32_16x16x32_bf16 v[36:39], v[68:71], v[100:103], v[36:39]
    v_mfma_f32_16x16x32_bf16 v[0:3], v[72:75], v[100:103], v[0:3]
    v_mfma_f32_16x16x32_bf16 v[32:35], v[76:79], v[100:103], v[32:35]
    ds_read_b128 v[100:103], v120 offset:15360
    s_waitcnt vmcnt(2) lgkmcnt(5)
    v_mfma_f32_16x16x32_bf16 v[8:11], v[64:67], v[104:107], v[8:11]
    v_mfma_f32_16x16x32_bf16 v[40:43], v[68:71], v[104:107], v[40:43]
    v_mfma_f32_16x16x32_bf16 v[4:7], v[72:75], v[104:107], v[4:7]
    v_mfma_f32_16x16x32_bf16 v[36:39], v[76:79], v[104:107], v[36:39]
    v_mfma_f32_16x16x32_bf16 v[0:3], v[80:83], v[104:107], v[0:3]
    v_mfma_f32_16x16x32_bf16 v[32:35], v[84:87], v[104:107], v[32:35]
    ds_read_b128 v[104:107], v122 offset:0
    s_waitcnt vmcnt(0) lgkmcnt(5)
    v_mfma_f32_16x16x32_bf16 v[12:15], v[64:67], v[108:111], v[12:15]
    v_mfma_f32_16x16x32_bf16 v[44:47], v[68:71], v[108:111], v[44:47]
    v_mfma_f32_16x16x32_bf16 v[8:11], v[72:75], v[108:111], v[8:11]
    v_mfma_f32_16x16x32_bf16 v[40:43], v[76:79], v[108:111], v[40:43]
    v_mfma_f32_16x16x32_bf16 v[4:7], v[80:83], v[108:111], v[4:7]
    v_mfma_f32_16x16x32_bf16 v[36:39], v[84:87], v[108:111], v[36:39]
    v_mfma_f32_16x16x32_bf16 v[0:3], v[88:91], v[108:111], v[0:3]
    v_mfma_f32_16x16x32_bf16 v[32:35], v[92:95], v[108:111], v[32:35]
    ds_read_b128 v[108:111], v121 offset:9216
    s_waitcnt lgkmcnt(5)
    v_mfma_f32_16x16x32_bf16 v[16:19], v[64:67], v[112:115], v[16:19]
    v_mfma_f32_16x16x32_bf16 v[48:51], v[68:71], v[112:115], v[48:51]
    v_mfma_f32_16x16x32_bf16 v[12:15], v[72:75], v[112:115], v[12:15]
    v_mfma_f32_16x16x32_bf16 v[44:47], v[76:79], v[112:115], v[44:47]
    v_mfma_f32_16x16x32_bf16 v[8:11], v[80:83], v[112:115], v[8:11]
    v_mfma_f32_16x16x32_bf16 v[40:43], v[84:87], v[112:115], v[40:43]
    v_mfma_f32_16x16x32_bf16 v[4:7], v[88:91], v[112:115], v[4:7]
    v_mfma_f32_16x16x32_bf16 v[36:39], v[92:95], v[112:115], v[36:39]
    ds_read_b128 v[112:115], v121 offset:10240
    v_xor_b32 v123, 0, v125
    ds_write_b128 v123, v[0:3]
    s_waitcnt lgkmcnt(6)
    v_mfma_f32_16x16x32_bf16 v[20:23], v[64:67], v[116:119], v[20:23]
    v_mfma_f32_16x16x32_bf16 v[52:55], v[68:71], v[116:119], v[52:55]
    v_mfma_f32_16x16x32_bf16 v[16:19], v[72:75], v[116:119], v[16:19]
    v_mfma_f32_16x16x32_bf16 v[48:51], v[76:79], v[116:119], v[48:51]
    v_mfma_f32_16x16x32_bf16 v[12:15], v[80:83], v[116:119], v[12:15]
    v_mfma_f32_16x16x32_bf16 v[44:47], v[84:87], v[116:119], v[44:47]
    v_mfma_f32_16x16x32_bf16 v[8:11], v[88:91], v[116:119], v[8:11]
    v_mfma_f32_16x16x32_bf16 v[40:43], v[92:95], v[116:119], v[40:43]
    v_xor_b32 v124, 16, v125
    ds_write_b128 v124, v[4:7]
    s_waitcnt lgkmcnt(2)
    v_mfma_f32_16x16x32_bf16 v[24:27], v[64:67], v[96:99], v[24:27]
    v_mfma_f32_16x16x32_bf16 v[56:59], v[68:71], v[96:99], v[56:59]
    v_mfma_f32_16x16x32_bf16 v[20:23], v[72:75], v[96:99], v[20:23]
    v_mfma_f32_16x16x32_bf16 v[52:55], v[76:79], v[96:99], v[52:55]
    v_mfma_f32_16x16x32_bf16 v[16:19], v[80:83], v[96:99], v[16:19]
    v_mfma_f32_16x16x32_bf16 v[48:51], v[84:87], v[96:99], v[48:51]
    v_mfma_f32_16x16x32_bf16 v[12:15], v[88:91], v[96:99], v[12:15]
    v_mfma_f32_16x16x32_bf16 v[44:47], v[92:95], v[96:99], v[44:47]
    v_xor_b32 v123, 32, v125
    ds_write_b128 v123, v[8:11]
    v_xor_b32 v124, 0, v126
    ds_write_b128 v124, v[32:35]
    v_mfma_f32_16x16x32_bf16 v[28:31], v[64:67], v[100:103], v[28:31]
    v_mfma_f32_16x16x32_bf16 v[60:63], v[68:71], v[100:103], v[60:63]
    v_mfma_f32_16x16x32_bf16 v[24:27], v[72:75], v[100:103], v[24:27]
    v_mfma_f32_16x16x32_bf16 v[56:59], v[76:79], v[100:103], v[56:59]
    v_mfma_f32_16x16x32_bf16 v[20:23], v[80:83], v[100:103], v[20:23]
    v_mfma_f32_16x16x32_bf16 v[52:55], v[84:87], v[100:103], v[52:55]
    v_mfma_f32_16x16x32_bf16 v[16:19], v[88:91], v[100:103], v[16:19]
    v_mfma_f32_16x16x32_bf16 v[48:51], v[92:95], v[100:103], v[48:51]
    v_xor_b32 v123, 16, v126
    ds_write_b128 v123, v[36:39]
    v_xor_b32 v124, 32, v126
    ds_write_b128 v124, v[40:43]
    v_mfma_f32_16x16x32_bf16 v[28:31], v[72:75], v[104:107], v[28:31]
    v_mfma_f32_16x16x32_bf16 v[60:63], v[76:79], v[104:107], v[60:63]
    v_mfma_f32_16x16x32_bf16 v[24:27], v[80:83], v[104:107], v[24:27]
    v_mfma_f32_16x16x32_bf16 v[56:59], v[84:87], v[104:107], v[56:59]
    v_mfma_f32_16x16x32_bf16 v[20:23], v[88:91], v[104:107], v[20:23]
    v_mfma_f32_16x16x32_bf16 v[52:55], v[92:95], v[104:107], v[52:55]
    v_xor_b32 v124, 48, v125
    ds_write_b128 v124, v[12:15]
    v_xor_b32 v123, 48, v126
    ds_write_b128 v123, v[44:47]
    v_mfma_f32_16x16x32_bf16 v[28:31], v[80:83], v[108:111], v[28:31]
    v_mfma_f32_16x16x32_bf16 v[60:63], v[84:87], v[108:111], v[60:63]
    v_mfma_f32_16x16x32_bf16 v[24:27], v[88:91], v[108:111], v[24:27]
    v_mfma_f32_16x16x32_bf16 v[56:59], v[92:95], v[108:111], v[56:59]
    v_xor_b32 v123, 64, v125
    ds_write_b128 v123, v[16:19]
    v_xor_b32 v124, 64, v126
    ds_write_b128 v124, v[48:51]
    v_mfma_f32_16x16x32_bf16 v[28:31], v[88:91], v[112:115], v[28:31]
    v_mfma_f32_16x16x32_bf16 v[60:63], v[92:95], v[112:115], v[60:63]
    v_xor_b32 v124, 80, v125
    ds_write_b128 v124, v[20:23]
    v_xor_b32 v123, 80, v126
    ds_write_b128 v123, v[52:55]
    v_and_b32 v108, 15, v127
    v_lshrrev_b32 v109, 4, v127
    v_lshrrev_b32 v110, 3, v108
    s_lshl_b32 s36, s20, 1
    v_add_u32 v110, s36, v110
    v_xor_b32 v111, v110, v108
    v_and_b32 v111, 7, v111
    v_lshlrev_b32 v111, 4, v111
    v_xor_b32 v123, 96, v125
    ds_write_b128 v123, v[24:27]
    v_lshl_add_u32 v111, v110, 7, v111
    v_lshl_add_u32 v120, v109, 11, v111
    v_add_u32 v121, 65536, v120
    v_add_u32 v64, 131072, v120
    s_lshl_b32 s36, s20, 9
    s_add_u32 s36, s36, 115712
    v_lshl_add_u32 v127, v109, 7, s36
    s_lshl_b32 s36, s20, 4
    v_add_u32 v108, s36, v108
    v_lshlrev_b32 v110, 6, v108
    v_lshl_add_u32 v110, v109, 4, v110
    s_mul_i32 s36, s29, 262144
    v_xor_b32 v124, 96, v126
    ds_write_b128 v124, v[56:59]
    s_lshl_b32 s37, s21, 4
    s_add_u32 s36, s36, s37
    v_add_u32 v110, s36, v110
    v_mov_b32 v111, 2130706432
    v_cmp_gt_u32 vcc, 125, v108
    s_mov_b32 s4, 0xbeaaaaab
    s_mov_b32 s5, s4
    s_mov_b32 s6, 0x3e800000
    s_mov_b32 s7, s6
    s_mov_b32 s8, 0xc0a00000
    s_mov_b32 s9, s8
    s_mov_b32 s10, 0xc0638e39
    v_xor_b32 v124, 112, v125
    ds_write_b128 v124, v[28:31]
    s_mov_b32 s11, s10
    s_mov_b32 s12, 0xbf638e39
    s_mov_b32 s13, s12
    s_mov_b32 s14, 0xbe638e39
    s_mov_b32 s15, s14
    s_mov_b32 s22, 0xbd638e39
    s_mov_b32 s23, s22
    s_mov_b32 s24, 0x3ff1c71c
    s_mov_b32 s25, s24
    s_mov_b32 s26, 0xbf2aaaab
    s_mov_b32 s27, s26
    s_mov_b32 s32, 0x3ecccccd
    v_xor_b32 v123, 112, v126
    s_waitcnt lgkmcnt(8)
    ds_write_b128 v123, v[60:63]
    s_mov_b32 s33, s32
    s_mov_b32 s34, 0xbd888889
    s_mov_b32 s35, s34
    s_mov_b32 s38, 0xbe4ccccd
    s_mov_b32 s39, s38
    s_mov_b32 s40, 0xbdd2d3e8
    s_mov_b32 s41, s40
    s_mov_b32 s42, 0x3f800000
    s_mov_b32 s43, s42
    s_setprio 0
    s_branch L_conv2_kernel_epi
L_conv2_kernel_m2:
    s_mul_i32 s37, s38, 2176
    s_add_u32 s37, s37, 98304
    v_add_u32 v116, s37, v8
    v_add_u32 v118, s37, v9
    v_add_u32 v117, 104832, v8
    s_cmp_eq_u32 s38, 0
    s_cbranch_scc1 L_conv2_kernel_hh0
    v_add_u32 v117, 98304, v9
L_conv2_kernel_hh0:
    s_lshl_b32 s37, s38, 12
    s_add_u32 s37, s37, s43
    s_add_u32 s37, s37, 49152
    v_lshl_add_u32 v119, v127, 4, s37
    v_mov_b32 v0, 0
    v_mov_b32 v1, 0
    v_mov_b32 v2, 0
    v_mov_b32 v3, 0
    v_mov_b32 v4, 0
    v_mov_b32 v5, 0
    v_mov_b32 v6, 0
    v_mov_b32 v7, 0
    v_mov_b32 v8, 0
    v_mov_b32 v9, 0
    v_mov_b32 v10, 0
    v_mov_b32 v11, 0
    v_mov_b32 v12, 0
    v_mov_b32 v13, 0
    v_mov_b32 v14, 0
    v_mov_b32 v15, 0
    v_mov_b32 v16, 0
    v_mov_b32 v17, 0
    v_mov_b32 v18, 0
    v_mov_b32 v19, 0
    v_mov_b32 v20, 0
    v_mov_b32 v21, 0
    v_mov_b32 v22, 0
    v_mov_b32 v23, 0
    v_mov_b32 v24, 0
    v_mov_b32 v25, 0
    v_mov_b32 v26, 0
    v_mov_b32 v27, 0
    v_mov_b32 v28, 0
    v_mov_b32 v29, 0
    v_mov_b32 v30, 0
    v_mov_b32 v31, 0
    v_mov_b32 v32, 0
    v_mov_b32 v33, 0
    v_mov_b32 v34, 0
    v_mov_b32 v35, 0
    v_mov_b32 v36, 0
    v_mov_b32 v37, 0
    v_mov_b32 v38, 0
    v_mov_b32 v39, 0
    v_mov_b32 v40, 0
    v_mov_b32 v41, 0
    v_mov_b32 v42, 0
    v_mov_b32 v43, 0
    v_mov_b32 v44, 0
    v_mov_b32 v45, 0
    v_mov_b32 v46, 0
    v_mov_b32 v47, 0
    v_mov_b32 v48, 0
    v_mov_b32 v49, 0
    v_mov_b32 v50, 0
    v_mov_b32 v51, 0
    v_mov_b32 v52, 0
    v_mov_b32 v53, 0
    v_mov_b32 v54, 0
    v_mov_b32 v55, 0
    v_mov_b32 v56, 0
    v_mov_b32 v57, 0
    v_mov_b32 v58, 0
    v_mov_b32 v59, 0
    v_mov_b32 v60, 0
    v_mov_b32 v61, 0
    v_mov_b32 v62, 0
    v_mov_b32 v63, 0
    buffer_load_dwordx4 v[96:99], v108, s[8:11], 0 offen
    buffer_load_dwordx4 v[100:103], v109, s[8:11], 0 offen
    buffer_load_dwordx4 v[104:107], v110, s[8:11], 0 offen
    s_mov_b32 s23, 0
    s_mov_b32 s26, 4096
    buffer_load_dwordx4 v[64:67], v125, s[12:15], s23 offen offset:0
    buffer_load_dwordx4 v[68:71], v125, s[12:15], s23 offen offset:2048
    buffer_load_dwordx4 v[80:83], v119, s[12:15], s23 offen offset:0
    buffer_load_dwordx4 v[72:75], v125, s[12:15], s26 offen offset:0
    buffer_load_dwordx4 v[84:87], v119, s[12:15], s23 offen offset:2048
    buffer_load_dwordx4 v[76:79], v125, s[12:15], s26 offen offset:2048
    s_mov_b32 s23, 57344
    s_mov_b32 s26, 61440
    s_waitcnt vmcnt(6)
    v_lshlrev_b32 v108, 16, v96
    v_and_b32 v111, s25, v96
    v_lshlrev_b32 v109, 16, v100
    v_and_b32 v112, s25, v100
    v_lshlrev_b32 v110, 16, v104
    v_and_b32 v113, s25, v104
    v_mul_f32 v114, s44, v108
    v_mul_f32 v115, s44, v111
    v_fmac_f32 v114, s45, v109
    v_fmac_f32 v115, s45, v112
    v_fmac_f32 v114, s46, v110
    v_fmac_f32 v115, s46, v113
    v_cvt_pk_bf16_f32 v96, v114, v115
    v_lshlrev_b32 v108, 16, v97
    v_and_b32 v111, s25, v97
    v_lshlrev_b32 v109, 16, v101
    v_and_b32 v112, s25, v101
    v_lshlrev_b32 v110, 16, v105
    v_and_b32 v113, s25, v105
    v_mul_f32 v114, s44, v108
    v_mul_f32 v115, s44, v111
    v_fmac_f32 v114, s45, v109
    v_fmac_f32 v115, s45, v112
    v_fmac_f32 v114, s46, v110
    v_fmac_f32 v115, s46, v113
    v_cvt_pk_bf16_f32 v97, v114, v115
    v_lshlrev_b32 v108, 16, v98
    v_and_b32 v111, s25, v98
    v_lshlrev_b32 v109, 16, v102
    v_and_b32 v112, s25, v102
    v_lshlrev_b32 v110, 16, v106
    v_and_b32 v113, s25, v106
    v_mul_f32 v114, s44, v108
    v_mul_f32 v115, s44, v111
    v_fmac_f32 v114, s45, v109
    v_fmac_f32 v115, s45, v112
    v_fmac_f32 v114, s46, v110
    v_fmac_f32 v115, s46, v113
    v_cvt_pk_bf16_f32 v98, v114, v115
    v_lshlrev_b32 v108, 16, v99
    v_and_b32 v111, s25, v99
    v_lshlrev_b32 v109, 16, v103
    v_and_b32 v112, s25, v103
    v_lshlrev_b32 v110, 16, v107
    v_and_b32 v113, s25, v107
    v_mul_f32 v114, s44, v108
    v_mul_f32 v115, s44, v111
    v_fmac_f32 v114, s45, v109
    v_fmac_f32 v115, s45, v112
    v_fmac_f32 v114, s46, v110
    v_fmac_f32 v115, s46, v113
    v_cvt_pk_bf16_f32 v99, v114, v115
    ds_write_b128 v126, v[96:99]
    v_and_b32 v111, 15, v127
    v_lshlrev_b32 v111, 2, v111
    v_add_u32 v111, 99328, v111
    ds_write_b32 v111, v0
    ds_write_b32 v111, v0 offset:8704
    s_waitcnt lgkmcnt(0)
    s_barrier
    s_mov_b32 s22, 4
    s_setprio 2
L_conv2_kernel_mloop2:
    ds_read_b128 v[88:91], v120 offset:0
    ds_read_b128 v[92:95], v120 offset:1024
    ds_read_b128 v[96:99], v116 offset:0
    ds_read_b128 v[100:103], v120 offset:2048
    ds_read_b128 v[104:107], v116 offset:1088
    ds_read_b128 v[108:111], v120 offset:3072
    ds_read_b128 v[112:115], v116 offset:2176
    s_waitcnt vmcnt(5) lgkmcnt(6)
    v_mfma_f32_16x16x32_bf16 v[0:3], v[64:67], v[88:91], v[0:3]
    ds_read_b128 v[88:91], v120 offset:4096
    s_waitcnt vmcnt(4) lgkmcnt(6)
    v_mfma_f32_16x16x32_bf16 v[4:7], v[64:67], v[92:95], v[4:7]
    v_mfma_f32_16x16x32_bf16 v[0:3], v[68:71], v[92:95], v[0:3]
    ds_read_b128 v[92:95], v116 offset:3264
    s_waitcnt vmcnt(3) lgkmcnt(6)
    v_mfma_f32_16x16x32_bf16 v[32:35], v[80:83], v[96:99], v[32:35]
    ds_read_b128 v[96:99], v120 offset:5120
    s_waitcnt vmcnt(2) lgkmcnt(6)
    v_mfma_f32_16x16x32_bf16 v[8:11], v[64:67], v[100:103], v[8:11]
    v_mfma_f32_16x16x32_bf16 v[4:7], v[68:71], v[100:103], v[4:7]
    v_mfma_f32_16x16x32_bf16 v[0:3], v[72:75], v[100:103], v[0:3]
    ds_read_b128 v[100:103], v116 offset:4352
    s_waitcnt vmcnt(1) lgkmcnt(6)
    v_mfma_f32_16x16x32_bf16 v[36:39], v[80:83], v[104:107], v[36:39]
    v_mfma_f32_16x16x32_bf16 v[32:35], v[84:87], v[104:107], v[32:35]
    ds_read_b128 v[104:107], v120 offset:6144
    s_waitcnt vmcnt(0) lgkmcnt(6)
    v_mfma_f32_16x16x32_bf16 v[12:15], v[64:67], v[108:111], v[12:15]
    v_mfma_f32_16x16x32_bf16 v[8:11], v[68:71], v[108:111], v[8:11]
    v_mfma_f32_16x16x32_bf16 v[4:7], v[72:75], v[108:111], v[4:7]
    v_mfma_f32_16x16x32_bf16 v[0:3], v[76:79], v[108:111], v[0:3]
    ds_read_b128 v[108:111], v116 offset:5440
    s_waitcnt lgkmcnt(6)
    v_mfma_f32_16x16x32_bf16 v[40:43], v[80:83], v[112:115], v[40:43]
    v_mfma_f32_16x16x32_bf16 v[36:39], v[84:87], v[112:115], v[36:39]
    ds_read_b128 v[112:115], v120 offset:7168
    s_waitcnt lgkmcnt(6)
    v_mfma_f32_16x16x32_bf16 v[16:19], v[64:67], v[88:91], v[16:19]
    v_mfma_f32_16x16x32_bf16 v[12:15], v[68:71], v[88:91], v[12:15]
    v_mfma_f32_16x16x32_bf16 v[8:11], v[72:75], v[88:91], v[8:11]
    v_mfma_f32_16x16x32_bf16 v[4:7], v[76:79], v[88:91], v[4:7]
    ds_read_b128 v[88:91], v117 offset:0
    s_waitcnt lgkmcnt(6)
    v_mfma_f32_16x16x32_bf16 v[44:47], v[80:83], v[92:95], v[44:47]
    v_mfma_f32_16x16x32_bf16 v[40:43], v[84:87], v[92:95], v[40:43]
    ds_read_b128 v[92:95], v122 offset:0
    v_add_u32 v122, v123, v122
    s_waitcnt lgkmcnt(6)
    v_mfma_f32_16x16x32_bf16 v[20:23], v[64:67], v[96:99], v[20:23]
    v_mfma_f32_16x16x32_bf16 v[16:19], v[68:71], v[96:99], v[16:19]
    v_mfma_f32_16x16x32_bf16 v[12:15], v[72:75], v[96:99], v[12:15]
    v_mfma_f32_16x16x32_bf16 v[8:11], v[76:79], v[96:99], v[8:11]
    ds_read_b128 v[96:99], v117 offset:1088
    s_waitcnt lgkmcnt(6)
    v_mfma_f32_16x16x32_bf16 v[48:51], v[80:83], v[100:103], v[48:51]
    v_mfma_f32_16x16x32_bf16 v[44:47], v[84:87], v[100:103], v[44:47]
    ds_read_b128 v[100:103], v121 offset:1024
    s_waitcnt lgkmcnt(6)
    v_mfma_f32_16x16x32_bf16 v[24:27], v[64:67], v[104:107], v[24:27]
    v_mfma_f32_16x16x32_bf16 v[20:23], v[68:71], v[104:107], v[20:23]
    v_mfma_f32_16x16x32_bf16 v[16:19], v[72:75], v[104:107], v[16:19]
    v_mfma_f32_16x16x32_bf16 v[12:15], v[76:79], v[104:107], v[12:15]
    ds_read_b128 v[104:107], v118 offset:0
    s_waitcnt lgkmcnt(6)
    v_mfma_f32_16x16x32_bf16 v[52:55], v[80:83], v[108:111], v[52:55]
    v_mfma_f32_16x16x32_bf16 v[48:51], v[84:87], v[108:111], v[48:51]
    ds_read_b128 v[108:111], v121 offset:2048
    s_waitcnt lgkmcnt(6)
    v_mfma_f32_16x16x32_bf16 v[28:31], v[64:67], v[112:115], v[28:31]
    v_mfma_f32_16x16x32_bf16 v[24:27], v[68:71], v[112:115], v[24:27]
    v_mfma_f32_16x16x32_bf16 v[20:23], v[72:75], v[112:115], v[20:23]
    v_mfma_f32_16x16x32_bf16 v[16:19], v[76:79], v[112:115], v[16:19]
    buffer_load_dwordx4 v[64:67], v125, s[12:15], s23 offen offset:0
    s_waitcnt lgkmcnt(5)
    v_mfma_f32_16x16x32_bf16 v[56:59], v[80:83], v[88:91], v[56:59]
    v_mfma_f32_16x16x32_bf16 v[52:55], v[84:87], v[88:91], v[52:55]
    s_waitcnt lgkmcnt(0)
    s_barrier
    v_mfma_f32_16x16x32_bf16 v[28:31], v[68:71], v[92:95], v[28:31]
    v_mfma_f32_16x16x32_bf16 v[24:27], v[72:75], v[92:95], v[24:27]
    v_mfma_f32_16x16x32_bf16 v[20:23], v[76:79], v[92:95], v[20:23]
    buffer_load_dwordx4 v[68:71], v125, s[12:15], s23 offen offset:2048
    v_mfma_f32_16x16x32_bf16 v[60:63], v[80:83], v[96:99], v[60:63]
    v_mfma_f32_16x16x32_bf16 v[56:59], v[84:87], v[96:99], v[56:59]
    buffer_load_dwordx4 v[80:83], v119, s[12:15], s23 offen offset:0
    v_mfma_f32_16x16x32_bf16 v[28:31], v[72:75], v[100:103], v[28:31]
    v_mfma_f32_16x16x32_bf16 v[24:27], v[76:79], v[100:103], v[24:27]
    buffer_load_dwordx4 v[72:75], v125, s[12:15], s26 offen offset:0
    v_mfma_f32_16x16x32_bf16 v[60:63], v[84:87], v[104:107], v[60:63]
    buffer_load_dwordx4 v[84:87], v119, s[12:15], s23 offen offset:2048
    v_mfma_f32_16x16x32_bf16 v[28:31], v[76:79], v[108:111], v[28:31]
    buffer_load_dwordx4 v[76:79], v125, s[12:15], s26 offen offset:2048
    s_add_u32 s23, s23, 57344
    s_add_u32 s26, s26, 57344
    s_sub_u32 s22, s22, 1
    s_cmp_eq_u32 s22, 0
    s_cbranch_scc1 L_conv2_kernel_mlast2
    ds_read_b128 v[88:91], v120 offset:8192
    ds_read_b128 v[92:95], v120 offset:9216
    ds_read_b128 v[96:99], v116 offset:8704
    ds_read_b128 v[100:103], v120 offset:10240
    ds_read_b128 v[104:107], v116 offset:9792
    ds_read_b128 v[108:111], v120 offset:11264
    ds_read_b128 v[112:115], v116 offset:10880
    s_waitcnt vmcnt(5) lgkmcnt(6)
    v_mfma_f32_16x16x32_bf16 v[0:3], v[64:67], v[88:91], v[0:3]
    ds_read_b128 v[88:91], v120 offset:12288
    s_waitcnt vmcnt(4) lgkmcnt(6)
    v_mfma_f32_16x16x32_bf16 v[4:7], v[64:67], v[92:95], v[4:7]
    v_mfma_f32_16x16x32_bf16 v[0:3], v[68:71], v[92:95], v[0:3]
    ds_read_b128 v[92:95], v116 offset:11968
    s_waitcnt vmcnt(3) lgkmcnt(6)
    v_mfma_f32_16x16x32_bf16 v[32:35], v[80:83], v[96:99], v[32:35]
    ds_read_b128 v[96:99], v120 offset:13312
    s_waitcnt vmcnt(2) lgkmcnt(6)
    v_mfma_f32_16x16x32_bf16 v[8:11], v[64:67], v[100:103], v[8:11]
    v_mfma_f32_16x16x32_bf16 v[4:7], v[68:71], v[100:103], v[4:7]
    v_mfma_f32_16x16x32_bf16 v[0:3], v[72:75], v[100:103], v[0:3]
    ds_read_b128 v[100:103], v116 offset:13056
    s_waitcnt vmcnt(1) lgkmcnt(6)
    v_mfma_f32_16x16x32_bf16 v[36:39], v[80:83], v[104:107], v[36:39]
    v_mfma_f32_16x16x32_bf16 v[32:35], v[84:87], v[104:107], v[32:35]
    ds_read_b128 v[104:107], v120 offset:14336
    s_waitcnt vmcnt(0) lgkmcnt(6)
    v_mfma_f32_16x16x32_bf16 v[12:15], v[64:67], v[108:111], v[12:15]
    v_mfma_f32_16x16x32_bf16 v[8:11], v[68:71], v[108:111], v[8:11]
    v_mfma_f32_16x16x32_bf16 v[4:7], v[72:75], v[108:111], v[4:7]
    v_mfma_f32_16x16x32_bf16 v[0:3], v[76:79], v[108:111], v[0:3]
    ds_read_b128 v[108:111], v116 offset:14144
    s_waitcnt lgkmcnt(6)
    v_mfma_f32_16x16x32_bf16 v[40:43], v[80:83], v[112:115], v[40:43]
    v_mfma_f32_16x16x32_bf16 v[36:39], v[84:87], v[112:115], v[36:39]
    ds_read_b128 v[112:115], v120 offset:15360
    s_waitcnt lgkmcnt(6)
    v_mfma_f32_16x16x32_bf16 v[16:19], v[64:67], v[88:91], v[16:19]
    v_mfma_f32_16x16x32_bf16 v[12:15], v[68:71], v[88:91], v[12:15]
    v_mfma_f32_16x16x32_bf16 v[8:11], v[72:75], v[88:91], v[8:11]
    v_mfma_f32_16x16x32_bf16 v[4:7], v[76:79], v[88:91], v[4:7]
    ds_read_b128 v[88:91], v117 offset:8704
    s_waitcnt lgkmcnt(6)
    v_mfma_f32_16x16x32_bf16 v[44:47], v[80:83], v[92:95], v[44:47]
    v_mfma_f32_16x16x32_bf16 v[40:43], v[84:87], v[92:95], v[40:43]
    ds_read_b128 v[92:95], v122 offset:0
    v_add_u32 v122, v124, v122
    s_waitcnt lgkmcnt(6)
    v_mfma_f32_16x16x32_bf16 v[20:23], v[64:67], v[96:99], v[20:23]
    v_mfma_f32_16x16x32_bf16 v[16:19], v[68:71], v[96:99], v[16:19]
    v_mfma_f32_16x16x32_bf16 v[12:15], v[72:75], v[96:99], v[12:15]
    v_mfma_f32_16x16x32_bf16 v[8:11], v[76:79], v[96:99], v[8:11]
    ds_read_b128 v[96:99], v117 offset:9792
    s_waitcnt lgkmcnt(6)
    v_mfma_f32_16x16x32_bf16 v[48:51], v[80:83], v[100:103], v[48:51]
    v_mfma_f32_16x16x32_bf16 v[44:47], v[84:87], v[100:103], v[44:47]
    ds_read_b128 v[100:103], v121 offset:9216
    s_waitcnt lgkmcnt(6)
    v_mfma_f32_16x16x32_bf16 v[24:27], v[64:67], v[104:107], v[24:27]
    v_mfma_f32_16x16x32_bf16 v[20:23], v[68:71], v[104:107], v[20:23]
    v_mfma_f32_16x16x32_bf16 v[16:19], v[72:75], v[104:107], v[16:19]
    v_mfma_f32_16x16x32_bf16 v[12:15], v[76:79], v[104:107], v[12:15]
    ds_read_b128 v[104:107], v118 offset:8704
    s_waitcnt lgkmcnt(6)
    v_mfma_f32_16x16x32_bf16 v[52:55], v[80:83], v[108:111], v[52:55]
    v_mfma_f32_16x16x32_bf16 v[48:51], v[84:87], v[108:111], v[48:51]
    ds_read_b128 v[108:111], v121 offset:10240
    s_waitcnt lgkmcnt(6)
    v_mfma_f32_16x16x32_bf16 v[28:31], v[64:67], v[112:115], v[28:31]
    v_mfma_f32_16x16x32_bf16 v[24:27], v[68:71], v[112:115], v[24:27]
    v_mfma_f32_16x16x32_bf16 v[20:23], v[72:75], v[112:115], v[20:23]
    v_mfma_f32_16x16x32_bf16 v[16:19], v[76:79], v[112:115], v[16:19]
    buffer_load_dwordx4 v[64:67], v125, s[12:15], s23 offen offset:0
    s_waitcnt lgkmcnt(5)
    v_mfma_f32_16x16x32_bf16 v[56:59], v[80:83], v[88:91], v[56:59]
    v_mfma_f32_16x16x32_bf16 v[52:55], v[84:87], v[88:91], v[52:55]
    s_waitcnt lgkmcnt(0)
    s_barrier
    v_mfma_f32_16x16x32_bf16 v[28:31], v[68:71], v[92:95], v[28:31]
    v_mfma_f32_16x16x32_bf16 v[24:27], v[72:75], v[92:95], v[24:27]
    v_mfma_f32_16x16x32_bf16 v[20:23], v[76:79], v[92:95], v[20:23]
    buffer_load_dwordx4 v[68:71], v125, s[12:15], s23 offen offset:2048
    v_mfma_f32_16x16x32_bf16 v[60:63], v[80:83], v[96:99], v[60:63]
    v_mfma_f32_16x16x32_bf16 v[56:59], v[84:87], v[96:99], v[56:59]
    buffer_load_dwordx4 v[80:83], v119, s[12:15], s23 offen offset:0
    v_mfma_f32_16x16x32_bf16 v[28:31], v[72:75], v[100:103], v[28:31]
    v_mfma_f32_16x16x32_bf16 v[24:27], v[76:79], v[100:103], v[24:27]
    buffer_load_dwordx4 v[72:75], v125, s[12:15], s26 offen offset:0
    v_mfma_f32_16x16x32_bf16 v[60:63], v[84:87], v[104:107], v[60:63]
    buffer_load_dwordx4 v[84:87], v119, s[12:15], s23 offen offset:2048
    v_mfma_f32_16x16x32_bf16 v[28:31], v[76:79], v[108:111], v[28:31]
    buffer_load_dwordx4 v[76:79], v125, s[12:15], s26 offen offset:2048
    s_add_u32 s23, s23, 57344
    s_add_u32 s26, s26, 57344
    s_branch L_conv2_kernel_mloop2
L_conv2_kernel_mlast2:
    v_and_b32 v125, 15, v127
    v_and_b32 v126, 7, v127
    v_lshlrev_b32 v126, 4, v126
    v_lshl_add_u32 v125, v125, 7, v126
    v_lshrrev_b32 v126, 4, v127
    v_lshl_add_u32 v125, v126, 11, v125
    s_mov_b32 s36, 65536
    s_cmp_eq_u32 s32, 1
    s_cselect_b32 s36, 121856, s36
    s_cmp_eq_u32 s32, 2
    s_cselect_b32 s36, 81920, s36
    s_cmp_eq_u32 s32, 3
    s_cselect_b32 s36, 130048, s36
    s_mov_b32 s37, 98304
    s_cmp_eq_u32 s32, 1
    s_cselect_b32 s37, 138240, s37
    s_cmp_eq_u32 s32, 2
    s_cselect_b32 s37, 146432, s37
    s_cmp_eq_u32 s32, 3
    s_cselect_b32 s37, 154624, s37
    v_add_u32 v126, s37, v125
    v_add_u32 v125, s36, v125
    ds_read_b128 v[88:91], v120 offset:8192
    ds_read_b128 v[92:95], v120 offset:9216
    ds_read_b128 v[96:99], v116 offset:8704
    ds_read_b128 v[100:103], v120 offset:10240
    ds_read_b128 v[104:107], v116 offset:9792
    ds_read_b128 v[108:111], v120 offset:11264
    ds_read_b128 v[112:115], v116 offset:10880
    s_waitcnt vmcnt(5) lgkmcnt(6)
    v_mfma_f32_16x16x32_bf16 v[0:3], v[64:67], v[88:91], v[0:3]
    ds_read_b128 v[88:91], v120 offset:12288
    s_waitcnt vmcnt(4) lgkmcnt(6)
    v_mfma_f32_16x16x32_bf16 v[4:7], v[64:67], v[92:95], v[4:7]
    v_mfma_f32_16x16x32_bf16 v[0:3], v[68:71], v[92:95], v[0:3]
    ds_read_b128 v[92:95], v116 offset:11968
    s_waitcnt vmcnt(3) lgkmcnt(6)
    v_mfma_f32_16x16x32_bf16 v[32:35], v[80:83], v[96:99], v[32:35]
    ds_read_b128 v[96:99], v120 offset:13312
    s_waitcnt vmcnt(2) lgkmcnt(6)
    v_mfma_f32_16x16x32_bf16 v[8:11], v[64:67], v[100:103], v[8:11]
    v_mfma_f32_16x16x32_bf16 v[4:7], v[68:71], v[100:103], v[4:7]
    v_mfma_f32_16x16x32_bf16 v[0:3], v[72:75], v[100:103], v[0:3]
    ds_read_b128 v[100:103], v116 offset:13056
    s_waitcnt vmcnt(1) lgkmcnt(6)
    v_mfma_f32_16x16x32_bf16 v[36:39], v[80:83], v[104:107], v[36:39]
    v_mfma_f32_16x16x32_bf16 v[32:35], v[84:87], v[104:107], v[32:35]
    ds_read_b128 v[104:107], v120 offset:14336
    s_waitcnt vmcnt(0) lgkmcnt(6)
    v_mfma_f32_16x16x32_bf16 v[12:15], v[64:67], v[108:111], v[12:15]
    v_mfma_f32_16x16x32_bf16 v[8:11], v[68:71], v[108:111], v[8:11]
    v_mfma_f32_16x16x32_bf16 v[4:7], v[72:75], v[108:111], v[4:7]
    v_mfma_f32_16x16x32_bf16 v[0:3], v[76:79], v[108:111], v[0:3]
    ds_read_b128 v[108:111], v116 offset:14144
    s_waitcnt lgkmcnt(6)
    v_mfma_f32_16x16x32_bf16 v[40:43], v[80:83], v[112:115], v[40:43]
    v_mfma_f32_16x16x32_bf16 v[36:39], v[84:87], v[112:115], v[36:39]
    ds_read_b128 v[112:115], v120 offset:15360
    s_waitcnt lgkmcnt(6)
    v_mfma_f32_16x16x32_bf16 v[16:19], v[64:67], v[88:91], v[16:19]
    v_mfma_f32_16x16x32_bf16 v[12:15], v[68:71], v[88:91], v[12:15]
    v_mfma_f32_16x16x32_bf16 v[8:11], v[72:75], v[88:91], v[8:11]
    v_mfma_f32_16x16x32_bf16 v[4:7], v[76:79], v[88:91], v[4:7]
    ds_read_b128 v[88:91], v117 offset:8704
    v_xor_b32 v124, 0, v126
    ds_write_b128 v124, v[32:35]
    s_waitcnt lgkmcnt(7)
    v_mfma_f32_16x16x32_bf16 v[44:47], v[80:83], v[92:95], v[44:47]
    v_mfma_f32_16x16x32_bf16 v[40:43], v[84:87], v[92:95], v[40:43]
    ds_read_b128 v[92:95], v122 offset:0
    v_xor_b32 v123, 0, v125
    ds_write_b128 v123, v[0:3]
    s_waitcnt lgkmcnt(8)
    v_mfma_f32_16x16x32_bf16 v[20:23], v[64:67], v[96:99], v[20:23]
    v_mfma_f32_16x16x32_bf16 v[16:19], v[68:71], v[96:99], v[16:19]
    v_mfma_f32_16x16x32_bf16 v[12:15], v[72:75], v[96:99], v[12:15]
    v_mfma_f32_16x16x32_bf16 v[8:11], v[76:79], v[96:99], v[8:11]
    ds_read_b128 v[96:99], v117 offset:9792
    v_xor_b32 v123, 16, v126
    ds_write_b128 v123, v[36:39]
    s_waitcnt lgkmcnt(9)
    v_mfma_f32_16x16x32_bf16 v[48:51], v[80:83], v[100:103], v[48:51]
    v_mfma_f32_16x16x32_bf16 v[44:47], v[84:87], v[100:103], v[44:47]
    ds_read_b128 v[100:103], v121 offset:9216
    v_xor_b32 v124, 16, v125
    ds_write_b128 v124, v[4:7]
    s_waitcnt lgkmcnt(10)
    v_mfma_f32_16x16x32_bf16 v[24:27], v[64:67], v[104:107], v[24:27]
    v_mfma_f32_16x16x32_bf16 v[20:23], v[68:71], v[104:107], v[20:23]
    v_mfma_f32_16x16x32_bf16 v[16:19], v[72:75], v[104:107], v[16:19]
    v_mfma_f32_16x16x32_bf16 v[12:15], v[76:79], v[104:107], v[12:15]
    ds_read_b128 v[104:107], v118 offset:8704
    v_xor_b32 v124, 32, v126
    ds_write_b128 v124, v[40:43]
    s_waitcnt lgkmcnt(11)
    v_mfma_f32_16x16x32_bf16 v[52:55], v[80:83], v[108:111], v[52:55]
    v_mfma_f32_16x16x32_bf16 v[48:51], v[84:87], v[108:111], v[48:51]
    ds_read_b128 v[108:111], v121 offset:10240
    v_xor_b32 v123, 32, v125
    ds_write_b128 v123, v[8:11]
    s_waitcnt lgkmcnt(12)
    v_mfma_f32_16x16x32_bf16 v[28:31], v[64:67], v[112:115], v[28:31]
    v_mfma_f32_16x16x32_bf16 v[24:27], v[68:71], v[112:115], v[24:27]
    v_mfma_f32_16x16x32_bf16 v[20:23], v[72:75], v[112:115], v[20:23]
    v_mfma_f32_16x16x32_bf16 v[16:19], v[76:79], v[112:115], v[16:19]
    v_xor_b32 v123, 48, v126
    ds_write_b128 v123, v[44:47]
    s_waitcnt lgkmcnt(12)
    v_mfma_f32_16x16x32_bf16 v[56:59], v[80:83], v[88:91], v[56:59]
    v_mfma_f32_16x16x32_bf16 v[52:55], v[84:87], v[88:91], v[52:55]
    v_xor_b32 v124, 48, v125
    ds_write_b128 v124, v[12:15]
    s_waitcnt lgkmcnt(11)
    v_mfma_f32_16x16x32_bf16 v[28:31], v[68:71], v[92:95], v[28:31]
    v_mfma_f32_16x16x32_bf16 v[24:27], v[72:75], v[92:95], v[24:27]
    v_mfma_f32_16x16x32_bf16 v[20:23], v[76:79], v[92:95], v[20:23]
    v_xor_b32 v124, 64, v126
    ds_write_b128 v124, v[48:51]
    s_waitcnt lgkmcnt(10)
    v_mfma_f32_16x16x32_bf16 v[60:63], v[80:83], v[96:99], v[60:63]
    v_mfma_f32_16x16x32_bf16 v[56:59], v[84:87], v[96:99], v[56:59]
    v_xor_b32 v123, 64, v125
    ds_write_b128 v123, v[16:19]
    s_waitcnt lgkmcnt(9)
    v_mfma_f32_16x16x32_bf16 v[28:31], v[72:75], v[100:103], v[28:31]
    v_mfma_f32_16x16x32_bf16 v[24:27], v[76:79], v[100:103], v[24:27]
    v_xor_b32 v123, 80, v126
    ds_write_b128 v123, v[52:55]
    s_waitcnt lgkmcnt(8)
    v_mfma_f32_16x16x32_bf16 v[60:63], v[84:87], v[104:107], v[60:63]
    v_xor_b32 v124, 80, v125
    ds_write_b128 v124, v[20:23]
    s_waitcnt lgkmcnt(7)
    v_mfma_f32_16x16x32_bf16 v[28:31], v[76:79], v[108:111], v[28:31]
    v_xor_b32 v124, 96, v126
    ds_write_b128 v124, v[56:59]
    v_and_b32 v108, 15, v127
    v_lshrrev_b32 v109, 4, v127
    v_lshrrev_b32 v110, 3, v108
    s_lshl_b32 s36, s20, 1
    v_add_u32 v110, s36, v110
    v_xor_b32 v111, v110, v108
    v_and_b32 v111, 7, v111
    v_lshlrev_b32 v111, 4, v111
    v_xor_b32 v123, 96, v125
    ds_write_b128 v123, v[24:27]
    v_lshl_add_u32 v111, v110, 7, v111
    v_lshl_add_u32 v120, v109, 11, v111
    v_add_u32 v121, 65536, v120
    v_add_u32 v64, 131072, v120
    s_lshl_b32 s36, s20, 9
    s_add_u32 s36, s36, 115712
    v_lshl_add_u32 v127, v109, 7, s36
    s_lshl_b32 s36, s20, 4
    v_add_u32 v108, s36, v108
    v_lshlrev_b32 v110, 6, v108
    v_lshl_add_u32 v110, v109, 4, v110
    s_mul_i32 s36, s29, 262144
    v_xor_b32 v123, 112, v126
    ds_write_b128 v123, v[60:63]
    s_lshl_b32 s37, s21, 4
    s_add_u32 s36, s36, s37
    v_add_u32 v110, s36, v110
    v_mov_b32 v111, 2130706432
    v_cmp_gt_u32 vcc, 125, v108
    s_mov_b32 s4, 0xbeaaaaab
    s_mov_b32 s5, s4
    s_mov_b32 s6, 0x3e800000
    s_mov_b32 s7, s6
    s_mov_b32 s8, 0xc0a00000
    s_mov_b32 s9, s8
    s_mov_b32 s10, 0xc0638e39
    v_xor_b32 v124, 112, v125
    ds_write_b128 v124, v[28:31]
    s_mov_b32 s11, s10
    s_mov_b32 s12, 0xbf638e39
    s_mov_b32 s13, s12
    s_mov_b32 s14, 0xbe638e39
    s_mov_b32 s15, s14
    s_mov_b32 s22, 0xbd638e39
    s_mov_b32 s23, s22
    s_mov_b32 s24, 0x3ff1c71c
    s_mov_b32 s25, s24
    s_mov_b32 s26, 0xbf2aaaab
    s_mov_b32 s27, s26
    s_mov_b32 s32, 0x3ecccccd
    s_mov_b32 s33, s32
    s_mov_b32 s34, 0xbd888889
    s_mov_b32 s35, s34
    s_mov_b32 s38, 0xbe4ccccd
    s_mov_b32 s39, s38
    s_mov_b32 s40, 0xbdd2d3e8
    s_mov_b32 s41, s40
    s_mov_b32 s42, 0x3f800000
    s_mov_b32 s43, s42
    s_setprio 0
    s_branch L_conv2_kernel_epi
L_conv2_kernel_helper:
    s_setprio 3
    v_lshlrev_b32 v8, 4, v6
    s_add_u32 s37, s33, 4294967289
    v_lshl_add_u32 v9, v7, 3, s37
    v_cmp_gt_u32 vcc, 8000, v9
    s_mul_i32 s37, s33, 131072
    s_add_u32 s37, s37, 0
    v_lshl_add_u32 v92, v7, 7, s37
    v_add_u32 v92, v92, v8
    v_mov_b32 v9, 2130706432
    v_cndmask_b32 v92, v9, v92, vcc
    s_add_u32 s37, s33, 4294967291
    v_lshl_add_u32 v9, v7, 3, s37
    v_cmp_gt_u32 vcc, 8000, v9
    s_mul_i32 s37, s33, 131072
    s_add_u32 s37, s37, 262144
    v_lshl_add_u32 v93, v7, 7, s37
    v_add_u32 v93, v93, v8
    v_mov_b32 v9, 2130706432
    v_cndmask_b32 v93, v9, v93, vcc
    s_add_u32 s37, s33, 4294967293
    v_lshl_add_u32 v9, v7, 3, s37
    v_cmp_gt_u32 vcc, 8000, v9
    s_mul_i32 s37, s33, 131072
    s_add_u32 s37, s37, 64
    v_lshl_add_u32 v94, v7, 7, s37
    v_add_u32 v94, v94, v8
    v_mov_b32 v9, 2130706432
    v_cndmask_b32 v94, v9, v94, vcc
    s_add_u32 s37, s33, 4294967295
    v_lshl_add_u32 v9, v7, 3, s37
    v_cmp_gt_u32 vcc, 8000, v9
    s_mul_i32 s37, s33, 131072
    s_add_u32 s37, s37, 262208
    v_lshl_add_u32 v95, v7, 7, s37
    v_add_u32 v95, v95, v8
    v_mov_b32 v9, 2130706432
    v_cndmask_b32 v95, v9, v95, vcc
    v_and_b32 v76, 4, v5
    v_lshrrev_b32 v76, 1, v76
    v_xor_b32 v76, v6, v76
    v_lshlrev_b32 v76, 4, v76
    v_lshl_add_u32 v76, v5, 6, v76
    s_mov_b32 s24, 0
    s_mov_b32 s27, 524288
    s_waitcnt lgkmcnt(0)
    s_add_u32 s8, s4, s47
    s_addc_u32 s9, s5, 0
    buffer_load_dwordx4 v[0:3], v92, s[8:11], s24 offen
    buffer_load_dwordx4 v[8:11], v94, s[8:11], s24 offen
    buffer_load_dwordx4 v[4:7], v93, s[8:11], s24 offen
    buffer_load_dwordx4 v[12:15], v95, s[8:11], s24 offen
    buffer_load_dwordx4 v[16:19], v92, s[8:11], s27 offen
    buffer_load_dwordx4 v[24:27], v94, s[8:11], s27 offen
    buffer_load_dwordx4 v[20:23], v93, s[8:11], s27 offen
    buffer_load_dwordx4 v[28:31], v95, s[8:11], s27 offen
    s_mul_i32 s36, s42, 1024
    v_add_u32 v96, s36, v76
    v_add_u32 v97, 65536, v96
    s_mul_i32 s36, s42, 1088
    s_add_u32 s36, s36, 98304
    v_add_u32 v98, s36, v76
    s_waitcnt vmcnt(0)
    s_mov_b32 s28, 0
    s_mov_b32 s22, 2
    s_cmp_ge_u32 s20, 12
    s_cbranch_scc1 L_conv2_kernel_h2
    ds_write_b128 v96, v[0:3] offset:0
    ds_write_b128 v98, v[12:15] offset:0
    v_lshlrev_b32 v76, 16, v0
    v_and_b32 v84, s25, v0
    v_lshlrev_b32 v77, 16, v4
    v_and_b32 v85, s25, v4
    v_lshlrev_b32 v78, 16, v8
    v_and_b32 v86, s25, v8
    v_lshlrev_b32 v79, 16, v12
    v_and_b32 v87, s25, v12
    v_add_f32 v80, v76, v78
    v_add_f32 v88, v84, v86
    v_add_f32 v81, v77, v79
    v_add_f32 v89, v85, v87
    v_fma_f32 v82, v78, 4.0, v76
    v_fma_f32 v90, v86, 4.0, v84
    v_fma_f32 v83, v79, 4.0, v77
    v_fma_f32 v91, v87, 4.0, v85
    v_add_f32 v77, v80, v81
    v_add_f32 v85, v88, v89
    v_sub_f32 v78, v80, v81
    v_sub_f32 v86, v88, v89
    v_fma_f32 v79, v83, 2.0, v82
    v_fma_f32 v87, v91, 2.0, v90
    v_fma_f32 v82, v83, -2.0, v82
    v_fma_f32 v90, v91, -2.0, v90
    v_fmamk_f32 v80, v76, 0x41700000, v82
    v_fmamk_f32 v88, v84, 0x41700000, v90
    v_fmamk_f32 v80, v81, 0x41200000, v80
    v_fmamk_f32 v88, v89, 0x41200000, v88
    v_cvt_pk_bf16_f32 v4, v77, v85
    v_cvt_pk_bf16_f32 v8, v78, v86
    v_cvt_pk_bf16_f32 v64, v79, v87
    v_cvt_pk_bf16_f32 v68, v82, v90
    v_cvt_pk_bf16_f32 v72, v80, v88
    v_lshlrev_b32 v76, 16, v1
    v_and_b32 v84, s25, v1
    v_lshlrev_b32 v77, 16, v5
    v_and_b32 v85, s25, v5
    v_lshlrev_b32 v78, 16, v9
    v_and_b32 v86, s25, v9
    v_lshlrev_b32 v79, 16, v13
    v_and_b32 v87, s25, v13
    v_add_f32 v80, v76, v78
    v_add_f32 v88, v84, v86
    v_add_f32 v81, v77, v79
    v_add_f32 v89, v85, v87
    v_fma_f32 v82, v78, 4.0, v76
    v_fma_f32 v90, v86, 4.0, v84
    v_fma_f32 v83, v79, 4.0, v77
    v_fma_f32 v91, v87, 4.0, v85
    v_add_f32 v77, v80, v81
    v_add_f32 v85, v88, v89
    v_sub_f32 v78, v80, v81
    v_sub_f32 v86, v88, v89
    v_fma_f32 v79, v83, 2.0, v82
    v_fma_f32 v87, v91, 2.0, v90
    v_fma_f32 v82, v83, -2.0, v82
    v_fma_f32 v90, v91, -2.0, v90
    v_fmamk_f32 v80, v76, 0x41700000, v82
    v_fmamk_f32 v88, v84, 0x41700000, v90
    v_fmamk_f32 v80, v81, 0x41200000, v80
    v_fmamk_f32 v88, v89, 0x41200000, v88
    v_cvt_pk_bf16_f32 v5, v77, v85
    v_cvt_pk_bf16_f32 v9, v78, v86
    v_cvt_pk_bf16_f32 v65, v79, v87
    v_cvt_pk_bf16_f32 v69, v82, v90
    v_cvt_pk_bf16_f32 v73, v80, v88
    v_lshlrev_b32 v76, 16, v2
    v_and_b32 v84, s25, v2
    v_lshlrev_b32 v77, 16, v6
    v_and_b32 v85, s25, v6
    v_lshlrev_b32 v78, 16, v10
    v_and_b32 v86, s25, v10
    v_lshlrev_b32 v79, 16, v14
    v_and_b32 v87, s25, v14
    v_add_f32 v80, v76, v78
    v_add_f32 v88, v84, v86
    v_add_f32 v81, v77, v79
    v_add_f32 v89, v85, v87
    v_fma_f32 v82, v78, 4.0, v76
    v_fma_f32 v90, v86, 4.0, v84
    v_fma_f32 v83, v79, 4.0, v77
    v_fma_f32 v91, v87, 4.0, v85
    v_add_f32 v77, v80, v81
    v_add_f32 v85, v88, v89
    v_sub_f32 v78, v80, v81
    v_sub_f32 v86, v88, v89
    v_fma_f32 v79, v83, 2.0, v82
    v_fma_f32 v87, v91, 2.0, v90
    v_fma_f32 v82, v83, -2.0, v82
    v_fma_f32 v90, v91, -2.0, v90
    v_fmamk_f32 v80, v76, 0x41700000, v82
    v_fmamk_f32 v88, v84, 0x41700000, v90
    v_fmamk_f32 v80, v81, 0x41200000, v80
    v_fmamk_f32 v88, v89, 0x41200000, v88
    v_cvt_pk_bf16_f32 v6, v77, v85
    v_cvt_pk_bf16_f32 v10, v78, v86
    v_cvt_pk_bf16_f32 v66, v79, v87
    v_cvt_pk_bf16_f32 v70, v82, v90
    v_cvt_pk_bf16_f32 v74, v80, v88
    v_lshlrev_b32 v76, 16, v3
    v_and_b32 v84, s25, v3
    v_lshlrev_b32 v77, 16, v7
    v_and_b32 v85, s25, v7
    v_lshlrev_b32 v78, 16, v11
    v_and_b32 v86, s25, v11
    v_lshlrev_b32 v79, 16, v15
    v_and_b32 v87, s25, v15
    v_add_f32 v80, v76, v78
    v_add_f32 v88, v84, v86
    v_add_f32 v81, v77, v79
    v_add_f32 v89, v85, v87
    v_fma_f32 v82, v78, 4.0, v76
    v_fma_f32 v90, v86, 4.0, v84
    v_fma_f32 v83, v79, 4.0, v77
    v_fma_f32 v91, v87, 4.0, v85
    v_add_f32 v77, v80, v81
    v_add_f32 v85, v88, v89
    v_sub_f32 v78, v80, v81
    v_sub_f32 v86, v88, v89
    v_fma_f32 v79, v83, 2.0, v82
    v_fma_f32 v87, v91, 2.0, v90
    v_fma_f32 v82, v83, -2.0, v82
    v_fma_f32 v90, v91, -2.0, v90
    v_fmamk_f32 v80, v76, 0x41700000, v82
    v_fmamk_f32 v88, v84, 0x41700000, v90
    v_fmamk_f32 v80, v81, 0x41200000, v80
    v_fmamk_f32 v88, v89, 0x41200000, v88
    v_cvt_pk_bf16_f32 v7, v77, v85
    v_cvt_pk_bf16_f32 v11, v78, v86
    v_cvt_pk_bf16_f32 v67, v79, v87
    v_cvt_pk_bf16_f32 v71, v82, v90
    v_cvt_pk_bf16_f32 v75, v80, v88
    ds_write_b128 v96, v[64:67] offset:49152
    ds_write_b128 v97, v[68:71] offset:0
    ds_write_b128 v97, v[72:75] offset:16384
    ds_write_b128 v96, v[4:7] offset:16384
    ds_write_b128 v96, v[8:11] offset:32768
    s_waitcnt vmcnt(0)
    s_mov_b32 s24, 1048576
    s_mov_b32 s27, 1572864
    s_waitcnt lgkmcnt(0)
    s_barrier
    buffer_load_dwordx4 v[32:35], v92, s[8:11], s24 offen
    buffer_load_dwordx4 v[40:43], v94, s[8:11], s24 offen
    buffer_load_dwordx4 v[36:39], v93, s[8:11], s24 offen
    buffer_load_dwordx4 v[44:47], v95, s[8:11], s24 offen
    s_setprio 1
L_conv2_kernel_hloop1:
    v_lshlrev_b32 v76, 16, v16
    v_and_b32 v84, s25, v16
    v_lshlrev_b32 v77, 16, v20
    v_and_b32 v85, s25, v20
    v_lshlrev_b32 v78, 16, v24
    v_and_b32 v86, s25, v24
    v_lshlrev_b32 v79, 16, v28
    v_and_b32 v87, s25, v28
    v_add_f32 v80, v76, v78
    v_add_f32 v88, v84, v86
    v_add_f32 v81, v77, v79
    v_add_f32 v89, v85, v87
    v_fma_f32 v82, v78, 4.0, v76
    buffer_load_dwordx4 v[48:51], v92, s[8:11], s27 offen
    buffer_load_dwordx4 v[56:59], v94, s[8:11], s27 offen
    v_fma_f32 v90, v86, 4.0, v84
    v_fma_f32 v83, v79, 4.0, v77
    v_fma_f32 v91, v87, 4.0, v85
    v_add_f32 v77, v80, v81
    v_add_f32 v85, v88, v89
    v_sub_f32 v78, v80, v81
    v_sub_f32 v86, v88, v89
    v_fma_f32 v79, v83, 2.0, v82
    v_fma_f32 v87, v91, 2.0, v90
    v_fma_f32 v82, v83, -2.0, v82
    v_fma_f32 v90, v91, -2.0, v90
    v_fmamk_f32 v80, v76, 0x41700000, v82
    v_fmamk_f32 v88, v84, 0x41700000, v90
    v_fmamk_f32 v80, v81, 0x41200000, v80
    v_fmamk_f32 v88, v89, 0x41200000, v88
    v_cvt_pk_bf16_f32 v20, v77, v85
    v_cvt_pk_bf16_f32 v24, v78, v86
    v_cvt_pk_bf16_f32 v64, v79, v87
    v_cvt_pk_bf16_f32 v68, v82, v90
    v_cvt_pk_bf16_f32 v72, v80, v88
    v_lshlrev_b32 v76, 16, v17
    v_and_b32 v84, s25, v17
    v_lshlrev_b32 v77, 16, v21
    v_and_b32 v85, s25, v21
    v_lshlrev_b32 v78, 16, v25
    v_and_b32 v86, s25, v25
    v_lshlrev_b32 v79, 16, v29
    v_and_b32 v87, s25, v29
    v_add_f32 v80, v76, v78
    v_add_f32 v88, v84, v86
    v_add_f32 v81, v77, v79
    v_add_f32 v89, v85, v87
    v_fma_f32 v82, v78, 4.0, v76
    v_fma_f32 v90, v86, 4.0, v84
    v_fma_f32 v83, v79, 4.0, v77
    v_fma_f32 v91, v87, 4.0, v85
    v_add_f32 v77, v80, v81
    v_add_f32 v85, v88, v89
    v_sub_f32 v78, v80, v81
    v_sub_f32 v86, v88, v89
    v_fma_f32 v79, v83, 2.0, v82
    v_fma_f32 v87, v91, 2.0, v90
    v_fma_f32 v82, v83, -2.0, v82
    v_fma_f32 v90, v91, -2.0, v90
    v_fmamk_f32 v80, v76, 0x41700000, v82
    v_fmamk_f32 v88, v84, 0x41700000, v90
    v_fmamk_f32 v80, v81, 0x41200000, v80
    v_fmamk_f32 v88, v89, 0x41200000, v88
    v_cvt_pk_bf16_f32 v21, v77, v85
    v_cvt_pk_bf16_f32 v25, v78, v86
    v_cvt_pk_bf16_f32 v65, v79, v87
    v_cvt_pk_bf16_f32 v69, v82, v90
    v_cvt_pk_bf16_f32 v73, v80, v88
    buffer_load_dwordx4 v[52:55], v93, s[8:11], s27 offen
    buffer_load_dwordx4 v[60:63], v95, s[8:11], s27 offen
    v_lshlrev_b32 v76, 16, v18
    v_and_b32 v84, s25, v18
    v_lshlrev_b32 v77, 16, v22
    v_and_b32 v85, s25, v22
    v_lshlrev_b32 v78, 16, v26
    v_and_b32 v86, s25, v26
    v_lshlrev_b32 v79, 16, v30
    v_and_b32 v87, s25, v30
    v_add_f32 v80, v76, v78
    v_add_f32 v88, v84, v86
    v_add_f32 v81, v77, v79
    v_add_f32 v89, v85, v87
    v_fma_f32 v82, v78, 4.0, v76
    v_fma_f32 v90, v86, 4.0, v84
    v_fma_f32 v83, v79, 4.0, v77
    v_fma_f32 v91, v87, 4.0, v85
    v_add_f32 v77, v80, v81
    v_add_f32 v85, v88, v89
    v_sub_f32 v78, v80, v81
    v_sub_f32 v86, v88, v89
    v_fma_f32 v79, v83, 2.0, v82
    v_fma_f32 v87, v91, 2.0, v90
    v_fma_f32 v82, v83, -2.0, v82
    v_fma_f32 v90, v91, -2.0, v90
    v_fmamk_f32 v80, v76, 0x41700000, v82
    v_fmamk_f32 v88, v84, 0x41700000, v90
    v_fmamk_f32 v80, v81, 0x41200000, v80
    v_fmamk_f32 v88, v89, 0x41200000, v88
    v_cvt_pk_bf16_f32 v22, v77, v85
    v_cvt_pk_bf16_f32 v26, v78, v86
    v_cvt_pk_bf16_f32 v66, v79, v87
    v_cvt_pk_bf16_f32 v70, v82, v90
    v_cvt_pk_bf16_f32 v74, v80, v88
    v_lshlrev_b32 v76, 16, v19
    v_and_b32 v84, s25, v19
    v_lshlrev_b32 v77, 16, v23
    v_and_b32 v85, s25, v23
    v_lshlrev_b32 v78, 16, v27
    v_and_b32 v86, s25, v27
    v_lshlrev_b32 v79, 16, v31
    v_and_b32 v87, s25, v31
    v_add_f32 v80, v76, v78
    v_add_f32 v88, v84, v86
    v_add_f32 v81, v77, v79
    v_add_f32 v89, v85, v87
    v_fma_f32 v82, v78, 4.0, v76
    v_fma_f32 v90, v86, 4.0, v84
    v_fma_f32 v83, v79, 4.0, v77
    v_fma_f32 v91, v87, 4.0, v85
    v_add_f32 v77, v80, v81
    v_add_f32 v85, v88, v89
    v_sub_f32 v78, v80, v81
    v_sub_f32 v86, v88, v89
    v_fma_f32 v79, v83, 2.0, v82
    v_fma_f32 v87, v91, 2.0, v90
    v_fma_f32 v82, v83, -2.0, v82
    v_fma_f32 v90, v91, -2.0, v90
    v_fmamk_f32 v80, v76, 0x41700000, v82
    v_fmamk_f32 v88, v84, 0x41700000, v90
    v_fmamk_f32 v80, v81, 0x41200000, v80
    v_fmamk_f32 v88, v89, 0x41200000, v88
    v_cvt_pk_bf16_f32 v23, v77, v85
    v_cvt_pk_bf16_f32 v27, v78, v86
    v_cvt_pk_bf16_f32 v67, v79, v87
    v_cvt_pk_bf16_f32 v71, v82, v90
    v_cvt_pk_bf16_f32 v75, v80, v88
    ds_write_b128 v96, v[64:67] offset:57344
    ds_write_b128 v97, v[68:71] offset:8192
    ds_write_b128 v97, v[72:75] offset:24576
    ds_write_b128 v96, v[16:19] offset:8192
    ds_write_b128 v96, v[20:23] offset:24576
    ds_write_b128 v96, v[24:27] offset:40960
    ds_write_b128 v98, v[28:31] offset:8704
    s_add_u32 s28, s28, 1
    s_waitcnt lgkmcnt(0)
    s_barrier
    s_add_u32 s24, s24, 1048576
    s_add_u32 s27, s27, 1048576
    s_waitcnt vmcnt(0)
    v_lshlrev_b32 v76, 16, v32
    v_and_b32 v84, s25, v32
    v_lshlrev_b32 v77, 16, v36
    v_and_b32 v85, s25, v36
    v_lshlrev_b32 v78, 16, v40
    v_and_b32 v86, s25, v40
    v_lshlrev_b32 v79, 16, v44
    v_and_b32 v87, s25, v44
    v_add_f32 v80, v76, v78
    v_add_f32 v88, v84, v86
    v_add_f32 v81, v77, v79
    v_add_f32 v89, v85, v87
    v_fma_f32 v82, v78, 4.0, v76
    v_fma_f32 v90, v86, 4.0, v84
    v_fma_f32 v83, v79, 4.0, v77
    v_fma_f32 v91, v87, 4.0, v85
    v_add_f32 v77, v80, v81
    v_add_f32 v85, v88, v89
    v_sub_f32 v78, v80, v81
    v_sub_f32 v86, v88, v89
    v_fma_f32 v79, v83, 2.0, v82
    v_fma_f32 v87, v91, 2.0, v90
    v_fma_f32 v82, v83, -2.0, v82
    v_fma_f32 v90, v91, -2.0, v90
    v_fmamk_f32 v80, v76, 0x41700000, v82
    v_fmamk_f32 v88, v84, 0x41700000, v90
    v_fmamk_f32 v80, v81, 0x41200000, v80
    v_fmamk_f32 v88, v89, 0x41200000, v88
    v_cvt_pk_bf16_f32 v36, v77, v85
    v_cvt_pk_bf16_f32 v40, v78, v86
    v_cvt_pk_bf16_f32 v64, v79, v87
    v_cvt_pk_bf16_f32 v68, v82, v90
    v_cvt_pk_bf16_f32 v72, v80, v88
    v_lshlrev_b32 v76, 16, v33
    v_and_b32 v84, s25, v33
    v_lshlrev_b32 v77, 16, v37
    v_and_b32 v85, s25, v37
    v_lshlrev_b32 v78, 16, v41
    v_and_b32 v86, s25, v41
    buffer_load_dwordx4 v[0:3], v92, s[8:11], s24 offen
    buffer_load_dwordx4 v[8:11], v94, s[8:11], s24 offen
    v_lshlrev_b32 v79, 16, v45
    v_and_b32 v87, s25, v45
    v_add_f32 v80, v76, v78
    v_add_f32 v88, v84, v86
    v_add_f32 v81, v77, v79
    v_add_f32 v89, v85, v87
    v_fma_f32 v82, v78, 4.0, v76
    v_fma_f32 v90, v86, 4.0, v84
    v_fma_f32 v83, v79, 4.0, v77
    v_fma_f32 v91, v87, 4.0, v85
    v_add_f32 v77, v80, v81
    v_add_f32 v85, v88, v89
    v_sub_f32 v78, v80, v81
    v_sub_f32 v86, v88, v89
    v_fma_f32 v79, v83, 2.0, v82
    v_fma_f32 v87, v91, 2.0, v90
    v_fma_f32 v82, v83, -2.0, v82
    v_fma_f32 v90, v91, -2.0, v90
    v_fmamk_f32 v80, v76, 0x41700000, v82
    v_fmamk_f32 v88, v84, 0x41700000, v90
    v_fmamk_f32 v80, v81, 0x41200000, v80
    v_fmamk_f32 v88, v89, 0x41200000, v88
    v_cvt_pk_bf16_f32 v37, v77, v85
    v_cvt_pk_bf16_f32 v41, v78, v86
    v_cvt_pk_bf16_f32 v65, v79, v87
    v_cvt_pk_bf16_f32 v69, v82, v90
    v_cvt_pk_bf16_f32 v73, v80, v88
    v_lshlrev_b32 v76, 16, v34
    v_and_b32 v84, s25, v34
    v_lshlrev_b32 v77, 16, v38
    v_and_b32 v85, s25, v38
    v_lshlrev_b32 v78, 16, v42
    v_and_b32 v86, s25, v42
    v_lshlrev_b32 v79, 16, v46
    v_and_b32 v87, s25, v46
    v_add_f32 v80, v76, v78
    v_add_f32 v88, v84, v86
    v_add_f32 v81, v77, v79
    v_add_f32 v89, v85, v87
    v_fma_f32 v82, v78, 4.0, v76
    v_fma_f32 v90, v86, 4.0, v84
    v_fma_f32 v83, v79, 4.0, v77
    v_fma_f32 v91, v87, 4.0, v85
    v_add_f32 v77, v80, v81
    v_add_f32 v85, v88, v89
    v_sub_f32 v78, v80, v81
    v_sub_f32 v86, v88, v89
    v_fma_f32 v79, v83, 2.0, v82
    v_fma_f32 v87, v91, 2.0, v90
    v_fma_f32 v82, v83, -2.0, v82
    v_fma_f32 v90, v91, -2.0, v90
    v_fmamk_f32 v80, v76, 0x41700000, v82
    v_fmamk_f32 v88, v84, 0x41700000, v90
    buffer_load_dwordx4 v[4:7], v93, s[8:11], s24 offen
    buffer_load_dwordx4 v[12:15], v95, s[8:11], s24 offen
    v_fmamk_f32 v80, v81, 0x41200000, v80
    v_fmamk_f32 v88, v89, 0x41200000, v88
    v_cvt_pk_bf16_f32 v38, v77, v85
    v_cvt_pk_bf16_f32 v42, v78, v86
    v_cvt_pk_bf16_f32 v66, v79, v87
    v_cvt_pk_bf16_f32 v70, v82, v90
    v_cvt_pk_bf16_f32 v74, v80, v88
    v_lshlrev_b32 v76, 16, v35
    v_and_b32 v84, s25, v35
    v_lshlrev_b32 v77, 16, v39
    v_and_b32 v85, s25, v39
    v_lshlrev_b32 v78, 16, v43
    v_and_b32 v86, s25, v43
    v_lshlrev_b32 v79, 16, v47
    v_and_b32 v87, s25, v47
    v_add_f32 v80, v76, v78
    v_add_f32 v88, v84, v86
    v_add_f32 v81, v77, v79
    v_add_f32 v89, v85, v87
    v_fma_f32 v82, v78, 4.0, v76
    v_fma_f32 v90, v86, 4.0, v84
    v_fma_f32 v83, v79, 4.0, v77
    v_fma_f32 v91, v87, 4.0, v85
    v_add_f32 v77, v80, v81
    v_add_f32 v85, v88, v89
    v_sub_f32 v78, v80, v81
    v_sub_f32 v86, v88, v89
    v_fma_f32 v79, v83, 2.0, v82
    v_fma_f32 v87, v91, 2.0, v90
    v_fma_f32 v82, v83, -2.0, v82
    v_fma_f32 v90, v91, -2.0, v90
    v_fmamk_f32 v80, v76, 0x41700000, v82
    v_fmamk_f32 v88, v84, 0x41700000, v90
    v_fmamk_f32 v80, v81, 0x41200000, v80
    v_fmamk_f32 v88, v89, 0x41200000, v88
    v_cvt_pk_bf16_f32 v39, v77, v85
    v_cvt_pk_bf16_f32 v43, v78, v86
    v_cvt_pk_bf16_f32 v67, v79, v87
    v_cvt_pk_bf16_f32 v71, v82, v90
    v_cvt_pk_bf16_f32 v75, v80, v88
    ds_write_b128 v96, v[64:67] offset:49152
    ds_write_b128 v97, v[68:71] offset:0
    ds_write_b128 v97, v[72:75] offset:16384
    ds_write_b128 v96, v[32:35] offset:0
    ds_write_b128 v96, v[36:39] offset:16384
    ds_write_b128 v96, v[40:43] offset:32768
    ds_write_b128 v98, v[44:47] offset:0
    s_add_u32 s28, s28, 1
    s_waitcnt lgkmcnt(0)
    s_barrier
    v_lshlrev_b32 v76, 16, v48
    v_and_b32 v84, s25, v48
    v_lshlrev_b32 v77, 16, v52
    v_and_b32 v85, s25, v52
    v_lshlrev_b32 v78, 16, v56
    v_and_b32 v86, s25, v56
    v_lshlrev_b32 v79, 16, v60
    v_and_b32 v87, s25, v60
    v_add_f32 v80, v76, v78
    v_add_f32 v88, v84, v86
    v_add_f32 v81, v77, v79
    v_add_f32 v89, v85, v87
    v_fma_f32 v82, v78, 4.0, v76
    buffer_load_dwordx4 v[16:19], v92, s[8:11], s27 offen
    buffer_load_dwordx4 v[24:27], v94, s[8:11], s27 offen
    v_fma_f32 v90, v86, 4.0, v84
    v_fma_f32 v83, v79, 4.0, v77
    v_fma_f32 v91, v87, 4.0, v85
    v_add_f32 v77, v80, v81
    v_add_f32 v85, v88, v89
    v_sub_f32 v78, v80, v81
    v_sub_f32 v86, v88, v89
    v_fma_f32 v79, v83, 2.0, v82
    v_fma_f32 v87, v91, 2.0, v90
    v_fma_f32 v82, v83, -2.0, v82
    v_fma_f32 v90, v91, -2.0, v90
    v_fmamk_f32 v80, v76, 0x41700000, v82
    v_fmamk_f32 v88, v84, 0x41700000, v90
    v_fmamk_f32 v80, v81, 0x41200000, v80
    v_fmamk_f32 v88, v89, 0x41200000, v88
    v_cvt_pk_bf16_f32 v52, v77, v85
    v_cvt_pk_bf16_f32 v56, v78, v86
    v_cvt_pk_bf16_f32 v64, v79, v87
    v_cvt_pk_bf16_f32 v68, v82, v90
    v_cvt_pk_bf16_f32 v72, v80, v88
    v_lshlrev_b32 v76, 16, v49
    v_and_b32 v84, s25, v49
    v_lshlrev_b32 v77, 16, v53
    v_and_b32 v85, s25, v53
    v_lshlrev_b32 v78, 16, v57
    v_and_b32 v86, s25, v57
    v_lshlrev_b32 v79, 16, v61
    v_and_b32 v87, s25, v61
    v_add_f32 v80, v76, v78
    v_add_f32 v88, v84, v86
    v_add_f32 v81, v77, v79
    v_add_f32 v89, v85, v87
    v_fma_f32 v82, v78, 4.0, v76
    v_fma_f32 v90, v86, 4.0, v84
    v_fma_f32 v83, v79, 4.0, v77
    v_fma_f32 v91, v87, 4.0, v85
    v_add_f32 v77, v80, v81
    v_add_f32 v85, v88, v89
    v_sub_f32 v78, v80, v81
    v_sub_f32 v86, v88, v89
    v_fma_f32 v79, v83, 2.0, v82
    v_fma_f32 v87, v91, 2.0, v90
    v_fma_f32 v82, v83, -2.0, v82
    v_fma_f32 v90, v91, -2.0, v90
    v_fmamk_f32 v80, v76, 0x41700000, v82
    v_fmamk_f32 v88, v84, 0x41700000, v90
    v_fmamk_f32 v80, v81, 0x41200000, v80
    v_fmamk_f32 v88, v89, 0x41200000, v88
    v_cvt_pk_bf16_f32 v53, v77, v85
    v_cvt_pk_bf16_f32 v57, v78, v86
    v_cvt_pk_bf16_f32 v65, v79, v87
    v_cvt_pk_bf16_f32 v69, v82, v90
    v_cvt_pk_bf16_f32 v73, v80, v88
    buffer_load_dwordx4 v[20:23], v93, s[8:11], s27 offen
    buffer_load_dwordx4 v[28:31], v95, s[8:11], s27 offen
    v_lshlrev_b32 v76, 16, v50
    v_and_b32 v84, s25, v50
    v_lshlrev_b32 v77, 16, v54
    v_and_b32 v85, s25, v54
    v_lshlrev_b32 v78, 16, v58
    v_and_b32 v86, s25, v58
    v_lshlrev_b32 v79, 16, v62
    v_and_b32 v87, s25, v62
    v_add_f32 v80, v76, v78
    v_add_f32 v88, v84, v86
    v_add_f32 v81, v77, v79
    v_add_f32 v89, v85, v87
    v_fma_f32 v82, v78, 4.0, v76
    v_fma_f32 v90, v86, 4.0, v84
    v_fma_f32 v83, v79, 4.0, v77
    v_fma_f32 v91, v87, 4.0, v85
    v_add_f32 v77, v80, v81
    v_add_f32 v85, v88, v89
    v_sub_f32 v78, v80, v81
    v_sub_f32 v86, v88, v89
    v_fma_f32 v79, v83, 2.0, v82
    v_fma_f32 v87, v91, 2.0, v90
    v_fma_f32 v82, v83, -2.0, v82
    v_fma_f32 v90, v91, -2.0, v90
    v_fmamk_f32 v80, v76, 0x41700000, v82
    v_fmamk_f32 v88, v84, 0x41700000, v90
    v_fmamk_f32 v80, v81, 0x41200000, v80
    v_fmamk_f32 v88, v89, 0x41200000, v88
    v_cvt_pk_bf16_f32 v54, v77, v85
    v_cvt_pk_bf16_f32 v58, v78, v86
    v_cvt_pk_bf16_f32 v66, v79, v87
    v_cvt_pk_bf16_f32 v70, v82, v90
    v_cvt_pk_bf16_f32 v74, v80, v88
    v_lshlrev_b32 v76, 16, v51
    v_and_b32 v84, s25, v51
    v_lshlrev_b32 v77, 16, v55
    v_and_b32 v85, s25, v55
    v_lshlrev_b32 v78, 16, v59
    v_and_b32 v86, s25, v59
    v_lshlrev_b32 v79, 16, v63
    v_and_b32 v87, s25, v63
    v_add_f32 v80, v76, v78
    v_add_f32 v88, v84, v86
    v_add_f32 v81, v77, v79
    v_add_f32 v89, v85, v87
    v_fma_f32 v82, v78, 4.0, v76
    v_fma_f32 v90, v86, 4.0, v84
    v_fma_f32 v83, v79, 4.0, v77
    v_fma_f32 v91, v87, 4.0, v85
    v_add_f32 v77, v80, v81
    v_add_f32 v85, v88, v89
    v_sub_f32 v78, v80, v81
    v_sub_f32 v86, v88, v89
    v_fma_f32 v79, v83, 2.0, v82
    v_fma_f32 v87, v91, 2.0, v90
    v_fma_f32 v82, v83, -2.0, v82
    v_fma_f32 v90, v91, -2.0, v90
    v_fmamk_f32 v80, v76, 0x41700000, v82
    v_fmamk_f32 v88, v84, 0x41700000, v90
    v_fmamk_f32 v80, v81, 0x41200000, v80
    v_fmamk_f32 v88, v89, 0x41200000, v88
    v_cvt_pk_bf16_f32 v55, v77, v85
    v_cvt_pk_bf16_f32 v59, v78, v86
    v_cvt_pk_bf16_f32 v67, v79, v87
    v_cvt_pk_bf16_f32 v71, v82, v90
    v_cvt_pk_bf16_f32 v75, v80, v88
    ds_write_b128 v96, v[64:67] offset:57344
    ds_write_b128 v97, v[68:71] offset:8192
    ds_write_b128 v97, v[72:75] offset:24576
    ds_write_b128 v96, v[48:51] offset:8192
    ds_write_b128 v96, v[52:55] offset:24576
    ds_write_b128 v96, v[56:59] offset:40960
    ds_write_b128 v98, v[60:63] offset:8704
    s_add_u32 s28, s28, 1
    s_waitcnt lgkmcnt(0)
    s_barrier
    s_cmp_eq_u32 s22, 1
    s_cbranch_scc1 L_conv2_kernel_hlast1
    s_add_u32 s24, s24, 1048576
    s_add_u32 s27, s27, 1048576
    s_waitcnt vmcnt(0)
    v_lshlrev_b32 v76, 16, v0
    v_and_b32 v84, s25, v0
    v_lshlrev_b32 v77, 16, v4
    v_and_b32 v85, s25, v4
    v_lshlrev_b32 v78, 16, v8
    v_and_b32 v86, s25, v8
    v_lshlrev_b32 v79, 16, v12
    v_and_b32 v87, s25, v12
    v_add_f32 v80, v76, v78
    v_add_f32 v88, v84, v86
    v_add_f32 v81, v77, v79
    v_add_f32 v89, v85, v87
    v_fma_f32 v82, v78, 4.0, v76
    v_fma_f32 v90, v86, 4.0, v84
    v_fma_f32 v83, v79, 4.0, v77
    v_fma_f32 v91, v87, 4.0, v85
    v_add_f32 v77, v80, v81
    v_add_f32 v85, v88, v89
    v_sub_f32 v78, v80, v81
    v_sub_f32 v86, v88, v89
    v_fma_f32 v79, v83, 2.0, v82
    v_fma_f32 v87, v91, 2.0, v90
    v_fma_f32 v82, v83, -2.0, v82
    v_fma_f32 v90, v91, -2.0, v90
    v_fmamk_f32 v80, v76, 0x41700000, v82
    v_fmamk_f32 v88, v84, 0x41700000, v90
    v_fmamk_f32 v80, v81, 0x41200000, v80
    v_fmamk_f32 v88, v89, 0x41200000, v88
    v_cvt_pk_bf16_f32 v4, v77, v85
    v_cvt_pk_bf16_f32 v8, v78, v86
    v_cvt_pk_bf16_f32 v64, v79, v87
    v_cvt_pk_bf16_f32 v68, v82, v90
    v_cvt_pk_bf16_f32 v72, v80, v88
    v_lshlrev_b32 v76, 16, v1
    v_and_b32 v84, s25, v1
    v_lshlrev_b32 v77, 16, v5
    v_and_b32 v85, s25, v5
    v_lshlrev_b32 v78, 16, v9
    v_and_b32 v86, s25, v9
    buffer_load_dwordx4 v[32:35], v92, s[8:11], s24 offen
    buffer_load_dwordx4 v[40:43], v94, s[8:11], s24 offen
    v_lshlrev_b32 v79, 16, v13
    v_and_b32 v87, s25, v13
    v_add_f32 v80, v76, v78
    v_add_f32 v88, v84, v86
    v_add_f32 v81, v77, v79
    v_add_f32 v89, v85, v87
    v_fma_f32 v82, v78, 4.0, v76
    v_fma_f32 v90, v86, 4.0, v84
    v_fma_f32 v83, v79, 4.0, v77
    v_fma_f32 v91, v87, 4.0, v85
    v_add_f32 v77, v80, v81
    v_add_f32 v85, v88, v89
    v_sub_f32 v78, v80, v81
    v_sub_f32 v86, v88, v89
    v_fma_f32 v79, v83, 2.0, v82
    v_fma_f32 v87, v91, 2.0, v90
    v_fma_f32 v82, v83, -2.0, v82
    v_fma_f32 v90, v91, -2.0, v90
    v_fmamk_f32 v80, v76, 0x41700000, v82
    v_fmamk_f32 v88, v84, 0x41700000, v90
    v_fmamk_f32 v80, v81, 0x41200000, v80
    v_fmamk_f32 v88, v89, 0x41200000, v88
    v_cvt_pk_bf16_f32 v5, v77, v85
    v_cvt_pk_bf16_f32 v9, v78, v86
    v_cvt_pk_bf16_f32 v65, v79, v87
    v_cvt_pk_bf16_f32 v69, v82, v90
    v_cvt_pk_bf16_f32 v73, v80, v88
    v_lshlrev_b32 v76, 16, v2
    v_and_b32 v84, s25, v2
    v_lshlrev_b32 v77, 16, v6
    v_and_b32 v85, s25, v6
    v_lshlrev_b32 v78, 16, v10
    v_and_b32 v86, s25, v10
    v_lshlrev_b32 v79, 16, v14
    v_and_b32 v87, s25, v14
    v_add_f32 v80, v76, v78
    v_add_f32 v88, v84, v86
    v_add_f32 v81, v77, v79
    v_add_f32 v89, v85, v87
    v_fma_f32 v82, v78, 4.0, v76
    v_fma_f32 v90, v86, 4.0, v84
    v_fma_f32 v83, v79, 4.0, v77
    v_fma_f32 v91, v87, 4.0, v85
    v_add_f32 v77, v80, v81
    v_add_f32 v85, v88, v89
    v_sub_f32 v78, v80, v81
    v_sub_f32 v86, v88, v89
    v_fma_f32 v79, v83, 2.0, v82
    v_fma_f32 v87, v91, 2.0, v90
    v_fma_f32 v82, v83, -2.0, v82
    v_fma_f32 v90, v91, -2.0, v90
    v_fmamk_f32 v80, v76, 0x41700000, v82
    v_fmamk_f32 v88, v84, 0x41700000, v90
    buffer_load_dwordx4 v[36:39], v93, s[8:11], s24 offen
    buffer_load_dwordx4 v[44:47], v95, s[8:11], s24 offen
    v_fmamk_f32 v80, v81, 0x41200000, v80
    v_fmamk_f32 v88, v89, 0x41200000, v88
    v_cvt_pk_bf16_f32 v6, v77, v85
    v_cvt_pk_bf16_f32 v10, v78, v86
    v_cvt_pk_bf16_f32 v66, v79, v87
    v_cvt_pk_bf16_f32 v70, v82, v90
    v_cvt_pk_bf16_f32 v74, v80, v88
    v_lshlrev_b32 v76, 16, v3
    v_and_b32 v84, s25, v3
    v_lshlrev_b32 v77, 16, v7
    v_and_b32 v85, s25, v7
    v_lshlrev_b32 v78, 16, v11
    v_and_b32 v86, s25, v11
    v_lshlrev_b32 v79, 16, v15
    v_and_b32 v87, s25, v15
    v_add_f32 v80, v76, v78
    v_add_f32 v88, v84, v86
    v_add_f32 v81, v77, v79
    v_add_f32 v89, v85, v87
    v_fma_f32 v82, v78, 4.0, v76
    v_fma_f32 v90, v86, 4.0, v84
    v_fma_f32 v83, v79, 4.0, v77
    v_fma_f32 v91, v87, 4.0, v85
    v_add_f32 v77, v80, v81
    v_add_f32 v85, v88, v89
    v_sub_f32 v78, v80, v81
    v_sub_f32 v86, v88, v89
    v_fma_f32 v79, v83, 2.0, v82
    v_fma_f32 v87, v91, 2.0, v90
    v_fma_f32 v82, v83, -2.0, v82
    v_fma_f32 v90, v91, -2.0, v90
    v_fmamk_f32 v80, v76, 0x41700000, v82
    v_fmamk_f32 v88, v84, 0x41700000, v90
    v_fmamk_f32 v80, v81, 0x41200000, v80
    v_fmamk_f32 v88, v89, 0x41200000, v88
    v_cvt_pk_bf16_f32 v7, v77, v85
    v_cvt_pk_bf16_f32 v11, v78, v86
    v_cvt_pk_bf16_f32 v67, v79, v87
    v_cvt_pk_bf16_f32 v71, v82, v90
    v_cvt_pk_bf16_f32 v75, v80, v88
    ds_write_b128 v96, v[64:67] offset:49152
    ds_write_b128 v97, v[68:71] offset:0
    ds_write_b128 v97, v[72:75] offset:16384
    ds_write_b128 v96, v[0:3] offset:0
    ds_write_b128 v96, v[4:7] offset:16384
    ds_write_b128 v96, v[8:11] offset:32768
    ds_write_b128 v98, v[12:15] offset:0
    s_add_u32 s28, s28, 1
    s_waitcnt lgkmcnt(0)
    s_barrier
    s_sub_u32 s22, s22, 1
    s_branch L_conv2_kernel_hloop1
L_conv2_kernel_hlast1:
    s_branch L_conv2_kernel_end
L_conv2_kernel_h2:
    ds_write_b128 v96, v[0:3] offset:0
    ds_write_b128 v98, v[12:15] offset:0
    v_lshlrev_b32 v76, 16, v0
    v_and_b32 v84, s25, v0
    v_lshlrev_b32 v77, 16, v4
    v_and_b32 v85, s25, v4
    v_lshlrev_b32 v78, 16, v8
    v_and_b32 v86, s25, v8
    v_lshlrev_b32 v79, 16, v12
    v_and_b32 v87, s25, v12
    v_add_f32 v80, v76, v78
    v_add_f32 v88, v84, v86
    v_add_f32 v81, v77, v79
    v_add_f32 v89, v85, v87
    v_fma_f32 v82, v78, 4.0, v76
    v_fma_f32 v90, v86, 4.0, v84
    v_fma_f32 v83, v79, 4.0, v77
    v_fma_f32 v91, v87, 4.0, v85
    v_add_f32 v77, v80, v81
    v_add_f32 v85, v88, v89
    v_sub_f32 v78, v80, v81
    v_sub_f32 v86, v88, v89
    v_fma_f32 v79, v83, 2.0, v82
    v_fma_f32 v87, v91, 2.0, v90
    v_fma_f32 v82, v83, -2.0, v82
    v_fma_f32 v90, v91, -2.0, v90
    v_fmamk_f32 v80, v76, 0x41700000, v82
    v_fmamk_f32 v88, v84, 0x41700000, v90
    v_fmamk_f32 v80, v81, 0x41200000, v80
    v_fmamk_f32 v88, v89, 0x41200000, v88
    v_cvt_pk_bf16_f32 v4, v77, v85
    v_cvt_pk_bf16_f32 v8, v78, v86
    v_cvt_pk_bf16_f32 v64, v79, v87
    v_cvt_pk_bf16_f32 v68, v82, v90
    v_cvt_pk_bf16_f32 v72, v80, v88
    v_lshlrev_b32 v76, 16, v1
    v_and_b32 v84, s25, v1
    v_lshlrev_b32 v77, 16, v5
    v_and_b32 v85, s25, v5
    v_lshlrev_b32 v78, 16, v9
    v_and_b32 v86, s25, v9
    v_lshlrev_b32 v79, 16, v13
    v_and_b32 v87, s25, v13
    v_add_f32 v80, v76, v78
    v_add_f32 v88, v84, v86
    v_add_f32 v81, v77, v79
    v_add_f32 v89, v85, v87
    v_fma_f32 v82, v78, 4.0, v76
    v_fma_f32 v90, v86, 4.0, v84
    v_fma_f32 v83, v79, 4.0, v77
    v_fma_f32 v91, v87, 4.0, v85
    v_add_f32 v77, v80, v81
    v_add_f32 v85, v88, v89
    v_sub_f32 v78, v80, v81
    v_sub_f32 v86, v88, v89
    v_fma_f32 v79, v83, 2.0, v82
    v_fma_f32 v87, v91, 2.0, v90
    v_fma_f32 v82, v83, -2.0, v82
    v_fma_f32 v90, v91, -2.0, v90
    v_fmamk_f32 v80, v76, 0x41700000, v82
    v_fmamk_f32 v88, v84, 0x41700000, v90
    v_fmamk_f32 v80, v81, 0x41200000, v80
    v_fmamk_f32 v88, v89, 0x41200000, v88
    v_cvt_pk_bf16_f32 v5, v77, v85
    v_cvt_pk_bf16_f32 v9, v78, v86
    v_cvt_pk_bf16_f32 v65, v79, v87
    v_cvt_pk_bf16_f32 v69, v82, v90
    v_cvt_pk_bf16_f32 v73, v80, v88
    v_lshlrev_b32 v76, 16, v2
    v_and_b32 v84, s25, v2
    v_lshlrev_b32 v77, 16, v6
    v_and_b32 v85, s25, v6
    v_lshlrev_b32 v78, 16, v10
    v_and_b32 v86, s25, v10
    v_lshlrev_b32 v79, 16, v14
    v_and_b32 v87, s25, v14
    v_add_f32 v80, v76, v78
    v_add_f32 v88, v84, v86
    v_add_f32 v81, v77, v79
    v_add_f32 v89, v85, v87
    v_fma_f32 v82, v78, 4.0, v76
    v_fma_f32 v90, v86, 4.0, v84
    v_fma_f32 v83, v79, 4.0, v77
    v_fma_f32 v91, v87, 4.0, v85
    v_add_f32 v77, v80, v81
    v_add_f32 v85, v88, v89
    v_sub_f32 v78, v80, v81
    v_sub_f32 v86, v88, v89
    v_fma_f32 v79, v83, 2.0, v82
    v_fma_f32 v87, v91, 2.0, v90
    v_fma_f32 v82, v83, -2.0, v82
    v_fma_f32 v90, v91, -2.0, v90
    v_fmamk_f32 v80, v76, 0x41700000, v82
    v_fmamk_f32 v88, v84, 0x41700000, v90
    v_fmamk_f32 v80, v81, 0x41200000, v80
    v_fmamk_f32 v88, v89, 0x41200000, v88
    v_cvt_pk_bf16_f32 v6, v77, v85
    v_cvt_pk_bf16_f32 v10, v78, v86
    v_cvt_pk_bf16_f32 v66, v79, v87
    v_cvt_pk_bf16_f32 v70, v82, v90
    v_cvt_pk_bf16_f32 v74, v80, v88
    v_lshlrev_b32 v76, 16, v3
    v_and_b32 v84, s25, v3
    v_lshlrev_b32 v77, 16, v7
    v_and_b32 v85, s25, v7
    v_lshlrev_b32 v78, 16, v11
    v_and_b32 v86, s25, v11
    v_lshlrev_b32 v79, 16, v15
    v_and_b32 v87, s25, v15
    v_add_f32 v80, v76, v78
    v_add_f32 v88, v84, v86
    v_add_f32 v81, v77, v79
    v_add_f32 v89, v85, v87
    v_fma_f32 v82, v78, 4.0, v76
    v_fma_f32 v90, v86, 4.0, v84
    v_fma_f32 v83, v79, 4.0, v77
    v_fma_f32 v91, v87, 4.0, v85
    v_add_f32 v77, v80, v81
    v_add_f32 v85, v88, v89
    v_sub_f32 v78, v80, v81
    v_sub_f32 v86, v88, v89
    v_fma_f32 v79, v83, 2.0, v82
    v_fma_f32 v87, v91, 2.0, v90
    v_fma_f32 v82, v83, -2.0, v82
    v_fma_f32 v90, v91, -2.0, v90
    v_fmamk_f32 v80, v76, 0x41700000, v82
    v_fmamk_f32 v88, v84, 0x41700000, v90
    v_fmamk_f32 v80, v81, 0x41200000, v80
    v_fmamk_f32 v88, v89, 0x41200000, v88
    v_cvt_pk_bf16_f32 v7, v77, v85
    v_cvt_pk_bf16_f32 v11, v78, v86
    v_cvt_pk_bf16_f32 v67, v79, v87
    v_cvt_pk_bf16_f32 v71, v82, v90
    v_cvt_pk_bf16_f32 v75, v80, v88
    ds_write_b128 v96, v[64:67] offset:49152
    ds_write_b128 v97, v[68:71] offset:0
    ds_write_b128 v97, v[72:75] offset:16384
    ds_write_b128 v96, v[4:7] offset:16384
    ds_write_b128 v96, v[8:11] offset:32768
    s_waitcnt vmcnt(0)
    s_mov_b32 s24, 1048576
    s_mov_b32 s27, 1572864
    s_waitcnt lgkmcnt(0)
    s_barrier
    buffer_load_dwordx4 v[32:35], v92, s[8:11], s24 offen
    buffer_load_dwordx4 v[40:43], v94, s[8:11], s24 offen
    buffer_load_dwordx4 v[36:39], v93, s[8:11], s24 offen
    buffer_load_dwordx4 v[44:47], v95, s[8:11], s24 offen
    buffer_load_dwordx4 v[48:51], v92, s[8:11], s27 offen
    buffer_load_dwordx4 v[56:59], v94, s[8:11], s27 offen
    buffer_load_dwordx4 v[52:55], v93, s[8:11], s27 offen
    buffer_load_dwordx4 v[60:63], v95, s[8:11], s27 offen
    s_setprio 0
    v_lshlrev_b32 v76, 16, v16
    v_and_b32 v84, s25, v16
    v_lshlrev_b32 v77, 16, v20
    v_and_b32 v85, s25, v20
    v_lshlrev_b32 v78, 16, v24
    v_and_b32 v86, s25, v24
    v_lshlrev_b32 v79, 16, v28
    v_and_b32 v87, s25, v28
    v_add_f32 v80, v76, v78
    v_add_f32 v88, v84, v86
    v_add_f32 v81, v77, v79
    v_add_f32 v89, v85, v87
    v_fma_f32 v82, v78, 4.0, v76
    v_fma_f32 v90, v86, 4.0, v84
    v_fma_f32 v83, v79, 4.0, v77
    v_fma_f32 v91, v87, 4.0, v85
    v_add_f32 v77, v80, v81
    v_add_f32 v85, v88, v89
    v_sub_f32 v78, v80, v81
    v_sub_f32 v86, v88, v89
    v_fma_f32 v79, v83, 2.0, v82
    v_fma_f32 v87, v91, 2.0, v90
    v_fma_f32 v82, v83, -2.0, v82
    v_fma_f32 v90, v91, -2.0, v90
    v_fmamk_f32 v80, v76, 0x41700000, v82
    v_fmamk_f32 v88, v84, 0x41700000, v90
    v_fmamk_f32 v80, v81, 0x41200000, v80
    v_fmamk_f32 v88, v89, 0x41200000, v88
    v_cvt_pk_bf16_f32 v20, v77, v85
    v_cvt_pk_bf16_f32 v24, v78, v86
    v_cvt_pk_bf16_f32 v64, v79, v87
    v_cvt_pk_bf16_f32 v68, v82, v90
    v_cvt_pk_bf16_f32 v72, v80, v88
    v_lshlrev_b32 v76, 16, v17
    v_and_b32 v84, s25, v17
    v_lshlrev_b32 v77, 16, v21
    v_and_b32 v85, s25, v21
    v_lshlrev_b32 v78, 16, v25
    v_and_b32 v86, s25, v25
    v_lshlrev_b32 v79, 16, v29
    v_and_b32 v87, s25, v29
    v_add_f32 v80, v76, v78
    v_add_f32 v88, v84, v86
    v_add_f32 v81, v77, v79
    v_add_f32 v89, v85, v87
    v_fma_f32 v82, v78, 4.0, v76
    v_fma_f32 v90, v86, 4.0, v84
    v_fma_f32 v83, v79, 4.0, v77
    v_fma_f32 v91, v87, 4.0, v85
    v_add_f32 v77, v80, v81
    v_add_f32 v85, v88, v89
    v_sub_f32 v78, v80, v81
    v_sub_f32 v86, v88, v89
    v_fma_f32 v79, v83, 2.0, v82
    v_fma_f32 v87, v91, 2.0, v90
    v_fma_f32 v82, v83, -2.0, v82
    v_fma_f32 v90, v91, -2.0, v90
    v_fmamk_f32 v80, v76, 0x41700000, v82
    v_fmamk_f32 v88, v84, 0x41700000, v90
    v_fmamk_f32 v80, v81, 0x41200000, v80
    v_fmamk_f32 v88, v89, 0x41200000, v88
    v_cvt_pk_bf16_f32 v21, v77, v85
    v_cvt_pk_bf16_f32 v25, v78, v86
    v_cvt_pk_bf16_f32 v65, v79, v87
    v_cvt_pk_bf16_f32 v69, v82, v90
    v_cvt_pk_bf16_f32 v73, v80, v88
    v_lshlrev_b32 v76, 16, v18
    v_and_b32 v84, s25, v18
    v_lshlrev_b32 v77, 16, v22
    v_and_b32 v85, s25, v22
    v_lshlrev_b32 v78, 16, v26
    v_and_b32 v86, s25, v26
    v_lshlrev_b32 v79, 16, v30
    v_and_b32 v87, s25, v30
    v_add_f32 v80, v76, v78
    v_add_f32 v88, v84, v86
    v_add_f32 v81, v77, v79
    v_add_f32 v89, v85, v87
    v_fma_f32 v82, v78, 4.0, v76
    v_fma_f32 v90, v86, 4.0, v84
    v_fma_f32 v83, v79, 4.0, v77
    v_fma_f32 v91, v87, 4.0, v85
    v_add_f32 v77, v80, v81
    v_add_f32 v85, v88, v89
    v_sub_f32 v78, v80, v81
    v_sub_f32 v86, v88, v89
    v_fma_f32 v79, v83, 2.0, v82
    v_fma_f32 v87, v91, 2.0, v90
    v_fma_f32 v82, v83, -2.0, v82
    v_fma_f32 v90, v91, -2.0, v90
    v_fmamk_f32 v80, v76, 0x41700000, v82
    v_fmamk_f32 v88, v84, 0x41700000, v90
    v_fmamk_f32 v80, v81, 0x41200000, v80
    v_fmamk_f32 v88, v89, 0x41200000, v88
    v_cvt_pk_bf16_f32 v22, v77, v85
    v_cvt_pk_bf16_f32 v26, v78, v86
    v_cvt_pk_bf16_f32 v66, v79, v87
    v_cvt_pk_bf16_f32 v70, v82, v90
    v_cvt_pk_bf16_f32 v74, v80, v88
    v_lshlrev_b32 v76, 16, v19
    v_and_b32 v84, s25, v19
    v_lshlrev_b32 v77, 16, v23
    v_and_b32 v85, s25, v23
    v_lshlrev_b32 v78, 16, v27
    v_and_b32 v86, s25, v27
    v_lshlrev_b32 v79, 16, v31
    v_and_b32 v87, s25, v31
    v_add_f32 v80, v76, v78
    v_add_f32 v88, v84, v86
    v_add_f32 v81, v77, v79
    v_add_f32 v89, v85, v87
    v_fma_f32 v82, v78, 4.0, v76
    v_fma_f32 v90, v86, 4.0, v84
    v_fma_f32 v83, v79, 4.0, v77
    v_fma_f32 v91, v87, 4.0, v85
    v_add_f32 v77, v80, v81
    v_add_f32 v85, v88, v89
    v_sub_f32 v78, v80, v81
    v_sub_f32 v86, v88, v89
    v_fma_f32 v79, v83, 2.0, v82
    v_fma_f32 v87, v91, 2.0, v90
    v_fma_f32 v82, v83, -2.0, v82
    v_fma_f32 v90, v91, -2.0, v90
    v_fmamk_f32 v80, v76, 0x41700000, v82
    v_fmamk_f32 v88, v84, 0x41700000, v90
    v_fmamk_f32 v80, v81, 0x41200000, v80
    v_fmamk_f32 v88, v89, 0x41200000, v88
    v_cvt_pk_bf16_f32 v23, v77, v85
    v_cvt_pk_bf16_f32 v27, v78, v86
    v_cvt_pk_bf16_f32 v67, v79, v87
    v_cvt_pk_bf16_f32 v71, v82, v90
    v_cvt_pk_bf16_f32 v75, v80, v88
L_conv2_kernel_hloop2:
    s_add_u32 s24, s24, 1048576
    s_add_u32 s27, s27, 1048576
    ds_write_b128 v96, v[64:67] offset:57344
    ds_write_b128 v97, v[68:71] offset:8192
    ds_write_b128 v97, v[72:75] offset:24576
    ds_write_b128 v96, v[16:19] offset:8192
    ds_write_b128 v96, v[20:23] offset:24576
    ds_write_b128 v96, v[24:27] offset:40960
    ds_write_b128 v98, v[28:31] offset:8704
    s_waitcnt vmcnt(0)
    buffer_load_dwordx4 v[0:3], v92, s[8:11], s24 offen
    buffer_load_dwordx4 v[8:11], v94, s[8:11], s24 offen
    buffer_load_dwordx4 v[4:7], v93, s[8:11], s24 offen
    buffer_load_dwordx4 v[12:15], v95, s[8:11], s24 offen
    v_lshlrev_b32 v76, 16, v32
    v_and_b32 v84, s25, v32
    v_lshlrev_b32 v77, 16, v36
    v_and_b32 v85, s25, v36
    v_lshlrev_b32 v78, 16, v40
    v_and_b32 v86, s25, v40
    v_lshlrev_b32 v79, 16, v44
    v_and_b32 v87, s25, v44
    v_add_f32 v80, v76, v78
    v_add_f32 v88, v84, v86
    v_add_f32 v81, v77, v79
    v_add_f32 v89, v85, v87
    v_fma_f32 v82, v78, 4.0, v76
    v_fma_f32 v90, v86, 4.0, v84
    v_fma_f32 v83, v79, 4.0, v77
    v_fma_f32 v91, v87, 4.0, v85
    v_add_f32 v77, v80, v81
    v_add_f32 v85, v88, v89
    v_sub_f32 v78, v80, v81
    v_sub_f32 v86, v88, v89
    v_fma_f32 v79, v83, 2.0, v82
    v_fma_f32 v87, v91, 2.0, v90
    v_fma_f32 v82, v83, -2.0, v82
    v_fma_f32 v90, v91, -2.0, v90
    v_fmamk_f32 v80, v76, 0x41700000, v82
    v_fmamk_f32 v88, v84, 0x41700000, v90
    v_fmamk_f32 v80, v81, 0x41200000, v80
    v_fmamk_f32 v88, v89, 0x41200000, v88
    v_cvt_pk_bf16_f32 v36, v77, v85
    v_cvt_pk_bf16_f32 v40, v78, v86
    v_cvt_pk_bf16_f32 v64, v79, v87
    v_cvt_pk_bf16_f32 v68, v82, v90
    v_cvt_pk_bf16_f32 v72, v80, v88
    v_lshlrev_b32 v76, 16, v33
    v_and_b32 v84, s25, v33
    v_lshlrev_b32 v77, 16, v37
    v_and_b32 v85, s25, v37
    v_lshlrev_b32 v78, 16, v41
    v_and_b32 v86, s25, v41
    v_lshlrev_b32 v79, 16, v45
    v_and_b32 v87, s25, v45
    v_add_f32 v80, v76, v78
    v_add_f32 v88, v84, v86
    v_add_f32 v81, v77, v79
    v_add_f32 v89, v85, v87
    v_fma_f32 v82, v78, 4.0, v76
    v_fma_f32 v90, v86, 4.0, v84
    v_fma_f32 v83, v79, 4.0, v77
    v_fma_f32 v91, v87, 4.0, v85
    v_add_f32 v77, v80, v81
    v_add_f32 v85, v88, v89
    v_sub_f32 v78, v80, v81
    v_sub_f32 v86, v88, v89
    v_fma_f32 v79, v83, 2.0, v82
    v_fma_f32 v87, v91, 2.0, v90
    v_fma_f32 v82, v83, -2.0, v82
    v_fma_f32 v90, v91, -2.0, v90
    v_fmamk_f32 v80, v76, 0x41700000, v82
    v_fmamk_f32 v88, v84, 0x41700000, v90
    v_fmamk_f32 v80, v81, 0x41200000, v80
    v_fmamk_f32 v88, v89, 0x41200000, v88
    v_cvt_pk_bf16_f32 v37, v77, v85
    v_cvt_pk_bf16_f32 v41, v78, v86
    v_cvt_pk_bf16_f32 v65, v79, v87
    v_cvt_pk_bf16_f32 v69, v82, v90
    v_cvt_pk_bf16_f32 v73, v80, v88
    v_lshlrev_b32 v76, 16, v34
    v_and_b32 v84, s25, v34
    v_lshlrev_b32 v77, 16, v38
    v_and_b32 v85, s25, v38
    v_lshlrev_b32 v78, 16, v42
    v_and_b32 v86, s25, v42
    v_lshlrev_b32 v79, 16, v46
    v_and_b32 v87, s25, v46
    v_add_f32 v80, v76, v78
    v_add_f32 v88, v84, v86
    v_add_f32 v81, v77, v79
    v_add_f32 v89, v85, v87
    v_fma_f32 v82, v78, 4.0, v76
    v_fma_f32 v90, v86, 4.0, v84
    v_fma_f32 v83, v79, 4.0, v77
    v_fma_f32 v91, v87, 4.0, v85
    v_add_f32 v77, v80, v81
    v_add_f32 v85, v88, v89
    v_sub_f32 v78, v80, v81
    v_sub_f32 v86, v88, v89
    v_fma_f32 v79, v83, 2.0, v82
    v_fma_f32 v87, v91, 2.0, v90
    v_fma_f32 v82, v83, -2.0, v82
    v_fma_f32 v90, v91, -2.0, v90
    v_fmamk_f32 v80, v76, 0x41700000, v82
    v_fmamk_f32 v88, v84, 0x41700000, v90
    v_fmamk_f32 v80, v81, 0x41200000, v80
    v_fmamk_f32 v88, v89, 0x41200000, v88
    v_cvt_pk_bf16_f32 v38, v77, v85
    v_cvt_pk_bf16_f32 v42, v78, v86
    v_cvt_pk_bf16_f32 v66, v79, v87
    v_cvt_pk_bf16_f32 v70, v82, v90
    v_cvt_pk_bf16_f32 v74, v80, v88
    v_lshlrev_b32 v76, 16, v35
    v_and_b32 v84, s25, v35
    v_lshlrev_b32 v77, 16, v39
    v_and_b32 v85, s25, v39
    v_lshlrev_b32 v78, 16, v43
    v_and_b32 v86, s25, v43
    v_lshlrev_b32 v79, 16, v47
    v_and_b32 v87, s25, v47
    v_add_f32 v80, v76, v78
    v_add_f32 v88, v84, v86
    v_add_f32 v81, v77, v79
    v_add_f32 v89, v85, v87
    v_fma_f32 v82, v78, 4.0, v76
    v_fma_f32 v90, v86, 4.0, v84
    v_fma_f32 v83, v79, 4.0, v77
    v_fma_f32 v91, v87, 4.0, v85
    v_add_f32 v77, v80, v81
    v_add_f32 v85, v88, v89
    v_sub_f32 v78, v80, v81
    v_sub_f32 v86, v88, v89
    v_fma_f32 v79, v83, 2.0, v82
    v_fma_f32 v87, v91, 2.0, v90
    v_fma_f32 v82, v83, -2.0, v82
    v_fma_f32 v90, v91, -2.0, v90
    v_fmamk_f32 v80, v76, 0x41700000, v82
    v_fmamk_f32 v88, v84, 0x41700000, v90
    v_fmamk_f32 v80, v81, 0x41200000, v80
    v_fmamk_f32 v88, v89, 0x41200000, v88
    v_cvt_pk_bf16_f32 v39, v77, v85
    v_cvt_pk_bf16_f32 v43, v78, v86
    v_cvt_pk_bf16_f32 v67, v79, v87
    v_cvt_pk_bf16_f32 v71, v82, v90
    v_cvt_pk_bf16_f32 v75, v80, v88
    s_add_u32 s28, s28, 1
    s_waitcnt lgkmcnt(0)
    s_barrier
    ds_write_b128 v96, v[64:67] offset:49152
    ds_write_b128 v97, v[68:71] offset:0
    ds_write_b128 v97, v[72:75] offset:16384
    ds_write_b128 v96, v[32:35] offset:0
    ds_write_b128 v96, v[36:39] offset:16384
    ds_write_b128 v96, v[40:43] offset:32768
    ds_write_b128 v98, v[44:47] offset:0
    buffer_load_dwordx4 v[16:19], v92, s[8:11], s27 offen
    buffer_load_dwordx4 v[24:27], v94, s[8:11], s27 offen
    buffer_load_dwordx4 v[20:23], v93, s[8:11], s27 offen
    buffer_load_dwordx4 v[28:31], v95, s[8:11], s27 offen
    v_lshlrev_b32 v76, 16, v48
    v_and_b32 v84, s25, v48
    v_lshlrev_b32 v77, 16, v52
    v_and_b32 v85, s25, v52
    v_lshlrev_b32 v78, 16, v56
    v_and_b32 v86, s25, v56
    v_lshlrev_b32 v79, 16, v60
    v_and_b32 v87, s25, v60
    v_add_f32 v80, v76, v78
    v_add_f32 v88, v84, v86
    v_add_f32 v81, v77, v79
    v_add_f32 v89, v85, v87
    v_fma_f32 v82, v78, 4.0, v76
    v_fma_f32 v90, v86, 4.0, v84
    v_fma_f32 v83, v79, 4.0, v77
    v_fma_f32 v91, v87, 4.0, v85
    v_add_f32 v77, v80, v81
    v_add_f32 v85, v88, v89
    v_sub_f32 v78, v80, v81
    v_sub_f32 v86, v88, v89
    v_fma_f32 v79, v83, 2.0, v82
    v_fma_f32 v87, v91, 2.0, v90
    v_fma_f32 v82, v83, -2.0, v82
    v_fma_f32 v90, v91, -2.0, v90
    v_fmamk_f32 v80, v76, 0x41700000, v82
    v_fmamk_f32 v88, v84, 0x41700000, v90
    v_fmamk_f32 v80, v81, 0x41200000, v80
    v_fmamk_f32 v88, v89, 0x41200000, v88
    v_cvt_pk_bf16_f32 v52, v77, v85
    v_cvt_pk_bf16_f32 v56, v78, v86
    v_cvt_pk_bf16_f32 v64, v79, v87
    v_cvt_pk_bf16_f32 v68, v82, v90
    v_cvt_pk_bf16_f32 v72, v80, v88
    v_lshlrev_b32 v76, 16, v49
    v_and_b32 v84, s25, v49
    v_lshlrev_b32 v77, 16, v53
    v_and_b32 v85, s25, v53
    v_lshlrev_b32 v78, 16, v57
    v_and_b32 v86, s25, v57
    v_lshlrev_b32 v79, 16, v61
    v_and_b32 v87, s25, v61
    v_add_f32 v80, v76, v78
    v_add_f32 v88, v84, v86
    v_add_f32 v81, v77, v79
    v_add_f32 v89, v85, v87
    v_fma_f32 v82, v78, 4.0, v76
    v_fma_f32 v90, v86, 4.0, v84
    v_fma_f32 v83, v79, 4.0, v77
    v_fma_f32 v91, v87, 4.0, v85
    v_add_f32 v77, v80, v81
    v_add_f32 v85, v88, v89
    v_sub_f32 v78, v80, v81
    v_sub_f32 v86, v88, v89
    v_fma_f32 v79, v83, 2.0, v82
    v_fma_f32 v87, v91, 2.0, v90
    v_fma_f32 v82, v83, -2.0, v82
    v_fma_f32 v90, v91, -2.0, v90
    v_fmamk_f32 v80, v76, 0x41700000, v82
    v_fmamk_f32 v88, v84, 0x41700000, v90
    v_fmamk_f32 v80, v81, 0x41200000, v80
    v_fmamk_f32 v88, v89, 0x41200000, v88
    v_cvt_pk_bf16_f32 v53, v77, v85
    v_cvt_pk_bf16_f32 v57, v78, v86
    v_cvt_pk_bf16_f32 v65, v79, v87
    v_cvt_pk_bf16_f32 v69, v82, v90
    v_cvt_pk_bf16_f32 v73, v80, v88
    v_lshlrev_b32 v76, 16, v50
    v_and_b32 v84, s25, v50
    v_lshlrev_b32 v77, 16, v54
    v_and_b32 v85, s25, v54
    v_lshlrev_b32 v78, 16, v58
    v_and_b32 v86, s25, v58
    v_lshlrev_b32 v79, 16, v62
    v_and_b32 v87, s25, v62
    v_add_f32 v80, v76, v78
    v_add_f32 v88, v84, v86
    v_add_f32 v81, v77, v79
    v_add_f32 v89, v85, v87
    v_fma_f32 v82, v78, 4.0, v76
    v_fma_f32 v90, v86, 4.0, v84
    v_fma_f32 v83, v79, 4.0, v77
    v_fma_f32 v91, v87, 4.0, v85
    v_add_f32 v77, v80, v81
    v_add_f32 v85, v88, v89
    v_sub_f32 v78, v80, v81
    v_sub_f32 v86, v88, v89
    v_fma_f32 v79, v83, 2.0, v82
    v_fma_f32 v87, v91, 2.0, v90
    v_fma_f32 v82, v83, -2.0, v82
    v_fma_f32 v90, v91, -2.0, v90
    v_fmamk_f32 v80, v76, 0x41700000, v82
    v_fmamk_f32 v88, v84, 0x41700000, v90
    v_fmamk_f32 v80, v81, 0x41200000, v80
    v_fmamk_f32 v88, v89, 0x41200000, v88
    v_cvt_pk_bf16_f32 v54, v77, v85
    v_cvt_pk_bf16_f32 v58, v78, v86
    v_cvt_pk_bf16_f32 v66, v79, v87
    v_cvt_pk_bf16_f32 v70, v82, v90
    v_cvt_pk_bf16_f32 v74, v80, v88
    v_lshlrev_b32 v76, 16, v51
    v_and_b32 v84, s25, v51
    v_lshlrev_b32 v77, 16, v55
    v_and_b32 v85, s25, v55
    v_lshlrev_b32 v78, 16, v59
    v_and_b32 v86, s25, v59
    v_lshlrev_b32 v79, 16, v63
    v_and_b32 v87, s25, v63
    v_add_f32 v80, v76, v78
    v_add_f32 v88, v84, v86
    v_add_f32 v81, v77, v79
    v_add_f32 v89, v85, v87
    v_fma_f32 v82, v78, 4.0, v76
    v_fma_f32 v90, v86, 4.0, v84
    v_fma_f32 v83, v79, 4.0, v77
    v_fma_f32 v91, v87, 4.0, v85
    v_add_f32 v77, v80, v81
    v_add_f32 v85, v88, v89
    v_sub_f32 v78, v80, v81
    v_sub_f32 v86, v88, v89
    v_fma_f32 v79, v83, 2.0, v82
    v_fma_f32 v87, v91, 2.0, v90
    v_fma_f32 v82, v83, -2.0, v82
    v_fma_f32 v90, v91, -2.0, v90
    v_fmamk_f32 v80, v76, 0x41700000, v82
    v_fmamk_f32 v88, v84, 0x41700000, v90
    v_fmamk_f32 v80, v81, 0x41200000, v80
    v_fmamk_f32 v88, v89, 0x41200000, v88
    v_cvt_pk_bf16_f32 v55, v77, v85
    v_cvt_pk_bf16_f32 v59, v78, v86
    v_cvt_pk_bf16_f32 v67, v79, v87
    v_cvt_pk_bf16_f32 v71, v82, v90
    v_cvt_pk_bf16_f32 v75, v80, v88
    s_add_u32 s28, s28, 1
    s_waitcnt lgkmcnt(0)
    s_barrier
    s_cmp_eq_u32 s22, 1
    s_cbranch_scc1 L_conv2_kernel_hlast2
    s_add_u32 s24, s24, 1048576
    s_add_u32 s27, s27, 1048576
    ds_write_b128 v96, v[64:67] offset:57344
    ds_write_b128 v97, v[68:71] offset:8192
    ds_write_b128 v97, v[72:75] offset:24576
    ds_write_b128 v96, v[48:51] offset:8192
    ds_write_b128 v96, v[52:55] offset:24576
    ds_write_b128 v96, v[56:59] offset:40960
    ds_write_b128 v98, v[60:63] offset:8704
    s_waitcnt vmcnt(0)
    buffer_load_dwordx4 v[32:35], v92, s[8:11], s24 offen
    buffer_load_dwordx4 v[40:43], v94, s[8:11], s24 offen
    buffer_load_dwordx4 v[36:39], v93, s[8:11], s24 offen
    buffer_load_dwordx4 v[44:47], v95, s[8:11], s24 offen
    v_lshlrev_b32 v76, 16, v0
    v_and_b32 v84, s25, v0
    v_lshlrev_b32 v77, 16, v4
    v_and_b32 v85, s25, v4
    v_lshlrev_b32 v78, 16, v8
    v_and_b32 v86, s25, v8
    v_lshlrev_b32 v79, 16, v12
    v_and_b32 v87, s25, v12
    v_add_f32 v80, v76, v78
    v_add_f32 v88, v84, v86
    v_add_f32 v81, v77, v79
    v_add_f32 v89, v85, v87
    v_fma_f32 v82, v78, 4.0, v76
    v_fma_f32 v90, v86, 4.0, v84
    v_fma_f32 v83, v79, 4.0, v77
    v_fma_f32 v91, v87, 4.0, v85
    v_add_f32 v77, v80, v81
    v_add_f32 v85, v88, v89
    v_sub_f32 v78, v80, v81
    v_sub_f32 v86, v88, v89
    v_fma_f32 v79, v83, 2.0, v82
    v_fma_f32 v87, v91, 2.0, v90
    v_fma_f32 v82, v83, -2.0, v82
    v_fma_f32 v90, v91, -2.0, v90
    v_fmamk_f32 v80, v76, 0x41700000, v82
    v_fmamk_f32 v88, v84, 0x41700000, v90
    v_fmamk_f32 v80, v81, 0x41200000, v80
    v_fmamk_f32 v88, v89, 0x41200000, v88
    v_cvt_pk_bf16_f32 v4, v77, v85
    v_cvt_pk_bf16_f32 v8, v78, v86
    v_cvt_pk_bf16_f32 v64, v79, v87
    v_cvt_pk_bf16_f32 v68, v82, v90
    v_cvt_pk_bf16_f32 v72, v80, v88
    v_lshlrev_b32 v76, 16, v1
    v_and_b32 v84, s25, v1
    v_lshlrev_b32 v77, 16, v5
    v_and_b32 v85, s25, v5
    v_lshlrev_b32 v78, 16, v9
    v_and_b32 v86, s25, v9
    v_lshlrev_b32 v79, 16, v13
    v_and_b32 v87, s25, v13
    v_add_f32 v80, v76, v78
    v_add_f32 v88, v84, v86
    v_add_f32 v81, v77, v79
    v_add_f32 v89, v85, v87
    v_fma_f32 v82, v78, 4.0, v76
    v_fma_f32 v90, v86, 4.0, v84
    v_fma_f32 v83, v79, 4.0, v77
    v_fma_f32 v91, v87, 4.0, v85
    v_add_f32 v77, v80, v81
    v_add_f32 v85, v88, v89
    v_sub_f32 v78, v80, v81
    v_sub_f32 v86, v88, v89
    v_fma_f32 v79, v83, 2.0, v82
    v_fma_f32 v87, v91, 2.0, v90
    v_fma_f32 v82, v83, -2.0, v82
    v_fma_f32 v90, v91, -2.0, v90
    v_fmamk_f32 v80, v76, 0x41700000, v82
    v_fmamk_f32 v88, v84, 0x41700000, v90
    v_fmamk_f32 v80, v81, 0x41200000, v80
    v_fmamk_f32 v88, v89, 0x41200000, v88
    v_cvt_pk_bf16_f32 v5, v77, v85
    v_cvt_pk_bf16_f32 v9, v78, v86
    v_cvt_pk_bf16_f32 v65, v79, v87
    v_cvt_pk_bf16_f32 v69, v82, v90
    v_cvt_pk_bf16_f32 v73, v80, v88
    v_lshlrev_b32 v76, 16, v2
    v_and_b32 v84, s25, v2
    v_lshlrev_b32 v77, 16, v6
    v_and_b32 v85, s25, v6
    v_lshlrev_b32 v78, 16, v10
    v_and_b32 v86, s25, v10
    v_lshlrev_b32 v79, 16, v14
    v_and_b32 v87, s25, v14
    v_add_f32 v80, v76, v78
    v_add_f32 v88, v84, v86
    v_add_f32 v81, v77, v79
    v_add_f32 v89, v85, v87
    v_fma_f32 v82, v78, 4.0, v76
    v_fma_f32 v90, v86, 4.0, v84
    v_fma_f32 v83, v79, 4.0, v77
    v_fma_f32 v91, v87, 4.0, v85
    v_add_f32 v77, v80, v81
    v_add_f32 v85, v88, v89
    v_sub_f32 v78, v80, v81
    v_sub_f32 v86, v88, v89
    v_fma_f32 v79, v83, 2.0, v82
    v_fma_f32 v87, v91, 2.0, v90
    v_fma_f32 v82, v83, -2.0, v82
    v_fma_f32 v90, v91, -2.0, v90
    v_fmamk_f32 v80, v76, 0x41700000, v82
    v_fmamk_f32 v88, v84, 0x41700000, v90
    v_fmamk_f32 v80, v81, 0x41200000, v80
    v_fmamk_f32 v88, v89, 0x41200000, v88
    v_cvt_pk_bf16_f32 v6, v77, v85
    v_cvt_pk_bf16_f32 v10, v78, v86
    v_cvt_pk_bf16_f32 v66, v79, v87
    v_cvt_pk_bf16_f32 v70, v82, v90
    v_cvt_pk_bf16_f32 v74, v80, v88
    v_lshlrev_b32 v76, 16, v3
    v_and_b32 v84, s25, v3
    v_lshlrev_b32 v77, 16, v7
    v_and_b32 v85, s25, v7
    v_lshlrev_b32 v78, 16, v11
    v_and_b32 v86, s25, v11
    v_lshlrev_b32 v79, 16, v15
    v_and_b32 v87, s25, v15
    v_add_f32 v80, v76, v78
    v_add_f32 v88, v84, v86
    v_add_f32 v81, v77, v79
    v_add_f32 v89, v85, v87
    v_fma_f32 v82, v78, 4.0, v76
    v_fma_f32 v90, v86, 4.0, v84
    v_fma_f32 v83, v79, 4.0, v77
    v_fma_f32 v91, v87, 4.0, v85
    v_add_f32 v77, v80, v81
    v_add_f32 v85, v88, v89
    v_sub_f32 v78, v80, v81
    v_sub_f32 v86, v88, v89
    v_fma_f32 v79, v83, 2.0, v82
    v_fma_f32 v87, v91, 2.0, v90
    v_fma_f32 v82, v83, -2.0, v82
    v_fma_f32 v90, v91, -2.0, v90
    v_fmamk_f32 v80, v76, 0x41700000, v82
    v_fmamk_f32 v88, v84, 0x41700000, v90
    v_fmamk_f32 v80, v81, 0x41200000, v80
    v_fmamk_f32 v88, v89, 0x41200000, v88
    v_cvt_pk_bf16_f32 v7, v77, v85
    v_cvt_pk_bf16_f32 v11, v78, v86
    v_cvt_pk_bf16_f32 v67, v79, v87
    v_cvt_pk_bf16_f32 v71, v82, v90
    v_cvt_pk_bf16_f32 v75, v80, v88
    s_add_u32 s28, s28, 1
    s_waitcnt lgkmcnt(0)
    s_barrier
    ds_write_b128 v96, v[64:67] offset:49152
    ds_write_b128 v97, v[68:71] offset:0
    ds_write_b128 v97, v[72:75] offset:16384
    ds_write_b128 v96, v[0:3] offset:0
    ds_write_b128 v96, v[4:7] offset:16384
    ds_write_b128 v96, v[8:11] offset:32768
    ds_write_b128 v98, v[12:15] offset:0
    buffer_load_dwordx4 v[48:51], v92, s[8:11], s27 offen
    buffer_load_dwordx4 v[56:59], v94, s[8:11], s27 offen
    buffer_load_dwordx4 v[52:55], v93, s[8:11], s27 offen
    buffer_load_dwordx4 v[60:63], v95, s[8:11], s27 offen
    v_lshlrev_b32 v76, 16, v16
    v_and_b32 v84, s25, v16
    v_lshlrev_b32 v77, 16, v20
    v_and_b32 v85, s25, v20
    v_lshlrev_b32 v78, 16, v24
    v_and_b32 v86, s25, v24
    v_lshlrev_b32 v79, 16, v28
    v_and_b32 v87, s25, v28
    v_add_f32 v80, v76, v78
    v_add_f32 v88, v84, v86
    v_add_f32 v81, v77, v79
    v_add_f32 v89, v85, v87
    v_fma_f32 v82, v78, 4.0, v76
    v_fma_f32 v90, v86, 4.0, v84
    v_fma_f32 v83, v79, 4.0, v77
    v_fma_f32 v91, v87, 4.0, v85
    v_add_f32 v77, v80, v81
    v_add_f32 v85, v88, v89
    v_sub_f32 v78, v80, v81
    v_sub_f32 v86, v88, v89
    v_fma_f32 v79, v83, 2.0, v82
    v_fma_f32 v87, v91, 2.0, v90
    v_fma_f32 v82, v83, -2.0, v82
    v_fma_f32 v90, v91, -2.0, v90
    v_fmamk_f32 v80, v76, 0x41700000, v82
    v_fmamk_f32 v88, v84, 0x41700000, v90
    v_fmamk_f32 v80, v81, 0x41200000, v80
    v_fmamk_f32 v88, v89, 0x41200000, v88
    v_cvt_pk_bf16_f32 v20, v77, v85
    v_cvt_pk_bf16_f32 v24, v78, v86
    v_cvt_pk_bf16_f32 v64, v79, v87
    v_cvt_pk_bf16_f32 v68, v82, v90
    v_cvt_pk_bf16_f32 v72, v80, v88
    v_lshlrev_b32 v76, 16, v17
    v_and_b32 v84, s25, v17
    v_lshlrev_b32 v77, 16, v21
    v_and_b32 v85, s25, v21
    v_lshlrev_b32 v78, 16, v25
    v_and_b32 v86, s25, v25
    v_lshlrev_b32 v79, 16, v29
    v_and_b32 v87, s25, v29
    v_add_f32 v80, v76, v78
    v_add_f32 v88, v84, v86
    v_add_f32 v81, v77, v79
    v_add_f32 v89, v85, v87
    v_fma_f32 v82, v78, 4.0, v76
    v_fma_f32 v90, v86, 4.0, v84
    v_fma_f32 v83, v79, 4.0, v77
    v_fma_f32 v91, v87, 4.0, v85
    v_add_f32 v77, v80, v81
    v_add_f32 v85, v88, v89
    v_sub_f32 v78, v80, v81
    v_sub_f32 v86, v88, v89
    v_fma_f32 v79, v83, 2.0, v82
    v_fma_f32 v87, v91, 2.0, v90
    v_fma_f32 v82, v83, -2.0, v82
    v_fma_f32 v90, v91, -2.0, v90
    v_fmamk_f32 v80, v76, 0x41700000, v82
    v_fmamk_f32 v88, v84, 0x41700000, v90
    v_fmamk_f32 v80, v81, 0x41200000, v80
    v_fmamk_f32 v88, v89, 0x41200000, v88
    v_cvt_pk_bf16_f32 v21, v77, v85
    v_cvt_pk_bf16_f32 v25, v78, v86
    v_cvt_pk_bf16_f32 v65, v79, v87
    v_cvt_pk_bf16_f32 v69, v82, v90
    v_cvt_pk_bf16_f32 v73, v80, v88
    v_lshlrev_b32 v76, 16, v18
    v_and_b32 v84, s25, v18
    v_lshlrev_b32 v77, 16, v22
    v_and_b32 v85, s25, v22
    v_lshlrev_b32 v78, 16, v26
    v_and_b32 v86, s25, v26
    v_lshlrev_b32 v79, 16, v30
    v_and_b32 v87, s25, v30
    v_add_f32 v80, v76, v78
    v_add_f32 v88, v84, v86
    v_add_f32 v81, v77, v79
    v_add_f32 v89, v85, v87
    v_fma_f32 v82, v78, 4.0, v76
    v_fma_f32 v90, v86, 4.0, v84
    v_fma_f32 v83, v79, 4.0, v77
    v_fma_f32 v91, v87, 4.0, v85
    v_add_f32 v77, v80, v81
    v_add_f32 v85, v88, v89
    v_sub_f32 v78, v80, v81
    v_sub_f32 v86, v88, v89
    v_fma_f32 v79, v83, 2.0, v82
    v_fma_f32 v87, v91, 2.0, v90
    v_fma_f32 v82, v83, -2.0, v82
    v_fma_f32 v90, v91, -2.0, v90
    v_fmamk_f32 v80, v76, 0x41700000, v82
    v_fmamk_f32 v88, v84, 0x41700000, v90
    v_fmamk_f32 v80, v81, 0x41200000, v80
    v_fmamk_f32 v88, v89, 0x41200000, v88
    v_cvt_pk_bf16_f32 v22, v77, v85
    v_cvt_pk_bf16_f32 v26, v78, v86
    v_cvt_pk_bf16_f32 v66, v79, v87
    v_cvt_pk_bf16_f32 v70, v82, v90
    v_cvt_pk_bf16_f32 v74, v80, v88
    v_lshlrev_b32 v76, 16, v19
    v_and_b32 v84, s25, v19
    v_lshlrev_b32 v77, 16, v23
    v_and_b32 v85, s25, v23
    v_lshlrev_b32 v78, 16, v27
    v_and_b32 v86, s25, v27
    v_lshlrev_b32 v79, 16, v31
    v_and_b32 v87, s25, v31
    v_add_f32 v80, v76, v78
    v_add_f32 v88, v84, v86
    v_add_f32 v81, v77, v79
    v_add_f32 v89, v85, v87
    v_fma_f32 v82, v78, 4.0, v76
    v_fma_f32 v90, v86, 4.0, v84
    v_fma_f32 v83, v79, 4.0, v77
    v_fma_f32 v91, v87, 4.0, v85
    v_add_f32 v77, v80, v81
    v_add_f32 v85, v88, v89
    v_sub_f32 v78, v80, v81
    v_sub_f32 v86, v88, v89
    v_fma_f32 v79, v83, 2.0, v82
    v_fma_f32 v87, v91, 2.0, v90
    v_fma_f32 v82, v83, -2.0, v82
    v_fma_f32 v90, v91, -2.0, v90
    v_fmamk_f32 v80, v76, 0x41700000, v82
    v_fmamk_f32 v88, v84, 0x41700000, v90
    v_fmamk_f32 v80, v81, 0x41200000, v80
    v_fmamk_f32 v88, v89, 0x41200000, v88
    v_cvt_pk_bf16_f32 v23, v77, v85
    v_cvt_pk_bf16_f32 v27, v78, v86
    v_cvt_pk_bf16_f32 v67, v79, v87
    v_cvt_pk_bf16_f32 v71, v82, v90
    v_cvt_pk_bf16_f32 v75, v80, v88
    s_add_u32 s28, s28, 1
    s_waitcnt lgkmcnt(0)
    s_barrier
    s_sub_u32 s22, s22, 1
    s_branch L_conv2_kernel_hloop2
L_conv2_kernel_hlast2:
    s_mov_b32 s25, 0xffff0000
    ds_write_b128 v96, v[64:67] offset:57344
    ds_write_b128 v97, v[68:71] offset:8192
    ds_write_b128 v97, v[72:75] offset:24576
    ds_write_b128 v96, v[48:51] offset:8192
    ds_write_b128 v96, v[52:55] offset:24576
    ds_write_b128 v96, v[56:59] offset:40960
    ds_write_b128 v98, v[60:63] offset:8704
    s_waitcnt lgkmcnt(0)
    s_barrier
    s_branch L_conv2_kernel_end
L_conv2_kernel_epi:
    s_waitcnt lgkmcnt(0)
    s_barrier
    v_cndmask_b32 v122, v111, v110, vcc
    ds_read_b128 v[0:3], v120 offset:0
    ds_read_b128 v[4:7], v120 offset:16384
    ds_read_b128 v[8:11], v120 offset:32768
    ds_read_b128 v[12:15], v120 offset:49152
    ds_read_b128 v[16:19], v121 offset:0
    ds_read_b128 v[20:23], v121 offset:16384
    ds_read_b128 v[24:27], v121 offset:32768
    ds_read_b128 v[28:31], v64 offset:15360
    ds_read_b128 v[32:35], v120 offset:8192
    ds_read_b128 v[36:39], v120 offset:24576
    ds_read_b128 v[40:43], v120 offset:40960
    ds_read_b128 v[44:47], v120 offset:57344
    ds_read_b128 v[48:51], v121 offset:56320
    ds_read_b128 v[52:55], v121 offset:64512
    ds_read_b128 v[56:59], v64 offset:7168
    s_waitcnt lgkmcnt(7)
    ds_read_b128 v[60:63], v64 offset:23552
    s_waitcnt lgkmcnt(8)
    v_pk_add_f32 v[88:89], v[24:25], v[28:29]
    v_pk_add_f32 v[90:91], v[26:27], v[30:31]
    v_pk_add_f32 v[24:25], v[4:5], v[8:9]
    v_pk_add_f32 v[26:27], v[6:7], v[10:11]
    v_pk_add_f32 v[4:5], v[4:5], v[8:9] neg_lo:[0,1] neg_hi:[0,1]
    v_pk_add_f32 v[6:7], v[6:7], v[10:11] neg_lo:[0,1] neg_hi:[0,1]
    v_pk_add_f32 v[72:73], v[12:13], v[16:17]
    v_pk_add_f32 v[74:75], v[14:15], v[18:19]
    v_pk_add_f32 v[12:13], v[12:13], v[16:17] neg_lo:[0,1] neg_hi:[0,1]
    v_pk_add_f32 v[14:15], v[14:15], v[18:19] neg_lo:[0,1] neg_hi:[0,1]
    v_pk_fma_f32 v[72:73], v[24:25], s[4:5], v[72:73]
    v_pk_fma_f32 v[74:75], v[26:27], s[4:5], v[74:75]
    v_pk_fma_f32 v[20:21], v[0:1], s[10:11], v[20:21]
    v_pk_fma_f32 v[22:23], v[2:3], s[10:11], v[22:23]
    v_pk_fma_f32 v[72:73], v[0:1], s[6:7], v[72:73]
    v_pk_fma_f32 v[74:75], v[2:3], s[6:7], v[74:75]
    v_pk_add_f32 v[24:25], v[24:25], v[0:1] neg_lo:[0,1] neg_hi:[0,1]
    v_pk_add_f32 v[26:27], v[26:27], v[2:3] neg_lo:[0,1] neg_hi:[0,1]
    v_pk_fma_f32 v[72:73], v[88:89], s[8:9], v[72:73]
    v_pk_fma_f32 v[74:75], v[90:91], s[8:9], v[74:75]
    v_pk_add_f32 v[24:25], v[24:25], v[88:89] neg_lo:[0,1] neg_hi:[0,1]
    v_pk_add_f32 v[26:27], v[26:27], v[90:91] neg_lo:[0,1] neg_hi:[0,1]
    v_pk_fma_f32 v[20:21], v[88:89], s[22:23], v[20:21]
    v_pk_fma_f32 v[22:23], v[90:91], s[22:23], v[22:23]
    v_pk_add_f32 v[8:9], v[24:25], v[72:73] neg_lo:[0,1] neg_hi:[0,1]
    v_pk_add_f32 v[10:11], v[26:27], v[74:75] neg_lo:[0,1] neg_hi:[0,1]
    v_pk_fma_f32 v[20:21], v[72:73], s[14:15], v[20:21]
    v_pk_fma_f32 v[22:23], v[74:75], s[14:15], v[22:23]
    v_pk_mul_f32 v[80:81], v[12:13], s[32:33]
    v_pk_mul_f32 v[82:83], v[14:15], s[32:33]
    v_pk_fma_f32 v[20:21], v[8:9], s[12:13], v[20:21]
    v_pk_fma_f32 v[22:23], v[10:11], s[12:13], v[22:23]
    v_pk_fma_f32 v[80:81], v[4:5], s[34:35], v[80:81]
    v_pk_fma_f32 v[82:83], v[6:7], s[34:35], v[82:83]
    v_pk_fma_f32 v[64:65], v[4:5], s[24:25], v[20:21] neg_lo:[0,0,1] neg_hi:[0,0,1]
    v_pk_fma_f32 v[66:67], v[6:7], s[24:25], v[22:23] neg_lo:[0,0,1] neg_hi:[0,0,1]
    v_pk_fma_f32 v[64:65], v[12:13], s[26:27], v[64:65]
    v_pk_fma_f32 v[66:67], v[14:15], s[26:27], v[66:67]
    v_pk_fma_f32 v[80:81], v[64:65], s[38:39], v[80:81]
    v_pk_fma_f32 v[82:83], v[66:67], s[38:39], v[82:83]
    v_pk_add_f32 v[4:5], v[4:5], v[64:65] neg_lo:[0,1] neg_hi:[0,1]
    v_pk_add_f32 v[6:7], v[6:7], v[66:67] neg_lo:[0,1] neg_hi:[0,1]
    v_pk_add_f32 v[4:5], v[4:5], v[80:81] neg_lo:[0,1] neg_hi:[0,1]
    v_pk_add_f32 v[6:7], v[6:7], v[82:83] neg_lo:[0,1] neg_hi:[0,1]
    s_waitcnt lgkmcnt(0)
    v_pk_add_f32 v[92:93], v[56:57], v[60:61]
    v_pk_add_f32 v[94:95], v[58:59], v[62:63]
    v_pk_add_f32 v[56:57], v[36:37], v[40:41]
    v_pk_add_f32 v[58:59], v[38:39], v[42:43]
    v_pk_add_f32 v[36:37], v[36:37], v[40:41] neg_lo:[0,1] neg_hi:[0,1]
    v_pk_add_f32 v[38:39], v[38:39], v[42:43] neg_lo:[0,1] neg_hi:[0,1]
    v_pk_add_f32 v[76:77], v[44:45], v[48:49]
    v_pk_add_f32 v[78:79], v[46:47], v[50:51]
    v_pk_add_f32 v[44:45], v[44:45], v[48:49] neg_lo:[0,1] neg_hi:[0,1]
    v_pk_add_f32 v[46:47], v[46:47], v[50:51] neg_lo:[0,1] neg_hi:[0,1]
    v_pk_fma_f32 v[76:77], v[56:57], s[4:5], v[76:77]
    v_pk_fma_f32 v[78:79], v[58:59], s[4:5], v[78:79]
    v_pk_fma_f32 v[52:53], v[32:33], s[10:11], v[52:53]
    v_pk_fma_f32 v[54:55], v[34:35], s[10:11], v[54:55]
    v_pk_fma_f32 v[76:77], v[32:33], s[6:7], v[76:77]
    v_pk_fma_f32 v[78:79], v[34:35], s[6:7], v[78:79]
    v_pk_add_f32 v[56:57], v[56:57], v[32:33] neg_lo:[0,1] neg_hi:[0,1]
    v_pk_add_f32 v[58:59], v[58:59], v[34:35] neg_lo:[0,1] neg_hi:[0,1]
    v_pk_fma_f32 v[76:77], v[92:93], s[8:9], v[76:77]
    v_pk_fma_f32 v[78:79], v[94:95], s[8:9], v[78:79]
    v_pk_add_f32 v[56:57], v[56:57], v[92:93] neg_lo:[0,1] neg_hi:[0,1]
    v_pk_add_f32 v[58:59], v[58:59], v[94:95] neg_lo:[0,1] neg_hi:[0,1]
    v_pk_fma_f32 v[52:53], v[92:93], s[22:23], v[52:53]
    v_pk_fma_f32 v[54:55], v[94:95], s[22:23], v[54:55]
    v_pk_add_f32 v[40:41], v[56:57], v[76:77] neg_lo:[0,1] neg_hi:[0,1]
    v_pk_add_f32 v[42:43], v[58:59], v[78:79] neg_lo:[0,1] neg_hi:[0,1]
    v_pk_fma_f32 v[52:53], v[76:77], s[14:15], v[52:53]
    v_pk_fma_f32 v[54:55], v[78:79], s[14:15], v[54:55]
    v_pk_mul_f32 v[84:85], v[44:45], s[32:33]
    v_pk_mul_f32 v[86:87], v[46:47], s[32:33]
    v_pk_fma_f32 v[52:53], v[40:41], s[12:13], v[52:53]
    v_pk_fma_f32 v[54:55], v[42:43], s[12:13], v[54:55]
    v_pk_fma_f32 v[84:85], v[36:37], s[34:35], v[84:85]
    v_pk_fma_f32 v[86:87], v[38:39], s[34:35], v[86:87]
    v_pk_fma_f32 v[68:69], v[36:37], s[24:25], v[52:53] neg_lo:[0,0,1] neg_hi:[0,0,1]
    v_pk_fma_f32 v[70:71], v[38:39], s[24:25], v[54:55] neg_lo:[0,0,1] neg_hi:[0,0,1]
    v_pk_fma_f32 v[68:69], v[44:45], s[26:27], v[68:69]
    v_pk_fma_f32 v[70:71], v[46:47], s[26:27], v[70:71]
    v_pk_fma_f32 v[84:85], v[68:69], s[38:39], v[84:85]
    v_pk_fma_f32 v[86:87], v[70:71], s[38:39], v[86:87]
    v_pk_add_f32 v[36:37], v[36:37], v[68:69] neg_lo:[0,1] neg_hi:[0,1]
    v_pk_add_f32 v[38:39], v[38:39], v[70:71] neg_lo:[0,1] neg_hi:[0,1]
    v_pk_add_f32 v[36:37], v[36:37], v[84:85] neg_lo:[0,1] neg_hi:[0,1]
    v_pk_add_f32 v[38:39], v[38:39], v[86:87] neg_lo:[0,1] neg_hi:[0,1]
    s_mov_b32 s36, 0x00010001
    s_mov_b32 s37, 0x00010001
    s_mov_b64 exec, s[36:37]
    ds_write_b128 v127, v[0:3] offset:0
    ds_write_b128 v127, v[32:35] offset:16
    ds_write_b128 v127, v[4:7] offset:32
    ds_write_b128 v127, v[36:39] offset:48
    ds_write_b128 v127, v[8:11] offset:64
    ds_write_b128 v127, v[40:43] offset:80
    s_mov_b64 exec, -1
    v_mov_b32 v44, 0xc0135761
    v_mov_b32 v45, v44
    v_cvt_pk_bf16_f32 v48, v64, v68
    v_cvt_pk_bf16_f32 v49, v65, v69
    v_cvt_pk_bf16_f32 v50, v66, v70
    v_cvt_pk_bf16_f32 v51, v67, v71
    s_mov_b32 s44, 0
    buffer_store_dwordx4 v[48:51], v122, s[16:19], s44 offen sc1
    s_waitcnt lgkmcnt(0)
    s_barrier
    ds_read_b128 v[96:99], v127 offset:512
    ds_read_b128 v[100:103], v127 offset:528
    ds_read_b128 v[104:107], v127 offset:544
    ds_read_b128 v[108:111], v127 offset:560
    ds_read_b128 v[112:115], v127 offset:576
    ds_read_b128 v[116:119], v127 offset:592
    s_waitcnt lgkmcnt(4)
    v_mov_b32_dpp v96, v0 row_shl:1 row_mask:0xf bank_mask:0xf
    v_mov_b32_dpp v97, v1 row_shl:1 row_mask:0xf bank_mask:0xf
    v_mov_b32_dpp v98, v2 row_shl:1 row_mask:0xf bank_mask:0xf
    v_mov_b32_dpp v99, v3 row_shl:1 row_mask:0xf bank_mask:0xf
    v_mov_b32_dpp v100, v32 row_shl:1 row_mask:0xf bank_mask:0xf
    v_mov_b32_dpp v101, v33 row_shl:1 row_mask:0xf bank_mask:0xf
    v_mov_b32_dpp v102, v34 row_shl:1 row_mask:0xf bank_mask:0xf
    v_mov_b32_dpp v103, v35 row_shl:1 row_mask:0xf bank_mask:0xf
    v_pk_add_f32 v[72:73], v[72:73], v[96:97]
    v_pk_add_f32 v[74:75], v[74:75], v[98:99]
    v_pk_add_f32 v[76:77], v[76:77], v[100:101]
    v_pk_add_f32 v[78:79], v[78:79], v[102:103]
    v_cvt_pk_bf16_f32 v52, v72, v76
    v_cvt_pk_bf16_f32 v53, v73, v77
    v_cvt_pk_bf16_f32 v54, v74, v78
    v_cvt_pk_bf16_f32 v55, v75, v79
    s_mov_b32 s44, 65536
    buffer_store_dwordx4 v[52:55], v122, s[16:19], s44 offen sc1
    s_waitcnt lgkmcnt(2)
    v_mov_b32_dpp v104, v4 row_shl:1 row_mask:0xf bank_mask:0xf
    v_mov_b32_dpp v105, v5 row_shl:1 row_mask:0xf bank_mask:0xf
    v_mov_b32_dpp v106, v6 row_shl:1 row_mask:0xf bank_mask:0xf
    v_mov_b32_dpp v107, v7 row_shl:1 row_mask:0xf bank_mask:0xf
    v_mov_b32_dpp v108, v36 row_shl:1 row_mask:0xf bank_mask:0xf
    v_mov_b32_dpp v109, v37 row_shl:1 row_mask:0xf bank_mask:0xf
    v_mov_b32_dpp v110, v38 row_shl:1 row_mask:0xf bank_mask:0xf
    v_mov_b32_dpp v111, v39 row_shl:1 row_mask:0xf bank_mask:0xf
    v_pk_add_f32 v[80:81], v[80:81], v[104:105]
    v_pk_add_f32 v[82:83], v[82:83], v[106:107]
    v_pk_add_f32 v[84:85], v[84:85], v[108:109]
    v_pk_add_f32 v[86:87], v[86:87], v[110:111]
    v_cvt_pk_bf16_f32 v56, v80, v84
    v_cvt_pk_bf16_f32 v57, v81, v85
    v_cvt_pk_bf16_f32 v58, v82, v86
    v_cvt_pk_bf16_f32 v59, v83, v87
    s_mov_b32 s44, 131072
    buffer_store_dwordx4 v[56:59], v122, s[16:19], s44 offen sc1
    s_waitcnt lgkmcnt(0)
    v_mov_b32_dpp v112, v8 row_shl:1 row_mask:0xf bank_mask:0xf
    v_mov_b32_dpp v113, v9 row_shl:1 row_mask:0xf bank_mask:0xf
    v_mov_b32_dpp v114, v10 row_shl:1 row_mask:0xf bank_mask:0xf
    v_mov_b32_dpp v115, v11 row_shl:1 row_mask:0xf bank_mask:0xf
    v_mov_b32_dpp v116, v40 row_shl:1 row_mask:0xf bank_mask:0xf
    v_mov_b32_dpp v117, v41 row_shl:1 row_mask:0xf bank_mask:0xf
    v_mov_b32_dpp v118, v42 row_shl:1 row_mask:0xf bank_mask:0xf
    v_mov_b32_dpp v119, v43 row_shl:1 row_mask:0xf bank_mask:0xf
    v_pk_add_f32 v[88:89], v[88:89], v[112:113]
    v_pk_add_f32 v[90:91], v[90:91], v[114:115]
    v_pk_add_f32 v[92:93], v[92:93], v[116:117]
    v_pk_add_f32 v[94:95], v[94:95], v[118:119]
    v_cvt_pk_bf16_f32 v60, v88, v92
    v_cvt_pk_bf16_f32 v61, v89, v93
    v_cvt_pk_bf16_f32 v62, v90, v94
    v_cvt_pk_bf16_f32 v63, v91, v95
    s_mov_b32 s44, 196608
    buffer_store_dwordx4 v[60:63], v122, s[16:19], s44 offen sc1
L_conv2_kernel_end:
L_conv2_kernel_done:
    s_endpgm
.globl joint_kernel
.p2align 8
.type joint_kernel,@function
joint_kernel:
    s_cmp_ge_u32 s2, 250
    s_cbranch_scc1 L_joint_kernel_done
    s_load_dwordx2 s[28:29], s[0:1], 56
    s_load_dwordx2 s[30:31], s[0:1], 72
    v_readfirstlane_b32 s20, v0
    s_lshr_b32 s20, s20, 6
    s_and_b32 s21, s20, 7
    v_and_b32 v127, 63, v0
    v_lshlrev_b32 v126, 4, v127
    s_cmp_ge_u32 s20, 8
    s_mov_b32 s33, 44171264
    s_cselect_b32 s33, 44040192, s33
    s_lshl_b32 s36, s21, 14
    s_add_u32 s33, s33, s36
    s_mov_b32 s14, 16384
    s_mov_b32 s15, 0x00020000
    s_lshl_b32 s35, s2, 9
    s_cmp_ge_u32 s2, 125
    s_cselect_b32 s36, 2033152, 0
    s_cselect_b32 s34, 8192, 0
    s_add_u32 s35, s35, s36
    s_add_u32 s34, s34, 44302336
    s_mov_b32 s10, 12582912
    s_mov_b32 s11, 0x00020000
    s_mov_b32 s42, 24576
    s_mov_b32 s43, 0x00020000
    s_waitcnt lgkmcnt(0)
    s_add_u32 s12, s30, s33
    s_addc_u32 s13, s31, 0
    s_add_u32 s40, s30, s34
    s_addc_u32 s41, s31, 0
    s_cmp_ge_u32 s20, 8
    s_cbranch_scc1 L_joint_kernel_T
    s_add_u32 s8, s30, 27262976
    s_addc_u32 s9, s31, 0
    v_mov_b32 v0, 99456
    v_mov_b32 v2, 0
    v_mov_b32 v3, 0
    ds_write_b64 v0, v[2:3]
    v_lshrrev_b32 v124, 5, v127
    v_and_b32 v123, 0x1ff, v126
    v_mul_u32_u24 v125, 65536, v124
    v_add_u32 v123, v125, v123
    s_mul_i32 s36, s21, 262144
    s_add_u32 s36, s36, s35
    s_add_u32 s37, s36, 8388608
    buffer_load_dwordx4 v[64:67], v123, s[8:11], s36 offen
    buffer_load_dwordx4 v[72:75], v123, s[8:11], s37 offen
    s_add_u32 s36, s36, 131072
    s_add_u32 s37, s36, 8388608
    buffer_load_dwordx4 v[68:71], v123, s[8:11], s36 offen
    buffer_load_dwordx4 v[76:79], v123, s[8:11], s37 offen
    s_lshl_b32 s38, s21, 10
    s_add_u32 s38, s38, 16384
    buffer_load_dwordx4 v[80:83], v126, s[40:43], s38 offen
    s_waitcnt lgkmcnt(0)
    s_barrier
    s_lshl_b32 s35, s2, 17
    s_add_u32 s16, s28, s35
    s_addc_u32 s17, s29, 0
    s_mov_b32 s18, 131072
    s_mov_b32 s19, 0x00020000
    s_mov_b32 s46, 0xbdd2d3e8
    s_mov_b32 s47, s46
    v_mov_b32 v120, 0xc0135761
    v_mov_b32 v121, v120
    s_mov_b32 s48, 1.0
    s_mov_b32 s49, 1.0
    v_bfe_u32 v123, v127, 2, 3
    v_lshl_add_u32 v124, v123, 2, v124
    v_mul_u32_u24 v124, 528, v124
    v_and_b32 v123, 0x30, v126
    s_lshl_b32 s36, s21, 6
    v_add3_u32 v124, v124, v123, s36
    s_mov_b32 s45, 0xffff0000
    s_mul_i32 s36, s21, 1040
    s_add_u32 s36, s36, 91136
    v_add_u32 v123, s36, v126
    s_mov_b32 s22, 2
    s_waitcnt vmcnt(3)
L_joint_kernel_floop:
    v_lshlrev_b32 v88, 16, v64
    v_and_b32 v89, s45, v64
    v_lshlrev_b32 v96, 16, v72
    v_and_b32 v97, s45, v72
    v_lshlrev_b32 v90, 16, v65
    v_and_b32 v91, s45, v65
    v_lshlrev_b32 v98, 16, v73
    v_and_b32 v99, s45, v73
    v_lshlrev_b32 v92, 16, v66
    v_and_b32 v93, s45, v66
    v_lshlrev_b32 v100, 16, v74
    v_and_b32 v101, s45, v74
    v_lshlrev_b32 v94, 16, v67
    v_and_b32 v95, s45, v67
    v_lshlrev_b32 v102, 16, v75
    v_and_b32 v103, s45, v75
    v_pk_add_f32 v[88:89], v[88:89], v[96:97]
    v_pk_add_f32 v[90:91], v[90:91], v[98:99]
    v_pk_add_f32 v[92:93], v[92:93], v[100:101]
    v_pk_add_f32 v[94:95], v[94:95], v[102:103]
    v_pk_mul_f32 v[96:97], v[88:89], v[88:89]
    v_pk_mul_f32 v[98:99], v[90:91], v[90:91]
    v_pk_mul_f32 v[100:101], v[92:93], v[92:93]
    v_pk_mul_f32 v[102:103], v[94:95], v[94:95]
    v_pk_fma_f32 v[96:97], v[96:97], s[46:47], v[120:121]
    v_pk_fma_f32 v[98:99], v[98:99], s[46:47], v[120:121]
    v_pk_fma_f32 v[100:101], v[100:101], s[46:47], v[120:121]
    v_pk_fma_f32 v[102:103], v[102:103], s[46:47], v[120:121]
    v_pk_mul_f32 v[96:97], v[96:97], v[88:89]
    v_pk_mul_f32 v[98:99], v[98:99], v[90:91]
    v_pk_mul_f32 v[100:101], v[100:101], v[92:93]
    v_pk_mul_f32 v[102:103], v[102:103], v[94:95]
    v_exp_f32 v96, v96
    v_exp_f32 v97, v97
    v_exp_f32 v98, v98
    v_exp_f32 v99, v99
    v_exp_f32 v100, v100
    v_exp_f32 v101, v101
    v_exp_f32 v102, v102
    v_exp_f32 v103, v103
    v_pk_add_f32 v[96:97], v[96:97], s[48:49]
    v_pk_add_f32 v[98:99], v[98:99], s[48:49]
    v_pk_add_f32 v[100:101], v[100:101], s[48:49]
    v_pk_add_f32 v[102:103], v[102:103], s[48:49]
    v_rcp_f32 v96, v96
    v_rcp_f32 v97, v97
    v_rcp_f32 v98, v98
    v_rcp_f32 v99, v99
    v_rcp_f32 v100, v100
    v_rcp_f32 v101, v101
    v_rcp_f32 v102, v102
    v_rcp_f32 v103, v103
    v_pk_mul_f32 v[88:89], v[88:89], v[96:97]
    v_pk_mul_f32 v[90:91], v[90:91], v[98:99]
    v_pk_mul_f32 v[92:93], v[92:93], v[100:101]
    v_pk_mul_f32 v[94:95], v[94:95], v[102:103]
    v_cvt_pk_bf16_f32 v104, v88, v89
    v_cvt_pk_bf16_f32 v105, v90, v91
    v_cvt_pk_bf16_f32 v106, v92, v93
    v_cvt_pk_bf16_f32 v107, v94, v95
    ds_write_b128 v124, v[104:107] offset:32768
    s_waitcnt vmcnt(0)
    v_pk_mov_b32 v[64:65], v[68:69], v[68:69] op_sel:[0,1]
    v_pk_mov_b32 v[72:73], v[76:77], v[76:77] op_sel:[0,1]
    v_pk_mov_b32 v[66:67], v[70:71], v[70:71] op_sel:[0,1]
    v_pk_mov_b32 v[74:75], v[78:79], v[78:79] op_sel:[0,1]
    v_add_u32 v124, 1056, v124
    s_sub_u32 s22, s22, 1
    s_cmp_lg_u32 s22, 0
    s_cbranch_scc1 L_joint_kernel_floop
    ds_write_b128 v123, v[80:83]
    s_waitcnt lgkmcnt(0)
    v_mov_b32 v120, 99456
    v_mov_b32 v121, 1
    s_mov_b64 exec, 1
    ds_add_u32 v120, v121 offset:0
    s_mov_b64 exec, -1
L_joint_kernel_ow:
    ds_read_b32 v121, v120 offset:4
    s_waitcnt lgkmcnt(0)
    v_readfirstlane_b32 s37, v121
    s_cmp_ge_u32 s37, 8
    s_cbranch_scc1 L_joint_kernel_ow_d
    s_sleep 1
    s_branch L_joint_kernel_ow
L_joint_kernel_ow_d:
    s_mov_b32 s36, 0
    buffer_load_dwordx4 v[0:3], v126, s[12:15], s36 offen offset:0
    buffer_load_dwordx4 v[4:7], v126, s[12:15], s36 offen offset:1024
    buffer_load_dwordx4 v[8:11], v126, s[12:15], s36 offen offset:2048
    buffer_load_dwordx4 v[12:15], v126, s[12:15], s36 offen offset:3072
    s_mov_b32 s36, 4096
    buffer_load_dwordx4 v[16:19], v126, s[12:15], s36 offen offset:0
    buffer_load_dwordx4 v[20:23], v126, s[12:15], s36 offen offset:1024
    buffer_load_dwordx4 v[24:27], v126, s[12:15], s36 offen offset:2048
    buffer_load_dwordx4 v[28:31], v126, s[12:15], s36 offen offset:3072
    s_mov_b32 s36, 8192
    buffer_load_dwordx4 v[32:35], v126, s[12:15], s36 offen offset:0
    buffer_load_dwordx4 v[36:39], v126, s[12:15], s36 offen offset:1024
    buffer_load_dwordx4 v[40:43], v126, s[12:15], s36 offen offset:2048
    buffer_load_dwordx4 v[44:47], v126, s[12:15], s36 offen offset:3072
    s_mov_b32 s36, 12288
    buffer_load_dwordx4 v[48:51], v126, s[12:15], s36 offen offset:0
    buffer_load_dwordx4 v[52:55], v126, s[12:15], s36 offen offset:1024
    buffer_load_dwordx4 v[56:59], v126, s[12:15], s36 offen offset:2048
    buffer_load_dwordx4 v[60:63], v126, s[12:15], s36 offen offset:3072
    v_lshrrev_b32 v125, 4, v127
    v_lshlrev_b32 v125, 11, v125
    v_and_b32 v124, 15, v127
    v_lshl_add_u32 v125, v124, 2, v125
    s_lshl_b32 s36, s21, 6
    v_add_u32 v125, s36, v125
    s_mov_b32 s44, 8192
    s_setprio 1
    s_barrier
    ds_read_b128 v[96:99], v126 offset:0
    ds_read_b128 v[100:103], v126 offset:1024
    ds_read_b128 v[104:107], v126 offset:2048
    ds_read_b128 v[108:111], v126 offset:3072
    s_waitcnt vmcnt(14) lgkmcnt(3)
    v_mfma_f32_16x16x32_bf16 v[64:67], v[96:99], v[0:3], 0
    v_mfma_f32_16x16x32_bf16 v[68:71], v[96:99], v[4:7], 0
    ds_read_b128 v[96:99], v126 offset:4096
    s_waitcnt lgkmcnt(3)
    v_mfma_f32_16x16x32_bf16 v[72:75], v[100:103], v[0:3], 0
    v_mfma_f32_16x16x32_bf16 v[76:79], v[100:103], v[4:7], 0
    ds_read_b128 v[100:103], v126 offset:5120
    s_waitcnt vmcnt(12) lgkmcnt(3)
    v_mfma_f32_16x16x32_bf16 v[64:67], v[104:107], v[8:11], v[64:67]
    v_mfma_f32_16x16x32_bf16 v[68:71], v[104:107], v[12:15], v[68:71]
    ds_read_b128 v[104:107], v126 offset:6144
    s_waitcnt lgkmcnt(3)
    v_mfma_f32_16x16x32_bf16 v[72:75], v[108:111], v[8:11], v[72:75]
    v_mfma_f32_16x16x32_bf16 v[76:79], v[108:111], v[12:15], v[76:79]
    ds_read_b128 v[108:111], v126 offset:7168
    s_waitcnt vmcnt(10) lgkmcnt(3)
    v_mfma_f32_16x16x32_bf16 v[64:67], v[96:99], v[16:19], v[64:67]
    v_mfma_f32_16x16x32_bf16 v[68:71], v[96:99], v[20:23], v[68:71]
    ds_read_b128 v[96:99], v126 offset:8192
    s_waitcnt lgkmcnt(3)
    v_mfma_f32_16x16x32_bf16 v[72:75], v[100:103], v[16:19], v[72:75]
    v_mfma_f32_16x16x32_bf16 v[76:79], v[100:103], v[20:23], v[76:79]
    ds_read_b128 v[100:103], v126 offset:9216
    s_waitcnt vmcnt(8) lgkmcnt(3)
    v_mfma_f32_16x16x32_bf16 v[64:67], v[104:107], v[24:27], v[64:67]
    v_mfma_f32_16x16x32_bf16 v[68:71], v[104:107], v[28:31], v[68:71]
    ds_read_b128 v[104:107], v126 offset:10240
    s_waitcnt lgkmcnt(3)
    v_mfma_f32_16x16x32_bf16 v[72:75], v[108:111], v[24:27], v[72:75]
    v_mfma_f32_16x16x32_bf16 v[76:79], v[108:111], v[28:31], v[76:79]
    ds_read_b128 v[108:111], v126 offset:11264
    s_waitcnt vmcnt(6) lgkmcnt(3)
    v_mfma_f32_16x16x32_bf16 v[64:67], v[96:99], v[32:35], v[64:67]
    v_mfma_f32_16x16x32_bf16 v[68:71], v[96:99], v[36:39], v[68:71]
    ds_read_b128 v[96:99], v126 offset:12288
    s_waitcnt lgkmcnt(3)
    v_mfma_f32_16x16x32_bf16 v[72:75], v[100:103], v[32:35], v[72:75]
    v_mfma_f32_16x16x32_bf16 v[76:79], v[100:103], v[36:39], v[76:79]
    ds_read_b128 v[100:103], v126 offset:13312
    s_waitcnt vmcnt(4) lgkmcnt(3)
    v_mfma_f32_16x16x32_bf16 v[64:67], v[104:107], v[40:43], v[64:67]
    v_mfma_f32_16x16x32_bf16 v[68:71], v[104:107], v[44:47], v[68:71]
    ds_read_b128 v[104:107], v126 offset:14336
    s_waitcnt lgkmcnt(3)
    v_mfma_f32_16x16x32_bf16 v[72:75], v[108:111], v[40:43], v[72:75]
    v_mfma_f32_16x16x32_bf16 v[76:79], v[108:111], v[44:47], v[76:79]
    ds_read_b128 v[108:111], v126 offset:15360
    s_waitcnt vmcnt(2) lgkmcnt(3)
    v_mfma_f32_16x16x32_bf16 v[64:67], v[96:99], v[48:51], v[64:67]
    v_mfma_f32_16x16x32_bf16 v[68:71], v[96:99], v[52:55], v[68:71]
    s_waitcnt lgkmcnt(0)
    s_barrier
    ds_read_b128 v[96:99], v126 offset:16384
    v_mfma_f32_16x16x32_bf16 v[72:75], v[100:103], v[48:51], v[72:75]
    v_mfma_f32_16x16x32_bf16 v[76:79], v[100:103], v[52:55], v[76:79]
    ds_read_b128 v[100:103], v126 offset:17408
    s_waitcnt vmcnt(0)
    v_mfma_f32_16x16x32_bf16 v[64:67], v[104:107], v[56:59], v[64:67]
    v_mfma_f32_16x16x32_bf16 v[68:71], v[104:107], v[60:63], v[68:71]
    ds_read_b128 v[104:107], v126 offset:18432
    v_mfma_f32_16x16x32_bf16 v[72:75], v[108:111], v[56:59], v[72:75]
    v_mfma_f32_16x16x32_bf16 v[76:79], v[108:111], v[60:63], v[76:79]
    ds_read_b128 v[108:111], v126 offset:19456
    s_mov_b32 s22, 4
L_joint_kernel_oloop:
    s_waitcnt lgkmcnt(3)
    v_mfma_f32_16x16x32_bf16 v[80:83], v[96:99], v[0:3], 0
    v_mfma_f32_16x16x32_bf16 v[84:87], v[96:99], v[4:7], 0
    ds_read_b128 v[96:99], v126 offset:20480
    s_waitcnt lgkmcnt(3)
    v_mfma_f32_16x16x32_bf16 v[88:91], v[100:103], v[0:3], 0
    v_mfma_f32_16x16x32_bf16 v[92:95], v[100:103], v[4:7], 0
    ds_read_b128 v[100:103], v126 offset:21504
    s_waitcnt lgkmcnt(3)
    v_mfma_f32_16x16x32_bf16 v[80:83], v[104:107], v[8:11], v[80:83]
    v_mfma_f32_16x16x32_bf16 v[84:87], v[104:107], v[12:15], v[84:87]
    ds_read_b128 v[104:107], v126 offset:22528
    s_waitcnt lgkmcnt(3)
    v_mfma_f32_16x16x32_bf16 v[88:91], v[108:111], v[8:11], v[88:91]
    v_cvt_pk_bf16_f32 v112, v64, v68
    v_mfma_f32_16x16x32_bf16 v[92:95], v[108:111], v[12:15], v[92:95]
    buffer_store_dword v112, v125, s[16:19], 0 offen offset:0 nt
    ds_read_b128 v[108:111], v126 offset:23552
    s_waitcnt lgkmcnt(3)
    v_mfma_f32_16x16x32_bf16 v[80:83], v[96:99], v[16:19], v[80:83]
    v_cvt_pk_bf16_f32 v113, v65, v69
    v_mfma_f32_16x16x32_bf16 v[84:87], v[96:99], v[20:23], v[84:87]
    buffer_store_dword v113, v125, s[16:19], 0 offen offset:512 nt
    ds_read_b128 v[96:99], v126 offset:24576
    s_waitcnt lgkmcnt(3)
    v_mfma_f32_16x16x32_bf16 v[88:91], v[100:103], v[16:19], v[88:91]
    v_cvt_pk_bf16_f32 v114, v66, v70
    v_mfma_f32_16x16x32_bf16 v[92:95], v[100:103], v[20:23], v[92:95]
    buffer_store_dword v114, v125, s[16:19], 0 offen offset:1024 nt
    ds_read_b128 v[100:103], v126 offset:25600
    s_waitcnt lgkmcnt(3)
    v_mfma_f32_16x16x32_bf16 v[80:83], v[104:107], v[24:27], v[80:83]
    v_cvt_pk_bf16_f32 v115, v67, v71
    v_mfma_f32_16x16x32_bf16 v[84:87], v[104:107], v[28:31], v[84:87]
    buffer_store_dword v115, v125, s[16:19], 0 offen offset:1536 nt
    ds_read_b128 v[104:107], v126 offset:26624
    s_waitcnt lgkmcnt(3)
    v_mfma_f32_16x16x32_bf16 v[88:91], v[108:111], v[24:27], v[88:91]
    v_cvt_pk_bf16_f32 v116, v72, v76
    v_mfma_f32_16x16x32_bf16 v[92:95], v[108:111], v[28:31], v[92:95]
    buffer_store_dword v116, v125, s[16:19], s44 offen offset:0 nt
    ds_read_b128 v[108:111], v126 offset:27648
    s_waitcnt lgkmcnt(3)
    v_mfma_f32_16x16x32_bf16 v[80:83], v[96:99], v[32:35], v[80:83]
    v_cvt_pk_bf16_f32 v117, v73, v77
    v_mfma_f32_16x16x32_bf16 v[84:87], v[96:99], v[36:39], v[84:87]
    buffer_store_dword v117, v125, s[16:19], s44 offen offset:512 nt
    ds_read_b128 v[96:99], v126 offset:28672
    s_waitcnt lgkmcnt(3)
    v_mfma_f32_16x16x32_bf16 v[88:91], v[100:103], v[32:35], v[88:91]
    v_cvt_pk_bf16_f32 v118, v74, v78
    v_mfma_f32_16x16x32_bf16 v[92:95], v[100:103], v[36:39], v[92:95]
    buffer_store_dword v118, v125, s[16:19], s44 offen offset:1024 nt
    ds_read_b128 v[100:103], v126 offset:29696
    s_waitcnt lgkmcnt(3)
    v_mfma_f32_16x16x32_bf16 v[80:83], v[104:107], v[40:43], v[80:83]
    v_cvt_pk_bf16_f32 v119, v75, v79
    v_mfma_f32_16x16x32_bf16 v[84:87], v[104:107], v[44:47], v[84:87]
    buffer_store_dword v119, v125, s[16:19], s44 offen offset:1536 nt
    ds_read_b128 v[104:107], v126 offset:30720
    s_waitcnt lgkmcnt(3)
    v_mfma_f32_16x16x32_bf16 v[88:91], v[108:111], v[40:43], v[88:91]
    v_add_u32 v125, 16384, v125
    v_mfma_f32_16x16x32_bf16 v[92:95], v[108:111], v[44:47], v[92:95]
    ds_read_b128 v[108:111], v126 offset:31744
    s_waitcnt lgkmcnt(3)
    v_mfma_f32_16x16x32_bf16 v[80:83], v[96:99], v[48:51], v[80:83]
    v_mfma_f32_16x16x32_bf16 v[84:87], v[96:99], v[52:55], v[84:87]
    s_waitcnt lgkmcnt(0)
    s_barrier
    ds_read_b128 v[96:99], v126 offset:0
    v_mfma_f32_16x16x32_bf16 v[88:91], v[100:103], v[48:51], v[88:91]
    v_mfma_f32_16x16x32_bf16 v[92:95], v[100:103], v[52:55], v[92:95]
    ds_read_b128 v[100:103], v126 offset:1024
    v_mfma_f32_16x16x32_bf16 v[80:83], v[104:107], v[56:59], v[80:83]
    v_mfma_f32_16x16x32_bf16 v[84:87], v[104:107], v[60:63], v[84:87]
    ds_read_b128 v[104:107], v126 offset:2048
    v_mfma_f32_16x16x32_bf16 v[88:91], v[108:111], v[56:59], v[88:91]
    v_mfma_f32_16x16x32_bf16 v[92:95], v[108:111], v[60:63], v[92:95]
    ds_read_b128 v[108:111], v126 offset:3072
    s_sub_u32 s22, s22, 1
    s_cmp_eq_u32 s22, 0
    s_cbranch_scc1 L_joint_kernel_oend
    s_waitcnt lgkmcnt(3)
    v_mfma_f32_16x16x32_bf16 v[64:67], v[96:99], v[0:3], 0
    v_mfma_f32_16x16x32_bf16 v[68:71], v[96:99], v[4:7], 0
    ds_read_b128 v[96:99], v126 offset:4096
    s_waitcnt lgkmcnt(3)
    v_mfma_f32_16x16x32_bf16 v[72:75], v[100:103], v[0:3], 0
    v_mfma_f32_16x16x32_bf16 v[76:79], v[100:103], v[4:7], 0
    ds_read_b128 v[100:103], v126 offset:5120
    s_waitcnt lgkmcnt(3)
    v_mfma_f32_16x16x32_bf16 v[64:67], v[104:107], v[8:11], v[64:67]
    v_mfma_f32_16x16x32_bf16 v[68:71], v[104:107], v[12:15], v[68:71]
    ds_read_b128 v[104:107], v126 offset:6144
    s_waitcnt lgkmcnt(3)
    v_mfma_f32_16x16x32_bf16 v[72:75], v[108:111], v[8:11], v[72:75]
    v_cvt_pk_bf16_f32 v112, v80, v84
    v_mfma_f32_16x16x32_bf16 v[76:79], v[108:111], v[12:15], v[76:79]
    buffer_store_dword v112, v125, s[16:19], 0 offen offset:0 nt
    ds_read_b128 v[108:111], v126 offset:7168
    s_waitcnt lgkmcnt(3)
    v_mfma_f32_16x16x32_bf16 v[64:67], v[96:99], v[16:19], v[64:67]
    v_cvt_pk_bf16_f32 v113, v81, v85
    v_mfma_f32_16x16x32_bf16 v[68:71], v[96:99], v[20:23], v[68:71]
    buffer_store_dword v113, v125, s[16:19], 0 offen offset:512 nt
    ds_read_b128 v[96:99], v126 offset:8192
    s_waitcnt lgkmcnt(3)
    v_mfma_f32_16x16x32_bf16 v[72:75], v[100:103], v[16:19], v[72:75]
    v_cvt_pk_bf16_f32 v114, v82, v86
    v_mfma_f32_16x16x32_bf16 v[76:79], v[100:103], v[20:23], v[76:79]
    buffer_store_dword v114, v125, s[16:19], 0 offen offset:1024 nt
    ds_read_b128 v[100:103], v126 offset:9216
    s_waitcnt lgkmcnt(3)
    v_mfma_f32_16x16x32_bf16 v[64:67], v[104:107], v[24:27], v[64:67]
    v_cvt_pk_bf16_f32 v115, v83, v87
    v_mfma_f32_16x16x32_bf16 v[68:71], v[104:107], v[28:31], v[68:71]
    buffer_store_dword v115, v125, s[16:19], 0 offen offset:1536 nt
    ds_read_b128 v[104:107], v126 offset:10240
    s_waitcnt lgkmcnt(3)
    v_mfma_f32_16x16x32_bf16 v[72:75], v[108:111], v[24:27], v[72:75]
    v_cvt_pk_bf16_f32 v116, v88, v92
    v_mfma_f32_16x16x32_bf16 v[76:79], v[108:111], v[28:31], v[76:79]
    buffer_store_dword v116, v125, s[16:19], s44 offen offset:0 nt
    ds_read_b128 v[108:111], v126 offset:11264
    s_waitcnt lgkmcnt(3)
    v_mfma_f32_16x16x32_bf16 v[64:67], v[96:99], v[32:35], v[64:67]
    v_cvt_pk_bf16_f32 v117, v89, v93
    v_mfma_f32_16x16x32_bf16 v[68:71], v[96:99], v[36:39], v[68:71]
    buffer_store_dword v117, v125, s[16:19], s44 offen offset:512 nt
    ds_read_b128 v[96:99], v126 offset:12288
    s_waitcnt lgkmcnt(3)
    v_mfma_f32_16x16x32_bf16 v[72:75], v[100:103], v[32:35], v[72:75]
    v_cvt_pk_bf16_f32 v118, v90, v94
    v_mfma_f32_16x16x32_bf16 v[76:79], v[100:103], v[36:39], v[76:79]
    buffer_store_dword v118, v125, s[16:19], s44 offen offset:1024 nt
    ds_read_b128 v[100:103], v126 offset:13312
    s_waitcnt lgkmcnt(3)
    v_mfma_f32_16x16x32_bf16 v[64:67], v[104:107], v[40:43], v[64:67]
    v_cvt_pk_bf16_f32 v119, v91, v95
    v_mfma_f32_16x16x32_bf16 v[68:71], v[104:107], v[44:47], v[68:71]
    buffer_store_dword v119, v125, s[16:19], s44 offen offset:1536 nt
    ds_read_b128 v[104:107], v126 offset:14336
    s_waitcnt lgkmcnt(3)
    v_mfma_f32_16x16x32_bf16 v[72:75], v[108:111], v[40:43], v[72:75]
    v_add_u32 v125, 16384, v125
    v_mfma_f32_16x16x32_bf16 v[76:79], v[108:111], v[44:47], v[76:79]
    ds_read_b128 v[108:111], v126 offset:15360
    s_waitcnt lgkmcnt(3)
    v_mfma_f32_16x16x32_bf16 v[64:67], v[96:99], v[48:51], v[64:67]
    v_mfma_f32_16x16x32_bf16 v[68:71], v[96:99], v[52:55], v[68:71]
    s_waitcnt lgkmcnt(0)
    s_barrier
    ds_read_b128 v[96:99], v126 offset:16384
    v_mfma_f32_16x16x32_bf16 v[72:75], v[100:103], v[48:51], v[72:75]
    v_mfma_f32_16x16x32_bf16 v[76:79], v[100:103], v[52:55], v[76:79]
    ds_read_b128 v[100:103], v126 offset:17408
    v_mfma_f32_16x16x32_bf16 v[64:67], v[104:107], v[56:59], v[64:67]
    v_mfma_f32_16x16x32_bf16 v[68:71], v[104:107], v[60:63], v[68:71]
    ds_read_b128 v[104:107], v126 offset:18432
    v_mfma_f32_16x16x32_bf16 v[72:75], v[108:111], v[56:59], v[72:75]
    v_mfma_f32_16x16x32_bf16 v[76:79], v[108:111], v[60:63], v[76:79]
    ds_read_b128 v[108:111], v126 offset:19456
    s_waitcnt vmcnt(32)
    s_branch L_joint_kernel_oloop
L_joint_kernel_oend:
    s_nop 7
    v_cvt_pk_bf16_f32 v112, v80, v84
    buffer_store_dword v112, v125, s[16:19], 0 offen offset:0 nt
    v_cvt_pk_bf16_f32 v113, v81, v85
    buffer_store_dword v113, v125, s[16:19], 0 offen offset:512 nt
    v_cvt_pk_bf16_f32 v114, v82, v86
    buffer_store_dword v114, v125, s[16:19], 0 offen offset:1024 nt
    v_cvt_pk_bf16_f32 v115, v83, v87
    buffer_store_dword v115, v125, s[16:19], 0 offen offset:1536 nt
    v_cvt_pk_bf16_f32 v116, v88, v92
    buffer_store_dword v116, v125, s[16:19], s44 offen offset:0 nt
    v_cvt_pk_bf16_f32 v117, v89, v93
    buffer_store_dword v117, v125, s[16:19], s44 offen offset:512 nt
    v_cvt_pk_bf16_f32 v118, v90, v94
    buffer_store_dword v118, v125, s[16:19], s44 offen offset:1024 nt
    v_cvt_pk_bf16_f32 v119, v91, v95
    buffer_store_dword v119, v125, s[16:19], s44 offen offset:1536 nt
    v_add_u32 v125, 16384, v125
    s_branch L_joint_kernel_fin
L_joint_kernel_T:
    s_setprio 3
    s_lshl_b32 s36, s21, 2
    s_add_u32 s36, s36, 44335104
    s_add_u32 s36, s30, s36
    s_addc_u32 s37, s31, 0
    s_load_dword s44, s[36:37], 0
    v_and_b32 v123, 15, v127
    v_lshrrev_b32 v121, 4, v127
    v_mul_u32_u24 v125, 528, v123
    v_lshl_add_u32 v125, v121, 4, v125
    v_lshlrev_b32 v121, 5, v121
    v_and_b32 v120, 7, v127
    v_lshl_add_u32 v124, v120, 10, v121
    s_lshl_b32 s38, s21, 7
    v_mul_u32_u24 v120, 1040, v120
    s_add_u32 s36, s38, 91136
    v_add3_u32 v120, v120, v121, s36
    s_mul_i32 s36, s21, 5184
    s_add_u32 s36, s36, 49664
    v_add_u32 v121, s36, v121
    v_mul_u32_u24 v122, 144, v123
    v_add_u32 v122, v122, v121
    v_lshrrev_b32 v123, 3, v123
    v_mul_u32_u24 v123, 144, v123
    v_add_u32 v121, v123, v121
    s_lshl_b32 s36, s21, 11
    v_add_u32 v123, s36, v126
    s_barrier
    s_mov_b32 s36, 0
    buffer_load_dwordx4 v[0:3], v126, s[12:15], s36 offen offset:0
    buffer_load_dwordx4 v[4:7], v126, s[12:15], s36 offen offset:1024
    buffer_load_dwordx4 v[8:11], v126, s[12:15], s36 offen offset:2048
    buffer_load_dwordx4 v[12:15], v126, s[12:15], s36 offen offset:3072
    s_mov_b32 s36, 4096
    buffer_load_dwordx4 v[16:19], v126, s[12:15], s36 offen offset:0
    buffer_load_dwordx4 v[20:23], v126, s[12:15], s36 offen offset:1024
    buffer_load_dwordx4 v[24:27], v126, s[12:15], s36 offen offset:2048
    buffer_load_dwordx4 v[28:31], v126, s[12:15], s36 offen offset:3072
    s_mov_b32 s36, 8192
    buffer_load_dwordx4 v[32:35], v126, s[12:15], s36 offen offset:0
    buffer_load_dwordx4 v[36:39], v126, s[12:15], s36 offen offset:1024
    buffer_load_dwordx4 v[40:43], v126, s[12:15], s36 offen offset:2048
    buffer_load_dwordx4 v[44:47], v126, s[12:15], s36 offen offset:3072
    s_mov_b32 s36, 12288
    buffer_load_dwordx4 v[48:51], v126, s[12:15], s36 offen offset:0
    buffer_load_dwordx4 v[52:55], v126, s[12:15], s36 offen offset:1024
    buffer_load_dwordx4 v[56:59], v126, s[12:15], s36 offen offset:2048
    buffer_load_dwordx4 v[60:63], v126, s[12:15], s36 offen offset:3072
    v_mov_b32 v64, 99456
    v_mov_b32 v65, 1
    s_mov_b64 exec, 1
    ds_add_u32 v64, v65 offset:4
    s_mov_b64 exec, -1
L_joint_kernel_tw:
    ds_read_b32 v65, v64 offset:0
    s_waitcnt lgkmcnt(0)
    v_readfirstlane_b32 s37, v65
    s_cmp_ge_u32 s37, 8
    s_cbranch_scc1 L_joint_kernel_tw_d
    s_sleep 1
    s_branch L_joint_kernel_tw
L_joint_kernel_tw_d:
    ds_read_b128 v[80:83], v125 offset:32768
    ds_read_b128 v[84:87], v125 offset:41216
    ds_read_b128 v[88:91], v125 offset:32832
    ds_read_b128 v[92:95], v125 offset:41280
    ds_read_b128 v[96:99], v125 offset:32896
    ds_read_b128 v[100:103], v125 offset:41344
    ds_read_b128 v[104:107], v125 offset:32960
    ds_read_b128 v[108:111], v125 offset:41408
    s_setprio 0
    s_waitcnt vmcnt(14) lgkmcnt(7)
    v_mfma_f32_16x16x32_bf16 v[64:67], v[0:3], v[80:83], 0
    v_mfma_f32_16x16x32_bf16 v[68:71], v[4:7], v[80:83], 0
    ds_read_b128 v[80:83], v125 offset:33024
    s_waitcnt lgkmcnt(7)
    v_mfma_f32_16x16x32_bf16 v[72:75], v[0:3], v[84:87], 0
    v_mfma_f32_16x16x32_bf16 v[76:79], v[4:7], v[84:87], 0
    ds_read_b128 v[84:87], v125 offset:41472
    s_waitcnt vmcnt(12) lgkmcnt(7)
    v_mfma_f32_16x16x32_bf16 v[64:67], v[8:11], v[88:91], v[64:67]
    v_mfma_f32_16x16x32_bf16 v[68:71], v[12:15], v[88:91], v[68:71]
    ds_read_b128 v[88:91], v125 offset:33088
    s_waitcnt lgkmcnt(7)
    v_mfma_f32_16x16x32_bf16 v[72:75], v[8:11], v[92:95], v[72:75]
    v_mfma_f32_16x16x32_bf16 v[76:79], v[12:15], v[92:95], v[76:79]
    ds_read_b128 v[92:95], v125 offset:41536
    s_waitcnt vmcnt(10) lgkmcnt(7)
    v_mfma_f32_16x16x32_bf16 v[64:67], v[16:19], v[96:99], v[64:67]
    v_mfma_f32_16x16x32_bf16 v[68:71], v[20:23], v[96:99], v[68:71]
    ds_read_b128 v[96:99], v125 offset:33152
    s_waitcnt lgkmcnt(7)
    v_mfma_f32_16x16x32_bf16 v[72:75], v[16:19], v[100:103], v[72:75]
    v_mfma_f32_16x16x32_bf16 v[76:79], v[20:23], v[100:103], v[76:79]
    ds_read_b128 v[100:103], v125 offset:41600
    s_waitcnt vmcnt(8) lgkmcnt(7)
    v_mfma_f32_16x16x32_bf16 v[64:67], v[24:27], v[104:107], v[64:67]
    v_mfma_f32_16x16x32_bf16 v[68:71], v[28:31], v[104:107], v[68:71]
    ds_read_b128 v[104:107], v125 offset:33216
    s_waitcnt lgkmcnt(7)
    v_mfma_f32_16x16x32_bf16 v[72:75], v[24:27], v[108:111], v[72:75]
    v_mfma_f32_16x16x32_bf16 v[76:79], v[28:31], v[108:111], v[76:79]
    ds_read_b128 v[108:111], v125 offset:41664
    s_waitcnt vmcnt(6) lgkmcnt(7)
    v_mfma_f32_16x16x32_bf16 v[64:67], v[32:35], v[80:83], v[64:67]
    v_mfma_f32_16x16x32_bf16 v[68:71], v[36:39], v[80:83], v[68:71]
    ds_read_b128 v[112:115], v120 offset:0
    s_waitcnt lgkmcnt(7)
    v_mfma_f32_16x16x32_bf16 v[72:75], v[32:35], v[84:87], v[72:75]
    v_mfma_f32_16x16x32_bf16 v[76:79], v[36:39], v[84:87], v[76:79]
    ds_read_b128 v[116:119], v120 offset:16
    s_waitcnt vmcnt(4) lgkmcnt(7)
    v_mfma_f32_16x16x32_bf16 v[64:67], v[40:43], v[88:91], v[64:67]
    v_mfma_f32_16x16x32_bf16 v[68:71], v[44:47], v[88:91], v[68:71]
    s_waitcnt lgkmcnt(6)
    v_mfma_f32_16x16x32_bf16 v[72:75], v[40:43], v[92:95], v[72:75]
    v_mfma_f32_16x16x32_bf16 v[76:79], v[44:47], v[92:95], v[76:79]
    s_waitcnt vmcnt(2) lgkmcnt(5)
    v_mfma_f32_16x16x32_bf16 v[64:67], v[48:51], v[96:99], v[64:67]
    v_mfma_f32_16x16x32_bf16 v[68:71], v[52:55], v[96:99], v[68:71]
    s_waitcnt lgkmcnt(4)
    v_mfma_f32_16x16x32_bf16 v[72:75], v[48:51], v[100:103], v[72:75]
    v_mfma_f32_16x16x32_bf16 v[76:79], v[52:55], v[100:103], v[76:79]
    s_waitcnt vmcnt(0) lgkmcnt(3)
    v_mfma_f32_16x16x32_bf16 v[64:67], v[56:59], v[104:107], v[64:67]
    v_mfma_f32_16x16x32_bf16 v[68:71], v[60:63], v[104:107], v[68:71]
    s_waitcnt lgkmcnt(2)
    v_mfma_f32_16x16x32_bf16 v[72:75], v[56:59], v[108:111], v[72:75]
    v_mfma_f32_16x16x32_bf16 v[76:79], v[60:63], v[108:111], v[76:79]
    s_mov_b32 s46, 0xffff0000
    s_mov_b32 s48, 0x4038aa3b
    s_mov_b32 s49, s48
    s_nop 3
    v_mov_b32 v28, 0
    s_waitcnt lgkmcnt(0)
    v_cvt_pk_bf16_f32 v24, v64, v68
    v_cvt_pk_bf16_f32 v25, v65, v69
    v_cvt_pk_bf16_f32 v26, v66, v70
    v_cvt_pk_bf16_f32 v27, v67, v71
    v_lshlrev_b32 v80, 16, v24
    v_and_b32 v81, s46, v24
    v_lshlrev_b32 v82, 16, v25
    v_and_b32 v83, s46, v25
    v_lshlrev_b32 v84, 16, v26
    v_and_b32 v85, s46, v26
    v_lshlrev_b32 v86, 16, v27
    v_and_b32 v87, s46, v27
    v_pk_mul_f32 v[80:81], v[80:81], s[48:49]
    v_pk_mul_f32 v[82:83], v[82:83], s[48:49]
    v_pk_mul_f32 v[84:85], v[84:85], s[48:49]
    v_pk_mul_f32 v[86:87], v[86:87], s[48:49]
    v_exp_f32 v96, v80
    v_exp_f32 v97, v81
    v_exp_f32 v98, v82
    v_exp_f32 v99, v83
    v_max3_f32 v28, |v80|, |v81|, v28
    v_max3_f32 v28, |v82|, |v83|, v28
    ds_write_b128 v122, v[96:99] offset:0
    v_exp_f32 v100, v84
    v_exp_f32 v101, v85
    v_exp_f32 v102, v86
    v_exp_f32 v103, v87
    v_max3_f32 v28, |v84|, |v85|, v28
    v_max3_f32 v28, |v86|, |v87|, v28
    ds_write_b128 v122, v[100:103] offset:16
    v_cvt_pk_bf16_f32 v24, v72, v76
    v_cvt_pk_bf16_f32 v25, v73, v77
    v_cvt_pk_bf16_f32 v26, v74, v78
    v_cvt_pk_bf16_f32 v27, v75, v79
    v_lshlrev_b32 v88, 16, v24
    v_and_b32 v89, s46, v24
    v_lshlrev_b32 v90, 16, v25
    v_and_b32 v91, s46, v25
    v_lshlrev_b32 v92, 16, v26
    v_and_b32 v93, s46, v26
    v_lshlrev_b32 v94, 16, v27
    v_and_b32 v95, s46, v27
    v_pk_mul_f32 v[88:89], v[88:89], s[48:49]
    v_pk_mul_f32 v[90:91], v[90:91], s[48:49]
    v_pk_mul_f32 v[92:93], v[92:93], s[48:49]
    v_pk_mul_f32 v[94:95], v[94:95], s[48:49]
    v_exp_f32 v104, v88
    v_exp_f32 v105, v89
    v_exp_f32 v106, v90
    v_exp_f32 v107, v91
    v_max3_f32 v28, |v88|, |v89|, v28
    v_max3_f32 v28, |v90|, |v91|, v28
    ds_write_b128 v122, v[104:107] offset:2304
    v_exp_f32 v108, v92
    v_exp_f32 v109, v93
    v_exp_f32 v110, v94
    v_exp_f32 v111, v95
    v_max3_f32 v28, |v92|, |v93|, v28
    v_max3_f32 v28, |v94|, |v95|, v28
    ds_write_b128 v122, v[108:111] offset:2320
    v_cmp_lt_f32 vcc, 0x42f00000, v28
    s_mov_b32 s22, 4
    s_or_b32 s44, s44, vcc_lo
    s_or_b32 s44, s44, vcc_hi
    s_cmp_lg_u32 s44, 0
    s_cbranch_scc1 L_joint_kernel_tslow
    ds_read_b128 v[32:35], v121 offset:0
    ds_read_b128 v[36:39], v121 offset:16
    ds_read_b128 v[40:43], v121 offset:288
    ds_read_b128 v[44:47], v121 offset:304
    v_add_u32 v121, 576, v121
    s_waitcnt vmcnt(0) lgkmcnt(0)
L_joint_kernel_tloop1:
    v_fma_f32 v48, v112, v32, 1.0
    v_fma_f32 v49, v113, v33, 1.0
    v_fma_f32 v50, v114, v34, 1.0
    v_fma_f32 v51, v115, v35, 1.0
    v_fma_f32 v52, v116, v36, 1.0
    v_fma_f32 v53, v117, v37, 1.0
    v_fma_f32 v54, v118, v38, 1.0
    v_fma_f32 v55, v119, v39, 1.0
    v_fma_f32 v56, v112, v40, 1.0
    v_fma_f32 v57, v113, v41, 1.0
    v_fma_f32 v58, v114, v42, 1.0
    v_fma_f32 v59, v115, v43, 1.0
    v_fma_f32 v60, v116, v44, 1.0
    v_fma_f32 v61, v117, v45, 1.0
    v_fma_f32 v62, v118, v46, 1.0
    v_fma_f32 v63, v119, v47, 1.0
    ds_read_b128 v[32:35], v121 offset:0
    ds_read_b128 v[36:39], v121 offset:16
    ds_read_b128 v[40:43], v121 offset:288
    ds_read_b128 v[44:47], v121 offset:304
    v_add_u32 v121, 576, v121
    v_rcp_f32 v48, v48
    v_rcp_f32 v49, v49
    v_rcp_f32 v50, v50
    v_rcp_f32 v51, v51
    v_rcp_f32 v52, v52
    v_rcp_f32 v53, v53
    v_rcp_f32 v54, v54
    v_rcp_f32 v55, v55
    v_fma_f32 v48, v48, -2.0, 1.0
    v_fma_f32 v49, v49, -2.0, 1.0
    v_fma_f32 v50, v50, -2.0, 1.0
    v_fma_f32 v51, v51, -2.0, 1.0
    v_fma_f32 v52, v52, -2.0, 1.0
    v_fma_f32 v53, v53, -2.0, 1.0
    v_fma_f32 v54, v54, -2.0, 1.0
    v_fma_f32 v55, v55, -2.0, 1.0
    v_cvt_pk_bf16_f32 v64, v48, v49
    v_cvt_pk_bf16_f32 v65, v50, v51
    v_cvt_pk_bf16_f32 v66, v52, v53
    v_cvt_pk_bf16_f32 v67, v54, v55
    ds_write_b128 v123, v[64:67] offset:0
    v_rcp_f32 v56, v56
    v_rcp_f32 v57, v57
    v_rcp_f32 v58, v58
    v_rcp_f32 v59, v59
    v_rcp_f32 v60, v60
    v_rcp_f32 v61, v61
    v_rcp_f32 v62, v62
    v_rcp_f32 v63, v63
    v_fma_f32 v56, v56, -2.0, 1.0
    v_fma_f32 v57, v57, -2.0, 1.0
    v_fma_f32 v58, v58, -2.0, 1.0
    v_fma_f32 v59, v59, -2.0, 1.0
    v_fma_f32 v60, v60, -2.0, 1.0
    v_fma_f32 v61, v61, -2.0, 1.0
    v_fma_f32 v62, v62, -2.0, 1.0
    v_fma_f32 v63, v63, -2.0, 1.0
    v_cvt_pk_bf16_f32 v68, v56, v57
    v_cvt_pk_bf16_f32 v69, v58, v59
    v_cvt_pk_bf16_f32 v70, v60, v61
    v_cvt_pk_bf16_f32 v71, v62, v63
    ds_write_b128 v123, v[68:71] offset:1024
    s_waitcnt lgkmcnt(0)
    s_barrier
    v_fma_f32 v48, v112, v32, 1.0
    v_fma_f32 v49, v113, v33, 1.0
    v_fma_f32 v50, v114, v34, 1.0
    v_fma_f32 v51, v115, v35, 1.0
    v_fma_f32 v52, v116, v36, 1.0
    v_fma_f32 v53, v117, v37, 1.0
    v_fma_f32 v54, v118, v38, 1.0
    v_fma_f32 v55, v119, v39, 1.0
    v_fma_f32 v56, v112, v40, 1.0
    v_fma_f32 v57, v113, v41, 1.0
    v_fma_f32 v58, v114, v42, 1.0
    v_fma_f32 v59, v115, v43, 1.0
    v_fma_f32 v60, v116, v44, 1.0
    v_fma_f32 v61, v117, v45, 1.0
    v_fma_f32 v62, v118, v46, 1.0
    v_fma_f32 v63, v119, v47, 1.0
    ds_read_b128 v[32:35], v121 offset:0
    ds_read_b128 v[36:39], v121 offset:16
    ds_read_b128 v[40:43], v121 offset:288
    ds_read_b128 v[44:47], v121 offset:304
    v_add_u32 v121, 576, v121
    v_rcp_f32 v48, v48
    v_rcp_f32 v49, v49
    v_rcp_f32 v50, v50
    v_rcp_f32 v51, v51
    v_rcp_f32 v52, v52
    v_rcp_f32 v53, v53
    v_rcp_f32 v54, v54
    v_rcp_f32 v55, v55
    v_fma_f32 v48, v48, -2.0, 1.0
    v_fma_f32 v49, v49, -2.0, 1.0
    v_fma_f32 v50, v50, -2.0, 1.0
    v_fma_f32 v51, v51, -2.0, 1.0
    v_fma_f32 v52, v52, -2.0, 1.0
    v_fma_f32 v53, v53, -2.0, 1.0
    v_fma_f32 v54, v54, -2.0, 1.0
    v_fma_f32 v55, v55, -2.0, 1.0
    v_cvt_pk_bf16_f32 v64, v48, v49
    v_cvt_pk_bf16_f32 v65, v50, v51
    v_cvt_pk_bf16_f32 v66, v52, v53
    v_cvt_pk_bf16_f32 v67, v54, v55
    ds_write_b128 v123, v[64:67] offset:16384
    v_rcp_f32 v56, v56
    v_rcp_f32 v57, v57
    v_rcp_f32 v58, v58
    v_rcp_f32 v59, v59
    v_rcp_f32 v60, v60
    v_rcp_f32 v61, v61
    v_rcp_f32 v62, v62
    v_rcp_f32 v63, v63
    v_fma_f32 v56, v56, -2.0, 1.0
    v_fma_f32 v57, v57, -2.0, 1.0
    v_fma_f32 v58, v58, -2.0, 1.0
    v_fma_f32 v59, v59, -2.0, 1.0
    v_fma_f32 v60, v60, -2.0, 1.0
    v_fma_f32 v61, v61, -2.0, 1.0
    v_fma_f32 v62, v62, -2.0, 1.0
    v_fma_f32 v63, v63, -2.0, 1.0
    v_cvt_pk_bf16_f32 v68, v56, v57
    v_cvt_pk_bf16_f32 v69, v58, v59
    v_cvt_pk_bf16_f32 v70, v60, v61
    v_cvt_pk_bf16_f32 v71, v62, v63
    ds_write_b128 v123, v[68:71] offset:17408
    s_waitcnt lgkmcnt(0)
    s_barrier
    s_sub_u32 s22, s22, 1
    s_cmp_lg_u32 s22, 0
    s_cbranch_scc1 L_joint_kernel_tloop1
    s_branch L_joint_kernel_fin
L_joint_kernel_tslow:
    buffer_load_dwordx4 v[112:115], v124, s[40:43], s38 offen offset:0
    buffer_load_dwordx4 v[116:119], v124, s[40:43], s38 offen offset:16
    ds_write_b128 v122, v[80:83] offset:0
    ds_write_b128 v122, v[84:87] offset:16
    ds_write_b128 v122, v[88:91] offset:2304
    ds_write_b128 v122, v[92:95] offset:2320
    ds_read_b128 v[32:35], v121 offset:0
    ds_read_b128 v[36:39], v121 offset:16
    ds_read_b128 v[40:43], v121 offset:288
    ds_read_b128 v[44:47], v121 offset:304
    v_add_u32 v121, 576, v121
    s_waitcnt vmcnt(0) lgkmcnt(0)
L_joint_kernel_tloop0:
    v_add_f32 v48, v112, v32
    v_add_f32 v49, v113, v33
    v_add_f32 v50, v114, v34
    v_add_f32 v51, v115, v35
    v_add_f32 v52, v116, v36
    v_add_f32 v53, v117, v37
    v_add_f32 v54, v118, v38
    v_add_f32 v55, v119, v39
    v_add_f32 v56, v112, v40
    v_add_f32 v57, v113, v41
    v_add_f32 v58, v114, v42
    v_add_f32 v59, v115, v43
    v_add_f32 v60, v116, v44
    v_add_f32 v61, v117, v45
    v_add_f32 v62, v118, v46
    v_add_f32 v63, v119, v47
    ds_read_b128 v[32:35], v121 offset:0
    ds_read_b128 v[36:39], v121 offset:16
    ds_read_b128 v[40:43], v121 offset:288
    ds_read_b128 v[44:47], v121 offset:304
    v_add_u32 v121, 576, v121
    v_exp_f32 v48, v48
    v_exp_f32 v49, v49
    v_exp_f32 v50, v50
    v_exp_f32 v51, v51
    v_exp_f32 v52, v52
    v_exp_f32 v53, v53
    v_exp_f32 v54, v54
    v_exp_f32 v55, v55
    v_add_f32 v48, 1.0, v48
    v_add_f32 v49, 1.0, v49
    v_add_f32 v50, 1.0, v50
    v_add_f32 v51, 1.0, v51
    v_add_f32 v52, 1.0, v52
    v_add_f32 v53, 1.0, v53
    v_add_f32 v54, 1.0, v54
    v_add_f32 v55, 1.0, v55
    v_rcp_f32 v48, v48
    v_rcp_f32 v49, v49
    v_rcp_f32 v50, v50
    v_rcp_f32 v51, v51
    v_rcp_f32 v52, v52
    v_rcp_f32 v53, v53
    v_rcp_f32 v54, v54
    v_rcp_f32 v55, v55
    v_fma_f32 v48, v48, -2.0, 1.0
    v_fma_f32 v49, v49, -2.0, 1.0
    v_fma_f32 v50, v50, -2.0, 1.0
    v_fma_f32 v51, v51, -2.0, 1.0
    v_fma_f32 v52, v52, -2.0, 1.0
    v_fma_f32 v53, v53, -2.0, 1.0
    v_fma_f32 v54, v54, -2.0, 1.0
    v_fma_f32 v55, v55, -2.0, 1.0
    v_cvt_pk_bf16_f32 v64, v48, v49
    v_cvt_pk_bf16_f32 v65, v50, v51
    v_cvt_pk_bf16_f32 v66, v52, v53
    v_cvt_pk_bf16_f32 v67, v54, v55
    ds_write_b128 v123, v[64:67] offset:0
    v_exp_f32 v56, v56
    v_exp_f32 v57, v57
    v_exp_f32 v58, v58
    v_exp_f32 v59, v59
    v_exp_f32 v60, v60
    v_exp_f32 v61, v61
    v_exp_f32 v62, v62
    v_exp_f32 v63, v63
    v_add_f32 v56, 1.0, v56
    v_add_f32 v57, 1.0, v57
    v_add_f32 v58, 1.0, v58
    v_add_f32 v59, 1.0, v59
    v_add_f32 v60, 1.0, v60
    v_add_f32 v61, 1.0, v61
    v_add_f32 v62, 1.0, v62
    v_add_f32 v63, 1.0, v63
    v_rcp_f32 v56, v56
    v_rcp_f32 v57, v57
    v_rcp_f32 v58, v58
    v_rcp_f32 v59, v59
    v_rcp_f32 v60, v60
    v_rcp_f32 v61, v61
    v_rcp_f32 v62, v62
    v_rcp_f32 v63, v63
    v_fma_f32 v56, v56, -2.0, 1.0
    v_fma_f32 v57, v57, -2.0, 1.0
    v_fma_f32 v58, v58, -2.0, 1.0
    v_fma_f32 v59, v59, -2.0, 1.0
    v_fma_f32 v60, v60, -2.0, 1.0
    v_fma_f32 v61, v61, -2.0, 1.0
    v_fma_f32 v62, v62, -2.0, 1.0
    v_fma_f32 v63, v63, -2.0, 1.0
    v_cvt_pk_bf16_f32 v68, v56, v57
    v_cvt_pk_bf16_f32 v69, v58, v59
    v_cvt_pk_bf16_f32 v70, v60, v61
    v_cvt_pk_bf16_f32 v71, v62, v63
    ds_write_b128 v123, v[68:71] offset:1024
    s_waitcnt lgkmcnt(0)
    s_barrier
    v_add_f32 v48, v112, v32
    v_add_f32 v49, v113, v33
    v_add_f32 v50, v114, v34
    v_add_f32 v51, v115, v35
    v_add_f32 v52, v116, v36
    v_add_f32 v53, v117, v37
    v_add_f32 v54, v118, v38
    v_add_f32 v55, v119, v39
    v_add_f32 v56, v112, v40
    v_add_f32 v57, v113, v41
    v_add_f32 v58, v114, v42
    v_add_f32 v59, v115, v43
    v_add_f32 v60, v116, v44
    v_add_f32 v61, v117, v45
    v_add_f32 v62, v118, v46
    v_add_f32 v63, v119, v47
    ds_read_b128 v[32:35], v121 offset:0
    ds_read_b128 v[36:39], v121 offset:16
    ds_read_b128 v[40:43], v121 offset:288
    ds_read_b128 v[44:47], v121 offset:304
    v_add_u32 v121, 576, v121
    v_exp_f32 v48, v48
    v_exp_f32 v49, v49
    v_exp_f32 v50, v50
    v_exp_f32 v51, v51
    v_exp_f32 v52, v52
    v_exp_f32 v53, v53
    v_exp_f32 v54, v54
    v_exp_f32 v55, v55
    v_add_f32 v48, 1.0, v48
    v_add_f32 v49, 1.0, v49
    v_add_f32 v50, 1.0, v50
    v_add_f32 v51, 1.0, v51
    v_add_f32 v52, 1.0, v52
    v_add_f32 v53, 1.0, v53
    v_add_f32 v54, 1.0, v54
    v_add_f32 v55, 1.0, v55
    v_rcp_f32 v48, v48
    v_rcp_f32 v49, v49
    v_rcp_f32 v50, v50
    v_rcp_f32 v51, v51
    v_rcp_f32 v52, v52
    v_rcp_f32 v53, v53
    v_rcp_f32 v54, v54
    v_rcp_f32 v55, v55
    v_fma_f32 v48, v48, -2.0, 1.0
    v_fma_f32 v49, v49, -2.0, 1.0
    v_fma_f32 v50, v50, -2.0, 1.0
    v_fma_f32 v51, v51, -2.0, 1.0
    v_fma_f32 v52, v52, -2.0, 1.0
    v_fma_f32 v53, v53, -2.0, 1.0
    v_fma_f32 v54, v54, -2.0, 1.0
    v_fma_f32 v55, v55, -2.0, 1.0
    v_cvt_pk_bf16_f32 v64, v48, v49
    v_cvt_pk_bf16_f32 v65, v50, v51
    v_cvt_pk_bf16_f32 v66, v52, v53
    v_cvt_pk_bf16_f32 v67, v54, v55
    ds_write_b128 v123, v[64:67] offset:16384
    v_exp_f32 v56, v56
    v_exp_f32 v57, v57
    v_exp_f32 v58, v58
    v_exp_f32 v59, v59
    v_exp_f32 v60, v60
    v_exp_f32 v61, v61
    v_exp_f32 v62, v62
    v_exp_f32 v63, v63
    v_add_f32 v56, 1.0, v56
    v_add_f32 v57, 1.0, v57
    v_add_f32 v58, 1.0, v58
    v_add_f32 v59, 1.0, v59
    v_add_f32 v60, 1.0, v60
    v_add_f32 v61, 1.0, v61
    v_add_f32 v62, 1.0, v62
    v_add_f32 v63, 1.0, v63
    v_rcp_f32 v56, v56
    v_rcp_f32 v57, v57
    v_rcp_f32 v58, v58
    v_rcp_f32 v59, v59
    v_rcp_f32 v60, v60
    v_rcp_f32 v61, v61
    v_rcp_f32 v62, v62
    v_rcp_f32 v63, v63
    v_fma_f32 v56, v56, -2.0, 1.0
    v_fma_f32 v57, v57, -2.0, 1.0
    v_fma_f32 v58, v58, -2.0, 1.0
    v_fma_f32 v59, v59, -2.0, 1.0
    v_fma_f32 v60, v60, -2.0, 1.0
    v_fma_f32 v61, v61, -2.0, 1.0
    v_fma_f32 v62, v62, -2.0, 1.0
    v_fma_f32 v63, v63, -2.0, 1.0
    v_cvt_pk_bf16_f32 v68, v56, v57
    v_cvt_pk_bf16_f32 v69, v58, v59
    v_cvt_pk_bf16_f32 v70, v60, v61
    v_cvt_pk_bf16_f32 v71, v62, v63
    ds_write_b128 v123, v[68:71] offset:17408
    s_waitcnt lgkmcnt(0)
    s_barrier
    s_sub_u32 s22, s22, 1
    s_cmp_lg_u32 s22, 0
    s_cbranch_scc1 L_joint_kernel_tloop0
L_joint_kernel_fin:
L_joint_kernel_done:
    s_endpgm
.section .rodata,"a"
.p2align 6
.amdhsa_kernel prep_kernel
  .amdhsa_next_free_vgpr 128
  .amdhsa_next_free_sgpr 102
  .amdhsa_accum_offset 128
  .amdhsa_group_segment_fixed_size 0
  .amdhsa_kernarg_size 80
  .amdhsa_user_sgpr_count 2
  .amdhsa_user_sgpr_kernarg_segment_ptr 1
  .amdhsa_system_sgpr_workgroup_id_x 1
.end_amdhsa_kernel
.p2align 6
.amdhsa_kernel conv1_kernel
  .amdhsa_next_free_vgpr 128
  .amdhsa_next_free_sgpr 102
  .amdhsa_accum_offset 128
  .amdhsa_group_segment_fixed_size 0
  .amdhsa_kernarg_size 80
  .amdhsa_user_sgpr_count 2
  .amdhsa_user_sgpr_kernarg_segment_ptr 1
  .amdhsa_system_sgpr_workgroup_id_x 1
.end_amdhsa_kernel
.p2align 6
.amdhsa_kernel conv2_kernel
  .amdhsa_next_free_vgpr 128
  .amdhsa_next_free_sgpr 102
  .amdhsa_accum_offset 128
  .amdhsa_group_segment_fixed_size 0
  .amdhsa_kernarg_size 80
  .amdhsa_user_sgpr_count 2
  .amdhsa_user_sgpr_kernarg_segment_ptr 1
  .amdhsa_system_sgpr_workgroup_id_x 1
.end_amdhsa_kernel
.p2align 6
.amdhsa_kernel joint_kernel
  .amdhsa_next_free_vgpr 128
  .amdhsa_next_free_sgpr 102
  .amdhsa_accum_offset 128
  .amdhsa_group_segment_fixed_size 0
  .amdhsa_kernarg_size 80
  .amdhsa_user_sgpr_count 2
  .amdhsa_user_sgpr_kernarg_segment_ptr 1
  .amdhsa_system_sgpr_workgroup_id_x 1
.end_amdhsa_kernel
```

```asm
; @launch kernel=prep_kernel grid=(256,1,1) block=(384,1,1) lds=4096
; @launch kernel=conv1_kernel grid=(256,1,1) block=(1024,1,1) lds=162816
; @launch kernel=conv2_kernel grid=(256,1,1) block=(1024,1,1) lds=162816
; @launch kernel=joint_kernel grid=(250,1,1) block=(1024,1,1) lds=99472
.amdgcn_target "amdgcn-amd-amdhsa--gfx950"
.text
.globl prep_kernel
.p2align 8
.type prep_kernel,@function
prep_kernel:
    s_cmp_ge_u32 s2, 256
    s_cbranch_scc1 L_prep_kernel_done
    s_mov_b32 s3, s2
    s_load_dwordx16 s[44:59], s[0:1], 0
    s_load_dwordx2 s[30:31], s[0:1], 72
    v_readfirstlane_b32 s40, v0
    s_lshr_b32 s40, s40, 6
    v_and_b32 v1, 63, v0
    s_cmp_lt_u32 s40, 4
    s_cbranch_scc1 L_prep_kernel_w
    s_cmp_ge_u32 s2, 24
    s_cbranch_scc1 L_prep_kernel_done
    s_lshr_b32 s41, s2, 3
    s_and_b32 s42, s2, 7
    s_sub_u32 s43, s40, 4
    s_lshl_b32 s26, s43, 16
    s_lshl_b32 s5, s42, 6
    s_add_u32 s26, s26, s5
    s_mov_b32 s10, 131072
    s_mov_b32 s11, 0x00020000
    v_lshrrev_b32 v2, 4, v1
    v_lshlrev_b32 v2, 12, v2
    v_and_b32 v3, 15, v1
    v_lshl_add_u32 v2, v3, 2, v2
    v_mov_b32 v9, 0
    ds_write_b32 v9, v9 offset:2048
    s_waitcnt lgkmcnt(0)
    s_cmp_eq_u32 s41, 1
    s_cselect_b32 s8, s56, s52
    s_cselect_b32 s9, s57, s53
    s_cmp_eq_u32 s41, 2
    s_cselect_b32 s8, s54, s8
    s_cselect_b32 s9, s55, s9
    s_barrier
    s_cmp_lg_u32 s41, 2
    s_cbranch_scc1 L_prep_kernel_nog
    s_mov_b32 s16, s50
    s_mov_b32 s17, s51
    s_mov_b32 s18, 8192
    s_mov_b32 s19, 0x00020000
    v_and_b32 v6, 0x30, v1
    v_lshl_add_u32 v6, v3, 9, v6
    s_lshl_b32 s6, s43, 8
    buffer_load_dwordx4 v[80:83], v6, s[16:19], s6 offen offset:0
    buffer_load_dwordx4 v[84:87], v6, s[16:19], s6 offen offset:64
    buffer_load_dwordx4 v[88:91], v6, s[16:19], s6 offen offset:128
    buffer_load_dwordx4 v[92:95], v6, s[16:19], s6 offen offset:192
L_prep_kernel_nog:
    buffer_load_dword v16, v2, s[8:11], s26 offen offset:0
    buffer_load_dword v17, v2, s[8:11], s26 offen offset:512
    buffer_load_dword v18, v2, s[8:11], s26 offen offset:1024
    buffer_load_dword v19, v2, s[8:11], s26 offen offset:1536
    buffer_load_dword v20, v2, s[8:11], s26 offen offset:2048
    buffer_load_dword v21, v2, s[8:11], s26 offen offset:2560
    buffer_load_dword v22, v2, s[8:11], s26 offen offset:3072
    buffer_load_dword v23, v2, s[8:11], s26 offen offset:3584
    s_add_u32 s26, s26, 16384
    buffer_load_dword v24, v2, s[8:11], s26 offen offset:0
    buffer_load_dword v25, v2, s[8:11], s26 offen offset:512
    buffer_load_dword v26, v2, s[8:11], s26 offen offset:1024
    buffer_load_dword v27, v2, s[8:11], s26 offen offset:1536
    buffer_load_dword v28, v2, s[8:11], s26 offen offset:2048
    buffer_load_dword v29, v2, s[8:11], s26 offen offset:2560
    buffer_load_dword v30, v2, s[8:11], s26 offen offset:3072
    buffer_load_dword v31, v2, s[8:11], s26 offen offset:3584
    s_add_u32 s26, s26, 16384
    buffer_load_dword v32, v2, s[8:11], s26 offen offset:0
    buffer_load_dword v33, v2, s[8:11], s26 offen offset:512
    buffer_load_dword v34, v2, s[8:11], s26 offen offset:1024
    buffer_load_dword v35, v2, s[8:11], s26 offen offset:1536
    buffer_load_dword v36, v2, s[8:11], s26 offen offset:2048
    buffer_load_dword v37, v2, s[8:11], s26 offen offset:2560
    buffer_load_dword v38, v2, s[8:11], s26 offen offset:3072
    buffer_load_dword v39, v2, s[8:11], s26 offen offset:3584
    s_add_u32 s26, s26, 16384
    buffer_load_dword v40, v2, s[8:11], s26 offen offset:0
    buffer_load_dword v41, v2, s[8:11], s26 offen offset:512
    buffer_load_dword v42, v2, s[8:11], s26 offen offset:1024
    buffer_load_dword v43, v2, s[8:11], s26 offen offset:1536
    buffer_load_dword v44, v2, s[8:11], s26 offen offset:2048
    buffer_load_dword v45, v2, s[8:11], s26 offen offset:2560
    buffer_load_dword v46, v2, s[8:11], s26 offen offset:3072
    buffer_load_dword v47, v2, s[8:11], s26 offen offset:3584
    s_branch L_prep_kernel_small
L_prep_kernel_w:
    s_lshl_b32 s21, s2, 2
    s_add_u32 s20, s40, s21
    s_load_dwordx2 s[8:9], s[0:1], 8
    s_lshr_b32 s22, s20, 8
    s_bfe_u32 s23, s20, 0x40004
    s_bfe_u32 s24, s20, 0x30001
    s_and_b32 s21, s20, 1
    v_lshrrev_b32 v5, 4, v1
    v_lshlrev_b32 v2, 11, v5
    v_and_b32 v3, 15, v1
    v_lshl_add_u32 v2, v3, 2, v2
    s_lshl_b32 s26, s22, 3
    s_lshr_b32 s27, s23, 3
    s_add_u32 s26, s26, s27
    s_lshl_b32 s26, s26, 17
    s_and_b32 s27, s23, 7
    s_lshl_b32 s27, s27, 1
    s_add_u32 s27, s27, s21
    s_lshl_b32 s27, s27, 13
    s_add_u32 s26, s26, s27
    s_lshl_b32 s27, s24, 6
    s_add_u32 s26, s26, s27
    s_mov_b32 s10, 4063232
    s_mov_b32 s11, 0x00020000
    s_add_u32 s37, s26, 262144
    s_add_u32 s38, s26, 524288
    s_add_u32 s39, s26, 786432
    s_mov_b32 s14, 7340032
    s_mov_b32 s15, 0x00020000
    v_lshrrev_b32 v4, 1, v5
    v_lshlrev_b32 v4, 8, v4
    v_lshl_add_u32 v4, v3, 4, v4
    v_and_b32 v5, 1, v5
    v_lshl_add_u32 v4, v5, 10, v4
    s_lshl_b32 s27, s24, 4
    s_add_u32 s27, s27, s23
    s_mul_i32 s27, s27, 57344
    s_lshl_b32 s28, s22, 11
    s_add_u32 s27, s27, s28
    s_lshl_b32 s28, s21, 9
    s_add_u32 s27, s27, s28
    s_mov_b32 s32, 0x05040100
    s_mov_b32 s33, 0x07060302
    s_mov_b32 s34, 0xffff0000
    s_mov_b32 s35, 0x3d2aaaab
    s_mov_b32 s40, 0x3c638e39
    s_waitcnt lgkmcnt(0)
    buffer_load_dword v16, v2, s[8:11], s26 offen offset:0
    buffer_load_dword v17, v2, s[8:11], s26 offen offset:512
    buffer_load_dword v20, v2, s[8:11], s37 offen offset:0
    buffer_load_dword v21, v2, s[8:11], s37 offen offset:512
    buffer_load_dword v24, v2, s[8:11], s38 offen offset:0
    buffer_load_dword v25, v2, s[8:11], s38 offen offset:512
    buffer_load_dword v28, v2, s[8:11], s39 offen offset:0
    buffer_load_dword v29, v2, s[8:11], s39 offen offset:512
    buffer_load_dword v18, v2, s[8:11], s26 offen offset:1024
    buffer_load_dword v19, v2, s[8:11], s26 offen offset:1536
    buffer_load_dword v22, v2, s[8:11], s37 offen offset:1024
    buffer_load_dword v23, v2, s[8:11], s37 offen offset:1536
    buffer_load_dword v26, v2, s[8:11], s38 offen offset:1024
    buffer_load_dword v27, v2, s[8:11], s38 offen offset:1536
    buffer_load_dword v30, v2, s[8:11], s39 offen offset:1024
    buffer_load_dword v31, v2, s[8:11], s39 offen offset:1536
    s_barrier
    s_add_u32 s12, s30, 0
    s_addc_u32 s13, s31, 0
    s_waitcnt vmcnt(8)
    v_perm_b32 v100, v17, v16, s32
    v_perm_b32 v76, v29, v28, s32
    v_lshlrev_b32 v104, 16, v28
    v_lshlrev_b32 v112, 16, v29
    v_lshlrev_b32 v105, 16, v24
    v_lshlrev_b32 v113, 16, v25
    v_lshlrev_b32 v106, 16, v20
    v_lshlrev_b32 v114, 16, v21
    v_lshlrev_b32 v107, 16, v16
    v_lshlrev_b32 v115, 16, v17
    v_add_f32 v108, v104, v106
    v_add_f32 v116, v112, v114
    v_add_f32 v109, v105, v107
    v_add_f32 v117, v113, v115
    v_fma_f32 v110, v106, 4.0, v104
    v_fma_f32 v118, v114, 4.0, v112
    v_fma_f32 v111, v107, 4.0, v105
    v_fma_f32 v119, v115, 4.0, v113
    v_add_f32 v105, v108, v109
    v_add_f32 v113, v116, v117
    v_sub_f32 v106, v108, v109
    v_sub_f32 v114, v116, v117
    v_fma_f32 v107, v111, 2.0, v110
    v_fma_f32 v115, v119, 2.0, v118
    v_fma_f32 v110, v111, -2.0, v110
    v_fma_f32 v118, v119, -2.0, v118
    v_fmamk_f32 v108, v104, 0x41700000, v110
    v_fmamk_f32 v116, v112, 0x41700000, v118
    v_fmamk_f32 v108, v109, 0x41200000, v108
    v_fmamk_f32 v116, v117, 0x41200000, v116
    v_mul_f32 v105, 0.5, v105
    v_mul_f32 v113, 0.5, v113
    v_mul_f32 v106, 0.5, v106
    v_mul_f32 v114, 0.5, v114
    v_mul_f32 v107, s35, v107
    v_mul_f32 v115, s35, v115
    v_mul_f32 v110, s35, v110
    v_mul_f32 v118, s35, v118
    v_mul_f32 v108, s40, v108
    v_mul_f32 v116, s40, v116
    v_cvt_pk_bf16_f32 v80, v105, v113
    v_cvt_pk_bf16_f32 v84, v106, v114
    v_cvt_pk_bf16_f32 v88, v107, v115
    v_cvt_pk_bf16_f32 v92, v110, v118
    v_cvt_pk_bf16_f32 v96, v108, v116
    v_perm_b32 v102, v17, v16, s33
    v_perm_b32 v78, v29, v28, s33
    v_and_b32 v104, s34, v28
    v_and_b32 v112, s34, v29
    v_and_b32 v105, s34, v24
    v_and_b32 v113, s34, v25
    v_and_b32 v106, s34, v20
    v_and_b32 v114, s34, v21
    v_and_b32 v107, s34, v16
    v_and_b32 v115, s34, v17
    v_add_f32 v108, v104, v106
    v_add_f32 v116, v112, v114
    v_add_f32 v109, v105, v107
    v_add_f32 v117, v113, v115
    v_fma_f32 v110, v106, 4.0, v104
    v_fma_f32 v118, v114, 4.0, v112
    v_fma_f32 v111, v107, 4.0, v105
    v_fma_f32 v119, v115, 4.0, v113
    v_add_f32 v105, v108, v109
    v_add_f32 v113, v116, v117
    v_sub_f32 v106, v108, v109
    v_sub_f32 v114, v116, v117
    v_fma_f32 v107, v111, 2.0, v110
    v_fma_f32 v115, v119, 2.0, v118
    v_fma_f32 v110, v111, -2.0, v110
    v_fma_f32 v118, v119, -2.0, v118
    v_fmamk_f32 v108, v104, 0x41700000, v110
    v_fmamk_f32 v116, v112, 0x41700000, v118
    v_fmamk_f32 v108, v109, 0x41200000, v108
    v_fmamk_f32 v116, v117, 0x41200000, v116
    v_mul_f32 v105, 0.5, v105
    v_mul_f32 v113, 0.5, v113
    v_mul_f32 v106, 0.5, v106
    v_mul_f32 v114, 0.5, v114
    v_mul_f32 v107, s35, v107
    v_mul_f32 v115, s35, v115
    v_mul_f32 v110, s35, v110
    v_mul_f32 v118, s35, v118
    v_mul_f32 v108, s40, v108
    v_mul_f32 v116, s40, v116
    v_cvt_pk_bf16_f32 v82, v105, v113
    v_cvt_pk_bf16_f32 v86, v106, v114
    v_cvt_pk_bf16_f32 v90, v107, v115
    v_cvt_pk_bf16_f32 v94, v110, v118
    v_cvt_pk_bf16_f32 v98, v108, v116
    s_waitcnt vmcnt(0)
    s_cmp_lt_u32 s3, 224
    s_cbranch_scc1 L_prep_kernel_ncw
    s_getpc_b64 s[62:63]
L_prep_kernel_pc:
    s_and_b32 s64, s3, 8
    s_lshl_b32 s64, s64, 12
    v_lshlrev_b32 v120, 7, v0
    v_add_u32 v120, s64, v120
    v_min_u32 v120, L_joint_kernel_done-L_prep_kernel_pc, v120
    v_mov_b32 v121, s63
    v_add_co_u32 v120, vcc, s62, v120
    s_nop 1
    v_addc_co_u32 v121, vcc, 0, v121, vcc
    global_load_dword v122, v[120:121], off
L_prep_kernel_ncw:
    v_perm_b32 v101, v19, v18, s32
    v_perm_b32 v77, v31, v30, s32
    v_lshlrev_b32 v104, 16, v30
    v_lshlrev_b32 v112, 16, v31
    v_lshlrev_b32 v105, 16, v26
    v_lshlrev_b32 v113, 16, v27
    v_lshlrev_b32 v106, 16, v22
    v_lshlrev_b32 v114, 16, v23
    v_lshlrev_b32 v107, 16, v18
    v_lshlrev_b32 v115, 16, v19
    v_add_f32 v108, v104, v106
    v_add_f32 v116, v112, v114
    v_add_f32 v109, v105, v107
    v_add_f32 v117, v113, v115
    v_fma_f32 v110, v106, 4.0, v104
    v_fma_f32 v118, v114, 4.0, v112
    v_fma_f32 v111, v107, 4.0, v105
    v_fma_f32 v119, v115, 4.0, v113
    v_add_f32 v105, v108, v109
    v_add_f32 v113, v116, v117
    v_sub_f32 v106, v108, v109
    v_sub_f32 v114, v116, v117
    v_fma_f32 v107, v111, 2.0, v110
    v_fma_f32 v115, v119, 2.0, v118
    v_fma_f32 v110, v111, -2.0, v110
    v_fma_f32 v118, v119, -2.0, v118
    v_fmamk_f32 v108, v104, 0x41700000, v110
    v_fmamk_f32 v116, v112, 0x41700000, v118
    v_fmamk_f32 v108, v109, 0x41200000, v108
    v_fmamk_f32 v116, v117, 0x41200000, v116
    v_mul_f32 v105, 0.5, v105
    v_mul_f32 v113, 0.5, v113
    v_mul_f32 v106, 0.5, v106
    v_mul_f32 v114, 0.5, v114
    v_mul_f32 v107, s35, v107
    v_mul_f32 v115, s35, v115
    v_mul_f32 v110, s35, v110
    v_mul_f32 v118, s35, v118
    v_mul_f32 v108, s40, v108
    v_mul_f32 v116, s40, v116
    v_cvt_pk_bf16_f32 v81, v105, v113
    v_cvt_pk_bf16_f32 v85, v106, v114
    v_cvt_pk_bf16_f32 v89, v107, v115
    v_cvt_pk_bf16_f32 v93, v110, v118
    v_cvt_pk_bf16_f32 v97, v108, v116
    v_perm_b32 v103, v19, v18, s33
    v_perm_b32 v79, v31, v30, s33
    v_and_b32 v104, s34, v30
    v_and_b32 v112, s34, v31
    v_and_b32 v105, s34, v26
    v_and_b32 v113, s34, v27
    v_and_b32 v106, s34, v22
    v_and_b32 v114, s34, v23
    v_and_b32 v107, s34, v18
    v_and_b32 v115, s34, v19
    v_add_f32 v108, v104, v106
    v_add_f32 v116, v112, v114
    v_add_f32 v109, v105, v107
    v_add_f32 v117, v113, v115
    v_fma_f32 v110, v106, 4.0, v104
    v_fma_f32 v118, v114, 4.0, v112
    v_fma_f32 v111, v107, 4.0, v105
    v_fma_f32 v119, v115, 4.0, v113
    v_add_f32 v105, v108, v109
    v_add_f32 v113, v116, v117
    v_sub_f32 v106, v108, v109
    v_sub_f32 v114, v116, v117
    v_fma_f32 v107, v111, 2.0, v110
    v_fma_f32 v115, v119, 2.0, v118
    v_fma_f32 v110, v111, -2.0, v110
    v_fma_f32 v118, v119, -2.0, v118
    v_fmamk_f32 v108, v104, 0x41700000, v110
    v_fmamk_f32 v116, v112, 0x41700000, v118
    v_fmamk_f32 v108, v109, 0x41200000, v108
    v_fmamk_f32 v116, v117, 0x41200000, v116
    v_mul_f32 v105, 0.5, v105
    v_mul_f32 v113, 0.5, v113
    v_mul_f32 v106, 0.5, v106
    v_mul_f32 v114, 0.5, v114
    v_mul_f32 v107, s35, v107
    v_mul_f32 v115, s35, v115
    v_mul_f32 v110, s35, v110
    v_mul_f32 v118, s35, v118
    v_mul_f32 v108, s40, v108
    v_mul_f32 v116, s40, v116
    v_cvt_pk_bf16_f32 v83, v105, v113
    v_cvt_pk_bf16_f32 v87, v106, v114
    v_cvt_pk_bf16_f32 v91, v107, v115
    v_cvt_pk_bf16_f32 v95, v110, v118
    v_cvt_pk_bf16_f32 v99, v108, v116
    v_permlane16_swap_b32 v100, v102
    v_permlane16_swap_b32 v101, v103
    s_add_u32 s28, s27, 49152
    buffer_store_dwordx4 v[100:103], v4, s[12:15], s28 offen sc1
    v_permlane16_swap_b32 v76, v78
    v_permlane16_swap_b32 v77, v79
    s_add_u32 s28, s27, 0
    buffer_store_dwordx4 v[76:79], v4, s[12:15], s28 offen sc1
    v_permlane16_swap_b32 v80, v82
    v_permlane16_swap_b32 v81, v83
    s_add_u32 s28, s27, 8192
    buffer_store_dwordx4 v[80:83], v4, s[12:15], s28 offen sc1
    v_permlane16_swap_b32 v84, v86
    v_permlane16_swap_b32 v85, v87
    s_add_u32 s28, s27, 16384
    buffer_store_dwordx4 v[84:87], v4, s[12:15], s28 offen sc1
    v_permlane16_swap_b32 v88, v90
    v_permlane16_swap_b32 v89, v91
    s_add_u32 s28, s27, 24576
    buffer_store_dwordx4 v[88:91], v4, s[12:15], s28 offen sc1
    v_permlane16_swap_b32 v92, v94
    v_permlane16_swap_b32 v93, v95
    s_add_u32 s28, s27, 32768
    buffer_store_dwordx4 v[92:95], v4, s[12:15], s28 offen sc1
    v_permlane16_swap_b32 v96, v98
    v_permlane16_swap_b32 v97, v99
    s_add_u32 s28, s27, 40960
    buffer_store_dwordx4 v[96:99], v4, s[12:15], s28 offen sc1
L_prep_kernel_done:
    s_endpgm
L_prep_kernel_small:
    v_lshrrev_b32 v2, 4, v1
    s_lshl_b32 s24, s41, 17
    s_add_u32 s24, s24, 44040192
    s_add_u32 s12, s30, s24
    s_addc_u32 s13, s31, 0
    s_mov_b32 s14, 131072
    s_mov_b32 s15, 0x00020000
    s_mov_b32 s32, 0x05040100
    s_mov_b32 s33, 0x07060302
    v_lshlrev_b32 v4, 4, v1
    s_lshl_b32 s24, s42, 14
    s_lshl_b32 s25, s43, 13
    s_add_u32 s24, s24, s25
    s_add_u32 s25, s24, 4096
    s_waitcnt vmcnt(0)
    v_perm_b32 v48, v17, v16, s32
    v_perm_b32 v49, v19, v18, s32
    v_perm_b32 v50, v21, v20, s32
    v_perm_b32 v51, v23, v22, s32
    v_perm_b32 v52, v17, v16, s33
    v_perm_b32 v53, v19, v18, s33
    v_perm_b32 v54, v21, v20, s33
    v_perm_b32 v55, v23, v22, s33
    v_perm_b32 v56, v25, v24, s32
    v_perm_b32 v57, v27, v26, s32
    v_perm_b32 v58, v29, v28, s32
    v_perm_b32 v59, v31, v30, s32
    v_perm_b32 v60, v25, v24, s33
    v_perm_b32 v61, v27, v26, s33
    v_perm_b32 v62, v29, v28, s33
    v_perm_b32 v63, v31, v30, s33
    v_perm_b32 v64, v33, v32, s32
    v_perm_b32 v65, v35, v34, s32
    v_perm_b32 v66, v37, v36, s32
    v_perm_b32 v67, v39, v38, s32
    v_perm_b32 v68, v33, v32, s33
    v_perm_b32 v69, v35, v34, s33
    v_perm_b32 v70, v37, v36, s33
    v_perm_b32 v71, v39, v38, s33
    v_perm_b32 v72, v41, v40, s32
    v_perm_b32 v73, v43, v42, s32
    v_perm_b32 v74, v45, v44, s32
    v_perm_b32 v75, v47, v46, s32
    v_perm_b32 v76, v41, v40, s33
    v_perm_b32 v77, v43, v42, s33
    v_perm_b32 v78, v45, v44, s33
    v_perm_b32 v79, v47, v46, s33
    s_cmp_eq_u32 s41, 2
    s_cbranch_scc1 L_prep_kernel_ge
    buffer_store_dwordx4 v[48:51], v4, s[12:15], s24 offen offset:0 sc1
    buffer_store_dwordx4 v[52:55], v4, s[12:15], s24 offen offset:1024 sc1
    buffer_store_dwordx4 v[56:59], v4, s[12:15], s24 offen offset:2048 sc1
    buffer_store_dwordx4 v[60:63], v4, s[12:15], s24 offen offset:3072 sc1
    buffer_store_dwordx4 v[64:67], v4, s[12:15], s25 offen offset:0 sc1
    buffer_store_dwordx4 v[68:71], v4, s[12:15], s25 offen offset:1024 sc1
    buffer_store_dwordx4 v[72:75], v4, s[12:15], s25 offen offset:2048 sc1
    buffer_store_dwordx4 v[76:79], v4, s[12:15], s25 offen offset:3072 sc1
    s_endpgm
L_prep_kernel_ge:
    v_mfma_f32_16x16x32_bf16 v[96:99], v[48:51], v[80:83], 0
    v_mfma_f32_16x16x32_bf16 v[100:103], v[52:55], v[80:83], 0
    v_mfma_f32_16x16x32_bf16 v[96:99], v[56:59], v[84:87], v[96:99]
    v_mfma_f32_16x16x32_bf16 v[100:103], v[60:63], v[84:87], v[100:103]
    v_mfma_f32_16x16x32_bf16 v[96:99], v[64:67], v[88:91], v[96:99]
    v_mfma_f32_16x16x32_bf16 v[100:103], v[68:71], v[88:91], v[100:103]
    v_mfma_f32_16x16x32_bf16 v[96:99], v[72:75], v[92:95], v[96:99]
    v_mfma_f32_16x16x32_bf16 v[100:103], v[76:79], v[92:95], v[100:103]
    v_mov_b32 v7, v4
    v_mov_b32 v10, 1
    s_nop 0
    s_mov_b32 s14, 16384
    v_lshlrev_b32 v8, 10, v3
    v_lshl_add_u32 v8, v2, 5, v8
    s_lshl_b32 s24, s42, 7
    s_mov_b32 s34, 0xffff0000
    s_mov_b32 s35, 0x4038aa3b
    s_cmp_eq_u32 s43, 0
    s_cbranch_scc1 L_prep_kernel_ge0
    ds_write_b128 v7, v[96:99]
    ds_write_b128 v7, v[100:103] offset:1024
    ds_write_b32 v9, v10 offset:2048
    s_endpgm
L_prep_kernel_ge0:
    ds_read_b32 v10, v9 offset:2048
    s_waitcnt lgkmcnt(0)
    v_readfirstlane_b32 s27, v10
    s_cmp_eq_u32 s27, 0
    s_cbranch_scc1 L_prep_kernel_ge0
    ds_read_b128 v[16:19], v7
    ds_read_b128 v[20:23], v7 offset:1024
    s_waitcnt lgkmcnt(0)
    v_add_f32 v16, v16, v96
    v_add_f32 v17, v17, v97
    v_add_f32 v18, v18, v98
    v_add_f32 v19, v19, v99
    v_add_f32 v20, v20, v100
    v_add_f32 v21, v21, v101
    v_add_f32 v22, v22, v102
    v_add_f32 v23, v23, v103
    v_cvt_pk_bf16_f32 v48, v16, v20
    v_cvt_pk_bf16_f32 v49, v17, v21
    v_cvt_pk_bf16_f32 v50, v18, v22
    v_cvt_pk_bf16_f32 v51, v19, v23
    v_lshlrev_b32 v56, 16, v48
    v_and_b32 v57, s34, v48
    v_lshlrev_b32 v58, 16, v49
    v_and_b32 v59, s34, v49
    v_lshlrev_b32 v60, 16, v50
    v_and_b32 v61, s34, v50
    v_lshlrev_b32 v62, 16, v51
    v_and_b32 v63, s34, v51
    v_mul_f32 v56, s35, v56
    v_mul_f32 v57, s35, v57
    v_mul_f32 v58, s35, v58
    v_mul_f32 v59, s35, v59
    v_mul_f32 v60, s35, v60
    v_mul_f32 v61, s35, v61
    v_mul_f32 v62, s35, v62
    v_mul_f32 v63, s35, v63
    buffer_store_dwordx4 v[56:59], v8, s[12:15], s24 offen sc1
    buffer_store_dwordx4 v[60:63], v8, s[12:15], s24 offen offset:16 sc1
    v_exp_f32 v64, v56
    v_exp_f32 v65, v57
    v_exp_f32 v66, v58
    v_exp_f32 v67, v59
    v_exp_f32 v68, v60
    v_exp_f32 v69, v61
    v_exp_f32 v70, v62
    v_exp_f32 v71, v63
    v_max3_f32 v72, |v56|, |v57|, |v58|
    v_max3_f32 v72, |v59|, |v60|, v72
    v_max3_f32 v72, |v61|, |v62|, v72
    v_max_f32 v72, |v63|, v72
    s_add_u32 s12, s12, 16384
    s_addc_u32 s13, s13, 0
    v_cmp_lt_f32 vcc, 0x42f00000, v72
    buffer_store_dwordx4 v[64:67], v8, s[12:15], s24 offen sc1
    buffer_store_dwordx4 v[68:71], v8, s[12:15], s24 offen offset:16 sc1
    s_add_u32 s12, s12, 16384
    s_addc_u32 s13, s13, 0
    s_or_b32 s26, vcc_lo, vcc_hi
    s_lshl_b32 s24, s42, 2
    v_mov_b32 v73, s26
    v_mov_b32 v74, 0
    buffer_store_dword v73, v74, s[12:15], s24 offen sc1
L_prep_kernel_last:
    s_endpgm
.globl conv1_kernel
.p2align 8
.type conv1_kernel,@function
conv1_kernel:
    s_cmp_ge_u32 s2, 256
    s_cbranch_scc1 L_conv1_kernel_done
    s_load_dwordx2 s[4:5], s[0:1], 0
    s_load_dwordx2 s[30:31], s[0:1], 72
    v_readfirstlane_b32 s20, v0
    s_lshr_b32 s20, s20, 6
    s_xor_b32 s20, s20, 8
    s_and_b32 s36, s2, 0
    s_lshl_b32 s36, s36, 3
    s_bfe_u32 s37, s2, 196611
    s_or_b32 s29, s36, s37
    s_bfe_u32 s36, s2, 196608
    s_lshl_b32 s36, s36, 2
    s_lshr_b32 s37, s2, 6
    s_or_b32 s36, s36, s37
    s_mov_b32 s33, 0
    s_and_b32 s34, s36, 15
    s_lshr_b32 s35, s36, 4
    s_mul_i32 s21, s34, 500
    s_and_b32 s32, s20, 3
    v_and_b32 v127, 63, v0
    v_lshrrev_b32 v5, 2, v127
    v_and_b32 v6, 3, v127
    s_and_b32 s42, s20, 7
    v_lshlrev_b32 v7, 15, v5
    v_lshl_add_u32 v7, v6, 4, v7
    s_lshl_b32 s41, s21, 10
    s_sub_u32 s41, s41, 7680
    s_lshl_b32 s37, s42, 12
    s_add_u32 s37, s37, s41
    v_add_u32 v7, s37, v7
    s_mul_i32 s36, s35, 8192000
    s_mov_b32 s10, 8192000
    s_mov_b32 s11, 0x00020000
    s_mov_b32 s25, 0xffff0000
    s_mov_b32 s47, s36
    s_cmp_ge_u32 s20, 8
    s_cbranch_scc1 L_conv1_kernel_helper
    s_add_u32 s37, s41, 524288
    v_lshl_add_u32 v108, v127, 4, s37
    v_add_u32 v109, 1024, v108
    v_add_u32 v110, 2048, v108
    s_waitcnt lgkmcnt(0)
    s_add_u32 s8, s4, s47
    s_addc_u32 s9, s5, 0
    s_lshl_b32 s36, s29, 4
    s_lshl_b32 s37, s33, 3
    s_add_u32 s36, s36, s37
    s_mul_i32 s36, s36, 57344
    s_add_u32 s36, s36, 0
    s_add_u32 s12, s30, s36
    s_addc_u32 s13, s31, 0
    s_mov_b32 s14, 917504
    s_mov_b32 s15, 0x00020000
    s_mul_i32 s36, s35, 4194304
    s_add_u32 s36, s36, 18874368
    s_add_u32 s16, s30, s36
    s_addc_u32 s17, s31, 0
    s_mov_b32 s18, 4194304
    s_mov_b32 s19, 0x00020000
    v_and_b32 v10, 15, v127
    v_lshrrev_b32 v11, 4, v127
    v_add_u32 v8, 0, v10
    v_and_b32 v16, 4, v8
    v_lshrrev_b32 v16, 1, v16
    v_xor_b32 v16, v11, v16
    v_lshlrev_b32 v16, 4, v16
    v_lshl_add_u32 v8, v8, 6, v16
    v_add_u32 v9, 1, v10
    v_and_b32 v16, 4, v9
    v_lshrrev_b32 v16, 1, v16
    v_xor_b32 v16, v11, v16
    v_lshlrev_b32 v16, 4, v16
    v_lshl_add_u32 v9, v9, 6, v16
    s_lshr_b32 s38, s32, 1
    s_and_b32 s39, s32, 1
    s_add_u32 s40, s38, 4
    s_lshl_b32 s43, s39, 10
    s_cmp_lt_u32 s20, 4
    s_cselect_b32 s40, s20, s40
    s_cselect_b32 s36, 0, s43
    s_lshl_b32 s37, s40, 13
    s_add_u32 s37, s37, s36
    v_lshl_add_u32 v125, v127, 4, s37
    s_mul_i32 s37, s40, 16384
    v_add_u32 v120, s37, v8
    v_add_u32 v121, s37, v9
    s_lshl_b32 s37, s40, 10
    s_add_u32 s37, s37, 115712
    v_lshl_add_u32 v16, v11, 4, s37
    v_cmp_eq_u32 vcc, 15, v10
    v_mov_b32 v17, 8192
    v_mov_b32 v18, 4294959104
    v_mov_b32 v19, 64
    v_cndmask_b32 v122, v121, v16, vcc
    v_cndmask_b32 v123, v17, v19, vcc
    v_cndmask_b32 v124, v18, v19, vcc
    v_lshl_add_u32 v126, v127, 4, s37
    s_mov_b32 s44, 0x3f800000
    s_mov_b32 s45, 0x00000000
    s_mov_b32 s46, 0x00000000
    s_cmp_eq_u32 s40, 1
    s_cselect_b32 s45, 0x3f800000, s45
    s_cselect_b32 s46, 0x3f800000, s46
    s_cmp_eq_u32 s40, 2
    s_cselect_b32 s45, 0xbf800000, s45
    s_cselect_b32 s46, 0x3f800000, s46
    s_cmp_eq_u32 s40, 3
    s_cselect_b32 s45, 0x40000000, s45
    s_cselect_b32 s46, 0x40800000, s46
    s_cmp_eq_u32 s40, 4
    s_cselect_b32 s45, 0xc0000000, s45
    s_cselect_b32 s46, 0x40800000, s46
    s_cmp_eq_u32 s40, 5
    s_cselect_b32 s44, 0x41800000, s44
    s_cselect_b32 s45, 0x41000000, s45
    s_cselect_b32 s46, 0x40800000, s46
    s_cmp_ge_u32 s20, 4
    s_cbranch_scc1 L_conv1_kernel_m2
    v_mov_b32 v0, 0
    v_mov_b32 v1, 0
    v_mov_b32 v2, 0
    v_mov_b32 v3, 0
    v_mov_b32 v4, 0
    v_mov_b32 v5, 0
    v_mov_b32 v6, 0
    v_mov_b32 v7, 0
    v_mov_b32 v8, 0
    v_mov_b32 v9, 0
    v_mov_b32 v10, 0
    v_mov_b32 v11, 0
    v_mov_b32 v12, 0
    v_mov_b32 v13, 0
    v_mov_b32 v14, 0
    v_mov_b32 v15, 0
    v_mov_b32 v16, 0
    v_mov_b32 v17, 0
    v_mov_b32 v18, 0
    v_mov_b32 v19, 0
    v_mov_b32 v20, 0
    v_mov_b32 v21, 0
    v_mov_b32 v22, 0
    v_mov_b32 v23, 0
    v_mov_b32 v24, 0
    v_mov_b32 v25, 0
    v_mov_b32 v26, 0
    v_mov_b32 v27, 0
    v_mov_b32 v28, 0
    v_mov_b32 v29, 0
    v_mov_b32 v30, 0
    v_mov_b32 v31, 0
    v_mov_b32 v32, 0
    v_mov_b32 v33, 0
    v_mov_b32 v34, 0
    v_mov_b32 v35, 0
    v_mov_b32 v36, 0
    v_mov_b32 v37, 0
    v_mov_b32 v38, 0
    v_mov_b32 v39, 0
    v_mov_b32 v40, 0
    v_mov_b32 v41, 0
    v_mov_b32 v42, 0
    v_mov_b32 v43, 0
    v_mov_b32 v44, 0
    v_mov_b32 v45, 0
    v_mov_b32 v46, 0
    v_mov_b32 v47, 0
    v_mov_b32 v48, 0
    v_mov_b32 v49, 0
    v_mov_b32 v50, 0
    v_mov_b32 v51, 0
    v_mov_b32 v52, 0
    v_mov_b32 v53, 0
    v_mov_b32 v54, 0
    v_mov_b32 v55, 0
    v_mov_b32 v56, 0
    v_mov_b32 v57, 0
    v_mov_b32 v58, 0
    v_mov_b32 v59, 0
    v_mov_b32 v60, 0
    v_mov_b32 v61, 0
    v_mov_b32 v62, 0
    v_mov_b32 v63, 0
    buffer_load_dwordx4 v[96:99], v108, s[8:11], 0 offen
    buffer_load_dwordx4 v[100:103], v109, s[8:11], 0 offen
    buffer_load_dwordx4 v[104:107], v110, s[8:11], 0 offen
    s_mov_b32 s23, 0
    s_mov_b32 s26, 4096
    buffer_load_dwordx4 v[64:67], v125, s[12:15], s23 offen offset:0
    buffer_load_dwordx4 v[68:71], v125, s[12:15], s23 offen offset:1024
    buffer_load_dwordx4 v[72:75], v125, s[12:15], s23 offen offset:2048
    buffer_load_dwordx4 v[76:79], v125, s[12:15], s23 offen offset:3072
    buffer_load_dwordx4 v[80:83], v125, s[12:15], s26 offen offset:0
    buffer_load_dwordx4 v[84:87], v125, s[12:15], s26 offen offset:1024
    buffer_load_dwordx4 v[88:91], v125, s[12:15], s26 offen offset:2048
    buffer_load_dwordx4 v[92:95], v125, s[12:15], s26 offen offset:3072
    s_mov_b32 s23, 57344
    s_mov_b32 s26, 61440
    s_waitcnt vmcnt(8)
    v_lshlrev_b32 v108, 16, v96
    v_and_b32 v111, s25, v96
    v_lshlrev_b32 v109, 16, v100
    v_and_b32 v112, s25, v100
    v_lshlrev_b32 v110, 16, v104
    v_and_b32 v113, s25, v104
    v_mul_f32 v114, s44, v108
    v_mul_f32 v115, s44, v111
    v_fmac_f32 v114, s45, v109
    v_fmac_f32 v115, s45, v112
    v_fmac_f32 v114, s46, v110
    v_fmac_f32 v115, s46, v113
    v_cvt_pk_bf16_f32 v96, v114, v115
    v_lshlrev_b32 v108, 16, v97
    v_and_b32 v111, s25, v97
    v_lshlrev_b32 v109, 16, v101
    v_and_b32 v112, s25, v101
    v_lshlrev_b32 v110, 16, v105
    v_and_b32 v113, s25, v105
    v_mul_f32 v114, s44, v108
    v_mul_f32 v115, s44, v111
    v_fmac_f32 v114, s45, v109
    v_fmac_f32 v115, s45, v112
    v_fmac_f32 v114, s46, v110
    v_fmac_f32 v115, s46, v113
    v_cvt_pk_bf16_f32 v97, v114, v115
    v_lshlrev_b32 v108, 16, v98
    v_and_b32 v111, s25, v98
    v_lshlrev_b32 v109, 16, v102
    v_and_b32 v112, s25, v102
    v_lshlrev_b32 v110, 16, v106
    v_and_b32 v113, s25, v106
    v_mul_f32 v114, s44, v108
    v_mul_f32 v115, s44, v111
    v_fmac_f32 v114, s45, v109
    v_fmac_f32 v115, s45, v112
    v_fmac_f32 v114, s46, v110
    v_fmac_f32 v115, s46, v113
    v_cvt_pk_bf16_f32 v98, v114, v115
    v_lshlrev_b32 v108, 16, v99
    v_and_b32 v111, s25, v99
    v_lshlrev_b32 v109, 16, v103
    v_and_b32 v112, s25, v103
    v_lshlrev_b32 v110, 16, v107
    v_and_b32 v113, s25, v107
    v_mul_f32 v114, s44, v108
    v_mul_f32 v115, s44, v111
    v_fmac_f32 v114, s45, v109
    v_fmac_f32 v115, s45, v112
    v_fmac_f32 v114, s46, v110
    v_fmac_f32 v115, s46, v113
    v_cvt_pk_bf16_f32 v99, v114, v115
    ds_write_b128 v126, v[96:99]
    s_waitcnt lgkmcnt(0)
    s_barrier
    s_mov_b32 s22, 8
    s_setprio 2
L_conv1_kernel_mloop1:
    ds_read_b128 v[96:99], v120 offset:0
    ds_read_b128 v[100:103], v120 offset:1024
    ds_read_b128 v[104:107], v120 offset:2048
    ds_read_b128 v[108:111], v120 offset:3072
    ds_read_b128 v[112:115], v120 offset:4096
    ds_read_b128 v[116:119], v120 offset:5120
    s_waitcnt vmcnt(6) lgkmcnt(5)
    v_mfma_f32_16x16x32_bf16 v[0:3], v[64:67], v[96:99], v[0:3]
    v_mfma_f32_16x16x32_bf16 v[32:35], v[68:71], v[96:99], v[32:35]
    ds_read_b128 v[96:99], v120 offset:6144
    s_waitcnt vmcnt(4) lgkmcnt(5)
    v_mfma_f32_16x16x32_bf16 v[4:7], v[64:67], v[100:103], v[4:7]
    v_mfma_f32_16x16x32_bf16 v[36:39], v[68:71], v[100:103], v[36:39]
    v_mfma_f32_16x16x32_bf16 v[0:3], v[72:75], v[100:103], v[0:3]
    v_mfma_f32_16x16x32_bf16 v[32:35], v[76:79], v[100:103], v[32:35]
    ds_read_b128 v[100:103], v120 offset:7168
    s_waitcnt vmcnt(2) lgkmcnt(5)
    v_mfma_f32_16x16x32_bf16 v[8:11], v[64:67], v[104:107], v[8:11]
    v_mfma_f32_16x16x32_bf16 v[40:43], v[68:71], v[104:107], v[40:43]
    v_mfma_f32_16x16x32_bf16 v[4:7], v[72:75], v[104:107], v[4:7]
    v_mfma_f32_16x16x32_bf16 v[36:39], v[76:79], v[104:107], v[36:39]
    v_mfma_f32_16x16x32_bf16 v[0:3], v[80:83], v[104:107], v[0:3]
    v_mfma_f32_16x16x32_bf16 v[32:35], v[84:87], v[104:107], v[32:35]
    ds_read_b128 v[104:107], v122 offset:0
    v_add_u32 v122, v123, v122
    s_waitcnt vmcnt(0) lgkmcnt(5)
    v_mfma_f32_16x16x32_bf16 v[12:15], v[64:67], v[108:111], v[12:15]
    v_mfma_f32_16x16x32_bf16 v[44:47], v[68:71], v[108:111], v[44:47]
    v_mfma_f32_16x16x32_bf16 v[8:11], v[72:75], v[108:111], v[8:11]
    v_mfma_f32_16x16x32_bf16 v[40:43], v[76:79], v[108:111], v[40:43]
    v_mfma_f32_16x16x32_bf16 v[4:7], v[80:83], v[108:111], v[4:7]
    v_mfma_f32_16x16x32_bf16 v[36:39], v[84:87], v[108:111], v[36:39]
    v_mfma_f32_16x16x32_bf16 v[0:3], v[88:91], v[108:111], v[0:3]
    v_mfma_f32_16x16x32_bf16 v[32:35], v[92:95], v[108:111], v[32:35]
    ds_read_b128 v[108:111], v121 offset:1024
    s_waitcnt lgkmcnt(5)
    v_mfma_f32_16x16x32_bf16 v[16:19], v[64:67], v[112:115], v[16:19]
    v_mfma_f32_16x16x32_bf16 v[48:51], v[68:71], v[112:115], v[48:51]
    v_mfma_f32_16x16x32_bf16 v[12:15], v[72:75], v[112:115], v[12:15]
    v_mfma_f32_16x16x32_bf16 v[44:47], v[76:79], v[112:115], v[44:47]
    v_mfma_f32_16x16x32_bf16 v[8:11], v[80:83], v[112:115], v[8:11]
    v_mfma_f32_16x16x32_bf16 v[40:43], v[84:87], v[112:115], v[40:43]
    v_mfma_f32_16x16x32_bf16 v[4:7], v[88:91], v[112:115], v[4:7]
    v_mfma_f32_16x16x32_bf16 v[36:39], v[92:95], v[112:115], v[36:39]
    ds_read_b128 v[112:115], v121 offset:2048
    s_waitcnt lgkmcnt(5)
    v_mfma_f32_16x16x32_bf16 v[20:23], v[64:67], v[116:119], v[20:23]
    v_mfma_f32_16x16x32_bf16 v[52:55], v[68:71], v[116:119], v[52:55]
    v_mfma_f32_16x16x32_bf16 v[16:19], v[72:75], v[116:119], v[16:19]
    v_mfma_f32_16x16x32_bf16 v[48:51], v[76:79], v[116:119], v[48:51]
    v_mfma_f32_16x16x32_bf16 v[12:15], v[80:83], v[116:119], v[12:15]
    v_mfma_f32_16x16x32_bf16 v[44:47], v[84:87], v[116:119], v[44:47]
    v_mfma_f32_16x16x32_bf16 v[8:11], v[88:91], v[116:119], v[8:11]
    v_mfma_f32_16x16x32_bf16 v[40:43], v[92:95], v[116:119], v[40:43]
    s_waitcnt lgkmcnt(4)
    v_mfma_f32_16x16x32_bf16 v[24:27], v[64:67], v[96:99], v[24:27]
    v_mfma_f32_16x16x32_bf16 v[56:59], v[68:71], v[96:99], v[56:59]
    v_mfma_f32_16x16x32_bf16 v[20:23], v[72:75], v[96:99], v[20:23]
    v_mfma_f32_16x16x32_bf16 v[52:55], v[76:79], v[96:99], v[52:55]
    v_mfma_f32_16x16x32_bf16 v[16:19], v[80:83], v[96:99], v[16:19]
    v_mfma_f32_16x16x32_bf16 v[48:51], v[84:87], v[96:99], v[48:51]
    v_mfma_f32_16x16x32_bf16 v[12:15], v[88:91], v[96:99], v[12:15]
    v_mfma_f32_16x16x32_bf16 v[44:47], v[92:95], v[96:99], v[44:47]
    s_waitcnt lgkmcnt(3)
    v_mfma_f32_16x16x32_bf16 v[28:31], v[64:67], v[100:103], v[28:31]
    v_mfma_f32_16x16x32_bf16 v[60:63], v[68:71], v[100:103], v[60:63]
    v_mfma_f32_16x16x32_bf16 v[24:27], v[72:75], v[100:103], v[24:27]
    v_mfma_f32_16x16x32_bf16 v[56:59], v[76:79], v[100:103], v[56:59]
    v_mfma_f32_16x16x32_bf16 v[20:23], v[80:83], v[100:103], v[20:23]
    v_mfma_f32_16x16x32_bf16 v[52:55], v[84:87], v[100:103], v[52:55]
    v_mfma_f32_16x16x32_bf16 v[16:19], v[88:91], v[100:103], v[16:19]
    v_mfma_f32_16x16x32_bf16 v[48:51], v[92:95], v[100:103], v[48:51]
    buffer_load_dwordx4 v[64:67], v125, s[12:15], s23 offen offset:0
    buffer_load_dwordx4 v[68:71], v125, s[12:15], s23 offen offset:1024
    s_waitcnt lgkmcnt(2)
    v_mfma_f32_16x16x32_bf16 v[28:31], v[72:75], v[104:107], v[28:31]
    v_mfma_f32_16x16x32_bf16 v[60:63], v[76:79], v[104:107], v[60:63]
    v_mfma_f32_16x16x32_bf16 v[24:27], v[80:83], v[104:107], v[24:27]
    v_mfma_f32_16x16x32_bf16 v[56:59], v[84:87], v[104:107], v[56:59]
    v_mfma_f32_16x16x32_bf16 v[20:23], v[88:91], v[104:107], v[20:23]
    v_mfma_f32_16x16x32_bf16 v[52:55], v[92:95], v[104:107], v[52:55]
    buffer_load_dwordx4 v[72:75], v125, s[12:15], s23 offen offset:2048
    buffer_load_dwordx4 v[76:79], v125, s[12:15], s23 offen offset:3072
    s_waitcnt lgkmcnt(1)
    v_mfma_f32_16x16x32_bf16 v[28:31], v[80:83], v[108:111], v[28:31]
    v_mfma_f32_16x16x32_bf16 v[60:63], v[84:87], v[108:111], v[60:63]
    v_mfma_f32_16x16x32_bf16 v[24:27], v[88:91], v[108:111], v[24:27]
    v_mfma_f32_16x16x32_bf16 v[56:59], v[92:95], v[108:111], v[56:59]
    buffer_load_dwordx4 v[80:83], v125, s[12:15], s26 offen offset:0
    buffer_load_dwordx4 v[84:87], v125, s[12:15], s26 offen offset:1024
    s_waitcnt lgkmcnt(0)
    v_mfma_f32_16x16x32_bf16 v[28:31], v[88:91], v[112:115], v[28:31]
    v_mfma_f32_16x16x32_bf16 v[60:63], v[92:95], v[112:115], v[60:63]
    buffer_load_dwordx4 v[88:91], v125, s[12:15], s26 offen offset:2048
    buffer_load_dwordx4 v[92:95], v125, s[12:15], s26 offen offset:3072
    s_add_u32 s23, s23, 57344
    s_add_u32 s26, s26, 57344
    s_barrier
    s_sub_u32 s22, s22, 1
    s_cmp_eq_u32 s22, 0
    s_cbranch_scc1 L_conv1_kernel_mlast1
    ds_read_b128 v[96:99], v120 offset:8192
    ds_read_b128 v[100:103], v120 offset:9216
    ds_read_b128 v[104:107], v120 offset:10240
    ds_read_b128 v[108:111], v120 offset:11264
    ds_read_b128 v[112:115], v120 offset:12288
    ds_read_b128 v[116:119], v120 offset:13312
    s_waitcnt vmcnt(6) lgkmcnt(5)
    v_mfma_f32_16x16x32_bf16 v[0:3], v[64:67], v[96:99], v[0:3]
    v_mfma_f32_16x16x32_bf16 v[32:35], v[68:71], v[96:99], v[32:35]
    ds_read_b128 v[96:99], v120 offset:14336
    s_waitcnt vmcnt(4) lgkmcnt(5)
    v_mfma_f32_16x16x32_bf16 v[4:7], v[64:67], v[100:103], v[4:7]
    v_mfma_f32_16x16x32_bf16 v[36:39], v[68:71], v[100:103], v[36:39]
    v_mfma_f32_16x16x32_bf16 v[0:3], v[72:75], v[100:103], v[0:3]
    v_mfma_f32_16x16x32_bf16 v[32:35], v[76:79], v[100:103], v[32:35]
    ds_read_b128 v[100:103], v120 offset:15360
    s_waitcnt vmcnt(2) lgkmcnt(5)
    v_mfma_f32_16x16x32_bf16 v[8:11], v[64:67], v[104:107], v[8:11]
    v_mfma_f32_16x16x32_bf16 v[40:43], v[68:71], v[104:107], v[40:43]
    v_mfma_f32_16x16x32_bf16 v[4:7], v[72:75], v[104:107], v[4:7]
    v_mfma_f32_16x16x32_bf16 v[36:39], v[76:79], v[104:107], v[36:39]
    v_mfma_f32_16x16x32_bf16 v[0:3], v[80:83], v[104:107], v[0:3]
    v_mfma_f32_16x16x32_bf16 v[32:35], v[84:87], v[104:107], v[32:35]
    ds_read_b128 v[104:107], v122 offset:0
    v_add_u32 v122, v124, v122
    s_waitcnt vmcnt(0) lgkmcnt(5)
    v_mfma_f32_16x16x32_bf16 v[12:15], v[64:67], v[108:111], v[12:15]
    v_mfma_f32_16x16x32_bf16 v[44:47], v[68:71], v[108:111], v[44:47]
    v_mfma_f32_16x16x32_bf16 v[8:11], v[72:75], v[108:111], v[8:11]
    v_mfma_f32_16x16x32_bf16 v[40:43], v[76:79], v[108:111], v[40:43]
    v_mfma_f32_16x16x32_bf16 v[4:7], v[80:83], v[108:111], v[4:7]
    v_mfma_f32_16x16x32_bf16 v[36:39], v[84:87], v[108:111], v[36:39]
    v_mfma_f32_16x16x32_bf16 v[0:3], v[88:91], v[108:111], v[0:3]
    v_mfma_f32_16x16x32_bf16 v[32:35], v[92:95], v[108:111], v[32:35]
    ds_read_b128 v[108:111], v121 offset:9216
    s_waitcnt lgkmcnt(5)
    v_mfma_f32_16x16x32_bf16 v[16:19], v[64:67], v[112:115], v[16:19]
    v_mfma_f32_16x16x32_bf16 v[48:51], v[68:71], v[112:115], v[48:51]
    v_mfma_f32_16x16x32_bf16 v[12:15], v[72:75], v[112:115], v[12:15]
    v_mfma_f32_16x16x32_bf16 v[44:47], v[76:79], v[112:115], v[44:47]
    v_mfma_f32_16x16x32_bf16 v[8:11], v[80:83], v[112:115], v[8:11]
    v_mfma_f32_16x16x32_bf16 v[40:43], v[84:87], v[112:115], v[40:43]
    v_mfma_f32_16x16x32_bf16 v[4:7], v[88:91], v[112:115], v[4:7]
    v_mfma_f32_16x16x32_bf16 v[36:39], v[92:95], v[112:115], v[36:39]
    ds_read_b128 v[112:115], v121 offset:10240
    s_waitcnt lgkmcnt(5)
    v_mfma_f32_16x16x32_bf16 v[20:23], v[64:67], v[116:119], v[20:23]
    v_mfma_f32_16x16x32_bf16 v[52:55], v[68:71], v[116:119], v[52:55]
    v_mfma_f32_16x16x32_bf16 v[16:19], v[72:75], v[116:119], v[16:19]
    v_mfma_f32_16x16x32_bf16 v[48:51], v[76:79], v[116:119], v[48:51]
    v_mfma_f32_16x16x32_bf16 v[12:15], v[80:83], v[116:119], v[12:15]
    v_mfma_f32_16x16x32_bf16 v[44:47], v[84:87], v[116:119], v[44:47]
    v_mfma_f32_16x16x32_bf16 v[8:11], v[88:91], v[116:119], v[8:11]
    v_mfma_f32_16x16x32_bf16 v[40:43], v[92:95], v[116:119], v[40:43]
    s_waitcnt lgkmcnt(4)
    v_mfma_f32_16x16x32_bf16 v[24:27], v[64:67], v[96:99], v[24:27]
    v_mfma_f32_16x16x32_bf16 v[56:59], v[68:71], v[96:99], v[56:59]
    v_mfma_f32_16x16x32_bf16 v[20:23], v[72:75], v[96:99], v[20:23]
    v_mfma_f32_16x16x32_bf16 v[52:55], v[76:79], v[96:99], v[52:55]
    v_mfma_f32_16x16x32_bf16 v[16:19], v[80:83], v[96:99], v[16:19]
    v_mfma_f32_16x16x32_bf16 v[48:51], v[84:87], v[96:99], v[48:51]
    v_mfma_f32_16x16x32_bf16 v[12:15], v[88:91], v[96:99], v[12:15]
    v_mfma_f32_16x16x32_bf16 v[44:47], v[92:95], v[96:99], v[44:47]
    s_waitcnt lgkmcnt(3)
    v_mfma_f32_16x16x32_bf16 v[28:31], v[64:67], v[100:103], v[28:31]
    v_mfma_f32_16x16x32_bf16 v[60:63], v[68:71], v[100:103], v[60:63]
    v_mfma_f32_16x16x32_bf16 v[24:27], v[72:75], v[100:103], v[24:27]
    v_mfma_f32_16x16x32_bf16 v[56:59], v[76:79], v[100:103], v[56:59]
    v_mfma_f32_16x16x32_bf16 v[20:23], v[80:83], v[100:103], v[20:23]
    v_mfma_f32_16x16x32_bf16 v[52:55], v[84:87], v[100:103], v[52:55]
    v_mfma_f32_16x16x32_bf16 v[16:19], v[88:91], v[100:103], v[16:19]
    v_mfma_f32_16x16x32_bf16 v[48:51], v[92:95], v[100:103], v[48:51]
    buffer_load_dwordx4 v[64:67], v125, s[12:15], s23 offen offset:0
    buffer_load_dwordx4 v[68:71], v125, s[12:15], s23 offen offset:1024
    s_waitcnt lgkmcnt(2)
    v_mfma_f32_16x16x32_bf16 v[28:31], v[72:75], v[104:107], v[28:31]
    v_mfma_f32_16x16x32_bf16 v[60:63], v[76:79], v[104:107], v[60:63]
    v_mfma_f32_16x16x32_bf16 v[24:27], v[80:83], v[104:107], v[24:27]
    v_mfma_f32_16x16x32_bf16 v[56:59], v[84:87], v[104:107], v[56:59]
    v_mfma_f32_16x16x32_bf16 v[20:23], v[88:91], v[104:107], v[20:23]
    v_mfma_f32_16x16x32_bf16 v[52:55], v[92:95], v[104:107], v[52:55]
    buffer_load_dwordx4 v[72:75], v125, s[12:15], s23 offen offset:2048
    buffer_load_dwordx4 v[76:79], v125, s[12:15], s23 offen offset:3072
    s_waitcnt lgkmcnt(1)
    v_mfma_f32_16x16x32_bf16 v[28:31], v[80:83], v[108:111], v[28:31]
    v_mfma_f32_16x16x32_bf16 v[60:63], v[84:87], v[108:111], v[60:63]
    v_mfma_f32_16x16x32_bf16 v[24:27], v[88:91], v[108:111], v[24:27]
    v_mfma_f32_16x16x32_bf16 v[56:59], v[92:95], v[108:111], v[56:59]
    buffer_load_dwordx4 v[80:83], v125, s[12:15], s26 offen offset:0
    buffer_load_dwordx4 v[84:87], v125, s[12:15], s26 offen offset:1024
    s_waitcnt lgkmcnt(0)
    v_mfma_f32_16x16x32_bf16 v[28:31], v[88:91], v[112:115], v[28:31]
    v_mfma_f32_16x16x32_bf16 v[60:63], v[92:95], v[112:115], v[60:63]
    buffer_load_dwordx4 v[88:91], v125, s[12:15], s26 offen offset:2048
    buffer_load_dwordx4 v[92:95], v125, s[12:15], s26 offen offset:3072
    s_add_u32 s23, s23, 57344
    s_add_u32 s26, s26, 57344
    s_barrier
    s_branch L_conv1_kernel_mloop1
L_conv1_kernel_mlast1:
    v_and_b32 v125, 15, v127
    v_and_b32 v126, 7, v127
    v_lshlrev_b32 v126, 4, v126
    v_lshl_add_u32 v125, v125, 7, v126
    v_lshrrev_b32 v126, 4, v127
    v_lshl_add_u32 v125, v126, 11, v125
    s_lshl_b32 s36, s20, 14
    s_add_u32 s37, s36, 8192
    v_add_u32 v126, s37, v125
    v_add_u32 v125, s36, v125
    ds_read_b128 v[96:99], v120 offset:8192
    ds_read_b128 v[100:103], v120 offset:9216
    ds_read_b128 v[104:107], v120 offset:10240
    ds_read_b128 v[108:111], v120 offset:11264
    ds_read_b128 v[112:115], v120 offset:12288
    ds_read_b128 v[116:119], v120 offset:13312
    s_waitcnt vmcnt(6) lgkmcnt(5)
    v_mfma_f32_16x16x32_bf16 v[0:3], v[64:67], v[96:99], v[0:3]
    v_mfma_f32_16x16x32_bf16 v[32:35], v[68:71], v[96:99], v[32:35]
    ds_read_b128 v[96:99], v120 offset:14336
    s_waitcnt vmcnt(4) lgkmcnt(5)
    v_mfma_f32_16x16x32_bf16 v[4:7], v[64:67], v[100:103], v[4:7]
    v_mfma_f32_16x16x32_bf16 v[36:39], v[68:71], v[100:103], v[36:39]
    v_mfma_f32_16x16x32_bf16 v[0:3], v[72:75], v[100:103], v[0:3]
    v_mfma_f32_16x16x32_bf16 v[32:35], v[76:79], v[100:103], v[32:35]
    ds_read_b128 v[100:103], v120 offset:15360
    s_waitcnt vmcnt(2) lgkmcnt(5)
    v_mfma_f32_16x16x32_bf16 v[8:11], v[64:67], v[104:107], v[8:11]
    v_mfma_f32_16x16x32_bf16 v[40:43], v[68:71], v[104:107], v[40:43]
    v_mfma_f32_16x16x32_bf16 v[4:7], v[72:75], v[104:107], v[4:7]
    v_mfma_f32_16x16x32_bf16 v[36:39], v[76:79], v[104:107], v[36:39]
    v_mfma_f32_16x16x32_bf16 v[0:3], v[80:83], v[104:107], v[0:3]
    v_mfma_f32_16x16x32_bf16 v[32:35], v[84:87], v[104:107], v[32:35]
    ds_read_b128 v[104:107], v122 offset:0
    s_waitcnt vmcnt(0) lgkmcnt(5)
    v_mfma_f32_16x16x32_bf16 v[12:15], v[64:67], v[108:111], v[12:15]
    v_mfma_f32_16x16x32_bf16 v[44:47], v[68:71], v[108:111], v[44:47]
    v_mfma_f32_16x16x32_bf16 v[8:11], v[72:75], v[108:111], v[8:11]
    v_mfma_f32_16x16x32_bf16 v[40:43], v[76:79], v[108:111], v[40:43]
    v_mfma_f32_16x16x32_bf16 v[4:7], v[80:83], v[108:111], v[4:7]
    v_mfma_f32_16x16x32_bf16 v[36:39], v[84:87], v[108:111], v[36:39]
    v_mfma_f32_16x16x32_bf16 v[0:3], v[88:91], v[108:111], v[0:3]
    v_mfma_f32_16x16x32_bf16 v[32:35], v[92:95], v[108:111], v[32:35]
    ds_read_b128 v[108:111], v121 offset:9216
    s_waitcnt lgkmcnt(5)
    v_mfma_f32_16x16x32_bf16 v[16:19], v[64:67], v[112:115], v[16:19]
    v_mfma_f32_16x16x32_bf16 v[48:51], v[68:71], v[112:115], v[48:51]
    v_mfma_f32_16x16x32_bf16 v[12:15], v[72:75], v[112:115], v[12:15]
    v_mfma_f32_16x16x32_bf16 v[44:47], v[76:79], v[112:115], v[44:47]
    v_mfma_f32_16x16x32_bf16 v[8:11], v[80:83], v[112:115], v[8:11]
    v_mfma_f32_16x16x32_bf16 v[40:43], v[84:87], v[112:115], v[40:43]
    v_mfma_f32_16x16x32_bf16 v[4:7], v[88:91], v[112:115], v[4:7]
    v_mfma_f32_16x16x32_bf16 v[36:39], v[92:95], v[112:115], v[36:39]
    ds_read_b128 v[112:115], v121 offset:10240
    v_xor_b32 v123, 0, v125
    ds_write_b128 v123, v[0:3]
    s_waitcnt lgkmcnt(6)
    v_mfma_f32_16x16x32_bf16 v[20:23], v[64:67], v[116:119], v[20:23]
    v_mfma_f32_16x16x32_bf16 v[52:55], v[68:71], v[116:119], v[52:55]
    v_mfma_f32_16x16x32_bf16 v[16:19], v[72:75], v[116:119], v[16:19]
    v_mfma_f32_16x16x32_bf16 v[48:51], v[76:79], v[116:119], v[48:51]
    v_mfma_f32_16x16x32_bf16 v[12:15], v[80:83], v[116:119], v[12:15]
    v_mfma_f32_16x16x32_bf16 v[44:47], v[84:87], v[116:119], v[44:47]
    v_mfma_f32_16x16x32_bf16 v[8:11], v[88:91], v[116:119], v[8:11]
    v_mfma_f32_16x16x32_bf16 v[40:43], v[92:95], v[116:119], v[40:43]
    v_xor_b32 v124, 16, v125
    ds_write_b128 v124, v[4:7]
    s_waitcnt lgkmcnt(2)
    v_mfma_f32_16x16x32_bf16 v[24:27], v[64:67], v[96:99], v[24:27]
    v_mfma_f32_16x16x32_bf16 v[56:59], v[68:71], v[96:99], v[56:59]
    v_mfma_f32_16x16x32_bf16 v[20:23], v[72:75], v[96:99], v[20:23]
    v_mfma_f32_16x16x32_bf16 v[52:55], v[76:79], v[96:99], v[52:55]
    v_mfma_f32_16x16x32_bf16 v[16:19], v[80:83], v[96:99], v[16:19]
    v_mfma_f32_16x16x32_bf16 v[48:51], v[84:87], v[96:99], v[48:51]
    v_mfma_f32_16x16x32_bf16 v[12:15], v[88:91], v[96:99], v[12:15]
    v_mfma_f32_16x16x32_bf16 v[44:47], v[92:95], v[96:99], v[44:47]
    v_xor_b32 v123, 32, v125
    ds_write_b128 v123, v[8:11]
    v_xor_b32 v124, 0, v126
    ds_write_b128 v124, v[32:35]
    v_mfma_f32_16x16x32_bf16 v[28:31], v[64:67], v[100:103], v[28:31]
    v_mfma_f32_16x16x32_bf16 v[60:63], v[68:71], v[100:103], v[60:63]
    v_mfma_f32_16x16x32_bf16 v[24:27], v[72:75], v[100:103], v[24:27]
    v_mfma_f32_16x16x32_bf16 v[56:59], v[76:79], v[100:103], v[56:59]
    v_mfma_f32_16x16x32_bf16 v[20:23], v[80:83], v[100:103], v[20:23]
    v_mfma_f32_16x16x32_bf16 v[52:55], v[84:87], v[100:103], v[52:55]
    v_mfma_f32_16x16x32_bf16 v[16:19], v[88:91], v[100:103], v[16:19]
    v_mfma_f32_16x16x32_bf16 v[48:51], v[92:95], v[100:103], v[48:51]
    v_xor_b32 v123, 16, v126
    ds_write_b128 v123, v[36:39]
    v_xor_b32 v124, 32, v126
    ds_write_b128 v124, v[40:43]
    v_mfma_f32_16x16x32_bf16 v[28:31], v[72:75], v[104:107], v[28:31]
    v_mfma_f32_16x16x32_bf16 v[60:63], v[76:79], v[104:107], v[60:63]
    v_mfma_f32_16x16x32_bf16 v[24:27], v[80:83], v[104:107], v[24:27]
    v_mfma_f32_16x16x32_bf16 v[56:59], v[84:87], v[104:107], v[56:59]
    v_mfma_f32_16x16x32_bf16 v[20:23], v[88:91], v[104:107], v[20:23]
    v_mfma_f32_16x16x32_bf16 v[52:55], v[92:95], v[104:107], v[52:55]
    v_xor_b32 v124, 48, v125
    ds_write_b128 v124, v[12:15]
    v_xor_b32 v123, 48, v126
    ds_write_b128 v123, v[44:47]
    v_mfma_f32_16x16x32_bf16 v[28:31], v[80:83], v[108:111], v[28:31]
    v_mfma_f32_16x16x32_bf16 v[60:63], v[84:87], v[108:111], v[60:63]
    v_mfma_f32_16x16x32_bf16 v[24:27], v[88:91], v[108:111], v[24:27]
    v_mfma_f32_16x16x32_bf16 v[56:59], v[92:95], v[108:111], v[56:59]
    v_xor_b32 v123, 64, v125
    ds_write_b128 v123, v[16:19]
    v_xor_b32 v124, 64, v126
    ds_write_b128 v124, v[48:51]
    v_mfma_f32_16x16x32_bf16 v[28:31], v[88:91], v[112:115], v[28:31]
    v_mfma_f32_16x16x32_bf16 v[60:63], v[92:95], v[112:115], v[60:63]
    v_xor_b32 v124, 80, v125
    ds_write_b128 v124, v[20:23]
    v_xor_b32 v123, 80, v126
    ds_write_b128 v123, v[52:55]
    v_and_b32 v108, 15, v127
    v_lshrrev_b32 v109, 4, v127
    v_lshrrev_b32 v110, 3, v108
    s_lshl_b32 s36, s20, 1
    v_add_u32 v110, s36, v110
    v_xor_b32 v111, v110, v108
    v_and_b32 v111, 7, v111
    v_lshlrev_b32 v111, 4, v111
    v_xor_b32 v123, 96, v125
    ds_write_b128 v123, v[24:27]
    v_lshl_add_u32 v111, v110, 7, v111
    v_lshl_add_u32 v120, v109, 11, v111
    v_add_u32 v121, 65536, v120
    v_add_u32 v64, 131072, v120
    s_lshl_b32 s36, s20, 9
    s_add_u32 s36, s36, 115712
    v_lshl_add_u32 v127, v109, 7, s36
    s_lshl_b32 s36, s20, 4
    v_add_u32 v108, s36, v108
    v_lshlrev_b32 v110, 6, v108
    v_lshl_add_u32 v110, v109, 4, v110
    s_mul_i32 s36, s29, 524288
    v_xor_b32 v124, 96, v126
    ds_write_b128 v124, v[56:59]
    s_lshl_b32 s37, s21, 4
    s_add_u32 s36, s36, s37
    v_add_u32 v110, s36, v110
    v_mov_b32 v111, 2130706432
    v_cmp_gt_u32 vcc, 125, v108
    s_mov_b32 s4, 0xbeaaaaab
    s_mov_b32 s5, s4
    s_mov_b32 s6, 0x3e800000
    s_mov_b32 s7, s6
    s_mov_b32 s8, 0xc0a00000
    s_mov_b32 s9, s8
    s_mov_b32 s10, 0xc0638e39
    v_xor_b32 v124, 112, v125
    ds_write_b128 v124, v[28:31]
    s_mov_b32 s11, s10
    s_mov_b32 s12, 0xbf638e39
    s_mov_b32 s13, s12
    s_mov_b32 s14, 0xbe638e39
    s_mov_b32 s15, s14
    s_mov_b32 s22, 0xbd638e39
    s_mov_b32 s23, s22
    s_mov_b32 s24, 0x3ff1c71c
    s_mov_b32 s25, s24
    s_mov_b32 s26, 0xbf2aaaab
    s_mov_b32 s27, s26
    s_mov_b32 s32, 0x3ecccccd
    v_xor_b32 v123, 112, v126
    s_waitcnt lgkmcnt(8)
    ds_write_b128 v123, v[60:63]
    s_mov_b32 s33, s32
    s_mov_b32 s34, 0xbd888889
    s_mov_b32 s35, s34
    s_mov_b32 s38, 0xbe4ccccd
    s_mov_b32 s39, s38
    s_mov_b32 s40, 0xbdd2d3e8
    s_mov_b32 s41, s40
    s_mov_b32 s42, 0x3f800000
    s_mov_b32 s43, s42
    s_setprio 0
    s_branch L_conv1_kernel_epi
L_conv1_kernel_m2:
    s_mul_i32 s37, s38, 2176
    s_add_u32 s37, s37, 98304
    v_add_u32 v116, s37, v8
    v_add_u32 v118, s37, v9
    v_add_u32 v117, 104832, v8
    s_cmp_eq_u32 s38, 0
    s_cbranch_scc1 L_conv1_kernel_hh0
    v_add_u32 v117, 98304, v9
L_conv1_kernel_hh0:
    s_lshl_b32 s37, s38, 12
    s_add_u32 s37, s37, s43
    s_add_u32 s37, s37, 49152
    v_lshl_add_u32 v119, v127, 4, s37
    v_mov_b32 v0, 0
    v_mov_b32 v1, 0
    v_mov_b32 v2, 0
    v_mov_b32 v3, 0
    v_mov_b32 v4, 0
    v_mov_b32 v5, 0
    v_mov_b32 v6, 0
    v_mov_b32 v7, 0
    v_mov_b32 v8, 0
    v_mov_b32 v9, 0
    v_mov_b32 v10, 0
    v_mov_b32 v11, 0
    v_mov_b32 v12, 0
    v_mov_b32 v13, 0
    v_mov_b32 v14, 0
    v_mov_b32 v15, 0
    v_mov_b32 v16, 0
    v_mov_b32 v17, 0
    v_mov_b32 v18, 0
    v_mov_b32 v19, 0
    v_mov_b32 v20, 0
    v_mov_b32 v21, 0
    v_mov_b32 v22, 0
    v_mov_b32 v23, 0
    v_mov_b32 v24, 0
    v_mov_b32 v25, 0
    v_mov_b32 v26, 0
    v_mov_b32 v27, 0
    v_mov_b32 v28, 0
    v_mov_b32 v29, 0
    v_mov_b32 v30, 0
    v_mov_b32 v31, 0
    v_mov_b32 v32, 0
    v_mov_b32 v33, 0
    v_mov_b32 v34, 0
    v_mov_b32 v35, 0
    v_mov_b32 v36, 0
    v_mov_b32 v37, 0
    v_mov_b32 v38, 0
    v_mov_b32 v39, 0
    v_mov_b32 v40, 0
    v_mov_b32 v41, 0
    v_mov_b32 v42, 0
    v_mov_b32 v43, 0
    v_mov_b32 v44, 0
    v_mov_b32 v45, 0
    v_mov_b32 v46, 0
    v_mov_b32 v47, 0
    v_mov_b32 v48, 0
    v_mov_b32 v49, 0
    v_mov_b32 v50, 0
    v_mov_b32 v51, 0
    v_mov_b32 v52, 0
    v_mov_b32 v53, 0
    v_mov_b32 v54, 0
    v_mov_b32 v55, 0
    v_mov_b32 v56, 0
    v_mov_b32 v57, 0
    v_mov_b32 v58, 0
    v_mov_b32 v59, 0
    v_mov_b32 v60, 0
    v_mov_b32 v61, 0
    v_mov_b32 v62, 0
    v_mov_b32 v63, 0
    buffer_load_dwordx4 v[96:99], v108, s[8:11], 0 offen
    buffer_load_dwordx4 v[100:103], v109, s[8:11], 0 offen
    buffer_load_dwordx4 v[104:107], v110, s[8:11], 0 offen
    s_mov_b32 s23, 0
    s_mov_b32 s26, 4096
    buffer_load_dwordx4 v[64:67], v125, s[12:15], s23 offen offset:0
    buffer_load_dwordx4 v[68:71], v125, s[12:15], s23 offen offset:2048
    buffer_load_dwordx4 v[80:83], v119, s[12:15], s23 offen offset:0
    buffer_load_dwordx4 v[72:75], v125, s[12:15], s26 offen offset:0
    buffer_load_dwordx4 v[84:87], v119, s[12:15], s23 offen offset:2048
    buffer_load_dwordx4 v[76:79], v125, s[12:15], s26 offen offset:2048
    s_mov_b32 s23, 57344
    s_mov_b32 s26, 61440
    s_waitcnt vmcnt(6)
    v_lshlrev_b32 v108, 16, v96
    v_and_b32 v111, s25, v96
    v_lshlrev_b32 v109, 16, v100
    v_and_b32 v112, s25, v100
    v_lshlrev_b32 v110, 16, v104
    v_and_b32 v113, s25, v104
    v_mul_f32 v114, s44, v108
    v_mul_f32 v115, s44, v111
    v_fmac_f32 v114, s45, v109
    v_fmac_f32 v115, s45, v112
    v_fmac_f32 v114, s46, v110
    v_fmac_f32 v115, s46, v113
    v_cvt_pk_bf16_f32 v96, v114, v115
    v_lshlrev_b32 v108, 16, v97
    v_and_b32 v111, s25, v97
    v_lshlrev_b32 v109, 16, v101
    v_and_b32 v112, s25, v101
    v_lshlrev_b32 v110, 16, v105
    v_and_b32 v113, s25, v105
    v_mul_f32 v114, s44, v108
    v_mul_f32 v115, s44, v111
    v_fmac_f32 v114, s45, v109
    v_fmac_f32 v115, s45, v112
    v_fmac_f32 v114, s46, v110
    v_fmac_f32 v115, s46, v113
    v_cvt_pk_bf16_f32 v97, v114, v115
    v_lshlrev_b32 v108, 16, v98
    v_and_b32 v111, s25, v98
    v_lshlrev_b32 v109, 16, v102
    v_and_b32 v112, s25, v102
    v_lshlrev_b32 v110, 16, v106
    v_and_b32 v113, s25, v106
    v_mul_f32 v114, s44, v108
    v_mul_f32 v115, s44, v111
    v_fmac_f32 v114, s45, v109
    v_fmac_f32 v115, s45, v112
    v_fmac_f32 v114, s46, v110
    v_fmac_f32 v115, s46, v113
    v_cvt_pk_bf16_f32 v98, v114, v115
    v_lshlrev_b32 v108, 16, v99
    v_and_b32 v111, s25, v99
    v_lshlrev_b32 v109, 16, v103
    v_and_b32 v112, s25, v103
    v_lshlrev_b32 v110, 16, v107
    v_and_b32 v113, s25, v107
    v_mul_f32 v114, s44, v108
    v_mul_f32 v115, s44, v111
    v_fmac_f32 v114, s45, v109
    v_fmac_f32 v115, s45, v112
    v_fmac_f32 v114, s46, v110
    v_fmac_f32 v115, s46, v113
    v_cvt_pk_bf16_f32 v99, v114, v115
    ds_write_b128 v126, v[96:99]
    v_and_b32 v111, 15, v127
    v_lshlrev_b32 v111, 2, v111
    v_add_u32 v111, 99328, v111
    ds_write_b32 v111, v0
    ds_write_b32 v111, v0 offset:8704
    s_waitcnt lgkmcnt(0)
    s_barrier
    s_mov_b32 s22, 8
    s_setprio 2
L_conv1_kernel_mloop2:
    ds_read_b128 v[88:91], v120 offset:0
    ds_read_b128 v[92:95], v120 offset:1024
    ds_read_b128 v[96:99], v116 offset:0
    ds_read_b128 v[100:103], v120 offset:2048
    ds_read_b128 v[104:107], v116 offset:1088
    ds_read_b128 v[108:111], v120 offset:3072
    ds_read_b128 v[112:115], v116 offset:2176
    s_waitcnt vmcnt(5) lgkmcnt(6)
    v_mfma_f32_16x16x32_bf16 v[0:3], v[64:67], v[88:91], v[0:3]
    ds_read_b128 v[88:91], v120 offset:4096
    s_waitcnt vmcnt(4) lgkmcnt(6)
    v_mfma_f32_16x16x32_bf16 v[4:7], v[64:67], v[92:95], v[4:7]
    v_mfma_f32_16x16x32_bf16 v[0:3], v[68:71], v[92:95], v[0:3]
    ds_read_b128 v[92:95], v116 offset:3264
    s_waitcnt vmcnt(3) lgkmcnt(6)
    v_mfma_f32_16x16x32_bf16 v[32:35], v[80:83], v[96:99], v[32:35]
    ds_read_b128 v[96:99], v120 offset:5120
    s_waitcnt vmcnt(2) lgkmcnt(6)
    v_mfma_f32_16x16x32_bf16 v[8:11], v[64:67], v[100:103], v[8:11]
    v_mfma_f32_16x16x32_bf16 v[4:7], v[68:71], v[100:103], v[4:7]
    v_mfma_f32_16x16x32_bf16 v[0:3], v[72:75], v[100:103], v[0:3]
    ds_read_b128 v[100:103], v116 offset:4352
    s_waitcnt vmcnt(1) lgkmcnt(6)
    v_mfma_f32_16x16x32_bf16 v[36:39], v[80:83], v[104:107], v[36:39]
    v_mfma_f32_16x16x32_bf16 v[32:35], v[84:87], v[104:107], v[32:35]
    ds_read_b128 v[104:107], v120 offset:6144
    s_waitcnt vmcnt(0) lgkmcnt(6)
    v_mfma_f32_16x16x32_bf16 v[12:15], v[64:67], v[108:111], v[12:15]
    v_mfma_f32_16x16x32_bf16 v[8:11], v[68:71], v[108:111], v[8:11]
    v_mfma_f32_16x16x32_bf16 v[4:7], v[72:75], v[108:111], v[4:7]
    v_mfma_f32_16x16x32_bf16 v[0:3], v[76:79], v[108:111], v[0:3]
    ds_read_b128 v[108:111], v116 offset:5440
    s_waitcnt lgkmcnt(6)
    v_mfma_f32_16x16x32_bf16 v[40:43], v[80:83], v[112:115], v[40:43]
    v_mfma_f32_16x16x32_bf16 v[36:39], v[84:87], v[112:115], v[36:39]
    ds_read_b128 v[112:115], v120 offset:7168
    s_waitcnt lgkmcnt(6)
    v_mfma_f32_16x16x32_bf16 v[16:19], v[64:67], v[88:91], v[16:19]
    v_mfma_f32_16x16x32_bf16 v[12:15], v[68:71], v[88:91], v[12:15]
    v_mfma_f32_16x16x32_bf16 v[8:11], v[72:75], v[88:91], v[8:11]
    v_mfma_f32_16x16x32_bf16 v[4:7], v[76:79], v[88:91], v[4:7]
    ds_read_b128 v[88:91], v117 offset:0
    s_waitcnt lgkmcnt(6)
    v_mfma_f32_16x16x32_bf16 v[44:47], v[80:83], v[92:95], v[44:47]
    v_mfma_f32_16x16x32_bf16 v[40:43], v[84:87], v[92:95], v[40:43]
    ds_read_b128 v[92:95], v122 offset:0
    v_add_u32 v122, v123, v122
    s_waitcnt lgkmcnt(6)
    v_mfma_f32_16x16x32_bf16 v[20:23], v[64:67], v[96:99], v[20:23]
    v_mfma_f32_16x16x32_bf16 v[16:19], v[68:71], v[96:99], v[16:19]
    v_mfma_f32_16x16x32_bf16 v[12:15], v[72:75], v[96:99], v[12:15]
    v_mfma_f32_16x16x32_bf16 v[8:11], v[76:79], v[96:99], v[8:11]
    ds_read_b128 v[96:99], v117 offset:1088
    s_waitcnt lgkmcnt(6)
    v_mfma_f32_16x16x32_bf16 v[48:51], v[80:83], v[100:103], v[48:51]
    v_mfma_f32_16x16x32_bf16 v[44:47], v[84:87], v[100:103], v[44:47]
    ds_read_b128 v[100:103], v121 offset:1024
    s_waitcnt lgkmcnt(6)
    v_mfma_f32_16x16x32_bf16 v[24:27], v[64:67], v[104:107], v[24:27]
    v_mfma_f32_16x16x32_bf16 v[20:23], v[68:71], v[104:107], v[20:23]
    v_mfma_f32_16x16x32_bf16 v[16:19], v[72:75], v[104:107], v[16:19]
    v_mfma_f32_16x16x32_bf16 v[12:15], v[76:79], v[104:107], v[12:15]
    ds_read_b128 v[104:107], v118 offset:0
    s_waitcnt lgkmcnt(6)
    v_mfma_f32_16x16x32_bf16 v[52:55], v[80:83], v[108:111], v[52:55]
    v_mfma_f32_16x16x32_bf16 v[48:51], v[84:87], v[108:111], v[48:51]
    ds_read_b128 v[108:111], v121 offset:2048
    s_waitcnt lgkmcnt(6)
    v_mfma_f32_16x16x32_bf16 v[28:31], v[64:67], v[112:115], v[28:31]
    v_mfma_f32_16x16x32_bf16 v[24:27], v[68:71], v[112:115], v[24:27]
    v_mfma_f32_16x16x32_bf16 v[20:23], v[72:75], v[112:115], v[20:23]
    v_mfma_f32_16x16x32_bf16 v[16:19], v[76:79], v[112:115], v[16:19]
    buffer_load_dwordx4 v[64:67], v125, s[12:15], s23 offen offset:0
    s_waitcnt lgkmcnt(5)
    v_mfma_f32_16x16x32_bf16 v[56:59], v[80:83], v[88:91], v[56:59]
    v_mfma_f32_16x16x32_bf16 v[52:55], v[84:87], v[88:91], v[52:55]
    s_waitcnt lgkmcnt(0)
    s_barrier
    v_mfma_f32_16x16x32_bf16 v[28:31], v[68:71], v[92:95], v[28:31]
    v_mfma_f32_16x16x32_bf16 v[24:27], v[72:75], v[92:95], v[24:27]
    v_mfma_f32_16x16x32_bf16 v[20:23], v[76:79], v[92:95], v[20:23]
    buffer_load_dwordx4 v[68:71], v125, s[12:15], s23 offen offset:2048
    v_mfma_f32_16x16x32_bf16 v[60:63], v[80:83], v[96:99], v[60:63]
    v_mfma_f32_16x16x32_bf16 v[56:59], v[84:87], v[96:99], v[56:59]
    buffer_load_dwordx4 v[80:83], v119, s[12:15], s23 offen offset:0
    v_mfma_f32_16x16x32_bf16 v[28:31], v[72:75], v[100:103], v[28:31]
    v_mfma_f32_16x16x32_bf16 v[24:27], v[76:79], v[100:103], v[24:27]
    buffer_load_dwordx4 v[72:75], v125, s[12:15], s26 offen offset:0
    v_mfma_f32_16x16x32_bf16 v[60:63], v[84:87], v[104:107], v[60:63]
    buffer_load_dwordx4 v[84:87], v119, s[12:15], s23 offen offset:2048
    v_mfma_f32_16x16x32_bf16 v[28:31], v[76:79], v[108:111], v[28:31]
    buffer_load_dwordx4 v[76:79], v125, s[12:15], s26 offen offset:2048
    s_add_u32 s23, s23, 57344
    s_add_u32 s26, s26, 57344
    s_sub_u32 s22, s22, 1
    s_cmp_eq_u32 s22, 0
    s_cbranch_scc1 L_conv1_kernel_mlast2
    ds_read_b128 v[88:91], v120 offset:8192
    ds_read_b128 v[92:95], v120 offset:9216
    ds_read_b128 v[96:99], v116 offset:8704
    ds_read_b128 v[100:103], v120 offset:10240
    ds_read_b128 v[104:107], v116 offset:9792
    ds_read_b128 v[108:111], v120 offset:11264
    ds_read_b128 v[112:115], v116 offset:10880
    s_waitcnt vmcnt(5) lgkmcnt(6)
    v_mfma_f32_16x16x32_bf16 v[0:3], v[64:67], v[88:91], v[0:3]
    ds_read_b128 v[88:91], v120 offset:12288
    s_waitcnt vmcnt(4) lgkmcnt(6)
    v_mfma_f32_16x16x32_bf16 v[4:7], v[64:67], v[92:95], v[4:7]
    v_mfma_f32_16x16x32_bf16 v[0:3], v[68:71], v[92:95], v[0:3]
    ds_read_b128 v[92:95], v116 offset:11968
    s_waitcnt vmcnt(3) lgkmcnt(6)
    v_mfma_f32_16x16x32_bf16 v[32:35], v[80:83], v[96:99], v[32:35]
    ds_read_b128 v[96:99], v120 offset:13312
    s_waitcnt vmcnt(2) lgkmcnt(6)
    v_mfma_f32_16x16x32_bf16 v[8:11], v[64:67], v[100:103], v[8:11]
    v_mfma_f32_16x16x32_bf16 v[4:7], v[68:71], v[100:103], v[4:7]
    v_mfma_f32_16x16x32_bf16 v[0:3], v[72:75], v[100:103], v[0:3]
    ds_read_b128 v[100:103], v116 offset:13056
    s_waitcnt vmcnt(1) lgkmcnt(6)
    v_mfma_f32_16x16x32_bf16 v[36:39], v[80:83], v[104:107], v[36:39]
    v_mfma_f32_16x16x32_bf16 v[32:35], v[84:87], v[104:107], v[32:35]
    ds_read_b128 v[104:107], v120 offset:14336
    s_waitcnt vmcnt(0) lgkmcnt(6)
    v_mfma_f32_16x16x32_bf16 v[12:15], v[64:67], v[108:111], v[12:15]
    v_mfma_f32_16x16x32_bf16 v[8:11], v[68:71], v[108:111], v[8:11]
    v_mfma_f32_16x16x32_bf16 v[4:7], v[72:75], v[108:111], v[4:7]
    v_mfma_f32_16x16x32_bf16 v[0:3], v[76:79], v[108:111], v[0:3]
    ds_read_b128 v[108:111], v116 offset:14144
    s_waitcnt lgkmcnt(6)
    v_mfma_f32_16x16x32_bf16 v[40:43], v[80:83], v[112:115], v[40:43]
    v_mfma_f32_16x16x32_bf16 v[36:39], v[84:87], v[112:115], v[36:39]
    ds_read_b128 v[112:115], v120 offset:15360
    s_waitcnt lgkmcnt(6)
    v_mfma_f32_16x16x32_bf16 v[16:19], v[64:67], v[88:91], v[16:19]
    v_mfma_f32_16x16x32_bf16 v[12:15], v[68:71], v[88:91], v[12:15]
    v_mfma_f32_16x16x32_bf16 v[8:11], v[72:75], v[88:91], v[8:11]
    v_mfma_f32_16x16x32_bf16 v[4:7], v[76:79], v[88:91], v[4:7]
    ds_read_b128 v[88:91], v117 offset:8704
    s_waitcnt lgkmcnt(6)
    v_mfma_f32_16x16x32_bf16 v[44:47], v[80:83], v[92:95], v[44:47]
    v_mfma_f32_16x16x32_bf16 v[40:43], v[84:87], v[92:95], v[40:43]
    ds_read_b128 v[92:95], v122 offset:0
    v_add_u32 v122, v124, v122
    s_waitcnt lgkmcnt(6)
    v_mfma_f32_16x16x32_bf16 v[20:23], v[64:67], v[96:99], v[20:23]
    v_mfma_f32_16x16x32_bf16 v[16:19], v[68:71], v[96:99], v[16:19]
    v_mfma_f32_16x16x32_bf16 v[12:15], v[72:75], v[96:99], v[12:15]
    v_mfma_f32_16x16x32_bf16 v[8:11], v[76:79], v[96:99], v[8:11]
    ds_read_b128 v[96:99], v117 offset:9792
    s_waitcnt lgkmcnt(6)
    v_mfma_f32_16x16x32_bf16 v[48:51], v[80:83], v[100:103], v[48:51]
    v_mfma_f32_16x16x32_bf16 v[44:47], v[84:87], v[100:103], v[44:47]
    ds_read_b128 v[100:103], v121 offset:9216
    s_waitcnt lgkmcnt(6)
    v_mfma_f32_16x16x32_bf16 v[24:27], v[64:67], v[104:107], v[24:27]
    v_mfma_f32_16x16x32_bf16 v[20:23], v[68:71], v[104:107], v[20:23]
    v_mfma_f32_16x16x32_bf16 v[16:19], v[72:75], v[104:107], v[16:19]
    v_mfma_f32_16x16x32_bf16 v[12:15], v[76:79], v[104:107], v[12:15]
    ds_read_b128 v[104:107], v118 offset:8704
    s_waitcnt lgkmcnt(6)
    v_mfma_f32_16x16x32_bf16 v[52:55], v[80:83], v[108:111], v[52:55]
    v_mfma_f32_16x16x32_bf16 v[48:51], v[84:87], v[108:111], v[48:51]
    ds_read_b128 v[108:111], v121 offset:10240
    s_waitcnt lgkmcnt(6)
    v_mfma_f32_16x16x32_bf16 v[28:31], v[64:67], v[112:115], v[28:31]
    v_mfma_f32_16x16x32_bf16 v[24:27], v[68:71], v[112:115], v[24:27]
    v_mfma_f32_16x16x32_bf16 v[20:23], v[72:75], v[112:115], v[20:23]
    v_mfma_f32_16x16x32_bf16 v[16:19], v[76:79], v[112:115], v[16:19]
    buffer_load_dwordx4 v[64:67], v125, s[12:15], s23 offen offset:0
    s_waitcnt lgkmcnt(5)
    v_mfma_f32_16x16x32_bf16 v[56:59], v[80:83], v[88:91], v[56:59]
    v_mfma_f32_16x16x32_bf16 v[52:55], v[84:87], v[88:91], v[52:55]
    s_waitcnt lgkmcnt(0)
    s_barrier
    v_mfma_f32_16x16x32_bf16 v[28:31], v[68:71], v[92:95], v[28:31]
    v_mfma_f32_16x16x32_bf16 v[24:27], v[72:75], v[92:95], v[24:27]
    v_mfma_f32_16x16x32_bf16 v[20:23], v[76:79], v[92:95], v[20:23]
    buffer_load_dwordx4 v[68:71], v125, s[12:15], s23 offen offset:2048
    v_mfma_f32_16x16x32_bf16 v[60:63], v[80:83], v[96:99], v[60:63]
    v_mfma_f32_16x16x32_bf16 v[56:59], v[84:87], v[96:99], v[56:59]
    buffer_load_dwordx4 v[80:83], v119, s[12:15], s23 offen offset:0
    v_mfma_f32_16x16x32_bf16 v[28:31], v[72:75], v[100:103], v[28:31]
    v_mfma_f32_16x16x32_bf16 v[24:27], v[76:79], v[100:103], v[24:27]
    buffer_load_dwordx4 v[72:75], v125, s[12:15], s26 offen offset:0
    v_mfma_f32_16x16x32_bf16 v[60:63], v[84:87], v[104:107], v[60:63]
    buffer_load_dwordx4 v[84:87], v119, s[12:15], s23 offen offset:2048
    v_mfma_f32_16x16x32_bf16 v[28:31], v[76:79], v[108:111], v[28:31]
    buffer_load_dwordx4 v[76:79], v125, s[12:15], s26 offen offset:2048
    s_add_u32 s23, s23, 57344
    s_add_u32 s26, s26, 57344
    s_branch L_conv1_kernel_mloop2
L_conv1_kernel_mlast2:
    v_and_b32 v125, 15, v127
    v_and_b32 v126, 7, v127
    v_lshlrev_b32 v126, 4, v126
    v_lshl_add_u32 v125, v125, 7, v126
    v_lshrrev_b32 v126, 4, v127
    v_lshl_add_u32 v125, v126, 11, v125
    s_mov_b32 s36, 65536
    s_cmp_eq_u32 s32, 1
    s_cselect_b32 s36, 121856, s36
    s_cmp_eq_u32 s32, 2
    s_cselect_b32 s36, 81920, s36
    s_cmp_eq_u32 s32, 3
    s_cselect_b32 s36, 130048, s36
    s_mov_b32 s37, 98304
    s_cmp_eq_u32 s32, 1
    s_cselect_b32 s37, 138240, s37
    s_cmp_eq_u32 s32, 2
    s_cselect_b32 s37, 146432, s37
    s_cmp_eq_u32 s32, 3
    s_cselect_b32 s37, 154624, s37
    v_add_u32 v126, s37, v125
    v_add_u32 v125, s36, v125
    ds_read_b128 v[88:91], v120 offset:8192
    ds_read_b128 v[92:95], v120 offset:9216
    ds_read_b128 v[96:99], v116 offset:8704
    ds_read_b128 v[100:103], v120 offset:10240
    ds_read_b128 v[104:107], v116 offset:9792
    ds_read_b128 v[108:111], v120 offset:11264
    ds_read_b128 v[112:115], v116 offset:10880
    s_waitcnt vmcnt(5) lgkmcnt(6)
    v_mfma_f32_16x16x32_bf16 v[0:3], v[64:67], v[88:91], v[0:3]
    ds_read_b128 v[88:91], v120 offset:12288
    s_waitcnt vmcnt(4) lgkmcnt(6)
    v_mfma_f32_16x16x32_bf16 v[4:7], v[64:67], v[92:95], v[4:7]
    v_mfma_f32_16x16x32_bf16 v[0:3], v[68:71], v[92:95], v[0:3]
    ds_read_b128 v[92:95], v116 offset:11968
    s_waitcnt vmcnt(3) lgkmcnt(6)
    v_mfma_f32_16x16x32_bf16 v[32:35], v[80:83], v[96:99], v[32:35]
    ds_read_b128 v[96:99], v120 offset:13312
    s_waitcnt vmcnt(2) lgkmcnt(6)
    v_mfma_f32_16x16x32_bf16 v[8:11], v[64:67], v[100:103], v[8:11]
    v_mfma_f32_16x16x32_bf16 v[4:7], v[68:71], v[100:103], v[4:7]
    v_mfma_f32_16x16x32_bf16 v[0:3], v[72:75], v[100:103], v[0:3]
    ds_read_b128 v[100:103], v116 offset:13056
    s_waitcnt vmcnt(1) lgkmcnt(6)
    v_mfma_f32_16x16x32_bf16 v[36:39], v[80:83], v[104:107], v[36:39]
    v_mfma_f32_16x16x32_bf16 v[32:35], v[84:87], v[104:107], v[32:35]
    ds_read_b128 v[104:107], v120 offset:14336
    s_waitcnt vmcnt(0) lgkmcnt(6)
    v_mfma_f32_16x16x32_bf16 v[12:15], v[64:67], v[108:111], v[12:15]
    v_mfma_f32_16x16x32_bf16 v[8:11], v[68:71], v[108:111], v[8:11]
    v_mfma_f32_16x16x32_bf16 v[4:7], v[72:75], v[108:111], v[4:7]
    v_mfma_f32_16x16x32_bf16 v[0:3], v[76:79], v[108:111], v[0:3]
    ds_read_b128 v[108:111], v116 offset:14144
    s_waitcnt lgkmcnt(6)
    v_mfma_f32_16x16x32_bf16 v[40:43], v[80:83], v[112:115], v[40:43]
    v_mfma_f32_16x16x32_bf16 v[36:39], v[84:87], v[112:115], v[36:39]
    ds_read_b128 v[112:115], v120 offset:15360
    s_waitcnt lgkmcnt(6)
    v_mfma_f32_16x16x32_bf16 v[16:19], v[64:67], v[88:91], v[16:19]
    v_mfma_f32_16x16x32_bf16 v[12:15], v[68:71], v[88:91], v[12:15]
    v_mfma_f32_16x16x32_bf16 v[8:11], v[72:75], v[88:91], v[8:11]
    v_mfma_f32_16x16x32_bf16 v[4:7], v[76:79], v[88:91], v[4:7]
    ds_read_b128 v[88:91], v117 offset:8704
    v_xor_b32 v124, 0, v126
    ds_write_b128 v124, v[32:35]
    s_waitcnt lgkmcnt(7)
    v_mfma_f32_16x16x32_bf16 v[44:47], v[80:83], v[92:95], v[44:47]
    v_mfma_f32_16x16x32_bf16 v[40:43], v[84:87], v[92:95], v[40:43]
    ds_read_b128 v[92:95], v122 offset:0
    v_xor_b32 v123, 0, v125
    ds_write_b128 v123, v[0:3]
    s_waitcnt lgkmcnt(8)
    v_mfma_f32_16x16x32_bf16 v[20:23], v[64:67], v[96:99], v[20:23]
    v_mfma_f32_16x16x32_bf16 v[16:19], v[68:71], v[96:99], v[16:19]
    v_mfma_f32_16x16x32_bf16 v[12:15], v[72:75], v[96:99], v[12:15]
    v_mfma_f32_16x16x32_bf16 v[8:11], v[76:79], v[96:99], v[8:11]
    ds_read_b128 v[96:99], v117 offset:9792
    v_xor_b32 v123, 16, v126
    ds_write_b128 v123, v[36:39]
    s_waitcnt lgkmcnt(9)
    v_mfma_f32_16x16x32_bf16 v[48:51], v[80:83], v[100:103], v[48:51]
    v_mfma_f32_16x16x32_bf16 v[44:47], v[84:87], v[100:103], v[44:47]
    ds_read_b128 v[100:103], v121 offset:9216
    v_xor_b32 v124, 16, v125
    ds_write_b128 v124, v[4:7]
    s_waitcnt lgkmcnt(10)
    v_mfma_f32_16x16x32_bf16 v[24:27], v[64:67], v[104:107], v[24:27]
    v_mfma_f32_16x16x32_bf16 v[20:23], v[68:71], v[104:107], v[20:23]
    v_mfma_f32_16x16x32_bf16 v[16:19], v[72:75], v[104:107], v[16:19]
    v_mfma_f32_16x16x32_bf16 v[12:15], v[76:79], v[104:107], v[12:15]
    ds_read_b128 v[104:107], v118 offset:8704
    v_xor_b32 v124, 32, v126
    ds_write_b128 v124, v[40:43]
    s_waitcnt lgkmcnt(11)
    v_mfma_f32_16x16x32_bf16 v[52:55], v[80:83], v[108:111], v[52:55]
    v_mfma_f32_16x16x32_bf16 v[48:51], v[84:87], v[108:111], v[48:51]
    ds_read_b128 v[108:111], v121 offset:10240
    v_xor_b32 v123, 32, v125
    ds_write_b128 v123, v[8:11]
    s_waitcnt lgkmcnt(12)
    v_mfma_f32_16x16x32_bf16 v[28:31], v[64:67], v[112:115], v[28:31]
    v_mfma_f32_16x16x32_bf16 v[24:27], v[68:71], v[112:115], v[24:27]
    v_mfma_f32_16x16x32_bf16 v[20:23], v[72:75], v[112:115], v[20:23]
    v_mfma_f32_16x16x32_bf16 v[16:19], v[76:79], v[112:115], v[16:19]
    v_xor_b32 v123, 48, v126
    ds_write_b128 v123, v[44:47]
    s_waitcnt lgkmcnt(12)
    v_mfma_f32_16x16x32_bf16 v[56:59], v[80:83], v[88:91], v[56:59]
    v_mfma_f32_16x16x32_bf16 v[52:55], v[84:87], v[88:91], v[52:55]
    v_xor_b32 v124, 48, v125
    ds_write_b128 v124, v[12:15]
    s_waitcnt lgkmcnt(11)
    v_mfma_f32_16x16x32_bf16 v[28:31], v[68:71], v[92:95], v[28:31]
    v_mfma_f32_16x16x32_bf16 v[24:27], v[72:75], v[92:95], v[24:27]
    v_mfma_f32_16x16x32_bf16 v[20:23], v[76:79], v[92:95], v[20:23]
    v_xor_b32 v124, 64, v126
    ds_write_b128 v124, v[48:51]
    s_waitcnt lgkmcnt(10)
    v_mfma_f32_16x16x32_bf16 v[60:63], v[80:83], v[96:99], v[60:63]
    v_mfma_f32_16x16x32_bf16 v[56:59], v[84:87], v[96:99], v[56:59]
    v_xor_b32 v123, 64, v125
    ds_write_b128 v123, v[16:19]
    s_waitcnt lgkmcnt(9)
    v_mfma_f32_16x16x32_bf16 v[28:31], v[72:75], v[100:103], v[28:31]
    v_mfma_f32_16x16x32_bf16 v[24:27], v[76:79], v[100:103], v[24:27]
    v_xor_b32 v123, 80, v126
    ds_write_b128 v123, v[52:55]
    s_waitcnt lgkmcnt(8)
    v_mfma_f32_16x16x32_bf16 v[60:63], v[84:87], v[104:107], v[60:63]
    v_xor_b32 v124, 80, v125
    ds_write_b128 v124, v[20:23]
    s_waitcnt lgkmcnt(7)
    v_mfma_f32_16x16x32_bf16 v[28:31], v[76:79], v[108:111], v[28:31]
    v_xor_b32 v124, 96, v126
    ds_write_b128 v124, v[56:59]
    v_and_b32 v108, 15, v127
    v_lshrrev_b32 v109, 4, v127
    v_lshrrev_b32 v110, 3, v108
    s_lshl_b32 s36, s20, 1
    v_add_u32 v110, s36, v110
    v_xor_b32 v111, v110, v108
    v_and_b32 v111, 7, v111
    v_lshlrev_b32 v111, 4, v111
    v_xor_b32 v123, 96, v125
    ds_write_b128 v123, v[24:27]
    v_lshl_add_u32 v111, v110, 7, v111
    v_lshl_add_u32 v120, v109, 11, v111
    v_add_u32 v121, 65536, v120
    v_add_u32 v64, 131072, v120
    s_lshl_b32 s36, s20, 9
    s_add_u32 s36, s36, 115712
    v_lshl_add_u32 v127, v109, 7, s36
    s_lshl_b32 s36, s20, 4
    v_add_u32 v108, s36, v108
    v_lshlrev_b32 v110, 6, v108
    v_lshl_add_u32 v110, v109, 4, v110
    s_mul_i32 s36, s29, 524288
    v_xor_b32 v123, 112, v126
    ds_write_b128 v123, v[60:63]
    s_lshl_b32 s37, s21, 4
    s_add_u32 s36, s36, s37
    v_add_u32 v110, s36, v110
    v_mov_b32 v111, 2130706432
    v_cmp_gt_u32 vcc, 125, v108
    s_mov_b32 s4, 0xbeaaaaab
    s_mov_b32 s5, s4
    s_mov_b32 s6, 0x3e800000
    s_mov_b32 s7, s6
    s_mov_b32 s8, 0xc0a00000
    s_mov_b32 s9, s8
    s_mov_b32 s10, 0xc0638e39
    v_xor_b32 v124, 112, v125
    ds_write_b128 v124, v[28:31]
    s_mov_b32 s11, s10
    s_mov_b32 s12, 0xbf638e39
    s_mov_b32 s13, s12
    s_mov_b32 s14, 0xbe638e39
    s_mov_b32 s15, s14
    s_mov_b32 s22, 0xbd638e39
    s_mov_b32 s23, s22
    s_mov_b32 s24, 0x3ff1c71c
    s_mov_b32 s25, s24
    s_mov_b32 s26, 0xbf2aaaab
    s_mov_b32 s27, s26
    s_mov_b32 s32, 0x3ecccccd
    s_mov_b32 s33, s32
    s_mov_b32 s34, 0xbd888889
    s_mov_b32 s35, s34
    s_mov_b32 s38, 0xbe4ccccd
    s_mov_b32 s39, s38
    s_mov_b32 s40, 0xbdd2d3e8
    s_mov_b32 s41, s40
    s_mov_b32 s42, 0x3f800000
    s_mov_b32 s43, s42
    s_setprio 0
    s_branch L_conv1_kernel_epi
L_conv1_kernel_helper:
    s_setprio 3
    v_add_u32 v92, 0, v7
    v_add_u32 v93, 1024, v7
    v_add_u32 v94, 2048, v7
    v_add_u32 v95, 3072, v7
    v_and_b32 v76, 4, v5
    v_lshrrev_b32 v76, 1, v76
    v_xor_b32 v76, v6, v76
    v_lshlrev_b32 v76, 4, v76
    v_lshl_add_u32 v76, v5, 6, v76
    s_mov_b32 s24, 0
    s_mov_b32 s27, 524288
    s_waitcnt lgkmcnt(0)
    s_add_u32 s8, s4, s47
    s_addc_u32 s9, s5, 0
    buffer_load_dwordx4 v[0:3], v92, s[8:11], s24 offen offset:0
    buffer_load_dwordx4 v[16:19], v92, s[8:11], s24 offen offset:64
    v_add_u32 v92, 128, v92
    buffer_load_dwordx4 v[4:7], v93, s[8:11], s24 offen offset:0
    buffer_load_dwordx4 v[20:23], v93, s[8:11], s24 offen offset:64
    v_add_u32 v93, 128, v93
    buffer_load_dwordx4 v[8:11], v94, s[8:11], s24 offen offset:0
    buffer_load_dwordx4 v[24:27], v94, s[8:11], s24 offen offset:64
    v_add_u32 v94, 128, v94
    buffer_load_dwordx4 v[12:15], v95, s[8:11], s24 offen offset:0
    buffer_load_dwordx4 v[28:31], v95, s[8:11], s24 offen offset:64
    v_add_u32 v95, 128, v95
    s_mul_i32 s36, s42, 1024
    v_add_u32 v96, s36, v76
    v_add_u32 v97, 65536, v96
    s_mul_i32 s36, s42, 1088
    s_add_u32 s36, s36, 98304
    v_add_u32 v98, s36, v76
    s_waitcnt vmcnt(0)
    s_mov_b32 s28, 0
    s_mov_b32 s22, 4
    s_cmp_ge_u32 s20, 12
    s_cbranch_scc1 L_conv1_kernel_h2
    ds_write_b128 v96, v[0:3] offset:0
    ds_write_b128 v98, v[12:15] offset:0
    v_lshlrev_b32 v76, 16, v0
    v_and_b32 v84, s25, v0
    v_lshlrev_b32 v77, 16, v4
    v_and_b32 v85, s25, v4
    v_lshlrev_b32 v78, 16, v8
    v_and_b32 v86, s25, v8
    v_lshlrev_b32 v79, 16, v12
    v_and_b32 v87, s25, v12
    v_add_f32 v80, v76, v78
    v_add_f32 v88, v84, v86
    v_add_f32 v81, v77, v79
    v_add_f32 v89, v85, v87
    v_fma_f32 v82, v78, 4.0, v76
    v_fma_f32 v90, v86, 4.0, v84
    v_fma_f32 v83, v79, 4.0, v77
    v_fma_f32 v91, v87, 4.0, v85
    v_add_f32 v77, v80, v81
    v_add_f32 v85, v88, v89
    v_sub_f32 v78, v80, v81
    v_sub_f32 v86, v88, v89
    v_fma_f32 v79, v83, 2.0, v82
    v_fma_f32 v87, v91, 2.0, v90
    v_fma_f32 v82, v83, -2.0, v82
    v_fma_f32 v90, v91, -2.0, v90
    v_fmamk_f32 v80, v76, 0x41700000, v82
    v_fmamk_f32 v88, v84, 0x41700000, v90
    v_fmamk_f32 v80, v81, 0x41200000, v80
    v_fmamk_f32 v88, v89, 0x41200000, v88
    v_cvt_pk_bf16_f32 v4, v77, v85
    v_cvt_pk_bf16_f32 v8, v78, v86
    v_cvt_pk_bf16_f32 v64, v79, v87
    v_cvt_pk_bf16_f32 v68, v82, v90
    v_cvt_pk_bf16_f32 v72, v80, v88
    v_lshlrev_b32 v76, 16, v1
    v_and_b32 v84, s25, v1
    v_lshlrev_b32 v77, 16, v5
    v_and_b32 v85, s25, v5
    v_lshlrev_b32 v78, 16, v9
    v_and_b32 v86, s25, v9
    v_lshlrev_b32 v79, 16, v13
    v_and_b32 v87, s25, v13
    v_add_f32 v80, v76, v78
    v_add_f32 v88, v84, v86
    v_add_f32 v81, v77, v79
    v_add_f32 v89, v85, v87
    v_fma_f32 v82, v78, 4.0, v76
    v_fma_f32 v90, v86, 4.0, v84
    v_fma_f32 v83, v79, 4.0, v77
    v_fma_f32 v91, v87, 4.0, v85
    v_add_f32 v77, v80, v81
    v_add_f32 v85, v88, v89
    v_sub_f32 v78, v80, v81
    v_sub_f32 v86, v88, v89
    v_fma_f32 v79, v83, 2.0, v82
    v_fma_f32 v87, v91, 2.0, v90
    v_fma_f32 v82, v83, -2.0, v82
    v_fma_f32 v90, v91, -2.0, v90
    v_fmamk_f32 v80, v76, 0x41700000, v82
    v_fmamk_f32 v88, v84, 0x41700000, v90
    v_fmamk_f32 v80, v81, 0x41200000, v80
    v_fmamk_f32 v88, v89, 0x41200000, v88
    v_cvt_pk_bf16_f32 v5, v77, v85
    v_cvt_pk_bf16_f32 v9, v78, v86
    v_cvt_pk_bf16_f32 v65, v79, v87
    v_cvt_pk_bf16_f32 v69, v82, v90
    v_cvt_pk_bf16_f32 v73, v80, v88
    v_lshlrev_b32 v76, 16, v2
    v_and_b32 v84, s25, v2
    v_lshlrev_b32 v77, 16, v6
    v_and_b32 v85, s25, v6
    v_lshlrev_b32 v78, 16, v10
    v_and_b32 v86, s25, v10
    v_lshlrev_b32 v79, 16, v14
    v_and_b32 v87, s25, v14
    v_add_f32 v80, v76, v78
    v_add_f32 v88, v84, v86
    v_add_f32 v81, v77, v79
    v_add_f32 v89, v85, v87
    v_fma_f32 v82, v78, 4.0, v76
    v_fma_f32 v90, v86, 4.0, v84
    v_fma_f32 v83, v79, 4.0, v77
    v_fma_f32 v91, v87, 4.0, v85
    v_add_f32 v77, v80, v81
    v_add_f32 v85, v88, v89
    v_sub_f32 v78, v80, v81
    v_sub_f32 v86, v88, v89
    v_fma_f32 v79, v83, 2.0, v82
    v_fma_f32 v87, v91, 2.0, v90
    v_fma_f32 v82, v83, -2.0, v82
    v_fma_f32 v90, v91, -2.0, v90
    v_fmamk_f32 v80, v76, 0x41700000, v82
    v_fmamk_f32 v88, v84, 0x41700000, v90
    v_fmamk_f32 v80, v81, 0x41200000, v80
    v_fmamk_f32 v88, v89, 0x41200000, v88
    v_cvt_pk_bf16_f32 v6, v77, v85
    v_cvt_pk_bf16_f32 v10, v78, v86
    v_cvt_pk_bf16_f32 v66, v79, v87
    v_cvt_pk_bf16_f32 v70, v82, v90
    v_cvt_pk_bf16_f32 v74, v80, v88
    v_lshlrev_b32 v76, 16, v3
    v_and_b32 v84, s25, v3
    v_lshlrev_b32 v77, 16, v7
    v_and_b32 v85, s25, v7
    v_lshlrev_b32 v78, 16, v11
    v_and_b32 v86, s25, v11
    v_lshlrev_b32 v79, 16, v15
    v_and_b32 v87, s25, v15
    v_add_f32 v80, v76, v78
    v_add_f32 v88, v84, v86
    v_add_f32 v81, v77, v79
    v_add_f32 v89, v85, v87
    v_fma_f32 v82, v78, 4.0, v76
    v_fma_f32 v90, v86, 4.0, v84
    v_fma_f32 v83, v79, 4.0, v77
    v_fma_f32 v91, v87, 4.0, v85
    v_add_f32 v77, v80, v81
    v_add_f32 v85, v88, v89
    v_sub_f32 v78, v80, v81
    v_sub_f32 v86, v88, v89
    v_fma_f32 v79, v83, 2.0, v82
    v_fma_f32 v87, v91, 2.0, v90
    v_fma_f32 v82, v83, -2.0, v82
    v_fma_f32 v90, v91, -2.0, v90
    v_fmamk_f32 v80, v76, 0x41700000, v82
    v_fmamk_f32 v88, v84, 0x41700000, v90
    v_fmamk_f32 v80, v81, 0x41200000, v80
    v_fmamk_f32 v88, v89, 0x41200000, v88
    v_cvt_pk_bf16_f32 v7, v77, v85
    v_cvt_pk_bf16_f32 v11, v78, v86
    v_cvt_pk_bf16_f32 v67, v79, v87
    v_cvt_pk_bf16_f32 v71, v82, v90
    v_cvt_pk_bf16_f32 v75, v80, v88
    ds_write_b128 v96, v[64:67] offset:49152
    ds_write_b128 v97, v[68:71] offset:0
    ds_write_b128 v97, v[72:75] offset:16384
    ds_write_b128 v96, v[4:7] offset:16384
    ds_write_b128 v96, v[8:11] offset:32768
    s_waitcnt vmcnt(0)
    s_waitcnt lgkmcnt(0)
    s_barrier
    buffer_load_dwordx4 v[32:35], v92, s[8:11], s24 offen offset:0
    buffer_load_dwordx4 v[48:51], v92, s[8:11], s24 offen offset:64
    v_add_u32 v92, 128, v92
    buffer_load_dwordx4 v[36:39], v93, s[8:11], s24 offen offset:0
    buffer_load_dwordx4 v[52:55], v93, s[8:11], s24 offen offset:64
    v_add_u32 v93, 128, v93
    s_setprio 1
L_conv1_kernel_hloop1:
    s_cmp_lt_u32 s28, 13
    s_cselect_b32 s24, 0, 2130706432
    v_lshlrev_b32 v76, 16, v16
    v_and_b32 v84, s25, v16
    v_lshlrev_b32 v77, 16, v20
    v_and_b32 v85, s25, v20
    v_lshlrev_b32 v78, 16, v24
    v_and_b32 v86, s25, v24
    v_lshlrev_b32 v79, 16, v28
    v_and_b32 v87, s25, v28
    v_add_f32 v80, v76, v78
    v_add_f32 v88, v84, v86
    v_add_f32 v81, v77, v79
    v_add_f32 v89, v85, v87
    v_fma_f32 v82, v78, 4.0, v76
    buffer_load_dwordx4 v[40:43], v94, s[8:11], s24 offen offset:0
    buffer_load_dwordx4 v[56:59], v94, s[8:11], s24 offen offset:64
    v_add_u32 v94, 128, v94
    v_fma_f32 v90, v86, 4.0, v84
    v_fma_f32 v83, v79, 4.0, v77
    v_fma_f32 v91, v87, 4.0, v85
    v_add_f32 v77, v80, v81
    v_add_f32 v85, v88, v89
    v_sub_f32 v78, v80, v81
    v_sub_f32 v86, v88, v89
    v_fma_f32 v79, v83, 2.0, v82
    v_fma_f32 v87, v91, 2.0, v90
    v_fma_f32 v82, v83, -2.0, v82
    v_fma_f32 v90, v91, -2.0, v90
    v_fmamk_f32 v80, v76, 0x41700000, v82
    v_fmamk_f32 v88, v84, 0x41700000, v90
    v_fmamk_f32 v80, v81, 0x41200000, v80
    v_fmamk_f32 v88, v89, 0x41200000, v88
    v_cvt_pk_bf16_f32 v20, v77, v85
    v_cvt_pk_bf16_f32 v24, v78, v86
    v_cvt_pk_bf16_f32 v64, v79, v87
    v_cvt_pk_bf16_f32 v68, v82, v90
    v_cvt_pk_bf16_f32 v72, v80, v88
    v_lshlrev_b32 v76, 16, v17
    v_and_b32 v84, s25, v17
    v_lshlrev_b32 v77, 16, v21
    v_and_b32 v85, s25, v21
    v_lshlrev_b32 v78, 16, v25
    v_and_b32 v86, s25, v25
    v_lshlrev_b32 v79, 16, v29
    v_and_b32 v87, s25, v29
    v_add_f32 v80, v76, v78
    v_add_f32 v88, v84, v86
    v_add_f32 v81, v77, v79
    v_add_f32 v89, v85, v87
    v_fma_f32 v82, v78, 4.0, v76
    v_fma_f32 v90, v86, 4.0, v84
    v_fma_f32 v83, v79, 4.0, v77
    v_fma_f32 v91, v87, 4.0, v85
    v_add_f32 v77, v80, v81
    v_add_f32 v85, v88, v89
    v_sub_f32 v78, v80, v81
    v_sub_f32 v86, v88, v89
    v_fma_f32 v79, v83, 2.0, v82
    v_fma_f32 v87, v91, 2.0, v90
    v_fma_f32 v82, v83, -2.0, v82
    v_fma_f32 v90, v91, -2.0, v90
    v_fmamk_f32 v80, v76, 0x41700000, v82
    v_fmamk_f32 v88, v84, 0x41700000, v90
    v_fmamk_f32 v80, v81, 0x41200000, v80
    v_fmamk_f32 v88, v89, 0x41200000, v88
    v_cvt_pk_bf16_f32 v21, v77, v85
    v_cvt_pk_bf16_f32 v25, v78, v86
    v_cvt_pk_bf16_f32 v65, v79, v87
    v_cvt_pk_bf16_f32 v69, v82, v90
    v_cvt_pk_bf16_f32 v73, v80, v88
    buffer_load_dwordx4 v[44:47], v95, s[8:11], s24 offen offset:0
    buffer_load_dwordx4 v[60:63], v95, s[8:11], s24 offen offset:64
    v_add_u32 v95, 128, v95
    v_lshlrev_b32 v76, 16, v18
    v_and_b32 v84, s25, v18
    v_lshlrev_b32 v77, 16, v22
    v_and_b32 v85, s25, v22
    v_lshlrev_b32 v78, 16, v26
    v_and_b32 v86, s25, v26
    v_lshlrev_b32 v79, 16, v30
    v_and_b32 v87, s25, v30
    v_add_f32 v80, v76, v78
    v_add_f32 v88, v84, v86
    v_add_f32 v81, v77, v79
    v_add_f32 v89, v85, v87
    v_fma_f32 v82, v78, 4.0, v76
    v_fma_f32 v90, v86, 4.0, v84
    v_fma_f32 v83, v79, 4.0, v77
    v_fma_f32 v91, v87, 4.0, v85
    v_add_f32 v77, v80, v81
    v_add_f32 v85, v88, v89
    v_sub_f32 v78, v80, v81
    v_sub_f32 v86, v88, v89
    v_fma_f32 v79, v83, 2.0, v82
    v_fma_f32 v87, v91, 2.0, v90
    v_fma_f32 v82, v83, -2.0, v82
    v_fma_f32 v90, v91, -2.0, v90
    v_fmamk_f32 v80, v76, 0x41700000, v82
    v_fmamk_f32 v88, v84, 0x41700000, v90
    v_fmamk_f32 v80, v81, 0x41200000, v80
    v_fmamk_f32 v88, v89, 0x41200000, v88
    v_cvt_pk_bf16_f32 v22, v77, v85
    v_cvt_pk_bf16_f32 v26, v78, v86
    v_cvt_pk_bf16_f32 v66, v79, v87
    v_cvt_pk_bf16_f32 v70, v82, v90
    v_cvt_pk_bf16_f32 v74, v80, v88
    v_lshlrev_b32 v76, 16, v19
    v_and_b32 v84, s25, v19
    v_lshlrev_b32 v77, 16, v23
    v_and_b32 v85, s25, v23
    v_lshlrev_b32 v78, 16, v27
    v_and_b32 v86, s25, v27
    v_lshlrev_b32 v79, 16, v31
    v_and_b32 v87, s25, v31
    v_add_f32 v80, v76, v78
    v_add_f32 v88, v84, v86
    v_add_f32 v81, v77, v79
    v_add_f32 v89, v85, v87
    v_fma_f32 v82, v78, 4.0, v76
    v_fma_f32 v90, v86, 4.0, v84
    v_fma_f32 v83, v79, 4.0, v77
    v_fma_f32 v91, v87, 4.0, v85
    v_add_f32 v77, v80, v81
    v_add_f32 v85, v88, v89
    v_sub_f32 v78, v80, v81
    v_sub_f32 v86, v88, v89
    v_fma_f32 v79, v83, 2.0, v82
    v_fma_f32 v87, v91, 2.0, v90
    v_fma_f32 v82, v83, -2.0, v82
    v_fma_f32 v90, v91, -2.0, v90
    v_fmamk_f32 v80, v76, 0x41700000, v82
    v_fmamk_f32 v88, v84, 0x41700000, v90
    v_fmamk_f32 v80, v81, 0x41200000, v80
    v_fmamk_f32 v88, v89, 0x41200000, v88
    v_cvt_pk_bf16_f32 v23, v77, v85
    v_cvt_pk_bf16_f32 v27, v78, v86
    v_cvt_pk_bf16_f32 v67, v79, v87
    v_cvt_pk_bf16_f32 v71, v82, v90
    v_cvt_pk_bf16_f32 v75, v80, v88
    ds_write_b128 v96, v[64:67] offset:57344
    ds_write_b128 v97, v[68:71] offset:8192
    ds_write_b128 v97, v[72:75] offset:24576
    ds_write_b128 v96, v[16:19] offset:8192
    ds_write_b128 v96, v[20:23] offset:24576
    ds_write_b128 v96, v[24:27] offset:40960
    ds_write_b128 v98, v[28:31] offset:8704
    s_add_u32 s28, s28, 1
    s_waitcnt lgkmcnt(0)
    s_barrier
    s_cmp_lt_u32 s28, 13
    s_cselect_b32 s24, 0, 2130706432
    s_waitcnt vmcnt(0)
    v_lshlrev_b32 v76, 16, v32
    v_and_b32 v84, s25, v32
    v_lshlrev_b32 v77, 16, v36
    v_and_b32 v85, s25, v36
    v_lshlrev_b32 v78, 16, v40
    v_and_b32 v86, s25, v40
    v_lshlrev_b32 v79, 16, v44
    v_and_b32 v87, s25, v44
    v_add_f32 v80, v76, v78
    v_add_f32 v88, v84, v86
    v_add_f32 v81, v77, v79
    v_add_f32 v89, v85, v87
    v_fma_f32 v82, v78, 4.0, v76
    v_fma_f32 v90, v86, 4.0, v84
    v_fma_f32 v83, v79, 4.0, v77
    v_fma_f32 v91, v87, 4.0, v85
    v_add_f32 v77, v80, v81
    v_add_f32 v85, v88, v89
    v_sub_f32 v78, v80, v81
    v_sub_f32 v86, v88, v89
    v_fma_f32 v79, v83, 2.0, v82
    v_fma_f32 v87, v91, 2.0, v90
    v_fma_f32 v82, v83, -2.0, v82
    v_fma_f32 v90, v91, -2.0, v90
    v_fmamk_f32 v80, v76, 0x41700000, v82
    v_fmamk_f32 v88, v84, 0x41700000, v90
    v_fmamk_f32 v80, v81, 0x41200000, v80
    v_fmamk_f32 v88, v89, 0x41200000, v88
    v_cvt_pk_bf16_f32 v36, v77, v85
    v_cvt_pk_bf16_f32 v40, v78, v86
    v_cvt_pk_bf16_f32 v64, v79, v87
    v_cvt_pk_bf16_f32 v68, v82, v90
    v_cvt_pk_bf16_f32 v72, v80, v88
    v_lshlrev_b32 v76, 16, v33
    v_and_b32 v84, s25, v33
    v_lshlrev_b32 v77, 16, v37
    v_and_b32 v85, s25, v37
    v_lshlrev_b32 v78, 16, v41
    v_and_b32 v86, s25, v41
    buffer_load_dwordx4 v[0:3], v92, s[8:11], s24 offen offset:0
    buffer_load_dwordx4 v[16:19], v92, s[8:11], s24 offen offset:64
    v_add_u32 v92, 128, v92
    v_lshlrev_b32 v79, 16, v45
    v_and_b32 v87, s25, v45
    v_add_f32 v80, v76, v78
    v_add_f32 v88, v84, v86
    v_add_f32 v81, v77, v79
    v_add_f32 v89, v85, v87
    v_fma_f32 v82, v78, 4.0, v76
    v_fma_f32 v90, v86, 4.0, v84
    v_fma_f32 v83, v79, 4.0, v77
    v_fma_f32 v91, v87, 4.0, v85
    v_add_f32 v77, v80, v81
    v_add_f32 v85, v88, v89
    v_sub_f32 v78, v80, v81
    v_sub_f32 v86, v88, v89
    v_fma_f32 v79, v83, 2.0, v82
    v_fma_f32 v87, v91, 2.0, v90
    v_fma_f32 v82, v83, -2.0, v82
    v_fma_f32 v90, v91, -2.0, v90
    v_fmamk_f32 v80, v76, 0x41700000, v82
    v_fmamk_f32 v88, v84, 0x41700000, v90
    v_fmamk_f32 v80, v81, 0x41200000, v80
    v_fmamk_f32 v88, v89, 0x41200000, v88
    v_cvt_pk_bf16_f32 v37, v77, v85
    v_cvt_pk_bf16_f32 v41, v78, v86
    v_cvt_pk_bf16_f32 v65, v79, v87
    v_cvt_pk_bf16_f32 v69, v82, v90
    v_cvt_pk_bf16_f32 v73, v80, v88
    v_lshlrev_b32 v76, 16, v34
    v_and_b32 v84, s25, v34
    v_lshlrev_b32 v77, 16, v38
    v_and_b32 v85, s25, v38
    v_lshlrev_b32 v78, 16, v42
    v_and_b32 v86, s25, v42
    v_lshlrev_b32 v79, 16, v46
    v_and_b32 v87, s25, v46
    v_add_f32 v80, v76, v78
    v_add_f32 v88, v84, v86
    v_add_f32 v81, v77, v79
    v_add_f32 v89, v85, v87
    v_fma_f32 v82, v78, 4.0, v76
    v_fma_f32 v90, v86, 4.0, v84
    v_fma_f32 v83, v79, 4.0, v77
    v_fma_f32 v91, v87, 4.0, v85
    v_add_f32 v77, v80, v81
    v_add_f32 v85, v88, v89
    v_sub_f32 v78, v80, v81
    v_sub_f32 v86, v88, v89
    v_fma_f32 v79, v83, 2.0, v82
    v_fma_f32 v87, v91, 2.0, v90
    v_fma_f32 v82, v83, -2.0, v82
    v_fma_f32 v90, v91, -2.0, v90
    v_fmamk_f32 v80, v76, 0x41700000, v82
    v_fmamk_f32 v88, v84, 0x41700000, v90
    buffer_load_dwordx4 v[4:7], v93, s[8:11], s24 offen offset:0
    buffer_load_dwordx4 v[20:23], v93, s[8:11], s24 offen offset:64
    v_add_u32 v93, 128, v93
    v_fmamk_f32 v80, v81, 0x41200000, v80
    v_fmamk_f32 v88, v89, 0x41200000, v88
    v_cvt_pk_bf16_f32 v38, v77, v85
    v_cvt_pk_bf16_f32 v42, v78, v86
    v_cvt_pk_bf16_f32 v66, v79, v87
    v_cvt_pk_bf16_f32 v70, v82, v90
    v_cvt_pk_bf16_f32 v74, v80, v88
    v_lshlrev_b32 v76, 16, v35
    v_and_b32 v84, s25, v35
    v_lshlrev_b32 v77, 16, v39
    v_and_b32 v85, s25, v39
    v_lshlrev_b32 v78, 16, v43
    v_and_b32 v86, s25, v43
    v_lshlrev_b32 v79, 16, v47
    v_and_b32 v87, s25, v47
    v_add_f32 v80, v76, v78
    v_add_f32 v88, v84, v86
    v_add_f32 v81, v77, v79
    v_add_f32 v89, v85, v87
    v_fma_f32 v82, v78, 4.0, v76
    v_fma_f32 v90, v86, 4.0, v84
    v_fma_f32 v83, v79, 4.0, v77
    v_fma_f32 v91, v87, 4.0, v85
    v_add_f32 v77, v80, v81
    v_add_f32 v85, v88, v89
    v_sub_f32 v78, v80, v81
    v_sub_f32 v86, v88, v89
    v_fma_f32 v79, v83, 2.0, v82
    v_fma_f32 v87, v91, 2.0, v90
    v_fma_f32 v82, v83, -2.0, v82
    v_fma_f32 v90, v91, -2.0, v90
    v_fmamk_f32 v80, v76, 0x41700000, v82
    v_fmamk_f32 v88, v84, 0x41700000, v90
    v_fmamk_f32 v80, v81, 0x41200000, v80
    v_fmamk_f32 v88, v89, 0x41200000, v88
    v_cvt_pk_bf16_f32 v39, v77, v85
    v_cvt_pk_bf16_f32 v43, v78, v86
    v_cvt_pk_bf16_f32 v67, v79, v87
    v_cvt_pk_bf16_f32 v71, v82, v90
    v_cvt_pk_bf16_f32 v75, v80, v88
    ds_write_b128 v96, v[64:67] offset:49152
    ds_write_b128 v97, v[68:71] offset:0
    ds_write_b128 v97, v[72:75] offset:16384
    ds_write_b128 v96, v[32:35] offset:0
    ds_write_b128 v96, v[36:39] offset:16384
    ds_write_b128 v96, v[40:43] offset:32768
    ds_write_b128 v98, v[44:47] offset:0
    s_add_u32 s28, s28, 1
    s_waitcnt lgkmcnt(0)
    s_barrier
    s_cmp_lt_u32 s28, 13
    s_cselect_b32 s24, 0, 2130706432
    v_lshlrev_b32 v76, 16, v48
    v_and_b32 v84, s25, v48
    v_lshlrev_b32 v77, 16, v52
    v_and_b32 v85, s25, v52
    v_lshlrev_b32 v78, 16, v56
    v_and_b32 v86, s25, v56
    v_lshlrev_b32 v79, 16, v60
    v_and_b32 v87, s25, v60
    v_add_f32 v80, v76, v78
    v_add_f32 v88, v84, v86
    v_add_f32 v81, v77, v79
    v_add_f32 v89, v85, v87
    v_fma_f32 v82, v78, 4.0, v76
    buffer_load_dwordx4 v[8:11], v94, s[8:11], s24 offen offset:0
    buffer_load_dwordx4 v[24:27], v94, s[8:11], s24 offen offset:64
    v_add_u32 v94, 128, v94
    v_fma_f32 v90, v86, 4.0, v84
    v_fma_f32 v83, v79, 4.0, v77
    v_fma_f32 v91, v87, 4.0, v85
    v_add_f32 v77, v80, v81
    v_add_f32 v85, v88, v89
    v_sub_f32 v78, v80, v81
    v_sub_f32 v86, v88, v89
    v_fma_f32 v79, v83, 2.0, v82
    v_fma_f32 v87, v91, 2.0, v90
    v_fma_f32 v82, v83, -2.0, v82
    v_fma_f32 v90, v91, -2.0, v90
    v_fmamk_f32 v80, v76, 0x41700000, v82
    v_fmamk_f32 v88, v84, 0x41700000, v90
    v_fmamk_f32 v80, v81, 0x41200000, v80
    v_fmamk_f32 v88, v89, 0x41200000, v88
    v_cvt_pk_bf16_f32 v52, v77, v85
    v_cvt_pk_bf16_f32 v56, v78, v86
    v_cvt_pk_bf16_f32 v64, v79, v87
    v_cvt_pk_bf16_f32 v68, v82, v90
    v_cvt_pk_bf16_f32 v72, v80, v88
    v_lshlrev_b32 v76, 16, v49
    v_and_b32 v84, s25, v49
    v_lshlrev_b32 v77, 16, v53
    v_and_b32 v85, s25, v53
    v_lshlrev_b32 v78, 16, v57
    v_and_b32 v86, s25, v57
    v_lshlrev_b32 v79, 16, v61
    v_and_b32 v87, s25, v61
    v_add_f32 v80, v76, v78
    v_add_f32 v88, v84, v86
    v_add_f32 v81, v77, v79
    v_add_f32 v89, v85, v87
    v_fma_f32 v82, v78, 4.0, v76
    v_fma_f32 v90, v86, 4.0, v84
    v_fma_f32 v83, v79, 4.0, v77
    v_fma_f32 v91, v87, 4.0, v85
    v_add_f32 v77, v80, v81
    v_add_f32 v85, v88, v89
    v_sub_f32 v78, v80, v81
    v_sub_f32 v86, v88, v89
    v_fma_f32 v79, v83, 2.0, v82
    v_fma_f32 v87, v91, 2.0, v90
    v_fma_f32 v82, v83, -2.0, v82
    v_fma_f32 v90, v91, -2.0, v90
    v_fmamk_f32 v80, v76, 0x41700000, v82
    v_fmamk_f32 v88, v84, 0x41700000, v90
    v_fmamk_f32 v80, v81, 0x41200000, v80
    v_fmamk_f32 v88, v89, 0x41200000, v88
    v_cvt_pk_bf16_f32 v53, v77, v85
    v_cvt_pk_bf16_f32 v57, v78, v86
    v_cvt_pk_bf16_f32 v65, v79, v87
    v_cvt_pk_bf16_f32 v69, v82, v90
    v_cvt_pk_bf16_f32 v73, v80, v88
    buffer_load_dwordx4 v[12:15], v95, s[8:11], s24 offen offset:0
    buffer_load_dwordx4 v[28:31], v95, s[8:11], s24 offen offset:64
    v_add_u32 v95, 128, v95
    v_lshlrev_b32 v76, 16, v50
    v_and_b32 v84, s25, v50
    v_lshlrev_b32 v77, 16, v54
    v_and_b32 v85, s25, v54
    v_lshlrev_b32 v78, 16, v58
    v_and_b32 v86, s25, v58
    v_lshlrev_b32 v79, 16, v62
    v_and_b32 v87, s25, v62
    v_add_f32 v80, v76, v78
    v_add_f32 v88, v84, v86
    v_add_f32 v81, v77, v79
    v_add_f32 v89, v85, v87
    v_fma_f32 v82, v78, 4.0, v76
    v_fma_f32 v90, v86, 4.0, v84
    v_fma_f32 v83, v79, 4.0, v77
    v_fma_f32 v91, v87, 4.0, v85
    v_add_f32 v77, v80, v81
    v_add_f32 v85, v88, v89
    v_sub_f32 v78, v80, v81
    v_sub_f32 v86, v88, v89
    v_fma_f32 v79, v83, 2.0, v82
    v_fma_f32 v87, v91, 2.0, v90
    v_fma_f32 v82, v83, -2.0, v82
    v_fma_f32 v90, v91, -2.0, v90
    v_fmamk_f32 v80, v76, 0x41700000, v82
    v_fmamk_f32 v88, v84, 0x41700000, v90
    v_fmamk_f32 v80, v81, 0x41200000, v80
    v_fmamk_f32 v88, v89, 0x41200000, v88
    v_cvt_pk_bf16_f32 v54, v77, v85
    v_cvt_pk_bf16_f32 v58, v78, v86
    v_cvt_pk_bf16_f32 v66, v79, v87
    v_cvt_pk_bf16_f32 v70, v82, v90
    v_cvt_pk_bf16_f32 v74, v80, v88
    v_lshlrev_b32 v76, 16, v51
    v_and_b32 v84, s25, v51
    v_lshlrev_b32 v77, 16, v55
    v_and_b32 v85, s25, v55
    v_lshlrev_b32 v78, 16, v59
    v_and_b32 v86, s25, v59
    v_lshlrev_b32 v79, 16, v63
    v_and_b32 v87, s25, v63
    v_add_f32 v80, v76, v78
    v_add_f32 v88, v84, v86
    v_add_f32 v81, v77, v79
    v_add_f32 v89, v85, v87
    v_fma_f32 v82, v78, 4.0, v76
    v_fma_f32 v90, v86, 4.0, v84
    v_fma_f32 v83, v79, 4.0, v77
    v_fma_f32 v91, v87, 4.0, v85
    v_add_f32 v77, v80, v81
    v_add_f32 v85, v88, v89
    v_sub_f32 v78, v80, v81
    v_sub_f32 v86, v88, v89
    v_fma_f32 v79, v83, 2.0, v82
    v_fma_f32 v87, v91, 2.0, v90
    v_fma_f32 v82, v83, -2.0, v82
    v_fma_f32 v90, v91, -2.0, v90
    v_fmamk_f32 v80, v76, 0x41700000, v82
    v_fmamk_f32 v88, v84, 0x41700000, v90
    v_fmamk_f32 v80, v81, 0x41200000, v80
    v_fmamk_f32 v88, v89, 0x41200000, v88
    v_cvt_pk_bf16_f32 v55, v77, v85
    v_cvt_pk_bf16_f32 v59, v78, v86
    v_cvt_pk_bf16_f32 v67, v79, v87
    v_cvt_pk_bf16_f32 v71, v82, v90
    v_cvt_pk_bf16_f32 v75, v80, v88
    ds_write_b128 v96, v[64:67] offset:57344
    ds_write_b128 v97, v[68:71] offset:8192
    ds_write_b128 v97, v[72:75] offset:24576
    ds_write_b128 v96, v[48:51] offset:8192
    ds_write_b128 v96, v[52:55] offset:24576
    ds_write_b128 v96, v[56:59] offset:40960
    ds_write_b128 v98, v[60:63] offset:8704
    s_add_u32 s28, s28, 1
    s_waitcnt lgkmcnt(0)
    s_barrier
    s_cmp_eq_u32 s22, 1
    s_cbranch_scc1 L_conv1_kernel_hlast1
    s_cmp_lt_u32 s28, 13
    s_cselect_b32 s24, 0, 2130706432
    s_waitcnt vmcnt(0)
    v_lshlrev_b32 v76, 16, v0
    v_and_b32 v84, s25, v0
    v_lshlrev_b32 v77, 16, v4
    v_and_b32 v85, s25, v4
    v_lshlrev_b32 v78, 16, v8
    v_and_b32 v86, s25, v8
    v_lshlrev_b32 v79, 16, v12
    v_and_b32 v87, s25, v12
    v_add_f32 v80, v76, v78
    v_add_f32 v88, v84, v86
    v_add_f32 v81, v77, v79
    v_add_f32 v89, v85, v87
    v_fma_f32 v82, v78, 4.0, v76
    v_fma_f32 v90, v86, 4.0, v84
    v_fma_f32 v83, v79, 4.0, v77
    v_fma_f32 v91, v87, 4.0, v85
    v_add_f32 v77, v80, v81
    v_add_f32 v85, v88, v89
    v_sub_f32 v78, v80, v81
    v_sub_f32 v86, v88, v89
    v_fma_f32 v79, v83, 2.0, v82
    v_fma_f32 v87, v91, 2.0, v90
    v_fma_f32 v82, v83, -2.0, v82
    v_fma_f32 v90, v91, -2.0, v90
    v_fmamk_f32 v80, v76, 0x41700000, v82
    v_fmamk_f32 v88, v84, 0x41700000, v90
    v_fmamk_f32 v80, v81, 0x41200000, v80
    v_fmamk_f32 v88, v89, 0x41200000, v88
    v_cvt_pk_bf16_f32 v4, v77, v85
    v_cvt_pk_bf16_f32 v8, v78, v86
    v_cvt_pk_bf16_f32 v64, v79, v87
    v_cvt_pk_bf16_f32 v68, v82, v90
    v_cvt_pk_bf16_f32 v72, v80, v88
    v_lshlrev_b32 v76, 16, v1
    v_and_b32 v84, s25, v1
    v_lshlrev_b32 v77, 16, v5
    v_and_b32 v85, s25, v5
    v_lshlrev_b32 v78, 16, v9
    v_and_b32 v86, s25, v9
    buffer_load_dwordx4 v[32:35], v92, s[8:11], s24 offen offset:0
    buffer_load_dwordx4 v[48:51], v92, s[8:11], s24 offen offset:64
    v_add_u32 v92, 128, v92
    v_lshlrev_b32 v79, 16, v13
    v_and_b32 v87, s25, v13
    v_add_f32 v80, v76, v78
    v_add_f32 v88, v84, v86
    v_add_f32 v81, v77, v79
    v_add_f32 v89, v85, v87
    v_fma_f32 v82, v78, 4.0, v76
    v_fma_f32 v90, v86, 4.0, v84
    v_fma_f32 v83, v79, 4.0, v77
    v_fma_f32 v91, v87, 4.0, v85
    v_add_f32 v77, v80, v81
    v_add_f32 v85, v88, v89
    v_sub_f32 v78, v80, v81
    v_sub_f32 v86, v88, v89
    v_fma_f32 v79, v83, 2.0, v82
    v_fma_f32 v87, v91, 2.0, v90
    v_fma_f32 v82, v83, -2.0, v82
    v_fma_f32 v90, v91, -2.0, v90
    v_fmamk_f32 v80, v76, 0x41700000, v82
    v_fmamk_f32 v88, v84, 0x41700000, v90
    v_fmamk_f32 v80, v81, 0x41200000, v80
    v_fmamk_f32 v88, v89, 0x41200000, v88
    v_cvt_pk_bf16_f32 v5, v77, v85
    v_cvt_pk_bf16_f32 v9, v78, v86
    v_cvt_pk_bf16_f32 v65, v79, v87
    v_cvt_pk_bf16_f32 v69, v82, v90
    v_cvt_pk_bf16_f32 v73, v80, v88
    v_lshlrev_b32 v76, 16, v2
    v_and_b32 v84, s25, v2
    v_lshlrev_b32 v77, 16, v6
    v_and_b32 v85, s25, v6
    v_lshlrev_b32 v78, 16, v10
    v_and_b32 v86, s25, v10
    v_lshlrev_b32 v79, 16, v14
    v_and_b32 v87, s25, v14
    v_add_f32 v80, v76, v78
    v_add_f32 v88, v84, v86
    v_add_f32 v81, v77, v79
    v_add_f32 v89, v85, v87
    v_fma_f32 v82, v78, 4.0, v76
    v_fma_f32 v90, v86, 4.0, v84
    v_fma_f32 v83, v79, 4.0, v77
    v_fma_f32 v91, v87, 4.0, v85
    v_add_f32 v77, v80, v81
    v_add_f32 v85, v88, v89
    v_sub_f32 v78, v80, v81
    v_sub_f32 v86, v88, v89
    v_fma_f32 v79, v83, 2.0, v82
    v_fma_f32 v87, v91, 2.0, v90
    v_fma_f32 v82, v83, -2.0, v82
    v_fma_f32 v90, v91, -2.0, v90
    v_fmamk_f32 v80, v76, 0x41700000, v82
    v_fmamk_f32 v88, v84, 0x41700000, v90
    buffer_load_dwordx4 v[36:39], v93, s[8:11], s24 offen offset:0
    buffer_load_dwordx4 v[52:55], v93, s[8:11], s24 offen offset:64
    v_add_u32 v93, 128, v93
    v_fmamk_f32 v80, v81, 0x41200000, v80
    v_fmamk_f32 v88, v89, 0x41200000, v88
    v_cvt_pk_bf16_f32 v6, v77, v85
    v_cvt_pk_bf16_f32 v10, v78, v86
    v_cvt_pk_bf16_f32 v66, v79, v87
    v_cvt_pk_bf16_f32 v70, v82, v90
    v_cvt_pk_bf16_f32 v74, v80, v88
    v_lshlrev_b32 v76, 16, v3
    v_and_b32 v84, s25, v3
    v_lshlrev_b32 v77, 16, v7
    v_and_b32 v85, s25, v7
    v_lshlrev_b32 v78, 16, v11
    v_and_b32 v86, s25, v11
    v_lshlrev_b32 v79, 16, v15
    v_and_b32 v87, s25, v15
    v_add_f32 v80, v76, v78
    v_add_f32 v88, v84, v86
    v_add_f32 v81, v77, v79
    v_add_f32 v89, v85, v87
    v_fma_f32 v82, v78, 4.0, v76
    v_fma_f32 v90, v86, 4.0, v84
    v_fma_f32 v83, v79, 4.0, v77
    v_fma_f32 v91, v87, 4.0, v85
    v_add_f32 v77, v80, v81
    v_add_f32 v85, v88, v89
    v_sub_f32 v78, v80, v81
    v_sub_f32 v86, v88, v89
    v_fma_f32 v79, v83, 2.0, v82
    v_fma_f32 v87, v91, 2.0, v90
    v_fma_f32 v82, v83, -2.0, v82
    v_fma_f32 v90, v91, -2.0, v90
    v_fmamk_f32 v80, v76, 0x41700000, v82
    v_fmamk_f32 v88, v84, 0x41700000, v90
    v_fmamk_f32 v80, v81, 0x41200000, v80
    v_fmamk_f32 v88, v89, 0x41200000, v88
    v_cvt_pk_bf16_f32 v7, v77, v85
    v_cvt_pk_bf16_f32 v11, v78, v86
    v_cvt_pk_bf16_f32 v67, v79, v87
    v_cvt_pk_bf16_f32 v71, v82, v90
    v_cvt_pk_bf16_f32 v75, v80, v88
    ds_write_b128 v96, v[64:67] offset:49152
    ds_write_b128 v97, v[68:71] offset:0
    ds_write_b128 v97, v[72:75] offset:16384
    ds_write_b128 v96, v[0:3] offset:0
    ds_write_b128 v96, v[4:7] offset:16384
    ds_write_b128 v96, v[8:11] offset:32768
    ds_write_b128 v98, v[12:15] offset:0
    s_add_u32 s28, s28, 1
    s_waitcnt lgkmcnt(0)
    s_barrier
    s_sub_u32 s22, s22, 1
    s_branch L_conv1_kernel_hloop1
L_conv1_kernel_hlast1:
    s_cmp_ge_u32 s2, 32
    s_cbranch_scc1 L_conv1_kernel_ntw
    s_getpc_b64 s[36:37]
L_conv1_kernel_pc:
    s_lshl_b32 s38, s32, 13
    s_add_u32 s38, s38, L_conv1_kernel_epi-L_conv1_kernel_pc
    v_lshl_add_u32 v2, v127, 7, s38
    v_min_u32 v2, L_conv2_kernel_done-L_conv1_kernel_pc, v2
    v_mov_b32 v3, s37
    v_add_co_u32 v2, vcc, s36, v2
    s_nop 1
    v_addc_co_u32 v3, vcc, 0, v3, vcc
    global_load_dword v4, v[2:3], off
L_conv1_kernel_ntw:
    s_branch L_conv1_kernel_end
L_conv1_kernel_h2:
    s_load_dwordx2 s[48:49], s[0:1], 16
    ds_write_b128 v96, v[0:3] offset:0
    ds_write_b128 v98, v[12:15] offset:0
    v_lshlrev_b32 v76, 16, v0
    v_and_b32 v84, s25, v0
    v_lshlrev_b32 v77, 16, v4
    v_and_b32 v85, s25, v4
    v_lshlrev_b32 v78, 16, v8
    v_and_b32 v86, s25, v8
    v_lshlrev_b32 v79, 16, v12
    v_and_b32 v87, s25, v12
    v_add_f32 v80, v76, v78
    v_add_f32 v88, v84, v86
    v_add_f32 v81, v77, v79
    v_add_f32 v89, v85, v87
    v_fma_f32 v82, v78, 4.0, v76
    v_fma_f32 v90, v86, 4.0, v84
    v_fma_f32 v83, v79, 4.0, v77
    v_fma_f32 v91, v87, 4.0, v85
    v_add_f32 v77, v80, v81
    v_add_f32 v85, v88, v89
    v_sub_f32 v78, v80, v81
    v_sub_f32 v86, v88, v89
    v_fma_f32 v79, v83, 2.0, v82
    v_fma_f32 v87, v91, 2.0, v90
    v_fma_f32 v82, v83, -2.0, v82
    v_fma_f32 v90, v91, -2.0, v90
    v_fmamk_f32 v80, v76, 0x41700000, v82
    v_fmamk_f32 v88, v84, 0x41700000, v90
    v_fmamk_f32 v80, v81, 0x41200000, v80
    v_fmamk_f32 v88, v89, 0x41200000, v88
    v_cvt_pk_bf16_f32 v4, v77, v85
    v_cvt_pk_bf16_f32 v8, v78, v86
    v_cvt_pk_bf16_f32 v64, v79, v87
    v_cvt_pk_bf16_f32 v68, v82, v90
    v_cvt_pk_bf16_f32 v72, v80, v88
    v_lshlrev_b32 v76, 16, v1
    v_and_b32 v84, s25, v1
    v_lshlrev_b32 v77, 16, v5
    v_and_b32 v85, s25, v5
    v_lshlrev_b32 v78, 16, v9
    v_and_b32 v86, s25, v9
    v_lshlrev_b32 v79, 16, v13
    v_and_b32 v87, s25, v13
    v_add_f32 v80, v76, v78
    v_add_f32 v88, v84, v86
    v_add_f32 v81, v77, v79
    v_add_f32 v89, v85, v87
    v_fma_f32 v82, v78, 4.0, v76
    v_fma_f32 v90, v86, 4.0, v84
    v_fma_f32 v83, v79, 4.0, v77
    v_fma_f32 v91, v87, 4.0, v85
    v_add_f32 v77, v80, v81
    v_add_f32 v85, v88, v89
    v_sub_f32 v78, v80, v81
    v_sub_f32 v86, v88, v89
    v_fma_f32 v79, v83, 2.0, v82
    v_fma_f32 v87, v91, 2.0, v90
    v_fma_f32 v82, v83, -2.0, v82
    v_fma_f32 v90, v91, -2.0, v90
    v_fmamk_f32 v80, v76, 0x41700000, v82
    v_fmamk_f32 v88, v84, 0x41700000, v90
    v_fmamk_f32 v80, v81, 0x41200000, v80
    v_fmamk_f32 v88, v89, 0x41200000, v88
    v_cvt_pk_bf16_f32 v5, v77, v85
    v_cvt_pk_bf16_f32 v9, v78, v86
    v_cvt_pk_bf16_f32 v65, v79, v87
    v_cvt_pk_bf16_f32 v69, v82, v90
    v_cvt_pk_bf16_f32 v73, v80, v88
    v_lshlrev_b32 v76, 16, v2
    v_and_b32 v84, s25, v2
    v_lshlrev_b32 v77, 16, v6
    v_and_b32 v85, s25, v6
    v_lshlrev_b32 v78, 16, v10
    v_and_b32 v86, s25, v10
    v_lshlrev_b32 v79, 16, v14
    v_and_b32 v87, s25, v14
    v_add_f32 v80, v76, v78
    v_add_f32 v88, v84, v86
    v_add_f32 v81, v77, v79
    v_add_f32 v89, v85, v87
    v_fma_f32 v82, v78, 4.0, v76
    v_fma_f32 v90, v86, 4.0, v84
    v_fma_f32 v83, v79, 4.0, v77
    v_fma_f32 v91, v87, 4.0, v85
    v_add_f32 v77, v80, v81
    v_add_f32 v85, v88, v89
    v_sub_f32 v78, v80, v81
    v_sub_f32 v86, v88, v89
    v_fma_f32 v79, v83, 2.0, v82
    v_fma_f32 v87, v91, 2.0, v90
    v_fma_f32 v82, v83, -2.0, v82
    v_fma_f32 v90, v91, -2.0, v90
    v_fmamk_f32 v80, v76, 0x41700000, v82
    v_fmamk_f32 v88, v84, 0x41700000, v90
    v_fmamk_f32 v80, v81, 0x41200000, v80
    v_fmamk_f32 v88, v89, 0x41200000, v88
    v_cvt_pk_bf16_f32 v6, v77, v85
    v_cvt_pk_bf16_f32 v10, v78, v86
    v_cvt_pk_bf16_f32 v66, v79, v87
    v_cvt_pk_bf16_f32 v70, v82, v90
    v_cvt_pk_bf16_f32 v74, v80, v88
    v_lshlrev_b32 v76, 16, v3
    v_and_b32 v84, s25, v3
    v_lshlrev_b32 v77, 16, v7
    v_and_b32 v85, s25, v7
    v_lshlrev_b32 v78, 16, v11
    v_and_b32 v86, s25, v11
    v_lshlrev_b32 v79, 16, v15
    v_and_b32 v87, s25, v15
    v_add_f32 v80, v76, v78
    v_add_f32 v88, v84, v86
    v_add_f32 v81, v77, v79
    v_add_f32 v89, v85, v87
    v_fma_f32 v82, v78, 4.0, v76
    v_fma_f32 v90, v86, 4.0, v84
    v_fma_f32 v83, v79, 4.0, v77
    v_fma_f32 v91, v87, 4.0, v85
    v_add_f32 v77, v80, v81
    v_add_f32 v85, v88, v89
    v_sub_f32 v78, v80, v81
    v_sub_f32 v86, v88, v89
    v_fma_f32 v79, v83, 2.0, v82
    v_fma_f32 v87, v91, 2.0, v90
    v_fma_f32 v82, v83, -2.0, v82
    v_fma_f32 v90, v91, -2.0, v90
    v_fmamk_f32 v80, v76, 0x41700000, v82
    v_fmamk_f32 v88, v84, 0x41700000, v90
    v_fmamk_f32 v80, v81, 0x41200000, v80
    v_fmamk_f32 v88, v89, 0x41200000, v88
    v_cvt_pk_bf16_f32 v7, v77, v85
    v_cvt_pk_bf16_f32 v11, v78, v86
    v_cvt_pk_bf16_f32 v67, v79, v87
    v_cvt_pk_bf16_f32 v71, v82, v90
    v_cvt_pk_bf16_f32 v75, v80, v88
    ds_write_b128 v96, v[64:67] offset:49152
    ds_write_b128 v97, v[68:71] offset:0
    ds_write_b128 v97, v[72:75] offset:16384
    ds_write_b128 v96, v[4:7] offset:16384
    ds_write_b128 v96, v[8:11] offset:32768
    s_waitcnt vmcnt(0)
    s_waitcnt lgkmcnt(0)
    s_barrier
    buffer_load_dwordx4 v[32:35], v92, s[8:11], s24 offen offset:0
    buffer_load_dwordx4 v[48:51], v92, s[8:11], s24 offen offset:64
    v_add_u32 v92, 128, v92
    buffer_load_dwordx4 v[36:39], v93, s[8:11], s24 offen offset:0
    buffer_load_dwordx4 v[52:55], v93, s[8:11], s24 offen offset:64
    v_add_u32 v93, 128, v93
    buffer_load_dwordx4 v[40:43], v94, s[8:11], s24 offen offset:0
    buffer_load_dwordx4 v[56:59], v94, s[8:11], s24 offen offset:64
    v_add_u32 v94, 128, v94
    buffer_load_dwordx4 v[44:47], v95, s[8:11], s24 offen offset:0
    buffer_load_dwordx4 v[60:63], v95, s[8:11], s24 offen offset:64
    v_add_u32 v95, 128, v95
    s_setprio 0
    v_lshlrev_b32 v76, 16, v16
    v_and_b32 v84, s25, v16
    v_lshlrev_b32 v77, 16, v20
    v_and_b32 v85, s25, v20
    v_lshlrev_b32 v78, 16, v24
    v_and_b32 v86, s25, v24
    v_lshlrev_b32 v79, 16, v28
    v_and_b32 v87, s25, v28
    v_add_f32 v80, v76, v78
    v_add_f32 v88, v84, v86
    v_add_f32 v81, v77, v79
    v_add_f32 v89, v85, v87
    v_fma_f32 v82, v78, 4.0, v76
    v_fma_f32 v90, v86, 4.0, v84
    v_fma_f32 v83, v79, 4.0, v77
    v_fma_f32 v91, v87, 4.0, v85
    v_add_f32 v77, v80, v81
    v_add_f32 v85, v88, v89
    v_sub_f32 v78, v80, v81
    v_sub_f32 v86, v88, v89
    v_fma_f32 v79, v83, 2.0, v82
    v_fma_f32 v87, v91, 2.0, v90
    v_fma_f32 v82, v83, -2.0, v82
    v_fma_f32 v90, v91, -2.0, v90
    v_fmamk_f32 v80, v76, 0x41700000, v82
    v_fmamk_f32 v88, v84, 0x41700000, v90
    v_fmamk_f32 v80, v81, 0x41200000, v80
    v_fmamk_f32 v88, v89, 0x41200000, v88
    v_cvt_pk_bf16_f32 v20, v77, v85
    v_cvt_pk_bf16_f32 v24, v78, v86
    v_cvt_pk_bf16_f32 v64, v79, v87
    v_cvt_pk_bf16_f32 v68, v82, v90
    v_cvt_pk_bf16_f32 v72, v80, v88
    v_lshlrev_b32 v76, 16, v17
    v_and_b32 v84, s25, v17
    v_lshlrev_b32 v77, 16, v21
    v_and_b32 v85, s25, v21
    v_lshlrev_b32 v78, 16, v25
    v_and_b32 v86, s25, v25
    v_lshlrev_b32 v79, 16, v29
    v_and_b32 v87, s25, v29
    v_add_f32 v80, v76, v78
    v_add_f32 v88, v84, v86
    v_add_f32 v81, v77, v79
    v_add_f32 v89, v85, v87
    v_fma_f32 v82, v78, 4.0, v76
    v_fma_f32 v90, v86, 4.0, v84
    v_fma_f32 v83, v79, 4.0, v77
    v_fma_f32 v91, v87, 4.0, v85
    v_add_f32 v77, v80, v81
    v_add_f32 v85, v88, v89
    v_sub_f32 v78, v80, v81
    v_sub_f32 v86, v88, v89
    v_fma_f32 v79, v83, 2.0, v82
    v_fma_f32 v87, v91, 2.0, v90
    v_fma_f32 v82, v83, -2.0, v82
    v_fma_f32 v90, v91, -2.0, v90
    v_fmamk_f32 v80, v76, 0x41700000, v82
    v_fmamk_f32 v88, v84, 0x41700000, v90
    v_fmamk_f32 v80, v81, 0x41200000, v80
    v_fmamk_f32 v88, v89, 0x41200000, v88
    v_cvt_pk_bf16_f32 v21, v77, v85
    v_cvt_pk_bf16_f32 v25, v78, v86
    v_cvt_pk_bf16_f32 v65, v79, v87
    v_cvt_pk_bf16_f32 v69, v82, v90
    v_cvt_pk_bf16_f32 v73, v80, v88
    v_lshlrev_b32 v76, 16, v18
    v_and_b32 v84, s25, v18
    v_lshlrev_b32 v77, 16, v22
    v_and_b32 v85, s25, v22
    v_lshlrev_b32 v78, 16, v26
    v_and_b32 v86, s25, v26
    v_lshlrev_b32 v79, 16, v30
    v_and_b32 v87, s25, v30
    v_add_f32 v80, v76, v78
    v_add_f32 v88, v84, v86
    v_add_f32 v81, v77, v79
    v_add_f32 v89, v85, v87
    v_fma_f32 v82, v78, 4.0, v76
    v_fma_f32 v90, v86, 4.0, v84
    v_fma_f32 v83, v79, 4.0, v77
    v_fma_f32 v91, v87, 4.0, v85
    v_add_f32 v77, v80, v81
    v_add_f32 v85, v88, v89
    v_sub_f32 v78, v80, v81
    v_sub_f32 v86, v88, v89
    v_fma_f32 v79, v83, 2.0, v82
    v_fma_f32 v87, v91, 2.0, v90
    v_fma_f32 v82, v83, -2.0, v82
    v_fma_f32 v90, v91, -2.0, v90
    v_fmamk_f32 v80, v76, 0x41700000, v82
    v_fmamk_f32 v88, v84, 0x41700000, v90
    v_fmamk_f32 v80, v81, 0x41200000, v80
    v_fmamk_f32 v88, v89, 0x41200000, v88
    v_cvt_pk_bf16_f32 v22, v77, v85
    v_cvt_pk_bf16_f32 v26, v78, v86
    v_cvt_pk_bf16_f32 v66, v79, v87
    v_cvt_pk_bf16_f32 v70, v82, v90
    v_cvt_pk_bf16_f32 v74, v80, v88
    v_lshlrev_b32 v76, 16, v19
    v_and_b32 v84, s25, v19
    v_lshlrev_b32 v77, 16, v23
    v_and_b32 v85, s25, v23
    v_lshlrev_b32 v78, 16, v27
    v_and_b32 v86, s25, v27
    v_lshlrev_b32 v79, 16, v31
    v_and_b32 v87, s25, v31
    v_add_f32 v80, v76, v78
    v_add_f32 v88, v84, v86
    v_add_f32 v81, v77, v79
    v_add_f32 v89, v85, v87
    v_fma_f32 v82, v78, 4.0, v76
    v_fma_f32 v90, v86, 4.0, v84
    v_fma_f32 v83, v79, 4.0, v77
    v_fma_f32 v91, v87, 4.0, v85
    v_add_f32 v77, v80, v81
    v_add_f32 v85, v88, v89
    v_sub_f32 v78, v80, v81
    v_sub_f32 v86, v88, v89
    v_fma_f32 v79, v83, 2.0, v82
    v_fma_f32 v87, v91, 2.0, v90
    v_fma_f32 v82, v83, -2.0, v82
    v_fma_f32 v90, v91, -2.0, v90
    v_fmamk_f32 v80, v76, 0x41700000, v82
    v_fmamk_f32 v88, v84, 0x41700000, v90
    v_fmamk_f32 v80, v81, 0x41200000, v80
    v_fmamk_f32 v88, v89, 0x41200000, v88
    v_cvt_pk_bf16_f32 v23, v77, v85
    v_cvt_pk_bf16_f32 v27, v78, v86
    v_cvt_pk_bf16_f32 v67, v79, v87
    v_cvt_pk_bf16_f32 v71, v82, v90
    v_cvt_pk_bf16_f32 v75, v80, v88
L_conv1_kernel_hloop2:
    s_cmp_lt_u32 s28, 12
    s_cselect_b32 s24, 0, 2130706432
    ds_write_b128 v96, v[64:67] offset:57344
    ds_write_b128 v97, v[68:71] offset:8192
    ds_write_b128 v97, v[72:75] offset:24576
    ds_write_b128 v96, v[16:19] offset:8192
    ds_write_b128 v96, v[20:23] offset:24576
    ds_write_b128 v96, v[24:27] offset:40960
    ds_write_b128 v98, v[28:31] offset:8704
    s_waitcnt vmcnt(0)
    buffer_load_dwordx4 v[0:3], v92, s[8:11], s24 offen offset:0
    buffer_load_dwordx4 v[16:19], v92, s[8:11], s24 offen offset:64
    v_add_u32 v92, 128, v92
    buffer_load_dwordx4 v[4:7], v93, s[8:11], s24 offen offset:0
    buffer_load_dwordx4 v[20:23], v93, s[8:11], s24 offen offset:64
    v_add_u32 v93, 128, v93
    v_lshlrev_b32 v76, 16, v32
    v_and_b32 v84, s25, v32
    v_lshlrev_b32 v77, 16, v36
    v_and_b32 v85, s25, v36
    v_lshlrev_b32 v78, 16, v40
    v_and_b32 v86, s25, v40
    v_lshlrev_b32 v79, 16, v44
    v_and_b32 v87, s25, v44
    v_add_f32 v80, v76, v78
    v_add_f32 v88, v84, v86
    v_add_f32 v81, v77, v79
    v_add_f32 v89, v85, v87
    v_fma_f32 v82, v78, 4.0, v76
    v_fma_f32 v90, v86, 4.0, v84
    v_fma_f32 v83, v79, 4.0, v77
    v_fma_f32 v91, v87, 4.0, v85
    v_add_f32 v77, v80, v81
    v_add_f32 v85, v88, v89
    v_sub_f32 v78, v80, v81
    v_sub_f32 v86, v88, v89
    v_fma_f32 v79, v83, 2.0, v82
    v_fma_f32 v87, v91, 2.0, v90
    v_fma_f32 v82, v83, -2.0, v82
    v_fma_f32 v90, v91, -2.0, v90
    v_fmamk_f32 v80, v76, 0x41700000, v82
    v_fmamk_f32 v88, v84, 0x41700000, v90
    v_fmamk_f32 v80, v81, 0x41200000, v80
    v_fmamk_f32 v88, v89, 0x41200000, v88
    v_cvt_pk_bf16_f32 v36, v77, v85
    v_cvt_pk_bf16_f32 v40, v78, v86
    v_cvt_pk_bf16_f32 v64, v79, v87
    v_cvt_pk_bf16_f32 v68, v82, v90
    v_cvt_pk_bf16_f32 v72, v80, v88
    v_lshlrev_b32 v76, 16, v33
    v_and_b32 v84, s25, v33
    v_lshlrev_b32 v77, 16, v37
    v_and_b32 v85, s25, v37
    v_lshlrev_b32 v78, 16, v41
    v_and_b32 v86, s25, v41
    v_lshlrev_b32 v79, 16, v45
    v_and_b32 v87, s25, v45
    v_add_f32 v80, v76, v78
    v_add_f32 v88, v84, v86
    v_add_f32 v81, v77, v79
    v_add_f32 v89, v85, v87
    v_fma_f32 v82, v78, 4.0, v76
    v_fma_f32 v90, v86, 4.0, v84
    v_fma_f32 v83, v79, 4.0, v77
    v_fma_f32 v91, v87, 4.0, v85
    v_add_f32 v77, v80, v81
    v_add_f32 v85, v88, v89
    v_sub_f32 v78, v80, v81
    v_sub_f32 v86, v88, v89
    v_fma_f32 v79, v83, 2.0, v82
    v_fma_f32 v87, v91, 2.0, v90
    v_fma_f32 v82, v83, -2.0, v82
    v_fma_f32 v90, v91, -2.0, v90
    v_fmamk_f32 v80, v76, 0x41700000, v82
    v_fmamk_f32 v88, v84, 0x41700000, v90
    v_fmamk_f32 v80, v81, 0x41200000, v80
    v_fmamk_f32 v88, v89, 0x41200000, v88
    v_cvt_pk_bf16_f32 v37, v77, v85
    v_cvt_pk_bf16_f32 v41, v78, v86
    v_cvt_pk_bf16_f32 v65, v79, v87
    v_cvt_pk_bf16_f32 v69, v82, v90
    v_cvt_pk_bf16_f32 v73, v80, v88
    v_lshlrev_b32 v76, 16, v34
    v_and_b32 v84, s25, v34
    v_lshlrev_b32 v77, 16, v38
    v_and_b32 v85, s25, v38
    v_lshlrev_b32 v78, 16, v42
    v_and_b32 v86, s25, v42
    v_lshlrev_b32 v79, 16, v46
    v_and_b32 v87, s25, v46
    v_add_f32 v80, v76, v78
    v_add_f32 v88, v84, v86
    v_add_f32 v81, v77, v79
    v_add_f32 v89, v85, v87
    v_fma_f32 v82, v78, 4.0, v76
    v_fma_f32 v90, v86, 4.0, v84
    v_fma_f32 v83, v79, 4.0, v77
    v_fma_f32 v91, v87, 4.0, v85
    v_add_f32 v77, v80, v81
    v_add_f32 v85, v88, v89
    v_sub_f32 v78, v80, v81
    v_sub_f32 v86, v88, v89
    v_fma_f32 v79, v83, 2.0, v82
    v_fma_f32 v87, v91, 2.0, v90
    v_fma_f32 v82, v83, -2.0, v82
    v_fma_f32 v90, v91, -2.0, v90
    v_fmamk_f32 v80, v76, 0x41700000, v82
    v_fmamk_f32 v88, v84, 0x41700000, v90
    v_fmamk_f32 v80, v81, 0x41200000, v80
    v_fmamk_f32 v88, v89, 0x41200000, v88
    v_cvt_pk_bf16_f32 v38, v77, v85
    v_cvt_pk_bf16_f32 v42, v78, v86
    v_cvt_pk_bf16_f32 v66, v79, v87
    v_cvt_pk_bf16_f32 v70, v82, v90
    v_cvt_pk_bf16_f32 v74, v80, v88
    v_lshlrev_b32 v76, 16, v35
    v_and_b32 v84, s25, v35
    v_lshlrev_b32 v77, 16, v39
    v_and_b32 v85, s25, v39
    v_lshlrev_b32 v78, 16, v43
    v_and_b32 v86, s25, v43
    v_lshlrev_b32 v79, 16, v47
    v_and_b32 v87, s25, v47
    v_add_f32 v80, v76, v78
    v_add_f32 v88, v84, v86
    v_add_f32 v81, v77, v79
    v_add_f32 v89, v85, v87
    v_fma_f32 v82, v78, 4.0, v76
    v_fma_f32 v90, v86, 4.0, v84
    v_fma_f32 v83, v79, 4.0, v77
    v_fma_f32 v91, v87, 4.0, v85
    v_add_f32 v77, v80, v81
    v_add_f32 v85, v88, v89
    v_sub_f32 v78, v80, v81
    v_sub_f32 v86, v88, v89
    v_fma_f32 v79, v83, 2.0, v82
    v_fma_f32 v87, v91, 2.0, v90
    v_fma_f32 v82, v83, -2.0, v82
    v_fma_f32 v90, v91, -2.0, v90
    v_fmamk_f32 v80, v76, 0x41700000, v82
    v_fmamk_f32 v88, v84, 0x41700000, v90
    v_fmamk_f32 v80, v81, 0x41200000, v80
    v_fmamk_f32 v88, v89, 0x41200000, v88
    v_cvt_pk_bf16_f32 v39, v77, v85
    v_cvt_pk_bf16_f32 v43, v78, v86
    v_cvt_pk_bf16_f32 v67, v79, v87
    v_cvt_pk_bf16_f32 v71, v82, v90
    v_cvt_pk_bf16_f32 v75, v80, v88
    s_add_u32 s28, s28, 1
    s_waitcnt lgkmcnt(0)
    s_barrier
    s_cmp_lt_u32 s28, 12
    s_cselect_b32 s24, 0, 2130706432
    ds_write_b128 v96, v[64:67] offset:49152
    ds_write_b128 v97, v[68:71] offset:0
    ds_write_b128 v97, v[72:75] offset:16384
    ds_write_b128 v96, v[32:35] offset:0
    ds_write_b128 v96, v[36:39] offset:16384
    ds_write_b128 v96, v[40:43] offset:32768
    ds_write_b128 v98, v[44:47] offset:0
    buffer_load_dwordx4 v[8:11], v94, s[8:11], s24 offen offset:0
    buffer_load_dwordx4 v[24:27], v94, s[8:11], s24 offen offset:64
    v_add_u32 v94, 128, v94
    buffer_load_dwordx4 v[12:15], v95, s[8:11], s24 offen offset:0
    buffer_load_dwordx4 v[28:31], v95, s[8:11], s24 offen offset:64
    v_add_u32 v95, 128, v95
    v_lshlrev_b32 v76, 16, v48
    v_and_b32 v84, s25, v48
    v_lshlrev_b32 v77, 16, v52
    v_and_b32 v85, s25, v52
    v_lshlrev_b32 v78, 16, v56
    v_and_b32 v86, s25, v56
    v_lshlrev_b32 v79, 16, v60
    v_and_b32 v87, s25, v60
    v_add_f32 v80, v76, v78
    v_add_f32 v88, v84, v86
    v_add_f32 v81, v77, v79
    v_add_f32 v89, v85, v87
    v_fma_f32 v82, v78, 4.0, v76
    v_fma_f32 v90, v86, 4.0, v84
    v_fma_f32 v83, v79, 4.0, v77
    v_fma_f32 v91, v87, 4.0, v85
    v_add_f32 v77, v80, v81
    v_add_f32 v85, v88, v89
    v_sub_f32 v78, v80, v81
    v_sub_f32 v86, v88, v89
    v_fma_f32 v79, v83, 2.0, v82
    v_fma_f32 v87, v91, 2.0, v90
    v_fma_f32 v82, v83, -2.0, v82
    v_fma_f32 v90, v91, -2.0, v90
    v_fmamk_f32 v80, v76, 0x41700000, v82
    v_fmamk_f32 v88, v84, 0x41700000, v90
    v_fmamk_f32 v80, v81, 0x41200000, v80
    v_fmamk_f32 v88, v89, 0x41200000, v88
    v_cvt_pk_bf16_f32 v52, v77, v85
    v_cvt_pk_bf16_f32 v56, v78, v86
    v_cvt_pk_bf16_f32 v64, v79, v87
    v_cvt_pk_bf16_f32 v68, v82, v90
    v_cvt_pk_bf16_f32 v72, v80, v88
    v_lshlrev_b32 v76, 16, v49
    v_and_b32 v84, s25, v49
    v_lshlrev_b32 v77, 16, v53
    v_and_b32 v85, s25, v53
    v_lshlrev_b32 v78, 16, v57
    v_and_b32 v86, s25, v57
    v_lshlrev_b32 v79, 16, v61
    v_and_b32 v87, s25, v61
    v_add_f32 v80, v76, v78
    v_add_f32 v88, v84, v86
    v_add_f32 v81, v77, v79
    v_add_f32 v89, v85, v87
    v_fma_f32 v82, v78, 4.0, v76
    v_fma_f32 v90, v86, 4.0, v84
    v_fma_f32 v83, v79, 4.0, v77
    v_fma_f32 v91, v87, 4.0, v85
    v_add_f32 v77, v80, v81
    v_add_f32 v85, v88, v89
    v_sub_f32 v78, v80, v81
    v_sub_f32 v86, v88, v89
    v_fma_f32 v79, v83, 2.0, v82
    v_fma_f32 v87, v91, 2.0, v90
    v_fma_f32 v82, v83, -2.0, v82
    v_fma_f32 v90, v91, -2.0, v90
    v_fmamk_f32 v80, v76, 0x41700000, v82
    v_fmamk_f32 v88, v84, 0x41700000, v90
    v_fmamk_f32 v80, v81, 0x41200000, v80
    v_fmamk_f32 v88, v89, 0x41200000, v88
    v_cvt_pk_bf16_f32 v53, v77, v85
    v_cvt_pk_bf16_f32 v57, v78, v86
    v_cvt_pk_bf16_f32 v65, v79, v87
    v_cvt_pk_bf16_f32 v69, v82, v90
    v_cvt_pk_bf16_f32 v73, v80, v88
    v_lshlrev_b32 v76, 16, v50
    v_and_b32 v84, s25, v50
    v_lshlrev_b32 v77, 16, v54
    v_and_b32 v85, s25, v54
    v_lshlrev_b32 v78, 16, v58
    v_and_b32 v86, s25, v58
    v_lshlrev_b32 v79, 16, v62
    v_and_b32 v87, s25, v62
    v_add_f32 v80, v76, v78
    v_add_f32 v88, v84, v86
    v_add_f32 v81, v77, v79
    v_add_f32 v89, v85, v87
    v_fma_f32 v82, v78, 4.0, v76
    v_fma_f32 v90, v86, 4.0, v84
    v_fma_f32 v83, v79, 4.0, v77
    v_fma_f32 v91, v87, 4.0, v85
    v_add_f32 v77, v80, v81
    v_add_f32 v85, v88, v89
    v_sub_f32 v78, v80, v81
    v_sub_f32 v86, v88, v89
    v_fma_f32 v79, v83, 2.0, v82
    v_fma_f32 v87, v91, 2.0, v90
    v_fma_f32 v82, v83, -2.0, v82
    v_fma_f32 v90, v91, -2.0, v90
    v_fmamk_f32 v80, v76, 0x41700000, v82
    v_fmamk_f32 v88, v84, 0x41700000, v90
    v_fmamk_f32 v80, v81, 0x41200000, v80
    v_fmamk_f32 v88, v89, 0x41200000, v88
    v_cvt_pk_bf16_f32 v54, v77, v85
    v_cvt_pk_bf16_f32 v58, v78, v86
    v_cvt_pk_bf16_f32 v66, v79, v87
    v_cvt_pk_bf16_f32 v70, v82, v90
    v_cvt_pk_bf16_f32 v74, v80, v88
    v_lshlrev_b32 v76, 16, v51
    v_and_b32 v84, s25, v51
    v_lshlrev_b32 v77, 16, v55
    v_and_b32 v85, s25, v55
    v_lshlrev_b32 v78, 16, v59
    v_and_b32 v86, s25, v59
    v_lshlrev_b32 v79, 16, v63
    v_and_b32 v87, s25, v63
    v_add_f32 v80, v76, v78
    v_add_f32 v88, v84, v86
    v_add_f32 v81, v77, v79
    v_add_f32 v89, v85, v87
    v_fma_f32 v82, v78, 4.0, v76
    v_fma_f32 v90, v86, 4.0, v84
    v_fma_f32 v83, v79, 4.0, v77
    v_fma_f32 v91, v87, 4.0, v85
    v_add_f32 v77, v80, v81
    v_add_f32 v85, v88, v89
    v_sub_f32 v78, v80, v81
    v_sub_f32 v86, v88, v89
    v_fma_f32 v79, v83, 2.0, v82
    v_fma_f32 v87, v91, 2.0, v90
    v_fma_f32 v82, v83, -2.0, v82
    v_fma_f32 v90, v91, -2.0, v90
    v_fmamk_f32 v80, v76, 0x41700000, v82
    v_fmamk_f32 v88, v84, 0x41700000, v90
    v_fmamk_f32 v80, v81, 0x41200000, v80
    v_fmamk_f32 v88, v89, 0x41200000, v88
    v_cvt_pk_bf16_f32 v55, v77, v85
    v_cvt_pk_bf16_f32 v59, v78, v86
    v_cvt_pk_bf16_f32 v67, v79, v87
    v_cvt_pk_bf16_f32 v71, v82, v90
    v_cvt_pk_bf16_f32 v75, v80, v88
    s_add_u32 s28, s28, 1
    s_waitcnt lgkmcnt(0)
    s_barrier
    s_cmp_eq_u32 s22, 1
    s_cbranch_scc1 L_conv1_kernel_hlast2
    s_cmp_lt_u32 s28, 12
    s_cselect_b32 s24, 0, 2130706432
    ds_write_b128 v96, v[64:67] offset:57344
    ds_write_b128 v97, v[68:71] offset:8192
    ds_write_b128 v97, v[72:75] offset:24576
    ds_write_b128 v96, v[48:51] offset:8192
    ds_write_b128 v96, v[52:55] offset:24576
    ds_write_b128 v96, v[56:59] offset:40960
    ds_write_b128 v98, v[60:63] offset:8704
    s_waitcnt vmcnt(0)
    buffer_load_dwordx4 v[32:35], v92, s[8:11], s24 offen offset:0
    buffer_load_dwordx4 v[48:51], v92, s[8:11], s24 offen offset:64
    v_add_u32 v92, 128, v92
    buffer_load_dwordx4 v[36:39], v93, s[8:11], s24 offen offset:0
    buffer_load_dwordx4 v[52:55], v93, s[8:11], s24 offen offset:64
    v_add_u32 v93, 128, v93
    v_lshlrev_b32 v76, 16, v0
    v_and_b32 v84, s25, v0
    v_lshlrev_b32 v77, 16, v4
    v_and_b32 v85, s25, v4
    v_lshlrev_b32 v78, 16, v8
    v_and_b32 v86, s25, v8
    v_lshlrev_b32 v79, 16, v12
    v_and_b32 v87, s25, v12
    v_add_f32 v80, v76, v78
    v_add_f32 v88, v84, v86
    v_add_f32 v81, v77, v79
    v_add_f32 v89, v85, v87
    v_fma_f32 v82, v78, 4.0, v76
    v_fma_f32 v90, v86, 4.0, v84
    v_fma_f32 v83, v79, 4.0, v77
    v_fma_f32 v91, v87, 4.0, v85
    v_add_f32 v77, v80, v81
    v_add_f32 v85, v88, v89
    v_sub_f32 v78, v80, v81
    v_sub_f32 v86, v88, v89
    v_fma_f32 v79, v83, 2.0, v82
    v_fma_f32 v87, v91, 2.0, v90
    v_fma_f32 v82, v83, -2.0, v82
    v_fma_f32 v90, v91, -2.0, v90
    v_fmamk_f32 v80, v76, 0x41700000, v82
    v_fmamk_f32 v88, v84, 0x41700000, v90
    v_fmamk_f32 v80, v81, 0x41200000, v80
    v_fmamk_f32 v88, v89, 0x41200000, v88
    v_cvt_pk_bf16_f32 v4, v77, v85
    v_cvt_pk_bf16_f32 v8, v78, v86
    v_cvt_pk_bf16_f32 v64, v79, v87
    v_cvt_pk_bf16_f32 v68, v82, v90
    v_cvt_pk_bf16_f32 v72, v80, v88
    v_lshlrev_b32 v76, 16, v1
    v_and_b32 v84, s25, v1
    v_lshlrev_b32 v77, 16, v5
    v_and_b32 v85, s25, v5
    v_lshlrev_b32 v78, 16, v9
    v_and_b32 v86, s25, v9
    v_lshlrev_b32 v79, 16, v13
    v_and_b32 v87, s25, v13
    v_add_f32 v80, v76, v78
    v_add_f32 v88, v84, v86
    v_add_f32 v81, v77, v79
    v_add_f32 v89, v85, v87
    v_fma_f32 v82, v78, 4.0, v76
    v_fma_f32 v90, v86, 4.0, v84
    v_fma_f32 v83, v79, 4.0, v77
    v_fma_f32 v91, v87, 4.0, v85
    v_add_f32 v77, v80, v81
    v_add_f32 v85, v88, v89
    v_sub_f32 v78, v80, v81
    v_sub_f32 v86, v88, v89
    v_fma_f32 v79, v83, 2.0, v82
    v_fma_f32 v87, v91, 2.0, v90
    v_fma_f32 v82, v83, -2.0, v82
    v_fma_f32 v90, v91, -2.0, v90
    v_fmamk_f32 v80, v76, 0x41700000, v82
    v_fmamk_f32 v88, v84, 0x41700000, v90
    v_fmamk_f32 v80, v81, 0x41200000, v80
    v_fmamk_f32 v88, v89, 0x41200000, v88
    v_cvt_pk_bf16_f32 v5, v77, v85
    v_cvt_pk_bf16_f32 v9, v78, v86
    v_cvt_pk_bf16_f32 v65, v79, v87
    v_cvt_pk_bf16_f32 v69, v82, v90
    v_cvt_pk_bf16_f32 v73, v80, v88
    v_lshlrev_b32 v76, 16, v2
    v_and_b32 v84, s25, v2
    v_lshlrev_b32 v77, 16, v6
    v_and_b32 v85, s25, v6
    v_lshlrev_b32 v78, 16, v10
    v_and_b32 v86, s25, v10
    v_lshlrev_b32 v79, 16, v14
    v_and_b32 v87, s25, v14
    v_add_f32 v80, v76, v78
    v_add_f32 v88, v84, v86
    v_add_f32 v81, v77, v79
    v_add_f32 v89, v85, v87
    v_fma_f32 v82, v78, 4.0, v76
    v_fma_f32 v90, v86, 4.0, v84
    v_fma_f32 v83, v79, 4.0, v77
    v_fma_f32 v91, v87, 4.0, v85
    v_add_f32 v77, v80, v81
    v_add_f32 v85, v88, v89
    v_sub_f32 v78, v80, v81
    v_sub_f32 v86, v88, v89
    v_fma_f32 v79, v83, 2.0, v82
    v_fma_f32 v87, v91, 2.0, v90
    v_fma_f32 v82, v83, -2.0, v82
    v_fma_f32 v90, v91, -2.0, v90
    v_fmamk_f32 v80, v76, 0x41700000, v82
    v_fmamk_f32 v88, v84, 0x41700000, v90
    v_fmamk_f32 v80, v81, 0x41200000, v80
    v_fmamk_f32 v88, v89, 0x41200000, v88
    v_cvt_pk_bf16_f32 v6, v77, v85
    v_cvt_pk_bf16_f32 v10, v78, v86
    v_cvt_pk_bf16_f32 v66, v79, v87
    v_cvt_pk_bf16_f32 v70, v82, v90
    v_cvt_pk_bf16_f32 v74, v80, v88
    v_lshlrev_b32 v76, 16, v3
    v_and_b32 v84, s25, v3
    v_lshlrev_b32 v77, 16, v7
    v_and_b32 v85, s25, v7
    v_lshlrev_b32 v78, 16, v11
    v_and_b32 v86, s25, v11
    v_lshlrev_b32 v79, 16, v15
    v_and_b32 v87, s25, v15
    v_add_f32 v80, v76, v78
    v_add_f32 v88, v84, v86
    v_add_f32 v81, v77, v79
    v_add_f32 v89, v85, v87
    v_fma_f32 v82, v78, 4.0, v76
    v_fma_f32 v90, v86, 4.0, v84
    v_fma_f32 v83, v79, 4.0, v77
    v_fma_f32 v91, v87, 4.0, v85
    v_add_f32 v77, v80, v81
    v_add_f32 v85, v88, v89
    v_sub_f32 v78, v80, v81
    v_sub_f32 v86, v88, v89
    v_fma_f32 v79, v83, 2.0, v82
    v_fma_f32 v87, v91, 2.0, v90
    v_fma_f32 v82, v83, -2.0, v82
    v_fma_f32 v90, v91, -2.0, v90
    v_fmamk_f32 v80, v76, 0x41700000, v82
    v_fmamk_f32 v88, v84, 0x41700000, v90
    v_fmamk_f32 v80, v81, 0x41200000, v80
    v_fmamk_f32 v88, v89, 0x41200000, v88
    v_cvt_pk_bf16_f32 v7, v77, v85
    v_cvt_pk_bf16_f32 v11, v78, v86
    v_cvt_pk_bf16_f32 v67, v79, v87
    v_cvt_pk_bf16_f32 v71, v82, v90
    v_cvt_pk_bf16_f32 v75, v80, v88
    s_add_u32 s28, s28, 1
    s_waitcnt lgkmcnt(0)
    s_barrier
    s_cmp_lt_u32 s28, 12
    s_cselect_b32 s24, 0, 2130706432
    ds_write_b128 v96, v[64:67] offset:49152
    ds_write_b128 v97, v[68:71] offset:0
    ds_write_b128 v97, v[72:75] offset:16384
    ds_write_b128 v96, v[0:3] offset:0
    ds_write_b128 v96, v[4:7] offset:16384
    ds_write_b128 v96, v[8:11] offset:32768
    ds_write_b128 v98, v[12:15] offset:0
    buffer_load_dwordx4 v[40:43], v94, s[8:11], s24 offen offset:0
    buffer_load_dwordx4 v[56:59], v94, s[8:11], s24 offen offset:64
    v_add_u32 v94, 128, v94
    buffer_load_dwordx4 v[44:47], v95, s[8:11], s24 offen offset:0
    buffer_load_dwordx4 v[60:63], v95, s[8:11], s24 offen offset:64
    v_add_u32 v95, 128, v95
    v_lshlrev_b32 v76, 16, v16
    v_and_b32 v84, s25, v16
    v_lshlrev_b32 v77, 16, v20
    v_and_b32 v85, s25, v20
    v_lshlrev_b32 v78, 16, v24
    v_and_b32 v86, s25, v24
    v_lshlrev_b32 v79, 16, v28
    v_and_b32 v87, s25, v28
    v_add_f32 v80, v76, v78
    v_add_f32 v88, v84, v86
    v_add_f32 v81, v77, v79
    v_add_f32 v89, v85, v87
    v_fma_f32 v82, v78, 4.0, v76
    v_fma_f32 v90, v86, 4.0, v84
    v_fma_f32 v83, v79, 4.0, v77
    v_fma_f32 v91, v87, 4.0, v85
    v_add_f32 v77, v80, v81
    v_add_f32 v85, v88, v89
    v_sub_f32 v78, v80, v81
    v_sub_f32 v86, v88, v89
    v_fma_f32 v79, v83, 2.0, v82
    v_fma_f32 v87, v91, 2.0, v90
    v_fma_f32 v82, v83, -2.0, v82
    v_fma_f32 v90, v91, -2.0, v90
    v_fmamk_f32 v80, v76, 0x41700000, v82
    v_fmamk_f32 v88, v84, 0x41700000, v90
    v_fmamk_f32 v80, v81, 0x41200000, v80
    v_fmamk_f32 v88, v89, 0x41200000, v88
    v_cvt_pk_bf16_f32 v20, v77, v85
    v_cvt_pk_bf16_f32 v24, v78, v86
    v_cvt_pk_bf16_f32 v64, v79, v87
    v_cvt_pk_bf16_f32 v68, v82, v90
    v_cvt_pk_bf16_f32 v72, v80, v88
    v_lshlrev_b32 v76, 16, v17
    v_and_b32 v84, s25, v17
    v_lshlrev_b32 v77, 16, v21
    v_and_b32 v85, s25, v21
    v_lshlrev_b32 v78, 16, v25
    v_and_b32 v86, s25, v25
    v_lshlrev_b32 v79, 16, v29
    v_and_b32 v87, s25, v29
    v_add_f32 v80, v76, v78
    v_add_f32 v88, v84, v86
    v_add_f32 v81, v77, v79
    v_add_f32 v89, v85, v87
    v_fma_f32 v82, v78, 4.0, v76
    v_fma_f32 v90, v86, 4.0, v84
    v_fma_f32 v83, v79, 4.0, v77
    v_fma_f32 v91, v87, 4.0, v85
    v_add_f32 v77, v80, v81
    v_add_f32 v85, v88, v89
    v_sub_f32 v78, v80, v81
    v_sub_f32 v86, v88, v89
    v_fma_f32 v79, v83, 2.0, v82
    v_fma_f32 v87, v91, 2.0, v90
    v_fma_f32 v82, v83, -2.0, v82
    v_fma_f32 v90, v91, -2.0, v90
    v_fmamk_f32 v80, v76, 0x41700000, v82
    v_fmamk_f32 v88, v84, 0x41700000, v90
    v_fmamk_f32 v80, v81, 0x41200000, v80
    v_fmamk_f32 v88, v89, 0x41200000, v88
    v_cvt_pk_bf16_f32 v21, v77, v85
    v_cvt_pk_bf16_f32 v25, v78, v86
    v_cvt_pk_bf16_f32 v65, v79, v87
    v_cvt_pk_bf16_f32 v69, v82, v90
    v_cvt_pk_bf16_f32 v73, v80, v88
    v_lshlrev_b32 v76, 16, v18
    v_and_b32 v84, s25, v18
    v_lshlrev_b32 v77, 16, v22
    v_and_b32 v85, s25, v22
    v_lshlrev_b32 v78, 16, v26
    v_and_b32 v86, s25, v26
    v_lshlrev_b32 v79, 16, v30
    v_and_b32 v87, s25, v30
    v_add_f32 v80, v76, v78
    v_add_f32 v88, v84, v86
    v_add_f32 v81, v77, v79
    v_add_f32 v89, v85, v87
    v_fma_f32 v82, v78, 4.0, v76
    v_fma_f32 v90, v86, 4.0, v84
    v_fma_f32 v83, v79, 4.0, v77
    v_fma_f32 v91, v87, 4.0, v85
    v_add_f32 v77, v80, v81
    v_add_f32 v85, v88, v89
    v_sub_f32 v78, v80, v81
    v_sub_f32 v86, v88, v89
    v_fma_f32 v79, v83, 2.0, v82
    v_fma_f32 v87, v91, 2.0, v90
    v_fma_f32 v82, v83, -2.0, v82
    v_fma_f32 v90, v91, -2.0, v90
    v_fmamk_f32 v80, v76, 0x41700000, v82
    v_fmamk_f32 v88, v84, 0x41700000, v90
    v_fmamk_f32 v80, v81, 0x41200000, v80
    v_fmamk_f32 v88, v89, 0x41200000, v88
    v_cvt_pk_bf16_f32 v22, v77, v85
    v_cvt_pk_bf16_f32 v26, v78, v86
    v_cvt_pk_bf16_f32 v66, v79, v87
    v_cvt_pk_bf16_f32 v70, v82, v90
    v_cvt_pk_bf16_f32 v74, v80, v88
    v_lshlrev_b32 v76, 16, v19
    v_and_b32 v84, s25, v19
    v_lshlrev_b32 v77, 16, v23
    v_and_b32 v85, s25, v23
    v_lshlrev_b32 v78, 16, v27
    v_and_b32 v86, s25, v27
    v_lshlrev_b32 v79, 16, v31
    v_and_b32 v87, s25, v31
    v_add_f32 v80, v76, v78
    v_add_f32 v88, v84, v86
    v_add_f32 v81, v77, v79
    v_add_f32 v89, v85, v87
    v_fma_f32 v82, v78, 4.0, v76
    v_fma_f32 v90, v86, 4.0, v84
    v_fma_f32 v83, v79, 4.0, v77
    v_fma_f32 v91, v87, 4.0, v85
    v_add_f32 v77, v80, v81
    v_add_f32 v85, v88, v89
    v_sub_f32 v78, v80, v81
    v_sub_f32 v86, v88, v89
    v_fma_f32 v79, v83, 2.0, v82
    v_fma_f32 v87, v91, 2.0, v90
    v_fma_f32 v82, v83, -2.0, v82
    v_fma_f32 v90, v91, -2.0, v90
    v_fmamk_f32 v80, v76, 0x41700000, v82
    v_fmamk_f32 v88, v84, 0x41700000, v90
    v_fmamk_f32 v80, v81, 0x41200000, v80
    v_fmamk_f32 v88, v89, 0x41200000, v88
    v_cvt_pk_bf16_f32 v23, v77, v85
    v_cvt_pk_bf16_f32 v27, v78, v86
    v_cvt_pk_bf16_f32 v67, v79, v87
    v_cvt_pk_bf16_f32 v71, v82, v90
    v_cvt_pk_bf16_f32 v75, v80, v88
    s_add_u32 s28, s28, 1
    s_waitcnt lgkmcnt(0)
    s_barrier
    s_sub_u32 s22, s22, 1
    s_branch L_conv1_kernel_hloop2
L_conv1_kernel_hlast2:
    s_waitcnt vmcnt(0)
    s_mov_b32 s58, s20
    s_lshl_b32 s20, s2, 2
    s_add_u32 s20, s20, s32
    v_mov_b32 v1, v127
    s_load_dwordx2 s[8:9], s[0:1], 16
    s_lshr_b32 s22, s20, 8
    s_bfe_u32 s23, s20, 0x40004
    s_bfe_u32 s24, s20, 0x30001
    s_and_b32 s21, s20, 1
    v_lshrrev_b32 v2, 4, v1
    v_lshlrev_b32 v2, 12, v2
    v_and_b32 v3, 15, v1
    v_lshl_add_u32 v2, v3, 2, v2
    s_lshl_b32 s26, s22, 3
    s_lshr_b32 s27, s23, 3
    s_add_u32 s26, s26, s27
    s_lshl_b32 s26, s26, 17
    s_and_b32 s27, s23, 7
    s_lshl_b32 s27, s27, 14
    s_add_u32 s26, s26, s27
    s_lshl_b32 s27, s24, 6
    s_add_u32 s26, s26, s27
    s_mov_b32 s10, 4063232
    s_mov_b32 s11, 0x00020000
    s_add_u32 s37, s26, 262144
    s_add_u32 s38, s26, 524288
    s_add_u32 s39, s26, 786432
    s_waitcnt lgkmcnt(0)
    buffer_load_dword v16, v2, s[8:11], s26 offen offset:0
    buffer_load_dword v17, v2, s[8:11], s26 offen offset:512
    buffer_load_dword v24, v2, s[8:11], s37 offen offset:0
    buffer_load_dword v25, v2, s[8:11], s37 offen offset:512
    buffer_load_dword v32, v2, s[8:11], s38 offen offset:0
    buffer_load_dword v33, v2, s[8:11], s38 offen offset:512
    buffer_load_dword v40, v2, s[8:11], s39 offen offset:0
    buffer_load_dword v41, v2, s[8:11], s39 offen offset:512
    buffer_load_dword v18, v2, s[8:11], s26 offen offset:1024
    buffer_load_dword v19, v2, s[8:11], s26 offen offset:1536
    buffer_load_dword v26, v2, s[8:11], s37 offen offset:1024
    buffer_load_dword v27, v2, s[8:11], s37 offen offset:1536
    buffer_load_dword v34, v2, s[8:11], s38 offen offset:1024
    buffer_load_dword v35, v2, s[8:11], s38 offen offset:1536
    buffer_load_dword v42, v2, s[8:11], s39 offen offset:1024
    buffer_load_dword v43, v2, s[8:11], s39 offen offset:1536
    buffer_load_dword v20, v2, s[8:11], s26 offen offset:2048
    buffer_load_dword v21, v2, s[8:11], s26 offen offset:2560
    buffer_load_dword v28, v2, s[8:11], s37 offen offset:2048
    buffer_load_dword v29, v2, s[8:11], s37 offen offset:2560
    buffer_load_dword v36, v2, s[8:11], s38 offen offset:2048
    buffer_load_dword v37, v2, s[8:11], s38 offen offset:2560
    buffer_load_dword v44, v2, s[8:11], s39 offen offset:2048
    buffer_load_dword v45, v2, s[8:11], s39 offen offset:2560
    buffer_load_dword v22, v2, s[8:11], s26 offen offset:3072
    buffer_load_dword v23, v2, s[8:11], s26 offen offset:3584
    buffer_load_dword v30, v2, s[8:11], s37 offen offset:3072
    buffer_load_dword v31, v2, s[8:11], s37 offen offset:3584
    buffer_load_dword v38, v2, s[8:11], s38 offen offset:3072
    buffer_load_dword v39, v2, s[8:11], s38 offen offset:3584
    buffer_load_dword v46, v2, s[8:11], s39 offen offset:3072
    buffer_load_dword v47, v2, s[8:11], s39 offen offset:3584
    s_add_u32 s12, s30, 9437184
    s_addc_u32 s13, s31, 0
    s_mov_b32 s14, 7340032
    s_mov_b32 s15, 0x00020000
    v_lshlrev_b32 v4, 4, v1
    s_lshl_b32 s27, s24, 4
    s_add_u32 s27, s27, s23
    s_mul_i32 s27, s27, 57344
    s_lshl_b32 s28, s22, 11
    s_add_u32 s27, s27, s28
    s_lshl_b32 s28, s21, 10
    s_add_u32 s27, s27, s28
    s_cmp_eq_u32 s21, 0
    s_mov_b32 s32, 0x07060302
    s_cselect_b32 s32, 0x05040100, s32
    s_mov_b32 s33, 0x03020c0c
    s_cselect_b32 s33, 0x01000c0c, s33
    s_mov_b32 s35, 0x3d2aaaab
    s_mov_b32 s36, 0x3c638e39
    s_mov_b32 s25, 0xffff0000
    ds_write_b128 v96, v[64:67] offset:57344
    ds_write_b128 v97, v[68:71] offset:8192
    ds_write_b128 v97, v[72:75] offset:24576
    ds_write_b128 v96, v[48:51] offset:8192
    ds_write_b128 v96, v[52:55] offset:24576
    ds_write_b128 v96, v[56:59] offset:40960
    ds_write_b128 v98, v[60:63] offset:8704
    s_waitcnt lgkmcnt(0)
    s_barrier
    s_waitcnt vmcnt(24)
    v_perm_b32 v72, v17, v16, s32
    v_perm_b32 v48, v41, v40, s32
    v_perm_b32 v76, v76, v40, s33
    v_perm_b32 v84, v84, v41, s33
    v_perm_b32 v77, v77, v32, s33
    v_perm_b32 v85, v85, v33, s33
    v_perm_b32 v78, v78, v24, s33
    v_perm_b32 v86, v86, v25, s33
    v_perm_b32 v79, v79, v16, s33
    v_perm_b32 v87, v87, v17, s33
    v_add_f32 v80, v76, v78
    v_add_f32 v88, v84, v86
    v_add_f32 v81, v77, v79
    v_add_f32 v89, v85, v87
    v_fma_f32 v82, v78, 4.0, v76
    v_fma_f32 v90, v86, 4.0, v84
    v_fma_f32 v83, v79, 4.0, v77
    v_fma_f32 v91, v87, 4.0, v85
    v_add_f32 v77, v80, v81
    v_add_f32 v85, v88, v89
    v_sub_f32 v78, v80, v81
    v_sub_f32 v86, v88, v89
    v_fma_f32 v79, v83, 2.0, v82
    v_fma_f32 v87, v91, 2.0, v90
    v_fma_f32 v82, v83, -2.0, v82
    v_fma_f32 v90, v91, -2.0, v90
    v_fmamk_f32 v80, v76, 0x41700000, v82
    v_fmamk_f32 v88, v84, 0x41700000, v90
    v_fmamk_f32 v80, v81, 0x41200000, v80
    v_fmamk_f32 v88, v89, 0x41200000, v88
    v_mul_f32 v77, 0.5, v77
    v_mul_f32 v85, 0.5, v85
    v_mul_f32 v78, 0.5, v78
    v_mul_f32 v86, 0.5, v86
    v_mul_f32 v79, s35, v79
    v_mul_f32 v87, s35, v87
    v_mul_f32 v82, s35, v82
    v_mul_f32 v90, s35, v90
    v_mul_f32 v80, s36, v80
    v_mul_f32 v88, s36, v88
    v_cvt_pk_bf16_f32 v52, v77, v85
    v_cvt_pk_bf16_f32 v56, v78, v86
    v_cvt_pk_bf16_f32 v60, v79, v87
    v_cvt_pk_bf16_f32 v64, v82, v90
    v_cvt_pk_bf16_f32 v68, v80, v88
    s_waitcnt vmcnt(16)
    v_perm_b32 v73, v19, v18, s32
    v_perm_b32 v49, v43, v42, s32
    v_perm_b32 v76, v76, v42, s33
    v_perm_b32 v84, v84, v43, s33
    v_perm_b32 v77, v77, v34, s33
    v_perm_b32 v85, v85, v35, s33
    v_perm_b32 v78, v78, v26, s33
    v_perm_b32 v86, v86, v27, s33
    v_perm_b32 v79, v79, v18, s33
    v_perm_b32 v87, v87, v19, s33
    v_add_f32 v80, v76, v78
    v_add_f32 v88, v84, v86
    v_add_f32 v81, v77, v79
    v_add_f32 v89, v85, v87
    v_fma_f32 v82, v78, 4.0, v76
    v_fma_f32 v90, v86, 4.0, v84
    v_fma_f32 v83, v79, 4.0, v77
    v_fma_f32 v91, v87, 4.0, v85
    v_add_f32 v77, v80, v81
    v_add_f32 v85, v88, v89
    v_sub_f32 v78, v80, v81
    v_sub_f32 v86, v88, v89
    v_fma_f32 v79, v83, 2.0, v82
    v_fma_f32 v87, v91, 2.0, v90
    v_fma_f32 v82, v83, -2.0, v82
    v_fma_f32 v90, v91, -2.0, v90
    v_fmamk_f32 v80, v76, 0x41700000, v82
    v_fmamk_f32 v88, v84, 0x41700000, v90
    v_fmamk_f32 v80, v81, 0x41200000, v80
    v_fmamk_f32 v88, v89, 0x41200000, v88
    v_mul_f32 v77, 0.5, v77
    v_mul_f32 v85, 0.5, v85
    v_mul_f32 v78, 0.5, v78
    v_mul_f32 v86, 0.5, v86
    v_mul_f32 v79, s35, v79
    v_mul_f32 v87, s35, v87
    v_mul_f32 v82, s35, v82
    v_mul_f32 v90, s35, v90
    v_mul_f32 v80, s36, v80
    v_mul_f32 v88, s36, v88
    v_cvt_pk_bf16_f32 v53, v77, v85
    v_cvt_pk_bf16_f32 v57, v78, v86
    v_cvt_pk_bf16_f32 v61, v79, v87
    v_cvt_pk_bf16_f32 v65, v82, v90
    v_cvt_pk_bf16_f32 v69, v80, v88
    s_waitcnt vmcnt(8)
    v_perm_b32 v74, v21, v20, s32
    v_perm_b32 v50, v45, v44, s32
    v_perm_b32 v76, v76, v44, s33
    v_perm_b32 v84, v84, v45, s33
    v_perm_b32 v77, v77, v36, s33
    v_perm_b32 v85, v85, v37, s33
    v_perm_b32 v78, v78, v28, s33
    v_perm_b32 v86, v86, v29, s33
    v_perm_b32 v79, v79, v20, s33
    v_perm_b32 v87, v87, v21, s33
    v_add_f32 v80, v76, v78
    v_add_f32 v88, v84, v86
    v_add_f32 v81, v77, v79
    v_add_f32 v89, v85, v87
    v_fma_f32 v82, v78, 4.0, v76
    v_fma_f32 v90, v86, 4.0, v84
    v_fma_f32 v83, v79, 4.0, v77
    v_fma_f32 v91, v87, 4.0, v85
    v_add_f32 v77, v80, v81
    v_add_f32 v85, v88, v89
    v_sub_f32 v78, v80, v81
    v_sub_f32 v86, v88, v89
    v_fma_f32 v79, v83, 2.0, v82
    v_fma_f32 v87, v91, 2.0, v90
    v_fma_f32 v82, v83, -2.0, v82
    v_fma_f32 v90, v91, -2.0, v90
    v_fmamk_f32 v80, v76, 0x41700000, v82
    v_fmamk_f32 v88, v84, 0x41700000, v90
    v_fmamk_f32 v80, v81, 0x41200000, v80
    v_fmamk_f32 v88, v89, 0x41200000, v88
    v_mul_f32 v77, 0.5, v77
    v_mul_f32 v85, 0.5, v85
    v_mul_f32 v78, 0.5, v78
    v_mul_f32 v86, 0.5, v86
    v_mul_f32 v79, s35, v79
    v_mul_f32 v87, s35, v87
    v_mul_f32 v82, s35, v82
    v_mul_f32 v90, s35, v90
    v_mul_f32 v80, s36, v80
    v_mul_f32 v88, s36, v88
    v_cvt_pk_bf16_f32 v54, v77, v85
    v_cvt_pk_bf16_f32 v58, v78, v86
    v_cvt_pk_bf16_f32 v62, v79, v87
    v_cvt_pk_bf16_f32 v66, v82, v90
    v_cvt_pk_bf16_f32 v70, v80, v88
    s_waitcnt vmcnt(0)
    v_perm_b32 v75, v23, v22, s32
    v_perm_b32 v51, v47, v46, s32
    v_perm_b32 v76, v76, v46, s33
    v_perm_b32 v84, v84, v47, s33
    v_perm_b32 v77, v77, v38, s33
    v_perm_b32 v85, v85, v39, s33
    v_perm_b32 v78, v78, v30, s33
    v_perm_b32 v86, v86, v31, s33
    v_perm_b32 v79, v79, v22, s33
    v_perm_b32 v87, v87, v23, s33
    v_add_f32 v80, v76, v78
    v_add_f32 v88, v84, v86
    v_add_f32 v81, v77, v79
    v_add_f32 v89, v85, v87
    v_fma_f32 v82, v78, 4.0, v76
    v_fma_f32 v90, v86, 4.0, v84
    v_fma_f32 v83, v79, 4.0, v77
    v_fma_f32 v91, v87, 4.0, v85
    v_add_f32 v77, v80, v81
    v_add_f32 v85, v88, v89
    v_sub_f32 v78, v80, v81
    v_sub_f32 v86, v88, v89
    v_fma_f32 v79, v83, 2.0, v82
    v_fma_f32 v87, v91, 2.0, v90
    v_fma_f32 v82, v83, -2.0, v82
    v_fma_f32 v90, v91, -2.0, v90
    v_fmamk_f32 v80, v76, 0x41700000, v82
    v_fmamk_f32 v88, v84, 0x41700000, v90
    v_fmamk_f32 v80, v81, 0x41200000, v80
    v_fmamk_f32 v88, v89, 0x41200000, v88
    v_mul_f32 v77, 0.5, v77
    v_mul_f32 v85, 0.5, v85
    v_mul_f32 v78, 0.5, v78
    v_mul_f32 v86, 0.5, v86
    v_mul_f32 v79, s35, v79
    v_mul_f32 v87, s35, v87
    v_mul_f32 v82, s35, v82
    v_mul_f32 v90, s35, v90
    v_mul_f32 v80, s36, v80
    v_mul_f32 v88, s36, v88
    v_cvt_pk_bf16_f32 v55, v77, v85
    v_cvt_pk_bf16_f32 v59, v78, v86
    v_cvt_pk_bf16_f32 v63, v79, v87
    v_cvt_pk_bf16_f32 v67, v82, v90
    v_cvt_pk_bf16_f32 v71, v80, v88
    s_add_u32 s28, s27, 49152
    buffer_store_dwordx4 v[72:75], v4, s[12:15], s28 offen sc1
    s_add_u32 s28, s27, 0
    buffer_store_dwordx4 v[48:51], v4, s[12:15], s28 offen sc1
    s_add_u32 s28, s27, 8192
    buffer_store_dwordx4 v[52:55], v4, s[12:15], s28 offen sc1
    s_add_u32 s28, s27, 16384
    buffer_store_dwordx4 v[56:59], v4, s[12:15], s28 offen sc1
    s_add_u32 s28, s27, 24576
    buffer_store_dwordx4 v[60:63], v4, s[12:15], s28 offen sc1
    s_add_u32 s28, s27, 32768
    buffer_store_dwordx4 v[64:67], v4, s[12:15], s28 offen sc1
    s_add_u32 s28, s27, 40960
    buffer_store_dwordx4 v[68:71], v4, s[12:15], s28 offen sc1
    s_mov_b32 s20, s58
    s_branch L_conv1_kernel_end
L_conv1_kernel_epi:
    s_waitcnt lgkmcnt(0)
    s_barrier
    v_cndmask_b32 v122, v111, v110, vcc
    ds_read_b128 v[0:3], v120 offset:0
    ds_read_b128 v[4:7], v120 offset:16384
    ds_read_b128 v[8:11], v120 offset:32768
    ds_read_b128 v[12:15], v120 offset:49152
    ds_read_b128 v[16:19], v121 offset:0
    ds_read_b128 v[20:23], v121 offset:16384
    ds_read_b128 v[24:27], v121 offset:32768
    ds_read_b128 v[28:31], v64 offset:15360
    ds_read_b128 v[32:35], v120 offset:8192
    ds_read_b128 v[36:39], v120 offset:24576
    ds_read_b128 v[40:43], v120 offset:40960
    ds_read_b128 v[44:47], v120 offset:57344
    ds_read_b128 v[48:51], v121 offset:56320
    ds_read_b128 v[52:55], v121 offset:64512
    ds_read_b128 v[56:59], v64 offset:7168
    s_waitcnt lgkmcnt(7)
    ds_read_b128 v[60:63], v64 offset:23552
    s_waitcnt lgkmcnt(8)
    v_pk_add_f32 v[88:89], v[24:25], v[28:29]
    v_pk_add_f32 v[90:91], v[26:27], v[30:31]
    v_pk_add_f32 v[24:25], v[4:5], v[8:9]
    v_pk_add_f32 v[26:27], v[6:7], v[10:11]
    v_pk_add_f32 v[4:5], v[4:5], v[8:9] neg_lo:[0,1] neg_hi:[0,1]
    v_pk_add_f32 v[6:7], v[6:7], v[10:11] neg_lo:[0,1] neg_hi:[0,1]
    v_pk_add_f32 v[72:73], v[12:13], v[16:17]
    v_pk_add_f32 v[74:75], v[14:15], v[18:19]
    v_pk_add_f32 v[12:13], v[12:13], v[16:17] neg_lo:[0,1] neg_hi:[0,1]
    v_pk_add_f32 v[14:15], v[14:15], v[18:19] neg_lo:[0,1] neg_hi:[0,1]
    v_pk_fma_f32 v[72:73], v[24:25], s[4:5], v[72:73]
    v_pk_fma_f32 v[74:75], v[26:27], s[4:5], v[74:75]
    v_pk_fma_f32 v[20:21], v[0:1], s[10:11], v[20:21]
    v_pk_fma_f32 v[22:23], v[2:3], s[10:11], v[22:23]
    v_pk_fma_f32 v[72:73], v[0:1], s[6:7], v[72:73]
    v_pk_fma_f32 v[74:75], v[2:3], s[6:7], v[74:75]
    v_pk_add_f32 v[24:25], v[24:25], v[0:1] neg_lo:[0,1] neg_hi:[0,1]
    v_pk_add_f32 v[26:27], v[26:27], v[2:3] neg_lo:[0,1] neg_hi:[0,1]
    v_pk_fma_f32 v[72:73], v[88:89], s[8:9], v[72:73]
    v_pk_fma_f32 v[74:75], v[90:91], s[8:9], v[74:75]
    v_pk_add_f32 v[24:25], v[24:25], v[88:89] neg_lo:[0,1] neg_hi:[0,1]
    v_pk_add_f32 v[26:27], v[26:27], v[90:91] neg_lo:[0,1] neg_hi:[0,1]
    v_pk_fma_f32 v[20:21], v[88:89], s[22:23], v[20:21]
    v_pk_fma_f32 v[22:23], v[90:91], s[22:23], v[22:23]
    v_pk_add_f32 v[8:9], v[24:25], v[72:73] neg_lo:[0,1] neg_hi:[0,1]
    v_pk_add_f32 v[10:11], v[26:27], v[74:75] neg_lo:[0,1] neg_hi:[0,1]
    v_pk_fma_f32 v[20:21], v[72:73], s[14:15], v[20:21]
    v_pk_fma_f32 v[22:23], v[74:75], s[14:15], v[22:23]
    v_pk_mul_f32 v[80:81], v[12:13], s[32:33]
    v_pk_mul_f32 v[82:83], v[14:15], s[32:33]
    v_pk_fma_f32 v[20:21], v[8:9], s[12:13], v[20:21]
    v_pk_fma_f32 v[22:23], v[10:11], s[12:13], v[22:23]
    v_pk_fma_f32 v[80:81], v[4:5], s[34:35], v[80:81]
    v_pk_fma_f32 v[82:83], v[6:7], s[34:35], v[82:83]
    v_pk_fma_f32 v[64:65], v[4:5], s[24:25], v[20:21] neg_lo:[0,0,1] neg_hi:[0,0,1]
    v_pk_fma_f32 v[66:67], v[6:7], s[24:25], v[22:23] neg_lo:[0,0,1] neg_hi:[0,0,1]
    v_pk_fma_f32 v[64:65], v[12:13], s[26:27], v[64:65]
    v_pk_fma_f32 v[66:67], v[14:15], s[26:27], v[66:67]
    v_pk_fma_f32 v[80:81], v[64:65], s[38:39], v[80:81]
    v_pk_fma_f32 v[82:83], v[66:67], s[38:39], v[82:83]
    v_pk_add_f32 v[4:5], v[4:5], v[64:65] neg_lo:[0,1] neg_hi:[0,1]
    v_pk_add_f32 v[6:7], v[6:7], v[66:67] neg_lo:[0,1] neg_hi:[0,1]
    v_pk_add_f32 v[4:5], v[4:5], v[80:81] neg_lo:[0,1] neg_hi:[0,1]
    v_pk_add_f32 v[6:7], v[6:7], v[82:83] neg_lo:[0,1] neg_hi:[0,1]
    s_waitcnt lgkmcnt(0)
    v_pk_add_f32 v[92:93], v[56:57], v[60:61]
    v_pk_add_f32 v[94:95], v[58:59], v[62:63]
    v_pk_add_f32 v[56:57], v[36:37], v[40:41]
    v_pk_add_f32 v[58:59], v[38:39], v[42:43]
    v_pk_add_f32 v[36:37], v[36:37], v[40:41] neg_lo:[0,1] neg_hi:[0,1]
    v_pk_add_f32 v[38:39], v[38:39], v[42:43] neg_lo:[0,1] neg_hi:[0,1]
    v_pk_add_f32 v[76:77], v[44:45], v[48:49]
    v_pk_add_f32 v[78:79], v[46:47], v[50:51]
    v_pk_add_f32 v[44:45], v[44:45], v[48:49] neg_lo:[0,1] neg_hi:[0,1]
    v_pk_add_f32 v[46:47], v[46:47], v[50:51] neg_lo:[0,1] neg_hi:[0,1]
    v_pk_fma_f32 v[76:77], v[56:57], s[4:5], v[76:77]
    v_pk_fma_f32 v[78:79], v[58:59], s[4:5], v[78:79]
    v_pk_fma_f32 v[52:53], v[32:33], s[10:11], v[52:53]
    v_pk_fma_f32 v[54:55], v[34:35], s[10:11], v[54:55]
    v_pk_fma_f32 v[76:77], v[32:33], s[6:7], v[76:77]
    v_pk_fma_f32 v[78:79], v[34:35], s[6:7], v[78:79]
    v_pk_add_f32 v[56:57], v[56:57], v[32:33] neg_lo:[0,1] neg_hi:[0,1]
    v_pk_add_f32 v[58:59], v[58:59], v[34:35] neg_lo:[0,1] neg_hi:[0,1]
    v_pk_fma_f32 v[76:77], v[92:93], s[8:9], v[76:77]
    v_pk_fma_f32 v[78:79], v[94:95], s[8:9], v[78:79]
    v_pk_add_f32 v[56:57], v[56:57], v[92:93] neg_lo:[0,1] neg_hi:[0,1]
    v_pk_add_f32 v[58:59], v[58:59], v[94:95] neg_lo:[0,1] neg_hi:[0,1]
    v_pk_fma_f32 v[52:53], v[92:93], s[22:23], v[52:53]
    v_pk_fma_f32 v[54:55], v[94:95], s[22:23], v[54:55]
    v_pk_add_f32 v[40:41], v[56:57], v[76:77] neg_lo:[0,1] neg_hi:[0,1]
    v_pk_add_f32 v[42:43], v[58:59], v[78:79] neg_lo:[0,1] neg_hi:[0,1]
    v_pk_fma_f32 v[52:53], v[76:77], s[14:15], v[52:53]
    v_pk_fma_f32 v[54:55], v[78:79], s[14:15], v[54:55]
    v_pk_mul_f32 v[84:85], v[44:45], s[32:33]
    v_pk_mul_f32 v[86:87], v[46:47], s[32:33]
    v_pk_fma_f32 v[52:53], v[40:41], s[12:13], v[52:53]
    v_pk_fma_f32 v[54:55], v[42:43], s[12:13], v[54:55]
    v_pk_fma_f32 v[84:85], v[36:37], s[34:35], v[84:85]
    v_pk_fma_f32 v[86:87], v[38:39], s[34:35], v[86:87]
    v_pk_fma_f32 v[68:69], v[36:37], s[24:25], v[52:53] neg_lo:[0,0,1] neg_hi:[0,0,1]
    v_pk_fma_f32 v[70:71], v[38:39], s[24:25], v[54:55] neg_lo:[0,0,1] neg_hi:[0,0,1]
    v_pk_fma_f32 v[68:69], v[44:45], s[26:27], v[68:69]
    v_pk_fma_f32 v[70:71], v[46:47], s[26:27], v[70:71]
    v_pk_fma_f32 v[84:85], v[68:69], s[38:39], v[84:85]
    v_pk_fma_f32 v[86:87], v[70:71], s[38:39], v[86:87]
    v_pk_add_f32 v[36:37], v[36:37], v[68:69] neg_lo:[0,1] neg_hi:[0,1]
    v_pk_add_f32 v[38:39], v[38:39], v[70:71] neg_lo:[0,1] neg_hi:[0,1]
    v_pk_add_f32 v[36:37], v[36:37], v[84:85] neg_lo:[0,1] neg_hi:[0,1]
    v_pk_add_f32 v[38:39], v[38:39], v[86:87] neg_lo:[0,1] neg_hi:[0,1]
    s_mov_b32 s36, 0x00010001
    s_mov_b32 s37, 0x00010001
    s_mov_b64 exec, s[36:37]
    ds_write_b128 v127, v[0:3] offset:0
    ds_write_b128 v127, v[32:35] offset:16
    ds_write_b128 v127, v[4:7] offset:32
    ds_write_b128 v127, v[36:39] offset:48
    ds_write_b128 v127, v[8:11] offset:64
    ds_write_b128 v127, v[40:43] offset:80
    s_mov_b64 exec, -1
    v_mov_b32 v44, 0xc0135761
    v_mov_b32 v45, v44
    v_pk_mul_f32 v[16:17], v[64:65], v[64:65]
    v_pk_mul_f32 v[18:19], v[66:67], v[66:67]
    v_pk_mul_f32 v[20:21], v[68:69], v[68:69]
    v_pk_mul_f32 v[22:23], v[70:71], v[70:71]
    v_pk_fma_f32 v[16:17], v[16:17], s[40:41], v[44:45]
    v_pk_fma_f32 v[18:19], v[18:19], s[40:41], v[44:45]
    v_pk_fma_f32 v[20:21], v[20:21], s[40:41], v[44:45]
    v_pk_fma_f32 v[22:23], v[22:23], s[40:41], v[44:45]
    v_pk_mul_f32 v[16:17], v[16:17], v[64:65]
    v_pk_mul_f32 v[18:19], v[18:19], v[66:67]
    v_pk_mul_f32 v[20:21], v[20:21], v[68:69]
    v_pk_mul_f32 v[22:23], v[22:23], v[70:71]
    v_exp_f32 v16, v16
    v_exp_f32 v17, v17
    v_exp_f32 v18, v18
    v_exp_f32 v19, v19
    v_exp_f32 v20, v20
    v_exp_f32 v21, v21
    v_exp_f32 v22, v22
    v_exp_f32 v23, v23
    v_pk_add_f32 v[16:17], v[16:17], s[42:43]
    v_pk_add_f32 v[18:19], v[18:19], s[42:43]
    v_pk_add_f32 v[20:21], v[20:21], s[42:43]
    v_pk_add_f32 v[22:23], v[22:23], s[42:43]
    v_rcp_f32 v16, v16
    v_rcp_f32 v17, v17
    v_rcp_f32 v18, v18
    v_rcp_f32 v19, v19
    v_rcp_f32 v20, v20
    v_rcp_f32 v21, v21
    v_rcp_f32 v22, v22
    v_rcp_f32 v23, v23
    v_pk_mul_f32 v[64:65], v[64:65], v[16:17]
    v_pk_mul_f32 v[66:67], v[66:67], v[18:19]
    v_pk_mul_f32 v[68:69], v[68:69], v[20:21]
    v_pk_mul_f32 v[70:71], v[70:71], v[22:23]
    v_cvt_pk_bf16_f32 v48, v64, v68
    v_cvt_pk_bf16_f32 v49, v65, v69
    v_cvt_pk_bf16_f32 v50, v66, v70
    v_cvt_pk_bf16_f32 v51, v67, v71
    s_mov_b32 s44, 393280
    buffer_store_dwordx4 v[48:51], v122, s[16:19], s44 offen sc1
    s_waitcnt lgkmcnt(0)
    s_barrier
    ds_read_b128 v[96:99], v127 offset:512
    ds_read_b128 v[100:103], v127 offset:528
    ds_read_b128 v[104:107], v127 offset:544
    ds_read_b128 v[108:111], v127 offset:560
    ds_read_b128 v[112:115], v127 offset:576
    ds_read_b128 v[116:119], v127 offset:592
    s_waitcnt lgkmcnt(4)
    v_mov_b32_dpp v96, v0 row_shl:1 row_mask:0xf bank_mask:0xf
    v_mov_b32_dpp v97, v1 row_shl:1 row_mask:0xf bank_mask:0xf
    v_mov_b32_dpp v98, v2 row_shl:1 row_mask:0xf bank_mask:0xf
    v_mov_b32_dpp v99, v3 row_shl:1 row_mask:0xf bank_mask:0xf
    v_mov_b32_dpp v100, v32 row_shl:1 row_mask:0xf bank_mask:0xf
    v_mov_b32_dpp v101, v33 row_shl:1 row_mask:0xf bank_mask:0xf
    v_mov_b32_dpp v102, v34 row_shl:1 row_mask:0xf bank_mask:0xf
    v_mov_b32_dpp v103, v35 row_shl:1 row_mask:0xf bank_mask:0xf
    v_pk_add_f32 v[72:73], v[72:73], v[96:97]
    v_pk_add_f32 v[74:75], v[74:75], v[98:99]
    v_pk_add_f32 v[76:77], v[76:77], v[100:101]
    v_pk_add_f32 v[78:79], v[78:79], v[102:103]
    v_pk_mul_f32 v[24:25], v[72:73], v[72:73]
    v_pk_mul_f32 v[26:27], v[74:75], v[74:75]
    v_pk_mul_f32 v[28:29], v[76:77], v[76:77]
    v_pk_mul_f32 v[30:31], v[78:79], v[78:79]
    v_pk_fma_f32 v[24:25], v[24:25], s[40:41], v[44:45]
    v_pk_fma_f32 v[26:27], v[26:27], s[40:41], v[44:45]
    v_pk_fma_f32 v[28:29], v[28:29], s[40:41], v[44:45]
    v_pk_fma_f32 v[30:31], v[30:31], s[40:41], v[44:45]
    v_pk_mul_f32 v[24:25], v[24:25], v[72:73]
    v_pk_mul_f32 v[26:27], v[26:27], v[74:75]
    v_pk_mul_f32 v[28:29], v[28:29], v[76:77]
    v_pk_mul_f32 v[30:31], v[30:31], v[78:79]
    v_exp_f32 v24, v24
    v_exp_f32 v25, v25
    v_exp_f32 v26, v26
    v_exp_f32 v27, v27
    v_exp_f32 v28, v28
    v_exp_f32 v29, v29
    v_exp_f32 v30, v30
    v_exp_f32 v31, v31
    v_pk_add_f32 v[24:25], v[24:25], s[42:43]
    v_pk_add_f32 v[26:27], v[26:27], s[42:43]
    v_pk_add_f32 v[28:29], v[28:29], s[42:43]
    v_pk_add_f32 v[30:31], v[30:31], s[42:43]
    v_rcp_f32 v24, v24
    v_rcp_f32 v25, v25
    v_rcp_f32 v26, v26
    v_rcp_f32 v27, v27
    v_rcp_f32 v28, v28
    v_rcp_f32 v29, v29
    v_rcp_f32 v30, v30
    v_rcp_f32 v31, v31
    v_pk_mul_f32 v[72:73], v[72:73], v[24:25]
    v_pk_mul_f32 v[74:75], v[74:75], v[26:27]
    v_pk_mul_f32 v[76:77], v[76:77], v[28:29]
    v_pk_mul_f32 v[78:79], v[78:79], v[30:31]
    v_cvt_pk_bf16_f32 v52, v72, v76
    v_cvt_pk_bf16_f32 v53, v73, v77
    v_cvt_pk_bf16_f32 v54, v74, v78
    v_cvt_pk_bf16_f32 v55, v75, v79
    s_mov_b32 s44, 128
    buffer_store_dwordx4 v[52:55], v122, s[16:19], s44 offen sc1
    s_waitcnt lgkmcnt(2)
    v_mov_b32_dpp v104, v4 row_shl:1 row_mask:0xf bank_mask:0xf
    v_mov_b32_dpp v105, v5 row_shl:1 row_mask:0xf bank_mask:0xf
    v_mov_b32_dpp v106, v6 row_shl:1 row_mask:0xf bank_mask:0xf
    v_mov_b32_dpp v107, v7 row_shl:1 row_mask:0xf bank_mask:0xf
    v_mov_b32_dpp v108, v36 row_shl:1 row_mask:0xf bank_mask:0xf
    v_mov_b32_dpp v109, v37 row_shl:1 row_mask:0xf bank_mask:0xf
    v_mov_b32_dpp v110, v38 row_shl:1 row_mask:0xf bank_mask:0xf
    v_mov_b32_dpp v111, v39 row_shl:1 row_mask:0xf bank_mask:0xf
    v_pk_add_f32 v[80:81], v[80:81], v[104:105]
    v_pk_add_f32 v[82:83], v[82:83], v[106:107]
    v_pk_add_f32 v[84:85], v[84:85], v[108:109]
    v_pk_add_f32 v[86:87], v[86:87], v[110:111]
    v_pk_mul_f32 v[16:17], v[80:81], v[80:81]
    v_pk_mul_f32 v[18:19], v[82:83], v[82:83]
    v_pk_mul_f32 v[20:21], v[84:85], v[84:85]
    v_pk_mul_f32 v[22:23], v[86:87], v[86:87]
    v_pk_fma_f32 v[16:17], v[16:17], s[40:41], v[44:45]
    v_pk_fma_f32 v[18:19], v[18:19], s[40:41], v[44:45]
    v_pk_fma_f32 v[20:21], v[20:21], s[40:41], v[44:45]
    v_pk_fma_f32 v[22:23], v[22:23], s[40:41], v[44:45]
    v_pk_mul_f32 v[16:17], v[16:17], v[80:81]
    v_pk_mul_f32 v[18:19], v[18:19], v[82:83]
    v_pk_mul_f32 v[20:21], v[20:21], v[84:85]
    v_pk_mul_f32 v[22:23], v[22:23], v[86:87]
    v_exp_f32 v16, v16
    v_exp_f32 v17, v17
    v_exp_f32 v18, v18
    v_exp_f32 v19, v19
    v_exp_f32 v20, v20
    v_exp_f32 v21, v21
    v_exp_f32 v22, v22
    v_exp_f32 v23, v23
    v_pk_add_f32 v[16:17], v[16:17], s[42:43]
    v_pk_add_f32 v[18:19], v[18:19], s[42:43]
    v_pk_add_f32 v[20:21], v[20:21], s[42:43]
    v_pk_add_f32 v[22:23], v[22:23], s[42:43]
    v_rcp_f32 v16, v16
    v_rcp_f32 v17, v17
    v_rcp_f32 v18, v18
    v_rcp_f32 v19, v19
    v_rcp_f32 v20, v20
    v_rcp_f32 v21, v21
    v_rcp_f32 v22, v22
    v_rcp_f32 v23, v23
    v_pk_mul_f32 v[80:81], v[80:81], v[16:17]
    v_pk_mul_f32 v[82:83], v[82:83], v[18:19]
    v_pk_mul_f32 v[84:85], v[84:85], v[20:21]
    v_pk_mul_f32 v[86:87], v[86:87], v[22:23]
    v_cvt_pk_bf16_f32 v56, v80, v84
    v_cvt_pk_bf16_f32 v57, v81, v85
    v_cvt_pk_bf16_f32 v58, v82, v86
    v_cvt_pk_bf16_f32 v59, v83, v87
    s_mov_b32 s44, 131200
    buffer_store_dwordx4 v[56:59], v122, s[16:19], s44 offen sc1
    s_waitcnt lgkmcnt(0)
    v_mov_b32_dpp v112, v8 row_shl:1 row_mask:0xf bank_mask:0xf
    v_mov_b32_dpp v113, v9 row_shl:1 row_mask:0xf bank_mask:0xf
    v_mov_b32_dpp v114, v10 row_shl:1 row_mask:0xf bank_mask:0xf
    v_mov_b32_dpp v115, v11 row_shl:1 row_mask:0xf bank_mask:0xf
    v_mov_b32_dpp v116, v40 row_shl:1 row_mask:0xf bank_mask:0xf
    v_mov_b32_dpp v117, v41 row_shl:1 row_mask:0xf bank_mask:0xf
    v_mov_b32_dpp v118, v42 row_shl:1 row_mask:0xf bank_mask:0xf
    v_mov_b32_dpp v119, v43 row_shl:1 row_mask:0xf bank_mask:0xf
    v_pk_add_f32 v[88:89], v[88:89], v[112:113]
    v_pk_add_f32 v[90:91], v[90:91], v[114:115]
    v_pk_add_f32 v[92:93], v[92:93], v[116:117]
    v_pk_add_f32 v[94:95], v[94:95], v[118:119]
    v_pk_mul_f32 v[24:25], v[88:89], v[88:89]
    v_pk_mul_f32 v[26:27], v[90:91], v[90:91]
    v_pk_mul_f32 v[28:29], v[92:93], v[92:93]
    v_pk_mul_f32 v[30:31], v[94:95], v[94:95]
    v_pk_fma_f32 v[24:25], v[24:25], s[40:41], v[44:45]
    v_pk_fma_f32 v[26:27], v[26:27], s[40:41], v[44:45]
    v_pk_fma_f32 v[28:29], v[28:29], s[40:41], v[44:45]
    v_pk_fma_f32 v[30:31], v[30:31], s[40:41], v[44:45]
    v_pk_mul_f32 v[24:25], v[24:25], v[88:89]
    v_pk_mul_f32 v[26:27], v[26:27], v[90:91]
    v_pk_mul_f32 v[28:29], v[28:29], v[92:93]
    v_pk_mul_f32 v[30:31], v[30:31], v[94:95]
    v_exp_f32 v24, v24
    v_exp_f32 v25, v25
    v_exp_f32 v26, v26
    v_exp_f32 v27, v27
    v_exp_f32 v28, v28
    v_exp_f32 v29, v29
    v_exp_f32 v30, v30
    v_exp_f32 v31, v31
    v_pk_add_f32 v[24:25], v[24:25], s[42:43]
    v_pk_add_f32 v[26:27], v[26:27], s[42:43]
    v_pk_add_f32 v[28:29], v[28:29], s[42:43]
    v_pk_add_f32 v[30:31], v[30:31], s[42:43]
    v_rcp_f32 v24, v24
    v_rcp_f32 v25, v25
    v_rcp_f32 v26, v26
    v_rcp_f32 v27, v27
    v_rcp_f32 v28, v28
    v_rcp_f32 v29, v29
    v_rcp_f32 v30, v30
    v_rcp_f32 v31, v31
    v_pk_mul_f32 v[88:89], v[88:89], v[24:25]
    v_pk_mul_f32 v[90:91], v[90:91], v[26:27]
    v_pk_mul_f32 v[92:93], v[92:93], v[28:29]
    v_pk_mul_f32 v[94:95], v[94:95], v[30:31]
    v_cvt_pk_bf16_f32 v60, v88, v92
    v_cvt_pk_bf16_f32 v61, v89, v93
    v_cvt_pk_bf16_f32 v62, v90, v94
    v_cvt_pk_bf16_f32 v63, v91, v95
    s_mov_b32 s44, 262272
    buffer_store_dwordx4 v[60:63], v122, s[16:19], s44 offen sc1
L_conv1_kernel_end:
L_conv1_kernel_done:
    s_endpgm
.globl conv2_kernel
.p2align 8
.type conv2_kernel,@function
conv2_kernel:
    s_cmp_ge_u32 s2, 256
    s_cbranch_scc1 L_conv2_kernel_done
    s_load_dwordx2 s[4:5], s[0:1], 72
    s_load_dwordx2 s[30:31], s[0:1], 72
    v_readfirstlane_b32 s20, v0
    s_lshr_b32 s20, s20, 6
    s_xor_b32 s20, s20, 8
    s_and_b32 s36, s2, 0
    s_lshl_b32 s36, s36, 3
    s_bfe_u32 s37, s2, 196611
    s_or_b32 s29, s36, s37
    s_bfe_u32 s36, s2, 196608
    s_lshl_b32 s36, s36, 2
    s_lshr_b32 s37, s2, 6
    s_or_b32 s36, s36, s37
    s_lshr_b32 s33, s36, 4
    s_and_b32 s34, s36, 7
    s_bfe_u32 s35, s36, 0x10003
    s_mul_i32 s21, s34, 500
    s_and_b32 s32, s20, 3
    v_and_b32 v127, 63, v0
    v_lshrrev_b32 v5, 2, v127
    v_and_b32 v6, 3, v127
    s_and_b32 s42, s20, 7
    s_lshr_b32 s41, s21, 2
    s_sub_u32 s41, s41, 1
    s_add_u32 s37, s41, s42
    v_lshl_add_u32 v7, v5, 3, s37
    s_mul_i32 s36, s35, 4194304
    s_add_u32 s36, s36, 18874368
    s_mov_b32 s10, 4194304
    s_mov_b32 s11, 0x00020000
    s_mov_b32 s25, 0xffff0000
    s_mov_b32 s47, s36
    s_cmp_ge_u32 s20, 8
    s_cbranch_scc1 L_conv2_kernel_helper
    s_add_u32 s37, s41, 128
    v_mov_b32 v16, s37
    v_mul_u32_u24 v17, 524288, v5
    v_lshl_add_u32 v17, v6, 4, v17
    s_add_u32 s37, s33, 4294967289
    v_lshl_add_u32 v18, v16, 3, s37
    v_cmp_gt_u32 vcc, 8000, v18
    s_mul_i32 s37, s33, 131072
    s_add_u32 s37, s37, 0
    v_lshl_add_u32 v108, v16, 7, s37
    v_add_u32 v108, v108, v17
    v_mov_b32 v18, 2130706432
    v_cndmask_b32 v108, v18, v108, vcc
    s_add_u32 s37, s33, 4294967291
    v_lshl_add_u32 v18, v16, 3, s37
    v_cmp_gt_u32 vcc, 8000, v18
    s_mul_i32 s37, s33, 131072
    s_add_u32 s37, s37, 262144
    v_lshl_add_u32 v109, v16, 7, s37
    v_add_u32 v109, v109, v17
    v_mov_b32 v18, 2130706432
    v_cndmask_b32 v109, v18, v109, vcc
    s_add_u32 s37, s33, 4294967293
    v_lshl_add_u32 v18, v16, 3, s37
    v_cmp_gt_u32 vcc, 8000, v18
    s_mul_i32 s37, s33, 131072
    s_add_u32 s37, s37, 64
    v_lshl_add_u32 v110, v16, 7, s37
    v_add_u32 v110, v110, v17
    v_mov_b32 v18, 2130706432
    v_cndmask_b32 v110, v18, v110, vcc
    s_waitcnt lgkmcnt(0)
    s_add_u32 s8, s4, s47
    s_addc_u32 s9, s5, 0
    s_lshl_b32 s36, s29, 4
    s_lshl_b32 s37, s33, 3
    s_add_u32 s36, s36, s37
    s_mul_i32 s36, s36, 57344
    s_add_u32 s36, s36, 9437184
    s_add_u32 s12, s30, s36
    s_addc_u32 s13, s31, 0
    s_mov_b32 s14, 458752
    s_mov_b32 s15, 0x00020000
    s_mul_i32 s36, s35, 2097152
    s_add_u32 s36, s36, 27262976
    s_mul_i32 s37, s33, 8388608
    s_add_u32 s36, s36, s37
    s_add_u32 s16, s30, s36
    s_addc_u32 s17, s31, 0
    s_mov_b32 s18, 2097152
    s_mov_b32 s19, 0x00020000
    v_and_b32 v10, 15, v127
    v_lshrrev_b32 v11, 4, v127
    v_add_u32 v8, 0, v10
    v_and_b32 v16, 4, v8
    v_lshrrev_b32 v16, 1, v16
    v_xor_b32 v16, v11, v16
    v_lshlrev_b32 v16, 4, v16
    v_lshl_add_u32 v8, v8, 6, v16
    v_add_u32 v9, 1, v10
    v_and_b32 v16, 4, v9
    v_lshrrev_b32 v16, 1, v16
    v_xor_b32 v16, v11, v16
    v_lshlrev_b32 v16, 4, v16
    v_lshl_add_u32 v9, v9, 6, v16
    s_lshr_b32 s38, s32, 1
    s_and_b32 s39, s32, 1
    s_add_u32 s40, s38, 4
    s_lshl_b32 s43, s39, 10
    s_cmp_lt_u32 s20, 4
    s_cselect_b32 s40, s20, s40
    s_cselect_b32 s36, 0, s43
    s_lshl_b32 s37, s40, 13
    s_add_u32 s37, s37, s36
    v_lshl_add_u32 v125, v127, 4, s37
    s_mul_i32 s37, s40, 16384
    v_add_u32 v120, s37, v8
    v_add_u32 v121, s37, v9
    s_lshl_b32 s37, s40, 10
    s_add_u32 s37, s37, 115712
    v_lshl_add_u32 v16, v11, 4, s37
    v_cmp_eq_u32 vcc, 15, v10
    v_mov_b32 v17, 8192
    v_mov_b32 v18, 4294959104
    v_mov_b32 v19, 64
    v_cndmask_b32 v122, v121, v16, vcc
    v_cndmask_b32 v123, v17, v19, vcc
    v_cndmask_b32 v124, v18, v19, vcc
    v_lshl_add_u32 v126, v127, 4, s37
    s_mov_b32 s44, 0x3f800000
    s_mov_b32 s45, 0x00000000
    s_mov_b32 s46, 0x00000000
    s_cmp_eq_u32 s40, 1
    s_cselect_b32 s45, 0x3f800000, s45
    s_cselect_b32 s46, 0x3f800000, s46
    s_cmp_eq_u32 s40, 2
    s_cselect_b32 s45, 0xbf800000, s45
    s_cselect_b32 s46, 0x3f800000, s46
    s_cmp_eq_u32 s40, 3
    s_cselect_b32 s45, 0x40000000, s45
    s_cselect_b32 s46, 0x40800000, s46
    s_cmp_eq_u32 s40, 4
    s_cselect_b32 s45, 0xc0000000, s45
    s_cselect_b32 s46, 0x40800000, s46
    s_cmp_eq_u32 s40, 5
    s_cselect_b32 s44, 0x41800000, s44
    s_cselect_b32 s45, 0x41000000, s45
    s_cselect_b32 s46, 0x40800000, s46
    s_cmp_ge_u32 s20, 4
    s_cbranch_scc1 L_conv2_kernel_m2
    v_mov_b32 v0, 0
    v_mov_b32 v1, 0
    v_mov_b32 v2, 0
    v_mov_b32 v3, 0
    v_mov_b32 v4, 0
    v_mov_b32 v5, 0
    v_mov_b32 v6, 0
    v_mov_b32 v7, 0
    v_mov_b32 v8, 0
    v_mov_b32 v9, 0
    v_mov_b32 v10, 0
    v_mov_b32 v11, 0
    v_mov_b32 v12, 0
    v_mov_b32 v13, 0
    v_mov_b32 v14, 0
    v_mov_b32 v15, 0
    v_mov_b32 v16, 0
    v_mov_b32 v17, 0
    v_mov_b32 v18, 0
    v_mov_b32 v19, 0
    v_mov_b32 v20, 0
    v_mov_b32 v21, 0
    v_mov_b32 v22, 0
    v_mov_b32 v23, 0
    v_mov_b32 v24, 0
    v_mov_b32 v25, 0
    v_mov_b32 v26, 0
    v_mov_b32 v27, 0
    v_mov_b32 v28, 0
    v_mov_b32 v29, 0
    v_mov_b32 v30, 0
    v_mov_b32 v31, 0
    v_mov_b32 v32, 0
    v_mov_b32 v33, 0
    v_mov_b32 v34, 0
    v_mov_b32 v35, 0
    v_mov_b32 v36, 0
    v_mov_b32 v37, 0
    v_mov_b32 v38, 0
    v_mov_b32 v39, 0
    v_mov_b32 v40, 0
    v_mov_b32 v41, 0
    v_mov_b32 v42, 0
    v_mov_b32 v43, 0
    v_mov_b32 v44, 0
    v_mov_b32 v45, 0
    v_mov_b32 v46, 0
    v_mov_b32 v47, 0
    v_mov_b32 v48, 0
    v_mov_b32 v49, 0
    v_mov_b32 v50, 0
    v_mov_b32 v51, 0
    v_mov_b32 v52, 0
    v_mov_b32 v53, 0
    v_mov_b32 v54, 0
    v_mov_b32 v55, 0
    v_mov_b32 v56, 0
    v_mov_b32 v57, 0
    v_mov_b32 v58, 0
    v_mov_b32 v59, 0
    v_mov_b32 v60, 0
    v_mov_b32 v61, 0
    v_mov_b32 v62, 0
    v_mov_b32 v63, 0
    buffer_load_dwordx4 v[96:99], v108, s[8:11], 0 offen
    buffer_load_dwordx4 v[100:103], v109, s[8:11], 0 offen
    buffer_load_dwordx4 v[104:107], v110, s[8:11], 0 offen
    s_mov_b32 s23, 0
    s_mov_b32 s26, 4096
    buffer_load_dwordx4 v[64:67], v125, s[12:15], s23 offen offset:0
    buffer_load_dwordx4 v[68:71], v125, s[12:15], s23 offen offset:1024
    buffer_load_dwordx4 v[72:75], v125, s[12:15], s23 offen offset:2048
    buffer_load_dwordx4 v[76:79], v125, s[12:15], s23 offen offset:3072
    buffer_load_dwordx4 v[80:83], v125, s[12:15], s26 offen offset:0
    buffer_load_dwordx4 v[84:87], v125, s[12:15], s26 offen offset:1024
    buffer_load_dwordx4 v[88:91], v125, s[12:15], s26 offen offset:2048
    buffer_load_dwordx4 v[92:95], v125, s[12:15], s26 offen offset:3072
    s_mov_b32 s23, 57344
    s_mov_b32 s26, 61440
    s_waitcnt vmcnt(8)
    v_lshlrev_b32 v108, 16, v96
    v_and_b32 v111, s25, v96
    v_lshlrev_b32 v109, 16, v100
    v_and_b32 v112, s25, v100
    v_lshlrev_b32 v110, 16, v104
    v_and_b32 v113, s25, v104
    v_mul_f32 v114, s44, v108
    v_mul_f32 v115, s44, v111
    v_fmac_f32 v114, s45, v109
    v_fmac_f32 v115, s45, v112
    v_fmac_f32 v114, s46, v110
    v_fmac_f32 v115, s46, v113
    v_cvt_pk_bf16_f32 v96, v114, v115
    v_lshlrev_b32 v108, 16, v97
    v_and_b32 v111, s25, v97
    v_lshlrev_b32 v109, 16, v101
    v_and_b32 v112, s25, v101
    v_lshlrev_b32 v110, 16, v105
    v_and_b32 v113, s25, v105
    v_mul_f32 v114, s44, v108
    v_mul_f32 v115, s44, v111
    v_fmac_f32 v114, s45, v109
    v_fmac_f32 v115, s45, v112
    v_fmac_f32 v114, s46, v110
    v_fmac_f32 v115, s46, v113
    v_cvt_pk_bf16_f32 v97, v114, v115
    v_lshlrev_b32 v108, 16, v98
    v_and_b32 v111, s25, v98
    v_lshlrev_b32 v109, 16, v102
    v_and_b32 v112, s25, v102
    v_lshlrev_b32 v110, 16, v106
    v_and_b32 v113, s25, v106
    v_mul_f32 v114, s44, v108
    v_mul_f32 v115, s44, v111
    v_fmac_f32 v114, s45, v109
    v_fmac_f32 v115, s45, v112
    v_fmac_f32 v114, s46, v110
    v_fmac_f32 v115, s46, v113
    v_cvt_pk_bf16_f32 v98, v114, v115
    v_lshlrev_b32 v108, 16, v99
    v_and_b32 v111, s25, v99
    v_lshlrev_b32 v109, 16, v103
    v_and_b32 v112, s25, v103
    v_lshlrev_b32 v110, 16, v107
    v_and_b32 v113, s25, v107
    v_mul_f32 v114, s44, v108
    v_mul_f32 v115, s44, v111
    v_fmac_f32 v114, s45, v109
    v_fmac_f32 v115, s45, v112
    v_fmac_f32 v114, s46, v110
    v_fmac_f32 v115, s46, v113
    v_cvt_pk_bf16_f32 v99, v114, v115
    ds_write_b128 v126, v[96:99]
    s_waitcnt lgkmcnt(0)
    s_barrier
    s_mov_b32 s22, 4
    s_setprio 2
L_conv2_kernel_mloop1:
    ds_read_b128 v[96:99], v120 offset:0
    ds_read_b128 v[100:103], v120 offset:1024
    ds_read_b128 v[104:107], v120 offset:2048
    ds_read_b128 v[108:111], v120 offset:3072
    ds_read_b128 v[112:115], v120 offset:4096
    ds_read_b128 v[116:119], v120 offset:5120
    s_waitcnt vmcnt(6) lgkmcnt(5)
    v_mfma_f32_16x16x32_bf16 v[0:3], v[64:67], v[96:99], v[0:3]
    v_mfma_f32_16x16x32_bf16 v[32:35], v[68:71], v[96:99], v[32:35]
    ds_read_b128 v[96:99], v120 offset:6144
    s_waitcnt vmcnt(4) lgkmcnt(5)
    v_mfma_f32_16x16x32_bf16 v[4:7], v[64:67], v[100:103], v[4:7]
    v_mfma_f32_16x16x32_bf16 v[36:39], v[68:71], v[100:103], v[36:39]
    v_mfma_f32_16x16x32_bf16 v[0:3], v[72:75], v[100:103], v[0:3]
    v_mfma_f32_16x16x32_bf16 v[32:35], v[76:79], v[100:103], v[32:35]
    ds_read_b128 v[100:103], v120 offset:7168
    s_waitcnt vmcnt(2) lgkmcnt(5)
    v_mfma_f32_16x16x32_bf16 v[8:11], v[64:67], v[104:107], v[8:11]
    v_mfma_f32_16x16x32_bf16 v[40:43], v[68:71], v[104:107], v[40:43]
    v_mfma_f32_16x16x32_bf16 v[4:7], v[72:75], v[104:107], v[4:7]
    v_mfma_f32_16x16x32_bf16 v[36:39], v[76:79], v[104:107], v[36:39]
    v_mfma_f32_16x16x32_bf16 v[0:3], v[80:83], v[104:107], v[0:3]
    v_mfma_f32_16x16x32_bf16 v[32:35], v[84:87], v[104:107], v[32:35]
    ds_read_b128 v[104:107], v122 offset:0
    v_add_u32 v122, v123, v122
    s_waitcnt vmcnt(0) lgkmcnt(5)
    v_mfma_f32_16x16x32_bf16 v[12:15], v[64:67], v[108:111], v[12:15]
    v_mfma_f32_16x16x32_bf16 v[44:47], v[68:71], v[108:111], v[44:47]
    v_mfma_f32_16x16x32_bf16 v[8:11], v[72:75], v[108:111], v[8:11]
    v_mfma_f32_16x16x32_bf16 v[40:43], v[76:79], v[108:111], v[40:43]
    v_mfma_f32_16x16x32_bf16 v[4:7], v[80:83], v[108:111], v[4:7]
    v_mfma_f32_16x16x32_bf16 v[36:39], v[84:87], v[108:111], v[36:39]
    v_mfma_f32_16x16x32_bf16 v[0:3], v[88:91], v[108:111], v[0:3]
    v_mfma_f32_16x16x32_bf16 v[32:35], v[92:95], v[108:111], v[32:35]
    ds_read_b128 v[108:111], v121 offset:1024
    s_waitcnt lgkmcnt(5)
    v_mfma_f32_16x16x32_bf16 v[16:19], v[64:67], v[112:115], v[16:19]
    v_mfma_f32_16x16x32_bf16 v[48:51], v[68:71], v[112:115], v[48:51]
    v_mfma_f32_16x16x32_bf16 v[12:15], v[72:75], v[112:115], v[12:15]
    v_mfma_f32_16x16x32_bf16 v[44:47], v[76:79], v[112:115], v[44:47]
    v_mfma_f32_16x16x32_bf16 v[8:11], v[80:83], v[112:115], v[8:11]
    v_mfma_f32_16x16x32_bf16 v[40:43], v[84:87], v[112:115], v[40:43]
    v_mfma_f32_16x16x32_bf16 v[4:7], v[88:91], v[112:115], v[4:7]
    v_mfma_f32_16x16x32_bf16 v[36:39], v[92:95], v[112:115], v[36:39]
    ds_read_b128 v[112:115], v121 offset:2048
    s_waitcnt lgkmcnt(5)
    v_mfma_f32_16x16x32_bf16 v[20:23], v[64:67], v[116:119], v[20:23]
    v_mfma_f32_16x16x32_bf16 v[52:55], v[68:71], v[116:119], v[52:55]
    v_mfma_f32_16x16x32_bf16 v[16:19], v[72:75], v[116:119], v[16:19]
    v_mfma_f32_16x16x32_bf16 v[48:51], v[76:79], v[116:119], v[48:51]
    v_mfma_f32_16x16x32_bf16 v[12:15], v[80:83], v[116:119], v[12:15]
    v_mfma_f32_16x16x32_bf16 v[44:47], v[84:87], v[116:119], v[44:47]
    v_mfma_f32_16x16x32_bf16 v[8:11], v[88:91], v[116:119], v[8:11]
    v_mfma_f32_16x16x32_bf16 v[40:43], v[92:95], v[116:119], v[40:43]
    s_waitcnt lgkmcnt(4)
    v_mfma_f32_16x16x32_bf16 v[24:27], v[64:67], v[96:99], v[24:27]
    v_mfma_f32_16x16x32_bf16 v[56:59], v[68:71], v[96:99], v[56:59]
    v_mfma_f32_16x16x32_bf16 v[20:23], v[72:75], v[96:99], v[20:23]
    v_mfma_f32_16x16x32_bf16 v[52:55], v[76:79], v[96:99], v[52:55]
    v_mfma_f32_16x16x32_bf16 v[16:19], v[80:83], v[96:99], v[16:19]
    v_mfma_f32_16x16x32_bf16 v[48:51], v[84:87], v[96:99], v[48:51]
    v_mfma_f32_16x16x32_bf16 v[12:15], v[88:91], v[96:99], v[12:15]
    v_mfma_f32_16x16x32_bf16 v[44:47], v[92:95], v[96:99], v[44:47]
    s_waitcnt lgkmcnt(3)
    v_mfma_f32_16x16x32_bf16 v[28:31], v[64:67], v[100:103], v[28:31]
    v_mfma_f32_16x16x32_bf16 v[60:63], v[68:71], v[100:103], v[60:63]
    v_mfma_f32_16x16x32_bf16 v[24:27], v[72:75], v[100:103], v[24:27]
    v_mfma_f32_16x16x32_bf16 v[56:59], v[76:79], v[100:103], v[56:59]
    v_mfma_f32_16x16x32_bf16 v[20:23], v[80:83], v[100:103], v[20:23]
    v_mfma_f32_16x16x32_bf16 v[52:55], v[84:87], v[100:103], v[52:55]
    v_mfma_f32_16x16x32_bf16 v[16:19], v[88:91], v[100:103], v[16:19]
    v_mfma_f32_16x16x32_bf16 v[48:51], v[92:95], v[100:103], v[48:51]
    buffer_load_dwordx4 v[64:67], v125, s[12:15], s23 offen offset:0
    buffer_load_dwordx4 v[68:71], v125, s[12:15], s23 offen offset:1024
    s_waitcnt lgkmcnt(2)
    v_mfma_f32_16x16x32_bf16 v[28:31], v[72:75], v[104:107], v[28:31]
    v_mfma_f32_16x16x32_bf16 v[60:63], v[76:79], v[104:107], v[60:63]
    v_mfma_f32_16x16x32_bf16 v[24:27], v[80:83], v[104:107], v[24:27]
    v_mfma_f32_16x16x32_bf16 v[56:59], v[84:87], v[104:107], v[56:59]
    v_mfma_f32_16x16x32_bf16 v[20:23], v[88:91], v[104:107], v[20:23]
    v_mfma_f32_16x16x32_bf16 v[52:55], v[92:95], v[104:107], v[52:55]
    buffer_load_dwordx4 v[72:75], v125, s[12:15], s23 offen offset:2048
    buffer_load_dwordx4 v[76:79], v125, s[12:15], s23 offen offset:3072
    s_waitcnt lgkmcnt(1)
    v_mfma_f32_16x16x32_bf16 v[28:31], v[80:83], v[108:111], v[28:31]
    v_mfma_f32_16x16x32_bf16 v[60:63], v[84:87], v[108:111], v[60:63]
    v_mfma_f32_16x16x32_bf16 v[24:27], v[88:91], v[108:111], v[24:27]
    v_mfma_f32_16x16x32_bf16 v[56:59], v[92:95], v[108:111], v[56:59]
    buffer_load_dwordx4 v[80:83], v125, s[12:15], s26 offen offset:0
    buffer_load_dwordx4 v[84:87], v125, s[12:15], s26 offen offset:1024
    s_waitcnt lgkmcnt(0)
    v_mfma_f32_16x16x32_bf16 v[28:31], v[88:91], v[112:115], v[28:31]
    v_mfma_f32_16x16x32_bf16 v[60:63], v[92:95], v[112:115], v[60:63]
    buffer_load_dwordx4 v[88:91], v125, s[12:15], s26 offen offset:2048
    buffer_load_dwordx4 v[92:95], v125, s[12:15], s26 offen offset:3072
    s_add_u32 s23, s23, 57344
    s_add_u32 s26, s26, 57344
    s_barrier
    s_sub_u32 s22, s22, 1
    s_cmp_eq_u32 s22, 0
    s_cbranch_scc1 L_conv2_kernel_mlast1
    ds_read_b128 v[96:99], v120 offset:8192
    ds_read_b128 v[100:103], v120 offset:9216
    ds_read_b128 v[104:107], v120 offset:10240
    ds_read_b128 v[108:111], v120 offset:11264
    ds_read_b128 v[112:115], v120 offset:12288
    ds_read_b128 v[116:119], v120 offset:13312
    s_waitcnt vmcnt(6) lgkmcnt(5)
    v_mfma_f32_16x16x32_bf16 v[0:3], v[64:67], v[96:99], v[0:3]
    v_mfma_f32_16x16x32_bf16 v[32:35], v[68:71], v[96:99], v[32:35]
    ds_read_b128 v[96:99], v120 offset:14336
    s_waitcnt vmcnt(4) lgkmcnt(5)
    v_mfma_f32_16x16x32_bf16 v[4:7], v[64:67], v[100:103], v[4:7]
    v_mfma_f32_16x16x32_bf16 v[36:39], v[68:71], v[100:103], v[36:39]
    v_mfma_f32_16x16x32_bf16 v[0:3], v[72:75], v[100:103], v[0:3]
    v_mfma_f32_16x16x32_bf16 v[32:35], v[76:79], v[100:103], v[32:35]
    ds_read_b128 v[100:103], v120 offset:15360
    s_waitcnt vmcnt(2) lgkmcnt(5)
    v_mfma_f32_16x16x32_bf16 v[8:11], v[64:67], v[104:107], v[8:11]
    v_mfma_f32_16x16x32_bf16 v[40:43], v[68:71], v[104:107], v[40:43]
    v_mfma_f32_16x16x32_bf16 v[4:7], v[72:75], v[104:107], v[4:7]
    v_mfma_f32_16x16x32_bf16 v[36:39], v[76:79], v[104:107], v[36:39]
    v_mfma_f32_16x16x32_bf16 v[0:3], v[80:83], v[104:107], v[0:3]
    v_mfma_f32_16x16x32_bf16 v[32:35], v[84:87], v[104:107], v[32:35]
    ds_read_b128 v[104:107], v122 offset:0
    v_add_u32 v122, v124, v122
    s_waitcnt vmcnt(0) lgkmcnt(5)
    v_mfma_f32_16x16x32_bf16 v[12:15], v[64:67], v[108:111], v[12:15]
    v_mfma_f32_16x16x32_bf16 v[44:47], v[68:71], v[108:111], v[44:47]
    v_mfma_f32_16x16x32_bf16 v[8:11], v[72:75], v[108:111], v[8:11]
    v_mfma_f32_16x16x32_bf16 v[40:43], v[76:79], v[108:111], v[40:43]
    v_mfma_f32_16x16x32_bf16 v[4:7], v[80:83], v[108:111], v[4:7]
    v_mfma_f32_16x16x32_bf16 v[36:39], v[84:87], v[108:111], v[36:39]
    v_mfma_f32_16x16x32_bf16 v[0:3], v[88:91], v[108:111], v[0:3]
    v_mfma_f32_16x16x32_bf16 v[32:35], v[92:95], v[108:111], v[32:35]
    ds_read_b128 v[108:111], v121 offset:9216
    s_waitcnt lgkmcnt(5)
    v_mfma_f32_16x16x32_bf16 v[16:19], v[64:67], v[112:115], v[16:19]
    v_mfma_f32_16x16x32_bf16 v[48:51], v[68:71], v[112:115], v[48:51]
    v_mfma_f32_16x16x32_bf16 v[12:15], v[72:75], v[112:115], v[12:15]
    v_mfma_f32_16x16x32_bf16 v[44:47], v[76:79], v[112:115], v[44:47]
    v_mfma_f32_16x16x32_bf16 v[8:11], v[80:83], v[112:115], v[8:11]
    v_mfma_f32_16x16x32_bf16 v[40:43], v[84:87], v[112:115], v[40:43]
    v_mfma_f32_16x16x32_bf16 v[4:7], v[88:91], v[112:115], v[4:7]
    v_mfma_f32_16x16x32_bf16 v[36:39], v[92:95], v[112:115], v[36:39]
    ds_read_b128 v[112:115], v121 offset:10240
    s_waitcnt lgkmcnt(5)
    v_mfma_f32_16x16x32_bf16 v[20:23], v[64:67], v[116:119], v[20:23]
    v_mfma_f32_16x16x32_bf16 v[52:55], v[68:71], v[116:119], v[52:55]
    v_mfma_f32_16x16x32_bf16 v[16:19], v[72:75], v[116:119], v[16:19]
    v_mfma_f32_16x16x32_bf16 v[48:51], v[76:79], v[116:119], v[48:51]
    v_mfma_f32_16x16x32_bf16 v[12:15], v[80:83], v[116:119], v[12:15]
    v_mfma_f32_16x16x32_bf16 v[44:47], v[84:87], v[116:119], v[44:47]
    v_mfma_f32_16x16x32_bf16 v[8:11], v[88:91], v[116:119], v[8:11]
    v_mfma_f32_16x16x32_bf16 v[40:43], v[92:95], v[116:119], v[40:43]
    s_waitcnt lgkmcnt(4)
    v_mfma_f32_16x16x32_bf16 v[24:27], v[64:67], v[96:99], v[24:27]
    v_mfma_f32_16x16x32_bf16 v[56:59], v[68:71], v[96:99], v[56:59]
    v_mfma_f32_16x16x32_bf16 v[20:23], v[72:75], v[96:99], v[20:23]
    v_mfma_f32_16x16x32_bf16 v[52:55], v[76:79], v[96:99], v[52:55]
    v_mfma_f32_16x16x32_bf16 v[16:19], v[80:83], v[96:99], v[16:19]
    v_mfma_f32_16x16x32_bf16 v[48:51], v[84:87], v[96:99], v[48:51]
    v_mfma_f32_16x16x32_bf16 v[12:15], v[88:91], v[96:99], v[12:15]
    v_mfma_f32_16x16x32_bf16 v[44:47], v[92:95], v[96:99], v[44:47]
    s_waitcnt lgkmcnt(3)
    v_mfma_f32_16x16x32_bf16 v[28:31], v[64:67], v[100:103], v[28:31]
    v_mfma_f32_16x16x32_bf16 v[60:63], v[68:71], v[100:103], v[60:63]
    v_mfma_f32_16x16x32_bf16 v[24:27], v[72:75], v[100:103], v[24:27]
    v_mfma_f32_16x16x32_bf16 v[56:59], v[76:79], v[100:103], v[56:59]
    v_mfma_f32_16x16x32_bf16 v[20:23], v[80:83], v[100:103], v[20:23]
    v_mfma_f32_16x16x32_bf16 v[52:55], v[84:87], v[100:103], v[52:55]
    v_mfma_f32_16x16x32_bf16 v[16:19], v[88:91], v[100:103], v[16:19]
    v_mfma_f32_16x16x32_bf16 v[48:51], v[92:95], v[100:103], v[48:51]
    buffer_load_dwordx4 v[64:67], v125, s[12:15], s23 offen offset:0
    buffer_load_dwordx4 v[68:71], v125, s[12:15], s23 offen offset:1024
    s_waitcnt lgkmcnt(2)
    v_mfma_f32_16x16x32_bf16 v[28:31], v[72:75], v[104:107], v[28:31]
    v_mfma_f32_16x16x32_bf16 v[60:63], v[76:79], v[104:107], v[60:63]
    v_mfma_f32_16x16x32_bf16 v[24:27], v[80:83], v[104:107], v[24:27]
    v_mfma_f32_16x16x32_bf16 v[56:59], v[84:87], v[104:107], v[56:59]
    v_mfma_f32_16x16x32_bf16 v[20:23], v[88:91], v[104:107], v[20:23]
    v_mfma_f32_16x16x32_bf16 v[52:55], v[92:95], v[104:107], v[52:55]
    buffer_load_dwordx4 v[72:75], v125, s[12:15], s23 offen offset:2048
    buffer_load_dwordx4 v[76:79], v125, s[12:15], s23 offen offset:3072
    s_waitcnt lgkmcnt(1)
    v_mfma_f32_16x16x32_bf16 v[28:31], v[80:83], v[108:111], v[28:31]
    v_mfma_f32_16x16x32_bf16 v[60:63], v[84:87], v[108:111], v[60:63]
    v_mfma_f32_16x16x32_bf16 v[24:27], v[88:91], v[108:111], v[24:27]
    v_mfma_f32_16x16x32_bf16 v[56:59], v[92:95], v[108:111], v[56:59]
    buffer_load_dwordx4 v[80:83], v125, s[12:15], s26 offen offset:0
    buffer_load_dwordx4 v[84:87], v125, s[12:15], s26 offen offset:1024
    s_waitcnt lgkmcnt(0)
    v_mfma_f32_16x16x32_bf16 v[28:31], v[88:91], v[112:115], v[28:31]
    v_mfma_f32_16x16x32_bf16 v[60:63], v[92:95], v[112:115], v[60:63]
    buffer_load_dwordx4 v[88:91], v125, s[12:15], s26 offen offset:2048
    buffer_load_dwordx4 v[92:95], v125, s[12:15], s26 offen offset:3072
    s_add_u32 s23, s23, 57344
    s_add_u32 s26, s26, 57344
    s_barrier
    s_branch L_conv2_kernel_mloop1
L_conv2_kernel_mlast1:
    v_and_b32 v125, 15, v127
    v_and_b32 v126, 7, v127
    v_lshlrev_b32 v126, 4, v126
    v_lshl_add_u32 v125, v125, 7, v126
    v_lshrrev_b32 v126, 4, v127
    v_lshl_add_u32 v125, v126, 11, v125
    s_lshl_b32 s36, s20, 14
    s_add_u32 s37, s36, 8192
    v_add_u32 v126, s37, v125
    v_add_u32 v125, s36, v125
    ds_read_b128 v[96:99], v120 offset:8192
    ds_read_b128 v[100:103], v120 offset:9216
    ds_read_b128 v[104:107], v120 offset:10240
    ds_read_b128 v[108:111], v120 offset:11264
    ds_read_b128 v[112:115], v120 offset:12288
    ds_read_b128 v[116:119], v120 offset:13312
    s_waitcnt vmcnt(6) lgkmcnt(5)
    v_mfma_f32_16x16x32_bf16 v[0:3], v[64:67], v[96:99], v[0:3]
    v_mfma_f32_16x16x32_bf16 v[32:35], v[68:71], v[96:99], v[32:35]
    ds_read_b128 v[96:99], v120 offset:14336
    s_waitcnt vmcnt(4) lgkmcnt(5)
    v_mfma_f32_16x16x32_bf16 v[4:7], v[64:67], v[100:103], v[4:7]
    v_mfma_f32_16x16x32_bf16 v[36:39], v[68:71], v[100:103], v[36:39]
    v_mfma_f32_16x16x32_bf16 v[0:3], v[72:75], v[100:103], v[0:3]
    v_mfma_f32_16x16x32_bf16 v[32:35], v[76:79], v[100:103], v[32:35]
    ds_read_b128 v[100:103], v120 offset:15360
    s_waitcnt vmcnt(2) lgkmcnt(5)
    v_mfma_f32_16x16x32_bf16 v[8:11], v[64:67], v[104:107], v[8:11]
    v_mfma_f32_16x16x32_bf16 v[40:43], v[68:71], v[104:107], v[40:43]
    v_mfma_f32_16x16x32_bf16 v[4:7], v[72:75], v[104:107], v[4:7]
    v_mfma_f32_16x16x32_bf16 v[36:39], v[76:79], v[104:107], v[36:39]
    v_mfma_f32_16x16x32_bf16 v[0:3], v[80:83], v[104:107], v[0:3]
    v_mfma_f32_16x16x32_bf16 v[32:35], v[84:87], v[104:107], v[32:35]
    ds_read_b128 v[104:107], v122 offset:0
    s_waitcnt vmcnt(0) lgkmcnt(5)
    v_mfma_f32_16x16x32_bf16 v[12:15], v[64:67], v[108:111], v[12:15]
    v_mfma_f32_16x16x32_bf16 v[44:47], v[68:71], v[108:111], v[44:47]
    v_mfma_f32_16x16x32_bf16 v[8:11], v[72:75], v[108:111], v[8:11]
    v_mfma_f32_16x16x32_bf16 v[40:43], v[76:79], v[108:111], v[40:43]
    v_mfma_f32_16x16x32_bf16 v[4:7], v[80:83], v[108:111], v[4:7]
    v_mfma_f32_16x16x32_bf16 v[36:39], v[84:87], v[108:111], v[36:39]
    v_mfma_f32_16x16x32_bf16 v[0:3], v[88:91], v[108:111], v[0:3]
    v_mfma_f32_16x16x32_bf16 v[32:35], v[92:95], v[108:111], v[32:35]
    ds_read_b128 v[108:111], v121 offset:9216
    s_waitcnt lgkmcnt(5)
    v_mfma_f32_16x16x32_bf16 v[16:19], v[64:67], v[112:115], v[16:19]
    v_mfma_f32_16x16x32_bf16 v[48:51], v[68:71], v[112:115], v[48:51]
    v_mfma_f32_16x16x32_bf16 v[12:15], v[72:75], v[112:115], v[12:15]
    v_mfma_f32_16x16x32_bf16 v[44:47], v[76:79], v[112:115], v[44:47]
    v_mfma_f32_16x16x32_bf16 v[8:11], v[80:83], v[112:115], v[8:11]
    v_mfma_f32_16x16x32_bf16 v[40:43], v[84:87], v[112:115], v[40:43]
    v_mfma_f32_16x16x32_bf16 v[4:7], v[88:91], v[112:115], v[4:7]
    v_mfma_f32_16x16x32_bf16 v[36:39], v[92:95], v[112:115], v[36:39]
    ds_read_b128 v[112:115], v121 offset:10240
    v_xor_b32 v123, 0, v125
    ds_write_b128 v123, v[0:3]
    s_waitcnt lgkmcnt(6)
    v_mfma_f32_16x16x32_bf16 v[20:23], v[64:67], v[116:119], v[20:23]
    v_mfma_f32_16x16x32_bf16 v[52:55], v[68:71], v[116:119], v[52:55]
    v_mfma_f32_16x16x32_bf16 v[16:19], v[72:75], v[116:119], v[16:19]
    v_mfma_f32_16x16x32_bf16 v[48:51], v[76:79], v[116:119], v[48:51]
    v_mfma_f32_16x16x32_bf16 v[12:15], v[80:83], v[116:119], v[12:15]
    v_mfma_f32_16x16x32_bf16 v[44:47], v[84:87], v[116:119], v[44:47]
    v_mfma_f32_16x16x32_bf16 v[8:11], v[88:91], v[116:119], v[8:11]
    v_mfma_f32_16x16x32_bf16 v[40:43], v[92:95], v[116:119], v[40:43]
    v_xor_b32 v124, 16, v125
    ds_write_b128 v124, v[4:7]
    s_waitcnt lgkmcnt(2)
    v_mfma_f32_16x16x32_bf16 v[24:27], v[64:67], v[96:99], v[24:27]
    v_mfma_f32_16x16x32_bf16 v[56:59], v[68:71], v[96:99], v[56:59]
    v_mfma_f32_16x16x32_bf16 v[20:23], v[72:75], v[96:99], v[20:23]
    v_mfma_f32_16x16x32_bf16 v[52:55], v[76:79], v[96:99], v[52:55]
    v_mfma_f32_16x16x32_bf16 v[16:19], v[80:83], v[96:99], v[16:19]
    v_mfma_f32_16x16x32_bf16 v[48:51], v[84:87], v[96:99], v[48:51]
    v_mfma_f32_16x16x32_bf16 v[12:15], v[88:91], v[96:99], v[12:15]
    v_mfma_f32_16x16x32_bf16 v[44:47], v[92:95], v[96:99], v[44:47]
    v_xor_b32 v123, 32, v125
    ds_write_b128 v123, v[8:11]
    v_xor_b32 v124, 0, v126
    ds_write_b128 v124, v[32:35]
    v_mfma_f32_16x16x32_bf16 v[28:31], v[64:67], v[100:103], v[28:31]
    v_mfma_f32_16x16x32_bf16 v[60:63], v[68:71], v[100:103], v[60:63]
    v_mfma_f32_16x16x32_bf16 v[24:27], v[72:75], v[100:103], v[24:27]
    v_mfma_f32_16x16x32_bf16 v[56:59], v[76:79], v[100:103], v[56:59]
    v_mfma_f32_16x16x32_bf16 v[20:23], v[80:83], v[100:103], v[20:23]
    v_mfma_f32_16x16x32_bf16 v[52:55], v[84:87], v[100:103], v[52:55]
    v_mfma_f32_16x16x32_bf16 v[16:19], v[88:91], v[100:103], v[16:19]
    v_mfma_f32_16x16x32_bf16 v[48:51], v[92:95], v[100:103], v[48:51]
    v_xor_b32 v123, 16, v126
    ds_write_b128 v123, v[36:39]
    v_xor_b32 v124, 32, v126
    ds_write_b128 v124, v[40:43]
    v_mfma_f32_16x16x32_bf16 v[28:31], v[72:75], v[104:107], v[28:31]
    v_mfma_f32_16x16x32_bf16 v[60:63], v[76:79], v[104:107], v[60:63]
    v_mfma_f32_16x16x32_bf16 v[24:27], v[80:83], v[104:107], v[24:27]
    v_mfma_f32_16x16x32_bf16 v[56:59], v[84:87], v[104:107], v[56:59]
    v_mfma_f32_16x16x32_bf16 v[20:23], v[88:91], v[104:107], v[20:23]
    v_mfma_f32_16x16x32_bf16 v[52:55], v[92:95], v[104:107], v[52:55]
    v_xor_b32 v124, 48, v125
    ds_write_b128 v124, v[12:15]
    v_xor_b32 v123, 48, v126
    ds_write_b128 v123, v[44:47]
    v_mfma_f32_16x16x32_bf16 v[28:31], v[80:83], v[108:111], v[28:31]
    v_mfma_f32_16x16x32_bf16 v[60:63], v[84:87], v[108:111], v[60:63]
    v_mfma_f32_16x16x32_bf16 v[24:27], v[88:91], v[108:111], v[24:27]
    v_mfma_f32_16x16x32_bf16 v[56:59], v[92:95], v[108:111], v[56:59]
    v_xor_b32 v123, 64, v125
    ds_write_b128 v123, v[16:19]
    v_xor_b32 v124, 64, v126
    ds_write_b128 v124, v[48:51]
    v_mfma_f32_16x16x32_bf16 v[28:31], v[88:91], v[112:115], v[28:31]
    v_mfma_f32_16x16x32_bf16 v[60:63], v[92:95], v[112:115], v[60:63]
    v_xor_b32 v124, 80, v125
    ds_write_b128 v124, v[20:23]
    v_xor_b32 v123, 80, v126
    ds_write_b128 v123, v[52:55]
    v_and_b32 v108, 15, v127
    v_lshrrev_b32 v109, 4, v127
    v_lshrrev_b32 v110, 3, v108
    s_lshl_b32 s36, s20, 1
    v_add_u32 v110, s36, v110
    v_xor_b32 v111, v110, v108
    v_and_b32 v111, 7, v111
    v_lshlrev_b32 v111, 4, v111
    v_xor_b32 v123, 96, v125
    ds_write_b128 v123, v[24:27]
    v_lshl_add_u32 v111, v110, 7, v111
    v_lshl_add_u32 v120, v109, 11, v111
    v_add_u32 v121, 65536, v120
    v_add_u32 v64, 131072, v120
    s_lshl_b32 s36, s20, 9
    s_add_u32 s36, s36, 115712
    v_lshl_add_u32 v127, v109, 7, s36
    s_lshl_b32 s36, s20, 4
    v_add_u32 v108, s36, v108
    v_lshlrev_b32 v110, 6, v108
    v_lshl_add_u32 v110, v109, 4, v110
    s_mul_i32 s36, s29, 262144
    v_xor_b32 v124, 96, v126
    ds_write_b128 v124, v[56:59]
    s_lshl_b32 s37, s21, 4
    s_add_u32 s36, s36, s37
    v_add_u32 v110, s36, v110
    v_mov_b32 v111, 2130706432
    v_cmp_gt_u32 vcc, 125, v108
    s_mov_b32 s4, 0xbeaaaaab
    s_mov_b32 s5, s4
    s_mov_b32 s6, 0x3e800000
    s_mov_b32 s7, s6
    s_mov_b32 s8, 0xc0a00000
    s_mov_b32 s9, s8
    s_mov_b32 s10, 0xc0638e39
    v_xor_b32 v124, 112, v125
    ds_write_b128 v124, v[28:31]
    s_mov_b32 s11, s10
    s_mov_b32 s12, 0xbf638e39
    s_mov_b32 s13, s12
    s_mov_b32 s14, 0xbe638e39
    s_mov_b32 s15, s14
    s_mov_b32 s22, 0xbd638e39
    s_mov_b32 s23, s22
    s_mov_b32 s24, 0x3ff1c71c
    s_mov_b32 s25, s24
    s_mov_b32 s26, 0xbf2aaaab
    s_mov_b32 s27, s26
    s_mov_b32 s32, 0x3ecccccd
    v_xor_b32 v123, 112, v126
    s_waitcnt lgkmcnt(8)
    ds_write_b128 v123, v[60:63]
    s_mov_b32 s33, s32
    s_mov_b32 s34, 0xbd888889
    s_mov_b32 s35, s34
    s_mov_b32 s38, 0xbe4ccccd
    s_mov_b32 s39, s38
    s_mov_b32 s40, 0xbdd2d3e8
    s_mov_b32 s41, s40
    s_mov_b32 s42, 0x3f800000
    s_mov_b32 s43, s42
    s_setprio 0
    s_branch L_conv2_kernel_epi
L_conv2_kernel_m2:
    s_mul_i32 s37, s38, 2176
    s_add_u32 s37, s37, 98304
    v_add_u32 v116, s37, v8
    v_add_u32 v118, s37, v9
    v_add_u32 v117, 104832, v8
    s_cmp_eq_u32 s38, 0
    s_cbranch_scc1 L_conv2_kernel_hh0
    v_add_u32 v117, 98304, v9
L_conv2_kernel_hh0:
    s_lshl_b32 s37, s38, 12
    s_add_u32 s37, s37, s43
    s_add_u32 s37, s37, 49152
    v_lshl_add_u32 v119, v127, 4, s37
    v_mov_b32 v0, 0
    v_mov_b32 v1, 0
    v_mov_b32 v2, 0
    v_mov_b32 v3, 0
    v_mov_b32 v4, 0
    v_mov_b32 v5, 0
    v_mov_b32 v6, 0
    v_mov_b32 v7, 0
    v_mov_b32 v8, 0
    v_mov_b32 v9, 0
    v_mov_b32 v10, 0
    v_mov_b32 v11, 0
    v_mov_b32 v12, 0
    v_mov_b32 v13, 0
    v_mov_b32 v14, 0
    v_mov_b32 v15, 0
    v_mov_b32 v16, 0
    v_mov_b32 v17, 0
    v_mov_b32 v18, 0
    v_mov_b32 v19, 0
    v_mov_b32 v20, 0
    v_mov_b32 v21, 0
    v_mov_b32 v22, 0
    v_mov_b32 v23, 0
    v_mov_b32 v24, 0
    v_mov_b32 v25, 0
    v_mov_b32 v26, 0
    v_mov_b32 v27, 0
    v_mov_b32 v28, 0
    v_mov_b32 v29, 0
    v_mov_b32 v30, 0
    v_mov_b32 v31, 0
    v_mov_b32 v32, 0
    v_mov_b32 v33, 0
    v_mov_b32 v34, 0
    v_mov_b32 v35, 0
    v_mov_b32 v36, 0
    v_mov_b32 v37, 0
    v_mov_b32 v38, 0
    v_mov_b32 v39, 0
    v_mov_b32 v40, 0
    v_mov_b32 v41, 0
    v_mov_b32 v42, 0
    v_mov_b32 v43, 0
    v_mov_b32 v44, 0
    v_mov_b32 v45, 0
    v_mov_b32 v46, 0
    v_mov_b32 v47, 0
    v_mov_b32 v48, 0
    v_mov_b32 v49, 0
    v_mov_b32 v50, 0
    v_mov_b32 v51, 0
    v_mov_b32 v52, 0
    v_mov_b32 v53, 0
    v_mov_b32 v54, 0
    v_mov_b32 v55, 0
    v_mov_b32 v56, 0
    v_mov_b32 v57, 0
    v_mov_b32 v58, 0
    v_mov_b32 v59, 0
    v_mov_b32 v60, 0
    v_mov_b32 v61, 0
    v_mov_b32 v62, 0
    v_mov_b32 v63, 0
    buffer_load_dwordx4 v[96:99], v108, s[8:11], 0 offen
    buffer_load_dwordx4 v[100:103], v109, s[8:11], 0 offen
    buffer_load_dwordx4 v[104:107], v110, s[8:11], 0 offen
    s_mov_b32 s23, 0
    s_mov_b32 s26, 4096
    buffer_load_dwordx4 v[64:67], v125, s[12:15], s23 offen offset:0
    buffer_load_dwordx4 v[68:71], v125, s[12:15], s23 offen offset:2048
    buffer_load_dwordx4 v[80:83], v119, s[12:15], s23 offen offset:0
    buffer_load_dwordx4 v[72:75], v125, s[12:15], s26 offen offset:0
    buffer_load_dwordx4 v[84:87], v119, s[12:15], s23 offen offset:2048
    buffer_load_dwordx4 v[76:79], v125, s[12:15], s26 offen offset:2048
    s_mov_b32 s23, 57344
    s_mov_b32 s26, 61440
    s_waitcnt vmcnt(6)
    v_lshlrev_b32 v108, 16, v96
    v_and_b32 v111, s25, v96
    v_lshlrev_b32 v109, 16, v100
    v_and_b32 v112, s25, v100
    v_lshlrev_b32 v110, 16, v104
    v_and_b32 v113, s25, v104
    v_mul_f32 v114, s44, v108
    v_mul_f32 v115, s44, v111
    v_fmac_f32 v114, s45, v109
    v_fmac_f32 v115, s45, v112
    v_fmac_f32 v114, s46, v110
    v_fmac_f32 v115, s46, v113
    v_cvt_pk_bf16_f32 v96, v114, v115
    v_lshlrev_b32 v108, 16, v97
    v_and_b32 v111, s25, v97
    v_lshlrev_b32 v109, 16, v101
    v_and_b32 v112, s25, v101
    v_lshlrev_b32 v110, 16, v105
    v_and_b32 v113, s25, v105
    v_mul_f32 v114, s44, v108
    v_mul_f32 v115, s44, v111
    v_fmac_f32 v114, s45, v109
    v_fmac_f32 v115, s45, v112
    v_fmac_f32 v114, s46, v110
    v_fmac_f32 v115, s46, v113
    v_cvt_pk_bf16_f32 v97, v114, v115
    v_lshlrev_b32 v108, 16, v98
    v_and_b32 v111, s25, v98
    v_lshlrev_b32 v109, 16, v102
    v_and_b32 v112, s25, v102
    v_lshlrev_b32 v110, 16, v106
    v_and_b32 v113, s25, v106
    v_mul_f32 v114, s44, v108
    v_mul_f32 v115, s44, v111
    v_fmac_f32 v114, s45, v109
    v_fmac_f32 v115, s45, v112
    v_fmac_f32 v114, s46, v110
    v_fmac_f32 v115, s46, v113
    v_cvt_pk_bf16_f32 v98, v114, v115
    v_lshlrev_b32 v108, 16, v99
    v_and_b32 v111, s25, v99
    v_lshlrev_b32 v109, 16, v103
    v_and_b32 v112, s25, v103
    v_lshlrev_b32 v110, 16, v107
    v_and_b32 v113, s25, v107
    v_mul_f32 v114, s44, v108
    v_mul_f32 v115, s44, v111
    v_fmac_f32 v114, s45, v109
    v_fmac_f32 v115, s45, v112
    v_fmac_f32 v114, s46, v110
    v_fmac_f32 v115, s46, v113
    v_cvt_pk_bf16_f32 v99, v114, v115
    ds_write_b128 v126, v[96:99]
    v_and_b32 v111, 15, v127
    v_lshlrev_b32 v111, 2, v111
    v_add_u32 v111, 99328, v111
    ds_write_b32 v111, v0
    ds_write_b32 v111, v0 offset:8704
    s_waitcnt lgkmcnt(0)
    s_barrier
    s_mov_b32 s22, 4
    s_setprio 2
L_conv2_kernel_mloop2:
    ds_read_b128 v[88:91], v120 offset:0
    ds_read_b128 v[92:95], v120 offset:1024
    ds_read_b128 v[96:99], v116 offset:0
    ds_read_b128 v[100:103], v120 offset:2048
    ds_read_b128 v[104:107], v116 offset:1088
    ds_read_b128 v[108:111], v120 offset:3072
    ds_read_b128 v[112:115], v116 offset:2176
    s_waitcnt vmcnt(5) lgkmcnt(6)
    v_mfma_f32_16x16x32_bf16 v[0:3], v[64:67], v[88:91], v[0:3]
    ds_read_b128 v[88:91], v120 offset:4096
    s_waitcnt vmcnt(4) lgkmcnt(6)
    v_mfma_f32_16x16x32_bf16 v[4:7], v[64:67], v[92:95], v[4:7]
    v_mfma_f32_16x16x32_bf16 v[0:3], v[68:71], v[92:95], v[0:3]
    ds_read_b128 v[92:95], v116 offset:3264
    s_waitcnt vmcnt(3) lgkmcnt(6)
    v_mfma_f32_16x16x32_bf16 v[32:35], v[80:83], v[96:99], v[32:35]
    ds_read_b128 v[96:99], v120 offset:5120
    s_waitcnt vmcnt(2) lgkmcnt(6)
    v_mfma_f32_16x16x32_bf16 v[8:11], v[64:67], v[100:103], v[8:11]
    v_mfma_f32_16x16x32_bf16 v[4:7], v[68:71], v[100:103], v[4:7]
    v_mfma_f32_16x16x32_bf16 v[0:3], v[72:75], v[100:103], v[0:3]
    ds_read_b128 v[100:103], v116 offset:4352
    s_waitcnt vmcnt(1) lgkmcnt(6)
    v_mfma_f32_16x16x32_bf16 v[36:39], v[80:83], v[104:107], v[36:39]
    v_mfma_f32_16x16x32_bf16 v[32:35], v[84:87], v[104:107], v[32:35]
    ds_read_b128 v[104:107], v120 offset:6144
    s_waitcnt vmcnt(0) lgkmcnt(6)
    v_mfma_f32_16x16x32_bf16 v[12:15], v[64:67], v[108:111], v[12:15]
    v_mfma_f32_16x16x32_bf16 v[8:11], v[68:71], v[108:111], v[8:11]
    v_mfma_f32_16x16x32_bf16 v[4:7], v[72:75], v[108:111], v[4:7]
    v_mfma_f32_16x16x32_bf16 v[0:3], v[76:79], v[108:111], v[0:3]
    ds_read_b128 v[108:111], v116 offset:5440
    s_waitcnt lgkmcnt(6)
    v_mfma_f32_16x16x32_bf16 v[40:43], v[80:83], v[112:115], v[40:43]
    v_mfma_f32_16x16x32_bf16 v[36:39], v[84:87], v[112:115], v[36:39]
    ds_read_b128 v[112:115], v120 offset:7168
    s_waitcnt lgkmcnt(6)
    v_mfma_f32_16x16x32_bf16 v[16:19], v[64:67], v[88:91], v[16:19]
    v_mfma_f32_16x16x32_bf16 v[12:15], v[68:71], v[88:91], v[12:15]
    v_mfma_f32_16x16x32_bf16 v[8:11], v[72:75], v[88:91], v[8:11]
    v_mfma_f32_16x16x32_bf16 v[4:7], v[76:79], v[88:91], v[4:7]
    ds_read_b128 v[88:91], v117 offset:0
    s_waitcnt lgkmcnt(6)
    v_mfma_f32_16x16x32_bf16 v[44:47], v[80:83], v[92:95], v[44:47]
    v_mfma_f32_16x16x32_bf16 v[40:43], v[84:87], v[92:95], v[40:43]
    ds_read_b128 v[92:95], v122 offset:0
    v_add_u32 v122, v123, v122
    s_waitcnt lgkmcnt(6)
    v_mfma_f32_16x16x32_bf16 v[20:23], v[64:67], v[96:99], v[20:23]
    v_mfma_f32_16x16x32_bf16 v[16:19], v[68:71], v[96:99], v[16:19]
    v_mfma_f32_16x16x32_bf16 v[12:15], v[72:75], v[96:99], v[12:15]
    v_mfma_f32_16x16x32_bf16 v[8:11], v[76:79], v[96:99], v[8:11]
    ds_read_b128 v[96:99], v117 offset:1088
    s_waitcnt lgkmcnt(6)
    v_mfma_f32_16x16x32_bf16 v[48:51], v[80:83], v[100:103], v[48:51]
    v_mfma_f32_16x16x32_bf16 v[44:47], v[84:87], v[100:103], v[44:47]
    ds_read_b128 v[100:103], v121 offset:1024
    s_waitcnt lgkmcnt(6)
    v_mfma_f32_16x16x32_bf16 v[24:27], v[64:67], v[104:107], v[24:27]
    v_mfma_f32_16x16x32_bf16 v[20:23], v[68:71], v[104:107], v[20:23]
    v_mfma_f32_16x16x32_bf16 v[16:19], v[72:75], v[104:107], v[16:19]
    v_mfma_f32_16x16x32_bf16 v[12:15], v[76:79], v[104:107], v[12:15]
    ds_read_b128 v[104:107], v118 offset:0
    s_waitcnt lgkmcnt(6)
    v_mfma_f32_16x16x32_bf16 v[52:55], v[80:83], v[108:111], v[52:55]
    v_mfma_f32_16x16x32_bf16 v[48:51], v[84:87], v[108:111], v[48:51]
    ds_read_b128 v[108:111], v121 offset:2048
    s_waitcnt lgkmcnt(6)
    v_mfma_f32_16x16x32_bf16 v[28:31], v[64:67], v[112:115], v[28:31]
    v_mfma_f32_16x16x32_bf16 v[24:27], v[68:71], v[112:115], v[24:27]
    v_mfma_f32_16x16x32_bf16 v[20:23], v[72:75], v[112:115], v[20:23]
    v_mfma_f32_16x16x32_bf16 v[16:19], v[76:79], v[112:115], v[16:19]
    buffer_load_dwordx4 v[64:67], v125, s[12:15], s23 offen offset:0
    s_waitcnt lgkmcnt(5)
    v_mfma_f32_16x16x32_bf16 v[56:59], v[80:83], v[88:91], v[56:59]
    v_mfma_f32_16x16x32_bf16 v[52:55], v[84:87], v[88:91], v[52:55]
    s_waitcnt lgkmcnt(0)
    s_barrier
    v_mfma_f32_16x16x32_bf16 v[28:31], v[68:71], v[92:95], v[28:31]
    v_mfma_f32_16x16x32_bf16 v[24:27], v[72:75], v[92:95], v[24:27]
    v_mfma_f32_16x16x32_bf16 v[20:23], v[76:79], v[92:95], v[20:23]
    buffer_load_dwordx4 v[68:71], v125, s[12:15], s23 offen offset:2048
    v_mfma_f32_16x16x32_bf16 v[60:63], v[80:83], v[96:99], v[60:63]
    v_mfma_f32_16x16x32_bf16 v[56:59], v[84:87], v[96:99], v[56:59]
    buffer_load_dwordx4 v[80:83], v119, s[12:15], s23 offen offset:0
    v_mfma_f32_16x16x32_bf16 v[28:31], v[72:75], v[100:103], v[28:31]
    v_mfma_f32_16x16x32_bf16 v[24:27], v[76:79], v[100:103], v[24:27]
    buffer_load_dwordx4 v[72:75], v125, s[12:15], s26 offen offset:0
    v_mfma_f32_16x16x32_bf16 v[60:63], v[84:87], v[104:107], v[60:63]
    buffer_load_dwordx4 v[84:87], v119, s[12:15], s23 offen offset:2048
    v_mfma_f32_16x16x32_bf16 v[28:31], v[76:79], v[108:111], v[28:31]
    buffer_load_dwordx4 v[76:79], v125, s[12:15], s26 offen offset:2048
    s_add_u32 s23, s23, 57344
    s_add_u32 s26, s26, 57344
    s_sub_u32 s22, s22, 1
    s_cmp_eq_u32 s22, 0
    s_cbranch_scc1 L_conv2_kernel_mlast2
    ds_read_b128 v[88:91], v120 offset:8192
    ds_read_b128 v[92:95], v120 offset:9216
    ds_read_b128 v[96:99], v116 offset:8704
    ds_read_b128 v[100:103], v120 offset:10240
    ds_read_b128 v[104:107], v116 offset:9792
    ds_read_b128 v[108:111], v120 offset:11264
    ds_read_b128 v[112:115], v116 offset:10880
    s_waitcnt vmcnt(5) lgkmcnt(6)
    v_mfma_f32_16x16x32_bf16 v[0:3], v[64:67], v[88:91], v[0:3]
    ds_read_b128 v[88:91], v120 offset:12288
    s_waitcnt vmcnt(4) lgkmcnt(6)
    v_mfma_f32_16x16x32_bf16 v[4:7], v[64:67], v[92:95], v[4:7]
    v_mfma_f32_16x16x32_bf16 v[0:3], v[68:71], v[92:95], v[0:3]
    ds_read_b128 v[92:95], v116 offset:11968
    s_waitcnt vmcnt(3) lgkmcnt(6)
    v_mfma_f32_16x16x32_bf16 v[32:35], v[80:83], v[96:99], v[32:35]
    ds_read_b128 v[96:99], v120 offset:13312
    s_waitcnt vmcnt(2) lgkmcnt(6)
    v_mfma_f32_16x16x32_bf16 v[8:11], v[64:67], v[100:103], v[8:11]
    v_mfma_f32_16x16x32_bf16 v[4:7], v[68:71], v[100:103], v[4:7]
    v_mfma_f32_16x16x32_bf16 v[0:3], v[72:75], v[100:103], v[0:3]
    ds_read_b128 v[100:103], v116 offset:13056
    s_waitcnt vmcnt(1) lgkmcnt(6)
    v_mfma_f32_16x16x32_bf16 v[36:39], v[80:83], v[104:107], v[36:39]
    v_mfma_f32_16x16x32_bf16 v[32:35], v[84:87], v[104:107], v[32:35]
    ds_read_b128 v[104:107], v120 offset:14336
    s_waitcnt vmcnt(0) lgkmcnt(6)
    v_mfma_f32_16x16x32_bf16 v[12:15], v[64:67], v[108:111], v[12:15]
    v_mfma_f32_16x16x32_bf16 v[8:11], v[68:71], v[108:111], v[8:11]
    v_mfma_f32_16x16x32_bf16 v[4:7], v[72:75], v[108:111], v[4:7]
    v_mfma_f32_16x16x32_bf16 v[0:3], v[76:79], v[108:111], v[0:3]
    ds_read_b128 v[108:111], v116 offset:14144
    s_waitcnt lgkmcnt(6)
    v_mfma_f32_16x16x32_bf16 v[40:43], v[80:83], v[112:115], v[40:43]
    v_mfma_f32_16x16x32_bf16 v[36:39], v[84:87], v[112:115], v[36:39]
    ds_read_b128 v[112:115], v120 offset:15360
    s_waitcnt lgkmcnt(6)
    v_mfma_f32_16x16x32_bf16 v[16:19], v[64:67], v[88:91], v[16:19]
    v_mfma_f32_16x16x32_bf16 v[12:15], v[68:71], v[88:91], v[12:15]
    v_mfma_f32_16x16x32_bf16 v[8:11], v[72:75], v[88:91], v[8:11]
    v_mfma_f32_16x16x32_bf16 v[4:7], v[76:79], v[88:91], v[4:7]
    ds_read_b128 v[88:91], v117 offset:8704
    s_waitcnt lgkmcnt(6)
    v_mfma_f32_16x16x32_bf16 v[44:47], v[80:83], v[92:95], v[44:47]
    v_mfma_f32_16x16x32_bf16 v[40:43], v[84:87], v[92:95], v[40:43]
    ds_read_b128 v[92:95], v122 offset:0
    v_add_u32 v122, v124, v122
    s_waitcnt lgkmcnt(6)
    v_mfma_f32_16x16x32_bf16 v[20:23], v[64:67], v[96:99], v[20:23]
    v_mfma_f32_16x16x32_bf16 v[16:19], v[68:71], v[96:99], v[16:19]
    v_mfma_f32_16x16x32_bf16 v[12:15], v[72:75], v[96:99], v[12:15]
    v_mfma_f32_16x16x32_bf16 v[8:11], v[76:79], v[96:99], v[8:11]
    ds_read_b128 v[96:99], v117 offset:9792
    s_waitcnt lgkmcnt(6)
    v_mfma_f32_16x16x32_bf16 v[48:51], v[80:83], v[100:103], v[48:51]
    v_mfma_f32_16x16x32_bf16 v[44:47], v[84:87], v[100:103], v[44:47]
    ds_read_b128 v[100:103], v121 offset:9216
    s_waitcnt lgkmcnt(6)
    v_mfma_f32_16x16x32_bf16 v[24:27], v[64:67], v[104:107], v[24:27]
    v_mfma_f32_16x16x32_bf16 v[20:23], v[68:71], v[104:107], v[20:23]
    v_mfma_f32_16x16x32_bf16 v[16:19], v[72:75], v[104:107], v[16:19]
    v_mfma_f32_16x16x32_bf16 v[12:15], v[76:79], v[104:107], v[12:15]
    ds_read_b128 v[104:107], v118 offset:8704
    s_waitcnt lgkmcnt(6)
    v_mfma_f32_16x16x32_bf16 v[52:55], v[80:83], v[108:111], v[52:55]
    v_mfma_f32_16x16x32_bf16 v[48:51], v[84:87], v[108:111], v[48:51]
    ds_read_b128 v[108:111], v121 offset:10240
    s_waitcnt lgkmcnt(6)
    v_mfma_f32_16x16x32_bf16 v[28:31], v[64:67], v[112:115], v[28:31]
    v_mfma_f32_16x16x32_bf16 v[24:27], v[68:71], v[112:115], v[24:27]
    v_mfma_f32_16x16x32_bf16 v[20:23], v[72:75], v[112:115], v[20:23]
    v_mfma_f32_16x16x32_bf16 v[16:19], v[76:79], v[112:115], v[16:19]
    buffer_load_dwordx4 v[64:67], v125, s[12:15], s23 offen offset:0
    s_waitcnt lgkmcnt(5)
    v_mfma_f32_16x16x32_bf16 v[56:59], v[80:83], v[88:91], v[56:59]
    v_mfma_f32_16x16x32_bf16 v[52:55], v[84:87], v[88:91], v[52:55]
    s_waitcnt lgkmcnt(0)
    s_barrier
    v_mfma_f32_16x16x32_bf16 v[28:31], v[68:71], v[92:95], v[28:31]
    v_mfma_f32_16x16x32_bf16 v[24:27], v[72:75], v[92:95], v[24:27]
    v_mfma_f32_16x16x32_bf16 v[20:23], v[76:79], v[92:95], v[20:23]
    buffer_load_dwordx4 v[68:71], v125, s[12:15], s23 offen offset:2048
    v_mfma_f32_16x16x32_bf16 v[60:63], v[80:83], v[96:99], v[60:63]
    v_mfma_f32_16x16x32_bf16 v[56:59], v[84:87], v[96:99], v[56:59]
    buffer_load_dwordx4 v[80:83], v119, s[12:15], s23 offen offset:0
    v_mfma_f32_16x16x32_bf16 v[28:31], v[72:75], v[100:103], v[28:31]
    v_mfma_f32_16x16x32_bf16 v[24:27], v[76:79], v[100:103], v[24:27]
    buffer_load_dwordx4 v[72:75], v125, s[12:15], s26 offen offset:0
    v_mfma_f32_16x16x32_bf16 v[60:63], v[84:87], v[104:107], v[60:63]
    buffer_load_dwordx4 v[84:87], v119, s[12:15], s23 offen offset:2048
    v_mfma_f32_16x16x32_bf16 v[28:31], v[76:79], v[108:111], v[28:31]
    buffer_load_dwordx4 v[76:79], v125, s[12:15], s26 offen offset:2048
    s_add_u32 s23, s23, 57344
    s_add_u32 s26, s26, 57344
    s_branch L_conv2_kernel_mloop2
L_conv2_kernel_mlast2:
    v_and_b32 v125, 15, v127
    v_and_b32 v126, 7, v127
    v_lshlrev_b32 v126, 4, v126
    v_lshl_add_u32 v125, v125, 7, v126
    v_lshrrev_b32 v126, 4, v127
    v_lshl_add_u32 v125, v126, 11, v125
    s_mov_b32 s36, 65536
    s_cmp_eq_u32 s32, 1
    s_cselect_b32 s36, 121856, s36
    s_cmp_eq_u32 s32, 2
    s_cselect_b32 s36, 81920, s36
    s_cmp_eq_u32 s32, 3
    s_cselect_b32 s36, 130048, s36
    s_mov_b32 s37, 98304
    s_cmp_eq_u32 s32, 1
    s_cselect_b32 s37, 138240, s37
    s_cmp_eq_u32 s32, 2
    s_cselect_b32 s37, 146432, s37
    s_cmp_eq_u32 s32, 3
    s_cselect_b32 s37, 154624, s37
    v_add_u32 v126, s37, v125
    v_add_u32 v125, s36, v125
    ds_read_b128 v[88:91], v120 offset:8192
    ds_read_b128 v[92:95], v120 offset:9216
    ds_read_b128 v[96:99], v116 offset:8704
    ds_read_b128 v[100:103], v120 offset:10240
    ds_read_b128 v[104:107], v116 offset:9792
    ds_read_b128 v[108:111], v120 offset:11264
    ds_read_b128 v[112:115], v116 offset:10880
    s_waitcnt vmcnt(5) lgkmcnt(6)
    v_mfma_f32_16x16x32_bf16 v[0:3], v[64:67], v[88:91], v[0:3]
    ds_read_b128 v[88:91], v120 offset:12288
    s_waitcnt vmcnt(4) lgkmcnt(6)
    v_mfma_f32_16x16x32_bf16 v[4:7], v[64:67], v[92:95], v[4:7]
    v_mfma_f32_16x16x32_bf16 v[0:3], v[68:71], v[92:95], v[0:3]
    ds_read_b128 v[92:95], v116 offset:11968
    s_waitcnt vmcnt(3) lgkmcnt(6)
    v_mfma_f32_16x16x32_bf16 v[32:35], v[80:83], v[96:99], v[32:35]
    ds_read_b128 v[96:99], v120 offset:13312
    s_waitcnt vmcnt(2) lgkmcnt(6)
    v_mfma_f32_16x16x32_bf16 v[8:11], v[64:67], v[100:103], v[8:11]
    v_mfma_f32_16x16x32_bf16 v[4:7], v[68:71], v[100:103], v[4:7]
    v_mfma_f32_16x16x32_bf16 v[0:3], v[72:75], v[100:103], v[0:3]
    ds_read_b128 v[100:103], v116 offset:13056
    s_waitcnt vmcnt(1) lgkmcnt(6)
    v_mfma_f32_16x16x32_bf16 v[36:39], v[80:83], v[104:107], v[36:39]
    v_mfma_f32_16x16x32_bf16 v[32:35], v[84:87], v[104:107], v[32:35]
    ds_read_b128 v[104:107], v120 offset:14336
    s_waitcnt vmcnt(0) lgkmcnt(6)
    v_mfma_f32_16x16x32_bf16 v[12:15], v[64:67], v[108:111], v[12:15]
    v_mfma_f32_16x16x32_bf16 v[8:11], v[68:71], v[108:111], v[8:11]
    v_mfma_f32_16x16x32_bf16 v[4:7], v[72:75], v[108:111], v[4:7]
    v_mfma_f32_16x16x32_bf16 v[0:3], v[76:79], v[108:111], v[0:3]
    ds_read_b128 v[108:111], v116 offset:14144
    s_waitcnt lgkmcnt(6)
    v_mfma_f32_16x16x32_bf16 v[40:43], v[80:83], v[112:115], v[40:43]
    v_mfma_f32_16x16x32_bf16 v[36:39], v[84:87], v[112:115], v[36:39]
    ds_read_b128 v[112:115], v120 offset:15360
    s_waitcnt lgkmcnt(6)
    v_mfma_f32_16x16x32_bf16 v[16:19], v[64:67], v[88:91], v[16:19]
    v_mfma_f32_16x16x32_bf16 v[12:15], v[68:71], v[88:91], v[12:15]
    v_mfma_f32_16x16x32_bf16 v[8:11], v[72:75], v[88:91], v[8:11]
    v_mfma_f32_16x16x32_bf16 v[4:7], v[76:79], v[88:91], v[4:7]
    ds_read_b128 v[88:91], v117 offset:8704
    v_xor_b32 v124, 0, v126
    ds_write_b128 v124, v[32:35]
    s_waitcnt lgkmcnt(7)
    v_mfma_f32_16x16x32_bf16 v[44:47], v[80:83], v[92:95], v[44:47]
    v_mfma_f32_16x16x32_bf16 v[40:43], v[84:87], v[92:95], v[40:43]
    ds_read_b128 v[92:95], v122 offset:0
    v_xor_b32 v123, 0, v125
    ds_write_b128 v123, v[0:3]
    s_waitcnt lgkmcnt(8)
    v_mfma_f32_16x16x32_bf16 v[20:23], v[64:67], v[96:99], v[20:23]
    v_mfma_f32_16x16x32_bf16 v[16:19], v[68:71], v[96:99], v[16:19]
    v_mfma_f32_16x16x32_bf16 v[12:15], v[72:75], v[96:99], v[12:15]
    v_mfma_f32_16x16x32_bf16 v[8:11], v[76:79], v[96:99], v[8:11]
    ds_read_b128 v[96:99], v117 offset:9792
    v_xor_b32 v123, 16, v126
    ds_write_b128 v123, v[36:39]
    s_waitcnt lgkmcnt(9)
    v_mfma_f32_16x16x32_bf16 v[48:51], v[80:83], v[100:103], v[48:51]
    v_mfma_f32_16x16x32_bf16 v[44:47], v[84:87], v[100:103], v[44:47]
    ds_read_b128 v[100:103], v121 offset:9216
    v_xor_b32 v124, 16, v125
    ds_write_b128 v124, v[4:7]
    s_waitcnt lgkmcnt(10)
    v_mfma_f32_16x16x32_bf16 v[24:27], v[64:67], v[104:107], v[24:27]
    v_mfma_f32_16x16x32_bf16 v[20:23], v[68:71], v[104:107], v[20:23]
    v_mfma_f32_16x16x32_bf16 v[16:19], v[72:75], v[104:107], v[16:19]
    v_mfma_f32_16x16x32_bf16 v[12:15], v[76:79], v[104:107], v[12:15]
    ds_read_b128 v[104:107], v118 offset:8704
    v_xor_b32 v124, 32, v126
    ds_write_b128 v124, v[40:43]
    s_waitcnt lgkmcnt(11)
    v_mfma_f32_16x16x32_bf16 v[52:55], v[80:83], v[108:111], v[52:55]
    v_mfma_f32_16x16x32_bf16 v[48:51], v[84:87], v[108:111], v[48:51]
    ds_read_b128 v[108:111], v121 offset:10240
    v_xor_b32 v123, 32, v125
    ds_write_b128 v123, v[8:11]
    s_waitcnt lgkmcnt(12)
    v_mfma_f32_16x16x32_bf16 v[28:31], v[64:67], v[112:115], v[28:31]
    v_mfma_f32_16x16x32_bf16 v[24:27], v[68:71], v[112:115], v[24:27]
    v_mfma_f32_16x16x32_bf16 v[20:23], v[72:75], v[112:115], v[20:23]
    v_mfma_f32_16x16x32_bf16 v[16:19], v[76:79], v[112:115], v[16:19]
    v_xor_b32 v123, 48, v126
    ds_write_b128 v123, v[44:47]
    s_waitcnt lgkmcnt(12)
    v_mfma_f32_16x16x32_bf16 v[56:59], v[80:83], v[88:91], v[56:59]
    v_mfma_f32_16x16x32_bf16 v[52:55], v[84:87], v[88:91], v[52:55]
    v_xor_b32 v124, 48, v125
    ds_write_b128 v124, v[12:15]
    s_waitcnt lgkmcnt(11)
    v_mfma_f32_16x16x32_bf16 v[28:31], v[68:71], v[92:95], v[28:31]
    v_mfma_f32_16x16x32_bf16 v[24:27], v[72:75], v[92:95], v[24:27]
    v_mfma_f32_16x16x32_bf16 v[20:23], v[76:79], v[92:95], v[20:23]
    v_xor_b32 v124, 64, v126
    ds_write_b128 v124, v[48:51]
    s_waitcnt lgkmcnt(10)
    v_mfma_f32_16x16x32_bf16 v[60:63], v[80:83], v[96:99], v[60:63]
    v_mfma_f32_16x16x32_bf16 v[56:59], v[84:87], v[96:99], v[56:59]
    v_xor_b32 v123, 64, v125
    ds_write_b128 v123, v[16:19]
    s_waitcnt lgkmcnt(9)
    v_mfma_f32_16x16x32_bf16 v[28:31], v[72:75], v[100:103], v[28:31]
    v_mfma_f32_16x16x32_bf16 v[24:27], v[76:79], v[100:103], v[24:27]
    v_xor_b32 v123, 80, v126
    ds_write_b128 v123, v[52:55]
    s_waitcnt lgkmcnt(8)
    v_mfma_f32_16x16x32_bf16 v[60:63], v[84:87], v[104:107], v[60:63]
    v_xor_b32 v124, 80, v125
    ds_write_b128 v124, v[20:23]
    s_waitcnt lgkmcnt(7)
    v_mfma_f32_16x16x32_bf16 v[28:31], v[76:79], v[108:111], v[28:31]
    v_xor_b32 v124, 96, v126
    ds_write_b128 v124, v[56:59]
    v_and_b32 v108, 15, v127
    v_lshrrev_b32 v109, 4, v127
    v_lshrrev_b32 v110, 3, v108
    s_lshl_b32 s36, s20, 1
    v_add_u32 v110, s36, v110
    v_xor_b32 v111, v110, v108
    v_and_b32 v111, 7, v111
    v_lshlrev_b32 v111, 4, v111
    v_xor_b32 v123, 96, v125
    ds_write_b128 v123, v[24:27]
    v_lshl_add_u32 v111, v110, 7, v111
    v_lshl_add_u32 v120, v109, 11, v111
    v_add_u32 v121, 65536, v120
    v_add_u32 v64, 131072, v120
    s_lshl_b32 s36, s20, 9
    s_add_u32 s36, s36, 115712
    v_lshl_add_u32 v127, v109, 7, s36
    s_lshl_b32 s36, s20, 4
    v_add_u32 v108, s36, v108
    v_lshlrev_b32 v110, 6, v108
    v_lshl_add_u32 v110, v109, 4, v110
    s_mul_i32 s36, s29, 262144
    v_xor_b32 v123, 112, v126
    ds_write_b128 v123, v[60:63]
    s_lshl_b32 s37, s21, 4
    s_add_u32 s36, s36, s37
    v_add_u32 v110, s36, v110
    v_mov_b32 v111, 2130706432
    v_cmp_gt_u32 vcc, 125, v108
    s_mov_b32 s4, 0xbeaaaaab
    s_mov_b32 s5, s4
    s_mov_b32 s6, 0x3e800000
    s_mov_b32 s7, s6
    s_mov_b32 s8, 0xc0a00000
    s_mov_b32 s9, s8
    s_mov_b32 s10, 0xc0638e39
    v_xor_b32 v124, 112, v125
    ds_write_b128 v124, v[28:31]
    s_mov_b32 s11, s10
    s_mov_b32 s12, 0xbf638e39
    s_mov_b32 s13, s12
    s_mov_b32 s14, 0xbe638e39
    s_mov_b32 s15, s14
    s_mov_b32 s22, 0xbd638e39
    s_mov_b32 s23, s22
    s_mov_b32 s24, 0x3ff1c71c
    s_mov_b32 s25, s24
    s_mov_b32 s26, 0xbf2aaaab
    s_mov_b32 s27, s26
    s_mov_b32 s32, 0x3ecccccd
    s_mov_b32 s33, s32
    s_mov_b32 s34, 0xbd888889
    s_mov_b32 s35, s34
    s_mov_b32 s38, 0xbe4ccccd
    s_mov_b32 s39, s38
    s_mov_b32 s40, 0xbdd2d3e8
    s_mov_b32 s41, s40
    s_mov_b32 s42, 0x3f800000
    s_mov_b32 s43, s42
    s_setprio 0
    s_branch L_conv2_kernel_epi
L_conv2_kernel_helper:
    s_setprio 3
    v_lshlrev_b32 v8, 4, v6
    s_add_u32 s37, s33, 4294967289
    v_lshl_add_u32 v9, v7, 3, s37
    v_cmp_gt_u32 vcc, 8000, v9
    s_mul_i32 s37, s33, 131072
    s_add_u32 s37, s37, 0
    v_lshl_add_u32 v92, v7, 7, s37
    v_add_u32 v92, v92, v8
    v_mov_b32 v9, 2130706432
    v_cndmask_b32 v92, v9, v92, vcc
    s_add_u32 s37, s33, 4294967291
    v_lshl_add_u32 v9, v7, 3, s37
    v_cmp_gt_u32 vcc, 8000, v9
    s_mul_i32 s37, s33, 131072
    s_add_u32 s37, s37, 262144
    v_lshl_add_u32 v93, v7, 7, s37
    v_add_u32 v93, v93, v8
    v_mov_b32 v9, 2130706432
    v_cndmask_b32 v93, v9, v93, vcc
    s_add_u32 s37, s33, 4294967293
    v_lshl_add_u32 v9, v7, 3, s37
    v_cmp_gt_u32 vcc, 8000, v9
    s_mul_i32 s37, s33, 131072
    s_add_u32 s37, s37, 64
    v_lshl_add_u32 v94, v7, 7, s37
    v_add_u32 v94, v94, v8
    v_mov_b32 v9, 2130706432
    v_cndmask_b32 v94, v9, v94, vcc
    s_add_u32 s37, s33, 4294967295
    v_lshl_add_u32 v9, v7, 3, s37
    v_cmp_gt_u32 vcc, 8000, v9
    s_mul_i32 s37, s33, 131072
    s_add_u32 s37, s37, 262208
    v_lshl_add_u32 v95, v7, 7, s37
    v_add_u32 v95, v95, v8
    v_mov_b32 v9, 2130706432
    v_cndmask_b32 v95, v9, v95, vcc
    v_and_b32 v76, 4, v5
    v_lshrrev_b32 v76, 1, v76
    v_xor_b32 v76, v6, v76
    v_lshlrev_b32 v76, 4, v76
    v_lshl_add_u32 v76, v5, 6, v76
    s_mov_b32 s24, 0
    s_mov_b32 s27, 524288
    s_waitcnt lgkmcnt(0)
    s_add_u32 s8, s4, s47
    s_addc_u32 s9, s5, 0
    buffer_load_dwordx4 v[0:3], v92, s[8:11], s24 offen
    buffer_load_dwordx4 v[8:11], v94, s[8:11], s24 offen
    buffer_load_dwordx4 v[4:7], v93, s[8:11], s24 offen
    buffer_load_dwordx4 v[12:15], v95, s[8:11], s24 offen
    buffer_load_dwordx4 v[16:19], v92, s[8:11], s27 offen
    buffer_load_dwordx4 v[24:27], v94, s[8:11], s27 offen
    buffer_load_dwordx4 v[20:23], v93, s[8:11], s27 offen
    buffer_load_dwordx4 v[28:31], v95, s[8:11], s27 offen
    s_mul_i32 s36, s42, 1024
    v_add_u32 v96, s36, v76
    v_add_u32 v97, 65536, v96
    s_mul_i32 s36, s42, 1088
    s_add_u32 s36, s36, 98304
    v_add_u32 v98, s36, v76
    s_waitcnt vmcnt(0)
    s_mov_b32 s28, 0
    s_mov_b32 s22, 2
    s_cmp_ge_u32 s20, 12
    s_cbranch_scc1 L_conv2_kernel_h2
    ds_write_b128 v96, v[0:3] offset:0
    ds_write_b128 v98, v[12:15] offset:0
    v_lshlrev_b32 v76, 16, v0
    v_and_b32 v84, s25, v0
    v_lshlrev_b32 v77, 16, v4
    v_and_b32 v85, s25, v4
    v_lshlrev_b32 v78, 16, v8
    v_and_b32 v86, s25, v8
    v_lshlrev_b32 v79, 16, v12
    v_and_b32 v87, s25, v12
    v_add_f32 v80, v76, v78
    v_add_f32 v88, v84, v86
    v_add_f32 v81, v77, v79
    v_add_f32 v89, v85, v87
    v_fma_f32 v82, v78, 4.0, v76
    v_fma_f32 v90, v86, 4.0, v84
    v_fma_f32 v83, v79, 4.0, v77
    v_fma_f32 v91, v87, 4.0, v85
    v_add_f32 v77, v80, v81
    v_add_f32 v85, v88, v89
    v_sub_f32 v78, v80, v81
    v_sub_f32 v86, v88, v89
    v_fma_f32 v79, v83, 2.0, v82
    v_fma_f32 v87, v91, 2.0, v90
    v_fma_f32 v82, v83, -2.0, v82
    v_fma_f32 v90, v91, -2.0, v90
    v_fmamk_f32 v80, v76, 0x41700000, v82
    v_fmamk_f32 v88, v84, 0x41700000, v90
    v_fmamk_f32 v80, v81, 0x41200000, v80
    v_fmamk_f32 v88, v89, 0x41200000, v88
    v_cvt_pk_bf16_f32 v4, v77, v85
    v_cvt_pk_bf16_f32 v8, v78, v86
    v_cvt_pk_bf16_f32 v64, v79, v87
    v_cvt_pk_bf16_f32 v68, v82, v90
    v_cvt_pk_bf16_f32 v72, v80, v88
    v_lshlrev_b32 v76, 16, v1
    v_and_b32 v84, s25, v1
    v_lshlrev_b32 v77, 16, v5
    v_and_b32 v85, s25, v5
    v_lshlrev_b32 v78, 16, v9
    v_and_b32 v86, s25, v9
    v_lshlrev_b32 v79, 16, v13
    v_and_b32 v87, s25, v13
    v_add_f32 v80, v76, v78
    v_add_f32 v88, v84, v86
    v_add_f32 v81, v77, v79
    v_add_f32 v89, v85, v87
    v_fma_f32 v82, v78, 4.0, v76
    v_fma_f32 v90, v86, 4.0, v84
    v_fma_f32 v83, v79, 4.0, v77
    v_fma_f32 v91, v87, 4.0, v85
    v_add_f32 v77, v80, v81
    v_add_f32 v85, v88, v89
    v_sub_f32 v78, v80, v81
    v_sub_f32 v86, v88, v89
    v_fma_f32 v79, v83, 2.0, v82
    v_fma_f32 v87, v91, 2.0, v90
    v_fma_f32 v82, v83, -2.0, v82
    v_fma_f32 v90, v91, -2.0, v90
    v_fmamk_f32 v80, v76, 0x41700000, v82
    v_fmamk_f32 v88, v84, 0x41700000, v90
    v_fmamk_f32 v80, v81, 0x41200000, v80
    v_fmamk_f32 v88, v89, 0x41200000, v88
    v_cvt_pk_bf16_f32 v5, v77, v85
    v_cvt_pk_bf16_f32 v9, v78, v86
    v_cvt_pk_bf16_f32 v65, v79, v87
    v_cvt_pk_bf16_f32 v69, v82, v90
    v_cvt_pk_bf16_f32 v73, v80, v88
    v_lshlrev_b32 v76, 16, v2
    v_and_b32 v84, s25, v2
    v_lshlrev_b32 v77, 16, v6
    v_and_b32 v85, s25, v6
    v_lshlrev_b32 v78, 16, v10
    v_and_b32 v86, s25, v10
    v_lshlrev_b32 v79, 16, v14
    v_and_b32 v87, s25, v14
    v_add_f32 v80, v76, v78
    v_add_f32 v88, v84, v86
    v_add_f32 v81, v77, v79
    v_add_f32 v89, v85, v87
    v_fma_f32 v82, v78, 4.0, v76
    v_fma_f32 v90, v86, 4.0, v84
    v_fma_f32 v83, v79, 4.0, v77
    v_fma_f32 v91, v87, 4.0, v85
    v_add_f32 v77, v80, v81
    v_add_f32 v85, v88, v89
    v_sub_f32 v78, v80, v81
    v_sub_f32 v86, v88, v89
    v_fma_f32 v79, v83, 2.0, v82
    v_fma_f32 v87, v91, 2.0, v90
    v_fma_f32 v82, v83, -2.0, v82
    v_fma_f32 v90, v91, -2.0, v90
    v_fmamk_f32 v80, v76, 0x41700000, v82
    v_fmamk_f32 v88, v84, 0x41700000, v90
    v_fmamk_f32 v80, v81, 0x41200000, v80
    v_fmamk_f32 v88, v89, 0x41200000, v88
    v_cvt_pk_bf16_f32 v6, v77, v85
    v_cvt_pk_bf16_f32 v10, v78, v86
    v_cvt_pk_bf16_f32 v66, v79, v87
    v_cvt_pk_bf16_f32 v70, v82, v90
    v_cvt_pk_bf16_f32 v74, v80, v88
    v_lshlrev_b32 v76, 16, v3
    v_and_b32 v84, s25, v3
    v_lshlrev_b32 v77, 16, v7
    v_and_b32 v85, s25, v7
    v_lshlrev_b32 v78, 16, v11
    v_and_b32 v86, s25, v11
    v_lshlrev_b32 v79, 16, v15
    v_and_b32 v87, s25, v15
    v_add_f32 v80, v76, v78
    v_add_f32 v88, v84, v86
    v_add_f32 v81, v77, v79
    v_add_f32 v89, v85, v87
    v_fma_f32 v82, v78, 4.0, v76
    v_fma_f32 v90, v86, 4.0, v84
    v_fma_f32 v83, v79, 4.0, v77
    v_fma_f32 v91, v87, 4.0, v85
    v_add_f32 v77, v80, v81
    v_add_f32 v85, v88, v89
    v_sub_f32 v78, v80, v81
    v_sub_f32 v86, v88, v89
    v_fma_f32 v79, v83, 2.0, v82
    v_fma_f32 v87, v91, 2.0, v90
    v_fma_f32 v82, v83, -2.0, v82
    v_fma_f32 v90, v91, -2.0, v90
    v_fmamk_f32 v80, v76, 0x41700000, v82
    v_fmamk_f32 v88, v84, 0x41700000, v90
    v_fmamk_f32 v80, v81, 0x41200000, v80
    v_fmamk_f32 v88, v89, 0x41200000, v88
    v_cvt_pk_bf16_f32 v7, v77, v85
    v_cvt_pk_bf16_f32 v11, v78, v86
    v_cvt_pk_bf16_f32 v67, v79, v87
    v_cvt_pk_bf16_f32 v71, v82, v90
    v_cvt_pk_bf16_f32 v75, v80, v88
    ds_write_b128 v96, v[64:67] offset:49152
    ds_write_b128 v97, v[68:71] offset:0
    ds_write_b128 v97, v[72:75] offset:16384
    ds_write_b128 v96, v[4:7] offset:16384
    ds_write_b128 v96, v[8:11] offset:32768
    s_waitcnt vmcnt(0)
    s_mov_b32 s24, 1048576
    s_mov_b32 s27, 1572864
    s_waitcnt lgkmcnt(0)
    s_barrier
    buffer_load_dwordx4 v[32:35], v92, s[8:11], s24 offen
    buffer_load_dwordx4 v[40:43], v94, s[8:11], s24 offen
    buffer_load_dwordx4 v[36:39], v93, s[8:11], s24 offen
    buffer_load_dwordx4 v[44:47], v95, s[8:11], s24 offen
    s_setprio 1
L_conv2_kernel_hloop1:
    v_lshlrev_b32 v76, 16, v16
    v_and_b32 v84, s25, v16
    v_lshlrev_b32 v77, 16, v20
    v_and_b32 v85, s25, v20
    v_lshlrev_b32 v78, 16, v24
    v_and_b32 v86, s25, v24
    v_lshlrev_b32 v79, 16, v28
    v_and_b32 v87, s25, v28
    v_add_f32 v80, v76, v78
    v_add_f32 v88, v84, v86
    v_add_f32 v81, v77, v79
    v_add_f32 v89, v85, v87
    v_fma_f32 v82, v78, 4.0, v76
    buffer_load_dwordx4 v[48:51], v92, s[8:11], s27 offen
    buffer_load_dwordx4 v[56:59], v94, s[8:11], s27 offen
    v_fma_f32 v90, v86, 4.0, v84
    v_fma_f32 v83, v79, 4.0, v77
    v_fma_f32 v91, v87, 4.0, v85
    v_add_f32 v77, v80, v81
    v_add_f32 v85, v88, v89
    v_sub_f32 v78, v80, v81
    v_sub_f32 v86, v88, v89
    v_fma_f32 v79, v83, 2.0, v82
    v_fma_f32 v87, v91, 2.0, v90
    v_fma_f32 v82, v83, -2.0, v82
    v_fma_f32 v90, v91, -2.0, v90
    v_fmamk_f32 v80, v76, 0x41700000, v82
    v_fmamk_f32 v88, v84, 0x41700000, v90
    v_fmamk_f32 v80, v81, 0x41200000, v80
    v_fmamk_f32 v88, v89, 0x41200000, v88
    v_cvt_pk_bf16_f32 v20, v77, v85
    v_cvt_pk_bf16_f32 v24, v78, v86
    v_cvt_pk_bf16_f32 v64, v79, v87
    v_cvt_pk_bf16_f32 v68, v82, v90
    v_cvt_pk_bf16_f32 v72, v80, v88
    v_lshlrev_b32 v76, 16, v17
    v_and_b32 v84, s25, v17
    v_lshlrev_b32 v77, 16, v21
    v_and_b32 v85, s25, v21
    v_lshlrev_b32 v78, 16, v25
    v_and_b32 v86, s25, v25
    v_lshlrev_b32 v79, 16, v29
    v_and_b32 v87, s25, v29
    v_add_f32 v80, v76, v78
    v_add_f32 v88, v84, v86
    v_add_f32 v81, v77, v79
    v_add_f32 v89, v85, v87
    v_fma_f32 v82, v78, 4.0, v76
    v_fma_f32 v90, v86, 4.0, v84
    v_fma_f32 v83, v79, 4.0, v77
    v_fma_f32 v91, v87, 4.0, v85
    v_add_f32 v77, v80, v81
    v_add_f32 v85, v88, v89
    v_sub_f32 v78, v80, v81
    v_sub_f32 v86, v88, v89
    v_fma_f32 v79, v83, 2.0, v82
    v_fma_f32 v87, v91, 2.0, v90
    v_fma_f32 v82, v83, -2.0, v82
    v_fma_f32 v90, v91, -2.0, v90
    v_fmamk_f32 v80, v76, 0x41700000, v82
    v_fmamk_f32 v88, v84, 0x41700000, v90
    v_fmamk_f32 v80, v81, 0x41200000, v80
    v_fmamk_f32 v88, v89, 0x41200000, v88
    v_cvt_pk_bf16_f32 v21, v77, v85
    v_cvt_pk_bf16_f32 v25, v78, v86
    v_cvt_pk_bf16_f32 v65, v79, v87
    v_cvt_pk_bf16_f32 v69, v82, v90
    v_cvt_pk_bf16_f32 v73, v80, v88
    buffer_load_dwordx4 v[52:55], v93, s[8:11], s27 offen
    buffer_load_dwordx4 v[60:63], v95, s[8:11], s27 offen
    v_lshlrev_b32 v76, 16, v18
    v_and_b32 v84, s25, v18
    v_lshlrev_b32 v77, 16, v22
    v_and_b32 v85, s25, v22
    v_lshlrev_b32 v78, 16, v26
    v_and_b32 v86, s25, v26
    v_lshlrev_b32 v79, 16, v30
    v_and_b32 v87, s25, v30
    v_add_f32 v80, v76, v78
    v_add_f32 v88, v84, v86
    v_add_f32 v81, v77, v79
    v_add_f32 v89, v85, v87
    v_fma_f32 v82, v78, 4.0, v76
    v_fma_f32 v90, v86, 4.0, v84
    v_fma_f32 v83, v79, 4.0, v77
    v_fma_f32 v91, v87, 4.0, v85
    v_add_f32 v77, v80, v81
    v_add_f32 v85, v88, v89
    v_sub_f32 v78, v80, v81
    v_sub_f32 v86, v88, v89
    v_fma_f32 v79, v83, 2.0, v82
    v_fma_f32 v87, v91, 2.0, v90
    v_fma_f32 v82, v83, -2.0, v82
    v_fma_f32 v90, v91, -2.0, v90
    v_fmamk_f32 v80, v76, 0x41700000, v82
    v_fmamk_f32 v88, v84, 0x41700000, v90
    v_fmamk_f32 v80, v81, 0x41200000, v80
    v_fmamk_f32 v88, v89, 0x41200000, v88
    v_cvt_pk_bf16_f32 v22, v77, v85
    v_cvt_pk_bf16_f32 v26, v78, v86
    v_cvt_pk_bf16_f32 v66, v79, v87
    v_cvt_pk_bf16_f32 v70, v82, v90
    v_cvt_pk_bf16_f32 v74, v80, v88
    v_lshlrev_b32 v76, 16, v19
    v_and_b32 v84, s25, v19
    v_lshlrev_b32 v77, 16, v23
    v_and_b32 v85, s25, v23
    v_lshlrev_b32 v78, 16, v27
    v_and_b32 v86, s25, v27
    v_lshlrev_b32 v79, 16, v31
    v_and_b32 v87, s25, v31
    v_add_f32 v80, v76, v78
    v_add_f32 v88, v84, v86
    v_add_f32 v81, v77, v79
    v_add_f32 v89, v85, v87
    v_fma_f32 v82, v78, 4.0, v76
    v_fma_f32 v90, v86, 4.0, v84
    v_fma_f32 v83, v79, 4.0, v77
    v_fma_f32 v91, v87, 4.0, v85
    v_add_f32 v77, v80, v81
    v_add_f32 v85, v88, v89
    v_sub_f32 v78, v80, v81
    v_sub_f32 v86, v88, v89
    v_fma_f32 v79, v83, 2.0, v82
    v_fma_f32 v87, v91, 2.0, v90
    v_fma_f32 v82, v83, -2.0, v82
    v_fma_f32 v90, v91, -2.0, v90
    v_fmamk_f32 v80, v76, 0x41700000, v82
    v_fmamk_f32 v88, v84, 0x41700000, v90
    v_fmamk_f32 v80, v81, 0x41200000, v80
    v_fmamk_f32 v88, v89, 0x41200000, v88
    v_cvt_pk_bf16_f32 v23, v77, v85
    v_cvt_pk_bf16_f32 v27, v78, v86
    v_cvt_pk_bf16_f32 v67, v79, v87
    v_cvt_pk_bf16_f32 v71, v82, v90
    v_cvt_pk_bf16_f32 v75, v80, v88
    ds_write_b128 v96, v[64:67] offset:57344
    ds_write_b128 v97, v[68:71] offset:8192
    ds_write_b128 v97, v[72:75] offset:24576
    ds_write_b128 v96, v[16:19] offset:8192
    ds_write_b128 v96, v[20:23] offset:24576
    ds_write_b128 v96, v[24:27] offset:40960
    ds_write_b128 v98, v[28:31] offset:8704
    s_add_u32 s28, s28, 1
    s_waitcnt lgkmcnt(0)
    s_barrier
    s_add_u32 s24, s24, 1048576
    s_add_u32 s27, s27, 1048576
    s_waitcnt vmcnt(0)
    v_lshlrev_b32 v76, 16, v32
    v_and_b32 v84, s25, v32
    v_lshlrev_b32 v77, 16, v36
    v_and_b32 v85, s25, v36
    v_lshlrev_b32 v78, 16, v40
    v_and_b32 v86, s25, v40
    v_lshlrev_b32 v79, 16, v44
    v_and_b32 v87, s25, v44
    v_add_f32 v80, v76, v78
    v_add_f32 v88, v84, v86
    v_add_f32 v81, v77, v79
    v_add_f32 v89, v85, v87
    v_fma_f32 v82, v78, 4.0, v76
    v_fma_f32 v90, v86, 4.0, v84
    v_fma_f32 v83, v79, 4.0, v77
    v_fma_f32 v91, v87, 4.0, v85
    v_add_f32 v77, v80, v81
    v_add_f32 v85, v88, v89
    v_sub_f32 v78, v80, v81
    v_sub_f32 v86, v88, v89
    v_fma_f32 v79, v83, 2.0, v82
    v_fma_f32 v87, v91, 2.0, v90
    v_fma_f32 v82, v83, -2.0, v82
    v_fma_f32 v90, v91, -2.0, v90
    v_fmamk_f32 v80, v76, 0x41700000, v82
    v_fmamk_f32 v88, v84, 0x41700000, v90
    v_fmamk_f32 v80, v81, 0x41200000, v80
    v_fmamk_f32 v88, v89, 0x41200000, v88
    v_cvt_pk_bf16_f32 v36, v77, v85
    v_cvt_pk_bf16_f32 v40, v78, v86
    v_cvt_pk_bf16_f32 v64, v79, v87
    v_cvt_pk_bf16_f32 v68, v82, v90
    v_cvt_pk_bf16_f32 v72, v80, v88
    v_lshlrev_b32 v76, 16, v33
    v_and_b32 v84, s25, v33
    v_lshlrev_b32 v77, 16, v37
    v_and_b32 v85, s25, v37
    v_lshlrev_b32 v78, 16, v41
    v_and_b32 v86, s25, v41
    buffer_load_dwordx4 v[0:3], v92, s[8:11], s24 offen
    buffer_load_dwordx4 v[8:11], v94, s[8:11], s24 offen
    v_lshlrev_b32 v79, 16, v45
    v_and_b32 v87, s25, v45
    v_add_f32 v80, v76, v78
    v_add_f32 v88, v84, v86
    v_add_f32 v81, v77, v79
    v_add_f32 v89, v85, v87
    v_fma_f32 v82, v78, 4.0, v76
    v_fma_f32 v90, v86, 4.0, v84
    v_fma_f32 v83, v79, 4.0, v77
    v_fma_f32 v91, v87, 4.0, v85
    v_add_f32 v77, v80, v81
    v_add_f32 v85, v88, v89
    v_sub_f32 v78, v80, v81
    v_sub_f32 v86, v88, v89
    v_fma_f32 v79, v83, 2.0, v82
    v_fma_f32 v87, v91, 2.0, v90
    v_fma_f32 v82, v83, -2.0, v82
    v_fma_f32 v90, v91, -2.0, v90
    v_fmamk_f32 v80, v76, 0x41700000, v82
    v_fmamk_f32 v88, v84, 0x41700000, v90
    v_fmamk_f32 v80, v81, 0x41200000, v80
    v_fmamk_f32 v88, v89, 0x41200000, v88
    v_cvt_pk_bf16_f32 v37, v77, v85
    v_cvt_pk_bf16_f32 v41, v78, v86
    v_cvt_pk_bf16_f32 v65, v79, v87
    v_cvt_pk_bf16_f32 v69, v82, v90
    v_cvt_pk_bf16_f32 v73, v80, v88
    v_lshlrev_b32 v76, 16, v34
    v_and_b32 v84, s25, v34
    v_lshlrev_b32 v77, 16, v38
    v_and_b32 v85, s25, v38
    v_lshlrev_b32 v78, 16, v42
    v_and_b32 v86, s25, v42
    v_lshlrev_b32 v79, 16, v46
    v_and_b32 v87, s25, v46
    v_add_f32 v80, v76, v78
    v_add_f32 v88, v84, v86
    v_add_f32 v81, v77, v79
    v_add_f32 v89, v85, v87
    v_fma_f32 v82, v78, 4.0, v76
    v_fma_f32 v90, v86, 4.0, v84
    v_fma_f32 v83, v79, 4.0, v77
    v_fma_f32 v91, v87, 4.0, v85
    v_add_f32 v77, v80, v81
    v_add_f32 v85, v88, v89
    v_sub_f32 v78, v80, v81
    v_sub_f32 v86, v88, v89
    v_fma_f32 v79, v83, 2.0, v82
    v_fma_f32 v87, v91, 2.0, v90
    v_fma_f32 v82, v83, -2.0, v82
    v_fma_f32 v90, v91, -2.0, v90
    v_fmamk_f32 v80, v76, 0x41700000, v82
    v_fmamk_f32 v88, v84, 0x41700000, v90
    buffer_load_dwordx4 v[4:7], v93, s[8:11], s24 offen
    buffer_load_dwordx4 v[12:15], v95, s[8:11], s24 offen
    v_fmamk_f32 v80, v81, 0x41200000, v80
    v_fmamk_f32 v88, v89, 0x41200000, v88
    v_cvt_pk_bf16_f32 v38, v77, v85
    v_cvt_pk_bf16_f32 v42, v78, v86
    v_cvt_pk_bf16_f32 v66, v79, v87
    v_cvt_pk_bf16_f32 v70, v82, v90
    v_cvt_pk_bf16_f32 v74, v80, v88
    v_lshlrev_b32 v76, 16, v35
    v_and_b32 v84, s25, v35
    v_lshlrev_b32 v77, 16, v39
    v_and_b32 v85, s25, v39
    v_lshlrev_b32 v78, 16, v43
    v_and_b32 v86, s25, v43
    v_lshlrev_b32 v79, 16, v47
    v_and_b32 v87, s25, v47
    v_add_f32 v80, v76, v78
    v_add_f32 v88, v84, v86
    v_add_f32 v81, v77, v79
    v_add_f32 v89, v85, v87
    v_fma_f32 v82, v78, 4.0, v76
    v_fma_f32 v90, v86, 4.0, v84
    v_fma_f32 v83, v79, 4.0, v77
    v_fma_f32 v91, v87, 4.0, v85
    v_add_f32 v77, v80, v81
    v_add_f32 v85, v88, v89
    v_sub_f32 v78, v80, v81
    v_sub_f32 v86, v88, v89
    v_fma_f32 v79, v83, 2.0, v82
    v_fma_f32 v87, v91, 2.0, v90
    v_fma_f32 v82, v83, -2.0, v82
    v_fma_f32 v90, v91, -2.0, v90
    v_fmamk_f32 v80, v76, 0x41700000, v82
    v_fmamk_f32 v88, v84, 0x41700000, v90
    v_fmamk_f32 v80, v81, 0x41200000, v80
    v_fmamk_f32 v88, v89, 0x41200000, v88
    v_cvt_pk_bf16_f32 v39, v77, v85
    v_cvt_pk_bf16_f32 v43, v78, v86
    v_cvt_pk_bf16_f32 v67, v79, v87
    v_cvt_pk_bf16_f32 v71, v82, v90
    v_cvt_pk_bf16_f32 v75, v80, v88
    ds_write_b128 v96, v[64:67] offset:49152
    ds_write_b128 v97, v[68:71] offset:0
    ds_write_b128 v97, v[72:75] offset:16384
    ds_write_b128 v96, v[32:35] offset:0
    ds_write_b128 v96, v[36:39] offset:16384
    ds_write_b128 v96, v[40:43] offset:32768
    ds_write_b128 v98, v[44:47] offset:0
    s_add_u32 s28, s28, 1
    s_waitcnt lgkmcnt(0)
    s_barrier
    v_lshlrev_b32 v76, 16, v48
    v_and_b32 v84, s25, v48
    v_lshlrev_b32 v77, 16, v52
    v_and_b32 v85, s25, v52
    v_lshlrev_b32 v78, 16, v56
    v_and_b32 v86, s25, v56
    v_lshlrev_b32 v79, 16, v60
    v_and_b32 v87, s25, v60
    v_add_f32 v80, v76, v78
    v_add_f32 v88, v84, v86
    v_add_f32 v81, v77, v79
    v_add_f32 v89, v85, v87
    v_fma_f32 v82, v78, 4.0, v76
    buffer_load_dwordx4 v[16:19], v92, s[8:11], s27 offen
    buffer_load_dwordx4 v[24:27], v94, s[8:11], s27 offen
    v_fma_f32 v90, v86, 4.0, v84
    v_fma_f32 v83, v79, 4.0, v77
    v_fma_f32 v91, v87, 4.0, v85
    v_add_f32 v77, v80, v81
    v_add_f32 v85, v88, v89
    v_sub_f32 v78, v80, v81
    v_sub_f32 v86, v88, v89
    v_fma_f32 v79, v83, 2.0, v82
    v_fma_f32 v87, v91, 2.0, v90
    v_fma_f32 v82, v83, -2.0, v82
    v_fma_f32 v90, v91, -2.0, v90
    v_fmamk_f32 v80, v76, 0x41700000, v82
    v_fmamk_f32 v88, v84, 0x41700000, v90
    v_fmamk_f32 v80, v81, 0x41200000, v80
    v_fmamk_f32 v88, v89, 0x41200000, v88
    v_cvt_pk_bf16_f32 v52, v77, v85
    v_cvt_pk_bf16_f32 v56, v78, v86
    v_cvt_pk_bf16_f32 v64, v79, v87
    v_cvt_pk_bf16_f32 v68, v82, v90
    v_cvt_pk_bf16_f32 v72, v80, v88
    v_lshlrev_b32 v76, 16, v49
    v_and_b32 v84, s25, v49
    v_lshlrev_b32 v77, 16, v53
    v_and_b32 v85, s25, v53
    v_lshlrev_b32 v78, 16, v57
    v_and_b32 v86, s25, v57
    v_lshlrev_b32 v79, 16, v61
    v_and_b32 v87, s25, v61
    v_add_f32 v80, v76, v78
    v_add_f32 v88, v84, v86
    v_add_f32 v81, v77, v79
    v_add_f32 v89, v85, v87
    v_fma_f32 v82, v78, 4.0, v76
    v_fma_f32 v90, v86, 4.0, v84
    v_fma_f32 v83, v79, 4.0, v77
    v_fma_f32 v91, v87, 4.0, v85
    v_add_f32 v77, v80, v81
    v_add_f32 v85, v88, v89
    v_sub_f32 v78, v80, v81
    v_sub_f32 v86, v88, v89
    v_fma_f32 v79, v83, 2.0, v82
    v_fma_f32 v87, v91, 2.0, v90
    v_fma_f32 v82, v83, -2.0, v82
    v_fma_f32 v90, v91, -2.0, v90
    v_fmamk_f32 v80, v76, 0x41700000, v82
    v_fmamk_f32 v88, v84, 0x41700000, v90
    v_fmamk_f32 v80, v81, 0x41200000, v80
    v_fmamk_f32 v88, v89, 0x41200000, v88
    v_cvt_pk_bf16_f32 v53, v77, v85
    v_cvt_pk_bf16_f32 v57, v78, v86
    v_cvt_pk_bf16_f32 v65, v79, v87
    v_cvt_pk_bf16_f32 v69, v82, v90
    v_cvt_pk_bf16_f32 v73, v80, v88
    buffer_load_dwordx4 v[20:23], v93, s[8:11], s27 offen
    buffer_load_dwordx4 v[28:31], v95, s[8:11], s27 offen
    v_lshlrev_b32 v76, 16, v50
    v_and_b32 v84, s25, v50
    v_lshlrev_b32 v77, 16, v54
    v_and_b32 v85, s25, v54
    v_lshlrev_b32 v78, 16, v58
    v_and_b32 v86, s25, v58
    v_lshlrev_b32 v79, 16, v62
    v_and_b32 v87, s25, v62
    v_add_f32 v80, v76, v78
    v_add_f32 v88, v84, v86
    v_add_f32 v81, v77, v79
    v_add_f32 v89, v85, v87
    v_fma_f32 v82, v78, 4.0, v76
    v_fma_f32 v90, v86, 4.0, v84
    v_fma_f32 v83, v79, 4.0, v77
    v_fma_f32 v91, v87, 4.0, v85
    v_add_f32 v77, v80, v81
    v_add_f32 v85, v88, v89
    v_sub_f32 v78, v80, v81
    v_sub_f32 v86, v88, v89
    v_fma_f32 v79, v83, 2.0, v82
    v_fma_f32 v87, v91, 2.0, v90
    v_fma_f32 v82, v83, -2.0, v82
    v_fma_f32 v90, v91, -2.0, v90
    v_fmamk_f32 v80, v76, 0x41700000, v82
    v_fmamk_f32 v88, v84, 0x41700000, v90
    v_fmamk_f32 v80, v81, 0x41200000, v80
    v_fmamk_f32 v88, v89, 0x41200000, v88
    v_cvt_pk_bf16_f32 v54, v77, v85
    v_cvt_pk_bf16_f32 v58, v78, v86
    v_cvt_pk_bf16_f32 v66, v79, v87
    v_cvt_pk_bf16_f32 v70, v82, v90
    v_cvt_pk_bf16_f32 v74, v80, v88
    v_lshlrev_b32 v76, 16, v51
    v_and_b32 v84, s25, v51
    v_lshlrev_b32 v77, 16, v55
    v_and_b32 v85, s25, v55
    v_lshlrev_b32 v78, 16, v59
    v_and_b32 v86, s25, v59
    v_lshlrev_b32 v79, 16, v63
    v_and_b32 v87, s25, v63
    v_add_f32 v80, v76, v78
    v_add_f32 v88, v84, v86
    v_add_f32 v81, v77, v79
    v_add_f32 v89, v85, v87
    v_fma_f32 v82, v78, 4.0, v76
    v_fma_f32 v90, v86, 4.0, v84
    v_fma_f32 v83, v79, 4.0, v77
    v_fma_f32 v91, v87, 4.0, v85
    v_add_f32 v77, v80, v81
    v_add_f32 v85, v88, v89
    v_sub_f32 v78, v80, v81
    v_sub_f32 v86, v88, v89
    v_fma_f32 v79, v83, 2.0, v82
    v_fma_f32 v87, v91, 2.0, v90
    v_fma_f32 v82, v83, -2.0, v82
    v_fma_f32 v90, v91, -2.0, v90
    v_fmamk_f32 v80, v76, 0x41700000, v82
    v_fmamk_f32 v88, v84, 0x41700000, v90
    v_fmamk_f32 v80, v81, 0x41200000, v80
    v_fmamk_f32 v88, v89, 0x41200000, v88
    v_cvt_pk_bf16_f32 v55, v77, v85
    v_cvt_pk_bf16_f32 v59, v78, v86
    v_cvt_pk_bf16_f32 v67, v79, v87
    v_cvt_pk_bf16_f32 v71, v82, v90
    v_cvt_pk_bf16_f32 v75, v80, v88
    ds_write_b128 v96, v[64:67] offset:57344
    ds_write_b128 v97, v[68:71] offset:8192
    ds_write_b128 v97, v[72:75] offset:24576
    ds_write_b128 v96, v[48:51] offset:8192
    ds_write_b128 v96, v[52:55] offset:24576
    ds_write_b128 v96, v[56:59] offset:40960
    ds_write_b128 v98, v[60:63] offset:8704
    s_add_u32 s28, s28, 1
    s_waitcnt lgkmcnt(0)
    s_barrier
    s_cmp_eq_u32 s22, 1
    s_cbranch_scc1 L_conv2_kernel_hlast1
    s_add_u32 s24, s24, 1048576
    s_add_u32 s27, s27, 1048576
    s_waitcnt vmcnt(0)
    v_lshlrev_b32 v76, 16, v0
    v_and_b32 v84, s25, v0
    v_lshlrev_b32 v77, 16, v4
    v_and_b32 v85, s25, v4
    v_lshlrev_b32 v78, 16, v8
    v_and_b32 v86, s25, v8
    v_lshlrev_b32 v79, 16, v12
    v_and_b32 v87, s25, v12
    v_add_f32 v80, v76, v78
    v_add_f32 v88, v84, v86
    v_add_f32 v81, v77, v79
    v_add_f32 v89, v85, v87
    v_fma_f32 v82, v78, 4.0, v76
    v_fma_f32 v90, v86, 4.0, v84
    v_fma_f32 v83, v79, 4.0, v77
    v_fma_f32 v91, v87, 4.0, v85
    v_add_f32 v77, v80, v81
    v_add_f32 v85, v88, v89
    v_sub_f32 v78, v80, v81
    v_sub_f32 v86, v88, v89
    v_fma_f32 v79, v83, 2.0, v82
    v_fma_f32 v87, v91, 2.0, v90
    v_fma_f32 v82, v83, -2.0, v82
    v_fma_f32 v90, v91, -2.0, v90
    v_fmamk_f32 v80, v76, 0x41700000, v82
    v_fmamk_f32 v88, v84, 0x41700000, v90
    v_fmamk_f32 v80, v81, 0x41200000, v80
    v_fmamk_f32 v88, v89, 0x41200000, v88
    v_cvt_pk_bf16_f32 v4, v77, v85
    v_cvt_pk_bf16_f32 v8, v78, v86
    v_cvt_pk_bf16_f32 v64, v79, v87
    v_cvt_pk_bf16_f32 v68, v82, v90
    v_cvt_pk_bf16_f32 v72, v80, v88
    v_lshlrev_b32 v76, 16, v1
    v_and_b32 v84, s25, v1
    v_lshlrev_b32 v77, 16, v5
    v_and_b32 v85, s25, v5
    v_lshlrev_b32 v78, 16, v9
    v_and_b32 v86, s25, v9
    buffer_load_dwordx4 v[32:35], v92, s[8:11], s24 offen
    buffer_load_dwordx4 v[40:43], v94, s[8:11], s24 offen
    v_lshlrev_b32 v79, 16, v13
    v_and_b32 v87, s25, v13
    v_add_f32 v80, v76, v78
    v_add_f32 v88, v84, v86
    v_add_f32 v81, v77, v79
    v_add_f32 v89, v85, v87
    v_fma_f32 v82, v78, 4.0, v76
    v_fma_f32 v90, v86, 4.0, v84
    v_fma_f32 v83, v79, 4.0, v77
    v_fma_f32 v91, v87, 4.0, v85
    v_add_f32 v77, v80, v81
    v_add_f32 v85, v88, v89
    v_sub_f32 v78, v80, v81
    v_sub_f32 v86, v88, v89
    v_fma_f32 v79, v83, 2.0, v82
    v_fma_f32 v87, v91, 2.0, v90
    v_fma_f32 v82, v83, -2.0, v82
    v_fma_f32 v90, v91, -2.0, v90
    v_fmamk_f32 v80, v76, 0x41700000, v82
    v_fmamk_f32 v88, v84, 0x41700000, v90
    v_fmamk_f32 v80, v81, 0x41200000, v80
    v_fmamk_f32 v88, v89, 0x41200000, v88
    v_cvt_pk_bf16_f32 v5, v77, v85
    v_cvt_pk_bf16_f32 v9, v78, v86
    v_cvt_pk_bf16_f32 v65, v79, v87
    v_cvt_pk_bf16_f32 v69, v82, v90
    v_cvt_pk_bf16_f32 v73, v80, v88
    v_lshlrev_b32 v76, 16, v2
    v_and_b32 v84, s25, v2
    v_lshlrev_b32 v77, 16, v6
    v_and_b32 v85, s25, v6
    v_lshlrev_b32 v78, 16, v10
    v_and_b32 v86, s25, v10
    v_lshlrev_b32 v79, 16, v14
    v_and_b32 v87, s25, v14
    v_add_f32 v80, v76, v78
    v_add_f32 v88, v84, v86
    v_add_f32 v81, v77, v79
    v_add_f32 v89, v85, v87
    v_fma_f32 v82, v78, 4.0, v76
    v_fma_f32 v90, v86, 4.0, v84
    v_fma_f32 v83, v79, 4.0, v77
    v_fma_f32 v91, v87, 4.0, v85
    v_add_f32 v77, v80, v81
    v_add_f32 v85, v88, v89
    v_sub_f32 v78, v80, v81
    v_sub_f32 v86, v88, v89
    v_fma_f32 v79, v83, 2.0, v82
    v_fma_f32 v87, v91, 2.0, v90
    v_fma_f32 v82, v83, -2.0, v82
    v_fma_f32 v90, v91, -2.0, v90
    v_fmamk_f32 v80, v76, 0x41700000, v82
    v_fmamk_f32 v88, v84, 0x41700000, v90
    buffer_load_dwordx4 v[36:39], v93, s[8:11], s24 offen
    buffer_load_dwordx4 v[44:47], v95, s[8:11], s24 offen
    v_fmamk_f32 v80, v81, 0x41200000, v80
    v_fmamk_f32 v88, v89, 0x41200000, v88
    v_cvt_pk_bf16_f32 v6, v77, v85
    v_cvt_pk_bf16_f32 v10, v78, v86
    v_cvt_pk_bf16_f32 v66, v79, v87
    v_cvt_pk_bf16_f32 v70, v82, v90
    v_cvt_pk_bf16_f32 v74, v80, v88
    v_lshlrev_b32 v76, 16, v3
    v_and_b32 v84, s25, v3
    v_lshlrev_b32 v77, 16, v7
    v_and_b32 v85, s25, v7
    v_lshlrev_b32 v78, 16, v11
    v_and_b32 v86, s25, v11
    v_lshlrev_b32 v79, 16, v15
    v_and_b32 v87, s25, v15
    v_add_f32 v80, v76, v78
    v_add_f32 v88, v84, v86
    v_add_f32 v81, v77, v79
    v_add_f32 v89, v85, v87
    v_fma_f32 v82, v78, 4.0, v76
    v_fma_f32 v90, v86, 4.0, v84
    v_fma_f32 v83, v79, 4.0, v77
    v_fma_f32 v91, v87, 4.0, v85
    v_add_f32 v77, v80, v81
    v_add_f32 v85, v88, v89
    v_sub_f32 v78, v80, v81
    v_sub_f32 v86, v88, v89
    v_fma_f32 v79, v83, 2.0, v82
    v_fma_f32 v87, v91, 2.0, v90
    v_fma_f32 v82, v83, -2.0, v82
    v_fma_f32 v90, v91, -2.0, v90
    v_fmamk_f32 v80, v76, 0x41700000, v82
    v_fmamk_f32 v88, v84, 0x41700000, v90
    v_fmamk_f32 v80, v81, 0x41200000, v80
    v_fmamk_f32 v88, v89, 0x41200000, v88
    v_cvt_pk_bf16_f32 v7, v77, v85
    v_cvt_pk_bf16_f32 v11, v78, v86
    v_cvt_pk_bf16_f32 v67, v79, v87
    v_cvt_pk_bf16_f32 v71, v82, v90
    v_cvt_pk_bf16_f32 v75, v80, v88
    ds_write_b128 v96, v[64:67] offset:49152
    ds_write_b128 v97, v[68:71] offset:0
    ds_write_b128 v97, v[72:75] offset:16384
    ds_write_b128 v96, v[0:3] offset:0
    ds_write_b128 v96, v[4:7] offset:16384
    ds_write_b128 v96, v[8:11] offset:32768
    ds_write_b128 v98, v[12:15] offset:0
    s_add_u32 s28, s28, 1
    s_waitcnt lgkmcnt(0)
    s_barrier
    s_sub_u32 s22, s22, 1
    s_branch L_conv2_kernel_hloop1
L_conv2_kernel_hlast1:
    s_cmp_ge_u32 s2, 32
    s_cbranch_scc1 L_conv2_kernel_ntw
    s_getpc_b64 s[36:37]
L_conv2_kernel_pc:
    s_lshl_b32 s38, s32, 13
    s_add_u32 s38, s38, L_conv2_kernel_epi-L_conv2_kernel_pc
    v_lshl_add_u32 v2, v127, 7, s38
    v_min_u32 v2, L_joint_kernel_done-L_conv2_kernel_pc, v2
    v_mov_b32 v3, s37
    v_add_co_u32 v2, vcc, s36, v2
    s_nop 1
    v_addc_co_u32 v3, vcc, 0, v3, vcc
    global_load_dword v4, v[2:3], off
L_conv2_kernel_ntw:
    s_branch L_conv2_kernel_end
L_conv2_kernel_h2:
    ds_write_b128 v96, v[0:3] offset:0
    ds_write_b128 v98, v[12:15] offset:0
    v_lshlrev_b32 v76, 16, v0
    v_and_b32 v84, s25, v0
    v_lshlrev_b32 v77, 16, v4
    v_and_b32 v85, s25, v4
    v_lshlrev_b32 v78, 16, v8
    v_and_b32 v86, s25, v8
    v_lshlrev_b32 v79, 16, v12
    v_and_b32 v87, s25, v12
    v_add_f32 v80, v76, v78
    v_add_f32 v88, v84, v86
    v_add_f32 v81, v77, v79
    v_add_f32 v89, v85, v87
    v_fma_f32 v82, v78, 4.0, v76
    v_fma_f32 v90, v86, 4.0, v84
    v_fma_f32 v83, v79, 4.0, v77
    v_fma_f32 v91, v87, 4.0, v85
    v_add_f32 v77, v80, v81
    v_add_f32 v85, v88, v89
    v_sub_f32 v78, v80, v81
    v_sub_f32 v86, v88, v89
    v_fma_f32 v79, v83, 2.0, v82
    v_fma_f32 v87, v91, 2.0, v90
    v_fma_f32 v82, v83, -2.0, v82
    v_fma_f32 v90, v91, -2.0, v90
    v_fmamk_f32 v80, v76, 0x41700000, v82
    v_fmamk_f32 v88, v84, 0x41700000, v90
    v_fmamk_f32 v80, v81, 0x41200000, v80
    v_fmamk_f32 v88, v89, 0x41200000, v88
    v_cvt_pk_bf16_f32 v4, v77, v85
    v_cvt_pk_bf16_f32 v8, v78, v86
    v_cvt_pk_bf16_f32 v64, v79, v87
    v_cvt_pk_bf16_f32 v68, v82, v90
    v_cvt_pk_bf16_f32 v72, v80, v88
    v_lshlrev_b32 v76, 16, v1
    v_and_b32 v84, s25, v1
    v_lshlrev_b32 v77, 16, v5
    v_and_b32 v85, s25, v5
    v_lshlrev_b32 v78, 16, v9
    v_and_b32 v86, s25, v9
    v_lshlrev_b32 v79, 16, v13
    v_and_b32 v87, s25, v13
    v_add_f32 v80, v76, v78
    v_add_f32 v88, v84, v86
    v_add_f32 v81, v77, v79
    v_add_f32 v89, v85, v87
    v_fma_f32 v82, v78, 4.0, v76
    v_fma_f32 v90, v86, 4.0, v84
    v_fma_f32 v83, v79, 4.0, v77
    v_fma_f32 v91, v87, 4.0, v85
    v_add_f32 v77, v80, v81
    v_add_f32 v85, v88, v89
    v_sub_f32 v78, v80, v81
    v_sub_f32 v86, v88, v89
    v_fma_f32 v79, v83, 2.0, v82
    v_fma_f32 v87, v91, 2.0, v90
    v_fma_f32 v82, v83, -2.0, v82
    v_fma_f32 v90, v91, -2.0, v90
    v_fmamk_f32 v80, v76, 0x41700000, v82
    v_fmamk_f32 v88, v84, 0x41700000, v90
    v_fmamk_f32 v80, v81, 0x41200000, v80
    v_fmamk_f32 v88, v89, 0x41200000, v88
    v_cvt_pk_bf16_f32 v5, v77, v85
    v_cvt_pk_bf16_f32 v9, v78, v86
    v_cvt_pk_bf16_f32 v65, v79, v87
    v_cvt_pk_bf16_f32 v69, v82, v90
    v_cvt_pk_bf16_f32 v73, v80, v88
    v_lshlrev_b32 v76, 16, v2
    v_and_b32 v84, s25, v2
    v_lshlrev_b32 v77, 16, v6
    v_and_b32 v85, s25, v6
    v_lshlrev_b32 v78, 16, v10
    v_and_b32 v86, s25, v10
    v_lshlrev_b32 v79, 16, v14
    v_and_b32 v87, s25, v14
    v_add_f32 v80, v76, v78
    v_add_f32 v88, v84, v86
    v_add_f32 v81, v77, v79
    v_add_f32 v89, v85, v87
    v_fma_f32 v82, v78, 4.0, v76
    v_fma_f32 v90, v86, 4.0, v84
    v_fma_f32 v83, v79, 4.0, v77
    v_fma_f32 v91, v87, 4.0, v85
    v_add_f32 v77, v80, v81
    v_add_f32 v85, v88, v89
    v_sub_f32 v78, v80, v81
    v_sub_f32 v86, v88, v89
    v_fma_f32 v79, v83, 2.0, v82
    v_fma_f32 v87, v91, 2.0, v90
    v_fma_f32 v82, v83, -2.0, v82
    v_fma_f32 v90, v91, -2.0, v90
    v_fmamk_f32 v80, v76, 0x41700000, v82
    v_fmamk_f32 v88, v84, 0x41700000, v90
    v_fmamk_f32 v80, v81, 0x41200000, v80
    v_fmamk_f32 v88, v89, 0x41200000, v88
    v_cvt_pk_bf16_f32 v6, v77, v85
    v_cvt_pk_bf16_f32 v10, v78, v86
    v_cvt_pk_bf16_f32 v66, v79, v87
    v_cvt_pk_bf16_f32 v70, v82, v90
    v_cvt_pk_bf16_f32 v74, v80, v88
    v_lshlrev_b32 v76, 16, v3
    v_and_b32 v84, s25, v3
    v_lshlrev_b32 v77, 16, v7
    v_and_b32 v85, s25, v7
    v_lshlrev_b32 v78, 16, v11
    v_and_b32 v86, s25, v11
    v_lshlrev_b32 v79, 16, v15
    v_and_b32 v87, s25, v15
    v_add_f32 v80, v76, v78
    v_add_f32 v88, v84, v86
    v_add_f32 v81, v77, v79
    v_add_f32 v89, v85, v87
    v_fma_f32 v82, v78, 4.0, v76
    v_fma_f32 v90, v86, 4.0, v84
    v_fma_f32 v83, v79, 4.0, v77
    v_fma_f32 v91, v87, 4.0, v85
    v_add_f32 v77, v80, v81
    v_add_f32 v85, v88, v89
    v_sub_f32 v78, v80, v81
    v_sub_f32 v86, v88, v89
    v_fma_f32 v79, v83, 2.0, v82
    v_fma_f32 v87, v91, 2.0, v90
    v_fma_f32 v82, v83, -2.0, v82
    v_fma_f32 v90, v91, -2.0, v90
    v_fmamk_f32 v80, v76, 0x41700000, v82
    v_fmamk_f32 v88, v84, 0x41700000, v90
    v_fmamk_f32 v80, v81, 0x41200000, v80
    v_fmamk_f32 v88, v89, 0x41200000, v88
    v_cvt_pk_bf16_f32 v7, v77, v85
    v_cvt_pk_bf16_f32 v11, v78, v86
    v_cvt_pk_bf16_f32 v67, v79, v87
    v_cvt_pk_bf16_f32 v71, v82, v90
    v_cvt_pk_bf16_f32 v75, v80, v88
    ds_write_b128 v96, v[64:67] offset:49152
    ds_write_b128 v97, v[68:71] offset:0
    ds_write_b128 v97, v[72:75] offset:16384
    ds_write_b128 v96, v[4:7] offset:16384
    ds_write_b128 v96, v[8:11] offset:32768
    s_waitcnt vmcnt(0)
    s_mov_b32 s24, 1048576
    s_mov_b32 s27, 1572864
    s_waitcnt lgkmcnt(0)
    s_barrier
    buffer_load_dwordx4 v[32:35], v92, s[8:11], s24 offen
    buffer_load_dwordx4 v[40:43], v94, s[8:11], s24 offen
    buffer_load_dwordx4 v[36:39], v93, s[8:11], s24 offen
    buffer_load_dwordx4 v[44:47], v95, s[8:11], s24 offen
    buffer_load_dwordx4 v[48:51], v92, s[8:11], s27 offen
    buffer_load_dwordx4 v[56:59], v94, s[8:11], s27 offen
    buffer_load_dwordx4 v[52:55], v93, s[8:11], s27 offen
    buffer_load_dwordx4 v[60:63], v95, s[8:11], s27 offen
    s_setprio 0
    v_lshlrev_b32 v76, 16, v16
    v_and_b32 v84, s25, v16
    v_lshlrev_b32 v77, 16, v20
    v_and_b32 v85, s25, v20
    v_lshlrev_b32 v78, 16, v24
    v_and_b32 v86, s25, v24
    v_lshlrev_b32 v79, 16, v28
    v_and_b32 v87, s25, v28
    v_add_f32 v80, v76, v78
    v_add_f32 v88, v84, v86
    v_add_f32 v81, v77, v79
    v_add_f32 v89, v85, v87
    v_fma_f32 v82, v78, 4.0, v76
    v_fma_f32 v90, v86, 4.0, v84
    v_fma_f32 v83, v79, 4.0, v77
    v_fma_f32 v91, v87, 4.0, v85
    v_add_f32 v77, v80, v81
    v_add_f32 v85, v88, v89
    v_sub_f32 v78, v80, v81
    v_sub_f32 v86, v88, v89
    v_fma_f32 v79, v83, 2.0, v82
    v_fma_f32 v87, v91, 2.0, v90
    v_fma_f32 v82, v83, -2.0, v82
    v_fma_f32 v90, v91, -2.0, v90
    v_fmamk_f32 v80, v76, 0x41700000, v82
    v_fmamk_f32 v88, v84, 0x41700000, v90
    v_fmamk_f32 v80, v81, 0x41200000, v80
    v_fmamk_f32 v88, v89, 0x41200000, v88
    v_cvt_pk_bf16_f32 v20, v77, v85
    v_cvt_pk_bf16_f32 v24, v78, v86
    v_cvt_pk_bf16_f32 v64, v79, v87
    v_cvt_pk_bf16_f32 v68, v82, v90
    v_cvt_pk_bf16_f32 v72, v80, v88
    v_lshlrev_b32 v76, 16, v17
    v_and_b32 v84, s25, v17
    v_lshlrev_b32 v77, 16, v21
    v_and_b32 v85, s25, v21
    v_lshlrev_b32 v78, 16, v25
    v_and_b32 v86, s25, v25
    v_lshlrev_b32 v79, 16, v29
    v_and_b32 v87, s25, v29
    v_add_f32 v80, v76, v78
    v_add_f32 v88, v84, v86
    v_add_f32 v81, v77, v79
    v_add_f32 v89, v85, v87
    v_fma_f32 v82, v78, 4.0, v76
    v_fma_f32 v90, v86, 4.0, v84
    v_fma_f32 v83, v79, 4.0, v77
    v_fma_f32 v91, v87, 4.0, v85
    v_add_f32 v77, v80, v81
    v_add_f32 v85, v88, v89
    v_sub_f32 v78, v80, v81
    v_sub_f32 v86, v88, v89
    v_fma_f32 v79, v83, 2.0, v82
    v_fma_f32 v87, v91, 2.0, v90
    v_fma_f32 v82, v83, -2.0, v82
    v_fma_f32 v90, v91, -2.0, v90
    v_fmamk_f32 v80, v76, 0x41700000, v82
    v_fmamk_f32 v88, v84, 0x41700000, v90
    v_fmamk_f32 v80, v81, 0x41200000, v80
    v_fmamk_f32 v88, v89, 0x41200000, v88
    v_cvt_pk_bf16_f32 v21, v77, v85
    v_cvt_pk_bf16_f32 v25, v78, v86
    v_cvt_pk_bf16_f32 v65, v79, v87
    v_cvt_pk_bf16_f32 v69, v82, v90
    v_cvt_pk_bf16_f32 v73, v80, v88
    v_lshlrev_b32 v76, 16, v18
    v_and_b32 v84, s25, v18
    v_lshlrev_b32 v77, 16, v22
    v_and_b32 v85, s25, v22
    v_lshlrev_b32 v78, 16, v26
    v_and_b32 v86, s25, v26
    v_lshlrev_b32 v79, 16, v30
    v_and_b32 v87, s25, v30
    v_add_f32 v80, v76, v78
    v_add_f32 v88, v84, v86
    v_add_f32 v81, v77, v79
    v_add_f32 v89, v85, v87
    v_fma_f32 v82, v78, 4.0, v76
    v_fma_f32 v90, v86, 4.0, v84
    v_fma_f32 v83, v79, 4.0, v77
    v_fma_f32 v91, v87, 4.0, v85
    v_add_f32 v77, v80, v81
    v_add_f32 v85, v88, v89
    v_sub_f32 v78, v80, v81
    v_sub_f32 v86, v88, v89
    v_fma_f32 v79, v83, 2.0, v82
    v_fma_f32 v87, v91, 2.0, v90
    v_fma_f32 v82, v83, -2.0, v82
    v_fma_f32 v90, v91, -2.0, v90
    v_fmamk_f32 v80, v76, 0x41700000, v82
    v_fmamk_f32 v88, v84, 0x41700000, v90
    v_fmamk_f32 v80, v81, 0x41200000, v80
    v_fmamk_f32 v88, v89, 0x41200000, v88
    v_cvt_pk_bf16_f32 v22, v77, v85
    v_cvt_pk_bf16_f32 v26, v78, v86
    v_cvt_pk_bf16_f32 v66, v79, v87
    v_cvt_pk_bf16_f32 v70, v82, v90
    v_cvt_pk_bf16_f32 v74, v80, v88
    v_lshlrev_b32 v76, 16, v19
    v_and_b32 v84, s25, v19
    v_lshlrev_b32 v77, 16, v23
    v_and_b32 v85, s25, v23
    v_lshlrev_b32 v78, 16, v27
    v_and_b32 v86, s25, v27
    v_lshlrev_b32 v79, 16, v31
    v_and_b32 v87, s25, v31
    v_add_f32 v80, v76, v78
    v_add_f32 v88, v84, v86
    v_add_f32 v81, v77, v79
    v_add_f32 v89, v85, v87
    v_fma_f32 v82, v78, 4.0, v76
    v_fma_f32 v90, v86, 4.0, v84
    v_fma_f32 v83, v79, 4.0, v77
    v_fma_f32 v91, v87, 4.0, v85
    v_add_f32 v77, v80, v81
    v_add_f32 v85, v88, v89
    v_sub_f32 v78, v80, v81
    v_sub_f32 v86, v88, v89
    v_fma_f32 v79, v83, 2.0, v82
    v_fma_f32 v87, v91, 2.0, v90
    v_fma_f32 v82, v83, -2.0, v82
    v_fma_f32 v90, v91, -2.0, v90
    v_fmamk_f32 v80, v76, 0x41700000, v82
    v_fmamk_f32 v88, v84, 0x41700000, v90
    v_fmamk_f32 v80, v81, 0x41200000, v80
    v_fmamk_f32 v88, v89, 0x41200000, v88
    v_cvt_pk_bf16_f32 v23, v77, v85
    v_cvt_pk_bf16_f32 v27, v78, v86
    v_cvt_pk_bf16_f32 v67, v79, v87
    v_cvt_pk_bf16_f32 v71, v82, v90
    v_cvt_pk_bf16_f32 v75, v80, v88
L_conv2_kernel_hloop2:
    s_add_u32 s24, s24, 1048576
    s_add_u32 s27, s27, 1048576
    ds_write_b128 v96, v[64:67] offset:57344
    ds_write_b128 v97, v[68:71] offset:8192
    ds_write_b128 v97, v[72:75] offset:24576
    ds_write_b128 v96, v[16:19] offset:8192
    ds_write_b128 v96, v[20:23] offset:24576
    ds_write_b128 v96, v[24:27] offset:40960
    ds_write_b128 v98, v[28:31] offset:8704
    s_waitcnt vmcnt(0)
    buffer_load_dwordx4 v[0:3], v92, s[8:11], s24 offen
    buffer_load_dwordx4 v[8:11], v94, s[8:11], s24 offen
    buffer_load_dwordx4 v[4:7], v93, s[8:11], s24 offen
    buffer_load_dwordx4 v[12:15], v95, s[8:11], s24 offen
    v_lshlrev_b32 v76, 16, v32
    v_and_b32 v84, s25, v32
    v_lshlrev_b32 v77, 16, v36
    v_and_b32 v85, s25, v36
    v_lshlrev_b32 v78, 16, v40
    v_and_b32 v86, s25, v40
    v_lshlrev_b32 v79, 16, v44
    v_and_b32 v87, s25, v44
    v_add_f32 v80, v76, v78
    v_add_f32 v88, v84, v86
    v_add_f32 v81, v77, v79
    v_add_f32 v89, v85, v87
    v_fma_f32 v82, v78, 4.0, v76
    v_fma_f32 v90, v86, 4.0, v84
    v_fma_f32 v83, v79, 4.0, v77
    v_fma_f32 v91, v87, 4.0, v85
    v_add_f32 v77, v80, v81
    v_add_f32 v85, v88, v89
    v_sub_f32 v78, v80, v81
    v_sub_f32 v86, v88, v89
    v_fma_f32 v79, v83, 2.0, v82
    v_fma_f32 v87, v91, 2.0, v90
    v_fma_f32 v82, v83, -2.0, v82
    v_fma_f32 v90, v91, -2.0, v90
    v_fmamk_f32 v80, v76, 0x41700000, v82
    v_fmamk_f32 v88, v84, 0x41700000, v90
    v_fmamk_f32 v80, v81, 0x41200000, v80
    v_fmamk_f32 v88, v89, 0x41200000, v88
    v_cvt_pk_bf16_f32 v36, v77, v85
    v_cvt_pk_bf16_f32 v40, v78, v86
    v_cvt_pk_bf16_f32 v64, v79, v87
    v_cvt_pk_bf16_f32 v68, v82, v90
    v_cvt_pk_bf16_f32 v72, v80, v88
    v_lshlrev_b32 v76, 16, v33
    v_and_b32 v84, s25, v33
    v_lshlrev_b32 v77, 16, v37
    v_and_b32 v85, s25, v37
    v_lshlrev_b32 v78, 16, v41
    v_and_b32 v86, s25, v41
    v_lshlrev_b32 v79, 16, v45
    v_and_b32 v87, s25, v45
    v_add_f32 v80, v76, v78
    v_add_f32 v88, v84, v86
    v_add_f32 v81, v77, v79
    v_add_f32 v89, v85, v87
    v_fma_f32 v82, v78, 4.0, v76
    v_fma_f32 v90, v86, 4.0, v84
    v_fma_f32 v83, v79, 4.0, v77
    v_fma_f32 v91, v87, 4.0, v85
    v_add_f32 v77, v80, v81
    v_add_f32 v85, v88, v89
    v_sub_f32 v78, v80, v81
    v_sub_f32 v86, v88, v89
    v_fma_f32 v79, v83, 2.0, v82
    v_fma_f32 v87, v91, 2.0, v90
    v_fma_f32 v82, v83, -2.0, v82
    v_fma_f32 v90, v91, -2.0, v90
    v_fmamk_f32 v80, v76, 0x41700000, v82
    v_fmamk_f32 v88, v84, 0x41700000, v90
    v_fmamk_f32 v80, v81, 0x41200000, v80
    v_fmamk_f32 v88, v89, 0x41200000, v88
    v_cvt_pk_bf16_f32 v37, v77, v85
    v_cvt_pk_bf16_f32 v41, v78, v86
    v_cvt_pk_bf16_f32 v65, v79, v87
    v_cvt_pk_bf16_f32 v69, v82, v90
    v_cvt_pk_bf16_f32 v73, v80, v88
    v_lshlrev_b32 v76, 16, v34
    v_and_b32 v84, s25, v34
    v_lshlrev_b32 v77, 16, v38
    v_and_b32 v85, s25, v38
    v_lshlrev_b32 v78, 16, v42
    v_and_b32 v86, s25, v42
    v_lshlrev_b32 v79, 16, v46
    v_and_b32 v87, s25, v46
    v_add_f32 v80, v76, v78
    v_add_f32 v88, v84, v86
    v_add_f32 v81, v77, v79
    v_add_f32 v89, v85, v87
    v_fma_f32 v82, v78, 4.0, v76
    v_fma_f32 v90, v86, 4.0, v84
    v_fma_f32 v83, v79, 4.0, v77
    v_fma_f32 v91, v87, 4.0, v85
    v_add_f32 v77, v80, v81
    v_add_f32 v85, v88, v89
    v_sub_f32 v78, v80, v81
    v_sub_f32 v86, v88, v89
    v_fma_f32 v79, v83, 2.0, v82
    v_fma_f32 v87, v91, 2.0, v90
    v_fma_f32 v82, v83, -2.0, v82
    v_fma_f32 v90, v91, -2.0, v90
    v_fmamk_f32 v80, v76, 0x41700000, v82
    v_fmamk_f32 v88, v84, 0x41700000, v90
    v_fmamk_f32 v80, v81, 0x41200000, v80
    v_fmamk_f32 v88, v89, 0x41200000, v88
    v_cvt_pk_bf16_f32 v38, v77, v85
    v_cvt_pk_bf16_f32 v42, v78, v86
    v_cvt_pk_bf16_f32 v66, v79, v87
    v_cvt_pk_bf16_f32 v70, v82, v90
    v_cvt_pk_bf16_f32 v74, v80, v88
    v_lshlrev_b32 v76, 16, v35
    v_and_b32 v84, s25, v35
    v_lshlrev_b32 v77, 16, v39
    v_and_b32 v85, s25, v39
    v_lshlrev_b32 v78, 16, v43
    v_and_b32 v86, s25, v43
    v_lshlrev_b32 v79, 16, v47
    v_and_b32 v87, s25, v47
    v_add_f32 v80, v76, v78
    v_add_f32 v88, v84, v86
    v_add_f32 v81, v77, v79
    v_add_f32 v89, v85, v87
    v_fma_f32 v82, v78, 4.0, v76
    v_fma_f32 v90, v86, 4.0, v84
    v_fma_f32 v83, v79, 4.0, v77
    v_fma_f32 v91, v87, 4.0, v85
    v_add_f32 v77, v80, v81
    v_add_f32 v85, v88, v89
    v_sub_f32 v78, v80, v81
    v_sub_f32 v86, v88, v89
    v_fma_f32 v79, v83, 2.0, v82
    v_fma_f32 v87, v91, 2.0, v90
    v_fma_f32 v82, v83, -2.0, v82
    v_fma_f32 v90, v91, -2.0, v90
    v_fmamk_f32 v80, v76, 0x41700000, v82
    v_fmamk_f32 v88, v84, 0x41700000, v90
    v_fmamk_f32 v80, v81, 0x41200000, v80
    v_fmamk_f32 v88, v89, 0x41200000, v88
    v_cvt_pk_bf16_f32 v39, v77, v85
    v_cvt_pk_bf16_f32 v43, v78, v86
    v_cvt_pk_bf16_f32 v67, v79, v87
    v_cvt_pk_bf16_f32 v71, v82, v90
    v_cvt_pk_bf16_f32 v75, v80, v88
    s_add_u32 s28, s28, 1
    s_waitcnt lgkmcnt(0)
    s_barrier
    ds_write_b128 v96, v[64:67] offset:49152
    ds_write_b128 v97, v[68:71] offset:0
    ds_write_b128 v97, v[72:75] offset:16384
    ds_write_b128 v96, v[32:35] offset:0
    ds_write_b128 v96, v[36:39] offset:16384
    ds_write_b128 v96, v[40:43] offset:32768
    ds_write_b128 v98, v[44:47] offset:0
    buffer_load_dwordx4 v[16:19], v92, s[8:11], s27 offen
    buffer_load_dwordx4 v[24:27], v94, s[8:11], s27 offen
    buffer_load_dwordx4 v[20:23], v93, s[8:11], s27 offen
    buffer_load_dwordx4 v[28:31], v95, s[8:11], s27 offen
    v_lshlrev_b32 v76, 16, v48
    v_and_b32 v84, s25, v48
    v_lshlrev_b32 v77, 16, v52
    v_and_b32 v85, s25, v52
    v_lshlrev_b32 v78, 16, v56
    v_and_b32 v86, s25, v56
    v_lshlrev_b32 v79, 16, v60
    v_and_b32 v87, s25, v60
    v_add_f32 v80, v76, v78
    v_add_f32 v88, v84, v86
    v_add_f32 v81, v77, v79
    v_add_f32 v89, v85, v87
    v_fma_f32 v82, v78, 4.0, v76
    v_fma_f32 v90, v86, 4.0, v84
    v_fma_f32 v83, v79, 4.0, v77
    v_fma_f32 v91, v87, 4.0, v85
    v_add_f32 v77, v80, v81
    v_add_f32 v85, v88, v89
    v_sub_f32 v78, v80, v81
    v_sub_f32 v86, v88, v89
    v_fma_f32 v79, v83, 2.0, v82
    v_fma_f32 v87, v91, 2.0, v90
    v_fma_f32 v82, v83, -2.0, v82
    v_fma_f32 v90, v91, -2.0, v90
    v_fmamk_f32 v80, v76, 0x41700000, v82
    v_fmamk_f32 v88, v84, 0x41700000, v90
    v_fmamk_f32 v80, v81, 0x41200000, v80
    v_fmamk_f32 v88, v89, 0x41200000, v88
    v_cvt_pk_bf16_f32 v52, v77, v85
    v_cvt_pk_bf16_f32 v56, v78, v86
    v_cvt_pk_bf16_f32 v64, v79, v87
    v_cvt_pk_bf16_f32 v68, v82, v90
    v_cvt_pk_bf16_f32 v72, v80, v88
    v_lshlrev_b32 v76, 16, v49
    v_and_b32 v84, s25, v49
    v_lshlrev_b32 v77, 16, v53
    v_and_b32 v85, s25, v53
    v_lshlrev_b32 v78, 16, v57
    v_and_b32 v86, s25, v57
    v_lshlrev_b32 v79, 16, v61
    v_and_b32 v87, s25, v61
    v_add_f32 v80, v76, v78
    v_add_f32 v88, v84, v86
    v_add_f32 v81, v77, v79
    v_add_f32 v89, v85, v87
    v_fma_f32 v82, v78, 4.0, v76
    v_fma_f32 v90, v86, 4.0, v84
    v_fma_f32 v83, v79, 4.0, v77
    v_fma_f32 v91, v87, 4.0, v85
    v_add_f32 v77, v80, v81
    v_add_f32 v85, v88, v89
    v_sub_f32 v78, v80, v81
    v_sub_f32 v86, v88, v89
    v_fma_f32 v79, v83, 2.0, v82
    v_fma_f32 v87, v91, 2.0, v90
    v_fma_f32 v82, v83, -2.0, v82
    v_fma_f32 v90, v91, -2.0, v90
    v_fmamk_f32 v80, v76, 0x41700000, v82
    v_fmamk_f32 v88, v84, 0x41700000, v90
    v_fmamk_f32 v80, v81, 0x41200000, v80
    v_fmamk_f32 v88, v89, 0x41200000, v88
    v_cvt_pk_bf16_f32 v53, v77, v85
    v_cvt_pk_bf16_f32 v57, v78, v86
    v_cvt_pk_bf16_f32 v65, v79, v87
    v_cvt_pk_bf16_f32 v69, v82, v90
    v_cvt_pk_bf16_f32 v73, v80, v88
    v_lshlrev_b32 v76, 16, v50
    v_and_b32 v84, s25, v50
    v_lshlrev_b32 v77, 16, v54
    v_and_b32 v85, s25, v54
    v_lshlrev_b32 v78, 16, v58
    v_and_b32 v86, s25, v58
    v_lshlrev_b32 v79, 16, v62
    v_and_b32 v87, s25, v62
    v_add_f32 v80, v76, v78
    v_add_f32 v88, v84, v86
    v_add_f32 v81, v77, v79
    v_add_f32 v89, v85, v87
    v_fma_f32 v82, v78, 4.0, v76
    v_fma_f32 v90, v86, 4.0, v84
    v_fma_f32 v83, v79, 4.0, v77
    v_fma_f32 v91, v87, 4.0, v85
    v_add_f32 v77, v80, v81
    v_add_f32 v85, v88, v89
    v_sub_f32 v78, v80, v81
    v_sub_f32 v86, v88, v89
    v_fma_f32 v79, v83, 2.0, v82
    v_fma_f32 v87, v91, 2.0, v90
    v_fma_f32 v82, v83, -2.0, v82
    v_fma_f32 v90, v91, -2.0, v90
    v_fmamk_f32 v80, v76, 0x41700000, v82
    v_fmamk_f32 v88, v84, 0x41700000, v90
    v_fmamk_f32 v80, v81, 0x41200000, v80
    v_fmamk_f32 v88, v89, 0x41200000, v88
    v_cvt_pk_bf16_f32 v54, v77, v85
    v_cvt_pk_bf16_f32 v58, v78, v86
    v_cvt_pk_bf16_f32 v66, v79, v87
    v_cvt_pk_bf16_f32 v70, v82, v90
    v_cvt_pk_bf16_f32 v74, v80, v88
    v_lshlrev_b32 v76, 16, v51
    v_and_b32 v84, s25, v51
    v_lshlrev_b32 v77, 16, v55
    v_and_b32 v85, s25, v55
    v_lshlrev_b32 v78, 16, v59
    v_and_b32 v86, s25, v59
    v_lshlrev_b32 v79, 16, v63
    v_and_b32 v87, s25, v63
    v_add_f32 v80, v76, v78
    v_add_f32 v88, v84, v86
    v_add_f32 v81, v77, v79
    v_add_f32 v89, v85, v87
    v_fma_f32 v82, v78, 4.0, v76
    v_fma_f32 v90, v86, 4.0, v84
    v_fma_f32 v83, v79, 4.0, v77
    v_fma_f32 v91, v87, 4.0, v85
    v_add_f32 v77, v80, v81
    v_add_f32 v85, v88, v89
    v_sub_f32 v78, v80, v81
    v_sub_f32 v86, v88, v89
    v_fma_f32 v79, v83, 2.0, v82
    v_fma_f32 v87, v91, 2.0, v90
    v_fma_f32 v82, v83, -2.0, v82
    v_fma_f32 v90, v91, -2.0, v90
    v_fmamk_f32 v80, v76, 0x41700000, v82
    v_fmamk_f32 v88, v84, 0x41700000, v90
    v_fmamk_f32 v80, v81, 0x41200000, v80
    v_fmamk_f32 v88, v89, 0x41200000, v88
    v_cvt_pk_bf16_f32 v55, v77, v85
    v_cvt_pk_bf16_f32 v59, v78, v86
    v_cvt_pk_bf16_f32 v67, v79, v87
    v_cvt_pk_bf16_f32 v71, v82, v90
    v_cvt_pk_bf16_f32 v75, v80, v88
    s_add_u32 s28, s28, 1
    s_waitcnt lgkmcnt(0)
    s_barrier
    s_cmp_eq_u32 s22, 1
    s_cbranch_scc1 L_conv2_kernel_hlast2
    s_add_u32 s24, s24, 1048576
    s_add_u32 s27, s27, 1048576
    ds_write_b128 v96, v[64:67] offset:57344
    ds_write_b128 v97, v[68:71] offset:8192
    ds_write_b128 v97, v[72:75] offset:24576
    ds_write_b128 v96, v[48:51] offset:8192
    ds_write_b128 v96, v[52:55] offset:24576
    ds_write_b128 v96, v[56:59] offset:40960
    ds_write_b128 v98, v[60:63] offset:8704
    s_waitcnt vmcnt(0)
    buffer_load_dwordx4 v[32:35], v92, s[8:11], s24 offen
    buffer_load_dwordx4 v[40:43], v94, s[8:11], s24 offen
    buffer_load_dwordx4 v[36:39], v93, s[8:11], s24 offen
    buffer_load_dwordx4 v[44:47], v95, s[8:11], s24 offen
    v_lshlrev_b32 v76, 16, v0
    v_and_b32 v84, s25, v0
    v_lshlrev_b32 v77, 16, v4
    v_and_b32 v85, s25, v4
    v_lshlrev_b32 v78, 16, v8
    v_and_b32 v86, s25, v8
    v_lshlrev_b32 v79, 16, v12
    v_and_b32 v87, s25, v12
    v_add_f32 v80, v76, v78
    v_add_f32 v88, v84, v86
    v_add_f32 v81, v77, v79
    v_add_f32 v89, v85, v87
    v_fma_f32 v82, v78, 4.0, v76
    v_fma_f32 v90, v86, 4.0, v84
    v_fma_f32 v83, v79, 4.0, v77
    v_fma_f32 v91, v87, 4.0, v85
    v_add_f32 v77, v80, v81
    v_add_f32 v85, v88, v89
    v_sub_f32 v78, v80, v81
    v_sub_f32 v86, v88, v89
    v_fma_f32 v79, v83, 2.0, v82
    v_fma_f32 v87, v91, 2.0, v90
    v_fma_f32 v82, v83, -2.0, v82
    v_fma_f32 v90, v91, -2.0, v90
    v_fmamk_f32 v80, v76, 0x41700000, v82
    v_fmamk_f32 v88, v84, 0x41700000, v90
    v_fmamk_f32 v80, v81, 0x41200000, v80
    v_fmamk_f32 v88, v89, 0x41200000, v88
    v_cvt_pk_bf16_f32 v4, v77, v85
    v_cvt_pk_bf16_f32 v8, v78, v86
    v_cvt_pk_bf16_f32 v64, v79, v87
    v_cvt_pk_bf16_f32 v68, v82, v90
    v_cvt_pk_bf16_f32 v72, v80, v88
    v_lshlrev_b32 v76, 16, v1
    v_and_b32 v84, s25, v1
    v_lshlrev_b32 v77, 16, v5
    v_and_b32 v85, s25, v5
    v_lshlrev_b32 v78, 16, v9
    v_and_b32 v86, s25, v9
    v_lshlrev_b32 v79, 16, v13
    v_and_b32 v87, s25, v13
    v_add_f32 v80, v76, v78
    v_add_f32 v88, v84, v86
    v_add_f32 v81, v77, v79
    v_add_f32 v89, v85, v87
    v_fma_f32 v82, v78, 4.0, v76
    v_fma_f32 v90, v86, 4.0, v84
    v_fma_f32 v83, v79, 4.0, v77
    v_fma_f32 v91, v87, 4.0, v85
    v_add_f32 v77, v80, v81
    v_add_f32 v85, v88, v89
    v_sub_f32 v78, v80, v81
    v_sub_f32 v86, v88, v89
    v_fma_f32 v79, v83, 2.0, v82
    v_fma_f32 v87, v91, 2.0, v90
    v_fma_f32 v82, v83, -2.0, v82
    v_fma_f32 v90, v91, -2.0, v90
    v_fmamk_f32 v80, v76, 0x41700000, v82
    v_fmamk_f32 v88, v84, 0x41700000, v90
    v_fmamk_f32 v80, v81, 0x41200000, v80
    v_fmamk_f32 v88, v89, 0x41200000, v88
    v_cvt_pk_bf16_f32 v5, v77, v85
    v_cvt_pk_bf16_f32 v9, v78, v86
    v_cvt_pk_bf16_f32 v65, v79, v87
    v_cvt_pk_bf16_f32 v69, v82, v90
    v_cvt_pk_bf16_f32 v73, v80, v88
    v_lshlrev_b32 v76, 16, v2
    v_and_b32 v84, s25, v2
    v_lshlrev_b32 v77, 16, v6
    v_and_b32 v85, s25, v6
    v_lshlrev_b32 v78, 16, v10
    v_and_b32 v86, s25, v10
    v_lshlrev_b32 v79, 16, v14
    v_and_b32 v87, s25, v14
    v_add_f32 v80, v76, v78
    v_add_f32 v88, v84, v86
    v_add_f32 v81, v77, v79
    v_add_f32 v89, v85, v87
    v_fma_f32 v82, v78, 4.0, v76
    v_fma_f32 v90, v86, 4.0, v84
    v_fma_f32 v83, v79, 4.0, v77
    v_fma_f32 v91, v87, 4.0, v85
    v_add_f32 v77, v80, v81
    v_add_f32 v85, v88, v89
    v_sub_f32 v78, v80, v81
    v_sub_f32 v86, v88, v89
    v_fma_f32 v79, v83, 2.0, v82
    v_fma_f32 v87, v91, 2.0, v90
    v_fma_f32 v82, v83, -2.0, v82
    v_fma_f32 v90, v91, -2.0, v90
    v_fmamk_f32 v80, v76, 0x41700000, v82
    v_fmamk_f32 v88, v84, 0x41700000, v90
    v_fmamk_f32 v80, v81, 0x41200000, v80
    v_fmamk_f32 v88, v89, 0x41200000, v88
    v_cvt_pk_bf16_f32 v6, v77, v85
    v_cvt_pk_bf16_f32 v10, v78, v86
    v_cvt_pk_bf16_f32 v66, v79, v87
    v_cvt_pk_bf16_f32 v70, v82, v90
    v_cvt_pk_bf16_f32 v74, v80, v88
    v_lshlrev_b32 v76, 16, v3
    v_and_b32 v84, s25, v3
    v_lshlrev_b32 v77, 16, v7
    v_and_b32 v85, s25, v7
    v_lshlrev_b32 v78, 16, v11
    v_and_b32 v86, s25, v11
    v_lshlrev_b32 v79, 16, v15
    v_and_b32 v87, s25, v15
    v_add_f32 v80, v76, v78
    v_add_f32 v88, v84, v86
    v_add_f32 v81, v77, v79
    v_add_f32 v89, v85, v87
    v_fma_f32 v82, v78, 4.0, v76
    v_fma_f32 v90, v86, 4.0, v84
    v_fma_f32 v83, v79, 4.0, v77
    v_fma_f32 v91, v87, 4.0, v85
    v_add_f32 v77, v80, v81
    v_add_f32 v85, v88, v89
    v_sub_f32 v78, v80, v81
    v_sub_f32 v86, v88, v89
    v_fma_f32 v79, v83, 2.0, v82
    v_fma_f32 v87, v91, 2.0, v90
    v_fma_f32 v82, v83, -2.0, v82
    v_fma_f32 v90, v91, -2.0, v90
    v_fmamk_f32 v80, v76, 0x41700000, v82
    v_fmamk_f32 v88, v84, 0x41700000, v90
    v_fmamk_f32 v80, v81, 0x41200000, v80
    v_fmamk_f32 v88, v89, 0x41200000, v88
    v_cvt_pk_bf16_f32 v7, v77, v85
    v_cvt_pk_bf16_f32 v11, v78, v86
    v_cvt_pk_bf16_f32 v67, v79, v87
    v_cvt_pk_bf16_f32 v71, v82, v90
    v_cvt_pk_bf16_f32 v75, v80, v88
    s_add_u32 s28, s28, 1
    s_waitcnt lgkmcnt(0)
    s_barrier
    ds_write_b128 v96, v[64:67] offset:49152
    ds_write_b128 v97, v[68:71] offset:0
    ds_write_b128 v97, v[72:75] offset:16384
    ds_write_b128 v96, v[0:3] offset:0
    ds_write_b128 v96, v[4:7] offset:16384
    ds_write_b128 v96, v[8:11] offset:32768
    ds_write_b128 v98, v[12:15] offset:0
    buffer_load_dwordx4 v[48:51], v92, s[8:11], s27 offen
    buffer_load_dwordx4 v[56:59], v94, s[8:11], s27 offen
    buffer_load_dwordx4 v[52:55], v93, s[8:11], s27 offen
    buffer_load_dwordx4 v[60:63], v95, s[8:11], s27 offen
    v_lshlrev_b32 v76, 16, v16
    v_and_b32 v84, s25, v16
    v_lshlrev_b32 v77, 16, v20
    v_and_b32 v85, s25, v20
    v_lshlrev_b32 v78, 16, v24
    v_and_b32 v86, s25, v24
    v_lshlrev_b32 v79, 16, v28
    v_and_b32 v87, s25, v28
    v_add_f32 v80, v76, v78
    v_add_f32 v88, v84, v86
    v_add_f32 v81, v77, v79
    v_add_f32 v89, v85, v87
    v_fma_f32 v82, v78, 4.0, v76
    v_fma_f32 v90, v86, 4.0, v84
    v_fma_f32 v83, v79, 4.0, v77
    v_fma_f32 v91, v87, 4.0, v85
    v_add_f32 v77, v80, v81
    v_add_f32 v85, v88, v89
    v_sub_f32 v78, v80, v81
    v_sub_f32 v86, v88, v89
    v_fma_f32 v79, v83, 2.0, v82
    v_fma_f32 v87, v91, 2.0, v90
    v_fma_f32 v82, v83, -2.0, v82
    v_fma_f32 v90, v91, -2.0, v90
    v_fmamk_f32 v80, v76, 0x41700000, v82
    v_fmamk_f32 v88, v84, 0x41700000, v90
    v_fmamk_f32 v80, v81, 0x41200000, v80
    v_fmamk_f32 v88, v89, 0x41200000, v88
    v_cvt_pk_bf16_f32 v20, v77, v85
    v_cvt_pk_bf16_f32 v24, v78, v86
    v_cvt_pk_bf16_f32 v64, v79, v87
    v_cvt_pk_bf16_f32 v68, v82, v90
    v_cvt_pk_bf16_f32 v72, v80, v88
    v_lshlrev_b32 v76, 16, v17
    v_and_b32 v84, s25, v17
    v_lshlrev_b32 v77, 16, v21
    v_and_b32 v85, s25, v21
    v_lshlrev_b32 v78, 16, v25
    v_and_b32 v86, s25, v25
    v_lshlrev_b32 v79, 16, v29
    v_and_b32 v87, s25, v29
    v_add_f32 v80, v76, v78
    v_add_f32 v88, v84, v86
    v_add_f32 v81, v77, v79
    v_add_f32 v89, v85, v87
    v_fma_f32 v82, v78, 4.0, v76
    v_fma_f32 v90, v86, 4.0, v84
    v_fma_f32 v83, v79, 4.0, v77
    v_fma_f32 v91, v87, 4.0, v85
    v_add_f32 v77, v80, v81
    v_add_f32 v85, v88, v89
    v_sub_f32 v78, v80, v81
    v_sub_f32 v86, v88, v89
    v_fma_f32 v79, v83, 2.0, v82
    v_fma_f32 v87, v91, 2.0, v90
    v_fma_f32 v82, v83, -2.0, v82
    v_fma_f32 v90, v91, -2.0, v90
    v_fmamk_f32 v80, v76, 0x41700000, v82
    v_fmamk_f32 v88, v84, 0x41700000, v90
    v_fmamk_f32 v80, v81, 0x41200000, v80
    v_fmamk_f32 v88, v89, 0x41200000, v88
    v_cvt_pk_bf16_f32 v21, v77, v85
    v_cvt_pk_bf16_f32 v25, v78, v86
    v_cvt_pk_bf16_f32 v65, v79, v87
    v_cvt_pk_bf16_f32 v69, v82, v90
    v_cvt_pk_bf16_f32 v73, v80, v88
    v_lshlrev_b32 v76, 16, v18
    v_and_b32 v84, s25, v18
    v_lshlrev_b32 v77, 16, v22
    v_and_b32 v85, s25, v22
    v_lshlrev_b32 v78, 16, v26
    v_and_b32 v86, s25, v26
    v_lshlrev_b32 v79, 16, v30
    v_and_b32 v87, s25, v30
    v_add_f32 v80, v76, v78
    v_add_f32 v88, v84, v86
    v_add_f32 v81, v77, v79
    v_add_f32 v89, v85, v87
    v_fma_f32 v82, v78, 4.0, v76
    v_fma_f32 v90, v86, 4.0, v84
    v_fma_f32 v83, v79, 4.0, v77
    v_fma_f32 v91, v87, 4.0, v85
    v_add_f32 v77, v80, v81
    v_add_f32 v85, v88, v89
    v_sub_f32 v78, v80, v81
    v_sub_f32 v86, v88, v89
    v_fma_f32 v79, v83, 2.0, v82
    v_fma_f32 v87, v91, 2.0, v90
    v_fma_f32 v82, v83, -2.0, v82
    v_fma_f32 v90, v91, -2.0, v90
    v_fmamk_f32 v80, v76, 0x41700000, v82
    v_fmamk_f32 v88, v84, 0x41700000, v90
    v_fmamk_f32 v80, v81, 0x41200000, v80
    v_fmamk_f32 v88, v89, 0x41200000, v88
    v_cvt_pk_bf16_f32 v22, v77, v85
    v_cvt_pk_bf16_f32 v26, v78, v86
    v_cvt_pk_bf16_f32 v66, v79, v87
    v_cvt_pk_bf16_f32 v70, v82, v90
    v_cvt_pk_bf16_f32 v74, v80, v88
    v_lshlrev_b32 v76, 16, v19
    v_and_b32 v84, s25, v19
    v_lshlrev_b32 v77, 16, v23
    v_and_b32 v85, s25, v23
    v_lshlrev_b32 v78, 16, v27
    v_and_b32 v86, s25, v27
    v_lshlrev_b32 v79, 16, v31
    v_and_b32 v87, s25, v31
    v_add_f32 v80, v76, v78
    v_add_f32 v88, v84, v86
    v_add_f32 v81, v77, v79
    v_add_f32 v89, v85, v87
    v_fma_f32 v82, v78, 4.0, v76
    v_fma_f32 v90, v86, 4.0, v84
    v_fma_f32 v83, v79, 4.0, v77
    v_fma_f32 v91, v87, 4.0, v85
    v_add_f32 v77, v80, v81
    v_add_f32 v85, v88, v89
    v_sub_f32 v78, v80, v81
    v_sub_f32 v86, v88, v89
    v_fma_f32 v79, v83, 2.0, v82
    v_fma_f32 v87, v91, 2.0, v90
    v_fma_f32 v82, v83, -2.0, v82
    v_fma_f32 v90, v91, -2.0, v90
    v_fmamk_f32 v80, v76, 0x41700000, v82
    v_fmamk_f32 v88, v84, 0x41700000, v90
    v_fmamk_f32 v80, v81, 0x41200000, v80
    v_fmamk_f32 v88, v89, 0x41200000, v88
    v_cvt_pk_bf16_f32 v23, v77, v85
    v_cvt_pk_bf16_f32 v27, v78, v86
    v_cvt_pk_bf16_f32 v67, v79, v87
    v_cvt_pk_bf16_f32 v71, v82, v90
    v_cvt_pk_bf16_f32 v75, v80, v88
    s_add_u32 s28, s28, 1
    s_waitcnt lgkmcnt(0)
    s_barrier
    s_sub_u32 s22, s22, 1
    s_branch L_conv2_kernel_hloop2
L_conv2_kernel_hlast2:
    s_mov_b32 s25, 0xffff0000
    ds_write_b128 v96, v[64:67] offset:57344
    ds_write_b128 v97, v[68:71] offset:8192
    ds_write_b128 v97, v[72:75] offset:24576
    ds_write_b128 v96, v[48:51] offset:8192
    ds_write_b128 v96, v[52:55] offset:24576
    ds_write_b128 v96, v[56:59] offset:40960
    ds_write_b128 v98, v[60:63] offset:8704
    s_waitcnt lgkmcnt(0)
    s_barrier
    s_branch L_conv2_kernel_end
L_conv2_kernel_epi:
    s_waitcnt lgkmcnt(0)
    s_barrier
    v_cndmask_b32 v122, v111, v110, vcc
    ds_read_b128 v[0:3], v120 offset:0
    ds_read_b128 v[4:7], v120 offset:16384
    ds_read_b128 v[8:11], v120 offset:32768
    ds_read_b128 v[12:15], v120 offset:49152
    ds_read_b128 v[16:19], v121 offset:0
    ds_read_b128 v[20:23], v121 offset:16384
    ds_read_b128 v[24:27], v121 offset:32768
    ds_read_b128 v[28:31], v64 offset:15360
    ds_read_b128 v[32:35], v120 offset:8192
    ds_read_b128 v[36:39], v120 offset:24576
    ds_read_b128 v[40:43], v120 offset:40960
    ds_read_b128 v[44:47], v120 offset:57344
    ds_read_b128 v[48:51], v121 offset:56320
    ds_read_b128 v[52:55], v121 offset:64512
    ds_read_b128 v[56:59], v64 offset:7168
    s_waitcnt lgkmcnt(7)
    ds_read_b128 v[60:63], v64 offset:23552
    s_waitcnt lgkmcnt(8)
    v_pk_add_f32 v[88:89], v[24:25], v[28:29]
    v_pk_add_f32 v[90:91], v[26:27], v[30:31]
    v_pk_add_f32 v[24:25], v[4:5], v[8:9]
    v_pk_add_f32 v[26:27], v[6:7], v[10:11]
    v_pk_add_f32 v[4:5], v[4:5], v[8:9] neg_lo:[0,1] neg_hi:[0,1]
    v_pk_add_f32 v[6:7], v[6:7], v[10:11] neg_lo:[0,1] neg_hi:[0,1]
    v_pk_add_f32 v[72:73], v[12:13], v[16:17]
    v_pk_add_f32 v[74:75], v[14:15], v[18:19]
    v_pk_add_f32 v[12:13], v[12:13], v[16:17] neg_lo:[0,1] neg_hi:[0,1]
    v_pk_add_f32 v[14:15], v[14:15], v[18:19] neg_lo:[0,1] neg_hi:[0,1]
    v_pk_fma_f32 v[72:73], v[24:25], s[4:5], v[72:73]
    v_pk_fma_f32 v[74:75], v[26:27], s[4:5], v[74:75]
    v_pk_fma_f32 v[20:21], v[0:1], s[10:11], v[20:21]
    v_pk_fma_f32 v[22:23], v[2:3], s[10:11], v[22:23]
    v_pk_fma_f32 v[72:73], v[0:1], s[6:7], v[72:73]
    v_pk_fma_f32 v[74:75], v[2:3], s[6:7], v[74:75]
    v_pk_add_f32 v[24:25], v[24:25], v[0:1] neg_lo:[0,1] neg_hi:[0,1]
    v_pk_add_f32 v[26:27], v[26:27], v[2:3] neg_lo:[0,1] neg_hi:[0,1]
    v_pk_fma_f32 v[72:73], v[88:89], s[8:9], v[72:73]
    v_pk_fma_f32 v[74:75], v[90:91], s[8:9], v[74:75]
    v_pk_add_f32 v[24:25], v[24:25], v[88:89] neg_lo:[0,1] neg_hi:[0,1]
    v_pk_add_f32 v[26:27], v[26:27], v[90:91] neg_lo:[0,1] neg_hi:[0,1]
    v_pk_fma_f32 v[20:21], v[88:89], s[22:23], v[20:21]
    v_pk_fma_f32 v[22:23], v[90:91], s[22:23], v[22:23]
    v_pk_add_f32 v[8:9], v[24:25], v[72:73] neg_lo:[0,1] neg_hi:[0,1]
    v_pk_add_f32 v[10:11], v[26:27], v[74:75] neg_lo:[0,1] neg_hi:[0,1]
    v_pk_fma_f32 v[20:21], v[72:73], s[14:15], v[20:21]
    v_pk_fma_f32 v[22:23], v[74:75], s[14:15], v[22:23]
    v_pk_mul_f32 v[80:81], v[12:13], s[32:33]
    v_pk_mul_f32 v[82:83], v[14:15], s[32:33]
    v_pk_fma_f32 v[20:21], v[8:9], s[12:13], v[20:21]
    v_pk_fma_f32 v[22:23], v[10:11], s[12:13], v[22:23]
    v_pk_fma_f32 v[80:81], v[4:5], s[34:35], v[80:81]
    v_pk_fma_f32 v[82:83], v[6:7], s[34:35], v[82:83]
    v_pk_fma_f32 v[64:65], v[4:5], s[24:25], v[20:21] neg_lo:[0,0,1] neg_hi:[0,0,1]
    v_pk_fma_f32 v[66:67], v[6:7], s[24:25], v[22:23] neg_lo:[0,0,1] neg_hi:[0,0,1]
    v_pk_fma_f32 v[64:65], v[12:13], s[26:27], v[64:65]
    v_pk_fma_f32 v[66:67], v[14:15], s[26:27], v[66:67]
    v_pk_fma_f32 v[80:81], v[64:65], s[38:39], v[80:81]
    v_pk_fma_f32 v[82:83], v[66:67], s[38:39], v[82:83]
    v_pk_add_f32 v[4:5], v[4:5], v[64:65] neg_lo:[0,1] neg_hi:[0,1]
    v_pk_add_f32 v[6:7], v[6:7], v[66:67] neg_lo:[0,1] neg_hi:[0,1]
    v_pk_add_f32 v[4:5], v[4:5], v[80:81] neg_lo:[0,1] neg_hi:[0,1]
    v_pk_add_f32 v[6:7], v[6:7], v[82:83] neg_lo:[0,1] neg_hi:[0,1]
    s_waitcnt lgkmcnt(0)
    v_pk_add_f32 v[92:93], v[56:57], v[60:61]
    v_pk_add_f32 v[94:95], v[58:59], v[62:63]
    v_pk_add_f32 v[56:57], v[36:37], v[40:41]
    v_pk_add_f32 v[58:59], v[38:39], v[42:43]
    v_pk_add_f32 v[36:37], v[36:37], v[40:41] neg_lo:[0,1] neg_hi:[0,1]
    v_pk_add_f32 v[38:39], v[38:39], v[42:43] neg_lo:[0,1] neg_hi:[0,1]
    v_pk_add_f32 v[76:77], v[44:45], v[48:49]
    v_pk_add_f32 v[78:79], v[46:47], v[50:51]
    v_pk_add_f32 v[44:45], v[44:45], v[48:49] neg_lo:[0,1] neg_hi:[0,1]
    v_pk_add_f32 v[46:47], v[46:47], v[50:51] neg_lo:[0,1] neg_hi:[0,1]
    v_pk_fma_f32 v[76:77], v[56:57], s[4:5], v[76:77]
    v_pk_fma_f32 v[78:79], v[58:59], s[4:5], v[78:79]
    v_pk_fma_f32 v[52:53], v[32:33], s[10:11], v[52:53]
    v_pk_fma_f32 v[54:55], v[34:35], s[10:11], v[54:55]
    v_pk_fma_f32 v[76:77], v[32:33], s[6:7], v[76:77]
    v_pk_fma_f32 v[78:79], v[34:35], s[6:7], v[78:79]
    v_pk_add_f32 v[56:57], v[56:57], v[32:33] neg_lo:[0,1] neg_hi:[0,1]
    v_pk_add_f32 v[58:59], v[58:59], v[34:35] neg_lo:[0,1] neg_hi:[0,1]
    v_pk_fma_f32 v[76:77], v[92:93], s[8:9], v[76:77]
    v_pk_fma_f32 v[78:79], v[94:95], s[8:9], v[78:79]
    v_pk_add_f32 v[56:57], v[56:57], v[92:93] neg_lo:[0,1] neg_hi:[0,1]
    v_pk_add_f32 v[58:59], v[58:59], v[94:95] neg_lo:[0,1] neg_hi:[0,1]
    v_pk_fma_f32 v[52:53], v[92:93], s[22:23], v[52:53]
    v_pk_fma_f32 v[54:55], v[94:95], s[22:23], v[54:55]
    v_pk_add_f32 v[40:41], v[56:57], v[76:77] neg_lo:[0,1] neg_hi:[0,1]
    v_pk_add_f32 v[42:43], v[58:59], v[78:79] neg_lo:[0,1] neg_hi:[0,1]
    v_pk_fma_f32 v[52:53], v[76:77], s[14:15], v[52:53]
    v_pk_fma_f32 v[54:55], v[78:79], s[14:15], v[54:55]
    v_pk_mul_f32 v[84:85], v[44:45], s[32:33]
    v_pk_mul_f32 v[86:87], v[46:47], s[32:33]
    v_pk_fma_f32 v[52:53], v[40:41], s[12:13], v[52:53]
    v_pk_fma_f32 v[54:55], v[42:43], s[12:13], v[54:55]
    v_pk_fma_f32 v[84:85], v[36:37], s[34:35], v[84:85]
    v_pk_fma_f32 v[86:87], v[38:39], s[34:35], v[86:87]
    v_pk_fma_f32 v[68:69], v[36:37], s[24:25], v[52:53] neg_lo:[0,0,1] neg_hi:[0,0,1]
    v_pk_fma_f32 v[70:71], v[38:39], s[24:25], v[54:55] neg_lo:[0,0,1] neg_hi:[0,0,1]
    v_pk_fma_f32 v[68:69], v[44:45], s[26:27], v[68:69]
    v_pk_fma_f32 v[70:71], v[46:47], s[26:27], v[70:71]
    v_pk_fma_f32 v[84:85], v[68:69], s[38:39], v[84:85]
    v_pk_fma_f32 v[86:87], v[70:71], s[38:39], v[86:87]
    v_pk_add_f32 v[36:37], v[36:37], v[68:69] neg_lo:[0,1] neg_hi:[0,1]
    v_pk_add_f32 v[38:39], v[38:39], v[70:71] neg_lo:[0,1] neg_hi:[0,1]
    v_pk_add_f32 v[36:37], v[36:37], v[84:85] neg_lo:[0,1] neg_hi:[0,1]
    v_pk_add_f32 v[38:39], v[38:39], v[86:87] neg_lo:[0,1] neg_hi:[0,1]
    s_mov_b32 s36, 0x00010001
    s_mov_b32 s37, 0x00010001
    s_mov_b64 exec, s[36:37]
    ds_write_b128 v127, v[0:3] offset:0
    ds_write_b128 v127, v[32:35] offset:16
    ds_write_b128 v127, v[4:7] offset:32
    ds_write_b128 v127, v[36:39] offset:48
    ds_write_b128 v127, v[8:11] offset:64
    ds_write_b128 v127, v[40:43] offset:80
    s_mov_b64 exec, -1
    v_mov_b32 v44, 0xc0135761
    v_mov_b32 v45, v44
    v_cvt_pk_bf16_f32 v48, v64, v68
    v_cvt_pk_bf16_f32 v49, v65, v69
    v_cvt_pk_bf16_f32 v50, v66, v70
    v_cvt_pk_bf16_f32 v51, v67, v71
    s_mov_b32 s44, 0
    buffer_store_dwordx4 v[48:51], v122, s[16:19], s44 offen sc1
    s_waitcnt lgkmcnt(0)
    s_barrier
    ds_read_b128 v[96:99], v127 offset:512
    ds_read_b128 v[100:103], v127 offset:528
    ds_read_b128 v[104:107], v127 offset:544
    ds_read_b128 v[108:111], v127 offset:560
    ds_read_b128 v[112:115], v127 offset:576
    ds_read_b128 v[116:119], v127 offset:592
    s_waitcnt lgkmcnt(4)
    v_mov_b32_dpp v96, v0 row_shl:1 row_mask:0xf bank_mask:0xf
    v_mov_b32_dpp v97, v1 row_shl:1 row_mask:0xf bank_mask:0xf
    v_mov_b32_dpp v98, v2 row_shl:1 row_mask:0xf bank_mask:0xf
    v_mov_b32_dpp v99, v3 row_shl:1 row_mask:0xf bank_mask:0xf
    v_mov_b32_dpp v100, v32 row_shl:1 row_mask:0xf bank_mask:0xf
    v_mov_b32_dpp v101, v33 row_shl:1 row_mask:0xf bank_mask:0xf
    v_mov_b32_dpp v102, v34 row_shl:1 row_mask:0xf bank_mask:0xf
    v_mov_b32_dpp v103, v35 row_shl:1 row_mask:0xf bank_mask:0xf
    v_pk_add_f32 v[72:73], v[72:73], v[96:97]
    v_pk_add_f32 v[74:75], v[74:75], v[98:99]
    v_pk_add_f32 v[76:77], v[76:77], v[100:101]
    v_pk_add_f32 v[78:79], v[78:79], v[102:103]
    v_cvt_pk_bf16_f32 v52, v72, v76
    v_cvt_pk_bf16_f32 v53, v73, v77
    v_cvt_pk_bf16_f32 v54, v74, v78
    v_cvt_pk_bf16_f32 v55, v75, v79
    s_mov_b32 s44, 65536
    buffer_store_dwordx4 v[52:55], v122, s[16:19], s44 offen sc1
    s_waitcnt lgkmcnt(2)
    v_mov_b32_dpp v104, v4 row_shl:1 row_mask:0xf bank_mask:0xf
    v_mov_b32_dpp v105, v5 row_shl:1 row_mask:0xf bank_mask:0xf
    v_mov_b32_dpp v106, v6 row_shl:1 row_mask:0xf bank_mask:0xf
    v_mov_b32_dpp v107, v7 row_shl:1 row_mask:0xf bank_mask:0xf
    v_mov_b32_dpp v108, v36 row_shl:1 row_mask:0xf bank_mask:0xf
    v_mov_b32_dpp v109, v37 row_shl:1 row_mask:0xf bank_mask:0xf
    v_mov_b32_dpp v110, v38 row_shl:1 row_mask:0xf bank_mask:0xf
    v_mov_b32_dpp v111, v39 row_shl:1 row_mask:0xf bank_mask:0xf
    v_pk_add_f32 v[80:81], v[80:81], v[104:105]
    v_pk_add_f32 v[82:83], v[82:83], v[106:107]
    v_pk_add_f32 v[84:85], v[84:85], v[108:109]
    v_pk_add_f32 v[86:87], v[86:87], v[110:111]
    v_cvt_pk_bf16_f32 v56, v80, v84
    v_cvt_pk_bf16_f32 v57, v81, v85
    v_cvt_pk_bf16_f32 v58, v82, v86
    v_cvt_pk_bf16_f32 v59, v83, v87
    s_mov_b32 s44, 131072
    buffer_store_dwordx4 v[56:59], v122, s[16:19], s44 offen sc1
    s_waitcnt lgkmcnt(0)
    v_mov_b32_dpp v112, v8 row_shl:1 row_mask:0xf bank_mask:0xf
    v_mov_b32_dpp v113, v9 row_shl:1 row_mask:0xf bank_mask:0xf
    v_mov_b32_dpp v114, v10 row_shl:1 row_mask:0xf bank_mask:0xf
    v_mov_b32_dpp v115, v11 row_shl:1 row_mask:0xf bank_mask:0xf
    v_mov_b32_dpp v116, v40 row_shl:1 row_mask:0xf bank_mask:0xf
    v_mov_b32_dpp v117, v41 row_shl:1 row_mask:0xf bank_mask:0xf
    v_mov_b32_dpp v118, v42 row_shl:1 row_mask:0xf bank_mask:0xf
    v_mov_b32_dpp v119, v43 row_shl:1 row_mask:0xf bank_mask:0xf
    v_pk_add_f32 v[88:89], v[88:89], v[112:113]
    v_pk_add_f32 v[90:91], v[90:91], v[114:115]
    v_pk_add_f32 v[92:93], v[92:93], v[116:117]
    v_pk_add_f32 v[94:95], v[94:95], v[118:119]
    v_cvt_pk_bf16_f32 v60, v88, v92
    v_cvt_pk_bf16_f32 v61, v89, v93
    v_cvt_pk_bf16_f32 v62, v90, v94
    v_cvt_pk_bf16_f32 v63, v91, v95
    s_mov_b32 s44, 196608
    buffer_store_dwordx4 v[60:63], v122, s[16:19], s44 offen sc1
L_conv2_kernel_end:
L_conv2_kernel_done:
    s_endpgm
.globl joint_kernel
.p2align 8
.type joint_kernel,@function
joint_kernel:
    s_cmp_ge_u32 s2, 250
    s_cbranch_scc1 L_joint_kernel_done
    s_load_dwordx2 s[28:29], s[0:1], 56
    s_load_dwordx2 s[30:31], s[0:1], 72
    v_readfirstlane_b32 s20, v0
    s_lshr_b32 s20, s20, 6
    s_and_b32 s21, s20, 7
    v_and_b32 v127, 63, v0
    v_lshlrev_b32 v126, 4, v127
    s_cmp_ge_u32 s20, 8
    s_mov_b32 s33, 44171264
    s_cselect_b32 s33, 44040192, s33
    s_lshl_b32 s36, s21, 14
    s_add_u32 s33, s33, s36
    s_mov_b32 s14, 16384
    s_mov_b32 s15, 0x00020000
    s_lshl_b32 s35, s2, 9
    s_cmp_ge_u32 s2, 125
    s_cselect_b32 s36, 2033152, 0
    s_cselect_b32 s34, 8192, 0
    s_add_u32 s35, s35, s36
    s_add_u32 s34, s34, 44302336
    s_mov_b32 s10, 12582912
    s_mov_b32 s11, 0x00020000
    s_mov_b32 s42, 24576
    s_mov_b32 s43, 0x00020000
    s_waitcnt lgkmcnt(0)
    s_add_u32 s12, s30, s33
    s_addc_u32 s13, s31, 0
    s_add_u32 s40, s30, s34
    s_addc_u32 s41, s31, 0
    s_cmp_ge_u32 s20, 8
    s_cbranch_scc1 L_joint_kernel_T
    s_add_u32 s8, s30, 27262976
    s_addc_u32 s9, s31, 0
    v_mov_b32 v0, 99456
    v_mov_b32 v2, 0
    v_mov_b32 v3, 0
    ds_write_b64 v0, v[2:3]
    v_lshrrev_b32 v124, 5, v127
    v_and_b32 v123, 0x1ff, v126
    v_mul_u32_u24 v125, 65536, v124
    v_add_u32 v123, v125, v123
    s_mul_i32 s36, s21, 262144
    s_add_u32 s36, s36, s35
    s_add_u32 s37, s36, 8388608
    buffer_load_dwordx4 v[64:67], v123, s[8:11], s36 offen
    buffer_load_dwordx4 v[72:75], v123, s[8:11], s37 offen
    s_add_u32 s36, s36, 131072
    s_add_u32 s37, s36, 8388608
    buffer_load_dwordx4 v[68:71], v123, s[8:11], s36 offen
    buffer_load_dwordx4 v[76:79], v123, s[8:11], s37 offen
    s_lshl_b32 s38, s21, 10
    s_add_u32 s38, s38, 16384
    buffer_load_dwordx4 v[80:83], v126, s[40:43], s38 offen
    s_waitcnt lgkmcnt(0)
    s_barrier
    s_lshl_b32 s35, s2, 17
    s_add_u32 s16, s28, s35
    s_addc_u32 s17, s29, 0
    s_mov_b32 s18, 131072
    s_mov_b32 s19, 0x00020000
    s_mov_b32 s46, 0xbdd2d3e8
    s_mov_b32 s47, s46
    v_mov_b32 v120, 0xc0135761
    v_mov_b32 v121, v120
    s_mov_b32 s48, 1.0
    s_mov_b32 s49, 1.0
    v_bfe_u32 v123, v127, 2, 3
    v_lshl_add_u32 v124, v123, 2, v124
    v_mul_u32_u24 v124, 528, v124
    v_and_b32 v123, 0x30, v126
    s_lshl_b32 s36, s21, 6
    v_add3_u32 v124, v124, v123, s36
    s_mov_b32 s45, 0xffff0000
    s_mul_i32 s36, s21, 1040
    s_add_u32 s36, s36, 91136
    v_add_u32 v123, s36, v126
    s_mov_b32 s22, 2
    s_waitcnt vmcnt(3)
L_joint_kernel_floop:
    v_lshlrev_b32 v88, 16, v64
    v_and_b32 v89, s45, v64
    v_lshlrev_b32 v96, 16, v72
    v_and_b32 v97, s45, v72
    v_lshlrev_b32 v90, 16, v65
    v_and_b32 v91, s45, v65
    v_lshlrev_b32 v98, 16, v73
    v_and_b32 v99, s45, v73
    v_lshlrev_b32 v92, 16, v66
    v_and_b32 v93, s45, v66
    v_lshlrev_b32 v100, 16, v74
    v_and_b32 v101, s45, v74
    v_lshlrev_b32 v94, 16, v67
    v_and_b32 v95, s45, v67
    v_lshlrev_b32 v102, 16, v75
    v_and_b32 v103, s45, v75
    v_pk_add_f32 v[88:89], v[88:89], v[96:97]
    v_pk_add_f32 v[90:91], v[90:91], v[98:99]
    v_pk_add_f32 v[92:93], v[92:93], v[100:101]
    v_pk_add_f32 v[94:95], v[94:95], v[102:103]
    v_pk_mul_f32 v[96:97], v[88:89], v[88:89]
    v_pk_mul_f32 v[98:99], v[90:91], v[90:91]
    v_pk_mul_f32 v[100:101], v[92:93], v[92:93]
    v_pk_mul_f32 v[102:103], v[94:95], v[94:95]
    v_pk_fma_f32 v[96:97], v[96:97], s[46:47], v[120:121]
    v_pk_fma_f32 v[98:99], v[98:99], s[46:47], v[120:121]
    v_pk_fma_f32 v[100:101], v[100:101], s[46:47], v[120:121]
    v_pk_fma_f32 v[102:103], v[102:103], s[46:47], v[120:121]
    v_pk_mul_f32 v[96:97], v[96:97], v[88:89]
    v_pk_mul_f32 v[98:99], v[98:99], v[90:91]
    v_pk_mul_f32 v[100:101], v[100:101], v[92:93]
    v_pk_mul_f32 v[102:103], v[102:103], v[94:95]
    v_exp_f32 v96, v96
    v_exp_f32 v97, v97
    v_exp_f32 v98, v98
    v_exp_f32 v99, v99
    v_exp_f32 v100, v100
    v_exp_f32 v101, v101
    v_exp_f32 v102, v102
    v_exp_f32 v103, v103
    v_pk_add_f32 v[96:97], v[96:97], s[48:49]
    v_pk_add_f32 v[98:99], v[98:99], s[48:49]
    v_pk_add_f32 v[100:101], v[100:101], s[48:49]
    v_pk_add_f32 v[102:103], v[102:103], s[48:49]
    v_rcp_f32 v96, v96
    v_rcp_f32 v97, v97
    v_rcp_f32 v98, v98
    v_rcp_f32 v99, v99
    v_rcp_f32 v100, v100
    v_rcp_f32 v101, v101
    v_rcp_f32 v102, v102
    v_rcp_f32 v103, v103
    v_pk_mul_f32 v[88:89], v[88:89], v[96:97]
    v_pk_mul_f32 v[90:91], v[90:91], v[98:99]
    v_pk_mul_f32 v[92:93], v[92:93], v[100:101]
    v_pk_mul_f32 v[94:95], v[94:95], v[102:103]
    v_cvt_pk_bf16_f32 v104, v88, v89
    v_cvt_pk_bf16_f32 v105, v90, v91
    v_cvt_pk_bf16_f32 v106, v92, v93
    v_cvt_pk_bf16_f32 v107, v94, v95
    ds_write_b128 v124, v[104:107] offset:32768
    s_waitcnt vmcnt(0)
    v_pk_mov_b32 v[64:65], v[68:69], v[68:69] op_sel:[0,1]
    v_pk_mov_b32 v[72:73], v[76:77], v[76:77] op_sel:[0,1]
    v_pk_mov_b32 v[66:67], v[70:71], v[70:71] op_sel:[0,1]
    v_pk_mov_b32 v[74:75], v[78:79], v[78:79] op_sel:[0,1]
    v_add_u32 v124, 1056, v124
    s_sub_u32 s22, s22, 1
    s_cmp_lg_u32 s22, 0
    s_cbranch_scc1 L_joint_kernel_floop
    ds_write_b128 v123, v[80:83]
    s_waitcnt lgkmcnt(0)
    v_mov_b32 v120, 99456
    v_mov_b32 v121, 1
    s_mov_b64 exec, 1
    ds_add_u32 v120, v121 offset:0
    s_mov_b64 exec, -1
L_joint_kernel_ow:
    ds_read_b32 v121, v120 offset:4
    s_waitcnt lgkmcnt(0)
    v_readfirstlane_b32 s37, v121
    s_cmp_ge_u32 s37, 8
    s_cbranch_scc1 L_joint_kernel_ow_d
    s_sleep 1
    s_branch L_joint_kernel_ow
L_joint_kernel_ow_d:
    s_mov_b32 s36, 0
    buffer_load_dwordx4 v[0:3], v126, s[12:15], s36 offen offset:0
    buffer_load_dwordx4 v[4:7], v126, s[12:15], s36 offen offset:1024
    buffer_load_dwordx4 v[8:11], v126, s[12:15], s36 offen offset:2048
    buffer_load_dwordx4 v[12:15], v126, s[12:15], s36 offen offset:3072
    s_mov_b32 s36, 4096
    buffer_load_dwordx4 v[16:19], v126, s[12:15], s36 offen offset:0
    buffer_load_dwordx4 v[20:23], v126, s[12:15], s36 offen offset:1024
    buffer_load_dwordx4 v[24:27], v126, s[12:15], s36 offen offset:2048
    buffer_load_dwordx4 v[28:31], v126, s[12:15], s36 offen offset:3072
    s_mov_b32 s36, 8192
    buffer_load_dwordx4 v[32:35], v126, s[12:15], s36 offen offset:0
    buffer_load_dwordx4 v[36:39], v126, s[12:15], s36 offen offset:1024
    buffer_load_dwordx4 v[40:43], v126, s[12:15], s36 offen offset:2048
    buffer_load_dwordx4 v[44:47], v126, s[12:15], s36 offen offset:3072
    s_mov_b32 s36, 12288
    buffer_load_dwordx4 v[48:51], v126, s[12:15], s36 offen offset:0
    buffer_load_dwordx4 v[52:55], v126, s[12:15], s36 offen offset:1024
    buffer_load_dwordx4 v[56:59], v126, s[12:15], s36 offen offset:2048
    buffer_load_dwordx4 v[60:63], v126, s[12:15], s36 offen offset:3072
    v_lshrrev_b32 v125, 4, v127
    v_lshlrev_b32 v125, 11, v125
    v_and_b32 v124, 15, v127
    v_lshl_add_u32 v125, v124, 2, v125
    s_lshl_b32 s36, s21, 6
    v_add_u32 v125, s36, v125
    s_mov_b32 s44, 8192
    s_setprio 1
    s_barrier
    ds_read_b128 v[96:99], v126 offset:0
    ds_read_b128 v[100:103], v126 offset:1024
    ds_read_b128 v[104:107], v126 offset:2048
    ds_read_b128 v[108:111], v126 offset:3072
    s_waitcnt vmcnt(14) lgkmcnt(3)
    v_mfma_f32_16x16x32_bf16 v[64:67], v[96:99], v[0:3], 0
    v_mfma_f32_16x16x32_bf16 v[68:71], v[96:99], v[4:7], 0
    ds_read_b128 v[96:99], v126 offset:4096
    s_waitcnt lgkmcnt(3)
    v_mfma_f32_16x16x32_bf16 v[72:75], v[100:103], v[0:3], 0
    v_mfma_f32_16x16x32_bf16 v[76:79], v[100:103], v[4:7], 0
    ds_read_b128 v[100:103], v126 offset:5120
    s_waitcnt vmcnt(12) lgkmcnt(3)
    v_mfma_f32_16x16x32_bf16 v[64:67], v[104:107], v[8:11], v[64:67]
    v_mfma_f32_16x16x32_bf16 v[68:71], v[104:107], v[12:15], v[68:71]
    ds_read_b128 v[104:107], v126 offset:6144
    s_waitcnt lgkmcnt(3)
    v_mfma_f32_16x16x32_bf16 v[72:75], v[108:111], v[8:11], v[72:75]
    v_mfma_f32_16x16x32_bf16 v[76:79], v[108:111], v[12:15], v[76:79]
    ds_read_b128 v[108:111], v126 offset:7168
    s_waitcnt vmcnt(10) lgkmcnt(3)
    v_mfma_f32_16x16x32_bf16 v[64:67], v[96:99], v[16:19], v[64:67]
    v_mfma_f32_16x16x32_bf16 v[68:71], v[96:99], v[20:23], v[68:71]
    ds_read_b128 v[96:99], v126 offset:8192
    s_waitcnt lgkmcnt(3)
    v_mfma_f32_16x16x32_bf16 v[72:75], v[100:103], v[16:19], v[72:75]
    v_mfma_f32_16x16x32_bf16 v[76:79], v[100:103], v[20:23], v[76:79]
    ds_read_b128 v[100:103], v126 offset:9216
    s_waitcnt vmcnt(8) lgkmcnt(3)
    v_mfma_f32_16x16x32_bf16 v[64:67], v[104:107], v[24:27], v[64:67]
    v_mfma_f32_16x16x32_bf16 v[68:71], v[104:107], v[28:31], v[68:71]
    ds_read_b128 v[104:107], v126 offset:10240
    s_waitcnt lgkmcnt(3)
    v_mfma_f32_16x16x32_bf16 v[72:75], v[108:111], v[24:27], v[72:75]
    v_mfma_f32_16x16x32_bf16 v[76:79], v[108:111], v[28:31], v[76:79]
    ds_read_b128 v[108:111], v126 offset:11264
    s_waitcnt vmcnt(6) lgkmcnt(3)
    v_mfma_f32_16x16x32_bf16 v[64:67], v[96:99], v[32:35], v[64:67]
    v_mfma_f32_16x16x32_bf16 v[68:71], v[96:99], v[36:39], v[68:71]
    ds_read_b128 v[96:99], v126 offset:12288
    s_waitcnt lgkmcnt(3)
    v_mfma_f32_16x16x32_bf16 v[72:75], v[100:103], v[32:35], v[72:75]
    v_mfma_f32_16x16x32_bf16 v[76:79], v[100:103], v[36:39], v[76:79]
    ds_read_b128 v[100:103], v126 offset:13312
    s_waitcnt vmcnt(4) lgkmcnt(3)
    v_mfma_f32_16x16x32_bf16 v[64:67], v[104:107], v[40:43], v[64:67]
    v_mfma_f32_16x16x32_bf16 v[68:71], v[104:107], v[44:47], v[68:71]
    ds_read_b128 v[104:107], v126 offset:14336
    s_waitcnt lgkmcnt(3)
    v_mfma_f32_16x16x32_bf16 v[72:75], v[108:111], v[40:43], v[72:75]
    v_mfma_f32_16x16x32_bf16 v[76:79], v[108:111], v[44:47], v[76:79]
    ds_read_b128 v[108:111], v126 offset:15360
    s_waitcnt vmcnt(2) lgkmcnt(3)
    v_mfma_f32_16x16x32_bf16 v[64:67], v[96:99], v[48:51], v[64:67]
    v_mfma_f32_16x16x32_bf16 v[68:71], v[96:99], v[52:55], v[68:71]
    s_waitcnt lgkmcnt(0)
    s_barrier
    ds_read_b128 v[96:99], v126 offset:16384
    v_mfma_f32_16x16x32_bf16 v[72:75], v[100:103], v[48:51], v[72:75]
    v_mfma_f32_16x16x32_bf16 v[76:79], v[100:103], v[52:55], v[76:79]
    ds_read_b128 v[100:103], v126 offset:17408
    s_waitcnt vmcnt(0)
    v_mfma_f32_16x16x32_bf16 v[64:67], v[104:107], v[56:59], v[64:67]
    v_mfma_f32_16x16x32_bf16 v[68:71], v[104:107], v[60:63], v[68:71]
    ds_read_b128 v[104:107], v126 offset:18432
    v_mfma_f32_16x16x32_bf16 v[72:75], v[108:111], v[56:59], v[72:75]
    v_mfma_f32_16x16x32_bf16 v[76:79], v[108:111], v[60:63], v[76:79]
    ds_read_b128 v[108:111], v126 offset:19456
    s_mov_b32 s22, 4
L_joint_kernel_oloop:
    s_waitcnt lgkmcnt(3)
    v_mfma_f32_16x16x32_bf16 v[80:83], v[96:99], v[0:3], 0
    v_mfma_f32_16x16x32_bf16 v[84:87], v[96:99], v[4:7], 0
    ds_read_b128 v[96:99], v126 offset:20480
    s_waitcnt lgkmcnt(3)
    v_mfma_f32_16x16x32_bf16 v[88:91], v[100:103], v[0:3], 0
    v_mfma_f32_16x16x32_bf16 v[92:95], v[100:103], v[4:7], 0
    ds_read_b128 v[100:103], v126 offset:21504
    s_waitcnt lgkmcnt(3)
    v_mfma_f32_16x16x32_bf16 v[80:83], v[104:107], v[8:11], v[80:83]
    v_mfma_f32_16x16x32_bf16 v[84:87], v[104:107], v[12:15], v[84:87]
    ds_read_b128 v[104:107], v126 offset:22528
    s_waitcnt lgkmcnt(3)
    v_mfma_f32_16x16x32_bf16 v[88:91], v[108:111], v[8:11], v[88:91]
    v_cvt_pk_bf16_f32 v112, v64, v68
    v_mfma_f32_16x16x32_bf16 v[92:95], v[108:111], v[12:15], v[92:95]
    buffer_store_dword v112, v125, s[16:19], 0 offen offset:0 nt
    ds_read_b128 v[108:111], v126 offset:23552
    s_waitcnt lgkmcnt(3)
    v_mfma_f32_16x16x32_bf16 v[80:83], v[96:99], v[16:19], v[80:83]
    v_cvt_pk_bf16_f32 v113, v65, v69
    v_mfma_f32_16x16x32_bf16 v[84:87], v[96:99], v[20:23], v[84:87]
    buffer_store_dword v113, v125, s[16:19], 0 offen offset:512 nt
    ds_read_b128 v[96:99], v126 offset:24576
    s_waitcnt lgkmcnt(3)
    v_mfma_f32_16x16x32_bf16 v[88:91], v[100:103], v[16:19], v[88:91]
    v_cvt_pk_bf16_f32 v114, v66, v70
    v_mfma_f32_16x16x32_bf16 v[92:95], v[100:103], v[20:23], v[92:95]
    buffer_store_dword v114, v125, s[16:19], 0 offen offset:1024 nt
    ds_read_b128 v[100:103], v126 offset:25600
    s_waitcnt lgkmcnt(3)
    v_mfma_f32_16x16x32_bf16 v[80:83], v[104:107], v[24:27], v[80:83]
    v_cvt_pk_bf16_f32 v115, v67, v71
    v_mfma_f32_16x16x32_bf16 v[84:87], v[104:107], v[28:31], v[84:87]
    buffer_store_dword v115, v125, s[16:19], 0 offen offset:1536 nt
    ds_read_b128 v[104:107], v126 offset:26624
    s_waitcnt lgkmcnt(3)
    v_mfma_f32_16x16x32_bf16 v[88:91], v[108:111], v[24:27], v[88:91]
    v_cvt_pk_bf16_f32 v116, v72, v76
    v_mfma_f32_16x16x32_bf16 v[92:95], v[108:111], v[28:31], v[92:95]
    buffer_store_dword v116, v125, s[16:19], s44 offen offset:0 nt
    ds_read_b128 v[108:111], v126 offset:27648
    s_waitcnt lgkmcnt(3)
    v_mfma_f32_16x16x32_bf16 v[80:83], v[96:99], v[32:35], v[80:83]
    v_cvt_pk_bf16_f32 v117, v73, v77
    v_mfma_f32_16x16x32_bf16 v[84:87], v[96:99], v[36:39], v[84:87]
    buffer_store_dword v117, v125, s[16:19], s44 offen offset:512 nt
    ds_read_b128 v[96:99], v126 offset:28672
    s_waitcnt lgkmcnt(3)
    v_mfma_f32_16x16x32_bf16 v[88:91], v[100:103], v[32:35], v[88:91]
    v_cvt_pk_bf16_f32 v118, v74, v78
    v_mfma_f32_16x16x32_bf16 v[92:95], v[100:103], v[36:39], v[92:95]
    buffer_store_dword v118, v125, s[16:19], s44 offen offset:1024 nt
    ds_read_b128 v[100:103], v126 offset:29696
    s_waitcnt lgkmcnt(3)
    v_mfma_f32_16x16x32_bf16 v[80:83], v[104:107], v[40:43], v[80:83]
    v_cvt_pk_bf16_f32 v119, v75, v79
    v_mfma_f32_16x16x32_bf16 v[84:87], v[104:107], v[44:47], v[84:87]
    buffer_store_dword v119, v125, s[16:19], s44 offen offset:1536 nt
    ds_read_b128 v[104:107], v126 offset:30720
    s_waitcnt lgkmcnt(3)
    v_mfma_f32_16x16x32_bf16 v[88:91], v[108:111], v[40:43], v[88:91]
    v_add_u32 v125, 16384, v125
    v_mfma_f32_16x16x32_bf16 v[92:95], v[108:111], v[44:47], v[92:95]
    ds_read_b128 v[108:111], v126 offset:31744
    s_waitcnt lgkmcnt(3)
    v_mfma_f32_16x16x32_bf16 v[80:83], v[96:99], v[48:51], v[80:83]
    v_mfma_f32_16x16x32_bf16 v[84:87], v[96:99], v[52:55], v[84:87]
    s_waitcnt lgkmcnt(0)
    s_barrier
    ds_read_b128 v[96:99], v126 offset:0
    v_mfma_f32_16x16x32_bf16 v[88:91], v[100:103], v[48:51], v[88:91]
    v_mfma_f32_16x16x32_bf16 v[92:95], v[100:103], v[52:55], v[92:95]
    ds_read_b128 v[100:103], v126 offset:1024
    v_mfma_f32_16x16x32_bf16 v[80:83], v[104:107], v[56:59], v[80:83]
    v_mfma_f32_16x16x32_bf16 v[84:87], v[104:107], v[60:63], v[84:87]
    ds_read_b128 v[104:107], v126 offset:2048
    v_mfma_f32_16x16x32_bf16 v[88:91], v[108:111], v[56:59], v[88:91]
    v_mfma_f32_16x16x32_bf16 v[92:95], v[108:111], v[60:63], v[92:95]
    ds_read_b128 v[108:111], v126 offset:3072
    s_sub_u32 s22, s22, 1
    s_cmp_eq_u32 s22, 0
    s_cbranch_scc1 L_joint_kernel_oend
    s_waitcnt lgkmcnt(3)
    v_mfma_f32_16x16x32_bf16 v[64:67], v[96:99], v[0:3], 0
    v_mfma_f32_16x16x32_bf16 v[68:71], v[96:99], v[4:7], 0
    ds_read_b128 v[96:99], v126 offset:4096
    s_waitcnt lgkmcnt(3)
    v_mfma_f32_16x16x32_bf16 v[72:75], v[100:103], v[0:3], 0
    v_mfma_f32_16x16x32_bf16 v[76:79], v[100:103], v[4:7], 0
    ds_read_b128 v[100:103], v126 offset:5120
    s_waitcnt lgkmcnt(3)
    v_mfma_f32_16x16x32_bf16 v[64:67], v[104:107], v[8:11], v[64:67]
    v_mfma_f32_16x16x32_bf16 v[68:71], v[104:107], v[12:15], v[68:71]
    ds_read_b128 v[104:107], v126 offset:6144
    s_waitcnt lgkmcnt(3)
    v_mfma_f32_16x16x32_bf16 v[72:75], v[108:111], v[8:11], v[72:75]
    v_cvt_pk_bf16_f32 v112, v80, v84
    v_mfma_f32_16x16x32_bf16 v[76:79], v[108:111], v[12:15], v[76:79]
    buffer_store_dword v112, v125, s[16:19], 0 offen offset:0 nt
    ds_read_b128 v[108:111], v126 offset:7168
    s_waitcnt lgkmcnt(3)
    v_mfma_f32_16x16x32_bf16 v[64:67], v[96:99], v[16:19], v[64:67]
    v_cvt_pk_bf16_f32 v113, v81, v85
    v_mfma_f32_16x16x32_bf16 v[68:71], v[96:99], v[20:23], v[68:71]
    buffer_store_dword v113, v125, s[16:19], 0 offen offset:512 nt
    ds_read_b128 v[96:99], v126 offset:8192
    s_waitcnt lgkmcnt(3)
    v_mfma_f32_16x16x32_bf16 v[72:75], v[100:103], v[16:19], v[72:75]
    v_cvt_pk_bf16_f32 v114, v82, v86
    v_mfma_f32_16x16x32_bf16 v[76:79], v[100:103], v[20:23], v[76:79]
    buffer_store_dword v114, v125, s[16:19], 0 offen offset:1024 nt
    ds_read_b128 v[100:103], v126 offset:9216
    s_waitcnt lgkmcnt(3)
    v_mfma_f32_16x16x32_bf16 v[64:67], v[104:107], v[24:27], v[64:67]
    v_cvt_pk_bf16_f32 v115, v83, v87
    v_mfma_f32_16x16x32_bf16 v[68:71], v[104:107], v[28:31], v[68:71]
    buffer_store_dword v115, v125, s[16:19], 0 offen offset:1536 nt
    ds_read_b128 v[104:107], v126 offset:10240
    s_waitcnt lgkmcnt(3)
    v_mfma_f32_16x16x32_bf16 v[72:75], v[108:111], v[24:27], v[72:75]
    v_cvt_pk_bf16_f32 v116, v88, v92
    v_mfma_f32_16x16x32_bf16 v[76:79], v[108:111], v[28:31], v[76:79]
    buffer_store_dword v116, v125, s[16:19], s44 offen offset:0 nt
    ds_read_b128 v[108:111], v126 offset:11264
    s_waitcnt lgkmcnt(3)
    v_mfma_f32_16x16x32_bf16 v[64:67], v[96:99], v[32:35], v[64:67]
    v_cvt_pk_bf16_f32 v117, v89, v93
    v_mfma_f32_16x16x32_bf16 v[68:71], v[96:99], v[36:39], v[68:71]
    buffer_store_dword v117, v125, s[16:19], s44 offen offset:512 nt
    ds_read_b128 v[96:99], v126 offset:12288
    s_waitcnt lgkmcnt(3)
    v_mfma_f32_16x16x32_bf16 v[72:75], v[100:103], v[32:35], v[72:75]
    v_cvt_pk_bf16_f32 v118, v90, v94
    v_mfma_f32_16x16x32_bf16 v[76:79], v[100:103], v[36:39], v[76:79]
    buffer_store_dword v118, v125, s[16:19], s44 offen offset:1024 nt
    ds_read_b128 v[100:103], v126 offset:13312
    s_waitcnt lgkmcnt(3)
    v_mfma_f32_16x16x32_bf16 v[64:67], v[104:107], v[40:43], v[64:67]
    v_cvt_pk_bf16_f32 v119, v91, v95
    v_mfma_f32_16x16x32_bf16 v[68:71], v[104:107], v[44:47], v[68:71]
    buffer_store_dword v119, v125, s[16:19], s44 offen offset:1536 nt
    ds_read_b128 v[104:107], v126 offset:14336
    s_waitcnt lgkmcnt(3)
    v_mfma_f32_16x16x32_bf16 v[72:75], v[108:111], v[40:43], v[72:75]
    v_add_u32 v125, 16384, v125
    v_mfma_f32_16x16x32_bf16 v[76:79], v[108:111], v[44:47], v[76:79]
    ds_read_b128 v[108:111], v126 offset:15360
    s_waitcnt lgkmcnt(3)
    v_mfma_f32_16x16x32_bf16 v[64:67], v[96:99], v[48:51], v[64:67]
    v_mfma_f32_16x16x32_bf16 v[68:71], v[96:99], v[52:55], v[68:71]
    s_waitcnt lgkmcnt(0)
    s_barrier
    ds_read_b128 v[96:99], v126 offset:16384
    v_mfma_f32_16x16x32_bf16 v[72:75], v[100:103], v[48:51], v[72:75]
    v_mfma_f32_16x16x32_bf16 v[76:79], v[100:103], v[52:55], v[76:79]
    ds_read_b128 v[100:103], v126 offset:17408
    v_mfma_f32_16x16x32_bf16 v[64:67], v[104:107], v[56:59], v[64:67]
    v_mfma_f32_16x16x32_bf16 v[68:71], v[104:107], v[60:63], v[68:71]
    ds_read_b128 v[104:107], v126 offset:18432
    v_mfma_f32_16x16x32_bf16 v[72:75], v[108:111], v[56:59], v[72:75]
    v_mfma_f32_16x16x32_bf16 v[76:79], v[108:111], v[60:63], v[76:79]
    ds_read_b128 v[108:111], v126 offset:19456
    s_waitcnt vmcnt(32)
    s_branch L_joint_kernel_oloop
L_joint_kernel_oend:
    s_nop 7
    v_cvt_pk_bf16_f32 v112, v80, v84
    buffer_store_dword v112, v125, s[16:19], 0 offen offset:0 nt
    v_cvt_pk_bf16_f32 v113, v81, v85
    buffer_store_dword v113, v125, s[16:19], 0 offen offset:512 nt
    v_cvt_pk_bf16_f32 v114, v82, v86
    buffer_store_dword v114, v125, s[16:19], 0 offen offset:1024 nt
    v_cvt_pk_bf16_f32 v115, v83, v87
    buffer_store_dword v115, v125, s[16:19], 0 offen offset:1536 nt
    v_cvt_pk_bf16_f32 v116, v88, v92
    buffer_store_dword v116, v125, s[16:19], s44 offen offset:0 nt
    v_cvt_pk_bf16_f32 v117, v89, v93
    buffer_store_dword v117, v125, s[16:19], s44 offen offset:512 nt
    v_cvt_pk_bf16_f32 v118, v90, v94
    buffer_store_dword v118, v125, s[16:19], s44 offen offset:1024 nt
    v_cvt_pk_bf16_f32 v119, v91, v95
    buffer_store_dword v119, v125, s[16:19], s44 offen offset:1536 nt
    v_add_u32 v125, 16384, v125
    s_branch L_joint_kernel_fin
L_joint_kernel_T:
    s_setprio 3
    s_lshl_b32 s36, s21, 2
    s_add_u32 s36, s36, 44335104
    s_add_u32 s36, s30, s36
    s_addc_u32 s37, s31, 0
    s_load_dword s44, s[36:37], 0
    v_and_b32 v123, 15, v127
    v_lshrrev_b32 v121, 4, v127
    v_mul_u32_u24 v125, 528, v123
    v_lshl_add_u32 v125, v121, 4, v125
    v_lshlrev_b32 v121, 5, v121
    v_and_b32 v120, 7, v127
    v_lshl_add_u32 v124, v120, 10, v121
    s_lshl_b32 s38, s21, 7
    v_mul_u32_u24 v120, 1040, v120
    s_add_u32 s36, s38, 91136
    v_add3_u32 v120, v120, v121, s36
    s_mul_i32 s36, s21, 5184
    s_add_u32 s36, s36, 49664
    v_add_u32 v121, s36, v121
    v_mul_u32_u24 v122, 144, v123
    v_add_u32 v122, v122, v121
    v_lshrrev_b32 v123, 3, v123
    v_mul_u32_u24 v123, 144, v123
    v_add_u32 v121, v123, v121
    s_lshl_b32 s36, s21, 11
    v_add_u32 v123, s36, v126
    s_barrier
    s_mov_b32 s36, 0
    buffer_load_dwordx4 v[0:3], v126, s[12:15], s36 offen offset:0
    buffer_load_dwordx4 v[4:7], v126, s[12:15], s36 offen offset:1024
    buffer_load_dwordx4 v[8:11], v126, s[12:15], s36 offen offset:2048
    buffer_load_dwordx4 v[12:15], v126, s[12:15], s36 offen offset:3072
    s_mov_b32 s36, 4096
    buffer_load_dwordx4 v[16:19], v126, s[12:15], s36 offen offset:0
    buffer_load_dwordx4 v[20:23], v126, s[12:15], s36 offen offset:1024
    buffer_load_dwordx4 v[24:27], v126, s[12:15], s36 offen offset:2048
    buffer_load_dwordx4 v[28:31], v126, s[12:15], s36 offen offset:3072
    s_mov_b32 s36, 8192
    buffer_load_dwordx4 v[32:35], v126, s[12:15], s36 offen offset:0
    buffer_load_dwordx4 v[36:39], v126, s[12:15], s36 offen offset:1024
    buffer_load_dwordx4 v[40:43], v126, s[12:15], s36 offen offset:2048
    buffer_load_dwordx4 v[44:47], v126, s[12:15], s36 offen offset:3072
    s_mov_b32 s36, 12288
    buffer_load_dwordx4 v[48:51], v126, s[12:15], s36 offen offset:0
    buffer_load_dwordx4 v[52:55], v126, s[12:15], s36 offen offset:1024
    buffer_load_dwordx4 v[56:59], v126, s[12:15], s36 offen offset:2048
    buffer_load_dwordx4 v[60:63], v126, s[12:15], s36 offen offset:3072
    v_mov_b32 v64, 99456
    v_mov_b32 v65, 1
    s_mov_b64 exec, 1
    ds_add_u32 v64, v65 offset:4
    s_mov_b64 exec, -1
L_joint_kernel_tw:
    ds_read_b32 v65, v64 offset:0
    s_waitcnt lgkmcnt(0)
    v_readfirstlane_b32 s37, v65
    s_cmp_ge_u32 s37, 8
    s_cbranch_scc1 L_joint_kernel_tw_d
    s_sleep 1
    s_branch L_joint_kernel_tw
L_joint_kernel_tw_d:
    ds_read_b128 v[80:83], v125 offset:32768
    ds_read_b128 v[84:87], v125 offset:41216
    ds_read_b128 v[88:91], v125 offset:32832
    ds_read_b128 v[92:95], v125 offset:41280
    ds_read_b128 v[96:99], v125 offset:32896
    ds_read_b128 v[100:103], v125 offset:41344
    ds_read_b128 v[104:107], v125 offset:32960
    ds_read_b128 v[108:111], v125 offset:41408
    s_setprio 0
    s_waitcnt vmcnt(14) lgkmcnt(7)
    v_mfma_f32_16x16x32_bf16 v[64:67], v[0:3], v[80:83], 0
    v_mfma_f32_16x16x32_bf16 v[68:71], v[4:7], v[80:83], 0
    ds_read_b128 v[80:83], v125 offset:33024
    s_waitcnt lgkmcnt(7)
    v_mfma_f32_16x16x32_bf16 v[72:75], v[0:3], v[84:87], 0
    v_mfma_f32_16x16x32_bf16 v[76:79], v[4:7], v[84:87], 0
    ds_read_b128 v[84:87], v125 offset:41472
    s_waitcnt vmcnt(12) lgkmcnt(7)
    v_mfma_f32_16x16x32_bf16 v[64:67], v[8:11], v[88:91], v[64:67]
    v_mfma_f32_16x16x32_bf16 v[68:71], v[12:15], v[88:91], v[68:71]
    ds_read_b128 v[88:91], v125 offset:33088
    s_waitcnt lgkmcnt(7)
    v_mfma_f32_16x16x32_bf16 v[72:75], v[8:11], v[92:95], v[72:75]
    v_mfma_f32_16x16x32_bf16 v[76:79], v[12:15], v[92:95], v[76:79]
    ds_read_b128 v[92:95], v125 offset:41536
    s_waitcnt vmcnt(10) lgkmcnt(7)
    v_mfma_f32_16x16x32_bf16 v[64:67], v[16:19], v[96:99], v[64:67]
    v_mfma_f32_16x16x32_bf16 v[68:71], v[20:23], v[96:99], v[68:71]
    ds_read_b128 v[96:99], v125 offset:33152
    s_waitcnt lgkmcnt(7)
    v_mfma_f32_16x16x32_bf16 v[72:75], v[16:19], v[100:103], v[72:75]
    v_mfma_f32_16x16x32_bf16 v[76:79], v[20:23], v[100:103], v[76:79]
    ds_read_b128 v[100:103], v125 offset:41600
    s_waitcnt vmcnt(8) lgkmcnt(7)
    v_mfma_f32_16x16x32_bf16 v[64:67], v[24:27], v[104:107], v[64:67]
    v_mfma_f32_16x16x32_bf16 v[68:71], v[28:31], v[104:107], v[68:71]
    ds_read_b128 v[104:107], v125 offset:33216
    s_waitcnt lgkmcnt(7)
    v_mfma_f32_16x16x32_bf16 v[72:75], v[24:27], v[108:111], v[72:75]
    v_mfma_f32_16x16x32_bf16 v[76:79], v[28:31], v[108:111], v[76:79]
    ds_read_b128 v[108:111], v125 offset:41664
    s_waitcnt vmcnt(6) lgkmcnt(7)
    v_mfma_f32_16x16x32_bf16 v[64:67], v[32:35], v[80:83], v[64:67]
    v_mfma_f32_16x16x32_bf16 v[68:71], v[36:39], v[80:83], v[68:71]
    ds_read_b128 v[112:115], v120 offset:0
    s_waitcnt lgkmcnt(7)
    v_mfma_f32_16x16x32_bf16 v[72:75], v[32:35], v[84:87], v[72:75]
    v_mfma_f32_16x16x32_bf16 v[76:79], v[36:39], v[84:87], v[76:79]
    ds_read_b128 v[116:119], v120 offset:16
    s_waitcnt vmcnt(4) lgkmcnt(7)
    v_mfma_f32_16x16x32_bf16 v[64:67], v[40:43], v[88:91], v[64:67]
    v_mfma_f32_16x16x32_bf16 v[68:71], v[44:47], v[88:91], v[68:71]
    s_waitcnt lgkmcnt(6)
    v_mfma_f32_16x16x32_bf16 v[72:75], v[40:43], v[92:95], v[72:75]
    v_mfma_f32_16x16x32_bf16 v[76:79], v[44:47], v[92:95], v[76:79]
    s_waitcnt vmcnt(2) lgkmcnt(5)
    v_mfma_f32_16x16x32_bf16 v[64:67], v[48:51], v[96:99], v[64:67]
    v_mfma_f32_16x16x32_bf16 v[68:71], v[52:55], v[96:99], v[68:71]
    s_waitcnt lgkmcnt(4)
    v_mfma_f32_16x16x32_bf16 v[72:75], v[48:51], v[100:103], v[72:75]
    v_mfma_f32_16x16x32_bf16 v[76:79], v[52:55], v[100:103], v[76:79]
    s_waitcnt vmcnt(0) lgkmcnt(3)
    v_mfma_f32_16x16x32_bf16 v[64:67], v[56:59], v[104:107], v[64:67]
    v_mfma_f32_16x16x32_bf16 v[68:71], v[60:63], v[104:107], v[68:71]
    s_waitcnt lgkmcnt(2)
    v_mfma_f32_16x16x32_bf16 v[72:75], v[56:59], v[108:111], v[72:75]
    v_mfma_f32_16x16x32_bf16 v[76:79], v[60:63], v[108:111], v[76:79]
    s_mov_b32 s46, 0xffff0000
    s_mov_b32 s48, 0x4038aa3b
    s_mov_b32 s49, s48
    s_nop 3
    v_mov_b32 v28, 0
    s_waitcnt lgkmcnt(0)
    v_cvt_pk_bf16_f32 v24, v64, v68
    v_cvt_pk_bf16_f32 v25, v65, v69
    v_cvt_pk_bf16_f32 v26, v66, v70
    v_cvt_pk_bf16_f32 v27, v67, v71
    v_lshlrev_b32 v80, 16, v24
    v_and_b32 v81, s46, v24
    v_lshlrev_b32 v82, 16, v25
    v_and_b32 v83, s46, v25
    v_lshlrev_b32 v84, 16, v26
    v_and_b32 v85, s46, v26
    v_lshlrev_b32 v86, 16, v27
    v_and_b32 v87, s46, v27
    v_pk_mul_f32 v[80:81], v[80:81], s[48:49]
    v_pk_mul_f32 v[82:83], v[82:83], s[48:49]
    v_pk_mul_f32 v[84:85], v[84:85], s[48:49]
    v_pk_mul_f32 v[86:87], v[86:87], s[48:49]
    v_exp_f32 v96, v80
    v_exp_f32 v97, v81
    v_exp_f32 v98, v82
    v_exp_f32 v99, v83
    v_max3_f32 v28, |v80|, |v81|, v28
    v_max3_f32 v28, |v82|, |v83|, v28
    ds_write_b128 v122, v[96:99] offset:0
    v_exp_f32 v100, v84
    v_exp_f32 v101, v85
    v_exp_f32 v102, v86
    v_exp_f32 v103, v87
    v_max3_f32 v28, |v84|, |v85|, v28
    v_max3_f32 v28, |v86|, |v87|, v28
    ds_write_b128 v122, v[100:103] offset:16
    v_cvt_pk_bf16_f32 v24, v72, v76
    v_cvt_pk_bf16_f32 v25, v73, v77
    v_cvt_pk_bf16_f32 v26, v74, v78
    v_cvt_pk_bf16_f32 v27, v75, v79
    v_lshlrev_b32 v88, 16, v24
    v_and_b32 v89, s46, v24
    v_lshlrev_b32 v90, 16, v25
    v_and_b32 v91, s46, v25
    v_lshlrev_b32 v92, 16, v26
    v_and_b32 v93, s46, v26
    v_lshlrev_b32 v94, 16, v27
    v_and_b32 v95, s46, v27
    v_pk_mul_f32 v[88:89], v[88:89], s[48:49]
    v_pk_mul_f32 v[90:91], v[90:91], s[48:49]
    v_pk_mul_f32 v[92:93], v[92:93], s[48:49]
    v_pk_mul_f32 v[94:95], v[94:95], s[48:49]
    v_exp_f32 v104, v88
    v_exp_f32 v105, v89
    v_exp_f32 v106, v90
    v_exp_f32 v107, v91
    v_max3_f32 v28, |v88|, |v89|, v28
    v_max3_f32 v28, |v90|, |v91|, v28
    ds_write_b128 v122, v[104:107] offset:2304
    v_exp_f32 v108, v92
    v_exp_f32 v109, v93
    v_exp_f32 v110, v94
    v_exp_f32 v111, v95
    v_max3_f32 v28, |v92|, |v93|, v28
    v_max3_f32 v28, |v94|, |v95|, v28
    ds_write_b128 v122, v[108:111] offset:2320
    v_cmp_lt_f32 vcc, 0x42f00000, v28
    s_mov_b32 s22, 4
    s_or_b32 s44, s44, vcc_lo
    s_or_b32 s44, s44, vcc_hi
    s_cmp_lg_u32 s44, 0
    s_cbranch_scc1 L_joint_kernel_tslow
    ds_read_b128 v[32:35], v121 offset:0
    ds_read_b128 v[36:39], v121 offset:16
    ds_read_b128 v[40:43], v121 offset:288
    ds_read_b128 v[44:47], v121 offset:304
    v_add_u32 v121, 576, v121
    s_waitcnt vmcnt(0) lgkmcnt(0)
L_joint_kernel_tloop1:
    v_fma_f32 v48, v112, v32, 1.0
    v_fma_f32 v49, v113, v33, 1.0
    v_fma_f32 v50, v114, v34, 1.0
    v_fma_f32 v51, v115, v35, 1.0
    v_fma_f32 v52, v116, v36, 1.0
    v_fma_f32 v53, v117, v37, 1.0
    v_fma_f32 v54, v118, v38, 1.0
    v_fma_f32 v55, v119, v39, 1.0
    v_fma_f32 v56, v112, v40, 1.0
    v_fma_f32 v57, v113, v41, 1.0
    v_fma_f32 v58, v114, v42, 1.0
    v_fma_f32 v59, v115, v43, 1.0
    v_fma_f32 v60, v116, v44, 1.0
    v_fma_f32 v61, v117, v45, 1.0
    v_fma_f32 v62, v118, v46, 1.0
    v_fma_f32 v63, v119, v47, 1.0
    ds_read_b128 v[32:35], v121 offset:0
    ds_read_b128 v[36:39], v121 offset:16
    ds_read_b128 v[40:43], v121 offset:288
    ds_read_b128 v[44:47], v121 offset:304
    v_add_u32 v121, 576, v121
    v_rcp_f32 v48, v48
    v_rcp_f32 v49, v49
    v_rcp_f32 v50, v50
    v_rcp_f32 v51, v51
    v_rcp_f32 v52, v52
    v_rcp_f32 v53, v53
    v_rcp_f32 v54, v54
    v_rcp_f32 v55, v55
    v_fma_f32 v48, v48, -2.0, 1.0
    v_fma_f32 v49, v49, -2.0, 1.0
    v_fma_f32 v50, v50, -2.0, 1.0
    v_fma_f32 v51, v51, -2.0, 1.0
    v_fma_f32 v52, v52, -2.0, 1.0
    v_fma_f32 v53, v53, -2.0, 1.0
    v_fma_f32 v54, v54, -2.0, 1.0
    v_fma_f32 v55, v55, -2.0, 1.0
    v_cvt_pk_bf16_f32 v64, v48, v49
    v_cvt_pk_bf16_f32 v65, v50, v51
    v_cvt_pk_bf16_f32 v66, v52, v53
    v_cvt_pk_bf16_f32 v67, v54, v55
    ds_write_b128 v123, v[64:67] offset:0
    v_rcp_f32 v56, v56
    v_rcp_f32 v57, v57
    v_rcp_f32 v58, v58
    v_rcp_f32 v59, v59
    v_rcp_f32 v60, v60
    v_rcp_f32 v61, v61
    v_rcp_f32 v62, v62
    v_rcp_f32 v63, v63
    v_fma_f32 v56, v56, -2.0, 1.0
    v_fma_f32 v57, v57, -2.0, 1.0
    v_fma_f32 v58, v58, -2.0, 1.0
    v_fma_f32 v59, v59, -2.0, 1.0
    v_fma_f32 v60, v60, -2.0, 1.0
    v_fma_f32 v61, v61, -2.0, 1.0
    v_fma_f32 v62, v62, -2.0, 1.0
    v_fma_f32 v63, v63, -2.0, 1.0
    v_cvt_pk_bf16_f32 v68, v56, v57
    v_cvt_pk_bf16_f32 v69, v58, v59
    v_cvt_pk_bf16_f32 v70, v60, v61
    v_cvt_pk_bf16_f32 v71, v62, v63
    ds_write_b128 v123, v[68:71] offset:1024
    s_waitcnt lgkmcnt(0)
    s_barrier
    v_fma_f32 v48, v112, v32, 1.0
    v_fma_f32 v49, v113, v33, 1.0
    v_fma_f32 v50, v114, v34, 1.0
    v_fma_f32 v51, v115, v35, 1.0
    v_fma_f32 v52, v116, v36, 1.0
    v_fma_f32 v53, v117, v37, 1.0
    v_fma_f32 v54, v118, v38, 1.0
    v_fma_f32 v55, v119, v39, 1.0
    v_fma_f32 v56, v112, v40, 1.0
    v_fma_f32 v57, v113, v41, 1.0
    v_fma_f32 v58, v114, v42, 1.0
    v_fma_f32 v59, v115, v43, 1.0
    v_fma_f32 v60, v116, v44, 1.0
    v_fma_f32 v61, v117, v45, 1.0
    v_fma_f32 v62, v118, v46, 1.0
    v_fma_f32 v63, v119, v47, 1.0
    ds_read_b128 v[32:35], v121 offset:0
    ds_read_b128 v[36:39], v121 offset:16
    ds_read_b128 v[40:43], v121 offset:288
    ds_read_b128 v[44:47], v121 offset:304
    v_add_u32 v121, 576, v121
    v_rcp_f32 v48, v48
    v_rcp_f32 v49, v49
    v_rcp_f32 v50, v50
    v_rcp_f32 v51, v51
    v_rcp_f32 v52, v52
    v_rcp_f32 v53, v53
    v_rcp_f32 v54, v54
    v_rcp_f32 v55, v55
    v_fma_f32 v48, v48, -2.0, 1.0
    v_fma_f32 v49, v49, -2.0, 1.0
    v_fma_f32 v50, v50, -2.0, 1.0
    v_fma_f32 v51, v51, -2.0, 1.0
    v_fma_f32 v52, v52, -2.0, 1.0
    v_fma_f32 v53, v53, -2.0, 1.0
    v_fma_f32 v54, v54, -2.0, 1.0
    v_fma_f32 v55, v55, -2.0, 1.0
    v_cvt_pk_bf16_f32 v64, v48, v49
    v_cvt_pk_bf16_f32 v65, v50, v51
    v_cvt_pk_bf16_f32 v66, v52, v53
    v_cvt_pk_bf16_f32 v67, v54, v55
    ds_write_b128 v123, v[64:67] offset:16384
    v_rcp_f32 v56, v56
    v_rcp_f32 v57, v57
    v_rcp_f32 v58, v58
    v_rcp_f32 v59, v59
    v_rcp_f32 v60, v60
    v_rcp_f32 v61, v61
    v_rcp_f32 v62, v62
    v_rcp_f32 v63, v63
    v_fma_f32 v56, v56, -2.0, 1.0
    v_fma_f32 v57, v57, -2.0, 1.0
    v_fma_f32 v58, v58, -2.0, 1.0
    v_fma_f32 v59, v59, -2.0, 1.0
    v_fma_f32 v60, v60, -2.0, 1.0
    v_fma_f32 v61, v61, -2.0, 1.0
    v_fma_f32 v62, v62, -2.0, 1.0
    v_fma_f32 v63, v63, -2.0, 1.0
    v_cvt_pk_bf16_f32 v68, v56, v57
    v_cvt_pk_bf16_f32 v69, v58, v59
    v_cvt_pk_bf16_f32 v70, v60, v61
    v_cvt_pk_bf16_f32 v71, v62, v63
    ds_write_b128 v123, v[68:71] offset:17408
    s_waitcnt lgkmcnt(0)
    s_barrier
    s_sub_u32 s22, s22, 1
    s_cmp_lg_u32 s22, 0
    s_cbranch_scc1 L_joint_kernel_tloop1
    s_branch L_joint_kernel_fin
L_joint_kernel_tslow:
    buffer_load_dwordx4 v[112:115], v124, s[40:43], s38 offen offset:0
    buffer_load_dwordx4 v[116:119], v124, s[40:43], s38 offen offset:16
    ds_write_b128 v122, v[80:83] offset:0
    ds_write_b128 v122, v[84:87] offset:16
    ds_write_b128 v122, v[88:91] offset:2304
    ds_write_b128 v122, v[92:95] offset:2320
    ds_read_b128 v[32:35], v121 offset:0
    ds_read_b128 v[36:39], v121 offset:16
    ds_read_b128 v[40:43], v121 offset:288
    ds_read_b128 v[44:47], v121 offset:304
    v_add_u32 v121, 576, v121
    s_waitcnt vmcnt(0) lgkmcnt(0)
L_joint_kernel_tloop0:
    v_add_f32 v48, v112, v32
    v_add_f32 v49, v113, v33
    v_add_f32 v50, v114, v34
    v_add_f32 v51, v115, v35
    v_add_f32 v52, v116, v36
    v_add_f32 v53, v117, v37
    v_add_f32 v54, v118, v38
    v_add_f32 v55, v119, v39
    v_add_f32 v56, v112, v40
    v_add_f32 v57, v113, v41
    v_add_f32 v58, v114, v42
    v_add_f32 v59, v115, v43
    v_add_f32 v60, v116, v44
    v_add_f32 v61, v117, v45
    v_add_f32 v62, v118, v46
    v_add_f32 v63, v119, v47
    ds_read_b128 v[32:35], v121 offset:0
    ds_read_b128 v[36:39], v121 offset:16
    ds_read_b128 v[40:43], v121 offset:288
    ds_read_b128 v[44:47], v121 offset:304
    v_add_u32 v121, 576, v121
    v_exp_f32 v48, v48
    v_exp_f32 v49, v49
    v_exp_f32 v50, v50
    v_exp_f32 v51, v51
    v_exp_f32 v52, v52
    v_exp_f32 v53, v53
    v_exp_f32 v54, v54
    v_exp_f32 v55, v55
    v_add_f32 v48, 1.0, v48
    v_add_f32 v49, 1.0, v49
    v_add_f32 v50, 1.0, v50
    v_add_f32 v51, 1.0, v51
    v_add_f32 v52, 1.0, v52
    v_add_f32 v53, 1.0, v53
    v_add_f32 v54, 1.0, v54
    v_add_f32 v55, 1.0, v55
    v_rcp_f32 v48, v48
    v_rcp_f32 v49, v49
    v_rcp_f32 v50, v50
    v_rcp_f32 v51, v51
    v_rcp_f32 v52, v52
    v_rcp_f32 v53, v53
    v_rcp_f32 v54, v54
    v_rcp_f32 v55, v55
    v_fma_f32 v48, v48, -2.0, 1.0
    v_fma_f32 v49, v49, -2.0, 1.0
    v_fma_f32 v50, v50, -2.0, 1.0
    v_fma_f32 v51, v51, -2.0, 1.0
    v_fma_f32 v52, v52, -2.0, 1.0
    v_fma_f32 v53, v53, -2.0, 1.0
    v_fma_f32 v54, v54, -2.0, 1.0
    v_fma_f32 v55, v55, -2.0, 1.0
    v_cvt_pk_bf16_f32 v64, v48, v49
    v_cvt_pk_bf16_f32 v65, v50, v51
    v_cvt_pk_bf16_f32 v66, v52, v53
    v_cvt_pk_bf16_f32 v67, v54, v55
    ds_write_b128 v123, v[64:67] offset:0
    v_exp_f32 v56, v56
    v_exp_f32 v57, v57
    v_exp_f32 v58, v58
    v_exp_f32 v59, v59
    v_exp_f32 v60, v60
    v_exp_f32 v61, v61
    v_exp_f32 v62, v62
    v_exp_f32 v63, v63
    v_add_f32 v56, 1.0, v56
    v_add_f32 v57, 1.0, v57
    v_add_f32 v58, 1.0, v58
    v_add_f32 v59, 1.0, v59
    v_add_f32 v60, 1.0, v60
    v_add_f32 v61, 1.0, v61
    v_add_f32 v62, 1.0, v62
    v_add_f32 v63, 1.0, v63
    v_rcp_f32 v56, v56
    v_rcp_f32 v57, v57
    v_rcp_f32 v58, v58
    v_rcp_f32 v59, v59
    v_rcp_f32 v60, v60
    v_rcp_f32 v61, v61
    v_rcp_f32 v62, v62
    v_rcp_f32 v63, v63
    v_fma_f32 v56, v56, -2.0, 1.0
    v_fma_f32 v57, v57, -2.0, 1.0
    v_fma_f32 v58, v58, -2.0, 1.0
    v_fma_f32 v59, v59, -2.0, 1.0
    v_fma_f32 v60, v60, -2.0, 1.0
    v_fma_f32 v61, v61, -2.0, 1.0
    v_fma_f32 v62, v62, -2.0, 1.0
    v_fma_f32 v63, v63, -2.0, 1.0
    v_cvt_pk_bf16_f32 v68, v56, v57
    v_cvt_pk_bf16_f32 v69, v58, v59
    v_cvt_pk_bf16_f32 v70, v60, v61
    v_cvt_pk_bf16_f32 v71, v62, v63
    ds_write_b128 v123, v[68:71] offset:1024
    s_waitcnt lgkmcnt(0)
    s_barrier
    v_add_f32 v48, v112, v32
    v_add_f32 v49, v113, v33
    v_add_f32 v50, v114, v34
    v_add_f32 v51, v115, v35
    v_add_f32 v52, v116, v36
    v_add_f32 v53, v117, v37
    v_add_f32 v54, v118, v38
    v_add_f32 v55, v119, v39
    v_add_f32 v56, v112, v40
    v_add_f32 v57, v113, v41
    v_add_f32 v58, v114, v42
    v_add_f32 v59, v115, v43
    v_add_f32 v60, v116, v44
    v_add_f32 v61, v117, v45
    v_add_f32 v62, v118, v46
    v_add_f32 v63, v119, v47
    ds_read_b128 v[32:35], v121 offset:0
    ds_read_b128 v[36:39], v121 offset:16
    ds_read_b128 v[40:43], v121 offset:288
    ds_read_b128 v[44:47], v121 offset:304
    v_add_u32 v121, 576, v121
    v_exp_f32 v48, v48
    v_exp_f32 v49, v49
    v_exp_f32 v50, v50
    v_exp_f32 v51, v51
    v_exp_f32 v52, v52
    v_exp_f32 v53, v53
    v_exp_f32 v54, v54
    v_exp_f32 v55, v55
    v_add_f32 v48, 1.0, v48
    v_add_f32 v49, 1.0, v49
    v_add_f32 v50, 1.0, v50
    v_add_f32 v51, 1.0, v51
    v_add_f32 v52, 1.0, v52
    v_add_f32 v53, 1.0, v53
    v_add_f32 v54, 1.0, v54
    v_add_f32 v55, 1.0, v55
    v_rcp_f32 v48, v48
    v_rcp_f32 v49, v49
    v_rcp_f32 v50, v50
    v_rcp_f32 v51, v51
    v_rcp_f32 v52, v52
    v_rcp_f32 v53, v53
    v_rcp_f32 v54, v54
    v_rcp_f32 v55, v55
    v_fma_f32 v48, v48, -2.0, 1.0
    v_fma_f32 v49, v49, -2.0, 1.0
    v_fma_f32 v50, v50, -2.0, 1.0
    v_fma_f32 v51, v51, -2.0, 1.0
    v_fma_f32 v52, v52, -2.0, 1.0
    v_fma_f32 v53, v53, -2.0, 1.0
    v_fma_f32 v54, v54, -2.0, 1.0
    v_fma_f32 v55, v55, -2.0, 1.0
    v_cvt_pk_bf16_f32 v64, v48, v49
    v_cvt_pk_bf16_f32 v65, v50, v51
    v_cvt_pk_bf16_f32 v66, v52, v53
    v_cvt_pk_bf16_f32 v67, v54, v55
    ds_write_b128 v123, v[64:67] offset:16384
    v_exp_f32 v56, v56
    v_exp_f32 v57, v57
    v_exp_f32 v58, v58
    v_exp_f32 v59, v59
    v_exp_f32 v60, v60
    v_exp_f32 v61, v61
    v_exp_f32 v62, v62
    v_exp_f32 v63, v63
    v_add_f32 v56, 1.0, v56
    v_add_f32 v57, 1.0, v57
    v_add_f32 v58, 1.0, v58
    v_add_f32 v59, 1.0, v59
    v_add_f32 v60, 1.0, v60
    v_add_f32 v61, 1.0, v61
    v_add_f32 v62, 1.0, v62
    v_add_f32 v63, 1.0, v63
    v_rcp_f32 v56, v56
    v_rcp_f32 v57, v57
    v_rcp_f32 v58, v58
    v_rcp_f32 v59, v59
    v_rcp_f32 v60, v60
    v_rcp_f32 v61, v61
    v_rcp_f32 v62, v62
    v_rcp_f32 v63, v63
    v_fma_f32 v56, v56, -2.0, 1.0
    v_fma_f32 v57, v57, -2.0, 1.0
    v_fma_f32 v58, v58, -2.0, 1.0
    v_fma_f32 v59, v59, -2.0, 1.0
    v_fma_f32 v60, v60, -2.0, 1.0
    v_fma_f32 v61, v61, -2.0, 1.0
    v_fma_f32 v62, v62, -2.0, 1.0
    v_fma_f32 v63, v63, -2.0, 1.0
    v_cvt_pk_bf16_f32 v68, v56, v57
    v_cvt_pk_bf16_f32 v69, v58, v59
    v_cvt_pk_bf16_f32 v70, v60, v61
    v_cvt_pk_bf16_f32 v71, v62, v63
    ds_write_b128 v123, v[68:71] offset:17408
    s_waitcnt lgkmcnt(0)
    s_barrier
    s_sub_u32 s22, s22, 1
    s_cmp_lg_u32 s22, 0
    s_cbranch_scc1 L_joint_kernel_tloop0
L_joint_kernel_fin:
L_joint_kernel_done:
    s_endpgm
.section .rodata,"a"
.p2align 6
.amdhsa_kernel prep_kernel
  .amdhsa_next_free_vgpr 128
  .amdhsa_next_free_sgpr 102
  .amdhsa_accum_offset 128
  .amdhsa_group_segment_fixed_size 0
  .amdhsa_kernarg_size 80
  .amdhsa_user_sgpr_count 2
  .amdhsa_user_sgpr_kernarg_segment_ptr 1
  .amdhsa_system_sgpr_workgroup_id_x 1
.end_amdhsa_kernel
.p2align 6
.amdhsa_kernel conv1_kernel
  .amdhsa_next_free_vgpr 128
  .amdhsa_next_free_sgpr 102
  .amdhsa_accum_offset 128
  .amdhsa_group_segment_fixed_size 0
  .amdhsa_kernarg_size 80
  .amdhsa_user_sgpr_count 2
  .amdhsa_user_sgpr_kernarg_segment_ptr 1
  .amdhsa_system_sgpr_workgroup_id_x 1
.end_amdhsa_kernel
.p2align 6
.amdhsa_kernel conv2_kernel
  .amdhsa_next_free_vgpr 128
  .amdhsa_next_free_sgpr 102
  .amdhsa_accum_offset 128
  .amdhsa_group_segment_fixed_size 0
  .amdhsa_kernarg_size 80
  .amdhsa_user_sgpr_count 2
  .amdhsa_user_sgpr_kernarg_segment_ptr 1
  .amdhsa_system_sgpr_workgroup_id_x 1
.end_amdhsa_kernel
.p2align 6
.amdhsa_kernel joint_kernel
  .amdhsa_next_free_vgpr 128
  .amdhsa_next_free_sgpr 102
  .amdhsa_accum_offset 128
  .amdhsa_group_segment_fixed_size 0
  .amdhsa_kernarg_size 80
  .amdhsa_user_sgpr_count 2
  .amdhsa_user_sgpr_kernarg_segment_ptr 1
  .amdhsa_system_sgpr_workgroup_id_x 1
.end_amdhsa_kernel
```

```asm
; @launch kernel=prep_kernel grid=(256,1,1) block=(384,1,1) lds=4096
; @launch kernel=conv1_kernel grid=(256,1,1) block=(1024,1,1) lds=162816
; @launch kernel=conv2_kernel grid=(256,1,1) block=(1024,1,1) lds=162816
; @launch kernel=joint_kernel grid=(250,1,1) block=(1024,1,1) lds=99472
.amdgcn_target "amdgcn-amd-amdhsa--gfx950"
.text
.globl prep_kernel
.p2align 8
.type prep_kernel,@function
prep_kernel:
    s_cmp_ge_u32 s2, 256
    s_cbranch_scc1 L_prep_kernel_done
    s_mov_b32 s3, s2
    s_load_dwordx16 s[44:59], s[0:1], 0
    s_load_dwordx2 s[30:31], s[0:1], 72
    v_readfirstlane_b32 s40, v0
    s_lshr_b32 s40, s40, 6
    v_and_b32 v1, 63, v0
    s_cmp_lt_u32 s40, 4
    s_cbranch_scc1 L_prep_kernel_w
    s_cmp_ge_u32 s2, 24
    s_cbranch_scc1 L_prep_kernel_done
    s_lshr_b32 s41, s2, 3
    s_and_b32 s42, s2, 7
    s_sub_u32 s43, s40, 4
    s_lshl_b32 s26, s43, 16
    s_lshl_b32 s5, s42, 6
    s_add_u32 s26, s26, s5
    s_mov_b32 s10, 131072
    s_mov_b32 s11, 0x00020000
    v_lshrrev_b32 v2, 4, v1
    v_lshlrev_b32 v2, 12, v2
    v_and_b32 v3, 15, v1
    v_lshl_add_u32 v2, v3, 2, v2
    v_mov_b32 v9, 0
    ds_write_b32 v9, v9 offset:2048
    s_waitcnt lgkmcnt(0)
    s_cmp_eq_u32 s41, 1
    s_cselect_b32 s8, s56, s52
    s_cselect_b32 s9, s57, s53
    s_cmp_eq_u32 s41, 2
    s_cselect_b32 s8, s54, s8
    s_cselect_b32 s9, s55, s9
    s_barrier
    s_cmp_lg_u32 s41, 2
    s_cbranch_scc1 L_prep_kernel_nog
    s_mov_b32 s16, s50
    s_mov_b32 s17, s51
    s_mov_b32 s18, 8192
    s_mov_b32 s19, 0x00020000
    v_and_b32 v6, 0x30, v1
    v_lshl_add_u32 v6, v3, 9, v6
    s_lshl_b32 s6, s43, 8
    buffer_load_dwordx4 v[80:83], v6, s[16:19], s6 offen offset:0
    buffer_load_dwordx4 v[84:87], v6, s[16:19], s6 offen offset:64
    buffer_load_dwordx4 v[88:91], v6, s[16:19], s6 offen offset:128
    buffer_load_dwordx4 v[92:95], v6, s[16:19], s6 offen offset:192
L_prep_kernel_nog:
    buffer_load_dword v16, v2, s[8:11], s26 offen offset:0
    buffer_load_dword v17, v2, s[8:11], s26 offen offset:512
    buffer_load_dword v18, v2, s[8:11], s26 offen offset:1024
    buffer_load_dword v19, v2, s[8:11], s26 offen offset:1536
    buffer_load_dword v20, v2, s[8:11], s26 offen offset:2048
    buffer_load_dword v21, v2, s[8:11], s26 offen offset:2560
    buffer_load_dword v22, v2, s[8:11], s26 offen offset:3072
    buffer_load_dword v23, v2, s[8:11], s26 offen offset:3584
    s_add_u32 s26, s26, 16384
    buffer_load_dword v24, v2, s[8:11], s26 offen offset:0
    buffer_load_dword v25, v2, s[8:11], s26 offen offset:512
    buffer_load_dword v26, v2, s[8:11], s26 offen offset:1024
    buffer_load_dword v27, v2, s[8:11], s26 offen offset:1536
    buffer_load_dword v28, v2, s[8:11], s26 offen offset:2048
    buffer_load_dword v29, v2, s[8:11], s26 offen offset:2560
    buffer_load_dword v30, v2, s[8:11], s26 offen offset:3072
    buffer_load_dword v31, v2, s[8:11], s26 offen offset:3584
    s_add_u32 s26, s26, 16384
    buffer_load_dword v32, v2, s[8:11], s26 offen offset:0
    buffer_load_dword v33, v2, s[8:11], s26 offen offset:512
    buffer_load_dword v34, v2, s[8:11], s26 offen offset:1024
    buffer_load_dword v35, v2, s[8:11], s26 offen offset:1536
    buffer_load_dword v36, v2, s[8:11], s26 offen offset:2048
    buffer_load_dword v37, v2, s[8:11], s26 offen offset:2560
    buffer_load_dword v38, v2, s[8:11], s26 offen offset:3072
    buffer_load_dword v39, v2, s[8:11], s26 offen offset:3584
    s_add_u32 s26, s26, 16384
    buffer_load_dword v40, v2, s[8:11], s26 offen offset:0
    buffer_load_dword v41, v2, s[8:11], s26 offen offset:512
    buffer_load_dword v42, v2, s[8:11], s26 offen offset:1024
    buffer_load_dword v43, v2, s[8:11], s26 offen offset:1536
    buffer_load_dword v44, v2, s[8:11], s26 offen offset:2048
    buffer_load_dword v45, v2, s[8:11], s26 offen offset:2560
    buffer_load_dword v46, v2, s[8:11], s26 offen offset:3072
    buffer_load_dword v47, v2, s[8:11], s26 offen offset:3584
    s_branch L_prep_kernel_small
L_prep_kernel_w:
    s_lshl_b32 s21, s2, 2
    s_add_u32 s20, s40, s21
    s_load_dwordx2 s[8:9], s[0:1], 8
    s_lshr_b32 s22, s20, 8
    s_bfe_u32 s23, s20, 0x40004
    s_bfe_u32 s24, s20, 0x30001
    s_and_b32 s21, s20, 1
    v_lshrrev_b32 v5, 4, v1
    v_lshlrev_b32 v2, 11, v5
    v_and_b32 v3, 15, v1
    v_lshl_add_u32 v2, v3, 2, v2
    s_lshl_b32 s26, s22, 3
    s_lshr_b32 s27, s23, 3
    s_add_u32 s26, s26, s27
    s_lshl_b32 s26, s26, 17
    s_and_b32 s27, s23, 7
    s_lshl_b32 s27, s27, 1
    s_add_u32 s27, s27, s21
    s_lshl_b32 s27, s27, 13
    s_add_u32 s26, s26, s27
    s_lshl_b32 s27, s24, 6
    s_add_u32 s26, s26, s27
    s_mov_b32 s10, 4063232
    s_mov_b32 s11, 0x00020000
    s_add_u32 s37, s26, 262144
    s_add_u32 s38, s26, 524288
    s_add_u32 s39, s26, 786432
    s_mov_b32 s14, 7340032
    s_mov_b32 s15, 0x00020000
    v_lshrrev_b32 v4, 1, v5
    v_lshlrev_b32 v4, 8, v4
    v_lshl_add_u32 v4, v3, 4, v4
    v_and_b32 v5, 1, v5
    v_lshl_add_u32 v4, v5, 10, v4
    s_lshl_b32 s27, s24, 4
    s_add_u32 s27, s27, s23
    s_mul_i32 s27, s27, 57344
    s_lshl_b32 s28, s22, 11
    s_add_u32 s27, s27, s28
    s_lshl_b32 s28, s21, 9
    s_add_u32 s27, s27, s28
    s_mov_b32 s32, 0x05040100
    s_mov_b32 s33, 0x07060302
    s_mov_b32 s34, 0xffff0000
    s_mov_b32 s35, 0x3d2aaaab
    s_mov_b32 s40, 0x3c638e39
    s_waitcnt lgkmcnt(0)
    buffer_load_dword v16, v2, s[8:11], s26 offen offset:0
    buffer_load_dword v17, v2, s[8:11], s26 offen offset:512
    buffer_load_dword v20, v2, s[8:11], s37 offen offset:0
    buffer_load_dword v21, v2, s[8:11], s37 offen offset:512
    buffer_load_dword v24, v2, s[8:11], s38 offen offset:0
    buffer_load_dword v25, v2, s[8:11], s38 offen offset:512
    buffer_load_dword v28, v2, s[8:11], s39 offen offset:0
    buffer_load_dword v29, v2, s[8:11], s39 offen offset:512
    buffer_load_dword v18, v2, s[8:11], s26 offen offset:1024
    buffer_load_dword v19, v2, s[8:11], s26 offen offset:1536
    buffer_load_dword v22, v2, s[8:11], s37 offen offset:1024
    buffer_load_dword v23, v2, s[8:11], s37 offen offset:1536
    buffer_load_dword v26, v2, s[8:11], s38 offen offset:1024
    buffer_load_dword v27, v2, s[8:11], s38 offen offset:1536
    buffer_load_dword v30, v2, s[8:11], s39 offen offset:1024
    buffer_load_dword v31, v2, s[8:11], s39 offen offset:1536
    s_barrier
    s_add_u32 s12, s30, 0
    s_addc_u32 s13, s31, 0
    s_waitcnt vmcnt(8)
    v_perm_b32 v100, v17, v16, s32
    v_perm_b32 v76, v29, v28, s32
    v_lshlrev_b32 v104, 16, v28
    v_lshlrev_b32 v112, 16, v29
    v_lshlrev_b32 v105, 16, v24
    v_lshlrev_b32 v113, 16, v25
    v_lshlrev_b32 v106, 16, v20
    v_lshlrev_b32 v114, 16, v21
    v_lshlrev_b32 v107, 16, v16
    v_lshlrev_b32 v115, 16, v17
    v_add_f32 v108, v104, v106
    v_add_f32 v116, v112, v114
    v_add_f32 v109, v105, v107
    v_add_f32 v117, v113, v115
    v_fma_f32 v110, v106, 4.0, v104
    v_fma_f32 v118, v114, 4.0, v112
    v_fma_f32 v111, v107, 4.0, v105
    v_fma_f32 v119, v115, 4.0, v113
    v_add_f32 v105, v108, v109
    v_add_f32 v113, v116, v117
    v_sub_f32 v106, v108, v109
    v_sub_f32 v114, v116, v117
    v_fma_f32 v107, v111, 2.0, v110
    v_fma_f32 v115, v119, 2.0, v118
    v_fma_f32 v110, v111, -2.0, v110
    v_fma_f32 v118, v119, -2.0, v118
    v_fmamk_f32 v108, v104, 0x41700000, v110
    v_fmamk_f32 v116, v112, 0x41700000, v118
    v_fmamk_f32 v108, v109, 0x41200000, v108
    v_fmamk_f32 v116, v117, 0x41200000, v116
    v_mul_f32 v105, 0.5, v105
    v_mul_f32 v113, 0.5, v113
    v_mul_f32 v106, 0.5, v106
    v_mul_f32 v114, 0.5, v114
    v_mul_f32 v107, s35, v107
    v_mul_f32 v115, s35, v115
    v_mul_f32 v110, s35, v110
    v_mul_f32 v118, s35, v118
    v_mul_f32 v108, s40, v108
    v_mul_f32 v116, s40, v116
    v_cvt_pk_bf16_f32 v80, v105, v113
    v_cvt_pk_bf16_f32 v84, v106, v114
    v_cvt_pk_bf16_f32 v88, v107, v115
    v_cvt_pk_bf16_f32 v92, v110, v118
    v_cvt_pk_bf16_f32 v96, v108, v116
    v_perm_b32 v102, v17, v16, s33
    v_perm_b32 v78, v29, v28, s33
    v_and_b32 v104, s34, v28
    v_and_b32 v112, s34, v29
    v_and_b32 v105, s34, v24
    v_and_b32 v113, s34, v25
    v_and_b32 v106, s34, v20
    v_and_b32 v114, s34, v21
    v_and_b32 v107, s34, v16
    v_and_b32 v115, s34, v17
    v_add_f32 v108, v104, v106
    v_add_f32 v116, v112, v114
    v_add_f32 v109, v105, v107
    v_add_f32 v117, v113, v115
    v_fma_f32 v110, v106, 4.0, v104
    v_fma_f32 v118, v114, 4.0, v112
    v_fma_f32 v111, v107, 4.0, v105
    v_fma_f32 v119, v115, 4.0, v113
    v_add_f32 v105, v108, v109
    v_add_f32 v113, v116, v117
    v_sub_f32 v106, v108, v109
    v_sub_f32 v114, v116, v117
    v_fma_f32 v107, v111, 2.0, v110
    v_fma_f32 v115, v119, 2.0, v118
    v_fma_f32 v110, v111, -2.0, v110
    v_fma_f32 v118, v119, -2.0, v118
    v_fmamk_f32 v108, v104, 0x41700000, v110
    v_fmamk_f32 v116, v112, 0x41700000, v118
    v_fmamk_f32 v108, v109, 0x41200000, v108
    v_fmamk_f32 v116, v117, 0x41200000, v116
    v_mul_f32 v105, 0.5, v105
    v_mul_f32 v113, 0.5, v113
    v_mul_f32 v106, 0.5, v106
    v_mul_f32 v114, 0.5, v114
    v_mul_f32 v107, s35, v107
    v_mul_f32 v115, s35, v115
    v_mul_f32 v110, s35, v110
    v_mul_f32 v118, s35, v118
    v_mul_f32 v108, s40, v108
    v_mul_f32 v116, s40, v116
    v_cvt_pk_bf16_f32 v82, v105, v113
    v_cvt_pk_bf16_f32 v86, v106, v114
    v_cvt_pk_bf16_f32 v90, v107, v115
    v_cvt_pk_bf16_f32 v94, v110, v118
    v_cvt_pk_bf16_f32 v98, v108, v116
    s_waitcnt vmcnt(0)
    s_cmp_lt_u32 s3, 224
    s_cbranch_scc1 L_prep_kernel_ncw
    s_getpc_b64 s[62:63]
L_prep_kernel_pc:
    s_and_b32 s64, s3, 8
    s_lshl_b32 s64, s64, 12
    v_lshlrev_b32 v120, 7, v0
    v_add_u32 v120, s64, v120
    v_min_u32 v120, L_joint_kernel_done-L_prep_kernel_pc, v120
    v_mov_b32 v121, s63
    v_add_co_u32 v120, vcc, s62, v120
    s_nop 1
    v_addc_co_u32 v121, vcc, 0, v121, vcc
    global_load_dword v122, v[120:121], off
L_prep_kernel_ncw:
    v_perm_b32 v101, v19, v18, s32
    v_perm_b32 v77, v31, v30, s32
    v_lshlrev_b32 v104, 16, v30
    v_lshlrev_b32 v112, 16, v31
    v_lshlrev_b32 v105, 16, v26
    v_lshlrev_b32 v113, 16, v27
    v_lshlrev_b32 v106, 16, v22
    v_lshlrev_b32 v114, 16, v23
    v_lshlrev_b32 v107, 16, v18
    v_lshlrev_b32 v115, 16, v19
    v_add_f32 v108, v104, v106
    v_add_f32 v116, v112, v114
    v_add_f32 v109, v105, v107
    v_add_f32 v117, v113, v115
    v_fma_f32 v110, v106, 4.0, v104
    v_fma_f32 v118, v114, 4.0, v112
    v_fma_f32 v111, v107, 4.0, v105
    v_fma_f32 v119, v115, 4.0, v113
    v_add_f32 v105, v108, v109
    v_add_f32 v113, v116, v117
    v_sub_f32 v106, v108, v109
    v_sub_f32 v114, v116, v117
    v_fma_f32 v107, v111, 2.0, v110
    v_fma_f32 v115, v119, 2.0, v118
    v_fma_f32 v110, v111, -2.0, v110
    v_fma_f32 v118, v119, -2.0, v118
    v_fmamk_f32 v108, v104, 0x41700000, v110
    v_fmamk_f32 v116, v112, 0x41700000, v118
    v_fmamk_f32 v108, v109, 0x41200000, v108
    v_fmamk_f32 v116, v117, 0x41200000, v116
    v_mul_f32 v105, 0.5, v105
    v_mul_f32 v113, 0.5, v113
    v_mul_f32 v106, 0.5, v106
    v_mul_f32 v114, 0.5, v114
    v_mul_f32 v107, s35, v107
    v_mul_f32 v115, s35, v115
    v_mul_f32 v110, s35, v110
    v_mul_f32 v118, s35, v118
    v_mul_f32 v108, s40, v108
    v_mul_f32 v116, s40, v116
    v_cvt_pk_bf16_f32 v81, v105, v113
    v_cvt_pk_bf16_f32 v85, v106, v114
    v_cvt_pk_bf16_f32 v89, v107, v115
    v_cvt_pk_bf16_f32 v93, v110, v118
    v_cvt_pk_bf16_f32 v97, v108, v116
    v_perm_b32 v103, v19, v18, s33
    v_perm_b32 v79, v31, v30, s33
    v_and_b32 v104, s34, v30
    v_and_b32 v112, s34, v31
    v_and_b32 v105, s34, v26
    v_and_b32 v113, s34, v27
    v_and_b32 v106, s34, v22
    v_and_b32 v114, s34, v23
    v_and_b32 v107, s34, v18
    v_and_b32 v115, s34, v19
    v_add_f32 v108, v104, v106
    v_add_f32 v116, v112, v114
    v_add_f32 v109, v105, v107
    v_add_f32 v117, v113, v115
    v_fma_f32 v110, v106, 4.0, v104
    v_fma_f32 v118, v114, 4.0, v112
    v_fma_f32 v111, v107, 4.0, v105
    v_fma_f32 v119, v115, 4.0, v113
    v_add_f32 v105, v108, v109
    v_add_f32 v113, v116, v117
    v_sub_f32 v106, v108, v109
    v_sub_f32 v114, v116, v117
    v_fma_f32 v107, v111, 2.0, v110
    v_fma_f32 v115, v119, 2.0, v118
    v_fma_f32 v110, v111, -2.0, v110
    v_fma_f32 v118, v119, -2.0, v118
    v_fmamk_f32 v108, v104, 0x41700000, v110
    v_fmamk_f32 v116, v112, 0x41700000, v118
    v_fmamk_f32 v108, v109, 0x41200000, v108
    v_fmamk_f32 v116, v117, 0x41200000, v116
    v_mul_f32 v105, 0.5, v105
    v_mul_f32 v113, 0.5, v113
    v_mul_f32 v106, 0.5, v106
    v_mul_f32 v114, 0.5, v114
    v_mul_f32 v107, s35, v107
    v_mul_f32 v115, s35, v115
    v_mul_f32 v110, s35, v110
    v_mul_f32 v118, s35, v118
    v_mul_f32 v108, s40, v108
    v_mul_f32 v116, s40, v116
    v_cvt_pk_bf16_f32 v83, v105, v113
    v_cvt_pk_bf16_f32 v87, v106, v114
    v_cvt_pk_bf16_f32 v91, v107, v115
    v_cvt_pk_bf16_f32 v95, v110, v118
    v_cvt_pk_bf16_f32 v99, v108, v116
    v_permlane16_swap_b32 v100, v102
    v_permlane16_swap_b32 v101, v103
    s_add_u32 s28, s27, 49152
    buffer_store_dwordx4 v[100:103], v4, s[12:15], s28 offen sc1
    v_permlane16_swap_b32 v76, v78
    v_permlane16_swap_b32 v77, v79
    s_add_u32 s28, s27, 0
    buffer_store_dwordx4 v[76:79], v4, s[12:15], s28 offen sc1
    v_permlane16_swap_b32 v80, v82
    v_permlane16_swap_b32 v81, v83
    s_add_u32 s28, s27, 8192
    buffer_store_dwordx4 v[80:83], v4, s[12:15], s28 offen sc1
    v_permlane16_swap_b32 v84, v86
    v_permlane16_swap_b32 v85, v87
    s_add_u32 s28, s27, 16384
    buffer_store_dwordx4 v[84:87], v4, s[12:15], s28 offen sc1
    v_permlane16_swap_b32 v88, v90
    v_permlane16_swap_b32 v89, v91
    s_add_u32 s28, s27, 24576
    buffer_store_dwordx4 v[88:91], v4, s[12:15], s28 offen sc1
    v_permlane16_swap_b32 v92, v94
    v_permlane16_swap_b32 v93, v95
    s_add_u32 s28, s27, 32768
    buffer_store_dwordx4 v[92:95], v4, s[12:15], s28 offen sc1
    v_permlane16_swap_b32 v96, v98
    v_permlane16_swap_b32 v97, v99
    s_add_u32 s28, s27, 40960
    buffer_store_dwordx4 v[96:99], v4, s[12:15], s28 offen sc1
L_prep_kernel_done:
    s_endpgm
L_prep_kernel_small:
    v_lshrrev_b32 v2, 4, v1
    s_lshl_b32 s24, s41, 17
    s_add_u32 s24, s24, 44040192
    s_add_u32 s12, s30, s24
    s_addc_u32 s13, s31, 0
    s_mov_b32 s14, 131072
    s_mov_b32 s15, 0x00020000
    s_mov_b32 s32, 0x05040100
    s_mov_b32 s33, 0x07060302
    v_lshlrev_b32 v4, 4, v1
    s_lshl_b32 s24, s42, 14
    s_lshl_b32 s25, s43, 13
    s_add_u32 s24, s24, s25
    s_add_u32 s25, s24, 4096
    s_waitcnt vmcnt(0)
    v_perm_b32 v48, v17, v16, s32
    v_perm_b32 v49, v19, v18, s32
    v_perm_b32 v50, v21, v20, s32
    v_perm_b32 v51, v23, v22, s32
    v_perm_b32 v52, v17, v16, s33
    v_perm_b32 v53, v19, v18, s33
    v_perm_b32 v54, v21, v20, s33
    v_perm_b32 v55, v23, v22, s33
    v_perm_b32 v56, v25, v24, s32
    v_perm_b32 v57, v27, v26, s32
    v_perm_b32 v58, v29, v28, s32
    v_perm_b32 v59, v31, v30, s32
    v_perm_b32 v60, v25, v24, s33
    v_perm_b32 v61, v27, v26, s33
    v_perm_b32 v62, v29, v28, s33
    v_perm_b32 v63, v31, v30, s33
    v_perm_b32 v64, v33, v32, s32
    v_perm_b32 v65, v35, v34, s32
    v_perm_b32 v66, v37, v36, s32
    v_perm_b32 v67, v39, v38, s32
    v_perm_b32 v68, v33, v32, s33
    v_perm_b32 v69, v35, v34, s33
    v_perm_b32 v70, v37, v36, s33
    v_perm_b32 v71, v39, v38, s33
    v_perm_b32 v72, v41, v40, s32
    v_perm_b32 v73, v43, v42, s32
    v_perm_b32 v74, v45, v44, s32
    v_perm_b32 v75, v47, v46, s32
    v_perm_b32 v76, v41, v40, s33
    v_perm_b32 v77, v43, v42, s33
    v_perm_b32 v78, v45, v44, s33
    v_perm_b32 v79, v47, v46, s33
    s_cmp_eq_u32 s41, 2
    s_cbranch_scc1 L_prep_kernel_ge
    buffer_store_dwordx4 v[48:51], v4, s[12:15], s24 offen offset:0 sc1
    buffer_store_dwordx4 v[52:55], v4, s[12:15], s24 offen offset:1024 sc1
    buffer_store_dwordx4 v[56:59], v4, s[12:15], s24 offen offset:2048 sc1
    buffer_store_dwordx4 v[60:63], v4, s[12:15], s24 offen offset:3072 sc1
    buffer_store_dwordx4 v[64:67], v4, s[12:15], s25 offen offset:0 sc1
    buffer_store_dwordx4 v[68:71], v4, s[12:15], s25 offen offset:1024 sc1
    buffer_store_dwordx4 v[72:75], v4, s[12:15], s25 offen offset:2048 sc1
    buffer_store_dwordx4 v[76:79], v4, s[12:15], s25 offen offset:3072 sc1
    s_endpgm
L_prep_kernel_ge:
    v_mfma_f32_16x16x32_bf16 v[96:99], v[48:51], v[80:83], 0
    v_mfma_f32_16x16x32_bf16 v[100:103], v[52:55], v[80:83], 0
    v_mfma_f32_16x16x32_bf16 v[96:99], v[56:59], v[84:87], v[96:99]
    v_mfma_f32_16x16x32_bf16 v[100:103], v[60:63], v[84:87], v[100:103]
    v_mfma_f32_16x16x32_bf16 v[96:99], v[64:67], v[88:91], v[96:99]
    v_mfma_f32_16x16x32_bf16 v[100:103], v[68:71], v[88:91], v[100:103]
    v_mfma_f32_16x16x32_bf16 v[96:99], v[72:75], v[92:95], v[96:99]
    v_mfma_f32_16x16x32_bf16 v[100:103], v[76:79], v[92:95], v[100:103]
    v_mov_b32 v7, v4
    v_mov_b32 v10, 1
    s_nop 0
    s_mov_b32 s14, 16384
    v_lshlrev_b32 v8, 10, v3
    v_lshl_add_u32 v8, v2, 5, v8
    s_lshl_b32 s24, s42, 7
    s_mov_b32 s34, 0xffff0000
    s_mov_b32 s35, 0x4038aa3b
    s_cmp_eq_u32 s43, 0
    s_cbranch_scc1 L_prep_kernel_ge0
    ds_write_b128 v7, v[96:99]
    ds_write_b128 v7, v[100:103] offset:1024
    ds_write_b32 v9, v10 offset:2048
    s_endpgm
L_prep_kernel_ge0:
    ds_read_b32 v10, v9 offset:2048
    s_waitcnt lgkmcnt(0)
    v_readfirstlane_b32 s27, v10
    s_cmp_eq_u32 s27, 0
    s_cbranch_scc1 L_prep_kernel_ge0
    ds_read_b128 v[16:19], v7
    ds_read_b128 v[20:23], v7 offset:1024
    s_waitcnt lgkmcnt(0)
    v_add_f32 v16, v16, v96
    v_add_f32 v17, v17, v97
    v_add_f32 v18, v18, v98
    v_add_f32 v19, v19, v99
    v_add_f32 v20, v20, v100
    v_add_f32 v21, v21, v101
    v_add_f32 v22, v22, v102
    v_add_f32 v23, v23, v103
    v_cvt_pk_bf16_f32 v48, v16, v20
    v_cvt_pk_bf16_f32 v49, v17, v21
    v_cvt_pk_bf16_f32 v50, v18, v22
    v_cvt_pk_bf16_f32 v51, v19, v23
    v_lshlrev_b32 v56, 16, v48
    v_and_b32 v57, s34, v48
    v_lshlrev_b32 v58, 16, v49
    v_and_b32 v59, s34, v49
    v_lshlrev_b32 v60, 16, v50
    v_and_b32 v61, s34, v50
    v_lshlrev_b32 v62, 16, v51
    v_and_b32 v63, s34, v51
    v_mul_f32 v56, s35, v56
    v_mul_f32 v57, s35, v57
    v_mul_f32 v58, s35, v58
    v_mul_f32 v59, s35, v59
    v_mul_f32 v60, s35, v60
    v_mul_f32 v61, s35, v61
    v_mul_f32 v62, s35, v62
    v_mul_f32 v63, s35, v63
    buffer_store_dwordx4 v[56:59], v8, s[12:15], s24 offen sc1
    buffer_store_dwordx4 v[60:63], v8, s[12:15], s24 offen offset:16 sc1
    v_exp_f32 v64, v56
    v_exp_f32 v65, v57
    v_exp_f32 v66, v58
    v_exp_f32 v67, v59
    v_exp_f32 v68, v60
    v_exp_f32 v69, v61
    v_exp_f32 v70, v62
    v_exp_f32 v71, v63
    v_max3_f32 v72, |v56|, |v57|, |v58|
    v_max3_f32 v72, |v59|, |v60|, v72
    v_max3_f32 v72, |v61|, |v62|, v72
    v_max_f32 v72, |v63|, v72
    s_add_u32 s12, s12, 16384
    s_addc_u32 s13, s13, 0
    v_cmp_lt_f32 vcc, 0x42f00000, v72
    buffer_store_dwordx4 v[64:67], v8, s[12:15], s24 offen sc1
    buffer_store_dwordx4 v[68:71], v8, s[12:15], s24 offen offset:16 sc1
    s_add_u32 s12, s12, 16384
    s_addc_u32 s13, s13, 0
    s_or_b32 s26, vcc_lo, vcc_hi
    s_lshl_b32 s24, s42, 2
    v_mov_b32 v73, s26
    v_mov_b32 v74, 0
    buffer_store_dword v73, v74, s[12:15], s24 offen sc1
L_prep_kernel_last:
    s_endpgm
.globl conv1_kernel
.p2align 8
.type conv1_kernel,@function
conv1_kernel:
    s_cmp_ge_u32 s2, 256
    s_cbranch_scc1 L_conv1_kernel_done
    s_load_dwordx2 s[4:5], s[0:1], 0
    s_load_dwordx2 s[30:31], s[0:1], 72
    v_readfirstlane_b32 s20, v0
    s_lshr_b32 s20, s20, 6
    s_xor_b32 s20, s20, 8
    s_and_b32 s36, s2, 0
    s_lshl_b32 s36, s36, 3
    s_bfe_u32 s37, s2, 196611
    s_or_b32 s29, s36, s37
    s_bfe_u32 s36, s2, 196608
    s_lshl_b32 s36, s36, 2
    s_lshr_b32 s37, s2, 6
    s_or_b32 s36, s36, s37
    s_mov_b32 s33, 0
    s_and_b32 s34, s36, 15
    s_lshr_b32 s35, s36, 4
    s_mul_i32 s21, s34, 500
    s_and_b32 s32, s20, 3
    v_and_b32 v127, 63, v0
    v_lshrrev_b32 v5, 2, v127
    v_and_b32 v6, 3, v127
    s_and_b32 s42, s20, 7
    v_lshlrev_b32 v7, 15, v5
    v_lshl_add_u32 v7, v6, 4, v7
    s_lshl_b32 s41, s21, 10
    s_sub_u32 s41, s41, 7680
    s_lshl_b32 s37, s42, 12
    s_add_u32 s37, s37, s41
    v_add_u32 v7, s37, v7
    s_mul_i32 s36, s35, 8192000
    s_mov_b32 s10, 8192000
    s_mov_b32 s11, 0x00020000
    s_mov_b32 s25, 0xffff0000
    s_mov_b32 s47, s36
    s_cmp_ge_u32 s20, 8
    s_cbranch_scc1 L_conv1_kernel_helper
    s_add_u32 s37, s41, 524288
    v_lshl_add_u32 v108, v127, 4, s37
    v_add_u32 v109, 1024, v108
    v_add_u32 v110, 2048, v108
    s_waitcnt lgkmcnt(0)
    s_add_u32 s8, s4, s47
    s_addc_u32 s9, s5, 0
    s_lshl_b32 s36, s29, 4
    s_lshl_b32 s37, s33, 3
    s_add_u32 s36, s36, s37
    s_mul_i32 s36, s36, 57344
    s_add_u32 s36, s36, 0
    s_add_u32 s12, s30, s36
    s_addc_u32 s13, s31, 0
    s_mov_b32 s14, 917504
    s_mov_b32 s15, 0x00020000
    s_mul_i32 s36, s35, 4194304
    s_add_u32 s36, s36, 18874368
    s_add_u32 s16, s30, s36
    s_addc_u32 s17, s31, 0
    s_mov_b32 s18, 4194304
    s_mov_b32 s19, 0x00020000
    v_and_b32 v10, 15, v127
    v_lshrrev_b32 v11, 4, v127
    v_add_u32 v8, 0, v10
    v_and_b32 v16, 4, v8
    v_lshrrev_b32 v16, 1, v16
    v_xor_b32 v16, v11, v16
    v_lshlrev_b32 v16, 4, v16
    v_lshl_add_u32 v8, v8, 6, v16
    v_add_u32 v9, 1, v10
    v_and_b32 v16, 4, v9
    v_lshrrev_b32 v16, 1, v16
    v_xor_b32 v16, v11, v16
    v_lshlrev_b32 v16, 4, v16
    v_lshl_add_u32 v9, v9, 6, v16
    s_lshr_b32 s38, s32, 1
    s_and_b32 s39, s32, 1
    s_add_u32 s40, s38, 4
    s_lshl_b32 s43, s39, 10
    s_cmp_lt_u32 s20, 4
    s_cselect_b32 s40, s20, s40
    s_cselect_b32 s36, 0, s43
    s_lshl_b32 s37, s40, 13
    s_add_u32 s37, s37, s36
    v_lshl_add_u32 v125, v127, 4, s37
    s_mul_i32 s37, s40, 16384
    v_add_u32 v120, s37, v8
    v_add_u32 v121, s37, v9
    s_lshl_b32 s37, s40, 10
    s_add_u32 s37, s37, 115712
    v_lshl_add_u32 v16, v11, 4, s37
    v_cmp_eq_u32 vcc, 15, v10
    v_mov_b32 v17, 8192
    v_mov_b32 v18, 4294959104
    v_mov_b32 v19, 64
    v_cndmask_b32 v122, v121, v16, vcc
    v_cndmask_b32 v123, v17, v19, vcc
    v_cndmask_b32 v124, v18, v19, vcc
    v_lshl_add_u32 v126, v127, 4, s37
    s_mov_b32 s44, 0x3f800000
    s_mov_b32 s45, 0x00000000
    s_mov_b32 s46, 0x00000000
    s_cmp_eq_u32 s40, 1
    s_cselect_b32 s45, 0x3f800000, s45
    s_cselect_b32 s46, 0x3f800000, s46
    s_cmp_eq_u32 s40, 2
    s_cselect_b32 s45, 0xbf800000, s45
    s_cselect_b32 s46, 0x3f800000, s46
    s_cmp_eq_u32 s40, 3
    s_cselect_b32 s45, 0x40000000, s45
    s_cselect_b32 s46, 0x40800000, s46
    s_cmp_eq_u32 s40, 4
    s_cselect_b32 s45, 0xc0000000, s45
    s_cselect_b32 s46, 0x40800000, s46
    s_cmp_eq_u32 s40, 5
    s_cselect_b32 s44, 0x41800000, s44
    s_cselect_b32 s45, 0x41000000, s45
    s_cselect_b32 s46, 0x40800000, s46
    s_cmp_ge_u32 s20, 4
    s_cbranch_scc1 L_conv1_kernel_m2
    v_mov_b32 v0, 0
    v_mov_b32 v1, 0
    v_mov_b32 v2, 0
    v_mov_b32 v3, 0
    v_mov_b32 v4, 0
    v_mov_b32 v5, 0
    v_mov_b32 v6, 0
    v_mov_b32 v7, 0
    v_mov_b32 v8, 0
    v_mov_b32 v9, 0
    v_mov_b32 v10, 0
    v_mov_b32 v11, 0
    v_mov_b32 v12, 0
    v_mov_b32 v13, 0
    v_mov_b32 v14, 0
    v_mov_b32 v15, 0
    v_mov_b32 v16, 0
    v_mov_b32 v17, 0
    v_mov_b32 v18, 0
    v_mov_b32 v19, 0
    v_mov_b32 v20, 0
    v_mov_b32 v21, 0
    v_mov_b32 v22, 0
    v_mov_b32 v23, 0
    v_mov_b32 v24, 0
    v_mov_b32 v25, 0
    v_mov_b32 v26, 0
    v_mov_b32 v27, 0
    v_mov_b32 v28, 0
    v_mov_b32 v29, 0
    v_mov_b32 v30, 0
    v_mov_b32 v31, 0
    v_mov_b32 v32, 0
    v_mov_b32 v33, 0
    v_mov_b32 v34, 0
    v_mov_b32 v35, 0
    v_mov_b32 v36, 0
    v_mov_b32 v37, 0
    v_mov_b32 v38, 0
    v_mov_b32 v39, 0
    v_mov_b32 v40, 0
    v_mov_b32 v41, 0
    v_mov_b32 v42, 0
    v_mov_b32 v43, 0
    v_mov_b32 v44, 0
    v_mov_b32 v45, 0
    v_mov_b32 v46, 0
    v_mov_b32 v47, 0
    v_mov_b32 v48, 0
    v_mov_b32 v49, 0
    v_mov_b32 v50, 0
    v_mov_b32 v51, 0
    v_mov_b32 v52, 0
    v_mov_b32 v53, 0
    v_mov_b32 v54, 0
    v_mov_b32 v55, 0
    v_mov_b32 v56, 0
    v_mov_b32 v57, 0
    v_mov_b32 v58, 0
    v_mov_b32 v59, 0
    v_mov_b32 v60, 0
    v_mov_b32 v61, 0
    v_mov_b32 v62, 0
    v_mov_b32 v63, 0
    buffer_load_dwordx4 v[96:99], v108, s[8:11], 0 offen
    buffer_load_dwordx4 v[100:103], v109, s[8:11], 0 offen
    buffer_load_dwordx4 v[104:107], v110, s[8:11], 0 offen
    s_mov_b32 s23, 0
    s_mov_b32 s26, 4096
    buffer_load_dwordx4 v[64:67], v125, s[12:15], s23 offen offset:0
    buffer_load_dwordx4 v[68:71], v125, s[12:15], s23 offen offset:1024
    buffer_load_dwordx4 v[72:75], v125, s[12:15], s23 offen offset:2048
    buffer_load_dwordx4 v[76:79], v125, s[12:15], s23 offen offset:3072
    buffer_load_dwordx4 v[80:83], v125, s[12:15], s26 offen offset:0
    buffer_load_dwordx4 v[84:87], v125, s[12:15], s26 offen offset:1024
    buffer_load_dwordx4 v[88:91], v125, s[12:15], s26 offen offset:2048
    buffer_load_dwordx4 v[92:95], v125, s[12:15], s26 offen offset:3072
    s_mov_b32 s23, 57344
    s_mov_b32 s26, 61440
    s_waitcnt vmcnt(8)
    v_lshlrev_b32 v108, 16, v96
    v_and_b32 v111, s25, v96
    v_lshlrev_b32 v109, 16, v100
    v_and_b32 v112, s25, v100
    v_lshlrev_b32 v110, 16, v104
    v_and_b32 v113, s25, v104
    v_mul_f32 v114, s44, v108
    v_mul_f32 v115, s44, v111
    v_fmac_f32 v114, s45, v109
    v_fmac_f32 v115, s45, v112
    v_fmac_f32 v114, s46, v110
    v_fmac_f32 v115, s46, v113
    v_cvt_pk_bf16_f32 v96, v114, v115
    v_lshlrev_b32 v108, 16, v97
    v_and_b32 v111, s25, v97
    v_lshlrev_b32 v109, 16, v101
    v_and_b32 v112, s25, v101
    v_lshlrev_b32 v110, 16, v105
    v_and_b32 v113, s25, v105
    v_mul_f32 v114, s44, v108
    v_mul_f32 v115, s44, v111
    v_fmac_f32 v114, s45, v109
    v_fmac_f32 v115, s45, v112
    v_fmac_f32 v114, s46, v110
    v_fmac_f32 v115, s46, v113
    v_cvt_pk_bf16_f32 v97, v114, v115
    v_lshlrev_b32 v108, 16, v98
    v_and_b32 v111, s25, v98
    v_lshlrev_b32 v109, 16, v102
    v_and_b32 v112, s25, v102
    v_lshlrev_b32 v110, 16, v106
    v_and_b32 v113, s25, v106
    v_mul_f32 v114, s44, v108
    v_mul_f32 v115, s44, v111
    v_fmac_f32 v114, s45, v109
    v_fmac_f32 v115, s45, v112
    v_fmac_f32 v114, s46, v110
    v_fmac_f32 v115, s46, v113
    v_cvt_pk_bf16_f32 v98, v114, v115
    v_lshlrev_b32 v108, 16, v99
    v_and_b32 v111, s25, v99
    v_lshlrev_b32 v109, 16, v103
    v_and_b32 v112, s25, v103
    v_lshlrev_b32 v110, 16, v107
    v_and_b32 v113, s25, v107
    v_mul_f32 v114, s44, v108
    v_mul_f32 v115, s44, v111
    v_fmac_f32 v114, s45, v109
    v_fmac_f32 v115, s45, v112
    v_fmac_f32 v114, s46, v110
    v_fmac_f32 v115, s46, v113
    v_cvt_pk_bf16_f32 v99, v114, v115
    ds_write_b128 v126, v[96:99]
    s_waitcnt lgkmcnt(0)
    s_barrier
    s_mov_b32 s22, 8
    s_setprio 2
L_conv1_kernel_mloop1:
    ds_read_b128 v[96:99], v120 offset:0
    ds_read_b128 v[100:103], v120 offset:1024
    ds_read_b128 v[104:107], v120 offset:2048
    ds_read_b128 v[108:111], v120 offset:3072
    ds_read_b128 v[112:115], v120 offset:4096
    ds_read_b128 v[116:119], v120 offset:5120
    s_waitcnt vmcnt(6) lgkmcnt(5)
    v_mfma_f32_16x16x32_bf16 v[0:3], v[64:67], v[96:99], v[0:3]
    v_mfma_f32_16x16x32_bf16 v[32:35], v[68:71], v[96:99], v[32:35]
    ds_read_b128 v[96:99], v120 offset:6144
    s_waitcnt vmcnt(4) lgkmcnt(5)
    v_mfma_f32_16x16x32_bf16 v[4:7], v[64:67], v[100:103], v[4:7]
    v_mfma_f32_16x16x32_bf16 v[36:39], v[68:71], v[100:103], v[36:39]
    v_mfma_f32_16x16x32_bf16 v[0:3], v[72:75], v[100:103], v[0:3]
    v_mfma_f32_16x16x32_bf16 v[32:35], v[76:79], v[100:103], v[32:35]
    ds_read_b128 v[100:103], v120 offset:7168
    s_waitcnt vmcnt(2) lgkmcnt(5)
    v_mfma_f32_16x16x32_bf16 v[8:11], v[64:67], v[104:107], v[8:11]
    v_mfma_f32_16x16x32_bf16 v[40:43], v[68:71], v[104:107], v[40:43]
    v_mfma_f32_16x16x32_bf16 v[4:7], v[72:75], v[104:107], v[4:7]
    v_mfma_f32_16x16x32_bf16 v[36:39], v[76:79], v[104:107], v[36:39]
    v_mfma_f32_16x16x32_bf16 v[0:3], v[80:83], v[104:107], v[0:3]
    v_mfma_f32_16x16x32_bf16 v[32:35], v[84:87], v[104:107], v[32:35]
    ds_read_b128 v[104:107], v122 offset:0
    v_add_u32 v122, v123, v122
    s_waitcnt vmcnt(0) lgkmcnt(5)
    v_mfma_f32_16x16x32_bf16 v[12:15], v[64:67], v[108:111], v[12:15]
    v_mfma_f32_16x16x32_bf16 v[44:47], v[68:71], v[108:111], v[44:47]
    v_mfma_f32_16x16x32_bf16 v[8:11], v[72:75], v[108:111], v[8:11]
    v_mfma_f32_16x16x32_bf16 v[40:43], v[76:79], v[108:111], v[40:43]
    v_mfma_f32_16x16x32_bf16 v[4:7], v[80:83], v[108:111], v[4:7]
    v_mfma_f32_16x16x32_bf16 v[36:39], v[84:87], v[108:111], v[36:39]
    v_mfma_f32_16x16x32_bf16 v[0:3], v[88:91], v[108:111], v[0:3]
    v_mfma_f32_16x16x32_bf16 v[32:35], v[92:95], v[108:111], v[32:35]
    ds_read_b128 v[108:111], v121 offset:1024
    s_waitcnt lgkmcnt(5)
    v_mfma_f32_16x16x32_bf16 v[16:19], v[64:67], v[112:115], v[16:19]
    v_mfma_f32_16x16x32_bf16 v[48:51], v[68:71], v[112:115], v[48:51]
    v_mfma_f32_16x16x32_bf16 v[12:15], v[72:75], v[112:115], v[12:15]
    v_mfma_f32_16x16x32_bf16 v[44:47], v[76:79], v[112:115], v[44:47]
    v_mfma_f32_16x16x32_bf16 v[8:11], v[80:83], v[112:115], v[8:11]
    v_mfma_f32_16x16x32_bf16 v[40:43], v[84:87], v[112:115], v[40:43]
    v_mfma_f32_16x16x32_bf16 v[4:7], v[88:91], v[112:115], v[4:7]
    v_mfma_f32_16x16x32_bf16 v[36:39], v[92:95], v[112:115], v[36:39]
    ds_read_b128 v[112:115], v121 offset:2048
    s_waitcnt lgkmcnt(5)
    v_mfma_f32_16x16x32_bf16 v[20:23], v[64:67], v[116:119], v[20:23]
    v_mfma_f32_16x16x32_bf16 v[52:55], v[68:71], v[116:119], v[52:55]
    v_mfma_f32_16x16x32_bf16 v[16:19], v[72:75], v[116:119], v[16:19]
    v_mfma_f32_16x16x32_bf16 v[48:51], v[76:79], v[116:119], v[48:51]
    v_mfma_f32_16x16x32_bf16 v[12:15], v[80:83], v[116:119], v[12:15]
    v_mfma_f32_16x16x32_bf16 v[44:47], v[84:87], v[116:119], v[44:47]
    v_mfma_f32_16x16x32_bf16 v[8:11], v[88:91], v[116:119], v[8:11]
    v_mfma_f32_16x16x32_bf16 v[40:43], v[92:95], v[116:119], v[40:43]
    s_waitcnt lgkmcnt(4)
    v_mfma_f32_16x16x32_bf16 v[24:27], v[64:67], v[96:99], v[24:27]
    v_mfma_f32_16x16x32_bf16 v[56:59], v[68:71], v[96:99], v[56:59]
    v_mfma_f32_16x16x32_bf16 v[20:23], v[72:75], v[96:99], v[20:23]
    v_mfma_f32_16x16x32_bf16 v[52:55], v[76:79], v[96:99], v[52:55]
    v_mfma_f32_16x16x32_bf16 v[16:19], v[80:83], v[96:99], v[16:19]
    v_mfma_f32_16x16x32_bf16 v[48:51], v[84:87], v[96:99], v[48:51]
    v_mfma_f32_16x16x32_bf16 v[12:15], v[88:91], v[96:99], v[12:15]
    v_mfma_f32_16x16x32_bf16 v[44:47], v[92:95], v[96:99], v[44:47]
    s_waitcnt lgkmcnt(3)
    v_mfma_f32_16x16x32_bf16 v[28:31], v[64:67], v[100:103], v[28:31]
    v_mfma_f32_16x16x32_bf16 v[60:63], v[68:71], v[100:103], v[60:63]
    v_mfma_f32_16x16x32_bf16 v[24:27], v[72:75], v[100:103], v[24:27]
    v_mfma_f32_16x16x32_bf16 v[56:59], v[76:79], v[100:103], v[56:59]
    v_mfma_f32_16x16x32_bf16 v[20:23], v[80:83], v[100:103], v[20:23]
    v_mfma_f32_16x16x32_bf16 v[52:55], v[84:87], v[100:103], v[52:55]
    v_mfma_f32_16x16x32_bf16 v[16:19], v[88:91], v[100:103], v[16:19]
    v_mfma_f32_16x16x32_bf16 v[48:51], v[92:95], v[100:103], v[48:51]
    buffer_load_dwordx4 v[64:67], v125, s[12:15], s23 offen offset:0
    buffer_load_dwordx4 v[68:71], v125, s[12:15], s23 offen offset:1024
    s_waitcnt lgkmcnt(2)
    v_mfma_f32_16x16x32_bf16 v[28:31], v[72:75], v[104:107], v[28:31]
    v_mfma_f32_16x16x32_bf16 v[60:63], v[76:79], v[104:107], v[60:63]
    v_mfma_f32_16x16x32_bf16 v[24:27], v[80:83], v[104:107], v[24:27]
    v_mfma_f32_16x16x32_bf16 v[56:59], v[84:87], v[104:107], v[56:59]
    v_mfma_f32_16x16x32_bf16 v[20:23], v[88:91], v[104:107], v[20:23]
    v_mfma_f32_16x16x32_bf16 v[52:55], v[92:95], v[104:107], v[52:55]
    buffer_load_dwordx4 v[72:75], v125, s[12:15], s23 offen offset:2048
    buffer_load_dwordx4 v[76:79], v125, s[12:15], s23 offen offset:3072
    s_waitcnt lgkmcnt(1)
    v_mfma_f32_16x16x32_bf16 v[28:31], v[80:83], v[108:111], v[28:31]
    v_mfma_f32_16x16x32_bf16 v[60:63], v[84:87], v[108:111], v[60:63]
    v_mfma_f32_16x16x32_bf16 v[24:27], v[88:91], v[108:111], v[24:27]
    v_mfma_f32_16x16x32_bf16 v[56:59], v[92:95], v[108:111], v[56:59]
    buffer_load_dwordx4 v[80:83], v125, s[12:15], s26 offen offset:0
    buffer_load_dwordx4 v[84:87], v125, s[12:15], s26 offen offset:1024
    s_waitcnt lgkmcnt(0)
    v_mfma_f32_16x16x32_bf16 v[28:31], v[88:91], v[112:115], v[28:31]
    v_mfma_f32_16x16x32_bf16 v[60:63], v[92:95], v[112:115], v[60:63]
    buffer_load_dwordx4 v[88:91], v125, s[12:15], s26 offen offset:2048
    buffer_load_dwordx4 v[92:95], v125, s[12:15], s26 offen offset:3072
    s_add_u32 s23, s23, 57344
    s_add_u32 s26, s26, 57344
    s_barrier
    s_sub_u32 s22, s22, 1
    s_cmp_eq_u32 s22, 0
    s_cbranch_scc1 L_conv1_kernel_mlast1
    ds_read_b128 v[96:99], v120 offset:8192
    ds_read_b128 v[100:103], v120 offset:9216
    ds_read_b128 v[104:107], v120 offset:10240
    ds_read_b128 v[108:111], v120 offset:11264
    ds_read_b128 v[112:115], v120 offset:12288
    ds_read_b128 v[116:119], v120 offset:13312
    s_waitcnt vmcnt(6) lgkmcnt(5)
    v_mfma_f32_16x16x32_bf16 v[0:3], v[64:67], v[96:99], v[0:3]
    v_mfma_f32_16x16x32_bf16 v[32:35], v[68:71], v[96:99], v[32:35]
    ds_read_b128 v[96:99], v120 offset:14336
    s_waitcnt vmcnt(4) lgkmcnt(5)
    v_mfma_f32_16x16x32_bf16 v[4:7], v[64:67], v[100:103], v[4:7]
    v_mfma_f32_16x16x32_bf16 v[36:39], v[68:71], v[100:103], v[36:39]
    v_mfma_f32_16x16x32_bf16 v[0:3], v[72:75], v[100:103], v[0:3]
    v_mfma_f32_16x16x32_bf16 v[32:35], v[76:79], v[100:103], v[32:35]
    ds_read_b128 v[100:103], v120 offset:15360
    s_waitcnt vmcnt(2) lgkmcnt(5)
    v_mfma_f32_16x16x32_bf16 v[8:11], v[64:67], v[104:107], v[8:11]
    v_mfma_f32_16x16x32_bf16 v[40:43], v[68:71], v[104:107], v[40:43]
    v_mfma_f32_16x16x32_bf16 v[4:7], v[72:75], v[104:107], v[4:7]
    v_mfma_f32_16x16x32_bf16 v[36:39], v[76:79], v[104:107], v[36:39]
    v_mfma_f32_16x16x32_bf16 v[0:3], v[80:83], v[104:107], v[0:3]
    v_mfma_f32_16x16x32_bf16 v[32:35], v[84:87], v[104:107], v[32:35]
    ds_read_b128 v[104:107], v122 offset:0
    v_add_u32 v122, v124, v122
    s_waitcnt vmcnt(0) lgkmcnt(5)
    v_mfma_f32_16x16x32_bf16 v[12:15], v[64:67], v[108:111], v[12:15]
    v_mfma_f32_16x16x32_bf16 v[44:47], v[68:71], v[108:111], v[44:47]
    v_mfma_f32_16x16x32_bf16 v[8:11], v[72:75], v[108:111], v[8:11]
    v_mfma_f32_16x16x32_bf16 v[40:43], v[76:79], v[108:111], v[40:43]
    v_mfma_f32_16x16x32_bf16 v[4:7], v[80:83], v[108:111], v[4:7]
    v_mfma_f32_16x16x32_bf16 v[36:39], v[84:87], v[108:111], v[36:39]
    v_mfma_f32_16x16x32_bf16 v[0:3], v[88:91], v[108:111], v[0:3]
    v_mfma_f32_16x16x32_bf16 v[32:35], v[92:95], v[108:111], v[32:35]
    ds_read_b128 v[108:111], v121 offset:9216
    s_waitcnt lgkmcnt(5)
    v_mfma_f32_16x16x32_bf16 v[16:19], v[64:67], v[112:115], v[16:19]
    v_mfma_f32_16x16x32_bf16 v[48:51], v[68:71], v[112:115], v[48:51]
    v_mfma_f32_16x16x32_bf16 v[12:15], v[72:75], v[112:115], v[12:15]
    v_mfma_f32_16x16x32_bf16 v[44:47], v[76:79], v[112:115], v[44:47]
    v_mfma_f32_16x16x32_bf16 v[8:11], v[80:83], v[112:115], v[8:11]
    v_mfma_f32_16x16x32_bf16 v[40:43], v[84:87], v[112:115], v[40:43]
    v_mfma_f32_16x16x32_bf16 v[4:7], v[88:91], v[112:115], v[4:7]
    v_mfma_f32_16x16x32_bf16 v[36:39], v[92:95], v[112:115], v[36:39]
    ds_read_b128 v[112:115], v121 offset:10240
    s_waitcnt lgkmcnt(5)
    v_mfma_f32_16x16x32_bf16 v[20:23], v[64:67], v[116:119], v[20:23]
    v_mfma_f32_16x16x32_bf16 v[52:55], v[68:71], v[116:119], v[52:55]
    v_mfma_f32_16x16x32_bf16 v[16:19], v[72:75], v[116:119], v[16:19]
    v_mfma_f32_16x16x32_bf16 v[48:51], v[76:79], v[116:119], v[48:51]
    v_mfma_f32_16x16x32_bf16 v[12:15], v[80:83], v[116:119], v[12:15]
    v_mfma_f32_16x16x32_bf16 v[44:47], v[84:87], v[116:119], v[44:47]
    v_mfma_f32_16x16x32_bf16 v[8:11], v[88:91], v[116:119], v[8:11]
    v_mfma_f32_16x16x32_bf16 v[40:43], v[92:95], v[116:119], v[40:43]
    s_waitcnt lgkmcnt(4)
    v_mfma_f32_16x16x32_bf16 v[24:27], v[64:67], v[96:99], v[24:27]
    v_mfma_f32_16x16x32_bf16 v[56:59], v[68:71], v[96:99], v[56:59]
    v_mfma_f32_16x16x32_bf16 v[20:23], v[72:75], v[96:99], v[20:23]
    v_mfma_f32_16x16x32_bf16 v[52:55], v[76:79], v[96:99], v[52:55]
    v_mfma_f32_16x16x32_bf16 v[16:19], v[80:83], v[96:99], v[16:19]
    v_mfma_f32_16x16x32_bf16 v[48:51], v[84:87], v[96:99], v[48:51]
    v_mfma_f32_16x16x32_bf16 v[12:15], v[88:91], v[96:99], v[12:15]
    v_mfma_f32_16x16x32_bf16 v[44:47], v[92:95], v[96:99], v[44:47]
    s_waitcnt lgkmcnt(3)
    v_mfma_f32_16x16x32_bf16 v[28:31], v[64:67], v[100:103], v[28:31]
    v_mfma_f32_16x16x32_bf16 v[60:63], v[68:71], v[100:103], v[60:63]
    v_mfma_f32_16x16x32_bf16 v[24:27], v[72:75], v[100:103], v[24:27]
    v_mfma_f32_16x16x32_bf16 v[56:59], v[76:79], v[100:103], v[56:59]
    v_mfma_f32_16x16x32_bf16 v[20:23], v[80:83], v[100:103], v[20:23]
    v_mfma_f32_16x16x32_bf16 v[52:55], v[84:87], v[100:103], v[52:55]
    v_mfma_f32_16x16x32_bf16 v[16:19], v[88:91], v[100:103], v[16:19]
    v_mfma_f32_16x16x32_bf16 v[48:51], v[92:95], v[100:103], v[48:51]
    buffer_load_dwordx4 v[64:67], v125, s[12:15], s23 offen offset:0
    buffer_load_dwordx4 v[68:71], v125, s[12:15], s23 offen offset:1024
    s_waitcnt lgkmcnt(2)
    v_mfma_f32_16x16x32_bf16 v[28:31], v[72:75], v[104:107], v[28:31]
    v_mfma_f32_16x16x32_bf16 v[60:63], v[76:79], v[104:107], v[60:63]
    v_mfma_f32_16x16x32_bf16 v[24:27], v[80:83], v[104:107], v[24:27]
    v_mfma_f32_16x16x32_bf16 v[56:59], v[84:87], v[104:107], v[56:59]
    v_mfma_f32_16x16x32_bf16 v[20:23], v[88:91], v[104:107], v[20:23]
    v_mfma_f32_16x16x32_bf16 v[52:55], v[92:95], v[104:107], v[52:55]
    buffer_load_dwordx4 v[72:75], v125, s[12:15], s23 offen offset:2048
    buffer_load_dwordx4 v[76:79], v125, s[12:15], s23 offen offset:3072
    s_waitcnt lgkmcnt(1)
    v_mfma_f32_16x16x32_bf16 v[28:31], v[80:83], v[108:111], v[28:31]
    v_mfma_f32_16x16x32_bf16 v[60:63], v[84:87], v[108:111], v[60:63]
    v_mfma_f32_16x16x32_bf16 v[24:27], v[88:91], v[108:111], v[24:27]
    v_mfma_f32_16x16x32_bf16 v[56:59], v[92:95], v[108:111], v[56:59]
    buffer_load_dwordx4 v[80:83], v125, s[12:15], s26 offen offset:0
    buffer_load_dwordx4 v[84:87], v125, s[12:15], s26 offen offset:1024
    s_waitcnt lgkmcnt(0)
    v_mfma_f32_16x16x32_bf16 v[28:31], v[88:91], v[112:115], v[28:31]
    v_mfma_f32_16x16x32_bf16 v[60:63], v[92:95], v[112:115], v[60:63]
    buffer_load_dwordx4 v[88:91], v125, s[12:15], s26 offen offset:2048
    buffer_load_dwordx4 v[92:95], v125, s[12:15], s26 offen offset:3072
    s_add_u32 s23, s23, 57344
    s_add_u32 s26, s26, 57344
    s_barrier
    s_branch L_conv1_kernel_mloop1
L_conv1_kernel_mlast1:
    v_and_b32 v125, 15, v127
    v_and_b32 v126, 7, v127
    v_lshlrev_b32 v126, 4, v126
    v_lshl_add_u32 v125, v125, 7, v126
    v_lshrrev_b32 v126, 4, v127
    v_lshl_add_u32 v125, v126, 11, v125
    s_lshl_b32 s36, s20, 14
    s_add_u32 s37, s36, 8192
    v_add_u32 v126, s37, v125
    v_add_u32 v125, s36, v125
    ds_read_b128 v[96:99], v120 offset:8192
    ds_read_b128 v[100:103], v120 offset:9216
    ds_read_b128 v[104:107], v120 offset:10240
    ds_read_b128 v[108:111], v120 offset:11264
    ds_read_b128 v[112:115], v120 offset:12288
    ds_read_b128 v[116:119], v120 offset:13312
    s_waitcnt vmcnt(6) lgkmcnt(5)
    v_mfma_f32_16x16x32_bf16 v[0:3], v[64:67], v[96:99], v[0:3]
    v_mfma_f32_16x16x32_bf16 v[32:35], v[68:71], v[96:99], v[32:35]
    ds_read_b128 v[96:99], v120 offset:14336
    s_waitcnt vmcnt(4) lgkmcnt(5)
    v_mfma_f32_16x16x32_bf16 v[4:7], v[64:67], v[100:103], v[4:7]
    v_mfma_f32_16x16x32_bf16 v[36:39], v[68:71], v[100:103], v[36:39]
    v_mfma_f32_16x16x32_bf16 v[0:3], v[72:75], v[100:103], v[0:3]
    v_mfma_f32_16x16x32_bf16 v[32:35], v[76:79], v[100:103], v[32:35]
    ds_read_b128 v[100:103], v120 offset:15360
    s_waitcnt vmcnt(2) lgkmcnt(5)
    v_mfma_f32_16x16x32_bf16 v[8:11], v[64:67], v[104:107], v[8:11]
    v_mfma_f32_16x16x32_bf16 v[40:43], v[68:71], v[104:107], v[40:43]
    v_mfma_f32_16x16x32_bf16 v[4:7], v[72:75], v[104:107], v[4:7]
    v_mfma_f32_16x16x32_bf16 v[36:39], v[76:79], v[104:107], v[36:39]
    v_mfma_f32_16x16x32_bf16 v[0:3], v[80:83], v[104:107], v[0:3]
    v_mfma_f32_16x16x32_bf16 v[32:35], v[84:87], v[104:107], v[32:35]
    ds_read_b128 v[104:107], v122 offset:0
    s_waitcnt vmcnt(0) lgkmcnt(5)
    v_mfma_f32_16x16x32_bf16 v[12:15], v[64:67], v[108:111], v[12:15]
    v_mfma_f32_16x16x32_bf16 v[44:47], v[68:71], v[108:111], v[44:47]
    v_mfma_f32_16x16x32_bf16 v[8:11], v[72:75], v[108:111], v[8:11]
    v_mfma_f32_16x16x32_bf16 v[40:43], v[76:79], v[108:111], v[40:43]
    v_mfma_f32_16x16x32_bf16 v[4:7], v[80:83], v[108:111], v[4:7]
    v_mfma_f32_16x16x32_bf16 v[36:39], v[84:87], v[108:111], v[36:39]
    v_mfma_f32_16x16x32_bf16 v[0:3], v[88:91], v[108:111], v[0:3]
    v_mfma_f32_16x16x32_bf16 v[32:35], v[92:95], v[108:111], v[32:35]
    ds_read_b128 v[108:111], v121 offset:9216
    s_waitcnt lgkmcnt(5)
    v_mfma_f32_16x16x32_bf16 v[16:19], v[64:67], v[112:115], v[16:19]
    v_mfma_f32_16x16x32_bf16 v[48:51], v[68:71], v[112:115], v[48:51]
    v_mfma_f32_16x16x32_bf16 v[12:15], v[72:75], v[112:115], v[12:15]
    v_mfma_f32_16x16x32_bf16 v[44:47], v[76:79], v[112:115], v[44:47]
    v_mfma_f32_16x16x32_bf16 v[8:11], v[80:83], v[112:115], v[8:11]
    v_mfma_f32_16x16x32_bf16 v[40:43], v[84:87], v[112:115], v[40:43]
    v_mfma_f32_16x16x32_bf16 v[4:7], v[88:91], v[112:115], v[4:7]
    v_mfma_f32_16x16x32_bf16 v[36:39], v[92:95], v[112:115], v[36:39]
    ds_read_b128 v[112:115], v121 offset:10240
    v_xor_b32 v123, 0, v125
    ds_write_b128 v123, v[0:3]
    s_waitcnt lgkmcnt(6)
    v_mfma_f32_16x16x32_bf16 v[20:23], v[64:67], v[116:119], v[20:23]
    v_mfma_f32_16x16x32_bf16 v[52:55], v[68:71], v[116:119], v[52:55]
    v_mfma_f32_16x16x32_bf16 v[16:19], v[72:75], v[116:119], v[16:19]
    v_mfma_f32_16x16x32_bf16 v[48:51], v[76:79], v[116:119], v[48:51]
    v_mfma_f32_16x16x32_bf16 v[12:15], v[80:83], v[116:119], v[12:15]
    v_mfma_f32_16x16x32_bf16 v[44:47], v[84:87], v[116:119], v[44:47]
    v_mfma_f32_16x16x32_bf16 v[8:11], v[88:91], v[116:119], v[8:11]
    v_mfma_f32_16x16x32_bf16 v[40:43], v[92:95], v[116:119], v[40:43]
    v_xor_b32 v124, 16, v125
    ds_write_b128 v124, v[4:7]
    s_waitcnt lgkmcnt(2)
    v_mfma_f32_16x16x32_bf16 v[24:27], v[64:67], v[96:99], v[24:27]
    v_mfma_f32_16x16x32_bf16 v[56:59], v[68:71], v[96:99], v[56:59]
    v_mfma_f32_16x16x32_bf16 v[20:23], v[72:75], v[96:99], v[20:23]
    v_mfma_f32_16x16x32_bf16 v[52:55], v[76:79], v[96:99], v[52:55]
    v_mfma_f32_16x16x32_bf16 v[16:19], v[80:83], v[96:99], v[16:19]
    v_mfma_f32_16x16x32_bf16 v[48:51], v[84:87], v[96:99], v[48:51]
    v_mfma_f32_16x16x32_bf16 v[12:15], v[88:91], v[96:99], v[12:15]
    v_mfma_f32_16x16x32_bf16 v[44:47], v[92:95], v[96:99], v[44:47]
    v_xor_b32 v123, 32, v125
    ds_write_b128 v123, v[8:11]
    v_xor_b32 v124, 0, v126
    ds_write_b128 v124, v[32:35]
    v_mfma_f32_16x16x32_bf16 v[28:31], v[64:67], v[100:103], v[28:31]
    v_mfma_f32_16x16x32_bf16 v[60:63], v[68:71], v[100:103], v[60:63]
    v_mfma_f32_16x16x32_bf16 v[24:27], v[72:75], v[100:103], v[24:27]
    v_mfma_f32_16x16x32_bf16 v[56:59], v[76:79], v[100:103], v[56:59]
    v_mfma_f32_16x16x32_bf16 v[20:23], v[80:83], v[100:103], v[20:23]
    v_mfma_f32_16x16x32_bf16 v[52:55], v[84:87], v[100:103], v[52:55]
    v_mfma_f32_16x16x32_bf16 v[16:19], v[88:91], v[100:103], v[16:19]
    v_mfma_f32_16x16x32_bf16 v[48:51], v[92:95], v[100:103], v[48:51]
    v_xor_b32 v123, 16, v126
    ds_write_b128 v123, v[36:39]
    v_xor_b32 v124, 32, v126
    ds_write_b128 v124, v[40:43]
    v_mfma_f32_16x16x32_bf16 v[28:31], v[72:75], v[104:107], v[28:31]
    v_mfma_f32_16x16x32_bf16 v[60:63], v[76:79], v[104:107], v[60:63]
    v_mfma_f32_16x16x32_bf16 v[24:27], v[80:83], v[104:107], v[24:27]
    v_mfma_f32_16x16x32_bf16 v[56:59], v[84:87], v[104:107], v[56:59]
    v_mfma_f32_16x16x32_bf16 v[20:23], v[88:91], v[104:107], v[20:23]
    v_mfma_f32_16x16x32_bf16 v[52:55], v[92:95], v[104:107], v[52:55]
    v_xor_b32 v124, 48, v125
    ds_write_b128 v124, v[12:15]
    v_xor_b32 v123, 48, v126
    ds_write_b128 v123, v[44:47]
    v_mfma_f32_16x16x32_bf16 v[28:31], v[80:83], v[108:111], v[28:31]
    v_mfma_f32_16x16x32_bf16 v[60:63], v[84:87], v[108:111], v[60:63]
    v_mfma_f32_16x16x32_bf16 v[24:27], v[88:91], v[108:111], v[24:27]
    v_mfma_f32_16x16x32_bf16 v[56:59], v[92:95], v[108:111], v[56:59]
    v_xor_b32 v123, 64, v125
    ds_write_b128 v123, v[16:19]
    v_xor_b32 v124, 64, v126
    ds_write_b128 v124, v[48:51]
    v_mfma_f32_16x16x32_bf16 v[28:31], v[88:91], v[112:115], v[28:31]
    v_mfma_f32_16x16x32_bf16 v[60:63], v[92:95], v[112:115], v[60:63]
    v_xor_b32 v124, 80, v125
    ds_write_b128 v124, v[20:23]
    v_xor_b32 v123, 80, v126
    ds_write_b128 v123, v[52:55]
    v_and_b32 v108, 15, v127
    v_lshrrev_b32 v109, 4, v127
    v_lshrrev_b32 v110, 3, v108
    s_lshl_b32 s36, s20, 1
    v_add_u32 v110, s36, v110
    v_xor_b32 v111, v110, v108
    v_and_b32 v111, 7, v111
    v_lshlrev_b32 v111, 4, v111
    v_xor_b32 v123, 96, v125
    ds_write_b128 v123, v[24:27]
    v_lshl_add_u32 v111, v110, 7, v111
    v_lshl_add_u32 v120, v109, 11, v111
    v_add_u32 v121, 65536, v120
    v_add_u32 v64, 131072, v120
    s_lshl_b32 s36, s20, 9
    s_add_u32 s36, s36, 115712
    v_lshl_add_u32 v127, v109, 7, s36
    s_lshl_b32 s36, s20, 4
    v_add_u32 v108, s36, v108
    v_lshlrev_b32 v110, 6, v108
    v_lshl_add_u32 v110, v109, 4, v110
    s_mul_i32 s36, s29, 524288
    v_xor_b32 v124, 96, v126
    ds_write_b128 v124, v[56:59]
    s_lshl_b32 s37, s21, 4
    s_add_u32 s36, s36, s37
    v_add_u32 v110, s36, v110
    v_mov_b32 v111, 2130706432
    v_cmp_gt_u32 vcc, 125, v108
    s_mov_b32 s4, 0xbeaaaaab
    s_mov_b32 s5, s4
    s_mov_b32 s6, 0x3e800000
    s_mov_b32 s7, s6
    s_mov_b32 s8, 0xc0a00000
    s_mov_b32 s9, s8
    s_mov_b32 s10, 0xc0638e39
    v_xor_b32 v124, 112, v125
    ds_write_b128 v124, v[28:31]
    s_mov_b32 s11, s10
    s_mov_b32 s12, 0xbf638e39
    s_mov_b32 s13, s12
    s_mov_b32 s14, 0xbe638e39
    s_mov_b32 s15, s14
    s_mov_b32 s22, 0xbd638e39
    s_mov_b32 s23, s22
    s_mov_b32 s24, 0x3ff1c71c
    s_mov_b32 s25, s24
    s_mov_b32 s26, 0xbf2aaaab
    s_mov_b32 s27, s26
    s_mov_b32 s32, 0x3ecccccd
    v_xor_b32 v123, 112, v126
    s_waitcnt lgkmcnt(8)
    ds_write_b128 v123, v[60:63]
    s_mov_b32 s33, s32
    s_mov_b32 s34, 0xbd888889
    s_mov_b32 s35, s34
    s_mov_b32 s38, 0xbe4ccccd
    s_mov_b32 s39, s38
    s_mov_b32 s40, 0xbdd2d3e8
    s_mov_b32 s41, s40
    s_mov_b32 s42, 0x3f800000
    s_mov_b32 s43, s42
    s_setprio 0
    s_branch L_conv1_kernel_epi
L_conv1_kernel_m2:
    s_mul_i32 s37, s38, 2176
    s_add_u32 s37, s37, 98304
    v_add_u32 v116, s37, v8
    v_add_u32 v118, s37, v9
    v_add_u32 v117, 104832, v8
    s_cmp_eq_u32 s38, 0
    s_cbranch_scc1 L_conv1_kernel_hh0
    v_add_u32 v117, 98304, v9
L_conv1_kernel_hh0:
    s_lshl_b32 s37, s38, 12
    s_add_u32 s37, s37, s43
    s_add_u32 s37, s37, 49152
    v_lshl_add_u32 v119, v127, 4, s37
    v_mov_b32 v0, 0
    v_mov_b32 v1, 0
    v_mov_b32 v2, 0
    v_mov_b32 v3, 0
    v_mov_b32 v4, 0
    v_mov_b32 v5, 0
    v_mov_b32 v6, 0
    v_mov_b32 v7, 0
    v_mov_b32 v8, 0
    v_mov_b32 v9, 0
    v_mov_b32 v10, 0
    v_mov_b32 v11, 0
    v_mov_b32 v12, 0
    v_mov_b32 v13, 0
    v_mov_b32 v14, 0
    v_mov_b32 v15, 0
    v_mov_b32 v16, 0
    v_mov_b32 v17, 0
    v_mov_b32 v18, 0
    v_mov_b32 v19, 0
    v_mov_b32 v20, 0
    v_mov_b32 v21, 0
    v_mov_b32 v22, 0
    v_mov_b32 v23, 0
    v_mov_b32 v24, 0
    v_mov_b32 v25, 0
    v_mov_b32 v26, 0
    v_mov_b32 v27, 0
    v_mov_b32 v28, 0
    v_mov_b32 v29, 0
    v_mov_b32 v30, 0
    v_mov_b32 v31, 0
    v_mov_b32 v32, 0
    v_mov_b32 v33, 0
    v_mov_b32 v34, 0
    v_mov_b32 v35, 0
    v_mov_b32 v36, 0
    v_mov_b32 v37, 0
    v_mov_b32 v38, 0
    v_mov_b32 v39, 0
    v_mov_b32 v40, 0
    v_mov_b32 v41, 0
    v_mov_b32 v42, 0
    v_mov_b32 v43, 0
    v_mov_b32 v44, 0
    v_mov_b32 v45, 0
    v_mov_b32 v46, 0
    v_mov_b32 v47, 0
    v_mov_b32 v48, 0
    v_mov_b32 v49, 0
    v_mov_b32 v50, 0
    v_mov_b32 v51, 0
    v_mov_b32 v52, 0
    v_mov_b32 v53, 0
    v_mov_b32 v54, 0
    v_mov_b32 v55, 0
    v_mov_b32 v56, 0
    v_mov_b32 v57, 0
    v_mov_b32 v58, 0
    v_mov_b32 v59, 0
    v_mov_b32 v60, 0
    v_mov_b32 v61, 0
    v_mov_b32 v62, 0
    v_mov_b32 v63, 0
    buffer_load_dwordx4 v[96:99], v108, s[8:11], 0 offen
    buffer_load_dwordx4 v[100:103], v109, s[8:11], 0 offen
    buffer_load_dwordx4 v[104:107], v110, s[8:11], 0 offen
    s_mov_b32 s23, 0
    s_mov_b32 s26, 4096
    buffer_load_dwordx4 v[64:67], v125, s[12:15], s23 offen offset:0
    buffer_load_dwordx4 v[68:71], v125, s[12:15], s23 offen offset:2048
    buffer_load_dwordx4 v[80:83], v119, s[12:15], s23 offen offset:0
    buffer_load_dwordx4 v[72:75], v125, s[12:15], s26 offen offset:0
    buffer_load_dwordx4 v[84:87], v119, s[12:15], s23 offen offset:2048
    buffer_load_dwordx4 v[76:79], v125, s[12:15], s26 offen offset:2048
    s_mov_b32 s23, 57344
    s_mov_b32 s26, 61440
    s_waitcnt vmcnt(6)
    v_lshlrev_b32 v108, 16, v96
    v_and_b32 v111, s25, v96
    v_lshlrev_b32 v109, 16, v100
    v_and_b32 v112, s25, v100
    v_lshlrev_b32 v110, 16, v104
    v_and_b32 v113, s25, v104
    v_mul_f32 v114, s44, v108
    v_mul_f32 v115, s44, v111
    v_fmac_f32 v114, s45, v109
    v_fmac_f32 v115, s45, v112
    v_fmac_f32 v114, s46, v110
    v_fmac_f32 v115, s46, v113
    v_cvt_pk_bf16_f32 v96, v114, v115
    v_lshlrev_b32 v108, 16, v97
    v_and_b32 v111, s25, v97
    v_lshlrev_b32 v109, 16, v101
    v_and_b32 v112, s25, v101
    v_lshlrev_b32 v110, 16, v105
    v_and_b32 v113, s25, v105
    v_mul_f32 v114, s44, v108
    v_mul_f32 v115, s44, v111
    v_fmac_f32 v114, s45, v109
    v_fmac_f32 v115, s45, v112
    v_fmac_f32 v114, s46, v110
    v_fmac_f32 v115, s46, v113
    v_cvt_pk_bf16_f32 v97, v114, v115
    v_lshlrev_b32 v108, 16, v98
    v_and_b32 v111, s25, v98
    v_lshlrev_b32 v109, 16, v102
    v_and_b32 v112, s25, v102
    v_lshlrev_b32 v110, 16, v106
    v_and_b32 v113, s25, v106
    v_mul_f32 v114, s44, v108
    v_mul_f32 v115, s44, v111
    v_fmac_f32 v114, s45, v109
    v_fmac_f32 v115, s45, v112
    v_fmac_f32 v114, s46, v110
    v_fmac_f32 v115, s46, v113
    v_cvt_pk_bf16_f32 v98, v114, v115
    v_lshlrev_b32 v108, 16, v99
    v_and_b32 v111, s25, v99
    v_lshlrev_b32 v109, 16, v103
    v_and_b32 v112, s25, v103
    v_lshlrev_b32 v110, 16, v107
    v_and_b32 v113, s25, v107
    v_mul_f32 v114, s44, v108
    v_mul_f32 v115, s44, v111
    v_fmac_f32 v114, s45, v109
    v_fmac_f32 v115, s45, v112
    v_fmac_f32 v114, s46, v110
    v_fmac_f32 v115, s46, v113
    v_cvt_pk_bf16_f32 v99, v114, v115
    ds_write_b128 v126, v[96:99]
    v_and_b32 v111, 15, v127
    v_lshlrev_b32 v111, 2, v111
    v_add_u32 v111, 99328, v111
    ds_write_b32 v111, v0
    ds_write_b32 v111, v0 offset:8704
    s_waitcnt lgkmcnt(0)
    s_barrier
    s_mov_b32 s22, 8
    s_setprio 2
L_conv1_kernel_mloop2:
    ds_read_b128 v[88:91], v120 offset:0
    ds_read_b128 v[92:95], v120 offset:1024
    ds_read_b128 v[96:99], v116 offset:0
    ds_read_b128 v[100:103], v120 offset:2048
    ds_read_b128 v[104:107], v116 offset:1088
    ds_read_b128 v[108:111], v120 offset:3072
    ds_read_b128 v[112:115], v116 offset:2176
    s_waitcnt vmcnt(5) lgkmcnt(6)
    v_mfma_f32_16x16x32_bf16 v[0:3], v[64:67], v[88:91], v[0:3]
    ds_read_b128 v[88:91], v120 offset:4096
    s_waitcnt vmcnt(4) lgkmcnt(6)
    v_mfma_f32_16x16x32_bf16 v[4:7], v[64:67], v[92:95], v[4:7]
    v_mfma_f32_16x16x32_bf16 v[0:3], v[68:71], v[92:95], v[0:3]
    ds_read_b128 v[92:95], v116 offset:3264
    s_waitcnt vmcnt(3) lgkmcnt(6)
    v_mfma_f32_16x16x32_bf16 v[32:35], v[80:83], v[96:99], v[32:35]
    ds_read_b128 v[96:99], v120 offset:5120
    s_waitcnt vmcnt(2) lgkmcnt(6)
    v_mfma_f32_16x16x32_bf16 v[8:11], v[64:67], v[100:103], v[8:11]
    v_mfma_f32_16x16x32_bf16 v[4:7], v[68:71], v[100:103], v[4:7]
    v_mfma_f32_16x16x32_bf16 v[0:3], v[72:75], v[100:103], v[0:3]
    ds_read_b128 v[100:103], v116 offset:4352
    s_waitcnt vmcnt(1) lgkmcnt(6)
    v_mfma_f32_16x16x32_bf16 v[36:39], v[80:83], v[104:107], v[36:39]
    v_mfma_f32_16x16x32_bf16 v[32:35], v[84:87], v[104:107], v[32:35]
    ds_read_b128 v[104:107], v120 offset:6144
    s_waitcnt vmcnt(0) lgkmcnt(6)
    v_mfma_f32_16x16x32_bf16 v[12:15], v[64:67], v[108:111], v[12:15]
    v_mfma_f32_16x16x32_bf16 v[8:11], v[68:71], v[108:111], v[8:11]
    v_mfma_f32_16x16x32_bf16 v[4:7], v[72:75], v[108:111], v[4:7]
    v_mfma_f32_16x16x32_bf16 v[0:3], v[76:79], v[108:111], v[0:3]
    ds_read_b128 v[108:111], v116 offset:5440
    s_waitcnt lgkmcnt(6)
    v_mfma_f32_16x16x32_bf16 v[40:43], v[80:83], v[112:115], v[40:43]
    v_mfma_f32_16x16x32_bf16 v[36:39], v[84:87], v[112:115], v[36:39]
    ds_read_b128 v[112:115], v120 offset:7168
    s_waitcnt lgkmcnt(6)
    v_mfma_f32_16x16x32_bf16 v[16:19], v[64:67], v[88:91], v[16:19]
    v_mfma_f32_16x16x32_bf16 v[12:15], v[68:71], v[88:91], v[12:15]
    v_mfma_f32_16x16x32_bf16 v[8:11], v[72:75], v[88:91], v[8:11]
    v_mfma_f32_16x16x32_bf16 v[4:7], v[76:79], v[88:91], v[4:7]
    ds_read_b128 v[88:91], v117 offset:0
    s_waitcnt lgkmcnt(6)
    v_mfma_f32_16x16x32_bf16 v[44:47], v[80:83], v[92:95], v[44:47]
    v_mfma_f32_16x16x32_bf16 v[40:43], v[84:87], v[92:95], v[40:43]
    ds_read_b128 v[92:95], v122 offset:0
    v_add_u32 v122, v123, v122
    s_waitcnt lgkmcnt(6)
    v_mfma_f32_16x16x32_bf16 v[20:23], v[64:67], v[96:99], v[20:23]
    v_mfma_f32_16x16x32_bf16 v[16:19], v[68:71], v[96:99], v[16:19]
    v_mfma_f32_16x16x32_bf16 v[12:15], v[72:75], v[96:99], v[12:15]
    v_mfma_f32_16x16x32_bf16 v[8:11], v[76:79], v[96:99], v[8:11]
    ds_read_b128 v[96:99], v117 offset:1088
    s_waitcnt lgkmcnt(6)
    v_mfma_f32_16x16x32_bf16 v[48:51], v[80:83], v[100:103], v[48:51]
    v_mfma_f32_16x16x32_bf16 v[44:47], v[84:87], v[100:103], v[44:47]
    ds_read_b128 v[100:103], v121 offset:1024
    s_waitcnt lgkmcnt(6)
    v_mfma_f32_16x16x32_bf16 v[24:27], v[64:67], v[104:107], v[24:27]
    v_mfma_f32_16x16x32_bf16 v[20:23], v[68:71], v[104:107], v[20:23]
    v_mfma_f32_16x16x32_bf16 v[16:19], v[72:75], v[104:107], v[16:19]
    v_mfma_f32_16x16x32_bf16 v[12:15], v[76:79], v[104:107], v[12:15]
    ds_read_b128 v[104:107], v118 offset:0
    s_waitcnt lgkmcnt(6)
    v_mfma_f32_16x16x32_bf16 v[52:55], v[80:83], v[108:111], v[52:55]
    v_mfma_f32_16x16x32_bf16 v[48:51], v[84:87], v[108:111], v[48:51]
    ds_read_b128 v[108:111], v121 offset:2048
    s_waitcnt lgkmcnt(6)
    v_mfma_f32_16x16x32_bf16 v[28:31], v[64:67], v[112:115], v[28:31]
    v_mfma_f32_16x16x32_bf16 v[24:27], v[68:71], v[112:115], v[24:27]
    v_mfma_f32_16x16x32_bf16 v[20:23], v[72:75], v[112:115], v[20:23]
    v_mfma_f32_16x16x32_bf16 v[16:19], v[76:79], v[112:115], v[16:19]
    buffer_load_dwordx4 v[64:67], v125, s[12:15], s23 offen offset:0
    s_waitcnt lgkmcnt(5)
    v_mfma_f32_16x16x32_bf16 v[56:59], v[80:83], v[88:91], v[56:59]
    v_mfma_f32_16x16x32_bf16 v[52:55], v[84:87], v[88:91], v[52:55]
    s_waitcnt lgkmcnt(0)
    s_barrier
    v_mfma_f32_16x16x32_bf16 v[28:31], v[68:71], v[92:95], v[28:31]
    v_mfma_f32_16x16x32_bf16 v[24:27], v[72:75], v[92:95], v[24:27]
    v_mfma_f32_16x16x32_bf16 v[20:23], v[76:79], v[92:95], v[20:23]
    buffer_load_dwordx4 v[68:71], v125, s[12:15], s23 offen offset:2048
    v_mfma_f32_16x16x32_bf16 v[60:63], v[80:83], v[96:99], v[60:63]
    v_mfma_f32_16x16x32_bf16 v[56:59], v[84:87], v[96:99], v[56:59]
    buffer_load_dwordx4 v[80:83], v119, s[12:15], s23 offen offset:0
    v_mfma_f32_16x16x32_bf16 v[28:31], v[72:75], v[100:103], v[28:31]
    v_mfma_f32_16x16x32_bf16 v[24:27], v[76:79], v[100:103], v[24:27]
    buffer_load_dwordx4 v[72:75], v125, s[12:15], s26 offen offset:0
    v_mfma_f32_16x16x32_bf16 v[60:63], v[84:87], v[104:107], v[60:63]
    buffer_load_dwordx4 v[84:87], v119, s[12:15], s23 offen offset:2048
    v_mfma_f32_16x16x32_bf16 v[28:31], v[76:79], v[108:111], v[28:31]
    buffer_load_dwordx4 v[76:79], v125, s[12:15], s26 offen offset:2048
    s_add_u32 s23, s23, 57344
    s_add_u32 s26, s26, 57344
    s_sub_u32 s22, s22, 1
    s_cmp_eq_u32 s22, 0
    s_cbranch_scc1 L_conv1_kernel_mlast2
    ds_read_b128 v[88:91], v120 offset:8192
    ds_read_b128 v[92:95], v120 offset:9216
    ds_read_b128 v[96:99], v116 offset:8704
    ds_read_b128 v[100:103], v120 offset:10240
    ds_read_b128 v[104:107], v116 offset:9792
    ds_read_b128 v[108:111], v120 offset:11264
    ds_read_b128 v[112:115], v116 offset:10880
    s_waitcnt vmcnt(5) lgkmcnt(6)
    v_mfma_f32_16x16x32_bf16 v[0:3], v[64:67], v[88:91], v[0:3]
    ds_read_b128 v[88:91], v120 offset:12288
    s_waitcnt vmcnt(4) lgkmcnt(6)
    v_mfma_f32_16x16x32_bf16 v[4:7], v[64:67], v[92:95], v[4:7]
    v_mfma_f32_16x16x32_bf16 v[0:3], v[68:71], v[92:95], v[0:3]
    ds_read_b128 v[92:95], v116 offset:11968
    s_waitcnt vmcnt(3) lgkmcnt(6)
    v_mfma_f32_16x16x32_bf16 v[32:35], v[80:83], v[96:99], v[32:35]
    ds_read_b128 v[96:99], v120 offset:13312
    s_waitcnt vmcnt(2) lgkmcnt(6)
    v_mfma_f32_16x16x32_bf16 v[8:11], v[64:67], v[100:103], v[8:11]
    v_mfma_f32_16x16x32_bf16 v[4:7], v[68:71], v[100:103], v[4:7]
    v_mfma_f32_16x16x32_bf16 v[0:3], v[72:75], v[100:103], v[0:3]
    ds_read_b128 v[100:103], v116 offset:13056
    s_waitcnt vmcnt(1) lgkmcnt(6)
    v_mfma_f32_16x16x32_bf16 v[36:39], v[80:83], v[104:107], v[36:39]
    v_mfma_f32_16x16x32_bf16 v[32:35], v[84:87], v[104:107], v[32:35]
    ds_read_b128 v[104:107], v120 offset:14336
    s_waitcnt vmcnt(0) lgkmcnt(6)
    v_mfma_f32_16x16x32_bf16 v[12:15], v[64:67], v[108:111], v[12:15]
    v_mfma_f32_16x16x32_bf16 v[8:11], v[68:71], v[108:111], v[8:11]
    v_mfma_f32_16x16x32_bf16 v[4:7], v[72:75], v[108:111], v[4:7]
    v_mfma_f32_16x16x32_bf16 v[0:3], v[76:79], v[108:111], v[0:3]
    ds_read_b128 v[108:111], v116 offset:14144
    s_waitcnt lgkmcnt(6)
    v_mfma_f32_16x16x32_bf16 v[40:43], v[80:83], v[112:115], v[40:43]
    v_mfma_f32_16x16x32_bf16 v[36:39], v[84:87], v[112:115], v[36:39]
    ds_read_b128 v[112:115], v120 offset:15360
    s_waitcnt lgkmcnt(6)
    v_mfma_f32_16x16x32_bf16 v[16:19], v[64:67], v[88:91], v[16:19]
    v_mfma_f32_16x16x32_bf16 v[12:15], v[68:71], v[88:91], v[12:15]
    v_mfma_f32_16x16x32_bf16 v[8:11], v[72:75], v[88:91], v[8:11]
    v_mfma_f32_16x16x32_bf16 v[4:7], v[76:79], v[88:91], v[4:7]
    ds_read_b128 v[88:91], v117 offset:8704
    s_waitcnt lgkmcnt(6)
    v_mfma_f32_16x16x32_bf16 v[44:47], v[80:83], v[92:95], v[44:47]
    v_mfma_f32_16x16x32_bf16 v[40:43], v[84:87], v[92:95], v[40:43]
    ds_read_b128 v[92:95], v122 offset:0
    v_add_u32 v122, v124, v122
    s_waitcnt lgkmcnt(6)
    v_mfma_f32_16x16x32_bf16 v[20:23], v[64:67], v[96:99], v[20:23]
    v_mfma_f32_16x16x32_bf16 v[16:19], v[68:71], v[96:99], v[16:19]
    v_mfma_f32_16x16x32_bf16 v[12:15], v[72:75], v[96:99], v[12:15]
    v_mfma_f32_16x16x32_bf16 v[8:11], v[76:79], v[96:99], v[8:11]
    ds_read_b128 v[96:99], v117 offset:9792
    s_waitcnt lgkmcnt(6)
    v_mfma_f32_16x16x32_bf16 v[48:51], v[80:83], v[100:103], v[48:51]
    v_mfma_f32_16x16x32_bf16 v[44:47], v[84:87], v[100:103], v[44:47]
    ds_read_b128 v[100:103], v121 offset:9216
    s_waitcnt lgkmcnt(6)
    v_mfma_f32_16x16x32_bf16 v[24:27], v[64:67], v[104:107], v[24:27]
    v_mfma_f32_16x16x32_bf16 v[20:23], v[68:71], v[104:107], v[20:23]
    v_mfma_f32_16x16x32_bf16 v[16:19], v[72:75], v[104:107], v[16:19]
    v_mfma_f32_16x16x32_bf16 v[12:15], v[76:79], v[104:107], v[12:15]
    ds_read_b128 v[104:107], v118 offset:8704
    s_waitcnt lgkmcnt(6)
    v_mfma_f32_16x16x32_bf16 v[52:55], v[80:83], v[108:111], v[52:55]
    v_mfma_f32_16x16x32_bf16 v[48:51], v[84:87], v[108:111], v[48:51]
    ds_read_b128 v[108:111], v121 offset:10240
    s_waitcnt lgkmcnt(6)
    v_mfma_f32_16x16x32_bf16 v[28:31], v[64:67], v[112:115], v[28:31]
    v_mfma_f32_16x16x32_bf16 v[24:27], v[68:71], v[112:115], v[24:27]
    v_mfma_f32_16x16x32_bf16 v[20:23], v[72:75], v[112:115], v[20:23]
    v_mfma_f32_16x16x32_bf16 v[16:19], v[76:79], v[112:115], v[16:19]
    buffer_load_dwordx4 v[64:67], v125, s[12:15], s23 offen offset:0
    s_waitcnt lgkmcnt(5)
    v_mfma_f32_16x16x32_bf16 v[56:59], v[80:83], v[88:91], v[56:59]
    v_mfma_f32_16x16x32_bf16 v[52:55], v[84:87], v[88:91], v[52:55]
    s_waitcnt lgkmcnt(0)
    s_barrier
    v_mfma_f32_16x16x32_bf16 v[28:31], v[68:71], v[92:95], v[28:31]
    v_mfma_f32_16x16x32_bf16 v[24:27], v[72:75], v[92:95], v[24:27]
    v_mfma_f32_16x16x32_bf16 v[20:23], v[76:79], v[92:95], v[20:23]
    buffer_load_dwordx4 v[68:71], v125, s[12:15], s23 offen offset:2048
    v_mfma_f32_16x16x32_bf16 v[60:63], v[80:83], v[96:99], v[60:63]
    v_mfma_f32_16x16x32_bf16 v[56:59], v[84:87], v[96:99], v[56:59]
    buffer_load_dwordx4 v[80:83], v119, s[12:15], s23 offen offset:0
    v_mfma_f32_16x16x32_bf16 v[28:31], v[72:75], v[100:103], v[28:31]
    v_mfma_f32_16x16x32_bf16 v[24:27], v[76:79], v[100:103], v[24:27]
    buffer_load_dwordx4 v[72:75], v125, s[12:15], s26 offen offset:0
    v_mfma_f32_16x16x32_bf16 v[60:63], v[84:87], v[104:107], v[60:63]
    buffer_load_dwordx4 v[84:87], v119, s[12:15], s23 offen offset:2048
    v_mfma_f32_16x16x32_bf16 v[28:31], v[76:79], v[108:111], v[28:31]
    buffer_load_dwordx4 v[76:79], v125, s[12:15], s26 offen offset:2048
    s_add_u32 s23, s23, 57344
    s_add_u32 s26, s26, 57344
    s_branch L_conv1_kernel_mloop2
L_conv1_kernel_mlast2:
    v_and_b32 v125, 15, v127
    v_and_b32 v126, 7, v127
    v_lshlrev_b32 v126, 4, v126
    v_lshl_add_u32 v125, v125, 7, v126
    v_lshrrev_b32 v126, 4, v127
    v_lshl_add_u32 v125, v126, 11, v125
    s_mov_b32 s36, 65536
    s_cmp_eq_u32 s32, 1
    s_cselect_b32 s36, 121856, s36
    s_cmp_eq_u32 s32, 2
    s_cselect_b32 s36, 81920, s36
    s_cmp_eq_u32 s32, 3
    s_cselect_b32 s36, 130048, s36
    s_mov_b32 s37, 98304
    s_cmp_eq_u32 s32, 1
    s_cselect_b32 s37, 138240, s37
    s_cmp_eq_u32 s32, 2
    s_cselect_b32 s37, 146432, s37
    s_cmp_eq_u32 s32, 3
    s_cselect_b32 s37, 154624, s37
    v_add_u32 v126, s37, v125
    v_add_u32 v125, s36, v125
    ds_read_b128 v[88:91], v120 offset:8192
    ds_read_b128 v[92:95], v120 offset:9216
    ds_read_b128 v[96:99], v116 offset:8704
    ds_read_b128 v[100:103], v120 offset:10240
    ds_read_b128 v[104:107], v116 offset:9792
    ds_read_b128 v[108:111], v120 offset:11264
    ds_read_b128 v[112:115], v116 offset:10880
    s_waitcnt vmcnt(5) lgkmcnt(6)
    v_mfma_f32_16x16x32_bf16 v[0:3], v[64:67], v[88:91], v[0:3]
    ds_read_b128 v[88:91], v120 offset:12288
    s_waitcnt vmcnt(4) lgkmcnt(6)
    v_mfma_f32_16x16x32_bf16 v[4:7], v[64:67], v[92:95], v[4:7]
    v_mfma_f32_16x16x32_bf16 v[0:3], v[68:71], v[92:95], v[0:3]
    ds_read_b128 v[92:95], v116 offset:11968
    s_waitcnt vmcnt(3) lgkmcnt(6)
    v_mfma_f32_16x16x32_bf16 v[32:35], v[80:83], v[96:99], v[32:35]
    ds_read_b128 v[96:99], v120 offset:13312
    s_waitcnt vmcnt(2) lgkmcnt(6)
    v_mfma_f32_16x16x32_bf16 v[8:11], v[64:67], v[100:103], v[8:11]
    v_mfma_f32_16x16x32_bf16 v[4:7], v[68:71], v[100:103], v[4:7]
    v_mfma_f32_16x16x32_bf16 v[0:3], v[72:75], v[100:103], v[0:3]
    ds_read_b128 v[100:103], v116 offset:13056
    s_waitcnt vmcnt(1) lgkmcnt(6)
    v_mfma_f32_16x16x32_bf16 v[36:39], v[80:83], v[104:107], v[36:39]
    v_mfma_f32_16x16x32_bf16 v[32:35], v[84:87], v[104:107], v[32:35]
    ds_read_b128 v[104:107], v120 offset:14336
    s_waitcnt vmcnt(0) lgkmcnt(6)
    v_mfma_f32_16x16x32_bf16 v[12:15], v[64:67], v[108:111], v[12:15]
    v_mfma_f32_16x16x32_bf16 v[8:11], v[68:71], v[108:111], v[8:11]
    v_mfma_f32_16x16x32_bf16 v[4:7], v[72:75], v[108:111], v[4:7]
    v_mfma_f32_16x16x32_bf16 v[0:3], v[76:79], v[108:111], v[0:3]
    ds_read_b128 v[108:111], v116 offset:14144
    s_waitcnt lgkmcnt(6)
    v_mfma_f32_16x16x32_bf16 v[40:43], v[80:83], v[112:115], v[40:43]
    v_mfma_f32_16x16x32_bf16 v[36:39], v[84:87], v[112:115], v[36:39]
    ds_read_b128 v[112:115], v120 offset:15360
    s_waitcnt lgkmcnt(6)
    v_mfma_f32_16x16x32_bf16 v[16:19], v[64:67], v[88:91], v[16:19]
    v_mfma_f32_16x16x32_bf16 v[12:15], v[68:71], v[88:91], v[12:15]
    v_mfma_f32_16x16x32_bf16 v[8:11], v[72:75], v[88:91], v[8:11]
    v_mfma_f32_16x16x32_bf16 v[4:7], v[76:79], v[88:91], v[4:7]
    ds_read_b128 v[88:91], v117 offset:8704
    v_xor_b32 v124, 0, v126
    ds_write_b128 v124, v[32:35]
    s_waitcnt lgkmcnt(7)
    v_mfma_f32_16x16x32_bf16 v[44:47], v[80:83], v[92:95], v[44:47]
    v_mfma_f32_16x16x32_bf16 v[40:43], v[84:87], v[92:95], v[40:43]
    ds_read_b128 v[92:95], v122 offset:0
    v_xor_b32 v123, 0, v125
    ds_write_b128 v123, v[0:3]
    s_waitcnt lgkmcnt(8)
    v_mfma_f32_16x16x32_bf16 v[20:23], v[64:67], v[96:99], v[20:23]
    v_mfma_f32_16x16x32_bf16 v[16:19], v[68:71], v[96:99], v[16:19]
    v_mfma_f32_16x16x32_bf16 v[12:15], v[72:75], v[96:99], v[12:15]
    v_mfma_f32_16x16x32_bf16 v[8:11], v[76:79], v[96:99], v[8:11]
    ds_read_b128 v[96:99], v117 offset:9792
    v_xor_b32 v123, 16, v126
    ds_write_b128 v123, v[36:39]
    s_waitcnt lgkmcnt(9)
    v_mfma_f32_16x16x32_bf16 v[48:51], v[80:83], v[100:103], v[48:51]
    v_mfma_f32_16x16x32_bf16 v[44:47], v[84:87], v[100:103], v[44:47]
    ds_read_b128 v[100:103], v121 offset:9216
    v_xor_b32 v124, 16, v125
    ds_write_b128 v124, v[4:7]
    s_waitcnt lgkmcnt(10)
    v_mfma_f32_16x16x32_bf16 v[24:27], v[64:67], v[104:107], v[24:27]
    v_mfma_f32_16x16x32_bf16 v[20:23], v[68:71], v[104:107], v[20:23]
    v_mfma_f32_16x16x32_bf16 v[16:19], v[72:75], v[104:107], v[16:19]
    v_mfma_f32_16x16x32_bf16 v[12:15], v[76:79], v[104:107], v[12:15]
    ds_read_b128 v[104:107], v118 offset:8704
    v_xor_b32 v124, 32, v126
    ds_write_b128 v124, v[40:43]
    s_waitcnt lgkmcnt(11)
    v_mfma_f32_16x16x32_bf16 v[52:55], v[80:83], v[108:111], v[52:55]
    v_mfma_f32_16x16x32_bf16 v[48:51], v[84:87], v[108:111], v[48:51]
    ds_read_b128 v[108:111], v121 offset:10240
    v_xor_b32 v123, 32, v125
    ds_write_b128 v123, v[8:11]
    s_waitcnt lgkmcnt(12)
    v_mfma_f32_16x16x32_bf16 v[28:31], v[64:67], v[112:115], v[28:31]
    v_mfma_f32_16x16x32_bf16 v[24:27], v[68:71], v[112:115], v[24:27]
    v_mfma_f32_16x16x32_bf16 v[20:23], v[72:75], v[112:115], v[20:23]
    v_mfma_f32_16x16x32_bf16 v[16:19], v[76:79], v[112:115], v[16:19]
    v_xor_b32 v123, 48, v126
    ds_write_b128 v123, v[44:47]
    s_waitcnt lgkmcnt(12)
    v_mfma_f32_16x16x32_bf16 v[56:59], v[80:83], v[88:91], v[56:59]
    v_mfma_f32_16x16x32_bf16 v[52:55], v[84:87], v[88:91], v[52:55]
    v_xor_b32 v124, 48, v125
    ds_write_b128 v124, v[12:15]
    s_waitcnt lgkmcnt(11)
    v_mfma_f32_16x16x32_bf16 v[28:31], v[68:71], v[92:95], v[28:31]
    v_mfma_f32_16x16x32_bf16 v[24:27], v[72:75], v[92:95], v[24:27]
    v_mfma_f32_16x16x32_bf16 v[20:23], v[76:79], v[92:95], v[20:23]
    v_xor_b32 v124, 64, v126
    ds_write_b128 v124, v[48:51]
    s_waitcnt lgkmcnt(10)
    v_mfma_f32_16x16x32_bf16 v[60:63], v[80:83], v[96:99], v[60:63]
    v_mfma_f32_16x16x32_bf16 v[56:59], v[84:87], v[96:99], v[56:59]
    v_xor_b32 v123, 64, v125
    ds_write_b128 v123, v[16:19]
    s_waitcnt lgkmcnt(9)
    v_mfma_f32_16x16x32_bf16 v[28:31], v[72:75], v[100:103], v[28:31]
    v_mfma_f32_16x16x32_bf16 v[24:27], v[76:79], v[100:103], v[24:27]
    v_xor_b32 v123, 80, v126
    ds_write_b128 v123, v[52:55]
    s_waitcnt lgkmcnt(8)
    v_mfma_f32_16x16x32_bf16 v[60:63], v[84:87], v[104:107], v[60:63]
    v_xor_b32 v124, 80, v125
    ds_write_b128 v124, v[20:23]
    s_waitcnt lgkmcnt(7)
    v_mfma_f32_16x16x32_bf16 v[28:31], v[76:79], v[108:111], v[28:31]
    v_xor_b32 v124, 96, v126
    ds_write_b128 v124, v[56:59]
    v_and_b32 v108, 15, v127
    v_lshrrev_b32 v109, 4, v127
    v_lshrrev_b32 v110, 3, v108
    s_lshl_b32 s36, s20, 1
    v_add_u32 v110, s36, v110
    v_xor_b32 v111, v110, v108
    v_and_b32 v111, 7, v111
    v_lshlrev_b32 v111, 4, v111
    v_xor_b32 v123, 96, v125
    ds_write_b128 v123, v[24:27]
    v_lshl_add_u32 v111, v110, 7, v111
    v_lshl_add_u32 v120, v109, 11, v111
    v_add_u32 v121, 65536, v120
    v_add_u32 v64, 131072, v120
    s_lshl_b32 s36, s20, 9
    s_add_u32 s36, s36, 115712
    v_lshl_add_u32 v127, v109, 7, s36
    s_lshl_b32 s36, s20, 4
    v_add_u32 v108, s36, v108
    v_lshlrev_b32 v110, 6, v108
    v_lshl_add_u32 v110, v109, 4, v110
    s_mul_i32 s36, s29, 524288
    v_xor_b32 v123, 112, v126
    ds_write_b128 v123, v[60:63]
    s_lshl_b32 s37, s21, 4
    s_add_u32 s36, s36, s37
    v_add_u32 v110, s36, v110
    v_mov_b32 v111, 2130706432
    v_cmp_gt_u32 vcc, 125, v108
    s_mov_b32 s4, 0xbeaaaaab
    s_mov_b32 s5, s4
    s_mov_b32 s6, 0x3e800000
    s_mov_b32 s7, s6
    s_mov_b32 s8, 0xc0a00000
    s_mov_b32 s9, s8
    s_mov_b32 s10, 0xc0638e39
    v_xor_b32 v124, 112, v125
    ds_write_b128 v124, v[28:31]
    s_mov_b32 s11, s10
    s_mov_b32 s12, 0xbf638e39
    s_mov_b32 s13, s12
    s_mov_b32 s14, 0xbe638e39
    s_mov_b32 s15, s14
    s_mov_b32 s22, 0xbd638e39
    s_mov_b32 s23, s22
    s_mov_b32 s24, 0x3ff1c71c
    s_mov_b32 s25, s24
    s_mov_b32 s26, 0xbf2aaaab
    s_mov_b32 s27, s26
    s_mov_b32 s32, 0x3ecccccd
    s_mov_b32 s33, s32
    s_mov_b32 s34, 0xbd888889
    s_mov_b32 s35, s34
    s_mov_b32 s38, 0xbe4ccccd
    s_mov_b32 s39, s38
    s_mov_b32 s40, 0xbdd2d3e8
    s_mov_b32 s41, s40
    s_mov_b32 s42, 0x3f800000
    s_mov_b32 s43, s42
    s_setprio 0
    s_branch L_conv1_kernel_epi
L_conv1_kernel_helper:
    s_setprio 3
    v_add_u32 v92, 0, v7
    v_add_u32 v93, 1024, v7
    v_add_u32 v94, 2048, v7
    v_add_u32 v95, 3072, v7
    v_and_b32 v76, 4, v5
    v_lshrrev_b32 v76, 1, v76
    v_xor_b32 v76, v6, v76
    v_lshlrev_b32 v76, 4, v76
    v_lshl_add_u32 v76, v5, 6, v76
    s_mov_b32 s24, 0
    s_mov_b32 s27, 524288
    s_waitcnt lgkmcnt(0)
    s_add_u32 s8, s4, s47
    s_addc_u32 s9, s5, 0
    buffer_load_dwordx4 v[0:3], v92, s[8:11], s24 offen offset:0
    buffer_load_dwordx4 v[16:19], v92, s[8:11], s24 offen offset:64
    v_add_u32 v92, 128, v92
    buffer_load_dwordx4 v[4:7], v93, s[8:11], s24 offen offset:0
    buffer_load_dwordx4 v[20:23], v93, s[8:11], s24 offen offset:64
    v_add_u32 v93, 128, v93
    buffer_load_dwordx4 v[8:11], v94, s[8:11], s24 offen offset:0
    buffer_load_dwordx4 v[24:27], v94, s[8:11], s24 offen offset:64
    v_add_u32 v94, 128, v94
    buffer_load_dwordx4 v[12:15], v95, s[8:11], s24 offen offset:0
    buffer_load_dwordx4 v[28:31], v95, s[8:11], s24 offen offset:64
    v_add_u32 v95, 128, v95
    s_mul_i32 s36, s42, 1024
    v_add_u32 v96, s36, v76
    v_add_u32 v97, 65536, v96
    s_mul_i32 s36, s42, 1088
    s_add_u32 s36, s36, 98304
    v_add_u32 v98, s36, v76
    s_waitcnt vmcnt(0)
    s_mov_b32 s28, 0
    s_mov_b32 s22, 4
    s_cmp_ge_u32 s20, 12
    s_cbranch_scc1 L_conv1_kernel_h2
    ds_write_b128 v96, v[0:3] offset:0
    ds_write_b128 v98, v[12:15] offset:0
    v_lshlrev_b32 v76, 16, v0
    v_and_b32 v84, s25, v0
    v_lshlrev_b32 v77, 16, v4
    v_and_b32 v85, s25, v4
    v_lshlrev_b32 v78, 16, v8
    v_and_b32 v86, s25, v8
    v_lshlrev_b32 v79, 16, v12
    v_and_b32 v87, s25, v12
    v_add_f32 v80, v76, v78
    v_add_f32 v88, v84, v86
    v_add_f32 v81, v77, v79
    v_add_f32 v89, v85, v87
    v_fma_f32 v82, v78, 4.0, v76
    v_fma_f32 v90, v86, 4.0, v84
    v_fma_f32 v83, v79, 4.0, v77
    v_fma_f32 v91, v87, 4.0, v85
    v_add_f32 v77, v80, v81
    v_add_f32 v85, v88, v89
    v_sub_f32 v78, v80, v81
    v_sub_f32 v86, v88, v89
    v_fma_f32 v79, v83, 2.0, v82
    v_fma_f32 v87, v91, 2.0, v90
    v_fma_f32 v82, v83, -2.0, v82
    v_fma_f32 v90, v91, -2.0, v90
    v_fmamk_f32 v80, v76, 0x41700000, v82
    v_fmamk_f32 v88, v84, 0x41700000, v90
    v_fmamk_f32 v80, v81, 0x41200000, v80
    v_fmamk_f32 v88, v89, 0x41200000, v88
    v_cvt_pk_bf16_f32 v4, v77, v85
    v_cvt_pk_bf16_f32 v8, v78, v86
    v_cvt_pk_bf16_f32 v64, v79, v87
    v_cvt_pk_bf16_f32 v68, v82, v90
    v_cvt_pk_bf16_f32 v72, v80, v88
    v_lshlrev_b32 v76, 16, v1
    v_and_b32 v84, s25, v1
    v_lshlrev_b32 v77, 16, v5
    v_and_b32 v85, s25, v5
    v_lshlrev_b32 v78, 16, v9
    v_and_b32 v86, s25, v9
    v_lshlrev_b32 v79, 16, v13
    v_and_b32 v87, s25, v13
    v_add_f32 v80, v76, v78
    v_add_f32 v88, v84, v86
    v_add_f32 v81, v77, v79
    v_add_f32 v89, v85, v87
    v_fma_f32 v82, v78, 4.0, v76
    v_fma_f32 v90, v86, 4.0, v84
    v_fma_f32 v83, v79, 4.0, v77
    v_fma_f32 v91, v87, 4.0, v85
    v_add_f32 v77, v80, v81
    v_add_f32 v85, v88, v89
    v_sub_f32 v78, v80, v81
    v_sub_f32 v86, v88, v89
    v_fma_f32 v79, v83, 2.0, v82
    v_fma_f32 v87, v91, 2.0, v90
    v_fma_f32 v82, v83, -2.0, v82
    v_fma_f32 v90, v91, -2.0, v90
    v_fmamk_f32 v80, v76, 0x41700000, v82
    v_fmamk_f32 v88, v84, 0x41700000, v90
    v_fmamk_f32 v80, v81, 0x41200000, v80
    v_fmamk_f32 v88, v89, 0x41200000, v88
    v_cvt_pk_bf16_f32 v5, v77, v85
    v_cvt_pk_bf16_f32 v9, v78, v86
    v_cvt_pk_bf16_f32 v65, v79, v87
    v_cvt_pk_bf16_f32 v69, v82, v90
    v_cvt_pk_bf16_f32 v73, v80, v88
    v_lshlrev_b32 v76, 16, v2
    v_and_b32 v84, s25, v2
    v_lshlrev_b32 v77, 16, v6
    v_and_b32 v85, s25, v6
    v_lshlrev_b32 v78, 16, v10
    v_and_b32 v86, s25, v10
    v_lshlrev_b32 v79, 16, v14
    v_and_b32 v87, s25, v14
    v_add_f32 v80, v76, v78
    v_add_f32 v88, v84, v86
    v_add_f32 v81, v77, v79
    v_add_f32 v89, v85, v87
    v_fma_f32 v82, v78, 4.0, v76
    v_fma_f32 v90, v86, 4.0, v84
    v_fma_f32 v83, v79, 4.0, v77
    v_fma_f32 v91, v87, 4.0, v85
    v_add_f32 v77, v80, v81
    v_add_f32 v85, v88, v89
    v_sub_f32 v78, v80, v81
    v_sub_f32 v86, v88, v89
    v_fma_f32 v79, v83, 2.0, v82
    v_fma_f32 v87, v91, 2.0, v90
    v_fma_f32 v82, v83, -2.0, v82
    v_fma_f32 v90, v91, -2.0, v90
    v_fmamk_f32 v80, v76, 0x41700000, v82
    v_fmamk_f32 v88, v84, 0x41700000, v90
    v_fmamk_f32 v80, v81, 0x41200000, v80
    v_fmamk_f32 v88, v89, 0x41200000, v88
    v_cvt_pk_bf16_f32 v6, v77, v85
    v_cvt_pk_bf16_f32 v10, v78, v86
    v_cvt_pk_bf16_f32 v66, v79, v87
    v_cvt_pk_bf16_f32 v70, v82, v90
    v_cvt_pk_bf16_f32 v74, v80, v88
    v_lshlrev_b32 v76, 16, v3
    v_and_b32 v84, s25, v3
    v_lshlrev_b32 v77, 16, v7
    v_and_b32 v85, s25, v7
    v_lshlrev_b32 v78, 16, v11
    v_and_b32 v86, s25, v11
    v_lshlrev_b32 v79, 16, v15
    v_and_b32 v87, s25, v15
    v_add_f32 v80, v76, v78
    v_add_f32 v88, v84, v86
    v_add_f32 v81, v77, v79
    v_add_f32 v89, v85, v87
    v_fma_f32 v82, v78, 4.0, v76
    v_fma_f32 v90, v86, 4.0, v84
    v_fma_f32 v83, v79, 4.0, v77
    v_fma_f32 v91, v87, 4.0, v85
    v_add_f32 v77, v80, v81
    v_add_f32 v85, v88, v89
    v_sub_f32 v78, v80, v81
    v_sub_f32 v86, v88, v89
    v_fma_f32 v79, v83, 2.0, v82
    v_fma_f32 v87, v91, 2.0, v90
    v_fma_f32 v82, v83, -2.0, v82
    v_fma_f32 v90, v91, -2.0, v90
    v_fmamk_f32 v80, v76, 0x41700000, v82
    v_fmamk_f32 v88, v84, 0x41700000, v90
    v_fmamk_f32 v80, v81, 0x41200000, v80
    v_fmamk_f32 v88, v89, 0x41200000, v88
    v_cvt_pk_bf16_f32 v7, v77, v85
    v_cvt_pk_bf16_f32 v11, v78, v86
    v_cvt_pk_bf16_f32 v67, v79, v87
    v_cvt_pk_bf16_f32 v71, v82, v90
    v_cvt_pk_bf16_f32 v75, v80, v88
    ds_write_b128 v96, v[64:67] offset:49152
    ds_write_b128 v97, v[68:71] offset:0
    ds_write_b128 v97, v[72:75] offset:16384
    ds_write_b128 v96, v[4:7] offset:16384
    ds_write_b128 v96, v[8:11] offset:32768
    s_waitcnt vmcnt(0)
    s_waitcnt lgkmcnt(0)
    s_barrier
    buffer_load_dwordx4 v[32:35], v92, s[8:11], s24 offen offset:0
    buffer_load_dwordx4 v[48:51], v92, s[8:11], s24 offen offset:64
    v_add_u32 v92, 128, v92
    buffer_load_dwordx4 v[36:39], v93, s[8:11], s24 offen offset:0
    buffer_load_dwordx4 v[52:55], v93, s[8:11], s24 offen offset:64
    v_add_u32 v93, 128, v93
    s_setprio 1
L_conv1_kernel_hloop1:
    s_cmp_lt_u32 s28, 13
    s_cselect_b32 s24, 0, 2130706432
    v_lshlrev_b32 v76, 16, v16
    v_and_b32 v84, s25, v16
    v_lshlrev_b32 v77, 16, v20
    v_and_b32 v85, s25, v20
    v_lshlrev_b32 v78, 16, v24
    v_and_b32 v86, s25, v24
    v_lshlrev_b32 v79, 16, v28
    v_and_b32 v87, s25, v28
    v_add_f32 v80, v76, v78
    v_add_f32 v88, v84, v86
    v_add_f32 v81, v77, v79
    v_add_f32 v89, v85, v87
    v_fma_f32 v82, v78, 4.0, v76
    buffer_load_dwordx4 v[40:43], v94, s[8:11], s24 offen offset:0
    buffer_load_dwordx4 v[56:59], v94, s[8:11], s24 offen offset:64
    v_add_u32 v94, 128, v94
    v_fma_f32 v90, v86, 4.0, v84
    v_fma_f32 v83, v79, 4.0, v77
    v_fma_f32 v91, v87, 4.0, v85
    v_add_f32 v77, v80, v81
    v_add_f32 v85, v88, v89
    v_sub_f32 v78, v80, v81
    v_sub_f32 v86, v88, v89
    v_fma_f32 v79, v83, 2.0, v82
    v_fma_f32 v87, v91, 2.0, v90
    v_fma_f32 v82, v83, -2.0, v82
    v_fma_f32 v90, v91, -2.0, v90
    v_fmamk_f32 v80, v76, 0x41700000, v82
    v_fmamk_f32 v88, v84, 0x41700000, v90
    v_fmamk_f32 v80, v81, 0x41200000, v80
    v_fmamk_f32 v88, v89, 0x41200000, v88
    v_cvt_pk_bf16_f32 v20, v77, v85
    v_cvt_pk_bf16_f32 v24, v78, v86
    v_cvt_pk_bf16_f32 v64, v79, v87
    v_cvt_pk_bf16_f32 v68, v82, v90
    v_cvt_pk_bf16_f32 v72, v80, v88
    v_lshlrev_b32 v76, 16, v17
    v_and_b32 v84, s25, v17
    v_lshlrev_b32 v77, 16, v21
    v_and_b32 v85, s25, v21
    v_lshlrev_b32 v78, 16, v25
    v_and_b32 v86, s25, v25
    v_lshlrev_b32 v79, 16, v29
    v_and_b32 v87, s25, v29
    v_add_f32 v80, v76, v78
    v_add_f32 v88, v84, v86
    v_add_f32 v81, v77, v79
    v_add_f32 v89, v85, v87
    v_fma_f32 v82, v78, 4.0, v76
    v_fma_f32 v90, v86, 4.0, v84
    v_fma_f32 v83, v79, 4.0, v77
    v_fma_f32 v91, v87, 4.0, v85
    v_add_f32 v77, v80, v81
    v_add_f32 v85, v88, v89
    v_sub_f32 v78, v80, v81
    v_sub_f32 v86, v88, v89
    v_fma_f32 v79, v83, 2.0, v82
    v_fma_f32 v87, v91, 2.0, v90
    v_fma_f32 v82, v83, -2.0, v82
    v_fma_f32 v90, v91, -2.0, v90
    v_fmamk_f32 v80, v76, 0x41700000, v82
    v_fmamk_f32 v88, v84, 0x41700000, v90
    v_fmamk_f32 v80, v81, 0x41200000, v80
    v_fmamk_f32 v88, v89, 0x41200000, v88
    v_cvt_pk_bf16_f32 v21, v77, v85
    v_cvt_pk_bf16_f32 v25, v78, v86
    v_cvt_pk_bf16_f32 v65, v79, v87
    v_cvt_pk_bf16_f32 v69, v82, v90
    v_cvt_pk_bf16_f32 v73, v80, v88
    buffer_load_dwordx4 v[44:47], v95, s[8:11], s24 offen offset:0
    buffer_load_dwordx4 v[60:63], v95, s[8:11], s24 offen offset:64
    v_add_u32 v95, 128, v95
    v_lshlrev_b32 v76, 16, v18
    v_and_b32 v84, s25, v18
    v_lshlrev_b32 v77, 16, v22
    v_and_b32 v85, s25, v22
    v_lshlrev_b32 v78, 16, v26
    v_and_b32 v86, s25, v26
    v_lshlrev_b32 v79, 16, v30
    v_and_b32 v87, s25, v30
    v_add_f32 v80, v76, v78
    v_add_f32 v88, v84, v86
    v_add_f32 v81, v77, v79
    v_add_f32 v89, v85, v87
    v_fma_f32 v82, v78, 4.0, v76
    v_fma_f32 v90, v86, 4.0, v84
    v_fma_f32 v83, v79, 4.0, v77
    v_fma_f32 v91, v87, 4.0, v85
    v_add_f32 v77, v80, v81
    v_add_f32 v85, v88, v89
    v_sub_f32 v78, v80, v81
    v_sub_f32 v86, v88, v89
    v_fma_f32 v79, v83, 2.0, v82
    v_fma_f32 v87, v91, 2.0, v90
    v_fma_f32 v82, v83, -2.0, v82
    v_fma_f32 v90, v91, -2.0, v90
    v_fmamk_f32 v80, v76, 0x41700000, v82
    v_fmamk_f32 v88, v84, 0x41700000, v90
    v_fmamk_f32 v80, v81, 0x41200000, v80
    v_fmamk_f32 v88, v89, 0x41200000, v88
    v_cvt_pk_bf16_f32 v22, v77, v85
    v_cvt_pk_bf16_f32 v26, v78, v86
    v_cvt_pk_bf16_f32 v66, v79, v87
    v_cvt_pk_bf16_f32 v70, v82, v90
    v_cvt_pk_bf16_f32 v74, v80, v88
    v_lshlrev_b32 v76, 16, v19
    v_and_b32 v84, s25, v19
    v_lshlrev_b32 v77, 16, v23
    v_and_b32 v85, s25, v23
    v_lshlrev_b32 v78, 16, v27
    v_and_b32 v86, s25, v27
    v_lshlrev_b32 v79, 16, v31
    v_and_b32 v87, s25, v31
    v_add_f32 v80, v76, v78
    v_add_f32 v88, v84, v86
    v_add_f32 v81, v77, v79
    v_add_f32 v89, v85, v87
    v_fma_f32 v82, v78, 4.0, v76
    v_fma_f32 v90, v86, 4.0, v84
    v_fma_f32 v83, v79, 4.0, v77
    v_fma_f32 v91, v87, 4.0, v85
    v_add_f32 v77, v80, v81
    v_add_f32 v85, v88, v89
    v_sub_f32 v78, v80, v81
    v_sub_f32 v86, v88, v89
    v_fma_f32 v79, v83, 2.0, v82
    v_fma_f32 v87, v91, 2.0, v90
    v_fma_f32 v82, v83, -2.0, v82
    v_fma_f32 v90, v91, -2.0, v90
    v_fmamk_f32 v80, v76, 0x41700000, v82
    v_fmamk_f32 v88, v84, 0x41700000, v90
    v_fmamk_f32 v80, v81, 0x41200000, v80
    v_fmamk_f32 v88, v89, 0x41200000, v88
    v_cvt_pk_bf16_f32 v23, v77, v85
    v_cvt_pk_bf16_f32 v27, v78, v86
    v_cvt_pk_bf16_f32 v67, v79, v87
    v_cvt_pk_bf16_f32 v71, v82, v90
    v_cvt_pk_bf16_f32 v75, v80, v88
    ds_write_b128 v96, v[64:67] offset:57344
    ds_write_b128 v97, v[68:71] offset:8192
    ds_write_b128 v97, v[72:75] offset:24576
    ds_write_b128 v96, v[16:19] offset:8192
    ds_write_b128 v96, v[20:23] offset:24576
    ds_write_b128 v96, v[24:27] offset:40960
    ds_write_b128 v98, v[28:31] offset:8704
    s_add_u32 s28, s28, 1
    s_waitcnt lgkmcnt(0)
    s_barrier
    s_cmp_lt_u32 s28, 13
    s_cselect_b32 s24, 0, 2130706432
    s_waitcnt vmcnt(0)
    v_lshlrev_b32 v76, 16, v32
    v_and_b32 v84, s25, v32
    v_lshlrev_b32 v77, 16, v36
    v_and_b32 v85, s25, v36
    v_lshlrev_b32 v78, 16, v40
    v_and_b32 v86, s25, v40
    v_lshlrev_b32 v79, 16, v44
    v_and_b32 v87, s25, v44
    v_add_f32 v80, v76, v78
    v_add_f32 v88, v84, v86
    v_add_f32 v81, v77, v79
    v_add_f32 v89, v85, v87
    v_fma_f32 v82, v78, 4.0, v76
    v_fma_f32 v90, v86, 4.0, v84
    v_fma_f32 v83, v79, 4.0, v77
    v_fma_f32 v91, v87, 4.0, v85
    v_add_f32 v77, v80, v81
    v_add_f32 v85, v88, v89
    v_sub_f32 v78, v80, v81
    v_sub_f32 v86, v88, v89
    v_fma_f32 v79, v83, 2.0, v82
    v_fma_f32 v87, v91, 2.0, v90
    v_fma_f32 v82, v83, -2.0, v82
    v_fma_f32 v90, v91, -2.0, v90
    v_fmamk_f32 v80, v76, 0x41700000, v82
    v_fmamk_f32 v88, v84, 0x41700000, v90
    v_fmamk_f32 v80, v81, 0x41200000, v80
    v_fmamk_f32 v88, v89, 0x41200000, v88
    v_cvt_pk_bf16_f32 v36, v77, v85
    v_cvt_pk_bf16_f32 v40, v78, v86
    v_cvt_pk_bf16_f32 v64, v79, v87
    v_cvt_pk_bf16_f32 v68, v82, v90
    v_cvt_pk_bf16_f32 v72, v80, v88
    v_lshlrev_b32 v76, 16, v33
    v_and_b32 v84, s25, v33
    v_lshlrev_b32 v77, 16, v37
    v_and_b32 v85, s25, v37
    v_lshlrev_b32 v78, 16, v41
    v_and_b32 v86, s25, v41
    buffer_load_dwordx4 v[0:3], v92, s[8:11], s24 offen offset:0
    buffer_load_dwordx4 v[16:19], v92, s[8:11], s24 offen offset:64
    v_add_u32 v92, 128, v92
    v_lshlrev_b32 v79, 16, v45
    v_and_b32 v87, s25, v45
    v_add_f32 v80, v76, v78
    v_add_f32 v88, v84, v86
    v_add_f32 v81, v77, v79
    v_add_f32 v89, v85, v87
    v_fma_f32 v82, v78, 4.0, v76
    v_fma_f32 v90, v86, 4.0, v84
    v_fma_f32 v83, v79, 4.0, v77
    v_fma_f32 v91, v87, 4.0, v85
    v_add_f32 v77, v80, v81
    v_add_f32 v85, v88, v89
    v_sub_f32 v78, v80, v81
    v_sub_f32 v86, v88, v89
    v_fma_f32 v79, v83, 2.0, v82
    v_fma_f32 v87, v91, 2.0, v90
    v_fma_f32 v82, v83, -2.0, v82
    v_fma_f32 v90, v91, -2.0, v90
    v_fmamk_f32 v80, v76, 0x41700000, v82
    v_fmamk_f32 v88, v84, 0x41700000, v90
    v_fmamk_f32 v80, v81, 0x41200000, v80
    v_fmamk_f32 v88, v89, 0x41200000, v88
    v_cvt_pk_bf16_f32 v37, v77, v85
    v_cvt_pk_bf16_f32 v41, v78, v86
    v_cvt_pk_bf16_f32 v65, v79, v87
    v_cvt_pk_bf16_f32 v69, v82, v90
    v_cvt_pk_bf16_f32 v73, v80, v88
    v_lshlrev_b32 v76, 16, v34
    v_and_b32 v84, s25, v34
    v_lshlrev_b32 v77, 16, v38
    v_and_b32 v85, s25, v38
    v_lshlrev_b32 v78, 16, v42
    v_and_b32 v86, s25, v42
    v_lshlrev_b32 v79, 16, v46
    v_and_b32 v87, s25, v46
    v_add_f32 v80, v76, v78
    v_add_f32 v88, v84, v86
    v_add_f32 v81, v77, v79
    v_add_f32 v89, v85, v87
    v_fma_f32 v82, v78, 4.0, v76
    v_fma_f32 v90, v86, 4.0, v84
    v_fma_f32 v83, v79, 4.0, v77
    v_fma_f32 v91, v87, 4.0, v85
    v_add_f32 v77, v80, v81
    v_add_f32 v85, v88, v89
    v_sub_f32 v78, v80, v81
    v_sub_f32 v86, v88, v89
    v_fma_f32 v79, v83, 2.0, v82
    v_fma_f32 v87, v91, 2.0, v90
    v_fma_f32 v82, v83, -2.0, v82
    v_fma_f32 v90, v91, -2.0, v90
    v_fmamk_f32 v80, v76, 0x41700000, v82
    v_fmamk_f32 v88, v84, 0x41700000, v90
    buffer_load_dwordx4 v[4:7], v93, s[8:11], s24 offen offset:0
    buffer_load_dwordx4 v[20:23], v93, s[8:11], s24 offen offset:64
    v_add_u32 v93, 128, v93
    v_fmamk_f32 v80, v81, 0x41200000, v80
    v_fmamk_f32 v88, v89, 0x41200000, v88
    v_cvt_pk_bf16_f32 v38, v77, v85
    v_cvt_pk_bf16_f32 v42, v78, v86
    v_cvt_pk_bf16_f32 v66, v79, v87
    v_cvt_pk_bf16_f32 v70, v82, v90
    v_cvt_pk_bf16_f32 v74, v80, v88
    v_lshlrev_b32 v76, 16, v35
    v_and_b32 v84, s25, v35
    v_lshlrev_b32 v77, 16, v39
    v_and_b32 v85, s25, v39
    v_lshlrev_b32 v78, 16, v43
    v_and_b32 v86, s25, v43
    v_lshlrev_b32 v79, 16, v47
    v_and_b32 v87, s25, v47
    v_add_f32 v80, v76, v78
    v_add_f32 v88, v84, v86
    v_add_f32 v81, v77, v79
    v_add_f32 v89, v85, v87
    v_fma_f32 v82, v78, 4.0, v76
    v_fma_f32 v90, v86, 4.0, v84
    v_fma_f32 v83, v79, 4.0, v77
    v_fma_f32 v91, v87, 4.0, v85
    v_add_f32 v77, v80, v81
    v_add_f32 v85, v88, v89
    v_sub_f32 v78, v80, v81
    v_sub_f32 v86, v88, v89
    v_fma_f32 v79, v83, 2.0, v82
    v_fma_f32 v87, v91, 2.0, v90
    v_fma_f32 v82, v83, -2.0, v82
    v_fma_f32 v90, v91, -2.0, v90
    v_fmamk_f32 v80, v76, 0x41700000, v82
    v_fmamk_f32 v88, v84, 0x41700000, v90
    v_fmamk_f32 v80, v81, 0x41200000, v80
    v_fmamk_f32 v88, v89, 0x41200000, v88
    v_cvt_pk_bf16_f32 v39, v77, v85
    v_cvt_pk_bf16_f32 v43, v78, v86
    v_cvt_pk_bf16_f32 v67, v79, v87
    v_cvt_pk_bf16_f32 v71, v82, v90
    v_cvt_pk_bf16_f32 v75, v80, v88
    ds_write_b128 v96, v[64:67] offset:49152
    ds_write_b128 v97, v[68:71] offset:0
    ds_write_b128 v97, v[72:75] offset:16384
    ds_write_b128 v96, v[32:35] offset:0
    ds_write_b128 v96, v[36:39] offset:16384
    ds_write_b128 v96, v[40:43] offset:32768
    ds_write_b128 v98, v[44:47] offset:0
    s_add_u32 s28, s28, 1
    s_waitcnt lgkmcnt(0)
    s_barrier
    s_cmp_lt_u32 s28, 13
    s_cselect_b32 s24, 0, 2130706432
    v_lshlrev_b32 v76, 16, v48
    v_and_b32 v84, s25, v48
    v_lshlrev_b32 v77, 16, v52
    v_and_b32 v85, s25, v52
    v_lshlrev_b32 v78, 16, v56
    v_and_b32 v86, s25, v56
    v_lshlrev_b32 v79, 16, v60
    v_and_b32 v87, s25, v60
    v_add_f32 v80, v76, v78
    v_add_f32 v88, v84, v86
    v_add_f32 v81, v77, v79
    v_add_f32 v89, v85, v87
    v_fma_f32 v82, v78, 4.0, v76
    buffer_load_dwordx4 v[8:11], v94, s[8:11], s24 offen offset:0
    buffer_load_dwordx4 v[24:27], v94, s[8:11], s24 offen offset:64
    v_add_u32 v94, 128, v94
    v_fma_f32 v90, v86, 4.0, v84
    v_fma_f32 v83, v79, 4.0, v77
    v_fma_f32 v91, v87, 4.0, v85
    v_add_f32 v77, v80, v81
    v_add_f32 v85, v88, v89
    v_sub_f32 v78, v80, v81
    v_sub_f32 v86, v88, v89
    v_fma_f32 v79, v83, 2.0, v82
    v_fma_f32 v87, v91, 2.0, v90
    v_fma_f32 v82, v83, -2.0, v82
    v_fma_f32 v90, v91, -2.0, v90
    v_fmamk_f32 v80, v76, 0x41700000, v82
    v_fmamk_f32 v88, v84, 0x41700000, v90
    v_fmamk_f32 v80, v81, 0x41200000, v80
    v_fmamk_f32 v88, v89, 0x41200000, v88
    v_cvt_pk_bf16_f32 v52, v77, v85
    v_cvt_pk_bf16_f32 v56, v78, v86
    v_cvt_pk_bf16_f32 v64, v79, v87
    v_cvt_pk_bf16_f32 v68, v82, v90
    v_cvt_pk_bf16_f32 v72, v80, v88
    v_lshlrev_b32 v76, 16, v49
    v_and_b32 v84, s25, v49
    v_lshlrev_b32 v77, 16, v53
    v_and_b32 v85, s25, v53
    v_lshlrev_b32 v78, 16, v57
    v_and_b32 v86, s25, v57
    v_lshlrev_b32 v79, 16, v61
    v_and_b32 v87, s25, v61
    v_add_f32 v80, v76, v78
    v_add_f32 v88, v84, v86
    v_add_f32 v81, v77, v79
    v_add_f32 v89, v85, v87
    v_fma_f32 v82, v78, 4.0, v76
    v_fma_f32 v90, v86, 4.0, v84
    v_fma_f32 v83, v79, 4.0, v77
    v_fma_f32 v91, v87, 4.0, v85
    v_add_f32 v77, v80, v81
    v_add_f32 v85, v88, v89
    v_sub_f32 v78, v80, v81
    v_sub_f32 v86, v88, v89
    v_fma_f32 v79, v83, 2.0, v82
    v_fma_f32 v87, v91, 2.0, v90
    v_fma_f32 v82, v83, -2.0, v82
    v_fma_f32 v90, v91, -2.0, v90
    v_fmamk_f32 v80, v76, 0x41700000, v82
    v_fmamk_f32 v88, v84, 0x41700000, v90
    v_fmamk_f32 v80, v81, 0x41200000, v80
    v_fmamk_f32 v88, v89, 0x41200000, v88
    v_cvt_pk_bf16_f32 v53, v77, v85
    v_cvt_pk_bf16_f32 v57, v78, v86
    v_cvt_pk_bf16_f32 v65, v79, v87
    v_cvt_pk_bf16_f32 v69, v82, v90
    v_cvt_pk_bf16_f32 v73, v80, v88
    buffer_load_dwordx4 v[12:15], v95, s[8:11], s24 offen offset:0
    buffer_load_dwordx4 v[28:31], v95, s[8:11], s24 offen offset:64
    v_add_u32 v95, 128, v95
    v_lshlrev_b32 v76, 16, v50
    v_and_b32 v84, s25, v50
    v_lshlrev_b32 v77, 16, v54
    v_and_b32 v85, s25, v54
    v_lshlrev_b32 v78, 16, v58
    v_and_b32 v86, s25, v58
    v_lshlrev_b32 v79, 16, v62
    v_and_b32 v87, s25, v62
    v_add_f32 v80, v76, v78
    v_add_f32 v88, v84, v86
    v_add_f32 v81, v77, v79
    v_add_f32 v89, v85, v87
    v_fma_f32 v82, v78, 4.0, v76
    v_fma_f32 v90, v86, 4.0, v84
    v_fma_f32 v83, v79, 4.0, v77
    v_fma_f32 v91, v87, 4.0, v85
    v_add_f32 v77, v80, v81
    v_add_f32 v85, v88, v89
    v_sub_f32 v78, v80, v81
    v_sub_f32 v86, v88, v89
    v_fma_f32 v79, v83, 2.0, v82
    v_fma_f32 v87, v91, 2.0, v90
    v_fma_f32 v82, v83, -2.0, v82
    v_fma_f32 v90, v91, -2.0, v90
    v_fmamk_f32 v80, v76, 0x41700000, v82
    v_fmamk_f32 v88, v84, 0x41700000, v90
    v_fmamk_f32 v80, v81, 0x41200000, v80
    v_fmamk_f32 v88, v89, 0x41200000, v88
    v_cvt_pk_bf16_f32 v54, v77, v85
    v_cvt_pk_bf16_f32 v58, v78, v86
    v_cvt_pk_bf16_f32 v66, v79, v87
    v_cvt_pk_bf16_f32 v70, v82, v90
    v_cvt_pk_bf16_f32 v74, v80, v88
    v_lshlrev_b32 v76, 16, v51
    v_and_b32 v84, s25, v51
    v_lshlrev_b32 v77, 16, v55
    v_and_b32 v85, s25, v55
    v_lshlrev_b32 v78, 16, v59
    v_and_b32 v86, s25, v59
    v_lshlrev_b32 v79, 16, v63
    v_and_b32 v87, s25, v63
    v_add_f32 v80, v76, v78
    v_add_f32 v88, v84, v86
    v_add_f32 v81, v77, v79
    v_add_f32 v89, v85, v87
    v_fma_f32 v82, v78, 4.0, v76
    v_fma_f32 v90, v86, 4.0, v84
    v_fma_f32 v83, v79, 4.0, v77
    v_fma_f32 v91, v87, 4.0, v85
    v_add_f32 v77, v80, v81
    v_add_f32 v85, v88, v89
    v_sub_f32 v78, v80, v81
    v_sub_f32 v86, v88, v89
    v_fma_f32 v79, v83, 2.0, v82
    v_fma_f32 v87, v91, 2.0, v90
    v_fma_f32 v82, v83, -2.0, v82
    v_fma_f32 v90, v91, -2.0, v90
    v_fmamk_f32 v80, v76, 0x41700000, v82
    v_fmamk_f32 v88, v84, 0x41700000, v90
    v_fmamk_f32 v80, v81, 0x41200000, v80
    v_fmamk_f32 v88, v89, 0x41200000, v88
    v_cvt_pk_bf16_f32 v55, v77, v85
    v_cvt_pk_bf16_f32 v59, v78, v86
    v_cvt_pk_bf16_f32 v67, v79, v87
    v_cvt_pk_bf16_f32 v71, v82, v90
    v_cvt_pk_bf16_f32 v75, v80, v88
    ds_write_b128 v96, v[64:67] offset:57344
    ds_write_b128 v97, v[68:71] offset:8192
    ds_write_b128 v97, v[72:75] offset:24576
    ds_write_b128 v96, v[48:51] offset:8192
    ds_write_b128 v96, v[52:55] offset:24576
    ds_write_b128 v96, v[56:59] offset:40960
    ds_write_b128 v98, v[60:63] offset:8704
    s_add_u32 s28, s28, 1
    s_waitcnt lgkmcnt(0)
    s_barrier
    s_cmp_eq_u32 s22, 1
    s_cbranch_scc1 L_conv1_kernel_hlast1
    s_cmp_lt_u32 s28, 13
    s_cselect_b32 s24, 0, 2130706432
    s_waitcnt vmcnt(0)
    v_lshlrev_b32 v76, 16, v0
    v_and_b32 v84, s25, v0
    v_lshlrev_b32 v77, 16, v4
    v_and_b32 v85, s25, v4
    v_lshlrev_b32 v78, 16, v8
    v_and_b32 v86, s25, v8
    v_lshlrev_b32 v79, 16, v12
    v_and_b32 v87, s25, v12
    v_add_f32 v80, v76, v78
    v_add_f32 v88, v84, v86
    v_add_f32 v81, v77, v79
    v_add_f32 v89, v85, v87
    v_fma_f32 v82, v78, 4.0, v76
    v_fma_f32 v90, v86, 4.0, v84
    v_fma_f32 v83, v79, 4.0, v77
    v_fma_f32 v91, v87, 4.0, v85
    v_add_f32 v77, v80, v81
    v_add_f32 v85, v88, v89
    v_sub_f32 v78, v80, v81
    v_sub_f32 v86, v88, v89
    v_fma_f32 v79, v83, 2.0, v82
    v_fma_f32 v87, v91, 2.0, v90
    v_fma_f32 v82, v83, -2.0, v82
    v_fma_f32 v90, v91, -2.0, v90
    v_fmamk_f32 v80, v76, 0x41700000, v82
    v_fmamk_f32 v88, v84, 0x41700000, v90
    v_fmamk_f32 v80, v81, 0x41200000, v80
    v_fmamk_f32 v88, v89, 0x41200000, v88
    v_cvt_pk_bf16_f32 v4, v77, v85
    v_cvt_pk_bf16_f32 v8, v78, v86
    v_cvt_pk_bf16_f32 v64, v79, v87
    v_cvt_pk_bf16_f32 v68, v82, v90
    v_cvt_pk_bf16_f32 v72, v80, v88
    v_lshlrev_b32 v76, 16, v1
    v_and_b32 v84, s25, v1
    v_lshlrev_b32 v77, 16, v5
    v_and_b32 v85, s25, v5
    v_lshlrev_b32 v78, 16, v9
    v_and_b32 v86, s25, v9
    buffer_load_dwordx4 v[32:35], v92, s[8:11], s24 offen offset:0
    buffer_load_dwordx4 v[48:51], v92, s[8:11], s24 offen offset:64
    v_add_u32 v92, 128, v92
    v_lshlrev_b32 v79, 16, v13
    v_and_b32 v87, s25, v13
    v_add_f32 v80, v76, v78
    v_add_f32 v88, v84, v86
    v_add_f32 v81, v77, v79
    v_add_f32 v89, v85, v87
    v_fma_f32 v82, v78, 4.0, v76
    v_fma_f32 v90, v86, 4.0, v84
    v_fma_f32 v83, v79, 4.0, v77
    v_fma_f32 v91, v87, 4.0, v85
    v_add_f32 v77, v80, v81
    v_add_f32 v85, v88, v89
    v_sub_f32 v78, v80, v81
    v_sub_f32 v86, v88, v89
    v_fma_f32 v79, v83, 2.0, v82
    v_fma_f32 v87, v91, 2.0, v90
    v_fma_f32 v82, v83, -2.0, v82
    v_fma_f32 v90, v91, -2.0, v90
    v_fmamk_f32 v80, v76, 0x41700000, v82
    v_fmamk_f32 v88, v84, 0x41700000, v90
    v_fmamk_f32 v80, v81, 0x41200000, v80
    v_fmamk_f32 v88, v89, 0x41200000, v88
    v_cvt_pk_bf16_f32 v5, v77, v85
    v_cvt_pk_bf16_f32 v9, v78, v86
    v_cvt_pk_bf16_f32 v65, v79, v87
    v_cvt_pk_bf16_f32 v69, v82, v90
    v_cvt_pk_bf16_f32 v73, v80, v88
    v_lshlrev_b32 v76, 16, v2
    v_and_b32 v84, s25, v2
    v_lshlrev_b32 v77, 16, v6
    v_and_b32 v85, s25, v6
    v_lshlrev_b32 v78, 16, v10
    v_and_b32 v86, s25, v10
    v_lshlrev_b32 v79, 16, v14
    v_and_b32 v87, s25, v14
    v_add_f32 v80, v76, v78
    v_add_f32 v88, v84, v86
    v_add_f32 v81, v77, v79
    v_add_f32 v89, v85, v87
    v_fma_f32 v82, v78, 4.0, v76
    v_fma_f32 v90, v86, 4.0, v84
    v_fma_f32 v83, v79, 4.0, v77
    v_fma_f32 v91, v87, 4.0, v85
    v_add_f32 v77, v80, v81
    v_add_f32 v85, v88, v89
    v_sub_f32 v78, v80, v81
    v_sub_f32 v86, v88, v89
    v_fma_f32 v79, v83, 2.0, v82
    v_fma_f32 v87, v91, 2.0, v90
    v_fma_f32 v82, v83, -2.0, v82
    v_fma_f32 v90, v91, -2.0, v90
    v_fmamk_f32 v80, v76, 0x41700000, v82
    v_fmamk_f32 v88, v84, 0x41700000, v90
    buffer_load_dwordx4 v[36:39], v93, s[8:11], s24 offen offset:0
    buffer_load_dwordx4 v[52:55], v93, s[8:11], s24 offen offset:64
    v_add_u32 v93, 128, v93
    v_fmamk_f32 v80, v81, 0x41200000, v80
    v_fmamk_f32 v88, v89, 0x41200000, v88
    v_cvt_pk_bf16_f32 v6, v77, v85
    v_cvt_pk_bf16_f32 v10, v78, v86
    v_cvt_pk_bf16_f32 v66, v79, v87
    v_cvt_pk_bf16_f32 v70, v82, v90
    v_cvt_pk_bf16_f32 v74, v80, v88
    v_lshlrev_b32 v76, 16, v3
    v_and_b32 v84, s25, v3
    v_lshlrev_b32 v77, 16, v7
    v_and_b32 v85, s25, v7
    v_lshlrev_b32 v78, 16, v11
    v_and_b32 v86, s25, v11
    v_lshlrev_b32 v79, 16, v15
    v_and_b32 v87, s25, v15
    v_add_f32 v80, v76, v78
    v_add_f32 v88, v84, v86
    v_add_f32 v81, v77, v79
    v_add_f32 v89, v85, v87
    v_fma_f32 v82, v78, 4.0, v76
    v_fma_f32 v90, v86, 4.0, v84
    v_fma_f32 v83, v79, 4.0, v77
    v_fma_f32 v91, v87, 4.0, v85
    v_add_f32 v77, v80, v81
    v_add_f32 v85, v88, v89
    v_sub_f32 v78, v80, v81
    v_sub_f32 v86, v88, v89
    v_fma_f32 v79, v83, 2.0, v82
    v_fma_f32 v87, v91, 2.0, v90
    v_fma_f32 v82, v83, -2.0, v82
    v_fma_f32 v90, v91, -2.0, v90
    v_fmamk_f32 v80, v76, 0x41700000, v82
    v_fmamk_f32 v88, v84, 0x41700000, v90
    v_fmamk_f32 v80, v81, 0x41200000, v80
    v_fmamk_f32 v88, v89, 0x41200000, v88
    v_cvt_pk_bf16_f32 v7, v77, v85
    v_cvt_pk_bf16_f32 v11, v78, v86
    v_cvt_pk_bf16_f32 v67, v79, v87
    v_cvt_pk_bf16_f32 v71, v82, v90
    v_cvt_pk_bf16_f32 v75, v80, v88
    ds_write_b128 v96, v[64:67] offset:49152
    ds_write_b128 v97, v[68:71] offset:0
    ds_write_b128 v97, v[72:75] offset:16384
    ds_write_b128 v96, v[0:3] offset:0
    ds_write_b128 v96, v[4:7] offset:16384
    ds_write_b128 v96, v[8:11] offset:32768
    ds_write_b128 v98, v[12:15] offset:0
    s_add_u32 s28, s28, 1
    s_waitcnt lgkmcnt(0)
    s_barrier
    s_sub_u32 s22, s22, 1
    s_branch L_conv1_kernel_hloop1
L_conv1_kernel_hlast1:
    s_cmp_ge_u32 s2, 32
    s_cbranch_scc1 L_conv1_kernel_ntw
    s_getpc_b64 s[36:37]
L_conv1_kernel_pc:
    s_lshl_b32 s38, s32, 13
    s_add_u32 s38, s38, L_conv1_kernel_epi-L_conv1_kernel_pc
    v_lshl_add_u32 v2, v127, 7, s38
    v_min_u32 v2, L_conv2_kernel_done-L_conv1_kernel_pc, v2
    v_mov_b32 v3, s37
    v_add_co_u32 v2, vcc, s36, v2
    s_nop 1
    v_addc_co_u32 v3, vcc, 0, v3, vcc
    global_load_dword v4, v[2:3], off
L_conv1_kernel_ntw:
    s_branch L_conv1_kernel_end
L_conv1_kernel_h2:
    s_load_dwordx2 s[48:49], s[0:1], 16
    ds_write_b128 v96, v[0:3] offset:0
    ds_write_b128 v98, v[12:15] offset:0
    v_lshlrev_b32 v76, 16, v0
    v_and_b32 v84, s25, v0
    v_lshlrev_b32 v77, 16, v4
    v_and_b32 v85, s25, v4
    v_lshlrev_b32 v78, 16, v8
    v_and_b32 v86, s25, v8
    v_lshlrev_b32 v79, 16, v12
    v_and_b32 v87, s25, v12
    v_add_f32 v80, v76, v78
    v_add_f32 v88, v84, v86
    v_add_f32 v81, v77, v79
    v_add_f32 v89, v85, v87
    v_fma_f32 v82, v78, 4.0, v76
    v_fma_f32 v90, v86, 4.0, v84
    v_fma_f32 v83, v79, 4.0, v77
    v_fma_f32 v91, v87, 4.0, v85
    v_add_f32 v77, v80, v81
    v_add_f32 v85, v88, v89
    v_sub_f32 v78, v80, v81
    v_sub_f32 v86, v88, v89
    v_fma_f32 v79, v83, 2.0, v82
    v_fma_f32 v87, v91, 2.0, v90
    v_fma_f32 v82, v83, -2.0, v82
    v_fma_f32 v90, v91, -2.0, v90
    v_fmamk_f32 v80, v76, 0x41700000, v82
    v_fmamk_f32 v88, v84, 0x41700000, v90
    v_fmamk_f32 v80, v81, 0x41200000, v80
    v_fmamk_f32 v88, v89, 0x41200000, v88
    v_cvt_pk_bf16_f32 v4, v77, v85
    v_cvt_pk_bf16_f32 v8, v78, v86
    v_cvt_pk_bf16_f32 v64, v79, v87
    v_cvt_pk_bf16_f32 v68, v82, v90
    v_cvt_pk_bf16_f32 v72, v80, v88
    v_lshlrev_b32 v76, 16, v1
    v_and_b32 v84, s25, v1
    v_lshlrev_b32 v77, 16, v5
    v_and_b32 v85, s25, v5
    v_lshlrev_b32 v78, 16, v9
    v_and_b32 v86, s25, v9
    v_lshlrev_b32 v79, 16, v13
    v_and_b32 v87, s25, v13
    v_add_f32 v80, v76, v78
    v_add_f32 v88, v84, v86
    v_add_f32 v81, v77, v79
    v_add_f32 v89, v85, v87
    v_fma_f32 v82, v78, 4.0, v76
    v_fma_f32 v90, v86, 4.0, v84
    v_fma_f32 v83, v79, 4.0, v77
    v_fma_f32 v91, v87, 4.0, v85
    v_add_f32 v77, v80, v81
    v_add_f32 v85, v88, v89
    v_sub_f32 v78, v80, v81
    v_sub_f32 v86, v88, v89
    v_fma_f32 v79, v83, 2.0, v82
    v_fma_f32 v87, v91, 2.0, v90
    v_fma_f32 v82, v83, -2.0, v82
    v_fma_f32 v90, v91, -2.0, v90
    v_fmamk_f32 v80, v76, 0x41700000, v82
    v_fmamk_f32 v88, v84, 0x41700000, v90
    v_fmamk_f32 v80, v81, 0x41200000, v80
    v_fmamk_f32 v88, v89, 0x41200000, v88
    v_cvt_pk_bf16_f32 v5, v77, v85
    v_cvt_pk_bf16_f32 v9, v78, v86
    v_cvt_pk_bf16_f32 v65, v79, v87
    v_cvt_pk_bf16_f32 v69, v82, v90
    v_cvt_pk_bf16_f32 v73, v80, v88
    v_lshlrev_b32 v76, 16, v2
    v_and_b32 v84, s25, v2
    v_lshlrev_b32 v77, 16, v6
    v_and_b32 v85, s25, v6
    v_lshlrev_b32 v78, 16, v10
    v_and_b32 v86, s25, v10
    v_lshlrev_b32 v79, 16, v14
    v_and_b32 v87, s25, v14
    v_add_f32 v80, v76, v78
    v_add_f32 v88, v84, v86
    v_add_f32 v81, v77, v79
    v_add_f32 v89, v85, v87
    v_fma_f32 v82, v78, 4.0, v76
    v_fma_f32 v90, v86, 4.0, v84
    v_fma_f32 v83, v79, 4.0, v77
    v_fma_f32 v91, v87, 4.0, v85
    v_add_f32 v77, v80, v81
    v_add_f32 v85, v88, v89
    v_sub_f32 v78, v80, v81
    v_sub_f32 v86, v88, v89
    v_fma_f32 v79, v83, 2.0, v82
    v_fma_f32 v87, v91, 2.0, v90
    v_fma_f32 v82, v83, -2.0, v82
    v_fma_f32 v90, v91, -2.0, v90
    v_fmamk_f32 v80, v76, 0x41700000, v82
    v_fmamk_f32 v88, v84, 0x41700000, v90
    v_fmamk_f32 v80, v81, 0x41200000, v80
    v_fmamk_f32 v88, v89, 0x41200000, v88
    v_cvt_pk_bf16_f32 v6, v77, v85
    v_cvt_pk_bf16_f32 v10, v78, v86
    v_cvt_pk_bf16_f32 v66, v79, v87
    v_cvt_pk_bf16_f32 v70, v82, v90
    v_cvt_pk_bf16_f32 v74, v80, v88
    v_lshlrev_b32 v76, 16, v3
    v_and_b32 v84, s25, v3
    v_lshlrev_b32 v77, 16, v7
    v_and_b32 v85, s25, v7
    v_lshlrev_b32 v78, 16, v11
    v_and_b32 v86, s25, v11
    v_lshlrev_b32 v79, 16, v15
    v_and_b32 v87, s25, v15
    v_add_f32 v80, v76, v78
    v_add_f32 v88, v84, v86
    v_add_f32 v81, v77, v79
    v_add_f32 v89, v85, v87
    v_fma_f32 v82, v78, 4.0, v76
    v_fma_f32 v90, v86, 4.0, v84
    v_fma_f32 v83, v79, 4.0, v77
    v_fma_f32 v91, v87, 4.0, v85
    v_add_f32 v77, v80, v81
    v_add_f32 v85, v88, v89
    v_sub_f32 v78, v80, v81
    v_sub_f32 v86, v88, v89
    v_fma_f32 v79, v83, 2.0, v82
    v_fma_f32 v87, v91, 2.0, v90
    v_fma_f32 v82, v83, -2.0, v82
    v_fma_f32 v90, v91, -2.0, v90
    v_fmamk_f32 v80, v76, 0x41700000, v82
    v_fmamk_f32 v88, v84, 0x41700000, v90
    v_fmamk_f32 v80, v81, 0x41200000, v80
    v_fmamk_f32 v88, v89, 0x41200000, v88
    v_cvt_pk_bf16_f32 v7, v77, v85
    v_cvt_pk_bf16_f32 v11, v78, v86
    v_cvt_pk_bf16_f32 v67, v79, v87
    v_cvt_pk_bf16_f32 v71, v82, v90
    v_cvt_pk_bf16_f32 v75, v80, v88
    ds_write_b128 v96, v[64:67] offset:49152
    ds_write_b128 v97, v[68:71] offset:0
    ds_write_b128 v97, v[72:75] offset:16384
    ds_write_b128 v96, v[4:7] offset:16384
    ds_write_b128 v96, v[8:11] offset:32768
    s_waitcnt vmcnt(0)
    s_waitcnt lgkmcnt(0)
    s_barrier
    buffer_load_dwordx4 v[32:35], v92, s[8:11], s24 offen offset:0
    buffer_load_dwordx4 v[48:51], v92, s[8:11], s24 offen offset:64
    v_add_u32 v92, 128, v92
    buffer_load_dwordx4 v[36:39], v93, s[8:11], s24 offen offset:0
    buffer_load_dwordx4 v[52:55], v93, s[8:11], s24 offen offset:64
    v_add_u32 v93, 128, v93
    buffer_load_dwordx4 v[40:43], v94, s[8:11], s24 offen offset:0
    buffer_load_dwordx4 v[56:59], v94, s[8:11], s24 offen offset:64
    v_add_u32 v94, 128, v94
    buffer_load_dwordx4 v[44:47], v95, s[8:11], s24 offen offset:0
    buffer_load_dwordx4 v[60:63], v95, s[8:11], s24 offen offset:64
    v_add_u32 v95, 128, v95
    s_setprio 0
    v_lshlrev_b32 v76, 16, v16
    v_and_b32 v84, s25, v16
    v_lshlrev_b32 v77, 16, v20
    v_and_b32 v85, s25, v20
    v_lshlrev_b32 v78, 16, v24
    v_and_b32 v86, s25, v24
    v_lshlrev_b32 v79, 16, v28
    v_and_b32 v87, s25, v28
    v_add_f32 v80, v76, v78
    v_add_f32 v88, v84, v86
    v_add_f32 v81, v77, v79
    v_add_f32 v89, v85, v87
    v_fma_f32 v82, v78, 4.0, v76
    v_fma_f32 v90, v86, 4.0, v84
    v_fma_f32 v83, v79, 4.0, v77
    v_fma_f32 v91, v87, 4.0, v85
    v_add_f32 v77, v80, v81
    v_add_f32 v85, v88, v89
    v_sub_f32 v78, v80, v81
    v_sub_f32 v86, v88, v89
    v_fma_f32 v79, v83, 2.0, v82
    v_fma_f32 v87, v91, 2.0, v90
    v_fma_f32 v82, v83, -2.0, v82
    v_fma_f32 v90, v91, -2.0, v90
    v_fmamk_f32 v80, v76, 0x41700000, v82
    v_fmamk_f32 v88, v84, 0x41700000, v90
    v_fmamk_f32 v80, v81, 0x41200000, v80
    v_fmamk_f32 v88, v89, 0x41200000, v88
    v_cvt_pk_bf16_f32 v20, v77, v85
    v_cvt_pk_bf16_f32 v24, v78, v86
    v_cvt_pk_bf16_f32 v64, v79, v87
    v_cvt_pk_bf16_f32 v68, v82, v90
    v_cvt_pk_bf16_f32 v72, v80, v88
    v_lshlrev_b32 v76, 16, v17
    v_and_b32 v84, s25, v17
    v_lshlrev_b32 v77, 16, v21
    v_and_b32 v85, s25, v21
    v_lshlrev_b32 v78, 16, v25
    v_and_b32 v86, s25, v25
    v_lshlrev_b32 v79, 16, v29
    v_and_b32 v87, s25, v29
    v_add_f32 v80, v76, v78
    v_add_f32 v88, v84, v86
    v_add_f32 v81, v77, v79
    v_add_f32 v89, v85, v87
    v_fma_f32 v82, v78, 4.0, v76
    v_fma_f32 v90, v86, 4.0, v84
    v_fma_f32 v83, v79, 4.0, v77
    v_fma_f32 v91, v87, 4.0, v85
    v_add_f32 v77, v80, v81
    v_add_f32 v85, v88, v89
    v_sub_f32 v78, v80, v81
    v_sub_f32 v86, v88, v89
    v_fma_f32 v79, v83, 2.0, v82
    v_fma_f32 v87, v91, 2.0, v90
    v_fma_f32 v82, v83, -2.0, v82
    v_fma_f32 v90, v91, -2.0, v90
    v_fmamk_f32 v80, v76, 0x41700000, v82
    v_fmamk_f32 v88, v84, 0x41700000, v90
    v_fmamk_f32 v80, v81, 0x41200000, v80
    v_fmamk_f32 v88, v89, 0x41200000, v88
    v_cvt_pk_bf16_f32 v21, v77, v85
    v_cvt_pk_bf16_f32 v25, v78, v86
    v_cvt_pk_bf16_f32 v65, v79, v87
    v_cvt_pk_bf16_f32 v69, v82, v90
    v_cvt_pk_bf16_f32 v73, v80, v88
    v_lshlrev_b32 v76, 16, v18
    v_and_b32 v84, s25, v18
    v_lshlrev_b32 v77, 16, v22
    v_and_b32 v85, s25, v22
    v_lshlrev_b32 v78, 16, v26
    v_and_b32 v86, s25, v26
    v_lshlrev_b32 v79, 16, v30
    v_and_b32 v87, s25, v30
    v_add_f32 v80, v76, v78
    v_add_f32 v88, v84, v86
    v_add_f32 v81, v77, v79
    v_add_f32 v89, v85, v87
    v_fma_f32 v82, v78, 4.0, v76
    v_fma_f32 v90, v86, 4.0, v84
    v_fma_f32 v83, v79, 4.0, v77
    v_fma_f32 v91, v87, 4.0, v85
    v_add_f32 v77, v80, v81
    v_add_f32 v85, v88, v89
    v_sub_f32 v78, v80, v81
    v_sub_f32 v86, v88, v89
    v_fma_f32 v79, v83, 2.0, v82
    v_fma_f32 v87, v91, 2.0, v90
    v_fma_f32 v82, v83, -2.0, v82
    v_fma_f32 v90, v91, -2.0, v90
    v_fmamk_f32 v80, v76, 0x41700000, v82
    v_fmamk_f32 v88, v84, 0x41700000, v90
    v_fmamk_f32 v80, v81, 0x41200000, v80
    v_fmamk_f32 v88, v89, 0x41200000, v88
    v_cvt_pk_bf16_f32 v22, v77, v85
    v_cvt_pk_bf16_f32 v26, v78, v86
    v_cvt_pk_bf16_f32 v66, v79, v87
    v_cvt_pk_bf16_f32 v70, v82, v90
    v_cvt_pk_bf16_f32 v74, v80, v88
    v_lshlrev_b32 v76, 16, v19
    v_and_b32 v84, s25, v19
    v_lshlrev_b32 v77, 16, v23
    v_and_b32 v85, s25, v23
    v_lshlrev_b32 v78, 16, v27
    v_and_b32 v86, s25, v27
    v_lshlrev_b32 v79, 16, v31
    v_and_b32 v87, s25, v31
    v_add_f32 v80, v76, v78
    v_add_f32 v88, v84, v86
    v_add_f32 v81, v77, v79
    v_add_f32 v89, v85, v87
    v_fma_f32 v82, v78, 4.0, v76
    v_fma_f32 v90, v86, 4.0, v84
    v_fma_f32 v83, v79, 4.0, v77
    v_fma_f32 v91, v87, 4.0, v85
    v_add_f32 v77, v80, v81
    v_add_f32 v85, v88, v89
    v_sub_f32 v78, v80, v81
    v_sub_f32 v86, v88, v89
    v_fma_f32 v79, v83, 2.0, v82
    v_fma_f32 v87, v91, 2.0, v90
    v_fma_f32 v82, v83, -2.0, v82
    v_fma_f32 v90, v91, -2.0, v90
    v_fmamk_f32 v80, v76, 0x41700000, v82
    v_fmamk_f32 v88, v84, 0x41700000, v90
    v_fmamk_f32 v80, v81, 0x41200000, v80
    v_fmamk_f32 v88, v89, 0x41200000, v88
    v_cvt_pk_bf16_f32 v23, v77, v85
    v_cvt_pk_bf16_f32 v27, v78, v86
    v_cvt_pk_bf16_f32 v67, v79, v87
    v_cvt_pk_bf16_f32 v71, v82, v90
    v_cvt_pk_bf16_f32 v75, v80, v88
L_conv1_kernel_hloop2:
    s_cmp_lt_u32 s28, 12
    s_cselect_b32 s24, 0, 2130706432
    ds_write_b128 v96, v[64:67] offset:57344
    ds_write_b128 v97, v[68:71] offset:8192
    ds_write_b128 v97, v[72:75] offset:24576
    ds_write_b128 v96, v[16:19] offset:8192
    ds_write_b128 v96, v[20:23] offset:24576
    ds_write_b128 v96, v[24:27] offset:40960
    ds_write_b128 v98, v[28:31] offset:8704
    s_waitcnt vmcnt(0)
    buffer_load_dwordx4 v[0:3], v92, s[8:11], s24 offen offset:0
    buffer_load_dwordx4 v[16:19], v92, s[8:11], s24 offen offset:64
    v_add_u32 v92, 128, v92
    buffer_load_dwordx4 v[4:7], v93, s[8:11], s24 offen offset:0
    buffer_load_dwordx4 v[20:23], v93, s[8:11], s24 offen offset:64
    v_add_u32 v93, 128, v93
    v_lshlrev_b32 v76, 16, v32
    v_and_b32 v84, s25, v32
    v_lshlrev_b32 v77, 16, v36
    v_and_b32 v85, s25, v36
    v_lshlrev_b32 v78, 16, v40
    v_and_b32 v86, s25, v40
    v_lshlrev_b32 v79, 16, v44
    v_and_b32 v87, s25, v44
    v_add_f32 v80, v76, v78
    v_add_f32 v88, v84, v86
    v_add_f32 v81, v77, v79
    v_add_f32 v89, v85, v87
    v_fma_f32 v82, v78, 4.0, v76
    v_fma_f32 v90, v86, 4.0, v84
    v_fma_f32 v83, v79, 4.0, v77
    v_fma_f32 v91, v87, 4.0, v85
    v_add_f32 v77, v80, v81
    v_add_f32 v85, v88, v89
    v_sub_f32 v78, v80, v81
    v_sub_f32 v86, v88, v89
    v_fma_f32 v79, v83, 2.0, v82
    v_fma_f32 v87, v91, 2.0, v90
    v_fma_f32 v82, v83, -2.0, v82
    v_fma_f32 v90, v91, -2.0, v90
    v_fmamk_f32 v80, v76, 0x41700000, v82
    v_fmamk_f32 v88, v84, 0x41700000, v90
    v_fmamk_f32 v80, v81, 0x41200000, v80
    v_fmamk_f32 v88, v89, 0x41200000, v88
    v_cvt_pk_bf16_f32 v36, v77, v85
    v_cvt_pk_bf16_f32 v40, v78, v86
    v_cvt_pk_bf16_f32 v64, v79, v87
    v_cvt_pk_bf16_f32 v68, v82, v90
    v_cvt_pk_bf16_f32 v72, v80, v88
    v_lshlrev_b32 v76, 16, v33
    v_and_b32 v84, s25, v33
    v_lshlrev_b32 v77, 16, v37
    v_and_b32 v85, s25, v37
    v_lshlrev_b32 v78, 16, v41
    v_and_b32 v86, s25, v41
    v_lshlrev_b32 v79, 16, v45
    v_and_b32 v87, s25, v45
    v_add_f32 v80, v76, v78
    v_add_f32 v88, v84, v86
    v_add_f32 v81, v77, v79
    v_add_f32 v89, v85, v87
    v_fma_f32 v82, v78, 4.0, v76
    v_fma_f32 v90, v86, 4.0, v84
    v_fma_f32 v83, v79, 4.0, v77
    v_fma_f32 v91, v87, 4.0, v85
    v_add_f32 v77, v80, v81
    v_add_f32 v85, v88, v89
    v_sub_f32 v78, v80, v81
    v_sub_f32 v86, v88, v89
    v_fma_f32 v79, v83, 2.0, v82
    v_fma_f32 v87, v91, 2.0, v90
    v_fma_f32 v82, v83, -2.0, v82
    v_fma_f32 v90, v91, -2.0, v90
    v_fmamk_f32 v80, v76, 0x41700000, v82
    v_fmamk_f32 v88, v84, 0x41700000, v90
    v_fmamk_f32 v80, v81, 0x41200000, v80
    v_fmamk_f32 v88, v89, 0x41200000, v88
    v_cvt_pk_bf16_f32 v37, v77, v85
    v_cvt_pk_bf16_f32 v41, v78, v86
    v_cvt_pk_bf16_f32 v65, v79, v87
    v_cvt_pk_bf16_f32 v69, v82, v90
    v_cvt_pk_bf16_f32 v73, v80, v88
    v_lshlrev_b32 v76, 16, v34
    v_and_b32 v84, s25, v34
    v_lshlrev_b32 v77, 16, v38
    v_and_b32 v85, s25, v38
    v_lshlrev_b32 v78, 16, v42
    v_and_b32 v86, s25, v42
    v_lshlrev_b32 v79, 16, v46
    v_and_b32 v87, s25, v46
    v_add_f32 v80, v76, v78
    v_add_f32 v88, v84, v86
    v_add_f32 v81, v77, v79
    v_add_f32 v89, v85, v87
    v_fma_f32 v82, v78, 4.0, v76
    v_fma_f32 v90, v86, 4.0, v84
    v_fma_f32 v83, v79, 4.0, v77
    v_fma_f32 v91, v87, 4.0, v85
    v_add_f32 v77, v80, v81
    v_add_f32 v85, v88, v89
    v_sub_f32 v78, v80, v81
    v_sub_f32 v86, v88, v89
    v_fma_f32 v79, v83, 2.0, v82
    v_fma_f32 v87, v91, 2.0, v90
    v_fma_f32 v82, v83, -2.0, v82
    v_fma_f32 v90, v91, -2.0, v90
    v_fmamk_f32 v80, v76, 0x41700000, v82
    v_fmamk_f32 v88, v84, 0x41700000, v90
    v_fmamk_f32 v80, v81, 0x41200000, v80
    v_fmamk_f32 v88, v89, 0x41200000, v88
    v_cvt_pk_bf16_f32 v38, v77, v85
    v_cvt_pk_bf16_f32 v42, v78, v86
    v_cvt_pk_bf16_f32 v66, v79, v87
    v_cvt_pk_bf16_f32 v70, v82, v90
    v_cvt_pk_bf16_f32 v74, v80, v88
    v_lshlrev_b32 v76, 16, v35
    v_and_b32 v84, s25, v35
    v_lshlrev_b32 v77, 16, v39
    v_and_b32 v85, s25, v39
    v_lshlrev_b32 v78, 16, v43
    v_and_b32 v86, s25, v43
    v_lshlrev_b32 v79, 16, v47
    v_and_b32 v87, s25, v47
    v_add_f32 v80, v76, v78
    v_add_f32 v88, v84, v86
    v_add_f32 v81, v77, v79
    v_add_f32 v89, v85, v87
    v_fma_f32 v82, v78, 4.0, v76
    v_fma_f32 v90, v86, 4.0, v84
    v_fma_f32 v83, v79, 4.0, v77
    v_fma_f32 v91, v87, 4.0, v85
    v_add_f32 v77, v80, v81
    v_add_f32 v85, v88, v89
    v_sub_f32 v78, v80, v81
    v_sub_f32 v86, v88, v89
    v_fma_f32 v79, v83, 2.0, v82
    v_fma_f32 v87, v91, 2.0, v90
    v_fma_f32 v82, v83, -2.0, v82
    v_fma_f32 v90, v91, -2.0, v90
    v_fmamk_f32 v80, v76, 0x41700000, v82
    v_fmamk_f32 v88, v84, 0x41700000, v90
    v_fmamk_f32 v80, v81, 0x41200000, v80
    v_fmamk_f32 v88, v89, 0x41200000, v88
    v_cvt_pk_bf16_f32 v39, v77, v85
    v_cvt_pk_bf16_f32 v43, v78, v86
    v_cvt_pk_bf16_f32 v67, v79, v87
    v_cvt_pk_bf16_f32 v71, v82, v90
    v_cvt_pk_bf16_f32 v75, v80, v88
    s_add_u32 s28, s28, 1
    s_waitcnt lgkmcnt(0)
    s_barrier
    s_cmp_lt_u32 s28, 12
    s_cselect_b32 s24, 0, 2130706432
    ds_write_b128 v96, v[64:67] offset:49152
    ds_write_b128 v97, v[68:71] offset:0
    ds_write_b128 v97, v[72:75] offset:16384
    ds_write_b128 v96, v[32:35] offset:0
    ds_write_b128 v96, v[36:39] offset:16384
    ds_write_b128 v96, v[40:43] offset:32768
    ds_write_b128 v98, v[44:47] offset:0
    buffer_load_dwordx4 v[8:11], v94, s[8:11], s24 offen offset:0
    buffer_load_dwordx4 v[24:27], v94, s[8:11], s24 offen offset:64
    v_add_u32 v94, 128, v94
    buffer_load_dwordx4 v[12:15], v95, s[8:11], s24 offen offset:0
    buffer_load_dwordx4 v[28:31], v95, s[8:11], s24 offen offset:64
    v_add_u32 v95, 128, v95
    v_lshlrev_b32 v76, 16, v48
    v_and_b32 v84, s25, v48
    v_lshlrev_b32 v77, 16, v52
    v_and_b32 v85, s25, v52
    v_lshlrev_b32 v78, 16, v56
    v_and_b32 v86, s25, v56
    v_lshlrev_b32 v79, 16, v60
    v_and_b32 v87, s25, v60
    v_add_f32 v80, v76, v78
    v_add_f32 v88, v84, v86
    v_add_f32 v81, v77, v79
    v_add_f32 v89, v85, v87
    v_fma_f32 v82, v78, 4.0, v76
    v_fma_f32 v90, v86, 4.0, v84
    v_fma_f32 v83, v79, 4.0, v77
    v_fma_f32 v91, v87, 4.0, v85
    v_add_f32 v77, v80, v81
    v_add_f32 v85, v88, v89
    v_sub_f32 v78, v80, v81
    v_sub_f32 v86, v88, v89
    v_fma_f32 v79, v83, 2.0, v82
    v_fma_f32 v87, v91, 2.0, v90
    v_fma_f32 v82, v83, -2.0, v82
    v_fma_f32 v90, v91, -2.0, v90
    v_fmamk_f32 v80, v76, 0x41700000, v82
    v_fmamk_f32 v88, v84, 0x41700000, v90
    v_fmamk_f32 v80, v81, 0x41200000, v80
    v_fmamk_f32 v88, v89, 0x41200000, v88
    v_cvt_pk_bf16_f32 v52, v77, v85
    v_cvt_pk_bf16_f32 v56, v78, v86
    v_cvt_pk_bf16_f32 v64, v79, v87
    v_cvt_pk_bf16_f32 v68, v82, v90
    v_cvt_pk_bf16_f32 v72, v80, v88
    v_lshlrev_b32 v76, 16, v49
    v_and_b32 v84, s25, v49
    v_lshlrev_b32 v77, 16, v53
    v_and_b32 v85, s25, v53
    v_lshlrev_b32 v78, 16, v57
    v_and_b32 v86, s25, v57
    v_lshlrev_b32 v79, 16, v61
    v_and_b32 v87, s25, v61
    v_add_f32 v80, v76, v78
    v_add_f32 v88, v84, v86
    v_add_f32 v81, v77, v79
    v_add_f32 v89, v85, v87
    v_fma_f32 v82, v78, 4.0, v76
    v_fma_f32 v90, v86, 4.0, v84
    v_fma_f32 v83, v79, 4.0, v77
    v_fma_f32 v91, v87, 4.0, v85
    v_add_f32 v77, v80, v81
    v_add_f32 v85, v88, v89
    v_sub_f32 v78, v80, v81
    v_sub_f32 v86, v88, v89
    v_fma_f32 v79, v83, 2.0, v82
    v_fma_f32 v87, v91, 2.0, v90
    v_fma_f32 v82, v83, -2.0, v82
    v_fma_f32 v90, v91, -2.0, v90
    v_fmamk_f32 v80, v76, 0x41700000, v82
    v_fmamk_f32 v88, v84, 0x41700000, v90
    v_fmamk_f32 v80, v81, 0x41200000, v80
    v_fmamk_f32 v88, v89, 0x41200000, v88
    v_cvt_pk_bf16_f32 v53, v77, v85
    v_cvt_pk_bf16_f32 v57, v78, v86
    v_cvt_pk_bf16_f32 v65, v79, v87
    v_cvt_pk_bf16_f32 v69, v82, v90
    v_cvt_pk_bf16_f32 v73, v80, v88
    v_lshlrev_b32 v76, 16, v50
    v_and_b32 v84, s25, v50
    v_lshlrev_b32 v77, 16, v54
    v_and_b32 v85, s25, v54
    v_lshlrev_b32 v78, 16, v58
    v_and_b32 v86, s25, v58
    v_lshlrev_b32 v79, 16, v62
    v_and_b32 v87, s25, v62
    v_add_f32 v80, v76, v78
    v_add_f32 v88, v84, v86
    v_add_f32 v81, v77, v79
    v_add_f32 v89, v85, v87
    v_fma_f32 v82, v78, 4.0, v76
    v_fma_f32 v90, v86, 4.0, v84
    v_fma_f32 v83, v79, 4.0, v77
    v_fma_f32 v91, v87, 4.0, v85
    v_add_f32 v77, v80, v81
    v_add_f32 v85, v88, v89
    v_sub_f32 v78, v80, v81
    v_sub_f32 v86, v88, v89
    v_fma_f32 v79, v83, 2.0, v82
    v_fma_f32 v87, v91, 2.0, v90
    v_fma_f32 v82, v83, -2.0, v82
    v_fma_f32 v90, v91, -2.0, v90
    v_fmamk_f32 v80, v76, 0x41700000, v82
    v_fmamk_f32 v88, v84, 0x41700000, v90
    v_fmamk_f32 v80, v81, 0x41200000, v80
    v_fmamk_f32 v88, v89, 0x41200000, v88
    v_cvt_pk_bf16_f32 v54, v77, v85
    v_cvt_pk_bf16_f32 v58, v78, v86
    v_cvt_pk_bf16_f32 v66, v79, v87
    v_cvt_pk_bf16_f32 v70, v82, v90
    v_cvt_pk_bf16_f32 v74, v80, v88
    v_lshlrev_b32 v76, 16, v51
    v_and_b32 v84, s25, v51
    v_lshlrev_b32 v77, 16, v55
    v_and_b32 v85, s25, v55
    v_lshlrev_b32 v78, 16, v59
    v_and_b32 v86, s25, v59
    v_lshlrev_b32 v79, 16, v63
    v_and_b32 v87, s25, v63
    v_add_f32 v80, v76, v78
    v_add_f32 v88, v84, v86
    v_add_f32 v81, v77, v79
    v_add_f32 v89, v85, v87
    v_fma_f32 v82, v78, 4.0, v76
    v_fma_f32 v90, v86, 4.0, v84
    v_fma_f32 v83, v79, 4.0, v77
    v_fma_f32 v91, v87, 4.0, v85
    v_add_f32 v77, v80, v81
    v_add_f32 v85, v88, v89
    v_sub_f32 v78, v80, v81
    v_sub_f32 v86, v88, v89
    v_fma_f32 v79, v83, 2.0, v82
    v_fma_f32 v87, v91, 2.0, v90
    v_fma_f32 v82, v83, -2.0, v82
    v_fma_f32 v90, v91, -2.0, v90
    v_fmamk_f32 v80, v76, 0x41700000, v82
    v_fmamk_f32 v88, v84, 0x41700000, v90
    v_fmamk_f32 v80, v81, 0x41200000, v80
    v_fmamk_f32 v88, v89, 0x41200000, v88
    v_cvt_pk_bf16_f32 v55, v77, v85
    v_cvt_pk_bf16_f32 v59, v78, v86
    v_cvt_pk_bf16_f32 v67, v79, v87
    v_cvt_pk_bf16_f32 v71, v82, v90
    v_cvt_pk_bf16_f32 v75, v80, v88
    s_add_u32 s28, s28, 1
    s_waitcnt lgkmcnt(0)
    s_barrier
    s_cmp_eq_u32 s22, 1
    s_cbranch_scc1 L_conv1_kernel_hlast2
    s_cmp_lt_u32 s28, 12
    s_cselect_b32 s24, 0, 2130706432
    ds_write_b128 v96, v[64:67] offset:57344
    ds_write_b128 v97, v[68:71] offset:8192
    ds_write_b128 v97, v[72:75] offset:24576
    ds_write_b128 v96, v[48:51] offset:8192
    ds_write_b128 v96, v[52:55] offset:24576
    ds_write_b128 v96, v[56:59] offset:40960
    ds_write_b128 v98, v[60:63] offset:8704
    s_waitcnt vmcnt(0)
    buffer_load_dwordx4 v[32:35], v92, s[8:11], s24 offen offset:0
    buffer_load_dwordx4 v[48:51], v92, s[8:11], s24 offen offset:64
    v_add_u32 v92, 128, v92
    buffer_load_dwordx4 v[36:39], v93, s[8:11], s24 offen offset:0
    buffer_load_dwordx4 v[52:55], v93, s[8:11], s24 offen offset:64
    v_add_u32 v93, 128, v93
    v_lshlrev_b32 v76, 16, v0
    v_and_b32 v84, s25, v0
    v_lshlrev_b32 v77, 16, v4
    v_and_b32 v85, s25, v4
    v_lshlrev_b32 v78, 16, v8
    v_and_b32 v86, s25, v8
    v_lshlrev_b32 v79, 16, v12
    v_and_b32 v87, s25, v12
    v_add_f32 v80, v76, v78
    v_add_f32 v88, v84, v86
    v_add_f32 v81, v77, v79
    v_add_f32 v89, v85, v87
    v_fma_f32 v82, v78, 4.0, v76
    v_fma_f32 v90, v86, 4.0, v84
    v_fma_f32 v83, v79, 4.0, v77
    v_fma_f32 v91, v87, 4.0, v85
    v_add_f32 v77, v80, v81
    v_add_f32 v85, v88, v89
    v_sub_f32 v78, v80, v81
    v_sub_f32 v86, v88, v89
    v_fma_f32 v79, v83, 2.0, v82
    v_fma_f32 v87, v91, 2.0, v90
    v_fma_f32 v82, v83, -2.0, v82
    v_fma_f32 v90, v91, -2.0, v90
    v_fmamk_f32 v80, v76, 0x41700000, v82
    v_fmamk_f32 v88, v84, 0x41700000, v90
    v_fmamk_f32 v80, v81, 0x41200000, v80
    v_fmamk_f32 v88, v89, 0x41200000, v88
    v_cvt_pk_bf16_f32 v4, v77, v85
    v_cvt_pk_bf16_f32 v8, v78, v86
    v_cvt_pk_bf16_f32 v64, v79, v87
    v_cvt_pk_bf16_f32 v68, v82, v90
    v_cvt_pk_bf16_f32 v72, v80, v88
    v_lshlrev_b32 v76, 16, v1
    v_and_b32 v84, s25, v1
    v_lshlrev_b32 v77, 16, v5
    v_and_b32 v85, s25, v5
    v_lshlrev_b32 v78, 16, v9
    v_and_b32 v86, s25, v9
    v_lshlrev_b32 v79, 16, v13
    v_and_b32 v87, s25, v13
    v_add_f32 v80, v76, v78
    v_add_f32 v88, v84, v86
    v_add_f32 v81, v77, v79
    v_add_f32 v89, v85, v87
    v_fma_f32 v82, v78, 4.0, v76
    v_fma_f32 v90, v86, 4.0, v84
    v_fma_f32 v83, v79, 4.0, v77
    v_fma_f32 v91, v87, 4.0, v85
    v_add_f32 v77, v80, v81
    v_add_f32 v85, v88, v89
    v_sub_f32 v78, v80, v81
    v_sub_f32 v86, v88, v89
    v_fma_f32 v79, v83, 2.0, v82
    v_fma_f32 v87, v91, 2.0, v90
    v_fma_f32 v82, v83, -2.0, v82
    v_fma_f32 v90, v91, -2.0, v90
    v_fmamk_f32 v80, v76, 0x41700000, v82
    v_fmamk_f32 v88, v84, 0x41700000, v90
    v_fmamk_f32 v80, v81, 0x41200000, v80
    v_fmamk_f32 v88, v89, 0x41200000, v88
    v_cvt_pk_bf16_f32 v5, v77, v85
    v_cvt_pk_bf16_f32 v9, v78, v86
    v_cvt_pk_bf16_f32 v65, v79, v87
    v_cvt_pk_bf16_f32 v69, v82, v90
    v_cvt_pk_bf16_f32 v73, v80, v88
    v_lshlrev_b32 v76, 16, v2
    v_and_b32 v84, s25, v2
    v_lshlrev_b32 v77, 16, v6
    v_and_b32 v85, s25, v6
    v_lshlrev_b32 v78, 16, v10
    v_and_b32 v86, s25, v10
    v_lshlrev_b32 v79, 16, v14
    v_and_b32 v87, s25, v14
    v_add_f32 v80, v76, v78
    v_add_f32 v88, v84, v86
    v_add_f32 v81, v77, v79
    v_add_f32 v89, v85, v87
    v_fma_f32 v82, v78, 4.0, v76
    v_fma_f32 v90, v86, 4.0, v84
    v_fma_f32 v83, v79, 4.0, v77
    v_fma_f32 v91, v87, 4.0, v85
    v_add_f32 v77, v80, v81
    v_add_f32 v85, v88, v89
    v_sub_f32 v78, v80, v81
    v_sub_f32 v86, v88, v89
    v_fma_f32 v79, v83, 2.0, v82
    v_fma_f32 v87, v91, 2.0, v90
    v_fma_f32 v82, v83, -2.0, v82
    v_fma_f32 v90, v91, -2.0, v90
    v_fmamk_f32 v80, v76, 0x41700000, v82
    v_fmamk_f32 v88, v84, 0x41700000, v90
    v_fmamk_f32 v80, v81, 0x41200000, v80
    v_fmamk_f32 v88, v89, 0x41200000, v88
    v_cvt_pk_bf16_f32 v6, v77, v85
    v_cvt_pk_bf16_f32 v10, v78, v86
    v_cvt_pk_bf16_f32 v66, v79, v87
    v_cvt_pk_bf16_f32 v70, v82, v90
    v_cvt_pk_bf16_f32 v74, v80, v88
    v_lshlrev_b32 v76, 16, v3
    v_and_b32 v84, s25, v3
    v_lshlrev_b32 v77, 16, v7
    v_and_b32 v85, s25, v7
    v_lshlrev_b32 v78, 16, v11
    v_and_b32 v86, s25, v11
    v_lshlrev_b32 v79, 16, v15
    v_and_b32 v87, s25, v15
    v_add_f32 v80, v76, v78
    v_add_f32 v88, v84, v86
    v_add_f32 v81, v77, v79
    v_add_f32 v89, v85, v87
    v_fma_f32 v82, v78, 4.0, v76
    v_fma_f32 v90, v86, 4.0, v84
    v_fma_f32 v83, v79, 4.0, v77
    v_fma_f32 v91, v87, 4.0, v85
    v_add_f32 v77, v80, v81
    v_add_f32 v85, v88, v89
    v_sub_f32 v78, v80, v81
    v_sub_f32 v86, v88, v89
    v_fma_f32 v79, v83, 2.0, v82
    v_fma_f32 v87, v91, 2.0, v90
    v_fma_f32 v82, v83, -2.0, v82
    v_fma_f32 v90, v91, -2.0, v90
    v_fmamk_f32 v80, v76, 0x41700000, v82
    v_fmamk_f32 v88, v84, 0x41700000, v90
    v_fmamk_f32 v80, v81, 0x41200000, v80
    v_fmamk_f32 v88, v89, 0x41200000, v88
    v_cvt_pk_bf16_f32 v7, v77, v85
    v_cvt_pk_bf16_f32 v11, v78, v86
    v_cvt_pk_bf16_f32 v67, v79, v87
    v_cvt_pk_bf16_f32 v71, v82, v90
    v_cvt_pk_bf16_f32 v75, v80, v88
    s_add_u32 s28, s28, 1
    s_waitcnt lgkmcnt(0)
    s_barrier
    s_cmp_lt_u32 s28, 12
    s_cselect_b32 s24, 0, 2130706432
    ds_write_b128 v96, v[64:67] offset:49152
    ds_write_b128 v97, v[68:71] offset:0
    ds_write_b128 v97, v[72:75] offset:16384
    ds_write_b128 v96, v[0:3] offset:0
    ds_write_b128 v96, v[4:7] offset:16384
    ds_write_b128 v96, v[8:11] offset:32768
    ds_write_b128 v98, v[12:15] offset:0
    buffer_load_dwordx4 v[40:43], v94, s[8:11], s24 offen offset:0
    buffer_load_dwordx4 v[56:59], v94, s[8:11], s24 offen offset:64
    v_add_u32 v94, 128, v94
    buffer_load_dwordx4 v[44:47], v95, s[8:11], s24 offen offset:0
    buffer_load_dwordx4 v[60:63], v95, s[8:11], s24 offen offset:64
    v_add_u32 v95, 128, v95
    v_lshlrev_b32 v76, 16, v16
    v_and_b32 v84, s25, v16
    v_lshlrev_b32 v77, 16, v20
    v_and_b32 v85, s25, v20
    v_lshlrev_b32 v78, 16, v24
    v_and_b32 v86, s25, v24
    v_lshlrev_b32 v79, 16, v28
    v_and_b32 v87, s25, v28
    v_add_f32 v80, v76, v78
    v_add_f32 v88, v84, v86
    v_add_f32 v81, v77, v79
    v_add_f32 v89, v85, v87
    v_fma_f32 v82, v78, 4.0, v76
    v_fma_f32 v90, v86, 4.0, v84
    v_fma_f32 v83, v79, 4.0, v77
    v_fma_f32 v91, v87, 4.0, v85
    v_add_f32 v77, v80, v81
    v_add_f32 v85, v88, v89
    v_sub_f32 v78, v80, v81
    v_sub_f32 v86, v88, v89
    v_fma_f32 v79, v83, 2.0, v82
    v_fma_f32 v87, v91, 2.0, v90
    v_fma_f32 v82, v83, -2.0, v82
    v_fma_f32 v90, v91, -2.0, v90
    v_fmamk_f32 v80, v76, 0x41700000, v82
    v_fmamk_f32 v88, v84, 0x41700000, v90
    v_fmamk_f32 v80, v81, 0x41200000, v80
    v_fmamk_f32 v88, v89, 0x41200000, v88
    v_cvt_pk_bf16_f32 v20, v77, v85
    v_cvt_pk_bf16_f32 v24, v78, v86
    v_cvt_pk_bf16_f32 v64, v79, v87
    v_cvt_pk_bf16_f32 v68, v82, v90
    v_cvt_pk_bf16_f32 v72, v80, v88
    v_lshlrev_b32 v76, 16, v17
    v_and_b32 v84, s25, v17
    v_lshlrev_b32 v77, 16, v21
    v_and_b32 v85, s25, v21
    v_lshlrev_b32 v78, 16, v25
    v_and_b32 v86, s25, v25
    v_lshlrev_b32 v79, 16, v29
    v_and_b32 v87, s25, v29
    v_add_f32 v80, v76, v78
    v_add_f32 v88, v84, v86
    v_add_f32 v81, v77, v79
    v_add_f32 v89, v85, v87
    v_fma_f32 v82, v78, 4.0, v76
    v_fma_f32 v90, v86, 4.0, v84
    v_fma_f32 v83, v79, 4.0, v77
    v_fma_f32 v91, v87, 4.0, v85
    v_add_f32 v77, v80, v81
    v_add_f32 v85, v88, v89
    v_sub_f32 v78, v80, v81
    v_sub_f32 v86, v88, v89
    v_fma_f32 v79, v83, 2.0, v82
    v_fma_f32 v87, v91, 2.0, v90
    v_fma_f32 v82, v83, -2.0, v82
    v_fma_f32 v90, v91, -2.0, v90
    v_fmamk_f32 v80, v76, 0x41700000, v82
    v_fmamk_f32 v88, v84, 0x41700000, v90
    v_fmamk_f32 v80, v81, 0x41200000, v80
    v_fmamk_f32 v88, v89, 0x41200000, v88
    v_cvt_pk_bf16_f32 v21, v77, v85
    v_cvt_pk_bf16_f32 v25, v78, v86
    v_cvt_pk_bf16_f32 v65, v79, v87
    v_cvt_pk_bf16_f32 v69, v82, v90
    v_cvt_pk_bf16_f32 v73, v80, v88
    v_lshlrev_b32 v76, 16, v18
    v_and_b32 v84, s25, v18
    v_lshlrev_b32 v77, 16, v22
    v_and_b32 v85, s25, v22
    v_lshlrev_b32 v78, 16, v26
    v_and_b32 v86, s25, v26
    v_lshlrev_b32 v79, 16, v30
    v_and_b32 v87, s25, v30
    v_add_f32 v80, v76, v78
    v_add_f32 v88, v84, v86
    v_add_f32 v81, v77, v79
    v_add_f32 v89, v85, v87
    v_fma_f32 v82, v78, 4.0, v76
    v_fma_f32 v90, v86, 4.0, v84
    v_fma_f32 v83, v79, 4.0, v77
    v_fma_f32 v91, v87, 4.0, v85
    v_add_f32 v77, v80, v81
    v_add_f32 v85, v88, v89
    v_sub_f32 v78, v80, v81
    v_sub_f32 v86, v88, v89
    v_fma_f32 v79, v83, 2.0, v82
    v_fma_f32 v87, v91, 2.0, v90
    v_fma_f32 v82, v83, -2.0, v82
    v_fma_f32 v90, v91, -2.0, v90
    v_fmamk_f32 v80, v76, 0x41700000, v82
    v_fmamk_f32 v88, v84, 0x41700000, v90
    v_fmamk_f32 v80, v81, 0x41200000, v80
    v_fmamk_f32 v88, v89, 0x41200000, v88
    v_cvt_pk_bf16_f32 v22, v77, v85
    v_cvt_pk_bf16_f32 v26, v78, v86
    v_cvt_pk_bf16_f32 v66, v79, v87
    v_cvt_pk_bf16_f32 v70, v82, v90
    v_cvt_pk_bf16_f32 v74, v80, v88
    v_lshlrev_b32 v76, 16, v19
    v_and_b32 v84, s25, v19
    v_lshlrev_b32 v77, 16, v23
    v_and_b32 v85, s25, v23
    v_lshlrev_b32 v78, 16, v27
    v_and_b32 v86, s25, v27
    v_lshlrev_b32 v79, 16, v31
    v_and_b32 v87, s25, v31
    v_add_f32 v80, v76, v78
    v_add_f32 v88, v84, v86
    v_add_f32 v81, v77, v79
    v_add_f32 v89, v85, v87
    v_fma_f32 v82, v78, 4.0, v76
    v_fma_f32 v90, v86, 4.0, v84
    v_fma_f32 v83, v79, 4.0, v77
    v_fma_f32 v91, v87, 4.0, v85
    v_add_f32 v77, v80, v81
    v_add_f32 v85, v88, v89
    v_sub_f32 v78, v80, v81
    v_sub_f32 v86, v88, v89
    v_fma_f32 v79, v83, 2.0, v82
    v_fma_f32 v87, v91, 2.0, v90
    v_fma_f32 v82, v83, -2.0, v82
    v_fma_f32 v90, v91, -2.0, v90
    v_fmamk_f32 v80, v76, 0x41700000, v82
    v_fmamk_f32 v88, v84, 0x41700000, v90
    v_fmamk_f32 v80, v81, 0x41200000, v80
    v_fmamk_f32 v88, v89, 0x41200000, v88
    v_cvt_pk_bf16_f32 v23, v77, v85
    v_cvt_pk_bf16_f32 v27, v78, v86
    v_cvt_pk_bf16_f32 v67, v79, v87
    v_cvt_pk_bf16_f32 v71, v82, v90
    v_cvt_pk_bf16_f32 v75, v80, v88
    s_add_u32 s28, s28, 1
    s_waitcnt lgkmcnt(0)
    s_barrier
    s_sub_u32 s22, s22, 1
    s_branch L_conv1_kernel_hloop2
L_conv1_kernel_hlast2:
    s_waitcnt vmcnt(0)
    s_mov_b32 s58, s20
    s_lshl_b32 s20, s2, 2
    s_add_u32 s20, s20, s32
    v_mov_b32 v1, v127
    s_load_dwordx2 s[8:9], s[0:1], 16
    s_lshr_b32 s22, s20, 8
    s_bfe_u32 s23, s20, 0x40004
    s_bfe_u32 s24, s20, 0x30001
    s_and_b32 s21, s20, 1
    v_lshrrev_b32 v2, 4, v1
    v_lshlrev_b32 v2, 12, v2
    v_and_b32 v3, 15, v1
    v_lshl_add_u32 v2, v3, 2, v2
    s_lshl_b32 s26, s22, 3
    s_lshr_b32 s27, s23, 3
    s_add_u32 s26, s26, s27
    s_lshl_b32 s26, s26, 17
    s_and_b32 s27, s23, 7
    s_lshl_b32 s27, s27, 14
    s_add_u32 s26, s26, s27
    s_lshl_b32 s27, s24, 6
    s_add_u32 s26, s26, s27
    s_mov_b32 s10, 4063232
    s_mov_b32 s11, 0x00020000
    s_add_u32 s37, s26, 262144
    s_add_u32 s38, s26, 524288
    s_add_u32 s39, s26, 786432
    s_waitcnt lgkmcnt(0)
    buffer_load_dword v16, v2, s[8:11], s26 offen offset:0
    buffer_load_dword v17, v2, s[8:11], s26 offen offset:512
    buffer_load_dword v24, v2, s[8:11], s37 offen offset:0
    buffer_load_dword v25, v2, s[8:11], s37 offen offset:512
    buffer_load_dword v32, v2, s[8:11], s38 offen offset:0
    buffer_load_dword v33, v2, s[8:11], s38 offen offset:512
    buffer_load_dword v40, v2, s[8:11], s39 offen offset:0
    buffer_load_dword v41, v2, s[8:11], s39 offen offset:512
    buffer_load_dword v18, v2, s[8:11], s26 offen offset:1024
    buffer_load_dword v19, v2, s[8:11], s26 offen offset:1536
    buffer_load_dword v26, v2, s[8:11], s37 offen offset:1024
    buffer_load_dword v27, v2, s[8:11], s37 offen offset:1536
    buffer_load_dword v34, v2, s[8:11], s38 offen offset:1024
    buffer_load_dword v35, v2, s[8:11], s38 offen offset:1536
    buffer_load_dword v42, v2, s[8:11], s39 offen offset:1024
    buffer_load_dword v43, v2, s[8:11], s39 offen offset:1536
    buffer_load_dword v20, v2, s[8:11], s26 offen offset:2048
    buffer_load_dword v21, v2, s[8:11], s26 offen offset:2560
    buffer_load_dword v28, v2, s[8:11], s37 offen offset:2048
    buffer_load_dword v29, v2, s[8:11], s37 offen offset:2560
    buffer_load_dword v36, v2, s[8:11], s38 offen offset:2048
    buffer_load_dword v37, v2, s[8:11], s38 offen offset:2560
    buffer_load_dword v44, v2, s[8:11], s39 offen offset:2048
    buffer_load_dword v45, v2, s[8:11], s39 offen offset:2560
    buffer_load_dword v22, v2, s[8:11], s26 offen offset:3072
    buffer_load_dword v23, v2, s[8:11], s26 offen offset:3584
    buffer_load_dword v30, v2, s[8:11], s37 offen offset:3072
    buffer_load_dword v31, v2, s[8:11], s37 offen offset:3584
    buffer_load_dword v38, v2, s[8:11], s38 offen offset:3072
    buffer_load_dword v39, v2, s[8:11], s38 offen offset:3584
    buffer_load_dword v46, v2, s[8:11], s39 offen offset:3072
    buffer_load_dword v47, v2, s[8:11], s39 offen offset:3584
    s_add_u32 s12, s30, 9437184
    s_addc_u32 s13, s31, 0
    s_mov_b32 s14, 7340032
    s_mov_b32 s15, 0x00020000
    v_lshlrev_b32 v4, 4, v1
    s_lshl_b32 s27, s24, 4
    s_add_u32 s27, s27, s23
    s_mul_i32 s27, s27, 57344
    s_lshl_b32 s28, s22, 11
    s_add_u32 s27, s27, s28
    s_lshl_b32 s28, s21, 10
    s_add_u32 s27, s27, s28
    s_cmp_eq_u32 s21, 0
    s_mov_b32 s32, 0x07060302
    s_cselect_b32 s32, 0x05040100, s32
    s_mov_b32 s33, 0x03020c0c
    s_cselect_b32 s33, 0x01000c0c, s33
    s_mov_b32 s35, 0x3d2aaaab
    s_mov_b32 s36, 0x3c638e39
    s_mov_b32 s25, 0xffff0000
    ds_write_b128 v96, v[64:67] offset:57344
    ds_write_b128 v97, v[68:71] offset:8192
    ds_write_b128 v97, v[72:75] offset:24576
    ds_write_b128 v96, v[48:51] offset:8192
    ds_write_b128 v96, v[52:55] offset:24576
    ds_write_b128 v96, v[56:59] offset:40960
    ds_write_b128 v98, v[60:63] offset:8704
    s_waitcnt lgkmcnt(0)
    s_barrier
    s_waitcnt vmcnt(24)
    v_perm_b32 v72, v17, v16, s32
    v_perm_b32 v48, v41, v40, s32
    v_perm_b32 v76, v76, v40, s33
    v_perm_b32 v84, v84, v41, s33
    v_perm_b32 v77, v77, v32, s33
    v_perm_b32 v85, v85, v33, s33
    v_perm_b32 v78, v78, v24, s33
    v_perm_b32 v86, v86, v25, s33
    v_perm_b32 v79, v79, v16, s33
    v_perm_b32 v87, v87, v17, s33
    v_add_f32 v80, v76, v78
    v_add_f32 v88, v84, v86
    v_add_f32 v81, v77, v79
    v_add_f32 v89, v85, v87
    v_fma_f32 v82, v78, 4.0, v76
    v_fma_f32 v90, v86, 4.0, v84
    v_fma_f32 v83, v79, 4.0, v77
    v_fma_f32 v91, v87, 4.0, v85
    v_add_f32 v77, v80, v81
    v_add_f32 v85, v88, v89
    v_sub_f32 v78, v80, v81
    v_sub_f32 v86, v88, v89
    v_fma_f32 v79, v83, 2.0, v82
    v_fma_f32 v87, v91, 2.0, v90
    v_fma_f32 v82, v83, -2.0, v82
    v_fma_f32 v90, v91, -2.0, v90
    v_fmamk_f32 v80, v76, 0x41700000, v82
    v_fmamk_f32 v88, v84, 0x41700000, v90
    v_fmamk_f32 v80, v81, 0x41200000, v80
    v_fmamk_f32 v88, v89, 0x41200000, v88
    v_mul_f32 v77, 0.5, v77
    v_mul_f32 v85, 0.5, v85
    v_mul_f32 v78, 0.5, v78
    v_mul_f32 v86, 0.5, v86
    v_mul_f32 v79, s35, v79
    v_mul_f32 v87, s35, v87
    v_mul_f32 v82, s35, v82
    v_mul_f32 v90, s35, v90
    v_mul_f32 v80, s36, v80
    v_mul_f32 v88, s36, v88
    v_cvt_pk_bf16_f32 v52, v77, v85
    v_cvt_pk_bf16_f32 v56, v78, v86
    v_cvt_pk_bf16_f32 v60, v79, v87
    v_cvt_pk_bf16_f32 v64, v82, v90
    v_cvt_pk_bf16_f32 v68, v80, v88
    s_waitcnt vmcnt(16)
    v_perm_b32 v73, v19, v18, s32
    v_perm_b32 v49, v43, v42, s32
    v_perm_b32 v76, v76, v42, s33
    v_perm_b32 v84, v84, v43, s33
    v_perm_b32 v77, v77, v34, s33
    v_perm_b32 v85, v85, v35, s33
    v_perm_b32 v78, v78, v26, s33
    v_perm_b32 v86, v86, v27, s33
    v_perm_b32 v79, v79, v18, s33
    v_perm_b32 v87, v87, v19, s33
    v_add_f32 v80, v76, v78
    v_add_f32 v88, v84, v86
    v_add_f32 v81, v77, v79
    v_add_f32 v89, v85, v87
    v_fma_f32 v82, v78, 4.0, v76
    v_fma_f32 v90, v86, 4.0, v84
    v_fma_f32 v83, v79, 4.0, v77
    v_fma_f32 v91, v87, 4.0, v85
    v_add_f32 v77, v80, v81
    v_add_f32 v85, v88, v89
    v_sub_f32 v78, v80, v81
    v_sub_f32 v86, v88, v89
    v_fma_f32 v79, v83, 2.0, v82
    v_fma_f32 v87, v91, 2.0, v90
    v_fma_f32 v82, v83, -2.0, v82
    v_fma_f32 v90, v91, -2.0, v90
    v_fmamk_f32 v80, v76, 0x41700000, v82
    v_fmamk_f32 v88, v84, 0x41700000, v90
    v_fmamk_f32 v80, v81, 0x41200000, v80
    v_fmamk_f32 v88, v89, 0x41200000, v88
    v_mul_f32 v77, 0.5, v77
    v_mul_f32 v85, 0.5, v85
    v_mul_f32 v78, 0.5, v78
    v_mul_f32 v86, 0.5, v86
    v_mul_f32 v79, s35, v79
    v_mul_f32 v87, s35, v87
    v_mul_f32 v82, s35, v82
    v_mul_f32 v90, s35, v90
    v_mul_f32 v80, s36, v80
    v_mul_f32 v88, s36, v88
    v_cvt_pk_bf16_f32 v53, v77, v85
    v_cvt_pk_bf16_f32 v57, v78, v86
    v_cvt_pk_bf16_f32 v61, v79, v87
    v_cvt_pk_bf16_f32 v65, v82, v90
    v_cvt_pk_bf16_f32 v69, v80, v88
    s_waitcnt vmcnt(8)
    v_perm_b32 v74, v21, v20, s32
    v_perm_b32 v50, v45, v44, s32
    v_perm_b32 v76, v76, v44, s33
    v_perm_b32 v84, v84, v45, s33
    v_perm_b32 v77, v77, v36, s33
    v_perm_b32 v85, v85, v37, s33
    v_perm_b32 v78, v78, v28, s33
    v_perm_b32 v86, v86, v29, s33
    v_perm_b32 v79, v79, v20, s33
    v_perm_b32 v87, v87, v21, s33
    v_add_f32 v80, v76, v78
    v_add_f32 v88, v84, v86
    v_add_f32 v81, v77, v79
    v_add_f32 v89, v85, v87
    v_fma_f32 v82, v78, 4.0, v76
    v_fma_f32 v90, v86, 4.0, v84
    v_fma_f32 v83, v79, 4.0, v77
    v_fma_f32 v91, v87, 4.0, v85
    v_add_f32 v77, v80, v81
    v_add_f32 v85, v88, v89
    v_sub_f32 v78, v80, v81
    v_sub_f32 v86, v88, v89
    v_fma_f32 v79, v83, 2.0, v82
    v_fma_f32 v87, v91, 2.0, v90
    v_fma_f32 v82, v83, -2.0, v82
    v_fma_f32 v90, v91, -2.0, v90
    v_fmamk_f32 v80, v76, 0x41700000, v82
    v_fmamk_f32 v88, v84, 0x41700000, v90
    v_fmamk_f32 v80, v81, 0x41200000, v80
    v_fmamk_f32 v88, v89, 0x41200000, v88
    v_mul_f32 v77, 0.5, v77
    v_mul_f32 v85, 0.5, v85
    v_mul_f32 v78, 0.5, v78
    v_mul_f32 v86, 0.5, v86
    v_mul_f32 v79, s35, v79
    v_mul_f32 v87, s35, v87
    v_mul_f32 v82, s35, v82
    v_mul_f32 v90, s35, v90
    v_mul_f32 v80, s36, v80
    v_mul_f32 v88, s36, v88
    v_cvt_pk_bf16_f32 v54, v77, v85
    v_cvt_pk_bf16_f32 v58, v78, v86
    v_cvt_pk_bf16_f32 v62, v79, v87
    v_cvt_pk_bf16_f32 v66, v82, v90
    v_cvt_pk_bf16_f32 v70, v80, v88
    s_waitcnt vmcnt(0)
    v_perm_b32 v75, v23, v22, s32
    v_perm_b32 v51, v47, v46, s32
    v_perm_b32 v76, v76, v46, s33
    v_perm_b32 v84, v84, v47, s33
    v_perm_b32 v77, v77, v38, s33
    v_perm_b32 v85, v85, v39, s33
    v_perm_b32 v78, v78, v30, s33
    v_perm_b32 v86, v86, v31, s33
    v_perm_b32 v79, v79, v22, s33
    v_perm_b32 v87, v87, v23, s33
    v_add_f32 v80, v76, v78
    v_add_f32 v88, v84, v86
    v_add_f32 v81, v77, v79
    v_add_f32 v89, v85, v87
    v_fma_f32 v82, v78, 4.0, v76
    v_fma_f32 v90, v86, 4.0, v84
    v_fma_f32 v83, v79, 4.0, v77
    v_fma_f32 v91, v87, 4.0, v85
    v_add_f32 v77, v80, v81
    v_add_f32 v85, v88, v89
    v_sub_f32 v78, v80, v81
    v_sub_f32 v86, v88, v89
    v_fma_f32 v79, v83, 2.0, v82
    v_fma_f32 v87, v91, 2.0, v90
    v_fma_f32 v82, v83, -2.0, v82
    v_fma_f32 v90, v91, -2.0, v90
    v_fmamk_f32 v80, v76, 0x41700000, v82
    v_fmamk_f32 v88, v84, 0x41700000, v90
    v_fmamk_f32 v80, v81, 0x41200000, v80
    v_fmamk_f32 v88, v89, 0x41200000, v88
    v_mul_f32 v77, 0.5, v77
    v_mul_f32 v85, 0.5, v85
    v_mul_f32 v78, 0.5, v78
    v_mul_f32 v86, 0.5, v86
    v_mul_f32 v79, s35, v79
    v_mul_f32 v87, s35, v87
    v_mul_f32 v82, s35, v82
    v_mul_f32 v90, s35, v90
    v_mul_f32 v80, s36, v80
    v_mul_f32 v88, s36, v88
    v_cvt_pk_bf16_f32 v55, v77, v85
    v_cvt_pk_bf16_f32 v59, v78, v86
    v_cvt_pk_bf16_f32 v63, v79, v87
    v_cvt_pk_bf16_f32 v67, v82, v90
    v_cvt_pk_bf16_f32 v71, v80, v88
    s_add_u32 s28, s27, 49152
    buffer_store_dwordx4 v[72:75], v4, s[12:15], s28 offen sc1
    s_add_u32 s28, s27, 0
    buffer_store_dwordx4 v[48:51], v4, s[12:15], s28 offen sc1
    s_add_u32 s28, s27, 8192
    buffer_store_dwordx4 v[52:55], v4, s[12:15], s28 offen sc1
    s_add_u32 s28, s27, 16384
    buffer_store_dwordx4 v[56:59], v4, s[12:15], s28 offen sc1
    s_add_u32 s28, s27, 24576
    buffer_store_dwordx4 v[60:63], v4, s[12:15], s28 offen sc1
    s_add_u32 s28, s27, 32768
    buffer_store_dwordx4 v[64:67], v4, s[12:15], s28 offen sc1
    s_add_u32 s28, s27, 40960
    buffer_store_dwordx4 v[68:71], v4, s[12:15], s28 offen sc1
    s_mov_b32 s20, s58
    s_branch L_conv1_kernel_end
L_conv1_kernel_epi:
    s_waitcnt lgkmcnt(0)
    s_barrier
    v_cndmask_b32 v122, v111, v110, vcc
    ds_read_b128 v[0:3], v120 offset:0
    ds_read_b128 v[4:7], v120 offset:16384
    ds_read_b128 v[8:11], v120 offset:32768
    ds_read_b128 v[12:15], v120 offset:49152
    ds_read_b128 v[16:19], v121 offset:0
    ds_read_b128 v[20:23], v121 offset:16384
    ds_read_b128 v[24:27], v121 offset:32768
    ds_read_b128 v[28:31], v64 offset:15360
    ds_read_b128 v[32:35], v120 offset:8192
    ds_read_b128 v[36:39], v120 offset:24576
    ds_read_b128 v[40:43], v120 offset:40960
    ds_read_b128 v[44:47], v120 offset:57344
    ds_read_b128 v[48:51], v121 offset:56320
    ds_read_b128 v[52:55], v121 offset:64512
    ds_read_b128 v[56:59], v64 offset:7168
    s_waitcnt lgkmcnt(7)
    ds_read_b128 v[60:63], v64 offset:23552
    s_waitcnt lgkmcnt(8)
    v_pk_add_f32 v[88:89], v[24:25], v[28:29]
    v_pk_add_f32 v[90:91], v[26:27], v[30:31]
    v_pk_add_f32 v[24:25], v[4:5], v[8:9]
    v_pk_add_f32 v[26:27], v[6:7], v[10:11]
    v_pk_add_f32 v[4:5], v[4:5], v[8:9] neg_lo:[0,1] neg_hi:[0,1]
    v_pk_add_f32 v[6:7], v[6:7], v[10:11] neg_lo:[0,1] neg_hi:[0,1]
    v_pk_add_f32 v[72:73], v[12:13], v[16:17]
    v_pk_add_f32 v[74:75], v[14:15], v[18:19]
    v_pk_add_f32 v[12:13], v[12:13], v[16:17] neg_lo:[0,1] neg_hi:[0,1]
    v_pk_add_f32 v[14:15], v[14:15], v[18:19] neg_lo:[0,1] neg_hi:[0,1]
    v_pk_fma_f32 v[72:73], v[24:25], s[4:5], v[72:73]
    v_pk_fma_f32 v[74:75], v[26:27], s[4:5], v[74:75]
    v_pk_fma_f32 v[20:21], v[0:1], s[10:11], v[20:21]
    v_pk_fma_f32 v[22:23], v[2:3], s[10:11], v[22:23]
    v_pk_fma_f32 v[72:73], v[0:1], s[6:7], v[72:73]
    v_pk_fma_f32 v[74:75], v[2:3], s[6:7], v[74:75]
    v_pk_add_f32 v[24:25], v[24:25], v[0:1] neg_lo:[0,1] neg_hi:[0,1]
    v_pk_add_f32 v[26:27], v[26:27], v[2:3] neg_lo:[0,1] neg_hi:[0,1]
    v_pk_fma_f32 v[72:73], v[88:89], s[8:9], v[72:73]
    v_pk_fma_f32 v[74:75], v[90:91], s[8:9], v[74:75]
    v_pk_add_f32 v[24:25], v[24:25], v[88:89] neg_lo:[0,1] neg_hi:[0,1]
    v_pk_add_f32 v[26:27], v[26:27], v[90:91] neg_lo:[0,1] neg_hi:[0,1]
    v_pk_fma_f32 v[20:21], v[88:89], s[22:23], v[20:21]
    v_pk_fma_f32 v[22:23], v[90:91], s[22:23], v[22:23]
    v_pk_add_f32 v[8:9], v[24:25], v[72:73] neg_lo:[0,1] neg_hi:[0,1]
    v_pk_add_f32 v[10:11], v[26:27], v[74:75] neg_lo:[0,1] neg_hi:[0,1]
    v_pk_fma_f32 v[20:21], v[72:73], s[14:15], v[20:21]
    v_pk_fma_f32 v[22:23], v[74:75], s[14:15], v[22:23]
    v_pk_mul_f32 v[80:81], v[12:13], s[32:33]
    v_pk_mul_f32 v[82:83], v[14:15], s[32:33]
    v_pk_fma_f32 v[20:21], v[8:9], s[12:13], v[20:21]
    v_pk_fma_f32 v[22:23], v[10:11], s[12:13], v[22:23]
    v_pk_fma_f32 v[80:81], v[4:5], s[34:35], v[80:81]
    v_pk_fma_f32 v[82:83], v[6:7], s[34:35], v[82:83]
    v_pk_fma_f32 v[64:65], v[4:5], s[24:25], v[20:21] neg_lo:[0,0,1] neg_hi:[0,0,1]
    v_pk_fma_f32 v[66:67], v[6:7], s[24:25], v[22:23] neg_lo:[0,0,1] neg_hi:[0,0,1]
    v_pk_fma_f32 v[64:65], v[12:13], s[26:27], v[64:65]
    v_pk_fma_f32 v[66:67], v[14:15], s[26:27], v[66:67]
    v_pk_fma_f32 v[80:81], v[64:65], s[38:39], v[80:81]
    v_pk_fma_f32 v[82:83], v[66:67], s[38:39], v[82:83]
    v_pk_add_f32 v[4:5], v[4:5], v[64:65] neg_lo:[0,1] neg_hi:[0,1]
    v_pk_add_f32 v[6:7], v[6:7], v[66:67] neg_lo:[0,1] neg_hi:[0,1]
    v_pk_add_f32 v[4:5], v[4:5], v[80:81] neg_lo:[0,1] neg_hi:[0,1]
    v_pk_add_f32 v[6:7], v[6:7], v[82:83] neg_lo:[0,1] neg_hi:[0,1]
    s_waitcnt lgkmcnt(0)
    v_pk_add_f32 v[92:93], v[56:57], v[60:61]
    v_pk_add_f32 v[94:95], v[58:59], v[62:63]
    v_pk_add_f32 v[56:57], v[36:37], v[40:41]
    v_pk_add_f32 v[58:59], v[38:39], v[42:43]
    v_pk_add_f32 v[36:37], v[36:37], v[40:41] neg_lo:[0,1] neg_hi:[0,1]
    v_pk_add_f32 v[38:39], v[38:39], v[42:43] neg_lo:[0,1] neg_hi:[0,1]
    v_pk_add_f32 v[76:77], v[44:45], v[48:49]
    v_pk_add_f32 v[78:79], v[46:47], v[50:51]
    v_pk_add_f32 v[44:45], v[44:45], v[48:49] neg_lo:[0,1] neg_hi:[0,1]
    v_pk_add_f32 v[46:47], v[46:47], v[50:51] neg_lo:[0,1] neg_hi:[0,1]
    v_pk_fma_f32 v[76:77], v[56:57], s[4:5], v[76:77]
    v_pk_fma_f32 v[78:79], v[58:59], s[4:5], v[78:79]
    v_pk_fma_f32 v[52:53], v[32:33], s[10:11], v[52:53]
    v_pk_fma_f32 v[54:55], v[34:35], s[10:11], v[54:55]
    v_pk_fma_f32 v[76:77], v[32:33], s[6:7], v[76:77]
    v_pk_fma_f32 v[78:79], v[34:35], s[6:7], v[78:79]
    v_pk_add_f32 v[56:57], v[56:57], v[32:33] neg_lo:[0,1] neg_hi:[0,1]
    v_pk_add_f32 v[58:59], v[58:59], v[34:35] neg_lo:[0,1] neg_hi:[0,1]
    v_pk_fma_f32 v[76:77], v[92:93], s[8:9], v[76:77]
    v_pk_fma_f32 v[78:79], v[94:95], s[8:9], v[78:79]
    v_pk_add_f32 v[56:57], v[56:57], v[92:93] neg_lo:[0,1] neg_hi:[0,1]
    v_pk_add_f32 v[58:59], v[58:59], v[94:95] neg_lo:[0,1] neg_hi:[0,1]
    v_pk_fma_f32 v[52:53], v[92:93], s[22:23], v[52:53]
    v_pk_fma_f32 v[54:55], v[94:95], s[22:23], v[54:55]
    v_pk_add_f32 v[40:41], v[56:57], v[76:77] neg_lo:[0,1] neg_hi:[0,1]
    v_pk_add_f32 v[42:43], v[58:59], v[78:79] neg_lo:[0,1] neg_hi:[0,1]
    v_pk_fma_f32 v[52:53], v[76:77], s[14:15], v[52:53]
    v_pk_fma_f32 v[54:55], v[78:79], s[14:15], v[54:55]
    v_pk_mul_f32 v[84:85], v[44:45], s[32:33]
    v_pk_mul_f32 v[86:87], v[46:47], s[32:33]
    v_pk_fma_f32 v[52:53], v[40:41], s[12:13], v[52:53]
    v_pk_fma_f32 v[54:55], v[42:43], s[12:13], v[54:55]
    v_pk_fma_f32 v[84:85], v[36:37], s[34:35], v[84:85]
    v_pk_fma_f32 v[86:87], v[38:39], s[34:35], v[86:87]
    v_pk_fma_f32 v[68:69], v[36:37], s[24:25], v[52:53] neg_lo:[0,0,1] neg_hi:[0,0,1]
    v_pk_fma_f32 v[70:71], v[38:39], s[24:25], v[54:55] neg_lo:[0,0,1] neg_hi:[0,0,1]
    v_pk_fma_f32 v[68:69], v[44:45], s[26:27], v[68:69]
    v_pk_fma_f32 v[70:71], v[46:47], s[26:27], v[70:71]
    v_pk_fma_f32 v[84:85], v[68:69], s[38:39], v[84:85]
    v_pk_fma_f32 v[86:87], v[70:71], s[38:39], v[86:87]
    v_pk_add_f32 v[36:37], v[36:37], v[68:69] neg_lo:[0,1] neg_hi:[0,1]
    v_pk_add_f32 v[38:39], v[38:39], v[70:71] neg_lo:[0,1] neg_hi:[0,1]
    v_pk_add_f32 v[36:37], v[36:37], v[84:85] neg_lo:[0,1] neg_hi:[0,1]
    v_pk_add_f32 v[38:39], v[38:39], v[86:87] neg_lo:[0,1] neg_hi:[0,1]
    s_mov_b32 s36, 0x00010001
    s_mov_b32 s37, 0x00010001
    s_mov_b64 exec, s[36:37]
    ds_write_b128 v127, v[0:3] offset:0
    ds_write_b128 v127, v[32:35] offset:16
    ds_write_b128 v127, v[4:7] offset:32
    ds_write_b128 v127, v[36:39] offset:48
    ds_write_b128 v127, v[8:11] offset:64
    ds_write_b128 v127, v[40:43] offset:80
    s_mov_b64 exec, -1
    v_mov_b32 v44, 0xc0135761
    v_mov_b32 v45, v44
    v_pk_mul_f32 v[16:17], v[64:65], v[64:65]
    v_pk_mul_f32 v[18:19], v[66:67], v[66:67]
    v_pk_mul_f32 v[20:21], v[68:69], v[68:69]
    v_pk_mul_f32 v[22:23], v[70:71], v[70:71]
    v_pk_fma_f32 v[16:17], v[16:17], s[40:41], v[44:45]
    v_pk_fma_f32 v[18:19], v[18:19], s[40:41], v[44:45]
    v_pk_fma_f32 v[20:21], v[20:21], s[40:41], v[44:45]
    v_pk_fma_f32 v[22:23], v[22:23], s[40:41], v[44:45]
    v_pk_mul_f32 v[16:17], v[16:17], v[64:65]
    v_pk_mul_f32 v[18:19], v[18:19], v[66:67]
    v_pk_mul_f32 v[20:21], v[20:21], v[68:69]
    v_pk_mul_f32 v[22:23], v[22:23], v[70:71]
    v_exp_f32 v16, v16
    v_exp_f32 v17, v17
    v_exp_f32 v18, v18
    v_exp_f32 v19, v19
    v_exp_f32 v20, v20
    v_exp_f32 v21, v21
    v_exp_f32 v22, v22
    v_exp_f32 v23, v23
    v_pk_add_f32 v[16:17], v[16:17], s[42:43]
    v_pk_add_f32 v[18:19], v[18:19], s[42:43]
    v_pk_add_f32 v[20:21], v[20:21], s[42:43]
    v_pk_add_f32 v[22:23], v[22:23], s[42:43]
    v_rcp_f32 v16, v16
    v_rcp_f32 v17, v17
    v_rcp_f32 v18, v18
    v_rcp_f32 v19, v19
    v_rcp_f32 v20, v20
    v_rcp_f32 v21, v21
    v_rcp_f32 v22, v22
    v_rcp_f32 v23, v23
    v_pk_mul_f32 v[64:65], v[64:65], v[16:17]
    v_pk_mul_f32 v[66:67], v[66:67], v[18:19]
    v_pk_mul_f32 v[68:69], v[68:69], v[20:21]
    v_pk_mul_f32 v[70:71], v[70:71], v[22:23]
    v_cvt_pk_bf16_f32 v48, v64, v68
    v_cvt_pk_bf16_f32 v49, v65, v69
    v_cvt_pk_bf16_f32 v50, v66, v70
    v_cvt_pk_bf16_f32 v51, v67, v71
    s_mov_b32 s44, 393280
    buffer_store_dwordx4 v[48:51], v122, s[16:19], s44 offen sc1
    s_waitcnt lgkmcnt(0)
    s_barrier
    ds_read_b128 v[96:99], v127 offset:512
    ds_read_b128 v[100:103], v127 offset:528
    ds_read_b128 v[104:107], v127 offset:544
    ds_read_b128 v[108:111], v127 offset:560
    ds_read_b128 v[112:115], v127 offset:576
    ds_read_b128 v[116:119], v127 offset:592
    s_waitcnt lgkmcnt(4)
    v_mov_b32_dpp v96, v0 row_shl:1 row_mask:0xf bank_mask:0xf
    v_mov_b32_dpp v97, v1 row_shl:1 row_mask:0xf bank_mask:0xf
    v_mov_b32_dpp v98, v2 row_shl:1 row_mask:0xf bank_mask:0xf
    v_mov_b32_dpp v99, v3 row_shl:1 row_mask:0xf bank_mask:0xf
    v_mov_b32_dpp v100, v32 row_shl:1 row_mask:0xf bank_mask:0xf
    v_mov_b32_dpp v101, v33 row_shl:1 row_mask:0xf bank_mask:0xf
    v_mov_b32_dpp v102, v34 row_shl:1 row_mask:0xf bank_mask:0xf
    v_mov_b32_dpp v103, v35 row_shl:1 row_mask:0xf bank_mask:0xf
    v_pk_add_f32 v[72:73], v[72:73], v[96:97]
    v_pk_add_f32 v[74:75], v[74:75], v[98:99]
    v_pk_add_f32 v[76:77], v[76:77], v[100:101]
    v_pk_add_f32 v[78:79], v[78:79], v[102:103]
    v_pk_mul_f32 v[24:25], v[72:73], v[72:73]
    v_pk_mul_f32 v[26:27], v[74:75], v[74:75]
    v_pk_mul_f32 v[28:29], v[76:77], v[76:77]
    v_pk_mul_f32 v[30:31], v[78:79], v[78:79]
    v_pk_fma_f32 v[24:25], v[24:25], s[40:41], v[44:45]
    v_pk_fma_f32 v[26:27], v[26:27], s[40:41], v[44:45]
    v_pk_fma_f32 v[28:29], v[28:29], s[40:41], v[44:45]
    v_pk_fma_f32 v[30:31], v[30:31], s[40:41], v[44:45]
    v_pk_mul_f32 v[24:25], v[24:25], v[72:73]
    v_pk_mul_f32 v[26:27], v[26:27], v[74:75]
    v_pk_mul_f32 v[28:29], v[28:29], v[76:77]
    v_pk_mul_f32 v[30:31], v[30:31], v[78:79]
    v_exp_f32 v24, v24
    v_exp_f32 v25, v25
    v_exp_f32 v26, v26
    v_exp_f32 v27, v27
    v_exp_f32 v28, v28
    v_exp_f32 v29, v29
    v_exp_f32 v30, v30
    v_exp_f32 v31, v31
    v_pk_add_f32 v[24:25], v[24:25], s[42:43]
    v_pk_add_f32 v[26:27], v[26:27], s[42:43]
    v_pk_add_f32 v[28:29], v[28:29], s[42:43]
    v_pk_add_f32 v[30:31], v[30:31], s[42:43]
    v_rcp_f32 v24, v24
    v_rcp_f32 v25, v25
    v_rcp_f32 v26, v26
    v_rcp_f32 v27, v27
    v_rcp_f32 v28, v28
    v_rcp_f32 v29, v29
    v_rcp_f32 v30, v30
    v_rcp_f32 v31, v31
    v_pk_mul_f32 v[72:73], v[72:73], v[24:25]
    v_pk_mul_f32 v[74:75], v[74:75], v[26:27]
    v_pk_mul_f32 v[76:77], v[76:77], v[28:29]
    v_pk_mul_f32 v[78:79], v[78:79], v[30:31]
    v_cvt_pk_bf16_f32 v52, v72, v76
    v_cvt_pk_bf16_f32 v53, v73, v77
    v_cvt_pk_bf16_f32 v54, v74, v78
    v_cvt_pk_bf16_f32 v55, v75, v79
    s_mov_b32 s44, 128
    buffer_store_dwordx4 v[52:55], v122, s[16:19], s44 offen sc1
    s_waitcnt lgkmcnt(2)
    v_mov_b32_dpp v104, v4 row_shl:1 row_mask:0xf bank_mask:0xf
    v_mov_b32_dpp v105, v5 row_shl:1 row_mask:0xf bank_mask:0xf
    v_mov_b32_dpp v106, v6 row_shl:1 row_mask:0xf bank_mask:0xf
    v_mov_b32_dpp v107, v7 row_shl:1 row_mask:0xf bank_mask:0xf
    v_mov_b32_dpp v108, v36 row_shl:1 row_mask:0xf bank_mask:0xf
    v_mov_b32_dpp v109, v37 row_shl:1 row_mask:0xf bank_mask:0xf
    v_mov_b32_dpp v110, v38 row_shl:1 row_mask:0xf bank_mask:0xf
    v_mov_b32_dpp v111, v39 row_shl:1 row_mask:0xf bank_mask:0xf
    v_pk_add_f32 v[80:81], v[80:81], v[104:105]
    v_pk_add_f32 v[82:83], v[82:83], v[106:107]
    v_pk_add_f32 v[84:85], v[84:85], v[108:109]
    v_pk_add_f32 v[86:87], v[86:87], v[110:111]
    v_pk_mul_f32 v[16:17], v[80:81], v[80:81]
    v_pk_mul_f32 v[18:19], v[82:83], v[82:83]
    v_pk_mul_f32 v[20:21], v[84:85], v[84:85]
    v_pk_mul_f32 v[22:23], v[86:87], v[86:87]
    v_pk_fma_f32 v[16:17], v[16:17], s[40:41], v[44:45]
    v_pk_fma_f32 v[18:19], v[18:19], s[40:41], v[44:45]
    v_pk_fma_f32 v[20:21], v[20:21], s[40:41], v[44:45]
    v_pk_fma_f32 v[22:23], v[22:23], s[40:41], v[44:45]
    v_pk_mul_f32 v[16:17], v[16:17], v[80:81]
    v_pk_mul_f32 v[18:19], v[18:19], v[82:83]
    v_pk_mul_f32 v[20:21], v[20:21], v[84:85]
    v_pk_mul_f32 v[22:23], v[22:23], v[86:87]
    v_exp_f32 v16, v16
    v_exp_f32 v17, v17
    v_exp_f32 v18, v18
    v_exp_f32 v19, v19
    v_exp_f32 v20, v20
    v_exp_f32 v21, v21
    v_exp_f32 v22, v22
    v_exp_f32 v23, v23
    v_pk_add_f32 v[16:17], v[16:17], s[42:43]
    v_pk_add_f32 v[18:19], v[18:19], s[42:43]
    v_pk_add_f32 v[20:21], v[20:21], s[42:43]
    v_pk_add_f32 v[22:23], v[22:23], s[42:43]
    v_rcp_f32 v16, v16
    v_rcp_f32 v17, v17
    v_rcp_f32 v18, v18
    v_rcp_f32 v19, v19
    v_rcp_f32 v20, v20
    v_rcp_f32 v21, v21
    v_rcp_f32 v22, v22
    v_rcp_f32 v23, v23
    v_pk_mul_f32 v[80:81], v[80:81], v[16:17]
    v_pk_mul_f32 v[82:83], v[82:83], v[18:19]
    v_pk_mul_f32 v[84:85], v[84:85], v[20:21]
    v_pk_mul_f32 v[86:87], v[86:87], v[22:23]
    v_cvt_pk_bf16_f32 v56, v80, v84
    v_cvt_pk_bf16_f32 v57, v81, v85
    v_cvt_pk_bf16_f32 v58, v82, v86
    v_cvt_pk_bf16_f32 v59, v83, v87
    s_mov_b32 s44, 131200
    buffer_store_dwordx4 v[56:59], v122, s[16:19], s44 offen sc1
    s_waitcnt lgkmcnt(0)
    v_mov_b32_dpp v112, v8 row_shl:1 row_mask:0xf bank_mask:0xf
    v_mov_b32_dpp v113, v9 row_shl:1 row_mask:0xf bank_mask:0xf
    v_mov_b32_dpp v114, v10 row_shl:1 row_mask:0xf bank_mask:0xf
    v_mov_b32_dpp v115, v11 row_shl:1 row_mask:0xf bank_mask:0xf
    v_mov_b32_dpp v116, v40 row_shl:1 row_mask:0xf bank_mask:0xf
    v_mov_b32_dpp v117, v41 row_shl:1 row_mask:0xf bank_mask:0xf
    v_mov_b32_dpp v118, v42 row_shl:1 row_mask:0xf bank_mask:0xf
    v_mov_b32_dpp v119, v43 row_shl:1 row_mask:0xf bank_mask:0xf
    v_pk_add_f32 v[88:89], v[88:89], v[112:113]
    v_pk_add_f32 v[90:91], v[90:91], v[114:115]
    v_pk_add_f32 v[92:93], v[92:93], v[116:117]
    v_pk_add_f32 v[94:95], v[94:95], v[118:119]
    v_pk_mul_f32 v[24:25], v[88:89], v[88:89]
    v_pk_mul_f32 v[26:27], v[90:91], v[90:91]
    v_pk_mul_f32 v[28:29], v[92:93], v[92:93]
    v_pk_mul_f32 v[30:31], v[94:95], v[94:95]
    v_pk_fma_f32 v[24:25], v[24:25], s[40:41], v[44:45]
    v_pk_fma_f32 v[26:27], v[26:27], s[40:41], v[44:45]
    v_pk_fma_f32 v[28:29], v[28:29], s[40:41], v[44:45]
    v_pk_fma_f32 v[30:31], v[30:31], s[40:41], v[44:45]
    v_pk_mul_f32 v[24:25], v[24:25], v[88:89]
    v_pk_mul_f32 v[26:27], v[26:27], v[90:91]
    v_pk_mul_f32 v[28:29], v[28:29], v[92:93]
    v_pk_mul_f32 v[30:31], v[30:31], v[94:95]
    v_exp_f32 v24, v24
    v_exp_f32 v25, v25
    v_exp_f32 v26, v26
    v_exp_f32 v27, v27
    v_exp_f32 v28, v28
    v_exp_f32 v29, v29
    v_exp_f32 v30, v30
    v_exp_f32 v31, v31
    v_pk_add_f32 v[24:25], v[24:25], s[42:43]
    v_pk_add_f32 v[26:27], v[26:27], s[42:43]
    v_pk_add_f32 v[28:29], v[28:29], s[42:43]
    v_pk_add_f32 v[30:31], v[30:31], s[42:43]
    v_rcp_f32 v24, v24
    v_rcp_f32 v25, v25
    v_rcp_f32 v26, v26
    v_rcp_f32 v27, v27
    v_rcp_f32 v28, v28
    v_rcp_f32 v29, v29
    v_rcp_f32 v30, v30
    v_rcp_f32 v31, v31
    v_pk_mul_f32 v[88:89], v[88:89], v[24:25]
    v_pk_mul_f32 v[90:91], v[90:91], v[26:27]
    v_pk_mul_f32 v[92:93], v[92:93], v[28:29]
    v_pk_mul_f32 v[94:95], v[94:95], v[30:31]
    v_cvt_pk_bf16_f32 v60, v88, v92
    v_cvt_pk_bf16_f32 v61, v89, v93
    v_cvt_pk_bf16_f32 v62, v90, v94
    v_cvt_pk_bf16_f32 v63, v91, v95
    s_mov_b32 s44, 262272
    buffer_store_dwordx4 v[60:63], v122, s[16:19], s44 offen sc1
L_conv1_kernel_end:
L_conv1_kernel_done:
    s_endpgm
.globl conv2_kernel
.p2align 8
.type conv2_kernel,@function
conv2_kernel:
    s_cmp_ge_u32 s2, 256
    s_cbranch_scc1 L_conv2_kernel_done
    s_load_dwordx2 s[4:5], s[0:1], 72
    s_load_dwordx2 s[30:31], s[0:1], 72
    v_readfirstlane_b32 s20, v0
    s_lshr_b32 s20, s20, 6
    s_xor_b32 s20, s20, 8
    s_and_b32 s36, s2, 0
    s_lshl_b32 s36, s36, 3
    s_bfe_u32 s37, s2, 196611
    s_or_b32 s29, s36, s37
    s_bfe_u32 s36, s2, 196608
    s_lshl_b32 s36, s36, 2
    s_lshr_b32 s37, s2, 6
    s_or_b32 s36, s36, s37
    s_lshr_b32 s33, s36, 4
    s_and_b32 s34, s36, 7
    s_bfe_u32 s35, s36, 0x10003
    s_mul_i32 s21, s34, 500
    s_and_b32 s32, s20, 3
    v_and_b32 v127, 63, v0
    v_lshrrev_b32 v5, 2, v127
    v_and_b32 v6, 3, v127
    s_and_b32 s42, s20, 7
    s_lshr_b32 s41, s21, 2
    s_sub_u32 s41, s41, 1
    s_add_u32 s37, s41, s42
    v_lshl_add_u32 v7, v5, 3, s37
    s_mul_i32 s36, s35, 4194304
    s_add_u32 s36, s36, 18874368
    s_mov_b32 s10, 4194304
    s_mov_b32 s11, 0x00020000
    s_mov_b32 s25, 0xffff0000
    s_mov_b32 s47, s36
    s_cmp_ge_u32 s20, 8
    s_cbranch_scc1 L_conv2_kernel_helper
    s_add_u32 s37, s41, 128
    v_mov_b32 v16, s37
    v_mul_u32_u24 v17, 524288, v5
    v_lshl_add_u32 v17, v6, 4, v17
    s_add_u32 s37, s33, 4294967289
    v_lshl_add_u32 v18, v16, 3, s37
    v_cmp_gt_u32 vcc, 8000, v18
    s_mul_i32 s37, s33, 131072
    s_add_u32 s37, s37, 0
    v_lshl_add_u32 v108, v16, 7, s37
    v_add_u32 v108, v108, v17
    v_mov_b32 v18, 2130706432
    v_cndmask_b32 v108, v18, v108, vcc
    s_add_u32 s37, s33, 4294967291
    v_lshl_add_u32 v18, v16, 3, s37
    v_cmp_gt_u32 vcc, 8000, v18
    s_mul_i32 s37, s33, 131072
    s_add_u32 s37, s37, 262144
    v_lshl_add_u32 v109, v16, 7, s37
    v_add_u32 v109, v109, v17
    v_mov_b32 v18, 2130706432
    v_cndmask_b32 v109, v18, v109, vcc
    s_add_u32 s37, s33, 4294967293
    v_lshl_add_u32 v18, v16, 3, s37
    v_cmp_gt_u32 vcc, 8000, v18
    s_mul_i32 s37, s33, 131072
    s_add_u32 s37, s37, 64
    v_lshl_add_u32 v110, v16, 7, s37
    v_add_u32 v110, v110, v17
    v_mov_b32 v18, 2130706432
    v_cndmask_b32 v110, v18, v110, vcc
    s_waitcnt lgkmcnt(0)
    s_add_u32 s8, s4, s47
    s_addc_u32 s9, s5, 0
    s_lshl_b32 s36, s29, 4
    s_lshl_b32 s37, s33, 3
    s_add_u32 s36, s36, s37
    s_mul_i32 s36, s36, 57344
    s_add_u32 s36, s36, 9437184
    s_add_u32 s12, s30, s36
    s_addc_u32 s13, s31, 0
    s_mov_b32 s14, 458752
    s_mov_b32 s15, 0x00020000
    s_mul_i32 s36, s35, 2097152
    s_add_u32 s36, s36, 27262976
    s_mul_i32 s37, s33, 8388608
    s_add_u32 s36, s36, s37
    s_add_u32 s16, s30, s36
    s_addc_u32 s17, s31, 0
    s_mov_b32 s18, 2097152
    s_mov_b32 s19, 0x00020000
    v_and_b32 v10, 15, v127
    v_lshrrev_b32 v11, 4, v127
    v_add_u32 v8, 0, v10
    v_and_b32 v16, 4, v8
    v_lshrrev_b32 v16, 1, v16
    v_xor_b32 v16, v11, v16
    v_lshlrev_b32 v16, 4, v16
    v_lshl_add_u32 v8, v8, 6, v16
    v_add_u32 v9, 1, v10
    v_and_b32 v16, 4, v9
    v_lshrrev_b32 v16, 1, v16
    v_xor_b32 v16, v11, v16
    v_lshlrev_b32 v16, 4, v16
    v_lshl_add_u32 v9, v9, 6, v16
    s_lshr_b32 s38, s32, 1
    s_and_b32 s39, s32, 1
    s_add_u32 s40, s38, 4
    s_lshl_b32 s43, s39, 10
    s_cmp_lt_u32 s20, 4
    s_cselect_b32 s40, s20, s40
    s_cselect_b32 s36, 0, s43
    s_lshl_b32 s37, s40, 13
    s_add_u32 s37, s37, s36
    v_lshl_add_u32 v125, v127, 4, s37
    s_mul_i32 s37, s40, 16384
    v_add_u32 v120, s37, v8
    v_add_u32 v121, s37, v9
    s_lshl_b32 s37, s40, 10
    s_add_u32 s37, s37, 115712
    v_lshl_add_u32 v16, v11, 4, s37
    v_cmp_eq_u32 vcc, 15, v10
    v_mov_b32 v17, 8192
    v_mov_b32 v18, 4294959104
    v_mov_b32 v19, 64
    v_cndmask_b32 v122, v121, v16, vcc
    v_cndmask_b32 v123, v17, v19, vcc
    v_cndmask_b32 v124, v18, v19, vcc
    v_lshl_add_u32 v126, v127, 4, s37
    s_mov_b32 s44, 0x3f800000
    s_mov_b32 s45, 0x00000000
    s_mov_b32 s46, 0x00000000
    s_cmp_eq_u32 s40, 1
    s_cselect_b32 s45, 0x3f800000, s45
    s_cselect_b32 s46, 0x3f800000, s46
    s_cmp_eq_u32 s40, 2
    s_cselect_b32 s45, 0xbf800000, s45
    s_cselect_b32 s46, 0x3f800000, s46
    s_cmp_eq_u32 s40, 3
    s_cselect_b32 s45, 0x40000000, s45
    s_cselect_b32 s46, 0x40800000, s46
    s_cmp_eq_u32 s40, 4
    s_cselect_b32 s45, 0xc0000000, s45
    s_cselect_b32 s46, 0x40800000, s46
    s_cmp_eq_u32 s40, 5
    s_cselect_b32 s44, 0x41800000, s44
    s_cselect_b32 s45, 0x41000000, s45
    s_cselect_b32 s46, 0x40800000, s46
    s_cmp_ge_u32 s20, 4
    s_cbranch_scc1 L_conv2_kernel_m2
    v_mov_b32 v0, 0
    v_mov_b32 v1, 0
    v_mov_b32 v2, 0
    v_mov_b32 v3, 0
    v_mov_b32 v4, 0
    v_mov_b32 v5, 0
    v_mov_b32 v6, 0
    v_mov_b32 v7, 0
    v_mov_b32 v8, 0
    v_mov_b32 v9, 0
    v_mov_b32 v10, 0
    v_mov_b32 v11, 0
    v_mov_b32 v12, 0
    v_mov_b32 v13, 0
    v_mov_b32 v14, 0
    v_mov_b32 v15, 0
    v_mov_b32 v16, 0
    v_mov_b32 v17, 0
    v_mov_b32 v18, 0
    v_mov_b32 v19, 0
    v_mov_b32 v20, 0
    v_mov_b32 v21, 0
    v_mov_b32 v22, 0
    v_mov_b32 v23, 0
    v_mov_b32 v24, 0
    v_mov_b32 v25, 0
    v_mov_b32 v26, 0
    v_mov_b32 v27, 0
    v_mov_b32 v28, 0
    v_mov_b32 v29, 0
    v_mov_b32 v30, 0
    v_mov_b32 v31, 0
    v_mov_b32 v32, 0
    v_mov_b32 v33, 0
    v_mov_b32 v34, 0
    v_mov_b32 v35, 0
    v_mov_b32 v36, 0
    v_mov_b32 v37, 0
    v_mov_b32 v38, 0
    v_mov_b32 v39, 0
    v_mov_b32 v40, 0
    v_mov_b32 v41, 0
    v_mov_b32 v42, 0
    v_mov_b32 v43, 0
    v_mov_b32 v44, 0
    v_mov_b32 v45, 0
    v_mov_b32 v46, 0
    v_mov_b32 v47, 0
    v_mov_b32 v48, 0
    v_mov_b32 v49, 0
    v_mov_b32 v50, 0
    v_mov_b32 v51, 0
    v_mov_b32 v52, 0
    v_mov_b32 v53, 0
    v_mov_b32 v54, 0
    v_mov_b32 v55, 0
    v_mov_b32 v56, 0
    v_mov_b32 v57, 0
    v_mov_b32 v58, 0
    v_mov_b32 v59, 0
    v_mov_b32 v60, 0
    v_mov_b32 v61, 0
    v_mov_b32 v62, 0
    v_mov_b32 v63, 0
    buffer_load_dwordx4 v[96:99], v108, s[8:11], 0 offen
    buffer_load_dwordx4 v[100:103], v109, s[8:11], 0 offen
    buffer_load_dwordx4 v[104:107], v110, s[8:11], 0 offen
    s_mov_b32 s23, 0
    s_mov_b32 s26, 4096
    buffer_load_dwordx4 v[64:67], v125, s[12:15], s23 offen offset:0
    buffer_load_dwordx4 v[68:71], v125, s[12:15], s23 offen offset:1024
    buffer_load_dwordx4 v[72:75], v125, s[12:15], s23 offen offset:2048
    buffer_load_dwordx4 v[76:79], v125, s[12:15], s23 offen offset:3072
    buffer_load_dwordx4 v[80:83], v125, s[12:15], s26 offen offset:0
    buffer_load_dwordx4 v[84:87], v125, s[12:15], s26 offen offset:1024
    buffer_load_dwordx4 v[88:91], v125, s[12:15], s26 offen offset:2048
    buffer_load_dwordx4 v[92:95], v125, s[12:15], s26 offen offset:3072
    s_mov_b32 s23, 57344
    s_mov_b32 s26, 61440
    s_waitcnt vmcnt(8)
    v_lshlrev_b32 v108, 16, v96
    v_and_b32 v111, s25, v96
    v_lshlrev_b32 v109, 16, v100
    v_and_b32 v112, s25, v100
    v_lshlrev_b32 v110, 16, v104
    v_and_b32 v113, s25, v104
    v_mul_f32 v114, s44, v108
    v_mul_f32 v115, s44, v111
    v_fmac_f32 v114, s45, v109
    v_fmac_f32 v115, s45, v112
    v_fmac_f32 v114, s46, v110
    v_fmac_f32 v115, s46, v113
    v_cvt_pk_bf16_f32 v96, v114, v115
    v_lshlrev_b32 v108, 16, v97
    v_and_b32 v111, s25, v97
    v_lshlrev_b32 v109, 16, v101
    v_and_b32 v112, s25, v101
    v_lshlrev_b32 v110, 16, v105
    v_and_b32 v113, s25, v105
    v_mul_f32 v114, s44, v108
    v_mul_f32 v115, s44, v111
    v_fmac_f32 v114, s45, v109
    v_fmac_f32 v115, s45, v112
    v_fmac_f32 v114, s46, v110
    v_fmac_f32 v115, s46, v113
    v_cvt_pk_bf16_f32 v97, v114, v115
    v_lshlrev_b32 v108, 16, v98
    v_and_b32 v111, s25, v98
    v_lshlrev_b32 v109, 16, v102
    v_and_b32 v112, s25, v102
    v_lshlrev_b32 v110, 16, v106
    v_and_b32 v113, s25, v106
    v_mul_f32 v114, s44, v108
    v_mul_f32 v115, s44, v111
    v_fmac_f32 v114, s45, v109
    v_fmac_f32 v115, s45, v112
    v_fmac_f32 v114, s46, v110
    v_fmac_f32 v115, s46, v113
    v_cvt_pk_bf16_f32 v98, v114, v115
    v_lshlrev_b32 v108, 16, v99
    v_and_b32 v111, s25, v99
    v_lshlrev_b32 v109, 16, v103
    v_and_b32 v112, s25, v103
    v_lshlrev_b32 v110, 16, v107
    v_and_b32 v113, s25, v107
    v_mul_f32 v114, s44, v108
    v_mul_f32 v115, s44, v111
    v_fmac_f32 v114, s45, v109
    v_fmac_f32 v115, s45, v112
    v_fmac_f32 v114, s46, v110
    v_fmac_f32 v115, s46, v113
    v_cvt_pk_bf16_f32 v99, v114, v115
    ds_write_b128 v126, v[96:99]
    s_waitcnt lgkmcnt(0)
    s_barrier
    s_mov_b32 s22, 4
    s_setprio 2
L_conv2_kernel_mloop1:
    ds_read_b128 v[96:99], v120 offset:0
    ds_read_b128 v[100:103], v120 offset:1024
    ds_read_b128 v[104:107], v120 offset:2048
    ds_read_b128 v[108:111], v120 offset:3072
    ds_read_b128 v[112:115], v120 offset:4096
    ds_read_b128 v[116:119], v120 offset:5120
    s_waitcnt vmcnt(6) lgkmcnt(5)
    v_mfma_f32_16x16x32_bf16 v[0:3], v[64:67], v[96:99], v[0:3]
    v_mfma_f32_16x16x32_bf16 v[32:35], v[68:71], v[96:99], v[32:35]
    ds_read_b128 v[96:99], v120 offset:6144
    s_waitcnt vmcnt(4) lgkmcnt(5)
    v_mfma_f32_16x16x32_bf16 v[4:7], v[64:67], v[100:103], v[4:7]
    v_mfma_f32_16x16x32_bf16 v[36:39], v[68:71], v[100:103], v[36:39]
    v_mfma_f32_16x16x32_bf16 v[0:3], v[72:75], v[100:103], v[0:3]
    v_mfma_f32_16x16x32_bf16 v[32:35], v[76:79], v[100:103], v[32:35]
    ds_read_b128 v[100:103], v120 offset:7168
    s_waitcnt vmcnt(2) lgkmcnt(5)
    v_mfma_f32_16x16x32_bf16 v[8:11], v[64:67], v[104:107], v[8:11]
    v_mfma_f32_16x16x32_bf16 v[40:43], v[68:71], v[104:107], v[40:43]
    v_mfma_f32_16x16x32_bf16 v[4:7], v[72:75], v[104:107], v[4:7]
    v_mfma_f32_16x16x32_bf16 v[36:39], v[76:79], v[104:107], v[36:39]
    v_mfma_f32_16x16x32_bf16 v[0:3], v[80:83], v[104:107], v[0:3]
    v_mfma_f32_16x16x32_bf16 v[32:35], v[84:87], v[104:107], v[32:35]
    ds_read_b128 v[104:107], v122 offset:0
    v_add_u32 v122, v123, v122
    s_waitcnt vmcnt(0) lgkmcnt(5)
    v_mfma_f32_16x16x32_bf16 v[12:15], v[64:67], v[108:111], v[12:15]
    v_mfma_f32_16x16x32_bf16 v[44:47], v[68:71], v[108:111], v[44:47]
    v_mfma_f32_16x16x32_bf16 v[8:11], v[72:75], v[108:111], v[8:11]
    v_mfma_f32_16x16x32_bf16 v[40:43], v[76:79], v[108:111], v[40:43]
    v_mfma_f32_16x16x32_bf16 v[4:7], v[80:83], v[108:111], v[4:7]
    v_mfma_f32_16x16x32_bf16 v[36:39], v[84:87], v[108:111], v[36:39]
    v_mfma_f32_16x16x32_bf16 v[0:3], v[88:91], v[108:111], v[0:3]
    v_mfma_f32_16x16x32_bf16 v[32:35], v[92:95], v[108:111], v[32:35]
    ds_read_b128 v[108:111], v121 offset:1024
    s_waitcnt lgkmcnt(5)
    v_mfma_f32_16x16x32_bf16 v[16:19], v[64:67], v[112:115], v[16:19]
    v_mfma_f32_16x16x32_bf16 v[48:51], v[68:71], v[112:115], v[48:51]
    v_mfma_f32_16x16x32_bf16 v[12:15], v[72:75], v[112:115], v[12:15]
    v_mfma_f32_16x16x32_bf16 v[44:47], v[76:79], v[112:115], v[44:47]
    v_mfma_f32_16x16x32_bf16 v[8:11], v[80:83], v[112:115], v[8:11]
    v_mfma_f32_16x16x32_bf16 v[40:43], v[84:87], v[112:115], v[40:43]
    v_mfma_f32_16x16x32_bf16 v[4:7], v[88:91], v[112:115], v[4:7]
    v_mfma_f32_16x16x32_bf16 v[36:39], v[92:95], v[112:115], v[36:39]
    ds_read_b128 v[112:115], v121 offset:2048
    s_waitcnt lgkmcnt(5)
    v_mfma_f32_16x16x32_bf16 v[20:23], v[64:67], v[116:119], v[20:23]
    v_mfma_f32_16x16x32_bf16 v[52:55], v[68:71], v[116:119], v[52:55]
    v_mfma_f32_16x16x32_bf16 v[16:19], v[72:75], v[116:119], v[16:19]
    v_mfma_f32_16x16x32_bf16 v[48:51], v[76:79], v[116:119], v[48:51]
    v_mfma_f32_16x16x32_bf16 v[12:15], v[80:83], v[116:119], v[12:15]
    v_mfma_f32_16x16x32_bf16 v[44:47], v[84:87], v[116:119], v[44:47]
    v_mfma_f32_16x16x32_bf16 v[8:11], v[88:91], v[116:119], v[8:11]
    v_mfma_f32_16x16x32_bf16 v[40:43], v[92:95], v[116:119], v[40:43]
    s_waitcnt lgkmcnt(4)
    v_mfma_f32_16x16x32_bf16 v[24:27], v[64:67], v[96:99], v[24:27]
    v_mfma_f32_16x16x32_bf16 v[56:59], v[68:71], v[96:99], v[56:59]
    v_mfma_f32_16x16x32_bf16 v[20:23], v[72:75], v[96:99], v[20:23]
    v_mfma_f32_16x16x32_bf16 v[52:55], v[76:79], v[96:99], v[52:55]
    v_mfma_f32_16x16x32_bf16 v[16:19], v[80:83], v[96:99], v[16:19]
    v_mfma_f32_16x16x32_bf16 v[48:51], v[84:87], v[96:99], v[48:51]
    v_mfma_f32_16x16x32_bf16 v[12:15], v[88:91], v[96:99], v[12:15]
    v_mfma_f32_16x16x32_bf16 v[44:47], v[92:95], v[96:99], v[44:47]
    s_waitcnt lgkmcnt(3)
    v_mfma_f32_16x16x32_bf16 v[28:31], v[64:67], v[100:103], v[28:31]
    v_mfma_f32_16x16x32_bf16 v[60:63], v[68:71], v[100:103], v[60:63]
    v_mfma_f32_16x16x32_bf16 v[24:27], v[72:75], v[100:103], v[24:27]
    v_mfma_f32_16x16x32_bf16 v[56:59], v[76:79], v[100:103], v[56:59]
    v_mfma_f32_16x16x32_bf16 v[20:23], v[80:83], v[100:103], v[20:23]
    v_mfma_f32_16x16x32_bf16 v[52:55], v[84:87], v[100:103], v[52:55]
    v_mfma_f32_16x16x32_bf16 v[16:19], v[88:91], v[100:103], v[16:19]
    v_mfma_f32_16x16x32_bf16 v[48:51], v[92:95], v[100:103], v[48:51]
    buffer_load_dwordx4 v[64:67], v125, s[12:15], s23 offen offset:0
    buffer_load_dwordx4 v[68:71], v125, s[12:15], s23 offen offset:1024
    s_waitcnt lgkmcnt(2)
    v_mfma_f32_16x16x32_bf16 v[28:31], v[72:75], v[104:107], v[28:31]
    v_mfma_f32_16x16x32_bf16 v[60:63], v[76:79], v[104:107], v[60:63]
    v_mfma_f32_16x16x32_bf16 v[24:27], v[80:83], v[104:107], v[24:27]
    v_mfma_f32_16x16x32_bf16 v[56:59], v[84:87], v[104:107], v[56:59]
    v_mfma_f32_16x16x32_bf16 v[20:23], v[88:91], v[104:107], v[20:23]
    v_mfma_f32_16x16x32_bf16 v[52:55], v[92:95], v[104:107], v[52:55]
    buffer_load_dwordx4 v[72:75], v125, s[12:15], s23 offen offset:2048
    buffer_load_dwordx4 v[76:79], v125, s[12:15], s23 offen offset:3072
    s_waitcnt lgkmcnt(1)
    v_mfma_f32_16x16x32_bf16 v[28:31], v[80:83], v[108:111], v[28:31]
    v_mfma_f32_16x16x32_bf16 v[60:63], v[84:87], v[108:111], v[60:63]
    v_mfma_f32_16x16x32_bf16 v[24:27], v[88:91], v[108:111], v[24:27]
    v_mfma_f32_16x16x32_bf16 v[56:59], v[92:95], v[108:111], v[56:59]
    buffer_load_dwordx4 v[80:83], v125, s[12:15], s26 offen offset:0
    buffer_load_dwordx4 v[84:87], v125, s[12:15], s26 offen offset:1024
    s_waitcnt lgkmcnt(0)
    v_mfma_f32_16x16x32_bf16 v[28:31], v[88:91], v[112:115], v[28:31]
    v_mfma_f32_16x16x32_bf16 v[60:63], v[92:95], v[112:115], v[60:63]
    buffer_load_dwordx4 v[88:91], v125, s[12:15], s26 offen offset:2048
    buffer_load_dwordx4 v[92:95], v125, s[12:15], s26 offen offset:3072
    s_add_u32 s23, s23, 57344
    s_add_u32 s26, s26, 57344
    s_barrier
    s_sub_u32 s22, s22, 1
    s_cmp_eq_u32 s22, 0
    s_cbranch_scc1 L_conv2_kernel_mlast1
    ds_read_b128 v[96:99], v120 offset:8192
    ds_read_b128 v[100:103], v120 offset:9216
    ds_read_b128 v[104:107], v120 offset:10240
    ds_read_b128 v[108:111], v120 offset:11264
    ds_read_b128 v[112:115], v120 offset:12288
    ds_read_b128 v[116:119], v120 offset:13312
    s_waitcnt vmcnt(6) lgkmcnt(5)
    v_mfma_f32_16x16x32_bf16 v[0:3], v[64:67], v[96:99], v[0:3]
    v_mfma_f32_16x16x32_bf16 v[32:35], v[68:71], v[96:99], v[32:35]
    ds_read_b128 v[96:99], v120 offset:14336
    s_waitcnt vmcnt(4) lgkmcnt(5)
    v_mfma_f32_16x16x32_bf16 v[4:7], v[64:67], v[100:103], v[4:7]
    v_mfma_f32_16x16x32_bf16 v[36:39], v[68:71], v[100:103], v[36:39]
    v_mfma_f32_16x16x32_bf16 v[0:3], v[72:75], v[100:103], v[0:3]
    v_mfma_f32_16x16x32_bf16 v[32:35], v[76:79], v[100:103], v[32:35]
    ds_read_b128 v[100:103], v120 offset:15360
    s_waitcnt vmcnt(2) lgkmcnt(5)
    v_mfma_f32_16x16x32_bf16 v[8:11], v[64:67], v[104:107], v[8:11]
    v_mfma_f32_16x16x32_bf16 v[40:43], v[68:71], v[104:107], v[40:43]
    v_mfma_f32_16x16x32_bf16 v[4:7], v[72:75], v[104:107], v[4:7]
    v_mfma_f32_16x16x32_bf16 v[36:39], v[76:79], v[104:107], v[36:39]
    v_mfma_f32_16x16x32_bf16 v[0:3], v[80:83], v[104:107], v[0:3]
    v_mfma_f32_16x16x32_bf16 v[32:35], v[84:87], v[104:107], v[32:35]
    ds_read_b128 v[104:107], v122 offset:0
    v_add_u32 v122, v124, v122
    s_waitcnt vmcnt(0) lgkmcnt(5)
    v_mfma_f32_16x16x32_bf16 v[12:15], v[64:67], v[108:111], v[12:15]
    v_mfma_f32_16x16x32_bf16 v[44:47], v[68:71], v[108:111], v[44:47]
    v_mfma_f32_16x16x32_bf16 v[8:11], v[72:75], v[108:111], v[8:11]
    v_mfma_f32_16x16x32_bf16 v[40:43], v[76:79], v[108:111], v[40:43]
    v_mfma_f32_16x16x32_bf16 v[4:7], v[80:83], v[108:111], v[4:7]
    v_mfma_f32_16x16x32_bf16 v[36:39], v[84:87], v[108:111], v[36:39]
    v_mfma_f32_16x16x32_bf16 v[0:3], v[88:91], v[108:111], v[0:3]
    v_mfma_f32_16x16x32_bf16 v[32:35], v[92:95], v[108:111], v[32:35]
    ds_read_b128 v[108:111], v121 offset:9216
    s_waitcnt lgkmcnt(5)
    v_mfma_f32_16x16x32_bf16 v[16:19], v[64:67], v[112:115], v[16:19]
    v_mfma_f32_16x16x32_bf16 v[48:51], v[68:71], v[112:115], v[48:51]
    v_mfma_f32_16x16x32_bf16 v[12:15], v[72:75], v[112:115], v[12:15]
    v_mfma_f32_16x16x32_bf16 v[44:47], v[76:79], v[112:115], v[44:47]
    v_mfma_f32_16x16x32_bf16 v[8:11], v[80:83], v[112:115], v[8:11]
    v_mfma_f32_16x16x32_bf16 v[40:43], v[84:87], v[112:115], v[40:43]
    v_mfma_f32_16x16x32_bf16 v[4:7], v[88:91], v[112:115], v[4:7]
    v_mfma_f32_16x16x32_bf16 v[36:39], v[92:95], v[112:115], v[36:39]
    ds_read_b128 v[112:115], v121 offset:10240
    s_waitcnt lgkmcnt(5)
    v_mfma_f32_16x16x32_bf16 v[20:23], v[64:67], v[116:119], v[20:23]
    v_mfma_f32_16x16x32_bf16 v[52:55], v[68:71], v[116:119], v[52:55]
    v_mfma_f32_16x16x32_bf16 v[16:19], v[72:75], v[116:119], v[16:19]
    v_mfma_f32_16x16x32_bf16 v[48:51], v[76:79], v[116:119], v[48:51]
    v_mfma_f32_16x16x32_bf16 v[12:15], v[80:83], v[116:119], v[12:15]
    v_mfma_f32_16x16x32_bf16 v[44:47], v[84:87], v[116:119], v[44:47]
    v_mfma_f32_16x16x32_bf16 v[8:11], v[88:91], v[116:119], v[8:11]
    v_mfma_f32_16x16x32_bf16 v[40:43], v[92:95], v[116:119], v[40:43]
    s_waitcnt lgkmcnt(4)
    v_mfma_f32_16x16x32_bf16 v[24:27], v[64:67], v[96:99], v[24:27]
    v_mfma_f32_16x16x32_bf16 v[56:59], v[68:71], v[96:99], v[56:59]
    v_mfma_f32_16x16x32_bf16 v[20:23], v[72:75], v[96:99], v[20:23]
    v_mfma_f32_16x16x32_bf16 v[52:55], v[76:79], v[96:99], v[52:55]
    v_mfma_f32_16x16x32_bf16 v[16:19], v[80:83], v[96:99], v[16:19]
    v_mfma_f32_16x16x32_bf16 v[48:51], v[84:87], v[96:99], v[48:51]
    v_mfma_f32_16x16x32_bf16 v[12:15], v[88:91], v[96:99], v[12:15]
    v_mfma_f32_16x16x32_bf16 v[44:47], v[92:95], v[96:99], v[44:47]
    s_waitcnt lgkmcnt(3)
    v_mfma_f32_16x16x32_bf16 v[28:31], v[64:67], v[100:103], v[28:31]
    v_mfma_f32_16x16x32_bf16 v[60:63], v[68:71], v[100:103], v[60:63]
    v_mfma_f32_16x16x32_bf16 v[24:27], v[72:75], v[100:103], v[24:27]
    v_mfma_f32_16x16x32_bf16 v[56:59], v[76:79], v[100:103], v[56:59]
    v_mfma_f32_16x16x32_bf16 v[20:23], v[80:83], v[100:103], v[20:23]
    v_mfma_f32_16x16x32_bf16 v[52:55], v[84:87], v[100:103], v[52:55]
    v_mfma_f32_16x16x32_bf16 v[16:19], v[88:91], v[100:103], v[16:19]
    v_mfma_f32_16x16x32_bf16 v[48:51], v[92:95], v[100:103], v[48:51]
    buffer_load_dwordx4 v[64:67], v125, s[12:15], s23 offen offset:0
    buffer_load_dwordx4 v[68:71], v125, s[12:15], s23 offen offset:1024
    s_waitcnt lgkmcnt(2)
    v_mfma_f32_16x16x32_bf16 v[28:31], v[72:75], v[104:107], v[28:31]
    v_mfma_f32_16x16x32_bf16 v[60:63], v[76:79], v[104:107], v[60:63]
    v_mfma_f32_16x16x32_bf16 v[24:27], v[80:83], v[104:107], v[24:27]
    v_mfma_f32_16x16x32_bf16 v[56:59], v[84:87], v[104:107], v[56:59]
    v_mfma_f32_16x16x32_bf16 v[20:23], v[88:91], v[104:107], v[20:23]
    v_mfma_f32_16x16x32_bf16 v[52:55], v[92:95], v[104:107], v[52:55]
    buffer_load_dwordx4 v[72:75], v125, s[12:15], s23 offen offset:2048
    buffer_load_dwordx4 v[76:79], v125, s[12:15], s23 offen offset:3072
    s_waitcnt lgkmcnt(1)
    v_mfma_f32_16x16x32_bf16 v[28:31], v[80:83], v[108:111], v[28:31]
    v_mfma_f32_16x16x32_bf16 v[60:63], v[84:87], v[108:111], v[60:63]
    v_mfma_f32_16x16x32_bf16 v[24:27], v[88:91], v[108:111], v[24:27]
    v_mfma_f32_16x16x32_bf16 v[56:59], v[92:95], v[108:111], v[56:59]
    buffer_load_dwordx4 v[80:83], v125, s[12:15], s26 offen offset:0
    buffer_load_dwordx4 v[84:87], v125, s[12:15], s26 offen offset:1024
    s_waitcnt lgkmcnt(0)
    v_mfma_f32_16x16x32_bf16 v[28:31], v[88:91], v[112:115], v[28:31]
    v_mfma_f32_16x16x32_bf16 v[60:63], v[92:95], v[112:115], v[60:63]
    buffer_load_dwordx4 v[88:91], v125, s[12:15], s26 offen offset:2048
    buffer_load_dwordx4 v[92:95], v125, s[12:15], s26 offen offset:3072
    s_add_u32 s23, s23, 57344
    s_add_u32 s26, s26, 57344
    s_barrier
    s_branch L_conv2_kernel_mloop1
L_conv2_kernel_mlast1:
    v_and_b32 v125, 15, v127
    v_and_b32 v126, 7, v127
    v_lshlrev_b32 v126, 4, v126
    v_lshl_add_u32 v125, v125, 7, v126
    v_lshrrev_b32 v126, 4, v127
    v_lshl_add_u32 v125, v126, 11, v125
    s_lshl_b32 s36, s20, 14
    s_add_u32 s37, s36, 8192
    v_add_u32 v126, s37, v125
    v_add_u32 v125, s36, v125
    ds_read_b128 v[96:99], v120 offset:8192
    ds_read_b128 v[100:103], v120 offset:9216
    ds_read_b128 v[104:107], v120 offset:10240
    ds_read_b128 v[108:111], v120 offset:11264
    ds_read_b128 v[112:115], v120 offset:12288
    ds_read_b128 v[116:119], v120 offset:13312
    s_waitcnt vmcnt(6) lgkmcnt(5)
    v_mfma_f32_16x16x32_bf16 v[0:3], v[64:67], v[96:99], v[0:3]
    v_mfma_f32_16x16x32_bf16 v[32:35], v[68:71], v[96:99], v[32:35]
    ds_read_b128 v[96:99], v120 offset:14336
    s_waitcnt vmcnt(4) lgkmcnt(5)
    v_mfma_f32_16x16x32_bf16 v[4:7], v[64:67], v[100:103], v[4:7]
    v_mfma_f32_16x16x32_bf16 v[36:39], v[68:71], v[100:103], v[36:39]
    v_mfma_f32_16x16x32_bf16 v[0:3], v[72:75], v[100:103], v[0:3]
    v_mfma_f32_16x16x32_bf16 v[32:35], v[76:79], v[100:103], v[32:35]
    ds_read_b128 v[100:103], v120 offset:15360
    s_waitcnt vmcnt(2) lgkmcnt(5)
    v_mfma_f32_16x16x32_bf16 v[8:11], v[64:67], v[104:107], v[8:11]
    v_mfma_f32_16x16x32_bf16 v[40:43], v[68:71], v[104:107], v[40:43]
    v_mfma_f32_16x16x32_bf16 v[4:7], v[72:75], v[104:107], v[4:7]
    v_mfma_f32_16x16x32_bf16 v[36:39], v[76:79], v[104:107], v[36:39]
    v_mfma_f32_16x16x32_bf16 v[0:3], v[80:83], v[104:107], v[0:3]
    v_mfma_f32_16x16x32_bf16 v[32:35], v[84:87], v[104:107], v[32:35]
    ds_read_b128 v[104:107], v122 offset:0
    s_waitcnt vmcnt(0) lgkmcnt(5)
    v_mfma_f32_16x16x32_bf16 v[12:15], v[64:67], v[108:111], v[12:15]
    v_mfma_f32_16x16x32_bf16 v[44:47], v[68:71], v[108:111], v[44:47]
    v_mfma_f32_16x16x32_bf16 v[8:11], v[72:75], v[108:111], v[8:11]
    v_mfma_f32_16x16x32_bf16 v[40:43], v[76:79], v[108:111], v[40:43]
    v_mfma_f32_16x16x32_bf16 v[4:7], v[80:83], v[108:111], v[4:7]
    v_mfma_f32_16x16x32_bf16 v[36:39], v[84:87], v[108:111], v[36:39]
    v_mfma_f32_16x16x32_bf16 v[0:3], v[88:91], v[108:111], v[0:3]
    v_mfma_f32_16x16x32_bf16 v[32:35], v[92:95], v[108:111], v[32:35]
    ds_read_b128 v[108:111], v121 offset:9216
    s_waitcnt lgkmcnt(5)
    v_mfma_f32_16x16x32_bf16 v[16:19], v[64:67], v[112:115], v[16:19]
    v_mfma_f32_16x16x32_bf16 v[48:51], v[68:71], v[112:115], v[48:51]
    v_mfma_f32_16x16x32_bf16 v[12:15], v[72:75], v[112:115], v[12:15]
    v_mfma_f32_16x16x32_bf16 v[44:47], v[76:79], v[112:115], v[44:47]
    v_mfma_f32_16x16x32_bf16 v[8:11], v[80:83], v[112:115], v[8:11]
    v_mfma_f32_16x16x32_bf16 v[40:43], v[84:87], v[112:115], v[40:43]
    v_mfma_f32_16x16x32_bf16 v[4:7], v[88:91], v[112:115], v[4:7]
    v_mfma_f32_16x16x32_bf16 v[36:39], v[92:95], v[112:115], v[36:39]
    ds_read_b128 v[112:115], v121 offset:10240
    v_xor_b32 v123, 0, v125
    ds_write_b128 v123, v[0:3]
    s_waitcnt lgkmcnt(6)
    v_mfma_f32_16x16x32_bf16 v[20:23], v[64:67], v[116:119], v[20:23]
    v_mfma_f32_16x16x32_bf16 v[52:55], v[68:71], v[116:119], v[52:55]
    v_mfma_f32_16x16x32_bf16 v[16:19], v[72:75], v[116:119], v[16:19]
    v_mfma_f32_16x16x32_bf16 v[48:51], v[76:79], v[116:119], v[48:51]
    v_mfma_f32_16x16x32_bf16 v[12:15], v[80:83], v[116:119], v[12:15]
    v_mfma_f32_16x16x32_bf16 v[44:47], v[84:87], v[116:119], v[44:47]
    v_mfma_f32_16x16x32_bf16 v[8:11], v[88:91], v[116:119], v[8:11]
    v_mfma_f32_16x16x32_bf16 v[40:43], v[92:95], v[116:119], v[40:43]
    v_xor_b32 v124, 16, v125
    ds_write_b128 v124, v[4:7]
    s_waitcnt lgkmcnt(2)
    v_mfma_f32_16x16x32_bf16 v[24:27], v[64:67], v[96:99], v[24:27]
    v_mfma_f32_16x16x32_bf16 v[56:59], v[68:71], v[96:99], v[56:59]
    v_mfma_f32_16x16x32_bf16 v[20:23], v[72:75], v[96:99], v[20:23]
    v_mfma_f32_16x16x32_bf16 v[52:55], v[76:79], v[96:99], v[52:55]
    v_mfma_f32_16x16x32_bf16 v[16:19], v[80:83], v[96:99], v[16:19]
    v_mfma_f32_16x16x32_bf16 v[48:51], v[84:87], v[96:99], v[48:51]
    v_mfma_f32_16x16x32_bf16 v[12:15], v[88:91], v[96:99], v[12:15]
    v_mfma_f32_16x16x32_bf16 v[44:47], v[92:95], v[96:99], v[44:47]
    v_xor_b32 v123, 32, v125
    ds_write_b128 v123, v[8:11]
    v_xor_b32 v124, 0, v126
    ds_write_b128 v124, v[32:35]
    v_mfma_f32_16x16x32_bf16 v[28:31], v[64:67], v[100:103], v[28:31]
    v_mfma_f32_16x16x32_bf16 v[60:63], v[68:71], v[100:103], v[60:63]
    v_mfma_f32_16x16x32_bf16 v[24:27], v[72:75], v[100:103], v[24:27]
    v_mfma_f32_16x16x32_bf16 v[56:59], v[76:79], v[100:103], v[56:59]
    v_mfma_f32_16x16x32_bf16 v[20:23], v[80:83], v[100:103], v[20:23]
    v_mfma_f32_16x16x32_bf16 v[52:55], v[84:87], v[100:103], v[52:55]
    v_mfma_f32_16x16x32_bf16 v[16:19], v[88:91], v[100:103], v[16:19]
    v_mfma_f32_16x16x32_bf16 v[48:51], v[92:95], v[100:103], v[48:51]
    v_xor_b32 v123, 16, v126
    ds_write_b128 v123, v[36:39]
    v_xor_b32 v124, 32, v126
    ds_write_b128 v124, v[40:43]
    v_mfma_f32_16x16x32_bf16 v[28:31], v[72:75], v[104:107], v[28:31]
    v_mfma_f32_16x16x32_bf16 v[60:63], v[76:79], v[104:107], v[60:63]
    v_mfma_f32_16x16x32_bf16 v[24:27], v[80:83], v[104:107], v[24:27]
    v_mfma_f32_16x16x32_bf16 v[56:59], v[84:87], v[104:107], v[56:59]
    v_mfma_f32_16x16x32_bf16 v[20:23], v[88:91], v[104:107], v[20:23]
    v_mfma_f32_16x16x32_bf16 v[52:55], v[92:95], v[104:107], v[52:55]
    v_xor_b32 v124, 48, v125
    ds_write_b128 v124, v[12:15]
    v_xor_b32 v123, 48, v126
    ds_write_b128 v123, v[44:47]
    v_mfma_f32_16x16x32_bf16 v[28:31], v[80:83], v[108:111], v[28:31]
    v_mfma_f32_16x16x32_bf16 v[60:63], v[84:87], v[108:111], v[60:63]
    v_mfma_f32_16x16x32_bf16 v[24:27], v[88:91], v[108:111], v[24:27]
    v_mfma_f32_16x16x32_bf16 v[56:59], v[92:95], v[108:111], v[56:59]
    v_xor_b32 v123, 64, v125
    ds_write_b128 v123, v[16:19]
    v_xor_b32 v124, 64, v126
    ds_write_b128 v124, v[48:51]
    v_mfma_f32_16x16x32_bf16 v[28:31], v[88:91], v[112:115], v[28:31]
    v_mfma_f32_16x16x32_bf16 v[60:63], v[92:95], v[112:115], v[60:63]
    v_xor_b32 v124, 80, v125
    ds_write_b128 v124, v[20:23]
    v_xor_b32 v123, 80, v126
    ds_write_b128 v123, v[52:55]
    v_and_b32 v108, 15, v127
    v_lshrrev_b32 v109, 4, v127
    v_lshrrev_b32 v110, 3, v108
    s_lshl_b32 s36, s20, 1
    v_add_u32 v110, s36, v110
    v_xor_b32 v111, v110, v108
    v_and_b32 v111, 7, v111
    v_lshlrev_b32 v111, 4, v111
    v_xor_b32 v123, 96, v125
    ds_write_b128 v123, v[24:27]
    v_lshl_add_u32 v111, v110, 7, v111
    v_lshl_add_u32 v120, v109, 11, v111
    v_add_u32 v121, 65536, v120
    v_add_u32 v64, 131072, v120
    s_lshl_b32 s36, s20, 9
    s_add_u32 s36, s36, 115712
    v_lshl_add_u32 v127, v109, 7, s36
    s_lshl_b32 s36, s20, 4
    v_add_u32 v108, s36, v108
    v_lshlrev_b32 v110, 6, v108
    v_lshl_add_u32 v110, v109, 4, v110
    s_mul_i32 s36, s29, 262144
    v_xor_b32 v124, 96, v126
    ds_write_b128 v124, v[56:59]
    s_lshl_b32 s37, s21, 4
    s_add_u32 s36, s36, s37
    v_add_u32 v110, s36, v110
    v_mov_b32 v111, 2130706432
    v_cmp_gt_u32 vcc, 125, v108
    s_mov_b32 s4, 0xbeaaaaab
    s_mov_b32 s5, s4
    s_mov_b32 s6, 0x3e800000
    s_mov_b32 s7, s6
    s_mov_b32 s8, 0xc0a00000
    s_mov_b32 s9, s8
    s_mov_b32 s10, 0xc0638e39
    v_xor_b32 v124, 112, v125
    ds_write_b128 v124, v[28:31]
    s_mov_b32 s11, s10
    s_mov_b32 s12, 0xbf638e39
    s_mov_b32 s13, s12
    s_mov_b32 s14, 0xbe638e39
    s_mov_b32 s15, s14
    s_mov_b32 s22, 0xbd638e39
    s_mov_b32 s23, s22
    s_mov_b32 s24, 0x3ff1c71c
    s_mov_b32 s25, s24
    s_mov_b32 s26, 0xbf2aaaab
    s_mov_b32 s27, s26
    s_mov_b32 s32, 0x3ecccccd
    v_xor_b32 v123, 112, v126
    s_waitcnt lgkmcnt(8)
    ds_write_b128 v123, v[60:63]
    s_mov_b32 s33, s32
    s_mov_b32 s34, 0xbd888889
    s_mov_b32 s35, s34
    s_mov_b32 s38, 0xbe4ccccd
    s_mov_b32 s39, s38
    s_mov_b32 s40, 0xbdd2d3e8
    s_mov_b32 s41, s40
    s_mov_b32 s42, 0x3f800000
    s_mov_b32 s43, s42
    s_setprio 0
    s_branch L_conv2_kernel_epi
L_conv2_kernel_m2:
    s_mul_i32 s37, s38, 2176
    s_add_u32 s37, s37, 98304
    v_add_u32 v116, s37, v8
    v_add_u32 v118, s37, v9
    v_add_u32 v117, 104832, v8
    s_cmp_eq_u32 s38, 0
    s_cbranch_scc1 L_conv2_kernel_hh0
    v_add_u32 v117, 98304, v9
L_conv2_kernel_hh0:
    s_lshl_b32 s37, s38, 12
    s_add_u32 s37, s37, s43
    s_add_u32 s37, s37, 49152
    v_lshl_add_u32 v119, v127, 4, s37
    v_mov_b32 v0, 0
    v_mov_b32 v1, 0
    v_mov_b32 v2, 0
    v_mov_b32 v3, 0
    v_mov_b32 v4, 0
    v_mov_b32 v5, 0
    v_mov_b32 v6, 0
    v_mov_b32 v7, 0
    v_mov_b32 v8, 0
    v_mov_b32 v9, 0
    v_mov_b32 v10, 0
    v_mov_b32 v11, 0
    v_mov_b32 v12, 0
    v_mov_b32 v13, 0
    v_mov_b32 v14, 0
    v_mov_b32 v15, 0
    v_mov_b32 v16, 0
    v_mov_b32 v17, 0
    v_mov_b32 v18, 0
    v_mov_b32 v19, 0
    v_mov_b32 v20, 0
    v_mov_b32 v21, 0
    v_mov_b32 v22, 0
    v_mov_b32 v23, 0
    v_mov_b32 v24, 0
    v_mov_b32 v25, 0
    v_mov_b32 v26, 0
    v_mov_b32 v27, 0
    v_mov_b32 v28, 0
    v_mov_b32 v29, 0
    v_mov_b32 v30, 0
    v_mov_b32 v31, 0
    v_mov_b32 v32, 0
    v_mov_b32 v33, 0
    v_mov_b32 v34, 0
    v_mov_b32 v35, 0
    v_mov_b32 v36, 0
    v_mov_b32 v37, 0
    v_mov_b32 v38, 0
    v_mov_b32 v39, 0
    v_mov_b32 v40, 0
    v_mov_b32 v41, 0
    v_mov_b32 v42, 0
    v_mov_b32 v43, 0
    v_mov_b32 v44, 0
    v_mov_b32 v45, 0
    v_mov_b32 v46, 0
    v_mov_b32 v47, 0
    v_mov_b32 v48, 0
    v_mov_b32 v49, 0
    v_mov_b32 v50, 0
    v_mov_b32 v51, 0
    v_mov_b32 v52, 0
    v_mov_b32 v53, 0
    v_mov_b32 v54, 0
    v_mov_b32 v55, 0
    v_mov_b32 v56, 0
    v_mov_b32 v57, 0
    v_mov_b32 v58, 0
    v_mov_b32 v59, 0
    v_mov_b32 v60, 0
    v_mov_b32 v61, 0
    v_mov_b32 v62, 0
    v_mov_b32 v63, 0
    buffer_load_dwordx4 v[96:99], v108, s[8:11], 0 offen
    buffer_load_dwordx4 v[100:103], v109, s[8:11], 0 offen
    buffer_load_dwordx4 v[104:107], v110, s[8:11], 0 offen
    s_mov_b32 s23, 0
    s_mov_b32 s26, 4096
    buffer_load_dwordx4 v[64:67], v125, s[12:15], s23 offen offset:0
    buffer_load_dwordx4 v[68:71], v125, s[12:15], s23 offen offset:2048
    buffer_load_dwordx4 v[80:83], v119, s[12:15], s23 offen offset:0
    buffer_load_dwordx4 v[72:75], v125, s[12:15], s26 offen offset:0
    buffer_load_dwordx4 v[84:87], v119, s[12:15], s23 offen offset:2048
    buffer_load_dwordx4 v[76:79], v125, s[12:15], s26 offen offset:2048
    s_mov_b32 s23, 57344
    s_mov_b32 s26, 61440
    s_waitcnt vmcnt(6)
    v_lshlrev_b32 v108, 16, v96
    v_and_b32 v111, s25, v96
    v_lshlrev_b32 v109, 16, v100
    v_and_b32 v112, s25, v100
    v_lshlrev_b32 v110, 16, v104
    v_and_b32 v113, s25, v104
    v_mul_f32 v114, s44, v108
    v_mul_f32 v115, s44, v111
    v_fmac_f32 v114, s45, v109
    v_fmac_f32 v115, s45, v112
    v_fmac_f32 v114, s46, v110
    v_fmac_f32 v115, s46, v113
    v_cvt_pk_bf16_f32 v96, v114, v115
    v_lshlrev_b32 v108, 16, v97
    v_and_b32 v111, s25, v97
    v_lshlrev_b32 v109, 16, v101
    v_and_b32 v112, s25, v101
    v_lshlrev_b32 v110, 16, v105
    v_and_b32 v113, s25, v105
    v_mul_f32 v114, s44, v108
    v_mul_f32 v115, s44, v111
    v_fmac_f32 v114, s45, v109
    v_fmac_f32 v115, s45, v112
    v_fmac_f32 v114, s46, v110
    v_fmac_f32 v115, s46, v113
    v_cvt_pk_bf16_f32 v97, v114, v115
    v_lshlrev_b32 v108, 16, v98
    v_and_b32 v111, s25, v98
    v_lshlrev_b32 v109, 16, v102
    v_and_b32 v112, s25, v102
    v_lshlrev_b32 v110, 16, v106
    v_and_b32 v113, s25, v106
    v_mul_f32 v114, s44, v108
    v_mul_f32 v115, s44, v111
    v_fmac_f32 v114, s45, v109
    v_fmac_f32 v115, s45, v112
    v_fmac_f32 v114, s46, v110
    v_fmac_f32 v115, s46, v113
    v_cvt_pk_bf16_f32 v98, v114, v115
    v_lshlrev_b32 v108, 16, v99
    v_and_b32 v111, s25, v99
    v_lshlrev_b32 v109, 16, v103
    v_and_b32 v112, s25, v103
    v_lshlrev_b32 v110, 16, v107
    v_and_b32 v113, s25, v107
    v_mul_f32 v114, s44, v108
    v_mul_f32 v115, s44, v111
    v_fmac_f32 v114, s45, v109
    v_fmac_f32 v115, s45, v112
    v_fmac_f32 v114, s46, v110
    v_fmac_f32 v115, s46, v113
    v_cvt_pk_bf16_f32 v99, v114, v115
    ds_write_b128 v126, v[96:99]
    v_and_b32 v111, 15, v127
    v_lshlrev_b32 v111, 2, v111
    v_add_u32 v111, 99328, v111
    ds_write_b32 v111, v0
    ds_write_b32 v111, v0 offset:8704
    s_waitcnt lgkmcnt(0)
    s_barrier
    s_mov_b32 s22, 4
    s_setprio 2
L_conv2_kernel_mloop2:
    ds_read_b128 v[88:91], v120 offset:0
    ds_read_b128 v[92:95], v120 offset:1024
    ds_read_b128 v[96:99], v116 offset:0
    ds_read_b128 v[100:103], v120 offset:2048
    ds_read_b128 v[104:107], v116 offset:1088
    ds_read_b128 v[108:111], v120 offset:3072
    ds_read_b128 v[112:115], v116 offset:2176
    s_waitcnt vmcnt(5) lgkmcnt(6)
    v_mfma_f32_16x16x32_bf16 v[0:3], v[64:67], v[88:91], v[0:3]
    ds_read_b128 v[88:91], v120 offset:4096
    s_waitcnt vmcnt(4) lgkmcnt(6)
    v_mfma_f32_16x16x32_bf16 v[4:7], v[64:67], v[92:95], v[4:7]
    v_mfma_f32_16x16x32_bf16 v[0:3], v[68:71], v[92:95], v[0:3]
    ds_read_b128 v[92:95], v116 offset:3264
    s_waitcnt vmcnt(3) lgkmcnt(6)
    v_mfma_f32_16x16x32_bf16 v[32:35], v[80:83], v[96:99], v[32:35]
    ds_read_b128 v[96:99], v120 offset:5120
    s_waitcnt vmcnt(2) lgkmcnt(6)
    v_mfma_f32_16x16x32_bf16 v[8:11], v[64:67], v[100:103], v[8:11]
    v_mfma_f32_16x16x32_bf16 v[4:7], v[68:71], v[100:103], v[4:7]
    v_mfma_f32_16x16x32_bf16 v[0:3], v[72:75], v[100:103], v[0:3]
    ds_read_b128 v[100:103], v116 offset:4352
    s_waitcnt vmcnt(1) lgkmcnt(6)
    v_mfma_f32_16x16x32_bf16 v[36:39], v[80:83], v[104:107], v[36:39]
    v_mfma_f32_16x16x32_bf16 v[32:35], v[84:87], v[104:107], v[32:35]
    ds_read_b128 v[104:107], v120 offset:6144
    s_waitcnt vmcnt(0) lgkmcnt(6)
    v_mfma_f32_16x16x32_bf16 v[12:15], v[64:67], v[108:111], v[12:15]
    v_mfma_f32_16x16x32_bf16 v[8:11], v[68:71], v[108:111], v[8:11]
    v_mfma_f32_16x16x32_bf16 v[4:7], v[72:75], v[108:111], v[4:7]
    v_mfma_f32_16x16x32_bf16 v[0:3], v[76:79], v[108:111], v[0:3]
    ds_read_b128 v[108:111], v116 offset:5440
    s_waitcnt lgkmcnt(6)
    v_mfma_f32_16x16x32_bf16 v[40:43], v[80:83], v[112:115], v[40:43]
    v_mfma_f32_16x16x32_bf16 v[36:39], v[84:87], v[112:115], v[36:39]
    ds_read_b128 v[112:115], v120 offset:7168
    s_waitcnt lgkmcnt(6)
    v_mfma_f32_16x16x32_bf16 v[16:19], v[64:67], v[88:91], v[16:19]
    v_mfma_f32_16x16x32_bf16 v[12:15], v[68:71], v[88:91], v[12:15]
    v_mfma_f32_16x16x32_bf16 v[8:11], v[72:75], v[88:91], v[8:11]
    v_mfma_f32_16x16x32_bf16 v[4:7], v[76:79], v[88:91], v[4:7]
    ds_read_b128 v[88:91], v117 offset:0
    s_waitcnt lgkmcnt(6)
    v_mfma_f32_16x16x32_bf16 v[44:47], v[80:83], v[92:95], v[44:47]
    v_mfma_f32_16x16x32_bf16 v[40:43], v[84:87], v[92:95], v[40:43]
    ds_read_b128 v[92:95], v122 offset:0
    v_add_u32 v122, v123, v122
    s_waitcnt lgkmcnt(6)
    v_mfma_f32_16x16x32_bf16 v[20:23], v[64:67], v[96:99], v[20:23]
    v_mfma_f32_16x16x32_bf16 v[16:19], v[68:71], v[96:99], v[16:19]
    v_mfma_f32_16x16x32_bf16 v[12:15], v[72:75], v[96:99], v[12:15]
    v_mfma_f32_16x16x32_bf16 v[8:11], v[76:79], v[96:99], v[8:11]
    ds_read_b128 v[96:99], v117 offset:1088
    s_waitcnt lgkmcnt(6)
    v_mfma_f32_16x16x32_bf16 v[48:51], v[80:83], v[100:103], v[48:51]
    v_mfma_f32_16x16x32_bf16 v[44:47], v[84:87], v[100:103], v[44:47]
    ds_read_b128 v[100:103], v121 offset:1024
    s_waitcnt lgkmcnt(6)
    v_mfma_f32_16x16x32_bf16 v[24:27], v[64:67], v[104:107], v[24:27]
    v_mfma_f32_16x16x32_bf16 v[20:23], v[68:71], v[104:107], v[20:23]
    v_mfma_f32_16x16x32_bf16 v[16:19], v[72:75], v[104:107], v[16:19]
    v_mfma_f32_16x16x32_bf16 v[12:15], v[76:79], v[104:107], v[12:15]
    ds_read_b128 v[104:107], v118 offset:0
    s_waitcnt lgkmcnt(6)
    v_mfma_f32_16x16x32_bf16 v[52:55], v[80:83], v[108:111], v[52:55]
    v_mfma_f32_16x16x32_bf16 v[48:51], v[84:87], v[108:111], v[48:51]
    ds_read_b128 v[108:111], v121 offset:2048
    s_waitcnt lgkmcnt(6)
    v_mfma_f32_16x16x32_bf16 v[28:31], v[64:67], v[112:115], v[28:31]
    v_mfma_f32_16x16x32_bf16 v[24:27], v[68:71], v[112:115], v[24:27]
    v_mfma_f32_16x16x32_bf16 v[20:23], v[72:75], v[112:115], v[20:23]
    v_mfma_f32_16x16x32_bf16 v[16:19], v[76:79], v[112:115], v[16:19]
    buffer_load_dwordx4 v[64:67], v125, s[12:15], s23 offen offset:0
    s_waitcnt lgkmcnt(5)
    v_mfma_f32_16x16x32_bf16 v[56:59], v[80:83], v[88:91], v[56:59]
    v_mfma_f32_16x16x32_bf16 v[52:55], v[84:87], v[88:91], v[52:55]
    s_waitcnt lgkmcnt(0)
    s_barrier
    v_mfma_f32_16x16x32_bf16 v[28:31], v[68:71], v[92:95], v[28:31]
    v_mfma_f32_16x16x32_bf16 v[24:27], v[72:75], v[92:95], v[24:27]
    v_mfma_f32_16x16x32_bf16 v[20:23], v[76:79], v[92:95], v[20:23]
    buffer_load_dwordx4 v[68:71], v125, s[12:15], s23 offen offset:2048
    v_mfma_f32_16x16x32_bf16 v[60:63], v[80:83], v[96:99], v[60:63]
    v_mfma_f32_16x16x32_bf16 v[56:59], v[84:87], v[96:99], v[56:59]
    buffer_load_dwordx4 v[80:83], v119, s[12:15], s23 offen offset:0
    v_mfma_f32_16x16x32_bf16 v[28:31], v[72:75], v[100:103], v[28:31]
    v_mfma_f32_16x16x32_bf16 v[24:27], v[76:79], v[100:103], v[24:27]
    buffer_load_dwordx4 v[72:75], v125, s[12:15], s26 offen offset:0
    v_mfma_f32_16x16x32_bf16 v[60:63], v[84:87], v[104:107], v[60:63]
    buffer_load_dwordx4 v[84:87], v119, s[12:15], s23 offen offset:2048
    v_mfma_f32_16x16x32_bf16 v[28:31], v[76:79], v[108:111], v[28:31]
    buffer_load_dwordx4 v[76:79], v125, s[12:15], s26 offen offset:2048
    s_add_u32 s23, s23, 57344
    s_add_u32 s26, s26, 57344
    s_sub_u32 s22, s22, 1
    s_cmp_eq_u32 s22, 0
    s_cbranch_scc1 L_conv2_kernel_mlast2
    ds_read_b128 v[88:91], v120 offset:8192
    ds_read_b128 v[92:95], v120 offset:9216
    ds_read_b128 v[96:99], v116 offset:8704
    ds_read_b128 v[100:103], v120 offset:10240
    ds_read_b128 v[104:107], v116 offset:9792
    ds_read_b128 v[108:111], v120 offset:11264
    ds_read_b128 v[112:115], v116 offset:10880
    s_waitcnt vmcnt(5) lgkmcnt(6)
    v_mfma_f32_16x16x32_bf16 v[0:3], v[64:67], v[88:91], v[0:3]
    ds_read_b128 v[88:91], v120 offset:12288
    s_waitcnt vmcnt(4) lgkmcnt(6)
    v_mfma_f32_16x16x32_bf16 v[4:7], v[64:67], v[92:95], v[4:7]
    v_mfma_f32_16x16x32_bf16 v[0:3], v[68:71], v[92:95], v[0:3]
    ds_read_b128 v[92:95], v116 offset:11968
    s_waitcnt vmcnt(3) lgkmcnt(6)
    v_mfma_f32_16x16x32_bf16 v[32:35], v[80:83], v[96:99], v[32:35]
    ds_read_b128 v[96:99], v120 offset:13312
    s_waitcnt vmcnt(2) lgkmcnt(6)
    v_mfma_f32_16x16x32_bf16 v[8:11], v[64:67], v[100:103], v[8:11]
    v_mfma_f32_16x16x32_bf16 v[4:7], v[68:71], v[100:103], v[4:7]
    v_mfma_f32_16x16x32_bf16 v[0:3], v[72:75], v[100:103], v[0:3]
    ds_read_b128 v[100:103], v116 offset:13056
    s_waitcnt vmcnt(1) lgkmcnt(6)
    v_mfma_f32_16x16x32_bf16 v[36:39], v[80:83], v[104:107], v[36:39]
    v_mfma_f32_16x16x32_bf16 v[32:35], v[84:87], v[104:107], v[32:35]
    ds_read_b128 v[104:107], v120 offset:14336
    s_waitcnt vmcnt(0) lgkmcnt(6)
    v_mfma_f32_16x16x32_bf16 v[12:15], v[64:67], v[108:111], v[12:15]
    v_mfma_f32_16x16x32_bf16 v[8:11], v[68:71], v[108:111], v[8:11]
    v_mfma_f32_16x16x32_bf16 v[4:7], v[72:75], v[108:111], v[4:7]
    v_mfma_f32_16x16x32_bf16 v[0:3], v[76:79], v[108:111], v[0:3]
    ds_read_b128 v[108:111], v116 offset:14144
    s_waitcnt lgkmcnt(6)
    v_mfma_f32_16x16x32_bf16 v[40:43], v[80:83], v[112:115], v[40:43]
    v_mfma_f32_16x16x32_bf16 v[36:39], v[84:87], v[112:115], v[36:39]
    ds_read_b128 v[112:115], v120 offset:15360
    s_waitcnt lgkmcnt(6)
    v_mfma_f32_16x16x32_bf16 v[16:19], v[64:67], v[88:91], v[16:19]
    v_mfma_f32_16x16x32_bf16 v[12:15], v[68:71], v[88:91], v[12:15]
    v_mfma_f32_16x16x32_bf16 v[8:11], v[72:75], v[88:91], v[8:11]
    v_mfma_f32_16x16x32_bf16 v[4:7], v[76:79], v[88:91], v[4:7]
    ds_read_b128 v[88:91], v117 offset:8704
    s_waitcnt lgkmcnt(6)
    v_mfma_f32_16x16x32_bf16 v[44:47], v[80:83], v[92:95], v[44:47]
    v_mfma_f32_16x16x32_bf16 v[40:43], v[84:87], v[92:95], v[40:43]
    ds_read_b128 v[92:95], v122 offset:0
    v_add_u32 v122, v124, v122
    s_waitcnt lgkmcnt(6)
    v_mfma_f32_16x16x32_bf16 v[20:23], v[64:67], v[96:99], v[20:23]
    v_mfma_f32_16x16x32_bf16 v[16:19], v[68:71], v[96:99], v[16:19]
    v_mfma_f32_16x16x32_bf16 v[12:15], v[72:75], v[96:99], v[12:15]
    v_mfma_f32_16x16x32_bf16 v[8:11], v[76:79], v[96:99], v[8:11]
    ds_read_b128 v[96:99], v117 offset:9792
    s_waitcnt lgkmcnt(6)
    v_mfma_f32_16x16x32_bf16 v[48:51], v[80:83], v[100:103], v[48:51]
    v_mfma_f32_16x16x32_bf16 v[44:47], v[84:87], v[100:103], v[44:47]
    ds_read_b128 v[100:103], v121 offset:9216
    s_waitcnt lgkmcnt(6)
    v_mfma_f32_16x16x32_bf16 v[24:27], v[64:67], v[104:107], v[24:27]
    v_mfma_f32_16x16x32_bf16 v[20:23], v[68:71], v[104:107], v[20:23]
    v_mfma_f32_16x16x32_bf16 v[16:19], v[72:75], v[104:107], v[16:19]
    v_mfma_f32_16x16x32_bf16 v[12:15], v[76:79], v[104:107], v[12:15]
    ds_read_b128 v[104:107], v118 offset:8704
    s_waitcnt lgkmcnt(6)
    v_mfma_f32_16x16x32_bf16 v[52:55], v[80:83], v[108:111], v[52:55]
    v_mfma_f32_16x16x32_bf16 v[48:51], v[84:87], v[108:111], v[48:51]
    ds_read_b128 v[108:111], v121 offset:10240
    s_waitcnt lgkmcnt(6)
    v_mfma_f32_16x16x32_bf16 v[28:31], v[64:67], v[112:115], v[28:31]
    v_mfma_f32_16x16x32_bf16 v[24:27], v[68:71], v[112:115], v[24:27]
    v_mfma_f32_16x16x32_bf16 v[20:23], v[72:75], v[112:115], v[20:23]
    v_mfma_f32_16x16x32_bf16 v[16:19], v[76:79], v[112:115], v[16:19]
    buffer_load_dwordx4 v[64:67], v125, s[12:15], s23 offen offset:0
    s_waitcnt lgkmcnt(5)
    v_mfma_f32_16x16x32_bf16 v[56:59], v[80:83], v[88:91], v[56:59]
    v_mfma_f32_16x16x32_bf16 v[52:55], v[84:87], v[88:91], v[52:55]
    s_waitcnt lgkmcnt(0)
    s_barrier
    v_mfma_f32_16x16x32_bf16 v[28:31], v[68:71], v[92:95], v[28:31]
    v_mfma_f32_16x16x32_bf16 v[24:27], v[72:75], v[92:95], v[24:27]
    v_mfma_f32_16x16x32_bf16 v[20:23], v[76:79], v[92:95], v[20:23]
    buffer_load_dwordx4 v[68:71], v125, s[12:15], s23 offen offset:2048
    v_mfma_f32_16x16x32_bf16 v[60:63], v[80:83], v[96:99], v[60:63]
    v_mfma_f32_16x16x32_bf16 v[56:59], v[84:87], v[96:99], v[56:59]
    buffer_load_dwordx4 v[80:83], v119, s[12:15], s23 offen offset:0
    v_mfma_f32_16x16x32_bf16 v[28:31], v[72:75], v[100:103], v[28:31]
    v_mfma_f32_16x16x32_bf16 v[24:27], v[76:79], v[100:103], v[24:27]
    buffer_load_dwordx4 v[72:75], v125, s[12:15], s26 offen offset:0
    v_mfma_f32_16x16x32_bf16 v[60:63], v[84:87], v[104:107], v[60:63]
    buffer_load_dwordx4 v[84:87], v119, s[12:15], s23 offen offset:2048
    v_mfma_f32_16x16x32_bf16 v[28:31], v[76:79], v[108:111], v[28:31]
    buffer_load_dwordx4 v[76:79], v125, s[12:15], s26 offen offset:2048
    s_add_u32 s23, s23, 57344
    s_add_u32 s26, s26, 57344
    s_branch L_conv2_kernel_mloop2
L_conv2_kernel_mlast2:
    v_and_b32 v125, 15, v127
    v_and_b32 v126, 7, v127
    v_lshlrev_b32 v126, 4, v126
    v_lshl_add_u32 v125, v125, 7, v126
    v_lshrrev_b32 v126, 4, v127
    v_lshl_add_u32 v125, v126, 11, v125
    s_mov_b32 s36, 65536
    s_cmp_eq_u32 s32, 1
    s_cselect_b32 s36, 121856, s36
    s_cmp_eq_u32 s32, 2
    s_cselect_b32 s36, 81920, s36
    s_cmp_eq_u32 s32, 3
    s_cselect_b32 s36, 130048, s36
    s_mov_b32 s37, 98304
    s_cmp_eq_u32 s32, 1
    s_cselect_b32 s37, 138240, s37
    s_cmp_eq_u32 s32, 2
    s_cselect_b32 s37, 146432, s37
    s_cmp_eq_u32 s32, 3
    s_cselect_b32 s37, 154624, s37
    v_add_u32 v126, s37, v125
    v_add_u32 v125, s36, v125
    ds_read_b128 v[88:91], v120 offset:8192
    ds_read_b128 v[92:95], v120 offset:9216
    ds_read_b128 v[96:99], v116 offset:8704
    ds_read_b128 v[100:103], v120 offset:10240
    ds_read_b128 v[104:107], v116 offset:9792
    ds_read_b128 v[108:111], v120 offset:11264
    ds_read_b128 v[112:115], v116 offset:10880
    s_waitcnt vmcnt(5) lgkmcnt(6)
    v_mfma_f32_16x16x32_bf16 v[0:3], v[64:67], v[88:91], v[0:3]
    ds_read_b128 v[88:91], v120 offset:12288
    s_waitcnt vmcnt(4) lgkmcnt(6)
    v_mfma_f32_16x16x32_bf16 v[4:7], v[64:67], v[92:95], v[4:7]
    v_mfma_f32_16x16x32_bf16 v[0:3], v[68:71], v[92:95], v[0:3]
    ds_read_b128 v[92:95], v116 offset:11968
    s_waitcnt vmcnt(3) lgkmcnt(6)
    v_mfma_f32_16x16x32_bf16 v[32:35], v[80:83], v[96:99], v[32:35]
    ds_read_b128 v[96:99], v120 offset:13312
    s_waitcnt vmcnt(2) lgkmcnt(6)
    v_mfma_f32_16x16x32_bf16 v[8:11], v[64:67], v[100:103], v[8:11]
    v_mfma_f32_16x16x32_bf16 v[4:7], v[68:71], v[100:103], v[4:7]
    v_mfma_f32_16x16x32_bf16 v[0:3], v[72:75], v[100:103], v[0:3]
    ds_read_b128 v[100:103], v116 offset:13056
    s_waitcnt vmcnt(1) lgkmcnt(6)
    v_mfma_f32_16x16x32_bf16 v[36:39], v[80:83], v[104:107], v[36:39]
    v_mfma_f32_16x16x32_bf16 v[32:35], v[84:87], v[104:107], v[32:35]
    ds_read_b128 v[104:107], v120 offset:14336
    s_waitcnt vmcnt(0) lgkmcnt(6)
    v_mfma_f32_16x16x32_bf16 v[12:15], v[64:67], v[108:111], v[12:15]
    v_mfma_f32_16x16x32_bf16 v[8:11], v[68:71], v[108:111], v[8:11]
    v_mfma_f32_16x16x32_bf16 v[4:7], v[72:75], v[108:111], v[4:7]
    v_mfma_f32_16x16x32_bf16 v[0:3], v[76:79], v[108:111], v[0:3]
    ds_read_b128 v[108:111], v116 offset:14144
    s_waitcnt lgkmcnt(6)
    v_mfma_f32_16x16x32_bf16 v[40:43], v[80:83], v[112:115], v[40:43]
    v_mfma_f32_16x16x32_bf16 v[36:39], v[84:87], v[112:115], v[36:39]
    ds_read_b128 v[112:115], v120 offset:15360
    s_waitcnt lgkmcnt(6)
    v_mfma_f32_16x16x32_bf16 v[16:19], v[64:67], v[88:91], v[16:19]
    v_mfma_f32_16x16x32_bf16 v[12:15], v[68:71], v[88:91], v[12:15]
    v_mfma_f32_16x16x32_bf16 v[8:11], v[72:75], v[88:91], v[8:11]
    v_mfma_f32_16x16x32_bf16 v[4:7], v[76:79], v[88:91], v[4:7]
    ds_read_b128 v[88:91], v117 offset:8704
    v_xor_b32 v124, 0, v126
    ds_write_b128 v124, v[32:35]
    s_waitcnt lgkmcnt(7)
    v_mfma_f32_16x16x32_bf16 v[44:47], v[80:83], v[92:95], v[44:47]
    v_mfma_f32_16x16x32_bf16 v[40:43], v[84:87], v[92:95], v[40:43]
    ds_read_b128 v[92:95], v122 offset:0
    v_xor_b32 v123, 0, v125
    ds_write_b128 v123, v[0:3]
    s_waitcnt lgkmcnt(8)
    v_mfma_f32_16x16x32_bf16 v[20:23], v[64:67], v[96:99], v[20:23]
    v_mfma_f32_16x16x32_bf16 v[16:19], v[68:71], v[96:99], v[16:19]
    v_mfma_f32_16x16x32_bf16 v[12:15], v[72:75], v[96:99], v[12:15]
    v_mfma_f32_16x16x32_bf16 v[8:11], v[76:79], v[96:99], v[8:11]
    ds_read_b128 v[96:99], v117 offset:9792
    v_xor_b32 v123, 16, v126
    ds_write_b128 v123, v[36:39]
    s_waitcnt lgkmcnt(9)
    v_mfma_f32_16x16x32_bf16 v[48:51], v[80:83], v[100:103], v[48:51]
    v_mfma_f32_16x16x32_bf16 v[44:47], v[84:87], v[100:103], v[44:47]
    ds_read_b128 v[100:103], v121 offset:9216
    v_xor_b32 v124, 16, v125
    ds_write_b128 v124, v[4:7]
    s_waitcnt lgkmcnt(10)
    v_mfma_f32_16x16x32_bf16 v[24:27], v[64:67], v[104:107], v[24:27]
    v_mfma_f32_16x16x32_bf16 v[20:23], v[68:71], v[104:107], v[20:23]
    v_mfma_f32_16x16x32_bf16 v[16:19], v[72:75], v[104:107], v[16:19]
    v_mfma_f32_16x16x32_bf16 v[12:15], v[76:79], v[104:107], v[12:15]
    ds_read_b128 v[104:107], v118 offset:8704
    v_xor_b32 v124, 32, v126
    ds_write_b128 v124, v[40:43]
    s_waitcnt lgkmcnt(11)
    v_mfma_f32_16x16x32_bf16 v[52:55], v[80:83], v[108:111], v[52:55]
    v_mfma_f32_16x16x32_bf16 v[48:51], v[84:87], v[108:111], v[48:51]
    ds_read_b128 v[108:111], v121 offset:10240
    v_xor_b32 v123, 32, v125
    ds_write_b128 v123, v[8:11]
    s_waitcnt lgkmcnt(12)
    v_mfma_f32_16x16x32_bf16 v[28:31], v[64:67], v[112:115], v[28:31]
    v_mfma_f32_16x16x32_bf16 v[24:27], v[68:71], v[112:115], v[24:27]
    v_mfma_f32_16x16x32_bf16 v[20:23], v[72:75], v[112:115], v[20:23]
    v_mfma_f32_16x16x32_bf16 v[16:19], v[76:79], v[112:115], v[16:19]
    v_xor_b32 v123, 48, v126
    ds_write_b128 v123, v[44:47]
    s_waitcnt lgkmcnt(12)
    v_mfma_f32_16x16x32_bf16 v[56:59], v[80:83], v[88:91], v[56:59]
    v_mfma_f32_16x16x32_bf16 v[52:55], v[84:87], v[88:91], v[52:55]
    v_xor_b32 v124, 48, v125
    ds_write_b128 v124, v[12:15]
    s_waitcnt lgkmcnt(11)
    v_mfma_f32_16x16x32_bf16 v[28:31], v[68:71], v[92:95], v[28:31]
    v_mfma_f32_16x16x32_bf16 v[24:27], v[72:75], v[92:95], v[24:27]
    v_mfma_f32_16x16x32_bf16 v[20:23], v[76:79], v[92:95], v[20:23]
    v_xor_b32 v124, 64, v126
    ds_write_b128 v124, v[48:51]
    s_waitcnt lgkmcnt(10)
    v_mfma_f32_16x16x32_bf16 v[60:63], v[80:83], v[96:99], v[60:63]
    v_mfma_f32_16x16x32_bf16 v[56:59], v[84:87], v[96:99], v[56:59]
    v_xor_b32 v123, 64, v125
    ds_write_b128 v123, v[16:19]
    s_waitcnt lgkmcnt(9)
    v_mfma_f32_16x16x32_bf16 v[28:31], v[72:75], v[100:103], v[28:31]
    v_mfma_f32_16x16x32_bf16 v[24:27], v[76:79], v[100:103], v[24:27]
    v_xor_b32 v123, 80, v126
    ds_write_b128 v123, v[52:55]
    s_waitcnt lgkmcnt(8)
    v_mfma_f32_16x16x32_bf16 v[60:63], v[84:87], v[104:107], v[60:63]
    v_xor_b32 v124, 80, v125
    ds_write_b128 v124, v[20:23]
    s_waitcnt lgkmcnt(7)
    v_mfma_f32_16x16x32_bf16 v[28:31], v[76:79], v[108:111], v[28:31]
    v_xor_b32 v124, 96, v126
    ds_write_b128 v124, v[56:59]
    v_and_b32 v108, 15, v127
    v_lshrrev_b32 v109, 4, v127
    v_lshrrev_b32 v110, 3, v108
    s_lshl_b32 s36, s20, 1
    v_add_u32 v110, s36, v110
    v_xor_b32 v111, v110, v108
    v_and_b32 v111, 7, v111
    v_lshlrev_b32 v111, 4, v111
    v_xor_b32 v123, 96, v125
    ds_write_b128 v123, v[24:27]
    v_lshl_add_u32 v111, v110, 7, v111
    v_lshl_add_u32 v120, v109, 11, v111
    v_add_u32 v121, 65536, v120
    v_add_u32 v64, 131072, v120
    s_lshl_b32 s36, s20, 9
    s_add_u32 s36, s36, 115712
    v_lshl_add_u32 v127, v109, 7, s36
    s_lshl_b32 s36, s20, 4
    v_add_u32 v108, s36, v108
    v_lshlrev_b32 v110, 6, v108
    v_lshl_add_u32 v110, v109, 4, v110
    s_mul_i32 s36, s29, 262144
    v_xor_b32 v123, 112, v126
    ds_write_b128 v123, v[60:63]
    s_lshl_b32 s37, s21, 4
    s_add_u32 s36, s36, s37
    v_add_u32 v110, s36, v110
    v_mov_b32 v111, 2130706432
    v_cmp_gt_u32 vcc, 125, v108
    s_mov_b32 s4, 0xbeaaaaab
    s_mov_b32 s5, s4
    s_mov_b32 s6, 0x3e800000
    s_mov_b32 s7, s6
    s_mov_b32 s8, 0xc0a00000
    s_mov_b32 s9, s8
    s_mov_b32 s10, 0xc0638e39
    v_xor_b32 v124, 112, v125
    ds_write_b128 v124, v[28:31]
    s_mov_b32 s11, s10
    s_mov_b32 s12, 0xbf638e39
    s_mov_b32 s13, s12
    s_mov_b32 s14, 0xbe638e39
    s_mov_b32 s15, s14
    s_mov_b32 s22, 0xbd638e39
    s_mov_b32 s23, s22
    s_mov_b32 s24, 0x3ff1c71c
    s_mov_b32 s25, s24
    s_mov_b32 s26, 0xbf2aaaab
    s_mov_b32 s27, s26
    s_mov_b32 s32, 0x3ecccccd
    s_mov_b32 s33, s32
    s_mov_b32 s34, 0xbd888889
    s_mov_b32 s35, s34
    s_mov_b32 s38, 0xbe4ccccd
    s_mov_b32 s39, s38
    s_mov_b32 s40, 0xbdd2d3e8
    s_mov_b32 s41, s40
    s_mov_b32 s42, 0x3f800000
    s_mov_b32 s43, s42
    s_setprio 0
    s_branch L_conv2_kernel_epi
L_conv2_kernel_helper:
    s_setprio 3
    v_lshlrev_b32 v8, 4, v6
    s_add_u32 s37, s33, 4294967289
    v_lshl_add_u32 v9, v7, 3, s37
    v_cmp_gt_u32 vcc, 8000, v9
    s_mul_i32 s37, s33, 131072
    s_add_u32 s37, s37, 0
    v_lshl_add_u32 v92, v7, 7, s37
    v_add_u32 v92, v92, v8
    v_mov_b32 v9, 2130706432
    v_cndmask_b32 v92, v9, v92, vcc
    s_add_u32 s37, s33, 4294967291
    v_lshl_add_u32 v9, v7, 3, s37
    v_cmp_gt_u32 vcc, 8000, v9
    s_mul_i32 s37, s33, 131072
    s_add_u32 s37, s37, 262144
    v_lshl_add_u32 v93, v7, 7, s37
    v_add_u32 v93, v93, v8
    v_mov_b32 v9, 2130706432
    v_cndmask_b32 v93, v9, v93, vcc
    s_add_u32 s37, s33, 4294967293
    v_lshl_add_u32 v9, v7, 3, s37
    v_cmp_gt_u32 vcc, 8000, v9
    s_mul_i32 s37, s33, 131072
    s_add_u32 s37, s37, 64
    v_lshl_add_u32 v94, v7, 7, s37
    v_add_u32 v94, v94, v8
    v_mov_b32 v9, 2130706432
    v_cndmask_b32 v94, v9, v94, vcc
    s_add_u32 s37, s33, 4294967295
    v_lshl_add_u32 v9, v7, 3, s37
    v_cmp_gt_u32 vcc, 8000, v9
    s_mul_i32 s37, s33, 131072
    s_add_u32 s37, s37, 262208
    v_lshl_add_u32 v95, v7, 7, s37
    v_add_u32 v95, v95, v8
    v_mov_b32 v9, 2130706432
    v_cndmask_b32 v95, v9, v95, vcc
    v_and_b32 v76, 4, v5
    v_lshrrev_b32 v76, 1, v76
    v_xor_b32 v76, v6, v76
    v_lshlrev_b32 v76, 4, v76
    v_lshl_add_u32 v76, v5, 6, v76
    s_mov_b32 s24, 0
    s_mov_b32 s27, 524288
    s_waitcnt lgkmcnt(0)
    s_add_u32 s8, s4, s47
    s_addc_u32 s9, s5, 0
    buffer_load_dwordx4 v[0:3], v92, s[8:11], s24 offen
    buffer_load_dwordx4 v[8:11], v94, s[8:11], s24 offen
    buffer_load_dwordx4 v[4:7], v93, s[8:11], s24 offen
    buffer_load_dwordx4 v[12:15], v95, s[8:11], s24 offen
    buffer_load_dwordx4 v[16:19], v92, s[8:11], s27 offen
    buffer_load_dwordx4 v[24:27], v94, s[8:11], s27 offen
    buffer_load_dwordx4 v[20:23], v93, s[8:11], s27 offen
    buffer_load_dwordx4 v[28:31], v95, s[8:11], s27 offen
    s_mul_i32 s36, s42, 1024
    v_add_u32 v96, s36, v76
    v_add_u32 v97, 65536, v96
    s_mul_i32 s36, s42, 1088
    s_add_u32 s36, s36, 98304
    v_add_u32 v98, s36, v76
    s_waitcnt vmcnt(0)
    s_mov_b32 s28, 0
    s_mov_b32 s22, 2
    s_cmp_ge_u32 s20, 12
    s_cbranch_scc1 L_conv2_kernel_h2
    ds_write_b128 v96, v[0:3] offset:0
    ds_write_b128 v98, v[12:15] offset:0
    v_lshlrev_b32 v76, 16, v0
    v_and_b32 v84, s25, v0
    v_lshlrev_b32 v77, 16, v4
    v_and_b32 v85, s25, v4
    v_lshlrev_b32 v78, 16, v8
    v_and_b32 v86, s25, v8
    v_lshlrev_b32 v79, 16, v12
    v_and_b32 v87, s25, v12
    v_add_f32 v80, v76, v78
    v_add_f32 v88, v84, v86
    v_add_f32 v81, v77, v79
    v_add_f32 v89, v85, v87
    v_fma_f32 v82, v78, 4.0, v76
    v_fma_f32 v90, v86, 4.0, v84
    v_fma_f32 v83, v79, 4.0, v77
    v_fma_f32 v91, v87, 4.0, v85
    v_add_f32 v77, v80, v81
    v_add_f32 v85, v88, v89
    v_sub_f32 v78, v80, v81
    v_sub_f32 v86, v88, v89
    v_fma_f32 v79, v83, 2.0, v82
    v_fma_f32 v87, v91, 2.0, v90
    v_fma_f32 v82, v83, -2.0, v82
    v_fma_f32 v90, v91, -2.0, v90
    v_fmamk_f32 v80, v76, 0x41700000, v82
    v_fmamk_f32 v88, v84, 0x41700000, v90
    v_fmamk_f32 v80, v81, 0x41200000, v80
    v_fmamk_f32 v88, v89, 0x41200000, v88
    v_cvt_pk_bf16_f32 v4, v77, v85
    v_cvt_pk_bf16_f32 v8, v78, v86
    v_cvt_pk_bf16_f32 v64, v79, v87
    v_cvt_pk_bf16_f32 v68, v82, v90
    v_cvt_pk_bf16_f32 v72, v80, v88
    v_lshlrev_b32 v76, 16, v1
    v_and_b32 v84, s25, v1
    v_lshlrev_b32 v77, 16, v5
    v_and_b32 v85, s25, v5
    v_lshlrev_b32 v78, 16, v9
    v_and_b32 v86, s25, v9
    v_lshlrev_b32 v79, 16, v13
    v_and_b32 v87, s25, v13
    v_add_f32 v80, v76, v78
    v_add_f32 v88, v84, v86
    v_add_f32 v81, v77, v79
    v_add_f32 v89, v85, v87
    v_fma_f32 v82, v78, 4.0, v76
    v_fma_f32 v90, v86, 4.0, v84
    v_fma_f32 v83, v79, 4.0, v77
    v_fma_f32 v91, v87, 4.0, v85
    v_add_f32 v77, v80, v81
    v_add_f32 v85, v88, v89
    v_sub_f32 v78, v80, v81
    v_sub_f32 v86, v88, v89
    v_fma_f32 v79, v83, 2.0, v82
    v_fma_f32 v87, v91, 2.0, v90
    v_fma_f32 v82, v83, -2.0, v82
    v_fma_f32 v90, v91, -2.0, v90
    v_fmamk_f32 v80, v76, 0x41700000, v82
    v_fmamk_f32 v88, v84, 0x41700000, v90
    v_fmamk_f32 v80, v81, 0x41200000, v80
    v_fmamk_f32 v88, v89, 0x41200000, v88
    v_cvt_pk_bf16_f32 v5, v77, v85
    v_cvt_pk_bf16_f32 v9, v78, v86
    v_cvt_pk_bf16_f32 v65, v79, v87
    v_cvt_pk_bf16_f32 v69, v82, v90
    v_cvt_pk_bf16_f32 v73, v80, v88
    v_lshlrev_b32 v76, 16, v2
    v_and_b32 v84, s25, v2
    v_lshlrev_b32 v77, 16, v6
    v_and_b32 v85, s25, v6
    v_lshlrev_b32 v78, 16, v10
    v_and_b32 v86, s25, v10
    v_lshlrev_b32 v79, 16, v14
    v_and_b32 v87, s25, v14
    v_add_f32 v80, v76, v78
    v_add_f32 v88, v84, v86
    v_add_f32 v81, v77, v79
    v_add_f32 v89, v85, v87
    v_fma_f32 v82, v78, 4.0, v76
    v_fma_f32 v90, v86, 4.0, v84
    v_fma_f32 v83, v79, 4.0, v77
    v_fma_f32 v91, v87, 4.0, v85
    v_add_f32 v77, v80, v81
    v_add_f32 v85, v88, v89
    v_sub_f32 v78, v80, v81
    v_sub_f32 v86, v88, v89
    v_fma_f32 v79, v83, 2.0, v82
    v_fma_f32 v87, v91, 2.0, v90
    v_fma_f32 v82, v83, -2.0, v82
    v_fma_f32 v90, v91, -2.0, v90
    v_fmamk_f32 v80, v76, 0x41700000, v82
    v_fmamk_f32 v88, v84, 0x41700000, v90
    v_fmamk_f32 v80, v81, 0x41200000, v80
    v_fmamk_f32 v88, v89, 0x41200000, v88
    v_cvt_pk_bf16_f32 v6, v77, v85
    v_cvt_pk_bf16_f32 v10, v78, v86
    v_cvt_pk_bf16_f32 v66, v79, v87
    v_cvt_pk_bf16_f32 v70, v82, v90
    v_cvt_pk_bf16_f32 v74, v80, v88
    v_lshlrev_b32 v76, 16, v3
    v_and_b32 v84, s25, v3
    v_lshlrev_b32 v77, 16, v7
    v_and_b32 v85, s25, v7
    v_lshlrev_b32 v78, 16, v11
    v_and_b32 v86, s25, v11
    v_lshlrev_b32 v79, 16, v15
    v_and_b32 v87, s25, v15
    v_add_f32 v80, v76, v78
    v_add_f32 v88, v84, v86
    v_add_f32 v81, v77, v79
    v_add_f32 v89, v85, v87
    v_fma_f32 v82, v78, 4.0, v76
    v_fma_f32 v90, v86, 4.0, v84
    v_fma_f32 v83, v79, 4.0, v77
    v_fma_f32 v91, v87, 4.0, v85
    v_add_f32 v77, v80, v81
    v_add_f32 v85, v88, v89
    v_sub_f32 v78, v80, v81
    v_sub_f32 v86, v88, v89
    v_fma_f32 v79, v83, 2.0, v82
    v_fma_f32 v87, v91, 2.0, v90
    v_fma_f32 v82, v83, -2.0, v82
    v_fma_f32 v90, v91, -2.0, v90
    v_fmamk_f32 v80, v76, 0x41700000, v82
    v_fmamk_f32 v88, v84, 0x41700000, v90
    v_fmamk_f32 v80, v81, 0x41200000, v80
    v_fmamk_f32 v88, v89, 0x41200000, v88
    v_cvt_pk_bf16_f32 v7, v77, v85
    v_cvt_pk_bf16_f32 v11, v78, v86
    v_cvt_pk_bf16_f32 v67, v79, v87
    v_cvt_pk_bf16_f32 v71, v82, v90
    v_cvt_pk_bf16_f32 v75, v80, v88
    ds_write_b128 v96, v[64:67] offset:49152
    ds_write_b128 v97, v[68:71] offset:0
    ds_write_b128 v97, v[72:75] offset:16384
    ds_write_b128 v96, v[4:7] offset:16384
    ds_write_b128 v96, v[8:11] offset:32768
    s_waitcnt vmcnt(0)
    s_mov_b32 s24, 1048576
    s_mov_b32 s27, 1572864
    s_waitcnt lgkmcnt(0)
    s_barrier
    buffer_load_dwordx4 v[32:35], v92, s[8:11], s24 offen
    buffer_load_dwordx4 v[40:43], v94, s[8:11], s24 offen
    buffer_load_dwordx4 v[36:39], v93, s[8:11], s24 offen
    buffer_load_dwordx4 v[44:47], v95, s[8:11], s24 offen
    s_setprio 1
L_conv2_kernel_hloop1:
    v_lshlrev_b32 v76, 16, v16
    v_and_b32 v84, s25, v16
    v_lshlrev_b32 v77, 16, v20
    v_and_b32 v85, s25, v20
    v_lshlrev_b32 v78, 16, v24
    v_and_b32 v86, s25, v24
    v_lshlrev_b32 v79, 16, v28
    v_and_b32 v87, s25, v28
    v_add_f32 v80, v76, v78
    v_add_f32 v88, v84, v86
    v_add_f32 v81, v77, v79
    v_add_f32 v89, v85, v87
    v_fma_f32 v82, v78, 4.0, v76
    buffer_load_dwordx4 v[48:51], v92, s[8:11], s27 offen
    buffer_load_dwordx4 v[56:59], v94, s[8:11], s27 offen
    v_fma_f32 v90, v86, 4.0, v84
    v_fma_f32 v83, v79, 4.0, v77
    v_fma_f32 v91, v87, 4.0, v85
    v_add_f32 v77, v80, v81
    v_add_f32 v85, v88, v89
    v_sub_f32 v78, v80, v81
    v_sub_f32 v86, v88, v89
    v_fma_f32 v79, v83, 2.0, v82
    v_fma_f32 v87, v91, 2.0, v90
    v_fma_f32 v82, v83, -2.0, v82
    v_fma_f32 v90, v91, -2.0, v90
    v_fmamk_f32 v80, v76, 0x41700000, v82
    v_fmamk_f32 v88, v84, 0x41700000, v90
    v_fmamk_f32 v80, v81, 0x41200000, v80
    v_fmamk_f32 v88, v89, 0x41200000, v88
    v_cvt_pk_bf16_f32 v20, v77, v85
    v_cvt_pk_bf16_f32 v24, v78, v86
    v_cvt_pk_bf16_f32 v64, v79, v87
    v_cvt_pk_bf16_f32 v68, v82, v90
    v_cvt_pk_bf16_f32 v72, v80, v88
    v_lshlrev_b32 v76, 16, v17
    v_and_b32 v84, s25, v17
    v_lshlrev_b32 v77, 16, v21
    v_and_b32 v85, s25, v21
    v_lshlrev_b32 v78, 16, v25
    v_and_b32 v86, s25, v25
    v_lshlrev_b32 v79, 16, v29
    v_and_b32 v87, s25, v29
    v_add_f32 v80, v76, v78
    v_add_f32 v88, v84, v86
    v_add_f32 v81, v77, v79
    v_add_f32 v89, v85, v87
    v_fma_f32 v82, v78, 4.0, v76
    v_fma_f32 v90, v86, 4.0, v84
    v_fma_f32 v83, v79, 4.0, v77
    v_fma_f32 v91, v87, 4.0, v85
    v_add_f32 v77, v80, v81
    v_add_f32 v85, v88, v89
    v_sub_f32 v78, v80, v81
    v_sub_f32 v86, v88, v89
    v_fma_f32 v79, v83, 2.0, v82
    v_fma_f32 v87, v91, 2.0, v90
    v_fma_f32 v82, v83, -2.0, v82
    v_fma_f32 v90, v91, -2.0, v90
    v_fmamk_f32 v80, v76, 0x41700000, v82
    v_fmamk_f32 v88, v84, 0x41700000, v90
    v_fmamk_f32 v80, v81, 0x41200000, v80
    v_fmamk_f32 v88, v89, 0x41200000, v88
    v_cvt_pk_bf16_f32 v21, v77, v85
    v_cvt_pk_bf16_f32 v25, v78, v86
    v_cvt_pk_bf16_f32 v65, v79, v87
    v_cvt_pk_bf16_f32 v69, v82, v90
    v_cvt_pk_bf16_f32 v73, v80, v88
    buffer_load_dwordx4 v[52:55], v93, s[8:11], s27 offen
    buffer_load_dwordx4 v[60:63], v95, s[8:11], s27 offen
    v_lshlrev_b32 v76, 16, v18
    v_and_b32 v84, s25, v18
    v_lshlrev_b32 v77, 16, v22
    v_and_b32 v85, s25, v22
    v_lshlrev_b32 v78, 16, v26
    v_and_b32 v86, s25, v26
    v_lshlrev_b32 v79, 16, v30
    v_and_b32 v87, s25, v30
    v_add_f32 v80, v76, v78
    v_add_f32 v88, v84, v86
    v_add_f32 v81, v77, v79
    v_add_f32 v89, v85, v87
    v_fma_f32 v82, v78, 4.0, v76
    v_fma_f32 v90, v86, 4.0, v84
    v_fma_f32 v83, v79, 4.0, v77
    v_fma_f32 v91, v87, 4.0, v85
    v_add_f32 v77, v80, v81
    v_add_f32 v85, v88, v89
    v_sub_f32 v78, v80, v81
    v_sub_f32 v86, v88, v89
    v_fma_f32 v79, v83, 2.0, v82
    v_fma_f32 v87, v91, 2.0, v90
    v_fma_f32 v82, v83, -2.0, v82
    v_fma_f32 v90, v91, -2.0, v90
    v_fmamk_f32 v80, v76, 0x41700000, v82
    v_fmamk_f32 v88, v84, 0x41700000, v90
    v_fmamk_f32 v80, v81, 0x41200000, v80
    v_fmamk_f32 v88, v89, 0x41200000, v88
    v_cvt_pk_bf16_f32 v22, v77, v85
    v_cvt_pk_bf16_f32 v26, v78, v86
    v_cvt_pk_bf16_f32 v66, v79, v87
    v_cvt_pk_bf16_f32 v70, v82, v90
    v_cvt_pk_bf16_f32 v74, v80, v88
    v_lshlrev_b32 v76, 16, v19
    v_and_b32 v84, s25, v19
    v_lshlrev_b32 v77, 16, v23
    v_and_b32 v85, s25, v23
    v_lshlrev_b32 v78, 16, v27
    v_and_b32 v86, s25, v27
    v_lshlrev_b32 v79, 16, v31
    v_and_b32 v87, s25, v31
    v_add_f32 v80, v76, v78
    v_add_f32 v88, v84, v86
    v_add_f32 v81, v77, v79
    v_add_f32 v89, v85, v87
    v_fma_f32 v82, v78, 4.0, v76
    v_fma_f32 v90, v86, 4.0, v84
    v_fma_f32 v83, v79, 4.0, v77
    v_fma_f32 v91, v87, 4.0, v85
    v_add_f32 v77, v80, v81
    v_add_f32 v85, v88, v89
    v_sub_f32 v78, v80, v81
    v_sub_f32 v86, v88, v89
    v_fma_f32 v79, v83, 2.0, v82
    v_fma_f32 v87, v91, 2.0, v90
    v_fma_f32 v82, v83, -2.0, v82
    v_fma_f32 v90, v91, -2.0, v90
    v_fmamk_f32 v80, v76, 0x41700000, v82
    v_fmamk_f32 v88, v84, 0x41700000, v90
    v_fmamk_f32 v80, v81, 0x41200000, v80
    v_fmamk_f32 v88, v89, 0x41200000, v88
    v_cvt_pk_bf16_f32 v23, v77, v85
    v_cvt_pk_bf16_f32 v27, v78, v86
    v_cvt_pk_bf16_f32 v67, v79, v87
    v_cvt_pk_bf16_f32 v71, v82, v90
    v_cvt_pk_bf16_f32 v75, v80, v88
    ds_write_b128 v96, v[64:67] offset:57344
    ds_write_b128 v97, v[68:71] offset:8192
    ds_write_b128 v97, v[72:75] offset:24576
    ds_write_b128 v96, v[16:19] offset:8192
    ds_write_b128 v96, v[20:23] offset:24576
    ds_write_b128 v96, v[24:27] offset:40960
    ds_write_b128 v98, v[28:31] offset:8704
    s_add_u32 s28, s28, 1
    s_waitcnt lgkmcnt(0)
    s_barrier
    s_add_u32 s24, s24, 1048576
    s_add_u32 s27, s27, 1048576
    s_waitcnt vmcnt(0)
    v_lshlrev_b32 v76, 16, v32
    v_and_b32 v84, s25, v32
    v_lshlrev_b32 v77, 16, v36
    v_and_b32 v85, s25, v36
    v_lshlrev_b32 v78, 16, v40
    v_and_b32 v86, s25, v40
    v_lshlrev_b32 v79, 16, v44
    v_and_b32 v87, s25, v44
    v_add_f32 v80, v76, v78
    v_add_f32 v88, v84, v86
    v_add_f32 v81, v77, v79
    v_add_f32 v89, v85, v87
    v_fma_f32 v82, v78, 4.0, v76
    v_fma_f32 v90, v86, 4.0, v84
    v_fma_f32 v83, v79, 4.0, v77
    v_fma_f32 v91, v87, 4.0, v85
    v_add_f32 v77, v80, v81
    v_add_f32 v85, v88, v89
    v_sub_f32 v78, v80, v81
    v_sub_f32 v86, v88, v89
    v_fma_f32 v79, v83, 2.0, v82
    v_fma_f32 v87, v91, 2.0, v90
    v_fma_f32 v82, v83, -2.0, v82
    v_fma_f32 v90, v91, -2.0, v90
    v_fmamk_f32 v80, v76, 0x41700000, v82
    v_fmamk_f32 v88, v84, 0x41700000, v90
    v_fmamk_f32 v80, v81, 0x41200000, v80
    v_fmamk_f32 v88, v89, 0x41200000, v88
    v_cvt_pk_bf16_f32 v36, v77, v85
    v_cvt_pk_bf16_f32 v40, v78, v86
    v_cvt_pk_bf16_f32 v64, v79, v87
    v_cvt_pk_bf16_f32 v68, v82, v90
    v_cvt_pk_bf16_f32 v72, v80, v88
    v_lshlrev_b32 v76, 16, v33
    v_and_b32 v84, s25, v33
    v_lshlrev_b32 v77, 16, v37
    v_and_b32 v85, s25, v37
    v_lshlrev_b32 v78, 16, v41
    v_and_b32 v86, s25, v41
    buffer_load_dwordx4 v[0:3], v92, s[8:11], s24 offen
    buffer_load_dwordx4 v[8:11], v94, s[8:11], s24 offen
    v_lshlrev_b32 v79, 16, v45
    v_and_b32 v87, s25, v45
    v_add_f32 v80, v76, v78
    v_add_f32 v88, v84, v86
    v_add_f32 v81, v77, v79
    v_add_f32 v89, v85, v87
    v_fma_f32 v82, v78, 4.0, v76
    v_fma_f32 v90, v86, 4.0, v84
    v_fma_f32 v83, v79, 4.0, v77
    v_fma_f32 v91, v87, 4.0, v85
    v_add_f32 v77, v80, v81
    v_add_f32 v85, v88, v89
    v_sub_f32 v78, v80, v81
    v_sub_f32 v86, v88, v89
    v_fma_f32 v79, v83, 2.0, v82
    v_fma_f32 v87, v91, 2.0, v90
    v_fma_f32 v82, v83, -2.0, v82
    v_fma_f32 v90, v91, -2.0, v90
    v_fmamk_f32 v80, v76, 0x41700000, v82
    v_fmamk_f32 v88, v84, 0x41700000, v90
    v_fmamk_f32 v80, v81, 0x41200000, v80
    v_fmamk_f32 v88, v89, 0x41200000, v88
    v_cvt_pk_bf16_f32 v37, v77, v85
    v_cvt_pk_bf16_f32 v41, v78, v86
    v_cvt_pk_bf16_f32 v65, v79, v87
    v_cvt_pk_bf16_f32 v69, v82, v90
    v_cvt_pk_bf16_f32 v73, v80, v88
    v_lshlrev_b32 v76, 16, v34
    v_and_b32 v84, s25, v34
    v_lshlrev_b32 v77, 16, v38
    v_and_b32 v85, s25, v38
    v_lshlrev_b32 v78, 16, v42
    v_and_b32 v86, s25, v42
    v_lshlrev_b32 v79, 16, v46
    v_and_b32 v87, s25, v46
    v_add_f32 v80, v76, v78
    v_add_f32 v88, v84, v86
    v_add_f32 v81, v77, v79
    v_add_f32 v89, v85, v87
    v_fma_f32 v82, v78, 4.0, v76
    v_fma_f32 v90, v86, 4.0, v84
    v_fma_f32 v83, v79, 4.0, v77
    v_fma_f32 v91, v87, 4.0, v85
    v_add_f32 v77, v80, v81
    v_add_f32 v85, v88, v89
    v_sub_f32 v78, v80, v81
    v_sub_f32 v86, v88, v89
    v_fma_f32 v79, v83, 2.0, v82
    v_fma_f32 v87, v91, 2.0, v90
    v_fma_f32 v82, v83, -2.0, v82
    v_fma_f32 v90, v91, -2.0, v90
    v_fmamk_f32 v80, v76, 0x41700000, v82
    v_fmamk_f32 v88, v84, 0x41700000, v90
    buffer_load_dwordx4 v[4:7], v93, s[8:11], s24 offen
    buffer_load_dwordx4 v[12:15], v95, s[8:11], s24 offen
    v_fmamk_f32 v80, v81, 0x41200000, v80
    v_fmamk_f32 v88, v89, 0x41200000, v88
    v_cvt_pk_bf16_f32 v38, v77, v85
    v_cvt_pk_bf16_f32 v42, v78, v86
    v_cvt_pk_bf16_f32 v66, v79, v87
    v_cvt_pk_bf16_f32 v70, v82, v90
    v_cvt_pk_bf16_f32 v74, v80, v88
    v_lshlrev_b32 v76, 16, v35
    v_and_b32 v84, s25, v35
    v_lshlrev_b32 v77, 16, v39
    v_and_b32 v85, s25, v39
    v_lshlrev_b32 v78, 16, v43
    v_and_b32 v86, s25, v43
    v_lshlrev_b32 v79, 16, v47
    v_and_b32 v87, s25, v47
    v_add_f32 v80, v76, v78
    v_add_f32 v88, v84, v86
    v_add_f32 v81, v77, v79
    v_add_f32 v89, v85, v87
    v_fma_f32 v82, v78, 4.0, v76
    v_fma_f32 v90, v86, 4.0, v84
    v_fma_f32 v83, v79, 4.0, v77
    v_fma_f32 v91, v87, 4.0, v85
    v_add_f32 v77, v80, v81
    v_add_f32 v85, v88, v89
    v_sub_f32 v78, v80, v81
    v_sub_f32 v86, v88, v89
    v_fma_f32 v79, v83, 2.0, v82
    v_fma_f32 v87, v91, 2.0, v90
    v_fma_f32 v82, v83, -2.0, v82
    v_fma_f32 v90, v91, -2.0, v90
    v_fmamk_f32 v80, v76, 0x41700000, v82
    v_fmamk_f32 v88, v84, 0x41700000, v90
    v_fmamk_f32 v80, v81, 0x41200000, v80
    v_fmamk_f32 v88, v89, 0x41200000, v88
    v_cvt_pk_bf16_f32 v39, v77, v85
    v_cvt_pk_bf16_f32 v43, v78, v86
    v_cvt_pk_bf16_f32 v67, v79, v87
    v_cvt_pk_bf16_f32 v71, v82, v90
    v_cvt_pk_bf16_f32 v75, v80, v88
    ds_write_b128 v96, v[64:67] offset:49152
    ds_write_b128 v97, v[68:71] offset:0
    ds_write_b128 v97, v[72:75] offset:16384
    ds_write_b128 v96, v[32:35] offset:0
    ds_write_b128 v96, v[36:39] offset:16384
    ds_write_b128 v96, v[40:43] offset:32768
    ds_write_b128 v98, v[44:47] offset:0
    s_add_u32 s28, s28, 1
    s_waitcnt lgkmcnt(0)
    s_barrier
    v_lshlrev_b32 v76, 16, v48
    v_and_b32 v84, s25, v48
    v_lshlrev_b32 v77, 16, v52
    v_and_b32 v85, s25, v52
    v_lshlrev_b32 v78, 16, v56
    v_and_b32 v86, s25, v56
    v_lshlrev_b32 v79, 16, v60
    v_and_b32 v87, s25, v60
    v_add_f32 v80, v76, v78
    v_add_f32 v88, v84, v86
    v_add_f32 v81, v77, v79
    v_add_f32 v89, v85, v87
    v_fma_f32 v82, v78, 4.0, v76
    buffer_load_dwordx4 v[16:19], v92, s[8:11], s27 offen
    buffer_load_dwordx4 v[24:27], v94, s[8:11], s27 offen
    v_fma_f32 v90, v86, 4.0, v84
    v_fma_f32 v83, v79, 4.0, v77
    v_fma_f32 v91, v87, 4.0, v85
    v_add_f32 v77, v80, v81
    v_add_f32 v85, v88, v89
    v_sub_f32 v78, v80, v81
    v_sub_f32 v86, v88, v89
    v_fma_f32 v79, v83, 2.0, v82
    v_fma_f32 v87, v91, 2.0, v90
    v_fma_f32 v82, v83, -2.0, v82
    v_fma_f32 v90, v91, -2.0, v90
    v_fmamk_f32 v80, v76, 0x41700000, v82
    v_fmamk_f32 v88, v84, 0x41700000, v90
    v_fmamk_f32 v80, v81, 0x41200000, v80
    v_fmamk_f32 v88, v89, 0x41200000, v88
    v_cvt_pk_bf16_f32 v52, v77, v85
    v_cvt_pk_bf16_f32 v56, v78, v86
    v_cvt_pk_bf16_f32 v64, v79, v87
    v_cvt_pk_bf16_f32 v68, v82, v90
    v_cvt_pk_bf16_f32 v72, v80, v88
    v_lshlrev_b32 v76, 16, v49
    v_and_b32 v84, s25, v49
    v_lshlrev_b32 v77, 16, v53
    v_and_b32 v85, s25, v53
    v_lshlrev_b32 v78, 16, v57
    v_and_b32 v86, s25, v57
    v_lshlrev_b32 v79, 16, v61
    v_and_b32 v87, s25, v61
    v_add_f32 v80, v76, v78
    v_add_f32 v88, v84, v86
    v_add_f32 v81, v77, v79
    v_add_f32 v89, v85, v87
    v_fma_f32 v82, v78, 4.0, v76
    v_fma_f32 v90, v86, 4.0, v84
    v_fma_f32 v83, v79, 4.0, v77
    v_fma_f32 v91, v87, 4.0, v85
    v_add_f32 v77, v80, v81
    v_add_f32 v85, v88, v89
    v_sub_f32 v78, v80, v81
    v_sub_f32 v86, v88, v89
    v_fma_f32 v79, v83, 2.0, v82
    v_fma_f32 v87, v91, 2.0, v90
    v_fma_f32 v82, v83, -2.0, v82
    v_fma_f32 v90, v91, -2.0, v90
    v_fmamk_f32 v80, v76, 0x41700000, v82
    v_fmamk_f32 v88, v84, 0x41700000, v90
    v_fmamk_f32 v80, v81, 0x41200000, v80
    v_fmamk_f32 v88, v89, 0x41200000, v88
    v_cvt_pk_bf16_f32 v53, v77, v85
    v_cvt_pk_bf16_f32 v57, v78, v86
    v_cvt_pk_bf16_f32 v65, v79, v87
    v_cvt_pk_bf16_f32 v69, v82, v90
    v_cvt_pk_bf16_f32 v73, v80, v88
    buffer_load_dwordx4 v[20:23], v93, s[8:11], s27 offen
    buffer_load_dwordx4 v[28:31], v95, s[8:11], s27 offen
    v_lshlrev_b32 v76, 16, v50
    v_and_b32 v84, s25, v50
    v_lshlrev_b32 v77, 16, v54
    v_and_b32 v85, s25, v54
    v_lshlrev_b32 v78, 16, v58
    v_and_b32 v86, s25, v58
    v_lshlrev_b32 v79, 16, v62
    v_and_b32 v87, s25, v62
    v_add_f32 v80, v76, v78
    v_add_f32 v88, v84, v86
    v_add_f32 v81, v77, v79
    v_add_f32 v89, v85, v87
    v_fma_f32 v82, v78, 4.0, v76
    v_fma_f32 v90, v86, 4.0, v84
    v_fma_f32 v83, v79, 4.0, v77
    v_fma_f32 v91, v87, 4.0, v85
    v_add_f32 v77, v80, v81
    v_add_f32 v85, v88, v89
    v_sub_f32 v78, v80, v81
    v_sub_f32 v86, v88, v89
    v_fma_f32 v79, v83, 2.0, v82
    v_fma_f32 v87, v91, 2.0, v90
    v_fma_f32 v82, v83, -2.0, v82
    v_fma_f32 v90, v91, -2.0, v90
    v_fmamk_f32 v80, v76, 0x41700000, v82
    v_fmamk_f32 v88, v84, 0x41700000, v90
    v_fmamk_f32 v80, v81, 0x41200000, v80
    v_fmamk_f32 v88, v89, 0x41200000, v88
    v_cvt_pk_bf16_f32 v54, v77, v85
    v_cvt_pk_bf16_f32 v58, v78, v86
    v_cvt_pk_bf16_f32 v66, v79, v87
    v_cvt_pk_bf16_f32 v70, v82, v90
    v_cvt_pk_bf16_f32 v74, v80, v88
    v_lshlrev_b32 v76, 16, v51
    v_and_b32 v84, s25, v51
    v_lshlrev_b32 v77, 16, v55
    v_and_b32 v85, s25, v55
    v_lshlrev_b32 v78, 16, v59
    v_and_b32 v86, s25, v59
    v_lshlrev_b32 v79, 16, v63
    v_and_b32 v87, s25, v63
    v_add_f32 v80, v76, v78
    v_add_f32 v88, v84, v86
    v_add_f32 v81, v77, v79
    v_add_f32 v89, v85, v87
    v_fma_f32 v82, v78, 4.0, v76
    v_fma_f32 v90, v86, 4.0, v84
    v_fma_f32 v83, v79, 4.0, v77
    v_fma_f32 v91, v87, 4.0, v85
    v_add_f32 v77, v80, v81
    v_add_f32 v85, v88, v89
    v_sub_f32 v78, v80, v81
    v_sub_f32 v86, v88, v89
    v_fma_f32 v79, v83, 2.0, v82
    v_fma_f32 v87, v91, 2.0, v90
    v_fma_f32 v82, v83, -2.0, v82
    v_fma_f32 v90, v91, -2.0, v90
    v_fmamk_f32 v80, v76, 0x41700000, v82
    v_fmamk_f32 v88, v84, 0x41700000, v90
    v_fmamk_f32 v80, v81, 0x41200000, v80
    v_fmamk_f32 v88, v89, 0x41200000, v88
    v_cvt_pk_bf16_f32 v55, v77, v85
    v_cvt_pk_bf16_f32 v59, v78, v86
    v_cvt_pk_bf16_f32 v67, v79, v87
    v_cvt_pk_bf16_f32 v71, v82, v90
    v_cvt_pk_bf16_f32 v75, v80, v88
    ds_write_b128 v96, v[64:67] offset:57344
    ds_write_b128 v97, v[68:71] offset:8192
    ds_write_b128 v97, v[72:75] offset:24576
    ds_write_b128 v96, v[48:51] offset:8192
    ds_write_b128 v96, v[52:55] offset:24576
    ds_write_b128 v96, v[56:59] offset:40960
    ds_write_b128 v98, v[60:63] offset:8704
    s_add_u32 s28, s28, 1
    s_waitcnt lgkmcnt(0)
    s_barrier
    s_cmp_eq_u32 s22, 1
    s_cbranch_scc1 L_conv2_kernel_hlast1
    s_add_u32 s24, s24, 1048576
    s_add_u32 s27, s27, 1048576
    s_waitcnt vmcnt(0)
    v_lshlrev_b32 v76, 16, v0
    v_and_b32 v84, s25, v0
    v_lshlrev_b32 v77, 16, v4
    v_and_b32 v85, s25, v4
    v_lshlrev_b32 v78, 16, v8
    v_and_b32 v86, s25, v8
    v_lshlrev_b32 v79, 16, v12
    v_and_b32 v87, s25, v12
    v_add_f32 v80, v76, v78
    v_add_f32 v88, v84, v86
    v_add_f32 v81, v77, v79
    v_add_f32 v89, v85, v87
    v_fma_f32 v82, v78, 4.0, v76
    v_fma_f32 v90, v86, 4.0, v84
    v_fma_f32 v83, v79, 4.0, v77
    v_fma_f32 v91, v87, 4.0, v85
    v_add_f32 v77, v80, v81
    v_add_f32 v85, v88, v89
    v_sub_f32 v78, v80, v81
    v_sub_f32 v86, v88, v89
    v_fma_f32 v79, v83, 2.0, v82
    v_fma_f32 v87, v91, 2.0, v90
    v_fma_f32 v82, v83, -2.0, v82
    v_fma_f32 v90, v91, -2.0, v90
    v_fmamk_f32 v80, v76, 0x41700000, v82
    v_fmamk_f32 v88, v84, 0x41700000, v90
    v_fmamk_f32 v80, v81, 0x41200000, v80
    v_fmamk_f32 v88, v89, 0x41200000, v88
    v_cvt_pk_bf16_f32 v4, v77, v85
    v_cvt_pk_bf16_f32 v8, v78, v86
    v_cvt_pk_bf16_f32 v64, v79, v87
    v_cvt_pk_bf16_f32 v68, v82, v90
    v_cvt_pk_bf16_f32 v72, v80, v88
    v_lshlrev_b32 v76, 16, v1
    v_and_b32 v84, s25, v1
    v_lshlrev_b32 v77, 16, v5
    v_and_b32 v85, s25, v5
    v_lshlrev_b32 v78, 16, v9
    v_and_b32 v86, s25, v9
    buffer_load_dwordx4 v[32:35], v92, s[8:11], s24 offen
    buffer_load_dwordx4 v[40:43], v94, s[8:11], s24 offen
    v_lshlrev_b32 v79, 16, v13
    v_and_b32 v87, s25, v13
    v_add_f32 v80, v76, v78
    v_add_f32 v88, v84, v86
    v_add_f32 v81, v77, v79
    v_add_f32 v89, v85, v87
    v_fma_f32 v82, v78, 4.0, v76
    v_fma_f32 v90, v86, 4.0, v84
    v_fma_f32 v83, v79, 4.0, v77
    v_fma_f32 v91, v87, 4.0, v85
    v_add_f32 v77, v80, v81
    v_add_f32 v85, v88, v89
    v_sub_f32 v78, v80, v81
    v_sub_f32 v86, v88, v89
    v_fma_f32 v79, v83, 2.0, v82
    v_fma_f32 v87, v91, 2.0, v90
    v_fma_f32 v82, v83, -2.0, v82
    v_fma_f32 v90, v91, -2.0, v90
    v_fmamk_f32 v80, v76, 0x41700000, v82
    v_fmamk_f32 v88, v84, 0x41700000, v90
    v_fmamk_f32 v80, v81, 0x41200000, v80
    v_fmamk_f32 v88, v89, 0x41200000, v88
    v_cvt_pk_bf16_f32 v5, v77, v85
    v_cvt_pk_bf16_f32 v9, v78, v86
    v_cvt_pk_bf16_f32 v65, v79, v87
    v_cvt_pk_bf16_f32 v69, v82, v90
    v_cvt_pk_bf16_f32 v73, v80, v88
    v_lshlrev_b32 v76, 16, v2
    v_and_b32 v84, s25, v2
    v_lshlrev_b32 v77, 16, v6
    v_and_b32 v85, s25, v6
    v_lshlrev_b32 v78, 16, v10
    v_and_b32 v86, s25, v10
    v_lshlrev_b32 v79, 16, v14
    v_and_b32 v87, s25, v14
    v_add_f32 v80, v76, v78
    v_add_f32 v88, v84, v86
    v_add_f32 v81, v77, v79
    v_add_f32 v89, v85, v87
    v_fma_f32 v82, v78, 4.0, v76
    v_fma_f32 v90, v86, 4.0, v84
    v_fma_f32 v83, v79, 4.0, v77
    v_fma_f32 v91, v87, 4.0, v85
    v_add_f32 v77, v80, v81
    v_add_f32 v85, v88, v89
    v_sub_f32 v78, v80, v81
    v_sub_f32 v86, v88, v89
    v_fma_f32 v79, v83, 2.0, v82
    v_fma_f32 v87, v91, 2.0, v90
    v_fma_f32 v82, v83, -2.0, v82
    v_fma_f32 v90, v91, -2.0, v90
    v_fmamk_f32 v80, v76, 0x41700000, v82
    v_fmamk_f32 v88, v84, 0x41700000, v90
    buffer_load_dwordx4 v[36:39], v93, s[8:11], s24 offen
    buffer_load_dwordx4 v[44:47], v95, s[8:11], s24 offen
    v_fmamk_f32 v80, v81, 0x41200000, v80
    v_fmamk_f32 v88, v89, 0x41200000, v88
    v_cvt_pk_bf16_f32 v6, v77, v85
    v_cvt_pk_bf16_f32 v10, v78, v86
    v_cvt_pk_bf16_f32 v66, v79, v87
    v_cvt_pk_bf16_f32 v70, v82, v90
    v_cvt_pk_bf16_f32 v74, v80, v88
    v_lshlrev_b32 v76, 16, v3
    v_and_b32 v84, s25, v3
    v_lshlrev_b32 v77, 16, v7
    v_and_b32 v85, s25, v7
    v_lshlrev_b32 v78, 16, v11
    v_and_b32 v86, s25, v11
    v_lshlrev_b32 v79, 16, v15
    v_and_b32 v87, s25, v15
    v_add_f32 v80, v76, v78
    v_add_f32 v88, v84, v86
    v_add_f32 v81, v77, v79
    v_add_f32 v89, v85, v87
    v_fma_f32 v82, v78, 4.0, v76
    v_fma_f32 v90, v86, 4.0, v84
    v_fma_f32 v83, v79, 4.0, v77
    v_fma_f32 v91, v87, 4.0, v85
    v_add_f32 v77, v80, v81
    v_add_f32 v85, v88, v89
    v_sub_f32 v78, v80, v81
    v_sub_f32 v86, v88, v89
    v_fma_f32 v79, v83, 2.0, v82
    v_fma_f32 v87, v91, 2.0, v90
    v_fma_f32 v82, v83, -2.0, v82
    v_fma_f32 v90, v91, -2.0, v90
    v_fmamk_f32 v80, v76, 0x41700000, v82
    v_fmamk_f32 v88, v84, 0x41700000, v90
    v_fmamk_f32 v80, v81, 0x41200000, v80
    v_fmamk_f32 v88, v89, 0x41200000, v88
    v_cvt_pk_bf16_f32 v7, v77, v85
    v_cvt_pk_bf16_f32 v11, v78, v86
    v_cvt_pk_bf16_f32 v67, v79, v87
    v_cvt_pk_bf16_f32 v71, v82, v90
    v_cvt_pk_bf16_f32 v75, v80, v88
    ds_write_b128 v96, v[64:67] offset:49152
    ds_write_b128 v97, v[68:71] offset:0
    ds_write_b128 v97, v[72:75] offset:16384
    ds_write_b128 v96, v[0:3] offset:0
    ds_write_b128 v96, v[4:7] offset:16384
    ds_write_b128 v96, v[8:11] offset:32768
    ds_write_b128 v98, v[12:15] offset:0
    s_add_u32 s28, s28, 1
    s_waitcnt lgkmcnt(0)
    s_barrier
    s_sub_u32 s22, s22, 1
    s_branch L_conv2_kernel_hloop1
L_conv2_kernel_hlast1:
    s_add_u32 s12, s30, 44040192
    s_addc_u32 s13, s31, 0
    s_mov_b32 s14, 294912
    s_mov_b32 s15, 0x00020000
    s_lshr_b32 s36, s2, 3
    s_lshl_b32 s36, s36, 2
    s_add_u32 s36, s36, s32
    s_mul_i32 s36, s36, 2304
    v_lshlrev_b32 v1, 4, v127
    buffer_load_dwordx4 v[4:7], v1, s[12:15], s36 offen offset:0
    buffer_load_dwordx4 v[4:7], v1, s[12:15], s36 offen offset:1024
    buffer_load_dwordx4 v[4:7], v1, s[12:15], s36 offen offset:2048
    s_cmp_ge_u32 s2, 32
    s_cbranch_scc1 L_conv2_kernel_ntw
    s_getpc_b64 s[36:37]
L_conv2_kernel_pc:
    s_lshl_b32 s38, s32, 13
    s_add_u32 s38, s38, L_conv2_kernel_epi-L_conv2_kernel_pc
    v_lshl_add_u32 v2, v127, 7, s38
    v_min_u32 v2, L_joint_kernel_done-L_conv2_kernel_pc, v2
    v_mov_b32 v3, s37
    v_add_co_u32 v2, vcc, s36, v2
    s_nop 1
    v_addc_co_u32 v3, vcc, 0, v3, vcc
    global_load_dword v4, v[2:3], off
L_conv2_kernel_ntw:
    s_branch L_conv2_kernel_end
L_conv2_kernel_h2:
    ds_write_b128 v96, v[0:3] offset:0
    ds_write_b128 v98, v[12:15] offset:0
    v_lshlrev_b32 v76, 16, v0
    v_and_b32 v84, s25, v0
    v_lshlrev_b32 v77, 16, v4
    v_and_b32 v85, s25, v4
    v_lshlrev_b32 v78, 16, v8
    v_and_b32 v86, s25, v8
    v_lshlrev_b32 v79, 16, v12
    v_and_b32 v87, s25, v12
    v_add_f32 v80, v76, v78
    v_add_f32 v88, v84, v86
    v_add_f32 v81, v77, v79
    v_add_f32 v89, v85, v87
    v_fma_f32 v82, v78, 4.0, v76
    v_fma_f32 v90, v86, 4.0, v84
    v_fma_f32 v83, v79, 4.0, v77
    v_fma_f32 v91, v87, 4.0, v85
    v_add_f32 v77, v80, v81
    v_add_f32 v85, v88, v89
    v_sub_f32 v78, v80, v81
    v_sub_f32 v86, v88, v89
    v_fma_f32 v79, v83, 2.0, v82
    v_fma_f32 v87, v91, 2.0, v90
    v_fma_f32 v82, v83, -2.0, v82
    v_fma_f32 v90, v91, -2.0, v90
    v_fmamk_f32 v80, v76, 0x41700000, v82
    v_fmamk_f32 v88, v84, 0x41700000, v90
    v_fmamk_f32 v80, v81, 0x41200000, v80
    v_fmamk_f32 v88, v89, 0x41200000, v88
    v_cvt_pk_bf16_f32 v4, v77, v85
    v_cvt_pk_bf16_f32 v8, v78, v86
    v_cvt_pk_bf16_f32 v64, v79, v87
    v_cvt_pk_bf16_f32 v68, v82, v90
    v_cvt_pk_bf16_f32 v72, v80, v88
    v_lshlrev_b32 v76, 16, v1
    v_and_b32 v84, s25, v1
    v_lshlrev_b32 v77, 16, v5
    v_and_b32 v85, s25, v5
    v_lshlrev_b32 v78, 16, v9
    v_and_b32 v86, s25, v9
    v_lshlrev_b32 v79, 16, v13
    v_and_b32 v87, s25, v13
    v_add_f32 v80, v76, v78
    v_add_f32 v88, v84, v86
    v_add_f32 v81, v77, v79
    v_add_f32 v89, v85, v87
    v_fma_f32 v82, v78, 4.0, v76
    v_fma_f32 v90, v86, 4.0, v84
    v_fma_f32 v83, v79, 4.0, v77
    v_fma_f32 v91, v87, 4.0, v85
    v_add_f32 v77, v80, v81
    v_add_f32 v85, v88, v89
    v_sub_f32 v78, v80, v81
    v_sub_f32 v86, v88, v89
    v_fma_f32 v79, v83, 2.0, v82
    v_fma_f32 v87, v91, 2.0, v90
    v_fma_f32 v82, v83, -2.0, v82
    v_fma_f32 v90, v91, -2.0, v90
    v_fmamk_f32 v80, v76, 0x41700000, v82
    v_fmamk_f32 v88, v84, 0x41700000, v90
    v_fmamk_f32 v80, v81, 0x41200000, v80
    v_fmamk_f32 v88, v89, 0x41200000, v88
    v_cvt_pk_bf16_f32 v5, v77, v85
    v_cvt_pk_bf16_f32 v9, v78, v86
    v_cvt_pk_bf16_f32 v65, v79, v87
    v_cvt_pk_bf16_f32 v69, v82, v90
    v_cvt_pk_bf16_f32 v73, v80, v88
    v_lshlrev_b32 v76, 16, v2
    v_and_b32 v84, s25, v2
    v_lshlrev_b32 v77, 16, v6
    v_and_b32 v85, s25, v6
    v_lshlrev_b32 v78, 16, v10
    v_and_b32 v86, s25, v10
    v_lshlrev_b32 v79, 16, v14
    v_and_b32 v87, s25, v14
    v_add_f32 v80, v76, v78
    v_add_f32 v88, v84, v86
    v_add_f32 v81, v77, v79
    v_add_f32 v89, v85, v87
    v_fma_f32 v82, v78, 4.0, v76
    v_fma_f32 v90, v86, 4.0, v84
    v_fma_f32 v83, v79, 4.0, v77
    v_fma_f32 v91, v87, 4.0, v85
    v_add_f32 v77, v80, v81
    v_add_f32 v85, v88, v89
    v_sub_f32 v78, v80, v81
    v_sub_f32 v86, v88, v89
    v_fma_f32 v79, v83, 2.0, v82
    v_fma_f32 v87, v91, 2.0, v90
    v_fma_f32 v82, v83, -2.0, v82
    v_fma_f32 v90, v91, -2.0, v90
    v_fmamk_f32 v80, v76, 0x41700000, v82
    v_fmamk_f32 v88, v84, 0x41700000, v90
    v_fmamk_f32 v80, v81, 0x41200000, v80
    v_fmamk_f32 v88, v89, 0x41200000, v88
    v_cvt_pk_bf16_f32 v6, v77, v85
    v_cvt_pk_bf16_f32 v10, v78, v86
    v_cvt_pk_bf16_f32 v66, v79, v87
    v_cvt_pk_bf16_f32 v70, v82, v90
    v_cvt_pk_bf16_f32 v74, v80, v88
    v_lshlrev_b32 v76, 16, v3
    v_and_b32 v84, s25, v3
    v_lshlrev_b32 v77, 16, v7
    v_and_b32 v85, s25, v7
    v_lshlrev_b32 v78, 16, v11
    v_and_b32 v86, s25, v11
    v_lshlrev_b32 v79, 16, v15
    v_and_b32 v87, s25, v15
    v_add_f32 v80, v76, v78
    v_add_f32 v88, v84, v86
    v_add_f32 v81, v77, v79
    v_add_f32 v89, v85, v87
    v_fma_f32 v82, v78, 4.0, v76
    v_fma_f32 v90, v86, 4.0, v84
    v_fma_f32 v83, v79, 4.0, v77
    v_fma_f32 v91, v87, 4.0, v85
    v_add_f32 v77, v80, v81
    v_add_f32 v85, v88, v89
    v_sub_f32 v78, v80, v81
    v_sub_f32 v86, v88, v89
    v_fma_f32 v79, v83, 2.0, v82
    v_fma_f32 v87, v91, 2.0, v90
    v_fma_f32 v82, v83, -2.0, v82
    v_fma_f32 v90, v91, -2.0, v90
    v_fmamk_f32 v80, v76, 0x41700000, v82
    v_fmamk_f32 v88, v84, 0x41700000, v90
    v_fmamk_f32 v80, v81, 0x41200000, v80
    v_fmamk_f32 v88, v89, 0x41200000, v88
    v_cvt_pk_bf16_f32 v7, v77, v85
    v_cvt_pk_bf16_f32 v11, v78, v86
    v_cvt_pk_bf16_f32 v67, v79, v87
    v_cvt_pk_bf16_f32 v71, v82, v90
    v_cvt_pk_bf16_f32 v75, v80, v88
    ds_write_b128 v96, v[64:67] offset:49152
    ds_write_b128 v97, v[68:71] offset:0
    ds_write_b128 v97, v[72:75] offset:16384
    ds_write_b128 v96, v[4:7] offset:16384
    ds_write_b128 v96, v[8:11] offset:32768
    s_waitcnt vmcnt(0)
    s_mov_b32 s24, 1048576
    s_mov_b32 s27, 1572864
    s_waitcnt lgkmcnt(0)
    s_barrier
    buffer_load_dwordx4 v[32:35], v92, s[8:11], s24 offen
    buffer_load_dwordx4 v[40:43], v94, s[8:11], s24 offen
    buffer_load_dwordx4 v[36:39], v93, s[8:11], s24 offen
    buffer_load_dwordx4 v[44:47], v95, s[8:11], s24 offen
    buffer_load_dwordx4 v[48:51], v92, s[8:11], s27 offen
    buffer_load_dwordx4 v[56:59], v94, s[8:11], s27 offen
    buffer_load_dwordx4 v[52:55], v93, s[8:11], s27 offen
    buffer_load_dwordx4 v[60:63], v95, s[8:11], s27 offen
    s_setprio 0
    v_lshlrev_b32 v76, 16, v16
    v_and_b32 v84, s25, v16
    v_lshlrev_b32 v77, 16, v20
    v_and_b32 v85, s25, v20
    v_lshlrev_b32 v78, 16, v24
    v_and_b32 v86, s25, v24
    v_lshlrev_b32 v79, 16, v28
    v_and_b32 v87, s25, v28
    v_add_f32 v80, v76, v78
    v_add_f32 v88, v84, v86
    v_add_f32 v81, v77, v79
    v_add_f32 v89, v85, v87
    v_fma_f32 v82, v78, 4.0, v76
    v_fma_f32 v90, v86, 4.0, v84
    v_fma_f32 v83, v79, 4.0, v77
    v_fma_f32 v91, v87, 4.0, v85
    v_add_f32 v77, v80, v81
    v_add_f32 v85, v88, v89
    v_sub_f32 v78, v80, v81
    v_sub_f32 v86, v88, v89
    v_fma_f32 v79, v83, 2.0, v82
    v_fma_f32 v87, v91, 2.0, v90
    v_fma_f32 v82, v83, -2.0, v82
    v_fma_f32 v90, v91, -2.0, v90
    v_fmamk_f32 v80, v76, 0x41700000, v82
    v_fmamk_f32 v88, v84, 0x41700000, v90
    v_fmamk_f32 v80, v81, 0x41200000, v80
    v_fmamk_f32 v88, v89, 0x41200000, v88
    v_cvt_pk_bf16_f32 v20, v77, v85
    v_cvt_pk_bf16_f32 v24, v78, v86
    v_cvt_pk_bf16_f32 v64, v79, v87
    v_cvt_pk_bf16_f32 v68, v82, v90
    v_cvt_pk_bf16_f32 v72, v80, v88
    v_lshlrev_b32 v76, 16, v17
    v_and_b32 v84, s25, v17
    v_lshlrev_b32 v77, 16, v21
    v_and_b32 v85, s25, v21
    v_lshlrev_b32 v78, 16, v25
    v_and_b32 v86, s25, v25
    v_lshlrev_b32 v79, 16, v29
    v_and_b32 v87, s25, v29
    v_add_f32 v80, v76, v78
    v_add_f32 v88, v84, v86
    v_add_f32 v81, v77, v79
    v_add_f32 v89, v85, v87
    v_fma_f32 v82, v78, 4.0, v76
    v_fma_f32 v90, v86, 4.0, v84
    v_fma_f32 v83, v79, 4.0, v77
    v_fma_f32 v91, v87, 4.0, v85
    v_add_f32 v77, v80, v81
    v_add_f32 v85, v88, v89
    v_sub_f32 v78, v80, v81
    v_sub_f32 v86, v88, v89
    v_fma_f32 v79, v83, 2.0, v82
    v_fma_f32 v87, v91, 2.0, v90
    v_fma_f32 v82, v83, -2.0, v82
    v_fma_f32 v90, v91, -2.0, v90
    v_fmamk_f32 v80, v76, 0x41700000, v82
    v_fmamk_f32 v88, v84, 0x41700000, v90
    v_fmamk_f32 v80, v81, 0x41200000, v80
    v_fmamk_f32 v88, v89, 0x41200000, v88
    v_cvt_pk_bf16_f32 v21, v77, v85
    v_cvt_pk_bf16_f32 v25, v78, v86
    v_cvt_pk_bf16_f32 v65, v79, v87
    v_cvt_pk_bf16_f32 v69, v82, v90
    v_cvt_pk_bf16_f32 v73, v80, v88
    v_lshlrev_b32 v76, 16, v18
    v_and_b32 v84, s25, v18
    v_lshlrev_b32 v77, 16, v22
    v_and_b32 v85, s25, v22
    v_lshlrev_b32 v78, 16, v26
    v_and_b32 v86, s25, v26
    v_lshlrev_b32 v79, 16, v30
    v_and_b32 v87, s25, v30
    v_add_f32 v80, v76, v78
    v_add_f32 v88, v84, v86
    v_add_f32 v81, v77, v79
    v_add_f32 v89, v85, v87
    v_fma_f32 v82, v78, 4.0, v76
    v_fma_f32 v90, v86, 4.0, v84
    v_fma_f32 v83, v79, 4.0, v77
    v_fma_f32 v91, v87, 4.0, v85
    v_add_f32 v77, v80, v81
    v_add_f32 v85, v88, v89
    v_sub_f32 v78, v80, v81
    v_sub_f32 v86, v88, v89
    v_fma_f32 v79, v83, 2.0, v82
    v_fma_f32 v87, v91, 2.0, v90
    v_fma_f32 v82, v83, -2.0, v82
    v_fma_f32 v90, v91, -2.0, v90
    v_fmamk_f32 v80, v76, 0x41700000, v82
    v_fmamk_f32 v88, v84, 0x41700000, v90
    v_fmamk_f32 v80, v81, 0x41200000, v80
    v_fmamk_f32 v88, v89, 0x41200000, v88
    v_cvt_pk_bf16_f32 v22, v77, v85
    v_cvt_pk_bf16_f32 v26, v78, v86
    v_cvt_pk_bf16_f32 v66, v79, v87
    v_cvt_pk_bf16_f32 v70, v82, v90
    v_cvt_pk_bf16_f32 v74, v80, v88
    v_lshlrev_b32 v76, 16, v19
    v_and_b32 v84, s25, v19
    v_lshlrev_b32 v77, 16, v23
    v_and_b32 v85, s25, v23
    v_lshlrev_b32 v78, 16, v27
    v_and_b32 v86, s25, v27
    v_lshlrev_b32 v79, 16, v31
    v_and_b32 v87, s25, v31
    v_add_f32 v80, v76, v78
    v_add_f32 v88, v84, v86
    v_add_f32 v81, v77, v79
    v_add_f32 v89, v85, v87
    v_fma_f32 v82, v78, 4.0, v76
    v_fma_f32 v90, v86, 4.0, v84
    v_fma_f32 v83, v79, 4.0, v77
    v_fma_f32 v91, v87, 4.0, v85
    v_add_f32 v77, v80, v81
    v_add_f32 v85, v88, v89
    v_sub_f32 v78, v80, v81
    v_sub_f32 v86, v88, v89
    v_fma_f32 v79, v83, 2.0, v82
    v_fma_f32 v87, v91, 2.0, v90
    v_fma_f32 v82, v83, -2.0, v82
    v_fma_f32 v90, v91, -2.0, v90
    v_fmamk_f32 v80, v76, 0x41700000, v82
    v_fmamk_f32 v88, v84, 0x41700000, v90
    v_fmamk_f32 v80, v81, 0x41200000, v80
    v_fmamk_f32 v88, v89, 0x41200000, v88
    v_cvt_pk_bf16_f32 v23, v77, v85
    v_cvt_pk_bf16_f32 v27, v78, v86
    v_cvt_pk_bf16_f32 v67, v79, v87
    v_cvt_pk_bf16_f32 v71, v82, v90
    v_cvt_pk_bf16_f32 v75, v80, v88
L_conv2_kernel_hloop2:
    s_add_u32 s24, s24, 1048576
    s_add_u32 s27, s27, 1048576
    ds_write_b128 v96, v[64:67] offset:57344
    ds_write_b128 v97, v[68:71] offset:8192
    ds_write_b128 v97, v[72:75] offset:24576
    ds_write_b128 v96, v[16:19] offset:8192
    ds_write_b128 v96, v[20:23] offset:24576
    ds_write_b128 v96, v[24:27] offset:40960
    ds_write_b128 v98, v[28:31] offset:8704
    s_waitcnt vmcnt(0)
    buffer_load_dwordx4 v[0:3], v92, s[8:11], s24 offen
    buffer_load_dwordx4 v[8:11], v94, s[8:11], s24 offen
    buffer_load_dwordx4 v[4:7], v93, s[8:11], s24 offen
    buffer_load_dwordx4 v[12:15], v95, s[8:11], s24 offen
    v_lshlrev_b32 v76, 16, v32
    v_and_b32 v84, s25, v32
    v_lshlrev_b32 v77, 16, v36
    v_and_b32 v85, s25, v36
    v_lshlrev_b32 v78, 16, v40
    v_and_b32 v86, s25, v40
    v_lshlrev_b32 v79, 16, v44
    v_and_b32 v87, s25, v44
    v_add_f32 v80, v76, v78
    v_add_f32 v88, v84, v86
    v_add_f32 v81, v77, v79
    v_add_f32 v89, v85, v87
    v_fma_f32 v82, v78, 4.0, v76
    v_fma_f32 v90, v86, 4.0, v84
    v_fma_f32 v83, v79, 4.0, v77
    v_fma_f32 v91, v87, 4.0, v85
    v_add_f32 v77, v80, v81
    v_add_f32 v85, v88, v89
    v_sub_f32 v78, v80, v81
    v_sub_f32 v86, v88, v89
    v_fma_f32 v79, v83, 2.0, v82
    v_fma_f32 v87, v91, 2.0, v90
    v_fma_f32 v82, v83, -2.0, v82
    v_fma_f32 v90, v91, -2.0, v90
    v_fmamk_f32 v80, v76, 0x41700000, v82
    v_fmamk_f32 v88, v84, 0x41700000, v90
    v_fmamk_f32 v80, v81, 0x41200000, v80
    v_fmamk_f32 v88, v89, 0x41200000, v88
    v_cvt_pk_bf16_f32 v36, v77, v85
    v_cvt_pk_bf16_f32 v40, v78, v86
    v_cvt_pk_bf16_f32 v64, v79, v87
    v_cvt_pk_bf16_f32 v68, v82, v90
    v_cvt_pk_bf16_f32 v72, v80, v88
    v_lshlrev_b32 v76, 16, v33
    v_and_b32 v84, s25, v33
    v_lshlrev_b32 v77, 16, v37
    v_and_b32 v85, s25, v37
    v_lshlrev_b32 v78, 16, v41
    v_and_b32 v86, s25, v41
    v_lshlrev_b32 v79, 16, v45
    v_and_b32 v87, s25, v45
    v_add_f32 v80, v76, v78
    v_add_f32 v88, v84, v86
    v_add_f32 v81, v77, v79
    v_add_f32 v89, v85, v87
    v_fma_f32 v82, v78, 4.0, v76
    v_fma_f32 v90, v86, 4.0, v84
    v_fma_f32 v83, v79, 4.0, v77
    v_fma_f32 v91, v87, 4.0, v85
    v_add_f32 v77, v80, v81
    v_add_f32 v85, v88, v89
    v_sub_f32 v78, v80, v81
    v_sub_f32 v86, v88, v89
    v_fma_f32 v79, v83, 2.0, v82
    v_fma_f32 v87, v91, 2.0, v90
    v_fma_f32 v82, v83, -2.0, v82
    v_fma_f32 v90, v91, -2.0, v90
    v_fmamk_f32 v80, v76, 0x41700000, v82
    v_fmamk_f32 v88, v84, 0x41700000, v90
    v_fmamk_f32 v80, v81, 0x41200000, v80
    v_fmamk_f32 v88, v89, 0x41200000, v88
    v_cvt_pk_bf16_f32 v37, v77, v85
    v_cvt_pk_bf16_f32 v41, v78, v86
    v_cvt_pk_bf16_f32 v65, v79, v87
    v_cvt_pk_bf16_f32 v69, v82, v90
    v_cvt_pk_bf16_f32 v73, v80, v88
    v_lshlrev_b32 v76, 16, v34
    v_and_b32 v84, s25, v34
    v_lshlrev_b32 v77, 16, v38
    v_and_b32 v85, s25, v38
    v_lshlrev_b32 v78, 16, v42
    v_and_b32 v86, s25, v42
    v_lshlrev_b32 v79, 16, v46
    v_and_b32 v87, s25, v46
    v_add_f32 v80, v76, v78
    v_add_f32 v88, v84, v86
    v_add_f32 v81, v77, v79
    v_add_f32 v89, v85, v87
    v_fma_f32 v82, v78, 4.0, v76
    v_fma_f32 v90, v86, 4.0, v84
    v_fma_f32 v83, v79, 4.0, v77
    v_fma_f32 v91, v87, 4.0, v85
    v_add_f32 v77, v80, v81
    v_add_f32 v85, v88, v89
    v_sub_f32 v78, v80, v81
    v_sub_f32 v86, v88, v89
    v_fma_f32 v79, v83, 2.0, v82
    v_fma_f32 v87, v91, 2.0, v90
    v_fma_f32 v82, v83, -2.0, v82
    v_fma_f32 v90, v91, -2.0, v90
    v_fmamk_f32 v80, v76, 0x41700000, v82
    v_fmamk_f32 v88, v84, 0x41700000, v90
    v_fmamk_f32 v80, v81, 0x41200000, v80
    v_fmamk_f32 v88, v89, 0x41200000, v88
    v_cvt_pk_bf16_f32 v38, v77, v85
    v_cvt_pk_bf16_f32 v42, v78, v86
    v_cvt_pk_bf16_f32 v66, v79, v87
    v_cvt_pk_bf16_f32 v70, v82, v90
    v_cvt_pk_bf16_f32 v74, v80, v88
    v_lshlrev_b32 v76, 16, v35
    v_and_b32 v84, s25, v35
    v_lshlrev_b32 v77, 16, v39
    v_and_b32 v85, s25, v39
    v_lshlrev_b32 v78, 16, v43
    v_and_b32 v86, s25, v43
    v_lshlrev_b32 v79, 16, v47
    v_and_b32 v87, s25, v47
    v_add_f32 v80, v76, v78
    v_add_f32 v88, v84, v86
    v_add_f32 v81, v77, v79
    v_add_f32 v89, v85, v87
    v_fma_f32 v82, v78, 4.0, v76
    v_fma_f32 v90, v86, 4.0, v84
    v_fma_f32 v83, v79, 4.0, v77
    v_fma_f32 v91, v87, 4.0, v85
    v_add_f32 v77, v80, v81
    v_add_f32 v85, v88, v89
    v_sub_f32 v78, v80, v81
    v_sub_f32 v86, v88, v89
    v_fma_f32 v79, v83, 2.0, v82
    v_fma_f32 v87, v91, 2.0, v90
    v_fma_f32 v82, v83, -2.0, v82
    v_fma_f32 v90, v91, -2.0, v90
    v_fmamk_f32 v80, v76, 0x41700000, v82
    v_fmamk_f32 v88, v84, 0x41700000, v90
    v_fmamk_f32 v80, v81, 0x41200000, v80
    v_fmamk_f32 v88, v89, 0x41200000, v88
    v_cvt_pk_bf16_f32 v39, v77, v85
    v_cvt_pk_bf16_f32 v43, v78, v86
    v_cvt_pk_bf16_f32 v67, v79, v87
    v_cvt_pk_bf16_f32 v71, v82, v90
    v_cvt_pk_bf16_f32 v75, v80, v88
    s_add_u32 s28, s28, 1
    s_waitcnt lgkmcnt(0)
    s_barrier
    ds_write_b128 v96, v[64:67] offset:49152
    ds_write_b128 v97, v[68:71] offset:0
    ds_write_b128 v97, v[72:75] offset:16384
    ds_write_b128 v96, v[32:35] offset:0
    ds_write_b128 v96, v[36:39] offset:16384
    ds_write_b128 v96, v[40:43] offset:32768
    ds_write_b128 v98, v[44:47] offset:0
    buffer_load_dwordx4 v[16:19], v92, s[8:11], s27 offen
    buffer_load_dwordx4 v[24:27], v94, s[8:11], s27 offen
    buffer_load_dwordx4 v[20:23], v93, s[8:11], s27 offen
    buffer_load_dwordx4 v[28:31], v95, s[8:11], s27 offen
    v_lshlrev_b32 v76, 16, v48
    v_and_b32 v84, s25, v48
    v_lshlrev_b32 v77, 16, v52
    v_and_b32 v85, s25, v52
    v_lshlrev_b32 v78, 16, v56
    v_and_b32 v86, s25, v56
    v_lshlrev_b32 v79, 16, v60
    v_and_b32 v87, s25, v60
    v_add_f32 v80, v76, v78
    v_add_f32 v88, v84, v86
    v_add_f32 v81, v77, v79
    v_add_f32 v89, v85, v87
    v_fma_f32 v82, v78, 4.0, v76
    v_fma_f32 v90, v86, 4.0, v84
    v_fma_f32 v83, v79, 4.0, v77
    v_fma_f32 v91, v87, 4.0, v85
    v_add_f32 v77, v80, v81
    v_add_f32 v85, v88, v89
    v_sub_f32 v78, v80, v81
    v_sub_f32 v86, v88, v89
    v_fma_f32 v79, v83, 2.0, v82
    v_fma_f32 v87, v91, 2.0, v90
    v_fma_f32 v82, v83, -2.0, v82
    v_fma_f32 v90, v91, -2.0, v90
    v_fmamk_f32 v80, v76, 0x41700000, v82
    v_fmamk_f32 v88, v84, 0x41700000, v90
    v_fmamk_f32 v80, v81, 0x41200000, v80
    v_fmamk_f32 v88, v89, 0x41200000, v88
    v_cvt_pk_bf16_f32 v52, v77, v85
    v_cvt_pk_bf16_f32 v56, v78, v86
    v_cvt_pk_bf16_f32 v64, v79, v87
    v_cvt_pk_bf16_f32 v68, v82, v90
    v_cvt_pk_bf16_f32 v72, v80, v88
    v_lshlrev_b32 v76, 16, v49
    v_and_b32 v84, s25, v49
    v_lshlrev_b32 v77, 16, v53
    v_and_b32 v85, s25, v53
    v_lshlrev_b32 v78, 16, v57
    v_and_b32 v86, s25, v57
    v_lshlrev_b32 v79, 16, v61
    v_and_b32 v87, s25, v61
    v_add_f32 v80, v76, v78
    v_add_f32 v88, v84, v86
    v_add_f32 v81, v77, v79
    v_add_f32 v89, v85, v87
    v_fma_f32 v82, v78, 4.0, v76
    v_fma_f32 v90, v86, 4.0, v84
    v_fma_f32 v83, v79, 4.0, v77
    v_fma_f32 v91, v87, 4.0, v85
    v_add_f32 v77, v80, v81
    v_add_f32 v85, v88, v89
    v_sub_f32 v78, v80, v81
    v_sub_f32 v86, v88, v89
    v_fma_f32 v79, v83, 2.0, v82
    v_fma_f32 v87, v91, 2.0, v90
    v_fma_f32 v82, v83, -2.0, v82
    v_fma_f32 v90, v91, -2.0, v90
    v_fmamk_f32 v80, v76, 0x41700000, v82
    v_fmamk_f32 v88, v84, 0x41700000, v90
    v_fmamk_f32 v80, v81, 0x41200000, v80
    v_fmamk_f32 v88, v89, 0x41200000, v88
    v_cvt_pk_bf16_f32 v53, v77, v85
    v_cvt_pk_bf16_f32 v57, v78, v86
    v_cvt_pk_bf16_f32 v65, v79, v87
    v_cvt_pk_bf16_f32 v69, v82, v90
    v_cvt_pk_bf16_f32 v73, v80, v88
    v_lshlrev_b32 v76, 16, v50
    v_and_b32 v84, s25, v50
    v_lshlrev_b32 v77, 16, v54
    v_and_b32 v85, s25, v54
    v_lshlrev_b32 v78, 16, v58
    v_and_b32 v86, s25, v58
    v_lshlrev_b32 v79, 16, v62
    v_and_b32 v87, s25, v62
    v_add_f32 v80, v76, v78
    v_add_f32 v88, v84, v86
    v_add_f32 v81, v77, v79
    v_add_f32 v89, v85, v87
    v_fma_f32 v82, v78, 4.0, v76
    v_fma_f32 v90, v86, 4.0, v84
    v_fma_f32 v83, v79, 4.0, v77
    v_fma_f32 v91, v87, 4.0, v85
    v_add_f32 v77, v80, v81
    v_add_f32 v85, v88, v89
    v_sub_f32 v78, v80, v81
    v_sub_f32 v86, v88, v89
    v_fma_f32 v79, v83, 2.0, v82
    v_fma_f32 v87, v91, 2.0, v90
    v_fma_f32 v82, v83, -2.0, v82
    v_fma_f32 v90, v91, -2.0, v90
    v_fmamk_f32 v80, v76, 0x41700000, v82
    v_fmamk_f32 v88, v84, 0x41700000, v90
    v_fmamk_f32 v80, v81, 0x41200000, v80
    v_fmamk_f32 v88, v89, 0x41200000, v88
    v_cvt_pk_bf16_f32 v54, v77, v85
    v_cvt_pk_bf16_f32 v58, v78, v86
    v_cvt_pk_bf16_f32 v66, v79, v87
    v_cvt_pk_bf16_f32 v70, v82, v90
    v_cvt_pk_bf16_f32 v74, v80, v88
    v_lshlrev_b32 v76, 16, v51
    v_and_b32 v84, s25, v51
    v_lshlrev_b32 v77, 16, v55
    v_and_b32 v85, s25, v55
    v_lshlrev_b32 v78, 16, v59
    v_and_b32 v86, s25, v59
    v_lshlrev_b32 v79, 16, v63
    v_and_b32 v87, s25, v63
    v_add_f32 v80, v76, v78
    v_add_f32 v88, v84, v86
    v_add_f32 v81, v77, v79
    v_add_f32 v89, v85, v87
    v_fma_f32 v82, v78, 4.0, v76
    v_fma_f32 v90, v86, 4.0, v84
    v_fma_f32 v83, v79, 4.0, v77
    v_fma_f32 v91, v87, 4.0, v85
    v_add_f32 v77, v80, v81
    v_add_f32 v85, v88, v89
    v_sub_f32 v78, v80, v81
    v_sub_f32 v86, v88, v89
    v_fma_f32 v79, v83, 2.0, v82
    v_fma_f32 v87, v91, 2.0, v90
    v_fma_f32 v82, v83, -2.0, v82
    v_fma_f32 v90, v91, -2.0, v90
    v_fmamk_f32 v80, v76, 0x41700000, v82
    v_fmamk_f32 v88, v84, 0x41700000, v90
    v_fmamk_f32 v80, v81, 0x41200000, v80
    v_fmamk_f32 v88, v89, 0x41200000, v88
    v_cvt_pk_bf16_f32 v55, v77, v85
    v_cvt_pk_bf16_f32 v59, v78, v86
    v_cvt_pk_bf16_f32 v67, v79, v87
    v_cvt_pk_bf16_f32 v71, v82, v90
    v_cvt_pk_bf16_f32 v75, v80, v88
    s_add_u32 s28, s28, 1
    s_waitcnt lgkmcnt(0)
    s_barrier
    s_cmp_eq_u32 s22, 1
    s_cbranch_scc1 L_conv2_kernel_hlast2
    s_add_u32 s24, s24, 1048576
    s_add_u32 s27, s27, 1048576
    ds_write_b128 v96, v[64:67] offset:57344
    ds_write_b128 v97, v[68:71] offset:8192
    ds_write_b128 v97, v[72:75] offset:24576
    ds_write_b128 v96, v[48:51] offset:8192
    ds_write_b128 v96, v[52:55] offset:24576
    ds_write_b128 v96, v[56:59] offset:40960
    ds_write_b128 v98, v[60:63] offset:8704
    s_waitcnt vmcnt(0)
    buffer_load_dwordx4 v[32:35], v92, s[8:11], s24 offen
    buffer_load_dwordx4 v[40:43], v94, s[8:11], s24 offen
    buffer_load_dwordx4 v[36:39], v93, s[8:11], s24 offen
    buffer_load_dwordx4 v[44:47], v95, s[8:11], s24 offen
    v_lshlrev_b32 v76, 16, v0
    v_and_b32 v84, s25, v0
    v_lshlrev_b32 v77, 16, v4
    v_and_b32 v85, s25, v4
    v_lshlrev_b32 v78, 16, v8
    v_and_b32 v86, s25, v8
    v_lshlrev_b32 v79, 16, v12
    v_and_b32 v87, s25, v12
    v_add_f32 v80, v76, v78
    v_add_f32 v88, v84, v86
    v_add_f32 v81, v77, v79
    v_add_f32 v89, v85, v87
    v_fma_f32 v82, v78, 4.0, v76
    v_fma_f32 v90, v86, 4.0, v84
    v_fma_f32 v83, v79, 4.0, v77
    v_fma_f32 v91, v87, 4.0, v85
    v_add_f32 v77, v80, v81
    v_add_f32 v85, v88, v89
    v_sub_f32 v78, v80, v81
    v_sub_f32 v86, v88, v89
    v_fma_f32 v79, v83, 2.0, v82
    v_fma_f32 v87, v91, 2.0, v90
    v_fma_f32 v82, v83, -2.0, v82
    v_fma_f32 v90, v91, -2.0, v90
    v_fmamk_f32 v80, v76, 0x41700000, v82
    v_fmamk_f32 v88, v84, 0x41700000, v90
    v_fmamk_f32 v80, v81, 0x41200000, v80
    v_fmamk_f32 v88, v89, 0x41200000, v88
    v_cvt_pk_bf16_f32 v4, v77, v85
    v_cvt_pk_bf16_f32 v8, v78, v86
    v_cvt_pk_bf16_f32 v64, v79, v87
    v_cvt_pk_bf16_f32 v68, v82, v90
    v_cvt_pk_bf16_f32 v72, v80, v88
    v_lshlrev_b32 v76, 16, v1
    v_and_b32 v84, s25, v1
    v_lshlrev_b32 v77, 16, v5
    v_and_b32 v85, s25, v5
    v_lshlrev_b32 v78, 16, v9
    v_and_b32 v86, s25, v9
    v_lshlrev_b32 v79, 16, v13
    v_and_b32 v87, s25, v13
    v_add_f32 v80, v76, v78
    v_add_f32 v88, v84, v86
    v_add_f32 v81, v77, v79
    v_add_f32 v89, v85, v87
    v_fma_f32 v82, v78, 4.0, v76
    v_fma_f32 v90, v86, 4.0, v84
    v_fma_f32 v83, v79, 4.0, v77
    v_fma_f32 v91, v87, 4.0, v85
    v_add_f32 v77, v80, v81
    v_add_f32 v85, v88, v89
    v_sub_f32 v78, v80, v81
    v_sub_f32 v86, v88, v89
    v_fma_f32 v79, v83, 2.0, v82
    v_fma_f32 v87, v91, 2.0, v90
    v_fma_f32 v82, v83, -2.0, v82
    v_fma_f32 v90, v91, -2.0, v90
    v_fmamk_f32 v80, v76, 0x41700000, v82
    v_fmamk_f32 v88, v84, 0x41700000, v90
    v_fmamk_f32 v80, v81, 0x41200000, v80
    v_fmamk_f32 v88, v89, 0x41200000, v88
    v_cvt_pk_bf16_f32 v5, v77, v85
    v_cvt_pk_bf16_f32 v9, v78, v86
    v_cvt_pk_bf16_f32 v65, v79, v87
    v_cvt_pk_bf16_f32 v69, v82, v90
    v_cvt_pk_bf16_f32 v73, v80, v88
    v_lshlrev_b32 v76, 16, v2
    v_and_b32 v84, s25, v2
    v_lshlrev_b32 v77, 16, v6
    v_and_b32 v85, s25, v6
    v_lshlrev_b32 v78, 16, v10
    v_and_b32 v86, s25, v10
    v_lshlrev_b32 v79, 16, v14
    v_and_b32 v87, s25, v14
    v_add_f32 v80, v76, v78
    v_add_f32 v88, v84, v86
    v_add_f32 v81, v77, v79
    v_add_f32 v89, v85, v87
    v_fma_f32 v82, v78, 4.0, v76
    v_fma_f32 v90, v86, 4.0, v84
    v_fma_f32 v83, v79, 4.0, v77
    v_fma_f32 v91, v87, 4.0, v85
    v_add_f32 v77, v80, v81
    v_add_f32 v85, v88, v89
    v_sub_f32 v78, v80, v81
    v_sub_f32 v86, v88, v89
    v_fma_f32 v79, v83, 2.0, v82
    v_fma_f32 v87, v91, 2.0, v90
    v_fma_f32 v82, v83, -2.0, v82
    v_fma_f32 v90, v91, -2.0, v90
    v_fmamk_f32 v80, v76, 0x41700000, v82
    v_fmamk_f32 v88, v84, 0x41700000, v90
    v_fmamk_f32 v80, v81, 0x41200000, v80
    v_fmamk_f32 v88, v89, 0x41200000, v88
    v_cvt_pk_bf16_f32 v6, v77, v85
    v_cvt_pk_bf16_f32 v10, v78, v86
    v_cvt_pk_bf16_f32 v66, v79, v87
    v_cvt_pk_bf16_f32 v70, v82, v90
    v_cvt_pk_bf16_f32 v74, v80, v88
    v_lshlrev_b32 v76, 16, v3
    v_and_b32 v84, s25, v3
    v_lshlrev_b32 v77, 16, v7
    v_and_b32 v85, s25, v7
    v_lshlrev_b32 v78, 16, v11
    v_and_b32 v86, s25, v11
    v_lshlrev_b32 v79, 16, v15
    v_and_b32 v87, s25, v15
    v_add_f32 v80, v76, v78
    v_add_f32 v88, v84, v86
    v_add_f32 v81, v77, v79
    v_add_f32 v89, v85, v87
    v_fma_f32 v82, v78, 4.0, v76
    v_fma_f32 v90, v86, 4.0, v84
    v_fma_f32 v83, v79, 4.0, v77
    v_fma_f32 v91, v87, 4.0, v85
    v_add_f32 v77, v80, v81
    v_add_f32 v85, v88, v89
    v_sub_f32 v78, v80, v81
    v_sub_f32 v86, v88, v89
    v_fma_f32 v79, v83, 2.0, v82
    v_fma_f32 v87, v91, 2.0, v90
    v_fma_f32 v82, v83, -2.0, v82
    v_fma_f32 v90, v91, -2.0, v90
    v_fmamk_f32 v80, v76, 0x41700000, v82
    v_fmamk_f32 v88, v84, 0x41700000, v90
    v_fmamk_f32 v80, v81, 0x41200000, v80
    v_fmamk_f32 v88, v89, 0x41200000, v88
    v_cvt_pk_bf16_f32 v7, v77, v85
    v_cvt_pk_bf16_f32 v11, v78, v86
    v_cvt_pk_bf16_f32 v67, v79, v87
    v_cvt_pk_bf16_f32 v71, v82, v90
    v_cvt_pk_bf16_f32 v75, v80, v88
    s_add_u32 s28, s28, 1
    s_waitcnt lgkmcnt(0)
    s_barrier
    ds_write_b128 v96, v[64:67] offset:49152
    ds_write_b128 v97, v[68:71] offset:0
    ds_write_b128 v97, v[72:75] offset:16384
    ds_write_b128 v96, v[0:3] offset:0
    ds_write_b128 v96, v[4:7] offset:16384
    ds_write_b128 v96, v[8:11] offset:32768
    ds_write_b128 v98, v[12:15] offset:0
    buffer_load_dwordx4 v[48:51], v92, s[8:11], s27 offen
    buffer_load_dwordx4 v[56:59], v94, s[8:11], s27 offen
    buffer_load_dwordx4 v[52:55], v93, s[8:11], s27 offen
    buffer_load_dwordx4 v[60:63], v95, s[8:11], s27 offen
    v_lshlrev_b32 v76, 16, v16
    v_and_b32 v84, s25, v16
    v_lshlrev_b32 v77, 16, v20
    v_and_b32 v85, s25, v20
    v_lshlrev_b32 v78, 16, v24
    v_and_b32 v86, s25, v24
    v_lshlrev_b32 v79, 16, v28
    v_and_b32 v87, s25, v28
    v_add_f32 v80, v76, v78
    v_add_f32 v88, v84, v86
    v_add_f32 v81, v77, v79
    v_add_f32 v89, v85, v87
    v_fma_f32 v82, v78, 4.0, v76
    v_fma_f32 v90, v86, 4.0, v84
    v_fma_f32 v83, v79, 4.0, v77
    v_fma_f32 v91, v87, 4.0, v85
    v_add_f32 v77, v80, v81
    v_add_f32 v85, v88, v89
    v_sub_f32 v78, v80, v81
    v_sub_f32 v86, v88, v89
    v_fma_f32 v79, v83, 2.0, v82
    v_fma_f32 v87, v91, 2.0, v90
    v_fma_f32 v82, v83, -2.0, v82
    v_fma_f32 v90, v91, -2.0, v90
    v_fmamk_f32 v80, v76, 0x41700000, v82
    v_fmamk_f32 v88, v84, 0x41700000, v90
    v_fmamk_f32 v80, v81, 0x41200000, v80
    v_fmamk_f32 v88, v89, 0x41200000, v88
    v_cvt_pk_bf16_f32 v20, v77, v85
    v_cvt_pk_bf16_f32 v24, v78, v86
    v_cvt_pk_bf16_f32 v64, v79, v87
    v_cvt_pk_bf16_f32 v68, v82, v90
    v_cvt_pk_bf16_f32 v72, v80, v88
    v_lshlrev_b32 v76, 16, v17
    v_and_b32 v84, s25, v17
    v_lshlrev_b32 v77, 16, v21
    v_and_b32 v85, s25, v21
    v_lshlrev_b32 v78, 16, v25
    v_and_b32 v86, s25, v25
    v_lshlrev_b32 v79, 16, v29
    v_and_b32 v87, s25, v29
    v_add_f32 v80, v76, v78
    v_add_f32 v88, v84, v86
    v_add_f32 v81, v77, v79
    v_add_f32 v89, v85, v87
    v_fma_f32 v82, v78, 4.0, v76
    v_fma_f32 v90, v86, 4.0, v84
    v_fma_f32 v83, v79, 4.0, v77
    v_fma_f32 v91, v87, 4.0, v85
    v_add_f32 v77, v80, v81
    v_add_f32 v85, v88, v89
    v_sub_f32 v78, v80, v81
    v_sub_f32 v86, v88, v89
    v_fma_f32 v79, v83, 2.0, v82
    v_fma_f32 v87, v91, 2.0, v90
    v_fma_f32 v82, v83, -2.0, v82
    v_fma_f32 v90, v91, -2.0, v90
    v_fmamk_f32 v80, v76, 0x41700000, v82
    v_fmamk_f32 v88, v84, 0x41700000, v90
    v_fmamk_f32 v80, v81, 0x41200000, v80
    v_fmamk_f32 v88, v89, 0x41200000, v88
    v_cvt_pk_bf16_f32 v21, v77, v85
    v_cvt_pk_bf16_f32 v25, v78, v86
    v_cvt_pk_bf16_f32 v65, v79, v87
    v_cvt_pk_bf16_f32 v69, v82, v90
    v_cvt_pk_bf16_f32 v73, v80, v88
    v_lshlrev_b32 v76, 16, v18
    v_and_b32 v84, s25, v18
    v_lshlrev_b32 v77, 16, v22
    v_and_b32 v85, s25, v22
    v_lshlrev_b32 v78, 16, v26
    v_and_b32 v86, s25, v26
    v_lshlrev_b32 v79, 16, v30
    v_and_b32 v87, s25, v30
    v_add_f32 v80, v76, v78
    v_add_f32 v88, v84, v86
    v_add_f32 v81, v77, v79
    v_add_f32 v89, v85, v87
    v_fma_f32 v82, v78, 4.0, v76
    v_fma_f32 v90, v86, 4.0, v84
    v_fma_f32 v83, v79, 4.0, v77
    v_fma_f32 v91, v87, 4.0, v85
    v_add_f32 v77, v80, v81
    v_add_f32 v85, v88, v89
    v_sub_f32 v78, v80, v81
    v_sub_f32 v86, v88, v89
    v_fma_f32 v79, v83, 2.0, v82
    v_fma_f32 v87, v91, 2.0, v90
    v_fma_f32 v82, v83, -2.0, v82
    v_fma_f32 v90, v91, -2.0, v90
    v_fmamk_f32 v80, v76, 0x41700000, v82
    v_fmamk_f32 v88, v84, 0x41700000, v90
    v_fmamk_f32 v80, v81, 0x41200000, v80
    v_fmamk_f32 v88, v89, 0x41200000, v88
    v_cvt_pk_bf16_f32 v22, v77, v85
    v_cvt_pk_bf16_f32 v26, v78, v86
    v_cvt_pk_bf16_f32 v66, v79, v87
    v_cvt_pk_bf16_f32 v70, v82, v90
    v_cvt_pk_bf16_f32 v74, v80, v88
    v_lshlrev_b32 v76, 16, v19
    v_and_b32 v84, s25, v19
    v_lshlrev_b32 v77, 16, v23
    v_and_b32 v85, s25, v23
    v_lshlrev_b32 v78, 16, v27
    v_and_b32 v86, s25, v27
    v_lshlrev_b32 v79, 16, v31
    v_and_b32 v87, s25, v31
    v_add_f32 v80, v76, v78
    v_add_f32 v88, v84, v86
    v_add_f32 v81, v77, v79
    v_add_f32 v89, v85, v87
    v_fma_f32 v82, v78, 4.0, v76
    v_fma_f32 v90, v86, 4.0, v84
    v_fma_f32 v83, v79, 4.0, v77
    v_fma_f32 v91, v87, 4.0, v85
    v_add_f32 v77, v80, v81
    v_add_f32 v85, v88, v89
    v_sub_f32 v78, v80, v81
    v_sub_f32 v86, v88, v89
    v_fma_f32 v79, v83, 2.0, v82
    v_fma_f32 v87, v91, 2.0, v90
    v_fma_f32 v82, v83, -2.0, v82
    v_fma_f32 v90, v91, -2.0, v90
    v_fmamk_f32 v80, v76, 0x41700000, v82
    v_fmamk_f32 v88, v84, 0x41700000, v90
    v_fmamk_f32 v80, v81, 0x41200000, v80
    v_fmamk_f32 v88, v89, 0x41200000, v88
    v_cvt_pk_bf16_f32 v23, v77, v85
    v_cvt_pk_bf16_f32 v27, v78, v86
    v_cvt_pk_bf16_f32 v67, v79, v87
    v_cvt_pk_bf16_f32 v71, v82, v90
    v_cvt_pk_bf16_f32 v75, v80, v88
    s_add_u32 s28, s28, 1
    s_waitcnt lgkmcnt(0)
    s_barrier
    s_sub_u32 s22, s22, 1
    s_branch L_conv2_kernel_hloop2
L_conv2_kernel_hlast2:
    s_mov_b32 s25, 0xffff0000
    ds_write_b128 v96, v[64:67] offset:57344
    ds_write_b128 v97, v[68:71] offset:8192
    ds_write_b128 v97, v[72:75] offset:24576
    ds_write_b128 v96, v[48:51] offset:8192
    ds_write_b128 v96, v[52:55] offset:24576
    ds_write_b128 v96, v[56:59] offset:40960
    ds_write_b128 v98, v[60:63] offset:8704
    s_waitcnt lgkmcnt(0)
    s_barrier
    s_branch L_conv2_kernel_end
L_conv2_kernel_epi:
    s_waitcnt lgkmcnt(0)
    s_barrier
    v_cndmask_b32 v122, v111, v110, vcc
    ds_read_b128 v[0:3], v120 offset:0
    ds_read_b128 v[4:7], v120 offset:16384
    ds_read_b128 v[8:11], v120 offset:32768
    ds_read_b128 v[12:15], v120 offset:49152
    ds_read_b128 v[16:19], v121 offset:0
    ds_read_b128 v[20:23], v121 offset:16384
    ds_read_b128 v[24:27], v121 offset:32768
    ds_read_b128 v[28:31], v64 offset:15360
    ds_read_b128 v[32:35], v120 offset:8192
    ds_read_b128 v[36:39], v120 offset:24576
    ds_read_b128 v[40:43], v120 offset:40960
    ds_read_b128 v[44:47], v120 offset:57344
    ds_read_b128 v[48:51], v121 offset:56320
    ds_read_b128 v[52:55], v121 offset:64512
    ds_read_b128 v[56:59], v64 offset:7168
    s_waitcnt lgkmcnt(7)
    ds_read_b128 v[60:63], v64 offset:23552
    s_waitcnt lgkmcnt(8)
    v_pk_add_f32 v[88:89], v[24:25], v[28:29]
    v_pk_add_f32 v[90:91], v[26:27], v[30:31]
    v_pk_add_f32 v[24:25], v[4:5], v[8:9]
    v_pk_add_f32 v[26:27], v[6:7], v[10:11]
    v_pk_add_f32 v[4:5], v[4:5], v[8:9] neg_lo:[0,1] neg_hi:[0,1]
    v_pk_add_f32 v[6:7], v[6:7], v[10:11] neg_lo:[0,1] neg_hi:[0,1]
    v_pk_add_f32 v[72:73], v[12:13], v[16:17]
    v_pk_add_f32 v[74:75], v[14:15], v[18:19]
    v_pk_add_f32 v[12:13], v[12:13], v[16:17] neg_lo:[0,1] neg_hi:[0,1]
    v_pk_add_f32 v[14:15], v[14:15], v[18:19] neg_lo:[0,1] neg_hi:[0,1]
    v_pk_fma_f32 v[72:73], v[24:25], s[4:5], v[72:73]
    v_pk_fma_f32 v[74:75], v[26:27], s[4:5], v[74:75]
    v_pk_fma_f32 v[20:21], v[0:1], s[10:11], v[20:21]
    v_pk_fma_f32 v[22:23], v[2:3], s[10:11], v[22:23]
    v_pk_fma_f32 v[72:73], v[0:1], s[6:7], v[72:73]
    v_pk_fma_f32 v[74:75], v[2:3], s[6:7], v[74:75]
    v_pk_add_f32 v[24:25], v[24:25], v[0:1] neg_lo:[0,1] neg_hi:[0,1]
    v_pk_add_f32 v[26:27], v[26:27], v[2:3] neg_lo:[0,1] neg_hi:[0,1]
    v_pk_fma_f32 v[72:73], v[88:89], s[8:9], v[72:73]
    v_pk_fma_f32 v[74:75], v[90:91], s[8:9], v[74:75]
    v_pk_add_f32 v[24:25], v[24:25], v[88:89] neg_lo:[0,1] neg_hi:[0,1]
    v_pk_add_f32 v[26:27], v[26:27], v[90:91] neg_lo:[0,1] neg_hi:[0,1]
    v_pk_fma_f32 v[20:21], v[88:89], s[22:23], v[20:21]
    v_pk_fma_f32 v[22:23], v[90:91], s[22:23], v[22:23]
    v_pk_add_f32 v[8:9], v[24:25], v[72:73] neg_lo:[0,1] neg_hi:[0,1]
    v_pk_add_f32 v[10:11], v[26:27], v[74:75] neg_lo:[0,1] neg_hi:[0,1]
    v_pk_fma_f32 v[20:21], v[72:73], s[14:15], v[20:21]
    v_pk_fma_f32 v[22:23], v[74:75], s[14:15], v[22:23]
    v_pk_mul_f32 v[80:81], v[12:13], s[32:33]
    v_pk_mul_f32 v[82:83], v[14:15], s[32:33]
    v_pk_fma_f32 v[20:21], v[8:9], s[12:13], v[20:21]
    v_pk_fma_f32 v[22:23], v[10:11], s[12:13], v[22:23]
    v_pk_fma_f32 v[80:81], v[4:5], s[34:35], v[80:81]
    v_pk_fma_f32 v[82:83], v[6:7], s[34:35], v[82:83]
    v_pk_fma_f32 v[64:65], v[4:5], s[24:25], v[20:21] neg_lo:[0,0,1] neg_hi:[0,0,1]
    v_pk_fma_f32 v[66:67], v[6:7], s[24:25], v[22:23] neg_lo:[0,0,1] neg_hi:[0,0,1]
    v_pk_fma_f32 v[64:65], v[12:13], s[26:27], v[64:65]
    v_pk_fma_f32 v[66:67], v[14:15], s[26:27], v[66:67]
    v_pk_fma_f32 v[80:81], v[64:65], s[38:39], v[80:81]
    v_pk_fma_f32 v[82:83], v[66:67], s[38:39], v[82:83]
    v_pk_add_f32 v[4:5], v[4:5], v[64:65] neg_lo:[0,1] neg_hi:[0,1]
    v_pk_add_f32 v[6:7], v[6:7], v[66:67] neg_lo:[0,1] neg_hi:[0,1]
    v_pk_add_f32 v[4:5], v[4:5], v[80:81] neg_lo:[0,1] neg_hi:[0,1]
    v_pk_add_f32 v[6:7], v[6:7], v[82:83] neg_lo:[0,1] neg_hi:[0,1]
    s_waitcnt lgkmcnt(0)
    v_pk_add_f32 v[92:93], v[56:57], v[60:61]
    v_pk_add_f32 v[94:95], v[58:59], v[62:63]
    v_pk_add_f32 v[56:57], v[36:37], v[40:41]
    v_pk_add_f32 v[58:59], v[38:39], v[42:43]
    v_pk_add_f32 v[36:37], v[36:37], v[40:41] neg_lo:[0,1] neg_hi:[0,1]
    v_pk_add_f32 v[38:39], v[38:39], v[42:43] neg_lo:[0,1] neg_hi:[0,1]
    v_pk_add_f32 v[76:77], v[44:45], v[48:49]
    v_pk_add_f32 v[78:79], v[46:47], v[50:51]
    v_pk_add_f32 v[44:45], v[44:45], v[48:49] neg_lo:[0,1] neg_hi:[0,1]
    v_pk_add_f32 v[46:47], v[46:47], v[50:51] neg_lo:[0,1] neg_hi:[0,1]
    v_pk_fma_f32 v[76:77], v[56:57], s[4:5], v[76:77]
    v_pk_fma_f32 v[78:79], v[58:59], s[4:5], v[78:79]
    v_pk_fma_f32 v[52:53], v[32:33], s[10:11], v[52:53]
    v_pk_fma_f32 v[54:55], v[34:35], s[10:11], v[54:55]
    v_pk_fma_f32 v[76:77], v[32:33], s[6:7], v[76:77]
    v_pk_fma_f32 v[78:79], v[34:35], s[6:7], v[78:79]
    v_pk_add_f32 v[56:57], v[56:57], v[32:33] neg_lo:[0,1] neg_hi:[0,1]
    v_pk_add_f32 v[58:59], v[58:59], v[34:35] neg_lo:[0,1] neg_hi:[0,1]
    v_pk_fma_f32 v[76:77], v[92:93], s[8:9], v[76:77]
    v_pk_fma_f32 v[78:79], v[94:95], s[8:9], v[78:79]
    v_pk_add_f32 v[56:57], v[56:57], v[92:93] neg_lo:[0,1] neg_hi:[0,1]
    v_pk_add_f32 v[58:59], v[58:59], v[94:95] neg_lo:[0,1] neg_hi:[0,1]
    v_pk_fma_f32 v[52:53], v[92:93], s[22:23], v[52:53]
    v_pk_fma_f32 v[54:55], v[94:95], s[22:23], v[54:55]
    v_pk_add_f32 v[40:41], v[56:57], v[76:77] neg_lo:[0,1] neg_hi:[0,1]
    v_pk_add_f32 v[42:43], v[58:59], v[78:79] neg_lo:[0,1] neg_hi:[0,1]
    v_pk_fma_f32 v[52:53], v[76:77], s[14:15], v[52:53]
    v_pk_fma_f32 v[54:55], v[78:79], s[14:15], v[54:55]
    v_pk_mul_f32 v[84:85], v[44:45], s[32:33]
    v_pk_mul_f32 v[86:87], v[46:47], s[32:33]
    v_pk_fma_f32 v[52:53], v[40:41], s[12:13], v[52:53]
    v_pk_fma_f32 v[54:55], v[42:43], s[12:13], v[54:55]
    v_pk_fma_f32 v[84:85], v[36:37], s[34:35], v[84:85]
    v_pk_fma_f32 v[86:87], v[38:39], s[34:35], v[86:87]
    v_pk_fma_f32 v[68:69], v[36:37], s[24:25], v[52:53] neg_lo:[0,0,1] neg_hi:[0,0,1]
    v_pk_fma_f32 v[70:71], v[38:39], s[24:25], v[54:55] neg_lo:[0,0,1] neg_hi:[0,0,1]
    v_pk_fma_f32 v[68:69], v[44:45], s[26:27], v[68:69]
    v_pk_fma_f32 v[70:71], v[46:47], s[26:27], v[70:71]
    v_pk_fma_f32 v[84:85], v[68:69], s[38:39], v[84:85]
    v_pk_fma_f32 v[86:87], v[70:71], s[38:39], v[86:87]
    v_pk_add_f32 v[36:37], v[36:37], v[68:69] neg_lo:[0,1] neg_hi:[0,1]
    v_pk_add_f32 v[38:39], v[38:39], v[70:71] neg_lo:[0,1] neg_hi:[0,1]
    v_pk_add_f32 v[36:37], v[36:37], v[84:85] neg_lo:[0,1] neg_hi:[0,1]
    v_pk_add_f32 v[38:39], v[38:39], v[86:87] neg_lo:[0,1] neg_hi:[0,1]
    s_mov_b32 s36, 0x00010001
    s_mov_b32 s37, 0x00010001
    s_mov_b64 exec, s[36:37]
    ds_write_b128 v127, v[0:3] offset:0
    ds_write_b128 v127, v[32:35] offset:16
    ds_write_b128 v127, v[4:7] offset:32
    ds_write_b128 v127, v[36:39] offset:48
    ds_write_b128 v127, v[8:11] offset:64
    ds_write_b128 v127, v[40:43] offset:80
    s_mov_b64 exec, -1
    v_mov_b32 v44, 0xc0135761
    v_mov_b32 v45, v44
    v_cvt_pk_bf16_f32 v48, v64, v68
    v_cvt_pk_bf16_f32 v49, v65, v69
    v_cvt_pk_bf16_f32 v50, v66, v70
    v_cvt_pk_bf16_f32 v51, v67, v71
    s_mov_b32 s44, 0
    buffer_store_dwordx4 v[48:51], v122, s[16:19], s44 offen sc1
    s_waitcnt lgkmcnt(0)
    s_barrier
    ds_read_b128 v[96:99], v127 offset:512
    ds_read_b128 v[100:103], v127 offset:528
    ds_read_b128 v[104:107], v127 offset:544
    ds_read_b128 v[108:111], v127 offset:560
    ds_read_b128 v[112:115], v127 offset:576
    ds_read_b128 v[116:119], v127 offset:592
    s_waitcnt lgkmcnt(4)
    v_mov_b32_dpp v96, v0 row_shl:1 row_mask:0xf bank_mask:0xf
    v_mov_b32_dpp v97, v1 row_shl:1 row_mask:0xf bank_mask:0xf
    v_mov_b32_dpp v98, v2 row_shl:1 row_mask:0xf bank_mask:0xf
    v_mov_b32_dpp v99, v3 row_shl:1 row_mask:0xf bank_mask:0xf
    v_mov_b32_dpp v100, v32 row_shl:1 row_mask:0xf bank_mask:0xf
    v_mov_b32_dpp v101, v33 row_shl:1 row_mask:0xf bank_mask:0xf
    v_mov_b32_dpp v102, v34 row_shl:1 row_mask:0xf bank_mask:0xf
    v_mov_b32_dpp v103, v35 row_shl:1 row_mask:0xf bank_mask:0xf
    v_pk_add_f32 v[72:73], v[72:73], v[96:97]
    v_pk_add_f32 v[74:75], v[74:75], v[98:99]
    v_pk_add_f32 v[76:77], v[76:77], v[100:101]
    v_pk_add_f32 v[78:79], v[78:79], v[102:103]
    v_cvt_pk_bf16_f32 v52, v72, v76
    v_cvt_pk_bf16_f32 v53, v73, v77
    v_cvt_pk_bf16_f32 v54, v74, v78
    v_cvt_pk_bf16_f32 v55, v75, v79
    s_mov_b32 s44, 65536
    buffer_store_dwordx4 v[52:55], v122, s[16:19], s44 offen sc1
    s_waitcnt lgkmcnt(2)
    v_mov_b32_dpp v104, v4 row_shl:1 row_mask:0xf bank_mask:0xf
    v_mov_b32_dpp v105, v5 row_shl:1 row_mask:0xf bank_mask:0xf
    v_mov_b32_dpp v106, v6 row_shl:1 row_mask:0xf bank_mask:0xf
    v_mov_b32_dpp v107, v7 row_shl:1 row_mask:0xf bank_mask:0xf
    v_mov_b32_dpp v108, v36 row_shl:1 row_mask:0xf bank_mask:0xf
    v_mov_b32_dpp v109, v37 row_shl:1 row_mask:0xf bank_mask:0xf
    v_mov_b32_dpp v110, v38 row_shl:1 row_mask:0xf bank_mask:0xf
    v_mov_b32_dpp v111, v39 row_shl:1 row_mask:0xf bank_mask:0xf
    v_pk_add_f32 v[80:81], v[80:81], v[104:105]
    v_pk_add_f32 v[82:83], v[82:83], v[106:107]
    v_pk_add_f32 v[84:85], v[84:85], v[108:109]
    v_pk_add_f32 v[86:87], v[86:87], v[110:111]
    v_cvt_pk_bf16_f32 v56, v80, v84
    v_cvt_pk_bf16_f32 v57, v81, v85
    v_cvt_pk_bf16_f32 v58, v82, v86
    v_cvt_pk_bf16_f32 v59, v83, v87
    s_mov_b32 s44, 131072
    buffer_store_dwordx4 v[56:59], v122, s[16:19], s44 offen sc1
    s_waitcnt lgkmcnt(0)
    v_mov_b32_dpp v112, v8 row_shl:1 row_mask:0xf bank_mask:0xf
    v_mov_b32_dpp v113, v9 row_shl:1 row_mask:0xf bank_mask:0xf
    v_mov_b32_dpp v114, v10 row_shl:1 row_mask:0xf bank_mask:0xf
    v_mov_b32_dpp v115, v11 row_shl:1 row_mask:0xf bank_mask:0xf
    v_mov_b32_dpp v116, v40 row_shl:1 row_mask:0xf bank_mask:0xf
    v_mov_b32_dpp v117, v41 row_shl:1 row_mask:0xf bank_mask:0xf
    v_mov_b32_dpp v118, v42 row_shl:1 row_mask:0xf bank_mask:0xf
    v_mov_b32_dpp v119, v43 row_shl:1 row_mask:0xf bank_mask:0xf
    v_pk_add_f32 v[88:89], v[88:89], v[112:113]
    v_pk_add_f32 v[90:91], v[90:91], v[114:115]
    v_pk_add_f32 v[92:93], v[92:93], v[116:117]
    v_pk_add_f32 v[94:95], v[94:95], v[118:119]
    v_cvt_pk_bf16_f32 v60, v88, v92
    v_cvt_pk_bf16_f32 v61, v89, v93
    v_cvt_pk_bf16_f32 v62, v90, v94
    v_cvt_pk_bf16_f32 v63, v91, v95
    s_mov_b32 s44, 196608
    buffer_store_dwordx4 v[60:63], v122, s[16:19], s44 offen sc1
L_conv2_kernel_end:
L_conv2_kernel_done:
    s_endpgm
.globl joint_kernel
.p2align 8
.type joint_kernel,@function
joint_kernel:
    s_cmp_ge_u32 s2, 250
    s_cbranch_scc1 L_joint_kernel_done
    s_load_dwordx2 s[28:29], s[0:1], 56
    s_load_dwordx2 s[30:31], s[0:1], 72
    v_readfirstlane_b32 s20, v0
    s_lshr_b32 s20, s20, 6
    s_and_b32 s21, s20, 7
    v_and_b32 v127, 63, v0
    v_lshlrev_b32 v126, 4, v127
    s_cmp_ge_u32 s20, 8
    s_mov_b32 s33, 44171264
    s_cselect_b32 s33, 44040192, s33
    s_lshl_b32 s36, s21, 14
    s_add_u32 s33, s33, s36
    s_mov_b32 s14, 16384
    s_mov_b32 s15, 0x00020000
    s_lshl_b32 s35, s2, 9
    s_cmp_ge_u32 s2, 125
    s_cselect_b32 s36, 2033152, 0
    s_cselect_b32 s34, 8192, 0
    s_add_u32 s35, s35, s36
    s_add_u32 s34, s34, 44302336
    s_mov_b32 s10, 12582912
    s_mov_b32 s11, 0x00020000
    s_mov_b32 s42, 24576
    s_mov_b32 s43, 0x00020000
    s_cmp_ge_u32 s20, 8
    s_cbranch_scc1 L_joint_kernel_T
    v_lshrrev_b32 v124, 5, v127
    v_and_b32 v123, 0x1ff, v126
    v_mul_u32_u24 v125, 65536, v124
    v_add_u32 v123, v125, v123
    s_mul_i32 s36, s21, 262144
    s_add_u32 s36, s36, s35
    s_waitcnt lgkmcnt(0)
    s_add_u32 s8, s30, 27262976
    s_addc_u32 s9, s31, 0
    s_add_u32 s37, s36, 8388608
    buffer_load_dwordx4 v[64:67], v123, s[8:11], s36 offen
    buffer_load_dwordx4 v[72:75], v123, s[8:11], s37 offen
    s_add_u32 s36, s36, 131072
    s_add_u32 s37, s36, 8388608
    buffer_load_dwordx4 v[68:71], v123, s[8:11], s36 offen
    buffer_load_dwordx4 v[76:79], v123, s[8:11], s37 offen
    v_mov_b32 v0, 99456
    v_mov_b32 v2, 0
    v_mov_b32 v3, 0
    ds_write_b64 v0, v[2:3]
    s_add_u32 s12, s30, s33
    s_addc_u32 s13, s31, 0
    s_add_u32 s40, s30, s34
    s_addc_u32 s41, s31, 0
    s_lshl_b32 s38, s21, 10
    s_add_u32 s38, s38, 16384
    buffer_load_dwordx4 v[80:83], v126, s[40:43], s38 offen
    s_waitcnt lgkmcnt(0)
    s_barrier
    s_lshl_b32 s35, s2, 17
    s_add_u32 s16, s28, s35
    s_addc_u32 s17, s29, 0
    s_mov_b32 s18, 131072
    s_mov_b32 s19, 0x00020000
    s_mov_b32 s46, 0xbdd2d3e8
    s_mov_b32 s47, s46
    v_mov_b32 v120, 0xc0135761
    v_mov_b32 v121, v120
    s_mov_b32 s48, 1.0
    s_mov_b32 s49, 1.0
    v_bfe_u32 v123, v127, 2, 3
    v_lshl_add_u32 v124, v123, 2, v124
    v_mul_u32_u24 v124, 528, v124
    v_and_b32 v123, 0x30, v126
    s_lshl_b32 s36, s21, 6
    v_add3_u32 v124, v124, v123, s36
    s_mov_b32 s45, 0xffff0000
    s_mul_i32 s36, s21, 1040
    s_add_u32 s36, s36, 91136
    v_add_u32 v123, s36, v126
    s_mov_b32 s22, 2
    s_waitcnt vmcnt(3)
L_joint_kernel_floop:
    v_lshlrev_b32 v88, 16, v64
    v_and_b32 v89, s45, v64
    v_lshlrev_b32 v96, 16, v72
    v_and_b32 v97, s45, v72
    v_lshlrev_b32 v90, 16, v65
    v_and_b32 v91, s45, v65
    v_lshlrev_b32 v98, 16, v73
    v_and_b32 v99, s45, v73
    v_lshlrev_b32 v92, 16, v66
    v_and_b32 v93, s45, v66
    v_lshlrev_b32 v100, 16, v74
    v_and_b32 v101, s45, v74
    v_lshlrev_b32 v94, 16, v67
    v_and_b32 v95, s45, v67
    v_lshlrev_b32 v102, 16, v75
    v_and_b32 v103, s45, v75
    v_pk_add_f32 v[88:89], v[88:89], v[96:97]
    v_pk_add_f32 v[90:91], v[90:91], v[98:99]
    v_pk_add_f32 v[92:93], v[92:93], v[100:101]
    v_pk_add_f32 v[94:95], v[94:95], v[102:103]
    v_pk_mul_f32 v[96:97], v[88:89], v[88:89]
    v_pk_mul_f32 v[98:99], v[90:91], v[90:91]
    v_pk_mul_f32 v[100:101], v[92:93], v[92:93]
    v_pk_mul_f32 v[102:103], v[94:95], v[94:95]
    v_pk_fma_f32 v[96:97], v[96:97], s[46:47], v[120:121]
    v_pk_fma_f32 v[98:99], v[98:99], s[46:47], v[120:121]
    v_pk_fma_f32 v[100:101], v[100:101], s[46:47], v[120:121]
    v_pk_fma_f32 v[102:103], v[102:103], s[46:47], v[120:121]
    v_pk_mul_f32 v[96:97], v[96:97], v[88:89]
    v_pk_mul_f32 v[98:99], v[98:99], v[90:91]
    v_pk_mul_f32 v[100:101], v[100:101], v[92:93]
    v_pk_mul_f32 v[102:103], v[102:103], v[94:95]
    v_exp_f32 v96, v96
    v_exp_f32 v97, v97
    v_exp_f32 v98, v98
    v_exp_f32 v99, v99
    v_exp_f32 v100, v100
    v_exp_f32 v101, v101
    v_exp_f32 v102, v102
    v_exp_f32 v103, v103
    v_pk_add_f32 v[96:97], v[96:97], s[48:49]
    v_pk_add_f32 v[98:99], v[98:99], s[48:49]
    v_pk_add_f32 v[100:101], v[100:101], s[48:49]
    v_pk_add_f32 v[102:103], v[102:103], s[48:49]
    v_rcp_f32 v96, v96
    v_rcp_f32 v97, v97
    v_rcp_f32 v98, v98
    v_rcp_f32 v99, v99
    v_rcp_f32 v100, v100
    v_rcp_f32 v101, v101
    v_rcp_f32 v102, v102
    v_rcp_f32 v103, v103
    v_pk_mul_f32 v[88:89], v[88:89], v[96:97]
    v_pk_mul_f32 v[90:91], v[90:91], v[98:99]
    v_pk_mul_f32 v[92:93], v[92:93], v[100:101]
    v_pk_mul_f32 v[94:95], v[94:95], v[102:103]
    v_cvt_pk_bf16_f32 v104, v88, v89
    v_cvt_pk_bf16_f32 v105, v90, v91
    v_cvt_pk_bf16_f32 v106, v92, v93
    v_cvt_pk_bf16_f32 v107, v94, v95
    ds_write_b128 v124, v[104:107] offset:32768
    s_waitcnt vmcnt(0)
    v_pk_mov_b32 v[64:65], v[68:69], v[68:69] op_sel:[0,1]
    v_pk_mov_b32 v[72:73], v[76:77], v[76:77] op_sel:[0,1]
    v_pk_mov_b32 v[66:67], v[70:71], v[70:71] op_sel:[0,1]
    v_pk_mov_b32 v[74:75], v[78:79], v[78:79] op_sel:[0,1]
    v_add_u32 v124, 1056, v124
    s_sub_u32 s22, s22, 1
    s_cmp_lg_u32 s22, 0
    s_cbranch_scc1 L_joint_kernel_floop
    ds_write_b128 v123, v[80:83]
    s_waitcnt lgkmcnt(0)
    v_mov_b32 v120, 99456
    v_mov_b32 v121, 1
    s_mov_b64 exec, 1
    ds_add_u32 v120, v121 offset:0
    s_mov_b64 exec, -1
L_joint_kernel_ow:
    ds_read_b32 v121, v120 offset:4
    s_waitcnt lgkmcnt(0)
    v_readfirstlane_b32 s37, v121
    s_cmp_ge_u32 s37, 8
    s_cbranch_scc1 L_joint_kernel_ow_d
    s_sleep 1
    s_branch L_joint_kernel_ow
L_joint_kernel_ow_d:
    s_mov_b32 s36, 0
    buffer_load_dwordx4 v[0:3], v126, s[12:15], s36 offen offset:0
    buffer_load_dwordx4 v[4:7], v126, s[12:15], s36 offen offset:1024
    buffer_load_dwordx4 v[8:11], v126, s[12:15], s36 offen offset:2048
    buffer_load_dwordx4 v[12:15], v126, s[12:15], s36 offen offset:3072
    s_mov_b32 s36, 4096
    buffer_load_dwordx4 v[16:19], v126, s[12:15], s36 offen offset:0
    buffer_load_dwordx4 v[20:23], v126, s[12:15], s36 offen offset:1024
    buffer_load_dwordx4 v[24:27], v126, s[12:15], s36 offen offset:2048
    buffer_load_dwordx4 v[28:31], v126, s[12:15], s36 offen offset:3072
    s_mov_b32 s36, 8192
    buffer_load_dwordx4 v[32:35], v126, s[12:15], s36 offen offset:0
    buffer_load_dwordx4 v[36:39], v126, s[12:15], s36 offen offset:1024
    buffer_load_dwordx4 v[40:43], v126, s[12:15], s36 offen offset:2048
    buffer_load_dwordx4 v[44:47], v126, s[12:15], s36 offen offset:3072
    s_mov_b32 s36, 12288
    buffer_load_dwordx4 v[48:51], v126, s[12:15], s36 offen offset:0
    buffer_load_dwordx4 v[52:55], v126, s[12:15], s36 offen offset:1024
    buffer_load_dwordx4 v[56:59], v126, s[12:15], s36 offen offset:2048
    buffer_load_dwordx4 v[60:63], v126, s[12:15], s36 offen offset:3072
    v_lshrrev_b32 v125, 4, v127
    v_lshlrev_b32 v125, 11, v125
    v_and_b32 v124, 15, v127
    v_lshl_add_u32 v125, v124, 2, v125
    s_lshl_b32 s36, s21, 6
    v_add_u32 v125, s36, v125
    s_mov_b32 s44, 8192
    s_setprio 1
    s_barrier
    ds_read_b128 v[96:99], v126 offset:0
    ds_read_b128 v[100:103], v126 offset:1024
    ds_read_b128 v[104:107], v126 offset:2048
    ds_read_b128 v[108:111], v126 offset:3072
    s_waitcnt vmcnt(14) lgkmcnt(3)
    v_mfma_f32_16x16x32_bf16 v[64:67], v[96:99], v[0:3], 0
    v_mfma_f32_16x16x32_bf16 v[68:71], v[96:99], v[4:7], 0
    ds_read_b128 v[96:99], v126 offset:4096
    s_waitcnt lgkmcnt(3)
    v_mfma_f32_16x16x32_bf16 v[72:75], v[100:103], v[0:3], 0
    v_mfma_f32_16x16x32_bf16 v[76:79], v[100:103], v[4:7], 0
    ds_read_b128 v[100:103], v126 offset:5120
    s_waitcnt vmcnt(12) lgkmcnt(3)
    v_mfma_f32_16x16x32_bf16 v[64:67], v[104:107], v[8:11], v[64:67]
    v_mfma_f32_16x16x32_bf16 v[68:71], v[104:107], v[12:15], v[68:71]
    ds_read_b128 v[104:107], v126 offset:6144
    s_waitcnt lgkmcnt(3)
    v_mfma_f32_16x16x32_bf16 v[72:75], v[108:111], v[8:11], v[72:75]
    v_mfma_f32_16x16x32_bf16 v[76:79], v[108:111], v[12:15], v[76:79]
    ds_read_b128 v[108:111], v126 offset:7168
    s_waitcnt vmcnt(10) lgkmcnt(3)
    v_mfma_f32_16x16x32_bf16 v[64:67], v[96:99], v[16:19], v[64:67]
    v_mfma_f32_16x16x32_bf16 v[68:71], v[96:99], v[20:23], v[68:71]
    ds_read_b128 v[96:99], v126 offset:8192
    s_waitcnt lgkmcnt(3)
    v_mfma_f32_16x16x32_bf16 v[72:75], v[100:103], v[16:19], v[72:75]
    v_mfma_f32_16x16x32_bf16 v[76:79], v[100:103], v[20:23], v[76:79]
    ds_read_b128 v[100:103], v126 offset:9216
    s_waitcnt vmcnt(8) lgkmcnt(3)
    v_mfma_f32_16x16x32_bf16 v[64:67], v[104:107], v[24:27], v[64:67]
    v_mfma_f32_16x16x32_bf16 v[68:71], v[104:107], v[28:31], v[68:71]
    ds_read_b128 v[104:107], v126 offset:10240
    s_waitcnt lgkmcnt(3)
    v_mfma_f32_16x16x32_bf16 v[72:75], v[108:111], v[24:27], v[72:75]
    v_mfma_f32_16x16x32_bf16 v[76:79], v[108:111], v[28:31], v[76:79]
    ds_read_b128 v[108:111], v126 offset:11264
    s_waitcnt vmcnt(6) lgkmcnt(3)
    v_mfma_f32_16x16x32_bf16 v[64:67], v[96:99], v[32:35], v[64:67]
    v_mfma_f32_16x16x32_bf16 v[68:71], v[96:99], v[36:39], v[68:71]
    ds_read_b128 v[96:99], v126 offset:12288
    s_waitcnt lgkmcnt(3)
    v_mfma_f32_16x16x32_bf16 v[72:75], v[100:103], v[32:35], v[72:75]
    v_mfma_f32_16x16x32_bf16 v[76:79], v[100:103], v[36:39], v[76:79]
    ds_read_b128 v[100:103], v126 offset:13312
    s_waitcnt vmcnt(4) lgkmcnt(3)
    v_mfma_f32_16x16x32_bf16 v[64:67], v[104:107], v[40:43], v[64:67]
    v_mfma_f32_16x16x32_bf16 v[68:71], v[104:107], v[44:47], v[68:71]
    ds_read_b128 v[104:107], v126 offset:14336
    s_waitcnt lgkmcnt(3)
    v_mfma_f32_16x16x32_bf16 v[72:75], v[108:111], v[40:43], v[72:75]
    v_mfma_f32_16x16x32_bf16 v[76:79], v[108:111], v[44:47], v[76:79]
    ds_read_b128 v[108:111], v126 offset:15360
    s_waitcnt vmcnt(2) lgkmcnt(3)
    v_mfma_f32_16x16x32_bf16 v[64:67], v[96:99], v[48:51], v[64:67]
    v_mfma_f32_16x16x32_bf16 v[68:71], v[96:99], v[52:55], v[68:71]
    s_waitcnt lgkmcnt(0)
    s_barrier
    ds_read_b128 v[96:99], v126 offset:16384
    v_mfma_f32_16x16x32_bf16 v[72:75], v[100:103], v[48:51], v[72:75]
    v_mfma_f32_16x16x32_bf16 v[76:79], v[100:103], v[52:55], v[76:79]
    ds_read_b128 v[100:103], v126 offset:17408
    s_waitcnt vmcnt(0)
    v_mfma_f32_16x16x32_bf16 v[64:67], v[104:107], v[56:59], v[64:67]
    v_mfma_f32_16x16x32_bf16 v[68:71], v[104:107], v[60:63], v[68:71]
    ds_read_b128 v[104:107], v126 offset:18432
    v_mfma_f32_16x16x32_bf16 v[72:75], v[108:111], v[56:59], v[72:75]
    v_mfma_f32_16x16x32_bf16 v[76:79], v[108:111], v[60:63], v[76:79]
    ds_read_b128 v[108:111], v126 offset:19456
    s_mov_b32 s22, 4
L_joint_kernel_oloop:
    s_waitcnt lgkmcnt(3)
    v_mfma_f32_16x16x32_bf16 v[80:83], v[96:99], v[0:3], 0
    v_mfma_f32_16x16x32_bf16 v[84:87], v[96:99], v[4:7], 0
    ds_read_b128 v[96:99], v126 offset:20480
    s_waitcnt lgkmcnt(3)
    v_mfma_f32_16x16x32_bf16 v[88:91], v[100:103], v[0:3], 0
    v_mfma_f32_16x16x32_bf16 v[92:95], v[100:103], v[4:7], 0
    ds_read_b128 v[100:103], v126 offset:21504
    s_waitcnt lgkmcnt(3)
    v_mfma_f32_16x16x32_bf16 v[80:83], v[104:107], v[8:11], v[80:83]
    v_mfma_f32_16x16x32_bf16 v[84:87], v[104:107], v[12:15], v[84:87]
    ds_read_b128 v[104:107], v126 offset:22528
    s_waitcnt lgkmcnt(3)
    v_mfma_f32_16x16x32_bf16 v[88:91], v[108:111], v[8:11], v[88:91]
    v_cvt_pk_bf16_f32 v112, v64, v68
    v_mfma_f32_16x16x32_bf16 v[92:95], v[108:111], v[12:15], v[92:95]
    buffer_store_dword v112, v125, s[16:19], 0 offen offset:0 nt
    ds_read_b128 v[108:111], v126 offset:23552
    s_waitcnt lgkmcnt(3)
    v_mfma_f32_16x16x32_bf16 v[80:83], v[96:99], v[16:19], v[80:83]
    v_cvt_pk_bf16_f32 v113, v65, v69
    v_mfma_f32_16x16x32_bf16 v[84:87], v[96:99], v[20:23], v[84:87]
    buffer_store_dword v113, v125, s[16:19], 0 offen offset:512 nt
    ds_read_b128 v[96:99], v126 offset:24576
    s_waitcnt lgkmcnt(3)
    v_mfma_f32_16x16x32_bf16 v[88:91], v[100:103], v[16:19], v[88:91]
    v_cvt_pk_bf16_f32 v114, v66, v70
    v_mfma_f32_16x16x32_bf16 v[92:95], v[100:103], v[20:23], v[92:95]
    buffer_store_dword v114, v125, s[16:19], 0 offen offset:1024 nt
    ds_read_b128 v[100:103], v126 offset:25600
    s_waitcnt lgkmcnt(3)
    v_mfma_f32_16x16x32_bf16 v[80:83], v[104:107], v[24:27], v[80:83]
    v_cvt_pk_bf16_f32 v115, v67, v71
    v_mfma_f32_16x16x32_bf16 v[84:87], v[104:107], v[28:31], v[84:87]
    buffer_store_dword v115, v125, s[16:19], 0 offen offset:1536 nt
    ds_read_b128 v[104:107], v126 offset:26624
    s_waitcnt lgkmcnt(3)
    v_mfma_f32_16x16x32_bf16 v[88:91], v[108:111], v[24:27], v[88:91]
    v_cvt_pk_bf16_f32 v116, v72, v76
    v_mfma_f32_16x16x32_bf16 v[92:95], v[108:111], v[28:31], v[92:95]
    buffer_store_dword v116, v125, s[16:19], s44 offen offset:0 nt
    ds_read_b128 v[108:111], v126 offset:27648
    s_waitcnt lgkmcnt(3)
    v_mfma_f32_16x16x32_bf16 v[80:83], v[96:99], v[32:35], v[80:83]
    v_cvt_pk_bf16_f32 v117, v73, v77
    v_mfma_f32_16x16x32_bf16 v[84:87], v[96:99], v[36:39], v[84:87]
    buffer_store_dword v117, v125, s[16:19], s44 offen offset:512 nt
    ds_read_b128 v[96:99], v126 offset:28672
    s_waitcnt lgkmcnt(3)
    v_mfma_f32_16x16x32_bf16 v[88:91], v[100:103], v[32:35], v[88:91]
    v_cvt_pk_bf16_f32 v118, v74, v78
    v_mfma_f32_16x16x32_bf16 v[92:95], v[100:103], v[36:39], v[92:95]
    buffer_store_dword v118, v125, s[16:19], s44 offen offset:1024 nt
    ds_read_b128 v[100:103], v126 offset:29696
    s_waitcnt lgkmcnt(3)
    v_mfma_f32_16x16x32_bf16 v[80:83], v[104:107], v[40:43], v[80:83]
    v_cvt_pk_bf16_f32 v119, v75, v79
    v_mfma_f32_16x16x32_bf16 v[84:87], v[104:107], v[44:47], v[84:87]
    buffer_store_dword v119, v125, s[16:19], s44 offen offset:1536 nt
    ds_read_b128 v[104:107], v126 offset:30720
    s_waitcnt lgkmcnt(3)
    v_mfma_f32_16x16x32_bf16 v[88:91], v[108:111], v[40:43], v[88:91]
    v_add_u32 v125, 16384, v125
    v_mfma_f32_16x16x32_bf16 v[92:95], v[108:111], v[44:47], v[92:95]
    ds_read_b128 v[108:111], v126 offset:31744
    s_waitcnt lgkmcnt(3)
    v_mfma_f32_16x16x32_bf16 v[80:83], v[96:99], v[48:51], v[80:83]
    v_mfma_f32_16x16x32_bf16 v[84:87], v[96:99], v[52:55], v[84:87]
    s_waitcnt lgkmcnt(0)
    s_barrier
    ds_read_b128 v[96:99], v126 offset:0
    v_mfma_f32_16x16x32_bf16 v[88:91], v[100:103], v[48:51], v[88:91]
    v_mfma_f32_16x16x32_bf16 v[92:95], v[100:103], v[52:55], v[92:95]
    ds_read_b128 v[100:103], v126 offset:1024
    v_mfma_f32_16x16x32_bf16 v[80:83], v[104:107], v[56:59], v[80:83]
    v_mfma_f32_16x16x32_bf16 v[84:87], v[104:107], v[60:63], v[84:87]
    ds_read_b128 v[104:107], v126 offset:2048
    v_mfma_f32_16x16x32_bf16 v[88:91], v[108:111], v[56:59], v[88:91]
    v_mfma_f32_16x16x32_bf16 v[92:95], v[108:111], v[60:63], v[92:95]
    ds_read_b128 v[108:111], v126 offset:3072
    s_sub_u32 s22, s22, 1
    s_cmp_eq_u32 s22, 0
    s_cbranch_scc1 L_joint_kernel_oend
    s_waitcnt lgkmcnt(3)
    v_mfma_f32_16x16x32_bf16 v[64:67], v[96:99], v[0:3], 0
    v_mfma_f32_16x16x32_bf16 v[68:71], v[96:99], v[4:7], 0
    ds_read_b128 v[96:99], v126 offset:4096
    s_waitcnt lgkmcnt(3)
    v_mfma_f32_16x16x32_bf16 v[72:75], v[100:103], v[0:3], 0
    v_mfma_f32_16x16x32_bf16 v[76:79], v[100:103], v[4:7], 0
    ds_read_b128 v[100:103], v126 offset:5120
    s_waitcnt lgkmcnt(3)
    v_mfma_f32_16x16x32_bf16 v[64:67], v[104:107], v[8:11], v[64:67]
    v_mfma_f32_16x16x32_bf16 v[68:71], v[104:107], v[12:15], v[68:71]
    ds_read_b128 v[104:107], v126 offset:6144
    s_waitcnt lgkmcnt(3)
    v_mfma_f32_16x16x32_bf16 v[72:75], v[108:111], v[8:11], v[72:75]
    v_cvt_pk_bf16_f32 v112, v80, v84
    v_mfma_f32_16x16x32_bf16 v[76:79], v[108:111], v[12:15], v[76:79]
    buffer_store_dword v112, v125, s[16:19], 0 offen offset:0 nt
    ds_read_b128 v[108:111], v126 offset:7168
    s_waitcnt lgkmcnt(3)
    v_mfma_f32_16x16x32_bf16 v[64:67], v[96:99], v[16:19], v[64:67]
    v_cvt_pk_bf16_f32 v113, v81, v85
    v_mfma_f32_16x16x32_bf16 v[68:71], v[96:99], v[20:23], v[68:71]
    buffer_store_dword v113, v125, s[16:19], 0 offen offset:512 nt
    ds_read_b128 v[96:99], v126 offset:8192
    s_waitcnt lgkmcnt(3)
    v_mfma_f32_16x16x32_bf16 v[72:75], v[100:103], v[16:19], v[72:75]
    v_cvt_pk_bf16_f32 v114, v82, v86
    v_mfma_f32_16x16x32_bf16 v[76:79], v[100:103], v[20:23], v[76:79]
    buffer_store_dword v114, v125, s[16:19], 0 offen offset:1024 nt
    ds_read_b128 v[100:103], v126 offset:9216
    s_waitcnt lgkmcnt(3)
    v_mfma_f32_16x16x32_bf16 v[64:67], v[104:107], v[24:27], v[64:67]
    v_cvt_pk_bf16_f32 v115, v83, v87
    v_mfma_f32_16x16x32_bf16 v[68:71], v[104:107], v[28:31], v[68:71]
    buffer_store_dword v115, v125, s[16:19], 0 offen offset:1536 nt
    ds_read_b128 v[104:107], v126 offset:10240
    s_waitcnt lgkmcnt(3)
    v_mfma_f32_16x16x32_bf16 v[72:75], v[108:111], v[24:27], v[72:75]
    v_cvt_pk_bf16_f32 v116, v88, v92
    v_mfma_f32_16x16x32_bf16 v[76:79], v[108:111], v[28:31], v[76:79]
    buffer_store_dword v116, v125, s[16:19], s44 offen offset:0 nt
    ds_read_b128 v[108:111], v126 offset:11264
    s_waitcnt lgkmcnt(3)
    v_mfma_f32_16x16x32_bf16 v[64:67], v[96:99], v[32:35], v[64:67]
    v_cvt_pk_bf16_f32 v117, v89, v93
    v_mfma_f32_16x16x32_bf16 v[68:71], v[96:99], v[36:39], v[68:71]
    buffer_store_dword v117, v125, s[16:19], s44 offen offset:512 nt
    ds_read_b128 v[96:99], v126 offset:12288
    s_waitcnt lgkmcnt(3)
    v_mfma_f32_16x16x32_bf16 v[72:75], v[100:103], v[32:35], v[72:75]
    v_cvt_pk_bf16_f32 v118, v90, v94
    v_mfma_f32_16x16x32_bf16 v[76:79], v[100:103], v[36:39], v[76:79]
    buffer_store_dword v118, v125, s[16:19], s44 offen offset:1024 nt
    ds_read_b128 v[100:103], v126 offset:13312
    s_waitcnt lgkmcnt(3)
    v_mfma_f32_16x16x32_bf16 v[64:67], v[104:107], v[40:43], v[64:67]
    v_cvt_pk_bf16_f32 v119, v91, v95
    v_mfma_f32_16x16x32_bf16 v[68:71], v[104:107], v[44:47], v[68:71]
    buffer_store_dword v119, v125, s[16:19], s44 offen offset:1536 nt
    ds_read_b128 v[104:107], v126 offset:14336
    s_waitcnt lgkmcnt(3)
    v_mfma_f32_16x16x32_bf16 v[72:75], v[108:111], v[40:43], v[72:75]
    v_add_u32 v125, 16384, v125
    v_mfma_f32_16x16x32_bf16 v[76:79], v[108:111], v[44:47], v[76:79]
    ds_read_b128 v[108:111], v126 offset:15360
    s_waitcnt lgkmcnt(3)
    v_mfma_f32_16x16x32_bf16 v[64:67], v[96:99], v[48:51], v[64:67]
    v_mfma_f32_16x16x32_bf16 v[68:71], v[96:99], v[52:55], v[68:71]
    s_waitcnt lgkmcnt(0)
    s_barrier
    ds_read_b128 v[96:99], v126 offset:16384
    v_mfma_f32_16x16x32_bf16 v[72:75], v[100:103], v[48:51], v[72:75]
    v_mfma_f32_16x16x32_bf16 v[76:79], v[100:103], v[52:55], v[76:79]
    ds_read_b128 v[100:103], v126 offset:17408
    v_mfma_f32_16x16x32_bf16 v[64:67], v[104:107], v[56:59], v[64:67]
    v_mfma_f32_16x16x32_bf16 v[68:71], v[104:107], v[60:63], v[68:71]
    ds_read_b128 v[104:107], v126 offset:18432
    v_mfma_f32_16x16x32_bf16 v[72:75], v[108:111], v[56:59], v[72:75]
    v_mfma_f32_16x16x32_bf16 v[76:79], v[108:111], v[60:63], v[76:79]
    ds_read_b128 v[108:111], v126 offset:19456
    s_waitcnt vmcnt(32)
    s_branch L_joint_kernel_oloop
L_joint_kernel_oend:
    s_nop 7
    v_cvt_pk_bf16_f32 v112, v80, v84
    buffer_store_dword v112, v125, s[16:19], 0 offen offset:0 nt
    v_cvt_pk_bf16_f32 v113, v81, v85
    buffer_store_dword v113, v125, s[16:19], 0 offen offset:512 nt
    v_cvt_pk_bf16_f32 v114, v82, v86
    buffer_store_dword v114, v125, s[16:19], 0 offen offset:1024 nt
    v_cvt_pk_bf16_f32 v115, v83, v87
    buffer_store_dword v115, v125, s[16:19], 0 offen offset:1536 nt
    v_cvt_pk_bf16_f32 v116, v88, v92
    buffer_store_dword v116, v125, s[16:19], s44 offen offset:0 nt
    v_cvt_pk_bf16_f32 v117, v89, v93
    buffer_store_dword v117, v125, s[16:19], s44 offen offset:512 nt
    v_cvt_pk_bf16_f32 v118, v90, v94
    buffer_store_dword v118, v125, s[16:19], s44 offen offset:1024 nt
    v_cvt_pk_bf16_f32 v119, v91, v95
    buffer_store_dword v119, v125, s[16:19], s44 offen offset:1536 nt
    v_add_u32 v125, 16384, v125
    s_branch L_joint_kernel_fin
L_joint_kernel_T:
    s_setprio 3
    s_waitcnt lgkmcnt(0)
    s_add_u32 s12, s30, s33
    s_addc_u32 s13, s31, 0
    s_add_u32 s40, s30, s34
    s_addc_u32 s41, s31, 0
    s_lshl_b32 s36, s21, 2
    s_add_u32 s36, s36, 44335104
    s_add_u32 s36, s30, s36
    s_addc_u32 s37, s31, 0
    s_load_dword s44, s[36:37], 0
    v_and_b32 v123, 15, v127
    v_lshrrev_b32 v121, 4, v127
    v_mul_u32_u24 v125, 528, v123
    v_lshl_add_u32 v125, v121, 4, v125
    v_lshlrev_b32 v121, 5, v121
    v_and_b32 v120, 7, v127
    v_lshl_add_u32 v124, v120, 10, v121
    s_lshl_b32 s38, s21, 7
    v_mul_u32_u24 v120, 1040, v120
    s_add_u32 s36, s38, 91136
    v_add3_u32 v120, v120, v121, s36
    s_mul_i32 s36, s21, 5184
    s_add_u32 s36, s36, 49664
    v_add_u32 v121, s36, v121
    v_mul_u32_u24 v122, 144, v123
    v_add_u32 v122, v122, v121
    v_lshrrev_b32 v123, 3, v123
    v_mul_u32_u24 v123, 144, v123
    v_add_u32 v121, v123, v121
    s_lshl_b32 s36, s21, 11
    v_add_u32 v123, s36, v126
    s_barrier
    s_mov_b32 s36, 0
    buffer_load_dwordx4 v[0:3], v126, s[12:15], s36 offen offset:0
    buffer_load_dwordx4 v[4:7], v126, s[12:15], s36 offen offset:1024
    buffer_load_dwordx4 v[8:11], v126, s[12:15], s36 offen offset:2048
    buffer_load_dwordx4 v[12:15], v126, s[12:15], s36 offen offset:3072
    s_mov_b32 s36, 4096
    buffer_load_dwordx4 v[16:19], v126, s[12:15], s36 offen offset:0
    buffer_load_dwordx4 v[20:23], v126, s[12:15], s36 offen offset:1024
    buffer_load_dwordx4 v[24:27], v126, s[12:15], s36 offen offset:2048
    buffer_load_dwordx4 v[28:31], v126, s[12:15], s36 offen offset:3072
    s_mov_b32 s36, 8192
    buffer_load_dwordx4 v[32:35], v126, s[12:15], s36 offen offset:0
    buffer_load_dwordx4 v[36:39], v126, s[12:15], s36 offen offset:1024
    buffer_load_dwordx4 v[40:43], v126, s[12:15], s36 offen offset:2048
    buffer_load_dwordx4 v[44:47], v126, s[12:15], s36 offen offset:3072
    s_mov_b32 s36, 12288
    buffer_load_dwordx4 v[48:51], v126, s[12:15], s36 offen offset:0
    buffer_load_dwordx4 v[52:55], v126, s[12:15], s36 offen offset:1024
    buffer_load_dwordx4 v[56:59], v126, s[12:15], s36 offen offset:2048
    buffer_load_dwordx4 v[60:63], v126, s[12:15], s36 offen offset:3072
    v_mov_b32 v64, 99456
    v_mov_b32 v65, 1
    s_mov_b64 exec, 1
    ds_add_u32 v64, v65 offset:4
    s_mov_b64 exec, -1
L_joint_kernel_tw:
    ds_read_b32 v65, v64 offset:0
    s_waitcnt lgkmcnt(0)
    v_readfirstlane_b32 s37, v65
    s_cmp_ge_u32 s37, 8
    s_cbranch_scc1 L_joint_kernel_tw_d
    s_sleep 1
    s_branch L_joint_kernel_tw
L_joint_kernel_tw_d:
    ds_read_b128 v[80:83], v125 offset:32768
    ds_read_b128 v[84:87], v125 offset:41216
    ds_read_b128 v[88:91], v125 offset:32832
    ds_read_b128 v[92:95], v125 offset:41280
    ds_read_b128 v[96:99], v125 offset:32896
    ds_read_b128 v[100:103], v125 offset:41344
    ds_read_b128 v[104:107], v125 offset:32960
    ds_read_b128 v[108:111], v125 offset:41408
    s_setprio 0
    s_waitcnt vmcnt(14) lgkmcnt(7)
    v_mfma_f32_16x16x32_bf16 v[64:67], v[0:3], v[80:83], 0
    v_mfma_f32_16x16x32_bf16 v[68:71], v[4:7], v[80:83], 0
    ds_read_b128 v[80:83], v125 offset:33024
    s_waitcnt lgkmcnt(7)
    v_mfma_f32_16x16x32_bf16 v[72:75], v[0:3], v[84:87], 0
    v_mfma_f32_16x16x32_bf16 v[76:79], v[4:7], v[84:87], 0
    ds_read_b128 v[84:87], v125 offset:41472
    s_waitcnt vmcnt(12) lgkmcnt(7)
    v_mfma_f32_16x16x32_bf16 v[64:67], v[8:11], v[88:91], v[64:67]
    v_mfma_f32_16x16x32_bf16 v[68:71], v[12:15], v[88:91], v[68:71]
    ds_read_b128 v[88:91], v125 offset:33088
    s_waitcnt lgkmcnt(7)
    v_mfma_f32_16x16x32_bf16 v[72:75], v[8:11], v[92:95], v[72:75]
    v_mfma_f32_16x16x32_bf16 v[76:79], v[12:15], v[92:95], v[76:79]
    ds_read_b128 v[92:95], v125 offset:41536
    s_waitcnt vmcnt(10) lgkmcnt(7)
    v_mfma_f32_16x16x32_bf16 v[64:67], v[16:19], v[96:99], v[64:67]
    v_mfma_f32_16x16x32_bf16 v[68:71], v[20:23], v[96:99], v[68:71]
    ds_read_b128 v[96:99], v125 offset:33152
    s_waitcnt lgkmcnt(7)
    v_mfma_f32_16x16x32_bf16 v[72:75], v[16:19], v[100:103], v[72:75]
    v_mfma_f32_16x16x32_bf16 v[76:79], v[20:23], v[100:103], v[76:79]
    ds_read_b128 v[100:103], v125 offset:41600
    s_waitcnt vmcnt(8) lgkmcnt(7)
    v_mfma_f32_16x16x32_bf16 v[64:67], v[24:27], v[104:107], v[64:67]
    v_mfma_f32_16x16x32_bf16 v[68:71], v[28:31], v[104:107], v[68:71]
    ds_read_b128 v[104:107], v125 offset:33216
    s_waitcnt lgkmcnt(7)
    v_mfma_f32_16x16x32_bf16 v[72:75], v[24:27], v[108:111], v[72:75]
    v_mfma_f32_16x16x32_bf16 v[76:79], v[28:31], v[108:111], v[76:79]
    ds_read_b128 v[108:111], v125 offset:41664
    s_waitcnt vmcnt(6) lgkmcnt(7)
    v_mfma_f32_16x16x32_bf16 v[64:67], v[32:35], v[80:83], v[64:67]
    v_mfma_f32_16x16x32_bf16 v[68:71], v[36:39], v[80:83], v[68:71]
    ds_read_b128 v[112:115], v120 offset:0
    s_waitcnt lgkmcnt(7)
    v_mfma_f32_16x16x32_bf16 v[72:75], v[32:35], v[84:87], v[72:75]
    v_mfma_f32_16x16x32_bf16 v[76:79], v[36:39], v[84:87], v[76:79]
    ds_read_b128 v[116:119], v120 offset:16
    s_waitcnt vmcnt(4) lgkmcnt(7)
    v_mfma_f32_16x16x32_bf16 v[64:67], v[40:43], v[88:91], v[64:67]
    v_mfma_f32_16x16x32_bf16 v[68:71], v[44:47], v[88:91], v[68:71]
    s_waitcnt lgkmcnt(6)
    v_mfma_f32_16x16x32_bf16 v[72:75], v[40:43], v[92:95], v[72:75]
    v_mfma_f32_16x16x32_bf16 v[76:79], v[44:47], v[92:95], v[76:79]
    s_waitcnt vmcnt(2) lgkmcnt(5)
    v_mfma_f32_16x16x32_bf16 v[64:67], v[48:51], v[96:99], v[64:67]
    v_mfma_f32_16x16x32_bf16 v[68:71], v[52:55], v[96:99], v[68:71]
    s_waitcnt lgkmcnt(4)
    v_mfma_f32_16x16x32_bf16 v[72:75], v[48:51], v[100:103], v[72:75]
    v_mfma_f32_16x16x32_bf16 v[76:79], v[52:55], v[100:103], v[76:79]
    s_waitcnt vmcnt(0) lgkmcnt(3)
    v_mfma_f32_16x16x32_bf16 v[64:67], v[56:59], v[104:107], v[64:67]
    v_mfma_f32_16x16x32_bf16 v[68:71], v[60:63], v[104:107], v[68:71]
    s_waitcnt lgkmcnt(2)
    v_mfma_f32_16x16x32_bf16 v[72:75], v[56:59], v[108:111], v[72:75]
    v_mfma_f32_16x16x32_bf16 v[76:79], v[60:63], v[108:111], v[76:79]
    s_mov_b32 s46, 0xffff0000
    s_mov_b32 s48, 0x4038aa3b
    s_mov_b32 s49, s48
    s_nop 3
    v_mov_b32 v28, 0
    s_waitcnt lgkmcnt(0)
    v_cvt_pk_bf16_f32 v24, v64, v68
    v_cvt_pk_bf16_f32 v25, v65, v69
    v_cvt_pk_bf16_f32 v26, v66, v70
    v_cvt_pk_bf16_f32 v27, v67, v71
    v_lshlrev_b32 v80, 16, v24
    v_and_b32 v81, s46, v24
    v_lshlrev_b32 v82, 16, v25
    v_and_b32 v83, s46, v25
    v_lshlrev_b32 v84, 16, v26
    v_and_b32 v85, s46, v26
    v_lshlrev_b32 v86, 16, v27
    v_and_b32 v87, s46, v27
    v_pk_mul_f32 v[80:81], v[80:81], s[48:49]
    v_pk_mul_f32 v[82:83], v[82:83], s[48:49]
    v_pk_mul_f32 v[84:85], v[84:85], s[48:49]
    v_pk_mul_f32 v[86:87], v[86:87], s[48:49]
    v_exp_f32 v96, v80
    v_exp_f32 v97, v81
    v_exp_f32 v98, v82
    v_exp_f32 v99, v83
    v_max3_f32 v28, |v80|, |v81|, v28
    v_max3_f32 v28, |v82|, |v83|, v28
    ds_write_b128 v122, v[96:99] offset:0
    v_exp_f32 v100, v84
    v_exp_f32 v101, v85
    v_exp_f32 v102, v86
    v_exp_f32 v103, v87
    v_max3_f32 v28, |v84|, |v85|, v28
    v_max3_f32 v28, |v86|, |v87|, v28
    ds_write_b128 v122, v[100:103] offset:16
    v_cvt_pk_bf16_f32 v24, v72, v76
    v_cvt_pk_bf16_f32 v25, v73, v77
    v_cvt_pk_bf16_f32 v26, v74, v78
    v_cvt_pk_bf16_f32 v27, v75, v79
    v_lshlrev_b32 v88, 16, v24
    v_and_b32 v89, s46, v24
    v_lshlrev_b32 v90, 16, v25
    v_and_b32 v91, s46, v25
    v_lshlrev_b32 v92, 16, v26
    v_and_b32 v93, s46, v26
    v_lshlrev_b32 v94, 16, v27
    v_and_b32 v95, s46, v27
    v_pk_mul_f32 v[88:89], v[88:89], s[48:49]
    v_pk_mul_f32 v[90:91], v[90:91], s[48:49]
    v_pk_mul_f32 v[92:93], v[92:93], s[48:49]
    v_pk_mul_f32 v[94:95], v[94:95], s[48:49]
    v_exp_f32 v104, v88
    v_exp_f32 v105, v89
    v_exp_f32 v106, v90
    v_exp_f32 v107, v91
    v_max3_f32 v28, |v88|, |v89|, v28
    v_max3_f32 v28, |v90|, |v91|, v28
    ds_write_b128 v122, v[104:107] offset:2304
    v_exp_f32 v108, v92
    v_exp_f32 v109, v93
    v_exp_f32 v110, v94
    v_exp_f32 v111, v95
    v_max3_f32 v28, |v92|, |v93|, v28
    v_max3_f32 v28, |v94|, |v95|, v28
    ds_write_b128 v122, v[108:111] offset:2320
    v_cmp_lt_f32 vcc, 0x42f00000, v28
    s_mov_b32 s22, 4
    s_or_b32 s44, s44, vcc_lo
    s_or_b32 s44, s44, vcc_hi
    s_cmp_lg_u32 s44, 0
    s_cbranch_scc1 L_joint_kernel_tslow
    ds_read_b128 v[32:35], v121 offset:0
    ds_read_b128 v[36:39], v121 offset:16
    ds_read_b128 v[40:43], v121 offset:288
    ds_read_b128 v[44:47], v121 offset:304
    v_add_u32 v121, 576, v121
    s_waitcnt vmcnt(0) lgkmcnt(0)
L_joint_kernel_tloop1:
    v_fma_f32 v48, v112, v32, 1.0
    v_fma_f32 v49, v113, v33, 1.0
    v_fma_f32 v50, v114, v34, 1.0
    v_fma_f32 v51, v115, v35, 1.0
    v_fma_f32 v52, v116, v36, 1.0
    v_fma_f32 v53, v117, v37, 1.0
    v_fma_f32 v54, v118, v38, 1.0
    v_fma_f32 v55, v119, v39, 1.0
    v_fma_f32 v56, v112, v40, 1.0
    v_fma_f32 v57, v113, v41, 1.0
    v_fma_f32 v58, v114, v42, 1.0
    v_fma_f32 v59, v115, v43, 1.0
    v_fma_f32 v60, v116, v44, 1.0
    v_fma_f32 v61, v117, v45, 1.0
    v_fma_f32 v62, v118, v46, 1.0
    v_fma_f32 v63, v119, v47, 1.0
    ds_read_b128 v[32:35], v121 offset:0
    ds_read_b128 v[36:39], v121 offset:16
    ds_read_b128 v[40:43], v121 offset:288
    ds_read_b128 v[44:47], v121 offset:304
    v_add_u32 v121, 576, v121
    v_rcp_f32 v48, v48
    v_rcp_f32 v49, v49
    v_rcp_f32 v50, v50
    v_rcp_f32 v51, v51
    v_rcp_f32 v52, v52
    v_rcp_f32 v53, v53
    v_rcp_f32 v54, v54
    v_rcp_f32 v55, v55
    v_fma_f32 v48, v48, -2.0, 1.0
    v_fma_f32 v49, v49, -2.0, 1.0
    v_fma_f32 v50, v50, -2.0, 1.0
    v_fma_f32 v51, v51, -2.0, 1.0
    v_fma_f32 v52, v52, -2.0, 1.0
    v_fma_f32 v53, v53, -2.0, 1.0
    v_fma_f32 v54, v54, -2.0, 1.0
    v_fma_f32 v55, v55, -2.0, 1.0
    v_cvt_pk_bf16_f32 v64, v48, v49
    v_cvt_pk_bf16_f32 v65, v50, v51
    v_cvt_pk_bf16_f32 v66, v52, v53
    v_cvt_pk_bf16_f32 v67, v54, v55
    ds_write_b128 v123, v[64:67] offset:0
    v_rcp_f32 v56, v56
    v_rcp_f32 v57, v57
    v_rcp_f32 v58, v58
    v_rcp_f32 v59, v59
    v_rcp_f32 v60, v60
    v_rcp_f32 v61, v61
    v_rcp_f32 v62, v62
    v_rcp_f32 v63, v63
    v_fma_f32 v56, v56, -2.0, 1.0
    v_fma_f32 v57, v57, -2.0, 1.0
    v_fma_f32 v58, v58, -2.0, 1.0
    v_fma_f32 v59, v59, -2.0, 1.0
    v_fma_f32 v60, v60, -2.0, 1.0
    v_fma_f32 v61, v61, -2.0, 1.0
    v_fma_f32 v62, v62, -2.0, 1.0
    v_fma_f32 v63, v63, -2.0, 1.0
    v_cvt_pk_bf16_f32 v68, v56, v57
    v_cvt_pk_bf16_f32 v69, v58, v59
    v_cvt_pk_bf16_f32 v70, v60, v61
    v_cvt_pk_bf16_f32 v71, v62, v63
    ds_write_b128 v123, v[68:71] offset:1024
    s_waitcnt lgkmcnt(0)
    s_barrier
    v_fma_f32 v48, v112, v32, 1.0
    v_fma_f32 v49, v113, v33, 1.0
    v_fma_f32 v50, v114, v34, 1.0
    v_fma_f32 v51, v115, v35, 1.0
    v_fma_f32 v52, v116, v36, 1.0
    v_fma_f32 v53, v117, v37, 1.0
    v_fma_f32 v54, v118, v38, 1.0
    v_fma_f32 v55, v119, v39, 1.0
    v_fma_f32 v56, v112, v40, 1.0
    v_fma_f32 v57, v113, v41, 1.0
    v_fma_f32 v58, v114, v42, 1.0
    v_fma_f32 v59, v115, v43, 1.0
    v_fma_f32 v60, v116, v44, 1.0
    v_fma_f32 v61, v117, v45, 1.0
    v_fma_f32 v62, v118, v46, 1.0
    v_fma_f32 v63, v119, v47, 1.0
    ds_read_b128 v[32:35], v121 offset:0
    ds_read_b128 v[36:39], v121 offset:16
    ds_read_b128 v[40:43], v121 offset:288
    ds_read_b128 v[44:47], v121 offset:304
    v_add_u32 v121, 576, v121
    v_rcp_f32 v48, v48
    v_rcp_f32 v49, v49
    v_rcp_f32 v50, v50
    v_rcp_f32 v51, v51
    v_rcp_f32 v52, v52
    v_rcp_f32 v53, v53
    v_rcp_f32 v54, v54
    v_rcp_f32 v55, v55
    v_fma_f32 v48, v48, -2.0, 1.0
    v_fma_f32 v49, v49, -2.0, 1.0
    v_fma_f32 v50, v50, -2.0, 1.0
    v_fma_f32 v51, v51, -2.0, 1.0
    v_fma_f32 v52, v52, -2.0, 1.0
    v_fma_f32 v53, v53, -2.0, 1.0
    v_fma_f32 v54, v54, -2.0, 1.0
    v_fma_f32 v55, v55, -2.0, 1.0
    v_cvt_pk_bf16_f32 v64, v48, v49
    v_cvt_pk_bf16_f32 v65, v50, v51
    v_cvt_pk_bf16_f32 v66, v52, v53
    v_cvt_pk_bf16_f32 v67, v54, v55
    ds_write_b128 v123, v[64:67] offset:16384
    v_rcp_f32 v56, v56
    v_rcp_f32 v57, v57
    v_rcp_f32 v58, v58
    v_rcp_f32 v59, v59
    v_rcp_f32 v60, v60
    v_rcp_f32 v61, v61
    v_rcp_f32 v62, v62
    v_rcp_f32 v63, v63
    v_fma_f32 v56, v56, -2.0, 1.0
    v_fma_f32 v57, v57, -2.0, 1.0
    v_fma_f32 v58, v58, -2.0, 1.0
    v_fma_f32 v59, v59, -2.0, 1.0
    v_fma_f32 v60, v60, -2.0, 1.0
    v_fma_f32 v61, v61, -2.0, 1.0
    v_fma_f32 v62, v62, -2.0, 1.0
    v_fma_f32 v63, v63, -2.0, 1.0
    v_cvt_pk_bf16_f32 v68, v56, v57
    v_cvt_pk_bf16_f32 v69, v58, v59
    v_cvt_pk_bf16_f32 v70, v60, v61
    v_cvt_pk_bf16_f32 v71, v62, v63
    ds_write_b128 v123, v[68:71] offset:17408
    s_waitcnt lgkmcnt(0)
    s_barrier
    s_sub_u32 s22, s22, 1
    s_cmp_lg_u32 s22, 0
    s_cbranch_scc1 L_joint_kernel_tloop1
    s_branch L_joint_kernel_fin
L_joint_kernel_tslow:
    buffer_load_dwordx4 v[112:115], v124, s[40:43], s38 offen offset:0
    buffer_load_dwordx4 v[116:119], v124, s[40:43], s38 offen offset:16
    ds_write_b128 v122, v[80:83] offset:0
    ds_write_b128 v122, v[84:87] offset:16
    ds_write_b128 v122, v[88:91] offset:2304
    ds_write_b128 v122, v[92:95] offset:2320
    ds_read_b128 v[32:35], v121 offset:0
    ds_read_b128 v[36:39], v121 offset:16
    ds_read_b128 v[40:43], v121 offset:288
    ds_read_b128 v[44:47], v121 offset:304
    v_add_u32 v121, 576, v121
    s_waitcnt vmcnt(0) lgkmcnt(0)
L_joint_kernel_tloop0:
    v_add_f32 v48, v112, v32
    v_add_f32 v49, v113, v33
    v_add_f32 v50, v114, v34
    v_add_f32 v51, v115, v35
    v_add_f32 v52, v116, v36
    v_add_f32 v53, v117, v37
    v_add_f32 v54, v118, v38
    v_add_f32 v55, v119, v39
    v_add_f32 v56, v112, v40
    v_add_f32 v57, v113, v41
    v_add_f32 v58, v114, v42
    v_add_f32 v59, v115, v43
    v_add_f32 v60, v116, v44
    v_add_f32 v61, v117, v45
    v_add_f32 v62, v118, v46
    v_add_f32 v63, v119, v47
    ds_read_b128 v[32:35], v121 offset:0
    ds_read_b128 v[36:39], v121 offset:16
    ds_read_b128 v[40:43], v121 offset:288
    ds_read_b128 v[44:47], v121 offset:304
    v_add_u32 v121, 576, v121
    v_exp_f32 v48, v48
    v_exp_f32 v49, v49
    v_exp_f32 v50, v50
    v_exp_f32 v51, v51
    v_exp_f32 v52, v52
    v_exp_f32 v53, v53
    v_exp_f32 v54, v54
    v_exp_f32 v55, v55
    v_add_f32 v48, 1.0, v48
    v_add_f32 v49, 1.0, v49
    v_add_f32 v50, 1.0, v50
    v_add_f32 v51, 1.0, v51
    v_add_f32 v52, 1.0, v52
    v_add_f32 v53, 1.0, v53
    v_add_f32 v54, 1.0, v54
    v_add_f32 v55, 1.0, v55
    v_rcp_f32 v48, v48
    v_rcp_f32 v49, v49
    v_rcp_f32 v50, v50
    v_rcp_f32 v51, v51
    v_rcp_f32 v52, v52
    v_rcp_f32 v53, v53
    v_rcp_f32 v54, v54
    v_rcp_f32 v55, v55
    v_fma_f32 v48, v48, -2.0, 1.0
    v_fma_f32 v49, v49, -2.0, 1.0
    v_fma_f32 v50, v50, -2.0, 1.0
    v_fma_f32 v51, v51, -2.0, 1.0
    v_fma_f32 v52, v52, -2.0, 1.0
    v_fma_f32 v53, v53, -2.0, 1.0
    v_fma_f32 v54, v54, -2.0, 1.0
    v_fma_f32 v55, v55, -2.0, 1.0
    v_cvt_pk_bf16_f32 v64, v48, v49
    v_cvt_pk_bf16_f32 v65, v50, v51
    v_cvt_pk_bf16_f32 v66, v52, v53
    v_cvt_pk_bf16_f32 v67, v54, v55
    ds_write_b128 v123, v[64:67] offset:0
    v_exp_f32 v56, v56
    v_exp_f32 v57, v57
    v_exp_f32 v58, v58
    v_exp_f32 v59, v59
    v_exp_f32 v60, v60
    v_exp_f32 v61, v61
    v_exp_f32 v62, v62
    v_exp_f32 v63, v63
    v_add_f32 v56, 1.0, v56
    v_add_f32 v57, 1.0, v57
    v_add_f32 v58, 1.0, v58
    v_add_f32 v59, 1.0, v59
    v_add_f32 v60, 1.0, v60
    v_add_f32 v61, 1.0, v61
    v_add_f32 v62, 1.0, v62
    v_add_f32 v63, 1.0, v63
    v_rcp_f32 v56, v56
    v_rcp_f32 v57, v57
    v_rcp_f32 v58, v58
    v_rcp_f32 v59, v59
    v_rcp_f32 v60, v60
    v_rcp_f32 v61, v61
    v_rcp_f32 v62, v62
    v_rcp_f32 v63, v63
    v_fma_f32 v56, v56, -2.0, 1.0
    v_fma_f32 v57, v57, -2.0, 1.0
    v_fma_f32 v58, v58, -2.0, 1.0
    v_fma_f32 v59, v59, -2.0, 1.0
    v_fma_f32 v60, v60, -2.0, 1.0
    v_fma_f32 v61, v61, -2.0, 1.0
    v_fma_f32 v62, v62, -2.0, 1.0
    v_fma_f32 v63, v63, -2.0, 1.0
    v_cvt_pk_bf16_f32 v68, v56, v57
    v_cvt_pk_bf16_f32 v69, v58, v59
    v_cvt_pk_bf16_f32 v70, v60, v61
    v_cvt_pk_bf16_f32 v71, v62, v63
    ds_write_b128 v123, v[68:71] offset:1024
    s_waitcnt lgkmcnt(0)
    s_barrier
    v_add_f32 v48, v112, v32
    v_add_f32 v49, v113, v33
    v_add_f32 v50, v114, v34
    v_add_f32 v51, v115, v35
    v_add_f32 v52, v116, v36
    v_add_f32 v53, v117, v37
    v_add_f32 v54, v118, v38
    v_add_f32 v55, v119, v39
    v_add_f32 v56, v112, v40
    v_add_f32 v57, v113, v41
    v_add_f32 v58, v114, v42
    v_add_f32 v59, v115, v43
    v_add_f32 v60, v116, v44
    v_add_f32 v61, v117, v45
    v_add_f32 v62, v118, v46
    v_add_f32 v63, v119, v47
    ds_read_b128 v[32:35], v121 offset:0
    ds_read_b128 v[36:39], v121 offset:16
    ds_read_b128 v[40:43], v121 offset:288
    ds_read_b128 v[44:47], v121 offset:304
    v_add_u32 v121, 576, v121
    v_exp_f32 v48, v48
    v_exp_f32 v49, v49
    v_exp_f32 v50, v50
    v_exp_f32 v51, v51
    v_exp_f32 v52, v52
    v_exp_f32 v53, v53
    v_exp_f32 v54, v54
    v_exp_f32 v55, v55
    v_add_f32 v48, 1.0, v48
    v_add_f32 v49, 1.0, v49
    v_add_f32 v50, 1.0, v50
    v_add_f32 v51, 1.0, v51
    v_add_f32 v52, 1.0, v52
    v_add_f32 v53, 1.0, v53
    v_add_f32 v54, 1.0, v54
    v_add_f32 v55, 1.0, v55
    v_rcp_f32 v48, v48
    v_rcp_f32 v49, v49
    v_rcp_f32 v50, v50
    v_rcp_f32 v51, v51
    v_rcp_f32 v52, v52
    v_rcp_f32 v53, v53
    v_rcp_f32 v54, v54
    v_rcp_f32 v55, v55
    v_fma_f32 v48, v48, -2.0, 1.0
    v_fma_f32 v49, v49, -2.0, 1.0
    v_fma_f32 v50, v50, -2.0, 1.0
    v_fma_f32 v51, v51, -2.0, 1.0
    v_fma_f32 v52, v52, -2.0, 1.0
    v_fma_f32 v53, v53, -2.0, 1.0
    v_fma_f32 v54, v54, -2.0, 1.0
    v_fma_f32 v55, v55, -2.0, 1.0
    v_cvt_pk_bf16_f32 v64, v48, v49
    v_cvt_pk_bf16_f32 v65, v50, v51
    v_cvt_pk_bf16_f32 v66, v52, v53
    v_cvt_pk_bf16_f32 v67, v54, v55
    ds_write_b128 v123, v[64:67] offset:16384
    v_exp_f32 v56, v56
    v_exp_f32 v57, v57
    v_exp_f32 v58, v58
    v_exp_f32 v59, v59
    v_exp_f32 v60, v60
    v_exp_f32 v61, v61
    v_exp_f32 v62, v62
    v_exp_f32 v63, v63
    v_add_f32 v56, 1.0, v56
    v_add_f32 v57, 1.0, v57
    v_add_f32 v58, 1.0, v58
    v_add_f32 v59, 1.0, v59
    v_add_f32 v60, 1.0, v60
    v_add_f32 v61, 1.0, v61
    v_add_f32 v62, 1.0, v62
    v_add_f32 v63, 1.0, v63
    v_rcp_f32 v56, v56
    v_rcp_f32 v57, v57
    v_rcp_f32 v58, v58
    v_rcp_f32 v59, v59
    v_rcp_f32 v60, v60
    v_rcp_f32 v61, v61
    v_rcp_f32 v62, v62
    v_rcp_f32 v63, v63
    v_fma_f32 v56, v56, -2.0, 1.0
    v_fma_f32 v57, v57, -2.0, 1.0
    v_fma_f32 v58, v58, -2.0, 1.0
    v_fma_f32 v59, v59, -2.0, 1.0
    v_fma_f32 v60, v60, -2.0, 1.0
    v_fma_f32 v61, v61, -2.0, 1.0
    v_fma_f32 v62, v62, -2.0, 1.0
    v_fma_f32 v63, v63, -2.0, 1.0
    v_cvt_pk_bf16_f32 v68, v56, v57
    v_cvt_pk_bf16_f32 v69, v58, v59
    v_cvt_pk_bf16_f32 v70, v60, v61
    v_cvt_pk_bf16_f32 v71, v62, v63
    ds_write_b128 v123, v[68:71] offset:17408
    s_waitcnt lgkmcnt(0)
    s_barrier
    s_sub_u32 s22, s22, 1
    s_cmp_lg_u32 s22, 0
    s_cbranch_scc1 L_joint_kernel_tloop0
L_joint_kernel_fin:
L_joint_kernel_done:
    s_endpgm
.section .rodata,"a"
.p2align 6
.amdhsa_kernel prep_kernel
  .amdhsa_next_free_vgpr 128
  .amdhsa_next_free_sgpr 102
  .amdhsa_accum_offset 128
  .amdhsa_group_segment_fixed_size 0
  .amdhsa_kernarg_size 80
  .amdhsa_user_sgpr_count 2
  .amdhsa_user_sgpr_kernarg_segment_ptr 1
  .amdhsa_system_sgpr_workgroup_id_x 1
.end_amdhsa_kernel
.p2align 6
.amdhsa_kernel conv1_kernel
  .amdhsa_next_free_vgpr 128
  .amdhsa_next_free_sgpr 102
  .amdhsa_accum_offset 128
  .amdhsa_group_segment_fixed_size 0
  .amdhsa_kernarg_size 80
  .amdhsa_user_sgpr_count 2
  .amdhsa_user_sgpr_kernarg_segment_ptr 1
  .amdhsa_system_sgpr_workgroup_id_x 1
.end_amdhsa_kernel
.p2align 6
.amdhsa_kernel conv2_kernel
  .amdhsa_next_free_vgpr 128
  .amdhsa_next_free_sgpr 102
  .amdhsa_accum_offset 128
  .amdhsa_group_segment_fixed_size 0
  .amdhsa_kernarg_size 80
  .amdhsa_user_sgpr_count 2
  .amdhsa_user_sgpr_kernarg_segment_ptr 1
  .amdhsa_system_sgpr_workgroup_id_x 1
.end_amdhsa_kernel
.p2align 6
.amdhsa_kernel joint_kernel
  .amdhsa_next_free_vgpr 128
  .amdhsa_next_free_sgpr 102
  .amdhsa_accum_offset 128
  .amdhsa_group_segment_fixed_size 0
  .amdhsa_kernarg_size 80
  .amdhsa_user_sgpr_count 2
  .amdhsa_user_sgpr_kernarg_segment_ptr 1
  .amdhsa_system_sgpr_workgroup_id_x 1
.end_amdhsa_kernel
```

```asm
; @launch kernel=prep_kernel grid=(256,1,1) block=(384,1,1) lds=4096
; @launch kernel=conv1_kernel grid=(256,1,1) block=(1024,1,1) lds=162816
; @launch kernel=conv2_kernel grid=(256,1,1) block=(1024,1,1) lds=162816
; @launch kernel=joint_kernel grid=(250,1,1) block=(1024,1,1) lds=99472
.amdgcn_target "amdgcn-amd-amdhsa--gfx950"
.text
.globl prep_kernel
.p2align 8
.type prep_kernel,@function
prep_kernel:
    s_cmp_ge_u32 s2, 256
    s_cbranch_scc1 L_prep_kernel_done
    s_mov_b32 s3, s2
    s_load_dwordx16 s[44:59], s[0:1], 0
    s_load_dwordx2 s[30:31], s[0:1], 72
    v_readfirstlane_b32 s40, v0
    s_lshr_b32 s40, s40, 6
    v_and_b32 v1, 63, v0
    s_cmp_lt_u32 s40, 4
    s_cbranch_scc1 L_prep_kernel_w
    s_cmp_ge_u32 s2, 24
    s_cbranch_scc1 L_prep_kernel_done
    s_lshr_b32 s41, s2, 3
    s_and_b32 s42, s2, 7
    s_sub_u32 s43, s40, 4
    s_lshl_b32 s26, s43, 16
    s_lshl_b32 s5, s42, 6
    s_add_u32 s26, s26, s5
    s_mov_b32 s10, 131072
    s_mov_b32 s11, 0x00020000
    v_lshrrev_b32 v2, 4, v1
    v_lshlrev_b32 v2, 12, v2
    v_and_b32 v3, 15, v1
    v_lshl_add_u32 v2, v3, 2, v2
    v_mov_b32 v9, 0
    ds_write_b32 v9, v9 offset:2048
    s_waitcnt lgkmcnt(0)
    s_cmp_eq_u32 s41, 1
    s_cselect_b32 s8, s56, s52
    s_cselect_b32 s9, s57, s53
    s_cmp_eq_u32 s41, 2
    s_cselect_b32 s8, s54, s8
    s_cselect_b32 s9, s55, s9
    s_barrier
    s_cmp_lg_u32 s41, 2
    s_cbranch_scc1 L_prep_kernel_nog
    s_mov_b32 s16, s50
    s_mov_b32 s17, s51
    s_mov_b32 s18, 8192
    s_mov_b32 s19, 0x00020000
    v_and_b32 v6, 0x30, v1
    v_lshl_add_u32 v6, v3, 9, v6
    s_lshl_b32 s6, s43, 8
    buffer_load_dwordx4 v[80:83], v6, s[16:19], s6 offen offset:0
    buffer_load_dwordx4 v[84:87], v6, s[16:19], s6 offen offset:64
    buffer_load_dwordx4 v[88:91], v6, s[16:19], s6 offen offset:128
    buffer_load_dwordx4 v[92:95], v6, s[16:19], s6 offen offset:192
L_prep_kernel_nog:
    buffer_load_dword v16, v2, s[8:11], s26 offen offset:0
    buffer_load_dword v17, v2, s[8:11], s26 offen offset:512
    buffer_load_dword v18, v2, s[8:11], s26 offen offset:1024
    buffer_load_dword v19, v2, s[8:11], s26 offen offset:1536
    buffer_load_dword v20, v2, s[8:11], s26 offen offset:2048
    buffer_load_dword v21, v2, s[8:11], s26 offen offset:2560
    buffer_load_dword v22, v2, s[8:11], s26 offen offset:3072
    buffer_load_dword v23, v2, s[8:11], s26 offen offset:3584
    s_add_u32 s26, s26, 16384
    buffer_load_dword v24, v2, s[8:11], s26 offen offset:0
    buffer_load_dword v25, v2, s[8:11], s26 offen offset:512
    buffer_load_dword v26, v2, s[8:11], s26 offen offset:1024
    buffer_load_dword v27, v2, s[8:11], s26 offen offset:1536
    buffer_load_dword v28, v2, s[8:11], s26 offen offset:2048
    buffer_load_dword v29, v2, s[8:11], s26 offen offset:2560
    buffer_load_dword v30, v2, s[8:11], s26 offen offset:3072
    buffer_load_dword v31, v2, s[8:11], s26 offen offset:3584
    s_add_u32 s26, s26, 16384
    buffer_load_dword v32, v2, s[8:11], s26 offen offset:0
    buffer_load_dword v33, v2, s[8:11], s26 offen offset:512
    buffer_load_dword v34, v2, s[8:11], s26 offen offset:1024
    buffer_load_dword v35, v2, s[8:11], s26 offen offset:1536
    buffer_load_dword v36, v2, s[8:11], s26 offen offset:2048
    buffer_load_dword v37, v2, s[8:11], s26 offen offset:2560
    buffer_load_dword v38, v2, s[8:11], s26 offen offset:3072
    buffer_load_dword v39, v2, s[8:11], s26 offen offset:3584
    s_add_u32 s26, s26, 16384
    buffer_load_dword v40, v2, s[8:11], s26 offen offset:0
    buffer_load_dword v41, v2, s[8:11], s26 offen offset:512
    buffer_load_dword v42, v2, s[8:11], s26 offen offset:1024
    buffer_load_dword v43, v2, s[8:11], s26 offen offset:1536
    buffer_load_dword v44, v2, s[8:11], s26 offen offset:2048
    buffer_load_dword v45, v2, s[8:11], s26 offen offset:2560
    buffer_load_dword v46, v2, s[8:11], s26 offen offset:3072
    buffer_load_dword v47, v2, s[8:11], s26 offen offset:3584
    s_branch L_prep_kernel_small
L_prep_kernel_w:
    s_lshl_b32 s21, s2, 2
    s_add_u32 s20, s40, s21
    s_load_dwordx2 s[8:9], s[0:1], 8
    s_lshr_b32 s22, s20, 8
    s_bfe_u32 s23, s20, 0x40004
    s_bfe_u32 s24, s20, 0x30001
    s_and_b32 s21, s20, 1
    v_lshrrev_b32 v5, 4, v1
    v_lshlrev_b32 v2, 11, v5
    v_and_b32 v3, 15, v1
    v_lshl_add_u32 v2, v3, 2, v2
    s_lshl_b32 s26, s22, 3
    s_lshr_b32 s27, s23, 3
    s_add_u32 s26, s26, s27
    s_lshl_b32 s26, s26, 17
    s_and_b32 s27, s23, 7
    s_lshl_b32 s27, s27, 1
    s_add_u32 s27, s27, s21
    s_lshl_b32 s27, s27, 13
    s_add_u32 s26, s26, s27
    s_lshl_b32 s27, s24, 6
    s_add_u32 s26, s26, s27
    s_mov_b32 s10, 4063232
    s_mov_b32 s11, 0x00020000
    s_add_u32 s37, s26, 262144
    s_add_u32 s38, s26, 524288
    s_add_u32 s39, s26, 786432
    s_mov_b32 s14, 7340032
    s_mov_b32 s15, 0x00020000
    v_lshrrev_b32 v4, 1, v5
    v_lshlrev_b32 v4, 8, v4
    v_lshl_add_u32 v4, v3, 4, v4
    v_and_b32 v5, 1, v5
    v_lshl_add_u32 v4, v5, 10, v4
    s_lshl_b32 s27, s24, 4
    s_add_u32 s27, s27, s23
    s_mul_i32 s27, s27, 57344
    s_lshl_b32 s28, s22, 11
    s_add_u32 s27, s27, s28
    s_lshl_b32 s28, s21, 9
    s_add_u32 s27, s27, s28
    s_mov_b32 s32, 0x05040100
    s_mov_b32 s33, 0x07060302
    s_mov_b32 s34, 0xffff0000
    s_mov_b32 s35, 0x3d2aaaab
    s_mov_b32 s40, 0x3c638e39
    s_waitcnt lgkmcnt(0)
    buffer_load_dword v16, v2, s[8:11], s26 offen offset:0
    buffer_load_dword v17, v2, s[8:11], s26 offen offset:512
    buffer_load_dword v20, v2, s[8:11], s37 offen offset:0
    buffer_load_dword v21, v2, s[8:11], s37 offen offset:512
    buffer_load_dword v24, v2, s[8:11], s38 offen offset:0
    buffer_load_dword v25, v2, s[8:11], s38 offen offset:512
    buffer_load_dword v28, v2, s[8:11], s39 offen offset:0
    buffer_load_dword v29, v2, s[8:11], s39 offen offset:512
    buffer_load_dword v18, v2, s[8:11], s26 offen offset:1024
    buffer_load_dword v19, v2, s[8:11], s26 offen offset:1536
    buffer_load_dword v22, v2, s[8:11], s37 offen offset:1024
    buffer_load_dword v23, v2, s[8:11], s37 offen offset:1536
    buffer_load_dword v26, v2, s[8:11], s38 offen offset:1024
    buffer_load_dword v27, v2, s[8:11], s38 offen offset:1536
    buffer_load_dword v30, v2, s[8:11], s39 offen offset:1024
    buffer_load_dword v31, v2, s[8:11], s39 offen offset:1536
    s_barrier
    s_add_u32 s12, s30, 0
    s_addc_u32 s13, s31, 0
    s_waitcnt vmcnt(8)
    v_perm_b32 v100, v17, v16, s32
    v_perm_b32 v76, v29, v28, s32
    v_lshlrev_b32 v104, 16, v28
    v_lshlrev_b32 v112, 16, v29
    v_lshlrev_b32 v105, 16, v24
    v_lshlrev_b32 v113, 16, v25
    v_lshlrev_b32 v106, 16, v20
    v_lshlrev_b32 v114, 16, v21
    v_lshlrev_b32 v107, 16, v16
    v_lshlrev_b32 v115, 16, v17
    v_add_f32 v108, v104, v106
    v_add_f32 v116, v112, v114
    v_add_f32 v109, v105, v107
    v_add_f32 v117, v113, v115
    v_fma_f32 v110, v106, 4.0, v104
    v_fma_f32 v118, v114, 4.0, v112
    v_fma_f32 v111, v107, 4.0, v105
    v_fma_f32 v119, v115, 4.0, v113
    v_add_f32 v105, v108, v109
    v_add_f32 v113, v116, v117
    v_sub_f32 v106, v108, v109
    v_sub_f32 v114, v116, v117
    v_fma_f32 v107, v111, 2.0, v110
    v_fma_f32 v115, v119, 2.0, v118
    v_fma_f32 v110, v111, -2.0, v110
    v_fma_f32 v118, v119, -2.0, v118
    v_fmamk_f32 v108, v104, 0x41700000, v110
    v_fmamk_f32 v116, v112, 0x41700000, v118
    v_fmamk_f32 v108, v109, 0x41200000, v108
    v_fmamk_f32 v116, v117, 0x41200000, v116
    v_mul_f32 v105, 0.5, v105
    v_mul_f32 v113, 0.5, v113
    v_mul_f32 v106, 0.5, v106
    v_mul_f32 v114, 0.5, v114
    v_mul_f32 v107, s35, v107
    v_mul_f32 v115, s35, v115
    v_mul_f32 v110, s35, v110
    v_mul_f32 v118, s35, v118
    v_mul_f32 v108, s40, v108
    v_mul_f32 v116, s40, v116
    v_cvt_pk_bf16_f32 v80, v105, v113
    v_cvt_pk_bf16_f32 v84, v106, v114
    v_cvt_pk_bf16_f32 v88, v107, v115
    v_cvt_pk_bf16_f32 v92, v110, v118
    v_cvt_pk_bf16_f32 v96, v108, v116
    v_perm_b32 v102, v17, v16, s33
    v_perm_b32 v78, v29, v28, s33
    v_and_b32 v104, s34, v28
    v_and_b32 v112, s34, v29
    v_and_b32 v105, s34, v24
    v_and_b32 v113, s34, v25
    v_and_b32 v106, s34, v20
    v_and_b32 v114, s34, v21
    v_and_b32 v107, s34, v16
    v_and_b32 v115, s34, v17
    v_add_f32 v108, v104, v106
    v_add_f32 v116, v112, v114
    v_add_f32 v109, v105, v107
    v_add_f32 v117, v113, v115
    v_fma_f32 v110, v106, 4.0, v104
    v_fma_f32 v118, v114, 4.0, v112
    v_fma_f32 v111, v107, 4.0, v105
    v_fma_f32 v119, v115, 4.0, v113
    v_add_f32 v105, v108, v109
    v_add_f32 v113, v116, v117
    v_sub_f32 v106, v108, v109
    v_sub_f32 v114, v116, v117
    v_fma_f32 v107, v111, 2.0, v110
    v_fma_f32 v115, v119, 2.0, v118
    v_fma_f32 v110, v111, -2.0, v110
    v_fma_f32 v118, v119, -2.0, v118
    v_fmamk_f32 v108, v104, 0x41700000, v110
    v_fmamk_f32 v116, v112, 0x41700000, v118
    v_fmamk_f32 v108, v109, 0x41200000, v108
    v_fmamk_f32 v116, v117, 0x41200000, v116
    v_mul_f32 v105, 0.5, v105
    v_mul_f32 v113, 0.5, v113
    v_mul_f32 v106, 0.5, v106
    v_mul_f32 v114, 0.5, v114
    v_mul_f32 v107, s35, v107
    v_mul_f32 v115, s35, v115
    v_mul_f32 v110, s35, v110
    v_mul_f32 v118, s35, v118
    v_mul_f32 v108, s40, v108
    v_mul_f32 v116, s40, v116
    v_cvt_pk_bf16_f32 v82, v105, v113
    v_cvt_pk_bf16_f32 v86, v106, v114
    v_cvt_pk_bf16_f32 v90, v107, v115
    v_cvt_pk_bf16_f32 v94, v110, v118
    v_cvt_pk_bf16_f32 v98, v108, v116
    s_waitcnt vmcnt(0)
    s_cmp_lt_u32 s3, 224
    s_cbranch_scc1 L_prep_kernel_ncw
    s_getpc_b64 s[62:63]
L_prep_kernel_pc:
    s_and_b32 s64, s3, 8
    s_lshl_b32 s64, s64, 12
    v_lshlrev_b32 v120, 7, v0
    v_add_u32 v120, s64, v120
    v_min_u32 v120, L_joint_kernel_done-L_prep_kernel_pc, v120
    v_mov_b32 v121, s63
    v_add_co_u32 v120, vcc, s62, v120
    s_nop 1
    v_addc_co_u32 v121, vcc, 0, v121, vcc
    global_load_dword v122, v[120:121], off
L_prep_kernel_ncw:
    v_perm_b32 v101, v19, v18, s32
    v_perm_b32 v77, v31, v30, s32
    v_lshlrev_b32 v104, 16, v30
    v_lshlrev_b32 v112, 16, v31
    v_lshlrev_b32 v105, 16, v26
    v_lshlrev_b32 v113, 16, v27
    v_lshlrev_b32 v106, 16, v22
    v_lshlrev_b32 v114, 16, v23
    v_lshlrev_b32 v107, 16, v18
    v_lshlrev_b32 v115, 16, v19
    v_add_f32 v108, v104, v106
    v_add_f32 v116, v112, v114
    v_add_f32 v109, v105, v107
    v_add_f32 v117, v113, v115
    v_fma_f32 v110, v106, 4.0, v104
    v_fma_f32 v118, v114, 4.0, v112
    v_fma_f32 v111, v107, 4.0, v105
    v_fma_f32 v119, v115, 4.0, v113
    v_add_f32 v105, v108, v109
    v_add_f32 v113, v116, v117
    v_sub_f32 v106, v108, v109
    v_sub_f32 v114, v116, v117
    v_fma_f32 v107, v111, 2.0, v110
    v_fma_f32 v115, v119, 2.0, v118
    v_fma_f32 v110, v111, -2.0, v110
    v_fma_f32 v118, v119, -2.0, v118
    v_fmamk_f32 v108, v104, 0x41700000, v110
    v_fmamk_f32 v116, v112, 0x41700000, v118
    v_fmamk_f32 v108, v109, 0x41200000, v108
    v_fmamk_f32 v116, v117, 0x41200000, v116
    v_mul_f32 v105, 0.5, v105
    v_mul_f32 v113, 0.5, v113
    v_mul_f32 v106, 0.5, v106
    v_mul_f32 v114, 0.5, v114
    v_mul_f32 v107, s35, v107
    v_mul_f32 v115, s35, v115
    v_mul_f32 v110, s35, v110
    v_mul_f32 v118, s35, v118
    v_mul_f32 v108, s40, v108
    v_mul_f32 v116, s40, v116
    v_cvt_pk_bf16_f32 v81, v105, v113
    v_cvt_pk_bf16_f32 v85, v106, v114
    v_cvt_pk_bf16_f32 v89, v107, v115
    v_cvt_pk_bf16_f32 v93, v110, v118
    v_cvt_pk_bf16_f32 v97, v108, v116
    v_perm_b32 v103, v19, v18, s33
    v_perm_b32 v79, v31, v30, s33
    v_and_b32 v104, s34, v30
    v_and_b32 v112, s34, v31
    v_and_b32 v105, s34, v26
    v_and_b32 v113, s34, v27
    v_and_b32 v106, s34, v22
    v_and_b32 v114, s34, v23
    v_and_b32 v107, s34, v18
    v_and_b32 v115, s34, v19
    v_add_f32 v108, v104, v106
    v_add_f32 v116, v112, v114
    v_add_f32 v109, v105, v107
    v_add_f32 v117, v113, v115
    v_fma_f32 v110, v106, 4.0, v104
    v_fma_f32 v118, v114, 4.0, v112
    v_fma_f32 v111, v107, 4.0, v105
    v_fma_f32 v119, v115, 4.0, v113
    v_add_f32 v105, v108, v109
    v_add_f32 v113, v116, v117
    v_sub_f32 v106, v108, v109
    v_sub_f32 v114, v116, v117
    v_fma_f32 v107, v111, 2.0, v110
    v_fma_f32 v115, v119, 2.0, v118
    v_fma_f32 v110, v111, -2.0, v110
    v_fma_f32 v118, v119, -2.0, v118
    v_fmamk_f32 v108, v104, 0x41700000, v110
    v_fmamk_f32 v116, v112, 0x41700000, v118
    v_fmamk_f32 v108, v109, 0x41200000, v108
    v_fmamk_f32 v116, v117, 0x41200000, v116
    v_mul_f32 v105, 0.5, v105
    v_mul_f32 v113, 0.5, v113
    v_mul_f32 v106, 0.5, v106
    v_mul_f32 v114, 0.5, v114
    v_mul_f32 v107, s35, v107
    v_mul_f32 v115, s35, v115
    v_mul_f32 v110, s35, v110
    v_mul_f32 v118, s35, v118
    v_mul_f32 v108, s40, v108
    v_mul_f32 v116, s40, v116
    v_cvt_pk_bf16_f32 v83, v105, v113
    v_cvt_pk_bf16_f32 v87, v106, v114
    v_cvt_pk_bf16_f32 v91, v107, v115
    v_cvt_pk_bf16_f32 v95, v110, v118
    v_cvt_pk_bf16_f32 v99, v108, v116
    v_permlane16_swap_b32 v100, v102
    v_permlane16_swap_b32 v101, v103
    s_add_u32 s28, s27, 49152
    buffer_store_dwordx4 v[100:103], v4, s[12:15], s28 offen sc1
    v_permlane16_swap_b32 v76, v78
    v_permlane16_swap_b32 v77, v79
    s_add_u32 s28, s27, 0
    buffer_store_dwordx4 v[76:79], v4, s[12:15], s28 offen sc1
    v_permlane16_swap_b32 v80, v82
    v_permlane16_swap_b32 v81, v83
    s_add_u32 s28, s27, 8192
    buffer_store_dwordx4 v[80:83], v4, s[12:15], s28 offen sc1
    v_permlane16_swap_b32 v84, v86
    v_permlane16_swap_b32 v85, v87
    s_add_u32 s28, s27, 16384
    buffer_store_dwordx4 v[84:87], v4, s[12:15], s28 offen sc1
    v_permlane16_swap_b32 v88, v90
    v_permlane16_swap_b32 v89, v91
    s_add_u32 s28, s27, 24576
    buffer_store_dwordx4 v[88:91], v4, s[12:15], s28 offen sc1
    v_permlane16_swap_b32 v92, v94
    v_permlane16_swap_b32 v93, v95
    s_add_u32 s28, s27, 32768
    buffer_store_dwordx4 v[92:95], v4, s[12:15], s28 offen sc1
    v_permlane16_swap_b32 v96, v98
    v_permlane16_swap_b32 v97, v99
    s_add_u32 s28, s27, 40960
    buffer_store_dwordx4 v[96:99], v4, s[12:15], s28 offen sc1
L_prep_kernel_done:
    s_endpgm
L_prep_kernel_small:
    v_lshrrev_b32 v2, 4, v1
    s_lshl_b32 s24, s41, 17
    s_add_u32 s24, s24, 44040192
    s_add_u32 s12, s30, s24
    s_addc_u32 s13, s31, 0
    s_mov_b32 s14, 131072
    s_mov_b32 s15, 0x00020000
    s_mov_b32 s32, 0x05040100
    s_mov_b32 s33, 0x07060302
    v_lshlrev_b32 v4, 4, v1
    s_lshl_b32 s24, s42, 14
    s_lshl_b32 s25, s43, 13
    s_add_u32 s24, s24, s25
    s_add_u32 s25, s24, 4096
    s_waitcnt vmcnt(0)
    v_perm_b32 v48, v17, v16, s32
    v_perm_b32 v49, v19, v18, s32
    v_perm_b32 v50, v21, v20, s32
    v_perm_b32 v51, v23, v22, s32
    v_perm_b32 v52, v17, v16, s33
    v_perm_b32 v53, v19, v18, s33
    v_perm_b32 v54, v21, v20, s33
    v_perm_b32 v55, v23, v22, s33
    v_perm_b32 v56, v25, v24, s32
    v_perm_b32 v57, v27, v26, s32
    v_perm_b32 v58, v29, v28, s32
    v_perm_b32 v59, v31, v30, s32
    v_perm_b32 v60, v25, v24, s33
    v_perm_b32 v61, v27, v26, s33
    v_perm_b32 v62, v29, v28, s33
    v_perm_b32 v63, v31, v30, s33
    v_perm_b32 v64, v33, v32, s32
    v_perm_b32 v65, v35, v34, s32
    v_perm_b32 v66, v37, v36, s32
    v_perm_b32 v67, v39, v38, s32
    v_perm_b32 v68, v33, v32, s33
    v_perm_b32 v69, v35, v34, s33
    v_perm_b32 v70, v37, v36, s33
    v_perm_b32 v71, v39, v38, s33
    v_perm_b32 v72, v41, v40, s32
    v_perm_b32 v73, v43, v42, s32
    v_perm_b32 v74, v45, v44, s32
    v_perm_b32 v75, v47, v46, s32
    v_perm_b32 v76, v41, v40, s33
    v_perm_b32 v77, v43, v42, s33
    v_perm_b32 v78, v45, v44, s33
    v_perm_b32 v79, v47, v46, s33
    s_cmp_eq_u32 s41, 2
    s_cbranch_scc1 L_prep_kernel_ge
    buffer_store_dwordx4 v[48:51], v4, s[12:15], s24 offen offset:0 sc1
    buffer_store_dwordx4 v[52:55], v4, s[12:15], s24 offen offset:1024 sc1
    buffer_store_dwordx4 v[56:59], v4, s[12:15], s24 offen offset:2048 sc1
    buffer_store_dwordx4 v[60:63], v4, s[12:15], s24 offen offset:3072 sc1
    buffer_store_dwordx4 v[64:67], v4, s[12:15], s25 offen offset:0 sc1
    buffer_store_dwordx4 v[68:71], v4, s[12:15], s25 offen offset:1024 sc1
    buffer_store_dwordx4 v[72:75], v4, s[12:15], s25 offen offset:2048 sc1
    buffer_store_dwordx4 v[76:79], v4, s[12:15], s25 offen offset:3072 sc1
    s_endpgm
L_prep_kernel_ge:
    v_mfma_f32_16x16x32_bf16 v[96:99], v[48:51], v[80:83], 0
    v_mfma_f32_16x16x32_bf16 v[100:103], v[52:55], v[80:83], 0
    v_mfma_f32_16x16x32_bf16 v[96:99], v[56:59], v[84:87], v[96:99]
    v_mfma_f32_16x16x32_bf16 v[100:103], v[60:63], v[84:87], v[100:103]
    v_mfma_f32_16x16x32_bf16 v[96:99], v[64:67], v[88:91], v[96:99]
    v_mfma_f32_16x16x32_bf16 v[100:103], v[68:71], v[88:91], v[100:103]
    v_mfma_f32_16x16x32_bf16 v[96:99], v[72:75], v[92:95], v[96:99]
    v_mfma_f32_16x16x32_bf16 v[100:103], v[76:79], v[92:95], v[100:103]
    v_mov_b32 v7, v4
    v_mov_b32 v10, 1
    s_nop 0
    s_mov_b32 s14, 16384
    v_lshlrev_b32 v8, 10, v3
    v_lshl_add_u32 v8, v2, 5, v8
    s_lshl_b32 s24, s42, 7
    s_mov_b32 s34, 0xffff0000
    s_mov_b32 s35, 0x4038aa3b
    s_cmp_eq_u32 s43, 0
    s_cbranch_scc1 L_prep_kernel_ge0
    ds_write_b128 v7, v[96:99]
    ds_write_b128 v7, v[100:103] offset:1024
    ds_write_b32 v9, v10 offset:2048
    s_endpgm
L_prep_kernel_ge0:
    ds_read_b32 v10, v9 offset:2048
    s_waitcnt lgkmcnt(0)
    v_readfirstlane_b32 s27, v10
    s_cmp_eq_u32 s27, 0
    s_cbranch_scc1 L_prep_kernel_ge0
    ds_read_b128 v[16:19], v7
    ds_read_b128 v[20:23], v7 offset:1024
    s_waitcnt lgkmcnt(0)
    v_add_f32 v16, v16, v96
    v_add_f32 v17, v17, v97
    v_add_f32 v18, v18, v98
    v_add_f32 v19, v19, v99
    v_add_f32 v20, v20, v100
    v_add_f32 v21, v21, v101
    v_add_f32 v22, v22, v102
    v_add_f32 v23, v23, v103
    v_cvt_pk_bf16_f32 v48, v16, v20
    v_cvt_pk_bf16_f32 v49, v17, v21
    v_cvt_pk_bf16_f32 v50, v18, v22
    v_cvt_pk_bf16_f32 v51, v19, v23
    v_lshlrev_b32 v56, 16, v48
    v_and_b32 v57, s34, v48
    v_lshlrev_b32 v58, 16, v49
    v_and_b32 v59, s34, v49
    v_lshlrev_b32 v60, 16, v50
    v_and_b32 v61, s34, v50
    v_lshlrev_b32 v62, 16, v51
    v_and_b32 v63, s34, v51
    v_mul_f32 v56, s35, v56
    v_mul_f32 v57, s35, v57
    v_mul_f32 v58, s35, v58
    v_mul_f32 v59, s35, v59
    v_mul_f32 v60, s35, v60
    v_mul_f32 v61, s35, v61
    v_mul_f32 v62, s35, v62
    v_mul_f32 v63, s35, v63
    buffer_store_dwordx4 v[56:59], v8, s[12:15], s24 offen sc1
    buffer_store_dwordx4 v[60:63], v8, s[12:15], s24 offen offset:16 sc1
    v_exp_f32 v64, v56
    v_exp_f32 v65, v57
    v_exp_f32 v66, v58
    v_exp_f32 v67, v59
    v_exp_f32 v68, v60
    v_exp_f32 v69, v61
    v_exp_f32 v70, v62
    v_exp_f32 v71, v63
    v_max3_f32 v72, |v56|, |v57|, |v58|
    v_max3_f32 v72, |v59|, |v60|, v72
    v_max3_f32 v72, |v61|, |v62|, v72
    v_max_f32 v72, |v63|, v72
    s_add_u32 s12, s12, 16384
    s_addc_u32 s13, s13, 0
    v_cmp_lt_f32 vcc, 0x42f00000, v72
    buffer_store_dwordx4 v[64:67], v8, s[12:15], s24 offen sc1
    buffer_store_dwordx4 v[68:71], v8, s[12:15], s24 offen offset:16 sc1
    s_add_u32 s12, s12, 16384
    s_addc_u32 s13, s13, 0
    s_or_b32 s26, vcc_lo, vcc_hi
    s_lshl_b32 s24, s42, 2
    v_mov_b32 v73, s26
    v_mov_b32 v74, 0
    buffer_store_dword v73, v74, s[12:15], s24 offen sc1
L_prep_kernel_last:
    s_endpgm
.globl conv1_kernel
.p2align 8
.type conv1_kernel,@function
conv1_kernel:
    s_cmp_ge_u32 s2, 256
    s_cbranch_scc1 L_conv1_kernel_done
    s_load_dwordx2 s[4:5], s[0:1], 0
    s_load_dwordx2 s[30:31], s[0:1], 72
    v_readfirstlane_b32 s20, v0
    s_lshr_b32 s20, s20, 6
    s_xor_b32 s20, s20, 8
    s_and_b32 s36, s2, 0
    s_lshl_b32 s36, s36, 3
    s_bfe_u32 s37, s2, 196611
    s_or_b32 s29, s36, s37
    s_bfe_u32 s36, s2, 196608
    s_lshl_b32 s36, s36, 2
    s_lshr_b32 s37, s2, 6
    s_or_b32 s36, s36, s37
    s_mov_b32 s33, 0
    s_and_b32 s34, s36, 15
    s_lshr_b32 s35, s36, 4
    s_mul_i32 s21, s34, 500
    s_and_b32 s32, s20, 3
    v_and_b32 v127, 63, v0
    v_lshrrev_b32 v5, 2, v127
    v_and_b32 v6, 3, v127
    s_and_b32 s42, s20, 7
    v_lshlrev_b32 v7, 15, v5
    v_lshl_add_u32 v7, v6, 4, v7
    s_lshl_b32 s41, s21, 10
    s_sub_u32 s41, s41, 7680
    s_lshl_b32 s37, s42, 12
    s_add_u32 s37, s37, s41
    v_add_u32 v7, s37, v7
    s_mul_i32 s36, s35, 8192000
    s_mov_b32 s10, 8192000
    s_mov_b32 s11, 0x00020000
    s_mov_b32 s25, 0xffff0000
    s_mov_b32 s47, s36
    s_cmp_ge_u32 s20, 8
    s_cbranch_scc0 L_conv1_kernel_mw
L_conv1_kernel_helper:
    s_setprio 3
    v_add_u32 v92, 0, v7
    v_add_u32 v93, 1024, v7
    v_add_u32 v94, 2048, v7
    v_add_u32 v95, 3072, v7
    v_and_b32 v76, 4, v5
    v_lshrrev_b32 v76, 1, v76
    v_xor_b32 v76, v6, v76
    v_lshlrev_b32 v76, 4, v76
    v_lshl_add_u32 v76, v5, 6, v76
    s_mov_b32 s24, 0
    s_mov_b32 s27, 524288
    s_waitcnt lgkmcnt(0)
    s_add_u32 s8, s4, s47
    s_addc_u32 s9, s5, 0
    buffer_load_dwordx4 v[0:3], v92, s[8:11], s24 offen offset:0
    buffer_load_dwordx4 v[16:19], v92, s[8:11], s24 offen offset:64
    v_add_u32 v92, 128, v92
    buffer_load_dwordx4 v[4:7], v93, s[8:11], s24 offen offset:0
    buffer_load_dwordx4 v[20:23], v93, s[8:11], s24 offen offset:64
    v_add_u32 v93, 128, v93
    buffer_load_dwordx4 v[8:11], v94, s[8:11], s24 offen offset:0
    buffer_load_dwordx4 v[24:27], v94, s[8:11], s24 offen offset:64
    v_add_u32 v94, 128, v94
    buffer_load_dwordx4 v[12:15], v95, s[8:11], s24 offen offset:0
    buffer_load_dwordx4 v[28:31], v95, s[8:11], s24 offen offset:64
    v_add_u32 v95, 128, v95
    s_mul_i32 s36, s42, 1024
    v_add_u32 v96, s36, v76
    v_add_u32 v97, 65536, v96
    s_mul_i32 s36, s42, 1088
    s_add_u32 s36, s36, 98304
    v_add_u32 v98, s36, v76
    s_waitcnt vmcnt(0)
    s_mov_b32 s28, 0
    s_mov_b32 s22, 4
    ds_write_b128 v96, v[0:3] offset:0
    ds_write_b128 v98, v[12:15] offset:0
    v_lshlrev_b32 v76, 16, v0
    v_and_b32 v84, s25, v0
    v_lshlrev_b32 v77, 16, v4
    v_and_b32 v85, s25, v4
    v_lshlrev_b32 v78, 16, v8
    v_and_b32 v86, s25, v8
    v_lshlrev_b32 v79, 16, v12
    v_and_b32 v87, s25, v12
    v_add_f32 v80, v76, v78
    v_add_f32 v88, v84, v86
    v_add_f32 v81, v77, v79
    v_add_f32 v89, v85, v87
    v_fma_f32 v82, v78, 4.0, v76
    v_fma_f32 v90, v86, 4.0, v84
    v_fma_f32 v83, v79, 4.0, v77
    v_fma_f32 v91, v87, 4.0, v85
    v_add_f32 v77, v80, v81
    v_add_f32 v85, v88, v89
    v_sub_f32 v78, v80, v81
    v_sub_f32 v86, v88, v89
    v_fma_f32 v79, v83, 2.0, v82
    v_fma_f32 v87, v91, 2.0, v90
    v_fma_f32 v82, v83, -2.0, v82
    v_fma_f32 v90, v91, -2.0, v90
    v_fmamk_f32 v80, v76, 0x41700000, v82
    v_fmamk_f32 v88, v84, 0x41700000, v90
    v_fmamk_f32 v80, v81, 0x41200000, v80
    v_fmamk_f32 v88, v89, 0x41200000, v88
    v_cvt_pk_bf16_f32 v4, v77, v85
    v_cvt_pk_bf16_f32 v8, v78, v86
    v_cvt_pk_bf16_f32 v64, v79, v87
    v_cvt_pk_bf16_f32 v68, v82, v90
    v_cvt_pk_bf16_f32 v72, v80, v88
    v_lshlrev_b32 v76, 16, v1
    v_and_b32 v84, s25, v1
    v_lshlrev_b32 v77, 16, v5
    v_and_b32 v85, s25, v5
    v_lshlrev_b32 v78, 16, v9
    v_and_b32 v86, s25, v9
    v_lshlrev_b32 v79, 16, v13
    v_and_b32 v87, s25, v13
    v_add_f32 v80, v76, v78
    v_add_f32 v88, v84, v86
    v_add_f32 v81, v77, v79
    v_add_f32 v89, v85, v87
    v_fma_f32 v82, v78, 4.0, v76
    v_fma_f32 v90, v86, 4.0, v84
    v_fma_f32 v83, v79, 4.0, v77
    v_fma_f32 v91, v87, 4.0, v85
    v_add_f32 v77, v80, v81
    v_add_f32 v85, v88, v89
    v_sub_f32 v78, v80, v81
    v_sub_f32 v86, v88, v89
    v_fma_f32 v79, v83, 2.0, v82
    v_fma_f32 v87, v91, 2.0, v90
    v_fma_f32 v82, v83, -2.0, v82
    v_fma_f32 v90, v91, -2.0, v90
    v_fmamk_f32 v80, v76, 0x41700000, v82
    v_fmamk_f32 v88, v84, 0x41700000, v90
    v_fmamk_f32 v80, v81, 0x41200000, v80
    v_fmamk_f32 v88, v89, 0x41200000, v88
    v_cvt_pk_bf16_f32 v5, v77, v85
    v_cvt_pk_bf16_f32 v9, v78, v86
    v_cvt_pk_bf16_f32 v65, v79, v87
    v_cvt_pk_bf16_f32 v69, v82, v90
    v_cvt_pk_bf16_f32 v73, v80, v88
    v_lshlrev_b32 v76, 16, v2
    v_and_b32 v84, s25, v2
    v_lshlrev_b32 v77, 16, v6
    v_and_b32 v85, s25, v6
    v_lshlrev_b32 v78, 16, v10
    v_and_b32 v86, s25, v10
    v_lshlrev_b32 v79, 16, v14
    v_and_b32 v87, s25, v14
    v_add_f32 v80, v76, v78
    v_add_f32 v88, v84, v86
    v_add_f32 v81, v77, v79
    v_add_f32 v89, v85, v87
    v_fma_f32 v82, v78, 4.0, v76
    v_fma_f32 v90, v86, 4.0, v84
    v_fma_f32 v83, v79, 4.0, v77
    v_fma_f32 v91, v87, 4.0, v85
    v_add_f32 v77, v80, v81
    v_add_f32 v85, v88, v89
    v_sub_f32 v78, v80, v81
    v_sub_f32 v86, v88, v89
    v_fma_f32 v79, v83, 2.0, v82
    v_fma_f32 v87, v91, 2.0, v90
    v_fma_f32 v82, v83, -2.0, v82
    v_fma_f32 v90, v91, -2.0, v90
    v_fmamk_f32 v80, v76, 0x41700000, v82
    v_fmamk_f32 v88, v84, 0x41700000, v90
    v_fmamk_f32 v80, v81, 0x41200000, v80
    v_fmamk_f32 v88, v89, 0x41200000, v88
    v_cvt_pk_bf16_f32 v6, v77, v85
    v_cvt_pk_bf16_f32 v10, v78, v86
    v_cvt_pk_bf16_f32 v66, v79, v87
    v_cvt_pk_bf16_f32 v70, v82, v90
    v_cvt_pk_bf16_f32 v74, v80, v88
    v_lshlrev_b32 v76, 16, v3
    v_and_b32 v84, s25, v3
    v_lshlrev_b32 v77, 16, v7
    v_and_b32 v85, s25, v7
    v_lshlrev_b32 v78, 16, v11
    v_and_b32 v86, s25, v11
    v_lshlrev_b32 v79, 16, v15
    v_and_b32 v87, s25, v15
    v_add_f32 v80, v76, v78
    v_add_f32 v88, v84, v86
    v_add_f32 v81, v77, v79
    v_add_f32 v89, v85, v87
    v_fma_f32 v82, v78, 4.0, v76
    v_fma_f32 v90, v86, 4.0, v84
    v_fma_f32 v83, v79, 4.0, v77
    v_fma_f32 v91, v87, 4.0, v85
    v_add_f32 v77, v80, v81
    v_add_f32 v85, v88, v89
    v_sub_f32 v78, v80, v81
    v_sub_f32 v86, v88, v89
    v_fma_f32 v79, v83, 2.0, v82
    v_fma_f32 v87, v91, 2.0, v90
    v_fma_f32 v82, v83, -2.0, v82
    v_fma_f32 v90, v91, -2.0, v90
    v_fmamk_f32 v80, v76, 0x41700000, v82
    v_fmamk_f32 v88, v84, 0x41700000, v90
    v_fmamk_f32 v80, v81, 0x41200000, v80
    v_fmamk_f32 v88, v89, 0x41200000, v88
    v_cvt_pk_bf16_f32 v7, v77, v85
    v_cvt_pk_bf16_f32 v11, v78, v86
    v_cvt_pk_bf16_f32 v67, v79, v87
    v_cvt_pk_bf16_f32 v71, v82, v90
    v_cvt_pk_bf16_f32 v75, v80, v88
    ds_write_b128 v96, v[64:67] offset:49152
    ds_write_b128 v97, v[68:71] offset:0
    ds_write_b128 v97, v[72:75] offset:16384
    ds_write_b128 v96, v[4:7] offset:16384
    ds_write_b128 v96, v[8:11] offset:32768
    s_cmp_ge_u32 s20, 12
    s_cbranch_scc1 L_conv1_kernel_h2
    s_waitcnt lgkmcnt(0)
    s_barrier
    buffer_load_dwordx4 v[32:35], v92, s[8:11], s24 offen offset:0
    buffer_load_dwordx4 v[48:51], v92, s[8:11], s24 offen offset:64
    v_add_u32 v92, 128, v92
    buffer_load_dwordx4 v[36:39], v93, s[8:11], s24 offen offset:0
    buffer_load_dwordx4 v[52:55], v93, s[8:11], s24 offen offset:64
    v_add_u32 v93, 128, v93
    s_setprio 1
L_conv1_kernel_hloop1:
    s_cmp_lt_u32 s28, 13
    s_cselect_b32 s24, 0, 2130706432
    v_lshlrev_b32 v76, 16, v16
    v_and_b32 v84, s25, v16
    v_lshlrev_b32 v77, 16, v20
    v_and_b32 v85, s25, v20
    v_lshlrev_b32 v78, 16, v24
    v_and_b32 v86, s25, v24
    v_lshlrev_b32 v79, 16, v28
    v_and_b32 v87, s25, v28
    v_add_f32 v80, v76, v78
    v_add_f32 v88, v84, v86
    v_add_f32 v81, v77, v79
    v_add_f32 v89, v85, v87
    v_fma_f32 v82, v78, 4.0, v76
    buffer_load_dwordx4 v[40:43], v94, s[8:11], s24 offen offset:0
    buffer_load_dwordx4 v[56:59], v94, s[8:11], s24 offen offset:64
    v_add_u32 v94, 128, v94
    v_fma_f32 v90, v86, 4.0, v84
    v_fma_f32 v83, v79, 4.0, v77
    v_fma_f32 v91, v87, 4.0, v85
    v_add_f32 v77, v80, v81
    v_add_f32 v85, v88, v89
    v_sub_f32 v78, v80, v81
    v_sub_f32 v86, v88, v89
    v_fma_f32 v79, v83, 2.0, v82
    v_fma_f32 v87, v91, 2.0, v90
    v_fma_f32 v82, v83, -2.0, v82
    v_fma_f32 v90, v91, -2.0, v90
    v_fmamk_f32 v80, v76, 0x41700000, v82
    v_fmamk_f32 v88, v84, 0x41700000, v90
    v_fmamk_f32 v80, v81, 0x41200000, v80
    v_fmamk_f32 v88, v89, 0x41200000, v88
    v_cvt_pk_bf16_f32 v20, v77, v85
    v_cvt_pk_bf16_f32 v24, v78, v86
    v_cvt_pk_bf16_f32 v64, v79, v87
    v_cvt_pk_bf16_f32 v68, v82, v90
    v_cvt_pk_bf16_f32 v72, v80, v88
    v_lshlrev_b32 v76, 16, v17
    v_and_b32 v84, s25, v17
    v_lshlrev_b32 v77, 16, v21
    v_and_b32 v85, s25, v21
    v_lshlrev_b32 v78, 16, v25
    v_and_b32 v86, s25, v25
    v_lshlrev_b32 v79, 16, v29
    v_and_b32 v87, s25, v29
    v_add_f32 v80, v76, v78
    v_add_f32 v88, v84, v86
    v_add_f32 v81, v77, v79
    v_add_f32 v89, v85, v87
    v_fma_f32 v82, v78, 4.0, v76
    v_fma_f32 v90, v86, 4.0, v84
    v_fma_f32 v83, v79, 4.0, v77
    v_fma_f32 v91, v87, 4.0, v85
    v_add_f32 v77, v80, v81
    v_add_f32 v85, v88, v89
    v_sub_f32 v78, v80, v81
    v_sub_f32 v86, v88, v89
    v_fma_f32 v79, v83, 2.0, v82
    v_fma_f32 v87, v91, 2.0, v90
    v_fma_f32 v82, v83, -2.0, v82
    v_fma_f32 v90, v91, -2.0, v90
    v_fmamk_f32 v80, v76, 0x41700000, v82
    v_fmamk_f32 v88, v84, 0x41700000, v90
    v_fmamk_f32 v80, v81, 0x41200000, v80
    v_fmamk_f32 v88, v89, 0x41200000, v88
    v_cvt_pk_bf16_f32 v21, v77, v85
    v_cvt_pk_bf16_f32 v25, v78, v86
    v_cvt_pk_bf16_f32 v65, v79, v87
    v_cvt_pk_bf16_f32 v69, v82, v90
    v_cvt_pk_bf16_f32 v73, v80, v88
    buffer_load_dwordx4 v[44:47], v95, s[8:11], s24 offen offset:0
    buffer_load_dwordx4 v[60:63], v95, s[8:11], s24 offen offset:64
    v_add_u32 v95, 128, v95
    v_lshlrev_b32 v76, 16, v18
    v_and_b32 v84, s25, v18
    v_lshlrev_b32 v77, 16, v22
    v_and_b32 v85, s25, v22
    v_lshlrev_b32 v78, 16, v26
    v_and_b32 v86, s25, v26
    v_lshlrev_b32 v79, 16, v30
    v_and_b32 v87, s25, v30
    v_add_f32 v80, v76, v78
    v_add_f32 v88, v84, v86
    v_add_f32 v81, v77, v79
    v_add_f32 v89, v85, v87
    v_fma_f32 v82, v78, 4.0, v76
    v_fma_f32 v90, v86, 4.0, v84
    v_fma_f32 v83, v79, 4.0, v77
    v_fma_f32 v91, v87, 4.0, v85
    v_add_f32 v77, v80, v81
    v_add_f32 v85, v88, v89
    v_sub_f32 v78, v80, v81
    v_sub_f32 v86, v88, v89
    v_fma_f32 v79, v83, 2.0, v82
    v_fma_f32 v87, v91, 2.0, v90
    v_fma_f32 v82, v83, -2.0, v82
    v_fma_f32 v90, v91, -2.0, v90
    v_fmamk_f32 v80, v76, 0x41700000, v82
    v_fmamk_f32 v88, v84, 0x41700000, v90
    v_fmamk_f32 v80, v81, 0x41200000, v80
    v_fmamk_f32 v88, v89, 0x41200000, v88
    v_cvt_pk_bf16_f32 v22, v77, v85
    v_cvt_pk_bf16_f32 v26, v78, v86
    v_cvt_pk_bf16_f32 v66, v79, v87
    v_cvt_pk_bf16_f32 v70, v82, v90
    v_cvt_pk_bf16_f32 v74, v80, v88
    v_lshlrev_b32 v76, 16, v19
    v_and_b32 v84, s25, v19
    v_lshlrev_b32 v77, 16, v23
    v_and_b32 v85, s25, v23
    v_lshlrev_b32 v78, 16, v27
    v_and_b32 v86, s25, v27
    v_lshlrev_b32 v79, 16, v31
    v_and_b32 v87, s25, v31
    v_add_f32 v80, v76, v78
    v_add_f32 v88, v84, v86
    v_add_f32 v81, v77, v79
    v_add_f32 v89, v85, v87
    v_fma_f32 v82, v78, 4.0, v76
    v_fma_f32 v90, v86, 4.0, v84
    v_fma_f32 v83, v79, 4.0, v77
    v_fma_f32 v91, v87, 4.0, v85
    v_add_f32 v77, v80, v81
    v_add_f32 v85, v88, v89
    v_sub_f32 v78, v80, v81
    v_sub_f32 v86, v88, v89
    v_fma_f32 v79, v83, 2.0, v82
    v_fma_f32 v87, v91, 2.0, v90
    v_fma_f32 v82, v83, -2.0, v82
    v_fma_f32 v90, v91, -2.0, v90
    v_fmamk_f32 v80, v76, 0x41700000, v82
    v_fmamk_f32 v88, v84, 0x41700000, v90
    v_fmamk_f32 v80, v81, 0x41200000, v80
    v_fmamk_f32 v88, v89, 0x41200000, v88
    v_cvt_pk_bf16_f32 v23, v77, v85
    v_cvt_pk_bf16_f32 v27, v78, v86
    v_cvt_pk_bf16_f32 v67, v79, v87
    v_cvt_pk_bf16_f32 v71, v82, v90
    v_cvt_pk_bf16_f32 v75, v80, v88
    ds_write_b128 v96, v[64:67] offset:57344
    ds_write_b128 v97, v[68:71] offset:8192
    ds_write_b128 v97, v[72:75] offset:24576
    ds_write_b128 v96, v[16:19] offset:8192
    ds_write_b128 v96, v[20:23] offset:24576
    ds_write_b128 v96, v[24:27] offset:40960
    ds_write_b128 v98, v[28:31] offset:8704
    s_add_u32 s28, s28, 1
    s_waitcnt lgkmcnt(0)
    s_barrier
    s_cmp_lt_u32 s28, 13
    s_cselect_b32 s24, 0, 2130706432
    s_waitcnt vmcnt(0)
    v_lshlrev_b32 v76, 16, v32
    v_and_b32 v84, s25, v32
    v_lshlrev_b32 v77, 16, v36
    v_and_b32 v85, s25, v36
    v_lshlrev_b32 v78, 16, v40
    v_and_b32 v86, s25, v40
    v_lshlrev_b32 v79, 16, v44
    v_and_b32 v87, s25, v44
    v_add_f32 v80, v76, v78
    v_add_f32 v88, v84, v86
    v_add_f32 v81, v77, v79
    v_add_f32 v89, v85, v87
    v_fma_f32 v82, v78, 4.0, v76
    v_fma_f32 v90, v86, 4.0, v84
    v_fma_f32 v83, v79, 4.0, v77
    v_fma_f32 v91, v87, 4.0, v85
    v_add_f32 v77, v80, v81
    v_add_f32 v85, v88, v89
    v_sub_f32 v78, v80, v81
    v_sub_f32 v86, v88, v89
    v_fma_f32 v79, v83, 2.0, v82
    v_fma_f32 v87, v91, 2.0, v90
    v_fma_f32 v82, v83, -2.0, v82
    v_fma_f32 v90, v91, -2.0, v90
    v_fmamk_f32 v80, v76, 0x41700000, v82
    v_fmamk_f32 v88, v84, 0x41700000, v90
    v_fmamk_f32 v80, v81, 0x41200000, v80
    v_fmamk_f32 v88, v89, 0x41200000, v88
    v_cvt_pk_bf16_f32 v36, v77, v85
    v_cvt_pk_bf16_f32 v40, v78, v86
    v_cvt_pk_bf16_f32 v64, v79, v87
    v_cvt_pk_bf16_f32 v68, v82, v90
    v_cvt_pk_bf16_f32 v72, v80, v88
    v_lshlrev_b32 v76, 16, v33
    v_and_b32 v84, s25, v33
    v_lshlrev_b32 v77, 16, v37
    v_and_b32 v85, s25, v37
    v_lshlrev_b32 v78, 16, v41
    v_and_b32 v86, s25, v41
    buffer_load_dwordx4 v[0:3], v92, s[8:11], s24 offen offset:0
    buffer_load_dwordx4 v[16:19], v92, s[8:11], s24 offen offset:64
    v_add_u32 v92, 128, v92
    v_lshlrev_b32 v79, 16, v45
    v_and_b32 v87, s25, v45
    v_add_f32 v80, v76, v78
    v_add_f32 v88, v84, v86
    v_add_f32 v81, v77, v79
    v_add_f32 v89, v85, v87
    v_fma_f32 v82, v78, 4.0, v76
    v_fma_f32 v90, v86, 4.0, v84
    v_fma_f32 v83, v79, 4.0, v77
    v_fma_f32 v91, v87, 4.0, v85
    v_add_f32 v77, v80, v81
    v_add_f32 v85, v88, v89
    v_sub_f32 v78, v80, v81
    v_sub_f32 v86, v88, v89
    v_fma_f32 v79, v83, 2.0, v82
    v_fma_f32 v87, v91, 2.0, v90
    v_fma_f32 v82, v83, -2.0, v82
    v_fma_f32 v90, v91, -2.0, v90
    v_fmamk_f32 v80, v76, 0x41700000, v82
    v_fmamk_f32 v88, v84, 0x41700000, v90
    v_fmamk_f32 v80, v81, 0x41200000, v80
    v_fmamk_f32 v88, v89, 0x41200000, v88
    v_cvt_pk_bf16_f32 v37, v77, v85
    v_cvt_pk_bf16_f32 v41, v78, v86
    v_cvt_pk_bf16_f32 v65, v79, v87
    v_cvt_pk_bf16_f32 v69, v82, v90
    v_cvt_pk_bf16_f32 v73, v80, v88
    v_lshlrev_b32 v76, 16, v34
    v_and_b32 v84, s25, v34
    v_lshlrev_b32 v77, 16, v38
    v_and_b32 v85, s25, v38
    v_lshlrev_b32 v78, 16, v42
    v_and_b32 v86, s25, v42
    v_lshlrev_b32 v79, 16, v46
    v_and_b32 v87, s25, v46
    v_add_f32 v80, v76, v78
    v_add_f32 v88, v84, v86
    v_add_f32 v81, v77, v79
    v_add_f32 v89, v85, v87
    v_fma_f32 v82, v78, 4.0, v76
    v_fma_f32 v90, v86, 4.0, v84
    v_fma_f32 v83, v79, 4.0, v77
    v_fma_f32 v91, v87, 4.0, v85
    v_add_f32 v77, v80, v81
    v_add_f32 v85, v88, v89
    v_sub_f32 v78, v80, v81
    v_sub_f32 v86, v88, v89
    v_fma_f32 v79, v83, 2.0, v82
    v_fma_f32 v87, v91, 2.0, v90
    v_fma_f32 v82, v83, -2.0, v82
    v_fma_f32 v90, v91, -2.0, v90
    v_fmamk_f32 v80, v76, 0x41700000, v82
    v_fmamk_f32 v88, v84, 0x41700000, v90
    buffer_load_dwordx4 v[4:7], v93, s[8:11], s24 offen offset:0
    buffer_load_dwordx4 v[20:23], v93, s[8:11], s24 offen offset:64
    v_add_u32 v93, 128, v93
    v_fmamk_f32 v80, v81, 0x41200000, v80
    v_fmamk_f32 v88, v89, 0x41200000, v88
    v_cvt_pk_bf16_f32 v38, v77, v85
    v_cvt_pk_bf16_f32 v42, v78, v86
    v_cvt_pk_bf16_f32 v66, v79, v87
    v_cvt_pk_bf16_f32 v70, v82, v90
    v_cvt_pk_bf16_f32 v74, v80, v88
    v_lshlrev_b32 v76, 16, v35
    v_and_b32 v84, s25, v35
    v_lshlrev_b32 v77, 16, v39
    v_and_b32 v85, s25, v39
    v_lshlrev_b32 v78, 16, v43
    v_and_b32 v86, s25, v43
    v_lshlrev_b32 v79, 16, v47
    v_and_b32 v87, s25, v47
    v_add_f32 v80, v76, v78
    v_add_f32 v88, v84, v86
    v_add_f32 v81, v77, v79
    v_add_f32 v89, v85, v87
    v_fma_f32 v82, v78, 4.0, v76
    v_fma_f32 v90, v86, 4.0, v84
    v_fma_f32 v83, v79, 4.0, v77
    v_fma_f32 v91, v87, 4.0, v85
    v_add_f32 v77, v80, v81
    v_add_f32 v85, v88, v89
    v_sub_f32 v78, v80, v81
    v_sub_f32 v86, v88, v89
    v_fma_f32 v79, v83, 2.0, v82
    v_fma_f32 v87, v91, 2.0, v90
    v_fma_f32 v82, v83, -2.0, v82
    v_fma_f32 v90, v91, -2.0, v90
    v_fmamk_f32 v80, v76, 0x41700000, v82
    v_fmamk_f32 v88, v84, 0x41700000, v90
    v_fmamk_f32 v80, v81, 0x41200000, v80
    v_fmamk_f32 v88, v89, 0x41200000, v88
    v_cvt_pk_bf16_f32 v39, v77, v85
    v_cvt_pk_bf16_f32 v43, v78, v86
    v_cvt_pk_bf16_f32 v67, v79, v87
    v_cvt_pk_bf16_f32 v71, v82, v90
    v_cvt_pk_bf16_f32 v75, v80, v88
    ds_write_b128 v96, v[64:67] offset:49152
    ds_write_b128 v97, v[68:71] offset:0
    ds_write_b128 v97, v[72:75] offset:16384
    ds_write_b128 v96, v[32:35] offset:0
    ds_write_b128 v96, v[36:39] offset:16384
    ds_write_b128 v96, v[40:43] offset:32768
    ds_write_b128 v98, v[44:47] offset:0
    s_add_u32 s28, s28, 1
    s_waitcnt lgkmcnt(0)
    s_barrier
    s_cmp_lt_u32 s28, 13
    s_cselect_b32 s24, 0, 2130706432
    v_lshlrev_b32 v76, 16, v48
    v_and_b32 v84, s25, v48
    v_lshlrev_b32 v77, 16, v52
    v_and_b32 v85, s25, v52
    v_lshlrev_b32 v78, 16, v56
    v_and_b32 v86, s25, v56
    v_lshlrev_b32 v79, 16, v60
    v_and_b32 v87, s25, v60
    v_add_f32 v80, v76, v78
    v_add_f32 v88, v84, v86
    v_add_f32 v81, v77, v79
    v_add_f32 v89, v85, v87
    v_fma_f32 v82, v78, 4.0, v76
    buffer_load_dwordx4 v[8:11], v94, s[8:11], s24 offen offset:0
    buffer_load_dwordx4 v[24:27], v94, s[8:11], s24 offen offset:64
    v_add_u32 v94, 128, v94
    v_fma_f32 v90, v86, 4.0, v84
    v_fma_f32 v83, v79, 4.0, v77
    v_fma_f32 v91, v87, 4.0, v85
    v_add_f32 v77, v80, v81
    v_add_f32 v85, v88, v89
    v_sub_f32 v78, v80, v81
    v_sub_f32 v86, v88, v89
    v_fma_f32 v79, v83, 2.0, v82
    v_fma_f32 v87, v91, 2.0, v90
    v_fma_f32 v82, v83, -2.0, v82
    v_fma_f32 v90, v91, -2.0, v90
    v_fmamk_f32 v80, v76, 0x41700000, v82
    v_fmamk_f32 v88, v84, 0x41700000, v90
    v_fmamk_f32 v80, v81, 0x41200000, v80
    v_fmamk_f32 v88, v89, 0x41200000, v88
    v_cvt_pk_bf16_f32 v52, v77, v85
    v_cvt_pk_bf16_f32 v56, v78, v86
    v_cvt_pk_bf16_f32 v64, v79, v87
    v_cvt_pk_bf16_f32 v68, v82, v90
    v_cvt_pk_bf16_f32 v72, v80, v88
    v_lshlrev_b32 v76, 16, v49
    v_and_b32 v84, s25, v49
    v_lshlrev_b32 v77, 16, v53
    v_and_b32 v85, s25, v53
    v_lshlrev_b32 v78, 16, v57
    v_and_b32 v86, s25, v57
    v_lshlrev_b32 v79, 16, v61
    v_and_b32 v87, s25, v61
    v_add_f32 v80, v76, v78
    v_add_f32 v88, v84, v86
    v_add_f32 v81, v77, v79
    v_add_f32 v89, v85, v87
    v_fma_f32 v82, v78, 4.0, v76
    v_fma_f32 v90, v86, 4.0, v84
    v_fma_f32 v83, v79, 4.0, v77
    v_fma_f32 v91, v87, 4.0, v85
    v_add_f32 v77, v80, v81
    v_add_f32 v85, v88, v89
    v_sub_f32 v78, v80, v81
    v_sub_f32 v86, v88, v89
    v_fma_f32 v79, v83, 2.0, v82
    v_fma_f32 v87, v91, 2.0, v90
    v_fma_f32 v82, v83, -2.0, v82
    v_fma_f32 v90, v91, -2.0, v90
    v_fmamk_f32 v80, v76, 0x41700000, v82
    v_fmamk_f32 v88, v84, 0x41700000, v90
    v_fmamk_f32 v80, v81, 0x41200000, v80
    v_fmamk_f32 v88, v89, 0x41200000, v88
    v_cvt_pk_bf16_f32 v53, v77, v85
    v_cvt_pk_bf16_f32 v57, v78, v86
    v_cvt_pk_bf16_f32 v65, v79, v87
    v_cvt_pk_bf16_f32 v69, v82, v90
    v_cvt_pk_bf16_f32 v73, v80, v88
    buffer_load_dwordx4 v[12:15], v95, s[8:11], s24 offen offset:0
    buffer_load_dwordx4 v[28:31], v95, s[8:11], s24 offen offset:64
    v_add_u32 v95, 128, v95
    v_lshlrev_b32 v76, 16, v50
    v_and_b32 v84, s25, v50
    v_lshlrev_b32 v77, 16, v54
    v_and_b32 v85, s25, v54
    v_lshlrev_b32 v78, 16, v58
    v_and_b32 v86, s25, v58
    v_lshlrev_b32 v79, 16, v62
    v_and_b32 v87, s25, v62
    v_add_f32 v80, v76, v78
    v_add_f32 v88, v84, v86
    v_add_f32 v81, v77, v79
    v_add_f32 v89, v85, v87
    v_fma_f32 v82, v78, 4.0, v76
    v_fma_f32 v90, v86, 4.0, v84
    v_fma_f32 v83, v79, 4.0, v77
    v_fma_f32 v91, v87, 4.0, v85
    v_add_f32 v77, v80, v81
    v_add_f32 v85, v88, v89
    v_sub_f32 v78, v80, v81
    v_sub_f32 v86, v88, v89
    v_fma_f32 v79, v83, 2.0, v82
    v_fma_f32 v87, v91, 2.0, v90
    v_fma_f32 v82, v83, -2.0, v82
    v_fma_f32 v90, v91, -2.0, v90
    v_fmamk_f32 v80, v76, 0x41700000, v82
    v_fmamk_f32 v88, v84, 0x41700000, v90
    v_fmamk_f32 v80, v81, 0x41200000, v80
    v_fmamk_f32 v88, v89, 0x41200000, v88
    v_cvt_pk_bf16_f32 v54, v77, v85
    v_cvt_pk_bf16_f32 v58, v78, v86
    v_cvt_pk_bf16_f32 v66, v79, v87
    v_cvt_pk_bf16_f32 v70, v82, v90
    v_cvt_pk_bf16_f32 v74, v80, v88
    v_lshlrev_b32 v76, 16, v51
    v_and_b32 v84, s25, v51
    v_lshlrev_b32 v77, 16, v55
    v_and_b32 v85, s25, v55
    v_lshlrev_b32 v78, 16, v59
    v_and_b32 v86, s25, v59
    v_lshlrev_b32 v79, 16, v63
    v_and_b32 v87, s25, v63
    v_add_f32 v80, v76, v78
    v_add_f32 v88, v84, v86
    v_add_f32 v81, v77, v79
    v_add_f32 v89, v85, v87
    v_fma_f32 v82, v78, 4.0, v76
    v_fma_f32 v90, v86, 4.0, v84
    v_fma_f32 v83, v79, 4.0, v77
    v_fma_f32 v91, v87, 4.0, v85
    v_add_f32 v77, v80, v81
    v_add_f32 v85, v88, v89
    v_sub_f32 v78, v80, v81
    v_sub_f32 v86, v88, v89
    v_fma_f32 v79, v83, 2.0, v82
    v_fma_f32 v87, v91, 2.0, v90
    v_fma_f32 v82, v83, -2.0, v82
    v_fma_f32 v90, v91, -2.0, v90
    v_fmamk_f32 v80, v76, 0x41700000, v82
    v_fmamk_f32 v88, v84, 0x41700000, v90
    v_fmamk_f32 v80, v81, 0x41200000, v80
    v_fmamk_f32 v88, v89, 0x41200000, v88
    v_cvt_pk_bf16_f32 v55, v77, v85
    v_cvt_pk_bf16_f32 v59, v78, v86
    v_cvt_pk_bf16_f32 v67, v79, v87
    v_cvt_pk_bf16_f32 v71, v82, v90
    v_cvt_pk_bf16_f32 v75, v80, v88
    ds_write_b128 v96, v[64:67] offset:57344
    ds_write_b128 v97, v[68:71] offset:8192
    ds_write_b128 v97, v[72:75] offset:24576
    ds_write_b128 v96, v[48:51] offset:8192
    ds_write_b128 v96, v[52:55] offset:24576
    ds_write_b128 v96, v[56:59] offset:40960
    ds_write_b128 v98, v[60:63] offset:8704
    s_add_u32 s28, s28, 1
    s_waitcnt lgkmcnt(0)
    s_barrier
    s_cmp_eq_u32 s22, 1
    s_cbranch_scc1 L_conv1_kernel_hlast1
    s_cmp_lt_u32 s28, 13
    s_cselect_b32 s24, 0, 2130706432
    s_waitcnt vmcnt(0)
    v_lshlrev_b32 v76, 16, v0
    v_and_b32 v84, s25, v0
    v_lshlrev_b32 v77, 16, v4
    v_and_b32 v85, s25, v4
    v_lshlrev_b32 v78, 16, v8
    v_and_b32 v86, s25, v8
    v_lshlrev_b32 v79, 16, v12
    v_and_b32 v87, s25, v12
    v_add_f32 v80, v76, v78
    v_add_f32 v88, v84, v86
    v_add_f32 v81, v77, v79
    v_add_f32 v89, v85, v87
    v_fma_f32 v82, v78, 4.0, v76
    v_fma_f32 v90, v86, 4.0, v84
    v_fma_f32 v83, v79, 4.0, v77
    v_fma_f32 v91, v87, 4.0, v85
    v_add_f32 v77, v80, v81
    v_add_f32 v85, v88, v89
    v_sub_f32 v78, v80, v81
    v_sub_f32 v86, v88, v89
    v_fma_f32 v79, v83, 2.0, v82
    v_fma_f32 v87, v91, 2.0, v90
    v_fma_f32 v82, v83, -2.0, v82
    v_fma_f32 v90, v91, -2.0, v90
    v_fmamk_f32 v80, v76, 0x41700000, v82
    v_fmamk_f32 v88, v84, 0x41700000, v90
    v_fmamk_f32 v80, v81, 0x41200000, v80
    v_fmamk_f32 v88, v89, 0x41200000, v88
    v_cvt_pk_bf16_f32 v4, v77, v85
    v_cvt_pk_bf16_f32 v8, v78, v86
    v_cvt_pk_bf16_f32 v64, v79, v87
    v_cvt_pk_bf16_f32 v68, v82, v90
    v_cvt_pk_bf16_f32 v72, v80, v88
    v_lshlrev_b32 v76, 16, v1
    v_and_b32 v84, s25, v1
    v_lshlrev_b32 v77, 16, v5
    v_and_b32 v85, s25, v5
    v_lshlrev_b32 v78, 16, v9
    v_and_b32 v86, s25, v9
    buffer_load_dwordx4 v[32:35], v92, s[8:11], s24 offen offset:0
    buffer_load_dwordx4 v[48:51], v92, s[8:11], s24 offen offset:64
    v_add_u32 v92, 128, v92
    v_lshlrev_b32 v79, 16, v13
    v_and_b32 v87, s25, v13
    v_add_f32 v80, v76, v78
    v_add_f32 v88, v84, v86
    v_add_f32 v81, v77, v79
    v_add_f32 v89, v85, v87
    v_fma_f32 v82, v78, 4.0, v76
    v_fma_f32 v90, v86, 4.0, v84
    v_fma_f32 v83, v79, 4.0, v77
    v_fma_f32 v91, v87, 4.0, v85
    v_add_f32 v77, v80, v81
    v_add_f32 v85, v88, v89
    v_sub_f32 v78, v80, v81
    v_sub_f32 v86, v88, v89
    v_fma_f32 v79, v83, 2.0, v82
    v_fma_f32 v87, v91, 2.0, v90
    v_fma_f32 v82, v83, -2.0, v82
    v_fma_f32 v90, v91, -2.0, v90
    v_fmamk_f32 v80, v76, 0x41700000, v82
    v_fmamk_f32 v88, v84, 0x41700000, v90
    v_fmamk_f32 v80, v81, 0x41200000, v80
    v_fmamk_f32 v88, v89, 0x41200000, v88
    v_cvt_pk_bf16_f32 v5, v77, v85
    v_cvt_pk_bf16_f32 v9, v78, v86
    v_cvt_pk_bf16_f32 v65, v79, v87
    v_cvt_pk_bf16_f32 v69, v82, v90
    v_cvt_pk_bf16_f32 v73, v80, v88
    v_lshlrev_b32 v76, 16, v2
    v_and_b32 v84, s25, v2
    v_lshlrev_b32 v77, 16, v6
    v_and_b32 v85, s25, v6
    v_lshlrev_b32 v78, 16, v10
    v_and_b32 v86, s25, v10
    v_lshlrev_b32 v79, 16, v14
    v_and_b32 v87, s25, v14
    v_add_f32 v80, v76, v78
    v_add_f32 v88, v84, v86
    v_add_f32 v81, v77, v79
    v_add_f32 v89, v85, v87
    v_fma_f32 v82, v78, 4.0, v76
    v_fma_f32 v90, v86, 4.0, v84
    v_fma_f32 v83, v79, 4.0, v77
    v_fma_f32 v91, v87, 4.0, v85
    v_add_f32 v77, v80, v81
    v_add_f32 v85, v88, v89
    v_sub_f32 v78, v80, v81
    v_sub_f32 v86, v88, v89
    v_fma_f32 v79, v83, 2.0, v82
    v_fma_f32 v87, v91, 2.0, v90
    v_fma_f32 v82, v83, -2.0, v82
    v_fma_f32 v90, v91, -2.0, v90
    v_fmamk_f32 v80, v76, 0x41700000, v82
    v_fmamk_f32 v88, v84, 0x41700000, v90
    buffer_load_dwordx4 v[36:39], v93, s[8:11], s24 offen offset:0
    buffer_load_dwordx4 v[52:55], v93, s[8:11], s24 offen offset:64
    v_add_u32 v93, 128, v93
    v_fmamk_f32 v80, v81, 0x41200000, v80
    v_fmamk_f32 v88, v89, 0x41200000, v88
    v_cvt_pk_bf16_f32 v6, v77, v85
    v_cvt_pk_bf16_f32 v10, v78, v86
    v_cvt_pk_bf16_f32 v66, v79, v87
    v_cvt_pk_bf16_f32 v70, v82, v90
    v_cvt_pk_bf16_f32 v74, v80, v88
    v_lshlrev_b32 v76, 16, v3
    v_and_b32 v84, s25, v3
    v_lshlrev_b32 v77, 16, v7
    v_and_b32 v85, s25, v7
    v_lshlrev_b32 v78, 16, v11
    v_and_b32 v86, s25, v11
    v_lshlrev_b32 v79, 16, v15
    v_and_b32 v87, s25, v15
    v_add_f32 v80, v76, v78
    v_add_f32 v88, v84, v86
    v_add_f32 v81, v77, v79
    v_add_f32 v89, v85, v87
    v_fma_f32 v82, v78, 4.0, v76
    v_fma_f32 v90, v86, 4.0, v84
    v_fma_f32 v83, v79, 4.0, v77
    v_fma_f32 v91, v87, 4.0, v85
    v_add_f32 v77, v80, v81
    v_add_f32 v85, v88, v89
    v_sub_f32 v78, v80, v81
    v_sub_f32 v86, v88, v89
    v_fma_f32 v79, v83, 2.0, v82
    v_fma_f32 v87, v91, 2.0, v90
    v_fma_f32 v82, v83, -2.0, v82
    v_fma_f32 v90, v91, -2.0, v90
    v_fmamk_f32 v80, v76, 0x41700000, v82
    v_fmamk_f32 v88, v84, 0x41700000, v90
    v_fmamk_f32 v80, v81, 0x41200000, v80
    v_fmamk_f32 v88, v89, 0x41200000, v88
    v_cvt_pk_bf16_f32 v7, v77, v85
    v_cvt_pk_bf16_f32 v11, v78, v86
    v_cvt_pk_bf16_f32 v67, v79, v87
    v_cvt_pk_bf16_f32 v71, v82, v90
    v_cvt_pk_bf16_f32 v75, v80, v88
    ds_write_b128 v96, v[64:67] offset:49152
    ds_write_b128 v97, v[68:71] offset:0
    ds_write_b128 v97, v[72:75] offset:16384
    ds_write_b128 v96, v[0:3] offset:0
    ds_write_b128 v96, v[4:7] offset:16384
    ds_write_b128 v96, v[8:11] offset:32768
    ds_write_b128 v98, v[12:15] offset:0
    s_add_u32 s28, s28, 1
    s_waitcnt lgkmcnt(0)
    s_barrier
    s_sub_u32 s22, s22, 1
    s_branch L_conv1_kernel_hloop1
L_conv1_kernel_hlast1:
    s_cmp_ge_u32 s2, 32
    s_cbranch_scc1 L_conv1_kernel_ntw
    s_getpc_b64 s[36:37]
L_conv1_kernel_pc:
    s_lshl_b32 s38, s32, 13
    s_add_u32 s38, s38, L_conv1_kernel_epi-L_conv1_kernel_pc
    v_lshl_add_u32 v2, v127, 7, s38
    v_min_u32 v2, L_conv2_kernel_done-L_conv1_kernel_pc, v2
    v_mov_b32 v3, s37
    v_add_co_u32 v2, vcc, s36, v2
    s_nop 1
    v_addc_co_u32 v3, vcc, 0, v3, vcc
    global_load_dword v4, v[2:3], off
L_conv1_kernel_ntw:
    s_branch L_conv1_kernel_end
L_conv1_kernel_h2:
    s_waitcnt lgkmcnt(0)
    s_barrier
    buffer_load_dwordx4 v[32:35], v92, s[8:11], s24 offen offset:0
    buffer_load_dwordx4 v[48:51], v92, s[8:11], s24 offen offset:64
    v_add_u32 v92, 128, v92
    buffer_load_dwordx4 v[36:39], v93, s[8:11], s24 offen offset:0
    buffer_load_dwordx4 v[52:55], v93, s[8:11], s24 offen offset:64
    v_add_u32 v93, 128, v93
    buffer_load_dwordx4 v[40:43], v94, s[8:11], s24 offen offset:0
    buffer_load_dwordx4 v[56:59], v94, s[8:11], s24 offen offset:64
    v_add_u32 v94, 128, v94
    buffer_load_dwordx4 v[44:47], v95, s[8:11], s24 offen offset:0
    buffer_load_dwordx4 v[60:63], v95, s[8:11], s24 offen offset:64
    v_add_u32 v95, 128, v95
    s_setprio 0
    v_lshlrev_b32 v76, 16, v16
    v_and_b32 v84, s25, v16
    v_lshlrev_b32 v77, 16, v20
    v_and_b32 v85, s25, v20
    v_lshlrev_b32 v78, 16, v24
    v_and_b32 v86, s25, v24
    v_lshlrev_b32 v79, 16, v28
    v_and_b32 v87, s25, v28
    v_add_f32 v80, v76, v78
    v_add_f32 v88, v84, v86
    v_add_f32 v81, v77, v79
    v_add_f32 v89, v85, v87
    v_fma_f32 v82, v78, 4.0, v76
    v_fma_f32 v90, v86, 4.0, v84
    v_fma_f32 v83, v79, 4.0, v77
    v_fma_f32 v91, v87, 4.0, v85
    v_add_f32 v77, v80, v81
    v_add_f32 v85, v88, v89
    v_sub_f32 v78, v80, v81
    v_sub_f32 v86, v88, v89
    v_fma_f32 v79, v83, 2.0, v82
    v_fma_f32 v87, v91, 2.0, v90
    v_fma_f32 v82, v83, -2.0, v82
    v_fma_f32 v90, v91, -2.0, v90
    v_fmamk_f32 v80, v76, 0x41700000, v82
    v_fmamk_f32 v88, v84, 0x41700000, v90
    v_fmamk_f32 v80, v81, 0x41200000, v80
    v_fmamk_f32 v88, v89, 0x41200000, v88
    v_cvt_pk_bf16_f32 v20, v77, v85
    v_cvt_pk_bf16_f32 v24, v78, v86
    v_cvt_pk_bf16_f32 v64, v79, v87
    v_cvt_pk_bf16_f32 v68, v82, v90
    v_cvt_pk_bf16_f32 v72, v80, v88
    v_lshlrev_b32 v76, 16, v17
    v_and_b32 v84, s25, v17
    v_lshlrev_b32 v77, 16, v21
    v_and_b32 v85, s25, v21
    v_lshlrev_b32 v78, 16, v25
    v_and_b32 v86, s25, v25
    v_lshlrev_b32 v79, 16, v29
    v_and_b32 v87, s25, v29
    v_add_f32 v80, v76, v78
    v_add_f32 v88, v84, v86
    v_add_f32 v81, v77, v79
    v_add_f32 v89, v85, v87
    v_fma_f32 v82, v78, 4.0, v76
    v_fma_f32 v90, v86, 4.0, v84
    v_fma_f32 v83, v79, 4.0, v77
    v_fma_f32 v91, v87, 4.0, v85
    v_add_f32 v77, v80, v81
    v_add_f32 v85, v88, v89
    v_sub_f32 v78, v80, v81
    v_sub_f32 v86, v88, v89
    v_fma_f32 v79, v83, 2.0, v82
    v_fma_f32 v87, v91, 2.0, v90
    v_fma_f32 v82, v83, -2.0, v82
    v_fma_f32 v90, v91, -2.0, v90
    v_fmamk_f32 v80, v76, 0x41700000, v82
    v_fmamk_f32 v88, v84, 0x41700000, v90
    v_fmamk_f32 v80, v81, 0x41200000, v80
    v_fmamk_f32 v88, v89, 0x41200000, v88
    v_cvt_pk_bf16_f32 v21, v77, v85
    v_cvt_pk_bf16_f32 v25, v78, v86
    v_cvt_pk_bf16_f32 v65, v79, v87
    v_cvt_pk_bf16_f32 v69, v82, v90
    v_cvt_pk_bf16_f32 v73, v80, v88
    v_lshlrev_b32 v76, 16, v18
    v_and_b32 v84, s25, v18
    v_lshlrev_b32 v77, 16, v22
    v_and_b32 v85, s25, v22
    v_lshlrev_b32 v78, 16, v26
    v_and_b32 v86, s25, v26
    v_lshlrev_b32 v79, 16, v30
    v_and_b32 v87, s25, v30
    v_add_f32 v80, v76, v78
    v_add_f32 v88, v84, v86
    v_add_f32 v81, v77, v79
    v_add_f32 v89, v85, v87
    v_fma_f32 v82, v78, 4.0, v76
    v_fma_f32 v90, v86, 4.0, v84
    v_fma_f32 v83, v79, 4.0, v77
    v_fma_f32 v91, v87, 4.0, v85
    v_add_f32 v77, v80, v81
    v_add_f32 v85, v88, v89
    v_sub_f32 v78, v80, v81
    v_sub_f32 v86, v88, v89
    v_fma_f32 v79, v83, 2.0, v82
    v_fma_f32 v87, v91, 2.0, v90
    v_fma_f32 v82, v83, -2.0, v82
    v_fma_f32 v90, v91, -2.0, v90
    v_fmamk_f32 v80, v76, 0x41700000, v82
    v_fmamk_f32 v88, v84, 0x41700000, v90
    v_fmamk_f32 v80, v81, 0x41200000, v80
    v_fmamk_f32 v88, v89, 0x41200000, v88
    v_cvt_pk_bf16_f32 v22, v77, v85
    v_cvt_pk_bf16_f32 v26, v78, v86
    v_cvt_pk_bf16_f32 v66, v79, v87
    v_cvt_pk_bf16_f32 v70, v82, v90
    v_cvt_pk_bf16_f32 v74, v80, v88
    v_lshlrev_b32 v76, 16, v19
    v_and_b32 v84, s25, v19
    v_lshlrev_b32 v77, 16, v23
    v_and_b32 v85, s25, v23
    v_lshlrev_b32 v78, 16, v27
    v_and_b32 v86, s25, v27
    v_lshlrev_b32 v79, 16, v31
    v_and_b32 v87, s25, v31
    v_add_f32 v80, v76, v78
    v_add_f32 v88, v84, v86
    v_add_f32 v81, v77, v79
    v_add_f32 v89, v85, v87
    v_fma_f32 v82, v78, 4.0, v76
    v_fma_f32 v90, v86, 4.0, v84
    v_fma_f32 v83, v79, 4.0, v77
    v_fma_f32 v91, v87, 4.0, v85
    v_add_f32 v77, v80, v81
    v_add_f32 v85, v88, v89
    v_sub_f32 v78, v80, v81
    v_sub_f32 v86, v88, v89
    v_fma_f32 v79, v83, 2.0, v82
    v_fma_f32 v87, v91, 2.0, v90
    v_fma_f32 v82, v83, -2.0, v82
    v_fma_f32 v90, v91, -2.0, v90
    v_fmamk_f32 v80, v76, 0x41700000, v82
    v_fmamk_f32 v88, v84, 0x41700000, v90
    v_fmamk_f32 v80, v81, 0x41200000, v80
    v_fmamk_f32 v88, v89, 0x41200000, v88
    v_cvt_pk_bf16_f32 v23, v77, v85
    v_cvt_pk_bf16_f32 v27, v78, v86
    v_cvt_pk_bf16_f32 v67, v79, v87
    v_cvt_pk_bf16_f32 v71, v82, v90
    v_cvt_pk_bf16_f32 v75, v80, v88
L_conv1_kernel_hloop2:
    s_cmp_lt_u32 s28, 12
    s_cselect_b32 s24, 0, 2130706432
    ds_write_b128 v96, v[64:67] offset:57344
    ds_write_b128 v97, v[68:71] offset:8192
    ds_write_b128 v97, v[72:75] offset:24576
    ds_write_b128 v96, v[16:19] offset:8192
    ds_write_b128 v96, v[20:23] offset:24576
    ds_write_b128 v96, v[24:27] offset:40960
    ds_write_b128 v98, v[28:31] offset:8704
    s_waitcnt vmcnt(0)
    buffer_load_dwordx4 v[0:3], v92, s[8:11], s24 offen offset:0
    buffer_load_dwordx4 v[16:19], v92, s[8:11], s24 offen offset:64
    v_add_u32 v92, 128, v92
    buffer_load_dwordx4 v[4:7], v93, s[8:11], s24 offen offset:0
    buffer_load_dwordx4 v[20:23], v93, s[8:11], s24 offen offset:64
    v_add_u32 v93, 128, v93
    v_lshlrev_b32 v76, 16, v32
    v_and_b32 v84, s25, v32
    v_lshlrev_b32 v77, 16, v36
    v_and_b32 v85, s25, v36
    v_lshlrev_b32 v78, 16, v40
    v_and_b32 v86, s25, v40
    v_lshlrev_b32 v79, 16, v44
    v_and_b32 v87, s25, v44
    v_add_f32 v80, v76, v78
    v_add_f32 v88, v84, v86
    v_add_f32 v81, v77, v79
    v_add_f32 v89, v85, v87
    v_fma_f32 v82, v78, 4.0, v76
    v_fma_f32 v90, v86, 4.0, v84
    v_fma_f32 v83, v79, 4.0, v77
    v_fma_f32 v91, v87, 4.0, v85
    v_add_f32 v77, v80, v81
    v_add_f32 v85, v88, v89
    v_sub_f32 v78, v80, v81
    v_sub_f32 v86, v88, v89
    v_fma_f32 v79, v83, 2.0, v82
    v_fma_f32 v87, v91, 2.0, v90
    v_fma_f32 v82, v83, -2.0, v82
    v_fma_f32 v90, v91, -2.0, v90
    v_fmamk_f32 v80, v76, 0x41700000, v82
    v_fmamk_f32 v88, v84, 0x41700000, v90
    v_fmamk_f32 v80, v81, 0x41200000, v80
    v_fmamk_f32 v88, v89, 0x41200000, v88
    v_cvt_pk_bf16_f32 v36, v77, v85
    v_cvt_pk_bf16_f32 v40, v78, v86
    v_cvt_pk_bf16_f32 v64, v79, v87
    v_cvt_pk_bf16_f32 v68, v82, v90
    v_cvt_pk_bf16_f32 v72, v80, v88
    v_lshlrev_b32 v76, 16, v33
    v_and_b32 v84, s25, v33
    v_lshlrev_b32 v77, 16, v37
    v_and_b32 v85, s25, v37
    v_lshlrev_b32 v78, 16, v41
    v_and_b32 v86, s25, v41
    v_lshlrev_b32 v79, 16, v45
    v_and_b32 v87, s25, v45
    v_add_f32 v80, v76, v78
    v_add_f32 v88, v84, v86
    v_add_f32 v81, v77, v79
    v_add_f32 v89, v85, v87
    v_fma_f32 v82, v78, 4.0, v76
    v_fma_f32 v90, v86, 4.0, v84
    v_fma_f32 v83, v79, 4.0, v77
    v_fma_f32 v91, v87, 4.0, v85
    v_add_f32 v77, v80, v81
    v_add_f32 v85, v88, v89
    v_sub_f32 v78, v80, v81
    v_sub_f32 v86, v88, v89
    v_fma_f32 v79, v83, 2.0, v82
    v_fma_f32 v87, v91, 2.0, v90
    v_fma_f32 v82, v83, -2.0, v82
    v_fma_f32 v90, v91, -2.0, v90
    v_fmamk_f32 v80, v76, 0x41700000, v82
    v_fmamk_f32 v88, v84, 0x41700000, v90
    v_fmamk_f32 v80, v81, 0x41200000, v80
    v_fmamk_f32 v88, v89, 0x41200000, v88
    v_cvt_pk_bf16_f32 v37, v77, v85
    v_cvt_pk_bf16_f32 v41, v78, v86
    v_cvt_pk_bf16_f32 v65, v79, v87
    v_cvt_pk_bf16_f32 v69, v82, v90
    v_cvt_pk_bf16_f32 v73, v80, v88
    v_lshlrev_b32 v76, 16, v34
    v_and_b32 v84, s25, v34
    v_lshlrev_b32 v77, 16, v38
    v_and_b32 v85, s25, v38
    v_lshlrev_b32 v78, 16, v42
    v_and_b32 v86, s25, v42
    v_lshlrev_b32 v79, 16, v46
    v_and_b32 v87, s25, v46
    v_add_f32 v80, v76, v78
    v_add_f32 v88, v84, v86
    v_add_f32 v81, v77, v79
    v_add_f32 v89, v85, v87
    v_fma_f32 v82, v78, 4.0, v76
    v_fma_f32 v90, v86, 4.0, v84
    v_fma_f32 v83, v79, 4.0, v77
    v_fma_f32 v91, v87, 4.0, v85
    v_add_f32 v77, v80, v81
    v_add_f32 v85, v88, v89
    v_sub_f32 v78, v80, v81
    v_sub_f32 v86, v88, v89
    v_fma_f32 v79, v83, 2.0, v82
    v_fma_f32 v87, v91, 2.0, v90
    v_fma_f32 v82, v83, -2.0, v82
    v_fma_f32 v90, v91, -2.0, v90
    v_fmamk_f32 v80, v76, 0x41700000, v82
    v_fmamk_f32 v88, v84, 0x41700000, v90
    v_fmamk_f32 v80, v81, 0x41200000, v80
    v_fmamk_f32 v88, v89, 0x41200000, v88
    v_cvt_pk_bf16_f32 v38, v77, v85
    v_cvt_pk_bf16_f32 v42, v78, v86
    v_cvt_pk_bf16_f32 v66, v79, v87
    v_cvt_pk_bf16_f32 v70, v82, v90
    v_cvt_pk_bf16_f32 v74, v80, v88
    v_lshlrev_b32 v76, 16, v35
    v_and_b32 v84, s25, v35
    v_lshlrev_b32 v77, 16, v39
    v_and_b32 v85, s25, v39
    v_lshlrev_b32 v78, 16, v43
    v_and_b32 v86, s25, v43
    v_lshlrev_b32 v79, 16, v47
    v_and_b32 v87, s25, v47
    v_add_f32 v80, v76, v78
    v_add_f32 v88, v84, v86
    v_add_f32 v81, v77, v79
    v_add_f32 v89, v85, v87
    v_fma_f32 v82, v78, 4.0, v76
    v_fma_f32 v90, v86, 4.0, v84
    v_fma_f32 v83, v79, 4.0, v77
    v_fma_f32 v91, v87, 4.0, v85
    v_add_f32 v77, v80, v81
    v_add_f32 v85, v88, v89
    v_sub_f32 v78, v80, v81
    v_sub_f32 v86, v88, v89
    v_fma_f32 v79, v83, 2.0, v82
    v_fma_f32 v87, v91, 2.0, v90
    v_fma_f32 v82, v83, -2.0, v82
    v_fma_f32 v90, v91, -2.0, v90
    v_fmamk_f32 v80, v76, 0x41700000, v82
    v_fmamk_f32 v88, v84, 0x41700000, v90
    v_fmamk_f32 v80, v81, 0x41200000, v80
    v_fmamk_f32 v88, v89, 0x41200000, v88
    v_cvt_pk_bf16_f32 v39, v77, v85
    v_cvt_pk_bf16_f32 v43, v78, v86
    v_cvt_pk_bf16_f32 v67, v79, v87
    v_cvt_pk_bf16_f32 v71, v82, v90
    v_cvt_pk_bf16_f32 v75, v80, v88
    s_add_u32 s28, s28, 1
    s_waitcnt lgkmcnt(0)
    s_barrier
    s_cmp_lt_u32 s28, 12
    s_cselect_b32 s24, 0, 2130706432
    ds_write_b128 v96, v[64:67] offset:49152
    ds_write_b128 v97, v[68:71] offset:0
    ds_write_b128 v97, v[72:75] offset:16384
    ds_write_b128 v96, v[32:35] offset:0
    ds_write_b128 v96, v[36:39] offset:16384
    ds_write_b128 v96, v[40:43] offset:32768
    ds_write_b128 v98, v[44:47] offset:0
    buffer_load_dwordx4 v[8:11], v94, s[8:11], s24 offen offset:0
    buffer_load_dwordx4 v[24:27], v94, s[8:11], s24 offen offset:64
    v_add_u32 v94, 128, v94
    buffer_load_dwordx4 v[12:15], v95, s[8:11], s24 offen offset:0
    buffer_load_dwordx4 v[28:31], v95, s[8:11], s24 offen offset:64
    v_add_u32 v95, 128, v95
    v_lshlrev_b32 v76, 16, v48
    v_and_b32 v84, s25, v48
    v_lshlrev_b32 v77, 16, v52
    v_and_b32 v85, s25, v52
    v_lshlrev_b32 v78, 16, v56
    v_and_b32 v86, s25, v56
    v_lshlrev_b32 v79, 16, v60
    v_and_b32 v87, s25, v60
    v_add_f32 v80, v76, v78
    v_add_f32 v88, v84, v86
    v_add_f32 v81, v77, v79
    v_add_f32 v89, v85, v87
    v_fma_f32 v82, v78, 4.0, v76
    v_fma_f32 v90, v86, 4.0, v84
    v_fma_f32 v83, v79, 4.0, v77
    v_fma_f32 v91, v87, 4.0, v85
    v_add_f32 v77, v80, v81
    v_add_f32 v85, v88, v89
    v_sub_f32 v78, v80, v81
    v_sub_f32 v86, v88, v89
    v_fma_f32 v79, v83, 2.0, v82
    v_fma_f32 v87, v91, 2.0, v90
    v_fma_f32 v82, v83, -2.0, v82
    v_fma_f32 v90, v91, -2.0, v90
    v_fmamk_f32 v80, v76, 0x41700000, v82
    v_fmamk_f32 v88, v84, 0x41700000, v90
    v_fmamk_f32 v80, v81, 0x41200000, v80
    v_fmamk_f32 v88, v89, 0x41200000, v88
    v_cvt_pk_bf16_f32 v52, v77, v85
    v_cvt_pk_bf16_f32 v56, v78, v86
    v_cvt_pk_bf16_f32 v64, v79, v87
    v_cvt_pk_bf16_f32 v68, v82, v90
    v_cvt_pk_bf16_f32 v72, v80, v88
    v_lshlrev_b32 v76, 16, v49
    v_and_b32 v84, s25, v49
    v_lshlrev_b32 v77, 16, v53
    v_and_b32 v85, s25, v53
    v_lshlrev_b32 v78, 16, v57
    v_and_b32 v86, s25, v57
    v_lshlrev_b32 v79, 16, v61
    v_and_b32 v87, s25, v61
    v_add_f32 v80, v76, v78
    v_add_f32 v88, v84, v86
    v_add_f32 v81, v77, v79
    v_add_f32 v89, v85, v87
    v_fma_f32 v82, v78, 4.0, v76
    v_fma_f32 v90, v86, 4.0, v84
    v_fma_f32 v83, v79, 4.0, v77
    v_fma_f32 v91, v87, 4.0, v85
    v_add_f32 v77, v80, v81
    v_add_f32 v85, v88, v89
    v_sub_f32 v78, v80, v81
    v_sub_f32 v86, v88, v89
    v_fma_f32 v79, v83, 2.0, v82
    v_fma_f32 v87, v91, 2.0, v90
    v_fma_f32 v82, v83, -2.0, v82
    v_fma_f32 v90, v91, -2.0, v90
    v_fmamk_f32 v80, v76, 0x41700000, v82
    v_fmamk_f32 v88, v84, 0x41700000, v90
    v_fmamk_f32 v80, v81, 0x41200000, v80
    v_fmamk_f32 v88, v89, 0x41200000, v88
    v_cvt_pk_bf16_f32 v53, v77, v85
    v_cvt_pk_bf16_f32 v57, v78, v86
    v_cvt_pk_bf16_f32 v65, v79, v87
    v_cvt_pk_bf16_f32 v69, v82, v90
    v_cvt_pk_bf16_f32 v73, v80, v88
    v_lshlrev_b32 v76, 16, v50
    v_and_b32 v84, s25, v50
    v_lshlrev_b32 v77, 16, v54
    v_and_b32 v85, s25, v54
    v_lshlrev_b32 v78, 16, v58
    v_and_b32 v86, s25, v58
    v_lshlrev_b32 v79, 16, v62
    v_and_b32 v87, s25, v62
    v_add_f32 v80, v76, v78
    v_add_f32 v88, v84, v86
    v_add_f32 v81, v77, v79
    v_add_f32 v89, v85, v87
    v_fma_f32 v82, v78, 4.0, v76
    v_fma_f32 v90, v86, 4.0, v84
    v_fma_f32 v83, v79, 4.0, v77
    v_fma_f32 v91, v87, 4.0, v85
    v_add_f32 v77, v80, v81
    v_add_f32 v85, v88, v89
    v_sub_f32 v78, v80, v81
    v_sub_f32 v86, v88, v89
    v_fma_f32 v79, v83, 2.0, v82
    v_fma_f32 v87, v91, 2.0, v90
    v_fma_f32 v82, v83, -2.0, v82
    v_fma_f32 v90, v91, -2.0, v90
    v_fmamk_f32 v80, v76, 0x41700000, v82
    v_fmamk_f32 v88, v84, 0x41700000, v90
    v_fmamk_f32 v80, v81, 0x41200000, v80
    v_fmamk_f32 v88, v89, 0x41200000, v88
    v_cvt_pk_bf16_f32 v54, v77, v85
    v_cvt_pk_bf16_f32 v58, v78, v86
    v_cvt_pk_bf16_f32 v66, v79, v87
    v_cvt_pk_bf16_f32 v70, v82, v90
    v_cvt_pk_bf16_f32 v74, v80, v88
    v_lshlrev_b32 v76, 16, v51
    v_and_b32 v84, s25, v51
    v_lshlrev_b32 v77, 16, v55
    v_and_b32 v85, s25, v55
    v_lshlrev_b32 v78, 16, v59
    v_and_b32 v86, s25, v59
    v_lshlrev_b32 v79, 16, v63
    v_and_b32 v87, s25, v63
    v_add_f32 v80, v76, v78
    v_add_f32 v88, v84, v86
    v_add_f32 v81, v77, v79
    v_add_f32 v89, v85, v87
    v_fma_f32 v82, v78, 4.0, v76
    v_fma_f32 v90, v86, 4.0, v84
    v_fma_f32 v83, v79, 4.0, v77
    v_fma_f32 v91, v87, 4.0, v85
    v_add_f32 v77, v80, v81
    v_add_f32 v85, v88, v89
    v_sub_f32 v78, v80, v81
    v_sub_f32 v86, v88, v89
    v_fma_f32 v79, v83, 2.0, v82
    v_fma_f32 v87, v91, 2.0, v90
    v_fma_f32 v82, v83, -2.0, v82
    v_fma_f32 v90, v91, -2.0, v90
    v_fmamk_f32 v80, v76, 0x41700000, v82
    v_fmamk_f32 v88, v84, 0x41700000, v90
    v_fmamk_f32 v80, v81, 0x41200000, v80
    v_fmamk_f32 v88, v89, 0x41200000, v88
    v_cvt_pk_bf16_f32 v55, v77, v85
    v_cvt_pk_bf16_f32 v59, v78, v86
    v_cvt_pk_bf16_f32 v67, v79, v87
    v_cvt_pk_bf16_f32 v71, v82, v90
    v_cvt_pk_bf16_f32 v75, v80, v88
    s_add_u32 s28, s28, 1
    s_waitcnt lgkmcnt(0)
    s_barrier
    s_cmp_eq_u32 s22, 1
    s_cbranch_scc1 L_conv1_kernel_hlast2
    s_cmp_lt_u32 s28, 12
    s_cselect_b32 s24, 0, 2130706432
    ds_write_b128 v96, v[64:67] offset:57344
    ds_write_b128 v97, v[68:71] offset:8192
    ds_write_b128 v97, v[72:75] offset:24576
    ds_write_b128 v96, v[48:51] offset:8192
    ds_write_b128 v96, v[52:55] offset:24576
    ds_write_b128 v96, v[56:59] offset:40960
    ds_write_b128 v98, v[60:63] offset:8704
    s_waitcnt vmcnt(0)
    buffer_load_dwordx4 v[32:35], v92, s[8:11], s24 offen offset:0
    buffer_load_dwordx4 v[48:51], v92, s[8:11], s24 offen offset:64
    v_add_u32 v92, 128, v92
    buffer_load_dwordx4 v[36:39], v93, s[8:11], s24 offen offset:0
    buffer_load_dwordx4 v[52:55], v93, s[8:11], s24 offen offset:64
    v_add_u32 v93, 128, v93
    v_lshlrev_b32 v76, 16, v0
    v_and_b32 v84, s25, v0
    v_lshlrev_b32 v77, 16, v4
    v_and_b32 v85, s25, v4
    v_lshlrev_b32 v78, 16, v8
    v_and_b32 v86, s25, v8
    v_lshlrev_b32 v79, 16, v12
    v_and_b32 v87, s25, v12
    v_add_f32 v80, v76, v78
    v_add_f32 v88, v84, v86
    v_add_f32 v81, v77, v79
    v_add_f32 v89, v85, v87
    v_fma_f32 v82, v78, 4.0, v76
    v_fma_f32 v90, v86, 4.0, v84
    v_fma_f32 v83, v79, 4.0, v77
    v_fma_f32 v91, v87, 4.0, v85
    v_add_f32 v77, v80, v81
    v_add_f32 v85, v88, v89
    v_sub_f32 v78, v80, v81
    v_sub_f32 v86, v88, v89
    v_fma_f32 v79, v83, 2.0, v82
    v_fma_f32 v87, v91, 2.0, v90
    v_fma_f32 v82, v83, -2.0, v82
    v_fma_f32 v90, v91, -2.0, v90
    v_fmamk_f32 v80, v76, 0x41700000, v82
    v_fmamk_f32 v88, v84, 0x41700000, v90
    v_fmamk_f32 v80, v81, 0x41200000, v80
    v_fmamk_f32 v88, v89, 0x41200000, v88
    v_cvt_pk_bf16_f32 v4, v77, v85
    v_cvt_pk_bf16_f32 v8, v78, v86
    v_cvt_pk_bf16_f32 v64, v79, v87
    v_cvt_pk_bf16_f32 v68, v82, v90
    v_cvt_pk_bf16_f32 v72, v80, v88
    v_lshlrev_b32 v76, 16, v1
    v_and_b32 v84, s25, v1
    v_lshlrev_b32 v77, 16, v5
    v_and_b32 v85, s25, v5
    v_lshlrev_b32 v78, 16, v9
    v_and_b32 v86, s25, v9
    v_lshlrev_b32 v79, 16, v13
    v_and_b32 v87, s25, v13
    v_add_f32 v80, v76, v78
    v_add_f32 v88, v84, v86
    v_add_f32 v81, v77, v79
    v_add_f32 v89, v85, v87
    v_fma_f32 v82, v78, 4.0, v76
    v_fma_f32 v90, v86, 4.0, v84
    v_fma_f32 v83, v79, 4.0, v77
    v_fma_f32 v91, v87, 4.0, v85
    v_add_f32 v77, v80, v81
    v_add_f32 v85, v88, v89
    v_sub_f32 v78, v80, v81
    v_sub_f32 v86, v88, v89
    v_fma_f32 v79, v83, 2.0, v82
    v_fma_f32 v87, v91, 2.0, v90
    v_fma_f32 v82, v83, -2.0, v82
    v_fma_f32 v90, v91, -2.0, v90
    v_fmamk_f32 v80, v76, 0x41700000, v82
    v_fmamk_f32 v88, v84, 0x41700000, v90
    v_fmamk_f32 v80, v81, 0x41200000, v80
    v_fmamk_f32 v88, v89, 0x41200000, v88
    v_cvt_pk_bf16_f32 v5, v77, v85
    v_cvt_pk_bf16_f32 v9, v78, v86
    v_cvt_pk_bf16_f32 v65, v79, v87
    v_cvt_pk_bf16_f32 v69, v82, v90
    v_cvt_pk_bf16_f32 v73, v80, v88
    v_lshlrev_b32 v76, 16, v2
    v_and_b32 v84, s25, v2
    v_lshlrev_b32 v77, 16, v6
    v_and_b32 v85, s25, v6
    v_lshlrev_b32 v78, 16, v10
    v_and_b32 v86, s25, v10
    v_lshlrev_b32 v79, 16, v14
    v_and_b32 v87, s25, v14
    v_add_f32 v80, v76, v78
    v_add_f32 v88, v84, v86
    v_add_f32 v81, v77, v79
    v_add_f32 v89, v85, v87
    v_fma_f32 v82, v78, 4.0, v76
    v_fma_f32 v90, v86, 4.0, v84
    v_fma_f32 v83, v79, 4.0, v77
    v_fma_f32 v91, v87, 4.0, v85
    v_add_f32 v77, v80, v81
    v_add_f32 v85, v88, v89
    v_sub_f32 v78, v80, v81
    v_sub_f32 v86, v88, v89
    v_fma_f32 v79, v83, 2.0, v82
    v_fma_f32 v87, v91, 2.0, v90
    v_fma_f32 v82, v83, -2.0, v82
    v_fma_f32 v90, v91, -2.0, v90
    v_fmamk_f32 v80, v76, 0x41700000, v82
    v_fmamk_f32 v88, v84, 0x41700000, v90
    v_fmamk_f32 v80, v81, 0x41200000, v80
    v_fmamk_f32 v88, v89, 0x41200000, v88
    v_cvt_pk_bf16_f32 v6, v77, v85
    v_cvt_pk_bf16_f32 v10, v78, v86
    v_cvt_pk_bf16_f32 v66, v79, v87
    v_cvt_pk_bf16_f32 v70, v82, v90
    v_cvt_pk_bf16_f32 v74, v80, v88
    v_lshlrev_b32 v76, 16, v3
    v_and_b32 v84, s25, v3
    v_lshlrev_b32 v77, 16, v7
    v_and_b32 v85, s25, v7
    v_lshlrev_b32 v78, 16, v11
    v_and_b32 v86, s25, v11
    v_lshlrev_b32 v79, 16, v15
    v_and_b32 v87, s25, v15
    v_add_f32 v80, v76, v78
    v_add_f32 v88, v84, v86
    v_add_f32 v81, v77, v79
    v_add_f32 v89, v85, v87
    v_fma_f32 v82, v78, 4.0, v76
    v_fma_f32 v90, v86, 4.0, v84
    v_fma_f32 v83, v79, 4.0, v77
    v_fma_f32 v91, v87, 4.0, v85
    v_add_f32 v77, v80, v81
    v_add_f32 v85, v88, v89
    v_sub_f32 v78, v80, v81
    v_sub_f32 v86, v88, v89
    v_fma_f32 v79, v83, 2.0, v82
    v_fma_f32 v87, v91, 2.0, v90
    v_fma_f32 v82, v83, -2.0, v82
    v_fma_f32 v90, v91, -2.0, v90
    v_fmamk_f32 v80, v76, 0x41700000, v82
    v_fmamk_f32 v88, v84, 0x41700000, v90
    v_fmamk_f32 v80, v81, 0x41200000, v80
    v_fmamk_f32 v88, v89, 0x41200000, v88
    v_cvt_pk_bf16_f32 v7, v77, v85
    v_cvt_pk_bf16_f32 v11, v78, v86
    v_cvt_pk_bf16_f32 v67, v79, v87
    v_cvt_pk_bf16_f32 v71, v82, v90
    v_cvt_pk_bf16_f32 v75, v80, v88
    s_add_u32 s28, s28, 1
    s_waitcnt lgkmcnt(0)
    s_barrier
    s_cmp_lt_u32 s28, 12
    s_cselect_b32 s24, 0, 2130706432
    ds_write_b128 v96, v[64:67] offset:49152
    ds_write_b128 v97, v[68:71] offset:0
    ds_write_b128 v97, v[72:75] offset:16384
    ds_write_b128 v96, v[0:3] offset:0
    ds_write_b128 v96, v[4:7] offset:16384
    ds_write_b128 v96, v[8:11] offset:32768
    ds_write_b128 v98, v[12:15] offset:0
    buffer_load_dwordx4 v[40:43], v94, s[8:11], s24 offen offset:0
    buffer_load_dwordx4 v[56:59], v94, s[8:11], s24 offen offset:64
    v_add_u32 v94, 128, v94
    buffer_load_dwordx4 v[44:47], v95, s[8:11], s24 offen offset:0
    buffer_load_dwordx4 v[60:63], v95, s[8:11], s24 offen offset:64
    v_add_u32 v95, 128, v95
    v_lshlrev_b32 v76, 16, v16
    v_and_b32 v84, s25, v16
    v_lshlrev_b32 v77, 16, v20
    v_and_b32 v85, s25, v20
    v_lshlrev_b32 v78, 16, v24
    v_and_b32 v86, s25, v24
    v_lshlrev_b32 v79, 16, v28
    v_and_b32 v87, s25, v28
    v_add_f32 v80, v76, v78
    v_add_f32 v88, v84, v86
    v_add_f32 v81, v77, v79
    v_add_f32 v89, v85, v87
    v_fma_f32 v82, v78, 4.0, v76
    v_fma_f32 v90, v86, 4.0, v84
    v_fma_f32 v83, v79, 4.0, v77
    v_fma_f32 v91, v87, 4.0, v85
    v_add_f32 v77, v80, v81
    v_add_f32 v85, v88, v89
    v_sub_f32 v78, v80, v81
    v_sub_f32 v86, v88, v89
    v_fma_f32 v79, v83, 2.0, v82
    v_fma_f32 v87, v91, 2.0, v90
    v_fma_f32 v82, v83, -2.0, v82
    v_fma_f32 v90, v91, -2.0, v90
    v_fmamk_f32 v80, v76, 0x41700000, v82
    v_fmamk_f32 v88, v84, 0x41700000, v90
    v_fmamk_f32 v80, v81, 0x41200000, v80
    v_fmamk_f32 v88, v89, 0x41200000, v88
    v_cvt_pk_bf16_f32 v20, v77, v85
    v_cvt_pk_bf16_f32 v24, v78, v86
    v_cvt_pk_bf16_f32 v64, v79, v87
    v_cvt_pk_bf16_f32 v68, v82, v90
    v_cvt_pk_bf16_f32 v72, v80, v88
    v_lshlrev_b32 v76, 16, v17
    v_and_b32 v84, s25, v17
    v_lshlrev_b32 v77, 16, v21
    v_and_b32 v85, s25, v21
    v_lshlrev_b32 v78, 16, v25
    v_and_b32 v86, s25, v25
    v_lshlrev_b32 v79, 16, v29
    v_and_b32 v87, s25, v29
    v_add_f32 v80, v76, v78
    v_add_f32 v88, v84, v86
    v_add_f32 v81, v77, v79
    v_add_f32 v89, v85, v87
    v_fma_f32 v82, v78, 4.0, v76
    v_fma_f32 v90, v86, 4.0, v84
    v_fma_f32 v83, v79, 4.0, v77
    v_fma_f32 v91, v87, 4.0, v85
    v_add_f32 v77, v80, v81
    v_add_f32 v85, v88, v89
    v_sub_f32 v78, v80, v81
    v_sub_f32 v86, v88, v89
    v_fma_f32 v79, v83, 2.0, v82
    v_fma_f32 v87, v91, 2.0, v90
    v_fma_f32 v82, v83, -2.0, v82
    v_fma_f32 v90, v91, -2.0, v90
    v_fmamk_f32 v80, v76, 0x41700000, v82
    v_fmamk_f32 v88, v84, 0x41700000, v90
    v_fmamk_f32 v80, v81, 0x41200000, v80
    v_fmamk_f32 v88, v89, 0x41200000, v88
    v_cvt_pk_bf16_f32 v21, v77, v85
    v_cvt_pk_bf16_f32 v25, v78, v86
    v_cvt_pk_bf16_f32 v65, v79, v87
    v_cvt_pk_bf16_f32 v69, v82, v90
    v_cvt_pk_bf16_f32 v73, v80, v88
    v_lshlrev_b32 v76, 16, v18
    v_and_b32 v84, s25, v18
    v_lshlrev_b32 v77, 16, v22
    v_and_b32 v85, s25, v22
    v_lshlrev_b32 v78, 16, v26
    v_and_b32 v86, s25, v26
    v_lshlrev_b32 v79, 16, v30
    v_and_b32 v87, s25, v30
    v_add_f32 v80, v76, v78
    v_add_f32 v88, v84, v86
    v_add_f32 v81, v77, v79
    v_add_f32 v89, v85, v87
    v_fma_f32 v82, v78, 4.0, v76
    v_fma_f32 v90, v86, 4.0, v84
    v_fma_f32 v83, v79, 4.0, v77
    v_fma_f32 v91, v87, 4.0, v85
    v_add_f32 v77, v80, v81
    v_add_f32 v85, v88, v89
    v_sub_f32 v78, v80, v81
    v_sub_f32 v86, v88, v89
    v_fma_f32 v79, v83, 2.0, v82
    v_fma_f32 v87, v91, 2.0, v90
    v_fma_f32 v82, v83, -2.0, v82
    v_fma_f32 v90, v91, -2.0, v90
    v_fmamk_f32 v80, v76, 0x41700000, v82
    v_fmamk_f32 v88, v84, 0x41700000, v90
    v_fmamk_f32 v80, v81, 0x41200000, v80
    v_fmamk_f32 v88, v89, 0x41200000, v88
    v_cvt_pk_bf16_f32 v22, v77, v85
    v_cvt_pk_bf16_f32 v26, v78, v86
    v_cvt_pk_bf16_f32 v66, v79, v87
    v_cvt_pk_bf16_f32 v70, v82, v90
    v_cvt_pk_bf16_f32 v74, v80, v88
    v_lshlrev_b32 v76, 16, v19
    v_and_b32 v84, s25, v19
    v_lshlrev_b32 v77, 16, v23
    v_and_b32 v85, s25, v23
    v_lshlrev_b32 v78, 16, v27
    v_and_b32 v86, s25, v27
    v_lshlrev_b32 v79, 16, v31
    v_and_b32 v87, s25, v31
    v_add_f32 v80, v76, v78
    v_add_f32 v88, v84, v86
    v_add_f32 v81, v77, v79
    v_add_f32 v89, v85, v87
    v_fma_f32 v82, v78, 4.0, v76
    v_fma_f32 v90, v86, 4.0, v84
    v_fma_f32 v83, v79, 4.0, v77
    v_fma_f32 v91, v87, 4.0, v85
    v_add_f32 v77, v80, v81
    v_add_f32 v85, v88, v89
    v_sub_f32 v78, v80, v81
    v_sub_f32 v86, v88, v89
    v_fma_f32 v79, v83, 2.0, v82
    v_fma_f32 v87, v91, 2.0, v90
    v_fma_f32 v82, v83, -2.0, v82
    v_fma_f32 v90, v91, -2.0, v90
    v_fmamk_f32 v80, v76, 0x41700000, v82
    v_fmamk_f32 v88, v84, 0x41700000, v90
    v_fmamk_f32 v80, v81, 0x41200000, v80
    v_fmamk_f32 v88, v89, 0x41200000, v88
    v_cvt_pk_bf16_f32 v23, v77, v85
    v_cvt_pk_bf16_f32 v27, v78, v86
    v_cvt_pk_bf16_f32 v67, v79, v87
    v_cvt_pk_bf16_f32 v71, v82, v90
    v_cvt_pk_bf16_f32 v75, v80, v88
    s_add_u32 s28, s28, 1
    s_waitcnt lgkmcnt(0)
    s_barrier
    s_sub_u32 s22, s22, 1
    s_branch L_conv1_kernel_hloop2
L_conv1_kernel_hlast2:
    s_waitcnt vmcnt(0)
    s_mov_b32 s58, s20
    s_lshl_b32 s20, s2, 2
    s_add_u32 s20, s20, s32
    v_mov_b32 v1, v127
    s_load_dwordx2 s[8:9], s[0:1], 16
    s_lshr_b32 s22, s20, 8
    s_bfe_u32 s23, s20, 0x40004
    s_bfe_u32 s24, s20, 0x30001
    s_and_b32 s21, s20, 1
    v_lshrrev_b32 v2, 4, v1
    v_lshlrev_b32 v2, 12, v2
    v_and_b32 v3, 15, v1
    v_lshl_add_u32 v2, v3, 2, v2
    s_lshl_b32 s26, s22, 3
    s_lshr_b32 s27, s23, 3
    s_add_u32 s26, s26, s27
    s_lshl_b32 s26, s26, 17
    s_and_b32 s27, s23, 7
    s_lshl_b32 s27, s27, 14
    s_add_u32 s26, s26, s27
    s_lshl_b32 s27, s24, 6
    s_add_u32 s26, s26, s27
    s_mov_b32 s10, 4063232
    s_mov_b32 s11, 0x00020000
    s_add_u32 s37, s26, 262144
    s_add_u32 s38, s26, 524288
    s_add_u32 s39, s26, 786432
    s_waitcnt lgkmcnt(0)
    buffer_load_dword v16, v2, s[8:11], s26 offen offset:0
    buffer_load_dword v17, v2, s[8:11], s26 offen offset:512
    buffer_load_dword v24, v2, s[8:11], s37 offen offset:0
    buffer_load_dword v25, v2, s[8:11], s37 offen offset:512
    buffer_load_dword v32, v2, s[8:11], s38 offen offset:0
    buffer_load_dword v33, v2, s[8:11], s38 offen offset:512
    buffer_load_dword v40, v2, s[8:11], s39 offen offset:0
    buffer_load_dword v41, v2, s[8:11], s39 offen offset:512
    buffer_load_dword v18, v2, s[8:11], s26 offen offset:1024
    buffer_load_dword v19, v2, s[8:11], s26 offen offset:1536
    buffer_load_dword v26, v2, s[8:11], s37 offen offset:1024
    buffer_load_dword v27, v2, s[8:11], s37 offen offset:1536
    buffer_load_dword v34, v2, s[8:11], s38 offen offset:1024
    buffer_load_dword v35, v2, s[8:11], s38 offen offset:1536
    buffer_load_dword v42, v2, s[8:11], s39 offen offset:1024
    buffer_load_dword v43, v2, s[8:11], s39 offen offset:1536
    buffer_load_dword v20, v2, s[8:11], s26 offen offset:2048
    buffer_load_dword v21, v2, s[8:11], s26 offen offset:2560
    buffer_load_dword v28, v2, s[8:11], s37 offen offset:2048
    buffer_load_dword v29, v2, s[8:11], s37 offen offset:2560
    buffer_load_dword v36, v2, s[8:11], s38 offen offset:2048
    buffer_load_dword v37, v2, s[8:11], s38 offen offset:2560
    buffer_load_dword v44, v2, s[8:11], s39 offen offset:2048
    buffer_load_dword v45, v2, s[8:11], s39 offen offset:2560
    buffer_load_dword v22, v2, s[8:11], s26 offen offset:3072
    buffer_load_dword v23, v2, s[8:11], s26 offen offset:3584
    buffer_load_dword v30, v2, s[8:11], s37 offen offset:3072
    buffer_load_dword v31, v2, s[8:11], s37 offen offset:3584
    buffer_load_dword v38, v2, s[8:11], s38 offen offset:3072
    buffer_load_dword v39, v2, s[8:11], s38 offen offset:3584
    buffer_load_dword v46, v2, s[8:11], s39 offen offset:3072
    buffer_load_dword v47, v2, s[8:11], s39 offen offset:3584
    s_add_u32 s12, s30, 9437184
    s_addc_u32 s13, s31, 0
    s_mov_b32 s14, 7340032
    s_mov_b32 s15, 0x00020000
    v_lshlrev_b32 v4, 4, v1
    s_lshl_b32 s27, s24, 4
    s_add_u32 s27, s27, s23
    s_mul_i32 s27, s27, 57344
    s_lshl_b32 s28, s22, 11
    s_add_u32 s27, s27, s28
    s_lshl_b32 s28, s21, 10
    s_add_u32 s27, s27, s28
    s_cmp_eq_u32 s21, 0
    s_mov_b32 s32, 0x07060302
    s_cselect_b32 s32, 0x05040100, s32
    s_mov_b32 s33, 0x03020c0c
    s_cselect_b32 s33, 0x01000c0c, s33
    s_mov_b32 s35, 0x3d2aaaab
    s_mov_b32 s36, 0x3c638e39
    s_mov_b32 s25, 0xffff0000
    ds_write_b128 v96, v[64:67] offset:57344
    ds_write_b128 v97, v[68:71] offset:8192
    ds_write_b128 v97, v[72:75] offset:24576
    ds_write_b128 v96, v[48:51] offset:8192
    ds_write_b128 v96, v[52:55] offset:24576
    ds_write_b128 v96, v[56:59] offset:40960
    ds_write_b128 v98, v[60:63] offset:8704
    s_waitcnt lgkmcnt(0)
    s_barrier
    s_waitcnt vmcnt(24)
    v_perm_b32 v72, v17, v16, s32
    v_perm_b32 v48, v41, v40, s32
    v_perm_b32 v76, v76, v40, s33
    v_perm_b32 v84, v84, v41, s33
    v_perm_b32 v77, v77, v32, s33
    v_perm_b32 v85, v85, v33, s33
    v_perm_b32 v78, v78, v24, s33
    v_perm_b32 v86, v86, v25, s33
    v_perm_b32 v79, v79, v16, s33
    v_perm_b32 v87, v87, v17, s33
    v_add_f32 v80, v76, v78
    v_add_f32 v88, v84, v86
    v_add_f32 v81, v77, v79
    v_add_f32 v89, v85, v87
    v_fma_f32 v82, v78, 4.0, v76
    v_fma_f32 v90, v86, 4.0, v84
    v_fma_f32 v83, v79, 4.0, v77
    v_fma_f32 v91, v87, 4.0, v85
    v_add_f32 v77, v80, v81
    v_add_f32 v85, v88, v89
    v_sub_f32 v78, v80, v81
    v_sub_f32 v86, v88, v89
    v_fma_f32 v79, v83, 2.0, v82
    v_fma_f32 v87, v91, 2.0, v90
    v_fma_f32 v82, v83, -2.0, v82
    v_fma_f32 v90, v91, -2.0, v90
    v_fmamk_f32 v80, v76, 0x41700000, v82
    v_fmamk_f32 v88, v84, 0x41700000, v90
    v_fmamk_f32 v80, v81, 0x41200000, v80
    v_fmamk_f32 v88, v89, 0x41200000, v88
    v_mul_f32 v77, 0.5, v77
    v_mul_f32 v85, 0.5, v85
    v_mul_f32 v78, 0.5, v78
    v_mul_f32 v86, 0.5, v86
    v_mul_f32 v79, s35, v79
    v_mul_f32 v87, s35, v87
    v_mul_f32 v82, s35, v82
    v_mul_f32 v90, s35, v90
    v_mul_f32 v80, s36, v80
    v_mul_f32 v88, s36, v88
    v_cvt_pk_bf16_f32 v52, v77, v85
    v_cvt_pk_bf16_f32 v56, v78, v86
    v_cvt_pk_bf16_f32 v60, v79, v87
    v_cvt_pk_bf16_f32 v64, v82, v90
    v_cvt_pk_bf16_f32 v68, v80, v88
    s_waitcnt vmcnt(16)
    v_perm_b32 v73, v19, v18, s32
    v_perm_b32 v49, v43, v42, s32
    v_perm_b32 v76, v76, v42, s33
    v_perm_b32 v84, v84, v43, s33
    v_perm_b32 v77, v77, v34, s33
    v_perm_b32 v85, v85, v35, s33
    v_perm_b32 v78, v78, v26, s33
    v_perm_b32 v86, v86, v27, s33
    v_perm_b32 v79, v79, v18, s33
    v_perm_b32 v87, v87, v19, s33
    v_add_f32 v80, v76, v78
    v_add_f32 v88, v84, v86
    v_add_f32 v81, v77, v79
    v_add_f32 v89, v85, v87
    v_fma_f32 v82, v78, 4.0, v76
    v_fma_f32 v90, v86, 4.0, v84
    v_fma_f32 v83, v79, 4.0, v77
    v_fma_f32 v91, v87, 4.0, v85
    v_add_f32 v77, v80, v81
    v_add_f32 v85, v88, v89
    v_sub_f32 v78, v80, v81
    v_sub_f32 v86, v88, v89
    v_fma_f32 v79, v83, 2.0, v82
    v_fma_f32 v87, v91, 2.0, v90
    v_fma_f32 v82, v83, -2.0, v82
    v_fma_f32 v90, v91, -2.0, v90
    v_fmamk_f32 v80, v76, 0x41700000, v82
    v_fmamk_f32 v88, v84, 0x41700000, v90
    v_fmamk_f32 v80, v81, 0x41200000, v80
    v_fmamk_f32 v88, v89, 0x41200000, v88
    v_mul_f32 v77, 0.5, v77
    v_mul_f32 v85, 0.5, v85
    v_mul_f32 v78, 0.5, v78
    v_mul_f32 v86, 0.5, v86
    v_mul_f32 v79, s35, v79
    v_mul_f32 v87, s35, v87
    v_mul_f32 v82, s35, v82
    v_mul_f32 v90, s35, v90
    v_mul_f32 v80, s36, v80
    v_mul_f32 v88, s36, v88
    v_cvt_pk_bf16_f32 v53, v77, v85
    v_cvt_pk_bf16_f32 v57, v78, v86
    v_cvt_pk_bf16_f32 v61, v79, v87
    v_cvt_pk_bf16_f32 v65, v82, v90
    v_cvt_pk_bf16_f32 v69, v80, v88
    s_waitcnt vmcnt(8)
    v_perm_b32 v74, v21, v20, s32
    v_perm_b32 v50, v45, v44, s32
    v_perm_b32 v76, v76, v44, s33
    v_perm_b32 v84, v84, v45, s33
    v_perm_b32 v77, v77, v36, s33
    v_perm_b32 v85, v85, v37, s33
    v_perm_b32 v78, v78, v28, s33
    v_perm_b32 v86, v86, v29, s33
    v_perm_b32 v79, v79, v20, s33
    v_perm_b32 v87, v87, v21, s33
    v_add_f32 v80, v76, v78
    v_add_f32 v88, v84, v86
    v_add_f32 v81, v77, v79
    v_add_f32 v89, v85, v87
    v_fma_f32 v82, v78, 4.0, v76
    v_fma_f32 v90, v86, 4.0, v84
    v_fma_f32 v83, v79, 4.0, v77
    v_fma_f32 v91, v87, 4.0, v85
    v_add_f32 v77, v80, v81
    v_add_f32 v85, v88, v89
    v_sub_f32 v78, v80, v81
    v_sub_f32 v86, v88, v89
    v_fma_f32 v79, v83, 2.0, v82
    v_fma_f32 v87, v91, 2.0, v90
    v_fma_f32 v82, v83, -2.0, v82
    v_fma_f32 v90, v91, -2.0, v90
    v_fmamk_f32 v80, v76, 0x41700000, v82
    v_fmamk_f32 v88, v84, 0x41700000, v90
    v_fmamk_f32 v80, v81, 0x41200000, v80
    v_fmamk_f32 v88, v89, 0x41200000, v88
    v_mul_f32 v77, 0.5, v77
    v_mul_f32 v85, 0.5, v85
    v_mul_f32 v78, 0.5, v78
    v_mul_f32 v86, 0.5, v86
    v_mul_f32 v79, s35, v79
    v_mul_f32 v87, s35, v87
    v_mul_f32 v82, s35, v82
    v_mul_f32 v90, s35, v90
    v_mul_f32 v80, s36, v80
    v_mul_f32 v88, s36, v88
    v_cvt_pk_bf16_f32 v54, v77, v85
    v_cvt_pk_bf16_f32 v58, v78, v86
    v_cvt_pk_bf16_f32 v62, v79, v87
    v_cvt_pk_bf16_f32 v66, v82, v90
    v_cvt_pk_bf16_f32 v70, v80, v88
    s_waitcnt vmcnt(0)
    v_perm_b32 v75, v23, v22, s32
    v_perm_b32 v51, v47, v46, s32
    v_perm_b32 v76, v76, v46, s33
    v_perm_b32 v84, v84, v47, s33
    v_perm_b32 v77, v77, v38, s33
    v_perm_b32 v85, v85, v39, s33
    v_perm_b32 v78, v78, v30, s33
    v_perm_b32 v86, v86, v31, s33
    v_perm_b32 v79, v79, v22, s33
    v_perm_b32 v87, v87, v23, s33
    v_add_f32 v80, v76, v78
    v_add_f32 v88, v84, v86
    v_add_f32 v81, v77, v79
    v_add_f32 v89, v85, v87
    v_fma_f32 v82, v78, 4.0, v76
    v_fma_f32 v90, v86, 4.0, v84
    v_fma_f32 v83, v79, 4.0, v77
    v_fma_f32 v91, v87, 4.0, v85
    v_add_f32 v77, v80, v81
    v_add_f32 v85, v88, v89
    v_sub_f32 v78, v80, v81
    v_sub_f32 v86, v88, v89
    v_fma_f32 v79, v83, 2.0, v82
    v_fma_f32 v87, v91, 2.0, v90
    v_fma_f32 v82, v83, -2.0, v82
    v_fma_f32 v90, v91, -2.0, v90
    v_fmamk_f32 v80, v76, 0x41700000, v82
    v_fmamk_f32 v88, v84, 0x41700000, v90
    v_fmamk_f32 v80, v81, 0x41200000, v80
    v_fmamk_f32 v88, v89, 0x41200000, v88
    v_mul_f32 v77, 0.5, v77
    v_mul_f32 v85, 0.5, v85
    v_mul_f32 v78, 0.5, v78
    v_mul_f32 v86, 0.5, v86
    v_mul_f32 v79, s35, v79
    v_mul_f32 v87, s35, v87
    v_mul_f32 v82, s35, v82
    v_mul_f32 v90, s35, v90
    v_mul_f32 v80, s36, v80
    v_mul_f32 v88, s36, v88
    v_cvt_pk_bf16_f32 v55, v77, v85
    v_cvt_pk_bf16_f32 v59, v78, v86
    v_cvt_pk_bf16_f32 v63, v79, v87
    v_cvt_pk_bf16_f32 v67, v82, v90
    v_cvt_pk_bf16_f32 v71, v80, v88
    s_add_u32 s28, s27, 49152
    buffer_store_dwordx4 v[72:75], v4, s[12:15], s28 offen sc1
    s_add_u32 s28, s27, 0
    buffer_store_dwordx4 v[48:51], v4, s[12:15], s28 offen sc1
    s_add_u32 s28, s27, 8192
    buffer_store_dwordx4 v[52:55], v4, s[12:15], s28 offen sc1
    s_add_u32 s28, s27, 16384
    buffer_store_dwordx4 v[56:59], v4, s[12:15], s28 offen sc1
    s_add_u32 s28, s27, 24576
    buffer_store_dwordx4 v[60:63], v4, s[12:15], s28 offen sc1
    s_add_u32 s28, s27, 32768
    buffer_store_dwordx4 v[64:67], v4, s[12:15], s28 offen sc1
    s_add_u32 s28, s27, 40960
    buffer_store_dwordx4 v[68:71], v4, s[12:15], s28 offen sc1
    s_mov_b32 s20, s58
    s_branch L_conv1_kernel_end
L_conv1_kernel_mw:
    s_add_u32 s37, s41, 524288
    v_lshl_add_u32 v108, v127, 4, s37
    v_add_u32 v109, 1024, v108
    v_add_u32 v110, 2048, v108
    s_waitcnt lgkmcnt(0)
    s_add_u32 s8, s4, s47
    s_addc_u32 s9, s5, 0
    s_lshl_b32 s36, s29, 4
    s_lshl_b32 s37, s33, 3
    s_add_u32 s36, s36, s37
    s_mul_i32 s36, s36, 57344
    s_add_u32 s36, s36, 0
    s_add_u32 s12, s30, s36
    s_addc_u32 s13, s31, 0
    s_mov_b32 s14, 917504
    s_mov_b32 s15, 0x00020000
    s_mul_i32 s36, s35, 4194304
    s_add_u32 s36, s36, 18874368
    s_add_u32 s16, s30, s36
    s_addc_u32 s17, s31, 0
    s_mov_b32 s18, 4194304
    s_mov_b32 s19, 0x00020000
    v_and_b32 v10, 15, v127
    v_lshrrev_b32 v11, 4, v127
    v_add_u32 v8, 0, v10
    v_and_b32 v16, 4, v8
    v_lshrrev_b32 v16, 1, v16
    v_xor_b32 v16, v11, v16
    v_lshlrev_b32 v16, 4, v16
    v_lshl_add_u32 v8, v8, 6, v16
    v_add_u32 v9, 1, v10
    v_and_b32 v16, 4, v9
    v_lshrrev_b32 v16, 1, v16
    v_xor_b32 v16, v11, v16
    v_lshlrev_b32 v16, 4, v16
    v_lshl_add_u32 v9, v9, 6, v16
    s_lshr_b32 s38, s32, 1
    s_and_b32 s39, s32, 1
    s_add_u32 s40, s38, 4
    s_lshl_b32 s43, s39, 10
    s_cmp_lt_u32 s20, 4
    s_cselect_b32 s40, s20, s40
    s_cselect_b32 s36, 0, s43
    s_lshl_b32 s37, s40, 13
    s_add_u32 s37, s37, s36
    v_lshl_add_u32 v125, v127, 4, s37
    s_mul_i32 s37, s40, 16384
    v_add_u32 v120, s37, v8
    v_add_u32 v121, s37, v9
    s_lshl_b32 s37, s40, 10
    s_add_u32 s37, s37, 115712
    v_lshl_add_u32 v16, v11, 4, s37
    v_cmp_eq_u32 vcc, 15, v10
    v_mov_b32 v17, 8192
    v_mov_b32 v18, 4294959104
    v_mov_b32 v19, 64
    v_cndmask_b32 v122, v121, v16, vcc
    v_cndmask_b32 v123, v17, v19, vcc
    v_cndmask_b32 v124, v18, v19, vcc
    v_lshl_add_u32 v126, v127, 4, s37
    s_mov_b32 s44, 0x3f800000
    s_mov_b32 s45, 0x00000000
    s_mov_b32 s46, 0x00000000
    s_cmp_eq_u32 s40, 1
    s_cselect_b32 s45, 0x3f800000, s45
    s_cselect_b32 s46, 0x3f800000, s46
    s_cmp_eq_u32 s40, 2
    s_cselect_b32 s45, 0xbf800000, s45
    s_cselect_b32 s46, 0x3f800000, s46
    s_cmp_eq_u32 s40, 3
    s_cselect_b32 s45, 0x40000000, s45
    s_cselect_b32 s46, 0x40800000, s46
    s_cmp_eq_u32 s40, 4
    s_cselect_b32 s45, 0xc0000000, s45
    s_cselect_b32 s46, 0x40800000, s46
    s_cmp_eq_u32 s40, 5
    s_cselect_b32 s44, 0x41800000, s44
    s_cselect_b32 s45, 0x41000000, s45
    s_cselect_b32 s46, 0x40800000, s46
    s_cmp_ge_u32 s20, 4
    s_cbranch_scc1 L_conv1_kernel_m2
    v_mov_b32 v0, 0
    v_mov_b32 v1, 0
    v_mov_b32 v2, 0
    v_mov_b32 v3, 0
    v_mov_b32 v4, 0
    v_mov_b32 v5, 0
    v_mov_b32 v6, 0
    v_mov_b32 v7, 0
    v_mov_b32 v8, 0
    v_mov_b32 v9, 0
    v_mov_b32 v10, 0
    v_mov_b32 v11, 0
    v_mov_b32 v12, 0
    v_mov_b32 v13, 0
    v_mov_b32 v14, 0
    v_mov_b32 v15, 0
    v_mov_b32 v16, 0
    v_mov_b32 v17, 0
    v_mov_b32 v18, 0
    v_mov_b32 v19, 0
    v_mov_b32 v20, 0
    v_mov_b32 v21, 0
    v_mov_b32 v22, 0
    v_mov_b32 v23, 0
    v_mov_b32 v24, 0
    v_mov_b32 v25, 0
    v_mov_b32 v26, 0
    v_mov_b32 v27, 0
    v_mov_b32 v28, 0
    v_mov_b32 v29, 0
    v_mov_b32 v30, 0
    v_mov_b32 v31, 0
    v_mov_b32 v32, 0
    v_mov_b32 v33, 0
    v_mov_b32 v34, 0
    v_mov_b32 v35, 0
    v_mov_b32 v36, 0
    v_mov_b32 v37, 0
    v_mov_b32 v38, 0
    v_mov_b32 v39, 0
    v_mov_b32 v40, 0
    v_mov_b32 v41, 0
    v_mov_b32 v42, 0
    v_mov_b32 v43, 0
    v_mov_b32 v44, 0
    v_mov_b32 v45, 0
    v_mov_b32 v46, 0
    v_mov_b32 v47, 0
    v_mov_b32 v48, 0
    v_mov_b32 v49, 0
    v_mov_b32 v50, 0
    v_mov_b32 v51, 0
    v_mov_b32 v52, 0
    v_mov_b32 v53, 0
    v_mov_b32 v54, 0
    v_mov_b32 v55, 0
    v_mov_b32 v56, 0
    v_mov_b32 v57, 0
    v_mov_b32 v58, 0
    v_mov_b32 v59, 0
    v_mov_b32 v60, 0
    v_mov_b32 v61, 0
    v_mov_b32 v62, 0
    v_mov_b32 v63, 0
    buffer_load_dwordx4 v[96:99], v108, s[8:11], 0 offen
    buffer_load_dwordx4 v[100:103], v109, s[8:11], 0 offen
    buffer_load_dwordx4 v[104:107], v110, s[8:11], 0 offen
    s_mov_b32 s23, 0
    s_mov_b32 s26, 4096
    buffer_load_dwordx4 v[64:67], v125, s[12:15], s23 offen offset:0
    buffer_load_dwordx4 v[68:71], v125, s[12:15], s23 offen offset:1024
    buffer_load_dwordx4 v[72:75], v125, s[12:15], s23 offen offset:2048
    buffer_load_dwordx4 v[76:79], v125, s[12:15], s23 offen offset:3072
    buffer_load_dwordx4 v[80:83], v125, s[12:15], s26 offen offset:0
    buffer_load_dwordx4 v[84:87], v125, s[12:15], s26 offen offset:1024
    buffer_load_dwordx4 v[88:91], v125, s[12:15], s26 offen offset:2048
    buffer_load_dwordx4 v[92:95], v125, s[12:15], s26 offen offset:3072
    s_mov_b32 s23, 57344
    s_mov_b32 s26, 61440
    s_waitcnt vmcnt(8)
    v_lshlrev_b32 v108, 16, v96
    v_and_b32 v111, s25, v96
    v_lshlrev_b32 v109, 16, v100
    v_and_b32 v112, s25, v100
    v_lshlrev_b32 v110, 16, v104
    v_and_b32 v113, s25, v104
    v_mul_f32 v114, s44, v108
    v_mul_f32 v115, s44, v111
    v_fmac_f32 v114, s45, v109
    v_fmac_f32 v115, s45, v112
    v_fmac_f32 v114, s46, v110
    v_fmac_f32 v115, s46, v113
    v_cvt_pk_bf16_f32 v96, v114, v115
    v_lshlrev_b32 v108, 16, v97
    v_and_b32 v111, s25, v97
    v_lshlrev_b32 v109, 16, v101
    v_and_b32 v112, s25, v101
    v_lshlrev_b32 v110, 16, v105
    v_and_b32 v113, s25, v105
    v_mul_f32 v114, s44, v108
    v_mul_f32 v115, s44, v111
    v_fmac_f32 v114, s45, v109
    v_fmac_f32 v115, s45, v112
    v_fmac_f32 v114, s46, v110
    v_fmac_f32 v115, s46, v113
    v_cvt_pk_bf16_f32 v97, v114, v115
    v_lshlrev_b32 v108, 16, v98
    v_and_b32 v111, s25, v98
    v_lshlrev_b32 v109, 16, v102
    v_and_b32 v112, s25, v102
    v_lshlrev_b32 v110, 16, v106
    v_and_b32 v113, s25, v106
    v_mul_f32 v114, s44, v108
    v_mul_f32 v115, s44, v111
    v_fmac_f32 v114, s45, v109
    v_fmac_f32 v115, s45, v112
    v_fmac_f32 v114, s46, v110
    v_fmac_f32 v115, s46, v113
    v_cvt_pk_bf16_f32 v98, v114, v115
    v_lshlrev_b32 v108, 16, v99
    v_and_b32 v111, s25, v99
    v_lshlrev_b32 v109, 16, v103
    v_and_b32 v112, s25, v103
    v_lshlrev_b32 v110, 16, v107
    v_and_b32 v113, s25, v107
    v_mul_f32 v114, s44, v108
    v_mul_f32 v115, s44, v111
    v_fmac_f32 v114, s45, v109
    v_fmac_f32 v115, s45, v112
    v_fmac_f32 v114, s46, v110
    v_fmac_f32 v115, s46, v113
    v_cvt_pk_bf16_f32 v99, v114, v115
    ds_write_b128 v126, v[96:99]
    s_waitcnt lgkmcnt(0)
    s_barrier
    s_mov_b32 s22, 8
    s_setprio 2
L_conv1_kernel_mloop1:
    ds_read_b128 v[96:99], v120 offset:0
    ds_read_b128 v[100:103], v120 offset:1024
    ds_read_b128 v[104:107], v120 offset:2048
    ds_read_b128 v[108:111], v120 offset:3072
    ds_read_b128 v[112:115], v120 offset:4096
    ds_read_b128 v[116:119], v120 offset:5120
    s_waitcnt vmcnt(6) lgkmcnt(5)
    v_mfma_f32_16x16x32_bf16 v[0:3], v[64:67], v[96:99], v[0:3]
    v_mfma_f32_16x16x32_bf16 v[32:35], v[68:71], v[96:99], v[32:35]
    ds_read_b128 v[96:99], v120 offset:6144
    s_waitcnt vmcnt(4) lgkmcnt(5)
    v_mfma_f32_16x16x32_bf16 v[4:7], v[64:67], v[100:103], v[4:7]
    v_mfma_f32_16x16x32_bf16 v[36:39], v[68:71], v[100:103], v[36:39]
    v_mfma_f32_16x16x32_bf16 v[0:3], v[72:75], v[100:103], v[0:3]
    v_mfma_f32_16x16x32_bf16 v[32:35], v[76:79], v[100:103], v[32:35]
    ds_read_b128 v[100:103], v120 offset:7168
    s_waitcnt vmcnt(2) lgkmcnt(5)
    v_mfma_f32_16x16x32_bf16 v[8:11], v[64:67], v[104:107], v[8:11]
    v_mfma_f32_16x16x32_bf16 v[40:43], v[68:71], v[104:107], v[40:43]
    v_mfma_f32_16x16x32_bf16 v[4:7], v[72:75], v[104:107], v[4:7]
    v_mfma_f32_16x16x32_bf16 v[36:39], v[76:79], v[104:107], v[36:39]
    v_mfma_f32_16x16x32_bf16 v[0:3], v[80:83], v[104:107], v[0:3]
    v_mfma_f32_16x16x32_bf16 v[32:35], v[84:87], v[104:107], v[32:35]
    ds_read_b128 v[104:107], v122 offset:0
    v_add_u32 v122, v123, v122
    s_waitcnt vmcnt(0) lgkmcnt(5)
    v_mfma_f32_16x16x32_bf16 v[12:15], v[64:67], v[108:111], v[12:15]
    v_mfma_f32_16x16x32_bf16 v[44:47], v[68:71], v[108:111], v[44:47]
    v_mfma_f32_16x16x32_bf16 v[8:11], v[72:75], v[108:111], v[8:11]
    v_mfma_f32_16x16x32_bf16 v[40:43], v[76:79], v[108:111], v[40:43]
    v_mfma_f32_16x16x32_bf16 v[4:7], v[80:83], v[108:111], v[4:7]
    v_mfma_f32_16x16x32_bf16 v[36:39], v[84:87], v[108:111], v[36:39]
    v_mfma_f32_16x16x32_bf16 v[0:3], v[88:91], v[108:111], v[0:3]
    v_mfma_f32_16x16x32_bf16 v[32:35], v[92:95], v[108:111], v[32:35]
    ds_read_b128 v[108:111], v121 offset:1024
    s_waitcnt lgkmcnt(5)
    v_mfma_f32_16x16x32_bf16 v[16:19], v[64:67], v[112:115], v[16:19]
    v_mfma_f32_16x16x32_bf16 v[48:51], v[68:71], v[112:115], v[48:51]
    v_mfma_f32_16x16x32_bf16 v[12:15], v[72:75], v[112:115], v[12:15]
    v_mfma_f32_16x16x32_bf16 v[44:47], v[76:79], v[112:115], v[44:47]
    v_mfma_f32_16x16x32_bf16 v[8:11], v[80:83], v[112:115], v[8:11]
    v_mfma_f32_16x16x32_bf16 v[40:43], v[84:87], v[112:115], v[40:43]
    v_mfma_f32_16x16x32_bf16 v[4:7], v[88:91], v[112:115], v[4:7]
    v_mfma_f32_16x16x32_bf16 v[36:39], v[92:95], v[112:115], v[36:39]
    ds_read_b128 v[112:115], v121 offset:2048
    s_waitcnt lgkmcnt(5)
    v_mfma_f32_16x16x32_bf16 v[20:23], v[64:67], v[116:119], v[20:23]
    v_mfma_f32_16x16x32_bf16 v[52:55], v[68:71], v[116:119], v[52:55]
    v_mfma_f32_16x16x32_bf16 v[16:19], v[72:75], v[116:119], v[16:19]
    v_mfma_f32_16x16x32_bf16 v[48:51], v[76:79], v[116:119], v[48:51]
    v_mfma_f32_16x16x32_bf16 v[12:15], v[80:83], v[116:119], v[12:15]
    v_mfma_f32_16x16x32_bf16 v[44:47], v[84:87], v[116:119], v[44:47]
    v_mfma_f32_16x16x32_bf16 v[8:11], v[88:91], v[116:119], v[8:11]
    v_mfma_f32_16x16x32_bf16 v[40:43], v[92:95], v[116:119], v[40:43]
    s_waitcnt lgkmcnt(4)
    v_mfma_f32_16x16x32_bf16 v[24:27], v[64:67], v[96:99], v[24:27]
    v_mfma_f32_16x16x32_bf16 v[56:59], v[68:71], v[96:99], v[56:59]
    v_mfma_f32_16x16x32_bf16 v[20:23], v[72:75], v[96:99], v[20:23]
    v_mfma_f32_16x16x32_bf16 v[52:55], v[76:79], v[96:99], v[52:55]
    v_mfma_f32_16x16x32_bf16 v[16:19], v[80:83], v[96:99], v[16:19]
    v_mfma_f32_16x16x32_bf16 v[48:51], v[84:87], v[96:99], v[48:51]
    v_mfma_f32_16x16x32_bf16 v[12:15], v[88:91], v[96:99], v[12:15]
    v_mfma_f32_16x16x32_bf16 v[44:47], v[92:95], v[96:99], v[44:47]
    s_waitcnt lgkmcnt(3)
    v_mfma_f32_16x16x32_bf16 v[28:31], v[64:67], v[100:103], v[28:31]
    v_mfma_f32_16x16x32_bf16 v[60:63], v[68:71], v[100:103], v[60:63]
    v_mfma_f32_16x16x32_bf16 v[24:27], v[72:75], v[100:103], v[24:27]
    v_mfma_f32_16x16x32_bf16 v[56:59], v[76:79], v[100:103], v[56:59]
    v_mfma_f32_16x16x32_bf16 v[20:23], v[80:83], v[100:103], v[20:23]
    v_mfma_f32_16x16x32_bf16 v[52:55], v[84:87], v[100:103], v[52:55]
    v_mfma_f32_16x16x32_bf16 v[16:19], v[88:91], v[100:103], v[16:19]
    v_mfma_f32_16x16x32_bf16 v[48:51], v[92:95], v[100:103], v[48:51]
    buffer_load_dwordx4 v[64:67], v125, s[12:15], s23 offen offset:0
    buffer_load_dwordx4 v[68:71], v125, s[12:15], s23 offen offset:1024
    s_waitcnt lgkmcnt(2)
    v_mfma_f32_16x16x32_bf16 v[28:31], v[72:75], v[104:107], v[28:31]
    v_mfma_f32_16x16x32_bf16 v[60:63], v[76:79], v[104:107], v[60:63]
    v_mfma_f32_16x16x32_bf16 v[24:27], v[80:83], v[104:107], v[24:27]
    v_mfma_f32_16x16x32_bf16 v[56:59], v[84:87], v[104:107], v[56:59]
    v_mfma_f32_16x16x32_bf16 v[20:23], v[88:91], v[104:107], v[20:23]
    v_mfma_f32_16x16x32_bf16 v[52:55], v[92:95], v[104:107], v[52:55]
    buffer_load_dwordx4 v[72:75], v125, s[12:15], s23 offen offset:2048
    buffer_load_dwordx4 v[76:79], v125, s[12:15], s23 offen offset:3072
    s_waitcnt lgkmcnt(1)
    v_mfma_f32_16x16x32_bf16 v[28:31], v[80:83], v[108:111], v[28:31]
    v_mfma_f32_16x16x32_bf16 v[60:63], v[84:87], v[108:111], v[60:63]
    v_mfma_f32_16x16x32_bf16 v[24:27], v[88:91], v[108:111], v[24:27]
    v_mfma_f32_16x16x32_bf16 v[56:59], v[92:95], v[108:111], v[56:59]
    buffer_load_dwordx4 v[80:83], v125, s[12:15], s26 offen offset:0
    buffer_load_dwordx4 v[84:87], v125, s[12:15], s26 offen offset:1024
    s_waitcnt lgkmcnt(0)
    v_mfma_f32_16x16x32_bf16 v[28:31], v[88:91], v[112:115], v[28:31]
    v_mfma_f32_16x16x32_bf16 v[60:63], v[92:95], v[112:115], v[60:63]
    buffer_load_dwordx4 v[88:91], v125, s[12:15], s26 offen offset:2048
    buffer_load_dwordx4 v[92:95], v125, s[12:15], s26 offen offset:3072
    s_add_u32 s23, s23, 57344
    s_add_u32 s26, s26, 57344
    s_barrier
    s_sub_u32 s22, s22, 1
    s_cmp_eq_u32 s22, 0
    s_cbranch_scc1 L_conv1_kernel_mlast1
    ds_read_b128 v[96:99], v120 offset:8192
    ds_read_b128 v[100:103], v120 offset:9216
    ds_read_b128 v[104:107], v120 offset:10240
    ds_read_b128 v[108:111], v120 offset:11264
    ds_read_b128 v[112:115], v120 offset:12288
    ds_read_b128 v[116:119], v120 offset:13312
    s_waitcnt vmcnt(6) lgkmcnt(5)
    v_mfma_f32_16x16x32_bf16 v[0:3], v[64:67], v[96:99], v[0:3]
    v_mfma_f32_16x16x32_bf16 v[32:35], v[68:71], v[96:99], v[32:35]
    ds_read_b128 v[96:99], v120 offset:14336
    s_waitcnt vmcnt(4) lgkmcnt(5)
    v_mfma_f32_16x16x32_bf16 v[4:7], v[64:67], v[100:103], v[4:7]
    v_mfma_f32_16x16x32_bf16 v[36:39], v[68:71], v[100:103], v[36:39]
    v_mfma_f32_16x16x32_bf16 v[0:3], v[72:75], v[100:103], v[0:3]
    v_mfma_f32_16x16x32_bf16 v[32:35], v[76:79], v[100:103], v[32:35]
    ds_read_b128 v[100:103], v120 offset:15360
    s_waitcnt vmcnt(2) lgkmcnt(5)
    v_mfma_f32_16x16x32_bf16 v[8:11], v[64:67], v[104:107], v[8:11]
    v_mfma_f32_16x16x32_bf16 v[40:43], v[68:71], v[104:107], v[40:43]
    v_mfma_f32_16x16x32_bf16 v[4:7], v[72:75], v[104:107], v[4:7]
    v_mfma_f32_16x16x32_bf16 v[36:39], v[76:79], v[104:107], v[36:39]
    v_mfma_f32_16x16x32_bf16 v[0:3], v[80:83], v[104:107], v[0:3]
    v_mfma_f32_16x16x32_bf16 v[32:35], v[84:87], v[104:107], v[32:35]
    ds_read_b128 v[104:107], v122 offset:0
    v_add_u32 v122, v124, v122
    s_waitcnt vmcnt(0) lgkmcnt(5)
    v_mfma_f32_16x16x32_bf16 v[12:15], v[64:67], v[108:111], v[12:15]
    v_mfma_f32_16x16x32_bf16 v[44:47], v[68:71], v[108:111], v[44:47]
    v_mfma_f32_16x16x32_bf16 v[8:11], v[72:75], v[108:111], v[8:11]
    v_mfma_f32_16x16x32_bf16 v[40:43], v[76:79], v[108:111], v[40:43]
    v_mfma_f32_16x16x32_bf16 v[4:7], v[80:83], v[108:111], v[4:7]
    v_mfma_f32_16x16x32_bf16 v[36:39], v[84:87], v[108:111], v[36:39]
    v_mfma_f32_16x16x32_bf16 v[0:3], v[88:91], v[108:111], v[0:3]
    v_mfma_f32_16x16x32_bf16 v[32:35], v[92:95], v[108:111], v[32:35]
    ds_read_b128 v[108:111], v121 offset:9216
    s_waitcnt lgkmcnt(5)
    v_mfma_f32_16x16x32_bf16 v[16:19], v[64:67], v[112:115], v[16:19]
    v_mfma_f32_16x16x32_bf16 v[48:51], v[68:71], v[112:115], v[48:51]
    v_mfma_f32_16x16x32_bf16 v[12:15], v[72:75], v[112:115], v[12:15]
    v_mfma_f32_16x16x32_bf16 v[44:47], v[76:79], v[112:115], v[44:47]
    v_mfma_f32_16x16x32_bf16 v[8:11], v[80:83], v[112:115], v[8:11]
    v_mfma_f32_16x16x32_bf16 v[40:43], v[84:87], v[112:115], v[40:43]
    v_mfma_f32_16x16x32_bf16 v[4:7], v[88:91], v[112:115], v[4:7]
    v_mfma_f32_16x16x32_bf16 v[36:39], v[92:95], v[112:115], v[36:39]
    ds_read_b128 v[112:115], v121 offset:10240
    s_waitcnt lgkmcnt(5)
    v_mfma_f32_16x16x32_bf16 v[20:23], v[64:67], v[116:119], v[20:23]
    v_mfma_f32_16x16x32_bf16 v[52:55], v[68:71], v[116:119], v[52:55]
    v_mfma_f32_16x16x32_bf16 v[16:19], v[72:75], v[116:119], v[16:19]
    v_mfma_f32_16x16x32_bf16 v[48:51], v[76:79], v[116:119], v[48:51]
    v_mfma_f32_16x16x32_bf16 v[12:15], v[80:83], v[116:119], v[12:15]
    v_mfma_f32_16x16x32_bf16 v[44:47], v[84:87], v[116:119], v[44:47]
    v_mfma_f32_16x16x32_bf16 v[8:11], v[88:91], v[116:119], v[8:11]
    v_mfma_f32_16x16x32_bf16 v[40:43], v[92:95], v[116:119], v[40:43]
    s_waitcnt lgkmcnt(4)
    v_mfma_f32_16x16x32_bf16 v[24:27], v[64:67], v[96:99], v[24:27]
    v_mfma_f32_16x16x32_bf16 v[56:59], v[68:71], v[96:99], v[56:59]
    v_mfma_f32_16x16x32_bf16 v[20:23], v[72:75], v[96:99], v[20:23]
    v_mfma_f32_16x16x32_bf16 v[52:55], v[76:79], v[96:99], v[52:55]
    v_mfma_f32_16x16x32_bf16 v[16:19], v[80:83], v[96:99], v[16:19]
    v_mfma_f32_16x16x32_bf16 v[48:51], v[84:87], v[96:99], v[48:51]
    v_mfma_f32_16x16x32_bf16 v[12:15], v[88:91], v[96:99], v[12:15]
    v_mfma_f32_16x16x32_bf16 v[44:47], v[92:95], v[96:99], v[44:47]
    s_waitcnt lgkmcnt(3)
    v_mfma_f32_16x16x32_bf16 v[28:31], v[64:67], v[100:103], v[28:31]
    v_mfma_f32_16x16x32_bf16 v[60:63], v[68:71], v[100:103], v[60:63]
    v_mfma_f32_16x16x32_bf16 v[24:27], v[72:75], v[100:103], v[24:27]
    v_mfma_f32_16x16x32_bf16 v[56:59], v[76:79], v[100:103], v[56:59]
    v_mfma_f32_16x16x32_bf16 v[20:23], v[80:83], v[100:103], v[20:23]
    v_mfma_f32_16x16x32_bf16 v[52:55], v[84:87], v[100:103], v[52:55]
    v_mfma_f32_16x16x32_bf16 v[16:19], v[88:91], v[100:103], v[16:19]
    v_mfma_f32_16x16x32_bf16 v[48:51], v[92:95], v[100:103], v[48:51]
    buffer_load_dwordx4 v[64:67], v125, s[12:15], s23 offen offset:0
    buffer_load_dwordx4 v[68:71], v125, s[12:15], s23 offen offset:1024
    s_waitcnt lgkmcnt(2)
    v_mfma_f32_16x16x32_bf16 v[28:31], v[72:75], v[104:107], v[28:31]
    v_mfma_f32_16x16x32_bf16 v[60:63], v[76:79], v[104:107], v[60:63]
    v_mfma_f32_16x16x32_bf16 v[24:27], v[80:83], v[104:107], v[24:27]
    v_mfma_f32_16x16x32_bf16 v[56:59], v[84:87], v[104:107], v[56:59]
    v_mfma_f32_16x16x32_bf16 v[20:23], v[88:91], v[104:107], v[20:23]
    v_mfma_f32_16x16x32_bf16 v[52:55], v[92:95], v[104:107], v[52:55]
    buffer_load_dwordx4 v[72:75], v125, s[12:15], s23 offen offset:2048
    buffer_load_dwordx4 v[76:79], v125, s[12:15], s23 offen offset:3072
    s_waitcnt lgkmcnt(1)
    v_mfma_f32_16x16x32_bf16 v[28:31], v[80:83], v[108:111], v[28:31]
    v_mfma_f32_16x16x32_bf16 v[60:63], v[84:87], v[108:111], v[60:63]
    v_mfma_f32_16x16x32_bf16 v[24:27], v[88:91], v[108:111], v[24:27]
    v_mfma_f32_16x16x32_bf16 v[56:59], v[92:95], v[108:111], v[56:59]
    buffer_load_dwordx4 v[80:83], v125, s[12:15], s26 offen offset:0
    buffer_load_dwordx4 v[84:87], v125, s[12:15], s26 offen offset:1024
    s_waitcnt lgkmcnt(0)
    v_mfma_f32_16x16x32_bf16 v[28:31], v[88:91], v[112:115], v[28:31]
    v_mfma_f32_16x16x32_bf16 v[60:63], v[92:95], v[112:115], v[60:63]
    buffer_load_dwordx4 v[88:91], v125, s[12:15], s26 offen offset:2048
    buffer_load_dwordx4 v[92:95], v125, s[12:15], s26 offen offset:3072
    s_add_u32 s23, s23, 57344
    s_add_u32 s26, s26, 57344
    s_barrier
    s_branch L_conv1_kernel_mloop1
L_conv1_kernel_mlast1:
    v_and_b32 v125, 15, v127
    v_and_b32 v126, 7, v127
    v_lshlrev_b32 v126, 4, v126
    v_lshl_add_u32 v125, v125, 7, v126
    v_lshrrev_b32 v126, 4, v127
    v_lshl_add_u32 v125, v126, 11, v125
    s_lshl_b32 s36, s20, 14
    s_add_u32 s37, s36, 8192
    v_add_u32 v126, s37, v125
    v_add_u32 v125, s36, v125
    ds_read_b128 v[96:99], v120 offset:8192
    ds_read_b128 v[100:103], v120 offset:9216
    ds_read_b128 v[104:107], v120 offset:10240
    ds_read_b128 v[108:111], v120 offset:11264
    ds_read_b128 v[112:115], v120 offset:12288
    ds_read_b128 v[116:119], v120 offset:13312
    s_waitcnt vmcnt(6) lgkmcnt(5)
    v_mfma_f32_16x16x32_bf16 v[0:3], v[64:67], v[96:99], v[0:3]
    v_mfma_f32_16x16x32_bf16 v[32:35], v[68:71], v[96:99], v[32:35]
    ds_read_b128 v[96:99], v120 offset:14336
    s_waitcnt vmcnt(4) lgkmcnt(5)
    v_mfma_f32_16x16x32_bf16 v[4:7], v[64:67], v[100:103], v[4:7]
    v_mfma_f32_16x16x32_bf16 v[36:39], v[68:71], v[100:103], v[36:39]
    v_mfma_f32_16x16x32_bf16 v[0:3], v[72:75], v[100:103], v[0:3]
    v_mfma_f32_16x16x32_bf16 v[32:35], v[76:79], v[100:103], v[32:35]
    ds_read_b128 v[100:103], v120 offset:15360
    s_waitcnt vmcnt(2) lgkmcnt(5)
    v_mfma_f32_16x16x32_bf16 v[8:11], v[64:67], v[104:107], v[8:11]
    v_mfma_f32_16x16x32_bf16 v[40:43], v[68:71], v[104:107], v[40:43]
    v_mfma_f32_16x16x32_bf16 v[4:7], v[72:75], v[104:107], v[4:7]
    v_mfma_f32_16x16x32_bf16 v[36:39], v[76:79], v[104:107], v[36:39]
    v_mfma_f32_16x16x32_bf16 v[0:3], v[80:83], v[104:107], v[0:3]
    v_mfma_f32_16x16x32_bf16 v[32:35], v[84:87], v[104:107], v[32:35]
    ds_read_b128 v[104:107], v122 offset:0
    s_waitcnt vmcnt(0) lgkmcnt(5)
    v_mfma_f32_16x16x32_bf16 v[12:15], v[64:67], v[108:111], v[12:15]
    v_mfma_f32_16x16x32_bf16 v[44:47], v[68:71], v[108:111], v[44:47]
    v_mfma_f32_16x16x32_bf16 v[8:11], v[72:75], v[108:111], v[8:11]
    v_mfma_f32_16x16x32_bf16 v[40:43], v[76:79], v[108:111], v[40:43]
    v_mfma_f32_16x16x32_bf16 v[4:7], v[80:83], v[108:111], v[4:7]
    v_mfma_f32_16x16x32_bf16 v[36:39], v[84:87], v[108:111], v[36:39]
    v_mfma_f32_16x16x32_bf16 v[0:3], v[88:91], v[108:111], v[0:3]
    v_mfma_f32_16x16x32_bf16 v[32:35], v[92:95], v[108:111], v[32:35]
    ds_read_b128 v[108:111], v121 offset:9216
    s_waitcnt lgkmcnt(5)
    v_mfma_f32_16x16x32_bf16 v[16:19], v[64:67], v[112:115], v[16:19]
    v_mfma_f32_16x16x32_bf16 v[48:51], v[68:71], v[112:115], v[48:51]
    v_mfma_f32_16x16x32_bf16 v[12:15], v[72:75], v[112:115], v[12:15]
    v_mfma_f32_16x16x32_bf16 v[44:47], v[76:79], v[112:115], v[44:47]
    v_mfma_f32_16x16x32_bf16 v[8:11], v[80:83], v[112:115], v[8:11]
    v_mfma_f32_16x16x32_bf16 v[40:43], v[84:87], v[112:115], v[40:43]
    v_mfma_f32_16x16x32_bf16 v[4:7], v[88:91], v[112:115], v[4:7]
    v_mfma_f32_16x16x32_bf16 v[36:39], v[92:95], v[112:115], v[36:39]
    ds_read_b128 v[112:115], v121 offset:10240
    v_xor_b32 v123, 0, v125
    ds_write_b128 v123, v[0:3]
    s_waitcnt lgkmcnt(6)
    v_mfma_f32_16x16x32_bf16 v[20:23], v[64:67], v[116:119], v[20:23]
    v_mfma_f32_16x16x32_bf16 v[52:55], v[68:71], v[116:119], v[52:55]
    v_mfma_f32_16x16x32_bf16 v[16:19], v[72:75], v[116:119], v[16:19]
    v_mfma_f32_16x16x32_bf16 v[48:51], v[76:79], v[116:119], v[48:51]
    v_mfma_f32_16x16x32_bf16 v[12:15], v[80:83], v[116:119], v[12:15]
    v_mfma_f32_16x16x32_bf16 v[44:47], v[84:87], v[116:119], v[44:47]
    v_mfma_f32_16x16x32_bf16 v[8:11], v[88:91], v[116:119], v[8:11]
    v_mfma_f32_16x16x32_bf16 v[40:43], v[92:95], v[116:119], v[40:43]
    v_xor_b32 v124, 16, v125
    ds_write_b128 v124, v[4:7]
    s_waitcnt lgkmcnt(2)
    v_mfma_f32_16x16x32_bf16 v[24:27], v[64:67], v[96:99], v[24:27]
    v_mfma_f32_16x16x32_bf16 v[56:59], v[68:71], v[96:99], v[56:59]
    v_mfma_f32_16x16x32_bf16 v[20:23], v[72:75], v[96:99], v[20:23]
    v_mfma_f32_16x16x32_bf16 v[52:55], v[76:79], v[96:99], v[52:55]
    v_mfma_f32_16x16x32_bf16 v[16:19], v[80:83], v[96:99], v[16:19]
    v_mfma_f32_16x16x32_bf16 v[48:51], v[84:87], v[96:99], v[48:51]
    v_mfma_f32_16x16x32_bf16 v[12:15], v[88:91], v[96:99], v[12:15]
    v_mfma_f32_16x16x32_bf16 v[44:47], v[92:95], v[96:99], v[44:47]
    v_xor_b32 v123, 32, v125
    ds_write_b128 v123, v[8:11]
    v_xor_b32 v124, 0, v126
    ds_write_b128 v124, v[32:35]
    v_mfma_f32_16x16x32_bf16 v[28:31], v[64:67], v[100:103], v[28:31]
    v_mfma_f32_16x16x32_bf16 v[60:63], v[68:71], v[100:103], v[60:63]
    v_mfma_f32_16x16x32_bf16 v[24:27], v[72:75], v[100:103], v[24:27]
    v_mfma_f32_16x16x32_bf16 v[56:59], v[76:79], v[100:103], v[56:59]
    v_mfma_f32_16x16x32_bf16 v[20:23], v[80:83], v[100:103], v[20:23]
    v_mfma_f32_16x16x32_bf16 v[52:55], v[84:87], v[100:103], v[52:55]
    v_mfma_f32_16x16x32_bf16 v[16:19], v[88:91], v[100:103], v[16:19]
    v_mfma_f32_16x16x32_bf16 v[48:51], v[92:95], v[100:103], v[48:51]
    v_xor_b32 v123, 16, v126
    ds_write_b128 v123, v[36:39]
    v_xor_b32 v124, 32, v126
    ds_write_b128 v124, v[40:43]
    v_mfma_f32_16x16x32_bf16 v[28:31], v[72:75], v[104:107], v[28:31]
    v_mfma_f32_16x16x32_bf16 v[60:63], v[76:79], v[104:107], v[60:63]
    v_mfma_f32_16x16x32_bf16 v[24:27], v[80:83], v[104:107], v[24:27]
    v_mfma_f32_16x16x32_bf16 v[56:59], v[84:87], v[104:107], v[56:59]
    v_mfma_f32_16x16x32_bf16 v[20:23], v[88:91], v[104:107], v[20:23]
    v_mfma_f32_16x16x32_bf16 v[52:55], v[92:95], v[104:107], v[52:55]
    v_xor_b32 v124, 48, v125
    ds_write_b128 v124, v[12:15]
    v_xor_b32 v123, 48, v126
    ds_write_b128 v123, v[44:47]
    v_mfma_f32_16x16x32_bf16 v[28:31], v[80:83], v[108:111], v[28:31]
    v_mfma_f32_16x16x32_bf16 v[60:63], v[84:87], v[108:111], v[60:63]
    v_mfma_f32_16x16x32_bf16 v[24:27], v[88:91], v[108:111], v[24:27]
    v_mfma_f32_16x16x32_bf16 v[56:59], v[92:95], v[108:111], v[56:59]
    v_xor_b32 v123, 64, v125
    ds_write_b128 v123, v[16:19]
    v_xor_b32 v124, 64, v126
    ds_write_b128 v124, v[48:51]
    v_mfma_f32_16x16x32_bf16 v[28:31], v[88:91], v[112:115], v[28:31]
    v_mfma_f32_16x16x32_bf16 v[60:63], v[92:95], v[112:115], v[60:63]
    v_xor_b32 v124, 80, v125
    ds_write_b128 v124, v[20:23]
    v_xor_b32 v123, 80, v126
    ds_write_b128 v123, v[52:55]
    v_and_b32 v108, 15, v127
    v_lshrrev_b32 v109, 4, v127
    v_lshrrev_b32 v110, 3, v108
    s_lshl_b32 s36, s20, 1
    v_add_u32 v110, s36, v110
    v_xor_b32 v111, v110, v108
    v_and_b32 v111, 7, v111
    v_lshlrev_b32 v111, 4, v111
    v_xor_b32 v123, 96, v125
    ds_write_b128 v123, v[24:27]
    v_lshl_add_u32 v111, v110, 7, v111
    v_lshl_add_u32 v120, v109, 11, v111
    v_add_u32 v121, 65536, v120
    v_add_u32 v64, 131072, v120
    s_lshl_b32 s36, s20, 9
    s_add_u32 s36, s36, 115712
    v_lshl_add_u32 v127, v109, 7, s36
    s_lshl_b32 s36, s20, 4
    v_add_u32 v108, s36, v108
    v_lshlrev_b32 v110, 6, v108
    v_lshl_add_u32 v110, v109, 4, v110
    s_mul_i32 s36, s29, 524288
    v_xor_b32 v124, 96, v126
    ds_write_b128 v124, v[56:59]
    s_lshl_b32 s37, s21, 4
    s_add_u32 s36, s36, s37
    v_add_u32 v110, s36, v110
    v_mov_b32 v111, 2130706432
    v_cmp_gt_u32 vcc, 125, v108
    s_mov_b32 s4, 0xbeaaaaab
    s_mov_b32 s5, s4
    s_mov_b32 s6, 0x3e800000
    s_mov_b32 s7, s6
    s_mov_b32 s8, 0xc0a00000
    s_mov_b32 s9, s8
    s_mov_b32 s10, 0xc0638e39
    v_xor_b32 v124, 112, v125
    ds_write_b128 v124, v[28:31]
    s_mov_b32 s11, s10
    s_mov_b32 s12, 0xbf638e39
    s_mov_b32 s13, s12
    s_mov_b32 s14, 0xbe638e39
    s_mov_b32 s15, s14
    s_mov_b32 s22, 0xbd638e39
    s_mov_b32 s23, s22
    s_mov_b32 s24, 0x3ff1c71c
    s_mov_b32 s25, s24
    s_mov_b32 s26, 0xbf2aaaab
    s_mov_b32 s27, s26
    s_mov_b32 s32, 0x3ecccccd
    v_xor_b32 v123, 112, v126
    s_waitcnt lgkmcnt(8)
    ds_write_b128 v123, v[60:63]
    s_mov_b32 s33, s32
    s_mov_b32 s34, 0xbd888889
    s_mov_b32 s35, s34
    s_mov_b32 s38, 0xbe4ccccd
    s_mov_b32 s39, s38
    s_mov_b32 s40, 0xbdd2d3e8
    s_mov_b32 s41, s40
    s_mov_b32 s42, 0x3f800000
    s_mov_b32 s43, s42
    s_setprio 0
    s_branch L_conv1_kernel_epi
L_conv1_kernel_m2:
    s_mul_i32 s37, s38, 2176
    s_add_u32 s37, s37, 98304
    v_add_u32 v116, s37, v8
    v_add_u32 v118, s37, v9
    v_add_u32 v117, 104832, v8
    s_cmp_eq_u32 s38, 0
    s_cbranch_scc1 L_conv1_kernel_hh0
    v_add_u32 v117, 98304, v9
L_conv1_kernel_hh0:
    s_lshl_b32 s37, s38, 12
    s_add_u32 s37, s37, s43
    s_add_u32 s37, s37, 49152
    v_lshl_add_u32 v119, v127, 4, s37
    v_mov_b32 v0, 0
    v_mov_b32 v1, 0
    v_mov_b32 v2, 0
    v_mov_b32 v3, 0
    v_mov_b32 v4, 0
    v_mov_b32 v5, 0
    v_mov_b32 v6, 0
    v_mov_b32 v7, 0
    v_mov_b32 v8, 0
    v_mov_b32 v9, 0
    v_mov_b32 v10, 0
    v_mov_b32 v11, 0
    v_mov_b32 v12, 0
    v_mov_b32 v13, 0
    v_mov_b32 v14, 0
    v_mov_b32 v15, 0
    v_mov_b32 v16, 0
    v_mov_b32 v17, 0
    v_mov_b32 v18, 0
    v_mov_b32 v19, 0
    v_mov_b32 v20, 0
    v_mov_b32 v21, 0
    v_mov_b32 v22, 0
    v_mov_b32 v23, 0
    v_mov_b32 v24, 0
    v_mov_b32 v25, 0
    v_mov_b32 v26, 0
    v_mov_b32 v27, 0
    v_mov_b32 v28, 0
    v_mov_b32 v29, 0
    v_mov_b32 v30, 0
    v_mov_b32 v31, 0
    v_mov_b32 v32, 0
    v_mov_b32 v33, 0
    v_mov_b32 v34, 0
    v_mov_b32 v35, 0
    v_mov_b32 v36, 0
    v_mov_b32 v37, 0
    v_mov_b32 v38, 0
    v_mov_b32 v39, 0
    v_mov_b32 v40, 0
    v_mov_b32 v41, 0
    v_mov_b32 v42, 0
    v_mov_b32 v43, 0
    v_mov_b32 v44, 0
    v_mov_b32 v45, 0
    v_mov_b32 v46, 0
    v_mov_b32 v47, 0
    v_mov_b32 v48, 0
    v_mov_b32 v49, 0
    v_mov_b32 v50, 0
    v_mov_b32 v51, 0
    v_mov_b32 v52, 0
    v_mov_b32 v53, 0
    v_mov_b32 v54, 0
    v_mov_b32 v55, 0
    v_mov_b32 v56, 0
    v_mov_b32 v57, 0
    v_mov_b32 v58, 0
    v_mov_b32 v59, 0
    v_mov_b32 v60, 0
    v_mov_b32 v61, 0
    v_mov_b32 v62, 0
    v_mov_b32 v63, 0
    buffer_load_dwordx4 v[96:99], v108, s[8:11], 0 offen
    buffer_load_dwordx4 v[100:103], v109, s[8:11], 0 offen
    buffer_load_dwordx4 v[104:107], v110, s[8:11], 0 offen
    s_mov_b32 s23, 0
    s_mov_b32 s26, 4096
    buffer_load_dwordx4 v[64:67], v125, s[12:15], s23 offen offset:0
    buffer_load_dwordx4 v[68:71], v125, s[12:15], s23 offen offset:2048
    buffer_load_dwordx4 v[80:83], v119, s[12:15], s23 offen offset:0
    buffer_load_dwordx4 v[72:75], v125, s[12:15], s26 offen offset:0
    buffer_load_dwordx4 v[84:87], v119, s[12:15], s23 offen offset:2048
    buffer_load_dwordx4 v[76:79], v125, s[12:15], s26 offen offset:2048
    s_mov_b32 s23, 57344
    s_mov_b32 s26, 61440
    s_waitcnt vmcnt(6)
    v_lshlrev_b32 v108, 16, v96
    v_and_b32 v111, s25, v96
    v_lshlrev_b32 v109, 16, v100
    v_and_b32 v112, s25, v100
    v_lshlrev_b32 v110, 16, v104
    v_and_b32 v113, s25, v104
    v_mul_f32 v114, s44, v108
    v_mul_f32 v115, s44, v111
    v_fmac_f32 v114, s45, v109
    v_fmac_f32 v115, s45, v112
    v_fmac_f32 v114, s46, v110
    v_fmac_f32 v115, s46, v113
    v_cvt_pk_bf16_f32 v96, v114, v115
    v_lshlrev_b32 v108, 16, v97
    v_and_b32 v111, s25, v97
    v_lshlrev_b32 v109, 16, v101
    v_and_b32 v112, s25, v101
    v_lshlrev_b32 v110, 16, v105
    v_and_b32 v113, s25, v105
    v_mul_f32 v114, s44, v108
    v_mul_f32 v115, s44, v111
    v_fmac_f32 v114, s45, v109
    v_fmac_f32 v115, s45, v112
    v_fmac_f32 v114, s46, v110
    v_fmac_f32 v115, s46, v113
    v_cvt_pk_bf16_f32 v97, v114, v115
    v_lshlrev_b32 v108, 16, v98
    v_and_b32 v111, s25, v98
    v_lshlrev_b32 v109, 16, v102
    v_and_b32 v112, s25, v102
    v_lshlrev_b32 v110, 16, v106
    v_and_b32 v113, s25, v106
    v_mul_f32 v114, s44, v108
    v_mul_f32 v115, s44, v111
    v_fmac_f32 v114, s45, v109
    v_fmac_f32 v115, s45, v112
    v_fmac_f32 v114, s46, v110
    v_fmac_f32 v115, s46, v113
    v_cvt_pk_bf16_f32 v98, v114, v115
    v_lshlrev_b32 v108, 16, v99
    v_and_b32 v111, s25, v99
    v_lshlrev_b32 v109, 16, v103
    v_and_b32 v112, s25, v103
    v_lshlrev_b32 v110, 16, v107
    v_and_b32 v113, s25, v107
    v_mul_f32 v114, s44, v108
    v_mul_f32 v115, s44, v111
    v_fmac_f32 v114, s45, v109
    v_fmac_f32 v115, s45, v112
    v_fmac_f32 v114, s46, v110
    v_fmac_f32 v115, s46, v113
    v_cvt_pk_bf16_f32 v99, v114, v115
    ds_write_b128 v126, v[96:99]
    v_and_b32 v111, 15, v127
    v_lshlrev_b32 v111, 2, v111
    v_add_u32 v111, 99328, v111
    ds_write_b32 v111, v0
    ds_write_b32 v111, v0 offset:8704
    s_waitcnt lgkmcnt(0)
    s_barrier
    s_mov_b32 s22, 8
    s_setprio 2
L_conv1_kernel_mloop2:
    ds_read_b128 v[88:91], v120 offset:0
    ds_read_b128 v[92:95], v120 offset:1024
    ds_read_b128 v[96:99], v116 offset:0
    ds_read_b128 v[100:103], v120 offset:2048
    ds_read_b128 v[104:107], v116 offset:1088
    ds_read_b128 v[108:111], v120 offset:3072
    ds_read_b128 v[112:115], v116 offset:2176
    s_waitcnt vmcnt(5) lgkmcnt(6)
    v_mfma_f32_16x16x32_bf16 v[0:3], v[64:67], v[88:91], v[0:3]
    ds_read_b128 v[88:91], v120 offset:4096
    s_waitcnt vmcnt(4) lgkmcnt(6)
    v_mfma_f32_16x16x32_bf16 v[4:7], v[64:67], v[92:95], v[4:7]
    v_mfma_f32_16x16x32_bf16 v[0:3], v[68:71], v[92:95], v[0:3]
    ds_read_b128 v[92:95], v116 offset:3264
    s_waitcnt vmcnt(3) lgkmcnt(6)
    v_mfma_f32_16x16x32_bf16 v[32:35], v[80:83], v[96:99], v[32:35]
    ds_read_b128 v[96:99], v120 offset:5120
    s_waitcnt vmcnt(2) lgkmcnt(6)
    v_mfma_f32_16x16x32_bf16 v[8:11], v[64:67], v[100:103], v[8:11]
    v_mfma_f32_16x16x32_bf16 v[4:7], v[68:71], v[100:103], v[4:7]
    v_mfma_f32_16x16x32_bf16 v[0:3], v[72:75], v[100:103], v[0:3]
    ds_read_b128 v[100:103], v116 offset:4352
    s_waitcnt vmcnt(1) lgkmcnt(6)
    v_mfma_f32_16x16x32_bf16 v[36:39], v[80:83], v[104:107], v[36:39]
    v_mfma_f32_16x16x32_bf16 v[32:35], v[84:87], v[104:107], v[32:35]
    ds_read_b128 v[104:107], v120 offset:6144
    s_waitcnt vmcnt(0) lgkmcnt(6)
    v_mfma_f32_16x16x32_bf16 v[12:15], v[64:67], v[108:111], v[12:15]
    v_mfma_f32_16x16x32_bf16 v[8:11], v[68:71], v[108:111], v[8:11]
    v_mfma_f32_16x16x32_bf16 v[4:7], v[72:75], v[108:111], v[4:7]
    v_mfma_f32_16x16x32_bf16 v[0:3], v[76:79], v[108:111], v[0:3]
    ds_read_b128 v[108:111], v116 offset:5440
    s_waitcnt lgkmcnt(6)
    v_mfma_f32_16x16x32_bf16 v[40:43], v[80:83], v[112:115], v[40:43]
    v_mfma_f32_16x16x32_bf16 v[36:39], v[84:87], v[112:115], v[36:39]
    ds_read_b128 v[112:115], v120 offset:7168
    s_waitcnt lgkmcnt(6)
    v_mfma_f32_16x16x32_bf16 v[16:19], v[64:67], v[88:91], v[16:19]
    v_mfma_f32_16x16x32_bf16 v[12:15], v[68:71], v[88:91], v[12:15]
    v_mfma_f32_16x16x32_bf16 v[8:11], v[72:75], v[88:91], v[8:11]
    v_mfma_f32_16x16x32_bf16 v[4:7], v[76:79], v[88:91], v[4:7]
    ds_read_b128 v[88:91], v117 offset:0
    s_waitcnt lgkmcnt(6)
    v_mfma_f32_16x16x32_bf16 v[44:47], v[80:83], v[92:95], v[44:47]
    v_mfma_f32_16x16x32_bf16 v[40:43], v[84:87], v[92:95], v[40:43]
    ds_read_b128 v[92:95], v122 offset:0
    v_add_u32 v122, v123, v122
    s_waitcnt lgkmcnt(6)
    v_mfma_f32_16x16x32_bf16 v[20:23], v[64:67], v[96:99], v[20:23]
    v_mfma_f32_16x16x32_bf16 v[16:19], v[68:71], v[96:99], v[16:19]
    v_mfma_f32_16x16x32_bf16 v[12:15], v[72:75], v[96:99], v[12:15]
    v_mfma_f32_16x16x32_bf16 v[8:11], v[76:79], v[96:99], v[8:11]
    ds_read_b128 v[96:99], v117 offset:1088
    s_waitcnt lgkmcnt(6)
    v_mfma_f32_16x16x32_bf16 v[48:51], v[80:83], v[100:103], v[48:51]
    v_mfma_f32_16x16x32_bf16 v[44:47], v[84:87], v[100:103], v[44:47]
    ds_read_b128 v[100:103], v121 offset:1024
    s_waitcnt lgkmcnt(6)
    v_mfma_f32_16x16x32_bf16 v[24:27], v[64:67], v[104:107], v[24:27]
    v_mfma_f32_16x16x32_bf16 v[20:23], v[68:71], v[104:107], v[20:23]
    v_mfma_f32_16x16x32_bf16 v[16:19], v[72:75], v[104:107], v[16:19]
    v_mfma_f32_16x16x32_bf16 v[12:15], v[76:79], v[104:107], v[12:15]
    ds_read_b128 v[104:107], v118 offset:0
    s_waitcnt lgkmcnt(6)
    v_mfma_f32_16x16x32_bf16 v[52:55], v[80:83], v[108:111], v[52:55]
    v_mfma_f32_16x16x32_bf16 v[48:51], v[84:87], v[108:111], v[48:51]
    ds_read_b128 v[108:111], v121 offset:2048
    s_waitcnt lgkmcnt(6)
    v_mfma_f32_16x16x32_bf16 v[28:31], v[64:67], v[112:115], v[28:31]
    v_mfma_f32_16x16x32_bf16 v[24:27], v[68:71], v[112:115], v[24:27]
    v_mfma_f32_16x16x32_bf16 v[20:23], v[72:75], v[112:115], v[20:23]
    v_mfma_f32_16x16x32_bf16 v[16:19], v[76:79], v[112:115], v[16:19]
    buffer_load_dwordx4 v[64:67], v125, s[12:15], s23 offen offset:0
    s_waitcnt lgkmcnt(5)
    v_mfma_f32_16x16x32_bf16 v[56:59], v[80:83], v[88:91], v[56:59]
    v_mfma_f32_16x16x32_bf16 v[52:55], v[84:87], v[88:91], v[52:55]
    s_waitcnt lgkmcnt(0)
    s_barrier
    v_mfma_f32_16x16x32_bf16 v[28:31], v[68:71], v[92:95], v[28:31]
    v_mfma_f32_16x16x32_bf16 v[24:27], v[72:75], v[92:95], v[24:27]
    v_mfma_f32_16x16x32_bf16 v[20:23], v[76:79], v[92:95], v[20:23]
    buffer_load_dwordx4 v[68:71], v125, s[12:15], s23 offen offset:2048
    v_mfma_f32_16x16x32_bf16 v[60:63], v[80:83], v[96:99], v[60:63]
    v_mfma_f32_16x16x32_bf16 v[56:59], v[84:87], v[96:99], v[56:59]
    buffer_load_dwordx4 v[80:83], v119, s[12:15], s23 offen offset:0
    v_mfma_f32_16x16x32_bf16 v[28:31], v[72:75], v[100:103], v[28:31]
    v_mfma_f32_16x16x32_bf16 v[24:27], v[76:79], v[100:103], v[24:27]
    buffer_load_dwordx4 v[72:75], v125, s[12:15], s26 offen offset:0
    v_mfma_f32_16x16x32_bf16 v[60:63], v[84:87], v[104:107], v[60:63]
    buffer_load_dwordx4 v[84:87], v119, s[12:15], s23 offen offset:2048
    v_mfma_f32_16x16x32_bf16 v[28:31], v[76:79], v[108:111], v[28:31]
    buffer_load_dwordx4 v[76:79], v125, s[12:15], s26 offen offset:2048
    s_add_u32 s23, s23, 57344
    s_add_u32 s26, s26, 57344
    s_sub_u32 s22, s22, 1
    s_cmp_eq_u32 s22, 0
    s_cbranch_scc1 L_conv1_kernel_mlast2
    ds_read_b128 v[88:91], v120 offset:8192
    ds_read_b128 v[92:95], v120 offset:9216
    ds_read_b128 v[96:99], v116 offset:8704
    ds_read_b128 v[100:103], v120 offset:10240
    ds_read_b128 v[104:107], v116 offset:9792
    ds_read_b128 v[108:111], v120 offset:11264
    ds_read_b128 v[112:115], v116 offset:10880
    s_waitcnt vmcnt(5) lgkmcnt(6)
    v_mfma_f32_16x16x32_bf16 v[0:3], v[64:67], v[88:91], v[0:3]
    ds_read_b128 v[88:91], v120 offset:12288
    s_waitcnt vmcnt(4) lgkmcnt(6)
    v_mfma_f32_16x16x32_bf16 v[4:7], v[64:67], v[92:95], v[4:7]
    v_mfma_f32_16x16x32_bf16 v[0:3], v[68:71], v[92:95], v[0:3]
    ds_read_b128 v[92:95], v116 offset:11968
    s_waitcnt vmcnt(3) lgkmcnt(6)
    v_mfma_f32_16x16x32_bf16 v[32:35], v[80:83], v[96:99], v[32:35]
    ds_read_b128 v[96:99], v120 offset:13312
    s_waitcnt vmcnt(2) lgkmcnt(6)
    v_mfma_f32_16x16x32_bf16 v[8:11], v[64:67], v[100:103], v[8:11]
    v_mfma_f32_16x16x32_bf16 v[4:7], v[68:71], v[100:103], v[4:7]
    v_mfma_f32_16x16x32_bf16 v[0:3], v[72:75], v[100:103], v[0:3]
    ds_read_b128 v[100:103], v116 offset:13056
    s_waitcnt vmcnt(1) lgkmcnt(6)
    v_mfma_f32_16x16x32_bf16 v[36:39], v[80:83], v[104:107], v[36:39]
    v_mfma_f32_16x16x32_bf16 v[32:35], v[84:87], v[104:107], v[32:35]
    ds_read_b128 v[104:107], v120 offset:14336
    s_waitcnt vmcnt(0) lgkmcnt(6)
    v_mfma_f32_16x16x32_bf16 v[12:15], v[64:67], v[108:111], v[12:15]
    v_mfma_f32_16x16x32_bf16 v[8:11], v[68:71], v[108:111], v[8:11]
    v_mfma_f32_16x16x32_bf16 v[4:7], v[72:75], v[108:111], v[4:7]
    v_mfma_f32_16x16x32_bf16 v[0:3], v[76:79], v[108:111], v[0:3]
    ds_read_b128 v[108:111], v116 offset:14144
    s_waitcnt lgkmcnt(6)
    v_mfma_f32_16x16x32_bf16 v[40:43], v[80:83], v[112:115], v[40:43]
    v_mfma_f32_16x16x32_bf16 v[36:39], v[84:87], v[112:115], v[36:39]
    ds_read_b128 v[112:115], v120 offset:15360
    s_waitcnt lgkmcnt(6)
    v_mfma_f32_16x16x32_bf16 v[16:19], v[64:67], v[88:91], v[16:19]
    v_mfma_f32_16x16x32_bf16 v[12:15], v[68:71], v[88:91], v[12:15]
    v_mfma_f32_16x16x32_bf16 v[8:11], v[72:75], v[88:91], v[8:11]
    v_mfma_f32_16x16x32_bf16 v[4:7], v[76:79], v[88:91], v[4:7]
    ds_read_b128 v[88:91], v117 offset:8704
    s_waitcnt lgkmcnt(6)
    v_mfma_f32_16x16x32_bf16 v[44:47], v[80:83], v[92:95], v[44:47]
    v_mfma_f32_16x16x32_bf16 v[40:43], v[84:87], v[92:95], v[40:43]
    ds_read_b128 v[92:95], v122 offset:0
    v_add_u32 v122, v124, v122
    s_waitcnt lgkmcnt(6)
    v_mfma_f32_16x16x32_bf16 v[20:23], v[64:67], v[96:99], v[20:23]
    v_mfma_f32_16x16x32_bf16 v[16:19], v[68:71], v[96:99], v[16:19]
    v_mfma_f32_16x16x32_bf16 v[12:15], v[72:75], v[96:99], v[12:15]
    v_mfma_f32_16x16x32_bf16 v[8:11], v[76:79], v[96:99], v[8:11]
    ds_read_b128 v[96:99], v117 offset:9792
    s_waitcnt lgkmcnt(6)
    v_mfma_f32_16x16x32_bf16 v[48:51], v[80:83], v[100:103], v[48:51]
    v_mfma_f32_16x16x32_bf16 v[44:47], v[84:87], v[100:103], v[44:47]
    ds_read_b128 v[100:103], v121 offset:9216
    s_waitcnt lgkmcnt(6)
    v_mfma_f32_16x16x32_bf16 v[24:27], v[64:67], v[104:107], v[24:27]
    v_mfma_f32_16x16x32_bf16 v[20:23], v[68:71], v[104:107], v[20:23]
    v_mfma_f32_16x16x32_bf16 v[16:19], v[72:75], v[104:107], v[16:19]
    v_mfma_f32_16x16x32_bf16 v[12:15], v[76:79], v[104:107], v[12:15]
    ds_read_b128 v[104:107], v118 offset:8704
    s_waitcnt lgkmcnt(6)
    v_mfma_f32_16x16x32_bf16 v[52:55], v[80:83], v[108:111], v[52:55]
    v_mfma_f32_16x16x32_bf16 v[48:51], v[84:87], v[108:111], v[48:51]
    ds_read_b128 v[108:111], v121 offset:10240
    s_waitcnt lgkmcnt(6)
    v_mfma_f32_16x16x32_bf16 v[28:31], v[64:67], v[112:115], v[28:31]
    v_mfma_f32_16x16x32_bf16 v[24:27], v[68:71], v[112:115], v[24:27]
    v_mfma_f32_16x16x32_bf16 v[20:23], v[72:75], v[112:115], v[20:23]
    v_mfma_f32_16x16x32_bf16 v[16:19], v[76:79], v[112:115], v[16:19]
    buffer_load_dwordx4 v[64:67], v125, s[12:15], s23 offen offset:0
    s_waitcnt lgkmcnt(5)
    v_mfma_f32_16x16x32_bf16 v[56:59], v[80:83], v[88:91], v[56:59]
    v_mfma_f32_16x16x32_bf16 v[52:55], v[84:87], v[88:91], v[52:55]
    s_waitcnt lgkmcnt(0)
    s_barrier
    v_mfma_f32_16x16x32_bf16 v[28:31], v[68:71], v[92:95], v[28:31]
    v_mfma_f32_16x16x32_bf16 v[24:27], v[72:75], v[92:95], v[24:27]
    v_mfma_f32_16x16x32_bf16 v[20:23], v[76:79], v[92:95], v[20:23]
    buffer_load_dwordx4 v[68:71], v125, s[12:15], s23 offen offset:2048
    v_mfma_f32_16x16x32_bf16 v[60:63], v[80:83], v[96:99], v[60:63]
    v_mfma_f32_16x16x32_bf16 v[56:59], v[84:87], v[96:99], v[56:59]
    buffer_load_dwordx4 v[80:83], v119, s[12:15], s23 offen offset:0
    v_mfma_f32_16x16x32_bf16 v[28:31], v[72:75], v[100:103], v[28:31]
    v_mfma_f32_16x16x32_bf16 v[24:27], v[76:79], v[100:103], v[24:27]
    buffer_load_dwordx4 v[72:75], v125, s[12:15], s26 offen offset:0
    v_mfma_f32_16x16x32_bf16 v[60:63], v[84:87], v[104:107], v[60:63]
    buffer_load_dwordx4 v[84:87], v119, s[12:15], s23 offen offset:2048
    v_mfma_f32_16x16x32_bf16 v[28:31], v[76:79], v[108:111], v[28:31]
    buffer_load_dwordx4 v[76:79], v125, s[12:15], s26 offen offset:2048
    s_add_u32 s23, s23, 57344
    s_add_u32 s26, s26, 57344
    s_branch L_conv1_kernel_mloop2
L_conv1_kernel_mlast2:
    v_and_b32 v125, 15, v127
    v_and_b32 v126, 7, v127
    v_lshlrev_b32 v126, 4, v126
    v_lshl_add_u32 v125, v125, 7, v126
    v_lshrrev_b32 v126, 4, v127
    v_lshl_add_u32 v125, v126, 11, v125
    s_mov_b32 s36, 65536
    s_cmp_eq_u32 s32, 1
    s_cselect_b32 s36, 121856, s36
    s_cmp_eq_u32 s32, 2
    s_cselect_b32 s36, 81920, s36
    s_cmp_eq_u32 s32, 3
    s_cselect_b32 s36, 130048, s36
    s_mov_b32 s37, 98304
    s_cmp_eq_u32 s32, 1
    s_cselect_b32 s37, 138240, s37
    s_cmp_eq_u32 s32, 2
    s_cselect_b32 s37, 146432, s37
    s_cmp_eq_u32 s32, 3
    s_cselect_b32 s37, 154624, s37
    v_add_u32 v126, s37, v125
    v_add_u32 v125, s36, v125
    ds_read_b128 v[88:91], v120 offset:8192
    ds_read_b128 v[92:95], v120 offset:9216
    ds_read_b128 v[96:99], v116 offset:8704
    ds_read_b128 v[100:103], v120 offset:10240
    ds_read_b128 v[104:107], v116 offset:9792
    ds_read_b128 v[108:111], v120 offset:11264
    ds_read_b128 v[112:115], v116 offset:10880
    s_waitcnt vmcnt(5) lgkmcnt(6)
    v_mfma_f32_16x16x32_bf16 v[0:3], v[64:67], v[88:91], v[0:3]
    ds_read_b128 v[88:91], v120 offset:12288
    s_waitcnt vmcnt(4) lgkmcnt(6)
    v_mfma_f32_16x16x32_bf16 v[4:7], v[64:67], v[92:95], v[4:7]
    v_mfma_f32_16x16x32_bf16 v[0:3], v[68:71], v[92:95], v[0:3]
    ds_read_b128 v[92:95], v116 offset:11968
    s_waitcnt vmcnt(3) lgkmcnt(6)
    v_mfma_f32_16x16x32_bf16 v[32:35], v[80:83], v[96:99], v[32:35]
    ds_read_b128 v[96:99], v120 offset:13312
    s_waitcnt vmcnt(2) lgkmcnt(6)
    v_mfma_f32_16x16x32_bf16 v[8:11], v[64:67], v[100:103], v[8:11]
    v_mfma_f32_16x16x32_bf16 v[4:7], v[68:71], v[100:103], v[4:7]
    v_mfma_f32_16x16x32_bf16 v[0:3], v[72:75], v[100:103], v[0:3]
    ds_read_b128 v[100:103], v116 offset:13056
    s_waitcnt vmcnt(1) lgkmcnt(6)
    v_mfma_f32_16x16x32_bf16 v[36:39], v[80:83], v[104:107], v[36:39]
    v_mfma_f32_16x16x32_bf16 v[32:35], v[84:87], v[104:107], v[32:35]
    ds_read_b128 v[104:107], v120 offset:14336
    s_waitcnt vmcnt(0) lgkmcnt(6)
    v_mfma_f32_16x16x32_bf16 v[12:15], v[64:67], v[108:111], v[12:15]
    v_mfma_f32_16x16x32_bf16 v[8:11], v[68:71], v[108:111], v[8:11]
    v_mfma_f32_16x16x32_bf16 v[4:7], v[72:75], v[108:111], v[4:7]
    v_mfma_f32_16x16x32_bf16 v[0:3], v[76:79], v[108:111], v[0:3]
    ds_read_b128 v[108:111], v116 offset:14144
    s_waitcnt lgkmcnt(6)
    v_mfma_f32_16x16x32_bf16 v[40:43], v[80:83], v[112:115], v[40:43]
    v_mfma_f32_16x16x32_bf16 v[36:39], v[84:87], v[112:115], v[36:39]
    ds_read_b128 v[112:115], v120 offset:15360
    s_waitcnt lgkmcnt(6)
    v_mfma_f32_16x16x32_bf16 v[16:19], v[64:67], v[88:91], v[16:19]
    v_mfma_f32_16x16x32_bf16 v[12:15], v[68:71], v[88:91], v[12:15]
    v_mfma_f32_16x16x32_bf16 v[8:11], v[72:75], v[88:91], v[8:11]
    v_mfma_f32_16x16x32_bf16 v[4:7], v[76:79], v[88:91], v[4:7]
    ds_read_b128 v[88:91], v117 offset:8704
    v_xor_b32 v124, 0, v126
    ds_write_b128 v124, v[32:35]
    s_waitcnt lgkmcnt(7)
    v_mfma_f32_16x16x32_bf16 v[44:47], v[80:83], v[92:95], v[44:47]
    v_mfma_f32_16x16x32_bf16 v[40:43], v[84:87], v[92:95], v[40:43]
    ds_read_b128 v[92:95], v122 offset:0
    v_xor_b32 v123, 0, v125
    ds_write_b128 v123, v[0:3]
    s_waitcnt lgkmcnt(8)
    v_mfma_f32_16x16x32_bf16 v[20:23], v[64:67], v[96:99], v[20:23]
    v_mfma_f32_16x16x32_bf16 v[16:19], v[68:71], v[96:99], v[16:19]
    v_mfma_f32_16x16x32_bf16 v[12:15], v[72:75], v[96:99], v[12:15]
    v_mfma_f32_16x16x32_bf16 v[8:11], v[76:79], v[96:99], v[8:11]
    ds_read_b128 v[96:99], v117 offset:9792
    v_xor_b32 v123, 16, v126
    ds_write_b128 v123, v[36:39]
    s_waitcnt lgkmcnt(9)
    v_mfma_f32_16x16x32_bf16 v[48:51], v[80:83], v[100:103], v[48:51]
    v_mfma_f32_16x16x32_bf16 v[44:47], v[84:87], v[100:103], v[44:47]
    ds_read_b128 v[100:103], v121 offset:9216
    v_xor_b32 v124, 16, v125
    ds_write_b128 v124, v[4:7]
    s_waitcnt lgkmcnt(10)
    v_mfma_f32_16x16x32_bf16 v[24:27], v[64:67], v[104:107], v[24:27]
    v_mfma_f32_16x16x32_bf16 v[20:23], v[68:71], v[104:107], v[20:23]
    v_mfma_f32_16x16x32_bf16 v[16:19], v[72:75], v[104:107], v[16:19]
    v_mfma_f32_16x16x32_bf16 v[12:15], v[76:79], v[104:107], v[12:15]
    ds_read_b128 v[104:107], v118 offset:8704
    v_xor_b32 v124, 32, v126
    ds_write_b128 v124, v[40:43]
    s_waitcnt lgkmcnt(11)
    v_mfma_f32_16x16x32_bf16 v[52:55], v[80:83], v[108:111], v[52:55]
    v_mfma_f32_16x16x32_bf16 v[48:51], v[84:87], v[108:111], v[48:51]
    ds_read_b128 v[108:111], v121 offset:10240
    v_xor_b32 v123, 32, v125
    ds_write_b128 v123, v[8:11]
    s_waitcnt lgkmcnt(12)
    v_mfma_f32_16x16x32_bf16 v[28:31], v[64:67], v[112:115], v[28:31]
    v_mfma_f32_16x16x32_bf16 v[24:27], v[68:71], v[112:115], v[24:27]
    v_mfma_f32_16x16x32_bf16 v[20:23], v[72:75], v[112:115], v[20:23]
    v_mfma_f32_16x16x32_bf16 v[16:19], v[76:79], v[112:115], v[16:19]
    v_xor_b32 v123, 48, v126
    ds_write_b128 v123, v[44:47]
    s_waitcnt lgkmcnt(12)
    v_mfma_f32_16x16x32_bf16 v[56:59], v[80:83], v[88:91], v[56:59]
    v_mfma_f32_16x16x32_bf16 v[52:55], v[84:87], v[88:91], v[52:55]
    v_xor_b32 v124, 48, v125
    ds_write_b128 v124, v[12:15]
    s_waitcnt lgkmcnt(11)
    v_mfma_f32_16x16x32_bf16 v[28:31], v[68:71], v[92:95], v[28:31]
    v_mfma_f32_16x16x32_bf16 v[24:27], v[72:75], v[92:95], v[24:27]
    v_mfma_f32_16x16x32_bf16 v[20:23], v[76:79], v[92:95], v[20:23]
    v_xor_b32 v124, 64, v126
    ds_write_b128 v124, v[48:51]
    s_waitcnt lgkmcnt(10)
    v_mfma_f32_16x16x32_bf16 v[60:63], v[80:83], v[96:99], v[60:63]
    v_mfma_f32_16x16x32_bf16 v[56:59], v[84:87], v[96:99], v[56:59]
    v_xor_b32 v123, 64, v125
    ds_write_b128 v123, v[16:19]
    s_waitcnt lgkmcnt(9)
    v_mfma_f32_16x16x32_bf16 v[28:31], v[72:75], v[100:103], v[28:31]
    v_mfma_f32_16x16x32_bf16 v[24:27], v[76:79], v[100:103], v[24:27]
    v_xor_b32 v123, 80, v126
    ds_write_b128 v123, v[52:55]
    s_waitcnt lgkmcnt(8)
    v_mfma_f32_16x16x32_bf16 v[60:63], v[84:87], v[104:107], v[60:63]
    v_xor_b32 v124, 80, v125
    ds_write_b128 v124, v[20:23]
    s_waitcnt lgkmcnt(7)
    v_mfma_f32_16x16x32_bf16 v[28:31], v[76:79], v[108:111], v[28:31]
    v_xor_b32 v124, 96, v126
    ds_write_b128 v124, v[56:59]
    v_and_b32 v108, 15, v127
    v_lshrrev_b32 v109, 4, v127
    v_lshrrev_b32 v110, 3, v108
    s_lshl_b32 s36, s20, 1
    v_add_u32 v110, s36, v110
    v_xor_b32 v111, v110, v108
    v_and_b32 v111, 7, v111
    v_lshlrev_b32 v111, 4, v111
    v_xor_b32 v123, 96, v125
    ds_write_b128 v123, v[24:27]
    v_lshl_add_u32 v111, v110, 7, v111
    v_lshl_add_u32 v120, v109, 11, v111
    v_add_u32 v121, 65536, v120
    v_add_u32 v64, 131072, v120
    s_lshl_b32 s36, s20, 9
    s_add_u32 s36, s36, 115712
    v_lshl_add_u32 v127, v109, 7, s36
    s_lshl_b32 s36, s20, 4
    v_add_u32 v108, s36, v108
    v_lshlrev_b32 v110, 6, v108
    v_lshl_add_u32 v110, v109, 4, v110
    s_mul_i32 s36, s29, 524288
    v_xor_b32 v123, 112, v126
    ds_write_b128 v123, v[60:63]
    s_lshl_b32 s37, s21, 4
    s_add_u32 s36, s36, s37
    v_add_u32 v110, s36, v110
    v_mov_b32 v111, 2130706432
    v_cmp_gt_u32 vcc, 125, v108
    s_mov_b32 s4, 0xbeaaaaab
    s_mov_b32 s5, s4
    s_mov_b32 s6, 0x3e800000
    s_mov_b32 s7, s6
    s_mov_b32 s8, 0xc0a00000
    s_mov_b32 s9, s8
    s_mov_b32 s10, 0xc0638e39
    v_xor_b32 v124, 112, v125
    ds_write_b128 v124, v[28:31]
    s_mov_b32 s11, s10
    s_mov_b32 s12, 0xbf638e39
    s_mov_b32 s13, s12
    s_mov_b32 s14, 0xbe638e39
    s_mov_b32 s15, s14
    s_mov_b32 s22, 0xbd638e39
    s_mov_b32 s23, s22
    s_mov_b32 s24, 0x3ff1c71c
    s_mov_b32 s25, s24
    s_mov_b32 s26, 0xbf2aaaab
    s_mov_b32 s27, s26
    s_mov_b32 s32, 0x3ecccccd
    s_mov_b32 s33, s32
    s_mov_b32 s34, 0xbd888889
    s_mov_b32 s35, s34
    s_mov_b32 s38, 0xbe4ccccd
    s_mov_b32 s39, s38
    s_mov_b32 s40, 0xbdd2d3e8
    s_mov_b32 s41, s40
    s_mov_b32 s42, 0x3f800000
    s_mov_b32 s43, s42
    s_setprio 0
    s_branch L_conv1_kernel_epi
L_conv1_kernel_epi:
    s_waitcnt lgkmcnt(0)
    s_barrier
    v_cndmask_b32 v122, v111, v110, vcc
    ds_read_b128 v[0:3], v120 offset:0
    ds_read_b128 v[4:7], v120 offset:16384
    ds_read_b128 v[8:11], v120 offset:32768
    ds_read_b128 v[12:15], v120 offset:49152
    ds_read_b128 v[16:19], v121 offset:0
    ds_read_b128 v[20:23], v121 offset:16384
    ds_read_b128 v[24:27], v121 offset:32768
    ds_read_b128 v[28:31], v64 offset:15360
    ds_read_b128 v[32:35], v120 offset:8192
    ds_read_b128 v[36:39], v120 offset:24576
    ds_read_b128 v[40:43], v120 offset:40960
    ds_read_b128 v[44:47], v120 offset:57344
    ds_read_b128 v[48:51], v121 offset:56320
    ds_read_b128 v[52:55], v121 offset:64512
    ds_read_b128 v[56:59], v64 offset:7168
    s_waitcnt lgkmcnt(7)
    ds_read_b128 v[60:63], v64 offset:23552
    s_waitcnt lgkmcnt(8)
    v_pk_add_f32 v[88:89], v[24:25], v[28:29]
    v_pk_add_f32 v[90:91], v[26:27], v[30:31]
    v_pk_add_f32 v[24:25], v[4:5], v[8:9]
    v_pk_add_f32 v[26:27], v[6:7], v[10:11]
    v_pk_add_f32 v[4:5], v[4:5], v[8:9] neg_lo:[0,1] neg_hi:[0,1]
    v_pk_add_f32 v[6:7], v[6:7], v[10:11] neg_lo:[0,1] neg_hi:[0,1]
    v_pk_add_f32 v[72:73], v[12:13], v[16:17]
    v_pk_add_f32 v[74:75], v[14:15], v[18:19]
    v_pk_add_f32 v[12:13], v[12:13], v[16:17] neg_lo:[0,1] neg_hi:[0,1]
    v_pk_add_f32 v[14:15], v[14:15], v[18:19] neg_lo:[0,1] neg_hi:[0,1]
    v_pk_fma_f32 v[72:73], v[24:25], s[4:5], v[72:73]
    v_pk_fma_f32 v[74:75], v[26:27], s[4:5], v[74:75]
    v_pk_fma_f32 v[20:21], v[0:1], s[10:11], v[20:21]
    v_pk_fma_f32 v[22:23], v[2:3], s[10:11], v[22:23]
    v_pk_fma_f32 v[72:73], v[0:1], s[6:7], v[72:73]
    v_pk_fma_f32 v[74:75], v[2:3], s[6:7], v[74:75]
    v_pk_add_f32 v[24:25], v[24:25], v[0:1] neg_lo:[0,1] neg_hi:[0,1]
    v_pk_add_f32 v[26:27], v[26:27], v[2:3] neg_lo:[0,1] neg_hi:[0,1]
    v_pk_fma_f32 v[72:73], v[88:89], s[8:9], v[72:73]
    v_pk_fma_f32 v[74:75], v[90:91], s[8:9], v[74:75]
    v_pk_add_f32 v[24:25], v[24:25], v[88:89] neg_lo:[0,1] neg_hi:[0,1]
    v_pk_add_f32 v[26:27], v[26:27], v[90:91] neg_lo:[0,1] neg_hi:[0,1]
    v_pk_fma_f32 v[20:21], v[88:89], s[22:23], v[20:21]
    v_pk_fma_f32 v[22:23], v[90:91], s[22:23], v[22:23]
    v_pk_add_f32 v[8:9], v[24:25], v[72:73] neg_lo:[0,1] neg_hi:[0,1]
    v_pk_add_f32 v[10:11], v[26:27], v[74:75] neg_lo:[0,1] neg_hi:[0,1]
    v_pk_fma_f32 v[20:21], v[72:73], s[14:15], v[20:21]
    v_pk_fma_f32 v[22:23], v[74:75], s[14:15], v[22:23]
    v_pk_mul_f32 v[80:81], v[12:13], s[32:33]
    v_pk_mul_f32 v[82:83], v[14:15], s[32:33]
    v_pk_fma_f32 v[20:21], v[8:9], s[12:13], v[20:21]
    v_pk_fma_f32 v[22:23], v[10:11], s[12:13], v[22:23]
    v_pk_fma_f32 v[80:81], v[4:5], s[34:35], v[80:81]
    v_pk_fma_f32 v[82:83], v[6:7], s[34:35], v[82:83]
    v_pk_fma_f32 v[64:65], v[4:5], s[24:25], v[20:21] neg_lo:[0,0,1] neg_hi:[0,0,1]
    v_pk_fma_f32 v[66:67], v[6:7], s[24:25], v[22:23] neg_lo:[0,0,1] neg_hi:[0,0,1]
    v_pk_fma_f32 v[64:65], v[12:13], s[26:27], v[64:65]
    v_pk_fma_f32 v[66:67], v[14:15], s[26:27], v[66:67]
    v_pk_fma_f32 v[80:81], v[64:65], s[38:39], v[80:81]
    v_pk_fma_f32 v[82:83], v[66:67], s[38:39], v[82:83]
    v_pk_add_f32 v[4:5], v[4:5], v[64:65] neg_lo:[0,1] neg_hi:[0,1]
    v_pk_add_f32 v[6:7], v[6:7], v[66:67] neg_lo:[0,1] neg_hi:[0,1]
    v_pk_add_f32 v[4:5], v[4:5], v[80:81] neg_lo:[0,1] neg_hi:[0,1]
    v_pk_add_f32 v[6:7], v[6:7], v[82:83] neg_lo:[0,1] neg_hi:[0,1]
    s_waitcnt lgkmcnt(0)
    v_pk_add_f32 v[92:93], v[56:57], v[60:61]
    v_pk_add_f32 v[94:95], v[58:59], v[62:63]
    v_pk_add_f32 v[56:57], v[36:37], v[40:41]
    v_pk_add_f32 v[58:59], v[38:39], v[42:43]
    v_pk_add_f32 v[36:37], v[36:37], v[40:41] neg_lo:[0,1] neg_hi:[0,1]
    v_pk_add_f32 v[38:39], v[38:39], v[42:43] neg_lo:[0,1] neg_hi:[0,1]
    v_pk_add_f32 v[76:77], v[44:45], v[48:49]
    v_pk_add_f32 v[78:79], v[46:47], v[50:51]
    v_pk_add_f32 v[44:45], v[44:45], v[48:49] neg_lo:[0,1] neg_hi:[0,1]
    v_pk_add_f32 v[46:47], v[46:47], v[50:51] neg_lo:[0,1] neg_hi:[0,1]
    v_pk_fma_f32 v[76:77], v[56:57], s[4:5], v[76:77]
    v_pk_fma_f32 v[78:79], v[58:59], s[4:5], v[78:79]
    v_pk_fma_f32 v[52:53], v[32:33], s[10:11], v[52:53]
    v_pk_fma_f32 v[54:55], v[34:35], s[10:11], v[54:55]
    v_pk_fma_f32 v[76:77], v[32:33], s[6:7], v[76:77]
    v_pk_fma_f32 v[78:79], v[34:35], s[6:7], v[78:79]
    v_pk_add_f32 v[56:57], v[56:57], v[32:33] neg_lo:[0,1] neg_hi:[0,1]
    v_pk_add_f32 v[58:59], v[58:59], v[34:35] neg_lo:[0,1] neg_hi:[0,1]
    v_pk_fma_f32 v[76:77], v[92:93], s[8:9], v[76:77]
    v_pk_fma_f32 v[78:79], v[94:95], s[8:9], v[78:79]
    v_pk_add_f32 v[56:57], v[56:57], v[92:93] neg_lo:[0,1] neg_hi:[0,1]
    v_pk_add_f32 v[58:59], v[58:59], v[94:95] neg_lo:[0,1] neg_hi:[0,1]
    v_pk_fma_f32 v[52:53], v[92:93], s[22:23], v[52:53]
    v_pk_fma_f32 v[54:55], v[94:95], s[22:23], v[54:55]
    v_pk_add_f32 v[40:41], v[56:57], v[76:77] neg_lo:[0,1] neg_hi:[0,1]
    v_pk_add_f32 v[42:43], v[58:59], v[78:79] neg_lo:[0,1] neg_hi:[0,1]
    v_pk_fma_f32 v[52:53], v[76:77], s[14:15], v[52:53]
    v_pk_fma_f32 v[54:55], v[78:79], s[14:15], v[54:55]
    v_pk_mul_f32 v[84:85], v[44:45], s[32:33]
    v_pk_mul_f32 v[86:87], v[46:47], s[32:33]
    v_pk_fma_f32 v[52:53], v[40:41], s[12:13], v[52:53]
    v_pk_fma_f32 v[54:55], v[42:43], s[12:13], v[54:55]
    v_pk_fma_f32 v[84:85], v[36:37], s[34:35], v[84:85]
    v_pk_fma_f32 v[86:87], v[38:39], s[34:35], v[86:87]
    v_pk_fma_f32 v[68:69], v[36:37], s[24:25], v[52:53] neg_lo:[0,0,1] neg_hi:[0,0,1]
    v_pk_fma_f32 v[70:71], v[38:39], s[24:25], v[54:55] neg_lo:[0,0,1] neg_hi:[0,0,1]
    v_pk_fma_f32 v[68:69], v[44:45], s[26:27], v[68:69]
    v_pk_fma_f32 v[70:71], v[46:47], s[26:27], v[70:71]
    v_pk_fma_f32 v[84:85], v[68:69], s[38:39], v[84:85]
    v_pk_fma_f32 v[86:87], v[70:71], s[38:39], v[86:87]
    v_pk_add_f32 v[36:37], v[36:37], v[68:69] neg_lo:[0,1] neg_hi:[0,1]
    v_pk_add_f32 v[38:39], v[38:39], v[70:71] neg_lo:[0,1] neg_hi:[0,1]
    v_pk_add_f32 v[36:37], v[36:37], v[84:85] neg_lo:[0,1] neg_hi:[0,1]
    v_pk_add_f32 v[38:39], v[38:39], v[86:87] neg_lo:[0,1] neg_hi:[0,1]
    s_mov_b32 s36, 0x00010001
    s_mov_b32 s37, 0x00010001
    s_mov_b64 exec, s[36:37]
    ds_write_b128 v127, v[0:3] offset:0
    ds_write_b128 v127, v[32:35] offset:16
    ds_write_b128 v127, v[4:7] offset:32
    ds_write_b128 v127, v[36:39] offset:48
    ds_write_b128 v127, v[8:11] offset:64
    ds_write_b128 v127, v[40:43] offset:80
    s_mov_b64 exec, -1
    v_mov_b32 v44, 0xc0135761
    v_mov_b32 v45, v44
    v_pk_mul_f32 v[16:17], v[64:65], v[64:65]
    v_pk_mul_f32 v[18:19], v[66:67], v[66:67]
    v_pk_mul_f32 v[20:21], v[68:69], v[68:69]
    v_pk_mul_f32 v[22:23], v[70:71], v[70:71]
    v_pk_fma_f32 v[16:17], v[16:17], s[40:41], v[44:45]
    v_pk_fma_f32 v[18:19], v[18:19], s[40:41], v[44:45]
    v_pk_fma_f32 v[20:21], v[20:21], s[40:41], v[44:45]
    v_pk_fma_f32 v[22:23], v[22:23], s[40:41], v[44:45]
    v_pk_mul_f32 v[16:17], v[16:17], v[64:65]
    v_pk_mul_f32 v[18:19], v[18:19], v[66:67]
    v_pk_mul_f32 v[20:21], v[20:21], v[68:69]
    v_pk_mul_f32 v[22:23], v[22:23], v[70:71]
    v_exp_f32 v16, v16
    v_exp_f32 v17, v17
    v_exp_f32 v18, v18
    v_exp_f32 v19, v19
    v_exp_f32 v20, v20
    v_exp_f32 v21, v21
    v_exp_f32 v22, v22
    v_exp_f32 v23, v23
    v_pk_add_f32 v[16:17], v[16:17], s[42:43]
    v_pk_add_f32 v[18:19], v[18:19], s[42:43]
    v_pk_add_f32 v[20:21], v[20:21], s[42:43]
    v_pk_add_f32 v[22:23], v[22:23], s[42:43]
    v_rcp_f32 v16, v16
    v_rcp_f32 v17, v17
    v_rcp_f32 v18, v18
    v_rcp_f32 v19, v19
    v_rcp_f32 v20, v20
    v_rcp_f32 v21, v21
    v_rcp_f32 v22, v22
    v_rcp_f32 v23, v23
    v_pk_mul_f32 v[64:65], v[64:65], v[16:17]
    v_pk_mul_f32 v[66:67], v[66:67], v[18:19]
    v_pk_mul_f32 v[68:69], v[68:69], v[20:21]
    v_pk_mul_f32 v[70:71], v[70:71], v[22:23]
    v_cvt_pk_bf16_f32 v48, v64, v68
    v_cvt_pk_bf16_f32 v49, v65, v69
    v_cvt_pk_bf16_f32 v50, v66, v70
    v_cvt_pk_bf16_f32 v51, v67, v71
    s_mov_b32 s44, 393280
    buffer_store_dwordx4 v[48:51], v122, s[16:19], s44 offen sc1
    s_waitcnt lgkmcnt(0)
    s_barrier
    ds_read_b128 v[96:99], v127 offset:512
    ds_read_b128 v[100:103], v127 offset:528
    ds_read_b128 v[104:107], v127 offset:544
    ds_read_b128 v[108:111], v127 offset:560
    ds_read_b128 v[112:115], v127 offset:576
    ds_read_b128 v[116:119], v127 offset:592
    s_waitcnt lgkmcnt(4)
    v_mov_b32_dpp v96, v0 row_shl:1 row_mask:0xf bank_mask:0xf
    v_mov_b32_dpp v97, v1 row_shl:1 row_mask:0xf bank_mask:0xf
    v_mov_b32_dpp v98, v2 row_shl:1 row_mask:0xf bank_mask:0xf
    v_mov_b32_dpp v99, v3 row_shl:1 row_mask:0xf bank_mask:0xf
    v_mov_b32_dpp v100, v32 row_shl:1 row_mask:0xf bank_mask:0xf
    v_mov_b32_dpp v101, v33 row_shl:1 row_mask:0xf bank_mask:0xf
    v_mov_b32_dpp v102, v34 row_shl:1 row_mask:0xf bank_mask:0xf
    v_mov_b32_dpp v103, v35 row_shl:1 row_mask:0xf bank_mask:0xf
    v_pk_add_f32 v[72:73], v[72:73], v[96:97]
    v_pk_add_f32 v[74:75], v[74:75], v[98:99]
    v_pk_add_f32 v[76:77], v[76:77], v[100:101]
    v_pk_add_f32 v[78:79], v[78:79], v[102:103]
    v_pk_mul_f32 v[24:25], v[72:73], v[72:73]
    v_pk_mul_f32 v[26:27], v[74:75], v[74:75]
    v_pk_mul_f32 v[28:29], v[76:77], v[76:77]
    v_pk_mul_f32 v[30:31], v[78:79], v[78:79]
    v_pk_fma_f32 v[24:25], v[24:25], s[40:41], v[44:45]
    v_pk_fma_f32 v[26:27], v[26:27], s[40:41], v[44:45]
    v_pk_fma_f32 v[28:29], v[28:29], s[40:41], v[44:45]
    v_pk_fma_f32 v[30:31], v[30:31], s[40:41], v[44:45]
    v_pk_mul_f32 v[24:25], v[24:25], v[72:73]
    v_pk_mul_f32 v[26:27], v[26:27], v[74:75]
    v_pk_mul_f32 v[28:29], v[28:29], v[76:77]
    v_pk_mul_f32 v[30:31], v[30:31], v[78:79]
    v_exp_f32 v24, v24
    v_exp_f32 v25, v25
    v_exp_f32 v26, v26
    v_exp_f32 v27, v27
    v_exp_f32 v28, v28
    v_exp_f32 v29, v29
    v_exp_f32 v30, v30
    v_exp_f32 v31, v31
    v_pk_add_f32 v[24:25], v[24:25], s[42:43]
    v_pk_add_f32 v[26:27], v[26:27], s[42:43]
    v_pk_add_f32 v[28:29], v[28:29], s[42:43]
    v_pk_add_f32 v[30:31], v[30:31], s[42:43]
    v_rcp_f32 v24, v24
    v_rcp_f32 v25, v25
    v_rcp_f32 v26, v26
    v_rcp_f32 v27, v27
    v_rcp_f32 v28, v28
    v_rcp_f32 v29, v29
    v_rcp_f32 v30, v30
    v_rcp_f32 v31, v31
    v_pk_mul_f32 v[72:73], v[72:73], v[24:25]
    v_pk_mul_f32 v[74:75], v[74:75], v[26:27]
    v_pk_mul_f32 v[76:77], v[76:77], v[28:29]
    v_pk_mul_f32 v[78:79], v[78:79], v[30:31]
    v_cvt_pk_bf16_f32 v52, v72, v76
    v_cvt_pk_bf16_f32 v53, v73, v77
    v_cvt_pk_bf16_f32 v54, v74, v78
    v_cvt_pk_bf16_f32 v55, v75, v79
    s_mov_b32 s44, 128
    buffer_store_dwordx4 v[52:55], v122, s[16:19], s44 offen sc1
    s_waitcnt lgkmcnt(2)
    v_mov_b32_dpp v104, v4 row_shl:1 row_mask:0xf bank_mask:0xf
    v_mov_b32_dpp v105, v5 row_shl:1 row_mask:0xf bank_mask:0xf
    v_mov_b32_dpp v106, v6 row_shl:1 row_mask:0xf bank_mask:0xf
    v_mov_b32_dpp v107, v7 row_shl:1 row_mask:0xf bank_mask:0xf
    v_mov_b32_dpp v108, v36 row_shl:1 row_mask:0xf bank_mask:0xf
    v_mov_b32_dpp v109, v37 row_shl:1 row_mask:0xf bank_mask:0xf
    v_mov_b32_dpp v110, v38 row_shl:1 row_mask:0xf bank_mask:0xf
    v_mov_b32_dpp v111, v39 row_shl:1 row_mask:0xf bank_mask:0xf
    v_pk_add_f32 v[80:81], v[80:81], v[104:105]
    v_pk_add_f32 v[82:83], v[82:83], v[106:107]
    v_pk_add_f32 v[84:85], v[84:85], v[108:109]
    v_pk_add_f32 v[86:87], v[86:87], v[110:111]
    v_pk_mul_f32 v[16:17], v[80:81], v[80:81]
    v_pk_mul_f32 v[18:19], v[82:83], v[82:83]
    v_pk_mul_f32 v[20:21], v[84:85], v[84:85]
    v_pk_mul_f32 v[22:23], v[86:87], v[86:87]
    v_pk_fma_f32 v[16:17], v[16:17], s[40:41], v[44:45]
    v_pk_fma_f32 v[18:19], v[18:19], s[40:41], v[44:45]
    v_pk_fma_f32 v[20:21], v[20:21], s[40:41], v[44:45]
    v_pk_fma_f32 v[22:23], v[22:23], s[40:41], v[44:45]
    v_pk_mul_f32 v[16:17], v[16:17], v[80:81]
    v_pk_mul_f32 v[18:19], v[18:19], v[82:83]
    v_pk_mul_f32 v[20:21], v[20:21], v[84:85]
    v_pk_mul_f32 v[22:23], v[22:23], v[86:87]
    v_exp_f32 v16, v16
    v_exp_f32 v17, v17
    v_exp_f32 v18, v18
    v_exp_f32 v19, v19
    v_exp_f32 v20, v20
    v_exp_f32 v21, v21
    v_exp_f32 v22, v22
    v_exp_f32 v23, v23
    v_pk_add_f32 v[16:17], v[16:17], s[42:43]
    v_pk_add_f32 v[18:19], v[18:19], s[42:43]
    v_pk_add_f32 v[20:21], v[20:21], s[42:43]
    v_pk_add_f32 v[22:23], v[22:23], s[42:43]
    v_rcp_f32 v16, v16
    v_rcp_f32 v17, v17
    v_rcp_f32 v18, v18
    v_rcp_f32 v19, v19
    v_rcp_f32 v20, v20
    v_rcp_f32 v21, v21
    v_rcp_f32 v22, v22
    v_rcp_f32 v23, v23
    v_pk_mul_f32 v[80:81], v[80:81], v[16:17]
    v_pk_mul_f32 v[82:83], v[82:83], v[18:19]
    v_pk_mul_f32 v[84:85], v[84:85], v[20:21]
    v_pk_mul_f32 v[86:87], v[86:87], v[22:23]
    v_cvt_pk_bf16_f32 v56, v80, v84
    v_cvt_pk_bf16_f32 v57, v81, v85
    v_cvt_pk_bf16_f32 v58, v82, v86
    v_cvt_pk_bf16_f32 v59, v83, v87
    s_mov_b32 s44, 131200
    buffer_store_dwordx4 v[56:59], v122, s[16:19], s44 offen sc1
    s_waitcnt lgkmcnt(0)
    v_mov_b32_dpp v112, v8 row_shl:1 row_mask:0xf bank_mask:0xf
    v_mov_b32_dpp v113, v9 row_shl:1 row_mask:0xf bank_mask:0xf
    v_mov_b32_dpp v114, v10 row_shl:1 row_mask:0xf bank_mask:0xf
    v_mov_b32_dpp v115, v11 row_shl:1 row_mask:0xf bank_mask:0xf
    v_mov_b32_dpp v116, v40 row_shl:1 row_mask:0xf bank_mask:0xf
    v_mov_b32_dpp v117, v41 row_shl:1 row_mask:0xf bank_mask:0xf
    v_mov_b32_dpp v118, v42 row_shl:1 row_mask:0xf bank_mask:0xf
    v_mov_b32_dpp v119, v43 row_shl:1 row_mask:0xf bank_mask:0xf
    v_pk_add_f32 v[88:89], v[88:89], v[112:113]
    v_pk_add_f32 v[90:91], v[90:91], v[114:115]
    v_pk_add_f32 v[92:93], v[92:93], v[116:117]
    v_pk_add_f32 v[94:95], v[94:95], v[118:119]
    v_pk_mul_f32 v[24:25], v[88:89], v[88:89]
    v_pk_mul_f32 v[26:27], v[90:91], v[90:91]
    v_pk_mul_f32 v[28:29], v[92:93], v[92:93]
    v_pk_mul_f32 v[30:31], v[94:95], v[94:95]
    v_pk_fma_f32 v[24:25], v[24:25], s[40:41], v[44:45]
    v_pk_fma_f32 v[26:27], v[26:27], s[40:41], v[44:45]
    v_pk_fma_f32 v[28:29], v[28:29], s[40:41], v[44:45]
    v_pk_fma_f32 v[30:31], v[30:31], s[40:41], v[44:45]
    v_pk_mul_f32 v[24:25], v[24:25], v[88:89]
    v_pk_mul_f32 v[26:27], v[26:27], v[90:91]
    v_pk_mul_f32 v[28:29], v[28:29], v[92:93]
    v_pk_mul_f32 v[30:31], v[30:31], v[94:95]
    v_exp_f32 v24, v24
    v_exp_f32 v25, v25
    v_exp_f32 v26, v26
    v_exp_f32 v27, v27
    v_exp_f32 v28, v28
    v_exp_f32 v29, v29
    v_exp_f32 v30, v30
    v_exp_f32 v31, v31
    v_pk_add_f32 v[24:25], v[24:25], s[42:43]
    v_pk_add_f32 v[26:27], v[26:27], s[42:43]
    v_pk_add_f32 v[28:29], v[28:29], s[42:43]
    v_pk_add_f32 v[30:31], v[30:31], s[42:43]
    v_rcp_f32 v24, v24
    v_rcp_f32 v25, v25
    v_rcp_f32 v26, v26
    v_rcp_f32 v27, v27
    v_rcp_f32 v28, v28
    v_rcp_f32 v29, v29
    v_rcp_f32 v30, v30
    v_rcp_f32 v31, v31
    v_pk_mul_f32 v[88:89], v[88:89], v[24:25]
    v_pk_mul_f32 v[90:91], v[90:91], v[26:27]
    v_pk_mul_f32 v[92:93], v[92:93], v[28:29]
    v_pk_mul_f32 v[94:95], v[94:95], v[30:31]
    v_cvt_pk_bf16_f32 v60, v88, v92
    v_cvt_pk_bf16_f32 v61, v89, v93
    v_cvt_pk_bf16_f32 v62, v90, v94
    v_cvt_pk_bf16_f32 v63, v91, v95
    s_mov_b32 s44, 262272
    buffer_store_dwordx4 v[60:63], v122, s[16:19], s44 offen sc1
L_conv1_kernel_end:
L_conv1_kernel_done:
    s_endpgm
.globl conv2_kernel
.p2align 8
.type conv2_kernel,@function
conv2_kernel:
    s_cmp_ge_u32 s2, 256
    s_cbranch_scc1 L_conv2_kernel_done
    s_load_dwordx2 s[4:5], s[0:1], 72
    s_load_dwordx2 s[30:31], s[0:1], 72
    v_readfirstlane_b32 s20, v0
    s_lshr_b32 s20, s20, 6
    s_xor_b32 s20, s20, 8
    s_and_b32 s36, s2, 0
    s_lshl_b32 s36, s36, 3
    s_bfe_u32 s37, s2, 196611
    s_or_b32 s29, s36, s37
    s_bfe_u32 s36, s2, 196608
    s_lshl_b32 s36, s36, 2
    s_lshr_b32 s37, s2, 6
    s_or_b32 s36, s36, s37
    s_lshr_b32 s33, s36, 4
    s_and_b32 s34, s36, 7
    s_bfe_u32 s35, s36, 0x10003
    s_mul_i32 s21, s34, 500
    s_and_b32 s32, s20, 3
    v_and_b32 v127, 63, v0
    v_lshrrev_b32 v5, 2, v127
    v_and_b32 v6, 3, v127
    s_and_b32 s42, s20, 7
    s_lshr_b32 s41, s21, 2
    s_sub_u32 s41, s41, 1
    s_add_u32 s37, s41, s42
    v_lshl_add_u32 v7, v5, 3, s37
    s_mul_i32 s36, s35, 4194304
    s_add_u32 s36, s36, 18874368
    s_mov_b32 s10, 4194304
    s_mov_b32 s11, 0x00020000
    s_mov_b32 s25, 0xffff0000
    s_mov_b32 s47, s36
    s_cmp_ge_u32 s20, 8
    s_cbranch_scc0 L_conv2_kernel_mw
L_conv2_kernel_helper:
    s_setprio 3
    v_lshlrev_b32 v8, 4, v6
    s_add_u32 s37, s33, 4294967289
    v_lshl_add_u32 v9, v7, 3, s37
    v_cmp_gt_u32 vcc, 8000, v9
    s_mul_i32 s37, s33, 131072
    s_add_u32 s37, s37, 0
    v_lshl_add_u32 v92, v7, 7, s37
    v_add_u32 v92, v92, v8
    v_mov_b32 v9, 2130706432
    v_cndmask_b32 v92, v9, v92, vcc
    s_add_u32 s37, s33, 4294967291
    v_lshl_add_u32 v9, v7, 3, s37
    v_cmp_gt_u32 vcc, 8000, v9
    s_mul_i32 s37, s33, 131072
    s_add_u32 s37, s37, 262144
    v_lshl_add_u32 v93, v7, 7, s37
    v_add_u32 v93, v93, v8
    v_mov_b32 v9, 2130706432
    v_cndmask_b32 v93, v9, v93, vcc
    s_add_u32 s37, s33, 4294967293
    v_lshl_add_u32 v9, v7, 3, s37
    v_cmp_gt_u32 vcc, 8000, v9
    s_mul_i32 s37, s33, 131072
    s_add_u32 s37, s37, 64
    v_lshl_add_u32 v94, v7, 7, s37
    v_add_u32 v94, v94, v8
    v_mov_b32 v9, 2130706432
    v_cndmask_b32 v94, v9, v94, vcc
    s_add_u32 s37, s33, 4294967295
    v_lshl_add_u32 v9, v7, 3, s37
    v_cmp_gt_u32 vcc, 8000, v9
    s_mul_i32 s37, s33, 131072
    s_add_u32 s37, s37, 262208
    v_lshl_add_u32 v95, v7, 7, s37
    v_add_u32 v95, v95, v8
    v_mov_b32 v9, 2130706432
    v_cndmask_b32 v95, v9, v95, vcc
    v_and_b32 v76, 4, v5
    v_lshrrev_b32 v76, 1, v76
    v_xor_b32 v76, v6, v76
    v_lshlrev_b32 v76, 4, v76
    v_lshl_add_u32 v76, v5, 6, v76
    s_mov_b32 s24, 0
    s_mov_b32 s27, 524288
    s_waitcnt lgkmcnt(0)
    s_add_u32 s8, s4, s47
    s_addc_u32 s9, s5, 0
    buffer_load_dwordx4 v[0:3], v92, s[8:11], s24 offen
    buffer_load_dwordx4 v[8:11], v94, s[8:11], s24 offen
    buffer_load_dwordx4 v[4:7], v93, s[8:11], s24 offen
    buffer_load_dwordx4 v[12:15], v95, s[8:11], s24 offen
    buffer_load_dwordx4 v[16:19], v92, s[8:11], s27 offen
    buffer_load_dwordx4 v[24:27], v94, s[8:11], s27 offen
    buffer_load_dwordx4 v[20:23], v93, s[8:11], s27 offen
    buffer_load_dwordx4 v[28:31], v95, s[8:11], s27 offen
    s_mul_i32 s36, s42, 1024
    v_add_u32 v96, s36, v76
    v_add_u32 v97, 65536, v96
    s_mul_i32 s36, s42, 1088
    s_add_u32 s36, s36, 98304
    v_add_u32 v98, s36, v76
    s_waitcnt vmcnt(0)
    s_mov_b32 s28, 0
    s_mov_b32 s22, 2
    ds_write_b128 v96, v[0:3] offset:0
    ds_write_b128 v98, v[12:15] offset:0
    v_lshlrev_b32 v76, 16, v0
    v_and_b32 v84, s25, v0
    v_lshlrev_b32 v77, 16, v4
    v_and_b32 v85, s25, v4
    v_lshlrev_b32 v78, 16, v8
    v_and_b32 v86, s25, v8
    v_lshlrev_b32 v79, 16, v12
    v_and_b32 v87, s25, v12
    v_add_f32 v80, v76, v78
    v_add_f32 v88, v84, v86
    v_add_f32 v81, v77, v79
    v_add_f32 v89, v85, v87
    v_fma_f32 v82, v78, 4.0, v76
    v_fma_f32 v90, v86, 4.0, v84
    v_fma_f32 v83, v79, 4.0, v77
    v_fma_f32 v91, v87, 4.0, v85
    v_add_f32 v77, v80, v81
    v_add_f32 v85, v88, v89
    v_sub_f32 v78, v80, v81
    v_sub_f32 v86, v88, v89
    v_fma_f32 v79, v83, 2.0, v82
    v_fma_f32 v87, v91, 2.0, v90
    v_fma_f32 v82, v83, -2.0, v82
    v_fma_f32 v90, v91, -2.0, v90
    v_fmamk_f32 v80, v76, 0x41700000, v82
    v_fmamk_f32 v88, v84, 0x41700000, v90
    v_fmamk_f32 v80, v81, 0x41200000, v80
    v_fmamk_f32 v88, v89, 0x41200000, v88
    v_cvt_pk_bf16_f32 v4, v77, v85
    v_cvt_pk_bf16_f32 v8, v78, v86
    v_cvt_pk_bf16_f32 v64, v79, v87
    v_cvt_pk_bf16_f32 v68, v82, v90
    v_cvt_pk_bf16_f32 v72, v80, v88
    v_lshlrev_b32 v76, 16, v1
    v_and_b32 v84, s25, v1
    v_lshlrev_b32 v77, 16, v5
    v_and_b32 v85, s25, v5
    v_lshlrev_b32 v78, 16, v9
    v_and_b32 v86, s25, v9
    v_lshlrev_b32 v79, 16, v13
    v_and_b32 v87, s25, v13
    v_add_f32 v80, v76, v78
    v_add_f32 v88, v84, v86
    v_add_f32 v81, v77, v79
    v_add_f32 v89, v85, v87
    v_fma_f32 v82, v78, 4.0, v76
    v_fma_f32 v90, v86, 4.0, v84
    v_fma_f32 v83, v79, 4.0, v77
    v_fma_f32 v91, v87, 4.0, v85
    v_add_f32 v77, v80, v81
    v_add_f32 v85, v88, v89
    v_sub_f32 v78, v80, v81
    v_sub_f32 v86, v88, v89
    v_fma_f32 v79, v83, 2.0, v82
    v_fma_f32 v87, v91, 2.0, v90
    v_fma_f32 v82, v83, -2.0, v82
    v_fma_f32 v90, v91, -2.0, v90
    v_fmamk_f32 v80, v76, 0x41700000, v82
    v_fmamk_f32 v88, v84, 0x41700000, v90
    v_fmamk_f32 v80, v81, 0x41200000, v80
    v_fmamk_f32 v88, v89, 0x41200000, v88
    v_cvt_pk_bf16_f32 v5, v77, v85
    v_cvt_pk_bf16_f32 v9, v78, v86
    v_cvt_pk_bf16_f32 v65, v79, v87
    v_cvt_pk_bf16_f32 v69, v82, v90
    v_cvt_pk_bf16_f32 v73, v80, v88
    v_lshlrev_b32 v76, 16, v2
    v_and_b32 v84, s25, v2
    v_lshlrev_b32 v77, 16, v6
    v_and_b32 v85, s25, v6
    v_lshlrev_b32 v78, 16, v10
    v_and_b32 v86, s25, v10
    v_lshlrev_b32 v79, 16, v14
    v_and_b32 v87, s25, v14
    v_add_f32 v80, v76, v78
    v_add_f32 v88, v84, v86
    v_add_f32 v81, v77, v79
    v_add_f32 v89, v85, v87
    v_fma_f32 v82, v78, 4.0, v76
    v_fma_f32 v90, v86, 4.0, v84
    v_fma_f32 v83, v79, 4.0, v77
    v_fma_f32 v91, v87, 4.0, v85
    v_add_f32 v77, v80, v81
    v_add_f32 v85, v88, v89
    v_sub_f32 v78, v80, v81
    v_sub_f32 v86, v88, v89
    v_fma_f32 v79, v83, 2.0, v82
    v_fma_f32 v87, v91, 2.0, v90
    v_fma_f32 v82, v83, -2.0, v82
    v_fma_f32 v90, v91, -2.0, v90
    v_fmamk_f32 v80, v76, 0x41700000, v82
    v_fmamk_f32 v88, v84, 0x41700000, v90
    v_fmamk_f32 v80, v81, 0x41200000, v80
    v_fmamk_f32 v88, v89, 0x41200000, v88
    v_cvt_pk_bf16_f32 v6, v77, v85
    v_cvt_pk_bf16_f32 v10, v78, v86
    v_cvt_pk_bf16_f32 v66, v79, v87
    v_cvt_pk_bf16_f32 v70, v82, v90
    v_cvt_pk_bf16_f32 v74, v80, v88
    v_lshlrev_b32 v76, 16, v3
    v_and_b32 v84, s25, v3
    v_lshlrev_b32 v77, 16, v7
    v_and_b32 v85, s25, v7
    v_lshlrev_b32 v78, 16, v11
    v_and_b32 v86, s25, v11
    v_lshlrev_b32 v79, 16, v15
    v_and_b32 v87, s25, v15
    v_add_f32 v80, v76, v78
    v_add_f32 v88, v84, v86
    v_add_f32 v81, v77, v79
    v_add_f32 v89, v85, v87
    v_fma_f32 v82, v78, 4.0, v76
    v_fma_f32 v90, v86, 4.0, v84
    v_fma_f32 v83, v79, 4.0, v77
    v_fma_f32 v91, v87, 4.0, v85
    v_add_f32 v77, v80, v81
    v_add_f32 v85, v88, v89
    v_sub_f32 v78, v80, v81
    v_sub_f32 v86, v88, v89
    v_fma_f32 v79, v83, 2.0, v82
    v_fma_f32 v87, v91, 2.0, v90
    v_fma_f32 v82, v83, -2.0, v82
    v_fma_f32 v90, v91, -2.0, v90
    v_fmamk_f32 v80, v76, 0x41700000, v82
    v_fmamk_f32 v88, v84, 0x41700000, v90
    v_fmamk_f32 v80, v81, 0x41200000, v80
    v_fmamk_f32 v88, v89, 0x41200000, v88
    v_cvt_pk_bf16_f32 v7, v77, v85
    v_cvt_pk_bf16_f32 v11, v78, v86
    v_cvt_pk_bf16_f32 v67, v79, v87
    v_cvt_pk_bf16_f32 v71, v82, v90
    v_cvt_pk_bf16_f32 v75, v80, v88
    ds_write_b128 v96, v[64:67] offset:49152
    ds_write_b128 v97, v[68:71] offset:0
    ds_write_b128 v97, v[72:75] offset:16384
    ds_write_b128 v96, v[4:7] offset:16384
    ds_write_b128 v96, v[8:11] offset:32768
    s_cmp_ge_u32 s20, 12
    s_cbranch_scc1 L_conv2_kernel_h2
    s_mov_b32 s24, 1048576
    s_mov_b32 s27, 1572864
    s_waitcnt lgkmcnt(0)
    s_barrier
    buffer_load_dwordx4 v[32:35], v92, s[8:11], s24 offen
    buffer_load_dwordx4 v[40:43], v94, s[8:11], s24 offen
    buffer_load_dwordx4 v[36:39], v93, s[8:11], s24 offen
    buffer_load_dwordx4 v[44:47], v95, s[8:11], s24 offen
    s_setprio 1
L_conv2_kernel_hloop1:
    v_lshlrev_b32 v76, 16, v16
    v_and_b32 v84, s25, v16
    v_lshlrev_b32 v77, 16, v20
    v_and_b32 v85, s25, v20
    v_lshlrev_b32 v78, 16, v24
    v_and_b32 v86, s25, v24
    v_lshlrev_b32 v79, 16, v28
    v_and_b32 v87, s25, v28
    v_add_f32 v80, v76, v78
    v_add_f32 v88, v84, v86
    v_add_f32 v81, v77, v79
    v_add_f32 v89, v85, v87
    v_fma_f32 v82, v78, 4.0, v76
    buffer_load_dwordx4 v[48:51], v92, s[8:11], s27 offen
    buffer_load_dwordx4 v[56:59], v94, s[8:11], s27 offen
    v_fma_f32 v90, v86, 4.0, v84
    v_fma_f32 v83, v79, 4.0, v77
    v_fma_f32 v91, v87, 4.0, v85
    v_add_f32 v77, v80, v81
    v_add_f32 v85, v88, v89
    v_sub_f32 v78, v80, v81
    v_sub_f32 v86, v88, v89
    v_fma_f32 v79, v83, 2.0, v82
    v_fma_f32 v87, v91, 2.0, v90
    v_fma_f32 v82, v83, -2.0, v82
    v_fma_f32 v90, v91, -2.0, v90
    v_fmamk_f32 v80, v76, 0x41700000, v82
    v_fmamk_f32 v88, v84, 0x41700000, v90
    v_fmamk_f32 v80, v81, 0x41200000, v80
    v_fmamk_f32 v88, v89, 0x41200000, v88
    v_cvt_pk_bf16_f32 v20, v77, v85
    v_cvt_pk_bf16_f32 v24, v78, v86
    v_cvt_pk_bf16_f32 v64, v79, v87
    v_cvt_pk_bf16_f32 v68, v82, v90
    v_cvt_pk_bf16_f32 v72, v80, v88
    v_lshlrev_b32 v76, 16, v17
    v_and_b32 v84, s25, v17
    v_lshlrev_b32 v77, 16, v21
    v_and_b32 v85, s25, v21
    v_lshlrev_b32 v78, 16, v25
    v_and_b32 v86, s25, v25
    v_lshlrev_b32 v79, 16, v29
    v_and_b32 v87, s25, v29
    v_add_f32 v80, v76, v78
    v_add_f32 v88, v84, v86
    v_add_f32 v81, v77, v79
    v_add_f32 v89, v85, v87
    v_fma_f32 v82, v78, 4.0, v76
    v_fma_f32 v90, v86, 4.0, v84
    v_fma_f32 v83, v79, 4.0, v77
    v_fma_f32 v91, v87, 4.0, v85
    v_add_f32 v77, v80, v81
    v_add_f32 v85, v88, v89
    v_sub_f32 v78, v80, v81
    v_sub_f32 v86, v88, v89
    v_fma_f32 v79, v83, 2.0, v82
    v_fma_f32 v87, v91, 2.0, v90
    v_fma_f32 v82, v83, -2.0, v82
    v_fma_f32 v90, v91, -2.0, v90
    v_fmamk_f32 v80, v76, 0x41700000, v82
    v_fmamk_f32 v88, v84, 0x41700000, v90
    v_fmamk_f32 v80, v81, 0x41200000, v80
    v_fmamk_f32 v88, v89, 0x41200000, v88
    v_cvt_pk_bf16_f32 v21, v77, v85
    v_cvt_pk_bf16_f32 v25, v78, v86
    v_cvt_pk_bf16_f32 v65, v79, v87
    v_cvt_pk_bf16_f32 v69, v82, v90
    v_cvt_pk_bf16_f32 v73, v80, v88
    buffer_load_dwordx4 v[52:55], v93, s[8:11], s27 offen
    buffer_load_dwordx4 v[60:63], v95, s[8:11], s27 offen
    v_lshlrev_b32 v76, 16, v18
    v_and_b32 v84, s25, v18
    v_lshlrev_b32 v77, 16, v22
    v_and_b32 v85, s25, v22
    v_lshlrev_b32 v78, 16, v26
    v_and_b32 v86, s25, v26
    v_lshlrev_b32 v79, 16, v30
    v_and_b32 v87, s25, v30
    v_add_f32 v80, v76, v78
    v_add_f32 v88, v84, v86
    v_add_f32 v81, v77, v79
    v_add_f32 v89, v85, v87
    v_fma_f32 v82, v78, 4.0, v76
    v_fma_f32 v90, v86, 4.0, v84
    v_fma_f32 v83, v79, 4.0, v77
    v_fma_f32 v91, v87, 4.0, v85
    v_add_f32 v77, v80, v81
    v_add_f32 v85, v88, v89
    v_sub_f32 v78, v80, v81
    v_sub_f32 v86, v88, v89
    v_fma_f32 v79, v83, 2.0, v82
    v_fma_f32 v87, v91, 2.0, v90
    v_fma_f32 v82, v83, -2.0, v82
    v_fma_f32 v90, v91, -2.0, v90
    v_fmamk_f32 v80, v76, 0x41700000, v82
    v_fmamk_f32 v88, v84, 0x41700000, v90
    v_fmamk_f32 v80, v81, 0x41200000, v80
    v_fmamk_f32 v88, v89, 0x41200000, v88
    v_cvt_pk_bf16_f32 v22, v77, v85
    v_cvt_pk_bf16_f32 v26, v78, v86
    v_cvt_pk_bf16_f32 v66, v79, v87
    v_cvt_pk_bf16_f32 v70, v82, v90
    v_cvt_pk_bf16_f32 v74, v80, v88
    v_lshlrev_b32 v76, 16, v19
    v_and_b32 v84, s25, v19
    v_lshlrev_b32 v77, 16, v23
    v_and_b32 v85, s25, v23
    v_lshlrev_b32 v78, 16, v27
    v_and_b32 v86, s25, v27
    v_lshlrev_b32 v79, 16, v31
    v_and_b32 v87, s25, v31
    v_add_f32 v80, v76, v78
    v_add_f32 v88, v84, v86
    v_add_f32 v81, v77, v79
    v_add_f32 v89, v85, v87
    v_fma_f32 v82, v78, 4.0, v76
    v_fma_f32 v90, v86, 4.0, v84
    v_fma_f32 v83, v79, 4.0, v77
    v_fma_f32 v91, v87, 4.0, v85
    v_add_f32 v77, v80, v81
    v_add_f32 v85, v88, v89
    v_sub_f32 v78, v80, v81
    v_sub_f32 v86, v88, v89
    v_fma_f32 v79, v83, 2.0, v82
    v_fma_f32 v87, v91, 2.0, v90
    v_fma_f32 v82, v83, -2.0, v82
    v_fma_f32 v90, v91, -2.0, v90
    v_fmamk_f32 v80, v76, 0x41700000, v82
    v_fmamk_f32 v88, v84, 0x41700000, v90
    v_fmamk_f32 v80, v81, 0x41200000, v80
    v_fmamk_f32 v88, v89, 0x41200000, v88
    v_cvt_pk_bf16_f32 v23, v77, v85
    v_cvt_pk_bf16_f32 v27, v78, v86
    v_cvt_pk_bf16_f32 v67, v79, v87
    v_cvt_pk_bf16_f32 v71, v82, v90
    v_cvt_pk_bf16_f32 v75, v80, v88
    ds_write_b128 v96, v[64:67] offset:57344
    ds_write_b128 v97, v[68:71] offset:8192
    ds_write_b128 v97, v[72:75] offset:24576
    ds_write_b128 v96, v[16:19] offset:8192
    ds_write_b128 v96, v[20:23] offset:24576
    ds_write_b128 v96, v[24:27] offset:40960
    ds_write_b128 v98, v[28:31] offset:8704
    s_add_u32 s28, s28, 1
    s_waitcnt lgkmcnt(0)
    s_barrier
    s_add_u32 s24, s24, 1048576
    s_add_u32 s27, s27, 1048576
    s_waitcnt vmcnt(0)
    v_lshlrev_b32 v76, 16, v32
    v_and_b32 v84, s25, v32
    v_lshlrev_b32 v77, 16, v36
    v_and_b32 v85, s25, v36
    v_lshlrev_b32 v78, 16, v40
    v_and_b32 v86, s25, v40
    v_lshlrev_b32 v79, 16, v44
    v_and_b32 v87, s25, v44
    v_add_f32 v80, v76, v78
    v_add_f32 v88, v84, v86
    v_add_f32 v81, v77, v79
    v_add_f32 v89, v85, v87
    v_fma_f32 v82, v78, 4.0, v76
    v_fma_f32 v90, v86, 4.0, v84
    v_fma_f32 v83, v79, 4.0, v77
    v_fma_f32 v91, v87, 4.0, v85
    v_add_f32 v77, v80, v81
    v_add_f32 v85, v88, v89
    v_sub_f32 v78, v80, v81
    v_sub_f32 v86, v88, v89
    v_fma_f32 v79, v83, 2.0, v82
    v_fma_f32 v87, v91, 2.0, v90
    v_fma_f32 v82, v83, -2.0, v82
    v_fma_f32 v90, v91, -2.0, v90
    v_fmamk_f32 v80, v76, 0x41700000, v82
    v_fmamk_f32 v88, v84, 0x41700000, v90
    v_fmamk_f32 v80, v81, 0x41200000, v80
    v_fmamk_f32 v88, v89, 0x41200000, v88
    v_cvt_pk_bf16_f32 v36, v77, v85
    v_cvt_pk_bf16_f32 v40, v78, v86
    v_cvt_pk_bf16_f32 v64, v79, v87
    v_cvt_pk_bf16_f32 v68, v82, v90
    v_cvt_pk_bf16_f32 v72, v80, v88
    v_lshlrev_b32 v76, 16, v33
    v_and_b32 v84, s25, v33
    v_lshlrev_b32 v77, 16, v37
    v_and_b32 v85, s25, v37
    v_lshlrev_b32 v78, 16, v41
    v_and_b32 v86, s25, v41
    buffer_load_dwordx4 v[0:3], v92, s[8:11], s24 offen
    buffer_load_dwordx4 v[8:11], v94, s[8:11], s24 offen
    v_lshlrev_b32 v79, 16, v45
    v_and_b32 v87, s25, v45
    v_add_f32 v80, v76, v78
    v_add_f32 v88, v84, v86
    v_add_f32 v81, v77, v79
    v_add_f32 v89, v85, v87
    v_fma_f32 v82, v78, 4.0, v76
    v_fma_f32 v90, v86, 4.0, v84
    v_fma_f32 v83, v79, 4.0, v77
    v_fma_f32 v91, v87, 4.0, v85
    v_add_f32 v77, v80, v81
    v_add_f32 v85, v88, v89
    v_sub_f32 v78, v80, v81
    v_sub_f32 v86, v88, v89
    v_fma_f32 v79, v83, 2.0, v82
    v_fma_f32 v87, v91, 2.0, v90
    v_fma_f32 v82, v83, -2.0, v82
    v_fma_f32 v90, v91, -2.0, v90
    v_fmamk_f32 v80, v76, 0x41700000, v82
    v_fmamk_f32 v88, v84, 0x41700000, v90
    v_fmamk_f32 v80, v81, 0x41200000, v80
    v_fmamk_f32 v88, v89, 0x41200000, v88
    v_cvt_pk_bf16_f32 v37, v77, v85
    v_cvt_pk_bf16_f32 v41, v78, v86
    v_cvt_pk_bf16_f32 v65, v79, v87
    v_cvt_pk_bf16_f32 v69, v82, v90
    v_cvt_pk_bf16_f32 v73, v80, v88
    v_lshlrev_b32 v76, 16, v34
    v_and_b32 v84, s25, v34
    v_lshlrev_b32 v77, 16, v38
    v_and_b32 v85, s25, v38
    v_lshlrev_b32 v78, 16, v42
    v_and_b32 v86, s25, v42
    v_lshlrev_b32 v79, 16, v46
    v_and_b32 v87, s25, v46
    v_add_f32 v80, v76, v78
    v_add_f32 v88, v84, v86
    v_add_f32 v81, v77, v79
    v_add_f32 v89, v85, v87
    v_fma_f32 v82, v78, 4.0, v76
    v_fma_f32 v90, v86, 4.0, v84
    v_fma_f32 v83, v79, 4.0, v77
    v_fma_f32 v91, v87, 4.0, v85
    v_add_f32 v77, v80, v81
    v_add_f32 v85, v88, v89
    v_sub_f32 v78, v80, v81
    v_sub_f32 v86, v88, v89
    v_fma_f32 v79, v83, 2.0, v82
    v_fma_f32 v87, v91, 2.0, v90
    v_fma_f32 v82, v83, -2.0, v82
    v_fma_f32 v90, v91, -2.0, v90
    v_fmamk_f32 v80, v76, 0x41700000, v82
    v_fmamk_f32 v88, v84, 0x41700000, v90
    buffer_load_dwordx4 v[4:7], v93, s[8:11], s24 offen
    buffer_load_dwordx4 v[12:15], v95, s[8:11], s24 offen
    v_fmamk_f32 v80, v81, 0x41200000, v80
    v_fmamk_f32 v88, v89, 0x41200000, v88
    v_cvt_pk_bf16_f32 v38, v77, v85
    v_cvt_pk_bf16_f32 v42, v78, v86
    v_cvt_pk_bf16_f32 v66, v79, v87
    v_cvt_pk_bf16_f32 v70, v82, v90
    v_cvt_pk_bf16_f32 v74, v80, v88
    v_lshlrev_b32 v76, 16, v35
    v_and_b32 v84, s25, v35
    v_lshlrev_b32 v77, 16, v39
    v_and_b32 v85, s25, v39
    v_lshlrev_b32 v78, 16, v43
    v_and_b32 v86, s25, v43
    v_lshlrev_b32 v79, 16, v47
    v_and_b32 v87, s25, v47
    v_add_f32 v80, v76, v78
    v_add_f32 v88, v84, v86
    v_add_f32 v81, v77, v79
    v_add_f32 v89, v85, v87
    v_fma_f32 v82, v78, 4.0, v76
    v_fma_f32 v90, v86, 4.0, v84
    v_fma_f32 v83, v79, 4.0, v77
    v_fma_f32 v91, v87, 4.0, v85
    v_add_f32 v77, v80, v81
    v_add_f32 v85, v88, v89
    v_sub_f32 v78, v80, v81
    v_sub_f32 v86, v88, v89
    v_fma_f32 v79, v83, 2.0, v82
    v_fma_f32 v87, v91, 2.0, v90
    v_fma_f32 v82, v83, -2.0, v82
    v_fma_f32 v90, v91, -2.0, v90
    v_fmamk_f32 v80, v76, 0x41700000, v82
    v_fmamk_f32 v88, v84, 0x41700000, v90
    v_fmamk_f32 v80, v81, 0x41200000, v80
    v_fmamk_f32 v88, v89, 0x41200000, v88
    v_cvt_pk_bf16_f32 v39, v77, v85
    v_cvt_pk_bf16_f32 v43, v78, v86
    v_cvt_pk_bf16_f32 v67, v79, v87
    v_cvt_pk_bf16_f32 v71, v82, v90
    v_cvt_pk_bf16_f32 v75, v80, v88
    ds_write_b128 v96, v[64:67] offset:49152
    ds_write_b128 v97, v[68:71] offset:0
    ds_write_b128 v97, v[72:75] offset:16384
    ds_write_b128 v96, v[32:35] offset:0
    ds_write_b128 v96, v[36:39] offset:16384
    ds_write_b128 v96, v[40:43] offset:32768
    ds_write_b128 v98, v[44:47] offset:0
    s_add_u32 s28, s28, 1
    s_waitcnt lgkmcnt(0)
    s_barrier
    v_lshlrev_b32 v76, 16, v48
    v_and_b32 v84, s25, v48
    v_lshlrev_b32 v77, 16, v52
    v_and_b32 v85, s25, v52
    v_lshlrev_b32 v78, 16, v56
    v_and_b32 v86, s25, v56
    v_lshlrev_b32 v79, 16, v60
    v_and_b32 v87, s25, v60
    v_add_f32 v80, v76, v78
    v_add_f32 v88, v84, v86
    v_add_f32 v81, v77, v79
    v_add_f32 v89, v85, v87
    v_fma_f32 v82, v78, 4.0, v76
    buffer_load_dwordx4 v[16:19], v92, s[8:11], s27 offen
    buffer_load_dwordx4 v[24:27], v94, s[8:11], s27 offen
    v_fma_f32 v90, v86, 4.0, v84
    v_fma_f32 v83, v79, 4.0, v77
    v_fma_f32 v91, v87, 4.0, v85
    v_add_f32 v77, v80, v81
    v_add_f32 v85, v88, v89
    v_sub_f32 v78, v80, v81
    v_sub_f32 v86, v88, v89
    v_fma_f32 v79, v83, 2.0, v82
    v_fma_f32 v87, v91, 2.0, v90
    v_fma_f32 v82, v83, -2.0, v82
    v_fma_f32 v90, v91, -2.0, v90
    v_fmamk_f32 v80, v76, 0x41700000, v82
    v_fmamk_f32 v88, v84, 0x41700000, v90
    v_fmamk_f32 v80, v81, 0x41200000, v80
    v_fmamk_f32 v88, v89, 0x41200000, v88
    v_cvt_pk_bf16_f32 v52, v77, v85
    v_cvt_pk_bf16_f32 v56, v78, v86
    v_cvt_pk_bf16_f32 v64, v79, v87
    v_cvt_pk_bf16_f32 v68, v82, v90
    v_cvt_pk_bf16_f32 v72, v80, v88
    v_lshlrev_b32 v76, 16, v49
    v_and_b32 v84, s25, v49
    v_lshlrev_b32 v77, 16, v53
    v_and_b32 v85, s25, v53
    v_lshlrev_b32 v78, 16, v57
    v_and_b32 v86, s25, v57
    v_lshlrev_b32 v79, 16, v61
    v_and_b32 v87, s25, v61
    v_add_f32 v80, v76, v78
    v_add_f32 v88, v84, v86
    v_add_f32 v81, v77, v79
    v_add_f32 v89, v85, v87
    v_fma_f32 v82, v78, 4.0, v76
    v_fma_f32 v90, v86, 4.0, v84
    v_fma_f32 v83, v79, 4.0, v77
    v_fma_f32 v91, v87, 4.0, v85
    v_add_f32 v77, v80, v81
    v_add_f32 v85, v88, v89
    v_sub_f32 v78, v80, v81
    v_sub_f32 v86, v88, v89
    v_fma_f32 v79, v83, 2.0, v82
    v_fma_f32 v87, v91, 2.0, v90
    v_fma_f32 v82, v83, -2.0, v82
    v_fma_f32 v90, v91, -2.0, v90
    v_fmamk_f32 v80, v76, 0x41700000, v82
    v_fmamk_f32 v88, v84, 0x41700000, v90
    v_fmamk_f32 v80, v81, 0x41200000, v80
    v_fmamk_f32 v88, v89, 0x41200000, v88
    v_cvt_pk_bf16_f32 v53, v77, v85
    v_cvt_pk_bf16_f32 v57, v78, v86
    v_cvt_pk_bf16_f32 v65, v79, v87
    v_cvt_pk_bf16_f32 v69, v82, v90
    v_cvt_pk_bf16_f32 v73, v80, v88
    buffer_load_dwordx4 v[20:23], v93, s[8:11], s27 offen
    buffer_load_dwordx4 v[28:31], v95, s[8:11], s27 offen
    v_lshlrev_b32 v76, 16, v50
    v_and_b32 v84, s25, v50
    v_lshlrev_b32 v77, 16, v54
    v_and_b32 v85, s25, v54
    v_lshlrev_b32 v78, 16, v58
    v_and_b32 v86, s25, v58
    v_lshlrev_b32 v79, 16, v62
    v_and_b32 v87, s25, v62
    v_add_f32 v80, v76, v78
    v_add_f32 v88, v84, v86
    v_add_f32 v81, v77, v79
    v_add_f32 v89, v85, v87
    v_fma_f32 v82, v78, 4.0, v76
    v_fma_f32 v90, v86, 4.0, v84
    v_fma_f32 v83, v79, 4.0, v77
    v_fma_f32 v91, v87, 4.0, v85
    v_add_f32 v77, v80, v81
    v_add_f32 v85, v88, v89
    v_sub_f32 v78, v80, v81
    v_sub_f32 v86, v88, v89
    v_fma_f32 v79, v83, 2.0, v82
    v_fma_f32 v87, v91, 2.0, v90
    v_fma_f32 v82, v83, -2.0, v82
    v_fma_f32 v90, v91, -2.0, v90
    v_fmamk_f32 v80, v76, 0x41700000, v82
    v_fmamk_f32 v88, v84, 0x41700000, v90
    v_fmamk_f32 v80, v81, 0x41200000, v80
    v_fmamk_f32 v88, v89, 0x41200000, v88
    v_cvt_pk_bf16_f32 v54, v77, v85
    v_cvt_pk_bf16_f32 v58, v78, v86
    v_cvt_pk_bf16_f32 v66, v79, v87
    v_cvt_pk_bf16_f32 v70, v82, v90
    v_cvt_pk_bf16_f32 v74, v80, v88
    v_lshlrev_b32 v76, 16, v51
    v_and_b32 v84, s25, v51
    v_lshlrev_b32 v77, 16, v55
    v_and_b32 v85, s25, v55
    v_lshlrev_b32 v78, 16, v59
    v_and_b32 v86, s25, v59
    v_lshlrev_b32 v79, 16, v63
    v_and_b32 v87, s25, v63
    v_add_f32 v80, v76, v78
    v_add_f32 v88, v84, v86
    v_add_f32 v81, v77, v79
    v_add_f32 v89, v85, v87
    v_fma_f32 v82, v78, 4.0, v76
    v_fma_f32 v90, v86, 4.0, v84
    v_fma_f32 v83, v79, 4.0, v77
    v_fma_f32 v91, v87, 4.0, v85
    v_add_f32 v77, v80, v81
    v_add_f32 v85, v88, v89
    v_sub_f32 v78, v80, v81
    v_sub_f32 v86, v88, v89
    v_fma_f32 v79, v83, 2.0, v82
    v_fma_f32 v87, v91, 2.0, v90
    v_fma_f32 v82, v83, -2.0, v82
    v_fma_f32 v90, v91, -2.0, v90
    v_fmamk_f32 v80, v76, 0x41700000, v82
    v_fmamk_f32 v88, v84, 0x41700000, v90
    v_fmamk_f32 v80, v81, 0x41200000, v80
    v_fmamk_f32 v88, v89, 0x41200000, v88
    v_cvt_pk_bf16_f32 v55, v77, v85
    v_cvt_pk_bf16_f32 v59, v78, v86
    v_cvt_pk_bf16_f32 v67, v79, v87
    v_cvt_pk_bf16_f32 v71, v82, v90
    v_cvt_pk_bf16_f32 v75, v80, v88
    ds_write_b128 v96, v[64:67] offset:57344
    ds_write_b128 v97, v[68:71] offset:8192
    ds_write_b128 v97, v[72:75] offset:24576
    ds_write_b128 v96, v[48:51] offset:8192
    ds_write_b128 v96, v[52:55] offset:24576
    ds_write_b128 v96, v[56:59] offset:40960
    ds_write_b128 v98, v[60:63] offset:8704
    s_add_u32 s28, s28, 1
    s_waitcnt lgkmcnt(0)
    s_barrier
    s_cmp_eq_u32 s22, 1
    s_cbranch_scc1 L_conv2_kernel_hlast1
    s_add_u32 s24, s24, 1048576
    s_add_u32 s27, s27, 1048576
    s_waitcnt vmcnt(0)
    v_lshlrev_b32 v76, 16, v0
    v_and_b32 v84, s25, v0
    v_lshlrev_b32 v77, 16, v4
    v_and_b32 v85, s25, v4
    v_lshlrev_b32 v78, 16, v8
    v_and_b32 v86, s25, v8
    v_lshlrev_b32 v79, 16, v12
    v_and_b32 v87, s25, v12
    v_add_f32 v80, v76, v78
    v_add_f32 v88, v84, v86
    v_add_f32 v81, v77, v79
    v_add_f32 v89, v85, v87
    v_fma_f32 v82, v78, 4.0, v76
    v_fma_f32 v90, v86, 4.0, v84
    v_fma_f32 v83, v79, 4.0, v77
    v_fma_f32 v91, v87, 4.0, v85
    v_add_f32 v77, v80, v81
    v_add_f32 v85, v88, v89
    v_sub_f32 v78, v80, v81
    v_sub_f32 v86, v88, v89
    v_fma_f32 v79, v83, 2.0, v82
    v_fma_f32 v87, v91, 2.0, v90
    v_fma_f32 v82, v83, -2.0, v82
    v_fma_f32 v90, v91, -2.0, v90
    v_fmamk_f32 v80, v76, 0x41700000, v82
    v_fmamk_f32 v88, v84, 0x41700000, v90
    v_fmamk_f32 v80, v81, 0x41200000, v80
    v_fmamk_f32 v88, v89, 0x41200000, v88
    v_cvt_pk_bf16_f32 v4, v77, v85
    v_cvt_pk_bf16_f32 v8, v78, v86
    v_cvt_pk_bf16_f32 v64, v79, v87
    v_cvt_pk_bf16_f32 v68, v82, v90
    v_cvt_pk_bf16_f32 v72, v80, v88
    v_lshlrev_b32 v76, 16, v1
    v_and_b32 v84, s25, v1
    v_lshlrev_b32 v77, 16, v5
    v_and_b32 v85, s25, v5
    v_lshlrev_b32 v78, 16, v9
    v_and_b32 v86, s25, v9
    buffer_load_dwordx4 v[32:35], v92, s[8:11], s24 offen
    buffer_load_dwordx4 v[40:43], v94, s[8:11], s24 offen
    v_lshlrev_b32 v79, 16, v13
    v_and_b32 v87, s25, v13
    v_add_f32 v80, v76, v78
    v_add_f32 v88, v84, v86
    v_add_f32 v81, v77, v79
    v_add_f32 v89, v85, v87
    v_fma_f32 v82, v78, 4.0, v76
    v_fma_f32 v90, v86, 4.0, v84
    v_fma_f32 v83, v79, 4.0, v77
    v_fma_f32 v91, v87, 4.0, v85
    v_add_f32 v77, v80, v81
    v_add_f32 v85, v88, v89
    v_sub_f32 v78, v80, v81
    v_sub_f32 v86, v88, v89
    v_fma_f32 v79, v83, 2.0, v82
    v_fma_f32 v87, v91, 2.0, v90
    v_fma_f32 v82, v83, -2.0, v82
    v_fma_f32 v90, v91, -2.0, v90
    v_fmamk_f32 v80, v76, 0x41700000, v82
    v_fmamk_f32 v88, v84, 0x41700000, v90
    v_fmamk_f32 v80, v81, 0x41200000, v80
    v_fmamk_f32 v88, v89, 0x41200000, v88
    v_cvt_pk_bf16_f32 v5, v77, v85
    v_cvt_pk_bf16_f32 v9, v78, v86
    v_cvt_pk_bf16_f32 v65, v79, v87
    v_cvt_pk_bf16_f32 v69, v82, v90
    v_cvt_pk_bf16_f32 v73, v80, v88
    v_lshlrev_b32 v76, 16, v2
    v_and_b32 v84, s25, v2
    v_lshlrev_b32 v77, 16, v6
    v_and_b32 v85, s25, v6
    v_lshlrev_b32 v78, 16, v10
    v_and_b32 v86, s25, v10
    v_lshlrev_b32 v79, 16, v14
    v_and_b32 v87, s25, v14
    v_add_f32 v80, v76, v78
    v_add_f32 v88, v84, v86
    v_add_f32 v81, v77, v79
    v_add_f32 v89, v85, v87
    v_fma_f32 v82, v78, 4.0, v76
    v_fma_f32 v90, v86, 4.0, v84
    v_fma_f32 v83, v79, 4.0, v77
    v_fma_f32 v91, v87, 4.0, v85
    v_add_f32 v77, v80, v81
    v_add_f32 v85, v88, v89
    v_sub_f32 v78, v80, v81
    v_sub_f32 v86, v88, v89
    v_fma_f32 v79, v83, 2.0, v82
    v_fma_f32 v87, v91, 2.0, v90
    v_fma_f32 v82, v83, -2.0, v82
    v_fma_f32 v90, v91, -2.0, v90
    v_fmamk_f32 v80, v76, 0x41700000, v82
    v_fmamk_f32 v88, v84, 0x41700000, v90
    buffer_load_dwordx4 v[36:39], v93, s[8:11], s24 offen
    buffer_load_dwordx4 v[44:47], v95, s[8:11], s24 offen
    v_fmamk_f32 v80, v81, 0x41200000, v80
    v_fmamk_f32 v88, v89, 0x41200000, v88
    v_cvt_pk_bf16_f32 v6, v77, v85
    v_cvt_pk_bf16_f32 v10, v78, v86
    v_cvt_pk_bf16_f32 v66, v79, v87
    v_cvt_pk_bf16_f32 v70, v82, v90
    v_cvt_pk_bf16_f32 v74, v80, v88
    v_lshlrev_b32 v76, 16, v3
    v_and_b32 v84, s25, v3
    v_lshlrev_b32 v77, 16, v7
    v_and_b32 v85, s25, v7
    v_lshlrev_b32 v78, 16, v11
    v_and_b32 v86, s25, v11
    v_lshlrev_b32 v79, 16, v15
    v_and_b32 v87, s25, v15
    v_add_f32 v80, v76, v78
    v_add_f32 v88, v84, v86
    v_add_f32 v81, v77, v79
    v_add_f32 v89, v85, v87
    v_fma_f32 v82, v78, 4.0, v76
    v_fma_f32 v90, v86, 4.0, v84
    v_fma_f32 v83, v79, 4.0, v77
    v_fma_f32 v91, v87, 4.0, v85
    v_add_f32 v77, v80, v81
    v_add_f32 v85, v88, v89
    v_sub_f32 v78, v80, v81
    v_sub_f32 v86, v88, v89
    v_fma_f32 v79, v83, 2.0, v82
    v_fma_f32 v87, v91, 2.0, v90
    v_fma_f32 v82, v83, -2.0, v82
    v_fma_f32 v90, v91, -2.0, v90
    v_fmamk_f32 v80, v76, 0x41700000, v82
    v_fmamk_f32 v88, v84, 0x41700000, v90
    v_fmamk_f32 v80, v81, 0x41200000, v80
    v_fmamk_f32 v88, v89, 0x41200000, v88
    v_cvt_pk_bf16_f32 v7, v77, v85
    v_cvt_pk_bf16_f32 v11, v78, v86
    v_cvt_pk_bf16_f32 v67, v79, v87
    v_cvt_pk_bf16_f32 v71, v82, v90
    v_cvt_pk_bf16_f32 v75, v80, v88
    ds_write_b128 v96, v[64:67] offset:49152
    ds_write_b128 v97, v[68:71] offset:0
    ds_write_b128 v97, v[72:75] offset:16384
    ds_write_b128 v96, v[0:3] offset:0
    ds_write_b128 v96, v[4:7] offset:16384
    ds_write_b128 v96, v[8:11] offset:32768
    ds_write_b128 v98, v[12:15] offset:0
    s_add_u32 s28, s28, 1
    s_waitcnt lgkmcnt(0)
    s_barrier
    s_sub_u32 s22, s22, 1
    s_branch L_conv2_kernel_hloop1
L_conv2_kernel_hlast1:
    s_add_u32 s12, s30, 44040192
    s_addc_u32 s13, s31, 0
    s_mov_b32 s14, 294912
    s_mov_b32 s15, 0x00020000
    s_lshr_b32 s36, s2, 3
    s_lshl_b32 s36, s36, 2
    s_add_u32 s36, s36, s32
    s_mul_i32 s36, s36, 2304
    v_lshlrev_b32 v1, 4, v127
    buffer_load_dwordx4 v[4:7], v1, s[12:15], s36 offen offset:0
    buffer_load_dwordx4 v[4:7], v1, s[12:15], s36 offen offset:1024
    buffer_load_dwordx4 v[4:7], v1, s[12:15], s36 offen offset:2048
    s_cmp_ge_u32 s2, 32
    s_cbranch_scc1 L_conv2_kernel_ntw
    s_getpc_b64 s[36:37]
L_conv2_kernel_pc:
    s_lshl_b32 s38, s32, 13
    s_add_u32 s38, s38, L_conv2_kernel_epi-L_conv2_kernel_pc
    v_lshl_add_u32 v2, v127, 7, s38
    v_min_u32 v2, L_joint_kernel_done-L_conv2_kernel_pc, v2
    v_mov_b32 v3, s37
    v_add_co_u32 v2, vcc, s36, v2
    s_nop 1
    v_addc_co_u32 v3, vcc, 0, v3, vcc
    global_load_dword v4, v[2:3], off
L_conv2_kernel_ntw:
    s_branch L_conv2_kernel_end
L_conv2_kernel_h2:
    s_mov_b32 s24, 1048576
    s_mov_b32 s27, 1572864
    s_waitcnt lgkmcnt(0)
    s_barrier
    buffer_load_dwordx4 v[32:35], v92, s[8:11], s24 offen
    buffer_load_dwordx4 v[40:43], v94, s[8:11], s24 offen
    buffer_load_dwordx4 v[36:39], v93, s[8:11], s24 offen
    buffer_load_dwordx4 v[44:47], v95, s[8:11], s24 offen
    buffer_load_dwordx4 v[48:51], v92, s[8:11], s27 offen
    buffer_load_dwordx4 v[56:59], v94, s[8:11], s27 offen
    buffer_load_dwordx4 v[52:55], v93, s[8:11], s27 offen
    buffer_load_dwordx4 v[60:63], v95, s[8:11], s27 offen
    s_setprio 0
    v_lshlrev_b32 v76, 16, v16
    v_and_b32 v84, s25, v16
    v_lshlrev_b32 v77, 16, v20
    v_and_b32 v85, s25, v20
    v_lshlrev_b32 v78, 16, v24
    v_and_b32 v86, s25, v24
    v_lshlrev_b32 v79, 16, v28
    v_and_b32 v87, s25, v28
    v_add_f32 v80, v76, v78
    v_add_f32 v88, v84, v86
    v_add_f32 v81, v77, v79
    v_add_f32 v89, v85, v87
    v_fma_f32 v82, v78, 4.0, v76
    v_fma_f32 v90, v86, 4.0, v84
    v_fma_f32 v83, v79, 4.0, v77
    v_fma_f32 v91, v87, 4.0, v85
    v_add_f32 v77, v80, v81
    v_add_f32 v85, v88, v89
    v_sub_f32 v78, v80, v81
    v_sub_f32 v86, v88, v89
    v_fma_f32 v79, v83, 2.0, v82
    v_fma_f32 v87, v91, 2.0, v90
    v_fma_f32 v82, v83, -2.0, v82
    v_fma_f32 v90, v91, -2.0, v90
    v_fmamk_f32 v80, v76, 0x41700000, v82
    v_fmamk_f32 v88, v84, 0x41700000, v90
    v_fmamk_f32 v80, v81, 0x41200000, v80
    v_fmamk_f32 v88, v89, 0x41200000, v88
    v_cvt_pk_bf16_f32 v20, v77, v85
    v_cvt_pk_bf16_f32 v24, v78, v86
    v_cvt_pk_bf16_f32 v64, v79, v87
    v_cvt_pk_bf16_f32 v68, v82, v90
    v_cvt_pk_bf16_f32 v72, v80, v88
    v_lshlrev_b32 v76, 16, v17
    v_and_b32 v84, s25, v17
    v_lshlrev_b32 v77, 16, v21
    v_and_b32 v85, s25, v21
    v_lshlrev_b32 v78, 16, v25
    v_and_b32 v86, s25, v25
    v_lshlrev_b32 v79, 16, v29
    v_and_b32 v87, s25, v29
    v_add_f32 v80, v76, v78
    v_add_f32 v88, v84, v86
    v_add_f32 v81, v77, v79
    v_add_f32 v89, v85, v87
    v_fma_f32 v82, v78, 4.0, v76
    v_fma_f32 v90, v86, 4.0, v84
    v_fma_f32 v83, v79, 4.0, v77
    v_fma_f32 v91, v87, 4.0, v85
    v_add_f32 v77, v80, v81
    v_add_f32 v85, v88, v89
    v_sub_f32 v78, v80, v81
    v_sub_f32 v86, v88, v89
    v_fma_f32 v79, v83, 2.0, v82
    v_fma_f32 v87, v91, 2.0, v90
    v_fma_f32 v82, v83, -2.0, v82
    v_fma_f32 v90, v91, -2.0, v90
    v_fmamk_f32 v80, v76, 0x41700000, v82
    v_fmamk_f32 v88, v84, 0x41700000, v90
    v_fmamk_f32 v80, v81, 0x41200000, v80
    v_fmamk_f32 v88, v89, 0x41200000, v88
    v_cvt_pk_bf16_f32 v21, v77, v85
    v_cvt_pk_bf16_f32 v25, v78, v86
    v_cvt_pk_bf16_f32 v65, v79, v87
    v_cvt_pk_bf16_f32 v69, v82, v90
    v_cvt_pk_bf16_f32 v73, v80, v88
    v_lshlrev_b32 v76, 16, v18
    v_and_b32 v84, s25, v18
    v_lshlrev_b32 v77, 16, v22
    v_and_b32 v85, s25, v22
    v_lshlrev_b32 v78, 16, v26
    v_and_b32 v86, s25, v26
    v_lshlrev_b32 v79, 16, v30
    v_and_b32 v87, s25, v30
    v_add_f32 v80, v76, v78
    v_add_f32 v88, v84, v86
    v_add_f32 v81, v77, v79
    v_add_f32 v89, v85, v87
    v_fma_f32 v82, v78, 4.0, v76
    v_fma_f32 v90, v86, 4.0, v84
    v_fma_f32 v83, v79, 4.0, v77
    v_fma_f32 v91, v87, 4.0, v85
    v_add_f32 v77, v80, v81
    v_add_f32 v85, v88, v89
    v_sub_f32 v78, v80, v81
    v_sub_f32 v86, v88, v89
    v_fma_f32 v79, v83, 2.0, v82
    v_fma_f32 v87, v91, 2.0, v90
    v_fma_f32 v82, v83, -2.0, v82
    v_fma_f32 v90, v91, -2.0, v90
    v_fmamk_f32 v80, v76, 0x41700000, v82
    v_fmamk_f32 v88, v84, 0x41700000, v90
    v_fmamk_f32 v80, v81, 0x41200000, v80
    v_fmamk_f32 v88, v89, 0x41200000, v88
    v_cvt_pk_bf16_f32 v22, v77, v85
    v_cvt_pk_bf16_f32 v26, v78, v86
    v_cvt_pk_bf16_f32 v66, v79, v87
    v_cvt_pk_bf16_f32 v70, v82, v90
    v_cvt_pk_bf16_f32 v74, v80, v88
    v_lshlrev_b32 v76, 16, v19
    v_and_b32 v84, s25, v19
    v_lshlrev_b32 v77, 16, v23
    v_and_b32 v85, s25, v23
    v_lshlrev_b32 v78, 16, v27
    v_and_b32 v86, s25, v27
    v_lshlrev_b32 v79, 16, v31
    v_and_b32 v87, s25, v31
    v_add_f32 v80, v76, v78
    v_add_f32 v88, v84, v86
    v_add_f32 v81, v77, v79
    v_add_f32 v89, v85, v87
    v_fma_f32 v82, v78, 4.0, v76
    v_fma_f32 v90, v86, 4.0, v84
    v_fma_f32 v83, v79, 4.0, v77
    v_fma_f32 v91, v87, 4.0, v85
    v_add_f32 v77, v80, v81
    v_add_f32 v85, v88, v89
    v_sub_f32 v78, v80, v81
    v_sub_f32 v86, v88, v89
    v_fma_f32 v79, v83, 2.0, v82
    v_fma_f32 v87, v91, 2.0, v90
    v_fma_f32 v82, v83, -2.0, v82
    v_fma_f32 v90, v91, -2.0, v90
    v_fmamk_f32 v80, v76, 0x41700000, v82
    v_fmamk_f32 v88, v84, 0x41700000, v90
    v_fmamk_f32 v80, v81, 0x41200000, v80
    v_fmamk_f32 v88, v89, 0x41200000, v88
    v_cvt_pk_bf16_f32 v23, v77, v85
    v_cvt_pk_bf16_f32 v27, v78, v86
    v_cvt_pk_bf16_f32 v67, v79, v87
    v_cvt_pk_bf16_f32 v71, v82, v90
    v_cvt_pk_bf16_f32 v75, v80, v88
L_conv2_kernel_hloop2:
    s_add_u32 s24, s24, 1048576
    s_add_u32 s27, s27, 1048576
    ds_write_b128 v96, v[64:67] offset:57344
    ds_write_b128 v97, v[68:71] offset:8192
    ds_write_b128 v97, v[72:75] offset:24576
    ds_write_b128 v96, v[16:19] offset:8192
    ds_write_b128 v96, v[20:23] offset:24576
    ds_write_b128 v96, v[24:27] offset:40960
    ds_write_b128 v98, v[28:31] offset:8704
    s_waitcnt vmcnt(0)
    buffer_load_dwordx4 v[0:3], v92, s[8:11], s24 offen
    buffer_load_dwordx4 v[8:11], v94, s[8:11], s24 offen
    buffer_load_dwordx4 v[4:7], v93, s[8:11], s24 offen
    buffer_load_dwordx4 v[12:15], v95, s[8:11], s24 offen
    v_lshlrev_b32 v76, 16, v32
    v_and_b32 v84, s25, v32
    v_lshlrev_b32 v77, 16, v36
    v_and_b32 v85, s25, v36
    v_lshlrev_b32 v78, 16, v40
    v_and_b32 v86, s25, v40
    v_lshlrev_b32 v79, 16, v44
    v_and_b32 v87, s25, v44
    v_add_f32 v80, v76, v78
    v_add_f32 v88, v84, v86
    v_add_f32 v81, v77, v79
    v_add_f32 v89, v85, v87
    v_fma_f32 v82, v78, 4.0, v76
    v_fma_f32 v90, v86, 4.0, v84
    v_fma_f32 v83, v79, 4.0, v77
    v_fma_f32 v91, v87, 4.0, v85
    v_add_f32 v77, v80, v81
    v_add_f32 v85, v88, v89
    v_sub_f32 v78, v80, v81
    v_sub_f32 v86, v88, v89
    v_fma_f32 v79, v83, 2.0, v82
    v_fma_f32 v87, v91, 2.0, v90
    v_fma_f32 v82, v83, -2.0, v82
    v_fma_f32 v90, v91, -2.0, v90
    v_fmamk_f32 v80, v76, 0x41700000, v82
    v_fmamk_f32 v88, v84, 0x41700000, v90
    v_fmamk_f32 v80, v81, 0x41200000, v80
    v_fmamk_f32 v88, v89, 0x41200000, v88
    v_cvt_pk_bf16_f32 v36, v77, v85
    v_cvt_pk_bf16_f32 v40, v78, v86
    v_cvt_pk_bf16_f32 v64, v79, v87
    v_cvt_pk_bf16_f32 v68, v82, v90
    v_cvt_pk_bf16_f32 v72, v80, v88
    v_lshlrev_b32 v76, 16, v33
    v_and_b32 v84, s25, v33
    v_lshlrev_b32 v77, 16, v37
    v_and_b32 v85, s25, v37
    v_lshlrev_b32 v78, 16, v41
    v_and_b32 v86, s25, v41
    v_lshlrev_b32 v79, 16, v45
    v_and_b32 v87, s25, v45
    v_add_f32 v80, v76, v78
    v_add_f32 v88, v84, v86
    v_add_f32 v81, v77, v79
    v_add_f32 v89, v85, v87
    v_fma_f32 v82, v78, 4.0, v76
    v_fma_f32 v90, v86, 4.0, v84
    v_fma_f32 v83, v79, 4.0, v77
    v_fma_f32 v91, v87, 4.0, v85
    v_add_f32 v77, v80, v81
    v_add_f32 v85, v88, v89
    v_sub_f32 v78, v80, v81
    v_sub_f32 v86, v88, v89
    v_fma_f32 v79, v83, 2.0, v82
    v_fma_f32 v87, v91, 2.0, v90
    v_fma_f32 v82, v83, -2.0, v82
    v_fma_f32 v90, v91, -2.0, v90
    v_fmamk_f32 v80, v76, 0x41700000, v82
    v_fmamk_f32 v88, v84, 0x41700000, v90
    v_fmamk_f32 v80, v81, 0x41200000, v80
    v_fmamk_f32 v88, v89, 0x41200000, v88
    v_cvt_pk_bf16_f32 v37, v77, v85
    v_cvt_pk_bf16_f32 v41, v78, v86
    v_cvt_pk_bf16_f32 v65, v79, v87
    v_cvt_pk_bf16_f32 v69, v82, v90
    v_cvt_pk_bf16_f32 v73, v80, v88
    v_lshlrev_b32 v76, 16, v34
    v_and_b32 v84, s25, v34
    v_lshlrev_b32 v77, 16, v38
    v_and_b32 v85, s25, v38
    v_lshlrev_b32 v78, 16, v42
    v_and_b32 v86, s25, v42
    v_lshlrev_b32 v79, 16, v46
    v_and_b32 v87, s25, v46
    v_add_f32 v80, v76, v78
    v_add_f32 v88, v84, v86
    v_add_f32 v81, v77, v79
    v_add_f32 v89, v85, v87
    v_fma_f32 v82, v78, 4.0, v76
    v_fma_f32 v90, v86, 4.0, v84
    v_fma_f32 v83, v79, 4.0, v77
    v_fma_f32 v91, v87, 4.0, v85
    v_add_f32 v77, v80, v81
    v_add_f32 v85, v88, v89
    v_sub_f32 v78, v80, v81
    v_sub_f32 v86, v88, v89
    v_fma_f32 v79, v83, 2.0, v82
    v_fma_f32 v87, v91, 2.0, v90
    v_fma_f32 v82, v83, -2.0, v82
    v_fma_f32 v90, v91, -2.0, v90
    v_fmamk_f32 v80, v76, 0x41700000, v82
    v_fmamk_f32 v88, v84, 0x41700000, v90
    v_fmamk_f32 v80, v81, 0x41200000, v80
    v_fmamk_f32 v88, v89, 0x41200000, v88
    v_cvt_pk_bf16_f32 v38, v77, v85
    v_cvt_pk_bf16_f32 v42, v78, v86
    v_cvt_pk_bf16_f32 v66, v79, v87
    v_cvt_pk_bf16_f32 v70, v82, v90
    v_cvt_pk_bf16_f32 v74, v80, v88
    v_lshlrev_b32 v76, 16, v35
    v_and_b32 v84, s25, v35
    v_lshlrev_b32 v77, 16, v39
    v_and_b32 v85, s25, v39
    v_lshlrev_b32 v78, 16, v43
    v_and_b32 v86, s25, v43
    v_lshlrev_b32 v79, 16, v47
    v_and_b32 v87, s25, v47
    v_add_f32 v80, v76, v78
    v_add_f32 v88, v84, v86
    v_add_f32 v81, v77, v79
    v_add_f32 v89, v85, v87
    v_fma_f32 v82, v78, 4.0, v76
    v_fma_f32 v90, v86, 4.0, v84
    v_fma_f32 v83, v79, 4.0, v77
    v_fma_f32 v91, v87, 4.0, v85
    v_add_f32 v77, v80, v81
    v_add_f32 v85, v88, v89
    v_sub_f32 v78, v80, v81
    v_sub_f32 v86, v88, v89
    v_fma_f32 v79, v83, 2.0, v82
    v_fma_f32 v87, v91, 2.0, v90
    v_fma_f32 v82, v83, -2.0, v82
    v_fma_f32 v90, v91, -2.0, v90
    v_fmamk_f32 v80, v76, 0x41700000, v82
    v_fmamk_f32 v88, v84, 0x41700000, v90
    v_fmamk_f32 v80, v81, 0x41200000, v80
    v_fmamk_f32 v88, v89, 0x41200000, v88
    v_cvt_pk_bf16_f32 v39, v77, v85
    v_cvt_pk_bf16_f32 v43, v78, v86
    v_cvt_pk_bf16_f32 v67, v79, v87
    v_cvt_pk_bf16_f32 v71, v82, v90
    v_cvt_pk_bf16_f32 v75, v80, v88
    s_add_u32 s28, s28, 1
    s_waitcnt lgkmcnt(0)
    s_barrier
    ds_write_b128 v96, v[64:67] offset:49152
    ds_write_b128 v97, v[68:71] offset:0
    ds_write_b128 v97, v[72:75] offset:16384
    ds_write_b128 v96, v[32:35] offset:0
    ds_write_b128 v96, v[36:39] offset:16384
    ds_write_b128 v96, v[40:43] offset:32768
    ds_write_b128 v98, v[44:47] offset:0
    buffer_load_dwordx4 v[16:19], v92, s[8:11], s27 offen
    buffer_load_dwordx4 v[24:27], v94, s[8:11], s27 offen
    buffer_load_dwordx4 v[20:23], v93, s[8:11], s27 offen
    buffer_load_dwordx4 v[28:31], v95, s[8:11], s27 offen
    v_lshlrev_b32 v76, 16, v48
    v_and_b32 v84, s25, v48
    v_lshlrev_b32 v77, 16, v52
    v_and_b32 v85, s25, v52
    v_lshlrev_b32 v78, 16, v56
    v_and_b32 v86, s25, v56
    v_lshlrev_b32 v79, 16, v60
    v_and_b32 v87, s25, v60
    v_add_f32 v80, v76, v78
    v_add_f32 v88, v84, v86
    v_add_f32 v81, v77, v79
    v_add_f32 v89, v85, v87
    v_fma_f32 v82, v78, 4.0, v76
    v_fma_f32 v90, v86, 4.0, v84
    v_fma_f32 v83, v79, 4.0, v77
    v_fma_f32 v91, v87, 4.0, v85
    v_add_f32 v77, v80, v81
    v_add_f32 v85, v88, v89
    v_sub_f32 v78, v80, v81
    v_sub_f32 v86, v88, v89
    v_fma_f32 v79, v83, 2.0, v82
    v_fma_f32 v87, v91, 2.0, v90
    v_fma_f32 v82, v83, -2.0, v82
    v_fma_f32 v90, v91, -2.0, v90
    v_fmamk_f32 v80, v76, 0x41700000, v82
    v_fmamk_f32 v88, v84, 0x41700000, v90
    v_fmamk_f32 v80, v81, 0x41200000, v80
    v_fmamk_f32 v88, v89, 0x41200000, v88
    v_cvt_pk_bf16_f32 v52, v77, v85
    v_cvt_pk_bf16_f32 v56, v78, v86
    v_cvt_pk_bf16_f32 v64, v79, v87
    v_cvt_pk_bf16_f32 v68, v82, v90
    v_cvt_pk_bf16_f32 v72, v80, v88
    v_lshlrev_b32 v76, 16, v49
    v_and_b32 v84, s25, v49
    v_lshlrev_b32 v77, 16, v53
    v_and_b32 v85, s25, v53
    v_lshlrev_b32 v78, 16, v57
    v_and_b32 v86, s25, v57
    v_lshlrev_b32 v79, 16, v61
    v_and_b32 v87, s25, v61
    v_add_f32 v80, v76, v78
    v_add_f32 v88, v84, v86
    v_add_f32 v81, v77, v79
    v_add_f32 v89, v85, v87
    v_fma_f32 v82, v78, 4.0, v76
    v_fma_f32 v90, v86, 4.0, v84
    v_fma_f32 v83, v79, 4.0, v77
    v_fma_f32 v91, v87, 4.0, v85
    v_add_f32 v77, v80, v81
    v_add_f32 v85, v88, v89
    v_sub_f32 v78, v80, v81
    v_sub_f32 v86, v88, v89
    v_fma_f32 v79, v83, 2.0, v82
    v_fma_f32 v87, v91, 2.0, v90
    v_fma_f32 v82, v83, -2.0, v82
    v_fma_f32 v90, v91, -2.0, v90
    v_fmamk_f32 v80, v76, 0x41700000, v82
    v_fmamk_f32 v88, v84, 0x41700000, v90
    v_fmamk_f32 v80, v81, 0x41200000, v80
    v_fmamk_f32 v88, v89, 0x41200000, v88
    v_cvt_pk_bf16_f32 v53, v77, v85
    v_cvt_pk_bf16_f32 v57, v78, v86
    v_cvt_pk_bf16_f32 v65, v79, v87
    v_cvt_pk_bf16_f32 v69, v82, v90
    v_cvt_pk_bf16_f32 v73, v80, v88
    v_lshlrev_b32 v76, 16, v50
    v_and_b32 v84, s25, v50
    v_lshlrev_b32 v77, 16, v54
    v_and_b32 v85, s25, v54
    v_lshlrev_b32 v78, 16, v58
    v_and_b32 v86, s25, v58
    v_lshlrev_b32 v79, 16, v62
    v_and_b32 v87, s25, v62
    v_add_f32 v80, v76, v78
    v_add_f32 v88, v84, v86
    v_add_f32 v81, v77, v79
    v_add_f32 v89, v85, v87
    v_fma_f32 v82, v78, 4.0, v76
    v_fma_f32 v90, v86, 4.0, v84
    v_fma_f32 v83, v79, 4.0, v77
    v_fma_f32 v91, v87, 4.0, v85
    v_add_f32 v77, v80, v81
    v_add_f32 v85, v88, v89
    v_sub_f32 v78, v80, v81
    v_sub_f32 v86, v88, v89
    v_fma_f32 v79, v83, 2.0, v82
    v_fma_f32 v87, v91, 2.0, v90
    v_fma_f32 v82, v83, -2.0, v82
    v_fma_f32 v90, v91, -2.0, v90
    v_fmamk_f32 v80, v76, 0x41700000, v82
    v_fmamk_f32 v88, v84, 0x41700000, v90
    v_fmamk_f32 v80, v81, 0x41200000, v80
    v_fmamk_f32 v88, v89, 0x41200000, v88
    v_cvt_pk_bf16_f32 v54, v77, v85
    v_cvt_pk_bf16_f32 v58, v78, v86
    v_cvt_pk_bf16_f32 v66, v79, v87
    v_cvt_pk_bf16_f32 v70, v82, v90
    v_cvt_pk_bf16_f32 v74, v80, v88
    v_lshlrev_b32 v76, 16, v51
    v_and_b32 v84, s25, v51
    v_lshlrev_b32 v77, 16, v55
    v_and_b32 v85, s25, v55
    v_lshlrev_b32 v78, 16, v59
    v_and_b32 v86, s25, v59
    v_lshlrev_b32 v79, 16, v63
    v_and_b32 v87, s25, v63
    v_add_f32 v80, v76, v78
    v_add_f32 v88, v84, v86
    v_add_f32 v81, v77, v79
    v_add_f32 v89, v85, v87
    v_fma_f32 v82, v78, 4.0, v76
    v_fma_f32 v90, v86, 4.0, v84
    v_fma_f32 v83, v79, 4.0, v77
    v_fma_f32 v91, v87, 4.0, v85
    v_add_f32 v77, v80, v81
    v_add_f32 v85, v88, v89
    v_sub_f32 v78, v80, v81
    v_sub_f32 v86, v88, v89
    v_fma_f32 v79, v83, 2.0, v82
    v_fma_f32 v87, v91, 2.0, v90
    v_fma_f32 v82, v83, -2.0, v82
    v_fma_f32 v90, v91, -2.0, v90
    v_fmamk_f32 v80, v76, 0x41700000, v82
    v_fmamk_f32 v88, v84, 0x41700000, v90
    v_fmamk_f32 v80, v81, 0x41200000, v80
    v_fmamk_f32 v88, v89, 0x41200000, v88
    v_cvt_pk_bf16_f32 v55, v77, v85
    v_cvt_pk_bf16_f32 v59, v78, v86
    v_cvt_pk_bf16_f32 v67, v79, v87
    v_cvt_pk_bf16_f32 v71, v82, v90
    v_cvt_pk_bf16_f32 v75, v80, v88
    s_add_u32 s28, s28, 1
    s_waitcnt lgkmcnt(0)
    s_barrier
    s_cmp_eq_u32 s22, 1
    s_cbranch_scc1 L_conv2_kernel_hlast2
    s_add_u32 s24, s24, 1048576
    s_add_u32 s27, s27, 1048576
    ds_write_b128 v96, v[64:67] offset:57344
    ds_write_b128 v97, v[68:71] offset:8192
    ds_write_b128 v97, v[72:75] offset:24576
    ds_write_b128 v96, v[48:51] offset:8192
    ds_write_b128 v96, v[52:55] offset:24576
    ds_write_b128 v96, v[56:59] offset:40960
    ds_write_b128 v98, v[60:63] offset:8704
    s_waitcnt vmcnt(0)
    buffer_load_dwordx4 v[32:35], v92, s[8:11], s24 offen
    buffer_load_dwordx4 v[40:43], v94, s[8:11], s24 offen
    buffer_load_dwordx4 v[36:39], v93, s[8:11], s24 offen
    buffer_load_dwordx4 v[44:47], v95, s[8:11], s24 offen
    v_lshlrev_b32 v76, 16, v0
    v_and_b32 v84, s25, v0
    v_lshlrev_b32 v77, 16, v4
    v_and_b32 v85, s25, v4
    v_lshlrev_b32 v78, 16, v8
    v_and_b32 v86, s25, v8
    v_lshlrev_b32 v79, 16, v12
    v_and_b32 v87, s25, v12
    v_add_f32 v80, v76, v78
    v_add_f32 v88, v84, v86
    v_add_f32 v81, v77, v79
    v_add_f32 v89, v85, v87
    v_fma_f32 v82, v78, 4.0, v76
    v_fma_f32 v90, v86, 4.0, v84
    v_fma_f32 v83, v79, 4.0, v77
    v_fma_f32 v91, v87, 4.0, v85
    v_add_f32 v77, v80, v81
    v_add_f32 v85, v88, v89
    v_sub_f32 v78, v80, v81
    v_sub_f32 v86, v88, v89
    v_fma_f32 v79, v83, 2.0, v82
    v_fma_f32 v87, v91, 2.0, v90
    v_fma_f32 v82, v83, -2.0, v82
    v_fma_f32 v90, v91, -2.0, v90
    v_fmamk_f32 v80, v76, 0x41700000, v82
    v_fmamk_f32 v88, v84, 0x41700000, v90
    v_fmamk_f32 v80, v81, 0x41200000, v80
    v_fmamk_f32 v88, v89, 0x41200000, v88
    v_cvt_pk_bf16_f32 v4, v77, v85
    v_cvt_pk_bf16_f32 v8, v78, v86
    v_cvt_pk_bf16_f32 v64, v79, v87
    v_cvt_pk_bf16_f32 v68, v82, v90
    v_cvt_pk_bf16_f32 v72, v80, v88
    v_lshlrev_b32 v76, 16, v1
    v_and_b32 v84, s25, v1
    v_lshlrev_b32 v77, 16, v5
    v_and_b32 v85, s25, v5
    v_lshlrev_b32 v78, 16, v9
    v_and_b32 v86, s25, v9
    v_lshlrev_b32 v79, 16, v13
    v_and_b32 v87, s25, v13
    v_add_f32 v80, v76, v78
    v_add_f32 v88, v84, v86
    v_add_f32 v81, v77, v79
    v_add_f32 v89, v85, v87
    v_fma_f32 v82, v78, 4.0, v76
    v_fma_f32 v90, v86, 4.0, v84
    v_fma_f32 v83, v79, 4.0, v77
    v_fma_f32 v91, v87, 4.0, v85
    v_add_f32 v77, v80, v81
    v_add_f32 v85, v88, v89
    v_sub_f32 v78, v80, v81
    v_sub_f32 v86, v88, v89
    v_fma_f32 v79, v83, 2.0, v82
    v_fma_f32 v87, v91, 2.0, v90
    v_fma_f32 v82, v83, -2.0, v82
    v_fma_f32 v90, v91, -2.0, v90
    v_fmamk_f32 v80, v76, 0x41700000, v82
    v_fmamk_f32 v88, v84, 0x41700000, v90
    v_fmamk_f32 v80, v81, 0x41200000, v80
    v_fmamk_f32 v88, v89, 0x41200000, v88
    v_cvt_pk_bf16_f32 v5, v77, v85
    v_cvt_pk_bf16_f32 v9, v78, v86
    v_cvt_pk_bf16_f32 v65, v79, v87
    v_cvt_pk_bf16_f32 v69, v82, v90
    v_cvt_pk_bf16_f32 v73, v80, v88
    v_lshlrev_b32 v76, 16, v2
    v_and_b32 v84, s25, v2
    v_lshlrev_b32 v77, 16, v6
    v_and_b32 v85, s25, v6
    v_lshlrev_b32 v78, 16, v10
    v_and_b32 v86, s25, v10
    v_lshlrev_b32 v79, 16, v14
    v_and_b32 v87, s25, v14
    v_add_f32 v80, v76, v78
    v_add_f32 v88, v84, v86
    v_add_f32 v81, v77, v79
    v_add_f32 v89, v85, v87
    v_fma_f32 v82, v78, 4.0, v76
    v_fma_f32 v90, v86, 4.0, v84
    v_fma_f32 v83, v79, 4.0, v77
    v_fma_f32 v91, v87, 4.0, v85
    v_add_f32 v77, v80, v81
    v_add_f32 v85, v88, v89
    v_sub_f32 v78, v80, v81
    v_sub_f32 v86, v88, v89
    v_fma_f32 v79, v83, 2.0, v82
    v_fma_f32 v87, v91, 2.0, v90
    v_fma_f32 v82, v83, -2.0, v82
    v_fma_f32 v90, v91, -2.0, v90
    v_fmamk_f32 v80, v76, 0x41700000, v82
    v_fmamk_f32 v88, v84, 0x41700000, v90
    v_fmamk_f32 v80, v81, 0x41200000, v80
    v_fmamk_f32 v88, v89, 0x41200000, v88
    v_cvt_pk_bf16_f32 v6, v77, v85
    v_cvt_pk_bf16_f32 v10, v78, v86
    v_cvt_pk_bf16_f32 v66, v79, v87
    v_cvt_pk_bf16_f32 v70, v82, v90
    v_cvt_pk_bf16_f32 v74, v80, v88
    v_lshlrev_b32 v76, 16, v3
    v_and_b32 v84, s25, v3
    v_lshlrev_b32 v77, 16, v7
    v_and_b32 v85, s25, v7
    v_lshlrev_b32 v78, 16, v11
    v_and_b32 v86, s25, v11
    v_lshlrev_b32 v79, 16, v15
    v_and_b32 v87, s25, v15
    v_add_f32 v80, v76, v78
    v_add_f32 v88, v84, v86
    v_add_f32 v81, v77, v79
    v_add_f32 v89, v85, v87
    v_fma_f32 v82, v78, 4.0, v76
    v_fma_f32 v90, v86, 4.0, v84
    v_fma_f32 v83, v79, 4.0, v77
    v_fma_f32 v91, v87, 4.0, v85
    v_add_f32 v77, v80, v81
    v_add_f32 v85, v88, v89
    v_sub_f32 v78, v80, v81
    v_sub_f32 v86, v88, v89
    v_fma_f32 v79, v83, 2.0, v82
    v_fma_f32 v87, v91, 2.0, v90
    v_fma_f32 v82, v83, -2.0, v82
    v_fma_f32 v90, v91, -2.0, v90
    v_fmamk_f32 v80, v76, 0x41700000, v82
    v_fmamk_f32 v88, v84, 0x41700000, v90
    v_fmamk_f32 v80, v81, 0x41200000, v80
    v_fmamk_f32 v88, v89, 0x41200000, v88
    v_cvt_pk_bf16_f32 v7, v77, v85
    v_cvt_pk_bf16_f32 v11, v78, v86
    v_cvt_pk_bf16_f32 v67, v79, v87
    v_cvt_pk_bf16_f32 v71, v82, v90
    v_cvt_pk_bf16_f32 v75, v80, v88
    s_add_u32 s28, s28, 1
    s_waitcnt lgkmcnt(0)
    s_barrier
    ds_write_b128 v96, v[64:67] offset:49152
    ds_write_b128 v97, v[68:71] offset:0
    ds_write_b128 v97, v[72:75] offset:16384
    ds_write_b128 v96, v[0:3] offset:0
    ds_write_b128 v96, v[4:7] offset:16384
    ds_write_b128 v96, v[8:11] offset:32768
    ds_write_b128 v98, v[12:15] offset:0
    buffer_load_dwordx4 v[48:51], v92, s[8:11], s27 offen
    buffer_load_dwordx4 v[56:59], v94, s[8:11], s27 offen
    buffer_load_dwordx4 v[52:55], v93, s[8:11], s27 offen
    buffer_load_dwordx4 v[60:63], v95, s[8:11], s27 offen
    v_lshlrev_b32 v76, 16, v16
    v_and_b32 v84, s25, v16
    v_lshlrev_b32 v77, 16, v20
    v_and_b32 v85, s25, v20
    v_lshlrev_b32 v78, 16, v24
    v_and_b32 v86, s25, v24
    v_lshlrev_b32 v79, 16, v28
    v_and_b32 v87, s25, v28
    v_add_f32 v80, v76, v78
    v_add_f32 v88, v84, v86
    v_add_f32 v81, v77, v79
    v_add_f32 v89, v85, v87
    v_fma_f32 v82, v78, 4.0, v76
    v_fma_f32 v90, v86, 4.0, v84
    v_fma_f32 v83, v79, 4.0, v77
    v_fma_f32 v91, v87, 4.0, v85
    v_add_f32 v77, v80, v81
    v_add_f32 v85, v88, v89
    v_sub_f32 v78, v80, v81
    v_sub_f32 v86, v88, v89
    v_fma_f32 v79, v83, 2.0, v82
    v_fma_f32 v87, v91, 2.0, v90
    v_fma_f32 v82, v83, -2.0, v82
    v_fma_f32 v90, v91, -2.0, v90
    v_fmamk_f32 v80, v76, 0x41700000, v82
    v_fmamk_f32 v88, v84, 0x41700000, v90
    v_fmamk_f32 v80, v81, 0x41200000, v80
    v_fmamk_f32 v88, v89, 0x41200000, v88
    v_cvt_pk_bf16_f32 v20, v77, v85
    v_cvt_pk_bf16_f32 v24, v78, v86
    v_cvt_pk_bf16_f32 v64, v79, v87
    v_cvt_pk_bf16_f32 v68, v82, v90
    v_cvt_pk_bf16_f32 v72, v80, v88
    v_lshlrev_b32 v76, 16, v17
    v_and_b32 v84, s25, v17
    v_lshlrev_b32 v77, 16, v21
    v_and_b32 v85, s25, v21
    v_lshlrev_b32 v78, 16, v25
    v_and_b32 v86, s25, v25
    v_lshlrev_b32 v79, 16, v29
    v_and_b32 v87, s25, v29
    v_add_f32 v80, v76, v78
    v_add_f32 v88, v84, v86
    v_add_f32 v81, v77, v79
    v_add_f32 v89, v85, v87
    v_fma_f32 v82, v78, 4.0, v76
    v_fma_f32 v90, v86, 4.0, v84
    v_fma_f32 v83, v79, 4.0, v77
    v_fma_f32 v91, v87, 4.0, v85
    v_add_f32 v77, v80, v81
    v_add_f32 v85, v88, v89
    v_sub_f32 v78, v80, v81
    v_sub_f32 v86, v88, v89
    v_fma_f32 v79, v83, 2.0, v82
    v_fma_f32 v87, v91, 2.0, v90
    v_fma_f32 v82, v83, -2.0, v82
    v_fma_f32 v90, v91, -2.0, v90
    v_fmamk_f32 v80, v76, 0x41700000, v82
    v_fmamk_f32 v88, v84, 0x41700000, v90
    v_fmamk_f32 v80, v81, 0x41200000, v80
    v_fmamk_f32 v88, v89, 0x41200000, v88
    v_cvt_pk_bf16_f32 v21, v77, v85
    v_cvt_pk_bf16_f32 v25, v78, v86
    v_cvt_pk_bf16_f32 v65, v79, v87
    v_cvt_pk_bf16_f32 v69, v82, v90
    v_cvt_pk_bf16_f32 v73, v80, v88
    v_lshlrev_b32 v76, 16, v18
    v_and_b32 v84, s25, v18
    v_lshlrev_b32 v77, 16, v22
    v_and_b32 v85, s25, v22
    v_lshlrev_b32 v78, 16, v26
    v_and_b32 v86, s25, v26
    v_lshlrev_b32 v79, 16, v30
    v_and_b32 v87, s25, v30
    v_add_f32 v80, v76, v78
    v_add_f32 v88, v84, v86
    v_add_f32 v81, v77, v79
    v_add_f32 v89, v85, v87
    v_fma_f32 v82, v78, 4.0, v76
    v_fma_f32 v90, v86, 4.0, v84
    v_fma_f32 v83, v79, 4.0, v77
    v_fma_f32 v91, v87, 4.0, v85
    v_add_f32 v77, v80, v81
    v_add_f32 v85, v88, v89
    v_sub_f32 v78, v80, v81
    v_sub_f32 v86, v88, v89
    v_fma_f32 v79, v83, 2.0, v82
    v_fma_f32 v87, v91, 2.0, v90
    v_fma_f32 v82, v83, -2.0, v82
    v_fma_f32 v90, v91, -2.0, v90
    v_fmamk_f32 v80, v76, 0x41700000, v82
    v_fmamk_f32 v88, v84, 0x41700000, v90
    v_fmamk_f32 v80, v81, 0x41200000, v80
    v_fmamk_f32 v88, v89, 0x41200000, v88
    v_cvt_pk_bf16_f32 v22, v77, v85
    v_cvt_pk_bf16_f32 v26, v78, v86
    v_cvt_pk_bf16_f32 v66, v79, v87
    v_cvt_pk_bf16_f32 v70, v82, v90
    v_cvt_pk_bf16_f32 v74, v80, v88
    v_lshlrev_b32 v76, 16, v19
    v_and_b32 v84, s25, v19
    v_lshlrev_b32 v77, 16, v23
    v_and_b32 v85, s25, v23
    v_lshlrev_b32 v78, 16, v27
    v_and_b32 v86, s25, v27
    v_lshlrev_b32 v79, 16, v31
    v_and_b32 v87, s25, v31
    v_add_f32 v80, v76, v78
    v_add_f32 v88, v84, v86
    v_add_f32 v81, v77, v79
    v_add_f32 v89, v85, v87
    v_fma_f32 v82, v78, 4.0, v76
    v_fma_f32 v90, v86, 4.0, v84
    v_fma_f32 v83, v79, 4.0, v77
    v_fma_f32 v91, v87, 4.0, v85
    v_add_f32 v77, v80, v81
    v_add_f32 v85, v88, v89
    v_sub_f32 v78, v80, v81
    v_sub_f32 v86, v88, v89
    v_fma_f32 v79, v83, 2.0, v82
    v_fma_f32 v87, v91, 2.0, v90
    v_fma_f32 v82, v83, -2.0, v82
    v_fma_f32 v90, v91, -2.0, v90
    v_fmamk_f32 v80, v76, 0x41700000, v82
    v_fmamk_f32 v88, v84, 0x41700000, v90
    v_fmamk_f32 v80, v81, 0x41200000, v80
    v_fmamk_f32 v88, v89, 0x41200000, v88
    v_cvt_pk_bf16_f32 v23, v77, v85
    v_cvt_pk_bf16_f32 v27, v78, v86
    v_cvt_pk_bf16_f32 v67, v79, v87
    v_cvt_pk_bf16_f32 v71, v82, v90
    v_cvt_pk_bf16_f32 v75, v80, v88
    s_add_u32 s28, s28, 1
    s_waitcnt lgkmcnt(0)
    s_barrier
    s_sub_u32 s22, s22, 1
    s_branch L_conv2_kernel_hloop2
L_conv2_kernel_hlast2:
    s_mov_b32 s25, 0xffff0000
    ds_write_b128 v96, v[64:67] offset:57344
    ds_write_b128 v97, v[68:71] offset:8192
    ds_write_b128 v97, v[72:75] offset:24576
    ds_write_b128 v96, v[48:51] offset:8192
    ds_write_b128 v96, v[52:55] offset:24576
    ds_write_b128 v96, v[56:59] offset:40960
    ds_write_b128 v98, v[60:63] offset:8704
    s_waitcnt lgkmcnt(0)
    s_barrier
    s_branch L_conv2_kernel_end
L_conv2_kernel_mw:
    s_add_u32 s37, s41, 128
    v_mov_b32 v16, s37
    v_mul_u32_u24 v17, 524288, v5
    v_lshl_add_u32 v17, v6, 4, v17
    s_add_u32 s37, s33, 4294967289
    v_lshl_add_u32 v18, v16, 3, s37
    v_cmp_gt_u32 vcc, 8000, v18
    s_mul_i32 s37, s33, 131072
    s_add_u32 s37, s37, 0
    v_lshl_add_u32 v108, v16, 7, s37
    v_add_u32 v108, v108, v17
    v_mov_b32 v18, 2130706432
    v_cndmask_b32 v108, v18, v108, vcc
    s_add_u32 s37, s33, 4294967291
    v_lshl_add_u32 v18, v16, 3, s37
    v_cmp_gt_u32 vcc, 8000, v18
    s_mul_i32 s37, s33, 131072
    s_add_u32 s37, s37, 262144
    v_lshl_add_u32 v109, v16, 7, s37
    v_add_u32 v109, v109, v17
    v_mov_b32 v18, 2130706432
    v_cndmask_b32 v109, v18, v109, vcc
    s_add_u32 s37, s33, 4294967293
    v_lshl_add_u32 v18, v16, 3, s37
    v_cmp_gt_u32 vcc, 8000, v18
    s_mul_i32 s37, s33, 131072
    s_add_u32 s37, s37, 64
    v_lshl_add_u32 v110, v16, 7, s37
    v_add_u32 v110, v110, v17
    v_mov_b32 v18, 2130706432
    v_cndmask_b32 v110, v18, v110, vcc
    s_waitcnt lgkmcnt(0)
    s_add_u32 s8, s4, s47
    s_addc_u32 s9, s5, 0
    s_lshl_b32 s36, s29, 4
    s_lshl_b32 s37, s33, 3
    s_add_u32 s36, s36, s37
    s_mul_i32 s36, s36, 57344
    s_add_u32 s36, s36, 9437184
    s_add_u32 s12, s30, s36
    s_addc_u32 s13, s31, 0
    s_mov_b32 s14, 458752
    s_mov_b32 s15, 0x00020000
    s_mul_i32 s36, s35, 2097152
    s_add_u32 s36, s36, 27262976
    s_mul_i32 s37, s33, 8388608
    s_add_u32 s36, s36, s37
    s_add_u32 s16, s30, s36
    s_addc_u32 s17, s31, 0
    s_mov_b32 s18, 2097152
    s_mov_b32 s19, 0x00020000
    v_and_b32 v10, 15, v127
    v_lshrrev_b32 v11, 4, v127
    v_add_u32 v8, 0, v10
    v_and_b32 v16, 4, v8
    v_lshrrev_b32 v16, 1, v16
    v_xor_b32 v16, v11, v16
    v_lshlrev_b32 v16, 4, v16
    v_lshl_add_u32 v8, v8, 6, v16
    v_add_u32 v9, 1, v10
    v_and_b32 v16, 4, v9
    v_lshrrev_b32 v16, 1, v16
    v_xor_b32 v16, v11, v16
    v_lshlrev_b32 v16, 4, v16
    v_lshl_add_u32 v9, v9, 6, v16
    s_lshr_b32 s38, s32, 1
    s_and_b32 s39, s32, 1
    s_add_u32 s40, s38, 4
    s_lshl_b32 s43, s39, 10
    s_cmp_lt_u32 s20, 4
    s_cselect_b32 s40, s20, s40
    s_cselect_b32 s36, 0, s43
    s_lshl_b32 s37, s40, 13
    s_add_u32 s37, s37, s36
    v_lshl_add_u32 v125, v127, 4, s37
    s_mul_i32 s37, s40, 16384
    v_add_u32 v120, s37, v8
    v_add_u32 v121, s37, v9
    s_lshl_b32 s37, s40, 10
    s_add_u32 s37, s37, 115712
    v_lshl_add_u32 v16, v11, 4, s37
    v_cmp_eq_u32 vcc, 15, v10
    v_mov_b32 v17, 8192
    v_mov_b32 v18, 4294959104
    v_mov_b32 v19, 64
    v_cndmask_b32 v122, v121, v16, vcc
    v_cndmask_b32 v123, v17, v19, vcc
    v_cndmask_b32 v124, v18, v19, vcc
    v_lshl_add_u32 v126, v127, 4, s37
    s_mov_b32 s44, 0x3f800000
    s_mov_b32 s45, 0x00000000
    s_mov_b32 s46, 0x00000000
    s_cmp_eq_u32 s40, 1
    s_cselect_b32 s45, 0x3f800000, s45
    s_cselect_b32 s46, 0x3f800000, s46
    s_cmp_eq_u32 s40, 2
    s_cselect_b32 s45, 0xbf800000, s45
    s_cselect_b32 s46, 0x3f800000, s46
    s_cmp_eq_u32 s40, 3
    s_cselect_b32 s45, 0x40000000, s45
    s_cselect_b32 s46, 0x40800000, s46
    s_cmp_eq_u32 s40, 4
    s_cselect_b32 s45, 0xc0000000, s45
    s_cselect_b32 s46, 0x40800000, s46
    s_cmp_eq_u32 s40, 5
    s_cselect_b32 s44, 0x41800000, s44
    s_cselect_b32 s45, 0x41000000, s45
    s_cselect_b32 s46, 0x40800000, s46
    s_cmp_ge_u32 s20, 4
    s_cbranch_scc1 L_conv2_kernel_m2
    v_mov_b32 v0, 0
    v_mov_b32 v1, 0
    v_mov_b32 v2, 0
    v_mov_b32 v3, 0
    v_mov_b32 v4, 0
    v_mov_b32 v5, 0
    v_mov_b32 v6, 0
    v_mov_b32 v7, 0
    v_mov_b32 v8, 0
    v_mov_b32 v9, 0
    v_mov_b32 v10, 0
    v_mov_b32 v11, 0
    v_mov_b32 v12, 0
    v_mov_b32 v13, 0
    v_mov_b32 v14, 0
    v_mov_b32 v15, 0
    v_mov_b32 v16, 0
    v_mov_b32 v17, 0
    v_mov_b32 v18, 0
    v_mov_b32 v19, 0
    v_mov_b32 v20, 0
    v_mov_b32 v21, 0
    v_mov_b32 v22, 0
    v_mov_b32 v23, 0
    v_mov_b32 v24, 0
    v_mov_b32 v25, 0
    v_mov_b32 v26, 0
    v_mov_b32 v27, 0
    v_mov_b32 v28, 0
    v_mov_b32 v29, 0
    v_mov_b32 v30, 0
    v_mov_b32 v31, 0
    v_mov_b32 v32, 0
    v_mov_b32 v33, 0
    v_mov_b32 v34, 0
    v_mov_b32 v35, 0
    v_mov_b32 v36, 0
    v_mov_b32 v37, 0
    v_mov_b32 v38, 0
    v_mov_b32 v39, 0
    v_mov_b32 v40, 0
    v_mov_b32 v41, 0
    v_mov_b32 v42, 0
    v_mov_b32 v43, 0
    v_mov_b32 v44, 0
    v_mov_b32 v45, 0
    v_mov_b32 v46, 0
    v_mov_b32 v47, 0
    v_mov_b32 v48, 0
    v_mov_b32 v49, 0
    v_mov_b32 v50, 0
    v_mov_b32 v51, 0
    v_mov_b32 v52, 0
    v_mov_b32 v53, 0
    v_mov_b32 v54, 0
    v_mov_b32 v55, 0
    v_mov_b32 v56, 0
    v_mov_b32 v57, 0
    v_mov_b32 v58, 0
    v_mov_b32 v59, 0
    v_mov_b32 v60, 0
    v_mov_b32 v61, 0
    v_mov_b32 v62, 0
    v_mov_b32 v63, 0
    buffer_load_dwordx4 v[96:99], v108, s[8:11], 0 offen
    buffer_load_dwordx4 v[100:103], v109, s[8:11], 0 offen
    buffer_load_dwordx4 v[104:107], v110, s[8:11], 0 offen
    s_mov_b32 s23, 0
    s_mov_b32 s26, 4096
    buffer_load_dwordx4 v[64:67], v125, s[12:15], s23 offen offset:0
    buffer_load_dwordx4 v[68:71], v125, s[12:15], s23 offen offset:1024
    buffer_load_dwordx4 v[72:75], v125, s[12:15], s23 offen offset:2048
    buffer_load_dwordx4 v[76:79], v125, s[12:15], s23 offen offset:3072
    buffer_load_dwordx4 v[80:83], v125, s[12:15], s26 offen offset:0
    buffer_load_dwordx4 v[84:87], v125, s[12:15], s26 offen offset:1024
    buffer_load_dwordx4 v[88:91], v125, s[12:15], s26 offen offset:2048
    buffer_load_dwordx4 v[92:95], v125, s[12:15], s26 offen offset:3072
    s_mov_b32 s23, 57344
    s_mov_b32 s26, 61440
    s_waitcnt vmcnt(8)
    v_lshlrev_b32 v108, 16, v96
    v_and_b32 v111, s25, v96
    v_lshlrev_b32 v109, 16, v100
    v_and_b32 v112, s25, v100
    v_lshlrev_b32 v110, 16, v104
    v_and_b32 v113, s25, v104
    v_mul_f32 v114, s44, v108
    v_mul_f32 v115, s44, v111
    v_fmac_f32 v114, s45, v109
    v_fmac_f32 v115, s45, v112
    v_fmac_f32 v114, s46, v110
    v_fmac_f32 v115, s46, v113
    v_cvt_pk_bf16_f32 v96, v114, v115
    v_lshlrev_b32 v108, 16, v97
    v_and_b32 v111, s25, v97
    v_lshlrev_b32 v109, 16, v101
    v_and_b32 v112, s25, v101
    v_lshlrev_b32 v110, 16, v105
    v_and_b32 v113, s25, v105
    v_mul_f32 v114, s44, v108
    v_mul_f32 v115, s44, v111
    v_fmac_f32 v114, s45, v109
    v_fmac_f32 v115, s45, v112
    v_fmac_f32 v114, s46, v110
    v_fmac_f32 v115, s46, v113
    v_cvt_pk_bf16_f32 v97, v114, v115
    v_lshlrev_b32 v108, 16, v98
    v_and_b32 v111, s25, v98
    v_lshlrev_b32 v109, 16, v102
    v_and_b32 v112, s25, v102
    v_lshlrev_b32 v110, 16, v106
    v_and_b32 v113, s25, v106
    v_mul_f32 v114, s44, v108
    v_mul_f32 v115, s44, v111
    v_fmac_f32 v114, s45, v109
    v_fmac_f32 v115, s45, v112
    v_fmac_f32 v114, s46, v110
    v_fmac_f32 v115, s46, v113
    v_cvt_pk_bf16_f32 v98, v114, v115
    v_lshlrev_b32 v108, 16, v99
    v_and_b32 v111, s25, v99
    v_lshlrev_b32 v109, 16, v103
    v_and_b32 v112, s25, v103
    v_lshlrev_b32 v110, 16, v107
    v_and_b32 v113, s25, v107
    v_mul_f32 v114, s44, v108
    v_mul_f32 v115, s44, v111
    v_fmac_f32 v114, s45, v109
    v_fmac_f32 v115, s45, v112
    v_fmac_f32 v114, s46, v110
    v_fmac_f32 v115, s46, v113
    v_cvt_pk_bf16_f32 v99, v114, v115
    ds_write_b128 v126, v[96:99]
    s_waitcnt lgkmcnt(0)
    s_barrier
    s_mov_b32 s22, 4
    s_setprio 2
L_conv2_kernel_mloop1:
    ds_read_b128 v[96:99], v120 offset:0
    ds_read_b128 v[100:103], v120 offset:1024
    ds_read_b128 v[104:107], v120 offset:2048
    ds_read_b128 v[108:111], v120 offset:3072
    ds_read_b128 v[112:115], v120 offset:4096
    ds_read_b128 v[116:119], v120 offset:5120
    s_waitcnt vmcnt(6) lgkmcnt(5)
    v_mfma_f32_16x16x32_bf16 v[0:3], v[64:67], v[96:99], v[0:3]
    v_mfma_f32_16x16x32_bf16 v[32:35], v[68:71], v[96:99], v[32:35]
    ds_read_b128 v[96:99], v120 offset:6144
    s_waitcnt vmcnt(4) lgkmcnt(5)
    v_mfma_f32_16x16x32_bf16 v[4:7], v[64:67], v[100:103], v[4:7]
    v_mfma_f32_16x16x32_bf16 v[36:39], v[68:71], v[100:103], v[36:39]
    v_mfma_f32_16x16x32_bf16 v[0:3], v[72:75], v[100:103], v[0:3]
    v_mfma_f32_16x16x32_bf16 v[32:35], v[76:79], v[100:103], v[32:35]
    ds_read_b128 v[100:103], v120 offset:7168
    s_waitcnt vmcnt(2) lgkmcnt(5)
    v_mfma_f32_16x16x32_bf16 v[8:11], v[64:67], v[104:107], v[8:11]
    v_mfma_f32_16x16x32_bf16 v[40:43], v[68:71], v[104:107], v[40:43]
    v_mfma_f32_16x16x32_bf16 v[4:7], v[72:75], v[104:107], v[4:7]
    v_mfma_f32_16x16x32_bf16 v[36:39], v[76:79], v[104:107], v[36:39]
    v_mfma_f32_16x16x32_bf16 v[0:3], v[80:83], v[104:107], v[0:3]
    v_mfma_f32_16x16x32_bf16 v[32:35], v[84:87], v[104:107], v[32:35]
    ds_read_b128 v[104:107], v122 offset:0
    v_add_u32 v122, v123, v122
    s_waitcnt vmcnt(0) lgkmcnt(5)
    v_mfma_f32_16x16x32_bf16 v[12:15], v[64:67], v[108:111], v[12:15]
    v_mfma_f32_16x16x32_bf16 v[44:47], v[68:71], v[108:111], v[44:47]
    v_mfma_f32_16x16x32_bf16 v[8:11], v[72:75], v[108:111], v[8:11]
    v_mfma_f32_16x16x32_bf16 v[40:43], v[76:79], v[108:111], v[40:43]
    v_mfma_f32_16x16x32_bf16 v[4:7], v[80:83], v[108:111], v[4:7]
    v_mfma_f32_16x16x32_bf16 v[36:39], v[84:87], v[108:111], v[36:39]
    v_mfma_f32_16x16x32_bf16 v[0:3], v[88:91], v[108:111], v[0:3]
    v_mfma_f32_16x16x32_bf16 v[32:35], v[92:95], v[108:111], v[32:35]
    ds_read_b128 v[108:111], v121 offset:1024
    s_waitcnt lgkmcnt(5)
    v_mfma_f32_16x16x32_bf16 v[16:19], v[64:67], v[112:115], v[16:19]
    v_mfma_f32_16x16x32_bf16 v[48:51], v[68:71], v[112:115], v[48:51]
    v_mfma_f32_16x16x32_bf16 v[12:15], v[72:75], v[112:115], v[12:15]
    v_mfma_f32_16x16x32_bf16 v[44:47], v[76:79], v[112:115], v[44:47]
    v_mfma_f32_16x16x32_bf16 v[8:11], v[80:83], v[112:115], v[8:11]
    v_mfma_f32_16x16x32_bf16 v[40:43], v[84:87], v[112:115], v[40:43]
    v_mfma_f32_16x16x32_bf16 v[4:7], v[88:91], v[112:115], v[4:7]
    v_mfma_f32_16x16x32_bf16 v[36:39], v[92:95], v[112:115], v[36:39]
    ds_read_b128 v[112:115], v121 offset:2048
    s_waitcnt lgkmcnt(5)
    v_mfma_f32_16x16x32_bf16 v[20:23], v[64:67], v[116:119], v[20:23]
    v_mfma_f32_16x16x32_bf16 v[52:55], v[68:71], v[116:119], v[52:55]
    v_mfma_f32_16x16x32_bf16 v[16:19], v[72:75], v[116:119], v[16:19]
    v_mfma_f32_16x16x32_bf16 v[48:51], v[76:79], v[116:119], v[48:51]
    v_mfma_f32_16x16x32_bf16 v[12:15], v[80:83], v[116:119], v[12:15]
    v_mfma_f32_16x16x32_bf16 v[44:47], v[84:87], v[116:119], v[44:47]
    v_mfma_f32_16x16x32_bf16 v[8:11], v[88:91], v[116:119], v[8:11]
    v_mfma_f32_16x16x32_bf16 v[40:43], v[92:95], v[116:119], v[40:43]
    s_waitcnt lgkmcnt(4)
    v_mfma_f32_16x16x32_bf16 v[24:27], v[64:67], v[96:99], v[24:27]
    v_mfma_f32_16x16x32_bf16 v[56:59], v[68:71], v[96:99], v[56:59]
    v_mfma_f32_16x16x32_bf16 v[20:23], v[72:75], v[96:99], v[20:23]
    v_mfma_f32_16x16x32_bf16 v[52:55], v[76:79], v[96:99], v[52:55]
    v_mfma_f32_16x16x32_bf16 v[16:19], v[80:83], v[96:99], v[16:19]
    v_mfma_f32_16x16x32_bf16 v[48:51], v[84:87], v[96:99], v[48:51]
    v_mfma_f32_16x16x32_bf16 v[12:15], v[88:91], v[96:99], v[12:15]
    v_mfma_f32_16x16x32_bf16 v[44:47], v[92:95], v[96:99], v[44:47]
    s_waitcnt lgkmcnt(3)
    v_mfma_f32_16x16x32_bf16 v[28:31], v[64:67], v[100:103], v[28:31]
    v_mfma_f32_16x16x32_bf16 v[60:63], v[68:71], v[100:103], v[60:63]
    v_mfma_f32_16x16x32_bf16 v[24:27], v[72:75], v[100:103], v[24:27]
    v_mfma_f32_16x16x32_bf16 v[56:59], v[76:79], v[100:103], v[56:59]
    v_mfma_f32_16x16x32_bf16 v[20:23], v[80:83], v[100:103], v[20:23]
    v_mfma_f32_16x16x32_bf16 v[52:55], v[84:87], v[100:103], v[52:55]
    v_mfma_f32_16x16x32_bf16 v[16:19], v[88:91], v[100:103], v[16:19]
    v_mfma_f32_16x16x32_bf16 v[48:51], v[92:95], v[100:103], v[48:51]
    buffer_load_dwordx4 v[64:67], v125, s[12:15], s23 offen offset:0
    buffer_load_dwordx4 v[68:71], v125, s[12:15], s23 offen offset:1024
    s_waitcnt lgkmcnt(2)
    v_mfma_f32_16x16x32_bf16 v[28:31], v[72:75], v[104:107], v[28:31]
    v_mfma_f32_16x16x32_bf16 v[60:63], v[76:79], v[104:107], v[60:63]
    v_mfma_f32_16x16x32_bf16 v[24:27], v[80:83], v[104:107], v[24:27]
    v_mfma_f32_16x16x32_bf16 v[56:59], v[84:87], v[104:107], v[56:59]
    v_mfma_f32_16x16x32_bf16 v[20:23], v[88:91], v[104:107], v[20:23]
    v_mfma_f32_16x16x32_bf16 v[52:55], v[92:95], v[104:107], v[52:55]
    buffer_load_dwordx4 v[72:75], v125, s[12:15], s23 offen offset:2048
    buffer_load_dwordx4 v[76:79], v125, s[12:15], s23 offen offset:3072
    s_waitcnt lgkmcnt(1)
    v_mfma_f32_16x16x32_bf16 v[28:31], v[80:83], v[108:111], v[28:31]
    v_mfma_f32_16x16x32_bf16 v[60:63], v[84:87], v[108:111], v[60:63]
    v_mfma_f32_16x16x32_bf16 v[24:27], v[88:91], v[108:111], v[24:27]
    v_mfma_f32_16x16x32_bf16 v[56:59], v[92:95], v[108:111], v[56:59]
    buffer_load_dwordx4 v[80:83], v125, s[12:15], s26 offen offset:0
    buffer_load_dwordx4 v[84:87], v125, s[12:15], s26 offen offset:1024
    s_waitcnt lgkmcnt(0)
    v_mfma_f32_16x16x32_bf16 v[28:31], v[88:91], v[112:115], v[28:31]
    v_mfma_f32_16x16x32_bf16 v[60:63], v[92:95], v[112:115], v[60:63]
    buffer_load_dwordx4 v[88:91], v125, s[12:15], s26 offen offset:2048
    buffer_load_dwordx4 v[92:95], v125, s[12:15], s26 offen offset:3072
    s_add_u32 s23, s23, 57344
    s_add_u32 s26, s26, 57344
    s_barrier
    s_sub_u32 s22, s22, 1
    s_cmp_eq_u32 s22, 0
    s_cbranch_scc1 L_conv2_kernel_mlast1
    ds_read_b128 v[96:99], v120 offset:8192
    ds_read_b128 v[100:103], v120 offset:9216
    ds_read_b128 v[104:107], v120 offset:10240
    ds_read_b128 v[108:111], v120 offset:11264
    ds_read_b128 v[112:115], v120 offset:12288
    ds_read_b128 v[116:119], v120 offset:13312
    s_waitcnt vmcnt(6) lgkmcnt(5)
    v_mfma_f32_16x16x32_bf16 v[0:3], v[64:67], v[96:99], v[0:3]
    v_mfma_f32_16x16x32_bf16 v[32:35], v[68:71], v[96:99], v[32:35]
    ds_read_b128 v[96:99], v120 offset:14336
    s_waitcnt vmcnt(4) lgkmcnt(5)
    v_mfma_f32_16x16x32_bf16 v[4:7], v[64:67], v[100:103], v[4:7]
    v_mfma_f32_16x16x32_bf16 v[36:39], v[68:71], v[100:103], v[36:39]
    v_mfma_f32_16x16x32_bf16 v[0:3], v[72:75], v[100:103], v[0:3]
    v_mfma_f32_16x16x32_bf16 v[32:35], v[76:79], v[100:103], v[32:35]
    ds_read_b128 v[100:103], v120 offset:15360
    s_waitcnt vmcnt(2) lgkmcnt(5)
    v_mfma_f32_16x16x32_bf16 v[8:11], v[64:67], v[104:107], v[8:11]
    v_mfma_f32_16x16x32_bf16 v[40:43], v[68:71], v[104:107], v[40:43]
    v_mfma_f32_16x16x32_bf16 v[4:7], v[72:75], v[104:107], v[4:7]
    v_mfma_f32_16x16x32_bf16 v[36:39], v[76:79], v[104:107], v[36:39]
    v_mfma_f32_16x16x32_bf16 v[0:3], v[80:83], v[104:107], v[0:3]
    v_mfma_f32_16x16x32_bf16 v[32:35], v[84:87], v[104:107], v[32:35]
    ds_read_b128 v[104:107], v122 offset:0
    v_add_u32 v122, v124, v122
    s_waitcnt vmcnt(0) lgkmcnt(5)
    v_mfma_f32_16x16x32_bf16 v[12:15], v[64:67], v[108:111], v[12:15]
    v_mfma_f32_16x16x32_bf16 v[44:47], v[68:71], v[108:111], v[44:47]
    v_mfma_f32_16x16x32_bf16 v[8:11], v[72:75], v[108:111], v[8:11]
    v_mfma_f32_16x16x32_bf16 v[40:43], v[76:79], v[108:111], v[40:43]
    v_mfma_f32_16x16x32_bf16 v[4:7], v[80:83], v[108:111], v[4:7]
    v_mfma_f32_16x16x32_bf16 v[36:39], v[84:87], v[108:111], v[36:39]
    v_mfma_f32_16x16x32_bf16 v[0:3], v[88:91], v[108:111], v[0:3]
    v_mfma_f32_16x16x32_bf16 v[32:35], v[92:95], v[108:111], v[32:35]
    ds_read_b128 v[108:111], v121 offset:9216
    s_waitcnt lgkmcnt(5)
    v_mfma_f32_16x16x32_bf16 v[16:19], v[64:67], v[112:115], v[16:19]
    v_mfma_f32_16x16x32_bf16 v[48:51], v[68:71], v[112:115], v[48:51]
    v_mfma_f32_16x16x32_bf16 v[12:15], v[72:75], v[112:115], v[12:15]
    v_mfma_f32_16x16x32_bf16 v[44:47], v[76:79], v[112:115], v[44:47]
    v_mfma_f32_16x16x32_bf16 v[8:11], v[80:83], v[112:115], v[8:11]
    v_mfma_f32_16x16x32_bf16 v[40:43], v[84:87], v[112:115], v[40:43]
    v_mfma_f32_16x16x32_bf16 v[4:7], v[88:91], v[112:115], v[4:7]
    v_mfma_f32_16x16x32_bf16 v[36:39], v[92:95], v[112:115], v[36:39]
    ds_read_b128 v[112:115], v121 offset:10240
    s_waitcnt lgkmcnt(5)
    v_mfma_f32_16x16x32_bf16 v[20:23], v[64:67], v[116:119], v[20:23]
    v_mfma_f32_16x16x32_bf16 v[52:55], v[68:71], v[116:119], v[52:55]
    v_mfma_f32_16x16x32_bf16 v[16:19], v[72:75], v[116:119], v[16:19]
    v_mfma_f32_16x16x32_bf16 v[48:51], v[76:79], v[116:119], v[48:51]
    v_mfma_f32_16x16x32_bf16 v[12:15], v[80:83], v[116:119], v[12:15]
    v_mfma_f32_16x16x32_bf16 v[44:47], v[84:87], v[116:119], v[44:47]
    v_mfma_f32_16x16x32_bf16 v[8:11], v[88:91], v[116:119], v[8:11]
    v_mfma_f32_16x16x32_bf16 v[40:43], v[92:95], v[116:119], v[40:43]
    s_waitcnt lgkmcnt(4)
    v_mfma_f32_16x16x32_bf16 v[24:27], v[64:67], v[96:99], v[24:27]
    v_mfma_f32_16x16x32_bf16 v[56:59], v[68:71], v[96:99], v[56:59]
    v_mfma_f32_16x16x32_bf16 v[20:23], v[72:75], v[96:99], v[20:23]
    v_mfma_f32_16x16x32_bf16 v[52:55], v[76:79], v[96:99], v[52:55]
    v_mfma_f32_16x16x32_bf16 v[16:19], v[80:83], v[96:99], v[16:19]
    v_mfma_f32_16x16x32_bf16 v[48:51], v[84:87], v[96:99], v[48:51]
    v_mfma_f32_16x16x32_bf16 v[12:15], v[88:91], v[96:99], v[12:15]
    v_mfma_f32_16x16x32_bf16 v[44:47], v[92:95], v[96:99], v[44:47]
    s_waitcnt lgkmcnt(3)
    v_mfma_f32_16x16x32_bf16 v[28:31], v[64:67], v[100:103], v[28:31]
    v_mfma_f32_16x16x32_bf16 v[60:63], v[68:71], v[100:103], v[60:63]
    v_mfma_f32_16x16x32_bf16 v[24:27], v[72:75], v[100:103], v[24:27]
    v_mfma_f32_16x16x32_bf16 v[56:59], v[76:79], v[100:103], v[56:59]
    v_mfma_f32_16x16x32_bf16 v[20:23], v[80:83], v[100:103], v[20:23]
    v_mfma_f32_16x16x32_bf16 v[52:55], v[84:87], v[100:103], v[52:55]
    v_mfma_f32_16x16x32_bf16 v[16:19], v[88:91], v[100:103], v[16:19]
    v_mfma_f32_16x16x32_bf16 v[48:51], v[92:95], v[100:103], v[48:51]
    buffer_load_dwordx4 v[64:67], v125, s[12:15], s23 offen offset:0
    buffer_load_dwordx4 v[68:71], v125, s[12:15], s23 offen offset:1024
    s_waitcnt lgkmcnt(2)
    v_mfma_f32_16x16x32_bf16 v[28:31], v[72:75], v[104:107], v[28:31]
    v_mfma_f32_16x16x32_bf16 v[60:63], v[76:79], v[104:107], v[60:63]
    v_mfma_f32_16x16x32_bf16 v[24:27], v[80:83], v[104:107], v[24:27]
    v_mfma_f32_16x16x32_bf16 v[56:59], v[84:87], v[104:107], v[56:59]
    v_mfma_f32_16x16x32_bf16 v[20:23], v[88:91], v[104:107], v[20:23]
    v_mfma_f32_16x16x32_bf16 v[52:55], v[92:95], v[104:107], v[52:55]
    buffer_load_dwordx4 v[72:75], v125, s[12:15], s23 offen offset:2048
    buffer_load_dwordx4 v[76:79], v125, s[12:15], s23 offen offset:3072
    s_waitcnt lgkmcnt(1)
    v_mfma_f32_16x16x32_bf16 v[28:31], v[80:83], v[108:111], v[28:31]
    v_mfma_f32_16x16x32_bf16 v[60:63], v[84:87], v[108:111], v[60:63]
    v_mfma_f32_16x16x32_bf16 v[24:27], v[88:91], v[108:111], v[24:27]
    v_mfma_f32_16x16x32_bf16 v[56:59], v[92:95], v[108:111], v[56:59]
    buffer_load_dwordx4 v[80:83], v125, s[12:15], s26 offen offset:0
    buffer_load_dwordx4 v[84:87], v125, s[12:15], s26 offen offset:1024
    s_waitcnt lgkmcnt(0)
    v_mfma_f32_16x16x32_bf16 v[28:31], v[88:91], v[112:115], v[28:31]
    v_mfma_f32_16x16x32_bf16 v[60:63], v[92:95], v[112:115], v[60:63]
    buffer_load_dwordx4 v[88:91], v125, s[12:15], s26 offen offset:2048
    buffer_load_dwordx4 v[92:95], v125, s[12:15], s26 offen offset:3072
    s_add_u32 s23, s23, 57344
    s_add_u32 s26, s26, 57344
    s_barrier
    s_branch L_conv2_kernel_mloop1
L_conv2_kernel_mlast1:
    v_and_b32 v125, 15, v127
    v_and_b32 v126, 7, v127
    v_lshlrev_b32 v126, 4, v126
    v_lshl_add_u32 v125, v125, 7, v126
    v_lshrrev_b32 v126, 4, v127
    v_lshl_add_u32 v125, v126, 11, v125
    s_lshl_b32 s36, s20, 14
    s_add_u32 s37, s36, 8192
    v_add_u32 v126, s37, v125
    v_add_u32 v125, s36, v125
    ds_read_b128 v[96:99], v120 offset:8192
    ds_read_b128 v[100:103], v120 offset:9216
    ds_read_b128 v[104:107], v120 offset:10240
    ds_read_b128 v[108:111], v120 offset:11264
    ds_read_b128 v[112:115], v120 offset:12288
    ds_read_b128 v[116:119], v120 offset:13312
    s_waitcnt vmcnt(6) lgkmcnt(5)
    v_mfma_f32_16x16x32_bf16 v[0:3], v[64:67], v[96:99], v[0:3]
    v_mfma_f32_16x16x32_bf16 v[32:35], v[68:71], v[96:99], v[32:35]
    ds_read_b128 v[96:99], v120 offset:14336
    s_waitcnt vmcnt(4) lgkmcnt(5)
    v_mfma_f32_16x16x32_bf16 v[4:7], v[64:67], v[100:103], v[4:7]
    v_mfma_f32_16x16x32_bf16 v[36:39], v[68:71], v[100:103], v[36:39]
    v_mfma_f32_16x16x32_bf16 v[0:3], v[72:75], v[100:103], v[0:3]
    v_mfma_f32_16x16x32_bf16 v[32:35], v[76:79], v[100:103], v[32:35]
    ds_read_b128 v[100:103], v120 offset:15360
    s_waitcnt vmcnt(2) lgkmcnt(5)
    v_mfma_f32_16x16x32_bf16 v[8:11], v[64:67], v[104:107], v[8:11]
    v_mfma_f32_16x16x32_bf16 v[40:43], v[68:71], v[104:107], v[40:43]
    v_mfma_f32_16x16x32_bf16 v[4:7], v[72:75], v[104:107], v[4:7]
    v_mfma_f32_16x16x32_bf16 v[36:39], v[76:79], v[104:107], v[36:39]
    v_mfma_f32_16x16x32_bf16 v[0:3], v[80:83], v[104:107], v[0:3]
    v_mfma_f32_16x16x32_bf16 v[32:35], v[84:87], v[104:107], v[32:35]
    ds_read_b128 v[104:107], v122 offset:0
    s_waitcnt vmcnt(0) lgkmcnt(5)
    v_mfma_f32_16x16x32_bf16 v[12:15], v[64:67], v[108:111], v[12:15]
    v_mfma_f32_16x16x32_bf16 v[44:47], v[68:71], v[108:111], v[44:47]
    v_mfma_f32_16x16x32_bf16 v[8:11], v[72:75], v[108:111], v[8:11]
    v_mfma_f32_16x16x32_bf16 v[40:43], v[76:79], v[108:111], v[40:43]
    v_mfma_f32_16x16x32_bf16 v[4:7], v[80:83], v[108:111], v[4:7]
    v_mfma_f32_16x16x32_bf16 v[36:39], v[84:87], v[108:111], v[36:39]
    v_mfma_f32_16x16x32_bf16 v[0:3], v[88:91], v[108:111], v[0:3]
    v_mfma_f32_16x16x32_bf16 v[32:35], v[92:95], v[108:111], v[32:35]
    ds_read_b128 v[108:111], v121 offset:9216
    s_waitcnt lgkmcnt(5)
    v_mfma_f32_16x16x32_bf16 v[16:19], v[64:67], v[112:115], v[16:19]
    v_mfma_f32_16x16x32_bf16 v[48:51], v[68:71], v[112:115], v[48:51]
    v_mfma_f32_16x16x32_bf16 v[12:15], v[72:75], v[112:115], v[12:15]
    v_mfma_f32_16x16x32_bf16 v[44:47], v[76:79], v[112:115], v[44:47]
    v_mfma_f32_16x16x32_bf16 v[8:11], v[80:83], v[112:115], v[8:11]
    v_mfma_f32_16x16x32_bf16 v[40:43], v[84:87], v[112:115], v[40:43]
    v_mfma_f32_16x16x32_bf16 v[4:7], v[88:91], v[112:115], v[4:7]
    v_mfma_f32_16x16x32_bf16 v[36:39], v[92:95], v[112:115], v[36:39]
    ds_read_b128 v[112:115], v121 offset:10240
    v_xor_b32 v123, 0, v125
    ds_write_b128 v123, v[0:3]
    s_waitcnt lgkmcnt(6)
    v_mfma_f32_16x16x32_bf16 v[20:23], v[64:67], v[116:119], v[20:23]
    v_mfma_f32_16x16x32_bf16 v[52:55], v[68:71], v[116:119], v[52:55]
    v_mfma_f32_16x16x32_bf16 v[16:19], v[72:75], v[116:119], v[16:19]
    v_mfma_f32_16x16x32_bf16 v[48:51], v[76:79], v[116:119], v[48:51]
    v_mfma_f32_16x16x32_bf16 v[12:15], v[80:83], v[116:119], v[12:15]
    v_mfma_f32_16x16x32_bf16 v[44:47], v[84:87], v[116:119], v[44:47]
    v_mfma_f32_16x16x32_bf16 v[8:11], v[88:91], v[116:119], v[8:11]
    v_mfma_f32_16x16x32_bf16 v[40:43], v[92:95], v[116:119], v[40:43]
    v_xor_b32 v124, 16, v125
    ds_write_b128 v124, v[4:7]
    s_waitcnt lgkmcnt(2)
    v_mfma_f32_16x16x32_bf16 v[24:27], v[64:67], v[96:99], v[24:27]
    v_mfma_f32_16x16x32_bf16 v[56:59], v[68:71], v[96:99], v[56:59]
    v_mfma_f32_16x16x32_bf16 v[20:23], v[72:75], v[96:99], v[20:23]
    v_mfma_f32_16x16x32_bf16 v[52:55], v[76:79], v[96:99], v[52:55]
    v_mfma_f32_16x16x32_bf16 v[16:19], v[80:83], v[96:99], v[16:19]
    v_mfma_f32_16x16x32_bf16 v[48:51], v[84:87], v[96:99], v[48:51]
    v_mfma_f32_16x16x32_bf16 v[12:15], v[88:91], v[96:99], v[12:15]
    v_mfma_f32_16x16x32_bf16 v[44:47], v[92:95], v[96:99], v[44:47]
    v_xor_b32 v123, 32, v125
    ds_write_b128 v123, v[8:11]
    v_xor_b32 v124, 0, v126
    ds_write_b128 v124, v[32:35]
    v_mfma_f32_16x16x32_bf16 v[28:31], v[64:67], v[100:103], v[28:31]
    v_mfma_f32_16x16x32_bf16 v[60:63], v[68:71], v[100:103], v[60:63]
    v_mfma_f32_16x16x32_bf16 v[24:27], v[72:75], v[100:103], v[24:27]
    v_mfma_f32_16x16x32_bf16 v[56:59], v[76:79], v[100:103], v[56:59]
    v_mfma_f32_16x16x32_bf16 v[20:23], v[80:83], v[100:103], v[20:23]
    v_mfma_f32_16x16x32_bf16 v[52:55], v[84:87], v[100:103], v[52:55]
    v_mfma_f32_16x16x32_bf16 v[16:19], v[88:91], v[100:103], v[16:19]
    v_mfma_f32_16x16x32_bf16 v[48:51], v[92:95], v[100:103], v[48:51]
    v_xor_b32 v123, 16, v126
    ds_write_b128 v123, v[36:39]
    v_xor_b32 v124, 32, v126
    ds_write_b128 v124, v[40:43]
    v_mfma_f32_16x16x32_bf16 v[28:31], v[72:75], v[104:107], v[28:31]
    v_mfma_f32_16x16x32_bf16 v[60:63], v[76:79], v[104:107], v[60:63]
    v_mfma_f32_16x16x32_bf16 v[24:27], v[80:83], v[104:107], v[24:27]
    v_mfma_f32_16x16x32_bf16 v[56:59], v[84:87], v[104:107], v[56:59]
    v_mfma_f32_16x16x32_bf16 v[20:23], v[88:91], v[104:107], v[20:23]
    v_mfma_f32_16x16x32_bf16 v[52:55], v[92:95], v[104:107], v[52:55]
    v_xor_b32 v124, 48, v125
    ds_write_b128 v124, v[12:15]
    v_xor_b32 v123, 48, v126
    ds_write_b128 v123, v[44:47]
    v_mfma_f32_16x16x32_bf16 v[28:31], v[80:83], v[108:111], v[28:31]
    v_mfma_f32_16x16x32_bf16 v[60:63], v[84:87], v[108:111], v[60:63]
    v_mfma_f32_16x16x32_bf16 v[24:27], v[88:91], v[108:111], v[24:27]
    v_mfma_f32_16x16x32_bf16 v[56:59], v[92:95], v[108:111], v[56:59]
    v_xor_b32 v123, 64, v125
    ds_write_b128 v123, v[16:19]
    v_xor_b32 v124, 64, v126
    ds_write_b128 v124, v[48:51]
    v_mfma_f32_16x16x32_bf16 v[28:31], v[88:91], v[112:115], v[28:31]
    v_mfma_f32_16x16x32_bf16 v[60:63], v[92:95], v[112:115], v[60:63]
    v_xor_b32 v124, 80, v125
    ds_write_b128 v124, v[20:23]
    v_xor_b32 v123, 80, v126
    ds_write_b128 v123, v[52:55]
    v_and_b32 v108, 15, v127
    v_lshrrev_b32 v109, 4, v127
    v_lshrrev_b32 v110, 3, v108
    s_lshl_b32 s36, s20, 1
    v_add_u32 v110, s36, v110
    v_xor_b32 v111, v110, v108
    v_and_b32 v111, 7, v111
    v_lshlrev_b32 v111, 4, v111
    v_xor_b32 v123, 96, v125
    ds_write_b128 v123, v[24:27]
    v_lshl_add_u32 v111, v110, 7, v111
    v_lshl_add_u32 v120, v109, 11, v111
    v_add_u32 v121, 65536, v120
    v_add_u32 v64, 131072, v120
    s_lshl_b32 s36, s20, 9
    s_add_u32 s36, s36, 115712
    v_lshl_add_u32 v127, v109, 7, s36
    s_lshl_b32 s36, s20, 4
    v_add_u32 v108, s36, v108
    v_lshlrev_b32 v110, 6, v108
    v_lshl_add_u32 v110, v109, 4, v110
    s_mul_i32 s36, s29, 262144
    v_xor_b32 v124, 96, v126
    ds_write_b128 v124, v[56:59]
    s_lshl_b32 s37, s21, 4
    s_add_u32 s36, s36, s37
    v_add_u32 v110, s36, v110
    v_mov_b32 v111, 2130706432
    v_cmp_gt_u32 vcc, 125, v108
    s_mov_b32 s4, 0xbeaaaaab
    s_mov_b32 s5, s4
    s_mov_b32 s6, 0x3e800000
    s_mov_b32 s7, s6
    s_mov_b32 s8, 0xc0a00000
    s_mov_b32 s9, s8
    s_mov_b32 s10, 0xc0638e39
    v_xor_b32 v124, 112, v125
    ds_write_b128 v124, v[28:31]
    s_mov_b32 s11, s10
    s_mov_b32 s12, 0xbf638e39
    s_mov_b32 s13, s12
    s_mov_b32 s14, 0xbe638e39
    s_mov_b32 s15, s14
    s_mov_b32 s22, 0xbd638e39
    s_mov_b32 s23, s22
    s_mov_b32 s24, 0x3ff1c71c
    s_mov_b32 s25, s24
    s_mov_b32 s26, 0xbf2aaaab
    s_mov_b32 s27, s26
    s_mov_b32 s32, 0x3ecccccd
    v_xor_b32 v123, 112, v126
    s_waitcnt lgkmcnt(8)
    ds_write_b128 v123, v[60:63]
    s_mov_b32 s33, s32
    s_mov_b32 s34, 0xbd888889
    s_mov_b32 s35, s34
    s_mov_b32 s38, 0xbe4ccccd
    s_mov_b32 s39, s38
    s_mov_b32 s40, 0xbdd2d3e8
    s_mov_b32 s41, s40
    s_mov_b32 s42, 0x3f800000
    s_mov_b32 s43, s42
    s_setprio 0
    s_branch L_conv2_kernel_epi
L_conv2_kernel_m2:
    s_mul_i32 s37, s38, 2176
    s_add_u32 s37, s37, 98304
    v_add_u32 v116, s37, v8
    v_add_u32 v118, s37, v9
    v_add_u32 v117, 104832, v8
    s_cmp_eq_u32 s38, 0
    s_cbranch_scc1 L_conv2_kernel_hh0
    v_add_u32 v117, 98304, v9
L_conv2_kernel_hh0:
    s_lshl_b32 s37, s38, 12
    s_add_u32 s37, s37, s43
    s_add_u32 s37, s37, 49152
    v_lshl_add_u32 v119, v127, 4, s37
    v_mov_b32 v0, 0
    v_mov_b32 v1, 0
    v_mov_b32 v2, 0
    v_mov_b32 v3, 0
    v_mov_b32 v4, 0
    v_mov_b32 v5, 0
    v_mov_b32 v6, 0
    v_mov_b32 v7, 0
    v_mov_b32 v8, 0
    v_mov_b32 v9, 0
    v_mov_b32 v10, 0
    v_mov_b32 v11, 0
    v_mov_b32 v12, 0
    v_mov_b32 v13, 0
    v_mov_b32 v14, 0
    v_mov_b32 v15, 0
    v_mov_b32 v16, 0
    v_mov_b32 v17, 0
    v_mov_b32 v18, 0
    v_mov_b32 v19, 0
    v_mov_b32 v20, 0
    v_mov_b32 v21, 0
    v_mov_b32 v22, 0
    v_mov_b32 v23, 0
    v_mov_b32 v24, 0
    v_mov_b32 v25, 0
    v_mov_b32 v26, 0
    v_mov_b32 v27, 0
    v_mov_b32 v28, 0
    v_mov_b32 v29, 0
    v_mov_b32 v30, 0
    v_mov_b32 v31, 0
    v_mov_b32 v32, 0
    v_mov_b32 v33, 0
    v_mov_b32 v34, 0
    v_mov_b32 v35, 0
    v_mov_b32 v36, 0
    v_mov_b32 v37, 0
    v_mov_b32 v38, 0
    v_mov_b32 v39, 0
    v_mov_b32 v40, 0
    v_mov_b32 v41, 0
    v_mov_b32 v42, 0
    v_mov_b32 v43, 0
    v_mov_b32 v44, 0
    v_mov_b32 v45, 0
    v_mov_b32 v46, 0
    v_mov_b32 v47, 0
    v_mov_b32 v48, 0
    v_mov_b32 v49, 0
    v_mov_b32 v50, 0
    v_mov_b32 v51, 0
    v_mov_b32 v52, 0
    v_mov_b32 v53, 0
    v_mov_b32 v54, 0
    v_mov_b32 v55, 0
    v_mov_b32 v56, 0
    v_mov_b32 v57, 0
    v_mov_b32 v58, 0
    v_mov_b32 v59, 0
    v_mov_b32 v60, 0
    v_mov_b32 v61, 0
    v_mov_b32 v62, 0
    v_mov_b32 v63, 0
    buffer_load_dwordx4 v[96:99], v108, s[8:11], 0 offen
    buffer_load_dwordx4 v[100:103], v109, s[8:11], 0 offen
    buffer_load_dwordx4 v[104:107], v110, s[8:11], 0 offen
    s_mov_b32 s23, 0
    s_mov_b32 s26, 4096
    buffer_load_dwordx4 v[64:67], v125, s[12:15], s23 offen offset:0
    buffer_load_dwordx4 v[68:71], v125, s[12:15], s23 offen offset:2048
    buffer_load_dwordx4 v[80:83], v119, s[12:15], s23 offen offset:0
    buffer_load_dwordx4 v[72:75], v125, s[12:15], s26 offen offset:0
    buffer_load_dwordx4 v[84:87], v119, s[12:15], s23 offen offset:2048
    buffer_load_dwordx4 v[76:79], v125, s[12:15], s26 offen offset:2048
    s_mov_b32 s23, 57344
    s_mov_b32 s26, 61440
    s_waitcnt vmcnt(6)
    v_lshlrev_b32 v108, 16, v96
    v_and_b32 v111, s25, v96
    v_lshlrev_b32 v109, 16, v100
    v_and_b32 v112, s25, v100
    v_lshlrev_b32 v110, 16, v104
    v_and_b32 v113, s25, v104
    v_mul_f32 v114, s44, v108
    v_mul_f32 v115, s44, v111
    v_fmac_f32 v114, s45, v109
    v_fmac_f32 v115, s45, v112
    v_fmac_f32 v114, s46, v110
    v_fmac_f32 v115, s46, v113
    v_cvt_pk_bf16_f32 v96, v114, v115
    v_lshlrev_b32 v108, 16, v97
    v_and_b32 v111, s25, v97
    v_lshlrev_b32 v109, 16, v101
    v_and_b32 v112, s25, v101
    v_lshlrev_b32 v110, 16, v105
    v_and_b32 v113, s25, v105
    v_mul_f32 v114, s44, v108
    v_mul_f32 v115, s44, v111
    v_fmac_f32 v114, s45, v109
    v_fmac_f32 v115, s45, v112
    v_fmac_f32 v114, s46, v110
    v_fmac_f32 v115, s46, v113
    v_cvt_pk_bf16_f32 v97, v114, v115
    v_lshlrev_b32 v108, 16, v98
    v_and_b32 v111, s25, v98
    v_lshlrev_b32 v109, 16, v102
    v_and_b32 v112, s25, v102
    v_lshlrev_b32 v110, 16, v106
    v_and_b32 v113, s25, v106
    v_mul_f32 v114, s44, v108
    v_mul_f32 v115, s44, v111
    v_fmac_f32 v114, s45, v109
    v_fmac_f32 v115, s45, v112
    v_fmac_f32 v114, s46, v110
    v_fmac_f32 v115, s46, v113
    v_cvt_pk_bf16_f32 v98, v114, v115
    v_lshlrev_b32 v108, 16, v99
    v_and_b32 v111, s25, v99
    v_lshlrev_b32 v109, 16, v103
    v_and_b32 v112, s25, v103
    v_lshlrev_b32 v110, 16, v107
    v_and_b32 v113, s25, v107
    v_mul_f32 v114, s44, v108
    v_mul_f32 v115, s44, v111
    v_fmac_f32 v114, s45, v109
    v_fmac_f32 v115, s45, v112
    v_fmac_f32 v114, s46, v110
    v_fmac_f32 v115, s46, v113
    v_cvt_pk_bf16_f32 v99, v114, v115
    ds_write_b128 v126, v[96:99]
    v_and_b32 v111, 15, v127
    v_lshlrev_b32 v111, 2, v111
    v_add_u32 v111, 99328, v111
    ds_write_b32 v111, v0
    ds_write_b32 v111, v0 offset:8704
    s_waitcnt lgkmcnt(0)
    s_barrier
    s_mov_b32 s22, 4
    s_setprio 2
L_conv2_kernel_mloop2:
    ds_read_b128 v[88:91], v120 offset:0
    ds_read_b128 v[92:95], v120 offset:1024
    ds_read_b128 v[96:99], v116 offset:0
    ds_read_b128 v[100:103], v120 offset:2048
    ds_read_b128 v[104:107], v116 offset:1088
    ds_read_b128 v[108:111], v120 offset:3072
    ds_read_b128 v[112:115], v116 offset:2176
    s_waitcnt vmcnt(5) lgkmcnt(6)
    v_mfma_f32_16x16x32_bf16 v[0:3], v[64:67], v[88:91], v[0:3]
    ds_read_b128 v[88:91], v120 offset:4096
    s_waitcnt vmcnt(4) lgkmcnt(6)
    v_mfma_f32_16x16x32_bf16 v[4:7], v[64:67], v[92:95], v[4:7]
    v_mfma_f32_16x16x32_bf16 v[0:3], v[68:71], v[92:95], v[0:3]
    ds_read_b128 v[92:95], v116 offset:3264
    s_waitcnt vmcnt(3) lgkmcnt(6)
    v_mfma_f32_16x16x32_bf16 v[32:35], v[80:83], v[96:99], v[32:35]
    ds_read_b128 v[96:99], v120 offset:5120
    s_waitcnt vmcnt(2) lgkmcnt(6)
    v_mfma_f32_16x16x32_bf16 v[8:11], v[64:67], v[100:103], v[8:11]
    v_mfma_f32_16x16x32_bf16 v[4:7], v[68:71], v[100:103], v[4:7]
    v_mfma_f32_16x16x32_bf16 v[0:3], v[72:75], v[100:103], v[0:3]
    ds_read_b128 v[100:103], v116 offset:4352
    s_waitcnt vmcnt(1) lgkmcnt(6)
    v_mfma_f32_16x16x32_bf16 v[36:39], v[80:83], v[104:107], v[36:39]
    v_mfma_f32_16x16x32_bf16 v[32:35], v[84:87], v[104:107], v[32:35]
    ds_read_b128 v[104:107], v120 offset:6144
    s_waitcnt vmcnt(0) lgkmcnt(6)
    v_mfma_f32_16x16x32_bf16 v[12:15], v[64:67], v[108:111], v[12:15]
    v_mfma_f32_16x16x32_bf16 v[8:11], v[68:71], v[108:111], v[8:11]
    v_mfma_f32_16x16x32_bf16 v[4:7], v[72:75], v[108:111], v[4:7]
    v_mfma_f32_16x16x32_bf16 v[0:3], v[76:79], v[108:111], v[0:3]
    ds_read_b128 v[108:111], v116 offset:5440
    s_waitcnt lgkmcnt(6)
    v_mfma_f32_16x16x32_bf16 v[40:43], v[80:83], v[112:115], v[40:43]
    v_mfma_f32_16x16x32_bf16 v[36:39], v[84:87], v[112:115], v[36:39]
    ds_read_b128 v[112:115], v120 offset:7168
    s_waitcnt lgkmcnt(6)
    v_mfma_f32_16x16x32_bf16 v[16:19], v[64:67], v[88:91], v[16:19]
    v_mfma_f32_16x16x32_bf16 v[12:15], v[68:71], v[88:91], v[12:15]
    v_mfma_f32_16x16x32_bf16 v[8:11], v[72:75], v[88:91], v[8:11]
    v_mfma_f32_16x16x32_bf16 v[4:7], v[76:79], v[88:91], v[4:7]
    ds_read_b128 v[88:91], v117 offset:0
    s_waitcnt lgkmcnt(6)
    v_mfma_f32_16x16x32_bf16 v[44:47], v[80:83], v[92:95], v[44:47]
    v_mfma_f32_16x16x32_bf16 v[40:43], v[84:87], v[92:95], v[40:43]
    ds_read_b128 v[92:95], v122 offset:0
    v_add_u32 v122, v123, v122
    s_waitcnt lgkmcnt(6)
    v_mfma_f32_16x16x32_bf16 v[20:23], v[64:67], v[96:99], v[20:23]
    v_mfma_f32_16x16x32_bf16 v[16:19], v[68:71], v[96:99], v[16:19]
    v_mfma_f32_16x16x32_bf16 v[12:15], v[72:75], v[96:99], v[12:15]
    v_mfma_f32_16x16x32_bf16 v[8:11], v[76:79], v[96:99], v[8:11]
    ds_read_b128 v[96:99], v117 offset:1088
    s_waitcnt lgkmcnt(6)
    v_mfma_f32_16x16x32_bf16 v[48:51], v[80:83], v[100:103], v[48:51]
    v_mfma_f32_16x16x32_bf16 v[44:47], v[84:87], v[100:103], v[44:47]
    ds_read_b128 v[100:103], v121 offset:1024
    s_waitcnt lgkmcnt(6)
    v_mfma_f32_16x16x32_bf16 v[24:27], v[64:67], v[104:107], v[24:27]
    v_mfma_f32_16x16x32_bf16 v[20:23], v[68:71], v[104:107], v[20:23]
    v_mfma_f32_16x16x32_bf16 v[16:19], v[72:75], v[104:107], v[16:19]
    v_mfma_f32_16x16x32_bf16 v[12:15], v[76:79], v[104:107], v[12:15]
    ds_read_b128 v[104:107], v118 offset:0
    s_waitcnt lgkmcnt(6)
    v_mfma_f32_16x16x32_bf16 v[52:55], v[80:83], v[108:111], v[52:55]
    v_mfma_f32_16x16x32_bf16 v[48:51], v[84:87], v[108:111], v[48:51]
    ds_read_b128 v[108:111], v121 offset:2048
    s_waitcnt lgkmcnt(6)
    v_mfma_f32_16x16x32_bf16 v[28:31], v[64:67], v[112:115], v[28:31]
    v_mfma_f32_16x16x32_bf16 v[24:27], v[68:71], v[112:115], v[24:27]
    v_mfma_f32_16x16x32_bf16 v[20:23], v[72:75], v[112:115], v[20:23]
    v_mfma_f32_16x16x32_bf16 v[16:19], v[76:79], v[112:115], v[16:19]
    buffer_load_dwordx4 v[64:67], v125, s[12:15], s23 offen offset:0
    s_waitcnt lgkmcnt(5)
    v_mfma_f32_16x16x32_bf16 v[56:59], v[80:83], v[88:91], v[56:59]
    v_mfma_f32_16x16x32_bf16 v[52:55], v[84:87], v[88:91], v[52:55]
    s_waitcnt lgkmcnt(0)
    s_barrier
    v_mfma_f32_16x16x32_bf16 v[28:31], v[68:71], v[92:95], v[28:31]
    v_mfma_f32_16x16x32_bf16 v[24:27], v[72:75], v[92:95], v[24:27]
    v_mfma_f32_16x16x32_bf16 v[20:23], v[76:79], v[92:95], v[20:23]
    buffer_load_dwordx4 v[68:71], v125, s[12:15], s23 offen offset:2048
    v_mfma_f32_16x16x32_bf16 v[60:63], v[80:83], v[96:99], v[60:63]
    v_mfma_f32_16x16x32_bf16 v[56:59], v[84:87], v[96:99], v[56:59]
    buffer_load_dwordx4 v[80:83], v119, s[12:15], s23 offen offset:0
    v_mfma_f32_16x16x32_bf16 v[28:31], v[72:75], v[100:103], v[28:31]
    v_mfma_f32_16x16x32_bf16 v[24:27], v[76:79], v[100:103], v[24:27]
    buffer_load_dwordx4 v[72:75], v125, s[12:15], s26 offen offset:0
    v_mfma_f32_16x16x32_bf16 v[60:63], v[84:87], v[104:107], v[60:63]
    buffer_load_dwordx4 v[84:87], v119, s[12:15], s23 offen offset:2048
    v_mfma_f32_16x16x32_bf16 v[28:31], v[76:79], v[108:111], v[28:31]
    buffer_load_dwordx4 v[76:79], v125, s[12:15], s26 offen offset:2048
    s_add_u32 s23, s23, 57344
    s_add_u32 s26, s26, 57344
    s_sub_u32 s22, s22, 1
    s_cmp_eq_u32 s22, 0
    s_cbranch_scc1 L_conv2_kernel_mlast2
    ds_read_b128 v[88:91], v120 offset:8192
    ds_read_b128 v[92:95], v120 offset:9216
    ds_read_b128 v[96:99], v116 offset:8704
    ds_read_b128 v[100:103], v120 offset:10240
    ds_read_b128 v[104:107], v116 offset:9792
    ds_read_b128 v[108:111], v120 offset:11264
    ds_read_b128 v[112:115], v116 offset:10880
    s_waitcnt vmcnt(5) lgkmcnt(6)
    v_mfma_f32_16x16x32_bf16 v[0:3], v[64:67], v[88:91], v[0:3]
    ds_read_b128 v[88:91], v120 offset:12288
    s_waitcnt vmcnt(4) lgkmcnt(6)
    v_mfma_f32_16x16x32_bf16 v[4:7], v[64:67], v[92:95], v[4:7]
    v_mfma_f32_16x16x32_bf16 v[0:3], v[68:71], v[92:95], v[0:3]
    ds_read_b128 v[92:95], v116 offset:11968
    s_waitcnt vmcnt(3) lgkmcnt(6)
    v_mfma_f32_16x16x32_bf16 v[32:35], v[80:83], v[96:99], v[32:35]
    ds_read_b128 v[96:99], v120 offset:13312
    s_waitcnt vmcnt(2) lgkmcnt(6)
    v_mfma_f32_16x16x32_bf16 v[8:11], v[64:67], v[100:103], v[8:11]
    v_mfma_f32_16x16x32_bf16 v[4:7], v[68:71], v[100:103], v[4:7]
    v_mfma_f32_16x16x32_bf16 v[0:3], v[72:75], v[100:103], v[0:3]
    ds_read_b128 v[100:103], v116 offset:13056
    s_waitcnt vmcnt(1) lgkmcnt(6)
    v_mfma_f32_16x16x32_bf16 v[36:39], v[80:83], v[104:107], v[36:39]
    v_mfma_f32_16x16x32_bf16 v[32:35], v[84:87], v[104:107], v[32:35]
    ds_read_b128 v[104:107], v120 offset:14336
    s_waitcnt vmcnt(0) lgkmcnt(6)
    v_mfma_f32_16x16x32_bf16 v[12:15], v[64:67], v[108:111], v[12:15]
    v_mfma_f32_16x16x32_bf16 v[8:11], v[68:71], v[108:111], v[8:11]
    v_mfma_f32_16x16x32_bf16 v[4:7], v[72:75], v[108:111], v[4:7]
    v_mfma_f32_16x16x32_bf16 v[0:3], v[76:79], v[108:111], v[0:3]
    ds_read_b128 v[108:111], v116 offset:14144
    s_waitcnt lgkmcnt(6)
    v_mfma_f32_16x16x32_bf16 v[40:43], v[80:83], v[112:115], v[40:43]
    v_mfma_f32_16x16x32_bf16 v[36:39], v[84:87], v[112:115], v[36:39]
    ds_read_b128 v[112:115], v120 offset:15360
    s_waitcnt lgkmcnt(6)
    v_mfma_f32_16x16x32_bf16 v[16:19], v[64:67], v[88:91], v[16:19]
    v_mfma_f32_16x16x32_bf16 v[12:15], v[68:71], v[88:91], v[12:15]
    v_mfma_f32_16x16x32_bf16 v[8:11], v[72:75], v[88:91], v[8:11]
    v_mfma_f32_16x16x32_bf16 v[4:7], v[76:79], v[88:91], v[4:7]
    ds_read_b128 v[88:91], v117 offset:8704
    s_waitcnt lgkmcnt(6)
    v_mfma_f32_16x16x32_bf16 v[44:47], v[80:83], v[92:95], v[44:47]
    v_mfma_f32_16x16x32_bf16 v[40:43], v[84:87], v[92:95], v[40:43]
    ds_read_b128 v[92:95], v122 offset:0
    v_add_u32 v122, v124, v122
    s_waitcnt lgkmcnt(6)
    v_mfma_f32_16x16x32_bf16 v[20:23], v[64:67], v[96:99], v[20:23]
    v_mfma_f32_16x16x32_bf16 v[16:19], v[68:71], v[96:99], v[16:19]
    v_mfma_f32_16x16x32_bf16 v[12:15], v[72:75], v[96:99], v[12:15]
    v_mfma_f32_16x16x32_bf16 v[8:11], v[76:79], v[96:99], v[8:11]
    ds_read_b128 v[96:99], v117 offset:9792
    s_waitcnt lgkmcnt(6)
    v_mfma_f32_16x16x32_bf16 v[48:51], v[80:83], v[100:103], v[48:51]
    v_mfma_f32_16x16x32_bf16 v[44:47], v[84:87], v[100:103], v[44:47]
    ds_read_b128 v[100:103], v121 offset:9216
    s_waitcnt lgkmcnt(6)
    v_mfma_f32_16x16x32_bf16 v[24:27], v[64:67], v[104:107], v[24:27]
    v_mfma_f32_16x16x32_bf16 v[20:23], v[68:71], v[104:107], v[20:23]
    v_mfma_f32_16x16x32_bf16 v[16:19], v[72:75], v[104:107], v[16:19]
    v_mfma_f32_16x16x32_bf16 v[12:15], v[76:79], v[104:107], v[12:15]
    ds_read_b128 v[104:107], v118 offset:8704
    s_waitcnt lgkmcnt(6)
    v_mfma_f32_16x16x32_bf16 v[52:55], v[80:83], v[108:111], v[52:55]
    v_mfma_f32_16x16x32_bf16 v[48:51], v[84:87], v[108:111], v[48:51]
    ds_read_b128 v[108:111], v121 offset:10240
    s_waitcnt lgkmcnt(6)
    v_mfma_f32_16x16x32_bf16 v[28:31], v[64:67], v[112:115], v[28:31]
    v_mfma_f32_16x16x32_bf16 v[24:27], v[68:71], v[112:115], v[24:27]
    v_mfma_f32_16x16x32_bf16 v[20:23], v[72:75], v[112:115], v[20:23]
    v_mfma_f32_16x16x32_bf16 v[16:19], v[76:79], v[112:115], v[16:19]
    buffer_load_dwordx4 v[64:67], v125, s[12:15], s23 offen offset:0
    s_waitcnt lgkmcnt(5)
    v_mfma_f32_16x16x32_bf16 v[56:59], v[80:83], v[88:91], v[56:59]
    v_mfma_f32_16x16x32_bf16 v[52:55], v[84:87], v[88:91], v[52:55]
    s_waitcnt lgkmcnt(0)
    s_barrier
    v_mfma_f32_16x16x32_bf16 v[28:31], v[68:71], v[92:95], v[28:31]
    v_mfma_f32_16x16x32_bf16 v[24:27], v[72:75], v[92:95], v[24:27]
    v_mfma_f32_16x16x32_bf16 v[20:23], v[76:79], v[92:95], v[20:23]
    buffer_load_dwordx4 v[68:71], v125, s[12:15], s23 offen offset:2048
    v_mfma_f32_16x16x32_bf16 v[60:63], v[80:83], v[96:99], v[60:63]
    v_mfma_f32_16x16x32_bf16 v[56:59], v[84:87], v[96:99], v[56:59]
    buffer_load_dwordx4 v[80:83], v119, s[12:15], s23 offen offset:0
    v_mfma_f32_16x16x32_bf16 v[28:31], v[72:75], v[100:103], v[28:31]
    v_mfma_f32_16x16x32_bf16 v[24:27], v[76:79], v[100:103], v[24:27]
    buffer_load_dwordx4 v[72:75], v125, s[12:15], s26 offen offset:0
    v_mfma_f32_16x16x32_bf16 v[60:63], v[84:87], v[104:107], v[60:63]
    buffer_load_dwordx4 v[84:87], v119, s[12:15], s23 offen offset:2048
    v_mfma_f32_16x16x32_bf16 v[28:31], v[76:79], v[108:111], v[28:31]
    buffer_load_dwordx4 v[76:79], v125, s[12:15], s26 offen offset:2048
    s_add_u32 s23, s23, 57344
    s_add_u32 s26, s26, 57344
    s_branch L_conv2_kernel_mloop2
L_conv2_kernel_mlast2:
    v_and_b32 v125, 15, v127
    v_and_b32 v126, 7, v127
    v_lshlrev_b32 v126, 4, v126
    v_lshl_add_u32 v125, v125, 7, v126
    v_lshrrev_b32 v126, 4, v127
    v_lshl_add_u32 v125, v126, 11, v125
    s_mov_b32 s36, 65536
    s_cmp_eq_u32 s32, 1
    s_cselect_b32 s36, 121856, s36
    s_cmp_eq_u32 s32, 2
    s_cselect_b32 s36, 81920, s36
    s_cmp_eq_u32 s32, 3
    s_cselect_b32 s36, 130048, s36
    s_mov_b32 s37, 98304
    s_cmp_eq_u32 s32, 1
    s_cselect_b32 s37, 138240, s37
    s_cmp_eq_u32 s32, 2
    s_cselect_b32 s37, 146432, s37
    s_cmp_eq_u32 s32, 3
    s_cselect_b32 s37, 154624, s37
    v_add_u32 v126, s37, v125
    v_add_u32 v125, s36, v125
    ds_read_b128 v[88:91], v120 offset:8192
    ds_read_b128 v[92:95], v120 offset:9216
    ds_read_b128 v[96:99], v116 offset:8704
    ds_read_b128 v[100:103], v120 offset:10240
    ds_read_b128 v[104:107], v116 offset:9792
    ds_read_b128 v[108:111], v120 offset:11264
    ds_read_b128 v[112:115], v116 offset:10880
    s_waitcnt vmcnt(5) lgkmcnt(6)
    v_mfma_f32_16x16x32_bf16 v[0:3], v[64:67], v[88:91], v[0:3]
    ds_read_b128 v[88:91], v120 offset:12288
    s_waitcnt vmcnt(4) lgkmcnt(6)
    v_mfma_f32_16x16x32_bf16 v[4:7], v[64:67], v[92:95], v[4:7]
    v_mfma_f32_16x16x32_bf16 v[0:3], v[68:71], v[92:95], v[0:3]
    ds_read_b128 v[92:95], v116 offset:11968
    s_waitcnt vmcnt(3) lgkmcnt(6)
    v_mfma_f32_16x16x32_bf16 v[32:35], v[80:83], v[96:99], v[32:35]
    ds_read_b128 v[96:99], v120 offset:13312
    s_waitcnt vmcnt(2) lgkmcnt(6)
    v_mfma_f32_16x16x32_bf16 v[8:11], v[64:67], v[100:103], v[8:11]
    v_mfma_f32_16x16x32_bf16 v[4:7], v[68:71], v[100:103], v[4:7]
    v_mfma_f32_16x16x32_bf16 v[0:3], v[72:75], v[100:103], v[0:3]
    ds_read_b128 v[100:103], v116 offset:13056
    s_waitcnt vmcnt(1) lgkmcnt(6)
    v_mfma_f32_16x16x32_bf16 v[36:39], v[80:83], v[104:107], v[36:39]
    v_mfma_f32_16x16x32_bf16 v[32:35], v[84:87], v[104:107], v[32:35]
    ds_read_b128 v[104:107], v120 offset:14336
    s_waitcnt vmcnt(0) lgkmcnt(6)
    v_mfma_f32_16x16x32_bf16 v[12:15], v[64:67], v[108:111], v[12:15]
    v_mfma_f32_16x16x32_bf16 v[8:11], v[68:71], v[108:111], v[8:11]
    v_mfma_f32_16x16x32_bf16 v[4:7], v[72:75], v[108:111], v[4:7]
    v_mfma_f32_16x16x32_bf16 v[0:3], v[76:79], v[108:111], v[0:3]
    ds_read_b128 v[108:111], v116 offset:14144
    s_waitcnt lgkmcnt(6)
    v_mfma_f32_16x16x32_bf16 v[40:43], v[80:83], v[112:115], v[40:43]
    v_mfma_f32_16x16x32_bf16 v[36:39], v[84:87], v[112:115], v[36:39]
    ds_read_b128 v[112:115], v120 offset:15360
    s_waitcnt lgkmcnt(6)
    v_mfma_f32_16x16x32_bf16 v[16:19], v[64:67], v[88:91], v[16:19]
    v_mfma_f32_16x16x32_bf16 v[12:15], v[68:71], v[88:91], v[12:15]
    v_mfma_f32_16x16x32_bf16 v[8:11], v[72:75], v[88:91], v[8:11]
    v_mfma_f32_16x16x32_bf16 v[4:7], v[76:79], v[88:91], v[4:7]
    ds_read_b128 v[88:91], v117 offset:8704
    v_xor_b32 v124, 0, v126
    ds_write_b128 v124, v[32:35]
    s_waitcnt lgkmcnt(7)
    v_mfma_f32_16x16x32_bf16 v[44:47], v[80:83], v[92:95], v[44:47]
    v_mfma_f32_16x16x32_bf16 v[40:43], v[84:87], v[92:95], v[40:43]
    ds_read_b128 v[92:95], v122 offset:0
    v_xor_b32 v123, 0, v125
    ds_write_b128 v123, v[0:3]
    s_waitcnt lgkmcnt(8)
    v_mfma_f32_16x16x32_bf16 v[20:23], v[64:67], v[96:99], v[20:23]
    v_mfma_f32_16x16x32_bf16 v[16:19], v[68:71], v[96:99], v[16:19]
    v_mfma_f32_16x16x32_bf16 v[12:15], v[72:75], v[96:99], v[12:15]
    v_mfma_f32_16x16x32_bf16 v[8:11], v[76:79], v[96:99], v[8:11]
    ds_read_b128 v[96:99], v117 offset:9792
    v_xor_b32 v123, 16, v126
    ds_write_b128 v123, v[36:39]
    s_waitcnt lgkmcnt(9)
    v_mfma_f32_16x16x32_bf16 v[48:51], v[80:83], v[100:103], v[48:51]
    v_mfma_f32_16x16x32_bf16 v[44:47], v[84:87], v[100:103], v[44:47]
    ds_read_b128 v[100:103], v121 offset:9216
    v_xor_b32 v124, 16, v125
    ds_write_b128 v124, v[4:7]
    s_waitcnt lgkmcnt(10)
    v_mfma_f32_16x16x32_bf16 v[24:27], v[64:67], v[104:107], v[24:27]
    v_mfma_f32_16x16x32_bf16 v[20:23], v[68:71], v[104:107], v[20:23]
    v_mfma_f32_16x16x32_bf16 v[16:19], v[72:75], v[104:107], v[16:19]
    v_mfma_f32_16x16x32_bf16 v[12:15], v[76:79], v[104:107], v[12:15]
    ds_read_b128 v[104:107], v118 offset:8704
    v_xor_b32 v124, 32, v126
    ds_write_b128 v124, v[40:43]
    s_waitcnt lgkmcnt(11)
    v_mfma_f32_16x16x32_bf16 v[52:55], v[80:83], v[108:111], v[52:55]
    v_mfma_f32_16x16x32_bf16 v[48:51], v[84:87], v[108:111], v[48:51]
    ds_read_b128 v[108:111], v121 offset:10240
    v_xor_b32 v123, 32, v125
    ds_write_b128 v123, v[8:11]
    s_waitcnt lgkmcnt(12)
    v_mfma_f32_16x16x32_bf16 v[28:31], v[64:67], v[112:115], v[28:31]
    v_mfma_f32_16x16x32_bf16 v[24:27], v[68:71], v[112:115], v[24:27]
    v_mfma_f32_16x16x32_bf16 v[20:23], v[72:75], v[112:115], v[20:23]
    v_mfma_f32_16x16x32_bf16 v[16:19], v[76:79], v[112:115], v[16:19]
    v_xor_b32 v123, 48, v126
    ds_write_b128 v123, v[44:47]
    s_waitcnt lgkmcnt(12)
    v_mfma_f32_16x16x32_bf16 v[56:59], v[80:83], v[88:91], v[56:59]
    v_mfma_f32_16x16x32_bf16 v[52:55], v[84:87], v[88:91], v[52:55]
    v_xor_b32 v124, 48, v125
    ds_write_b128 v124, v[12:15]
    s_waitcnt lgkmcnt(11)
    v_mfma_f32_16x16x32_bf16 v[28:31], v[68:71], v[92:95], v[28:31]
    v_mfma_f32_16x16x32_bf16 v[24:27], v[72:75], v[92:95], v[24:27]
    v_mfma_f32_16x16x32_bf16 v[20:23], v[76:79], v[92:95], v[20:23]
    v_xor_b32 v124, 64, v126
    ds_write_b128 v124, v[48:51]
    s_waitcnt lgkmcnt(10)
    v_mfma_f32_16x16x32_bf16 v[60:63], v[80:83], v[96:99], v[60:63]
    v_mfma_f32_16x16x32_bf16 v[56:59], v[84:87], v[96:99], v[56:59]
    v_xor_b32 v123, 64, v125
    ds_write_b128 v123, v[16:19]
    s_waitcnt lgkmcnt(9)
    v_mfma_f32_16x16x32_bf16 v[28:31], v[72:75], v[100:103], v[28:31]
    v_mfma_f32_16x16x32_bf16 v[24:27], v[76:79], v[100:103], v[24:27]
    v_xor_b32 v123, 80, v126
    ds_write_b128 v123, v[52:55]
    s_waitcnt lgkmcnt(8)
    v_mfma_f32_16x16x32_bf16 v[60:63], v[84:87], v[104:107], v[60:63]
    v_xor_b32 v124, 80, v125
    ds_write_b128 v124, v[20:23]
    s_waitcnt lgkmcnt(7)
    v_mfma_f32_16x16x32_bf16 v[28:31], v[76:79], v[108:111], v[28:31]
    v_xor_b32 v124, 96, v126
    ds_write_b128 v124, v[56:59]
    v_and_b32 v108, 15, v127
    v_lshrrev_b32 v109, 4, v127
    v_lshrrev_b32 v110, 3, v108
    s_lshl_b32 s36, s20, 1
    v_add_u32 v110, s36, v110
    v_xor_b32 v111, v110, v108
    v_and_b32 v111, 7, v111
    v_lshlrev_b32 v111, 4, v111
    v_xor_b32 v123, 96, v125
    ds_write_b128 v123, v[24:27]
    v_lshl_add_u32 v111, v110, 7, v111
    v_lshl_add_u32 v120, v109, 11, v111
    v_add_u32 v121, 65536, v120
    v_add_u32 v64, 131072, v120
    s_lshl_b32 s36, s20, 9
    s_add_u32 s36, s36, 115712
    v_lshl_add_u32 v127, v109, 7, s36
    s_lshl_b32 s36, s20, 4
    v_add_u32 v108, s36, v108
    v_lshlrev_b32 v110, 6, v108
    v_lshl_add_u32 v110, v109, 4, v110
    s_mul_i32 s36, s29, 262144
    v_xor_b32 v123, 112, v126
    ds_write_b128 v123, v[60:63]
    s_lshl_b32 s37, s21, 4
    s_add_u32 s36, s36, s37
    v_add_u32 v110, s36, v110
    v_mov_b32 v111, 2130706432
    v_cmp_gt_u32 vcc, 125, v108
    s_mov_b32 s4, 0xbeaaaaab
    s_mov_b32 s5, s4
    s_mov_b32 s6, 0x3e800000
    s_mov_b32 s7, s6
    s_mov_b32 s8, 0xc0a00000
    s_mov_b32 s9, s8
    s_mov_b32 s10, 0xc0638e39
    v_xor_b32 v124, 112, v125
    ds_write_b128 v124, v[28:31]
    s_mov_b32 s11, s10
    s_mov_b32 s12, 0xbf638e39
    s_mov_b32 s13, s12
    s_mov_b32 s14, 0xbe638e39
    s_mov_b32 s15, s14
    s_mov_b32 s22, 0xbd638e39
    s_mov_b32 s23, s22
    s_mov_b32 s24, 0x3ff1c71c
    s_mov_b32 s25, s24
    s_mov_b32 s26, 0xbf2aaaab
    s_mov_b32 s27, s26
    s_mov_b32 s32, 0x3ecccccd
    s_mov_b32 s33, s32
    s_mov_b32 s34, 0xbd888889
    s_mov_b32 s35, s34
    s_mov_b32 s38, 0xbe4ccccd
    s_mov_b32 s39, s38
    s_mov_b32 s40, 0xbdd2d3e8
    s_mov_b32 s41, s40
    s_mov_b32 s42, 0x3f800000
    s_mov_b32 s43, s42
    s_setprio 0
    s_branch L_conv2_kernel_epi
L_conv2_kernel_epi:
    s_waitcnt lgkmcnt(0)
    s_barrier
    v_cndmask_b32 v122, v111, v110, vcc
    ds_read_b128 v[0:3], v120 offset:0
    ds_read_b128 v[4:7], v120 offset:16384
    ds_read_b128 v[8:11], v120 offset:32768
    ds_read_b128 v[12:15], v120 offset:49152
    ds_read_b128 v[16:19], v121 offset:0
    ds_read_b128 v[20:23], v121 offset:16384
    ds_read_b128 v[24:27], v121 offset:32768
    ds_read_b128 v[28:31], v64 offset:15360
    ds_read_b128 v[32:35], v120 offset:8192
    ds_read_b128 v[36:39], v120 offset:24576
    ds_read_b128 v[40:43], v120 offset:40960
    ds_read_b128 v[44:47], v120 offset:57344
    ds_read_b128 v[48:51], v121 offset:56320
    ds_read_b128 v[52:55], v121 offset:64512
    ds_read_b128 v[56:59], v64 offset:7168
    s_waitcnt lgkmcnt(7)
    ds_read_b128 v[60:63], v64 offset:23552
    s_waitcnt lgkmcnt(8)
    v_pk_add_f32 v[88:89], v[24:25], v[28:29]
    v_pk_add_f32 v[90:91], v[26:27], v[30:31]
    v_pk_add_f32 v[24:25], v[4:5], v[8:9]
    v_pk_add_f32 v[26:27], v[6:7], v[10:11]
    v_pk_add_f32 v[4:5], v[4:5], v[8:9] neg_lo:[0,1] neg_hi:[0,1]
    v_pk_add_f32 v[6:7], v[6:7], v[10:11] neg_lo:[0,1] neg_hi:[0,1]
    v_pk_add_f32 v[72:73], v[12:13], v[16:17]
    v_pk_add_f32 v[74:75], v[14:15], v[18:19]
    v_pk_add_f32 v[12:13], v[12:13], v[16:17] neg_lo:[0,1] neg_hi:[0,1]
    v_pk_add_f32 v[14:15], v[14:15], v[18:19] neg_lo:[0,1] neg_hi:[0,1]
    v_pk_fma_f32 v[72:73], v[24:25], s[4:5], v[72:73]
    v_pk_fma_f32 v[74:75], v[26:27], s[4:5], v[74:75]
    v_pk_fma_f32 v[20:21], v[0:1], s[10:11], v[20:21]
    v_pk_fma_f32 v[22:23], v[2:3], s[10:11], v[22:23]
    v_pk_fma_f32 v[72:73], v[0:1], s[6:7], v[72:73]
    v_pk_fma_f32 v[74:75], v[2:3], s[6:7], v[74:75]
    v_pk_add_f32 v[24:25], v[24:25], v[0:1] neg_lo:[0,1] neg_hi:[0,1]
    v_pk_add_f32 v[26:27], v[26:27], v[2:3] neg_lo:[0,1] neg_hi:[0,1]
    v_pk_fma_f32 v[72:73], v[88:89], s[8:9], v[72:73]
    v_pk_fma_f32 v[74:75], v[90:91], s[8:9], v[74:75]
    v_pk_add_f32 v[24:25], v[24:25], v[88:89] neg_lo:[0,1] neg_hi:[0,1]
    v_pk_add_f32 v[26:27], v[26:27], v[90:91] neg_lo:[0,1] neg_hi:[0,1]
    v_pk_fma_f32 v[20:21], v[88:89], s[22:23], v[20:21]
    v_pk_fma_f32 v[22:23], v[90:91], s[22:23], v[22:23]
    v_pk_add_f32 v[8:9], v[24:25], v[72:73] neg_lo:[0,1] neg_hi:[0,1]
    v_pk_add_f32 v[10:11], v[26:27], v[74:75] neg_lo:[0,1] neg_hi:[0,1]
    v_pk_fma_f32 v[20:21], v[72:73], s[14:15], v[20:21]
    v_pk_fma_f32 v[22:23], v[74:75], s[14:15], v[22:23]
    v_pk_mul_f32 v[80:81], v[12:13], s[32:33]
    v_pk_mul_f32 v[82:83], v[14:15], s[32:33]
    v_pk_fma_f32 v[20:21], v[8:9], s[12:13], v[20:21]
    v_pk_fma_f32 v[22:23], v[10:11], s[12:13], v[22:23]
    v_pk_fma_f32 v[80:81], v[4:5], s[34:35], v[80:81]
    v_pk_fma_f32 v[82:83], v[6:7], s[34:35], v[82:83]
    v_pk_fma_f32 v[64:65], v[4:5], s[24:25], v[20:21] neg_lo:[0,0,1] neg_hi:[0,0,1]
    v_pk_fma_f32 v[66:67], v[6:7], s[24:25], v[22:23] neg_lo:[0,0,1] neg_hi:[0,0,1]
    v_pk_fma_f32 v[64:65], v[12:13], s[26:27], v[64:65]
    v_pk_fma_f32 v[66:67], v[14:15], s[26:27], v[66:67]
    v_pk_fma_f32 v[80:81], v[64:65], s[38:39], v[80:81]
    v_pk_fma_f32 v[82:83], v[66:67], s[38:39], v[82:83]
    v_pk_add_f32 v[4:5], v[4:5], v[64:65] neg_lo:[0,1] neg_hi:[0,1]
    v_pk_add_f32 v[6:7], v[6:7], v[66:67] neg_lo:[0,1] neg_hi:[0,1]
    v_pk_add_f32 v[4:5], v[4:5], v[80:81] neg_lo:[0,1] neg_hi:[0,1]
    v_pk_add_f32 v[6:7], v[6:7], v[82:83] neg_lo:[0,1] neg_hi:[0,1]
    s_waitcnt lgkmcnt(0)
    v_pk_add_f32 v[92:93], v[56:57], v[60:61]
    v_pk_add_f32 v[94:95], v[58:59], v[62:63]
    v_pk_add_f32 v[56:57], v[36:37], v[40:41]
    v_pk_add_f32 v[58:59], v[38:39], v[42:43]
    v_pk_add_f32 v[36:37], v[36:37], v[40:41] neg_lo:[0,1] neg_hi:[0,1]
    v_pk_add_f32 v[38:39], v[38:39], v[42:43] neg_lo:[0,1] neg_hi:[0,1]
    v_pk_add_f32 v[76:77], v[44:45], v[48:49]
    v_pk_add_f32 v[78:79], v[46:47], v[50:51]
    v_pk_add_f32 v[44:45], v[44:45], v[48:49] neg_lo:[0,1] neg_hi:[0,1]
    v_pk_add_f32 v[46:47], v[46:47], v[50:51] neg_lo:[0,1] neg_hi:[0,1]
    v_pk_fma_f32 v[76:77], v[56:57], s[4:5], v[76:77]
    v_pk_fma_f32 v[78:79], v[58:59], s[4:5], v[78:79]
    v_pk_fma_f32 v[52:53], v[32:33], s[10:11], v[52:53]
    v_pk_fma_f32 v[54:55], v[34:35], s[10:11], v[54:55]
    v_pk_fma_f32 v[76:77], v[32:33], s[6:7], v[76:77]
    v_pk_fma_f32 v[78:79], v[34:35], s[6:7], v[78:79]
    v_pk_add_f32 v[56:57], v[56:57], v[32:33] neg_lo:[0,1] neg_hi:[0,1]
    v_pk_add_f32 v[58:59], v[58:59], v[34:35] neg_lo:[0,1] neg_hi:[0,1]
    v_pk_fma_f32 v[76:77], v[92:93], s[8:9], v[76:77]
    v_pk_fma_f32 v[78:79], v[94:95], s[8:9], v[78:79]
    v_pk_add_f32 v[56:57], v[56:57], v[92:93] neg_lo:[0,1] neg_hi:[0,1]
    v_pk_add_f32 v[58:59], v[58:59], v[94:95] neg_lo:[0,1] neg_hi:[0,1]
    v_pk_fma_f32 v[52:53], v[92:93], s[22:23], v[52:53]
    v_pk_fma_f32 v[54:55], v[94:95], s[22:23], v[54:55]
    v_pk_add_f32 v[40:41], v[56:57], v[76:77] neg_lo:[0,1] neg_hi:[0,1]
    v_pk_add_f32 v[42:43], v[58:59], v[78:79] neg_lo:[0,1] neg_hi:[0,1]
    v_pk_fma_f32 v[52:53], v[76:77], s[14:15], v[52:53]
    v_pk_fma_f32 v[54:55], v[78:79], s[14:15], v[54:55]
    v_pk_mul_f32 v[84:85], v[44:45], s[32:33]
    v_pk_mul_f32 v[86:87], v[46:47], s[32:33]
    v_pk_fma_f32 v[52:53], v[40:41], s[12:13], v[52:53]
    v_pk_fma_f32 v[54:55], v[42:43], s[12:13], v[54:55]
    v_pk_fma_f32 v[84:85], v[36:37], s[34:35], v[84:85]
    v_pk_fma_f32 v[86:87], v[38:39], s[34:35], v[86:87]
    v_pk_fma_f32 v[68:69], v[36:37], s[24:25], v[52:53] neg_lo:[0,0,1] neg_hi:[0,0,1]
    v_pk_fma_f32 v[70:71], v[38:39], s[24:25], v[54:55] neg_lo:[0,0,1] neg_hi:[0,0,1]
    v_pk_fma_f32 v[68:69], v[44:45], s[26:27], v[68:69]
    v_pk_fma_f32 v[70:71], v[46:47], s[26:27], v[70:71]
    v_pk_fma_f32 v[84:85], v[68:69], s[38:39], v[84:85]
    v_pk_fma_f32 v[86:87], v[70:71], s[38:39], v[86:87]
    v_pk_add_f32 v[36:37], v[36:37], v[68:69] neg_lo:[0,1] neg_hi:[0,1]
    v_pk_add_f32 v[38:39], v[38:39], v[70:71] neg_lo:[0,1] neg_hi:[0,1]
    v_pk_add_f32 v[36:37], v[36:37], v[84:85] neg_lo:[0,1] neg_hi:[0,1]
    v_pk_add_f32 v[38:39], v[38:39], v[86:87] neg_lo:[0,1] neg_hi:[0,1]
    s_mov_b32 s36, 0x00010001
    s_mov_b32 s37, 0x00010001
    s_mov_b64 exec, s[36:37]
    ds_write_b128 v127, v[0:3] offset:0
    ds_write_b128 v127, v[32:35] offset:16
    ds_write_b128 v127, v[4:7] offset:32
    ds_write_b128 v127, v[36:39] offset:48
    ds_write_b128 v127, v[8:11] offset:64
    ds_write_b128 v127, v[40:43] offset:80
    s_mov_b64 exec, -1
    v_mov_b32 v44, 0xc0135761
    v_mov_b32 v45, v44
    v_cvt_pk_bf16_f32 v48, v64, v68
    v_cvt_pk_bf16_f32 v49, v65, v69
    v_cvt_pk_bf16_f32 v50, v66, v70
    v_cvt_pk_bf16_f32 v51, v67, v71
    s_mov_b32 s44, 0
    buffer_store_dwordx4 v[48:51], v122, s[16:19], s44 offen sc1
    s_waitcnt lgkmcnt(0)
    s_barrier
    ds_read_b128 v[96:99], v127 offset:512
    ds_read_b128 v[100:103], v127 offset:528
    ds_read_b128 v[104:107], v127 offset:544
    ds_read_b128 v[108:111], v127 offset:560
    ds_read_b128 v[112:115], v127 offset:576
    ds_read_b128 v[116:119], v127 offset:592
    s_waitcnt lgkmcnt(4)
    v_mov_b32_dpp v96, v0 row_shl:1 row_mask:0xf bank_mask:0xf
    v_mov_b32_dpp v97, v1 row_shl:1 row_mask:0xf bank_mask:0xf
    v_mov_b32_dpp v98, v2 row_shl:1 row_mask:0xf bank_mask:0xf
    v_mov_b32_dpp v99, v3 row_shl:1 row_mask:0xf bank_mask:0xf
    v_mov_b32_dpp v100, v32 row_shl:1 row_mask:0xf bank_mask:0xf
    v_mov_b32_dpp v101, v33 row_shl:1 row_mask:0xf bank_mask:0xf
    v_mov_b32_dpp v102, v34 row_shl:1 row_mask:0xf bank_mask:0xf
    v_mov_b32_dpp v103, v35 row_shl:1 row_mask:0xf bank_mask:0xf
    v_pk_add_f32 v[72:73], v[72:73], v[96:97]
    v_pk_add_f32 v[74:75], v[74:75], v[98:99]
    v_pk_add_f32 v[76:77], v[76:77], v[100:101]
    v_pk_add_f32 v[78:79], v[78:79], v[102:103]
    v_cvt_pk_bf16_f32 v52, v72, v76
    v_cvt_pk_bf16_f32 v53, v73, v77
    v_cvt_pk_bf16_f32 v54, v74, v78
    v_cvt_pk_bf16_f32 v55, v75, v79
    s_mov_b32 s44, 65536
    buffer_store_dwordx4 v[52:55], v122, s[16:19], s44 offen sc1
    s_waitcnt lgkmcnt(2)
    v_mov_b32_dpp v104, v4 row_shl:1 row_mask:0xf bank_mask:0xf
    v_mov_b32_dpp v105, v5 row_shl:1 row_mask:0xf bank_mask:0xf
    v_mov_b32_dpp v106, v6 row_shl:1 row_mask:0xf bank_mask:0xf
    v_mov_b32_dpp v107, v7 row_shl:1 row_mask:0xf bank_mask:0xf
    v_mov_b32_dpp v108, v36 row_shl:1 row_mask:0xf bank_mask:0xf
    v_mov_b32_dpp v109, v37 row_shl:1 row_mask:0xf bank_mask:0xf
    v_mov_b32_dpp v110, v38 row_shl:1 row_mask:0xf bank_mask:0xf
    v_mov_b32_dpp v111, v39 row_shl:1 row_mask:0xf bank_mask:0xf
    v_pk_add_f32 v[80:81], v[80:81], v[104:105]
    v_pk_add_f32 v[82:83], v[82:83], v[106:107]
    v_pk_add_f32 v[84:85], v[84:85], v[108:109]
    v_pk_add_f32 v[86:87], v[86:87], v[110:111]
    v_cvt_pk_bf16_f32 v56, v80, v84
    v_cvt_pk_bf16_f32 v57, v81, v85
    v_cvt_pk_bf16_f32 v58, v82, v86
    v_cvt_pk_bf16_f32 v59, v83, v87
    s_mov_b32 s44, 131072
    buffer_store_dwordx4 v[56:59], v122, s[16:19], s44 offen sc1
    s_waitcnt lgkmcnt(0)
    v_mov_b32_dpp v112, v8 row_shl:1 row_mask:0xf bank_mask:0xf
    v_mov_b32_dpp v113, v9 row_shl:1 row_mask:0xf bank_mask:0xf
    v_mov_b32_dpp v114, v10 row_shl:1 row_mask:0xf bank_mask:0xf
    v_mov_b32_dpp v115, v11 row_shl:1 row_mask:0xf bank_mask:0xf
    v_mov_b32_dpp v116, v40 row_shl:1 row_mask:0xf bank_mask:0xf
    v_mov_b32_dpp v117, v41 row_shl:1 row_mask:0xf bank_mask:0xf
    v_mov_b32_dpp v118, v42 row_shl:1 row_mask:0xf bank_mask:0xf
    v_mov_b32_dpp v119, v43 row_shl:1 row_mask:0xf bank_mask:0xf
    v_pk_add_f32 v[88:89], v[88:89], v[112:113]
    v_pk_add_f32 v[90:91], v[90:91], v[114:115]
    v_pk_add_f32 v[92:93], v[92:93], v[116:117]
    v_pk_add_f32 v[94:95], v[94:95], v[118:119]
    v_cvt_pk_bf16_f32 v60, v88, v92
    v_cvt_pk_bf16_f32 v61, v89, v93
    v_cvt_pk_bf16_f32 v62, v90, v94
    v_cvt_pk_bf16_f32 v63, v91, v95
    s_mov_b32 s44, 196608
    buffer_store_dwordx4 v[60:63], v122, s[16:19], s44 offen sc1
L_conv2_kernel_end:
L_conv2_kernel_done:
    s_endpgm
.globl joint_kernel
.p2align 8
.type joint_kernel,@function
joint_kernel:
    s_cmp_ge_u32 s2, 250
    s_cbranch_scc1 L_joint_kernel_done
    s_load_dwordx2 s[28:29], s[0:1], 56
    s_load_dwordx2 s[30:31], s[0:1], 72
    v_readfirstlane_b32 s20, v0
    s_lshr_b32 s20, s20, 6
    s_and_b32 s21, s20, 7
    v_and_b32 v127, 63, v0
    v_lshlrev_b32 v126, 4, v127
    s_cmp_ge_u32 s20, 8
    s_mov_b32 s33, 44171264
    s_cselect_b32 s33, 44040192, s33
    s_lshl_b32 s36, s21, 14
    s_add_u32 s33, s33, s36
    s_mov_b32 s14, 16384
    s_mov_b32 s15, 0x00020000
    s_lshl_b32 s35, s2, 9
    s_cmp_ge_u32 s2, 125
    s_cselect_b32 s36, 2033152, 0
    s_cselect_b32 s34, 8192, 0
    s_add_u32 s35, s35, s36
    s_add_u32 s34, s34, 44302336
    s_mov_b32 s10, 12582912
    s_mov_b32 s11, 0x00020000
    s_mov_b32 s42, 24576
    s_mov_b32 s43, 0x00020000
    s_cmp_ge_u32 s20, 8
    s_cbranch_scc1 L_joint_kernel_T
    v_lshrrev_b32 v124, 5, v127
    v_and_b32 v123, 0x1ff, v126
    v_mul_u32_u24 v125, 65536, v124
    v_add_u32 v123, v125, v123
    s_mul_i32 s36, s21, 262144
    s_add_u32 s36, s36, s35
    s_waitcnt lgkmcnt(0)
    s_add_u32 s8, s30, 27262976
    s_addc_u32 s9, s31, 0
    s_add_u32 s37, s36, 8388608
    buffer_load_dwordx4 v[64:67], v123, s[8:11], s36 offen
    buffer_load_dwordx4 v[72:75], v123, s[8:11], s37 offen
    s_add_u32 s36, s36, 131072
    s_add_u32 s37, s36, 8388608
    buffer_load_dwordx4 v[68:71], v123, s[8:11], s36 offen
    buffer_load_dwordx4 v[76:79], v123, s[8:11], s37 offen
    v_mov_b32 v0, 99456
    v_mov_b32 v2, 0
    v_mov_b32 v3, 0
    ds_write_b64 v0, v[2:3]
    s_add_u32 s12, s30, s33
    s_addc_u32 s13, s31, 0
    s_add_u32 s40, s30, s34
    s_addc_u32 s41, s31, 0
    s_lshl_b32 s38, s21, 10
    s_add_u32 s38, s38, 16384
    buffer_load_dwordx4 v[80:83], v126, s[40:43], s38 offen
    s_waitcnt lgkmcnt(0)
    s_barrier
    s_lshl_b32 s35, s2, 17
    s_add_u32 s16, s28, s35
    s_addc_u32 s17, s29, 0
    s_mov_b32 s18, 131072
    s_mov_b32 s19, 0x00020000
    s_mov_b32 s46, 0xbdd2d3e8
    s_mov_b32 s47, s46
    v_mov_b32 v120, 0xc0135761
    v_mov_b32 v121, v120
    s_mov_b32 s48, 1.0
    s_mov_b32 s49, 1.0
    v_bfe_u32 v123, v127, 2, 3
    v_lshl_add_u32 v124, v123, 2, v124
    v_mul_u32_u24 v124, 528, v124
    v_and_b32 v123, 0x30, v126
    s_lshl_b32 s36, s21, 6
    v_add3_u32 v124, v124, v123, s36
    s_mov_b32 s45, 0xffff0000
    s_mul_i32 s36, s21, 1040
    s_add_u32 s36, s36, 91136
    v_add_u32 v123, s36, v126
    s_mov_b32 s22, 2
    s_waitcnt vmcnt(3)
L_joint_kernel_floop:
    v_lshlrev_b32 v88, 16, v64
    v_and_b32 v89, s45, v64
    v_lshlrev_b32 v96, 16, v72
    v_and_b32 v97, s45, v72
    v_lshlrev_b32 v90, 16, v65
    v_and_b32 v91, s45, v65
    v_lshlrev_b32 v98, 16, v73
    v_and_b32 v99, s45, v73
    v_lshlrev_b32 v92, 16, v66
    v_and_b32 v93, s45, v66
    v_lshlrev_b32 v100, 16, v74
    v_and_b32 v101, s45, v74
    v_lshlrev_b32 v94, 16, v67
    v_and_b32 v95, s45, v67
    v_lshlrev_b32 v102, 16, v75
    v_and_b32 v103, s45, v75
    v_pk_add_f32 v[88:89], v[88:89], v[96:97]
    v_pk_add_f32 v[90:91], v[90:91], v[98:99]
    v_pk_add_f32 v[92:93], v[92:93], v[100:101]
    v_pk_add_f32 v[94:95], v[94:95], v[102:103]
    v_pk_mul_f32 v[96:97], v[88:89], v[88:89]
    v_pk_mul_f32 v[98:99], v[90:91], v[90:91]
    v_pk_mul_f32 v[100:101], v[92:93], v[92:93]
    v_pk_mul_f32 v[102:103], v[94:95], v[94:95]
    v_pk_fma_f32 v[96:97], v[96:97], s[46:47], v[120:121]
    v_pk_fma_f32 v[98:99], v[98:99], s[46:47], v[120:121]
    v_pk_fma_f32 v[100:101], v[100:101], s[46:47], v[120:121]
    v_pk_fma_f32 v[102:103], v[102:103], s[46:47], v[120:121]
    v_pk_mul_f32 v[96:97], v[96:97], v[88:89]
    v_pk_mul_f32 v[98:99], v[98:99], v[90:91]
    v_pk_mul_f32 v[100:101], v[100:101], v[92:93]
    v_pk_mul_f32 v[102:103], v[102:103], v[94:95]
    v_exp_f32 v96, v96
    v_exp_f32 v97, v97
    v_exp_f32 v98, v98
    v_exp_f32 v99, v99
    v_exp_f32 v100, v100
    v_exp_f32 v101, v101
    v_exp_f32 v102, v102
    v_exp_f32 v103, v103
    v_pk_add_f32 v[96:97], v[96:97], s[48:49]
    v_pk_add_f32 v[98:99], v[98:99], s[48:49]
    v_pk_add_f32 v[100:101], v[100:101], s[48:49]
    v_pk_add_f32 v[102:103], v[102:103], s[48:49]
    v_rcp_f32 v96, v96
    v_rcp_f32 v97, v97
    v_rcp_f32 v98, v98
    v_rcp_f32 v99, v99
    v_rcp_f32 v100, v100
    v_rcp_f32 v101, v101
    v_rcp_f32 v102, v102
    v_rcp_f32 v103, v103
    v_pk_mul_f32 v[88:89], v[88:89], v[96:97]
    v_pk_mul_f32 v[90:91], v[90:91], v[98:99]
    v_pk_mul_f32 v[92:93], v[92:93], v[100:101]
    v_pk_mul_f32 v[94:95], v[94:95], v[102:103]
    v_cvt_pk_bf16_f32 v104, v88, v89
    v_cvt_pk_bf16_f32 v105, v90, v91
    v_cvt_pk_bf16_f32 v106, v92, v93
    v_cvt_pk_bf16_f32 v107, v94, v95
    ds_write_b128 v124, v[104:107] offset:32768
    s_waitcnt vmcnt(0)
    v_pk_mov_b32 v[64:65], v[68:69], v[68:69] op_sel:[0,1]
    v_pk_mov_b32 v[72:73], v[76:77], v[76:77] op_sel:[0,1]
    v_pk_mov_b32 v[66:67], v[70:71], v[70:71] op_sel:[0,1]
    v_pk_mov_b32 v[74:75], v[78:79], v[78:79] op_sel:[0,1]
    v_add_u32 v124, 1056, v124
    s_sub_u32 s22, s22, 1
    s_cmp_lg_u32 s22, 0
    s_cbranch_scc1 L_joint_kernel_floop
    ds_write_b128 v123, v[80:83]
    s_waitcnt lgkmcnt(0)
    v_mov_b32 v120, 99456
    v_mov_b32 v121, 1
    s_mov_b64 exec, 1
    ds_add_u32 v120, v121 offset:0
    s_mov_b64 exec, -1
L_joint_kernel_ow:
    ds_read_b32 v121, v120 offset:4
    s_waitcnt lgkmcnt(0)
    v_readfirstlane_b32 s37, v121
    s_cmp_ge_u32 s37, 8
    s_cbranch_scc1 L_joint_kernel_ow_d
    s_sleep 1
    s_branch L_joint_kernel_ow
L_joint_kernel_ow_d:
    s_mov_b32 s36, 0
    buffer_load_dwordx4 v[0:3], v126, s[12:15], s36 offen offset:0
    buffer_load_dwordx4 v[4:7], v126, s[12:15], s36 offen offset:1024
    buffer_load_dwordx4 v[8:11], v126, s[12:15], s36 offen offset:2048
    buffer_load_dwordx4 v[12:15], v126, s[12:15], s36 offen offset:3072
    s_mov_b32 s36, 4096
    buffer_load_dwordx4 v[16:19], v126, s[12:15], s36 offen offset:0
    buffer_load_dwordx4 v[20:23], v126, s[12:15], s36 offen offset:1024
    buffer_load_dwordx4 v[24:27], v126, s[12:15], s36 offen offset:2048
    buffer_load_dwordx4 v[28:31], v126, s[12:15], s36 offen offset:3072
    s_mov_b32 s36, 8192
    buffer_load_dwordx4 v[32:35], v126, s[12:15], s36 offen offset:0
    buffer_load_dwordx4 v[36:39], v126, s[12:15], s36 offen offset:1024
    buffer_load_dwordx4 v[40:43], v126, s[12:15], s36 offen offset:2048
    buffer_load_dwordx4 v[44:47], v126, s[12:15], s36 offen offset:3072
    s_mov_b32 s36, 12288
    buffer_load_dwordx4 v[48:51], v126, s[12:15], s36 offen offset:0
    buffer_load_dwordx4 v[52:55], v126, s[12:15], s36 offen offset:1024
    buffer_load_dwordx4 v[56:59], v126, s[12:15], s36 offen offset:2048
    buffer_load_dwordx4 v[60:63], v126, s[12:15], s36 offen offset:3072
    v_lshrrev_b32 v125, 4, v127
    v_lshlrev_b32 v125, 11, v125
    v_and_b32 v124, 15, v127
    v_lshl_add_u32 v125, v124, 2, v125
    s_lshl_b32 s36, s21, 6
    v_add_u32 v125, s36, v125
    s_mov_b32 s44, 8192
    s_setprio 1
    s_barrier
    ds_read_b128 v[96:99], v126 offset:0
    ds_read_b128 v[100:103], v126 offset:1024
    ds_read_b128 v[104:107], v126 offset:2048
    ds_read_b128 v[108:111], v126 offset:3072
    s_waitcnt vmcnt(14) lgkmcnt(3)
    v_mfma_f32_16x16x32_bf16 v[64:67], v[96:99], v[0:3], 0
    v_mfma_f32_16x16x32_bf16 v[68:71], v[96:99], v[4:7], 0
    ds_read_b128 v[96:99], v126 offset:4096
    s_waitcnt lgkmcnt(3)
    v_mfma_f32_16x16x32_bf16 v[72:75], v[100:103], v[0:3], 0
    v_mfma_f32_16x16x32_bf16 v[76:79], v[100:103], v[4:7], 0
    ds_read_b128 v[100:103], v126 offset:5120
    s_waitcnt vmcnt(12) lgkmcnt(3)
    v_mfma_f32_16x16x32_bf16 v[64:67], v[104:107], v[8:11], v[64:67]
    v_mfma_f32_16x16x32_bf16 v[68:71], v[104:107], v[12:15], v[68:71]
    ds_read_b128 v[104:107], v126 offset:6144
    s_waitcnt lgkmcnt(3)
    v_mfma_f32_16x16x32_bf16 v[72:75], v[108:111], v[8:11], v[72:75]
    v_mfma_f32_16x16x32_bf16 v[76:79], v[108:111], v[12:15], v[76:79]
    ds_read_b128 v[108:111], v126 offset:7168
    s_waitcnt vmcnt(10) lgkmcnt(3)
    v_mfma_f32_16x16x32_bf16 v[64:67], v[96:99], v[16:19], v[64:67]
    v_mfma_f32_16x16x32_bf16 v[68:71], v[96:99], v[20:23], v[68:71]
    ds_read_b128 v[96:99], v126 offset:8192
    s_waitcnt lgkmcnt(3)
    v_mfma_f32_16x16x32_bf16 v[72:75], v[100:103], v[16:19], v[72:75]
    v_mfma_f32_16x16x32_bf16 v[76:79], v[100:103], v[20:23], v[76:79]
    ds_read_b128 v[100:103], v126 offset:9216
    s_waitcnt vmcnt(8) lgkmcnt(3)
    v_mfma_f32_16x16x32_bf16 v[64:67], v[104:107], v[24:27], v[64:67]
    v_mfma_f32_16x16x32_bf16 v[68:71], v[104:107], v[28:31], v[68:71]
    ds_read_b128 v[104:107], v126 offset:10240
    s_waitcnt lgkmcnt(3)
    v_mfma_f32_16x16x32_bf16 v[72:75], v[108:111], v[24:27], v[72:75]
    v_mfma_f32_16x16x32_bf16 v[76:79], v[108:111], v[28:31], v[76:79]
    ds_read_b128 v[108:111], v126 offset:11264
    s_waitcnt vmcnt(6) lgkmcnt(3)
    v_mfma_f32_16x16x32_bf16 v[64:67], v[96:99], v[32:35], v[64:67]
    v_mfma_f32_16x16x32_bf16 v[68:71], v[96:99], v[36:39], v[68:71]
    ds_read_b128 v[96:99], v126 offset:12288
    s_waitcnt lgkmcnt(3)
    v_mfma_f32_16x16x32_bf16 v[72:75], v[100:103], v[32:35], v[72:75]
    v_mfma_f32_16x16x32_bf16 v[76:79], v[100:103], v[36:39], v[76:79]
    ds_read_b128 v[100:103], v126 offset:13312
    s_waitcnt vmcnt(4) lgkmcnt(3)
    v_mfma_f32_16x16x32_bf16 v[64:67], v[104:107], v[40:43], v[64:67]
    v_mfma_f32_16x16x32_bf16 v[68:71], v[104:107], v[44:47], v[68:71]
    ds_read_b128 v[104:107], v126 offset:14336
    s_waitcnt lgkmcnt(3)
    v_mfma_f32_16x16x32_bf16 v[72:75], v[108:111], v[40:43], v[72:75]
    v_mfma_f32_16x16x32_bf16 v[76:79], v[108:111], v[44:47], v[76:79]
    ds_read_b128 v[108:111], v126 offset:15360
    s_waitcnt vmcnt(2) lgkmcnt(3)
    v_mfma_f32_16x16x32_bf16 v[64:67], v[96:99], v[48:51], v[64:67]
    v_mfma_f32_16x16x32_bf16 v[68:71], v[96:99], v[52:55], v[68:71]
    s_waitcnt lgkmcnt(0)
    s_barrier
    ds_read_b128 v[96:99], v126 offset:16384
    v_mfma_f32_16x16x32_bf16 v[72:75], v[100:103], v[48:51], v[72:75]
    v_mfma_f32_16x16x32_bf16 v[76:79], v[100:103], v[52:55], v[76:79]
    ds_read_b128 v[100:103], v126 offset:17408
    s_waitcnt vmcnt(0)
    v_mfma_f32_16x16x32_bf16 v[64:67], v[104:107], v[56:59], v[64:67]
    v_mfma_f32_16x16x32_bf16 v[68:71], v[104:107], v[60:63], v[68:71]
    ds_read_b128 v[104:107], v126 offset:18432
    v_mfma_f32_16x16x32_bf16 v[72:75], v[108:111], v[56:59], v[72:75]
    v_mfma_f32_16x16x32_bf16 v[76:79], v[108:111], v[60:63], v[76:79]
    ds_read_b128 v[108:111], v126 offset:19456
    s_mov_b32 s22, 4
L_joint_kernel_oloop:
    s_waitcnt lgkmcnt(3)
    v_mfma_f32_16x16x32_bf16 v[80:83], v[96:99], v[0:3], 0
    v_mfma_f32_16x16x32_bf16 v[84:87], v[96:99], v[4:7], 0
    ds_read_b128 v[96:99], v126 offset:20480
    s_waitcnt lgkmcnt(3)
    v_mfma_f32_16x16x32_bf16 v[88:91], v[100:103], v[0:3], 0
    v_mfma_f32_16x16x32_bf16 v[92:95], v[100:103], v[4:7], 0
    ds_read_b128 v[100:103], v126 offset:21504
    s_waitcnt lgkmcnt(3)
    v_mfma_f32_16x16x32_bf16 v[80:83], v[104:107], v[8:11], v[80:83]
    v_mfma_f32_16x16x32_bf16 v[84:87], v[104:107], v[12:15], v[84:87]
    ds_read_b128 v[104:107], v126 offset:22528
    s_waitcnt lgkmcnt(3)
    v_mfma_f32_16x16x32_bf16 v[88:91], v[108:111], v[8:11], v[88:91]
    v_cvt_pk_bf16_f32 v112, v64, v68
    v_mfma_f32_16x16x32_bf16 v[92:95], v[108:111], v[12:15], v[92:95]
    buffer_store_dword v112, v125, s[16:19], 0 offen offset:0 nt
    ds_read_b128 v[108:111], v126 offset:23552
    s_waitcnt lgkmcnt(3)
    v_mfma_f32_16x16x32_bf16 v[80:83], v[96:99], v[16:19], v[80:83]
    v_cvt_pk_bf16_f32 v113, v65, v69
    v_mfma_f32_16x16x32_bf16 v[84:87], v[96:99], v[20:23], v[84:87]
    buffer_store_dword v113, v125, s[16:19], 0 offen offset:512 nt
    ds_read_b128 v[96:99], v126 offset:24576
    s_waitcnt lgkmcnt(3)
    v_mfma_f32_16x16x32_bf16 v[88:91], v[100:103], v[16:19], v[88:91]
    v_cvt_pk_bf16_f32 v114, v66, v70
    v_mfma_f32_16x16x32_bf16 v[92:95], v[100:103], v[20:23], v[92:95]
    buffer_store_dword v114, v125, s[16:19], 0 offen offset:1024 nt
    ds_read_b128 v[100:103], v126 offset:25600
    s_waitcnt lgkmcnt(3)
    v_mfma_f32_16x16x32_bf16 v[80:83], v[104:107], v[24:27], v[80:83]
    v_cvt_pk_bf16_f32 v115, v67, v71
    v_mfma_f32_16x16x32_bf16 v[84:87], v[104:107], v[28:31], v[84:87]
    buffer_store_dword v115, v125, s[16:19], 0 offen offset:1536 nt
    ds_read_b128 v[104:107], v126 offset:26624
    s_waitcnt lgkmcnt(3)
    v_mfma_f32_16x16x32_bf16 v[88:91], v[108:111], v[24:27], v[88:91]
    v_cvt_pk_bf16_f32 v116, v72, v76
    v_mfma_f32_16x16x32_bf16 v[92:95], v[108:111], v[28:31], v[92:95]
    buffer_store_dword v116, v125, s[16:19], s44 offen offset:0 nt
    ds_read_b128 v[108:111], v126 offset:27648
    s_waitcnt lgkmcnt(3)
    v_mfma_f32_16x16x32_bf16 v[80:83], v[96:99], v[32:35], v[80:83]
    v_cvt_pk_bf16_f32 v117, v73, v77
    v_mfma_f32_16x16x32_bf16 v[84:87], v[96:99], v[36:39], v[84:87]
    buffer_store_dword v117, v125, s[16:19], s44 offen offset:512 nt
    ds_read_b128 v[96:99], v126 offset:28672
    s_waitcnt lgkmcnt(3)
    v_mfma_f32_16x16x32_bf16 v[88:91], v[100:103], v[32:35], v[88:91]
    v_cvt_pk_bf16_f32 v118, v74, v78
    v_mfma_f32_16x16x32_bf16 v[92:95], v[100:103], v[36:39], v[92:95]
    buffer_store_dword v118, v125, s[16:19], s44 offen offset:1024 nt
    ds_read_b128 v[100:103], v126 offset:29696
    s_waitcnt lgkmcnt(3)
    v_mfma_f32_16x16x32_bf16 v[80:83], v[104:107], v[40:43], v[80:83]
    v_cvt_pk_bf16_f32 v119, v75, v79
    v_mfma_f32_16x16x32_bf16 v[84:87], v[104:107], v[44:47], v[84:87]
    buffer_store_dword v119, v125, s[16:19], s44 offen offset:1536 nt
    ds_read_b128 v[104:107], v126 offset:30720
    s_waitcnt lgkmcnt(3)
    v_mfma_f32_16x16x32_bf16 v[88:91], v[108:111], v[40:43], v[88:91]
    v_add_u32 v125, 16384, v125
    v_mfma_f32_16x16x32_bf16 v[92:95], v[108:111], v[44:47], v[92:95]
    ds_read_b128 v[108:111], v126 offset:31744
    s_waitcnt lgkmcnt(3)
    v_mfma_f32_16x16x32_bf16 v[80:83], v[96:99], v[48:51], v[80:83]
    v_mfma_f32_16x16x32_bf16 v[84:87], v[96:99], v[52:55], v[84:87]
    s_waitcnt lgkmcnt(0)
    s_barrier
    ds_read_b128 v[96:99], v126 offset:0
    v_mfma_f32_16x16x32_bf16 v[88:91], v[100:103], v[48:51], v[88:91]
    v_mfma_f32_16x16x32_bf16 v[92:95], v[100:103], v[52:55], v[92:95]
    ds_read_b128 v[100:103], v126 offset:1024
    v_mfma_f32_16x16x32_bf16 v[80:83], v[104:107], v[56:59], v[80:83]
    v_mfma_f32_16x16x32_bf16 v[84:87], v[104:107], v[60:63], v[84:87]
    ds_read_b128 v[104:107], v126 offset:2048
    v_mfma_f32_16x16x32_bf16 v[88:91], v[108:111], v[56:59], v[88:91]
    v_mfma_f32_16x16x32_bf16 v[92:95], v[108:111], v[60:63], v[92:95]
    ds_read_b128 v[108:111], v126 offset:3072
    s_sub_u32 s22, s22, 1
    s_cmp_eq_u32 s22, 0
    s_cbranch_scc1 L_joint_kernel_oend
    s_waitcnt lgkmcnt(3)
    v_mfma_f32_16x16x32_bf16 v[64:67], v[96:99], v[0:3], 0
    v_mfma_f32_16x16x32_bf16 v[68:71], v[96:99], v[4:7], 0
    ds_read_b128 v[96:99], v126 offset:4096
    s_waitcnt lgkmcnt(3)
    v_mfma_f32_16x16x32_bf16 v[72:75], v[100:103], v[0:3], 0
    v_mfma_f32_16x16x32_bf16 v[76:79], v[100:103], v[4:7], 0
    ds_read_b128 v[100:103], v126 offset:5120
    s_waitcnt lgkmcnt(3)
    v_mfma_f32_16x16x32_bf16 v[64:67], v[104:107], v[8:11], v[64:67]
    v_mfma_f32_16x16x32_bf16 v[68:71], v[104:107], v[12:15], v[68:71]
    ds_read_b128 v[104:107], v126 offset:6144
    s_waitcnt lgkmcnt(3)
    v_mfma_f32_16x16x32_bf16 v[72:75], v[108:111], v[8:11], v[72:75]
    v_cvt_pk_bf16_f32 v112, v80, v84
    v_mfma_f32_16x16x32_bf16 v[76:79], v[108:111], v[12:15], v[76:79]
    buffer_store_dword v112, v125, s[16:19], 0 offen offset:0 nt
    ds_read_b128 v[108:111], v126 offset:7168
    s_waitcnt lgkmcnt(3)
    v_mfma_f32_16x16x32_bf16 v[64:67], v[96:99], v[16:19], v[64:67]
    v_cvt_pk_bf16_f32 v113, v81, v85
    v_mfma_f32_16x16x32_bf16 v[68:71], v[96:99], v[20:23], v[68:71]
    buffer_store_dword v113, v125, s[16:19], 0 offen offset:512 nt
    ds_read_b128 v[96:99], v126 offset:8192
    s_waitcnt lgkmcnt(3)
    v_mfma_f32_16x16x32_bf16 v[72:75], v[100:103], v[16:19], v[72:75]
    v_cvt_pk_bf16_f32 v114, v82, v86
    v_mfma_f32_16x16x32_bf16 v[76:79], v[100:103], v[20:23], v[76:79]
    buffer_store_dword v114, v125, s[16:19], 0 offen offset:1024 nt
    ds_read_b128 v[100:103], v126 offset:9216
    s_waitcnt lgkmcnt(3)
    v_mfma_f32_16x16x32_bf16 v[64:67], v[104:107], v[24:27], v[64:67]
    v_cvt_pk_bf16_f32 v115, v83, v87
    v_mfma_f32_16x16x32_bf16 v[68:71], v[104:107], v[28:31], v[68:71]
    buffer_store_dword v115, v125, s[16:19], 0 offen offset:1536 nt
    ds_read_b128 v[104:107], v126 offset:10240
    s_waitcnt lgkmcnt(3)
    v_mfma_f32_16x16x32_bf16 v[72:75], v[108:111], v[24:27], v[72:75]
    v_cvt_pk_bf16_f32 v116, v88, v92
    v_mfma_f32_16x16x32_bf16 v[76:79], v[108:111], v[28:31], v[76:79]
    buffer_store_dword v116, v125, s[16:19], s44 offen offset:0 nt
    ds_read_b128 v[108:111], v126 offset:11264
    s_waitcnt lgkmcnt(3)
    v_mfma_f32_16x16x32_bf16 v[64:67], v[96:99], v[32:35], v[64:67]
    v_cvt_pk_bf16_f32 v117, v89, v93
    v_mfma_f32_16x16x32_bf16 v[68:71], v[96:99], v[36:39], v[68:71]
    buffer_store_dword v117, v125, s[16:19], s44 offen offset:512 nt
    ds_read_b128 v[96:99], v126 offset:12288
    s_waitcnt lgkmcnt(3)
    v_mfma_f32_16x16x32_bf16 v[72:75], v[100:103], v[32:35], v[72:75]
    v_cvt_pk_bf16_f32 v118, v90, v94
    v_mfma_f32_16x16x32_bf16 v[76:79], v[100:103], v[36:39], v[76:79]
    buffer_store_dword v118, v125, s[16:19], s44 offen offset:1024 nt
    ds_read_b128 v[100:103], v126 offset:13312
    s_waitcnt lgkmcnt(3)
    v_mfma_f32_16x16x32_bf16 v[64:67], v[104:107], v[40:43], v[64:67]
    v_cvt_pk_bf16_f32 v119, v91, v95
    v_mfma_f32_16x16x32_bf16 v[68:71], v[104:107], v[44:47], v[68:71]
    buffer_store_dword v119, v125, s[16:19], s44 offen offset:1536 nt
    ds_read_b128 v[104:107], v126 offset:14336
    s_waitcnt lgkmcnt(3)
    v_mfma_f32_16x16x32_bf16 v[72:75], v[108:111], v[40:43], v[72:75]
    v_add_u32 v125, 16384, v125
    v_mfma_f32_16x16x32_bf16 v[76:79], v[108:111], v[44:47], v[76:79]
    ds_read_b128 v[108:111], v126 offset:15360
    s_waitcnt lgkmcnt(3)
    v_mfma_f32_16x16x32_bf16 v[64:67], v[96:99], v[48:51], v[64:67]
    v_mfma_f32_16x16x32_bf16 v[68:71], v[96:99], v[52:55], v[68:71]
    s_waitcnt lgkmcnt(0)
    s_barrier
    ds_read_b128 v[96:99], v126 offset:16384
    v_mfma_f32_16x16x32_bf16 v[72:75], v[100:103], v[48:51], v[72:75]
    v_mfma_f32_16x16x32_bf16 v[76:79], v[100:103], v[52:55], v[76:79]
    ds_read_b128 v[100:103], v126 offset:17408
    v_mfma_f32_16x16x32_bf16 v[64:67], v[104:107], v[56:59], v[64:67]
    v_mfma_f32_16x16x32_bf16 v[68:71], v[104:107], v[60:63], v[68:71]
    ds_read_b128 v[104:107], v126 offset:18432
    v_mfma_f32_16x16x32_bf16 v[72:75], v[108:111], v[56:59], v[72:75]
    v_mfma_f32_16x16x32_bf16 v[76:79], v[108:111], v[60:63], v[76:79]
    ds_read_b128 v[108:111], v126 offset:19456
    s_waitcnt vmcnt(32)
    s_branch L_joint_kernel_oloop
L_joint_kernel_oend:
    s_nop 7
    v_cvt_pk_bf16_f32 v112, v80, v84
    buffer_store_dword v112, v125, s[16:19], 0 offen offset:0 nt
    v_cvt_pk_bf16_f32 v113, v81, v85
    buffer_store_dword v113, v125, s[16:19], 0 offen offset:512 nt
    v_cvt_pk_bf16_f32 v114, v82, v86
    buffer_store_dword v114, v125, s[16:19], 0 offen offset:1024 nt
    v_cvt_pk_bf16_f32 v115, v83, v87
    buffer_store_dword v115, v125, s[16:19], 0 offen offset:1536 nt
    v_cvt_pk_bf16_f32 v116, v88, v92
    buffer_store_dword v116, v125, s[16:19], s44 offen offset:0 nt
    v_cvt_pk_bf16_f32 v117, v89, v93
    buffer_store_dword v117, v125, s[16:19], s44 offen offset:512 nt
    v_cvt_pk_bf16_f32 v118, v90, v94
    buffer_store_dword v118, v125, s[16:19], s44 offen offset:1024 nt
    v_cvt_pk_bf16_f32 v119, v91, v95
    buffer_store_dword v119, v125, s[16:19], s44 offen offset:1536 nt
    v_add_u32 v125, 16384, v125
    s_branch L_joint_kernel_fin
L_joint_kernel_T:
    s_setprio 3
    s_waitcnt lgkmcnt(0)
    s_add_u32 s12, s30, s33
    s_addc_u32 s13, s31, 0
    s_add_u32 s40, s30, s34
    s_addc_u32 s41, s31, 0
    s_lshl_b32 s36, s21, 2
    s_add_u32 s36, s36, 44335104
    s_add_u32 s36, s30, s36
    s_addc_u32 s37, s31, 0
    s_load_dword s44, s[36:37], 0
    v_and_b32 v123, 15, v127
    v_lshrrev_b32 v121, 4, v127
    v_mul_u32_u24 v125, 528, v123
    v_lshl_add_u32 v125, v121, 4, v125
    v_lshlrev_b32 v121, 5, v121
    v_and_b32 v120, 7, v127
    v_lshl_add_u32 v124, v120, 10, v121
    s_lshl_b32 s38, s21, 7
    v_mul_u32_u24 v120, 1040, v120
    s_add_u32 s36, s38, 91136
    v_add3_u32 v120, v120, v121, s36
    s_mul_i32 s36, s21, 5184
    s_add_u32 s36, s36, 49664
    v_add_u32 v121, s36, v121
    v_mul_u32_u24 v122, 144, v123
    v_add_u32 v122, v122, v121
    v_lshrrev_b32 v123, 3, v123
    v_mul_u32_u24 v123, 144, v123
    v_add_u32 v121, v123, v121
    s_lshl_b32 s36, s21, 11
    v_add_u32 v123, s36, v126
    s_barrier
    s_mov_b32 s36, 0
    buffer_load_dwordx4 v[0:3], v126, s[12:15], s36 offen offset:0
    buffer_load_dwordx4 v[4:7], v126, s[12:15], s36 offen offset:1024
    buffer_load_dwordx4 v[8:11], v126, s[12:15], s36 offen offset:2048
    buffer_load_dwordx4 v[12:15], v126, s[12:15], s36 offen offset:3072
    s_mov_b32 s36, 4096
    buffer_load_dwordx4 v[16:19], v126, s[12:15], s36 offen offset:0
    buffer_load_dwordx4 v[20:23], v126, s[12:15], s36 offen offset:1024
    buffer_load_dwordx4 v[24:27], v126, s[12:15], s36 offen offset:2048
    buffer_load_dwordx4 v[28:31], v126, s[12:15], s36 offen offset:3072
    s_mov_b32 s36, 8192
    buffer_load_dwordx4 v[32:35], v126, s[12:15], s36 offen offset:0
    buffer_load_dwordx4 v[36:39], v126, s[12:15], s36 offen offset:1024
    buffer_load_dwordx4 v[40:43], v126, s[12:15], s36 offen offset:2048
    buffer_load_dwordx4 v[44:47], v126, s[12:15], s36 offen offset:3072
    s_mov_b32 s36, 12288
    buffer_load_dwordx4 v[48:51], v126, s[12:15], s36 offen offset:0
    buffer_load_dwordx4 v[52:55], v126, s[12:15], s36 offen offset:1024
    buffer_load_dwordx4 v[56:59], v126, s[12:15], s36 offen offset:2048
    buffer_load_dwordx4 v[60:63], v126, s[12:15], s36 offen offset:3072
    v_mov_b32 v64, 99456
    v_mov_b32 v65, 1
    s_mov_b64 exec, 1
    ds_add_u32 v64, v65 offset:4
    s_mov_b64 exec, -1
L_joint_kernel_tw:
    ds_read_b32 v65, v64 offset:0
    s_waitcnt lgkmcnt(0)
    v_readfirstlane_b32 s37, v65
    s_cmp_ge_u32 s37, 8
    s_cbranch_scc1 L_joint_kernel_tw_d
    s_sleep 1
    s_branch L_joint_kernel_tw
L_joint_kernel_tw_d:
    ds_read_b128 v[80:83], v125 offset:32768
    ds_read_b128 v[84:87], v125 offset:41216
    ds_read_b128 v[88:91], v125 offset:32832
    ds_read_b128 v[92:95], v125 offset:41280
    ds_read_b128 v[96:99], v125 offset:32896
    ds_read_b128 v[100:103], v125 offset:41344
    ds_read_b128 v[104:107], v125 offset:32960
    ds_read_b128 v[108:111], v125 offset:41408
    s_setprio 0
    s_waitcnt vmcnt(14) lgkmcnt(7)
    v_mfma_f32_16x16x32_bf16 v[64:67], v[0:3], v[80:83], 0
    v_mfma_f32_16x16x32_bf16 v[68:71], v[4:7], v[80:83], 0
    ds_read_b128 v[80:83], v125 offset:33024
    s_waitcnt lgkmcnt(7)
    v_mfma_f32_16x16x32_bf16 v[72:75], v[0:3], v[84:87], 0
    v_mfma_f32_16x16x32_bf16 v[76:79], v[4:7], v[84:87], 0
    ds_read_b128 v[84:87], v125 offset:41472
    s_waitcnt vmcnt(12) lgkmcnt(7)
    v_mfma_f32_16x16x32_bf16 v[64:67], v[8:11], v[88:91], v[64:67]
    v_mfma_f32_16x16x32_bf16 v[68:71], v[12:15], v[88:91], v[68:71]
    ds_read_b128 v[88:91], v125 offset:33088
    s_waitcnt lgkmcnt(7)
    v_mfma_f32_16x16x32_bf16 v[72:75], v[8:11], v[92:95], v[72:75]
    v_mfma_f32_16x16x32_bf16 v[76:79], v[12:15], v[92:95], v[76:79]
    ds_read_b128 v[92:95], v125 offset:41536
    s_waitcnt vmcnt(10) lgkmcnt(7)
    v_mfma_f32_16x16x32_bf16 v[64:67], v[16:19], v[96:99], v[64:67]
    v_mfma_f32_16x16x32_bf16 v[68:71], v[20:23], v[96:99], v[68:71]
    ds_read_b128 v[96:99], v125 offset:33152
    s_waitcnt lgkmcnt(7)
    v_mfma_f32_16x16x32_bf16 v[72:75], v[16:19], v[100:103], v[72:75]
    v_mfma_f32_16x16x32_bf16 v[76:79], v[20:23], v[100:103], v[76:79]
    ds_read_b128 v[100:103], v125 offset:41600
    s_waitcnt vmcnt(8) lgkmcnt(7)
    v_mfma_f32_16x16x32_bf16 v[64:67], v[24:27], v[104:107], v[64:67]
    v_mfma_f32_16x16x32_bf16 v[68:71], v[28:31], v[104:107], v[68:71]
    ds_read_b128 v[104:107], v125 offset:33216
    s_waitcnt lgkmcnt(7)
    v_mfma_f32_16x16x32_bf16 v[72:75], v[24:27], v[108:111], v[72:75]
    v_mfma_f32_16x16x32_bf16 v[76:79], v[28:31], v[108:111], v[76:79]
    ds_read_b128 v[108:111], v125 offset:41664
    s_waitcnt vmcnt(6) lgkmcnt(7)
    v_mfma_f32_16x16x32_bf16 v[64:67], v[32:35], v[80:83], v[64:67]
    v_mfma_f32_16x16x32_bf16 v[68:71], v[36:39], v[80:83], v[68:71]
    ds_read_b128 v[112:115], v120 offset:0
    s_waitcnt lgkmcnt(7)
    v_mfma_f32_16x16x32_bf16 v[72:75], v[32:35], v[84:87], v[72:75]
    v_mfma_f32_16x16x32_bf16 v[76:79], v[36:39], v[84:87], v[76:79]
    ds_read_b128 v[116:119], v120 offset:16
    s_waitcnt vmcnt(4) lgkmcnt(7)
    v_mfma_f32_16x16x32_bf16 v[64:67], v[40:43], v[88:91], v[64:67]
    v_mfma_f32_16x16x32_bf16 v[68:71], v[44:47], v[88:91], v[68:71]
    s_waitcnt lgkmcnt(6)
    v_mfma_f32_16x16x32_bf16 v[72:75], v[40:43], v[92:95], v[72:75]
    v_mfma_f32_16x16x32_bf16 v[76:79], v[44:47], v[92:95], v[76:79]
    s_waitcnt vmcnt(2) lgkmcnt(5)
    v_mfma_f32_16x16x32_bf16 v[64:67], v[48:51], v[96:99], v[64:67]
    v_mfma_f32_16x16x32_bf16 v[68:71], v[52:55], v[96:99], v[68:71]
    s_waitcnt lgkmcnt(4)
    v_mfma_f32_16x16x32_bf16 v[72:75], v[48:51], v[100:103], v[72:75]
    v_mfma_f32_16x16x32_bf16 v[76:79], v[52:55], v[100:103], v[76:79]
    s_waitcnt vmcnt(0) lgkmcnt(3)
    v_mfma_f32_16x16x32_bf16 v[64:67], v[56:59], v[104:107], v[64:67]
    v_mfma_f32_16x16x32_bf16 v[68:71], v[60:63], v[104:107], v[68:71]
    s_waitcnt lgkmcnt(2)
    v_mfma_f32_16x16x32_bf16 v[72:75], v[56:59], v[108:111], v[72:75]
    v_mfma_f32_16x16x32_bf16 v[76:79], v[60:63], v[108:111], v[76:79]
    s_mov_b32 s46, 0xffff0000
    s_mov_b32 s48, 0x4038aa3b
    s_mov_b32 s49, s48
    s_nop 3
    v_mov_b32 v28, 0
    s_waitcnt lgkmcnt(0)
    v_cvt_pk_bf16_f32 v24, v64, v68
    v_cvt_pk_bf16_f32 v25, v65, v69
    v_cvt_pk_bf16_f32 v26, v66, v70
    v_cvt_pk_bf16_f32 v27, v67, v71
    v_lshlrev_b32 v80, 16, v24
    v_and_b32 v81, s46, v24
    v_lshlrev_b32 v82, 16, v25
    v_and_b32 v83, s46, v25
    v_lshlrev_b32 v84, 16, v26
    v_and_b32 v85, s46, v26
    v_lshlrev_b32 v86, 16, v27
    v_and_b32 v87, s46, v27
    v_pk_mul_f32 v[80:81], v[80:81], s[48:49]
    v_pk_mul_f32 v[82:83], v[82:83], s[48:49]
    v_pk_mul_f32 v[84:85], v[84:85], s[48:49]
    v_pk_mul_f32 v[86:87], v[86:87], s[48:49]
    v_exp_f32 v96, v80
    v_exp_f32 v97, v81
    v_exp_f32 v98, v82
    v_exp_f32 v99, v83
    v_max3_f32 v28, |v80|, |v81|, v28
    v_max3_f32 v28, |v82|, |v83|, v28
    ds_write_b128 v122, v[96:99] offset:0
    v_exp_f32 v100, v84
    v_exp_f32 v101, v85
    v_exp_f32 v102, v86
    v_exp_f32 v103, v87
    v_max3_f32 v28, |v84|, |v85|, v28
    v_max3_f32 v28, |v86|, |v87|, v28
    ds_write_b128 v122, v[100:103] offset:16
    v_cvt_pk_bf16_f32 v24, v72, v76
    v_cvt_pk_bf16_f32 v25, v73, v77
    v_cvt_pk_bf16_f32 v26, v74, v78
    v_cvt_pk_bf16_f32 v27, v75, v79
    v_lshlrev_b32 v88, 16, v24
    v_and_b32 v89, s46, v24
    v_lshlrev_b32 v90, 16, v25
    v_and_b32 v91, s46, v25
    v_lshlrev_b32 v92, 16, v26
    v_and_b32 v93, s46, v26
    v_lshlrev_b32 v94, 16, v27
    v_and_b32 v95, s46, v27
    v_pk_mul_f32 v[88:89], v[88:89], s[48:49]
    v_pk_mul_f32 v[90:91], v[90:91], s[48:49]
    v_pk_mul_f32 v[92:93], v[92:93], s[48:49]
    v_pk_mul_f32 v[94:95], v[94:95], s[48:49]
    v_exp_f32 v104, v88
    v_exp_f32 v105, v89
    v_exp_f32 v106, v90
    v_exp_f32 v107, v91
    v_max3_f32 v28, |v88|, |v89|, v28
    v_max3_f32 v28, |v90|, |v91|, v28
    ds_write_b128 v122, v[104:107] offset:2304
    v_exp_f32 v108, v92
    v_exp_f32 v109, v93
    v_exp_f32 v110, v94
    v_exp_f32 v111, v95
    v_max3_f32 v28, |v92|, |v93|, v28
    v_max3_f32 v28, |v94|, |v95|, v28
    ds_write_b128 v122, v[108:111] offset:2320
    v_cmp_lt_f32 vcc, 0x42f00000, v28
    s_mov_b32 s22, 4
    s_or_b32 s44, s44, vcc_lo
    s_or_b32 s44, s44, vcc_hi
    s_cmp_lg_u32 s44, 0
    s_cbranch_scc1 L_joint_kernel_tslow
    ds_read_b128 v[32:35], v121 offset:0
    ds_read_b128 v[36:39], v121 offset:16
    ds_read_b128 v[40:43], v121 offset:288
    ds_read_b128 v[44:47], v121 offset:304
    v_add_u32 v121, 576, v121
    s_waitcnt vmcnt(0) lgkmcnt(0)
L_joint_kernel_tloop1:
    v_fma_f32 v48, v112, v32, 1.0
    v_fma_f32 v49, v113, v33, 1.0
    v_fma_f32 v50, v114, v34, 1.0
    v_fma_f32 v51, v115, v35, 1.0
    v_fma_f32 v52, v116, v36, 1.0
    v_fma_f32 v53, v117, v37, 1.0
    v_fma_f32 v54, v118, v38, 1.0
    v_fma_f32 v55, v119, v39, 1.0
    v_fma_f32 v56, v112, v40, 1.0
    v_fma_f32 v57, v113, v41, 1.0
    v_fma_f32 v58, v114, v42, 1.0
    v_fma_f32 v59, v115, v43, 1.0
    v_fma_f32 v60, v116, v44, 1.0
    v_fma_f32 v61, v117, v45, 1.0
    v_fma_f32 v62, v118, v46, 1.0
    v_fma_f32 v63, v119, v47, 1.0
    ds_read_b128 v[32:35], v121 offset:0
    ds_read_b128 v[36:39], v121 offset:16
    ds_read_b128 v[40:43], v121 offset:288
    ds_read_b128 v[44:47], v121 offset:304
    v_add_u32 v121, 576, v121
    v_rcp_f32 v48, v48
    v_rcp_f32 v49, v49
    v_rcp_f32 v50, v50
    v_rcp_f32 v51, v51
    v_rcp_f32 v52, v52
    v_rcp_f32 v53, v53
    v_rcp_f32 v54, v54
    v_rcp_f32 v55, v55
    v_fma_f32 v48, v48, -2.0, 1.0
    v_fma_f32 v49, v49, -2.0, 1.0
    v_fma_f32 v50, v50, -2.0, 1.0
    v_fma_f32 v51, v51, -2.0, 1.0
    v_fma_f32 v52, v52, -2.0, 1.0
    v_fma_f32 v53, v53, -2.0, 1.0
    v_fma_f32 v54, v54, -2.0, 1.0
    v_fma_f32 v55, v55, -2.0, 1.0
    v_cvt_pk_bf16_f32 v64, v48, v49
    v_cvt_pk_bf16_f32 v65, v50, v51
    v_cvt_pk_bf16_f32 v66, v52, v53
    v_cvt_pk_bf16_f32 v67, v54, v55
    ds_write_b128 v123, v[64:67] offset:0
    v_rcp_f32 v56, v56
    v_rcp_f32 v57, v57
    v_rcp_f32 v58, v58
    v_rcp_f32 v59, v59
    v_rcp_f32 v60, v60
    v_rcp_f32 v61, v61
    v_rcp_f32 v62, v62
    v_rcp_f32 v63, v63
    v_fma_f32 v56, v56, -2.0, 1.0
    v_fma_f32 v57, v57, -2.0, 1.0
    v_fma_f32 v58, v58, -2.0, 1.0
    v_fma_f32 v59, v59, -2.0, 1.0
    v_fma_f32 v60, v60, -2.0, 1.0
    v_fma_f32 v61, v61, -2.0, 1.0
    v_fma_f32 v62, v62, -2.0, 1.0
    v_fma_f32 v63, v63, -2.0, 1.0
    v_cvt_pk_bf16_f32 v68, v56, v57
    v_cvt_pk_bf16_f32 v69, v58, v59
    v_cvt_pk_bf16_f32 v70, v60, v61
    v_cvt_pk_bf16_f32 v71, v62, v63
    ds_write_b128 v123, v[68:71] offset:1024
    s_waitcnt lgkmcnt(0)
    s_barrier
    v_fma_f32 v48, v112, v32, 1.0
    v_fma_f32 v49, v113, v33, 1.0
    v_fma_f32 v50, v114, v34, 1.0
    v_fma_f32 v51, v115, v35, 1.0
    v_fma_f32 v52, v116, v36, 1.0
    v_fma_f32 v53, v117, v37, 1.0
    v_fma_f32 v54, v118, v38, 1.0
    v_fma_f32 v55, v119, v39, 1.0
    v_fma_f32 v56, v112, v40, 1.0
    v_fma_f32 v57, v113, v41, 1.0
    v_fma_f32 v58, v114, v42, 1.0
    v_fma_f32 v59, v115, v43, 1.0
    v_fma_f32 v60, v116, v44, 1.0
    v_fma_f32 v61, v117, v45, 1.0
    v_fma_f32 v62, v118, v46, 1.0
    v_fma_f32 v63, v119, v47, 1.0
    ds_read_b128 v[32:35], v121 offset:0
    ds_read_b128 v[36:39], v121 offset:16
    ds_read_b128 v[40:43], v121 offset:288
    ds_read_b128 v[44:47], v121 offset:304
    v_add_u32 v121, 576, v121
    v_rcp_f32 v48, v48
    v_rcp_f32 v49, v49
    v_rcp_f32 v50, v50
    v_rcp_f32 v51, v51
    v_rcp_f32 v52, v52
    v_rcp_f32 v53, v53
    v_rcp_f32 v54, v54
    v_rcp_f32 v55, v55
    v_fma_f32 v48, v48, -2.0, 1.0
    v_fma_f32 v49, v49, -2.0, 1.0
    v_fma_f32 v50, v50, -2.0, 1.0
    v_fma_f32 v51, v51, -2.0, 1.0
    v_fma_f32 v52, v52, -2.0, 1.0
    v_fma_f32 v53, v53, -2.0, 1.0
    v_fma_f32 v54, v54, -2.0, 1.0
    v_fma_f32 v55, v55, -2.0, 1.0
    v_cvt_pk_bf16_f32 v64, v48, v49
    v_cvt_pk_bf16_f32 v65, v50, v51
    v_cvt_pk_bf16_f32 v66, v52, v53
    v_cvt_pk_bf16_f32 v67, v54, v55
    ds_write_b128 v123, v[64:67] offset:16384
    v_rcp_f32 v56, v56
    v_rcp_f32 v57, v57
    v_rcp_f32 v58, v58
    v_rcp_f32 v59, v59
    v_rcp_f32 v60, v60
    v_rcp_f32 v61, v61
    v_rcp_f32 v62, v62
    v_rcp_f32 v63, v63
    v_fma_f32 v56, v56, -2.0, 1.0
    v_fma_f32 v57, v57, -2.0, 1.0
    v_fma_f32 v58, v58, -2.0, 1.0
    v_fma_f32 v59, v59, -2.0, 1.0
    v_fma_f32 v60, v60, -2.0, 1.0
    v_fma_f32 v61, v61, -2.0, 1.0
    v_fma_f32 v62, v62, -2.0, 1.0
    v_fma_f32 v63, v63, -2.0, 1.0
    v_cvt_pk_bf16_f32 v68, v56, v57
    v_cvt_pk_bf16_f32 v69, v58, v59
    v_cvt_pk_bf16_f32 v70, v60, v61
    v_cvt_pk_bf16_f32 v71, v62, v63
    ds_write_b128 v123, v[68:71] offset:17408
    s_waitcnt lgkmcnt(0)
    s_barrier
    s_sub_u32 s22, s22, 1
    s_cmp_lg_u32 s22, 0
    s_cbranch_scc1 L_joint_kernel_tloop1
    s_branch L_joint_kernel_fin
L_joint_kernel_tslow:
    buffer_load_dwordx4 v[112:115], v124, s[40:43], s38 offen offset:0
    buffer_load_dwordx4 v[116:119], v124, s[40:43], s38 offen offset:16
    ds_write_b128 v122, v[80:83] offset:0
    ds_write_b128 v122, v[84:87] offset:16
    ds_write_b128 v122, v[88:91] offset:2304
    ds_write_b128 v122, v[92:95] offset:2320
    ds_read_b128 v[32:35], v121 offset:0
    ds_read_b128 v[36:39], v121 offset:16
    ds_read_b128 v[40:43], v121 offset:288
    ds_read_b128 v[44:47], v121 offset:304
    v_add_u32 v121, 576, v121
    s_waitcnt vmcnt(0) lgkmcnt(0)
L_joint_kernel_tloop0:
    v_add_f32 v48, v112, v32
    v_add_f32 v49, v113, v33
    v_add_f32 v50, v114, v34
    v_add_f32 v51, v115, v35
    v_add_f32 v52, v116, v36
    v_add_f32 v53, v117, v37
    v_add_f32 v54, v118, v38
    v_add_f32 v55, v119, v39
    v_add_f32 v56, v112, v40
    v_add_f32 v57, v113, v41
    v_add_f32 v58, v114, v42
    v_add_f32 v59, v115, v43
    v_add_f32 v60, v116, v44
    v_add_f32 v61, v117, v45
    v_add_f32 v62, v118, v46
    v_add_f32 v63, v119, v47
    ds_read_b128 v[32:35], v121 offset:0
    ds_read_b128 v[36:39], v121 offset:16
    ds_read_b128 v[40:43], v121 offset:288
    ds_read_b128 v[44:47], v121 offset:304
    v_add_u32 v121, 576, v121
    v_exp_f32 v48, v48
    v_exp_f32 v49, v49
    v_exp_f32 v50, v50
    v_exp_f32 v51, v51
    v_exp_f32 v52, v52
    v_exp_f32 v53, v53
    v_exp_f32 v54, v54
    v_exp_f32 v55, v55
    v_add_f32 v48, 1.0, v48
    v_add_f32 v49, 1.0, v49
    v_add_f32 v50, 1.0, v50
    v_add_f32 v51, 1.0, v51
    v_add_f32 v52, 1.0, v52
    v_add_f32 v53, 1.0, v53
    v_add_f32 v54, 1.0, v54
    v_add_f32 v55, 1.0, v55
    v_rcp_f32 v48, v48
    v_rcp_f32 v49, v49
    v_rcp_f32 v50, v50
    v_rcp_f32 v51, v51
    v_rcp_f32 v52, v52
    v_rcp_f32 v53, v53
    v_rcp_f32 v54, v54
    v_rcp_f32 v55, v55
    v_fma_f32 v48, v48, -2.0, 1.0
    v_fma_f32 v49, v49, -2.0, 1.0
    v_fma_f32 v50, v50, -2.0, 1.0
    v_fma_f32 v51, v51, -2.0, 1.0
    v_fma_f32 v52, v52, -2.0, 1.0
    v_fma_f32 v53, v53, -2.0, 1.0
    v_fma_f32 v54, v54, -2.0, 1.0
    v_fma_f32 v55, v55, -2.0, 1.0
    v_cvt_pk_bf16_f32 v64, v48, v49
    v_cvt_pk_bf16_f32 v65, v50, v51
    v_cvt_pk_bf16_f32 v66, v52, v53
    v_cvt_pk_bf16_f32 v67, v54, v55
    ds_write_b128 v123, v[64:67] offset:0
    v_exp_f32 v56, v56
    v_exp_f32 v57, v57
    v_exp_f32 v58, v58
    v_exp_f32 v59, v59
    v_exp_f32 v60, v60
    v_exp_f32 v61, v61
    v_exp_f32 v62, v62
    v_exp_f32 v63, v63
    v_add_f32 v56, 1.0, v56
    v_add_f32 v57, 1.0, v57
    v_add_f32 v58, 1.0, v58
    v_add_f32 v59, 1.0, v59
    v_add_f32 v60, 1.0, v60
    v_add_f32 v61, 1.0, v61
    v_add_f32 v62, 1.0, v62
    v_add_f32 v63, 1.0, v63
    v_rcp_f32 v56, v56
    v_rcp_f32 v57, v57
    v_rcp_f32 v58, v58
    v_rcp_f32 v59, v59
    v_rcp_f32 v60, v60
    v_rcp_f32 v61, v61
    v_rcp_f32 v62, v62
    v_rcp_f32 v63, v63
    v_fma_f32 v56, v56, -2.0, 1.0
    v_fma_f32 v57, v57, -2.0, 1.0
    v_fma_f32 v58, v58, -2.0, 1.0
    v_fma_f32 v59, v59, -2.0, 1.0
    v_fma_f32 v60, v60, -2.0, 1.0
    v_fma_f32 v61, v61, -2.0, 1.0
    v_fma_f32 v62, v62, -2.0, 1.0
    v_fma_f32 v63, v63, -2.0, 1.0
    v_cvt_pk_bf16_f32 v68, v56, v57
    v_cvt_pk_bf16_f32 v69, v58, v59
    v_cvt_pk_bf16_f32 v70, v60, v61
    v_cvt_pk_bf16_f32 v71, v62, v63
    ds_write_b128 v123, v[68:71] offset:1024
    s_waitcnt lgkmcnt(0)
    s_barrier
    v_add_f32 v48, v112, v32
    v_add_f32 v49, v113, v33
    v_add_f32 v50, v114, v34
    v_add_f32 v51, v115, v35
    v_add_f32 v52, v116, v36
    v_add_f32 v53, v117, v37
    v_add_f32 v54, v118, v38
    v_add_f32 v55, v119, v39
    v_add_f32 v56, v112, v40
    v_add_f32 v57, v113, v41
    v_add_f32 v58, v114, v42
    v_add_f32 v59, v115, v43
    v_add_f32 v60, v116, v44
    v_add_f32 v61, v117, v45
    v_add_f32 v62, v118, v46
    v_add_f32 v63, v119, v47
    ds_read_b128 v[32:35], v121 offset:0
    ds_read_b128 v[36:39], v121 offset:16
    ds_read_b128 v[40:43], v121 offset:288
    ds_read_b128 v[44:47], v121 offset:304
    v_add_u32 v121, 576, v121
    v_exp_f32 v48, v48
    v_exp_f32 v49, v49
    v_exp_f32 v50, v50
    v_exp_f32 v51, v51
    v_exp_f32 v52, v52
    v_exp_f32 v53, v53
    v_exp_f32 v54, v54
    v_exp_f32 v55, v55
    v_add_f32 v48, 1.0, v48
    v_add_f32 v49, 1.0, v49
    v_add_f32 v50, 1.0, v50
    v_add_f32 v51, 1.0, v51
    v_add_f32 v52, 1.0, v52
    v_add_f32 v53, 1.0, v53
    v_add_f32 v54, 1.0, v54
    v_add_f32 v55, 1.0, v55
    v_rcp_f32 v48, v48
    v_rcp_f32 v49, v49
    v_rcp_f32 v50, v50
    v_rcp_f32 v51, v51
    v_rcp_f32 v52, v52
    v_rcp_f32 v53, v53
    v_rcp_f32 v54, v54
    v_rcp_f32 v55, v55
    v_fma_f32 v48, v48, -2.0, 1.0
    v_fma_f32 v49, v49, -2.0, 1.0
    v_fma_f32 v50, v50, -2.0, 1.0
    v_fma_f32 v51, v51, -2.0, 1.0
    v_fma_f32 v52, v52, -2.0, 1.0
    v_fma_f32 v53, v53, -2.0, 1.0
    v_fma_f32 v54, v54, -2.0, 1.0
    v_fma_f32 v55, v55, -2.0, 1.0
    v_cvt_pk_bf16_f32 v64, v48, v49
    v_cvt_pk_bf16_f32 v65, v50, v51
    v_cvt_pk_bf16_f32 v66, v52, v53
    v_cvt_pk_bf16_f32 v67, v54, v55
    ds_write_b128 v123, v[64:67] offset:16384
    v_exp_f32 v56, v56
    v_exp_f32 v57, v57
    v_exp_f32 v58, v58
    v_exp_f32 v59, v59
    v_exp_f32 v60, v60
    v_exp_f32 v61, v61
    v_exp_f32 v62, v62
    v_exp_f32 v63, v63
    v_add_f32 v56, 1.0, v56
    v_add_f32 v57, 1.0, v57
    v_add_f32 v58, 1.0, v58
    v_add_f32 v59, 1.0, v59
    v_add_f32 v60, 1.0, v60
    v_add_f32 v61, 1.0, v61
    v_add_f32 v62, 1.0, v62
    v_add_f32 v63, 1.0, v63
    v_rcp_f32 v56, v56
    v_rcp_f32 v57, v57
    v_rcp_f32 v58, v58
    v_rcp_f32 v59, v59
    v_rcp_f32 v60, v60
    v_rcp_f32 v61, v61
    v_rcp_f32 v62, v62
    v_rcp_f32 v63, v63
    v_fma_f32 v56, v56, -2.0, 1.0
    v_fma_f32 v57, v57, -2.0, 1.0
    v_fma_f32 v58, v58, -2.0, 1.0
    v_fma_f32 v59, v59, -2.0, 1.0
    v_fma_f32 v60, v60, -2.0, 1.0
    v_fma_f32 v61, v61, -2.0, 1.0
    v_fma_f32 v62, v62, -2.0, 1.0
    v_fma_f32 v63, v63, -2.0, 1.0
    v_cvt_pk_bf16_f32 v68, v56, v57
    v_cvt_pk_bf16_f32 v69, v58, v59
    v_cvt_pk_bf16_f32 v70, v60, v61
    v_cvt_pk_bf16_f32 v71, v62, v63
    ds_write_b128 v123, v[68:71] offset:17408
    s_waitcnt lgkmcnt(0)
    s_barrier
    s_sub_u32 s22, s22, 1
    s_cmp_lg_u32 s22, 0
    s_cbranch_scc1 L_joint_kernel_tloop0
L_joint_kernel_fin:
L_joint_kernel_done:
    s_endpgm
.section .rodata,"a"
.p2align 6
.amdhsa_kernel prep_kernel
  .amdhsa_next_free_vgpr 128
  .amdhsa_next_free_sgpr 102
  .amdhsa_accum_offset 128
  .amdhsa_group_segment_fixed_size 0
  .amdhsa_kernarg_size 80
  .amdhsa_user_sgpr_count 2
  .amdhsa_user_sgpr_kernarg_segment_ptr 1
  .amdhsa_system_sgpr_workgroup_id_x 1
.end_amdhsa_kernel
.p2align 6
.amdhsa_kernel conv1_kernel
  .amdhsa_next_free_vgpr 128
  .amdhsa_next_free_sgpr 102
  .amdhsa_accum_offset 128
  .amdhsa_group_segment_fixed_size 0
  .amdhsa_kernarg_size 80
  .amdhsa_user_sgpr_count 2
  .amdhsa_user_sgpr_kernarg_segment_ptr 1
  .amdhsa_system_sgpr_workgroup_id_x 1
.end_amdhsa_kernel
.p2align 6
.amdhsa_kernel conv2_kernel
  .amdhsa_next_free_vgpr 128
  .amdhsa_next_free_sgpr 102
  .amdhsa_accum_offset 128
  .amdhsa_group_segment_fixed_size 0
  .amdhsa_kernarg_size 80
  .amdhsa_user_sgpr_count 2
  .amdhsa_user_sgpr_kernarg_segment_ptr 1
  .amdhsa_system_sgpr_workgroup_id_x 1
.end_amdhsa_kernel
.p2align 6
.amdhsa_kernel joint_kernel
  .amdhsa_next_free_vgpr 128
  .amdhsa_next_free_sgpr 102
  .amdhsa_accum_offset 128
  .amdhsa_group_segment_fixed_size 0
  .amdhsa_kernarg_size 80
  .amdhsa_user_sgpr_count 2
  .amdhsa_user_sgpr_kernarg_segment_ptr 1
  .amdhsa_system_sgpr_workgroup_id_x 1
.end_amdhsa_kernel
```

```asm
; @launch kernel=prep_kernel grid=(256,1,1) block=(384,1,1) lds=4096
; @launch kernel=conv1_kernel grid=(256,1,1) block=(1024,1,1) lds=162816
; @launch kernel=conv2_kernel grid=(256,1,1) block=(1024,1,1) lds=162816
; @launch kernel=joint_kernel grid=(250,1,1) block=(1024,1,1) lds=99472
.amdgcn_target "amdgcn-amd-amdhsa--gfx950"
.text
.globl prep_kernel
.p2align 8
.type prep_kernel,@function
prep_kernel:
    s_cmp_ge_u32 s2, 256
    s_cbranch_scc1 L_prep_kernel_done
    s_mov_b32 s3, s2
    s_load_dwordx16 s[44:59], s[0:1], 0
    s_load_dwordx2 s[30:31], s[0:1], 72
    v_readfirstlane_b32 s40, v0
    s_lshr_b32 s40, s40, 6
    v_and_b32 v1, 63, v0
    s_cmp_lt_u32 s40, 4
    s_cbranch_scc1 L_prep_kernel_w
    s_cmp_ge_u32 s2, 24
    s_cbranch_scc1 L_prep_kernel_done
    s_lshr_b32 s41, s2, 3
    s_and_b32 s42, s2, 7
    s_sub_u32 s43, s40, 4
    s_lshl_b32 s26, s43, 16
    s_lshl_b32 s5, s42, 6
    s_add_u32 s26, s26, s5
    s_mov_b32 s10, 131072
    s_mov_b32 s11, 0x00020000
    v_lshrrev_b32 v2, 4, v1
    v_lshlrev_b32 v2, 12, v2
    v_and_b32 v3, 15, v1
    v_lshl_add_u32 v2, v3, 2, v2
    v_mov_b32 v9, 0
    ds_write_b32 v9, v9 offset:2048
    s_waitcnt lgkmcnt(0)
    s_cmp_eq_u32 s41, 1
    s_cselect_b32 s8, s56, s52
    s_cselect_b32 s9, s57, s53
    s_cmp_eq_u32 s41, 2
    s_cselect_b32 s8, s54, s8
    s_cselect_b32 s9, s55, s9
    s_barrier
    s_cmp_lg_u32 s41, 2
    s_cbranch_scc1 L_prep_kernel_nog
    s_mov_b32 s16, s50
    s_mov_b32 s17, s51
    s_mov_b32 s18, 8192
    s_mov_b32 s19, 0x00020000
    v_and_b32 v6, 0x30, v1
    v_lshl_add_u32 v6, v3, 9, v6
    s_lshl_b32 s6, s43, 8
    buffer_load_dwordx4 v[80:83], v6, s[16:19], s6 offen offset:0
    buffer_load_dwordx4 v[84:87], v6, s[16:19], s6 offen offset:64
    buffer_load_dwordx4 v[88:91], v6, s[16:19], s6 offen offset:128
    buffer_load_dwordx4 v[92:95], v6, s[16:19], s6 offen offset:192
L_prep_kernel_nog:
    buffer_load_dword v16, v2, s[8:11], s26 offen offset:0
    buffer_load_dword v17, v2, s[8:11], s26 offen offset:512
    buffer_load_dword v18, v2, s[8:11], s26 offen offset:1024
    buffer_load_dword v19, v2, s[8:11], s26 offen offset:1536
    buffer_load_dword v20, v2, s[8:11], s26 offen offset:2048
    buffer_load_dword v21, v2, s[8:11], s26 offen offset:2560
    buffer_load_dword v22, v2, s[8:11], s26 offen offset:3072
    buffer_load_dword v23, v2, s[8:11], s26 offen offset:3584
    s_add_u32 s26, s26, 16384
    buffer_load_dword v24, v2, s[8:11], s26 offen offset:0
    buffer_load_dword v25, v2, s[8:11], s26 offen offset:512
    buffer_load_dword v26, v2, s[8:11], s26 offen offset:1024
    buffer_load_dword v27, v2, s[8:11], s26 offen offset:1536
    buffer_load_dword v28, v2, s[8:11], s26 offen offset:2048
    buffer_load_dword v29, v2, s[8:11], s26 offen offset:2560
    buffer_load_dword v30, v2, s[8:11], s26 offen offset:3072
    buffer_load_dword v31, v2, s[8:11], s26 offen offset:3584
    s_add_u32 s26, s26, 16384
    buffer_load_dword v32, v2, s[8:11], s26 offen offset:0
    buffer_load_dword v33, v2, s[8:11], s26 offen offset:512
    buffer_load_dword v34, v2, s[8:11], s26 offen offset:1024
    buffer_load_dword v35, v2, s[8:11], s26 offen offset:1536
    buffer_load_dword v36, v2, s[8:11], s26 offen offset:2048
    buffer_load_dword v37, v2, s[8:11], s26 offen offset:2560
    buffer_load_dword v38, v2, s[8:11], s26 offen offset:3072
    buffer_load_dword v39, v2, s[8:11], s26 offen offset:3584
    s_add_u32 s26, s26, 16384
    buffer_load_dword v40, v2, s[8:11], s26 offen offset:0
    buffer_load_dword v41, v2, s[8:11], s26 offen offset:512
    buffer_load_dword v42, v2, s[8:11], s26 offen offset:1024
    buffer_load_dword v43, v2, s[8:11], s26 offen offset:1536
    buffer_load_dword v44, v2, s[8:11], s26 offen offset:2048
    buffer_load_dword v45, v2, s[8:11], s26 offen offset:2560
    buffer_load_dword v46, v2, s[8:11], s26 offen offset:3072
    buffer_load_dword v47, v2, s[8:11], s26 offen offset:3584
    s_branch L_prep_kernel_small
L_prep_kernel_w:
    s_lshl_b32 s21, s2, 2
    s_add_u32 s20, s40, s21
    s_load_dwordx2 s[8:9], s[0:1], 8
    s_lshr_b32 s22, s20, 8
    s_bfe_u32 s23, s20, 0x40004
    s_bfe_u32 s24, s20, 0x30001
    s_and_b32 s21, s20, 1
    v_lshrrev_b32 v5, 4, v1
    v_lshlrev_b32 v2, 11, v5
    v_and_b32 v3, 15, v1
    v_lshl_add_u32 v2, v3, 2, v2
    s_lshl_b32 s26, s22, 3
    s_lshr_b32 s27, s23, 3
    s_add_u32 s26, s26, s27
    s_lshl_b32 s26, s26, 17
    s_and_b32 s27, s23, 7
    s_lshl_b32 s27, s27, 1
    s_add_u32 s27, s27, s21
    s_lshl_b32 s27, s27, 13
    s_add_u32 s26, s26, s27
    s_lshl_b32 s27, s24, 6
    s_add_u32 s26, s26, s27
    s_mov_b32 s10, 4063232
    s_mov_b32 s11, 0x00020000
    s_add_u32 s37, s26, 262144
    s_add_u32 s38, s26, 524288
    s_add_u32 s39, s26, 786432
    s_mov_b32 s14, 7340032
    s_mov_b32 s15, 0x00020000
    v_lshrrev_b32 v4, 1, v5
    v_lshlrev_b32 v4, 8, v4
    v_lshl_add_u32 v4, v3, 4, v4
    v_and_b32 v5, 1, v5
    v_lshl_add_u32 v4, v5, 10, v4
    s_lshl_b32 s27, s24, 4
    s_add_u32 s27, s27, s23
    s_mul_i32 s27, s27, 57344
    s_lshl_b32 s28, s22, 11
    s_add_u32 s27, s27, s28
    s_lshl_b32 s28, s21, 9
    s_add_u32 s27, s27, s28
    s_mov_b32 s32, 0x05040100
    s_mov_b32 s33, 0x07060302
    s_mov_b32 s34, 0xffff0000
    s_mov_b32 s35, 0x3d2aaaab
    s_mov_b32 s40, 0x3c638e39
    s_waitcnt lgkmcnt(0)
    buffer_load_dword v16, v2, s[8:11], s26 offen offset:0
    buffer_load_dword v17, v2, s[8:11], s26 offen offset:512
    buffer_load_dword v20, v2, s[8:11], s37 offen offset:0
    buffer_load_dword v21, v2, s[8:11], s37 offen offset:512
    buffer_load_dword v24, v2, s[8:11], s38 offen offset:0
    buffer_load_dword v25, v2, s[8:11], s38 offen offset:512
    buffer_load_dword v28, v2, s[8:11], s39 offen offset:0
    buffer_load_dword v29, v2, s[8:11], s39 offen offset:512
    buffer_load_dword v18, v2, s[8:11], s26 offen offset:1024
    buffer_load_dword v19, v2, s[8:11], s26 offen offset:1536
    buffer_load_dword v22, v2, s[8:11], s37 offen offset:1024
    buffer_load_dword v23, v2, s[8:11], s37 offen offset:1536
    buffer_load_dword v26, v2, s[8:11], s38 offen offset:1024
    buffer_load_dword v27, v2, s[8:11], s38 offen offset:1536
    buffer_load_dword v30, v2, s[8:11], s39 offen offset:1024
    buffer_load_dword v31, v2, s[8:11], s39 offen offset:1536
    s_barrier
    s_add_u32 s12, s30, 0
    s_addc_u32 s13, s31, 0
    s_waitcnt vmcnt(8)
    v_perm_b32 v100, v17, v16, s32
    v_perm_b32 v76, v29, v28, s32
    v_lshlrev_b32 v104, 16, v28
    v_lshlrev_b32 v112, 16, v29
    v_lshlrev_b32 v105, 16, v24
    v_lshlrev_b32 v113, 16, v25
    v_lshlrev_b32 v106, 16, v20
    v_lshlrev_b32 v114, 16, v21
    v_lshlrev_b32 v107, 16, v16
    v_lshlrev_b32 v115, 16, v17
    v_add_f32 v108, v104, v106
    v_add_f32 v116, v112, v114
    v_add_f32 v109, v105, v107
    v_add_f32 v117, v113, v115
    v_fma_f32 v110, v106, 4.0, v104
    v_fma_f32 v118, v114, 4.0, v112
    v_fma_f32 v111, v107, 4.0, v105
    v_fma_f32 v119, v115, 4.0, v113
    v_add_f32 v105, v108, v109
    v_add_f32 v113, v116, v117
    v_sub_f32 v106, v108, v109
    v_sub_f32 v114, v116, v117
    v_fma_f32 v107, v111, 2.0, v110
    v_fma_f32 v115, v119, 2.0, v118
    v_fma_f32 v110, v111, -2.0, v110
    v_fma_f32 v118, v119, -2.0, v118
    v_fmamk_f32 v108, v104, 0x41700000, v110
    v_fmamk_f32 v116, v112, 0x41700000, v118
    v_fmamk_f32 v108, v109, 0x41200000, v108
    v_fmamk_f32 v116, v117, 0x41200000, v116
    v_mul_f32 v105, 0.5, v105
    v_mul_f32 v113, 0.5, v113
    v_mul_f32 v106, 0.5, v106
    v_mul_f32 v114, 0.5, v114
    v_mul_f32 v107, s35, v107
    v_mul_f32 v115, s35, v115
    v_mul_f32 v110, s35, v110
    v_mul_f32 v118, s35, v118
    v_mul_f32 v108, s40, v108
    v_mul_f32 v116, s40, v116
    v_cvt_pk_bf16_f32 v80, v105, v113
    v_cvt_pk_bf16_f32 v84, v106, v114
    v_cvt_pk_bf16_f32 v88, v107, v115
    v_cvt_pk_bf16_f32 v92, v110, v118
    v_cvt_pk_bf16_f32 v96, v108, v116
    v_perm_b32 v102, v17, v16, s33
    v_perm_b32 v78, v29, v28, s33
    v_and_b32 v104, s34, v28
    v_and_b32 v112, s34, v29
    v_and_b32 v105, s34, v24
    v_and_b32 v113, s34, v25
    v_and_b32 v106, s34, v20
    v_and_b32 v114, s34, v21
    v_and_b32 v107, s34, v16
    v_and_b32 v115, s34, v17
    v_add_f32 v108, v104, v106
    v_add_f32 v116, v112, v114
    v_add_f32 v109, v105, v107
    v_add_f32 v117, v113, v115
    v_fma_f32 v110, v106, 4.0, v104
    v_fma_f32 v118, v114, 4.0, v112
    v_fma_f32 v111, v107, 4.0, v105
    v_fma_f32 v119, v115, 4.0, v113
    v_add_f32 v105, v108, v109
    v_add_f32 v113, v116, v117
    v_sub_f32 v106, v108, v109
    v_sub_f32 v114, v116, v117
    v_fma_f32 v107, v111, 2.0, v110
    v_fma_f32 v115, v119, 2.0, v118
    v_fma_f32 v110, v111, -2.0, v110
    v_fma_f32 v118, v119, -2.0, v118
    v_fmamk_f32 v108, v104, 0x41700000, v110
    v_fmamk_f32 v116, v112, 0x41700000, v118
    v_fmamk_f32 v108, v109, 0x41200000, v108
    v_fmamk_f32 v116, v117, 0x41200000, v116
    v_mul_f32 v105, 0.5, v105
    v_mul_f32 v113, 0.5, v113
    v_mul_f32 v106, 0.5, v106
    v_mul_f32 v114, 0.5, v114
    v_mul_f32 v107, s35, v107
    v_mul_f32 v115, s35, v115
    v_mul_f32 v110, s35, v110
    v_mul_f32 v118, s35, v118
    v_mul_f32 v108, s40, v108
    v_mul_f32 v116, s40, v116
    v_cvt_pk_bf16_f32 v82, v105, v113
    v_cvt_pk_bf16_f32 v86, v106, v114
    v_cvt_pk_bf16_f32 v90, v107, v115
    v_cvt_pk_bf16_f32 v94, v110, v118
    v_cvt_pk_bf16_f32 v98, v108, v116
    s_waitcnt vmcnt(0)
    s_cmp_lt_u32 s3, 224
    s_cbranch_scc1 L_prep_kernel_ncw
    s_getpc_b64 s[62:63]
L_prep_kernel_pc:
    s_and_b32 s64, s3, 8
    s_lshl_b32 s64, s64, 12
    v_lshlrev_b32 v120, 7, v0
    v_add_u32 v120, s64, v120
    v_min_u32 v120, L_joint_kernel_done-L_prep_kernel_pc, v120
    v_mov_b32 v121, s63
    v_add_co_u32 v120, vcc, s62, v120
    s_nop 1
    v_addc_co_u32 v121, vcc, 0, v121, vcc
    global_load_dword v122, v[120:121], off
L_prep_kernel_ncw:
    v_perm_b32 v101, v19, v18, s32
    v_perm_b32 v77, v31, v30, s32
    v_lshlrev_b32 v104, 16, v30
    v_lshlrev_b32 v112, 16, v31
    v_lshlrev_b32 v105, 16, v26
    v_lshlrev_b32 v113, 16, v27
    v_lshlrev_b32 v106, 16, v22
    v_lshlrev_b32 v114, 16, v23
    v_lshlrev_b32 v107, 16, v18
    v_lshlrev_b32 v115, 16, v19
    v_add_f32 v108, v104, v106
    v_add_f32 v116, v112, v114
    v_add_f32 v109, v105, v107
    v_add_f32 v117, v113, v115
    v_fma_f32 v110, v106, 4.0, v104
    v_fma_f32 v118, v114, 4.0, v112
    v_fma_f32 v111, v107, 4.0, v105
    v_fma_f32 v119, v115, 4.0, v113
    v_add_f32 v105, v108, v109
    v_add_f32 v113, v116, v117
    v_sub_f32 v106, v108, v109
    v_sub_f32 v114, v116, v117
    v_fma_f32 v107, v111, 2.0, v110
    v_fma_f32 v115, v119, 2.0, v118
    v_fma_f32 v110, v111, -2.0, v110
    v_fma_f32 v118, v119, -2.0, v118
    v_fmamk_f32 v108, v104, 0x41700000, v110
    v_fmamk_f32 v116, v112, 0x41700000, v118
    v_fmamk_f32 v108, v109, 0x41200000, v108
    v_fmamk_f32 v116, v117, 0x41200000, v116
    v_mul_f32 v105, 0.5, v105
    v_mul_f32 v113, 0.5, v113
    v_mul_f32 v106, 0.5, v106
    v_mul_f32 v114, 0.5, v114
    v_mul_f32 v107, s35, v107
    v_mul_f32 v115, s35, v115
    v_mul_f32 v110, s35, v110
    v_mul_f32 v118, s35, v118
    v_mul_f32 v108, s40, v108
    v_mul_f32 v116, s40, v116
    v_cvt_pk_bf16_f32 v81, v105, v113
    v_cvt_pk_bf16_f32 v85, v106, v114
    v_cvt_pk_bf16_f32 v89, v107, v115
    v_cvt_pk_bf16_f32 v93, v110, v118
    v_cvt_pk_bf16_f32 v97, v108, v116
    v_perm_b32 v103, v19, v18, s33
    v_perm_b32 v79, v31, v30, s33
    v_and_b32 v104, s34, v30
    v_and_b32 v112, s34, v31
    v_and_b32 v105, s34, v26
    v_and_b32 v113, s34, v27
    v_and_b32 v106, s34, v22
    v_and_b32 v114, s34, v23
    v_and_b32 v107, s34, v18
    v_and_b32 v115, s34, v19
    v_add_f32 v108, v104, v106
    v_add_f32 v116, v112, v114
    v_add_f32 v109, v105, v107
    v_add_f32 v117, v113, v115
    v_fma_f32 v110, v106, 4.0, v104
    v_fma_f32 v118, v114, 4.0, v112
    v_fma_f32 v111, v107, 4.0, v105
    v_fma_f32 v119, v115, 4.0, v113
    v_add_f32 v105, v108, v109
    v_add_f32 v113, v116, v117
    v_sub_f32 v106, v108, v109
    v_sub_f32 v114, v116, v117
    v_fma_f32 v107, v111, 2.0, v110
    v_fma_f32 v115, v119, 2.0, v118
    v_fma_f32 v110, v111, -2.0, v110
    v_fma_f32 v118, v119, -2.0, v118
    v_fmamk_f32 v108, v104, 0x41700000, v110
    v_fmamk_f32 v116, v112, 0x41700000, v118
    v_fmamk_f32 v108, v109, 0x41200000, v108
    v_fmamk_f32 v116, v117, 0x41200000, v116
    v_mul_f32 v105, 0.5, v105
    v_mul_f32 v113, 0.5, v113
    v_mul_f32 v106, 0.5, v106
    v_mul_f32 v114, 0.5, v114
    v_mul_f32 v107, s35, v107
    v_mul_f32 v115, s35, v115
    v_mul_f32 v110, s35, v110
    v_mul_f32 v118, s35, v118
    v_mul_f32 v108, s40, v108
    v_mul_f32 v116, s40, v116
    v_cvt_pk_bf16_f32 v83, v105, v113
    v_cvt_pk_bf16_f32 v87, v106, v114
    v_cvt_pk_bf16_f32 v91, v107, v115
    v_cvt_pk_bf16_f32 v95, v110, v118
    v_cvt_pk_bf16_f32 v99, v108, v116
    v_permlane16_swap_b32 v100, v102
    v_permlane16_swap_b32 v101, v103
    s_add_u32 s28, s27, 49152
    buffer_store_dwordx4 v[100:103], v4, s[12:15], s28 offen sc1
    v_permlane16_swap_b32 v76, v78
    v_permlane16_swap_b32 v77, v79
    s_add_u32 s28, s27, 0
    buffer_store_dwordx4 v[76:79], v4, s[12:15], s28 offen sc1
    v_permlane16_swap_b32 v80, v82
    v_permlane16_swap_b32 v81, v83
    s_add_u32 s28, s27, 8192
    buffer_store_dwordx4 v[80:83], v4, s[12:15], s28 offen sc1
    v_permlane16_swap_b32 v84, v86
    v_permlane16_swap_b32 v85, v87
    s_add_u32 s28, s27, 16384
    buffer_store_dwordx4 v[84:87], v4, s[12:15], s28 offen sc1
    v_permlane16_swap_b32 v88, v90
    v_permlane16_swap_b32 v89, v91
    s_add_u32 s28, s27, 24576
    buffer_store_dwordx4 v[88:91], v4, s[12:15], s28 offen sc1
    v_permlane16_swap_b32 v92, v94
    v_permlane16_swap_b32 v93, v95
    s_add_u32 s28, s27, 32768
    buffer_store_dwordx4 v[92:95], v4, s[12:15], s28 offen sc1
    v_permlane16_swap_b32 v96, v98
    v_permlane16_swap_b32 v97, v99
    s_add_u32 s28, s27, 40960
    buffer_store_dwordx4 v[96:99], v4, s[12:15], s28 offen sc1
L_prep_kernel_done:
    s_endpgm
L_prep_kernel_small:
    v_lshrrev_b32 v2, 4, v1
    s_lshl_b32 s24, s41, 17
    s_add_u32 s24, s24, 44040192
    s_add_u32 s12, s30, s24
    s_addc_u32 s13, s31, 0
    s_mov_b32 s14, 131072
    s_mov_b32 s15, 0x00020000
    s_mov_b32 s32, 0x05040100
    s_mov_b32 s33, 0x07060302
    v_lshlrev_b32 v4, 4, v1
    s_lshl_b32 s24, s42, 14
    s_lshl_b32 s25, s43, 13
    s_add_u32 s24, s24, s25
    s_add_u32 s25, s24, 4096
    s_waitcnt vmcnt(0)
    v_perm_b32 v48, v17, v16, s32
    v_perm_b32 v49, v19, v18, s32
    v_perm_b32 v50, v21, v20, s32
    v_perm_b32 v51, v23, v22, s32
    v_perm_b32 v52, v17, v16, s33
    v_perm_b32 v53, v19, v18, s33
    v_perm_b32 v54, v21, v20, s33
    v_perm_b32 v55, v23, v22, s33
    v_perm_b32 v56, v25, v24, s32
    v_perm_b32 v57, v27, v26, s32
    v_perm_b32 v58, v29, v28, s32
    v_perm_b32 v59, v31, v30, s32
    v_perm_b32 v60, v25, v24, s33
    v_perm_b32 v61, v27, v26, s33
    v_perm_b32 v62, v29, v28, s33
    v_perm_b32 v63, v31, v30, s33
    v_perm_b32 v64, v33, v32, s32
    v_perm_b32 v65, v35, v34, s32
    v_perm_b32 v66, v37, v36, s32
    v_perm_b32 v67, v39, v38, s32
    v_perm_b32 v68, v33, v32, s33
    v_perm_b32 v69, v35, v34, s33
    v_perm_b32 v70, v37, v36, s33
    v_perm_b32 v71, v39, v38, s33
    v_perm_b32 v72, v41, v40, s32
    v_perm_b32 v73, v43, v42, s32
    v_perm_b32 v74, v45, v44, s32
    v_perm_b32 v75, v47, v46, s32
    v_perm_b32 v76, v41, v40, s33
    v_perm_b32 v77, v43, v42, s33
    v_perm_b32 v78, v45, v44, s33
    v_perm_b32 v79, v47, v46, s33
    s_cmp_eq_u32 s41, 2
    s_cbranch_scc1 L_prep_kernel_ge
    buffer_store_dwordx4 v[48:51], v4, s[12:15], s24 offen offset:0 sc1
    buffer_store_dwordx4 v[52:55], v4, s[12:15], s24 offen offset:1024 sc1
    buffer_store_dwordx4 v[56:59], v4, s[12:15], s24 offen offset:2048 sc1
    buffer_store_dwordx4 v[60:63], v4, s[12:15], s24 offen offset:3072 sc1
    buffer_store_dwordx4 v[64:67], v4, s[12:15], s25 offen offset:0 sc1
    buffer_store_dwordx4 v[68:71], v4, s[12:15], s25 offen offset:1024 sc1
    buffer_store_dwordx4 v[72:75], v4, s[12:15], s25 offen offset:2048 sc1
    buffer_store_dwordx4 v[76:79], v4, s[12:15], s25 offen offset:3072 sc1
    s_endpgm
L_prep_kernel_ge:
    v_mfma_f32_16x16x32_bf16 v[96:99], v[48:51], v[80:83], 0
    v_mfma_f32_16x16x32_bf16 v[100:103], v[52:55], v[80:83], 0
    v_mfma_f32_16x16x32_bf16 v[96:99], v[56:59], v[84:87], v[96:99]
    v_mfma_f32_16x16x32_bf16 v[100:103], v[60:63], v[84:87], v[100:103]
    v_mfma_f32_16x16x32_bf16 v[96:99], v[64:67], v[88:91], v[96:99]
    v_mfma_f32_16x16x32_bf16 v[100:103], v[68:71], v[88:91], v[100:103]
    v_mfma_f32_16x16x32_bf16 v[96:99], v[72:75], v[92:95], v[96:99]
    v_mfma_f32_16x16x32_bf16 v[100:103], v[76:79], v[92:95], v[100:103]
    v_mov_b32 v7, v4
    v_mov_b32 v10, 1
    s_nop 0
    s_mov_b32 s14, 16384
    v_lshlrev_b32 v8, 10, v3
    v_lshl_add_u32 v8, v2, 5, v8
    s_lshl_b32 s24, s42, 7
    s_mov_b32 s34, 0xffff0000
    s_mov_b32 s35, 0x4038aa3b
    s_cmp_eq_u32 s43, 0
    s_cbranch_scc1 L_prep_kernel_ge0
    ds_write_b128 v7, v[96:99]
    ds_write_b128 v7, v[100:103] offset:1024
    ds_write_b32 v9, v10 offset:2048
    s_endpgm
L_prep_kernel_ge0:
    ds_read_b32 v10, v9 offset:2048
    s_waitcnt lgkmcnt(0)
    v_readfirstlane_b32 s27, v10
    s_cmp_eq_u32 s27, 0
    s_cbranch_scc1 L_prep_kernel_ge0
    ds_read_b128 v[16:19], v7
    ds_read_b128 v[20:23], v7 offset:1024
    s_waitcnt lgkmcnt(0)
    v_add_f32 v16, v16, v96
    v_add_f32 v17, v17, v97
    v_add_f32 v18, v18, v98
    v_add_f32 v19, v19, v99
    v_add_f32 v20, v20, v100
    v_add_f32 v21, v21, v101
    v_add_f32 v22, v22, v102
    v_add_f32 v23, v23, v103
    v_cvt_pk_bf16_f32 v48, v16, v20
    v_cvt_pk_bf16_f32 v49, v17, v21
    v_cvt_pk_bf16_f32 v50, v18, v22
    v_cvt_pk_bf16_f32 v51, v19, v23
    v_lshlrev_b32 v56, 16, v48
    v_and_b32 v57, s34, v48
    v_lshlrev_b32 v58, 16, v49
    v_and_b32 v59, s34, v49
    v_lshlrev_b32 v60, 16, v50
    v_and_b32 v61, s34, v50
    v_lshlrev_b32 v62, 16, v51
    v_and_b32 v63, s34, v51
    v_mul_f32 v56, s35, v56
    v_mul_f32 v57, s35, v57
    v_mul_f32 v58, s35, v58
    v_mul_f32 v59, s35, v59
    v_mul_f32 v60, s35, v60
    v_mul_f32 v61, s35, v61
    v_mul_f32 v62, s35, v62
    v_mul_f32 v63, s35, v63
    buffer_store_dwordx4 v[56:59], v8, s[12:15], s24 offen sc1
    buffer_store_dwordx4 v[60:63], v8, s[12:15], s24 offen offset:16 sc1
    v_exp_f32 v64, v56
    v_exp_f32 v65, v57
    v_exp_f32 v66, v58
    v_exp_f32 v67, v59
    v_exp_f32 v68, v60
    v_exp_f32 v69, v61
    v_exp_f32 v70, v62
    v_exp_f32 v71, v63
    v_max3_f32 v72, |v56|, |v57|, |v58|
    v_max3_f32 v72, |v59|, |v60|, v72
    v_max3_f32 v72, |v61|, |v62|, v72
    v_max_f32 v72, |v63|, v72
    s_add_u32 s12, s12, 16384
    s_addc_u32 s13, s13, 0
    v_cmp_lt_f32 vcc, 0x42f00000, v72
    buffer_store_dwordx4 v[64:67], v8, s[12:15], s24 offen sc1
    buffer_store_dwordx4 v[68:71], v8, s[12:15], s24 offen offset:16 sc1
    s_add_u32 s12, s12, 16384
    s_addc_u32 s13, s13, 0
    s_or_b32 s26, vcc_lo, vcc_hi
    s_lshl_b32 s24, s42, 2
    v_mov_b32 v73, s26
    v_mov_b32 v74, 0
    buffer_store_dword v73, v74, s[12:15], s24 offen sc1
L_prep_kernel_last:
    s_endpgm
.globl conv1_kernel
.p2align 8
.type conv1_kernel,@function
conv1_kernel:
    s_cmp_ge_u32 s2, 256
    s_cbranch_scc1 L_conv1_kernel_done
    s_load_dwordx2 s[4:5], s[0:1], 0
    s_load_dwordx2 s[30:31], s[0:1], 72
    v_readfirstlane_b32 s20, v0
    s_lshr_b32 s20, s20, 6
    s_xor_b32 s20, s20, 8
    s_and_b32 s36, s2, 0
    s_lshl_b32 s36, s36, 3
    s_bfe_u32 s37, s2, 196611
    s_or_b32 s29, s36, s37
    s_bfe_u32 s36, s2, 196608
    s_lshl_b32 s36, s36, 2
    s_lshr_b32 s37, s2, 6
    s_or_b32 s36, s36, s37
    s_mov_b32 s33, 0
    s_and_b32 s34, s36, 15
    s_lshr_b32 s35, s36, 4
    s_mul_i32 s21, s34, 500
    s_and_b32 s32, s20, 3
    v_and_b32 v127, 63, v0
    v_lshrrev_b32 v5, 2, v127
    v_and_b32 v6, 3, v127
    s_and_b32 s42, s20, 7
    v_lshlrev_b32 v7, 15, v5
    v_lshl_add_u32 v7, v6, 4, v7
    s_lshl_b32 s41, s21, 10
    s_sub_u32 s41, s41, 7680
    s_lshl_b32 s37, s42, 12
    s_add_u32 s37, s37, s41
    v_add_u32 v7, s37, v7
    s_mul_i32 s36, s35, 8192000
    s_mov_b32 s10, 8192000
    s_mov_b32 s11, 0x00020000
    s_mov_b32 s25, 0xffff0000
    s_mov_b32 s47, s36
    s_cmp_ge_u32 s20, 8
    s_cbranch_scc0 L_conv1_kernel_mw
L_conv1_kernel_helper:
    s_setprio 3
    v_add_u32 v92, 0, v7
    v_add_u32 v93, 1024, v7
    v_add_u32 v94, 2048, v7
    v_add_u32 v95, 3072, v7
    v_and_b32 v76, 4, v5
    v_lshrrev_b32 v76, 1, v76
    v_xor_b32 v76, v6, v76
    v_lshlrev_b32 v76, 4, v76
    v_lshl_add_u32 v76, v5, 6, v76
    s_mov_b32 s24, 0
    s_mov_b32 s27, 524288
    s_waitcnt lgkmcnt(0)
    s_add_u32 s8, s4, s47
    s_addc_u32 s9, s5, 0
    buffer_load_dwordx4 v[0:3], v92, s[8:11], s24 offen offset:0
    buffer_load_dwordx4 v[16:19], v92, s[8:11], s24 offen offset:64
    v_add_u32 v92, 128, v92
    buffer_load_dwordx4 v[4:7], v93, s[8:11], s24 offen offset:0
    buffer_load_dwordx4 v[20:23], v93, s[8:11], s24 offen offset:64
    v_add_u32 v93, 128, v93
    buffer_load_dwordx4 v[8:11], v94, s[8:11], s24 offen offset:0
    buffer_load_dwordx4 v[24:27], v94, s[8:11], s24 offen offset:64
    v_add_u32 v94, 128, v94
    buffer_load_dwordx4 v[12:15], v95, s[8:11], s24 offen offset:0
    buffer_load_dwordx4 v[28:31], v95, s[8:11], s24 offen offset:64
    v_add_u32 v95, 128, v95
    s_mul_i32 s36, s42, 1024
    v_add_u32 v96, s36, v76
    v_add_u32 v97, 65536, v96
    s_mul_i32 s36, s42, 1088
    s_add_u32 s36, s36, 98304
    v_add_u32 v98, s36, v76
    s_waitcnt vmcnt(0)
    s_mov_b32 s28, 0
    s_mov_b32 s22, 4
    ds_write_b128 v96, v[0:3] offset:0
    ds_write_b128 v98, v[12:15] offset:0
    v_lshlrev_b32 v76, 16, v0
    v_and_b32 v84, s25, v0
    v_lshlrev_b32 v77, 16, v4
    v_and_b32 v85, s25, v4
    v_lshlrev_b32 v78, 16, v8
    v_and_b32 v86, s25, v8
    v_lshlrev_b32 v79, 16, v12
    v_and_b32 v87, s25, v12
    v_add_f32 v80, v76, v78
    v_add_f32 v88, v84, v86
    v_add_f32 v81, v77, v79
    v_add_f32 v89, v85, v87
    v_fma_f32 v82, v78, 4.0, v76
    v_fma_f32 v90, v86, 4.0, v84
    v_fma_f32 v83, v79, 4.0, v77
    v_fma_f32 v91, v87, 4.0, v85
    v_add_f32 v77, v80, v81
    v_add_f32 v85, v88, v89
    v_sub_f32 v78, v80, v81
    v_sub_f32 v86, v88, v89
    v_fma_f32 v79, v83, 2.0, v82
    v_fma_f32 v87, v91, 2.0, v90
    v_fma_f32 v82, v83, -2.0, v82
    v_fma_f32 v90, v91, -2.0, v90
    v_fmamk_f32 v80, v76, 0x41700000, v82
    v_fmamk_f32 v88, v84, 0x41700000, v90
    v_fmamk_f32 v80, v81, 0x41200000, v80
    v_fmamk_f32 v88, v89, 0x41200000, v88
    v_cvt_pk_bf16_f32 v4, v77, v85
    v_cvt_pk_bf16_f32 v8, v78, v86
    v_cvt_pk_bf16_f32 v64, v79, v87
    v_cvt_pk_bf16_f32 v68, v82, v90
    v_cvt_pk_bf16_f32 v72, v80, v88
    v_lshlrev_b32 v76, 16, v1
    v_and_b32 v84, s25, v1
    v_lshlrev_b32 v77, 16, v5
    v_and_b32 v85, s25, v5
    v_lshlrev_b32 v78, 16, v9
    v_and_b32 v86, s25, v9
    v_lshlrev_b32 v79, 16, v13
    v_and_b32 v87, s25, v13
    v_add_f32 v80, v76, v78
    v_add_f32 v88, v84, v86
    v_add_f32 v81, v77, v79
    v_add_f32 v89, v85, v87
    v_fma_f32 v82, v78, 4.0, v76
    v_fma_f32 v90, v86, 4.0, v84
    v_fma_f32 v83, v79, 4.0, v77
    v_fma_f32 v91, v87, 4.0, v85
    v_add_f32 v77, v80, v81
    v_add_f32 v85, v88, v89
    v_sub_f32 v78, v80, v81
    v_sub_f32 v86, v88, v89
    v_fma_f32 v79, v83, 2.0, v82
    v_fma_f32 v87, v91, 2.0, v90
    v_fma_f32 v82, v83, -2.0, v82
    v_fma_f32 v90, v91, -2.0, v90
    v_fmamk_f32 v80, v76, 0x41700000, v82
    v_fmamk_f32 v88, v84, 0x41700000, v90
    v_fmamk_f32 v80, v81, 0x41200000, v80
    v_fmamk_f32 v88, v89, 0x41200000, v88
    v_cvt_pk_bf16_f32 v5, v77, v85
    v_cvt_pk_bf16_f32 v9, v78, v86
    v_cvt_pk_bf16_f32 v65, v79, v87
    v_cvt_pk_bf16_f32 v69, v82, v90
    v_cvt_pk_bf16_f32 v73, v80, v88
    v_lshlrev_b32 v76, 16, v2
    v_and_b32 v84, s25, v2
    v_lshlrev_b32 v77, 16, v6
    v_and_b32 v85, s25, v6
    v_lshlrev_b32 v78, 16, v10
    v_and_b32 v86, s25, v10
    v_lshlrev_b32 v79, 16, v14
    v_and_b32 v87, s25, v14
    v_add_f32 v80, v76, v78
    v_add_f32 v88, v84, v86
    v_add_f32 v81, v77, v79
    v_add_f32 v89, v85, v87
    v_fma_f32 v82, v78, 4.0, v76
    v_fma_f32 v90, v86, 4.0, v84
    v_fma_f32 v83, v79, 4.0, v77
    v_fma_f32 v91, v87, 4.0, v85
    v_add_f32 v77, v80, v81
    v_add_f32 v85, v88, v89
    v_sub_f32 v78, v80, v81
    v_sub_f32 v86, v88, v89
    v_fma_f32 v79, v83, 2.0, v82
    v_fma_f32 v87, v91, 2.0, v90
    v_fma_f32 v82, v83, -2.0, v82
    v_fma_f32 v90, v91, -2.0, v90
    v_fmamk_f32 v80, v76, 0x41700000, v82
    v_fmamk_f32 v88, v84, 0x41700000, v90
    v_fmamk_f32 v80, v81, 0x41200000, v80
    v_fmamk_f32 v88, v89, 0x41200000, v88
    v_cvt_pk_bf16_f32 v6, v77, v85
    v_cvt_pk_bf16_f32 v10, v78, v86
    v_cvt_pk_bf16_f32 v66, v79, v87
    v_cvt_pk_bf16_f32 v70, v82, v90
    v_cvt_pk_bf16_f32 v74, v80, v88
    v_lshlrev_b32 v76, 16, v3
    v_and_b32 v84, s25, v3
    v_lshlrev_b32 v77, 16, v7
    v_and_b32 v85, s25, v7
    v_lshlrev_b32 v78, 16, v11
    v_and_b32 v86, s25, v11
    v_lshlrev_b32 v79, 16, v15
    v_and_b32 v87, s25, v15
    v_add_f32 v80, v76, v78
    v_add_f32 v88, v84, v86
    v_add_f32 v81, v77, v79
    v_add_f32 v89, v85, v87
    v_fma_f32 v82, v78, 4.0, v76
    v_fma_f32 v90, v86, 4.0, v84
    v_fma_f32 v83, v79, 4.0, v77
    v_fma_f32 v91, v87, 4.0, v85
    v_add_f32 v77, v80, v81
    v_add_f32 v85, v88, v89
    v_sub_f32 v78, v80, v81
    v_sub_f32 v86, v88, v89
    v_fma_f32 v79, v83, 2.0, v82
    v_fma_f32 v87, v91, 2.0, v90
    v_fma_f32 v82, v83, -2.0, v82
    v_fma_f32 v90, v91, -2.0, v90
    v_fmamk_f32 v80, v76, 0x41700000, v82
    v_fmamk_f32 v88, v84, 0x41700000, v90
    v_fmamk_f32 v80, v81, 0x41200000, v80
    v_fmamk_f32 v88, v89, 0x41200000, v88
    v_cvt_pk_bf16_f32 v7, v77, v85
    v_cvt_pk_bf16_f32 v11, v78, v86
    v_cvt_pk_bf16_f32 v67, v79, v87
    v_cvt_pk_bf16_f32 v71, v82, v90
    v_cvt_pk_bf16_f32 v75, v80, v88
    ds_write_b128 v96, v[64:67] offset:49152
    ds_write_b128 v97, v[68:71] offset:0
    ds_write_b128 v97, v[72:75] offset:16384
    ds_write_b128 v96, v[4:7] offset:16384
    ds_write_b128 v96, v[8:11] offset:32768
    s_cmp_ge_u32 s20, 12
    s_cbranch_scc1 L_conv1_kernel_h2
    s_waitcnt lgkmcnt(0)
    s_barrier
    buffer_load_dwordx4 v[32:35], v92, s[8:11], s24 offen offset:0
    buffer_load_dwordx4 v[48:51], v92, s[8:11], s24 offen offset:64
    v_add_u32 v92, 128, v92
    buffer_load_dwordx4 v[36:39], v93, s[8:11], s24 offen offset:0
    buffer_load_dwordx4 v[52:55], v93, s[8:11], s24 offen offset:64
    v_add_u32 v93, 128, v93
    s_setprio 1
L_conv1_kernel_hloop1:
    s_cmp_lt_u32 s28, 13
    s_cselect_b32 s24, 0, 2130706432
    v_lshlrev_b32 v76, 16, v16
    v_and_b32 v84, s25, v16
    v_lshlrev_b32 v77, 16, v20
    v_and_b32 v85, s25, v20
    v_lshlrev_b32 v78, 16, v24
    v_and_b32 v86, s25, v24
    v_lshlrev_b32 v79, 16, v28
    v_and_b32 v87, s25, v28
    v_add_f32 v80, v76, v78
    v_add_f32 v88, v84, v86
    v_add_f32 v81, v77, v79
    v_add_f32 v89, v85, v87
    v_fma_f32 v82, v78, 4.0, v76
    v_fma_f32 v90, v86, 4.0, v84
    v_fma_f32 v83, v79, 4.0, v77
    v_fma_f32 v91, v87, 4.0, v85
    v_add_f32 v77, v80, v81
    v_add_f32 v85, v88, v89
    v_sub_f32 v78, v80, v81
    v_sub_f32 v86, v88, v89
    v_fma_f32 v79, v83, 2.0, v82
    v_fma_f32 v87, v91, 2.0, v90
    v_fma_f32 v82, v83, -2.0, v82
    v_fma_f32 v90, v91, -2.0, v90
    v_fmamk_f32 v80, v76, 0x41700000, v82
    v_fmamk_f32 v88, v84, 0x41700000, v90
    buffer_load_dwordx4 v[40:43], v94, s[8:11], s24 offen offset:0
    buffer_load_dwordx4 v[56:59], v94, s[8:11], s24 offen offset:64
    v_add_u32 v94, 128, v94
    v_fmamk_f32 v80, v81, 0x41200000, v80
    v_fmamk_f32 v88, v89, 0x41200000, v88
    v_cvt_pk_bf16_f32 v20, v77, v85
    v_cvt_pk_bf16_f32 v24, v78, v86
    v_cvt_pk_bf16_f32 v64, v79, v87
    v_cvt_pk_bf16_f32 v68, v82, v90
    v_cvt_pk_bf16_f32 v72, v80, v88
    v_lshlrev_b32 v76, 16, v17
    v_and_b32 v84, s25, v17
    v_lshlrev_b32 v77, 16, v21
    v_and_b32 v85, s25, v21
    v_lshlrev_b32 v78, 16, v25
    v_and_b32 v86, s25, v25
    v_lshlrev_b32 v79, 16, v29
    v_and_b32 v87, s25, v29
    v_add_f32 v80, v76, v78
    v_add_f32 v88, v84, v86
    v_add_f32 v81, v77, v79
    v_add_f32 v89, v85, v87
    v_fma_f32 v82, v78, 4.0, v76
    v_fma_f32 v90, v86, 4.0, v84
    v_fma_f32 v83, v79, 4.0, v77
    v_fma_f32 v91, v87, 4.0, v85
    v_add_f32 v77, v80, v81
    v_add_f32 v85, v88, v89
    v_sub_f32 v78, v80, v81
    buffer_load_dwordx4 v[44:47], v95, s[8:11], s24 offen offset:0
    buffer_load_dwordx4 v[60:63], v95, s[8:11], s24 offen offset:64
    v_add_u32 v95, 128, v95
    v_sub_f32 v86, v88, v89
    v_fma_f32 v79, v83, 2.0, v82
    v_fma_f32 v87, v91, 2.0, v90
    v_fma_f32 v82, v83, -2.0, v82
    v_fma_f32 v90, v91, -2.0, v90
    v_fmamk_f32 v80, v76, 0x41700000, v82
    v_fmamk_f32 v88, v84, 0x41700000, v90
    v_fmamk_f32 v80, v81, 0x41200000, v80
    v_fmamk_f32 v88, v89, 0x41200000, v88
    v_cvt_pk_bf16_f32 v21, v77, v85
    v_cvt_pk_bf16_f32 v25, v78, v86
    v_cvt_pk_bf16_f32 v65, v79, v87
    v_cvt_pk_bf16_f32 v69, v82, v90
    v_cvt_pk_bf16_f32 v73, v80, v88
    v_lshlrev_b32 v76, 16, v18
    v_and_b32 v84, s25, v18
    v_lshlrev_b32 v77, 16, v22
    v_and_b32 v85, s25, v22
    v_lshlrev_b32 v78, 16, v26
    v_and_b32 v86, s25, v26
    v_lshlrev_b32 v79, 16, v30
    v_and_b32 v87, s25, v30
    v_add_f32 v80, v76, v78
    v_add_f32 v88, v84, v86
    v_add_f32 v81, v77, v79
    v_add_f32 v89, v85, v87
    v_fma_f32 v82, v78, 4.0, v76
    v_fma_f32 v90, v86, 4.0, v84
    v_fma_f32 v83, v79, 4.0, v77
    v_fma_f32 v91, v87, 4.0, v85
    v_add_f32 v77, v80, v81
    v_add_f32 v85, v88, v89
    v_sub_f32 v78, v80, v81
    v_sub_f32 v86, v88, v89
    v_fma_f32 v79, v83, 2.0, v82
    v_fma_f32 v87, v91, 2.0, v90
    v_fma_f32 v82, v83, -2.0, v82
    v_fma_f32 v90, v91, -2.0, v90
    v_fmamk_f32 v80, v76, 0x41700000, v82
    v_fmamk_f32 v88, v84, 0x41700000, v90
    v_fmamk_f32 v80, v81, 0x41200000, v80
    v_fmamk_f32 v88, v89, 0x41200000, v88
    v_cvt_pk_bf16_f32 v22, v77, v85
    v_cvt_pk_bf16_f32 v26, v78, v86
    v_cvt_pk_bf16_f32 v66, v79, v87
    v_cvt_pk_bf16_f32 v70, v82, v90
    v_cvt_pk_bf16_f32 v74, v80, v88
    v_lshlrev_b32 v76, 16, v19
    v_and_b32 v84, s25, v19
    v_lshlrev_b32 v77, 16, v23
    v_and_b32 v85, s25, v23
    v_lshlrev_b32 v78, 16, v27
    v_and_b32 v86, s25, v27
    v_lshlrev_b32 v79, 16, v31
    v_and_b32 v87, s25, v31
    v_add_f32 v80, v76, v78
    v_add_f32 v88, v84, v86
    v_add_f32 v81, v77, v79
    v_add_f32 v89, v85, v87
    v_fma_f32 v82, v78, 4.0, v76
    v_fma_f32 v90, v86, 4.0, v84
    v_fma_f32 v83, v79, 4.0, v77
    v_fma_f32 v91, v87, 4.0, v85
    v_add_f32 v77, v80, v81
    v_add_f32 v85, v88, v89
    v_sub_f32 v78, v80, v81
    v_sub_f32 v86, v88, v89
    v_fma_f32 v79, v83, 2.0, v82
    v_fma_f32 v87, v91, 2.0, v90
    v_fma_f32 v82, v83, -2.0, v82
    v_fma_f32 v90, v91, -2.0, v90
    v_fmamk_f32 v80, v76, 0x41700000, v82
    v_fmamk_f32 v88, v84, 0x41700000, v90
    v_fmamk_f32 v80, v81, 0x41200000, v80
    v_fmamk_f32 v88, v89, 0x41200000, v88
    v_cvt_pk_bf16_f32 v23, v77, v85
    v_cvt_pk_bf16_f32 v27, v78, v86
    v_cvt_pk_bf16_f32 v67, v79, v87
    v_cvt_pk_bf16_f32 v71, v82, v90
    v_cvt_pk_bf16_f32 v75, v80, v88
    ds_write_b128 v96, v[64:67] offset:57344
    ds_write_b128 v97, v[68:71] offset:8192
    ds_write_b128 v97, v[72:75] offset:24576
    ds_write_b128 v96, v[16:19] offset:8192
    ds_write_b128 v96, v[20:23] offset:24576
    ds_write_b128 v96, v[24:27] offset:40960
    ds_write_b128 v98, v[28:31] offset:8704
    s_add_u32 s28, s28, 1
    s_waitcnt lgkmcnt(0)
    s_barrier
    s_cmp_lt_u32 s28, 13
    s_cselect_b32 s24, 0, 2130706432
    s_waitcnt vmcnt(0)
    v_lshlrev_b32 v76, 16, v32
    v_and_b32 v84, s25, v32
    v_lshlrev_b32 v77, 16, v36
    v_and_b32 v85, s25, v36
    v_lshlrev_b32 v78, 16, v40
    v_and_b32 v86, s25, v40
    v_lshlrev_b32 v79, 16, v44
    v_and_b32 v87, s25, v44
    v_add_f32 v80, v76, v78
    v_add_f32 v88, v84, v86
    v_add_f32 v81, v77, v79
    v_add_f32 v89, v85, v87
    v_fma_f32 v82, v78, 4.0, v76
    v_fma_f32 v90, v86, 4.0, v84
    v_fma_f32 v83, v79, 4.0, v77
    v_fma_f32 v91, v87, 4.0, v85
    v_add_f32 v77, v80, v81
    v_add_f32 v85, v88, v89
    v_sub_f32 v78, v80, v81
    v_sub_f32 v86, v88, v89
    v_fma_f32 v79, v83, 2.0, v82
    v_fma_f32 v87, v91, 2.0, v90
    v_fma_f32 v82, v83, -2.0, v82
    v_fma_f32 v90, v91, -2.0, v90
    v_fmamk_f32 v80, v76, 0x41700000, v82
    v_fmamk_f32 v88, v84, 0x41700000, v90
    buffer_load_dwordx4 v[0:3], v92, s[8:11], s24 offen offset:0
    buffer_load_dwordx4 v[16:19], v92, s[8:11], s24 offen offset:64
    v_add_u32 v92, 128, v92
    v_fmamk_f32 v80, v81, 0x41200000, v80
    v_fmamk_f32 v88, v89, 0x41200000, v88
    v_cvt_pk_bf16_f32 v36, v77, v85
    v_cvt_pk_bf16_f32 v40, v78, v86
    v_cvt_pk_bf16_f32 v64, v79, v87
    v_cvt_pk_bf16_f32 v68, v82, v90
    v_cvt_pk_bf16_f32 v72, v80, v88
    v_lshlrev_b32 v76, 16, v33
    v_and_b32 v84, s25, v33
    v_lshlrev_b32 v77, 16, v37
    v_and_b32 v85, s25, v37
    v_lshlrev_b32 v78, 16, v41
    v_and_b32 v86, s25, v41
    v_lshlrev_b32 v79, 16, v45
    v_and_b32 v87, s25, v45
    v_add_f32 v80, v76, v78
    v_add_f32 v88, v84, v86
    v_add_f32 v81, v77, v79
    v_add_f32 v89, v85, v87
    v_fma_f32 v82, v78, 4.0, v76
    v_fma_f32 v90, v86, 4.0, v84
    v_fma_f32 v83, v79, 4.0, v77
    v_fma_f32 v91, v87, 4.0, v85
    v_add_f32 v77, v80, v81
    v_add_f32 v85, v88, v89
    v_sub_f32 v78, v80, v81
    buffer_load_dwordx4 v[4:7], v93, s[8:11], s24 offen offset:0
    buffer_load_dwordx4 v[20:23], v93, s[8:11], s24 offen offset:64
    v_add_u32 v93, 128, v93
    v_sub_f32 v86, v88, v89
    v_fma_f32 v79, v83, 2.0, v82
    v_fma_f32 v87, v91, 2.0, v90
    v_fma_f32 v82, v83, -2.0, v82
    v_fma_f32 v90, v91, -2.0, v90
    v_fmamk_f32 v80, v76, 0x41700000, v82
    v_fmamk_f32 v88, v84, 0x41700000, v90
    v_fmamk_f32 v80, v81, 0x41200000, v80
    v_fmamk_f32 v88, v89, 0x41200000, v88
    v_cvt_pk_bf16_f32 v37, v77, v85
    v_cvt_pk_bf16_f32 v41, v78, v86
    v_cvt_pk_bf16_f32 v65, v79, v87
    v_cvt_pk_bf16_f32 v69, v82, v90
    v_cvt_pk_bf16_f32 v73, v80, v88
    v_lshlrev_b32 v76, 16, v34
    v_and_b32 v84, s25, v34
    v_lshlrev_b32 v77, 16, v38
    v_and_b32 v85, s25, v38
    v_lshlrev_b32 v78, 16, v42
    v_and_b32 v86, s25, v42
    v_lshlrev_b32 v79, 16, v46
    v_and_b32 v87, s25, v46
    v_add_f32 v80, v76, v78
    v_add_f32 v88, v84, v86
    v_add_f32 v81, v77, v79
    v_add_f32 v89, v85, v87
    v_fma_f32 v82, v78, 4.0, v76
    v_fma_f32 v90, v86, 4.0, v84
    v_fma_f32 v83, v79, 4.0, v77
    v_fma_f32 v91, v87, 4.0, v85
    v_add_f32 v77, v80, v81
    v_add_f32 v85, v88, v89
    v_sub_f32 v78, v80, v81
    v_sub_f32 v86, v88, v89
    v_fma_f32 v79, v83, 2.0, v82
    v_fma_f32 v87, v91, 2.0, v90
    v_fma_f32 v82, v83, -2.0, v82
    v_fma_f32 v90, v91, -2.0, v90
    v_fmamk_f32 v80, v76, 0x41700000, v82
    v_fmamk_f32 v88, v84, 0x41700000, v90
    v_fmamk_f32 v80, v81, 0x41200000, v80
    v_fmamk_f32 v88, v89, 0x41200000, v88
    v_cvt_pk_bf16_f32 v38, v77, v85
    v_cvt_pk_bf16_f32 v42, v78, v86
    v_cvt_pk_bf16_f32 v66, v79, v87
    v_cvt_pk_bf16_f32 v70, v82, v90
    v_cvt_pk_bf16_f32 v74, v80, v88
    v_lshlrev_b32 v76, 16, v35
    v_and_b32 v84, s25, v35
    v_lshlrev_b32 v77, 16, v39
    v_and_b32 v85, s25, v39
    v_lshlrev_b32 v78, 16, v43
    v_and_b32 v86, s25, v43
    v_lshlrev_b32 v79, 16, v47
    v_and_b32 v87, s25, v47
    v_add_f32 v80, v76, v78
    v_add_f32 v88, v84, v86
    v_add_f32 v81, v77, v79
    v_add_f32 v89, v85, v87
    v_fma_f32 v82, v78, 4.0, v76
    v_fma_f32 v90, v86, 4.0, v84
    v_fma_f32 v83, v79, 4.0, v77
    v_fma_f32 v91, v87, 4.0, v85
    v_add_f32 v77, v80, v81
    v_add_f32 v85, v88, v89
    v_sub_f32 v78, v80, v81
    v_sub_f32 v86, v88, v89
    v_fma_f32 v79, v83, 2.0, v82
    v_fma_f32 v87, v91, 2.0, v90
    v_fma_f32 v82, v83, -2.0, v82
    v_fma_f32 v90, v91, -2.0, v90
    v_fmamk_f32 v80, v76, 0x41700000, v82
    v_fmamk_f32 v88, v84, 0x41700000, v90
    v_fmamk_f32 v80, v81, 0x41200000, v80
    v_fmamk_f32 v88, v89, 0x41200000, v88
    v_cvt_pk_bf16_f32 v39, v77, v85
    v_cvt_pk_bf16_f32 v43, v78, v86
    v_cvt_pk_bf16_f32 v67, v79, v87
    v_cvt_pk_bf16_f32 v71, v82, v90
    v_cvt_pk_bf16_f32 v75, v80, v88
    ds_write_b128 v96, v[64:67] offset:49152
    ds_write_b128 v97, v[68:71] offset:0
    ds_write_b128 v97, v[72:75] offset:16384
    ds_write_b128 v96, v[32:35] offset:0
    ds_write_b128 v96, v[36:39] offset:16384
    ds_write_b128 v96, v[40:43] offset:32768
    ds_write_b128 v98, v[44:47] offset:0
    s_add_u32 s28, s28, 1
    s_waitcnt lgkmcnt(0)
    s_barrier
    s_cmp_lt_u32 s28, 13
    s_cselect_b32 s24, 0, 2130706432
    v_lshlrev_b32 v76, 16, v48
    v_and_b32 v84, s25, v48
    v_lshlrev_b32 v77, 16, v52
    v_and_b32 v85, s25, v52
    v_lshlrev_b32 v78, 16, v56
    v_and_b32 v86, s25, v56
    v_lshlrev_b32 v79, 16, v60
    v_and_b32 v87, s25, v60
    v_add_f32 v80, v76, v78
    v_add_f32 v88, v84, v86
    v_add_f32 v81, v77, v79
    v_add_f32 v89, v85, v87
    v_fma_f32 v82, v78, 4.0, v76
    v_fma_f32 v90, v86, 4.0, v84
    v_fma_f32 v83, v79, 4.0, v77
    v_fma_f32 v91, v87, 4.0, v85
    v_add_f32 v77, v80, v81
    v_add_f32 v85, v88, v89
    v_sub_f32 v78, v80, v81
    v_sub_f32 v86, v88, v89
    v_fma_f32 v79, v83, 2.0, v82
    v_fma_f32 v87, v91, 2.0, v90
    v_fma_f32 v82, v83, -2.0, v82
    v_fma_f32 v90, v91, -2.0, v90
    v_fmamk_f32 v80, v76, 0x41700000, v82
    v_fmamk_f32 v88, v84, 0x41700000, v90
    buffer_load_dwordx4 v[8:11], v94, s[8:11], s24 offen offset:0
    buffer_load_dwordx4 v[24:27], v94, s[8:11], s24 offen offset:64
    v_add_u32 v94, 128, v94
    v_fmamk_f32 v80, v81, 0x41200000, v80
    v_fmamk_f32 v88, v89, 0x41200000, v88
    v_cvt_pk_bf16_f32 v52, v77, v85
    v_cvt_pk_bf16_f32 v56, v78, v86
    v_cvt_pk_bf16_f32 v64, v79, v87
    v_cvt_pk_bf16_f32 v68, v82, v90
    v_cvt_pk_bf16_f32 v72, v80, v88
    v_lshlrev_b32 v76, 16, v49
    v_and_b32 v84, s25, v49
    v_lshlrev_b32 v77, 16, v53
    v_and_b32 v85, s25, v53
    v_lshlrev_b32 v78, 16, v57
    v_and_b32 v86, s25, v57
    v_lshlrev_b32 v79, 16, v61
    v_and_b32 v87, s25, v61
    v_add_f32 v80, v76, v78
    v_add_f32 v88, v84, v86
    v_add_f32 v81, v77, v79
    v_add_f32 v89, v85, v87
    v_fma_f32 v82, v78, 4.0, v76
    v_fma_f32 v90, v86, 4.0, v84
    v_fma_f32 v83, v79, 4.0, v77
    v_fma_f32 v91, v87, 4.0, v85
    v_add_f32 v77, v80, v81
    v_add_f32 v85, v88, v89
    v_sub_f32 v78, v80, v81
    buffer_load_dwordx4 v[12:15], v95, s[8:11], s24 offen offset:0
    buffer_load_dwordx4 v[28:31], v95, s[8:11], s24 offen offset:64
    v_add_u32 v95, 128, v95
    v_sub_f32 v86, v88, v89
    v_fma_f32 v79, v83, 2.0, v82
    v_fma_f32 v87, v91, 2.0, v90
    v_fma_f32 v82, v83, -2.0, v82
    v_fma_f32 v90, v91, -2.0, v90
    v_fmamk_f32 v80, v76, 0x41700000, v82
    v_fmamk_f32 v88, v84, 0x41700000, v90
    v_fmamk_f32 v80, v81, 0x41200000, v80
    v_fmamk_f32 v88, v89, 0x41200000, v88
    v_cvt_pk_bf16_f32 v53, v77, v85
    v_cvt_pk_bf16_f32 v57, v78, v86
    v_cvt_pk_bf16_f32 v65, v79, v87
    v_cvt_pk_bf16_f32 v69, v82, v90
    v_cvt_pk_bf16_f32 v73, v80, v88
    v_lshlrev_b32 v76, 16, v50
    v_and_b32 v84, s25, v50
    v_lshlrev_b32 v77, 16, v54
    v_and_b32 v85, s25, v54
    v_lshlrev_b32 v78, 16, v58
    v_and_b32 v86, s25, v58
    v_lshlrev_b32 v79, 16, v62
    v_and_b32 v87, s25, v62
    v_add_f32 v80, v76, v78
    v_add_f32 v88, v84, v86
    v_add_f32 v81, v77, v79
    v_add_f32 v89, v85, v87
    v_fma_f32 v82, v78, 4.0, v76
    v_fma_f32 v90, v86, 4.0, v84
    v_fma_f32 v83, v79, 4.0, v77
    v_fma_f32 v91, v87, 4.0, v85
    v_add_f32 v77, v80, v81
    v_add_f32 v85, v88, v89
    v_sub_f32 v78, v80, v81
    v_sub_f32 v86, v88, v89
    v_fma_f32 v79, v83, 2.0, v82
    v_fma_f32 v87, v91, 2.0, v90
    v_fma_f32 v82, v83, -2.0, v82
    v_fma_f32 v90, v91, -2.0, v90
    v_fmamk_f32 v80, v76, 0x41700000, v82
    v_fmamk_f32 v88, v84, 0x41700000, v90
    v_fmamk_f32 v80, v81, 0x41200000, v80
    v_fmamk_f32 v88, v89, 0x41200000, v88
    v_cvt_pk_bf16_f32 v54, v77, v85
    v_cvt_pk_bf16_f32 v58, v78, v86
    v_cvt_pk_bf16_f32 v66, v79, v87
    v_cvt_pk_bf16_f32 v70, v82, v90
    v_cvt_pk_bf16_f32 v74, v80, v88
    v_lshlrev_b32 v76, 16, v51
    v_and_b32 v84, s25, v51
    v_lshlrev_b32 v77, 16, v55
    v_and_b32 v85, s25, v55
    v_lshlrev_b32 v78, 16, v59
    v_and_b32 v86, s25, v59
    v_lshlrev_b32 v79, 16, v63
    v_and_b32 v87, s25, v63
    v_add_f32 v80, v76, v78
    v_add_f32 v88, v84, v86
    v_add_f32 v81, v77, v79
    v_add_f32 v89, v85, v87
    v_fma_f32 v82, v78, 4.0, v76
    v_fma_f32 v90, v86, 4.0, v84
    v_fma_f32 v83, v79, 4.0, v77
    v_fma_f32 v91, v87, 4.0, v85
    v_add_f32 v77, v80, v81
    v_add_f32 v85, v88, v89
    v_sub_f32 v78, v80, v81
    v_sub_f32 v86, v88, v89
    v_fma_f32 v79, v83, 2.0, v82
    v_fma_f32 v87, v91, 2.0, v90
    v_fma_f32 v82, v83, -2.0, v82
    v_fma_f32 v90, v91, -2.0, v90
    v_fmamk_f32 v80, v76, 0x41700000, v82
    v_fmamk_f32 v88, v84, 0x41700000, v90
    v_fmamk_f32 v80, v81, 0x41200000, v80
    v_fmamk_f32 v88, v89, 0x41200000, v88
    v_cvt_pk_bf16_f32 v55, v77, v85
    v_cvt_pk_bf16_f32 v59, v78, v86
    v_cvt_pk_bf16_f32 v67, v79, v87
    v_cvt_pk_bf16_f32 v71, v82, v90
    v_cvt_pk_bf16_f32 v75, v80, v88
    ds_write_b128 v96, v[64:67] offset:57344
    ds_write_b128 v97, v[68:71] offset:8192
    ds_write_b128 v97, v[72:75] offset:24576
    ds_write_b128 v96, v[48:51] offset:8192
    ds_write_b128 v96, v[52:55] offset:24576
    ds_write_b128 v96, v[56:59] offset:40960
    ds_write_b128 v98, v[60:63] offset:8704
    s_add_u32 s28, s28, 1
    s_waitcnt lgkmcnt(0)
    s_barrier
    s_cmp_eq_u32 s22, 1
    s_cbranch_scc1 L_conv1_kernel_hlast1
    s_cmp_lt_u32 s28, 13
    s_cselect_b32 s24, 0, 2130706432
    s_waitcnt vmcnt(0)
    v_lshlrev_b32 v76, 16, v0
    v_and_b32 v84, s25, v0
    v_lshlrev_b32 v77, 16, v4
    v_and_b32 v85, s25, v4
    v_lshlrev_b32 v78, 16, v8
    v_and_b32 v86, s25, v8
    v_lshlrev_b32 v79, 16, v12
    v_and_b32 v87, s25, v12
    v_add_f32 v80, v76, v78
    v_add_f32 v88, v84, v86
    v_add_f32 v81, v77, v79
    v_add_f32 v89, v85, v87
    v_fma_f32 v82, v78, 4.0, v76
    v_fma_f32 v90, v86, 4.0, v84
    v_fma_f32 v83, v79, 4.0, v77
    v_fma_f32 v91, v87, 4.0, v85
    v_add_f32 v77, v80, v81
    v_add_f32 v85, v88, v89
    v_sub_f32 v78, v80, v81
    v_sub_f32 v86, v88, v89
    v_fma_f32 v79, v83, 2.0, v82
    v_fma_f32 v87, v91, 2.0, v90
    v_fma_f32 v82, v83, -2.0, v82
    v_fma_f32 v90, v91, -2.0, v90
    v_fmamk_f32 v80, v76, 0x41700000, v82
    v_fmamk_f32 v88, v84, 0x41700000, v90
    buffer_load_dwordx4 v[32:35], v92, s[8:11], s24 offen offset:0
    buffer_load_dwordx4 v[48:51], v92, s[8:11], s24 offen offset:64
    v_add_u32 v92, 128, v92
    v_fmamk_f32 v80, v81, 0x41200000, v80
    v_fmamk_f32 v88, v89, 0x41200000, v88
    v_cvt_pk_bf16_f32 v4, v77, v85
    v_cvt_pk_bf16_f32 v8, v78, v86
    v_cvt_pk_bf16_f32 v64, v79, v87
    v_cvt_pk_bf16_f32 v68, v82, v90
    v_cvt_pk_bf16_f32 v72, v80, v88
    v_lshlrev_b32 v76, 16, v1
    v_and_b32 v84, s25, v1
    v_lshlrev_b32 v77, 16, v5
    v_and_b32 v85, s25, v5
    v_lshlrev_b32 v78, 16, v9
    v_and_b32 v86, s25, v9
    v_lshlrev_b32 v79, 16, v13
    v_and_b32 v87, s25, v13
    v_add_f32 v80, v76, v78
    v_add_f32 v88, v84, v86
    v_add_f32 v81, v77, v79
    v_add_f32 v89, v85, v87
    v_fma_f32 v82, v78, 4.0, v76
    v_fma_f32 v90, v86, 4.0, v84
    v_fma_f32 v83, v79, 4.0, v77
    v_fma_f32 v91, v87, 4.0, v85
    v_add_f32 v77, v80, v81
    v_add_f32 v85, v88, v89
    v_sub_f32 v78, v80, v81
    buffer_load_dwordx4 v[36:39], v93, s[8:11], s24 offen offset:0
    buffer_load_dwordx4 v[52:55], v93, s[8:11], s24 offen offset:64
    v_add_u32 v93, 128, v93
    v_sub_f32 v86, v88, v89
    v_fma_f32 v79, v83, 2.0, v82
    v_fma_f32 v87, v91, 2.0, v90
    v_fma_f32 v82, v83, -2.0, v82
    v_fma_f32 v90, v91, -2.0, v90
    v_fmamk_f32 v80, v76, 0x41700000, v82
    v_fmamk_f32 v88, v84, 0x41700000, v90
    v_fmamk_f32 v80, v81, 0x41200000, v80
    v_fmamk_f32 v88, v89, 0x41200000, v88
    v_cvt_pk_bf16_f32 v5, v77, v85
    v_cvt_pk_bf16_f32 v9, v78, v86
    v_cvt_pk_bf16_f32 v65, v79, v87
    v_cvt_pk_bf16_f32 v69, v82, v90
    v_cvt_pk_bf16_f32 v73, v80, v88
    v_lshlrev_b32 v76, 16, v2
    v_and_b32 v84, s25, v2
    v_lshlrev_b32 v77, 16, v6
    v_and_b32 v85, s25, v6
    v_lshlrev_b32 v78, 16, v10
    v_and_b32 v86, s25, v10
    v_lshlrev_b32 v79, 16, v14
    v_and_b32 v87, s25, v14
    v_add_f32 v80, v76, v78
    v_add_f32 v88, v84, v86
    v_add_f32 v81, v77, v79
    v_add_f32 v89, v85, v87
    v_fma_f32 v82, v78, 4.0, v76
    v_fma_f32 v90, v86, 4.0, v84
    v_fma_f32 v83, v79, 4.0, v77
    v_fma_f32 v91, v87, 4.0, v85
    v_add_f32 v77, v80, v81
    v_add_f32 v85, v88, v89
    v_sub_f32 v78, v80, v81
    v_sub_f32 v86, v88, v89
    v_fma_f32 v79, v83, 2.0, v82
    v_fma_f32 v87, v91, 2.0, v90
    v_fma_f32 v82, v83, -2.0, v82
    v_fma_f32 v90, v91, -2.0, v90
    v_fmamk_f32 v80, v76, 0x41700000, v82
    v_fmamk_f32 v88, v84, 0x41700000, v90
    v_fmamk_f32 v80, v81, 0x41200000, v80
    v_fmamk_f32 v88, v89, 0x41200000, v88
    v_cvt_pk_bf16_f32 v6, v77, v85
    v_cvt_pk_bf16_f32 v10, v78, v86
    v_cvt_pk_bf16_f32 v66, v79, v87
    v_cvt_pk_bf16_f32 v70, v82, v90
    v_cvt_pk_bf16_f32 v74, v80, v88
    v_lshlrev_b32 v76, 16, v3
    v_and_b32 v84, s25, v3
    v_lshlrev_b32 v77, 16, v7
    v_and_b32 v85, s25, v7
    v_lshlrev_b32 v78, 16, v11
    v_and_b32 v86, s25, v11
    v_lshlrev_b32 v79, 16, v15
    v_and_b32 v87, s25, v15
    v_add_f32 v80, v76, v78
    v_add_f32 v88, v84, v86
    v_add_f32 v81, v77, v79
    v_add_f32 v89, v85, v87
    v_fma_f32 v82, v78, 4.0, v76
    v_fma_f32 v90, v86, 4.0, v84
    v_fma_f32 v83, v79, 4.0, v77
    v_fma_f32 v91, v87, 4.0, v85
    v_add_f32 v77, v80, v81
    v_add_f32 v85, v88, v89
    v_sub_f32 v78, v80, v81
    v_sub_f32 v86, v88, v89
    v_fma_f32 v79, v83, 2.0, v82
    v_fma_f32 v87, v91, 2.0, v90
    v_fma_f32 v82, v83, -2.0, v82
    v_fma_f32 v90, v91, -2.0, v90
    v_fmamk_f32 v80, v76, 0x41700000, v82
    v_fmamk_f32 v88, v84, 0x41700000, v90
    v_fmamk_f32 v80, v81, 0x41200000, v80
    v_fmamk_f32 v88, v89, 0x41200000, v88
    v_cvt_pk_bf16_f32 v7, v77, v85
    v_cvt_pk_bf16_f32 v11, v78, v86
    v_cvt_pk_bf16_f32 v67, v79, v87
    v_cvt_pk_bf16_f32 v71, v82, v90
    v_cvt_pk_bf16_f32 v75, v80, v88
    ds_write_b128 v96, v[64:67] offset:49152
    ds_write_b128 v97, v[68:71] offset:0
    ds_write_b128 v97, v[72:75] offset:16384
    ds_write_b128 v96, v[0:3] offset:0
    ds_write_b128 v96, v[4:7] offset:16384
    ds_write_b128 v96, v[8:11] offset:32768
    ds_write_b128 v98, v[12:15] offset:0
    s_add_u32 s28, s28, 1
    s_waitcnt lgkmcnt(0)
    s_barrier
    s_sub_u32 s22, s22, 1
    s_branch L_conv1_kernel_hloop1
L_conv1_kernel_hlast1:
    s_cmp_ge_u32 s2, 32
    s_cbranch_scc1 L_conv1_kernel_ntw
    s_getpc_b64 s[36:37]
L_conv1_kernel_pc:
    s_lshl_b32 s38, s32, 13
    s_add_u32 s38, s38, L_conv1_kernel_epi-L_conv1_kernel_pc
    v_lshl_add_u32 v2, v127, 7, s38
    v_min_u32 v2, L_conv2_kernel_done-L_conv1_kernel_pc, v2
    v_mov_b32 v3, s37
    v_add_co_u32 v2, vcc, s36, v2
    s_nop 1
    v_addc_co_u32 v3, vcc, 0, v3, vcc
    global_load_dword v4, v[2:3], off
L_conv1_kernel_ntw:
    s_branch L_conv1_kernel_end
L_conv1_kernel_h2:
    s_waitcnt lgkmcnt(0)
    s_barrier
    buffer_load_dwordx4 v[32:35], v92, s[8:11], s24 offen offset:0
    buffer_load_dwordx4 v[48:51], v92, s[8:11], s24 offen offset:64
    v_add_u32 v92, 128, v92
    buffer_load_dwordx4 v[36:39], v93, s[8:11], s24 offen offset:0
    buffer_load_dwordx4 v[52:55], v93, s[8:11], s24 offen offset:64
    v_add_u32 v93, 128, v93
    buffer_load_dwordx4 v[40:43], v94, s[8:11], s24 offen offset:0
    buffer_load_dwordx4 v[56:59], v94, s[8:11], s24 offen offset:64
    v_add_u32 v94, 128, v94
    buffer_load_dwordx4 v[44:47], v95, s[8:11], s24 offen offset:0
    buffer_load_dwordx4 v[60:63], v95, s[8:11], s24 offen offset:64
    v_add_u32 v95, 128, v95
    s_setprio 0
    v_lshlrev_b32 v76, 16, v16
    v_and_b32 v84, s25, v16
    v_lshlrev_b32 v77, 16, v20
    v_and_b32 v85, s25, v20
    v_lshlrev_b32 v78, 16, v24
    v_and_b32 v86, s25, v24
    v_lshlrev_b32 v79, 16, v28
    v_and_b32 v87, s25, v28
    v_add_f32 v80, v76, v78
    v_add_f32 v88, v84, v86
    v_add_f32 v81, v77, v79
    v_add_f32 v89, v85, v87
    v_fma_f32 v82, v78, 4.0, v76
    v_fma_f32 v90, v86, 4.0, v84
    v_fma_f32 v83, v79, 4.0, v77
    v_fma_f32 v91, v87, 4.0, v85
    v_add_f32 v77, v80, v81
    v_add_f32 v85, v88, v89
    v_sub_f32 v78, v80, v81
    v_sub_f32 v86, v88, v89
    v_fma_f32 v79, v83, 2.0, v82
    v_fma_f32 v87, v91, 2.0, v90
    v_fma_f32 v82, v83, -2.0, v82
    v_fma_f32 v90, v91, -2.0, v90
    v_fmamk_f32 v80, v76, 0x41700000, v82
    v_fmamk_f32 v88, v84, 0x41700000, v90
    v_fmamk_f32 v80, v81, 0x41200000, v80
    v_fmamk_f32 v88, v89, 0x41200000, v88
    v_cvt_pk_bf16_f32 v20, v77, v85
    v_cvt_pk_bf16_f32 v24, v78, v86
    v_cvt_pk_bf16_f32 v64, v79, v87
    v_cvt_pk_bf16_f32 v68, v82, v90
    v_cvt_pk_bf16_f32 v72, v80, v88
    v_lshlrev_b32 v76, 16, v17
    v_and_b32 v84, s25, v17
    v_lshlrev_b32 v77, 16, v21
    v_and_b32 v85, s25, v21
    v_lshlrev_b32 v78, 16, v25
    v_and_b32 v86, s25, v25
    v_lshlrev_b32 v79, 16, v29
    v_and_b32 v87, s25, v29
    v_add_f32 v80, v76, v78
    v_add_f32 v88, v84, v86
    v_add_f32 v81, v77, v79
    v_add_f32 v89, v85, v87
    v_fma_f32 v82, v78, 4.0, v76
    v_fma_f32 v90, v86, 4.0, v84
    v_fma_f32 v83, v79, 4.0, v77
    v_fma_f32 v91, v87, 4.0, v85
    v_add_f32 v77, v80, v81
    v_add_f32 v85, v88, v89
    v_sub_f32 v78, v80, v81
    v_sub_f32 v86, v88, v89
    v_fma_f32 v79, v83, 2.0, v82
    v_fma_f32 v87, v91, 2.0, v90
    v_fma_f32 v82, v83, -2.0, v82
    v_fma_f32 v90, v91, -2.0, v90
    v_fmamk_f32 v80, v76, 0x41700000, v82
    v_fmamk_f32 v88, v84, 0x41700000, v90
    v_fmamk_f32 v80, v81, 0x41200000, v80
    v_fmamk_f32 v88, v89, 0x41200000, v88
    v_cvt_pk_bf16_f32 v21, v77, v85
    v_cvt_pk_bf16_f32 v25, v78, v86
    v_cvt_pk_bf16_f32 v65, v79, v87
    v_cvt_pk_bf16_f32 v69, v82, v90
    v_cvt_pk_bf16_f32 v73, v80, v88
    v_lshlrev_b32 v76, 16, v18
    v_and_b32 v84, s25, v18
    v_lshlrev_b32 v77, 16, v22
    v_and_b32 v85, s25, v22
    v_lshlrev_b32 v78, 16, v26
    v_and_b32 v86, s25, v26
    v_lshlrev_b32 v79, 16, v30
    v_and_b32 v87, s25, v30
    v_add_f32 v80, v76, v78
    v_add_f32 v88, v84, v86
    v_add_f32 v81, v77, v79
    v_add_f32 v89, v85, v87
    v_fma_f32 v82, v78, 4.0, v76
    v_fma_f32 v90, v86, 4.0, v84
    v_fma_f32 v83, v79, 4.0, v77
    v_fma_f32 v91, v87, 4.0, v85
    v_add_f32 v77, v80, v81
    v_add_f32 v85, v88, v89
    v_sub_f32 v78, v80, v81
    v_sub_f32 v86, v88, v89
    v_fma_f32 v79, v83, 2.0, v82
    v_fma_f32 v87, v91, 2.0, v90
    v_fma_f32 v82, v83, -2.0, v82
    v_fma_f32 v90, v91, -2.0, v90
    v_fmamk_f32 v80, v76, 0x41700000, v82
    v_fmamk_f32 v88, v84, 0x41700000, v90
    v_fmamk_f32 v80, v81, 0x41200000, v80
    v_fmamk_f32 v88, v89, 0x41200000, v88
    v_cvt_pk_bf16_f32 v22, v77, v85
    v_cvt_pk_bf16_f32 v26, v78, v86
    v_cvt_pk_bf16_f32 v66, v79, v87
    v_cvt_pk_bf16_f32 v70, v82, v90
    v_cvt_pk_bf16_f32 v74, v80, v88
    v_lshlrev_b32 v76, 16, v19
    v_and_b32 v84, s25, v19
    v_lshlrev_b32 v77, 16, v23
    v_and_b32 v85, s25, v23
    v_lshlrev_b32 v78, 16, v27
    v_and_b32 v86, s25, v27
    v_lshlrev_b32 v79, 16, v31
    v_and_b32 v87, s25, v31
    v_add_f32 v80, v76, v78
    v_add_f32 v88, v84, v86
    v_add_f32 v81, v77, v79
    v_add_f32 v89, v85, v87
    v_fma_f32 v82, v78, 4.0, v76
    v_fma_f32 v90, v86, 4.0, v84
    v_fma_f32 v83, v79, 4.0, v77
    v_fma_f32 v91, v87, 4.0, v85
    v_add_f32 v77, v80, v81
    v_add_f32 v85, v88, v89
    v_sub_f32 v78, v80, v81
    v_sub_f32 v86, v88, v89
    v_fma_f32 v79, v83, 2.0, v82
    v_fma_f32 v87, v91, 2.0, v90
    v_fma_f32 v82, v83, -2.0, v82
    v_fma_f32 v90, v91, -2.0, v90
    v_fmamk_f32 v80, v76, 0x41700000, v82
    v_fmamk_f32 v88, v84, 0x41700000, v90
    v_fmamk_f32 v80, v81, 0x41200000, v80
    v_fmamk_f32 v88, v89, 0x41200000, v88
    v_cvt_pk_bf16_f32 v23, v77, v85
    v_cvt_pk_bf16_f32 v27, v78, v86
    v_cvt_pk_bf16_f32 v67, v79, v87
    v_cvt_pk_bf16_f32 v71, v82, v90
    v_cvt_pk_bf16_f32 v75, v80, v88
L_conv1_kernel_hloop2:
    s_cmp_lt_u32 s28, 12
    s_cselect_b32 s24, 0, 2130706432
    ds_write_b128 v96, v[64:67] offset:57344
    ds_write_b128 v97, v[68:71] offset:8192
    ds_write_b128 v97, v[72:75] offset:24576
    ds_write_b128 v96, v[16:19] offset:8192
    ds_write_b128 v96, v[20:23] offset:24576
    ds_write_b128 v96, v[24:27] offset:40960
    ds_write_b128 v98, v[28:31] offset:8704
    s_waitcnt vmcnt(0)
    v_lshlrev_b32 v76, 16, v32
    v_and_b32 v84, s25, v32
    v_lshlrev_b32 v77, 16, v36
    v_and_b32 v85, s25, v36
    v_lshlrev_b32 v78, 16, v40
    v_and_b32 v86, s25, v40
    v_lshlrev_b32 v79, 16, v44
    v_and_b32 v87, s25, v44
    v_add_f32 v80, v76, v78
    v_add_f32 v88, v84, v86
    v_add_f32 v81, v77, v79
    v_add_f32 v89, v85, v87
    v_fma_f32 v82, v78, 4.0, v76
    v_fma_f32 v90, v86, 4.0, v84
    v_fma_f32 v83, v79, 4.0, v77
    v_fma_f32 v91, v87, 4.0, v85
    v_add_f32 v77, v80, v81
    v_add_f32 v85, v88, v89
    v_sub_f32 v78, v80, v81
    v_sub_f32 v86, v88, v89
    v_fma_f32 v79, v83, 2.0, v82
    v_fma_f32 v87, v91, 2.0, v90
    v_fma_f32 v82, v83, -2.0, v82
    v_fma_f32 v90, v91, -2.0, v90
    v_fmamk_f32 v80, v76, 0x41700000, v82
    v_fmamk_f32 v88, v84, 0x41700000, v90
    v_fmamk_f32 v80, v81, 0x41200000, v80
    v_fmamk_f32 v88, v89, 0x41200000, v88
    v_cvt_pk_bf16_f32 v36, v77, v85
    v_cvt_pk_bf16_f32 v40, v78, v86
    v_cvt_pk_bf16_f32 v64, v79, v87
    v_cvt_pk_bf16_f32 v68, v82, v90
    v_cvt_pk_bf16_f32 v72, v80, v88
    v_lshlrev_b32 v76, 16, v33
    v_and_b32 v84, s25, v33
    v_lshlrev_b32 v77, 16, v37
    v_and_b32 v85, s25, v37
    v_lshlrev_b32 v78, 16, v41
    v_and_b32 v86, s25, v41
    buffer_load_dwordx4 v[0:3], v92, s[8:11], s24 offen offset:0
    buffer_load_dwordx4 v[16:19], v92, s[8:11], s24 offen offset:64
    v_add_u32 v92, 128, v92
    v_lshlrev_b32 v79, 16, v45
    v_and_b32 v87, s25, v45
    v_add_f32 v80, v76, v78
    v_add_f32 v88, v84, v86
    v_add_f32 v81, v77, v79
    v_add_f32 v89, v85, v87
    v_fma_f32 v82, v78, 4.0, v76
    v_fma_f32 v90, v86, 4.0, v84
    v_fma_f32 v83, v79, 4.0, v77
    v_fma_f32 v91, v87, 4.0, v85
    v_add_f32 v77, v80, v81
    v_add_f32 v85, v88, v89
    v_sub_f32 v78, v80, v81
    v_sub_f32 v86, v88, v89
    v_fma_f32 v79, v83, 2.0, v82
    v_fma_f32 v87, v91, 2.0, v90
    v_fma_f32 v82, v83, -2.0, v82
    v_fma_f32 v90, v91, -2.0, v90
    v_fmamk_f32 v80, v76, 0x41700000, v82
    v_fmamk_f32 v88, v84, 0x41700000, v90
    v_fmamk_f32 v80, v81, 0x41200000, v80
    v_fmamk_f32 v88, v89, 0x41200000, v88
    v_cvt_pk_bf16_f32 v37, v77, v85
    v_cvt_pk_bf16_f32 v41, v78, v86
    v_cvt_pk_bf16_f32 v65, v79, v87
    v_cvt_pk_bf16_f32 v69, v82, v90
    v_cvt_pk_bf16_f32 v73, v80, v88
    buffer_load_dwordx4 v[4:7], v93, s[8:11], s24 offen offset:0
    buffer_load_dwordx4 v[20:23], v93, s[8:11], s24 offen offset:64
    v_add_u32 v93, 128, v93
    v_lshlrev_b32 v76, 16, v34
    v_and_b32 v84, s25, v34
    v_lshlrev_b32 v77, 16, v38
    v_and_b32 v85, s25, v38
    v_lshlrev_b32 v78, 16, v42
    v_and_b32 v86, s25, v42
    v_lshlrev_b32 v79, 16, v46
    v_and_b32 v87, s25, v46
    v_add_f32 v80, v76, v78
    v_add_f32 v88, v84, v86
    v_add_f32 v81, v77, v79
    v_add_f32 v89, v85, v87
    v_fma_f32 v82, v78, 4.0, v76
    v_fma_f32 v90, v86, 4.0, v84
    v_fma_f32 v83, v79, 4.0, v77
    v_fma_f32 v91, v87, 4.0, v85
    v_add_f32 v77, v80, v81
    v_add_f32 v85, v88, v89
    v_sub_f32 v78, v80, v81
    v_sub_f32 v86, v88, v89
    v_fma_f32 v79, v83, 2.0, v82
    v_fma_f32 v87, v91, 2.0, v90
    v_fma_f32 v82, v83, -2.0, v82
    v_fma_f32 v90, v91, -2.0, v90
    v_fmamk_f32 v80, v76, 0x41700000, v82
    v_fmamk_f32 v88, v84, 0x41700000, v90
    v_fmamk_f32 v80, v81, 0x41200000, v80
    v_fmamk_f32 v88, v89, 0x41200000, v88
    v_cvt_pk_bf16_f32 v38, v77, v85
    v_cvt_pk_bf16_f32 v42, v78, v86
    v_cvt_pk_bf16_f32 v66, v79, v87
    v_cvt_pk_bf16_f32 v70, v82, v90
    v_cvt_pk_bf16_f32 v74, v80, v88
    v_lshlrev_b32 v76, 16, v35
    v_and_b32 v84, s25, v35
    v_lshlrev_b32 v77, 16, v39
    v_and_b32 v85, s25, v39
    v_lshlrev_b32 v78, 16, v43
    v_and_b32 v86, s25, v43
    v_lshlrev_b32 v79, 16, v47
    v_and_b32 v87, s25, v47
    v_add_f32 v80, v76, v78
    v_add_f32 v88, v84, v86
    v_add_f32 v81, v77, v79
    v_add_f32 v89, v85, v87
    v_fma_f32 v82, v78, 4.0, v76
    v_fma_f32 v90, v86, 4.0, v84
    v_fma_f32 v83, v79, 4.0, v77
    v_fma_f32 v91, v87, 4.0, v85
    v_add_f32 v77, v80, v81
    v_add_f32 v85, v88, v89
    v_sub_f32 v78, v80, v81
    v_sub_f32 v86, v88, v89
    v_fma_f32 v79, v83, 2.0, v82
    v_fma_f32 v87, v91, 2.0, v90
    v_fma_f32 v82, v83, -2.0, v82
    v_fma_f32 v90, v91, -2.0, v90
    v_fmamk_f32 v80, v76, 0x41700000, v82
    v_fmamk_f32 v88, v84, 0x41700000, v90
    v_fmamk_f32 v80, v81, 0x41200000, v80
    v_fmamk_f32 v88, v89, 0x41200000, v88
    v_cvt_pk_bf16_f32 v39, v77, v85
    v_cvt_pk_bf16_f32 v43, v78, v86
    v_cvt_pk_bf16_f32 v67, v79, v87
    v_cvt_pk_bf16_f32 v71, v82, v90
    v_cvt_pk_bf16_f32 v75, v80, v88
    s_add_u32 s28, s28, 1
    s_waitcnt lgkmcnt(0)
    s_barrier
    s_cmp_lt_u32 s28, 12
    s_cselect_b32 s24, 0, 2130706432
    ds_write_b128 v96, v[64:67] offset:49152
    ds_write_b128 v97, v[68:71] offset:0
    ds_write_b128 v97, v[72:75] offset:16384
    ds_write_b128 v96, v[32:35] offset:0
    ds_write_b128 v96, v[36:39] offset:16384
    ds_write_b128 v96, v[40:43] offset:32768
    ds_write_b128 v98, v[44:47] offset:0
    v_lshlrev_b32 v76, 16, v48
    v_and_b32 v84, s25, v48
    v_lshlrev_b32 v77, 16, v52
    v_and_b32 v85, s25, v52
    v_lshlrev_b32 v78, 16, v56
    v_and_b32 v86, s25, v56
    v_lshlrev_b32 v79, 16, v60
    v_and_b32 v87, s25, v60
    v_add_f32 v80, v76, v78
    v_add_f32 v88, v84, v86
    v_add_f32 v81, v77, v79
    v_add_f32 v89, v85, v87
    v_fma_f32 v82, v78, 4.0, v76
    v_fma_f32 v90, v86, 4.0, v84
    v_fma_f32 v83, v79, 4.0, v77
    v_fma_f32 v91, v87, 4.0, v85
    v_add_f32 v77, v80, v81
    v_add_f32 v85, v88, v89
    v_sub_f32 v78, v80, v81
    v_sub_f32 v86, v88, v89
    v_fma_f32 v79, v83, 2.0, v82
    v_fma_f32 v87, v91, 2.0, v90
    v_fma_f32 v82, v83, -2.0, v82
    v_fma_f32 v90, v91, -2.0, v90
    v_fmamk_f32 v80, v76, 0x41700000, v82
    v_fmamk_f32 v88, v84, 0x41700000, v90
    v_fmamk_f32 v80, v81, 0x41200000, v80
    v_fmamk_f32 v88, v89, 0x41200000, v88
    v_cvt_pk_bf16_f32 v52, v77, v85
    v_cvt_pk_bf16_f32 v56, v78, v86
    v_cvt_pk_bf16_f32 v64, v79, v87
    v_cvt_pk_bf16_f32 v68, v82, v90
    v_cvt_pk_bf16_f32 v72, v80, v88
    v_lshlrev_b32 v76, 16, v49
    v_and_b32 v84, s25, v49
    v_lshlrev_b32 v77, 16, v53
    v_and_b32 v85, s25, v53
    v_lshlrev_b32 v78, 16, v57
    v_and_b32 v86, s25, v57
    buffer_load_dwordx4 v[8:11], v94, s[8:11], s24 offen offset:0
    buffer_load_dwordx4 v[24:27], v94, s[8:11], s24 offen offset:64
    v_add_u32 v94, 128, v94
    v_lshlrev_b32 v79, 16, v61
    v_and_b32 v87, s25, v61
    v_add_f32 v80, v76, v78
    v_add_f32 v88, v84, v86
    v_add_f32 v81, v77, v79
    v_add_f32 v89, v85, v87
    v_fma_f32 v82, v78, 4.0, v76
    v_fma_f32 v90, v86, 4.0, v84
    v_fma_f32 v83, v79, 4.0, v77
    v_fma_f32 v91, v87, 4.0, v85
    v_add_f32 v77, v80, v81
    v_add_f32 v85, v88, v89
    v_sub_f32 v78, v80, v81
    v_sub_f32 v86, v88, v89
    v_fma_f32 v79, v83, 2.0, v82
    v_fma_f32 v87, v91, 2.0, v90
    v_fma_f32 v82, v83, -2.0, v82
    v_fma_f32 v90, v91, -2.0, v90
    v_fmamk_f32 v80, v76, 0x41700000, v82
    v_fmamk_f32 v88, v84, 0x41700000, v90
    v_fmamk_f32 v80, v81, 0x41200000, v80
    v_fmamk_f32 v88, v89, 0x41200000, v88
    v_cvt_pk_bf16_f32 v53, v77, v85
    v_cvt_pk_bf16_f32 v57, v78, v86
    v_cvt_pk_bf16_f32 v65, v79, v87
    v_cvt_pk_bf16_f32 v69, v82, v90
    v_cvt_pk_bf16_f32 v73, v80, v88
    buffer_load_dwordx4 v[12:15], v95, s[8:11], s24 offen offset:0
    buffer_load_dwordx4 v[28:31], v95, s[8:11], s24 offen offset:64
    v_add_u32 v95, 128, v95
    v_lshlrev_b32 v76, 16, v50
    v_and_b32 v84, s25, v50
    v_lshlrev_b32 v77, 16, v54
    v_and_b32 v85, s25, v54
    v_lshlrev_b32 v78, 16, v58
    v_and_b32 v86, s25, v58
    v_lshlrev_b32 v79, 16, v62
    v_and_b32 v87, s25, v62
    v_add_f32 v80, v76, v78
    v_add_f32 v88, v84, v86
    v_add_f32 v81, v77, v79
    v_add_f32 v89, v85, v87
    v_fma_f32 v82, v78, 4.0, v76
    v_fma_f32 v90, v86, 4.0, v84
    v_fma_f32 v83, v79, 4.0, v77
    v_fma_f32 v91, v87, 4.0, v85
    v_add_f32 v77, v80, v81
    v_add_f32 v85, v88, v89
    v_sub_f32 v78, v80, v81
    v_sub_f32 v86, v88, v89
    v_fma_f32 v79, v83, 2.0, v82
    v_fma_f32 v87, v91, 2.0, v90
    v_fma_f32 v82, v83, -2.0, v82
    v_fma_f32 v90, v91, -2.0, v90
    v_fmamk_f32 v80, v76, 0x41700000, v82
    v_fmamk_f32 v88, v84, 0x41700000, v90
    v_fmamk_f32 v80, v81, 0x41200000, v80
    v_fmamk_f32 v88, v89, 0x41200000, v88
    v_cvt_pk_bf16_f32 v54, v77, v85
    v_cvt_pk_bf16_f32 v58, v78, v86
    v_cvt_pk_bf16_f32 v66, v79, v87
    v_cvt_pk_bf16_f32 v70, v82, v90
    v_cvt_pk_bf16_f32 v74, v80, v88
    v_lshlrev_b32 v76, 16, v51
    v_and_b32 v84, s25, v51
    v_lshlrev_b32 v77, 16, v55
    v_and_b32 v85, s25, v55
    v_lshlrev_b32 v78, 16, v59
    v_and_b32 v86, s25, v59
    v_lshlrev_b32 v79, 16, v63
    v_and_b32 v87, s25, v63
    v_add_f32 v80, v76, v78
    v_add_f32 v88, v84, v86
    v_add_f32 v81, v77, v79
    v_add_f32 v89, v85, v87
    v_fma_f32 v82, v78, 4.0, v76
    v_fma_f32 v90, v86, 4.0, v84
    v_fma_f32 v83, v79, 4.0, v77
    v_fma_f32 v91, v87, 4.0, v85
    v_add_f32 v77, v80, v81
    v_add_f32 v85, v88, v89
    v_sub_f32 v78, v80, v81
    v_sub_f32 v86, v88, v89
    v_fma_f32 v79, v83, 2.0, v82
    v_fma_f32 v87, v91, 2.0, v90
    v_fma_f32 v82, v83, -2.0, v82
    v_fma_f32 v90, v91, -2.0, v90
    v_fmamk_f32 v80, v76, 0x41700000, v82
    v_fmamk_f32 v88, v84, 0x41700000, v90
    v_fmamk_f32 v80, v81, 0x41200000, v80
    v_fmamk_f32 v88, v89, 0x41200000, v88
    v_cvt_pk_bf16_f32 v55, v77, v85
    v_cvt_pk_bf16_f32 v59, v78, v86
    v_cvt_pk_bf16_f32 v67, v79, v87
    v_cvt_pk_bf16_f32 v71, v82, v90
    v_cvt_pk_bf16_f32 v75, v80, v88
    s_add_u32 s28, s28, 1
    s_waitcnt lgkmcnt(0)
    s_barrier
    s_cmp_eq_u32 s22, 1
    s_cbranch_scc1 L_conv1_kernel_hlast2
    s_cmp_lt_u32 s28, 12
    s_cselect_b32 s24, 0, 2130706432
    ds_write_b128 v96, v[64:67] offset:57344
    ds_write_b128 v97, v[68:71] offset:8192
    ds_write_b128 v97, v[72:75] offset:24576
    ds_write_b128 v96, v[48:51] offset:8192
    ds_write_b128 v96, v[52:55] offset:24576
    ds_write_b128 v96, v[56:59] offset:40960
    ds_write_b128 v98, v[60:63] offset:8704
    s_waitcnt vmcnt(0)
    v_lshlrev_b32 v76, 16, v0
    v_and_b32 v84, s25, v0
    v_lshlrev_b32 v77, 16, v4
    v_and_b32 v85, s25, v4
    v_lshlrev_b32 v78, 16, v8
    v_and_b32 v86, s25, v8
    v_lshlrev_b32 v79, 16, v12
    v_and_b32 v87, s25, v12
    v_add_f32 v80, v76, v78
    v_add_f32 v88, v84, v86
    v_add_f32 v81, v77, v79
    v_add_f32 v89, v85, v87
    v_fma_f32 v82, v78, 4.0, v76
    v_fma_f32 v90, v86, 4.0, v84
    v_fma_f32 v83, v79, 4.0, v77
    v_fma_f32 v91, v87, 4.0, v85
    v_add_f32 v77, v80, v81
    v_add_f32 v85, v88, v89
    v_sub_f32 v78, v80, v81
    v_sub_f32 v86, v88, v89
    v_fma_f32 v79, v83, 2.0, v82
    v_fma_f32 v87, v91, 2.0, v90
    v_fma_f32 v82, v83, -2.0, v82
    v_fma_f32 v90, v91, -2.0, v90
    v_fmamk_f32 v80, v76, 0x41700000, v82
    v_fmamk_f32 v88, v84, 0x41700000, v90
    v_fmamk_f32 v80, v81, 0x41200000, v80
    v_fmamk_f32 v88, v89, 0x41200000, v88
    v_cvt_pk_bf16_f32 v4, v77, v85
    v_cvt_pk_bf16_f32 v8, v78, v86
    v_cvt_pk_bf16_f32 v64, v79, v87
    v_cvt_pk_bf16_f32 v68, v82, v90
    v_cvt_pk_bf16_f32 v72, v80, v88
    v_lshlrev_b32 v76, 16, v1
    v_and_b32 v84, s25, v1
    v_lshlrev_b32 v77, 16, v5
    v_and_b32 v85, s25, v5
    v_lshlrev_b32 v78, 16, v9
    v_and_b32 v86, s25, v9
    buffer_load_dwordx4 v[32:35], v92, s[8:11], s24 offen offset:0
    buffer_load_dwordx4 v[48:51], v92, s[8:11], s24 offen offset:64
    v_add_u32 v92, 128, v92
    v_lshlrev_b32 v79, 16, v13
    v_and_b32 v87, s25, v13
    v_add_f32 v80, v76, v78
    v_add_f32 v88, v84, v86
    v_add_f32 v81, v77, v79
    v_add_f32 v89, v85, v87
    v_fma_f32 v82, v78, 4.0, v76
    v_fma_f32 v90, v86, 4.0, v84
    v_fma_f32 v83, v79, 4.0, v77
    v_fma_f32 v91, v87, 4.0, v85
    v_add_f32 v77, v80, v81
    v_add_f32 v85, v88, v89
    v_sub_f32 v78, v80, v81
    v_sub_f32 v86, v88, v89
    v_fma_f32 v79, v83, 2.0, v82
    v_fma_f32 v87, v91, 2.0, v90
    v_fma_f32 v82, v83, -2.0, v82
    v_fma_f32 v90, v91, -2.0, v90
    v_fmamk_f32 v80, v76, 0x41700000, v82
    v_fmamk_f32 v88, v84, 0x41700000, v90
    v_fmamk_f32 v80, v81, 0x41200000, v80
    v_fmamk_f32 v88, v89, 0x41200000, v88
    v_cvt_pk_bf16_f32 v5, v77, v85
    v_cvt_pk_bf16_f32 v9, v78, v86
    v_cvt_pk_bf16_f32 v65, v79, v87
    v_cvt_pk_bf16_f32 v69, v82, v90
    v_cvt_pk_bf16_f32 v73, v80, v88
    buffer_load_dwordx4 v[36:39], v93, s[8:11], s24 offen offset:0
    buffer_load_dwordx4 v[52:55], v93, s[8:11], s24 offen offset:64
    v_add_u32 v93, 128, v93
    v_lshlrev_b32 v76, 16, v2
    v_and_b32 v84, s25, v2
    v_lshlrev_b32 v77, 16, v6
    v_and_b32 v85, s25, v6
    v_lshlrev_b32 v78, 16, v10
    v_and_b32 v86, s25, v10
    v_lshlrev_b32 v79, 16, v14
    v_and_b32 v87, s25, v14
    v_add_f32 v80, v76, v78
    v_add_f32 v88, v84, v86
    v_add_f32 v81, v77, v79
    v_add_f32 v89, v85, v87
    v_fma_f32 v82, v78, 4.0, v76
    v_fma_f32 v90, v86, 4.0, v84
    v_fma_f32 v83, v79, 4.0, v77
    v_fma_f32 v91, v87, 4.0, v85
    v_add_f32 v77, v80, v81
    v_add_f32 v85, v88, v89
    v_sub_f32 v78, v80, v81
    v_sub_f32 v86, v88, v89
    v_fma_f32 v79, v83, 2.0, v82
    v_fma_f32 v87, v91, 2.0, v90
    v_fma_f32 v82, v83, -2.0, v82
    v_fma_f32 v90, v91, -2.0, v90
    v_fmamk_f32 v80, v76, 0x41700000, v82
    v_fmamk_f32 v88, v84, 0x41700000, v90
    v_fmamk_f32 v80, v81, 0x41200000, v80
    v_fmamk_f32 v88, v89, 0x41200000, v88
    v_cvt_pk_bf16_f32 v6, v77, v85
    v_cvt_pk_bf16_f32 v10, v78, v86
    v_cvt_pk_bf16_f32 v66, v79, v87
    v_cvt_pk_bf16_f32 v70, v82, v90
    v_cvt_pk_bf16_f32 v74, v80, v88
    v_lshlrev_b32 v76, 16, v3
    v_and_b32 v84, s25, v3
    v_lshlrev_b32 v77, 16, v7
    v_and_b32 v85, s25, v7
    v_lshlrev_b32 v78, 16, v11
    v_and_b32 v86, s25, v11
    v_lshlrev_b32 v79, 16, v15
    v_and_b32 v87, s25, v15
    v_add_f32 v80, v76, v78
    v_add_f32 v88, v84, v86
    v_add_f32 v81, v77, v79
    v_add_f32 v89, v85, v87
    v_fma_f32 v82, v78, 4.0, v76
    v_fma_f32 v90, v86, 4.0, v84
    v_fma_f32 v83, v79, 4.0, v77
    v_fma_f32 v91, v87, 4.0, v85
    v_add_f32 v77, v80, v81
    v_add_f32 v85, v88, v89
    v_sub_f32 v78, v80, v81
    v_sub_f32 v86, v88, v89
    v_fma_f32 v79, v83, 2.0, v82
    v_fma_f32 v87, v91, 2.0, v90
    v_fma_f32 v82, v83, -2.0, v82
    v_fma_f32 v90, v91, -2.0, v90
    v_fmamk_f32 v80, v76, 0x41700000, v82
    v_fmamk_f32 v88, v84, 0x41700000, v90
    v_fmamk_f32 v80, v81, 0x41200000, v80
    v_fmamk_f32 v88, v89, 0x41200000, v88
    v_cvt_pk_bf16_f32 v7, v77, v85
    v_cvt_pk_bf16_f32 v11, v78, v86
    v_cvt_pk_bf16_f32 v67, v79, v87
    v_cvt_pk_bf16_f32 v71, v82, v90
    v_cvt_pk_bf16_f32 v75, v80, v88
    s_add_u32 s28, s28, 1
    s_waitcnt lgkmcnt(0)
    s_barrier
    s_cmp_lt_u32 s28, 12
    s_cselect_b32 s24, 0, 2130706432
    ds_write_b128 v96, v[64:67] offset:49152
    ds_write_b128 v97, v[68:71] offset:0
    ds_write_b128 v97, v[72:75] offset:16384
    ds_write_b128 v96, v[0:3] offset:0
    ds_write_b128 v96, v[4:7] offset:16384
    ds_write_b128 v96, v[8:11] offset:32768
    ds_write_b128 v98, v[12:15] offset:0
    v_lshlrev_b32 v76, 16, v16
    v_and_b32 v84, s25, v16
    v_lshlrev_b32 v77, 16, v20
    v_and_b32 v85, s25, v20
    v_lshlrev_b32 v78, 16, v24
    v_and_b32 v86, s25, v24
    v_lshlrev_b32 v79, 16, v28
    v_and_b32 v87, s25, v28
    v_add_f32 v80, v76, v78
    v_add_f32 v88, v84, v86
    v_add_f32 v81, v77, v79
    v_add_f32 v89, v85, v87
    v_fma_f32 v82, v78, 4.0, v76
    v_fma_f32 v90, v86, 4.0, v84
    v_fma_f32 v83, v79, 4.0, v77
    v_fma_f32 v91, v87, 4.0, v85
    v_add_f32 v77, v80, v81
    v_add_f32 v85, v88, v89
    v_sub_f32 v78, v80, v81
    v_sub_f32 v86, v88, v89
    v_fma_f32 v79, v83, 2.0, v82
    v_fma_f32 v87, v91, 2.0, v90
    v_fma_f32 v82, v83, -2.0, v82
    v_fma_f32 v90, v91, -2.0, v90
    v_fmamk_f32 v80, v76, 0x41700000, v82
    v_fmamk_f32 v88, v84, 0x41700000, v90
    v_fmamk_f32 v80, v81, 0x41200000, v80
    v_fmamk_f32 v88, v89, 0x41200000, v88
    v_cvt_pk_bf16_f32 v20, v77, v85
    v_cvt_pk_bf16_f32 v24, v78, v86
    v_cvt_pk_bf16_f32 v64, v79, v87
    v_cvt_pk_bf16_f32 v68, v82, v90
    v_cvt_pk_bf16_f32 v72, v80, v88
    v_lshlrev_b32 v76, 16, v17
    v_and_b32 v84, s25, v17
    v_lshlrev_b32 v77, 16, v21
    v_and_b32 v85, s25, v21
    v_lshlrev_b32 v78, 16, v25
    v_and_b32 v86, s25, v25
    buffer_load_dwordx4 v[40:43], v94, s[8:11], s24 offen offset:0
    buffer_load_dwordx4 v[56:59], v94, s[8:11], s24 offen offset:64
    v_add_u32 v94, 128, v94
    v_lshlrev_b32 v79, 16, v29
    v_and_b32 v87, s25, v29
    v_add_f32 v80, v76, v78
    v_add_f32 v88, v84, v86
    v_add_f32 v81, v77, v79
    v_add_f32 v89, v85, v87
    v_fma_f32 v82, v78, 4.0, v76
    v_fma_f32 v90, v86, 4.0, v84
    v_fma_f32 v83, v79, 4.0, v77
    v_fma_f32 v91, v87, 4.0, v85
    v_add_f32 v77, v80, v81
    v_add_f32 v85, v88, v89
    v_sub_f32 v78, v80, v81
    v_sub_f32 v86, v88, v89
    v_fma_f32 v79, v83, 2.0, v82
    v_fma_f32 v87, v91, 2.0, v90
    v_fma_f32 v82, v83, -2.0, v82
    v_fma_f32 v90, v91, -2.0, v90
    v_fmamk_f32 v80, v76, 0x41700000, v82
    v_fmamk_f32 v88, v84, 0x41700000, v90
    v_fmamk_f32 v80, v81, 0x41200000, v80
    v_fmamk_f32 v88, v89, 0x41200000, v88
    v_cvt_pk_bf16_f32 v21, v77, v85
    v_cvt_pk_bf16_f32 v25, v78, v86
    v_cvt_pk_bf16_f32 v65, v79, v87
    v_cvt_pk_bf16_f32 v69, v82, v90
    v_cvt_pk_bf16_f32 v73, v80, v88
    buffer_load_dwordx4 v[44:47], v95, s[8:11], s24 offen offset:0
    buffer_load_dwordx4 v[60:63], v95, s[8:11], s24 offen offset:64
    v_add_u32 v95, 128, v95
    v_lshlrev_b32 v76, 16, v18
    v_and_b32 v84, s25, v18
    v_lshlrev_b32 v77, 16, v22
    v_and_b32 v85, s25, v22
    v_lshlrev_b32 v78, 16, v26
    v_and_b32 v86, s25, v26
    v_lshlrev_b32 v79, 16, v30
    v_and_b32 v87, s25, v30
    v_add_f32 v80, v76, v78
    v_add_f32 v88, v84, v86
    v_add_f32 v81, v77, v79
    v_add_f32 v89, v85, v87
    v_fma_f32 v82, v78, 4.0, v76
    v_fma_f32 v90, v86, 4.0, v84
    v_fma_f32 v83, v79, 4.0, v77
    v_fma_f32 v91, v87, 4.0, v85
    v_add_f32 v77, v80, v81
    v_add_f32 v85, v88, v89
    v_sub_f32 v78, v80, v81
    v_sub_f32 v86, v88, v89
    v_fma_f32 v79, v83, 2.0, v82
    v_fma_f32 v87, v91, 2.0, v90
    v_fma_f32 v82, v83, -2.0, v82
    v_fma_f32 v90, v91, -2.0, v90
    v_fmamk_f32 v80, v76, 0x41700000, v82
    v_fmamk_f32 v88, v84, 0x41700000, v90
    v_fmamk_f32 v80, v81, 0x41200000, v80
    v_fmamk_f32 v88, v89, 0x41200000, v88
    v_cvt_pk_bf16_f32 v22, v77, v85
    v_cvt_pk_bf16_f32 v26, v78, v86
    v_cvt_pk_bf16_f32 v66, v79, v87
    v_cvt_pk_bf16_f32 v70, v82, v90
    v_cvt_pk_bf16_f32 v74, v80, v88
    v_lshlrev_b32 v76, 16, v19
    v_and_b32 v84, s25, v19
    v_lshlrev_b32 v77, 16, v23
    v_and_b32 v85, s25, v23
    v_lshlrev_b32 v78, 16, v27
    v_and_b32 v86, s25, v27
    v_lshlrev_b32 v79, 16, v31
    v_and_b32 v87, s25, v31
    v_add_f32 v80, v76, v78
    v_add_f32 v88, v84, v86
    v_add_f32 v81, v77, v79
    v_add_f32 v89, v85, v87
    v_fma_f32 v82, v78, 4.0, v76
    v_fma_f32 v90, v86, 4.0, v84
    v_fma_f32 v83, v79, 4.0, v77
    v_fma_f32 v91, v87, 4.0, v85
    v_add_f32 v77, v80, v81
    v_add_f32 v85, v88, v89
    v_sub_f32 v78, v80, v81
    v_sub_f32 v86, v88, v89
    v_fma_f32 v79, v83, 2.0, v82
    v_fma_f32 v87, v91, 2.0, v90
    v_fma_f32 v82, v83, -2.0, v82
    v_fma_f32 v90, v91, -2.0, v90
    v_fmamk_f32 v80, v76, 0x41700000, v82
    v_fmamk_f32 v88, v84, 0x41700000, v90
    v_fmamk_f32 v80, v81, 0x41200000, v80
    v_fmamk_f32 v88, v89, 0x41200000, v88
    v_cvt_pk_bf16_f32 v23, v77, v85
    v_cvt_pk_bf16_f32 v27, v78, v86
    v_cvt_pk_bf16_f32 v67, v79, v87
    v_cvt_pk_bf16_f32 v71, v82, v90
    v_cvt_pk_bf16_f32 v75, v80, v88
    s_add_u32 s28, s28, 1
    s_waitcnt lgkmcnt(0)
    s_barrier
    s_sub_u32 s22, s22, 1
    s_branch L_conv1_kernel_hloop2
L_conv1_kernel_hlast2:
    s_waitcnt vmcnt(0)
    s_mov_b32 s58, s20
    s_lshl_b32 s20, s2, 2
    s_add_u32 s20, s20, s32
    v_mov_b32 v1, v127
    s_load_dwordx2 s[8:9], s[0:1], 16
    s_lshr_b32 s22, s20, 8
    s_bfe_u32 s23, s20, 0x40004
    s_bfe_u32 s24, s20, 0x30001
    s_and_b32 s21, s20, 1
    v_lshrrev_b32 v2, 4, v1
    v_lshlrev_b32 v2, 12, v2
    v_and_b32 v3, 15, v1
    v_lshl_add_u32 v2, v3, 2, v2
    s_lshl_b32 s26, s22, 3
    s_lshr_b32 s27, s23, 3
    s_add_u32 s26, s26, s27
    s_lshl_b32 s26, s26, 17
    s_and_b32 s27, s23, 7
    s_lshl_b32 s27, s27, 14
    s_add_u32 s26, s26, s27
    s_lshl_b32 s27, s24, 6
    s_add_u32 s26, s26, s27
    s_mov_b32 s10, 4063232
    s_mov_b32 s11, 0x00020000
    s_add_u32 s37, s26, 262144
    s_add_u32 s38, s26, 524288
    s_add_u32 s39, s26, 786432
    s_waitcnt lgkmcnt(0)
    buffer_load_dword v16, v2, s[8:11], s26 offen offset:0
    buffer_load_dword v17, v2, s[8:11], s26 offen offset:512
    buffer_load_dword v24, v2, s[8:11], s37 offen offset:0
    buffer_load_dword v25, v2, s[8:11], s37 offen offset:512
    buffer_load_dword v32, v2, s[8:11], s38 offen offset:0
    buffer_load_dword v33, v2, s[8:11], s38 offen offset:512
    buffer_load_dword v40, v2, s[8:11], s39 offen offset:0
    buffer_load_dword v41, v2, s[8:11], s39 offen offset:512
    buffer_load_dword v18, v2, s[8:11], s26 offen offset:1024
    buffer_load_dword v19, v2, s[8:11], s26 offen offset:1536
    buffer_load_dword v26, v2, s[8:11], s37 offen offset:1024
    buffer_load_dword v27, v2, s[8:11], s37 offen offset:1536
    buffer_load_dword v34, v2, s[8:11], s38 offen offset:1024
    buffer_load_dword v35, v2, s[8:11], s38 offen offset:1536
    buffer_load_dword v42, v2, s[8:11], s39 offen offset:1024
    buffer_load_dword v43, v2, s[8:11], s39 offen offset:1536
    buffer_load_dword v20, v2, s[8:11], s26 offen offset:2048
    buffer_load_dword v21, v2, s[8:11], s26 offen offset:2560
    buffer_load_dword v28, v2, s[8:11], s37 offen offset:2048
    buffer_load_dword v29, v2, s[8:11], s37 offen offset:2560
    buffer_load_dword v36, v2, s[8:11], s38 offen offset:2048
    buffer_load_dword v37, v2, s[8:11], s38 offen offset:2560
    buffer_load_dword v44, v2, s[8:11], s39 offen offset:2048
    buffer_load_dword v45, v2, s[8:11], s39 offen offset:2560
    buffer_load_dword v22, v2, s[8:11], s26 offen offset:3072
    buffer_load_dword v23, v2, s[8:11], s26 offen offset:3584
    buffer_load_dword v30, v2, s[8:11], s37 offen offset:3072
    buffer_load_dword v31, v2, s[8:11], s37 offen offset:3584
    buffer_load_dword v38, v2, s[8:11], s38 offen offset:3072
    buffer_load_dword v39, v2, s[8:11], s38 offen offset:3584
    buffer_load_dword v46, v2, s[8:11], s39 offen offset:3072
    buffer_load_dword v47, v2, s[8:11], s39 offen offset:3584
    s_add_u32 s12, s30, 9437184
    s_addc_u32 s13, s31, 0
    s_mov_b32 s14, 7340032
    s_mov_b32 s15, 0x00020000
    v_lshlrev_b32 v4, 4, v1
    s_lshl_b32 s27, s24, 4
    s_add_u32 s27, s27, s23
    s_mul_i32 s27, s27, 57344
    s_lshl_b32 s28, s22, 11
    s_add_u32 s27, s27, s28
    s_lshl_b32 s28, s21, 10
    s_add_u32 s27, s27, s28
    s_cmp_eq_u32 s21, 0
    s_mov_b32 s32, 0x07060302
    s_cselect_b32 s32, 0x05040100, s32
    s_mov_b32 s33, 0x03020c0c
    s_cselect_b32 s33, 0x01000c0c, s33
    s_mov_b32 s35, 0x3d2aaaab
    s_mov_b32 s36, 0x3c638e39
    s_mov_b32 s25, 0xffff0000
    ds_write_b128 v96, v[64:67] offset:57344
    ds_write_b128 v97, v[68:71] offset:8192
    ds_write_b128 v97, v[72:75] offset:24576
    ds_write_b128 v96, v[48:51] offset:8192
    ds_write_b128 v96, v[52:55] offset:24576
    ds_write_b128 v96, v[56:59] offset:40960
    ds_write_b128 v98, v[60:63] offset:8704
    s_waitcnt lgkmcnt(0)
    s_barrier
    s_waitcnt vmcnt(24)
    v_perm_b32 v72, v17, v16, s32
    v_perm_b32 v48, v41, v40, s32
    v_perm_b32 v76, v76, v40, s33
    v_perm_b32 v84, v84, v41, s33
    v_perm_b32 v77, v77, v32, s33
    v_perm_b32 v85, v85, v33, s33
    v_perm_b32 v78, v78, v24, s33
    v_perm_b32 v86, v86, v25, s33
    v_perm_b32 v79, v79, v16, s33
    v_perm_b32 v87, v87, v17, s33
    v_add_f32 v80, v76, v78
    v_add_f32 v88, v84, v86
    v_add_f32 v81, v77, v79
    v_add_f32 v89, v85, v87
    v_fma_f32 v82, v78, 4.0, v76
    v_fma_f32 v90, v86, 4.0, v84
    v_fma_f32 v83, v79, 4.0, v77
    v_fma_f32 v91, v87, 4.0, v85
    v_add_f32 v77, v80, v81
    v_add_f32 v85, v88, v89
    v_sub_f32 v78, v80, v81
    v_sub_f32 v86, v88, v89
    v_fma_f32 v79, v83, 2.0, v82
    v_fma_f32 v87, v91, 2.0, v90
    v_fma_f32 v82, v83, -2.0, v82
    v_fma_f32 v90, v91, -2.0, v90
    v_fmamk_f32 v80, v76, 0x41700000, v82
    v_fmamk_f32 v88, v84, 0x41700000, v90
    v_fmamk_f32 v80, v81, 0x41200000, v80
    v_fmamk_f32 v88, v89, 0x41200000, v88
    v_mul_f32 v77, 0.5, v77
    v_mul_f32 v85, 0.5, v85
    v_mul_f32 v78, 0.5, v78
    v_mul_f32 v86, 0.5, v86
    v_mul_f32 v79, s35, v79
    v_mul_f32 v87, s35, v87
    v_mul_f32 v82, s35, v82
    v_mul_f32 v90, s35, v90
    v_mul_f32 v80, s36, v80
    v_mul_f32 v88, s36, v88
    v_cvt_pk_bf16_f32 v52, v77, v85
    v_cvt_pk_bf16_f32 v56, v78, v86
    v_cvt_pk_bf16_f32 v60, v79, v87
    v_cvt_pk_bf16_f32 v64, v82, v90
    v_cvt_pk_bf16_f32 v68, v80, v88
    s_waitcnt vmcnt(16)
    v_perm_b32 v73, v19, v18, s32
    v_perm_b32 v49, v43, v42, s32
    v_perm_b32 v76, v76, v42, s33
    v_perm_b32 v84, v84, v43, s33
    v_perm_b32 v77, v77, v34, s33
    v_perm_b32 v85, v85, v35, s33
    v_perm_b32 v78, v78, v26, s33
    v_perm_b32 v86, v86, v27, s33
    v_perm_b32 v79, v79, v18, s33
    v_perm_b32 v87, v87, v19, s33
    v_add_f32 v80, v76, v78
    v_add_f32 v88, v84, v86
    v_add_f32 v81, v77, v79
    v_add_f32 v89, v85, v87
    v_fma_f32 v82, v78, 4.0, v76
    v_fma_f32 v90, v86, 4.0, v84
    v_fma_f32 v83, v79, 4.0, v77
    v_fma_f32 v91, v87, 4.0, v85
    v_add_f32 v77, v80, v81
    v_add_f32 v85, v88, v89
    v_sub_f32 v78, v80, v81
    v_sub_f32 v86, v88, v89
    v_fma_f32 v79, v83, 2.0, v82
    v_fma_f32 v87, v91, 2.0, v90
    v_fma_f32 v82, v83, -2.0, v82
    v_fma_f32 v90, v91, -2.0, v90
    v_fmamk_f32 v80, v76, 0x41700000, v82
    v_fmamk_f32 v88, v84, 0x41700000, v90
    v_fmamk_f32 v80, v81, 0x41200000, v80
    v_fmamk_f32 v88, v89, 0x41200000, v88
    v_mul_f32 v77, 0.5, v77
    v_mul_f32 v85, 0.5, v85
    v_mul_f32 v78, 0.5, v78
    v_mul_f32 v86, 0.5, v86
    v_mul_f32 v79, s35, v79
    v_mul_f32 v87, s35, v87
    v_mul_f32 v82, s35, v82
    v_mul_f32 v90, s35, v90
    v_mul_f32 v80, s36, v80
    v_mul_f32 v88, s36, v88
    v_cvt_pk_bf16_f32 v53, v77, v85
    v_cvt_pk_bf16_f32 v57, v78, v86
    v_cvt_pk_bf16_f32 v61, v79, v87
    v_cvt_pk_bf16_f32 v65, v82, v90
    v_cvt_pk_bf16_f32 v69, v80, v88
    s_waitcnt vmcnt(8)
    v_perm_b32 v74, v21, v20, s32
    v_perm_b32 v50, v45, v44, s32
    v_perm_b32 v76, v76, v44, s33
    v_perm_b32 v84, v84, v45, s33
    v_perm_b32 v77, v77, v36, s33
    v_perm_b32 v85, v85, v37, s33
    v_perm_b32 v78, v78, v28, s33
    v_perm_b32 v86, v86, v29, s33
    v_perm_b32 v79, v79, v20, s33
    v_perm_b32 v87, v87, v21, s33
    v_add_f32 v80, v76, v78
    v_add_f32 v88, v84, v86
    v_add_f32 v81, v77, v79
    v_add_f32 v89, v85, v87
    v_fma_f32 v82, v78, 4.0, v76
    v_fma_f32 v90, v86, 4.0, v84
    v_fma_f32 v83, v79, 4.0, v77
    v_fma_f32 v91, v87, 4.0, v85
    v_add_f32 v77, v80, v81
    v_add_f32 v85, v88, v89
    v_sub_f32 v78, v80, v81
    v_sub_f32 v86, v88, v89
    v_fma_f32 v79, v83, 2.0, v82
    v_fma_f32 v87, v91, 2.0, v90
    v_fma_f32 v82, v83, -2.0, v82
    v_fma_f32 v90, v91, -2.0, v90
    v_fmamk_f32 v80, v76, 0x41700000, v82
    v_fmamk_f32 v88, v84, 0x41700000, v90
    v_fmamk_f32 v80, v81, 0x41200000, v80
    v_fmamk_f32 v88, v89, 0x41200000, v88
    v_mul_f32 v77, 0.5, v77
    v_mul_f32 v85, 0.5, v85
    v_mul_f32 v78, 0.5, v78
    v_mul_f32 v86, 0.5, v86
    v_mul_f32 v79, s35, v79
    v_mul_f32 v87, s35, v87
    v_mul_f32 v82, s35, v82
    v_mul_f32 v90, s35, v90
    v_mul_f32 v80, s36, v80
    v_mul_f32 v88, s36, v88
    v_cvt_pk_bf16_f32 v54, v77, v85
    v_cvt_pk_bf16_f32 v58, v78, v86
    v_cvt_pk_bf16_f32 v62, v79, v87
    v_cvt_pk_bf16_f32 v66, v82, v90
    v_cvt_pk_bf16_f32 v70, v80, v88
    s_waitcnt vmcnt(0)
    v_perm_b32 v75, v23, v22, s32
    v_perm_b32 v51, v47, v46, s32
    v_perm_b32 v76, v76, v46, s33
    v_perm_b32 v84, v84, v47, s33
    v_perm_b32 v77, v77, v38, s33
    v_perm_b32 v85, v85, v39, s33
    v_perm_b32 v78, v78, v30, s33
    v_perm_b32 v86, v86, v31, s33
    v_perm_b32 v79, v79, v22, s33
    v_perm_b32 v87, v87, v23, s33
    v_add_f32 v80, v76, v78
    v_add_f32 v88, v84, v86
    v_add_f32 v81, v77, v79
    v_add_f32 v89, v85, v87
    v_fma_f32 v82, v78, 4.0, v76
    v_fma_f32 v90, v86, 4.0, v84
    v_fma_f32 v83, v79, 4.0, v77
    v_fma_f32 v91, v87, 4.0, v85
    v_add_f32 v77, v80, v81
    v_add_f32 v85, v88, v89
    v_sub_f32 v78, v80, v81
    v_sub_f32 v86, v88, v89
    v_fma_f32 v79, v83, 2.0, v82
    v_fma_f32 v87, v91, 2.0, v90
    v_fma_f32 v82, v83, -2.0, v82
    v_fma_f32 v90, v91, -2.0, v90
    v_fmamk_f32 v80, v76, 0x41700000, v82
    v_fmamk_f32 v88, v84, 0x41700000, v90
    v_fmamk_f32 v80, v81, 0x41200000, v80
    v_fmamk_f32 v88, v89, 0x41200000, v88
    v_mul_f32 v77, 0.5, v77
    v_mul_f32 v85, 0.5, v85
    v_mul_f32 v78, 0.5, v78
    v_mul_f32 v86, 0.5, v86
    v_mul_f32 v79, s35, v79
    v_mul_f32 v87, s35, v87
    v_mul_f32 v82, s35, v82
    v_mul_f32 v90, s35, v90
    v_mul_f32 v80, s36, v80
    v_mul_f32 v88, s36, v88
    v_cvt_pk_bf16_f32 v55, v77, v85
    v_cvt_pk_bf16_f32 v59, v78, v86
    v_cvt_pk_bf16_f32 v63, v79, v87
    v_cvt_pk_bf16_f32 v67, v82, v90
    v_cvt_pk_bf16_f32 v71, v80, v88
    s_add_u32 s28, s27, 49152
    buffer_store_dwordx4 v[72:75], v4, s[12:15], s28 offen sc1
    s_add_u32 s28, s27, 0
    buffer_store_dwordx4 v[48:51], v4, s[12:15], s28 offen sc1
    s_add_u32 s28, s27, 8192
    buffer_store_dwordx4 v[52:55], v4, s[12:15], s28 offen sc1
    s_add_u32 s28, s27, 16384
    buffer_store_dwordx4 v[56:59], v4, s[12:15], s28 offen sc1
    s_add_u32 s28, s27, 24576
    buffer_store_dwordx4 v[60:63], v4, s[12:15], s28 offen sc1
    s_add_u32 s28, s27, 32768
    buffer_store_dwordx4 v[64:67], v4, s[12:15], s28 offen sc1
    s_add_u32 s28, s27, 40960
    buffer_store_dwordx4 v[68:71], v4, s[12:15], s28 offen sc1
    s_mov_b32 s20, s58
    s_branch L_conv1_kernel_end
L_conv1_kernel_mw:
    s_add_u32 s37, s41, 524288
    v_lshl_add_u32 v108, v127, 4, s37
    v_add_u32 v109, 1024, v108
    v_add_u32 v110, 2048, v108
    s_waitcnt lgkmcnt(0)
    s_add_u32 s8, s4, s47
    s_addc_u32 s9, s5, 0
    s_lshl_b32 s36, s29, 4
    s_lshl_b32 s37, s33, 3
    s_add_u32 s36, s36, s37
    s_mul_i32 s36, s36, 57344
    s_add_u32 s36, s36, 0
    s_add_u32 s12, s30, s36
    s_addc_u32 s13, s31, 0
    s_mov_b32 s14, 917504
    s_mov_b32 s15, 0x00020000
    s_mul_i32 s36, s35, 4194304
    s_add_u32 s36, s36, 18874368
    s_add_u32 s16, s30, s36
    s_addc_u32 s17, s31, 0
    s_mov_b32 s18, 4194304
    s_mov_b32 s19, 0x00020000
    v_and_b32 v10, 15, v127
    v_lshrrev_b32 v11, 4, v127
    v_add_u32 v8, 0, v10
    v_and_b32 v16, 4, v8
    v_lshrrev_b32 v16, 1, v16
    v_xor_b32 v16, v11, v16
    v_lshlrev_b32 v16, 4, v16
    v_lshl_add_u32 v8, v8, 6, v16
    v_add_u32 v9, 1, v10
    v_and_b32 v16, 4, v9
    v_lshrrev_b32 v16, 1, v16
    v_xor_b32 v16, v11, v16
    v_lshlrev_b32 v16, 4, v16
    v_lshl_add_u32 v9, v9, 6, v16
    s_lshr_b32 s38, s32, 1
    s_and_b32 s39, s32, 1
    s_add_u32 s40, s38, 4
    s_lshl_b32 s43, s39, 10
    s_cmp_lt_u32 s20, 4
    s_cselect_b32 s40, s20, s40
    s_cselect_b32 s36, 0, s43
    s_lshl_b32 s37, s40, 13
    s_add_u32 s37, s37, s36
    v_lshl_add_u32 v125, v127, 4, s37
    s_mul_i32 s37, s40, 16384
    v_add_u32 v120, s37, v8
    v_add_u32 v121, s37, v9
    s_lshl_b32 s37, s40, 10
    s_add_u32 s37, s37, 115712
    v_lshl_add_u32 v16, v11, 4, s37
    v_cmp_eq_u32 vcc, 15, v10
    v_mov_b32 v17, 8192
    v_mov_b32 v18, 4294959104
    v_mov_b32 v19, 64
    v_cndmask_b32 v122, v121, v16, vcc
    v_cndmask_b32 v123, v17, v19, vcc
    v_cndmask_b32 v124, v18, v19, vcc
    v_lshl_add_u32 v126, v127, 4, s37
    s_mov_b32 s44, 0x3f800000
    s_mov_b32 s45, 0x00000000
    s_mov_b32 s46, 0x00000000
    s_cmp_eq_u32 s40, 1
    s_cselect_b32 s45, 0x3f800000, s45
    s_cselect_b32 s46, 0x3f800000, s46
    s_cmp_eq_u32 s40, 2
    s_cselect_b32 s45, 0xbf800000, s45
    s_cselect_b32 s46, 0x3f800000, s46
    s_cmp_eq_u32 s40, 3
    s_cselect_b32 s45, 0x40000000, s45
    s_cselect_b32 s46, 0x40800000, s46
    s_cmp_eq_u32 s40, 4
    s_cselect_b32 s45, 0xc0000000, s45
    s_cselect_b32 s46, 0x40800000, s46
    s_cmp_eq_u32 s40, 5
    s_cselect_b32 s44, 0x41800000, s44
    s_cselect_b32 s45, 0x41000000, s45
    s_cselect_b32 s46, 0x40800000, s46
    s_cmp_ge_u32 s20, 4
    s_cbranch_scc1 L_conv1_kernel_m2
    v_mov_b32 v0, 0
    v_mov_b32 v1, 0
    v_mov_b32 v2, 0
    v_mov_b32 v3, 0
    v_mov_b32 v4, 0
    v_mov_b32 v5, 0
    v_mov_b32 v6, 0
    v_mov_b32 v7, 0
    v_mov_b32 v8, 0
    v_mov_b32 v9, 0
    v_mov_b32 v10, 0
    v_mov_b32 v11, 0
    v_mov_b32 v12, 0
    v_mov_b32 v13, 0
    v_mov_b32 v14, 0
    v_mov_b32 v15, 0
    v_mov_b32 v16, 0
    v_mov_b32 v17, 0
    v_mov_b32 v18, 0
    v_mov_b32 v19, 0
    v_mov_b32 v20, 0
    v_mov_b32 v21, 0
    v_mov_b32 v22, 0
    v_mov_b32 v23, 0
    v_mov_b32 v24, 0
    v_mov_b32 v25, 0
    v_mov_b32 v26, 0
    v_mov_b32 v27, 0
    v_mov_b32 v28, 0
    v_mov_b32 v29, 0
    v_mov_b32 v30, 0
    v_mov_b32 v31, 0
    v_mov_b32 v32, 0
    v_mov_b32 v33, 0
    v_mov_b32 v34, 0
    v_mov_b32 v35, 0
    v_mov_b32 v36, 0
    v_mov_b32 v37, 0
    v_mov_b32 v38, 0
    v_mov_b32 v39, 0
    v_mov_b32 v40, 0
    v_mov_b32 v41, 0
    v_mov_b32 v42, 0
    v_mov_b32 v43, 0
    v_mov_b32 v44, 0
    v_mov_b32 v45, 0
    v_mov_b32 v46, 0
    v_mov_b32 v47, 0
    v_mov_b32 v48, 0
    v_mov_b32 v49, 0
    v_mov_b32 v50, 0
    v_mov_b32 v51, 0
    v_mov_b32 v52, 0
    v_mov_b32 v53, 0
    v_mov_b32 v54, 0
    v_mov_b32 v55, 0
    v_mov_b32 v56, 0
    v_mov_b32 v57, 0
    v_mov_b32 v58, 0
    v_mov_b32 v59, 0
    v_mov_b32 v60, 0
    v_mov_b32 v61, 0
    v_mov_b32 v62, 0
    v_mov_b32 v63, 0
    buffer_load_dwordx4 v[96:99], v108, s[8:11], 0 offen
    buffer_load_dwordx4 v[100:103], v109, s[8:11], 0 offen
    buffer_load_dwordx4 v[104:107], v110, s[8:11], 0 offen
    s_mov_b32 s23, 0
    s_mov_b32 s26, 4096
    buffer_load_dwordx4 v[64:67], v125, s[12:15], s23 offen offset:0
    buffer_load_dwordx4 v[68:71], v125, s[12:15], s23 offen offset:1024
    buffer_load_dwordx4 v[72:75], v125, s[12:15], s23 offen offset:2048
    buffer_load_dwordx4 v[76:79], v125, s[12:15], s23 offen offset:3072
    buffer_load_dwordx4 v[80:83], v125, s[12:15], s26 offen offset:0
    buffer_load_dwordx4 v[84:87], v125, s[12:15], s26 offen offset:1024
    buffer_load_dwordx4 v[88:91], v125, s[12:15], s26 offen offset:2048
    buffer_load_dwordx4 v[92:95], v125, s[12:15], s26 offen offset:3072
    s_mov_b32 s23, 57344
    s_mov_b32 s26, 61440
    s_waitcnt vmcnt(8)
    v_lshlrev_b32 v108, 16, v96
    v_and_b32 v111, s25, v96
    v_lshlrev_b32 v109, 16, v100
    v_and_b32 v112, s25, v100
    v_lshlrev_b32 v110, 16, v104
    v_and_b32 v113, s25, v104
    v_mul_f32 v114, s44, v108
    v_mul_f32 v115, s44, v111
    v_fmac_f32 v114, s45, v109
    v_fmac_f32 v115, s45, v112
    v_fmac_f32 v114, s46, v110
    v_fmac_f32 v115, s46, v113
    v_cvt_pk_bf16_f32 v96, v114, v115
    v_lshlrev_b32 v108, 16, v97
    v_and_b32 v111, s25, v97
    v_lshlrev_b32 v109, 16, v101
    v_and_b32 v112, s25, v101
    v_lshlrev_b32 v110, 16, v105
    v_and_b32 v113, s25, v105
    v_mul_f32 v114, s44, v108
    v_mul_f32 v115, s44, v111
    v_fmac_f32 v114, s45, v109
    v_fmac_f32 v115, s45, v112
    v_fmac_f32 v114, s46, v110
    v_fmac_f32 v115, s46, v113
    v_cvt_pk_bf16_f32 v97, v114, v115
    v_lshlrev_b32 v108, 16, v98
    v_and_b32 v111, s25, v98
    v_lshlrev_b32 v109, 16, v102
    v_and_b32 v112, s25, v102
    v_lshlrev_b32 v110, 16, v106
    v_and_b32 v113, s25, v106
    v_mul_f32 v114, s44, v108
    v_mul_f32 v115, s44, v111
    v_fmac_f32 v114, s45, v109
    v_fmac_f32 v115, s45, v112
    v_fmac_f32 v114, s46, v110
    v_fmac_f32 v115, s46, v113
    v_cvt_pk_bf16_f32 v98, v114, v115
    v_lshlrev_b32 v108, 16, v99
    v_and_b32 v111, s25, v99
    v_lshlrev_b32 v109, 16, v103
    v_and_b32 v112, s25, v103
    v_lshlrev_b32 v110, 16, v107
    v_and_b32 v113, s25, v107
    v_mul_f32 v114, s44, v108
    v_mul_f32 v115, s44, v111
    v_fmac_f32 v114, s45, v109
    v_fmac_f32 v115, s45, v112
    v_fmac_f32 v114, s46, v110
    v_fmac_f32 v115, s46, v113
    v_cvt_pk_bf16_f32 v99, v114, v115
    ds_write_b128 v126, v[96:99]
    s_waitcnt lgkmcnt(0)
    s_barrier
    s_mov_b32 s22, 8
    s_setprio 2
L_conv1_kernel_mloop1:
    ds_read_b128 v[96:99], v120 offset:0
    ds_read_b128 v[100:103], v120 offset:1024
    ds_read_b128 v[104:107], v120 offset:2048
    ds_read_b128 v[108:111], v120 offset:3072
    ds_read_b128 v[112:115], v120 offset:4096
    ds_read_b128 v[116:119], v120 offset:5120
    s_waitcnt vmcnt(6) lgkmcnt(5)
    v_mfma_f32_16x16x32_bf16 v[0:3], v[64:67], v[96:99], v[0:3]
    v_mfma_f32_16x16x32_bf16 v[32:35], v[68:71], v[96:99], v[32:35]
    ds_read_b128 v[96:99], v120 offset:6144
    s_waitcnt vmcnt(4) lgkmcnt(5)
    v_mfma_f32_16x16x32_bf16 v[4:7], v[64:67], v[100:103], v[4:7]
    v_mfma_f32_16x16x32_bf16 v[36:39], v[68:71], v[100:103], v[36:39]
    v_mfma_f32_16x16x32_bf16 v[0:3], v[72:75], v[100:103], v[0:3]
    v_mfma_f32_16x16x32_bf16 v[32:35], v[76:79], v[100:103], v[32:35]
    ds_read_b128 v[100:103], v120 offset:7168
    s_waitcnt vmcnt(2) lgkmcnt(5)
    v_mfma_f32_16x16x32_bf16 v[8:11], v[64:67], v[104:107], v[8:11]
    v_mfma_f32_16x16x32_bf16 v[40:43], v[68:71], v[104:107], v[40:43]
    v_mfma_f32_16x16x32_bf16 v[4:7], v[72:75], v[104:107], v[4:7]
    v_mfma_f32_16x16x32_bf16 v[36:39], v[76:79], v[104:107], v[36:39]
    v_mfma_f32_16x16x32_bf16 v[0:3], v[80:83], v[104:107], v[0:3]
    v_mfma_f32_16x16x32_bf16 v[32:35], v[84:87], v[104:107], v[32:35]
    ds_read_b128 v[104:107], v122 offset:0
    v_add_u32 v122, v123, v122
    s_waitcnt vmcnt(0) lgkmcnt(5)
    v_mfma_f32_16x16x32_bf16 v[12:15], v[64:67], v[108:111], v[12:15]
    v_mfma_f32_16x16x32_bf16 v[44:47], v[68:71], v[108:111], v[44:47]
    v_mfma_f32_16x16x32_bf16 v[8:11], v[72:75], v[108:111], v[8:11]
    v_mfma_f32_16x16x32_bf16 v[40:43], v[76:79], v[108:111], v[40:43]
    v_mfma_f32_16x16x32_bf16 v[4:7], v[80:83], v[108:111], v[4:7]
    v_mfma_f32_16x16x32_bf16 v[36:39], v[84:87], v[108:111], v[36:39]
    v_mfma_f32_16x16x32_bf16 v[0:3], v[88:91], v[108:111], v[0:3]
    v_mfma_f32_16x16x32_bf16 v[32:35], v[92:95], v[108:111], v[32:35]
    ds_read_b128 v[108:111], v121 offset:1024
    s_waitcnt lgkmcnt(5)
    v_mfma_f32_16x16x32_bf16 v[16:19], v[64:67], v[112:115], v[16:19]
    v_mfma_f32_16x16x32_bf16 v[48:51], v[68:71], v[112:115], v[48:51]
    v_mfma_f32_16x16x32_bf16 v[12:15], v[72:75], v[112:115], v[12:15]
    v_mfma_f32_16x16x32_bf16 v[44:47], v[76:79], v[112:115], v[44:47]
    v_mfma_f32_16x16x32_bf16 v[8:11], v[80:83], v[112:115], v[8:11]
    v_mfma_f32_16x16x32_bf16 v[40:43], v[84:87], v[112:115], v[40:43]
    v_mfma_f32_16x16x32_bf16 v[4:7], v[88:91], v[112:115], v[4:7]
    v_mfma_f32_16x16x32_bf16 v[36:39], v[92:95], v[112:115], v[36:39]
    ds_read_b128 v[112:115], v121 offset:2048
    s_waitcnt lgkmcnt(5)
    v_mfma_f32_16x16x32_bf16 v[20:23], v[64:67], v[116:119], v[20:23]
    v_mfma_f32_16x16x32_bf16 v[52:55], v[68:71], v[116:119], v[52:55]
    v_mfma_f32_16x16x32_bf16 v[16:19], v[72:75], v[116:119], v[16:19]
    v_mfma_f32_16x16x32_bf16 v[48:51], v[76:79], v[116:119], v[48:51]
    v_mfma_f32_16x16x32_bf16 v[12:15], v[80:83], v[116:119], v[12:15]
    v_mfma_f32_16x16x32_bf16 v[44:47], v[84:87], v[116:119], v[44:47]
    v_mfma_f32_16x16x32_bf16 v[8:11], v[88:91], v[116:119], v[8:11]
    v_mfma_f32_16x16x32_bf16 v[40:43], v[92:95], v[116:119], v[40:43]
    s_waitcnt lgkmcnt(4)
    v_mfma_f32_16x16x32_bf16 v[24:27], v[64:67], v[96:99], v[24:27]
    v_mfma_f32_16x16x32_bf16 v[56:59], v[68:71], v[96:99], v[56:59]
    v_mfma_f32_16x16x32_bf16 v[20:23], v[72:75], v[96:99], v[20:23]
    v_mfma_f32_16x16x32_bf16 v[52:55], v[76:79], v[96:99], v[52:55]
    v_mfma_f32_16x16x32_bf16 v[16:19], v[80:83], v[96:99], v[16:19]
    v_mfma_f32_16x16x32_bf16 v[48:51], v[84:87], v[96:99], v[48:51]
    v_mfma_f32_16x16x32_bf16 v[12:15], v[88:91], v[96:99], v[12:15]
    v_mfma_f32_16x16x32_bf16 v[44:47], v[92:95], v[96:99], v[44:47]
    s_waitcnt lgkmcnt(3)
    v_mfma_f32_16x16x32_bf16 v[28:31], v[64:67], v[100:103], v[28:31]
    v_mfma_f32_16x16x32_bf16 v[60:63], v[68:71], v[100:103], v[60:63]
    v_mfma_f32_16x16x32_bf16 v[24:27], v[72:75], v[100:103], v[24:27]
    v_mfma_f32_16x16x32_bf16 v[56:59], v[76:79], v[100:103], v[56:59]
    v_mfma_f32_16x16x32_bf16 v[20:23], v[80:83], v[100:103], v[20:23]
    v_mfma_f32_16x16x32_bf16 v[52:55], v[84:87], v[100:103], v[52:55]
    v_mfma_f32_16x16x32_bf16 v[16:19], v[88:91], v[100:103], v[16:19]
    v_mfma_f32_16x16x32_bf16 v[48:51], v[92:95], v[100:103], v[48:51]
    buffer_load_dwordx4 v[64:67], v125, s[12:15], s23 offen offset:0
    buffer_load_dwordx4 v[68:71], v125, s[12:15], s23 offen offset:1024
    s_waitcnt lgkmcnt(2)
    v_mfma_f32_16x16x32_bf16 v[28:31], v[72:75], v[104:107], v[28:31]
    v_mfma_f32_16x16x32_bf16 v[60:63], v[76:79], v[104:107], v[60:63]
    v_mfma_f32_16x16x32_bf16 v[24:27], v[80:83], v[104:107], v[24:27]
    v_mfma_f32_16x16x32_bf16 v[56:59], v[84:87], v[104:107], v[56:59]
    v_mfma_f32_16x16x32_bf16 v[20:23], v[88:91], v[104:107], v[20:23]
    v_mfma_f32_16x16x32_bf16 v[52:55], v[92:95], v[104:107], v[52:55]
    buffer_load_dwordx4 v[72:75], v125, s[12:15], s23 offen offset:2048
    buffer_load_dwordx4 v[76:79], v125, s[12:15], s23 offen offset:3072
    s_waitcnt lgkmcnt(1)
    v_mfma_f32_16x16x32_bf16 v[28:31], v[80:83], v[108:111], v[28:31]
    v_mfma_f32_16x16x32_bf16 v[60:63], v[84:87], v[108:111], v[60:63]
    v_mfma_f32_16x16x32_bf16 v[24:27], v[88:91], v[108:111], v[24:27]
    v_mfma_f32_16x16x32_bf16 v[56:59], v[92:95], v[108:111], v[56:59]
    buffer_load_dwordx4 v[80:83], v125, s[12:15], s26 offen offset:0
    buffer_load_dwordx4 v[84:87], v125, s[12:15], s26 offen offset:1024
    s_waitcnt lgkmcnt(0)
    v_mfma_f32_16x16x32_bf16 v[28:31], v[88:91], v[112:115], v[28:31]
    v_mfma_f32_16x16x32_bf16 v[60:63], v[92:95], v[112:115], v[60:63]
    buffer_load_dwordx4 v[88:91], v125, s[12:15], s26 offen offset:2048
    buffer_load_dwordx4 v[92:95], v125, s[12:15], s26 offen offset:3072
    s_add_u32 s23, s23, 57344
    s_add_u32 s26, s26, 57344
    s_barrier
    s_sub_u32 s22, s22, 1
    s_cmp_eq_u32 s22, 0
    s_cbranch_scc1 L_conv1_kernel_mlast1
    ds_read_b128 v[96:99], v120 offset:8192
    ds_read_b128 v[100:103], v120 offset:9216
    ds_read_b128 v[104:107], v120 offset:10240
    ds_read_b128 v[108:111], v120 offset:11264
    ds_read_b128 v[112:115], v120 offset:12288
    ds_read_b128 v[116:119], v120 offset:13312
    s_waitcnt vmcnt(6) lgkmcnt(5)
    v_mfma_f32_16x16x32_bf16 v[0:3], v[64:67], v[96:99], v[0:3]
    v_mfma_f32_16x16x32_bf16 v[32:35], v[68:71], v[96:99], v[32:35]
    ds_read_b128 v[96:99], v120 offset:14336
    s_waitcnt vmcnt(4) lgkmcnt(5)
    v_mfma_f32_16x16x32_bf16 v[4:7], v[64:67], v[100:103], v[4:7]
    v_mfma_f32_16x16x32_bf16 v[36:39], v[68:71], v[100:103], v[36:39]
    v_mfma_f32_16x16x32_bf16 v[0:3], v[72:75], v[100:103], v[0:3]
    v_mfma_f32_16x16x32_bf16 v[32:35], v[76:79], v[100:103], v[32:35]
    ds_read_b128 v[100:103], v120 offset:15360
    s_waitcnt vmcnt(2) lgkmcnt(5)
    v_mfma_f32_16x16x32_bf16 v[8:11], v[64:67], v[104:107], v[8:11]
    v_mfma_f32_16x16x32_bf16 v[40:43], v[68:71], v[104:107], v[40:43]
    v_mfma_f32_16x16x32_bf16 v[4:7], v[72:75], v[104:107], v[4:7]
    v_mfma_f32_16x16x32_bf16 v[36:39], v[76:79], v[104:107], v[36:39]
    v_mfma_f32_16x16x32_bf16 v[0:3], v[80:83], v[104:107], v[0:3]
    v_mfma_f32_16x16x32_bf16 v[32:35], v[84:87], v[104:107], v[32:35]
    ds_read_b128 v[104:107], v122 offset:0
    v_add_u32 v122, v124, v122
    s_waitcnt vmcnt(0) lgkmcnt(5)
    v_mfma_f32_16x16x32_bf16 v[12:15], v[64:67], v[108:111], v[12:15]
    v_mfma_f32_16x16x32_bf16 v[44:47], v[68:71], v[108:111], v[44:47]
    v_mfma_f32_16x16x32_bf16 v[8:11], v[72:75], v[108:111], v[8:11]
    v_mfma_f32_16x16x32_bf16 v[40:43], v[76:79], v[108:111], v[40:43]
    v_mfma_f32_16x16x32_bf16 v[4:7], v[80:83], v[108:111], v[4:7]
    v_mfma_f32_16x16x32_bf16 v[36:39], v[84:87], v[108:111], v[36:39]
    v_mfma_f32_16x16x32_bf16 v[0:3], v[88:91], v[108:111], v[0:3]
    v_mfma_f32_16x16x32_bf16 v[32:35], v[92:95], v[108:111], v[32:35]
    ds_read_b128 v[108:111], v121 offset:9216
    s_waitcnt lgkmcnt(5)
    v_mfma_f32_16x16x32_bf16 v[16:19], v[64:67], v[112:115], v[16:19]
    v_mfma_f32_16x16x32_bf16 v[48:51], v[68:71], v[112:115], v[48:51]
    v_mfma_f32_16x16x32_bf16 v[12:15], v[72:75], v[112:115], v[12:15]
    v_mfma_f32_16x16x32_bf16 v[44:47], v[76:79], v[112:115], v[44:47]
    v_mfma_f32_16x16x32_bf16 v[8:11], v[80:83], v[112:115], v[8:11]
    v_mfma_f32_16x16x32_bf16 v[40:43], v[84:87], v[112:115], v[40:43]
    v_mfma_f32_16x16x32_bf16 v[4:7], v[88:91], v[112:115], v[4:7]
    v_mfma_f32_16x16x32_bf16 v[36:39], v[92:95], v[112:115], v[36:39]
    ds_read_b128 v[112:115], v121 offset:10240
    s_waitcnt lgkmcnt(5)
    v_mfma_f32_16x16x32_bf16 v[20:23], v[64:67], v[116:119], v[20:23]
    v_mfma_f32_16x16x32_bf16 v[52:55], v[68:71], v[116:119], v[52:55]
    v_mfma_f32_16x16x32_bf16 v[16:19], v[72:75], v[116:119], v[16:19]
    v_mfma_f32_16x16x32_bf16 v[48:51], v[76:79], v[116:119], v[48:51]
    v_mfma_f32_16x16x32_bf16 v[12:15], v[80:83], v[116:119], v[12:15]
    v_mfma_f32_16x16x32_bf16 v[44:47], v[84:87], v[116:119], v[44:47]
    v_mfma_f32_16x16x32_bf16 v[8:11], v[88:91], v[116:119], v[8:11]
    v_mfma_f32_16x16x32_bf16 v[40:43], v[92:95], v[116:119], v[40:43]
    s_waitcnt lgkmcnt(4)
    v_mfma_f32_16x16x32_bf16 v[24:27], v[64:67], v[96:99], v[24:27]
    v_mfma_f32_16x16x32_bf16 v[56:59], v[68:71], v[96:99], v[56:59]
    v_mfma_f32_16x16x32_bf16 v[20:23], v[72:75], v[96:99], v[20:23]
    v_mfma_f32_16x16x32_bf16 v[52:55], v[76:79], v[96:99], v[52:55]
    v_mfma_f32_16x16x32_bf16 v[16:19], v[80:83], v[96:99], v[16:19]
    v_mfma_f32_16x16x32_bf16 v[48:51], v[84:87], v[96:99], v[48:51]
    v_mfma_f32_16x16x32_bf16 v[12:15], v[88:91], v[96:99], v[12:15]
    v_mfma_f32_16x16x32_bf16 v[44:47], v[92:95], v[96:99], v[44:47]
    s_waitcnt lgkmcnt(3)
    v_mfma_f32_16x16x32_bf16 v[28:31], v[64:67], v[100:103], v[28:31]
    v_mfma_f32_16x16x32_bf16 v[60:63], v[68:71], v[100:103], v[60:63]
    v_mfma_f32_16x16x32_bf16 v[24:27], v[72:75], v[100:103], v[24:27]
    v_mfma_f32_16x16x32_bf16 v[56:59], v[76:79], v[100:103], v[56:59]
    v_mfma_f32_16x16x32_bf16 v[20:23], v[80:83], v[100:103], v[20:23]
    v_mfma_f32_16x16x32_bf16 v[52:55], v[84:87], v[100:103], v[52:55]
    v_mfma_f32_16x16x32_bf16 v[16:19], v[88:91], v[100:103], v[16:19]
    v_mfma_f32_16x16x32_bf16 v[48:51], v[92:95], v[100:103], v[48:51]
    buffer_load_dwordx4 v[64:67], v125, s[12:15], s23 offen offset:0
    buffer_load_dwordx4 v[68:71], v125, s[12:15], s23 offen offset:1024
    s_waitcnt lgkmcnt(2)
    v_mfma_f32_16x16x32_bf16 v[28:31], v[72:75], v[104:107], v[28:31]
    v_mfma_f32_16x16x32_bf16 v[60:63], v[76:79], v[104:107], v[60:63]
    v_mfma_f32_16x16x32_bf16 v[24:27], v[80:83], v[104:107], v[24:27]
    v_mfma_f32_16x16x32_bf16 v[56:59], v[84:87], v[104:107], v[56:59]
    v_mfma_f32_16x16x32_bf16 v[20:23], v[88:91], v[104:107], v[20:23]
    v_mfma_f32_16x16x32_bf16 v[52:55], v[92:95], v[104:107], v[52:55]
    buffer_load_dwordx4 v[72:75], v125, s[12:15], s23 offen offset:2048
    buffer_load_dwordx4 v[76:79], v125, s[12:15], s23 offen offset:3072
    s_waitcnt lgkmcnt(1)
    v_mfma_f32_16x16x32_bf16 v[28:31], v[80:83], v[108:111], v[28:31]
    v_mfma_f32_16x16x32_bf16 v[60:63], v[84:87], v[108:111], v[60:63]
    v_mfma_f32_16x16x32_bf16 v[24:27], v[88:91], v[108:111], v[24:27]
    v_mfma_f32_16x16x32_bf16 v[56:59], v[92:95], v[108:111], v[56:59]
    buffer_load_dwordx4 v[80:83], v125, s[12:15], s26 offen offset:0
    buffer_load_dwordx4 v[84:87], v125, s[12:15], s26 offen offset:1024
    s_waitcnt lgkmcnt(0)
    v_mfma_f32_16x16x32_bf16 v[28:31], v[88:91], v[112:115], v[28:31]
    v_mfma_f32_16x16x32_bf16 v[60:63], v[92:95], v[112:115], v[60:63]
    buffer_load_dwordx4 v[88:91], v125, s[12:15], s26 offen offset:2048
    buffer_load_dwordx4 v[92:95], v125, s[12:15], s26 offen offset:3072
    s_add_u32 s23, s23, 57344
    s_add_u32 s26, s26, 57344
    s_barrier
    s_branch L_conv1_kernel_mloop1
L_conv1_kernel_mlast1:
    v_and_b32 v125, 15, v127
    v_and_b32 v126, 7, v127
    v_lshlrev_b32 v126, 4, v126
    v_lshl_add_u32 v125, v125, 7, v126
    v_lshrrev_b32 v126, 4, v127
    v_lshl_add_u32 v125, v126, 11, v125
    s_lshl_b32 s36, s20, 14
    s_add_u32 s37, s36, 8192
    v_add_u32 v126, s37, v125
    v_add_u32 v125, s36, v125
    ds_read_b128 v[96:99], v120 offset:8192
    ds_read_b128 v[100:103], v120 offset:9216
    ds_read_b128 v[104:107], v120 offset:10240
    ds_read_b128 v[108:111], v120 offset:11264
    ds_read_b128 v[112:115], v120 offset:12288
    ds_read_b128 v[116:119], v120 offset:13312
    s_waitcnt vmcnt(6) lgkmcnt(5)
    v_mfma_f32_16x16x32_bf16 v[0:3], v[64:67], v[96:99], v[0:3]
    v_mfma_f32_16x16x32_bf16 v[32:35], v[68:71], v[96:99], v[32:35]
    ds_read_b128 v[96:99], v120 offset:14336
    s_waitcnt vmcnt(4) lgkmcnt(5)
    v_mfma_f32_16x16x32_bf16 v[4:7], v[64:67], v[100:103], v[4:7]
    v_mfma_f32_16x16x32_bf16 v[36:39], v[68:71], v[100:103], v[36:39]
    v_mfma_f32_16x16x32_bf16 v[0:3], v[72:75], v[100:103], v[0:3]
    v_mfma_f32_16x16x32_bf16 v[32:35], v[76:79], v[100:103], v[32:35]
    ds_read_b128 v[100:103], v120 offset:15360
    s_waitcnt vmcnt(2) lgkmcnt(5)
    v_mfma_f32_16x16x32_bf16 v[8:11], v[64:67], v[104:107], v[8:11]
    v_mfma_f32_16x16x32_bf16 v[40:43], v[68:71], v[104:107], v[40:43]
    v_mfma_f32_16x16x32_bf16 v[4:7], v[72:75], v[104:107], v[4:7]
    v_mfma_f32_16x16x32_bf16 v[36:39], v[76:79], v[104:107], v[36:39]
    v_mfma_f32_16x16x32_bf16 v[0:3], v[80:83], v[104:107], v[0:3]
    v_mfma_f32_16x16x32_bf16 v[32:35], v[84:87], v[104:107], v[32:35]
    ds_read_b128 v[104:107], v122 offset:0
    s_waitcnt vmcnt(0) lgkmcnt(5)
    v_mfma_f32_16x16x32_bf16 v[12:15], v[64:67], v[108:111], v[12:15]
    v_mfma_f32_16x16x32_bf16 v[44:47], v[68:71], v[108:111], v[44:47]
    v_mfma_f32_16x16x32_bf16 v[8:11], v[72:75], v[108:111], v[8:11]
    v_mfma_f32_16x16x32_bf16 v[40:43], v[76:79], v[108:111], v[40:43]
    v_mfma_f32_16x16x32_bf16 v[4:7], v[80:83], v[108:111], v[4:7]
    v_mfma_f32_16x16x32_bf16 v[36:39], v[84:87], v[108:111], v[36:39]
    v_mfma_f32_16x16x32_bf16 v[0:3], v[88:91], v[108:111], v[0:3]
    v_mfma_f32_16x16x32_bf16 v[32:35], v[92:95], v[108:111], v[32:35]
    ds_read_b128 v[108:111], v121 offset:9216
    s_waitcnt lgkmcnt(5)
    v_mfma_f32_16x16x32_bf16 v[16:19], v[64:67], v[112:115], v[16:19]
    v_mfma_f32_16x16x32_bf16 v[48:51], v[68:71], v[112:115], v[48:51]
    v_mfma_f32_16x16x32_bf16 v[12:15], v[72:75], v[112:115], v[12:15]
    v_mfma_f32_16x16x32_bf16 v[44:47], v[76:79], v[112:115], v[44:47]
    v_mfma_f32_16x16x32_bf16 v[8:11], v[80:83], v[112:115], v[8:11]
    v_mfma_f32_16x16x32_bf16 v[40:43], v[84:87], v[112:115], v[40:43]
    v_mfma_f32_16x16x32_bf16 v[4:7], v[88:91], v[112:115], v[4:7]
    v_mfma_f32_16x16x32_bf16 v[36:39], v[92:95], v[112:115], v[36:39]
    ds_read_b128 v[112:115], v121 offset:10240
    v_xor_b32 v123, 0, v125
    ds_write_b128 v123, v[0:3]
    s_waitcnt lgkmcnt(6)
    v_mfma_f32_16x16x32_bf16 v[20:23], v[64:67], v[116:119], v[20:23]
    v_mfma_f32_16x16x32_bf16 v[52:55], v[68:71], v[116:119], v[52:55]
    v_mfma_f32_16x16x32_bf16 v[16:19], v[72:75], v[116:119], v[16:19]
    v_mfma_f32_16x16x32_bf16 v[48:51], v[76:79], v[116:119], v[48:51]
    v_mfma_f32_16x16x32_bf16 v[12:15], v[80:83], v[116:119], v[12:15]
    v_mfma_f32_16x16x32_bf16 v[44:47], v[84:87], v[116:119], v[44:47]
    v_mfma_f32_16x16x32_bf16 v[8:11], v[88:91], v[116:119], v[8:11]
    v_mfma_f32_16x16x32_bf16 v[40:43], v[92:95], v[116:119], v[40:43]
    v_xor_b32 v124, 16, v125
    ds_write_b128 v124, v[4:7]
    s_waitcnt lgkmcnt(2)
    v_mfma_f32_16x16x32_bf16 v[24:27], v[64:67], v[96:99], v[24:27]
    v_mfma_f32_16x16x32_bf16 v[56:59], v[68:71], v[96:99], v[56:59]
    v_mfma_f32_16x16x32_bf16 v[20:23], v[72:75], v[96:99], v[20:23]
    v_mfma_f32_16x16x32_bf16 v[52:55], v[76:79], v[96:99], v[52:55]
    v_mfma_f32_16x16x32_bf16 v[16:19], v[80:83], v[96:99], v[16:19]
    v_mfma_f32_16x16x32_bf16 v[48:51], v[84:87], v[96:99], v[48:51]
    v_mfma_f32_16x16x32_bf16 v[12:15], v[88:91], v[96:99], v[12:15]
    v_mfma_f32_16x16x32_bf16 v[44:47], v[92:95], v[96:99], v[44:47]
    v_xor_b32 v123, 32, v125
    ds_write_b128 v123, v[8:11]
    v_xor_b32 v124, 0, v126
    ds_write_b128 v124, v[32:35]
    v_mfma_f32_16x16x32_bf16 v[28:31], v[64:67], v[100:103], v[28:31]
    v_mfma_f32_16x16x32_bf16 v[60:63], v[68:71], v[100:103], v[60:63]
    v_mfma_f32_16x16x32_bf16 v[24:27], v[72:75], v[100:103], v[24:27]
    v_mfma_f32_16x16x32_bf16 v[56:59], v[76:79], v[100:103], v[56:59]
    v_mfma_f32_16x16x32_bf16 v[20:23], v[80:83], v[100:103], v[20:23]
    v_mfma_f32_16x16x32_bf16 v[52:55], v[84:87], v[100:103], v[52:55]
    v_mfma_f32_16x16x32_bf16 v[16:19], v[88:91], v[100:103], v[16:19]
    v_mfma_f32_16x16x32_bf16 v[48:51], v[92:95], v[100:103], v[48:51]
    v_xor_b32 v123, 16, v126
    ds_write_b128 v123, v[36:39]
    v_xor_b32 v124, 32, v126
    ds_write_b128 v124, v[40:43]
    v_mfma_f32_16x16x32_bf16 v[28:31], v[72:75], v[104:107], v[28:31]
    v_mfma_f32_16x16x32_bf16 v[60:63], v[76:79], v[104:107], v[60:63]
    v_mfma_f32_16x16x32_bf16 v[24:27], v[80:83], v[104:107], v[24:27]
    v_mfma_f32_16x16x32_bf16 v[56:59], v[84:87], v[104:107], v[56:59]
    v_mfma_f32_16x16x32_bf16 v[20:23], v[88:91], v[104:107], v[20:23]
    v_mfma_f32_16x16x32_bf16 v[52:55], v[92:95], v[104:107], v[52:55]
    v_xor_b32 v124, 48, v125
    ds_write_b128 v124, v[12:15]
    v_xor_b32 v123, 48, v126
    ds_write_b128 v123, v[44:47]
    v_mfma_f32_16x16x32_bf16 v[28:31], v[80:83], v[108:111], v[28:31]
    v_mfma_f32_16x16x32_bf16 v[60:63], v[84:87], v[108:111], v[60:63]
    v_mfma_f32_16x16x32_bf16 v[24:27], v[88:91], v[108:111], v[24:27]
    v_mfma_f32_16x16x32_bf16 v[56:59], v[92:95], v[108:111], v[56:59]
    v_xor_b32 v123, 64, v125
    ds_write_b128 v123, v[16:19]
    v_xor_b32 v124, 64, v126
    ds_write_b128 v124, v[48:51]
    v_mfma_f32_16x16x32_bf16 v[28:31], v[88:91], v[112:115], v[28:31]
    v_mfma_f32_16x16x32_bf16 v[60:63], v[92:95], v[112:115], v[60:63]
    v_xor_b32 v124, 80, v125
    ds_write_b128 v124, v[20:23]
    v_xor_b32 v123, 80, v126
    ds_write_b128 v123, v[52:55]
    v_and_b32 v108, 15, v127
    v_lshrrev_b32 v109, 4, v127
    v_lshrrev_b32 v110, 3, v108
    s_lshl_b32 s36, s20, 1
    v_add_u32 v110, s36, v110
    v_xor_b32 v111, v110, v108
    v_and_b32 v111, 7, v111
    v_lshlrev_b32 v111, 4, v111
    v_xor_b32 v123, 96, v125
    ds_write_b128 v123, v[24:27]
    v_lshl_add_u32 v111, v110, 7, v111
    v_lshl_add_u32 v120, v109, 11, v111
    v_add_u32 v121, 65536, v120
    v_add_u32 v64, 131072, v120
    s_lshl_b32 s36, s20, 9
    s_add_u32 s36, s36, 115712
    v_lshl_add_u32 v127, v109, 7, s36
    s_lshl_b32 s36, s20, 4
    v_add_u32 v108, s36, v108
    v_lshlrev_b32 v110, 6, v108
    v_lshl_add_u32 v110, v109, 4, v110
    s_mul_i32 s36, s29, 524288
    v_xor_b32 v124, 96, v126
    ds_write_b128 v124, v[56:59]
    s_lshl_b32 s37, s21, 4
    s_add_u32 s36, s36, s37
    v_add_u32 v110, s36, v110
    v_mov_b32 v111, 2130706432
    v_cmp_gt_u32 vcc, 125, v108
    s_mov_b32 s4, 0xbeaaaaab
    s_mov_b32 s5, s4
    s_mov_b32 s6, 0x3e800000
    s_mov_b32 s7, s6
    s_mov_b32 s8, 0xc0a00000
    s_mov_b32 s9, s8
    s_mov_b32 s10, 0xc0638e39
    v_xor_b32 v124, 112, v125
    ds_write_b128 v124, v[28:31]
    s_mov_b32 s11, s10
    s_mov_b32 s12, 0xbf638e39
    s_mov_b32 s13, s12
    s_mov_b32 s14, 0xbe638e39
    s_mov_b32 s15, s14
    s_mov_b32 s22, 0xbd638e39
    s_mov_b32 s23, s22
    s_mov_b32 s24, 0x3ff1c71c
    s_mov_b32 s25, s24
    s_mov_b32 s26, 0xbf2aaaab
    s_mov_b32 s27, s26
    s_mov_b32 s32, 0x3ecccccd
    v_xor_b32 v123, 112, v126
    s_waitcnt lgkmcnt(8)
    ds_write_b128 v123, v[60:63]
    s_mov_b32 s33, s32
    s_mov_b32 s34, 0xbd888889
    s_mov_b32 s35, s34
    s_mov_b32 s38, 0xbe4ccccd
    s_mov_b32 s39, s38
    s_mov_b32 s40, 0xbdd2d3e8
    s_mov_b32 s41, s40
    s_mov_b32 s42, 0x3f800000
    s_mov_b32 s43, s42
    s_setprio 0
    s_branch L_conv1_kernel_epi
L_conv1_kernel_m2:
    s_mul_i32 s37, s38, 2176
    s_add_u32 s37, s37, 98304
    v_add_u32 v116, s37, v8
    v_add_u32 v118, s37, v9
    v_add_u32 v117, 104832, v8
    s_cmp_eq_u32 s38, 0
    s_cbranch_scc1 L_conv1_kernel_hh0
    v_add_u32 v117, 98304, v9
L_conv1_kernel_hh0:
    s_lshl_b32 s37, s38, 12
    s_add_u32 s37, s37, s43
    s_add_u32 s37, s37, 49152
    v_lshl_add_u32 v119, v127, 4, s37
    v_mov_b32 v0, 0
    v_mov_b32 v1, 0
    v_mov_b32 v2, 0
    v_mov_b32 v3, 0
    v_mov_b32 v4, 0
    v_mov_b32 v5, 0
    v_mov_b32 v6, 0
    v_mov_b32 v7, 0
    v_mov_b32 v8, 0
    v_mov_b32 v9, 0
    v_mov_b32 v10, 0
    v_mov_b32 v11, 0
    v_mov_b32 v12, 0
    v_mov_b32 v13, 0
    v_mov_b32 v14, 0
    v_mov_b32 v15, 0
    v_mov_b32 v16, 0
    v_mov_b32 v17, 0
    v_mov_b32 v18, 0
    v_mov_b32 v19, 0
    v_mov_b32 v20, 0
    v_mov_b32 v21, 0
    v_mov_b32 v22, 0
    v_mov_b32 v23, 0
    v_mov_b32 v24, 0
    v_mov_b32 v25, 0
    v_mov_b32 v26, 0
    v_mov_b32 v27, 0
    v_mov_b32 v28, 0
    v_mov_b32 v29, 0
    v_mov_b32 v30, 0
    v_mov_b32 v31, 0
    v_mov_b32 v32, 0
    v_mov_b32 v33, 0
    v_mov_b32 v34, 0
    v_mov_b32 v35, 0
    v_mov_b32 v36, 0
    v_mov_b32 v37, 0
    v_mov_b32 v38, 0
    v_mov_b32 v39, 0
    v_mov_b32 v40, 0
    v_mov_b32 v41, 0
    v_mov_b32 v42, 0
    v_mov_b32 v43, 0
    v_mov_b32 v44, 0
    v_mov_b32 v45, 0
    v_mov_b32 v46, 0
    v_mov_b32 v47, 0
    v_mov_b32 v48, 0
    v_mov_b32 v49, 0
    v_mov_b32 v50, 0
    v_mov_b32 v51, 0
    v_mov_b32 v52, 0
    v_mov_b32 v53, 0
    v_mov_b32 v54, 0
    v_mov_b32 v55, 0
    v_mov_b32 v56, 0
    v_mov_b32 v57, 0
    v_mov_b32 v58, 0
    v_mov_b32 v59, 0
    v_mov_b32 v60, 0
    v_mov_b32 v61, 0
    v_mov_b32 v62, 0
    v_mov_b32 v63, 0
    buffer_load_dwordx4 v[96:99], v108, s[8:11], 0 offen
    buffer_load_dwordx4 v[100:103], v109, s[8:11], 0 offen
    buffer_load_dwordx4 v[104:107], v110, s[8:11], 0 offen
    s_mov_b32 s23, 0
    s_mov_b32 s26, 4096
    buffer_load_dwordx4 v[64:67], v125, s[12:15], s23 offen offset:0
    buffer_load_dwordx4 v[68:71], v125, s[12:15], s23 offen offset:2048
    buffer_load_dwordx4 v[80:83], v119, s[12:15], s23 offen offset:0
    buffer_load_dwordx4 v[72:75], v125, s[12:15], s26 offen offset:0
    buffer_load_dwordx4 v[84:87], v119, s[12:15], s23 offen offset:2048
    buffer_load_dwordx4 v[76:79], v125, s[12:15], s26 offen offset:2048
    s_mov_b32 s23, 57344
    s_mov_b32 s26, 61440
    s_waitcnt vmcnt(6)
    v_lshlrev_b32 v108, 16, v96
    v_and_b32 v111, s25, v96
    v_lshlrev_b32 v109, 16, v100
    v_and_b32 v112, s25, v100
    v_lshlrev_b32 v110, 16, v104
    v_and_b32 v113, s25, v104
    v_mul_f32 v114, s44, v108
    v_mul_f32 v115, s44, v111
    v_fmac_f32 v114, s45, v109
    v_fmac_f32 v115, s45, v112
    v_fmac_f32 v114, s46, v110
    v_fmac_f32 v115, s46, v113
    v_cvt_pk_bf16_f32 v96, v114, v115
    v_lshlrev_b32 v108, 16, v97
    v_and_b32 v111, s25, v97
    v_lshlrev_b32 v109, 16, v101
    v_and_b32 v112, s25, v101
    v_lshlrev_b32 v110, 16, v105
    v_and_b32 v113, s25, v105
    v_mul_f32 v114, s44, v108
    v_mul_f32 v115, s44, v111
    v_fmac_f32 v114, s45, v109
    v_fmac_f32 v115, s45, v112
    v_fmac_f32 v114, s46, v110
    v_fmac_f32 v115, s46, v113
    v_cvt_pk_bf16_f32 v97, v114, v115
    v_lshlrev_b32 v108, 16, v98
    v_and_b32 v111, s25, v98
    v_lshlrev_b32 v109, 16, v102
    v_and_b32 v112, s25, v102
    v_lshlrev_b32 v110, 16, v106
    v_and_b32 v113, s25, v106
    v_mul_f32 v114, s44, v108
    v_mul_f32 v115, s44, v111
    v_fmac_f32 v114, s45, v109
    v_fmac_f32 v115, s45, v112
    v_fmac_f32 v114, s46, v110
    v_fmac_f32 v115, s46, v113
    v_cvt_pk_bf16_f32 v98, v114, v115
    v_lshlrev_b32 v108, 16, v99
    v_and_b32 v111, s25, v99
    v_lshlrev_b32 v109, 16, v103
    v_and_b32 v112, s25, v103
    v_lshlrev_b32 v110, 16, v107
    v_and_b32 v113, s25, v107
    v_mul_f32 v114, s44, v108
    v_mul_f32 v115, s44, v111
    v_fmac_f32 v114, s45, v109
    v_fmac_f32 v115, s45, v112
    v_fmac_f32 v114, s46, v110
    v_fmac_f32 v115, s46, v113
    v_cvt_pk_bf16_f32 v99, v114, v115
    ds_write_b128 v126, v[96:99]
    v_and_b32 v111, 15, v127
    v_lshlrev_b32 v111, 2, v111
    v_add_u32 v111, 99328, v111
    ds_write_b32 v111, v0
    ds_write_b32 v111, v0 offset:8704
    s_waitcnt lgkmcnt(0)
    s_barrier
    s_mov_b32 s22, 8
    s_setprio 2
L_conv1_kernel_mloop2:
    ds_read_b128 v[88:91], v120 offset:0
    ds_read_b128 v[92:95], v120 offset:1024
    ds_read_b128 v[96:99], v116 offset:0
    ds_read_b128 v[100:103], v120 offset:2048
    ds_read_b128 v[104:107], v116 offset:1088
    ds_read_b128 v[108:111], v120 offset:3072
    ds_read_b128 v[112:115], v116 offset:2176
    s_waitcnt vmcnt(5) lgkmcnt(6)
    v_mfma_f32_16x16x32_bf16 v[0:3], v[64:67], v[88:91], v[0:3]
    ds_read_b128 v[88:91], v120 offset:4096
    s_waitcnt vmcnt(4) lgkmcnt(6)
    v_mfma_f32_16x16x32_bf16 v[4:7], v[64:67], v[92:95], v[4:7]
    v_mfma_f32_16x16x32_bf16 v[0:3], v[68:71], v[92:95], v[0:3]
    ds_read_b128 v[92:95], v116 offset:3264
    s_waitcnt vmcnt(3) lgkmcnt(6)
    v_mfma_f32_16x16x32_bf16 v[32:35], v[80:83], v[96:99], v[32:35]
    ds_read_b128 v[96:99], v120 offset:5120
    s_waitcnt vmcnt(2) lgkmcnt(6)
    v_mfma_f32_16x16x32_bf16 v[8:11], v[64:67], v[100:103], v[8:11]
    v_mfma_f32_16x16x32_bf16 v[4:7], v[68:71], v[100:103], v[4:7]
    v_mfma_f32_16x16x32_bf16 v[0:3], v[72:75], v[100:103], v[0:3]
    ds_read_b128 v[100:103], v116 offset:4352
    s_waitcnt vmcnt(1) lgkmcnt(6)
    v_mfma_f32_16x16x32_bf16 v[36:39], v[80:83], v[104:107], v[36:39]
    v_mfma_f32_16x16x32_bf16 v[32:35], v[84:87], v[104:107], v[32:35]
    ds_read_b128 v[104:107], v120 offset:6144
    s_waitcnt vmcnt(0) lgkmcnt(6)
    v_mfma_f32_16x16x32_bf16 v[12:15], v[64:67], v[108:111], v[12:15]
    v_mfma_f32_16x16x32_bf16 v[8:11], v[68:71], v[108:111], v[8:11]
    v_mfma_f32_16x16x32_bf16 v[4:7], v[72:75], v[108:111], v[4:7]
    v_mfma_f32_16x16x32_bf16 v[0:3], v[76:79], v[108:111], v[0:3]
    ds_read_b128 v[108:111], v116 offset:5440
    s_waitcnt lgkmcnt(6)
    v_mfma_f32_16x16x32_bf16 v[40:43], v[80:83], v[112:115], v[40:43]
    v_mfma_f32_16x16x32_bf16 v[36:39], v[84:87], v[112:115], v[36:39]
    ds_read_b128 v[112:115], v120 offset:7168
    s_waitcnt lgkmcnt(6)
    v_mfma_f32_16x16x32_bf16 v[16:19], v[64:67], v[88:91], v[16:19]
    v_mfma_f32_16x16x32_bf16 v[12:15], v[68:71], v[88:91], v[12:15]
    v_mfma_f32_16x16x32_bf16 v[8:11], v[72:75], v[88:91], v[8:11]
    v_mfma_f32_16x16x32_bf16 v[4:7], v[76:79], v[88:91], v[4:7]
    ds_read_b128 v[88:91], v117 offset:0
    s_waitcnt lgkmcnt(6)
    v_mfma_f32_16x16x32_bf16 v[44:47], v[80:83], v[92:95], v[44:47]
    v_mfma_f32_16x16x32_bf16 v[40:43], v[84:87], v[92:95], v[40:43]
    ds_read_b128 v[92:95], v122 offset:0
    v_add_u32 v122, v123, v122
    s_waitcnt lgkmcnt(6)
    v_mfma_f32_16x16x32_bf16 v[20:23], v[64:67], v[96:99], v[20:23]
    v_mfma_f32_16x16x32_bf16 v[16:19], v[68:71], v[96:99], v[16:19]
    v_mfma_f32_16x16x32_bf16 v[12:15], v[72:75], v[96:99], v[12:15]
    v_mfma_f32_16x16x32_bf16 v[8:11], v[76:79], v[96:99], v[8:11]
    ds_read_b128 v[96:99], v117 offset:1088
    s_waitcnt lgkmcnt(6)
    v_mfma_f32_16x16x32_bf16 v[48:51], v[80:83], v[100:103], v[48:51]
    v_mfma_f32_16x16x32_bf16 v[44:47], v[84:87], v[100:103], v[44:47]
    ds_read_b128 v[100:103], v121 offset:1024
    s_waitcnt lgkmcnt(6)
    v_mfma_f32_16x16x32_bf16 v[24:27], v[64:67], v[104:107], v[24:27]
    v_mfma_f32_16x16x32_bf16 v[20:23], v[68:71], v[104:107], v[20:23]
    v_mfma_f32_16x16x32_bf16 v[16:19], v[72:75], v[104:107], v[16:19]
    v_mfma_f32_16x16x32_bf16 v[12:15], v[76:79], v[104:107], v[12:15]
    ds_read_b128 v[104:107], v118 offset:0
    s_waitcnt lgkmcnt(6)
    v_mfma_f32_16x16x32_bf16 v[52:55], v[80:83], v[108:111], v[52:55]
    v_mfma_f32_16x16x32_bf16 v[48:51], v[84:87], v[108:111], v[48:51]
    ds_read_b128 v[108:111], v121 offset:2048
    s_waitcnt lgkmcnt(6)
    v_mfma_f32_16x16x32_bf16 v[28:31], v[64:67], v[112:115], v[28:31]
    v_mfma_f32_16x16x32_bf16 v[24:27], v[68:71], v[112:115], v[24:27]
    v_mfma_f32_16x16x32_bf16 v[20:23], v[72:75], v[112:115], v[20:23]
    v_mfma_f32_16x16x32_bf16 v[16:19], v[76:79], v[112:115], v[16:19]
    buffer_load_dwordx4 v[64:67], v125, s[12:15], s23 offen offset:0
    s_waitcnt lgkmcnt(5)
    v_mfma_f32_16x16x32_bf16 v[56:59], v[80:83], v[88:91], v[56:59]
    v_mfma_f32_16x16x32_bf16 v[52:55], v[84:87], v[88:91], v[52:55]
    s_waitcnt lgkmcnt(0)
    s_barrier
    v_mfma_f32_16x16x32_bf16 v[28:31], v[68:71], v[92:95], v[28:31]
    v_mfma_f32_16x16x32_bf16 v[24:27], v[72:75], v[92:95], v[24:27]
    v_mfma_f32_16x16x32_bf16 v[20:23], v[76:79], v[92:95], v[20:23]
    buffer_load_dwordx4 v[68:71], v125, s[12:15], s23 offen offset:2048
    v_mfma_f32_16x16x32_bf16 v[60:63], v[80:83], v[96:99], v[60:63]
    v_mfma_f32_16x16x32_bf16 v[56:59], v[84:87], v[96:99], v[56:59]
    buffer_load_dwordx4 v[80:83], v119, s[12:15], s23 offen offset:0
    v_mfma_f32_16x16x32_bf16 v[28:31], v[72:75], v[100:103], v[28:31]
    v_mfma_f32_16x16x32_bf16 v[24:27], v[76:79], v[100:103], v[24:27]
    buffer_load_dwordx4 v[72:75], v125, s[12:15], s26 offen offset:0
    v_mfma_f32_16x16x32_bf16 v[60:63], v[84:87], v[104:107], v[60:63]
    buffer_load_dwordx4 v[84:87], v119, s[12:15], s23 offen offset:2048
    v_mfma_f32_16x16x32_bf16 v[28:31], v[76:79], v[108:111], v[28:31]
    buffer_load_dwordx4 v[76:79], v125, s[12:15], s26 offen offset:2048
    s_add_u32 s23, s23, 57344
    s_add_u32 s26, s26, 57344
    s_sub_u32 s22, s22, 1
    s_cmp_eq_u32 s22, 0
    s_cbranch_scc1 L_conv1_kernel_mlast2
    ds_read_b128 v[88:91], v120 offset:8192
    ds_read_b128 v[92:95], v120 offset:9216
    ds_read_b128 v[96:99], v116 offset:8704
    ds_read_b128 v[100:103], v120 offset:10240
    ds_read_b128 v[104:107], v116 offset:9792
    ds_read_b128 v[108:111], v120 offset:11264
    ds_read_b128 v[112:115], v116 offset:10880
    s_waitcnt vmcnt(5) lgkmcnt(6)
    v_mfma_f32_16x16x32_bf16 v[0:3], v[64:67], v[88:91], v[0:3]
    ds_read_b128 v[88:91], v120 offset:12288
    s_waitcnt vmcnt(4) lgkmcnt(6)
    v_mfma_f32_16x16x32_bf16 v[4:7], v[64:67], v[92:95], v[4:7]
    v_mfma_f32_16x16x32_bf16 v[0:3], v[68:71], v[92:95], v[0:3]
    ds_read_b128 v[92:95], v116 offset:11968
    s_waitcnt vmcnt(3) lgkmcnt(6)
    v_mfma_f32_16x16x32_bf16 v[32:35], v[80:83], v[96:99], v[32:35]
    ds_read_b128 v[96:99], v120 offset:13312
    s_waitcnt vmcnt(2) lgkmcnt(6)
    v_mfma_f32_16x16x32_bf16 v[8:11], v[64:67], v[100:103], v[8:11]
    v_mfma_f32_16x16x32_bf16 v[4:7], v[68:71], v[100:103], v[4:7]
    v_mfma_f32_16x16x32_bf16 v[0:3], v[72:75], v[100:103], v[0:3]
    ds_read_b128 v[100:103], v116 offset:13056
    s_waitcnt vmcnt(1) lgkmcnt(6)
    v_mfma_f32_16x16x32_bf16 v[36:39], v[80:83], v[104:107], v[36:39]
    v_mfma_f32_16x16x32_bf16 v[32:35], v[84:87], v[104:107], v[32:35]
    ds_read_b128 v[104:107], v120 offset:14336
    s_waitcnt vmcnt(0) lgkmcnt(6)
    v_mfma_f32_16x16x32_bf16 v[12:15], v[64:67], v[108:111], v[12:15]
    v_mfma_f32_16x16x32_bf16 v[8:11], v[68:71], v[108:111], v[8:11]
    v_mfma_f32_16x16x32_bf16 v[4:7], v[72:75], v[108:111], v[4:7]
    v_mfma_f32_16x16x32_bf16 v[0:3], v[76:79], v[108:111], v[0:3]
    ds_read_b128 v[108:111], v116 offset:14144
    s_waitcnt lgkmcnt(6)
    v_mfma_f32_16x16x32_bf16 v[40:43], v[80:83], v[112:115], v[40:43]
    v_mfma_f32_16x16x32_bf16 v[36:39], v[84:87], v[112:115], v[36:39]
    ds_read_b128 v[112:115], v120 offset:15360
    s_waitcnt lgkmcnt(6)
    v_mfma_f32_16x16x32_bf16 v[16:19], v[64:67], v[88:91], v[16:19]
    v_mfma_f32_16x16x32_bf16 v[12:15], v[68:71], v[88:91], v[12:15]
    v_mfma_f32_16x16x32_bf16 v[8:11], v[72:75], v[88:91], v[8:11]
    v_mfma_f32_16x16x32_bf16 v[4:7], v[76:79], v[88:91], v[4:7]
    ds_read_b128 v[88:91], v117 offset:8704
    s_waitcnt lgkmcnt(6)
    v_mfma_f32_16x16x32_bf16 v[44:47], v[80:83], v[92:95], v[44:47]
    v_mfma_f32_16x16x32_bf16 v[40:43], v[84:87], v[92:95], v[40:43]
    ds_read_b128 v[92:95], v122 offset:0
    v_add_u32 v122, v124, v122
    s_waitcnt lgkmcnt(6)
    v_mfma_f32_16x16x32_bf16 v[20:23], v[64:67], v[96:99], v[20:23]
    v_mfma_f32_16x16x32_bf16 v[16:19], v[68:71], v[96:99], v[16:19]
    v_mfma_f32_16x16x32_bf16 v[12:15], v[72:75], v[96:99], v[12:15]
    v_mfma_f32_16x16x32_bf16 v[8:11], v[76:79], v[96:99], v[8:11]
    ds_read_b128 v[96:99], v117 offset:9792
    s_waitcnt lgkmcnt(6)
    v_mfma_f32_16x16x32_bf16 v[48:51], v[80:83], v[100:103], v[48:51]
    v_mfma_f32_16x16x32_bf16 v[44:47], v[84:87], v[100:103], v[44:47]
    ds_read_b128 v[100:103], v121 offset:9216
    s_waitcnt lgkmcnt(6)
    v_mfma_f32_16x16x32_bf16 v[24:27], v[64:67], v[104:107], v[24:27]
    v_mfma_f32_16x16x32_bf16 v[20:23], v[68:71], v[104:107], v[20:23]
    v_mfma_f32_16x16x32_bf16 v[16:19], v[72:75], v[104:107], v[16:19]
    v_mfma_f32_16x16x32_bf16 v[12:15], v[76:79], v[104:107], v[12:15]
    ds_read_b128 v[104:107], v118 offset:8704
    s_waitcnt lgkmcnt(6)
    v_mfma_f32_16x16x32_bf16 v[52:55], v[80:83], v[108:111], v[52:55]
    v_mfma_f32_16x16x32_bf16 v[48:51], v[84:87], v[108:111], v[48:51]
    ds_read_b128 v[108:111], v121 offset:10240
    s_waitcnt lgkmcnt(6)
    v_mfma_f32_16x16x32_bf16 v[28:31], v[64:67], v[112:115], v[28:31]
    v_mfma_f32_16x16x32_bf16 v[24:27], v[68:71], v[112:115], v[24:27]
    v_mfma_f32_16x16x32_bf16 v[20:23], v[72:75], v[112:115], v[20:23]
    v_mfma_f32_16x16x32_bf16 v[16:19], v[76:79], v[112:115], v[16:19]
    buffer_load_dwordx4 v[64:67], v125, s[12:15], s23 offen offset:0
    s_waitcnt lgkmcnt(5)
    v_mfma_f32_16x16x32_bf16 v[56:59], v[80:83], v[88:91], v[56:59]
    v_mfma_f32_16x16x32_bf16 v[52:55], v[84:87], v[88:91], v[52:55]
    s_waitcnt lgkmcnt(0)
    s_barrier
    v_mfma_f32_16x16x32_bf16 v[28:31], v[68:71], v[92:95], v[28:31]
    v_mfma_f32_16x16x32_bf16 v[24:27], v[72:75], v[92:95], v[24:27]
    v_mfma_f32_16x16x32_bf16 v[20:23], v[76:79], v[92:95], v[20:23]
    buffer_load_dwordx4 v[68:71], v125, s[12:15], s23 offen offset:2048
    v_mfma_f32_16x16x32_bf16 v[60:63], v[80:83], v[96:99], v[60:63]
    v_mfma_f32_16x16x32_bf16 v[56:59], v[84:87], v[96:99], v[56:59]
    buffer_load_dwordx4 v[80:83], v119, s[12:15], s23 offen offset:0
    v_mfma_f32_16x16x32_bf16 v[28:31], v[72:75], v[100:103], v[28:31]
    v_mfma_f32_16x16x32_bf16 v[24:27], v[76:79], v[100:103], v[24:27]
    buffer_load_dwordx4 v[72:75], v125, s[12:15], s26 offen offset:0
    v_mfma_f32_16x16x32_bf16 v[60:63], v[84:87], v[104:107], v[60:63]
    buffer_load_dwordx4 v[84:87], v119, s[12:15], s23 offen offset:2048
    v_mfma_f32_16x16x32_bf16 v[28:31], v[76:79], v[108:111], v[28:31]
    buffer_load_dwordx4 v[76:79], v125, s[12:15], s26 offen offset:2048
    s_add_u32 s23, s23, 57344
    s_add_u32 s26, s26, 57344
    s_branch L_conv1_kernel_mloop2
L_conv1_kernel_mlast2:
    v_and_b32 v125, 15, v127
    v_and_b32 v126, 7, v127
    v_lshlrev_b32 v126, 4, v126
    v_lshl_add_u32 v125, v125, 7, v126
    v_lshrrev_b32 v126, 4, v127
    v_lshl_add_u32 v125, v126, 11, v125
    s_mov_b32 s36, 65536
    s_cmp_eq_u32 s32, 1
    s_cselect_b32 s36, 121856, s36
    s_cmp_eq_u32 s32, 2
    s_cselect_b32 s36, 81920, s36
    s_cmp_eq_u32 s32, 3
    s_cselect_b32 s36, 130048, s36
    s_mov_b32 s37, 98304
    s_cmp_eq_u32 s32, 1
    s_cselect_b32 s37, 138240, s37
    s_cmp_eq_u32 s32, 2
    s_cselect_b32 s37, 146432, s37
    s_cmp_eq_u32 s32, 3
    s_cselect_b32 s37, 154624, s37
    v_add_u32 v126, s37, v125
    v_add_u32 v125, s36, v125
    ds_read_b128 v[88:91], v120 offset:8192
    ds_read_b128 v[92:95], v120 offset:9216
    ds_read_b128 v[96:99], v116 offset:8704
    ds_read_b128 v[100:103], v120 offset:10240
    ds_read_b128 v[104:107], v116 offset:9792
    ds_read_b128 v[108:111], v120 offset:11264
    ds_read_b128 v[112:115], v116 offset:10880
    s_waitcnt vmcnt(5) lgkmcnt(6)
    v_mfma_f32_16x16x32_bf16 v[0:3], v[64:67], v[88:91], v[0:3]
    ds_read_b128 v[88:91], v120 offset:12288
    s_waitcnt vmcnt(4) lgkmcnt(6)
    v_mfma_f32_16x16x32_bf16 v[4:7], v[64:67], v[92:95], v[4:7]
    v_mfma_f32_16x16x32_bf16 v[0:3], v[68:71], v[92:95], v[0:3]
    ds_read_b128 v[92:95], v116 offset:11968
    s_waitcnt vmcnt(3) lgkmcnt(6)
    v_mfma_f32_16x16x32_bf16 v[32:35], v[80:83], v[96:99], v[32:35]
    ds_read_b128 v[96:99], v120 offset:13312
    s_waitcnt vmcnt(2) lgkmcnt(6)
    v_mfma_f32_16x16x32_bf16 v[8:11], v[64:67], v[100:103], v[8:11]
    v_mfma_f32_16x16x32_bf16 v[4:7], v[68:71], v[100:103], v[4:7]
    v_mfma_f32_16x16x32_bf16 v[0:3], v[72:75], v[100:103], v[0:3]
    ds_read_b128 v[100:103], v116 offset:13056
    s_waitcnt vmcnt(1) lgkmcnt(6)
    v_mfma_f32_16x16x32_bf16 v[36:39], v[80:83], v[104:107], v[36:39]
    v_mfma_f32_16x16x32_bf16 v[32:35], v[84:87], v[104:107], v[32:35]
    ds_read_b128 v[104:107], v120 offset:14336
    s_waitcnt vmcnt(0) lgkmcnt(6)
    v_mfma_f32_16x16x32_bf16 v[12:15], v[64:67], v[108:111], v[12:15]
    v_mfma_f32_16x16x32_bf16 v[8:11], v[68:71], v[108:111], v[8:11]
    v_mfma_f32_16x16x32_bf16 v[4:7], v[72:75], v[108:111], v[4:7]
    v_mfma_f32_16x16x32_bf16 v[0:3], v[76:79], v[108:111], v[0:3]
    ds_read_b128 v[108:111], v116 offset:14144
    s_waitcnt lgkmcnt(6)
    v_mfma_f32_16x16x32_bf16 v[40:43], v[80:83], v[112:115], v[40:43]
    v_mfma_f32_16x16x32_bf16 v[36:39], v[84:87], v[112:115], v[36:39]
    ds_read_b128 v[112:115], v120 offset:15360
    s_waitcnt lgkmcnt(6)
    v_mfma_f32_16x16x32_bf16 v[16:19], v[64:67], v[88:91], v[16:19]
    v_mfma_f32_16x16x32_bf16 v[12:15], v[68:71], v[88:91], v[12:15]
    v_mfma_f32_16x16x32_bf16 v[8:11], v[72:75], v[88:91], v[8:11]
    v_mfma_f32_16x16x32_bf16 v[4:7], v[76:79], v[88:91], v[4:7]
    ds_read_b128 v[88:91], v117 offset:8704
    v_xor_b32 v124, 0, v126
    ds_write_b128 v124, v[32:35]
    s_waitcnt lgkmcnt(7)
    v_mfma_f32_16x16x32_bf16 v[44:47], v[80:83], v[92:95], v[44:47]
    v_mfma_f32_16x16x32_bf16 v[40:43], v[84:87], v[92:95], v[40:43]
    ds_read_b128 v[92:95], v122 offset:0
    v_xor_b32 v123, 0, v125
    ds_write_b128 v123, v[0:3]
    s_waitcnt lgkmcnt(8)
    v_mfma_f32_16x16x32_bf16 v[20:23], v[64:67], v[96:99], v[20:23]
    v_mfma_f32_16x16x32_bf16 v[16:19], v[68:71], v[96:99], v[16:19]
    v_mfma_f32_16x16x32_bf16 v[12:15], v[72:75], v[96:99], v[12:15]
    v_mfma_f32_16x16x32_bf16 v[8:11], v[76:79], v[96:99], v[8:11]
    ds_read_b128 v[96:99], v117 offset:9792
    v_xor_b32 v123, 16, v126
    ds_write_b128 v123, v[36:39]
    s_waitcnt lgkmcnt(9)
    v_mfma_f32_16x16x32_bf16 v[48:51], v[80:83], v[100:103], v[48:51]
    v_mfma_f32_16x16x32_bf16 v[44:47], v[84:87], v[100:103], v[44:47]
    ds_read_b128 v[100:103], v121 offset:9216
    v_xor_b32 v124, 16, v125
    ds_write_b128 v124, v[4:7]
    s_waitcnt lgkmcnt(10)
    v_mfma_f32_16x16x32_bf16 v[24:27], v[64:67], v[104:107], v[24:27]
    v_mfma_f32_16x16x32_bf16 v[20:23], v[68:71], v[104:107], v[20:23]
    v_mfma_f32_16x16x32_bf16 v[16:19], v[72:75], v[104:107], v[16:19]
    v_mfma_f32_16x16x32_bf16 v[12:15], v[76:79], v[104:107], v[12:15]
    ds_read_b128 v[104:107], v118 offset:8704
    v_xor_b32 v124, 32, v126
    ds_write_b128 v124, v[40:43]
    s_waitcnt lgkmcnt(11)
    v_mfma_f32_16x16x32_bf16 v[52:55], v[80:83], v[108:111], v[52:55]
    v_mfma_f32_16x16x32_bf16 v[48:51], v[84:87], v[108:111], v[48:51]
    ds_read_b128 v[108:111], v121 offset:10240
    v_xor_b32 v123, 32, v125
    ds_write_b128 v123, v[8:11]
    s_waitcnt lgkmcnt(12)
    v_mfma_f32_16x16x32_bf16 v[28:31], v[64:67], v[112:115], v[28:31]
    v_mfma_f32_16x16x32_bf16 v[24:27], v[68:71], v[112:115], v[24:27]
    v_mfma_f32_16x16x32_bf16 v[20:23], v[72:75], v[112:115], v[20:23]
    v_mfma_f32_16x16x32_bf16 v[16:19], v[76:79], v[112:115], v[16:19]
    v_xor_b32 v123, 48, v126
    ds_write_b128 v123, v[44:47]
    s_waitcnt lgkmcnt(12)
    v_mfma_f32_16x16x32_bf16 v[56:59], v[80:83], v[88:91], v[56:59]
    v_mfma_f32_16x16x32_bf16 v[52:55], v[84:87], v[88:91], v[52:55]
    v_xor_b32 v124, 48, v125
    ds_write_b128 v124, v[12:15]
    s_waitcnt lgkmcnt(11)
    v_mfma_f32_16x16x32_bf16 v[28:31], v[68:71], v[92:95], v[28:31]
    v_mfma_f32_16x16x32_bf16 v[24:27], v[72:75], v[92:95], v[24:27]
    v_mfma_f32_16x16x32_bf16 v[20:23], v[76:79], v[92:95], v[20:23]
    v_xor_b32 v124, 64, v126
    ds_write_b128 v124, v[48:51]
    s_waitcnt lgkmcnt(10)
    v_mfma_f32_16x16x32_bf16 v[60:63], v[80:83], v[96:99], v[60:63]
    v_mfma_f32_16x16x32_bf16 v[56:59], v[84:87], v[96:99], v[56:59]
    v_xor_b32 v123, 64, v125
    ds_write_b128 v123, v[16:19]
    s_waitcnt lgkmcnt(9)
    v_mfma_f32_16x16x32_bf16 v[28:31], v[72:75], v[100:103], v[28:31]
    v_mfma_f32_16x16x32_bf16 v[24:27], v[76:79], v[100:103], v[24:27]
    v_xor_b32 v123, 80, v126
    ds_write_b128 v123, v[52:55]
    s_waitcnt lgkmcnt(8)
    v_mfma_f32_16x16x32_bf16 v[60:63], v[84:87], v[104:107], v[60:63]
    v_xor_b32 v124, 80, v125
    ds_write_b128 v124, v[20:23]
    s_waitcnt lgkmcnt(7)
    v_mfma_f32_16x16x32_bf16 v[28:31], v[76:79], v[108:111], v[28:31]
    v_xor_b32 v124, 96, v126
    ds_write_b128 v124, v[56:59]
    v_and_b32 v108, 15, v127
    v_lshrrev_b32 v109, 4, v127
    v_lshrrev_b32 v110, 3, v108
    s_lshl_b32 s36, s20, 1
    v_add_u32 v110, s36, v110
    v_xor_b32 v111, v110, v108
    v_and_b32 v111, 7, v111
    v_lshlrev_b32 v111, 4, v111
    v_xor_b32 v123, 96, v125
    ds_write_b128 v123, v[24:27]
    v_lshl_add_u32 v111, v110, 7, v111
    v_lshl_add_u32 v120, v109, 11, v111
    v_add_u32 v121, 65536, v120
    v_add_u32 v64, 131072, v120
    s_lshl_b32 s36, s20, 9
    s_add_u32 s36, s36, 115712
    v_lshl_add_u32 v127, v109, 7, s36
    s_lshl_b32 s36, s20, 4
    v_add_u32 v108, s36, v108
    v_lshlrev_b32 v110, 6, v108
    v_lshl_add_u32 v110, v109, 4, v110
    s_mul_i32 s36, s29, 524288
    v_xor_b32 v123, 112, v126
    ds_write_b128 v123, v[60:63]
    s_lshl_b32 s37, s21, 4
    s_add_u32 s36, s36, s37
    v_add_u32 v110, s36, v110
    v_mov_b32 v111, 2130706432
    v_cmp_gt_u32 vcc, 125, v108
    s_mov_b32 s4, 0xbeaaaaab
    s_mov_b32 s5, s4
    s_mov_b32 s6, 0x3e800000
    s_mov_b32 s7, s6
    s_mov_b32 s8, 0xc0a00000
    s_mov_b32 s9, s8
    s_mov_b32 s10, 0xc0638e39
    v_xor_b32 v124, 112, v125
    ds_write_b128 v124, v[28:31]
    s_mov_b32 s11, s10
    s_mov_b32 s12, 0xbf638e39
    s_mov_b32 s13, s12
    s_mov_b32 s14, 0xbe638e39
    s_mov_b32 s15, s14
    s_mov_b32 s22, 0xbd638e39
    s_mov_b32 s23, s22
    s_mov_b32 s24, 0x3ff1c71c
    s_mov_b32 s25, s24
    s_mov_b32 s26, 0xbf2aaaab
    s_mov_b32 s27, s26
    s_mov_b32 s32, 0x3ecccccd
    s_mov_b32 s33, s32
    s_mov_b32 s34, 0xbd888889
    s_mov_b32 s35, s34
    s_mov_b32 s38, 0xbe4ccccd
    s_mov_b32 s39, s38
    s_mov_b32 s40, 0xbdd2d3e8
    s_mov_b32 s41, s40
    s_mov_b32 s42, 0x3f800000
    s_mov_b32 s43, s42
    s_setprio 0
    s_branch L_conv1_kernel_epi
L_conv1_kernel_epi:
    s_waitcnt lgkmcnt(0)
    s_barrier
    v_cndmask_b32 v122, v111, v110, vcc
    ds_read_b128 v[0:3], v120 offset:0
    ds_read_b128 v[4:7], v120 offset:16384
    ds_read_b128 v[8:11], v120 offset:32768
    ds_read_b128 v[12:15], v120 offset:49152
    ds_read_b128 v[16:19], v121 offset:0
    ds_read_b128 v[20:23], v121 offset:16384
    ds_read_b128 v[24:27], v121 offset:32768
    ds_read_b128 v[28:31], v64 offset:15360
    ds_read_b128 v[32:35], v120 offset:8192
    ds_read_b128 v[36:39], v120 offset:24576
    ds_read_b128 v[40:43], v120 offset:40960
    ds_read_b128 v[44:47], v120 offset:57344
    ds_read_b128 v[48:51], v121 offset:56320
    ds_read_b128 v[52:55], v121 offset:64512
    ds_read_b128 v[56:59], v64 offset:7168
    s_waitcnt lgkmcnt(7)
    ds_read_b128 v[60:63], v64 offset:23552
    s_waitcnt lgkmcnt(8)
    v_pk_add_f32 v[88:89], v[24:25], v[28:29]
    v_pk_add_f32 v[90:91], v[26:27], v[30:31]
    v_pk_add_f32 v[24:25], v[4:5], v[8:9]
    v_pk_add_f32 v[26:27], v[6:7], v[10:11]
    v_pk_add_f32 v[4:5], v[4:5], v[8:9] neg_lo:[0,1] neg_hi:[0,1]
    v_pk_add_f32 v[6:7], v[6:7], v[10:11] neg_lo:[0,1] neg_hi:[0,1]
    v_pk_add_f32 v[72:73], v[12:13], v[16:17]
    v_pk_add_f32 v[74:75], v[14:15], v[18:19]
    v_pk_add_f32 v[12:13], v[12:13], v[16:17] neg_lo:[0,1] neg_hi:[0,1]
    v_pk_add_f32 v[14:15], v[14:15], v[18:19] neg_lo:[0,1] neg_hi:[0,1]
    v_pk_fma_f32 v[72:73], v[24:25], s[4:5], v[72:73]
    v_pk_fma_f32 v[74:75], v[26:27], s[4:5], v[74:75]
    v_pk_fma_f32 v[20:21], v[0:1], s[10:11], v[20:21]
    v_pk_fma_f32 v[22:23], v[2:3], s[10:11], v[22:23]
    v_pk_fma_f32 v[72:73], v[0:1], s[6:7], v[72:73]
    v_pk_fma_f32 v[74:75], v[2:3], s[6:7], v[74:75]
    v_pk_add_f32 v[24:25], v[24:25], v[0:1] neg_lo:[0,1] neg_hi:[0,1]
    v_pk_add_f32 v[26:27], v[26:27], v[2:3] neg_lo:[0,1] neg_hi:[0,1]
    v_pk_fma_f32 v[72:73], v[88:89], s[8:9], v[72:73]
    v_pk_fma_f32 v[74:75], v[90:91], s[8:9], v[74:75]
    v_pk_add_f32 v[24:25], v[24:25], v[88:89] neg_lo:[0,1] neg_hi:[0,1]
    v_pk_add_f32 v[26:27], v[26:27], v[90:91] neg_lo:[0,1] neg_hi:[0,1]
    v_pk_fma_f32 v[20:21], v[88:89], s[22:23], v[20:21]
    v_pk_fma_f32 v[22:23], v[90:91], s[22:23], v[22:23]
    v_pk_add_f32 v[8:9], v[24:25], v[72:73] neg_lo:[0,1] neg_hi:[0,1]
    v_pk_add_f32 v[10:11], v[26:27], v[74:75] neg_lo:[0,1] neg_hi:[0,1]
    v_pk_fma_f32 v[20:21], v[72:73], s[14:15], v[20:21]
    v_pk_fma_f32 v[22:23], v[74:75], s[14:15], v[22:23]
    v_pk_mul_f32 v[80:81], v[12:13], s[32:33]
    v_pk_mul_f32 v[82:83], v[14:15], s[32:33]
    v_pk_fma_f32 v[20:21], v[8:9], s[12:13], v[20:21]
    v_pk_fma_f32 v[22:23], v[10:11], s[12:13], v[22:23]
    v_pk_fma_f32 v[80:81], v[4:5], s[34:35], v[80:81]
    v_pk_fma_f32 v[82:83], v[6:7], s[34:35], v[82:83]
    v_pk_fma_f32 v[64:65], v[4:5], s[24:25], v[20:21] neg_lo:[0,0,1] neg_hi:[0,0,1]
    v_pk_fma_f32 v[66:67], v[6:7], s[24:25], v[22:23] neg_lo:[0,0,1] neg_hi:[0,0,1]
    v_pk_fma_f32 v[64:65], v[12:13], s[26:27], v[64:65]
    v_pk_fma_f32 v[66:67], v[14:15], s[26:27], v[66:67]
    v_pk_fma_f32 v[80:81], v[64:65], s[38:39], v[80:81]
    v_pk_fma_f32 v[82:83], v[66:67], s[38:39], v[82:83]
    v_pk_add_f32 v[4:5], v[4:5], v[64:65] neg_lo:[0,1] neg_hi:[0,1]
    v_pk_add_f32 v[6:7], v[6:7], v[66:67] neg_lo:[0,1] neg_hi:[0,1]
    v_pk_add_f32 v[4:5], v[4:5], v[80:81] neg_lo:[0,1] neg_hi:[0,1]
    v_pk_add_f32 v[6:7], v[6:7], v[82:83] neg_lo:[0,1] neg_hi:[0,1]
    s_waitcnt lgkmcnt(0)
    v_pk_add_f32 v[92:93], v[56:57], v[60:61]
    v_pk_add_f32 v[94:95], v[58:59], v[62:63]
    v_pk_add_f32 v[56:57], v[36:37], v[40:41]
    v_pk_add_f32 v[58:59], v[38:39], v[42:43]
    v_pk_add_f32 v[36:37], v[36:37], v[40:41] neg_lo:[0,1] neg_hi:[0,1]
    v_pk_add_f32 v[38:39], v[38:39], v[42:43] neg_lo:[0,1] neg_hi:[0,1]
    v_pk_add_f32 v[76:77], v[44:45], v[48:49]
    v_pk_add_f32 v[78:79], v[46:47], v[50:51]
    v_pk_add_f32 v[44:45], v[44:45], v[48:49] neg_lo:[0,1] neg_hi:[0,1]
    v_pk_add_f32 v[46:47], v[46:47], v[50:51] neg_lo:[0,1] neg_hi:[0,1]
    v_pk_fma_f32 v[76:77], v[56:57], s[4:5], v[76:77]
    v_pk_fma_f32 v[78:79], v[58:59], s[4:5], v[78:79]
    v_pk_fma_f32 v[52:53], v[32:33], s[10:11], v[52:53]
    v_pk_fma_f32 v[54:55], v[34:35], s[10:11], v[54:55]
    v_pk_fma_f32 v[76:77], v[32:33], s[6:7], v[76:77]
    v_pk_fma_f32 v[78:79], v[34:35], s[6:7], v[78:79]
    v_pk_add_f32 v[56:57], v[56:57], v[32:33] neg_lo:[0,1] neg_hi:[0,1]
    v_pk_add_f32 v[58:59], v[58:59], v[34:35] neg_lo:[0,1] neg_hi:[0,1]
    v_pk_fma_f32 v[76:77], v[92:93], s[8:9], v[76:77]
    v_pk_fma_f32 v[78:79], v[94:95], s[8:9], v[78:79]
    v_pk_add_f32 v[56:57], v[56:57], v[92:93] neg_lo:[0,1] neg_hi:[0,1]
    v_pk_add_f32 v[58:59], v[58:59], v[94:95] neg_lo:[0,1] neg_hi:[0,1]
    v_pk_fma_f32 v[52:53], v[92:93], s[22:23], v[52:53]
    v_pk_fma_f32 v[54:55], v[94:95], s[22:23], v[54:55]
    v_pk_add_f32 v[40:41], v[56:57], v[76:77] neg_lo:[0,1] neg_hi:[0,1]
    v_pk_add_f32 v[42:43], v[58:59], v[78:79] neg_lo:[0,1] neg_hi:[0,1]
    v_pk_fma_f32 v[52:53], v[76:77], s[14:15], v[52:53]
    v_pk_fma_f32 v[54:55], v[78:79], s[14:15], v[54:55]
    v_pk_mul_f32 v[84:85], v[44:45], s[32:33]
    v_pk_mul_f32 v[86:87], v[46:47], s[32:33]
    v_pk_fma_f32 v[52:53], v[40:41], s[12:13], v[52:53]
    v_pk_fma_f32 v[54:55], v[42:43], s[12:13], v[54:55]
    v_pk_fma_f32 v[84:85], v[36:37], s[34:35], v[84:85]
    v_pk_fma_f32 v[86:87], v[38:39], s[34:35], v[86:87]
    v_pk_fma_f32 v[68:69], v[36:37], s[24:25], v[52:53] neg_lo:[0,0,1] neg_hi:[0,0,1]
    v_pk_fma_f32 v[70:71], v[38:39], s[24:25], v[54:55] neg_lo:[0,0,1] neg_hi:[0,0,1]
    v_pk_fma_f32 v[68:69], v[44:45], s[26:27], v[68:69]
    v_pk_fma_f32 v[70:71], v[46:47], s[26:27], v[70:71]
    v_pk_fma_f32 v[84:85], v[68:69], s[38:39], v[84:85]
    v_pk_fma_f32 v[86:87], v[70:71], s[38:39], v[86:87]
    v_pk_add_f32 v[36:37], v[36:37], v[68:69] neg_lo:[0,1] neg_hi:[0,1]
    v_pk_add_f32 v[38:39], v[38:39], v[70:71] neg_lo:[0,1] neg_hi:[0,1]
    v_pk_add_f32 v[36:37], v[36:37], v[84:85] neg_lo:[0,1] neg_hi:[0,1]
    v_pk_add_f32 v[38:39], v[38:39], v[86:87] neg_lo:[0,1] neg_hi:[0,1]
    s_mov_b32 s36, 0x00010001
    s_mov_b32 s37, 0x00010001
    s_mov_b64 exec, s[36:37]
    ds_write_b128 v127, v[0:3] offset:0
    ds_write_b128 v127, v[32:35] offset:16
    ds_write_b128 v127, v[4:7] offset:32
    ds_write_b128 v127, v[36:39] offset:48
    ds_write_b128 v127, v[8:11] offset:64
    ds_write_b128 v127, v[40:43] offset:80
    s_mov_b64 exec, -1
    v_mov_b32 v44, 0xc0135761
    v_mov_b32 v45, v44
    v_pk_mul_f32 v[16:17], v[64:65], v[64:65]
    v_pk_mul_f32 v[18:19], v[66:67], v[66:67]
    v_pk_mul_f32 v[20:21], v[68:69], v[68:69]
    v_pk_mul_f32 v[22:23], v[70:71], v[70:71]
    v_pk_fma_f32 v[16:17], v[16:17], s[40:41], v[44:45]
    v_pk_fma_f32 v[18:19], v[18:19], s[40:41], v[44:45]
    v_pk_fma_f32 v[20:21], v[20:21], s[40:41], v[44:45]
    v_pk_fma_f32 v[22:23], v[22:23], s[40:41], v[44:45]
    v_pk_mul_f32 v[16:17], v[16:17], v[64:65]
    v_pk_mul_f32 v[18:19], v[18:19], v[66:67]
    v_pk_mul_f32 v[20:21], v[20:21], v[68:69]
    v_pk_mul_f32 v[22:23], v[22:23], v[70:71]
    v_exp_f32 v16, v16
    v_exp_f32 v17, v17
    v_exp_f32 v18, v18
    v_exp_f32 v19, v19
    v_exp_f32 v20, v20
    v_exp_f32 v21, v21
    v_exp_f32 v22, v22
    v_exp_f32 v23, v23
    v_pk_add_f32 v[16:17], v[16:17], s[42:43]
    v_pk_add_f32 v[18:19], v[18:19], s[42:43]
    v_pk_add_f32 v[20:21], v[20:21], s[42:43]
    v_pk_add_f32 v[22:23], v[22:23], s[42:43]
    v_rcp_f32 v16, v16
    v_rcp_f32 v17, v17
    v_rcp_f32 v18, v18
    v_rcp_f32 v19, v19
    v_rcp_f32 v20, v20
    v_rcp_f32 v21, v21
    v_rcp_f32 v22, v22
    v_rcp_f32 v23, v23
    v_pk_mul_f32 v[64:65], v[64:65], v[16:17]
    v_pk_mul_f32 v[66:67], v[66:67], v[18:19]
    v_pk_mul_f32 v[68:69], v[68:69], v[20:21]
    v_pk_mul_f32 v[70:71], v[70:71], v[22:23]
    v_cvt_pk_bf16_f32 v48, v64, v68
    v_cvt_pk_bf16_f32 v49, v65, v69
    v_cvt_pk_bf16_f32 v50, v66, v70
    v_cvt_pk_bf16_f32 v51, v67, v71
    s_mov_b32 s44, 393280
    buffer_store_dwordx4 v[48:51], v122, s[16:19], s44 offen sc1
    s_waitcnt lgkmcnt(0)
    s_barrier
    ds_read_b128 v[96:99], v127 offset:512
    ds_read_b128 v[100:103], v127 offset:528
    ds_read_b128 v[104:107], v127 offset:544
    ds_read_b128 v[108:111], v127 offset:560
    ds_read_b128 v[112:115], v127 offset:576
    ds_read_b128 v[116:119], v127 offset:592
    s_waitcnt lgkmcnt(4)
    v_mov_b32_dpp v96, v0 row_shl:1 row_mask:0xf bank_mask:0xf
    v_mov_b32_dpp v97, v1 row_shl:1 row_mask:0xf bank_mask:0xf
    v_mov_b32_dpp v98, v2 row_shl:1 row_mask:0xf bank_mask:0xf
    v_mov_b32_dpp v99, v3 row_shl:1 row_mask:0xf bank_mask:0xf
    v_mov_b32_dpp v100, v32 row_shl:1 row_mask:0xf bank_mask:0xf
    v_mov_b32_dpp v101, v33 row_shl:1 row_mask:0xf bank_mask:0xf
    v_mov_b32_dpp v102, v34 row_shl:1 row_mask:0xf bank_mask:0xf
    v_mov_b32_dpp v103, v35 row_shl:1 row_mask:0xf bank_mask:0xf
    v_pk_add_f32 v[72:73], v[72:73], v[96:97]
    v_pk_add_f32 v[74:75], v[74:75], v[98:99]
    v_pk_add_f32 v[76:77], v[76:77], v[100:101]
    v_pk_add_f32 v[78:79], v[78:79], v[102:103]
    v_pk_mul_f32 v[24:25], v[72:73], v[72:73]
    v_pk_mul_f32 v[26:27], v[74:75], v[74:75]
    v_pk_mul_f32 v[28:29], v[76:77], v[76:77]
    v_pk_mul_f32 v[30:31], v[78:79], v[78:79]
    v_pk_fma_f32 v[24:25], v[24:25], s[40:41], v[44:45]
    v_pk_fma_f32 v[26:27], v[26:27], s[40:41], v[44:45]
    v_pk_fma_f32 v[28:29], v[28:29], s[40:41], v[44:45]
    v_pk_fma_f32 v[30:31], v[30:31], s[40:41], v[44:45]
    v_pk_mul_f32 v[24:25], v[24:25], v[72:73]
    v_pk_mul_f32 v[26:27], v[26:27], v[74:75]
    v_pk_mul_f32 v[28:29], v[28:29], v[76:77]
    v_pk_mul_f32 v[30:31], v[30:31], v[78:79]
    v_exp_f32 v24, v24
    v_exp_f32 v25, v25
    v_exp_f32 v26, v26
    v_exp_f32 v27, v27
    v_exp_f32 v28, v28
    v_exp_f32 v29, v29
    v_exp_f32 v30, v30
    v_exp_f32 v31, v31
    v_pk_add_f32 v[24:25], v[24:25], s[42:43]
    v_pk_add_f32 v[26:27], v[26:27], s[42:43]
    v_pk_add_f32 v[28:29], v[28:29], s[42:43]
    v_pk_add_f32 v[30:31], v[30:31], s[42:43]
    v_rcp_f32 v24, v24
    v_rcp_f32 v25, v25
    v_rcp_f32 v26, v26
    v_rcp_f32 v27, v27
    v_rcp_f32 v28, v28
    v_rcp_f32 v29, v29
    v_rcp_f32 v30, v30
    v_rcp_f32 v31, v31
    v_pk_mul_f32 v[72:73], v[72:73], v[24:25]
    v_pk_mul_f32 v[74:75], v[74:75], v[26:27]
    v_pk_mul_f32 v[76:77], v[76:77], v[28:29]
    v_pk_mul_f32 v[78:79], v[78:79], v[30:31]
    v_cvt_pk_bf16_f32 v52, v72, v76
    v_cvt_pk_bf16_f32 v53, v73, v77
    v_cvt_pk_bf16_f32 v54, v74, v78
    v_cvt_pk_bf16_f32 v55, v75, v79
    s_mov_b32 s44, 128
    buffer_store_dwordx4 v[52:55], v122, s[16:19], s44 offen sc1
    s_waitcnt lgkmcnt(2)
    v_mov_b32_dpp v104, v4 row_shl:1 row_mask:0xf bank_mask:0xf
    v_mov_b32_dpp v105, v5 row_shl:1 row_mask:0xf bank_mask:0xf
    v_mov_b32_dpp v106, v6 row_shl:1 row_mask:0xf bank_mask:0xf
    v_mov_b32_dpp v107, v7 row_shl:1 row_mask:0xf bank_mask:0xf
    v_mov_b32_dpp v108, v36 row_shl:1 row_mask:0xf bank_mask:0xf
    v_mov_b32_dpp v109, v37 row_shl:1 row_mask:0xf bank_mask:0xf
    v_mov_b32_dpp v110, v38 row_shl:1 row_mask:0xf bank_mask:0xf
    v_mov_b32_dpp v111, v39 row_shl:1 row_mask:0xf bank_mask:0xf
    v_pk_add_f32 v[80:81], v[80:81], v[104:105]
    v_pk_add_f32 v[82:83], v[82:83], v[106:107]
    v_pk_add_f32 v[84:85], v[84:85], v[108:109]
    v_pk_add_f32 v[86:87], v[86:87], v[110:111]
    v_pk_mul_f32 v[16:17], v[80:81], v[80:81]
    v_pk_mul_f32 v[18:19], v[82:83], v[82:83]
    v_pk_mul_f32 v[20:21], v[84:85], v[84:85]
    v_pk_mul_f32 v[22:23], v[86:87], v[86:87]
    v_pk_fma_f32 v[16:17], v[16:17], s[40:41], v[44:45]
    v_pk_fma_f32 v[18:19], v[18:19], s[40:41], v[44:45]
    v_pk_fma_f32 v[20:21], v[20:21], s[40:41], v[44:45]
    v_pk_fma_f32 v[22:23], v[22:23], s[40:41], v[44:45]
    v_pk_mul_f32 v[16:17], v[16:17], v[80:81]
    v_pk_mul_f32 v[18:19], v[18:19], v[82:83]
    v_pk_mul_f32 v[20:21], v[20:21], v[84:85]
    v_pk_mul_f32 v[22:23], v[22:23], v[86:87]
    v_exp_f32 v16, v16
    v_exp_f32 v17, v17
    v_exp_f32 v18, v18
    v_exp_f32 v19, v19
    v_exp_f32 v20, v20
    v_exp_f32 v21, v21
    v_exp_f32 v22, v22
    v_exp_f32 v23, v23
    v_pk_add_f32 v[16:17], v[16:17], s[42:43]
    v_pk_add_f32 v[18:19], v[18:19], s[42:43]
    v_pk_add_f32 v[20:21], v[20:21], s[42:43]
    v_pk_add_f32 v[22:23], v[22:23], s[42:43]
    v_rcp_f32 v16, v16
    v_rcp_f32 v17, v17
    v_rcp_f32 v18, v18
    v_rcp_f32 v19, v19
    v_rcp_f32 v20, v20
    v_rcp_f32 v21, v21
    v_rcp_f32 v22, v22
    v_rcp_f32 v23, v23
    v_pk_mul_f32 v[80:81], v[80:81], v[16:17]
    v_pk_mul_f32 v[82:83], v[82:83], v[18:19]
    v_pk_mul_f32 v[84:85], v[84:85], v[20:21]
    v_pk_mul_f32 v[86:87], v[86:87], v[22:23]
    v_cvt_pk_bf16_f32 v56, v80, v84
    v_cvt_pk_bf16_f32 v57, v81, v85
    v_cvt_pk_bf16_f32 v58, v82, v86
    v_cvt_pk_bf16_f32 v59, v83, v87
    s_mov_b32 s44, 131200
    buffer_store_dwordx4 v[56:59], v122, s[16:19], s44 offen sc1
    s_waitcnt lgkmcnt(0)
    v_mov_b32_dpp v112, v8 row_shl:1 row_mask:0xf bank_mask:0xf
    v_mov_b32_dpp v113, v9 row_shl:1 row_mask:0xf bank_mask:0xf
    v_mov_b32_dpp v114, v10 row_shl:1 row_mask:0xf bank_mask:0xf
    v_mov_b32_dpp v115, v11 row_shl:1 row_mask:0xf bank_mask:0xf
    v_mov_b32_dpp v116, v40 row_shl:1 row_mask:0xf bank_mask:0xf
    v_mov_b32_dpp v117, v41 row_shl:1 row_mask:0xf bank_mask:0xf
    v_mov_b32_dpp v118, v42 row_shl:1 row_mask:0xf bank_mask:0xf
    v_mov_b32_dpp v119, v43 row_shl:1 row_mask:0xf bank_mask:0xf
    v_pk_add_f32 v[88:89], v[88:89], v[112:113]
    v_pk_add_f32 v[90:91], v[90:91], v[114:115]
    v_pk_add_f32 v[92:93], v[92:93], v[116:117]
    v_pk_add_f32 v[94:95], v[94:95], v[118:119]
    v_pk_mul_f32 v[24:25], v[88:89], v[88:89]
    v_pk_mul_f32 v[26:27], v[90:91], v[90:91]
    v_pk_mul_f32 v[28:29], v[92:93], v[92:93]
    v_pk_mul_f32 v[30:31], v[94:95], v[94:95]
    v_pk_fma_f32 v[24:25], v[24:25], s[40:41], v[44:45]
    v_pk_fma_f32 v[26:27], v[26:27], s[40:41], v[44:45]
    v_pk_fma_f32 v[28:29], v[28:29], s[40:41], v[44:45]
    v_pk_fma_f32 v[30:31], v[30:31], s[40:41], v[44:45]
    v_pk_mul_f32 v[24:25], v[24:25], v[88:89]
    v_pk_mul_f32 v[26:27], v[26:27], v[90:91]
    v_pk_mul_f32 v[28:29], v[28:29], v[92:93]
    v_pk_mul_f32 v[30:31], v[30:31], v[94:95]
    v_exp_f32 v24, v24
    v_exp_f32 v25, v25
    v_exp_f32 v26, v26
    v_exp_f32 v27, v27
    v_exp_f32 v28, v28
    v_exp_f32 v29, v29
    v_exp_f32 v30, v30
    v_exp_f32 v31, v31
    v_pk_add_f32 v[24:25], v[24:25], s[42:43]
    v_pk_add_f32 v[26:27], v[26:27], s[42:43]
    v_pk_add_f32 v[28:29], v[28:29], s[42:43]
    v_pk_add_f32 v[30:31], v[30:31], s[42:43]
    v_rcp_f32 v24, v24
    v_rcp_f32 v25, v25
    v_rcp_f32 v26, v26
    v_rcp_f32 v27, v27
    v_rcp_f32 v28, v28
    v_rcp_f32 v29, v29
    v_rcp_f32 v30, v30
    v_rcp_f32 v31, v31
    v_pk_mul_f32 v[88:89], v[88:89], v[24:25]
    v_pk_mul_f32 v[90:91], v[90:91], v[26:27]
    v_pk_mul_f32 v[92:93], v[92:93], v[28:29]
    v_pk_mul_f32 v[94:95], v[94:95], v[30:31]
    v_cvt_pk_bf16_f32 v60, v88, v92
    v_cvt_pk_bf16_f32 v61, v89, v93
    v_cvt_pk_bf16_f32 v62, v90, v94
    v_cvt_pk_bf16_f32 v63, v91, v95
    s_mov_b32 s44, 262272
    buffer_store_dwordx4 v[60:63], v122, s[16:19], s44 offen sc1
L_conv1_kernel_end:
L_conv1_kernel_done:
    s_endpgm
.globl conv2_kernel
.p2align 8
.type conv2_kernel,@function
conv2_kernel:
    s_cmp_ge_u32 s2, 256
    s_cbranch_scc1 L_conv2_kernel_done
    s_load_dwordx2 s[4:5], s[0:1], 72
    s_load_dwordx2 s[30:31], s[0:1], 72
    v_readfirstlane_b32 s20, v0
    s_lshr_b32 s20, s20, 6
    s_xor_b32 s20, s20, 8
    s_and_b32 s36, s2, 0
    s_lshl_b32 s36, s36, 3
    s_bfe_u32 s37, s2, 196611
    s_or_b32 s29, s36, s37
    s_bfe_u32 s36, s2, 196608
    s_lshl_b32 s36, s36, 2
    s_lshr_b32 s37, s2, 6
    s_or_b32 s36, s36, s37
    s_lshr_b32 s33, s36, 4
    s_and_b32 s34, s36, 7
    s_bfe_u32 s35, s36, 0x10003
    s_mul_i32 s21, s34, 500
    s_and_b32 s32, s20, 3
    v_and_b32 v127, 63, v0
    v_lshrrev_b32 v5, 2, v127
    v_and_b32 v6, 3, v127
    s_and_b32 s42, s20, 7
    s_lshr_b32 s41, s21, 2
    s_sub_u32 s41, s41, 1
    s_add_u32 s37, s41, s42
    v_lshl_add_u32 v7, v5, 3, s37
    s_mul_i32 s36, s35, 4194304
    s_add_u32 s36, s36, 18874368
    s_mov_b32 s10, 4194304
    s_mov_b32 s11, 0x00020000
    s_mov_b32 s25, 0xffff0000
    s_mov_b32 s47, s36
    s_cmp_ge_u32 s20, 8
    s_cbranch_scc0 L_conv2_kernel_mw
L_conv2_kernel_helper:
    s_setprio 3
    v_lshlrev_b32 v8, 4, v6
    s_add_u32 s37, s33, 4294967289
    v_lshl_add_u32 v9, v7, 3, s37
    v_cmp_gt_u32 vcc, 8000, v9
    s_mul_i32 s37, s33, 131072
    s_add_u32 s37, s37, 0
    v_lshl_add_u32 v92, v7, 7, s37
    v_add_u32 v92, v92, v8
    v_mov_b32 v9, 2130706432
    v_cndmask_b32 v92, v9, v92, vcc
    s_add_u32 s37, s33, 4294967291
    v_lshl_add_u32 v9, v7, 3, s37
    v_cmp_gt_u32 vcc, 8000, v9
    s_mul_i32 s37, s33, 131072
    s_add_u32 s37, s37, 262144
    v_lshl_add_u32 v93, v7, 7, s37
    v_add_u32 v93, v93, v8
    v_mov_b32 v9, 2130706432
    v_cndmask_b32 v93, v9, v93, vcc
    s_add_u32 s37, s33, 4294967293
    v_lshl_add_u32 v9, v7, 3, s37
    v_cmp_gt_u32 vcc, 8000, v9
    s_mul_i32 s37, s33, 131072
    s_add_u32 s37, s37, 64
    v_lshl_add_u32 v94, v7, 7, s37
    v_add_u32 v94, v94, v8
    v_mov_b32 v9, 2130706432
    v_cndmask_b32 v94, v9, v94, vcc
    s_add_u32 s37, s33, 4294967295
    v_lshl_add_u32 v9, v7, 3, s37
    v_cmp_gt_u32 vcc, 8000, v9
    s_mul_i32 s37, s33, 131072
    s_add_u32 s37, s37, 262208
    v_lshl_add_u32 v95, v7, 7, s37
    v_add_u32 v95, v95, v8
    v_mov_b32 v9, 2130706432
    v_cndmask_b32 v95, v9, v95, vcc
    v_and_b32 v76, 4, v5
    v_lshrrev_b32 v76, 1, v76
    v_xor_b32 v76, v6, v76
    v_lshlrev_b32 v76, 4, v76
    v_lshl_add_u32 v76, v5, 6, v76
    s_mov_b32 s24, 0
    s_mov_b32 s27, 524288
    s_waitcnt lgkmcnt(0)
    s_add_u32 s8, s4, s47
    s_addc_u32 s9, s5, 0
    buffer_load_dwordx4 v[0:3], v92, s[8:11], s24 offen
    buffer_load_dwordx4 v[8:11], v94, s[8:11], s24 offen
    buffer_load_dwordx4 v[4:7], v93, s[8:11], s24 offen
    buffer_load_dwordx4 v[12:15], v95, s[8:11], s24 offen
    buffer_load_dwordx4 v[16:19], v92, s[8:11], s27 offen
    buffer_load_dwordx4 v[24:27], v94, s[8:11], s27 offen
    buffer_load_dwordx4 v[20:23], v93, s[8:11], s27 offen
    buffer_load_dwordx4 v[28:31], v95, s[8:11], s27 offen
    s_mul_i32 s36, s42, 1024
    v_add_u32 v96, s36, v76
    v_add_u32 v97, 65536, v96
    s_mul_i32 s36, s42, 1088
    s_add_u32 s36, s36, 98304
    v_add_u32 v98, s36, v76
    s_waitcnt vmcnt(0)
    s_mov_b32 s28, 0
    s_mov_b32 s22, 2
    ds_write_b128 v96, v[0:3] offset:0
    ds_write_b128 v98, v[12:15] offset:0
    v_lshlrev_b32 v76, 16, v0
    v_and_b32 v84, s25, v0
    v_lshlrev_b32 v77, 16, v4
    v_and_b32 v85, s25, v4
    v_lshlrev_b32 v78, 16, v8
    v_and_b32 v86, s25, v8
    v_lshlrev_b32 v79, 16, v12
    v_and_b32 v87, s25, v12
    v_add_f32 v80, v76, v78
    v_add_f32 v88, v84, v86
    v_add_f32 v81, v77, v79
    v_add_f32 v89, v85, v87
    v_fma_f32 v82, v78, 4.0, v76
    v_fma_f32 v90, v86, 4.0, v84
    v_fma_f32 v83, v79, 4.0, v77
    v_fma_f32 v91, v87, 4.0, v85
    v_add_f32 v77, v80, v81
    v_add_f32 v85, v88, v89
    v_sub_f32 v78, v80, v81
    v_sub_f32 v86, v88, v89
    v_fma_f32 v79, v83, 2.0, v82
    v_fma_f32 v87, v91, 2.0, v90
    v_fma_f32 v82, v83, -2.0, v82
    v_fma_f32 v90, v91, -2.0, v90
    v_fmamk_f32 v80, v76, 0x41700000, v82
    v_fmamk_f32 v88, v84, 0x41700000, v90
    v_fmamk_f32 v80, v81, 0x41200000, v80
    v_fmamk_f32 v88, v89, 0x41200000, v88
    v_cvt_pk_bf16_f32 v4, v77, v85
    v_cvt_pk_bf16_f32 v8, v78, v86
    v_cvt_pk_bf16_f32 v64, v79, v87
    v_cvt_pk_bf16_f32 v68, v82, v90
    v_cvt_pk_bf16_f32 v72, v80, v88
    v_lshlrev_b32 v76, 16, v1
    v_and_b32 v84, s25, v1
    v_lshlrev_b32 v77, 16, v5
    v_and_b32 v85, s25, v5
    v_lshlrev_b32 v78, 16, v9
    v_and_b32 v86, s25, v9
    v_lshlrev_b32 v79, 16, v13
    v_and_b32 v87, s25, v13
    v_add_f32 v80, v76, v78
    v_add_f32 v88, v84, v86
    v_add_f32 v81, v77, v79
    v_add_f32 v89, v85, v87
    v_fma_f32 v82, v78, 4.0, v76
    v_fma_f32 v90, v86, 4.0, v84
    v_fma_f32 v83, v79, 4.0, v77
    v_fma_f32 v91, v87, 4.0, v85
    v_add_f32 v77, v80, v81
    v_add_f32 v85, v88, v89
    v_sub_f32 v78, v80, v81
    v_sub_f32 v86, v88, v89
    v_fma_f32 v79, v83, 2.0, v82
    v_fma_f32 v87, v91, 2.0, v90
    v_fma_f32 v82, v83, -2.0, v82
    v_fma_f32 v90, v91, -2.0, v90
    v_fmamk_f32 v80, v76, 0x41700000, v82
    v_fmamk_f32 v88, v84, 0x41700000, v90
    v_fmamk_f32 v80, v81, 0x41200000, v80
    v_fmamk_f32 v88, v89, 0x41200000, v88
    v_cvt_pk_bf16_f32 v5, v77, v85
    v_cvt_pk_bf16_f32 v9, v78, v86
    v_cvt_pk_bf16_f32 v65, v79, v87
    v_cvt_pk_bf16_f32 v69, v82, v90
    v_cvt_pk_bf16_f32 v73, v80, v88
    v_lshlrev_b32 v76, 16, v2
    v_and_b32 v84, s25, v2
    v_lshlrev_b32 v77, 16, v6
    v_and_b32 v85, s25, v6
    v_lshlrev_b32 v78, 16, v10
    v_and_b32 v86, s25, v10
    v_lshlrev_b32 v79, 16, v14
    v_and_b32 v87, s25, v14
    v_add_f32 v80, v76, v78
    v_add_f32 v88, v84, v86
    v_add_f32 v81, v77, v79
    v_add_f32 v89, v85, v87
    v_fma_f32 v82, v78, 4.0, v76
    v_fma_f32 v90, v86, 4.0, v84
    v_fma_f32 v83, v79, 4.0, v77
    v_fma_f32 v91, v87, 4.0, v85
    v_add_f32 v77, v80, v81
    v_add_f32 v85, v88, v89
    v_sub_f32 v78, v80, v81
    v_sub_f32 v86, v88, v89
    v_fma_f32 v79, v83, 2.0, v82
    v_fma_f32 v87, v91, 2.0, v90
    v_fma_f32 v82, v83, -2.0, v82
    v_fma_f32 v90, v91, -2.0, v90
    v_fmamk_f32 v80, v76, 0x41700000, v82
    v_fmamk_f32 v88, v84, 0x41700000, v90
    v_fmamk_f32 v80, v81, 0x41200000, v80
    v_fmamk_f32 v88, v89, 0x41200000, v88
    v_cvt_pk_bf16_f32 v6, v77, v85
    v_cvt_pk_bf16_f32 v10, v78, v86
    v_cvt_pk_bf16_f32 v66, v79, v87
    v_cvt_pk_bf16_f32 v70, v82, v90
    v_cvt_pk_bf16_f32 v74, v80, v88
    v_lshlrev_b32 v76, 16, v3
    v_and_b32 v84, s25, v3
    v_lshlrev_b32 v77, 16, v7
    v_and_b32 v85, s25, v7
    v_lshlrev_b32 v78, 16, v11
    v_and_b32 v86, s25, v11
    v_lshlrev_b32 v79, 16, v15
    v_and_b32 v87, s25, v15
    v_add_f32 v80, v76, v78
    v_add_f32 v88, v84, v86
    v_add_f32 v81, v77, v79
    v_add_f32 v89, v85, v87
    v_fma_f32 v82, v78, 4.0, v76
    v_fma_f32 v90, v86, 4.0, v84
    v_fma_f32 v83, v79, 4.0, v77
    v_fma_f32 v91, v87, 4.0, v85
    v_add_f32 v77, v80, v81
    v_add_f32 v85, v88, v89
    v_sub_f32 v78, v80, v81
    v_sub_f32 v86, v88, v89
    v_fma_f32 v79, v83, 2.0, v82
    v_fma_f32 v87, v91, 2.0, v90
    v_fma_f32 v82, v83, -2.0, v82
    v_fma_f32 v90, v91, -2.0, v90
    v_fmamk_f32 v80, v76, 0x41700000, v82
    v_fmamk_f32 v88, v84, 0x41700000, v90
    v_fmamk_f32 v80, v81, 0x41200000, v80
    v_fmamk_f32 v88, v89, 0x41200000, v88
    v_cvt_pk_bf16_f32 v7, v77, v85
    v_cvt_pk_bf16_f32 v11, v78, v86
    v_cvt_pk_bf16_f32 v67, v79, v87
    v_cvt_pk_bf16_f32 v71, v82, v90
    v_cvt_pk_bf16_f32 v75, v80, v88
    ds_write_b128 v96, v[64:67] offset:49152
    ds_write_b128 v97, v[68:71] offset:0
    ds_write_b128 v97, v[72:75] offset:16384
    ds_write_b128 v96, v[4:7] offset:16384
    ds_write_b128 v96, v[8:11] offset:32768
    s_cmp_ge_u32 s20, 12
    s_cbranch_scc1 L_conv2_kernel_h2
    s_mov_b32 s24, 1048576
    s_mov_b32 s27, 1572864
    s_waitcnt lgkmcnt(0)
    s_barrier
    buffer_load_dwordx4 v[32:35], v92, s[8:11], s24 offen
    buffer_load_dwordx4 v[40:43], v94, s[8:11], s24 offen
    buffer_load_dwordx4 v[36:39], v93, s[8:11], s24 offen
    buffer_load_dwordx4 v[44:47], v95, s[8:11], s24 offen
    s_setprio 1
L_conv2_kernel_hloop1:
    v_lshlrev_b32 v76, 16, v16
    v_and_b32 v84, s25, v16
    v_lshlrev_b32 v77, 16, v20
    v_and_b32 v85, s25, v20
    v_lshlrev_b32 v78, 16, v24
    v_and_b32 v86, s25, v24
    v_lshlrev_b32 v79, 16, v28
    v_and_b32 v87, s25, v28
    v_add_f32 v80, v76, v78
    v_add_f32 v88, v84, v86
    v_add_f32 v81, v77, v79
    v_add_f32 v89, v85, v87
    v_fma_f32 v82, v78, 4.0, v76
    v_fma_f32 v90, v86, 4.0, v84
    v_fma_f32 v83, v79, 4.0, v77
    v_fma_f32 v91, v87, 4.0, v85
    v_add_f32 v77, v80, v81
    v_add_f32 v85, v88, v89
    v_sub_f32 v78, v80, v81
    v_sub_f32 v86, v88, v89
    v_fma_f32 v79, v83, 2.0, v82
    v_fma_f32 v87, v91, 2.0, v90
    v_fma_f32 v82, v83, -2.0, v82
    v_fma_f32 v90, v91, -2.0, v90
    v_fmamk_f32 v80, v76, 0x41700000, v82
    v_fmamk_f32 v88, v84, 0x41700000, v90
    v_fmamk_f32 v80, v81, 0x41200000, v80
    v_fmamk_f32 v88, v89, 0x41200000, v88
    v_cvt_pk_bf16_f32 v20, v77, v85
    v_cvt_pk_bf16_f32 v24, v78, v86
    v_cvt_pk_bf16_f32 v64, v79, v87
    v_cvt_pk_bf16_f32 v68, v82, v90
    v_cvt_pk_bf16_f32 v72, v80, v88
    v_lshlrev_b32 v76, 16, v17
    v_and_b32 v84, s25, v17
    v_lshlrev_b32 v77, 16, v21
    v_and_b32 v85, s25, v21
    v_lshlrev_b32 v78, 16, v25
    v_and_b32 v86, s25, v25
    v_lshlrev_b32 v79, 16, v29
    v_and_b32 v87, s25, v29
    v_add_f32 v80, v76, v78
    v_add_f32 v88, v84, v86
    v_add_f32 v81, v77, v79
    v_add_f32 v89, v85, v87
    v_fma_f32 v82, v78, 4.0, v76
    v_fma_f32 v90, v86, 4.0, v84
    v_fma_f32 v83, v79, 4.0, v77
    v_fma_f32 v91, v87, 4.0, v85
    v_add_f32 v77, v80, v81
    v_add_f32 v85, v88, v89
    v_sub_f32 v78, v80, v81
    v_sub_f32 v86, v88, v89
    v_fma_f32 v79, v83, 2.0, v82
    v_fma_f32 v87, v91, 2.0, v90
    v_fma_f32 v82, v83, -2.0, v82
    v_fma_f32 v90, v91, -2.0, v90
    v_fmamk_f32 v80, v76, 0x41700000, v82
    v_fmamk_f32 v88, v84, 0x41700000, v90
    v_fmamk_f32 v80, v81, 0x41200000, v80
    v_fmamk_f32 v88, v89, 0x41200000, v88
    v_cvt_pk_bf16_f32 v21, v77, v85
    v_cvt_pk_bf16_f32 v25, v78, v86
    v_cvt_pk_bf16_f32 v65, v79, v87
    v_cvt_pk_bf16_f32 v69, v82, v90
    v_cvt_pk_bf16_f32 v73, v80, v88
    v_lshlrev_b32 v76, 16, v18
    v_and_b32 v84, s25, v18
    v_lshlrev_b32 v77, 16, v22
    v_and_b32 v85, s25, v22
    v_lshlrev_b32 v78, 16, v26
    v_and_b32 v86, s25, v26
    v_lshlrev_b32 v79, 16, v30
    v_and_b32 v87, s25, v30
    v_add_f32 v80, v76, v78
    v_add_f32 v88, v84, v86
    v_add_f32 v81, v77, v79
    v_add_f32 v89, v85, v87
    v_fma_f32 v82, v78, 4.0, v76
    v_fma_f32 v90, v86, 4.0, v84
    v_fma_f32 v83, v79, 4.0, v77
    v_fma_f32 v91, v87, 4.0, v85
    v_add_f32 v77, v80, v81
    v_add_f32 v85, v88, v89
    v_sub_f32 v78, v80, v81
    v_sub_f32 v86, v88, v89
    v_fma_f32 v79, v83, 2.0, v82
    v_fma_f32 v87, v91, 2.0, v90
    v_fma_f32 v82, v83, -2.0, v82
    v_fma_f32 v90, v91, -2.0, v90
    v_fmamk_f32 v80, v76, 0x41700000, v82
    v_fmamk_f32 v88, v84, 0x41700000, v90
    v_fmamk_f32 v80, v81, 0x41200000, v80
    v_fmamk_f32 v88, v89, 0x41200000, v88
    v_cvt_pk_bf16_f32 v22, v77, v85
    v_cvt_pk_bf16_f32 v26, v78, v86
    v_cvt_pk_bf16_f32 v66, v79, v87
    v_cvt_pk_bf16_f32 v70, v82, v90
    v_cvt_pk_bf16_f32 v74, v80, v88
    v_lshlrev_b32 v76, 16, v19
    v_and_b32 v84, s25, v19
    v_lshlrev_b32 v77, 16, v23
    v_and_b32 v85, s25, v23
    v_lshlrev_b32 v78, 16, v27
    v_and_b32 v86, s25, v27
    v_lshlrev_b32 v79, 16, v31
    v_and_b32 v87, s25, v31
    v_add_f32 v80, v76, v78
    v_add_f32 v88, v84, v86
    v_add_f32 v81, v77, v79
    v_add_f32 v89, v85, v87
    v_fma_f32 v82, v78, 4.0, v76
    v_fma_f32 v90, v86, 4.0, v84
    v_fma_f32 v83, v79, 4.0, v77
    v_fma_f32 v91, v87, 4.0, v85
    v_add_f32 v77, v80, v81
    v_add_f32 v85, v88, v89
    v_sub_f32 v78, v80, v81
    v_sub_f32 v86, v88, v89
    v_fma_f32 v79, v83, 2.0, v82
    v_fma_f32 v87, v91, 2.0, v90
    v_fma_f32 v82, v83, -2.0, v82
    v_fma_f32 v90, v91, -2.0, v90
    v_fmamk_f32 v80, v76, 0x41700000, v82
    v_fmamk_f32 v88, v84, 0x41700000, v90
    v_fmamk_f32 v80, v81, 0x41200000, v80
    v_fmamk_f32 v88, v89, 0x41200000, v88
    v_cvt_pk_bf16_f32 v23, v77, v85
    v_cvt_pk_bf16_f32 v27, v78, v86
    v_cvt_pk_bf16_f32 v67, v79, v87
    v_cvt_pk_bf16_f32 v71, v82, v90
    v_cvt_pk_bf16_f32 v75, v80, v88
    ds_write_b128 v96, v[64:67] offset:57344
    ds_write_b128 v97, v[68:71] offset:8192
    ds_write_b128 v97, v[72:75] offset:24576
    ds_write_b128 v96, v[16:19] offset:8192
    ds_write_b128 v96, v[20:23] offset:24576
    ds_write_b128 v96, v[24:27] offset:40960
    ds_write_b128 v98, v[28:31] offset:8704
    buffer_load_dwordx4 v[48:51], v92, s[8:11], s27 offen
    buffer_load_dwordx4 v[56:59], v94, s[8:11], s27 offen
    buffer_load_dwordx4 v[52:55], v93, s[8:11], s27 offen
    buffer_load_dwordx4 v[60:63], v95, s[8:11], s27 offen
    s_add_u32 s28, s28, 1
    s_waitcnt lgkmcnt(0)
    s_barrier
    s_add_u32 s24, s24, 1048576
    s_add_u32 s27, s27, 1048576
    s_waitcnt vmcnt(0)
    v_lshlrev_b32 v76, 16, v32
    v_and_b32 v84, s25, v32
    v_lshlrev_b32 v77, 16, v36
    v_and_b32 v85, s25, v36
    v_lshlrev_b32 v78, 16, v40
    v_and_b32 v86, s25, v40
    v_lshlrev_b32 v79, 16, v44
    v_and_b32 v87, s25, v44
    v_add_f32 v80, v76, v78
    v_add_f32 v88, v84, v86
    v_add_f32 v81, v77, v79
    v_add_f32 v89, v85, v87
    v_fma_f32 v82, v78, 4.0, v76
    v_fma_f32 v90, v86, 4.0, v84
    v_fma_f32 v83, v79, 4.0, v77
    v_fma_f32 v91, v87, 4.0, v85
    v_add_f32 v77, v80, v81
    v_add_f32 v85, v88, v89
    v_sub_f32 v78, v80, v81
    v_sub_f32 v86, v88, v89
    v_fma_f32 v79, v83, 2.0, v82
    v_fma_f32 v87, v91, 2.0, v90
    v_fma_f32 v82, v83, -2.0, v82
    v_fma_f32 v90, v91, -2.0, v90
    v_fmamk_f32 v80, v76, 0x41700000, v82
    v_fmamk_f32 v88, v84, 0x41700000, v90
    v_fmamk_f32 v80, v81, 0x41200000, v80
    v_fmamk_f32 v88, v89, 0x41200000, v88
    v_cvt_pk_bf16_f32 v36, v77, v85
    v_cvt_pk_bf16_f32 v40, v78, v86
    v_cvt_pk_bf16_f32 v64, v79, v87
    v_cvt_pk_bf16_f32 v68, v82, v90
    v_cvt_pk_bf16_f32 v72, v80, v88
    v_lshlrev_b32 v76, 16, v33
    v_and_b32 v84, s25, v33
    v_lshlrev_b32 v77, 16, v37
    v_and_b32 v85, s25, v37
    v_lshlrev_b32 v78, 16, v41
    v_and_b32 v86, s25, v41
    v_lshlrev_b32 v79, 16, v45
    v_and_b32 v87, s25, v45
    v_add_f32 v80, v76, v78
    v_add_f32 v88, v84, v86
    v_add_f32 v81, v77, v79
    v_add_f32 v89, v85, v87
    v_fma_f32 v82, v78, 4.0, v76
    v_fma_f32 v90, v86, 4.0, v84
    v_fma_f32 v83, v79, 4.0, v77
    v_fma_f32 v91, v87, 4.0, v85
    v_add_f32 v77, v80, v81
    v_add_f32 v85, v88, v89
    v_sub_f32 v78, v80, v81
    v_sub_f32 v86, v88, v89
    v_fma_f32 v79, v83, 2.0, v82
    v_fma_f32 v87, v91, 2.0, v90
    v_fma_f32 v82, v83, -2.0, v82
    v_fma_f32 v90, v91, -2.0, v90
    v_fmamk_f32 v80, v76, 0x41700000, v82
    v_fmamk_f32 v88, v84, 0x41700000, v90
    v_fmamk_f32 v80, v81, 0x41200000, v80
    v_fmamk_f32 v88, v89, 0x41200000, v88
    v_cvt_pk_bf16_f32 v37, v77, v85
    v_cvt_pk_bf16_f32 v41, v78, v86
    v_cvt_pk_bf16_f32 v65, v79, v87
    v_cvt_pk_bf16_f32 v69, v82, v90
    v_cvt_pk_bf16_f32 v73, v80, v88
    v_lshlrev_b32 v76, 16, v34
    v_and_b32 v84, s25, v34
    v_lshlrev_b32 v77, 16, v38
    v_and_b32 v85, s25, v38
    v_lshlrev_b32 v78, 16, v42
    v_and_b32 v86, s25, v42
    v_lshlrev_b32 v79, 16, v46
    v_and_b32 v87, s25, v46
    v_add_f32 v80, v76, v78
    v_add_f32 v88, v84, v86
    v_add_f32 v81, v77, v79
    v_add_f32 v89, v85, v87
    v_fma_f32 v82, v78, 4.0, v76
    v_fma_f32 v90, v86, 4.0, v84
    v_fma_f32 v83, v79, 4.0, v77
    v_fma_f32 v91, v87, 4.0, v85
    v_add_f32 v77, v80, v81
    v_add_f32 v85, v88, v89
    v_sub_f32 v78, v80, v81
    v_sub_f32 v86, v88, v89
    v_fma_f32 v79, v83, 2.0, v82
    v_fma_f32 v87, v91, 2.0, v90
    v_fma_f32 v82, v83, -2.0, v82
    v_fma_f32 v90, v91, -2.0, v90
    v_fmamk_f32 v80, v76, 0x41700000, v82
    v_fmamk_f32 v88, v84, 0x41700000, v90
    v_fmamk_f32 v80, v81, 0x41200000, v80
    v_fmamk_f32 v88, v89, 0x41200000, v88
    v_cvt_pk_bf16_f32 v38, v77, v85
    v_cvt_pk_bf16_f32 v42, v78, v86
    v_cvt_pk_bf16_f32 v66, v79, v87
    v_cvt_pk_bf16_f32 v70, v82, v90
    v_cvt_pk_bf16_f32 v74, v80, v88
    v_lshlrev_b32 v76, 16, v35
    v_and_b32 v84, s25, v35
    v_lshlrev_b32 v77, 16, v39
    v_and_b32 v85, s25, v39
    v_lshlrev_b32 v78, 16, v43
    v_and_b32 v86, s25, v43
    v_lshlrev_b32 v79, 16, v47
    v_and_b32 v87, s25, v47
    v_add_f32 v80, v76, v78
    v_add_f32 v88, v84, v86
    v_add_f32 v81, v77, v79
    v_add_f32 v89, v85, v87
    v_fma_f32 v82, v78, 4.0, v76
    v_fma_f32 v90, v86, 4.0, v84
    v_fma_f32 v83, v79, 4.0, v77
    v_fma_f32 v91, v87, 4.0, v85
    v_add_f32 v77, v80, v81
    v_add_f32 v85, v88, v89
    v_sub_f32 v78, v80, v81
    v_sub_f32 v86, v88, v89
    v_fma_f32 v79, v83, 2.0, v82
    v_fma_f32 v87, v91, 2.0, v90
    v_fma_f32 v82, v83, -2.0, v82
    v_fma_f32 v90, v91, -2.0, v90
    v_fmamk_f32 v80, v76, 0x41700000, v82
    v_fmamk_f32 v88, v84, 0x41700000, v90
    v_fmamk_f32 v80, v81, 0x41200000, v80
    v_fmamk_f32 v88, v89, 0x41200000, v88
    v_cvt_pk_bf16_f32 v39, v77, v85
    v_cvt_pk_bf16_f32 v43, v78, v86
    v_cvt_pk_bf16_f32 v67, v79, v87
    v_cvt_pk_bf16_f32 v71, v82, v90
    v_cvt_pk_bf16_f32 v75, v80, v88
    ds_write_b128 v96, v[64:67] offset:49152
    ds_write_b128 v97, v[68:71] offset:0
    ds_write_b128 v97, v[72:75] offset:16384
    ds_write_b128 v96, v[32:35] offset:0
    ds_write_b128 v96, v[36:39] offset:16384
    ds_write_b128 v96, v[40:43] offset:32768
    ds_write_b128 v98, v[44:47] offset:0
    buffer_load_dwordx4 v[0:3], v92, s[8:11], s24 offen
    buffer_load_dwordx4 v[8:11], v94, s[8:11], s24 offen
    buffer_load_dwordx4 v[4:7], v93, s[8:11], s24 offen
    buffer_load_dwordx4 v[12:15], v95, s[8:11], s24 offen
    s_add_u32 s28, s28, 1
    s_waitcnt lgkmcnt(0)
    s_barrier
    v_lshlrev_b32 v76, 16, v48
    v_and_b32 v84, s25, v48
    v_lshlrev_b32 v77, 16, v52
    v_and_b32 v85, s25, v52
    v_lshlrev_b32 v78, 16, v56
    v_and_b32 v86, s25, v56
    v_lshlrev_b32 v79, 16, v60
    v_and_b32 v87, s25, v60
    v_add_f32 v80, v76, v78
    v_add_f32 v88, v84, v86
    v_add_f32 v81, v77, v79
    v_add_f32 v89, v85, v87
    v_fma_f32 v82, v78, 4.0, v76
    v_fma_f32 v90, v86, 4.0, v84
    v_fma_f32 v83, v79, 4.0, v77
    v_fma_f32 v91, v87, 4.0, v85
    v_add_f32 v77, v80, v81
    v_add_f32 v85, v88, v89
    v_sub_f32 v78, v80, v81
    v_sub_f32 v86, v88, v89
    v_fma_f32 v79, v83, 2.0, v82
    v_fma_f32 v87, v91, 2.0, v90
    v_fma_f32 v82, v83, -2.0, v82
    v_fma_f32 v90, v91, -2.0, v90
    v_fmamk_f32 v80, v76, 0x41700000, v82
    v_fmamk_f32 v88, v84, 0x41700000, v90
    v_fmamk_f32 v80, v81, 0x41200000, v80
    v_fmamk_f32 v88, v89, 0x41200000, v88
    v_cvt_pk_bf16_f32 v52, v77, v85
    v_cvt_pk_bf16_f32 v56, v78, v86
    v_cvt_pk_bf16_f32 v64, v79, v87
    v_cvt_pk_bf16_f32 v68, v82, v90
    v_cvt_pk_bf16_f32 v72, v80, v88
    v_lshlrev_b32 v76, 16, v49
    v_and_b32 v84, s25, v49
    v_lshlrev_b32 v77, 16, v53
    v_and_b32 v85, s25, v53
    v_lshlrev_b32 v78, 16, v57
    v_and_b32 v86, s25, v57
    v_lshlrev_b32 v79, 16, v61
    v_and_b32 v87, s25, v61
    v_add_f32 v80, v76, v78
    v_add_f32 v88, v84, v86
    v_add_f32 v81, v77, v79
    v_add_f32 v89, v85, v87
    v_fma_f32 v82, v78, 4.0, v76
    v_fma_f32 v90, v86, 4.0, v84
    v_fma_f32 v83, v79, 4.0, v77
    v_fma_f32 v91, v87, 4.0, v85
    v_add_f32 v77, v80, v81
    v_add_f32 v85, v88, v89
    v_sub_f32 v78, v80, v81
    v_sub_f32 v86, v88, v89
    v_fma_f32 v79, v83, 2.0, v82
    v_fma_f32 v87, v91, 2.0, v90
    v_fma_f32 v82, v83, -2.0, v82
    v_fma_f32 v90, v91, -2.0, v90
    v_fmamk_f32 v80, v76, 0x41700000, v82
    v_fmamk_f32 v88, v84, 0x41700000, v90
    v_fmamk_f32 v80, v81, 0x41200000, v80
    v_fmamk_f32 v88, v89, 0x41200000, v88
    v_cvt_pk_bf16_f32 v53, v77, v85
    v_cvt_pk_bf16_f32 v57, v78, v86
    v_cvt_pk_bf16_f32 v65, v79, v87
    v_cvt_pk_bf16_f32 v69, v82, v90
    v_cvt_pk_bf16_f32 v73, v80, v88
    v_lshlrev_b32 v76, 16, v50
    v_and_b32 v84, s25, v50
    v_lshlrev_b32 v77, 16, v54
    v_and_b32 v85, s25, v54
    v_lshlrev_b32 v78, 16, v58
    v_and_b32 v86, s25, v58
    v_lshlrev_b32 v79, 16, v62
    v_and_b32 v87, s25, v62
    v_add_f32 v80, v76, v78
    v_add_f32 v88, v84, v86
    v_add_f32 v81, v77, v79
    v_add_f32 v89, v85, v87
    v_fma_f32 v82, v78, 4.0, v76
    v_fma_f32 v90, v86, 4.0, v84
    v_fma_f32 v83, v79, 4.0, v77
    v_fma_f32 v91, v87, 4.0, v85
    v_add_f32 v77, v80, v81
    v_add_f32 v85, v88, v89
    v_sub_f32 v78, v80, v81
    v_sub_f32 v86, v88, v89
    v_fma_f32 v79, v83, 2.0, v82
    v_fma_f32 v87, v91, 2.0, v90
    v_fma_f32 v82, v83, -2.0, v82
    v_fma_f32 v90, v91, -2.0, v90
    v_fmamk_f32 v80, v76, 0x41700000, v82
    v_fmamk_f32 v88, v84, 0x41700000, v90
    v_fmamk_f32 v80, v81, 0x41200000, v80
    v_fmamk_f32 v88, v89, 0x41200000, v88
    v_cvt_pk_bf16_f32 v54, v77, v85
    v_cvt_pk_bf16_f32 v58, v78, v86
    v_cvt_pk_bf16_f32 v66, v79, v87
    v_cvt_pk_bf16_f32 v70, v82, v90
    v_cvt_pk_bf16_f32 v74, v80, v88
    v_lshlrev_b32 v76, 16, v51
    v_and_b32 v84, s25, v51
    v_lshlrev_b32 v77, 16, v55
    v_and_b32 v85, s25, v55
    v_lshlrev_b32 v78, 16, v59
    v_and_b32 v86, s25, v59
    v_lshlrev_b32 v79, 16, v63
    v_and_b32 v87, s25, v63
    v_add_f32 v80, v76, v78
    v_add_f32 v88, v84, v86
    v_add_f32 v81, v77, v79
    v_add_f32 v89, v85, v87
    v_fma_f32 v82, v78, 4.0, v76
    v_fma_f32 v90, v86, 4.0, v84
    v_fma_f32 v83, v79, 4.0, v77
    v_fma_f32 v91, v87, 4.0, v85
    v_add_f32 v77, v80, v81
    v_add_f32 v85, v88, v89
    v_sub_f32 v78, v80, v81
    v_sub_f32 v86, v88, v89
    v_fma_f32 v79, v83, 2.0, v82
    v_fma_f32 v87, v91, 2.0, v90
    v_fma_f32 v82, v83, -2.0, v82
    v_fma_f32 v90, v91, -2.0, v90
    v_fmamk_f32 v80, v76, 0x41700000, v82
    v_fmamk_f32 v88, v84, 0x41700000, v90
    v_fmamk_f32 v80, v81, 0x41200000, v80
    v_fmamk_f32 v88, v89, 0x41200000, v88
    v_cvt_pk_bf16_f32 v55, v77, v85
    v_cvt_pk_bf16_f32 v59, v78, v86
    v_cvt_pk_bf16_f32 v67, v79, v87
    v_cvt_pk_bf16_f32 v71, v82, v90
    v_cvt_pk_bf16_f32 v75, v80, v88
    ds_write_b128 v96, v[64:67] offset:57344
    ds_write_b128 v97, v[68:71] offset:8192
    ds_write_b128 v97, v[72:75] offset:24576
    ds_write_b128 v96, v[48:51] offset:8192
    ds_write_b128 v96, v[52:55] offset:24576
    ds_write_b128 v96, v[56:59] offset:40960
    ds_write_b128 v98, v[60:63] offset:8704
    buffer_load_dwordx4 v[16:19], v92, s[8:11], s27 offen
    buffer_load_dwordx4 v[24:27], v94, s[8:11], s27 offen
    buffer_load_dwordx4 v[20:23], v93, s[8:11], s27 offen
    buffer_load_dwordx4 v[28:31], v95, s[8:11], s27 offen
    s_add_u32 s28, s28, 1
    s_waitcnt lgkmcnt(0)
    s_barrier
    s_cmp_eq_u32 s22, 1
    s_cbranch_scc1 L_conv2_kernel_hlast1
    s_add_u32 s24, s24, 1048576
    s_add_u32 s27, s27, 1048576
    s_waitcnt vmcnt(0)
    v_lshlrev_b32 v76, 16, v0
    v_and_b32 v84, s25, v0
    v_lshlrev_b32 v77, 16, v4
    v_and_b32 v85, s25, v4
    v_lshlrev_b32 v78, 16, v8
    v_and_b32 v86, s25, v8
    v_lshlrev_b32 v79, 16, v12
    v_and_b32 v87, s25, v12
    v_add_f32 v80, v76, v78
    v_add_f32 v88, v84, v86
    v_add_f32 v81, v77, v79
    v_add_f32 v89, v85, v87
    v_fma_f32 v82, v78, 4.0, v76
    v_fma_f32 v90, v86, 4.0, v84
    v_fma_f32 v83, v79, 4.0, v77
    v_fma_f32 v91, v87, 4.0, v85
    v_add_f32 v77, v80, v81
    v_add_f32 v85, v88, v89
    v_sub_f32 v78, v80, v81
    v_sub_f32 v86, v88, v89
    v_fma_f32 v79, v83, 2.0, v82
    v_fma_f32 v87, v91, 2.0, v90
    v_fma_f32 v82, v83, -2.0, v82
    v_fma_f32 v90, v91, -2.0, v90
    v_fmamk_f32 v80, v76, 0x41700000, v82
    v_fmamk_f32 v88, v84, 0x41700000, v90
    v_fmamk_f32 v80, v81, 0x41200000, v80
    v_fmamk_f32 v88, v89, 0x41200000, v88
    v_cvt_pk_bf16_f32 v4, v77, v85
    v_cvt_pk_bf16_f32 v8, v78, v86
    v_cvt_pk_bf16_f32 v64, v79, v87
    v_cvt_pk_bf16_f32 v68, v82, v90
    v_cvt_pk_bf16_f32 v72, v80, v88
    v_lshlrev_b32 v76, 16, v1
    v_and_b32 v84, s25, v1
    v_lshlrev_b32 v77, 16, v5
    v_and_b32 v85, s25, v5
    v_lshlrev_b32 v78, 16, v9
    v_and_b32 v86, s25, v9
    v_lshlrev_b32 v79, 16, v13
    v_and_b32 v87, s25, v13
    v_add_f32 v80, v76, v78
    v_add_f32 v88, v84, v86
    v_add_f32 v81, v77, v79
    v_add_f32 v89, v85, v87
    v_fma_f32 v82, v78, 4.0, v76
    v_fma_f32 v90, v86, 4.0, v84
    v_fma_f32 v83, v79, 4.0, v77
    v_fma_f32 v91, v87, 4.0, v85
    v_add_f32 v77, v80, v81
    v_add_f32 v85, v88, v89
    v_sub_f32 v78, v80, v81
    v_sub_f32 v86, v88, v89
    v_fma_f32 v79, v83, 2.0, v82
    v_fma_f32 v87, v91, 2.0, v90
    v_fma_f32 v82, v83, -2.0, v82
    v_fma_f32 v90, v91, -2.0, v90
    v_fmamk_f32 v80, v76, 0x41700000, v82
    v_fmamk_f32 v88, v84, 0x41700000, v90
    v_fmamk_f32 v80, v81, 0x41200000, v80
    v_fmamk_f32 v88, v89, 0x41200000, v88
    v_cvt_pk_bf16_f32 v5, v77, v85
    v_cvt_pk_bf16_f32 v9, v78, v86
    v_cvt_pk_bf16_f32 v65, v79, v87
    v_cvt_pk_bf16_f32 v69, v82, v90
    v_cvt_pk_bf16_f32 v73, v80, v88
    v_lshlrev_b32 v76, 16, v2
    v_and_b32 v84, s25, v2
    v_lshlrev_b32 v77, 16, v6
    v_and_b32 v85, s25, v6
    v_lshlrev_b32 v78, 16, v10
    v_and_b32 v86, s25, v10
    v_lshlrev_b32 v79, 16, v14
    v_and_b32 v87, s25, v14
    v_add_f32 v80, v76, v78
    v_add_f32 v88, v84, v86
    v_add_f32 v81, v77, v79
    v_add_f32 v89, v85, v87
    v_fma_f32 v82, v78, 4.0, v76
    v_fma_f32 v90, v86, 4.0, v84
    v_fma_f32 v83, v79, 4.0, v77
    v_fma_f32 v91, v87, 4.0, v85
    v_add_f32 v77, v80, v81
    v_add_f32 v85, v88, v89
    v_sub_f32 v78, v80, v81
    v_sub_f32 v86, v88, v89
    v_fma_f32 v79, v83, 2.0, v82
    v_fma_f32 v87, v91, 2.0, v90
    v_fma_f32 v82, v83, -2.0, v82
    v_fma_f32 v90, v91, -2.0, v90
    v_fmamk_f32 v80, v76, 0x41700000, v82
    v_fmamk_f32 v88, v84, 0x41700000, v90
    v_fmamk_f32 v80, v81, 0x41200000, v80
    v_fmamk_f32 v88, v89, 0x41200000, v88
    v_cvt_pk_bf16_f32 v6, v77, v85
    v_cvt_pk_bf16_f32 v10, v78, v86
    v_cvt_pk_bf16_f32 v66, v79, v87
    v_cvt_pk_bf16_f32 v70, v82, v90
    v_cvt_pk_bf16_f32 v74, v80, v88
    v_lshlrev_b32 v76, 16, v3
    v_and_b32 v84, s25, v3
    v_lshlrev_b32 v77, 16, v7
    v_and_b32 v85, s25, v7
    v_lshlrev_b32 v78, 16, v11
    v_and_b32 v86, s25, v11
    v_lshlrev_b32 v79, 16, v15
    v_and_b32 v87, s25, v15
    v_add_f32 v80, v76, v78
    v_add_f32 v88, v84, v86
    v_add_f32 v81, v77, v79
    v_add_f32 v89, v85, v87
    v_fma_f32 v82, v78, 4.0, v76
    v_fma_f32 v90, v86, 4.0, v84
    v_fma_f32 v83, v79, 4.0, v77
    v_fma_f32 v91, v87, 4.0, v85
    v_add_f32 v77, v80, v81
    v_add_f32 v85, v88, v89
    v_sub_f32 v78, v80, v81
    v_sub_f32 v86, v88, v89
    v_fma_f32 v79, v83, 2.0, v82
    v_fma_f32 v87, v91, 2.0, v90
    v_fma_f32 v82, v83, -2.0, v82
    v_fma_f32 v90, v91, -2.0, v90
    v_fmamk_f32 v80, v76, 0x41700000, v82
    v_fmamk_f32 v88, v84, 0x41700000, v90
    v_fmamk_f32 v80, v81, 0x41200000, v80
    v_fmamk_f32 v88, v89, 0x41200000, v88
    v_cvt_pk_bf16_f32 v7, v77, v85
    v_cvt_pk_bf16_f32 v11, v78, v86
    v_cvt_pk_bf16_f32 v67, v79, v87
    v_cvt_pk_bf16_f32 v71, v82, v90
    v_cvt_pk_bf16_f32 v75, v80, v88
    ds_write_b128 v96, v[64:67] offset:49152
    ds_write_b128 v97, v[68:71] offset:0
    ds_write_b128 v97, v[72:75] offset:16384
    ds_write_b128 v96, v[0:3] offset:0
    ds_write_b128 v96, v[4:7] offset:16384
    ds_write_b128 v96, v[8:11] offset:32768
    ds_write_b128 v98, v[12:15] offset:0
    buffer_load_dwordx4 v[32:35], v92, s[8:11], s24 offen
    buffer_load_dwordx4 v[40:43], v94, s[8:11], s24 offen
    buffer_load_dwordx4 v[36:39], v93, s[8:11], s24 offen
    buffer_load_dwordx4 v[44:47], v95, s[8:11], s24 offen
    s_add_u32 s28, s28, 1
    s_waitcnt lgkmcnt(0)
    s_barrier
    s_sub_u32 s22, s22, 1
    s_branch L_conv2_kernel_hloop1
L_conv2_kernel_hlast1:
    s_add_u32 s12, s30, 44040192
    s_addc_u32 s13, s31, 0
    s_mov_b32 s14, 294912
    s_mov_b32 s15, 0x00020000
    s_lshr_b32 s36, s2, 3
    s_lshl_b32 s36, s36, 2
    s_add_u32 s36, s36, s32
    s_mul_i32 s36, s36, 2304
    v_lshlrev_b32 v1, 4, v127
    buffer_load_dwordx4 v[4:7], v1, s[12:15], s36 offen offset:0
    buffer_load_dwordx4 v[4:7], v1, s[12:15], s36 offen offset:1024
    buffer_load_dwordx4 v[4:7], v1, s[12:15], s36 offen offset:2048
    s_cmp_ge_u32 s2, 32
    s_cbranch_scc1 L_conv2_kernel_ntw
    s_getpc_b64 s[36:37]
L_conv2_kernel_pc:
    s_lshl_b32 s38, s32, 13
    s_add_u32 s38, s38, L_conv2_kernel_epi-L_conv2_kernel_pc
    v_lshl_add_u32 v2, v127, 7, s38
    v_min_u32 v2, L_joint_kernel_done-L_conv2_kernel_pc, v2
    v_mov_b32 v3, s37
    v_add_co_u32 v2, vcc, s36, v2
    s_nop 1
    v_addc_co_u32 v3, vcc, 0, v3, vcc
    global_load_dword v4, v[2:3], off
L_conv2_kernel_ntw:
    s_branch L_conv2_kernel_end
L_conv2_kernel_h2:
    s_mov_b32 s24, 1048576
    s_mov_b32 s27, 1572864
    s_waitcnt lgkmcnt(0)
    s_barrier
    buffer_load_dwordx4 v[32:35], v92, s[8:11], s24 offen
    buffer_load_dwordx4 v[40:43], v94, s[8:11], s24 offen
    buffer_load_dwordx4 v[36:39], v93, s[8:11], s24 offen
    buffer_load_dwordx4 v[44:47], v95, s[8:11], s24 offen
    buffer_load_dwordx4 v[48:51], v92, s[8:11], s27 offen
    buffer_load_dwordx4 v[56:59], v94, s[8:11], s27 offen
    buffer_load_dwordx4 v[52:55], v93, s[8:11], s27 offen
    buffer_load_dwordx4 v[60:63], v95, s[8:11], s27 offen
    s_setprio 0
    v_lshlrev_b32 v76, 16, v16
    v_and_b32 v84, s25, v16
    v_lshlrev_b32 v77, 16, v20
    v_and_b32 v85, s25, v20
    v_lshlrev_b32 v78, 16, v24
    v_and_b32 v86, s25, v24
    v_lshlrev_b32 v79, 16, v28
    v_and_b32 v87, s25, v28
    v_add_f32 v80, v76, v78
    v_add_f32 v88, v84, v86
    v_add_f32 v81, v77, v79
    v_add_f32 v89, v85, v87
    v_fma_f32 v82, v78, 4.0, v76
    v_fma_f32 v90, v86, 4.0, v84
    v_fma_f32 v83, v79, 4.0, v77
    v_fma_f32 v91, v87, 4.0, v85
    v_add_f32 v77, v80, v81
    v_add_f32 v85, v88, v89
    v_sub_f32 v78, v80, v81
    v_sub_f32 v86, v88, v89
    v_fma_f32 v79, v83, 2.0, v82
    v_fma_f32 v87, v91, 2.0, v90
    v_fma_f32 v82, v83, -2.0, v82
    v_fma_f32 v90, v91, -2.0, v90
    v_fmamk_f32 v80, v76, 0x41700000, v82
    v_fmamk_f32 v88, v84, 0x41700000, v90
    v_fmamk_f32 v80, v81, 0x41200000, v80
    v_fmamk_f32 v88, v89, 0x41200000, v88
    v_cvt_pk_bf16_f32 v20, v77, v85
    v_cvt_pk_bf16_f32 v24, v78, v86
    v_cvt_pk_bf16_f32 v64, v79, v87
    v_cvt_pk_bf16_f32 v68, v82, v90
    v_cvt_pk_bf16_f32 v72, v80, v88
    v_lshlrev_b32 v76, 16, v17
    v_and_b32 v84, s25, v17
    v_lshlrev_b32 v77, 16, v21
    v_and_b32 v85, s25, v21
    v_lshlrev_b32 v78, 16, v25
    v_and_b32 v86, s25, v25
    v_lshlrev_b32 v79, 16, v29
    v_and_b32 v87, s25, v29
    v_add_f32 v80, v76, v78
    v_add_f32 v88, v84, v86
    v_add_f32 v81, v77, v79
    v_add_f32 v89, v85, v87
    v_fma_f32 v82, v78, 4.0, v76
    v_fma_f32 v90, v86, 4.0, v84
    v_fma_f32 v83, v79, 4.0, v77
    v_fma_f32 v91, v87, 4.0, v85
    v_add_f32 v77, v80, v81
    v_add_f32 v85, v88, v89
    v_sub_f32 v78, v80, v81
    v_sub_f32 v86, v88, v89
    v_fma_f32 v79, v83, 2.0, v82
    v_fma_f32 v87, v91, 2.0, v90
    v_fma_f32 v82, v83, -2.0, v82
    v_fma_f32 v90, v91, -2.0, v90
    v_fmamk_f32 v80, v76, 0x41700000, v82
    v_fmamk_f32 v88, v84, 0x41700000, v90
    v_fmamk_f32 v80, v81, 0x41200000, v80
    v_fmamk_f32 v88, v89, 0x41200000, v88
    v_cvt_pk_bf16_f32 v21, v77, v85
    v_cvt_pk_bf16_f32 v25, v78, v86
    v_cvt_pk_bf16_f32 v65, v79, v87
    v_cvt_pk_bf16_f32 v69, v82, v90
    v_cvt_pk_bf16_f32 v73, v80, v88
    v_lshlrev_b32 v76, 16, v18
    v_and_b32 v84, s25, v18
    v_lshlrev_b32 v77, 16, v22
    v_and_b32 v85, s25, v22
    v_lshlrev_b32 v78, 16, v26
    v_and_b32 v86, s25, v26
    v_lshlrev_b32 v79, 16, v30
    v_and_b32 v87, s25, v30
    v_add_f32 v80, v76, v78
    v_add_f32 v88, v84, v86
    v_add_f32 v81, v77, v79
    v_add_f32 v89, v85, v87
    v_fma_f32 v82, v78, 4.0, v76
    v_fma_f32 v90, v86, 4.0, v84
    v_fma_f32 v83, v79, 4.0, v77
    v_fma_f32 v91, v87, 4.0, v85
    v_add_f32 v77, v80, v81
    v_add_f32 v85, v88, v89
    v_sub_f32 v78, v80, v81
    v_sub_f32 v86, v88, v89
    v_fma_f32 v79, v83, 2.0, v82
    v_fma_f32 v87, v91, 2.0, v90
    v_fma_f32 v82, v83, -2.0, v82
    v_fma_f32 v90, v91, -2.0, v90
    v_fmamk_f32 v80, v76, 0x41700000, v82
    v_fmamk_f32 v88, v84, 0x41700000, v90
    v_fmamk_f32 v80, v81, 0x41200000, v80
    v_fmamk_f32 v88, v89, 0x41200000, v88
    v_cvt_pk_bf16_f32 v22, v77, v85
    v_cvt_pk_bf16_f32 v26, v78, v86
    v_cvt_pk_bf16_f32 v66, v79, v87
    v_cvt_pk_bf16_f32 v70, v82, v90
    v_cvt_pk_bf16_f32 v74, v80, v88
    v_lshlrev_b32 v76, 16, v19
    v_and_b32 v84, s25, v19
    v_lshlrev_b32 v77, 16, v23
    v_and_b32 v85, s25, v23
    v_lshlrev_b32 v78, 16, v27
    v_and_b32 v86, s25, v27
    v_lshlrev_b32 v79, 16, v31
    v_and_b32 v87, s25, v31
    v_add_f32 v80, v76, v78
    v_add_f32 v88, v84, v86
    v_add_f32 v81, v77, v79
    v_add_f32 v89, v85, v87
    v_fma_f32 v82, v78, 4.0, v76
    v_fma_f32 v90, v86, 4.0, v84
    v_fma_f32 v83, v79, 4.0, v77
    v_fma_f32 v91, v87, 4.0, v85
    v_add_f32 v77, v80, v81
    v_add_f32 v85, v88, v89
    v_sub_f32 v78, v80, v81
    v_sub_f32 v86, v88, v89
    v_fma_f32 v79, v83, 2.0, v82
    v_fma_f32 v87, v91, 2.0, v90
    v_fma_f32 v82, v83, -2.0, v82
    v_fma_f32 v90, v91, -2.0, v90
    v_fmamk_f32 v80, v76, 0x41700000, v82
    v_fmamk_f32 v88, v84, 0x41700000, v90
    v_fmamk_f32 v80, v81, 0x41200000, v80
    v_fmamk_f32 v88, v89, 0x41200000, v88
    v_cvt_pk_bf16_f32 v23, v77, v85
    v_cvt_pk_bf16_f32 v27, v78, v86
    v_cvt_pk_bf16_f32 v67, v79, v87
    v_cvt_pk_bf16_f32 v71, v82, v90
    v_cvt_pk_bf16_f32 v75, v80, v88
L_conv2_kernel_hloop2:
    s_add_u32 s24, s24, 1048576
    s_add_u32 s27, s27, 1048576
    ds_write_b128 v96, v[64:67] offset:57344
    ds_write_b128 v97, v[68:71] offset:8192
    ds_write_b128 v97, v[72:75] offset:24576
    ds_write_b128 v96, v[16:19] offset:8192
    ds_write_b128 v96, v[20:23] offset:24576
    ds_write_b128 v96, v[24:27] offset:40960
    ds_write_b128 v98, v[28:31] offset:8704
    s_waitcnt vmcnt(0)
    buffer_load_dwordx4 v[0:3], v92, s[8:11], s24 offen
    buffer_load_dwordx4 v[8:11], v94, s[8:11], s24 offen
    buffer_load_dwordx4 v[4:7], v93, s[8:11], s24 offen
    buffer_load_dwordx4 v[12:15], v95, s[8:11], s24 offen
    v_lshlrev_b32 v76, 16, v32
    v_and_b32 v84, s25, v32
    v_lshlrev_b32 v77, 16, v36
    v_and_b32 v85, s25, v36
    v_lshlrev_b32 v78, 16, v40
    v_and_b32 v86, s25, v40
    v_lshlrev_b32 v79, 16, v44
    v_and_b32 v87, s25, v44
    v_add_f32 v80, v76, v78
    v_add_f32 v88, v84, v86
    v_add_f32 v81, v77, v79
    v_add_f32 v89, v85, v87
    v_fma_f32 v82, v78, 4.0, v76
    v_fma_f32 v90, v86, 4.0, v84
    v_fma_f32 v83, v79, 4.0, v77
    v_fma_f32 v91, v87, 4.0, v85
    v_add_f32 v77, v80, v81
    v_add_f32 v85, v88, v89
    v_sub_f32 v78, v80, v81
    v_sub_f32 v86, v88, v89
    v_fma_f32 v79, v83, 2.0, v82
    v_fma_f32 v87, v91, 2.0, v90
    v_fma_f32 v82, v83, -2.0, v82
    v_fma_f32 v90, v91, -2.0, v90
    v_fmamk_f32 v80, v76, 0x41700000, v82
    v_fmamk_f32 v88, v84, 0x41700000, v90
    v_fmamk_f32 v80, v81, 0x41200000, v80
    v_fmamk_f32 v88, v89, 0x41200000, v88
    v_cvt_pk_bf16_f32 v36, v77, v85
    v_cvt_pk_bf16_f32 v40, v78, v86
    v_cvt_pk_bf16_f32 v64, v79, v87
    v_cvt_pk_bf16_f32 v68, v82, v90
    v_cvt_pk_bf16_f32 v72, v80, v88
    v_lshlrev_b32 v76, 16, v33
    v_and_b32 v84, s25, v33
    v_lshlrev_b32 v77, 16, v37
    v_and_b32 v85, s25, v37
    v_lshlrev_b32 v78, 16, v41
    v_and_b32 v86, s25, v41
    v_lshlrev_b32 v79, 16, v45
    v_and_b32 v87, s25, v45
    v_add_f32 v80, v76, v78
    v_add_f32 v88, v84, v86
    v_add_f32 v81, v77, v79
    v_add_f32 v89, v85, v87
    v_fma_f32 v82, v78, 4.0, v76
    v_fma_f32 v90, v86, 4.0, v84
    v_fma_f32 v83, v79, 4.0, v77
    v_fma_f32 v91, v87, 4.0, v85
    v_add_f32 v77, v80, v81
    v_add_f32 v85, v88, v89
    v_sub_f32 v78, v80, v81
    v_sub_f32 v86, v88, v89
    v_fma_f32 v79, v83, 2.0, v82
    v_fma_f32 v87, v91, 2.0, v90
    v_fma_f32 v82, v83, -2.0, v82
    v_fma_f32 v90, v91, -2.0, v90
    v_fmamk_f32 v80, v76, 0x41700000, v82
    v_fmamk_f32 v88, v84, 0x41700000, v90
    v_fmamk_f32 v80, v81, 0x41200000, v80
    v_fmamk_f32 v88, v89, 0x41200000, v88
    v_cvt_pk_bf16_f32 v37, v77, v85
    v_cvt_pk_bf16_f32 v41, v78, v86
    v_cvt_pk_bf16_f32 v65, v79, v87
    v_cvt_pk_bf16_f32 v69, v82, v90
    v_cvt_pk_bf16_f32 v73, v80, v88
    v_lshlrev_b32 v76, 16, v34
    v_and_b32 v84, s25, v34
    v_lshlrev_b32 v77, 16, v38
    v_and_b32 v85, s25, v38
    v_lshlrev_b32 v78, 16, v42
    v_and_b32 v86, s25, v42
    v_lshlrev_b32 v79, 16, v46
    v_and_b32 v87, s25, v46
    v_add_f32 v80, v76, v78
    v_add_f32 v88, v84, v86
    v_add_f32 v81, v77, v79
    v_add_f32 v89, v85, v87
    v_fma_f32 v82, v78, 4.0, v76
    v_fma_f32 v90, v86, 4.0, v84
    v_fma_f32 v83, v79, 4.0, v77
    v_fma_f32 v91, v87, 4.0, v85
    v_add_f32 v77, v80, v81
    v_add_f32 v85, v88, v89
    v_sub_f32 v78, v80, v81
    v_sub_f32 v86, v88, v89
    v_fma_f32 v79, v83, 2.0, v82
    v_fma_f32 v87, v91, 2.0, v90
    v_fma_f32 v82, v83, -2.0, v82
    v_fma_f32 v90, v91, -2.0, v90
    v_fmamk_f32 v80, v76, 0x41700000, v82
    v_fmamk_f32 v88, v84, 0x41700000, v90
    v_fmamk_f32 v80, v81, 0x41200000, v80
    v_fmamk_f32 v88, v89, 0x41200000, v88
    v_cvt_pk_bf16_f32 v38, v77, v85
    v_cvt_pk_bf16_f32 v42, v78, v86
    v_cvt_pk_bf16_f32 v66, v79, v87
    v_cvt_pk_bf16_f32 v70, v82, v90
    v_cvt_pk_bf16_f32 v74, v80, v88
    v_lshlrev_b32 v76, 16, v35
    v_and_b32 v84, s25, v35
    v_lshlrev_b32 v77, 16, v39
    v_and_b32 v85, s25, v39
    v_lshlrev_b32 v78, 16, v43
    v_and_b32 v86, s25, v43
    v_lshlrev_b32 v79, 16, v47
    v_and_b32 v87, s25, v47
    v_add_f32 v80, v76, v78
    v_add_f32 v88, v84, v86
    v_add_f32 v81, v77, v79
    v_add_f32 v89, v85, v87
    v_fma_f32 v82, v78, 4.0, v76
    v_fma_f32 v90, v86, 4.0, v84
    v_fma_f32 v83, v79, 4.0, v77
    v_fma_f32 v91, v87, 4.0, v85
    v_add_f32 v77, v80, v81
    v_add_f32 v85, v88, v89
    v_sub_f32 v78, v80, v81
    v_sub_f32 v86, v88, v89
    v_fma_f32 v79, v83, 2.0, v82
    v_fma_f32 v87, v91, 2.0, v90
    v_fma_f32 v82, v83, -2.0, v82
    v_fma_f32 v90, v91, -2.0, v90
    v_fmamk_f32 v80, v76, 0x41700000, v82
    v_fmamk_f32 v88, v84, 0x41700000, v90
    v_fmamk_f32 v80, v81, 0x41200000, v80
    v_fmamk_f32 v88, v89, 0x41200000, v88
    v_cvt_pk_bf16_f32 v39, v77, v85
    v_cvt_pk_bf16_f32 v43, v78, v86
    v_cvt_pk_bf16_f32 v67, v79, v87
    v_cvt_pk_bf16_f32 v71, v82, v90
    v_cvt_pk_bf16_f32 v75, v80, v88
    s_add_u32 s28, s28, 1
    s_waitcnt lgkmcnt(0)
    s_barrier
    ds_write_b128 v96, v[64:67] offset:49152
    ds_write_b128 v97, v[68:71] offset:0
    ds_write_b128 v97, v[72:75] offset:16384
    ds_write_b128 v96, v[32:35] offset:0
    ds_write_b128 v96, v[36:39] offset:16384
    ds_write_b128 v96, v[40:43] offset:32768
    ds_write_b128 v98, v[44:47] offset:0
    buffer_load_dwordx4 v[16:19], v92, s[8:11], s27 offen
    buffer_load_dwordx4 v[24:27], v94, s[8:11], s27 offen
    buffer_load_dwordx4 v[20:23], v93, s[8:11], s27 offen
    buffer_load_dwordx4 v[28:31], v95, s[8:11], s27 offen
    v_lshlrev_b32 v76, 16, v48
    v_and_b32 v84, s25, v48
    v_lshlrev_b32 v77, 16, v52
    v_and_b32 v85, s25, v52
    v_lshlrev_b32 v78, 16, v56
    v_and_b32 v86, s25, v56
    v_lshlrev_b32 v79, 16, v60
    v_and_b32 v87, s25, v60
    v_add_f32 v80, v76, v78
    v_add_f32 v88, v84, v86
    v_add_f32 v81, v77, v79
    v_add_f32 v89, v85, v87
    v_fma_f32 v82, v78, 4.0, v76
    v_fma_f32 v90, v86, 4.0, v84
    v_fma_f32 v83, v79, 4.0, v77
    v_fma_f32 v91, v87, 4.0, v85
    v_add_f32 v77, v80, v81
    v_add_f32 v85, v88, v89
    v_sub_f32 v78, v80, v81
    v_sub_f32 v86, v88, v89
    v_fma_f32 v79, v83, 2.0, v82
    v_fma_f32 v87, v91, 2.0, v90
    v_fma_f32 v82, v83, -2.0, v82
    v_fma_f32 v90, v91, -2.0, v90
    v_fmamk_f32 v80, v76, 0x41700000, v82
    v_fmamk_f32 v88, v84, 0x41700000, v90
    v_fmamk_f32 v80, v81, 0x41200000, v80
    v_fmamk_f32 v88, v89, 0x41200000, v88
    v_cvt_pk_bf16_f32 v52, v77, v85
    v_cvt_pk_bf16_f32 v56, v78, v86
    v_cvt_pk_bf16_f32 v64, v79, v87
    v_cvt_pk_bf16_f32 v68, v82, v90
    v_cvt_pk_bf16_f32 v72, v80, v88
    v_lshlrev_b32 v76, 16, v49
    v_and_b32 v84, s25, v49
    v_lshlrev_b32 v77, 16, v53
    v_and_b32 v85, s25, v53
    v_lshlrev_b32 v78, 16, v57
    v_and_b32 v86, s25, v57
    v_lshlrev_b32 v79, 16, v61
    v_and_b32 v87, s25, v61
    v_add_f32 v80, v76, v78
    v_add_f32 v88, v84, v86
    v_add_f32 v81, v77, v79
    v_add_f32 v89, v85, v87
    v_fma_f32 v82, v78, 4.0, v76
    v_fma_f32 v90, v86, 4.0, v84
    v_fma_f32 v83, v79, 4.0, v77
    v_fma_f32 v91, v87, 4.0, v85
    v_add_f32 v77, v80, v81
    v_add_f32 v85, v88, v89
    v_sub_f32 v78, v80, v81
    v_sub_f32 v86, v88, v89
    v_fma_f32 v79, v83, 2.0, v82
    v_fma_f32 v87, v91, 2.0, v90
    v_fma_f32 v82, v83, -2.0, v82
    v_fma_f32 v90, v91, -2.0, v90
    v_fmamk_f32 v80, v76, 0x41700000, v82
    v_fmamk_f32 v88, v84, 0x41700000, v90
    v_fmamk_f32 v80, v81, 0x41200000, v80
    v_fmamk_f32 v88, v89, 0x41200000, v88
    v_cvt_pk_bf16_f32 v53, v77, v85
    v_cvt_pk_bf16_f32 v57, v78, v86
    v_cvt_pk_bf16_f32 v65, v79, v87
    v_cvt_pk_bf16_f32 v69, v82, v90
    v_cvt_pk_bf16_f32 v73, v80, v88
    v_lshlrev_b32 v76, 16, v50
    v_and_b32 v84, s25, v50
    v_lshlrev_b32 v77, 16, v54
    v_and_b32 v85, s25, v54
    v_lshlrev_b32 v78, 16, v58
    v_and_b32 v86, s25, v58
    v_lshlrev_b32 v79, 16, v62
    v_and_b32 v87, s25, v62
    v_add_f32 v80, v76, v78
    v_add_f32 v88, v84, v86
    v_add_f32 v81, v77, v79
    v_add_f32 v89, v85, v87
    v_fma_f32 v82, v78, 4.0, v76
    v_fma_f32 v90, v86, 4.0, v84
    v_fma_f32 v83, v79, 4.0, v77
    v_fma_f32 v91, v87, 4.0, v85
    v_add_f32 v77, v80, v81
    v_add_f32 v85, v88, v89
    v_sub_f32 v78, v80, v81
    v_sub_f32 v86, v88, v89
    v_fma_f32 v79, v83, 2.0, v82
    v_fma_f32 v87, v91, 2.0, v90
    v_fma_f32 v82, v83, -2.0, v82
    v_fma_f32 v90, v91, -2.0, v90
    v_fmamk_f32 v80, v76, 0x41700000, v82
    v_fmamk_f32 v88, v84, 0x41700000, v90
    v_fmamk_f32 v80, v81, 0x41200000, v80
    v_fmamk_f32 v88, v89, 0x41200000, v88
    v_cvt_pk_bf16_f32 v54, v77, v85
    v_cvt_pk_bf16_f32 v58, v78, v86
    v_cvt_pk_bf16_f32 v66, v79, v87
    v_cvt_pk_bf16_f32 v70, v82, v90
    v_cvt_pk_bf16_f32 v74, v80, v88
    v_lshlrev_b32 v76, 16, v51
    v_and_b32 v84, s25, v51
    v_lshlrev_b32 v77, 16, v55
    v_and_b32 v85, s25, v55
    v_lshlrev_b32 v78, 16, v59
    v_and_b32 v86, s25, v59
    v_lshlrev_b32 v79, 16, v63
    v_and_b32 v87, s25, v63
    v_add_f32 v80, v76, v78
    v_add_f32 v88, v84, v86
    v_add_f32 v81, v77, v79
    v_add_f32 v89, v85, v87
    v_fma_f32 v82, v78, 4.0, v76
    v_fma_f32 v90, v86, 4.0, v84
    v_fma_f32 v83, v79, 4.0, v77
    v_fma_f32 v91, v87, 4.0, v85
    v_add_f32 v77, v80, v81
    v_add_f32 v85, v88, v89
    v_sub_f32 v78, v80, v81
    v_sub_f32 v86, v88, v89
    v_fma_f32 v79, v83, 2.0, v82
    v_fma_f32 v87, v91, 2.0, v90
    v_fma_f32 v82, v83, -2.0, v82
    v_fma_f32 v90, v91, -2.0, v90
    v_fmamk_f32 v80, v76, 0x41700000, v82
    v_fmamk_f32 v88, v84, 0x41700000, v90
    v_fmamk_f32 v80, v81, 0x41200000, v80
    v_fmamk_f32 v88, v89, 0x41200000, v88
    v_cvt_pk_bf16_f32 v55, v77, v85
    v_cvt_pk_bf16_f32 v59, v78, v86
    v_cvt_pk_bf16_f32 v67, v79, v87
    v_cvt_pk_bf16_f32 v71, v82, v90
    v_cvt_pk_bf16_f32 v75, v80, v88
    s_add_u32 s28, s28, 1
    s_waitcnt lgkmcnt(0)
    s_barrier
    s_cmp_eq_u32 s22, 1
    s_cbranch_scc1 L_conv2_kernel_hlast2
    s_add_u32 s24, s24, 1048576
    s_add_u32 s27, s27, 1048576
    ds_write_b128 v96, v[64:67] offset:57344
    ds_write_b128 v97, v[68:71] offset:8192
    ds_write_b128 v97, v[72:75] offset:24576
    ds_write_b128 v96, v[48:51] offset:8192
    ds_write_b128 v96, v[52:55] offset:24576
    ds_write_b128 v96, v[56:59] offset:40960
    ds_write_b128 v98, v[60:63] offset:8704
    s_waitcnt vmcnt(0)
    buffer_load_dwordx4 v[32:35], v92, s[8:11], s24 offen
    buffer_load_dwordx4 v[40:43], v94, s[8:11], s24 offen
    buffer_load_dwordx4 v[36:39], v93, s[8:11], s24 offen
    buffer_load_dwordx4 v[44:47], v95, s[8:11], s24 offen
    v_lshlrev_b32 v76, 16, v0
    v_and_b32 v84, s25, v0
    v_lshlrev_b32 v77, 16, v4
    v_and_b32 v85, s25, v4
    v_lshlrev_b32 v78, 16, v8
    v_and_b32 v86, s25, v8
    v_lshlrev_b32 v79, 16, v12
    v_and_b32 v87, s25, v12
    v_add_f32 v80, v76, v78
    v_add_f32 v88, v84, v86
    v_add_f32 v81, v77, v79
    v_add_f32 v89, v85, v87
    v_fma_f32 v82, v78, 4.0, v76
    v_fma_f32 v90, v86, 4.0, v84
    v_fma_f32 v83, v79, 4.0, v77
    v_fma_f32 v91, v87, 4.0, v85
    v_add_f32 v77, v80, v81
    v_add_f32 v85, v88, v89
    v_sub_f32 v78, v80, v81
    v_sub_f32 v86, v88, v89
    v_fma_f32 v79, v83, 2.0, v82
    v_fma_f32 v87, v91, 2.0, v90
    v_fma_f32 v82, v83, -2.0, v82
    v_fma_f32 v90, v91, -2.0, v90
    v_fmamk_f32 v80, v76, 0x41700000, v82
    v_fmamk_f32 v88, v84, 0x41700000, v90
    v_fmamk_f32 v80, v81, 0x41200000, v80
    v_fmamk_f32 v88, v89, 0x41200000, v88
    v_cvt_pk_bf16_f32 v4, v77, v85
    v_cvt_pk_bf16_f32 v8, v78, v86
    v_cvt_pk_bf16_f32 v64, v79, v87
    v_cvt_pk_bf16_f32 v68, v82, v90
    v_cvt_pk_bf16_f32 v72, v80, v88
    v_lshlrev_b32 v76, 16, v1
    v_and_b32 v84, s25, v1
    v_lshlrev_b32 v77, 16, v5
    v_and_b32 v85, s25, v5
    v_lshlrev_b32 v78, 16, v9
    v_and_b32 v86, s25, v9
    v_lshlrev_b32 v79, 16, v13
    v_and_b32 v87, s25, v13
    v_add_f32 v80, v76, v78
    v_add_f32 v88, v84, v86
    v_add_f32 v81, v77, v79
    v_add_f32 v89, v85, v87
    v_fma_f32 v82, v78, 4.0, v76
    v_fma_f32 v90, v86, 4.0, v84
    v_fma_f32 v83, v79, 4.0, v77
    v_fma_f32 v91, v87, 4.0, v85
    v_add_f32 v77, v80, v81
    v_add_f32 v85, v88, v89
    v_sub_f32 v78, v80, v81
    v_sub_f32 v86, v88, v89
    v_fma_f32 v79, v83, 2.0, v82
    v_fma_f32 v87, v91, 2.0, v90
    v_fma_f32 v82, v83, -2.0, v82
    v_fma_f32 v90, v91, -2.0, v90
    v_fmamk_f32 v80, v76, 0x41700000, v82
    v_fmamk_f32 v88, v84, 0x41700000, v90
    v_fmamk_f32 v80, v81, 0x41200000, v80
    v_fmamk_f32 v88, v89, 0x41200000, v88
    v_cvt_pk_bf16_f32 v5, v77, v85
    v_cvt_pk_bf16_f32 v9, v78, v86
    v_cvt_pk_bf16_f32 v65, v79, v87
    v_cvt_pk_bf16_f32 v69, v82, v90
    v_cvt_pk_bf16_f32 v73, v80, v88
    v_lshlrev_b32 v76, 16, v2
    v_and_b32 v84, s25, v2
    v_lshlrev_b32 v77, 16, v6
    v_and_b32 v85, s25, v6
    v_lshlrev_b32 v78, 16, v10
    v_and_b32 v86, s25, v10
    v_lshlrev_b32 v79, 16, v14
    v_and_b32 v87, s25, v14
    v_add_f32 v80, v76, v78
    v_add_f32 v88, v84, v86
    v_add_f32 v81, v77, v79
    v_add_f32 v89, v85, v87
    v_fma_f32 v82, v78, 4.0, v76
    v_fma_f32 v90, v86, 4.0, v84
    v_fma_f32 v83, v79, 4.0, v77
    v_fma_f32 v91, v87, 4.0, v85
    v_add_f32 v77, v80, v81
    v_add_f32 v85, v88, v89
    v_sub_f32 v78, v80, v81
    v_sub_f32 v86, v88, v89
    v_fma_f32 v79, v83, 2.0, v82
    v_fma_f32 v87, v91, 2.0, v90
    v_fma_f32 v82, v83, -2.0, v82
    v_fma_f32 v90, v91, -2.0, v90
    v_fmamk_f32 v80, v76, 0x41700000, v82
    v_fmamk_f32 v88, v84, 0x41700000, v90
    v_fmamk_f32 v80, v81, 0x41200000, v80
    v_fmamk_f32 v88, v89, 0x41200000, v88
    v_cvt_pk_bf16_f32 v6, v77, v85
    v_cvt_pk_bf16_f32 v10, v78, v86
    v_cvt_pk_bf16_f32 v66, v79, v87
    v_cvt_pk_bf16_f32 v70, v82, v90
    v_cvt_pk_bf16_f32 v74, v80, v88
    v_lshlrev_b32 v76, 16, v3
    v_and_b32 v84, s25, v3
    v_lshlrev_b32 v77, 16, v7
    v_and_b32 v85, s25, v7
    v_lshlrev_b32 v78, 16, v11
    v_and_b32 v86, s25, v11
    v_lshlrev_b32 v79, 16, v15
    v_and_b32 v87, s25, v15
    v_add_f32 v80, v76, v78
    v_add_f32 v88, v84, v86
    v_add_f32 v81, v77, v79
    v_add_f32 v89, v85, v87
    v_fma_f32 v82, v78, 4.0, v76
    v_fma_f32 v90, v86, 4.0, v84
    v_fma_f32 v83, v79, 4.0, v77
    v_fma_f32 v91, v87, 4.0, v85
    v_add_f32 v77, v80, v81
    v_add_f32 v85, v88, v89
    v_sub_f32 v78, v80, v81
    v_sub_f32 v86, v88, v89
    v_fma_f32 v79, v83, 2.0, v82
    v_fma_f32 v87, v91, 2.0, v90
    v_fma_f32 v82, v83, -2.0, v82
    v_fma_f32 v90, v91, -2.0, v90
    v_fmamk_f32 v80, v76, 0x41700000, v82
    v_fmamk_f32 v88, v84, 0x41700000, v90
    v_fmamk_f32 v80, v81, 0x41200000, v80
    v_fmamk_f32 v88, v89, 0x41200000, v88
    v_cvt_pk_bf16_f32 v7, v77, v85
    v_cvt_pk_bf16_f32 v11, v78, v86
    v_cvt_pk_bf16_f32 v67, v79, v87
    v_cvt_pk_bf16_f32 v71, v82, v90
    v_cvt_pk_bf16_f32 v75, v80, v88
    s_add_u32 s28, s28, 1
    s_waitcnt lgkmcnt(0)
    s_barrier
    ds_write_b128 v96, v[64:67] offset:49152
    ds_write_b128 v97, v[68:71] offset:0
    ds_write_b128 v97, v[72:75] offset:16384
    ds_write_b128 v96, v[0:3] offset:0
    ds_write_b128 v96, v[4:7] offset:16384
    ds_write_b128 v96, v[8:11] offset:32768
    ds_write_b128 v98, v[12:15] offset:0
    buffer_load_dwordx4 v[48:51], v92, s[8:11], s27 offen
    buffer_load_dwordx4 v[56:59], v94, s[8:11], s27 offen
    buffer_load_dwordx4 v[52:55], v93, s[8:11], s27 offen
    buffer_load_dwordx4 v[60:63], v95, s[8:11], s27 offen
    v_lshlrev_b32 v76, 16, v16
    v_and_b32 v84, s25, v16
    v_lshlrev_b32 v77, 16, v20
    v_and_b32 v85, s25, v20
    v_lshlrev_b32 v78, 16, v24
    v_and_b32 v86, s25, v24
    v_lshlrev_b32 v79, 16, v28
    v_and_b32 v87, s25, v28
    v_add_f32 v80, v76, v78
    v_add_f32 v88, v84, v86
    v_add_f32 v81, v77, v79
    v_add_f32 v89, v85, v87
    v_fma_f32 v82, v78, 4.0, v76
    v_fma_f32 v90, v86, 4.0, v84
    v_fma_f32 v83, v79, 4.0, v77
    v_fma_f32 v91, v87, 4.0, v85
    v_add_f32 v77, v80, v81
    v_add_f32 v85, v88, v89
    v_sub_f32 v78, v80, v81
    v_sub_f32 v86, v88, v89
    v_fma_f32 v79, v83, 2.0, v82
    v_fma_f32 v87, v91, 2.0, v90
    v_fma_f32 v82, v83, -2.0, v82
    v_fma_f32 v90, v91, -2.0, v90
    v_fmamk_f32 v80, v76, 0x41700000, v82
    v_fmamk_f32 v88, v84, 0x41700000, v90
    v_fmamk_f32 v80, v81, 0x41200000, v80
    v_fmamk_f32 v88, v89, 0x41200000, v88
    v_cvt_pk_bf16_f32 v20, v77, v85
    v_cvt_pk_bf16_f32 v24, v78, v86
    v_cvt_pk_bf16_f32 v64, v79, v87
    v_cvt_pk_bf16_f32 v68, v82, v90
    v_cvt_pk_bf16_f32 v72, v80, v88
    v_lshlrev_b32 v76, 16, v17
    v_and_b32 v84, s25, v17
    v_lshlrev_b32 v77, 16, v21
    v_and_b32 v85, s25, v21
    v_lshlrev_b32 v78, 16, v25
    v_and_b32 v86, s25, v25
    v_lshlrev_b32 v79, 16, v29
    v_and_b32 v87, s25, v29
    v_add_f32 v80, v76, v78
    v_add_f32 v88, v84, v86
    v_add_f32 v81, v77, v79
    v_add_f32 v89, v85, v87
    v_fma_f32 v82, v78, 4.0, v76
    v_fma_f32 v90, v86, 4.0, v84
    v_fma_f32 v83, v79, 4.0, v77
    v_fma_f32 v91, v87, 4.0, v85
    v_add_f32 v77, v80, v81
    v_add_f32 v85, v88, v89
    v_sub_f32 v78, v80, v81
    v_sub_f32 v86, v88, v89
    v_fma_f32 v79, v83, 2.0, v82
    v_fma_f32 v87, v91, 2.0, v90
    v_fma_f32 v82, v83, -2.0, v82
    v_fma_f32 v90, v91, -2.0, v90
    v_fmamk_f32 v80, v76, 0x41700000, v82
    v_fmamk_f32 v88, v84, 0x41700000, v90
    v_fmamk_f32 v80, v81, 0x41200000, v80
    v_fmamk_f32 v88, v89, 0x41200000, v88
    v_cvt_pk_bf16_f32 v21, v77, v85
    v_cvt_pk_bf16_f32 v25, v78, v86
    v_cvt_pk_bf16_f32 v65, v79, v87
    v_cvt_pk_bf16_f32 v69, v82, v90
    v_cvt_pk_bf16_f32 v73, v80, v88
    v_lshlrev_b32 v76, 16, v18
    v_and_b32 v84, s25, v18
    v_lshlrev_b32 v77, 16, v22
    v_and_b32 v85, s25, v22
    v_lshlrev_b32 v78, 16, v26
    v_and_b32 v86, s25, v26
    v_lshlrev_b32 v79, 16, v30
    v_and_b32 v87, s25, v30
    v_add_f32 v80, v76, v78
    v_add_f32 v88, v84, v86
    v_add_f32 v81, v77, v79
    v_add_f32 v89, v85, v87
    v_fma_f32 v82, v78, 4.0, v76
    v_fma_f32 v90, v86, 4.0, v84
    v_fma_f32 v83, v79, 4.0, v77
    v_fma_f32 v91, v87, 4.0, v85
    v_add_f32 v77, v80, v81
    v_add_f32 v85, v88, v89
    v_sub_f32 v78, v80, v81
    v_sub_f32 v86, v88, v89
    v_fma_f32 v79, v83, 2.0, v82
    v_fma_f32 v87, v91, 2.0, v90
    v_fma_f32 v82, v83, -2.0, v82
    v_fma_f32 v90, v91, -2.0, v90
    v_fmamk_f32 v80, v76, 0x41700000, v82
    v_fmamk_f32 v88, v84, 0x41700000, v90
    v_fmamk_f32 v80, v81, 0x41200000, v80
    v_fmamk_f32 v88, v89, 0x41200000, v88
    v_cvt_pk_bf16_f32 v22, v77, v85
    v_cvt_pk_bf16_f32 v26, v78, v86
    v_cvt_pk_bf16_f32 v66, v79, v87
    v_cvt_pk_bf16_f32 v70, v82, v90
    v_cvt_pk_bf16_f32 v74, v80, v88
    v_lshlrev_b32 v76, 16, v19
    v_and_b32 v84, s25, v19
    v_lshlrev_b32 v77, 16, v23
    v_and_b32 v85, s25, v23
    v_lshlrev_b32 v78, 16, v27
    v_and_b32 v86, s25, v27
    v_lshlrev_b32 v79, 16, v31
    v_and_b32 v87, s25, v31
    v_add_f32 v80, v76, v78
    v_add_f32 v88, v84, v86
    v_add_f32 v81, v77, v79
    v_add_f32 v89, v85, v87
    v_fma_f32 v82, v78, 4.0, v76
    v_fma_f32 v90, v86, 4.0, v84
    v_fma_f32 v83, v79, 4.0, v77
    v_fma_f32 v91, v87, 4.0, v85
    v_add_f32 v77, v80, v81
    v_add_f32 v85, v88, v89
    v_sub_f32 v78, v80, v81
    v_sub_f32 v86, v88, v89
    v_fma_f32 v79, v83, 2.0, v82
    v_fma_f32 v87, v91, 2.0, v90
    v_fma_f32 v82, v83, -2.0, v82
    v_fma_f32 v90, v91, -2.0, v90
    v_fmamk_f32 v80, v76, 0x41700000, v82
    v_fmamk_f32 v88, v84, 0x41700000, v90
    v_fmamk_f32 v80, v81, 0x41200000, v80
    v_fmamk_f32 v88, v89, 0x41200000, v88
    v_cvt_pk_bf16_f32 v23, v77, v85
    v_cvt_pk_bf16_f32 v27, v78, v86
    v_cvt_pk_bf16_f32 v67, v79, v87
    v_cvt_pk_bf16_f32 v71, v82, v90
    v_cvt_pk_bf16_f32 v75, v80, v88
    s_add_u32 s28, s28, 1
    s_waitcnt lgkmcnt(0)
    s_barrier
    s_sub_u32 s22, s22, 1
    s_branch L_conv2_kernel_hloop2
L_conv2_kernel_hlast2:
    s_mov_b32 s25, 0xffff0000
    ds_write_b128 v96, v[64:67] offset:57344
    ds_write_b128 v97, v[68:71] offset:8192
    ds_write_b128 v97, v[72:75] offset:24576
    ds_write_b128 v96, v[48:51] offset:8192
    ds_write_b128 v96, v[52:55] offset:24576
    ds_write_b128 v96, v[56:59] offset:40960
    ds_write_b128 v98, v[60:63] offset:8704
    s_waitcnt lgkmcnt(0)
    s_barrier
    s_branch L_conv2_kernel_end
L_conv2_kernel_mw:
    s_add_u32 s37, s41, 128
    v_mov_b32 v16, s37
    v_mul_u32_u24 v17, 524288, v5
    v_lshl_add_u32 v17, v6, 4, v17
    s_add_u32 s37, s33, 4294967289
    v_lshl_add_u32 v18, v16, 3, s37
    v_cmp_gt_u32 vcc, 8000, v18
    s_mul_i32 s37, s33, 131072
    s_add_u32 s37, s37, 0
    v_lshl_add_u32 v108, v16, 7, s37
    v_add_u32 v108, v108, v17
    v_mov_b32 v18, 2130706432
    v_cndmask_b32 v108, v18, v108, vcc
    s_add_u32 s37, s33, 4294967291
    v_lshl_add_u32 v18, v16, 3, s37
    v_cmp_gt_u32 vcc, 8000, v18
    s_mul_i32 s37, s33, 131072
    s_add_u32 s37, s37, 262144
    v_lshl_add_u32 v109, v16, 7, s37
    v_add_u32 v109, v109, v17
    v_mov_b32 v18, 2130706432
    v_cndmask_b32 v109, v18, v109, vcc
    s_add_u32 s37, s33, 4294967293
    v_lshl_add_u32 v18, v16, 3, s37
    v_cmp_gt_u32 vcc, 8000, v18
    s_mul_i32 s37, s33, 131072
    s_add_u32 s37, s37, 64
    v_lshl_add_u32 v110, v16, 7, s37
    v_add_u32 v110, v110, v17
    v_mov_b32 v18, 2130706432
    v_cndmask_b32 v110, v18, v110, vcc
    s_waitcnt lgkmcnt(0)
    s_add_u32 s8, s4, s47
    s_addc_u32 s9, s5, 0
    s_lshl_b32 s36, s29, 4
    s_lshl_b32 s37, s33, 3
    s_add_u32 s36, s36, s37
    s_mul_i32 s36, s36, 57344
    s_add_u32 s36, s36, 9437184
    s_add_u32 s12, s30, s36
    s_addc_u32 s13, s31, 0
    s_mov_b32 s14, 458752
    s_mov_b32 s15, 0x00020000
    s_mul_i32 s36, s35, 2097152
    s_add_u32 s36, s36, 27262976
    s_mul_i32 s37, s33, 8388608
    s_add_u32 s36, s36, s37
    s_add_u32 s16, s30, s36
    s_addc_u32 s17, s31, 0
    s_mov_b32 s18, 2097152
    s_mov_b32 s19, 0x00020000
    v_and_b32 v10, 15, v127
    v_lshrrev_b32 v11, 4, v127
    v_add_u32 v8, 0, v10
    v_and_b32 v16, 4, v8
    v_lshrrev_b32 v16, 1, v16
    v_xor_b32 v16, v11, v16
    v_lshlrev_b32 v16, 4, v16
    v_lshl_add_u32 v8, v8, 6, v16
    v_add_u32 v9, 1, v10
    v_and_b32 v16, 4, v9
    v_lshrrev_b32 v16, 1, v16
    v_xor_b32 v16, v11, v16
    v_lshlrev_b32 v16, 4, v16
    v_lshl_add_u32 v9, v9, 6, v16
    s_lshr_b32 s38, s32, 1
    s_and_b32 s39, s32, 1
    s_add_u32 s40, s38, 4
    s_lshl_b32 s43, s39, 10
    s_cmp_lt_u32 s20, 4
    s_cselect_b32 s40, s20, s40
    s_cselect_b32 s36, 0, s43
    s_lshl_b32 s37, s40, 13
    s_add_u32 s37, s37, s36
    v_lshl_add_u32 v125, v127, 4, s37
    s_mul_i32 s37, s40, 16384
    v_add_u32 v120, s37, v8
    v_add_u32 v121, s37, v9
    s_lshl_b32 s37, s40, 10
    s_add_u32 s37, s37, 115712
    v_lshl_add_u32 v16, v11, 4, s37
    v_cmp_eq_u32 vcc, 15, v10
    v_mov_b32 v17, 8192
    v_mov_b32 v18, 4294959104
    v_mov_b32 v19, 64
    v_cndmask_b32 v122, v121, v16, vcc
    v_cndmask_b32 v123, v17, v19, vcc
    v_cndmask_b32 v124, v18, v19, vcc
    v_lshl_add_u32 v126, v127, 4, s37
    s_mov_b32 s44, 0x3f800000
    s_mov_b32 s45, 0x00000000
    s_mov_b32 s46, 0x00000000
    s_cmp_eq_u32 s40, 1
    s_cselect_b32 s45, 0x3f800000, s45
    s_cselect_b32 s46, 0x3f800000, s46
    s_cmp_eq_u32 s40, 2
    s_cselect_b32 s45, 0xbf800000, s45
    s_cselect_b32 s46, 0x3f800000, s46
    s_cmp_eq_u32 s40, 3
    s_cselect_b32 s45, 0x40000000, s45
    s_cselect_b32 s46, 0x40800000, s46
    s_cmp_eq_u32 s40, 4
    s_cselect_b32 s45, 0xc0000000, s45
    s_cselect_b32 s46, 0x40800000, s46
    s_cmp_eq_u32 s40, 5
    s_cselect_b32 s44, 0x41800000, s44
    s_cselect_b32 s45, 0x41000000, s45
    s_cselect_b32 s46, 0x40800000, s46
    s_cmp_ge_u32 s20, 4
    s_cbranch_scc1 L_conv2_kernel_m2
    v_mov_b32 v0, 0
    v_mov_b32 v1, 0
    v_mov_b32 v2, 0
    v_mov_b32 v3, 0
    v_mov_b32 v4, 0
    v_mov_b32 v5, 0
    v_mov_b32 v6, 0
    v_mov_b32 v7, 0
    v_mov_b32 v8, 0
    v_mov_b32 v9, 0
    v_mov_b32 v10, 0
    v_mov_b32 v11, 0
    v_mov_b32 v12, 0
    v_mov_b32 v13, 0
    v_mov_b32 v14, 0
    v_mov_b32 v15, 0
    v_mov_b32 v16, 0
    v_mov_b32 v17, 0
    v_mov_b32 v18, 0
    v_mov_b32 v19, 0
    v_mov_b32 v20, 0
    v_mov_b32 v21, 0
    v_mov_b32 v22, 0
    v_mov_b32 v23, 0
    v_mov_b32 v24, 0
    v_mov_b32 v25, 0
    v_mov_b32 v26, 0
    v_mov_b32 v27, 0
    v_mov_b32 v28, 0
    v_mov_b32 v29, 0
    v_mov_b32 v30, 0
    v_mov_b32 v31, 0
    v_mov_b32 v32, 0
    v_mov_b32 v33, 0
    v_mov_b32 v34, 0
    v_mov_b32 v35, 0
    v_mov_b32 v36, 0
    v_mov_b32 v37, 0
    v_mov_b32 v38, 0
    v_mov_b32 v39, 0
    v_mov_b32 v40, 0
    v_mov_b32 v41, 0
    v_mov_b32 v42, 0
    v_mov_b32 v43, 0
    v_mov_b32 v44, 0
    v_mov_b32 v45, 0
    v_mov_b32 v46, 0
    v_mov_b32 v47, 0
    v_mov_b32 v48, 0
    v_mov_b32 v49, 0
    v_mov_b32 v50, 0
    v_mov_b32 v51, 0
    v_mov_b32 v52, 0
    v_mov_b32 v53, 0
    v_mov_b32 v54, 0
    v_mov_b32 v55, 0
    v_mov_b32 v56, 0
    v_mov_b32 v57, 0
    v_mov_b32 v58, 0
    v_mov_b32 v59, 0
    v_mov_b32 v60, 0
    v_mov_b32 v61, 0
    v_mov_b32 v62, 0
    v_mov_b32 v63, 0
    buffer_load_dwordx4 v[96:99], v108, s[8:11], 0 offen
    buffer_load_dwordx4 v[100:103], v109, s[8:11], 0 offen
    buffer_load_dwordx4 v[104:107], v110, s[8:11], 0 offen
    s_mov_b32 s23, 0
    s_mov_b32 s26, 4096
    buffer_load_dwordx4 v[64:67], v125, s[12:15], s23 offen offset:0
    buffer_load_dwordx4 v[68:71], v125, s[12:15], s23 offen offset:1024
    buffer_load_dwordx4 v[72:75], v125, s[12:15], s23 offen offset:2048
    buffer_load_dwordx4 v[76:79], v125, s[12:15], s23 offen offset:3072
    buffer_load_dwordx4 v[80:83], v125, s[12:15], s26 offen offset:0
    buffer_load_dwordx4 v[84:87], v125, s[12:15], s26 offen offset:1024
    buffer_load_dwordx4 v[88:91], v125, s[12:15], s26 offen offset:2048
    buffer_load_dwordx4 v[92:95], v125, s[12:15], s26 offen offset:3072
    s_mov_b32 s23, 57344
    s_mov_b32 s26, 61440
    s_waitcnt vmcnt(8)
    v_lshlrev_b32 v108, 16, v96
    v_and_b32 v111, s25, v96
    v_lshlrev_b32 v109, 16, v100
    v_and_b32 v112, s25, v100
    v_lshlrev_b32 v110, 16, v104
    v_and_b32 v113, s25, v104
    v_mul_f32 v114, s44, v108
    v_mul_f32 v115, s44, v111
    v_fmac_f32 v114, s45, v109
    v_fmac_f32 v115, s45, v112
    v_fmac_f32 v114, s46, v110
    v_fmac_f32 v115, s46, v113
    v_cvt_pk_bf16_f32 v96, v114, v115
    v_lshlrev_b32 v108, 16, v97
    v_and_b32 v111, s25, v97
    v_lshlrev_b32 v109, 16, v101
    v_and_b32 v112, s25, v101
    v_lshlrev_b32 v110, 16, v105
    v_and_b32 v113, s25, v105
    v_mul_f32 v114, s44, v108
    v_mul_f32 v115, s44, v111
    v_fmac_f32 v114, s45, v109
    v_fmac_f32 v115, s45, v112
    v_fmac_f32 v114, s46, v110
    v_fmac_f32 v115, s46, v113
    v_cvt_pk_bf16_f32 v97, v114, v115
    v_lshlrev_b32 v108, 16, v98
    v_and_b32 v111, s25, v98
    v_lshlrev_b32 v109, 16, v102
    v_and_b32 v112, s25, v102
    v_lshlrev_b32 v110, 16, v106
    v_and_b32 v113, s25, v106
    v_mul_f32 v114, s44, v108
    v_mul_f32 v115, s44, v111
    v_fmac_f32 v114, s45, v109
    v_fmac_f32 v115, s45, v112
    v_fmac_f32 v114, s46, v110
    v_fmac_f32 v115, s46, v113
    v_cvt_pk_bf16_f32 v98, v114, v115
    v_lshlrev_b32 v108, 16, v99
    v_and_b32 v111, s25, v99
    v_lshlrev_b32 v109, 16, v103
    v_and_b32 v112, s25, v103
    v_lshlrev_b32 v110, 16, v107
    v_and_b32 v113, s25, v107
    v_mul_f32 v114, s44, v108
    v_mul_f32 v115, s44, v111
    v_fmac_f32 v114, s45, v109
    v_fmac_f32 v115, s45, v112
    v_fmac_f32 v114, s46, v110
    v_fmac_f32 v115, s46, v113
    v_cvt_pk_bf16_f32 v99, v114, v115
    ds_write_b128 v126, v[96:99]
    s_waitcnt lgkmcnt(0)
    s_barrier
    s_mov_b32 s22, 4
    s_setprio 2
L_conv2_kernel_mloop1:
    ds_read_b128 v[96:99], v120 offset:0
    ds_read_b128 v[100:103], v120 offset:1024
    ds_read_b128 v[104:107], v120 offset:2048
    ds_read_b128 v[108:111], v120 offset:3072
    ds_read_b128 v[112:115], v120 offset:4096
    ds_read_b128 v[116:119], v120 offset:5120
    s_waitcnt vmcnt(6) lgkmcnt(5)
    v_mfma_f32_16x16x32_bf16 v[0:3], v[64:67], v[96:99], v[0:3]
    v_mfma_f32_16x16x32_bf16 v[32:35], v[68:71], v[96:99], v[32:35]
    ds_read_b128 v[96:99], v120 offset:6144
    s_waitcnt vmcnt(4) lgkmcnt(5)
    v_mfma_f32_16x16x32_bf16 v[4:7], v[64:67], v[100:103], v[4:7]
    v_mfma_f32_16x16x32_bf16 v[36:39], v[68:71], v[100:103], v[36:39]
    v_mfma_f32_16x16x32_bf16 v[0:3], v[72:75], v[100:103], v[0:3]
    v_mfma_f32_16x16x32_bf16 v[32:35], v[76:79], v[100:103], v[32:35]
    ds_read_b128 v[100:103], v120 offset:7168
    s_waitcnt vmcnt(2) lgkmcnt(5)
    v_mfma_f32_16x16x32_bf16 v[8:11], v[64:67], v[104:107], v[8:11]
    v_mfma_f32_16x16x32_bf16 v[40:43], v[68:71], v[104:107], v[40:43]
    v_mfma_f32_16x16x32_bf16 v[4:7], v[72:75], v[104:107], v[4:7]
    v_mfma_f32_16x16x32_bf16 v[36:39], v[76:79], v[104:107], v[36:39]
    v_mfma_f32_16x16x32_bf16 v[0:3], v[80:83], v[104:107], v[0:3]
    v_mfma_f32_16x16x32_bf16 v[32:35], v[84:87], v[104:107], v[32:35]
    ds_read_b128 v[104:107], v122 offset:0
    v_add_u32 v122, v123, v122
    s_waitcnt vmcnt(0) lgkmcnt(5)
    v_mfma_f32_16x16x32_bf16 v[12:15], v[64:67], v[108:111], v[12:15]
    v_mfma_f32_16x16x32_bf16 v[44:47], v[68:71], v[108:111], v[44:47]
    v_mfma_f32_16x16x32_bf16 v[8:11], v[72:75], v[108:111], v[8:11]
    v_mfma_f32_16x16x32_bf16 v[40:43], v[76:79], v[108:111], v[40:43]
    v_mfma_f32_16x16x32_bf16 v[4:7], v[80:83], v[108:111], v[4:7]
    v_mfma_f32_16x16x32_bf16 v[36:39], v[84:87], v[108:111], v[36:39]
    v_mfma_f32_16x16x32_bf16 v[0:3], v[88:91], v[108:111], v[0:3]
    v_mfma_f32_16x16x32_bf16 v[32:35], v[92:95], v[108:111], v[32:35]
    ds_read_b128 v[108:111], v121 offset:1024
    s_waitcnt lgkmcnt(5)
    v_mfma_f32_16x16x32_bf16 v[16:19], v[64:67], v[112:115], v[16:19]
    v_mfma_f32_16x16x32_bf16 v[48:51], v[68:71], v[112:115], v[48:51]
    v_mfma_f32_16x16x32_bf16 v[12:15], v[72:75], v[112:115], v[12:15]
    v_mfma_f32_16x16x32_bf16 v[44:47], v[76:79], v[112:115], v[44:47]
    v_mfma_f32_16x16x32_bf16 v[8:11], v[80:83], v[112:115], v[8:11]
    v_mfma_f32_16x16x32_bf16 v[40:43], v[84:87], v[112:115], v[40:43]
    v_mfma_f32_16x16x32_bf16 v[4:7], v[88:91], v[112:115], v[4:7]
    v_mfma_f32_16x16x32_bf16 v[36:39], v[92:95], v[112:115], v[36:39]
    ds_read_b128 v[112:115], v121 offset:2048
    s_waitcnt lgkmcnt(5)
    v_mfma_f32_16x16x32_bf16 v[20:23], v[64:67], v[116:119], v[20:23]
    v_mfma_f32_16x16x32_bf16 v[52:55], v[68:71], v[116:119], v[52:55]
    v_mfma_f32_16x16x32_bf16 v[16:19], v[72:75], v[116:119], v[16:19]
    v_mfma_f32_16x16x32_bf16 v[48:51], v[76:79], v[116:119], v[48:51]
    v_mfma_f32_16x16x32_bf16 v[12:15], v[80:83], v[116:119], v[12:15]
    v_mfma_f32_16x16x32_bf16 v[44:47], v[84:87], v[116:119], v[44:47]
    v_mfma_f32_16x16x32_bf16 v[8:11], v[88:91], v[116:119], v[8:11]
    v_mfma_f32_16x16x32_bf16 v[40:43], v[92:95], v[116:119], v[40:43]
    s_waitcnt lgkmcnt(4)
    v_mfma_f32_16x16x32_bf16 v[24:27], v[64:67], v[96:99], v[24:27]
    v_mfma_f32_16x16x32_bf16 v[56:59], v[68:71], v[96:99], v[56:59]
    v_mfma_f32_16x16x32_bf16 v[20:23], v[72:75], v[96:99], v[20:23]
    v_mfma_f32_16x16x32_bf16 v[52:55], v[76:79], v[96:99], v[52:55]
    v_mfma_f32_16x16x32_bf16 v[16:19], v[80:83], v[96:99], v[16:19]
    v_mfma_f32_16x16x32_bf16 v[48:51], v[84:87], v[96:99], v[48:51]
    v_mfma_f32_16x16x32_bf16 v[12:15], v[88:91], v[96:99], v[12:15]
    v_mfma_f32_16x16x32_bf16 v[44:47], v[92:95], v[96:99], v[44:47]
    s_waitcnt lgkmcnt(3)
    v_mfma_f32_16x16x32_bf16 v[28:31], v[64:67], v[100:103], v[28:31]
    v_mfma_f32_16x16x32_bf16 v[60:63], v[68:71], v[100:103], v[60:63]
    v_mfma_f32_16x16x32_bf16 v[24:27], v[72:75], v[100:103], v[24:27]
    v_mfma_f32_16x16x32_bf16 v[56:59], v[76:79], v[100:103], v[56:59]
    v_mfma_f32_16x16x32_bf16 v[20:23], v[80:83], v[100:103], v[20:23]
    v_mfma_f32_16x16x32_bf16 v[52:55], v[84:87], v[100:103], v[52:55]
    v_mfma_f32_16x16x32_bf16 v[16:19], v[88:91], v[100:103], v[16:19]
    v_mfma_f32_16x16x32_bf16 v[48:51], v[92:95], v[100:103], v[48:51]
    buffer_load_dwordx4 v[64:67], v125, s[12:15], s23 offen offset:0
    buffer_load_dwordx4 v[68:71], v125, s[12:15], s23 offen offset:1024
    s_waitcnt lgkmcnt(2)
    v_mfma_f32_16x16x32_bf16 v[28:31], v[72:75], v[104:107], v[28:31]
    v_mfma_f32_16x16x32_bf16 v[60:63], v[76:79], v[104:107], v[60:63]
    v_mfma_f32_16x16x32_bf16 v[24:27], v[80:83], v[104:107], v[24:27]
    v_mfma_f32_16x16x32_bf16 v[56:59], v[84:87], v[104:107], v[56:59]
    v_mfma_f32_16x16x32_bf16 v[20:23], v[88:91], v[104:107], v[20:23]
    v_mfma_f32_16x16x32_bf16 v[52:55], v[92:95], v[104:107], v[52:55]
    buffer_load_dwordx4 v[72:75], v125, s[12:15], s23 offen offset:2048
    buffer_load_dwordx4 v[76:79], v125, s[12:15], s23 offen offset:3072
    s_waitcnt lgkmcnt(1)
    v_mfma_f32_16x16x32_bf16 v[28:31], v[80:83], v[108:111], v[28:31]
    v_mfma_f32_16x16x32_bf16 v[60:63], v[84:87], v[108:111], v[60:63]
    v_mfma_f32_16x16x32_bf16 v[24:27], v[88:91], v[108:111], v[24:27]
    v_mfma_f32_16x16x32_bf16 v[56:59], v[92:95], v[108:111], v[56:59]
    buffer_load_dwordx4 v[80:83], v125, s[12:15], s26 offen offset:0
    buffer_load_dwordx4 v[84:87], v125, s[12:15], s26 offen offset:1024
    s_waitcnt lgkmcnt(0)
    v_mfma_f32_16x16x32_bf16 v[28:31], v[88:91], v[112:115], v[28:31]
    v_mfma_f32_16x16x32_bf16 v[60:63], v[92:95], v[112:115], v[60:63]
    buffer_load_dwordx4 v[88:91], v125, s[12:15], s26 offen offset:2048
    buffer_load_dwordx4 v[92:95], v125, s[12:15], s26 offen offset:3072
    s_add_u32 s23, s23, 57344
    s_add_u32 s26, s26, 57344
    s_barrier
    s_sub_u32 s22, s22, 1
    s_cmp_eq_u32 s22, 0
    s_cbranch_scc1 L_conv2_kernel_mlast1
    ds_read_b128 v[96:99], v120 offset:8192
    ds_read_b128 v[100:103], v120 offset:9216
    ds_read_b128 v[104:107], v120 offset:10240
    ds_read_b128 v[108:111], v120 offset:11264
    ds_read_b128 v[112:115], v120 offset:12288
    ds_read_b128 v[116:119], v120 offset:13312
    s_waitcnt vmcnt(6) lgkmcnt(5)
    v_mfma_f32_16x16x32_bf16 v[0:3], v[64:67], v[96:99], v[0:3]
    v_mfma_f32_16x16x32_bf16 v[32:35], v[68:71], v[96:99], v[32:35]
    ds_read_b128 v[96:99], v120 offset:14336
    s_waitcnt vmcnt(4) lgkmcnt(5)
    v_mfma_f32_16x16x32_bf16 v[4:7], v[64:67], v[100:103], v[4:7]
    v_mfma_f32_16x16x32_bf16 v[36:39], v[68:71], v[100:103], v[36:39]
    v_mfma_f32_16x16x32_bf16 v[0:3], v[72:75], v[100:103], v[0:3]
    v_mfma_f32_16x16x32_bf16 v[32:35], v[76:79], v[100:103], v[32:35]
    ds_read_b128 v[100:103], v120 offset:15360
    s_waitcnt vmcnt(2) lgkmcnt(5)
    v_mfma_f32_16x16x32_bf16 v[8:11], v[64:67], v[104:107], v[8:11]
    v_mfma_f32_16x16x32_bf16 v[40:43], v[68:71], v[104:107], v[40:43]
    v_mfma_f32_16x16x32_bf16 v[4:7], v[72:75], v[104:107], v[4:7]
    v_mfma_f32_16x16x32_bf16 v[36:39], v[76:79], v[104:107], v[36:39]
    v_mfma_f32_16x16x32_bf16 v[0:3], v[80:83], v[104:107], v[0:3]
    v_mfma_f32_16x16x32_bf16 v[32:35], v[84:87], v[104:107], v[32:35]
    ds_read_b128 v[104:107], v122 offset:0
    v_add_u32 v122, v124, v122
    s_waitcnt vmcnt(0) lgkmcnt(5)
    v_mfma_f32_16x16x32_bf16 v[12:15], v[64:67], v[108:111], v[12:15]
    v_mfma_f32_16x16x32_bf16 v[44:47], v[68:71], v[108:111], v[44:47]
    v_mfma_f32_16x16x32_bf16 v[8:11], v[72:75], v[108:111], v[8:11]
    v_mfma_f32_16x16x32_bf16 v[40:43], v[76:79], v[108:111], v[40:43]
    v_mfma_f32_16x16x32_bf16 v[4:7], v[80:83], v[108:111], v[4:7]
    v_mfma_f32_16x16x32_bf16 v[36:39], v[84:87], v[108:111], v[36:39]
    v_mfma_f32_16x16x32_bf16 v[0:3], v[88:91], v[108:111], v[0:3]
    v_mfma_f32_16x16x32_bf16 v[32:35], v[92:95], v[108:111], v[32:35]
    ds_read_b128 v[108:111], v121 offset:9216
    s_waitcnt lgkmcnt(5)
    v_mfma_f32_16x16x32_bf16 v[16:19], v[64:67], v[112:115], v[16:19]
    v_mfma_f32_16x16x32_bf16 v[48:51], v[68:71], v[112:115], v[48:51]
    v_mfma_f32_16x16x32_bf16 v[12:15], v[72:75], v[112:115], v[12:15]
    v_mfma_f32_16x16x32_bf16 v[44:47], v[76:79], v[112:115], v[44:47]
    v_mfma_f32_16x16x32_bf16 v[8:11], v[80:83], v[112:115], v[8:11]
    v_mfma_f32_16x16x32_bf16 v[40:43], v[84:87], v[112:115], v[40:43]
    v_mfma_f32_16x16x32_bf16 v[4:7], v[88:91], v[112:115], v[4:7]
    v_mfma_f32_16x16x32_bf16 v[36:39], v[92:95], v[112:115], v[36:39]
    ds_read_b128 v[112:115], v121 offset:10240
    s_waitcnt lgkmcnt(5)
    v_mfma_f32_16x16x32_bf16 v[20:23], v[64:67], v[116:119], v[20:23]
    v_mfma_f32_16x16x32_bf16 v[52:55], v[68:71], v[116:119], v[52:55]
    v_mfma_f32_16x16x32_bf16 v[16:19], v[72:75], v[116:119], v[16:19]
    v_mfma_f32_16x16x32_bf16 v[48:51], v[76:79], v[116:119], v[48:51]
    v_mfma_f32_16x16x32_bf16 v[12:15], v[80:83], v[116:119], v[12:15]
    v_mfma_f32_16x16x32_bf16 v[44:47], v[84:87], v[116:119], v[44:47]
    v_mfma_f32_16x16x32_bf16 v[8:11], v[88:91], v[116:119], v[8:11]
    v_mfma_f32_16x16x32_bf16 v[40:43], v[92:95], v[116:119], v[40:43]
    s_waitcnt lgkmcnt(4)
    v_mfma_f32_16x16x32_bf16 v[24:27], v[64:67], v[96:99], v[24:27]
    v_mfma_f32_16x16x32_bf16 v[56:59], v[68:71], v[96:99], v[56:59]
    v_mfma_f32_16x16x32_bf16 v[20:23], v[72:75], v[96:99], v[20:23]
    v_mfma_f32_16x16x32_bf16 v[52:55], v[76:79], v[96:99], v[52:55]
    v_mfma_f32_16x16x32_bf16 v[16:19], v[80:83], v[96:99], v[16:19]
    v_mfma_f32_16x16x32_bf16 v[48:51], v[84:87], v[96:99], v[48:51]
    v_mfma_f32_16x16x32_bf16 v[12:15], v[88:91], v[96:99], v[12:15]
    v_mfma_f32_16x16x32_bf16 v[44:47], v[92:95], v[96:99], v[44:47]
    s_waitcnt lgkmcnt(3)
    v_mfma_f32_16x16x32_bf16 v[28:31], v[64:67], v[100:103], v[28:31]
    v_mfma_f32_16x16x32_bf16 v[60:63], v[68:71], v[100:103], v[60:63]
    v_mfma_f32_16x16x32_bf16 v[24:27], v[72:75], v[100:103], v[24:27]
    v_mfma_f32_16x16x32_bf16 v[56:59], v[76:79], v[100:103], v[56:59]
    v_mfma_f32_16x16x32_bf16 v[20:23], v[80:83], v[100:103], v[20:23]
    v_mfma_f32_16x16x32_bf16 v[52:55], v[84:87], v[100:103], v[52:55]
    v_mfma_f32_16x16x32_bf16 v[16:19], v[88:91], v[100:103], v[16:19]
    v_mfma_f32_16x16x32_bf16 v[48:51], v[92:95], v[100:103], v[48:51]
    buffer_load_dwordx4 v[64:67], v125, s[12:15], s23 offen offset:0
    buffer_load_dwordx4 v[68:71], v125, s[12:15], s23 offen offset:1024
    s_waitcnt lgkmcnt(2)
    v_mfma_f32_16x16x32_bf16 v[28:31], v[72:75], v[104:107], v[28:31]
    v_mfma_f32_16x16x32_bf16 v[60:63], v[76:79], v[104:107], v[60:63]
    v_mfma_f32_16x16x32_bf16 v[24:27], v[80:83], v[104:107], v[24:27]
    v_mfma_f32_16x16x32_bf16 v[56:59], v[84:87], v[104:107], v[56:59]
    v_mfma_f32_16x16x32_bf16 v[20:23], v[88:91], v[104:107], v[20:23]
    v_mfma_f32_16x16x32_bf16 v[52:55], v[92:95], v[104:107], v[52:55]
    buffer_load_dwordx4 v[72:75], v125, s[12:15], s23 offen offset:2048
    buffer_load_dwordx4 v[76:79], v125, s[12:15], s23 offen offset:3072
    s_waitcnt lgkmcnt(1)
    v_mfma_f32_16x16x32_bf16 v[28:31], v[80:83], v[108:111], v[28:31]
    v_mfma_f32_16x16x32_bf16 v[60:63], v[84:87], v[108:111], v[60:63]
    v_mfma_f32_16x16x32_bf16 v[24:27], v[88:91], v[108:111], v[24:27]
    v_mfma_f32_16x16x32_bf16 v[56:59], v[92:95], v[108:111], v[56:59]
    buffer_load_dwordx4 v[80:83], v125, s[12:15], s26 offen offset:0
    buffer_load_dwordx4 v[84:87], v125, s[12:15], s26 offen offset:1024
    s_waitcnt lgkmcnt(0)
    v_mfma_f32_16x16x32_bf16 v[28:31], v[88:91], v[112:115], v[28:31]
    v_mfma_f32_16x16x32_bf16 v[60:63], v[92:95], v[112:115], v[60:63]
    buffer_load_dwordx4 v[88:91], v125, s[12:15], s26 offen offset:2048
    buffer_load_dwordx4 v[92:95], v125, s[12:15], s26 offen offset:3072
    s_add_u32 s23, s23, 57344
    s_add_u32 s26, s26, 57344
    s_barrier
    s_branch L_conv2_kernel_mloop1
L_conv2_kernel_mlast1:
    v_and_b32 v125, 15, v127
    v_and_b32 v126, 7, v127
    v_lshlrev_b32 v126, 4, v126
    v_lshl_add_u32 v125, v125, 7, v126
    v_lshrrev_b32 v126, 4, v127
    v_lshl_add_u32 v125, v126, 11, v125
    s_lshl_b32 s36, s20, 14
    s_add_u32 s37, s36, 8192
    v_add_u32 v126, s37, v125
    v_add_u32 v125, s36, v125
    ds_read_b128 v[96:99], v120 offset:8192
    ds_read_b128 v[100:103], v120 offset:9216
    ds_read_b128 v[104:107], v120 offset:10240
    ds_read_b128 v[108:111], v120 offset:11264
    ds_read_b128 v[112:115], v120 offset:12288
    ds_read_b128 v[116:119], v120 offset:13312
    s_waitcnt vmcnt(6) lgkmcnt(5)
    v_mfma_f32_16x16x32_bf16 v[0:3], v[64:67], v[96:99], v[0:3]
    v_mfma_f32_16x16x32_bf16 v[32:35], v[68:71], v[96:99], v[32:35]
    ds_read_b128 v[96:99], v120 offset:14336
    s_waitcnt vmcnt(4) lgkmcnt(5)
    v_mfma_f32_16x16x32_bf16 v[4:7], v[64:67], v[100:103], v[4:7]
    v_mfma_f32_16x16x32_bf16 v[36:39], v[68:71], v[100:103], v[36:39]
    v_mfma_f32_16x16x32_bf16 v[0:3], v[72:75], v[100:103], v[0:3]
    v_mfma_f32_16x16x32_bf16 v[32:35], v[76:79], v[100:103], v[32:35]
    ds_read_b128 v[100:103], v120 offset:15360
    s_waitcnt vmcnt(2) lgkmcnt(5)
    v_mfma_f32_16x16x32_bf16 v[8:11], v[64:67], v[104:107], v[8:11]
    v_mfma_f32_16x16x32_bf16 v[40:43], v[68:71], v[104:107], v[40:43]
    v_mfma_f32_16x16x32_bf16 v[4:7], v[72:75], v[104:107], v[4:7]
    v_mfma_f32_16x16x32_bf16 v[36:39], v[76:79], v[104:107], v[36:39]
    v_mfma_f32_16x16x32_bf16 v[0:3], v[80:83], v[104:107], v[0:3]
    v_mfma_f32_16x16x32_bf16 v[32:35], v[84:87], v[104:107], v[32:35]
    ds_read_b128 v[104:107], v122 offset:0
    s_waitcnt vmcnt(0) lgkmcnt(5)
    v_mfma_f32_16x16x32_bf16 v[12:15], v[64:67], v[108:111], v[12:15]
    v_mfma_f32_16x16x32_bf16 v[44:47], v[68:71], v[108:111], v[44:47]
    v_mfma_f32_16x16x32_bf16 v[8:11], v[72:75], v[108:111], v[8:11]
    v_mfma_f32_16x16x32_bf16 v[40:43], v[76:79], v[108:111], v[40:43]
    v_mfma_f32_16x16x32_bf16 v[4:7], v[80:83], v[108:111], v[4:7]
    v_mfma_f32_16x16x32_bf16 v[36:39], v[84:87], v[108:111], v[36:39]
    v_mfma_f32_16x16x32_bf16 v[0:3], v[88:91], v[108:111], v[0:3]
    v_mfma_f32_16x16x32_bf16 v[32:35], v[92:95], v[108:111], v[32:35]
    ds_read_b128 v[108:111], v121 offset:9216
    s_waitcnt lgkmcnt(5)
    v_mfma_f32_16x16x32_bf16 v[16:19], v[64:67], v[112:115], v[16:19]
    v_mfma_f32_16x16x32_bf16 v[48:51], v[68:71], v[112:115], v[48:51]
    v_mfma_f32_16x16x32_bf16 v[12:15], v[72:75], v[112:115], v[12:15]
    v_mfma_f32_16x16x32_bf16 v[44:47], v[76:79], v[112:115], v[44:47]
    v_mfma_f32_16x16x32_bf16 v[8:11], v[80:83], v[112:115], v[8:11]
    v_mfma_f32_16x16x32_bf16 v[40:43], v[84:87], v[112:115], v[40:43]
    v_mfma_f32_16x16x32_bf16 v[4:7], v[88:91], v[112:115], v[4:7]
    v_mfma_f32_16x16x32_bf16 v[36:39], v[92:95], v[112:115], v[36:39]
    ds_read_b128 v[112:115], v121 offset:10240
    v_xor_b32 v123, 0, v125
    ds_write_b128 v123, v[0:3]
    s_waitcnt lgkmcnt(6)
    v_mfma_f32_16x16x32_bf16 v[20:23], v[64:67], v[116:119], v[20:23]
    v_mfma_f32_16x16x32_bf16 v[52:55], v[68:71], v[116:119], v[52:55]
    v_mfma_f32_16x16x32_bf16 v[16:19], v[72:75], v[116:119], v[16:19]
    v_mfma_f32_16x16x32_bf16 v[48:51], v[76:79], v[116:119], v[48:51]
    v_mfma_f32_16x16x32_bf16 v[12:15], v[80:83], v[116:119], v[12:15]
    v_mfma_f32_16x16x32_bf16 v[44:47], v[84:87], v[116:119], v[44:47]
    v_mfma_f32_16x16x32_bf16 v[8:11], v[88:91], v[116:119], v[8:11]
    v_mfma_f32_16x16x32_bf16 v[40:43], v[92:95], v[116:119], v[40:43]
    v_xor_b32 v124, 16, v125
    ds_write_b128 v124, v[4:7]
    s_waitcnt lgkmcnt(2)
    v_mfma_f32_16x16x32_bf16 v[24:27], v[64:67], v[96:99], v[24:27]
    v_mfma_f32_16x16x32_bf16 v[56:59], v[68:71], v[96:99], v[56:59]
    v_mfma_f32_16x16x32_bf16 v[20:23], v[72:75], v[96:99], v[20:23]
    v_mfma_f32_16x16x32_bf16 v[52:55], v[76:79], v[96:99], v[52:55]
    v_mfma_f32_16x16x32_bf16 v[16:19], v[80:83], v[96:99], v[16:19]
    v_mfma_f32_16x16x32_bf16 v[48:51], v[84:87], v[96:99], v[48:51]
    v_mfma_f32_16x16x32_bf16 v[12:15], v[88:91], v[96:99], v[12:15]
    v_mfma_f32_16x16x32_bf16 v[44:47], v[92:95], v[96:99], v[44:47]
    v_xor_b32 v123, 32, v125
    ds_write_b128 v123, v[8:11]
    v_xor_b32 v124, 0, v126
    ds_write_b128 v124, v[32:35]
    v_mfma_f32_16x16x32_bf16 v[28:31], v[64:67], v[100:103], v[28:31]
    v_mfma_f32_16x16x32_bf16 v[60:63], v[68:71], v[100:103], v[60:63]
    v_mfma_f32_16x16x32_bf16 v[24:27], v[72:75], v[100:103], v[24:27]
    v_mfma_f32_16x16x32_bf16 v[56:59], v[76:79], v[100:103], v[56:59]
    v_mfma_f32_16x16x32_bf16 v[20:23], v[80:83], v[100:103], v[20:23]
    v_mfma_f32_16x16x32_bf16 v[52:55], v[84:87], v[100:103], v[52:55]
    v_mfma_f32_16x16x32_bf16 v[16:19], v[88:91], v[100:103], v[16:19]
    v_mfma_f32_16x16x32_bf16 v[48:51], v[92:95], v[100:103], v[48:51]
    v_xor_b32 v123, 16, v126
    ds_write_b128 v123, v[36:39]
    v_xor_b32 v124, 32, v126
    ds_write_b128 v124, v[40:43]
    v_mfma_f32_16x16x32_bf16 v[28:31], v[72:75], v[104:107], v[28:31]
    v_mfma_f32_16x16x32_bf16 v[60:63], v[76:79], v[104:107], v[60:63]
    v_mfma_f32_16x16x32_bf16 v[24:27], v[80:83], v[104:107], v[24:27]
    v_mfma_f32_16x16x32_bf16 v[56:59], v[84:87], v[104:107], v[56:59]
    v_mfma_f32_16x16x32_bf16 v[20:23], v[88:91], v[104:107], v[20:23]
    v_mfma_f32_16x16x32_bf16 v[52:55], v[92:95], v[104:107], v[52:55]
    v_xor_b32 v124, 48, v125
    ds_write_b128 v124, v[12:15]
    v_xor_b32 v123, 48, v126
    ds_write_b128 v123, v[44:47]
    v_mfma_f32_16x16x32_bf16 v[28:31], v[80:83], v[108:111], v[28:31]
    v_mfma_f32_16x16x32_bf16 v[60:63], v[84:87], v[108:111], v[60:63]
    v_mfma_f32_16x16x32_bf16 v[24:27], v[88:91], v[108:111], v[24:27]
    v_mfma_f32_16x16x32_bf16 v[56:59], v[92:95], v[108:111], v[56:59]
    v_xor_b32 v123, 64, v125
    ds_write_b128 v123, v[16:19]
    v_xor_b32 v124, 64, v126
    ds_write_b128 v124, v[48:51]
    v_mfma_f32_16x16x32_bf16 v[28:31], v[88:91], v[112:115], v[28:31]
    v_mfma_f32_16x16x32_bf16 v[60:63], v[92:95], v[112:115], v[60:63]
    v_xor_b32 v124, 80, v125
    ds_write_b128 v124, v[20:23]
    v_xor_b32 v123, 80, v126
    ds_write_b128 v123, v[52:55]
    v_and_b32 v108, 15, v127
    v_lshrrev_b32 v109, 4, v127
    v_lshrrev_b32 v110, 3, v108
    s_lshl_b32 s36, s20, 1
    v_add_u32 v110, s36, v110
    v_xor_b32 v111, v110, v108
    v_and_b32 v111, 7, v111
    v_lshlrev_b32 v111, 4, v111
    v_xor_b32 v123, 96, v125
    ds_write_b128 v123, v[24:27]
    v_lshl_add_u32 v111, v110, 7, v111
    v_lshl_add_u32 v120, v109, 11, v111
    v_add_u32 v121, 65536, v120
    v_add_u32 v64, 131072, v120
    s_lshl_b32 s36, s20, 9
    s_add_u32 s36, s36, 115712
    v_lshl_add_u32 v127, v109, 7, s36
    s_lshl_b32 s36, s20, 4
    v_add_u32 v108, s36, v108
    v_lshlrev_b32 v110, 6, v108
    v_lshl_add_u32 v110, v109, 4, v110
    s_mul_i32 s36, s29, 262144
    v_xor_b32 v124, 96, v126
    ds_write_b128 v124, v[56:59]
    s_lshl_b32 s37, s21, 4
    s_add_u32 s36, s36, s37
    v_add_u32 v110, s36, v110
    v_mov_b32 v111, 2130706432
    v_cmp_gt_u32 vcc, 125, v108
    s_mov_b32 s4, 0xbeaaaaab
    s_mov_b32 s5, s4
    s_mov_b32 s6, 0x3e800000
    s_mov_b32 s7, s6
    s_mov_b32 s8, 0xc0a00000
    s_mov_b32 s9, s8
    s_mov_b32 s10, 0xc0638e39
    v_xor_b32 v124, 112, v125
    ds_write_b128 v124, v[28:31]
    s_mov_b32 s11, s10
    s_mov_b32 s12, 0xbf638e39
    s_mov_b32 s13, s12
    s_mov_b32 s14, 0xbe638e39
    s_mov_b32 s15, s14
    s_mov_b32 s22, 0xbd638e39
    s_mov_b32 s23, s22
    s_mov_b32 s24, 0x3ff1c71c
    s_mov_b32 s25, s24
    s_mov_b32 s26, 0xbf2aaaab
    s_mov_b32 s27, s26
    s_mov_b32 s32, 0x3ecccccd
    v_xor_b32 v123, 112, v126
    s_waitcnt lgkmcnt(8)
    ds_write_b128 v123, v[60:63]
    s_mov_b32 s33, s32
    s_mov_b32 s34, 0xbd888889
    s_mov_b32 s35, s34
    s_mov_b32 s38, 0xbe4ccccd
    s_mov_b32 s39, s38
    s_mov_b32 s40, 0xbdd2d3e8
    s_mov_b32 s41, s40
    s_mov_b32 s42, 0x3f800000
    s_mov_b32 s43, s42
    s_setprio 0
    s_branch L_conv2_kernel_epi
L_conv2_kernel_m2:
    s_mul_i32 s37, s38, 2176
    s_add_u32 s37, s37, 98304
    v_add_u32 v116, s37, v8
    v_add_u32 v118, s37, v9
    v_add_u32 v117, 104832, v8
    s_cmp_eq_u32 s38, 0
    s_cbranch_scc1 L_conv2_kernel_hh0
    v_add_u32 v117, 98304, v9
L_conv2_kernel_hh0:
    s_lshl_b32 s37, s38, 12
    s_add_u32 s37, s37, s43
    s_add_u32 s37, s37, 49152
    v_lshl_add_u32 v119, v127, 4, s37
    v_mov_b32 v0, 0
    v_mov_b32 v1, 0
    v_mov_b32 v2, 0
    v_mov_b32 v3, 0
    v_mov_b32 v4, 0
    v_mov_b32 v5, 0
    v_mov_b32 v6, 0
    v_mov_b32 v7, 0
    v_mov_b32 v8, 0
    v_mov_b32 v9, 0
    v_mov_b32 v10, 0
    v_mov_b32 v11, 0
    v_mov_b32 v12, 0
    v_mov_b32 v13, 0
    v_mov_b32 v14, 0
    v_mov_b32 v15, 0
    v_mov_b32 v16, 0
    v_mov_b32 v17, 0
    v_mov_b32 v18, 0
    v_mov_b32 v19, 0
    v_mov_b32 v20, 0
    v_mov_b32 v21, 0
    v_mov_b32 v22, 0
    v_mov_b32 v23, 0
    v_mov_b32 v24, 0
    v_mov_b32 v25, 0
    v_mov_b32 v26, 0
    v_mov_b32 v27, 0
    v_mov_b32 v28, 0
    v_mov_b32 v29, 0
    v_mov_b32 v30, 0
    v_mov_b32 v31, 0
    v_mov_b32 v32, 0
    v_mov_b32 v33, 0
    v_mov_b32 v34, 0
    v_mov_b32 v35, 0
    v_mov_b32 v36, 0
    v_mov_b32 v37, 0
    v_mov_b32 v38, 0
    v_mov_b32 v39, 0
    v_mov_b32 v40, 0
    v_mov_b32 v41, 0
    v_mov_b32 v42, 0
    v_mov_b32 v43, 0
    v_mov_b32 v44, 0
    v_mov_b32 v45, 0
    v_mov_b32 v46, 0
    v_mov_b32 v47, 0
    v_mov_b32 v48, 0
    v_mov_b32 v49, 0
    v_mov_b32 v50, 0
    v_mov_b32 v51, 0
    v_mov_b32 v52, 0
    v_mov_b32 v53, 0
    v_mov_b32 v54, 0
    v_mov_b32 v55, 0
    v_mov_b32 v56, 0
    v_mov_b32 v57, 0
    v_mov_b32 v58, 0
    v_mov_b32 v59, 0
    v_mov_b32 v60, 0
    v_mov_b32 v61, 0
    v_mov_b32 v62, 0
    v_mov_b32 v63, 0
    buffer_load_dwordx4 v[96:99], v108, s[8:11], 0 offen
    buffer_load_dwordx4 v[100:103], v109, s[8:11], 0 offen
    buffer_load_dwordx4 v[104:107], v110, s[8:11], 0 offen
    s_mov_b32 s23, 0
    s_mov_b32 s26, 4096
    buffer_load_dwordx4 v[64:67], v125, s[12:15], s23 offen offset:0
    buffer_load_dwordx4 v[68:71], v125, s[12:15], s23 offen offset:2048
    buffer_load_dwordx4 v[80:83], v119, s[12:15], s23 offen offset:0
    buffer_load_dwordx4 v[72:75], v125, s[12:15], s26 offen offset:0
    buffer_load_dwordx4 v[84:87], v119, s[12:15], s23 offen offset:2048
    buffer_load_dwordx4 v[76:79], v125, s[12:15], s26 offen offset:2048
    s_mov_b32 s23, 57344
    s_mov_b32 s26, 61440
    s_waitcnt vmcnt(6)
    v_lshlrev_b32 v108, 16, v96
    v_and_b32 v111, s25, v96
    v_lshlrev_b32 v109, 16, v100
    v_and_b32 v112, s25, v100
    v_lshlrev_b32 v110, 16, v104
    v_and_b32 v113, s25, v104
    v_mul_f32 v114, s44, v108
    v_mul_f32 v115, s44, v111
    v_fmac_f32 v114, s45, v109
    v_fmac_f32 v115, s45, v112
    v_fmac_f32 v114, s46, v110
    v_fmac_f32 v115, s46, v113
    v_cvt_pk_bf16_f32 v96, v114, v115
    v_lshlrev_b32 v108, 16, v97
    v_and_b32 v111, s25, v97
    v_lshlrev_b32 v109, 16, v101
    v_and_b32 v112, s25, v101
    v_lshlrev_b32 v110, 16, v105
    v_and_b32 v113, s25, v105
    v_mul_f32 v114, s44, v108
    v_mul_f32 v115, s44, v111
    v_fmac_f32 v114, s45, v109
    v_fmac_f32 v115, s45, v112
    v_fmac_f32 v114, s46, v110
    v_fmac_f32 v115, s46, v113
    v_cvt_pk_bf16_f32 v97, v114, v115
    v_lshlrev_b32 v108, 16, v98
    v_and_b32 v111, s25, v98
    v_lshlrev_b32 v109, 16, v102
    v_and_b32 v112, s25, v102
    v_lshlrev_b32 v110, 16, v106
    v_and_b32 v113, s25, v106
    v_mul_f32 v114, s44, v108
    v_mul_f32 v115, s44, v111
    v_fmac_f32 v114, s45, v109
    v_fmac_f32 v115, s45, v112
    v_fmac_f32 v114, s46, v110
    v_fmac_f32 v115, s46, v113
    v_cvt_pk_bf16_f32 v98, v114, v115
    v_lshlrev_b32 v108, 16, v99
    v_and_b32 v111, s25, v99
    v_lshlrev_b32 v109, 16, v103
    v_and_b32 v112, s25, v103
    v_lshlrev_b32 v110, 16, v107
    v_and_b32 v113, s25, v107
    v_mul_f32 v114, s44, v108
    v_mul_f32 v115, s44, v111
    v_fmac_f32 v114, s45, v109
    v_fmac_f32 v115, s45, v112
    v_fmac_f32 v114, s46, v110
    v_fmac_f32 v115, s46, v113
    v_cvt_pk_bf16_f32 v99, v114, v115
    ds_write_b128 v126, v[96:99]
    v_and_b32 v111, 15, v127
    v_lshlrev_b32 v111, 2, v111
    v_add_u32 v111, 99328, v111
    ds_write_b32 v111, v0
    ds_write_b32 v111, v0 offset:8704
    s_waitcnt lgkmcnt(0)
    s_barrier
    s_mov_b32 s22, 4
    s_setprio 2
L_conv2_kernel_mloop2:
    ds_read_b128 v[88:91], v120 offset:0
    ds_read_b128 v[92:95], v120 offset:1024
    ds_read_b128 v[96:99], v116 offset:0
    ds_read_b128 v[100:103], v120 offset:2048
    ds_read_b128 v[104:107], v116 offset:1088
    ds_read_b128 v[108:111], v120 offset:3072
    ds_read_b128 v[112:115], v116 offset:2176
    s_waitcnt vmcnt(5) lgkmcnt(6)
    v_mfma_f32_16x16x32_bf16 v[0:3], v[64:67], v[88:91], v[0:3]
    ds_read_b128 v[88:91], v120 offset:4096
    s_waitcnt vmcnt(4) lgkmcnt(6)
    v_mfma_f32_16x16x32_bf16 v[4:7], v[64:67], v[92:95], v[4:7]
    v_mfma_f32_16x16x32_bf16 v[0:3], v[68:71], v[92:95], v[0:3]
    ds_read_b128 v[92:95], v116 offset:3264
    s_waitcnt vmcnt(3) lgkmcnt(6)
    v_mfma_f32_16x16x32_bf16 v[32:35], v[80:83], v[96:99], v[32:35]
    ds_read_b128 v[96:99], v120 offset:5120
    s_waitcnt vmcnt(2) lgkmcnt(6)
    v_mfma_f32_16x16x32_bf16 v[8:11], v[64:67], v[100:103], v[8:11]
    v_mfma_f32_16x16x32_bf16 v[4:7], v[68:71], v[100:103], v[4:7]
    v_mfma_f32_16x16x32_bf16 v[0:3], v[72:75], v[100:103], v[0:3]
    ds_read_b128 v[100:103], v116 offset:4352
    s_waitcnt vmcnt(1) lgkmcnt(6)
    v_mfma_f32_16x16x32_bf16 v[36:39], v[80:83], v[104:107], v[36:39]
    v_mfma_f32_16x16x32_bf16 v[32:35], v[84:87], v[104:107], v[32:35]
    ds_read_b128 v[104:107], v120 offset:6144
    s_waitcnt vmcnt(0) lgkmcnt(6)
    v_mfma_f32_16x16x32_bf16 v[12:15], v[64:67], v[108:111], v[12:15]
    v_mfma_f32_16x16x32_bf16 v[8:11], v[68:71], v[108:111], v[8:11]
    v_mfma_f32_16x16x32_bf16 v[4:7], v[72:75], v[108:111], v[4:7]
    v_mfma_f32_16x16x32_bf16 v[0:3], v[76:79], v[108:111], v[0:3]
    ds_read_b128 v[108:111], v116 offset:5440
    s_waitcnt lgkmcnt(6)
    v_mfma_f32_16x16x32_bf16 v[40:43], v[80:83], v[112:115], v[40:43]
    v_mfma_f32_16x16x32_bf16 v[36:39], v[84:87], v[112:115], v[36:39]
    ds_read_b128 v[112:115], v120 offset:7168
    s_waitcnt lgkmcnt(6)
    v_mfma_f32_16x16x32_bf16 v[16:19], v[64:67], v[88:91], v[16:19]
    v_mfma_f32_16x16x32_bf16 v[12:15], v[68:71], v[88:91], v[12:15]
    v_mfma_f32_16x16x32_bf16 v[8:11], v[72:75], v[88:91], v[8:11]
    v_mfma_f32_16x16x32_bf16 v[4:7], v[76:79], v[88:91], v[4:7]
    ds_read_b128 v[88:91], v117 offset:0
    s_waitcnt lgkmcnt(6)
    v_mfma_f32_16x16x32_bf16 v[44:47], v[80:83], v[92:95], v[44:47]
    v_mfma_f32_16x16x32_bf16 v[40:43], v[84:87], v[92:95], v[40:43]
    ds_read_b128 v[92:95], v122 offset:0
    v_add_u32 v122, v123, v122
    s_waitcnt lgkmcnt(6)
    v_mfma_f32_16x16x32_bf16 v[20:23], v[64:67], v[96:99], v[20:23]
    v_mfma_f32_16x16x32_bf16 v[16:19], v[68:71], v[96:99], v[16:19]
    v_mfma_f32_16x16x32_bf16 v[12:15], v[72:75], v[96:99], v[12:15]
    v_mfma_f32_16x16x32_bf16 v[8:11], v[76:79], v[96:99], v[8:11]
    ds_read_b128 v[96:99], v117 offset:1088
    s_waitcnt lgkmcnt(6)
    v_mfma_f32_16x16x32_bf16 v[48:51], v[80:83], v[100:103], v[48:51]
    v_mfma_f32_16x16x32_bf16 v[44:47], v[84:87], v[100:103], v[44:47]
    ds_read_b128 v[100:103], v121 offset:1024
    s_waitcnt lgkmcnt(6)
    v_mfma_f32_16x16x32_bf16 v[24:27], v[64:67], v[104:107], v[24:27]
    v_mfma_f32_16x16x32_bf16 v[20:23], v[68:71], v[104:107], v[20:23]
    v_mfma_f32_16x16x32_bf16 v[16:19], v[72:75], v[104:107], v[16:19]
    v_mfma_f32_16x16x32_bf16 v[12:15], v[76:79], v[104:107], v[12:15]
    ds_read_b128 v[104:107], v118 offset:0
    s_waitcnt lgkmcnt(6)
    v_mfma_f32_16x16x32_bf16 v[52:55], v[80:83], v[108:111], v[52:55]
    v_mfma_f32_16x16x32_bf16 v[48:51], v[84:87], v[108:111], v[48:51]
    ds_read_b128 v[108:111], v121 offset:2048
    s_waitcnt lgkmcnt(6)
    v_mfma_f32_16x16x32_bf16 v[28:31], v[64:67], v[112:115], v[28:31]
    v_mfma_f32_16x16x32_bf16 v[24:27], v[68:71], v[112:115], v[24:27]
    v_mfma_f32_16x16x32_bf16 v[20:23], v[72:75], v[112:115], v[20:23]
    v_mfma_f32_16x16x32_bf16 v[16:19], v[76:79], v[112:115], v[16:19]
    buffer_load_dwordx4 v[64:67], v125, s[12:15], s23 offen offset:0
    s_waitcnt lgkmcnt(5)
    v_mfma_f32_16x16x32_bf16 v[56:59], v[80:83], v[88:91], v[56:59]
    v_mfma_f32_16x16x32_bf16 v[52:55], v[84:87], v[88:91], v[52:55]
    s_waitcnt lgkmcnt(0)
    s_barrier
    v_mfma_f32_16x16x32_bf16 v[28:31], v[68:71], v[92:95], v[28:31]
    v_mfma_f32_16x16x32_bf16 v[24:27], v[72:75], v[92:95], v[24:27]
    v_mfma_f32_16x16x32_bf16 v[20:23], v[76:79], v[92:95], v[20:23]
    buffer_load_dwordx4 v[68:71], v125, s[12:15], s23 offen offset:2048
    v_mfma_f32_16x16x32_bf16 v[60:63], v[80:83], v[96:99], v[60:63]
    v_mfma_f32_16x16x32_bf16 v[56:59], v[84:87], v[96:99], v[56:59]
    buffer_load_dwordx4 v[80:83], v119, s[12:15], s23 offen offset:0
    v_mfma_f32_16x16x32_bf16 v[28:31], v[72:75], v[100:103], v[28:31]
    v_mfma_f32_16x16x32_bf16 v[24:27], v[76:79], v[100:103], v[24:27]
    buffer_load_dwordx4 v[72:75], v125, s[12:15], s26 offen offset:0
    v_mfma_f32_16x16x32_bf16 v[60:63], v[84:87], v[104:107], v[60:63]
    buffer_load_dwordx4 v[84:87], v119, s[12:15], s23 offen offset:2048
    v_mfma_f32_16x16x32_bf16 v[28:31], v[76:79], v[108:111], v[28:31]
    buffer_load_dwordx4 v[76:79], v125, s[12:15], s26 offen offset:2048
    s_add_u32 s23, s23, 57344
    s_add_u32 s26, s26, 57344
    s_sub_u32 s22, s22, 1
    s_cmp_eq_u32 s22, 0
    s_cbranch_scc1 L_conv2_kernel_mlast2
    ds_read_b128 v[88:91], v120 offset:8192
    ds_read_b128 v[92:95], v120 offset:9216
    ds_read_b128 v[96:99], v116 offset:8704
    ds_read_b128 v[100:103], v120 offset:10240
    ds_read_b128 v[104:107], v116 offset:9792
    ds_read_b128 v[108:111], v120 offset:11264
    ds_read_b128 v[112:115], v116 offset:10880
    s_waitcnt vmcnt(5) lgkmcnt(6)
    v_mfma_f32_16x16x32_bf16 v[0:3], v[64:67], v[88:91], v[0:3]
    ds_read_b128 v[88:91], v120 offset:12288
    s_waitcnt vmcnt(4) lgkmcnt(6)
    v_mfma_f32_16x16x32_bf16 v[4:7], v[64:67], v[92:95], v[4:7]
    v_mfma_f32_16x16x32_bf16 v[0:3], v[68:71], v[92:95], v[0:3]
    ds_read_b128 v[92:95], v116 offset:11968
    s_waitcnt vmcnt(3) lgkmcnt(6)
    v_mfma_f32_16x16x32_bf16 v[32:35], v[80:83], v[96:99], v[32:35]
    ds_read_b128 v[96:99], v120 offset:13312
    s_waitcnt vmcnt(2) lgkmcnt(6)
    v_mfma_f32_16x16x32_bf16 v[8:11], v[64:67], v[100:103], v[8:11]
    v_mfma_f32_16x16x32_bf16 v[4:7], v[68:71], v[100:103], v[4:7]
    v_mfma_f32_16x16x32_bf16 v[0:3], v[72:75], v[100:103], v[0:3]
    ds_read_b128 v[100:103], v116 offset:13056
    s_waitcnt vmcnt(1) lgkmcnt(6)
    v_mfma_f32_16x16x32_bf16 v[36:39], v[80:83], v[104:107], v[36:39]
    v_mfma_f32_16x16x32_bf16 v[32:35], v[84:87], v[104:107], v[32:35]
    ds_read_b128 v[104:107], v120 offset:14336
    s_waitcnt vmcnt(0) lgkmcnt(6)
    v_mfma_f32_16x16x32_bf16 v[12:15], v[64:67], v[108:111], v[12:15]
    v_mfma_f32_16x16x32_bf16 v[8:11], v[68:71], v[108:111], v[8:11]
    v_mfma_f32_16x16x32_bf16 v[4:7], v[72:75], v[108:111], v[4:7]
    v_mfma_f32_16x16x32_bf16 v[0:3], v[76:79], v[108:111], v[0:3]
    ds_read_b128 v[108:111], v116 offset:14144
    s_waitcnt lgkmcnt(6)
    v_mfma_f32_16x16x32_bf16 v[40:43], v[80:83], v[112:115], v[40:43]
    v_mfma_f32_16x16x32_bf16 v[36:39], v[84:87], v[112:115], v[36:39]
    ds_read_b128 v[112:115], v120 offset:15360
    s_waitcnt lgkmcnt(6)
    v_mfma_f32_16x16x32_bf16 v[16:19], v[64:67], v[88:91], v[16:19]
    v_mfma_f32_16x16x32_bf16 v[12:15], v[68:71], v[88:91], v[12:15]
    v_mfma_f32_16x16x32_bf16 v[8:11], v[72:75], v[88:91], v[8:11]
    v_mfma_f32_16x16x32_bf16 v[4:7], v[76:79], v[88:91], v[4:7]
    ds_read_b128 v[88:91], v117 offset:8704
    s_waitcnt lgkmcnt(6)
    v_mfma_f32_16x16x32_bf16 v[44:47], v[80:83], v[92:95], v[44:47]
    v_mfma_f32_16x16x32_bf16 v[40:43], v[84:87], v[92:95], v[40:43]
    ds_read_b128 v[92:95], v122 offset:0
    v_add_u32 v122, v124, v122
    s_waitcnt lgkmcnt(6)
    v_mfma_f32_16x16x32_bf16 v[20:23], v[64:67], v[96:99], v[20:23]
    v_mfma_f32_16x16x32_bf16 v[16:19], v[68:71], v[96:99], v[16:19]
    v_mfma_f32_16x16x32_bf16 v[12:15], v[72:75], v[96:99], v[12:15]
    v_mfma_f32_16x16x32_bf16 v[8:11], v[76:79], v[96:99], v[8:11]
    ds_read_b128 v[96:99], v117 offset:9792
    s_waitcnt lgkmcnt(6)
    v_mfma_f32_16x16x32_bf16 v[48:51], v[80:83], v[100:103], v[48:51]
    v_mfma_f32_16x16x32_bf16 v[44:47], v[84:87], v[100:103], v[44:47]
    ds_read_b128 v[100:103], v121 offset:9216
    s_waitcnt lgkmcnt(6)
    v_mfma_f32_16x16x32_bf16 v[24:27], v[64:67], v[104:107], v[24:27]
    v_mfma_f32_16x16x32_bf16 v[20:23], v[68:71], v[104:107], v[20:23]
    v_mfma_f32_16x16x32_bf16 v[16:19], v[72:75], v[104:107], v[16:19]
    v_mfma_f32_16x16x32_bf16 v[12:15], v[76:79], v[104:107], v[12:15]
    ds_read_b128 v[104:107], v118 offset:8704
    s_waitcnt lgkmcnt(6)
    v_mfma_f32_16x16x32_bf16 v[52:55], v[80:83], v[108:111], v[52:55]
    v_mfma_f32_16x16x32_bf16 v[48:51], v[84:87], v[108:111], v[48:51]
    ds_read_b128 v[108:111], v121 offset:10240
    s_waitcnt lgkmcnt(6)
    v_mfma_f32_16x16x32_bf16 v[28:31], v[64:67], v[112:115], v[28:31]
    v_mfma_f32_16x16x32_bf16 v[24:27], v[68:71], v[112:115], v[24:27]
    v_mfma_f32_16x16x32_bf16 v[20:23], v[72:75], v[112:115], v[20:23]
    v_mfma_f32_16x16x32_bf16 v[16:19], v[76:79], v[112:115], v[16:19]
    buffer_load_dwordx4 v[64:67], v125, s[12:15], s23 offen offset:0
    s_waitcnt lgkmcnt(5)
    v_mfma_f32_16x16x32_bf16 v[56:59], v[80:83], v[88:91], v[56:59]
    v_mfma_f32_16x16x32_bf16 v[52:55], v[84:87], v[88:91], v[52:55]
    s_waitcnt lgkmcnt(0)
    s_barrier
    v_mfma_f32_16x16x32_bf16 v[28:31], v[68:71], v[92:95], v[28:31]
    v_mfma_f32_16x16x32_bf16 v[24:27], v[72:75], v[92:95], v[24:27]
    v_mfma_f32_16x16x32_bf16 v[20:23], v[76:79], v[92:95], v[20:23]
    buffer_load_dwordx4 v[68:71], v125, s[12:15], s23 offen offset:2048
    v_mfma_f32_16x16x32_bf16 v[60:63], v[80:83], v[96:99], v[60:63]
    v_mfma_f32_16x16x32_bf16 v[56:59], v[84:87], v[96:99], v[56:59]
    buffer_load_dwordx4 v[80:83], v119, s[12:15], s23 offen offset:0
    v_mfma_f32_16x16x32_bf16 v[28:31], v[72:75], v[100:103], v[28:31]
    v_mfma_f32_16x16x32_bf16 v[24:27], v[76:79], v[100:103], v[24:27]
    buffer_load_dwordx4 v[72:75], v125, s[12:15], s26 offen offset:0
    v_mfma_f32_16x16x32_bf16 v[60:63], v[84:87], v[104:107], v[60:63]
    buffer_load_dwordx4 v[84:87], v119, s[12:15], s23 offen offset:2048
    v_mfma_f32_16x16x32_bf16 v[28:31], v[76:79], v[108:111], v[28:31]
    buffer_load_dwordx4 v[76:79], v125, s[12:15], s26 offen offset:2048
    s_add_u32 s23, s23, 57344
    s_add_u32 s26, s26, 57344
    s_branch L_conv2_kernel_mloop2
L_conv2_kernel_mlast2:
    v_and_b32 v125, 15, v127
    v_and_b32 v126, 7, v127
    v_lshlrev_b32 v126, 4, v126
    v_lshl_add_u32 v125, v125, 7, v126
    v_lshrrev_b32 v126, 4, v127
    v_lshl_add_u32 v125, v126, 11, v125
    s_mov_b32 s36, 65536
    s_cmp_eq_u32 s32, 1
    s_cselect_b32 s36, 121856, s36
    s_cmp_eq_u32 s32, 2
    s_cselect_b32 s36, 81920, s36
    s_cmp_eq_u32 s32, 3
    s_cselect_b32 s36, 130048, s36
    s_mov_b32 s37, 98304
    s_cmp_eq_u32 s32, 1
    s_cselect_b32 s37, 138240, s37
    s_cmp_eq_u32 s32, 2
    s_cselect_b32 s37, 146432, s37
    s_cmp_eq_u32 s32, 3
    s_cselect_b32 s37, 154624, s37
    v_add_u32 v126, s37, v125
    v_add_u32 v125, s36, v125
    ds_read_b128 v[88:91], v120 offset:8192
    ds_read_b128 v[92:95], v120 offset:9216
    ds_read_b128 v[96:99], v116 offset:8704
    ds_read_b128 v[100:103], v120 offset:10240
    ds_read_b128 v[104:107], v116 offset:9792
    ds_read_b128 v[108:111], v120 offset:11264
    ds_read_b128 v[112:115], v116 offset:10880
    s_waitcnt vmcnt(5) lgkmcnt(6)
    v_mfma_f32_16x16x32_bf16 v[0:3], v[64:67], v[88:91], v[0:3]
    ds_read_b128 v[88:91], v120 offset:12288
    s_waitcnt vmcnt(4) lgkmcnt(6)
    v_mfma_f32_16x16x32_bf16 v[4:7], v[64:67], v[92:95], v[4:7]
    v_mfma_f32_16x16x32_bf16 v[0:3], v[68:71], v[92:95], v[0:3]
    ds_read_b128 v[92:95], v116 offset:11968
    s_waitcnt vmcnt(3) lgkmcnt(6)
    v_mfma_f32_16x16x32_bf16 v[32:35], v[80:83], v[96:99], v[32:35]
    ds_read_b128 v[96:99], v120 offset:13312
    s_waitcnt vmcnt(2) lgkmcnt(6)
    v_mfma_f32_16x16x32_bf16 v[8:11], v[64:67], v[100:103], v[8:11]
    v_mfma_f32_16x16x32_bf16 v[4:7], v[68:71], v[100:103], v[4:7]
    v_mfma_f32_16x16x32_bf16 v[0:3], v[72:75], v[100:103], v[0:3]
    ds_read_b128 v[100:103], v116 offset:13056
    s_waitcnt vmcnt(1) lgkmcnt(6)
    v_mfma_f32_16x16x32_bf16 v[36:39], v[80:83], v[104:107], v[36:39]
    v_mfma_f32_16x16x32_bf16 v[32:35], v[84:87], v[104:107], v[32:35]
    ds_read_b128 v[104:107], v120 offset:14336
    s_waitcnt vmcnt(0) lgkmcnt(6)
    v_mfma_f32_16x16x32_bf16 v[12:15], v[64:67], v[108:111], v[12:15]
    v_mfma_f32_16x16x32_bf16 v[8:11], v[68:71], v[108:111], v[8:11]
    v_mfma_f32_16x16x32_bf16 v[4:7], v[72:75], v[108:111], v[4:7]
    v_mfma_f32_16x16x32_bf16 v[0:3], v[76:79], v[108:111], v[0:3]
    ds_read_b128 v[108:111], v116 offset:14144
    s_waitcnt lgkmcnt(6)
    v_mfma_f32_16x16x32_bf16 v[40:43], v[80:83], v[112:115], v[40:43]
    v_mfma_f32_16x16x32_bf16 v[36:39], v[84:87], v[112:115], v[36:39]
    ds_read_b128 v[112:115], v120 offset:15360
    s_waitcnt lgkmcnt(6)
    v_mfma_f32_16x16x32_bf16 v[16:19], v[64:67], v[88:91], v[16:19]
    v_mfma_f32_16x16x32_bf16 v[12:15], v[68:71], v[88:91], v[12:15]
    v_mfma_f32_16x16x32_bf16 v[8:11], v[72:75], v[88:91], v[8:11]
    v_mfma_f32_16x16x32_bf16 v[4:7], v[76:79], v[88:91], v[4:7]
    ds_read_b128 v[88:91], v117 offset:8704
    v_xor_b32 v124, 0, v126
    ds_write_b128 v124, v[32:35]
    s_waitcnt lgkmcnt(7)
    v_mfma_f32_16x16x32_bf16 v[44:47], v[80:83], v[92:95], v[44:47]
    v_mfma_f32_16x16x32_bf16 v[40:43], v[84:87], v[92:95], v[40:43]
    ds_read_b128 v[92:95], v122 offset:0
    v_xor_b32 v123, 0, v125
    ds_write_b128 v123, v[0:3]
    s_waitcnt lgkmcnt(8)
    v_mfma_f32_16x16x32_bf16 v[20:23], v[64:67], v[96:99], v[20:23]
    v_mfma_f32_16x16x32_bf16 v[16:19], v[68:71], v[96:99], v[16:19]
    v_mfma_f32_16x16x32_bf16 v[12:15], v[72:75], v[96:99], v[12:15]
    v_mfma_f32_16x16x32_bf16 v[8:11], v[76:79], v[96:99], v[8:11]
    ds_read_b128 v[96:99], v117 offset:9792
    v_xor_b32 v123, 16, v126
    ds_write_b128 v123, v[36:39]
    s_waitcnt lgkmcnt(9)
    v_mfma_f32_16x16x32_bf16 v[48:51], v[80:83], v[100:103], v[48:51]
    v_mfma_f32_16x16x32_bf16 v[44:47], v[84:87], v[100:103], v[44:47]
    ds_read_b128 v[100:103], v121 offset:9216
    v_xor_b32 v124, 16, v125
    ds_write_b128 v124, v[4:7]
    s_waitcnt lgkmcnt(10)
    v_mfma_f32_16x16x32_bf16 v[24:27], v[64:67], v[104:107], v[24:27]
    v_mfma_f32_16x16x32_bf16 v[20:23], v[68:71], v[104:107], v[20:23]
    v_mfma_f32_16x16x32_bf16 v[16:19], v[72:75], v[104:107], v[16:19]
    v_mfma_f32_16x16x32_bf16 v[12:15], v[76:79], v[104:107], v[12:15]
    ds_read_b128 v[104:107], v118 offset:8704
    v_xor_b32 v124, 32, v126
    ds_write_b128 v124, v[40:43]
    s_waitcnt lgkmcnt(11)
    v_mfma_f32_16x16x32_bf16 v[52:55], v[80:83], v[108:111], v[52:55]
    v_mfma_f32_16x16x32_bf16 v[48:51], v[84:87], v[108:111], v[48:51]
    ds_read_b128 v[108:111], v121 offset:10240
    v_xor_b32 v123, 32, v125
    ds_write_b128 v123, v[8:11]
    s_waitcnt lgkmcnt(12)
    v_mfma_f32_16x16x32_bf16 v[28:31], v[64:67], v[112:115], v[28:31]
    v_mfma_f32_16x16x32_bf16 v[24:27], v[68:71], v[112:115], v[24:27]
    v_mfma_f32_16x16x32_bf16 v[20:23], v[72:75], v[112:115], v[20:23]
    v_mfma_f32_16x16x32_bf16 v[16:19], v[76:79], v[112:115], v[16:19]
    v_xor_b32 v123, 48, v126
    ds_write_b128 v123, v[44:47]
    s_waitcnt lgkmcnt(12)
    v_mfma_f32_16x16x32_bf16 v[56:59], v[80:83], v[88:91], v[56:59]
    v_mfma_f32_16x16x32_bf16 v[52:55], v[84:87], v[88:91], v[52:55]
    v_xor_b32 v124, 48, v125
    ds_write_b128 v124, v[12:15]
    s_waitcnt lgkmcnt(11)
    v_mfma_f32_16x16x32_bf16 v[28:31], v[68:71], v[92:95], v[28:31]
    v_mfma_f32_16x16x32_bf16 v[24:27], v[72:75], v[92:95], v[24:27]
    v_mfma_f32_16x16x32_bf16 v[20:23], v[76:79], v[92:95], v[20:23]
    v_xor_b32 v124, 64, v126
    ds_write_b128 v124, v[48:51]
    s_waitcnt lgkmcnt(10)
    v_mfma_f32_16x16x32_bf16 v[60:63], v[80:83], v[96:99], v[60:63]
    v_mfma_f32_16x16x32_bf16 v[56:59], v[84:87], v[96:99], v[56:59]
    v_xor_b32 v123, 64, v125
    ds_write_b128 v123, v[16:19]
    s_waitcnt lgkmcnt(9)
    v_mfma_f32_16x16x32_bf16 v[28:31], v[72:75], v[100:103], v[28:31]
    v_mfma_f32_16x16x32_bf16 v[24:27], v[76:79], v[100:103], v[24:27]
    v_xor_b32 v123, 80, v126
    ds_write_b128 v123, v[52:55]
    s_waitcnt lgkmcnt(8)
    v_mfma_f32_16x16x32_bf16 v[60:63], v[84:87], v[104:107], v[60:63]
    v_xor_b32 v124, 80, v125
    ds_write_b128 v124, v[20:23]
    s_waitcnt lgkmcnt(7)
    v_mfma_f32_16x16x32_bf16 v[28:31], v[76:79], v[108:111], v[28:31]
    v_xor_b32 v124, 96, v126
    ds_write_b128 v124, v[56:59]
    v_and_b32 v108, 15, v127
    v_lshrrev_b32 v109, 4, v127
    v_lshrrev_b32 v110, 3, v108
    s_lshl_b32 s36, s20, 1
    v_add_u32 v110, s36, v110
    v_xor_b32 v111, v110, v108
    v_and_b32 v111, 7, v111
    v_lshlrev_b32 v111, 4, v111
    v_xor_b32 v123, 96, v125
    ds_write_b128 v123, v[24:27]
    v_lshl_add_u32 v111, v110, 7, v111
    v_lshl_add_u32 v120, v109, 11, v111
    v_add_u32 v121, 65536, v120
    v_add_u32 v64, 131072, v120
    s_lshl_b32 s36, s20, 9
    s_add_u32 s36, s36, 115712
    v_lshl_add_u32 v127, v109, 7, s36
    s_lshl_b32 s36, s20, 4
    v_add_u32 v108, s36, v108
    v_lshlrev_b32 v110, 6, v108
    v_lshl_add_u32 v110, v109, 4, v110
    s_mul_i32 s36, s29, 262144
    v_xor_b32 v123, 112, v126
    ds_write_b128 v123, v[60:63]
    s_lshl_b32 s37, s21, 4
    s_add_u32 s36, s36, s37
    v_add_u32 v110, s36, v110
    v_mov_b32 v111, 2130706432
    v_cmp_gt_u32 vcc, 125, v108
    s_mov_b32 s4, 0xbeaaaaab
    s_mov_b32 s5, s4
    s_mov_b32 s6, 0x3e800000
    s_mov_b32 s7, s6
    s_mov_b32 s8, 0xc0a00000
    s_mov_b32 s9, s8
    s_mov_b32 s10, 0xc0638e39
    v_xor_b32 v124, 112, v125
    ds_write_b128 v124, v[28:31]
    s_mov_b32 s11, s10
    s_mov_b32 s12, 0xbf638e39
    s_mov_b32 s13, s12
    s_mov_b32 s14, 0xbe638e39
    s_mov_b32 s15, s14
    s_mov_b32 s22, 0xbd638e39
    s_mov_b32 s23, s22
    s_mov_b32 s24, 0x3ff1c71c
    s_mov_b32 s25, s24
    s_mov_b32 s26, 0xbf2aaaab
    s_mov_b32 s27, s26
    s_mov_b32 s32, 0x3ecccccd
    s_mov_b32 s33, s32
    s_mov_b32 s34, 0xbd888889
    s_mov_b32 s35, s34
    s_mov_b32 s38, 0xbe4ccccd
    s_mov_b32 s39, s38
    s_mov_b32 s40, 0xbdd2d3e8
    s_mov_b32 s41, s40
    s_mov_b32 s42, 0x3f800000
    s_mov_b32 s43, s42
    s_setprio 0
    s_branch L_conv2_kernel_epi
L_conv2_kernel_epi:
    s_waitcnt lgkmcnt(0)
    s_barrier
    v_cndmask_b32 v122, v111, v110, vcc
    ds_read_b128 v[0:3], v120 offset:0
    ds_read_b128 v[4:7], v120 offset:16384
    ds_read_b128 v[8:11], v120 offset:32768
    ds_read_b128 v[12:15], v120 offset:49152
    ds_read_b128 v[16:19], v121 offset:0
    ds_read_b128 v[20:23], v121 offset:16384
    ds_read_b128 v[24:27], v121 offset:32768
    ds_read_b128 v[28:31], v64 offset:15360
    ds_read_b128 v[32:35], v120 offset:8192
    ds_read_b128 v[36:39], v120 offset:24576
    ds_read_b128 v[40:43], v120 offset:40960
    ds_read_b128 v[44:47], v120 offset:57344
    ds_read_b128 v[48:51], v121 offset:56320
    ds_read_b128 v[52:55], v121 offset:64512
    ds_read_b128 v[56:59], v64 offset:7168
    s_waitcnt lgkmcnt(7)
    ds_read_b128 v[60:63], v64 offset:23552
    s_waitcnt lgkmcnt(8)
    v_pk_add_f32 v[88:89], v[24:25], v[28:29]
    v_pk_add_f32 v[90:91], v[26:27], v[30:31]
    v_pk_add_f32 v[24:25], v[4:5], v[8:9]
    v_pk_add_f32 v[26:27], v[6:7], v[10:11]
    v_pk_add_f32 v[4:5], v[4:5], v[8:9] neg_lo:[0,1] neg_hi:[0,1]
    v_pk_add_f32 v[6:7], v[6:7], v[10:11] neg_lo:[0,1] neg_hi:[0,1]
    v_pk_add_f32 v[72:73], v[12:13], v[16:17]
    v_pk_add_f32 v[74:75], v[14:15], v[18:19]
    v_pk_add_f32 v[12:13], v[12:13], v[16:17] neg_lo:[0,1] neg_hi:[0,1]
    v_pk_add_f32 v[14:15], v[14:15], v[18:19] neg_lo:[0,1] neg_hi:[0,1]
    v_pk_fma_f32 v[72:73], v[24:25], s[4:5], v[72:73]
    v_pk_fma_f32 v[74:75], v[26:27], s[4:5], v[74:75]
    v_pk_fma_f32 v[20:21], v[0:1], s[10:11], v[20:21]
    v_pk_fma_f32 v[22:23], v[2:3], s[10:11], v[22:23]
    v_pk_fma_f32 v[72:73], v[0:1], s[6:7], v[72:73]
    v_pk_fma_f32 v[74:75], v[2:3], s[6:7], v[74:75]
    v_pk_add_f32 v[24:25], v[24:25], v[0:1] neg_lo:[0,1] neg_hi:[0,1]
    v_pk_add_f32 v[26:27], v[26:27], v[2:3] neg_lo:[0,1] neg_hi:[0,1]
    v_pk_fma_f32 v[72:73], v[88:89], s[8:9], v[72:73]
    v_pk_fma_f32 v[74:75], v[90:91], s[8:9], v[74:75]
    v_pk_add_f32 v[24:25], v[24:25], v[88:89] neg_lo:[0,1] neg_hi:[0,1]
    v_pk_add_f32 v[26:27], v[26:27], v[90:91] neg_lo:[0,1] neg_hi:[0,1]
    v_pk_fma_f32 v[20:21], v[88:89], s[22:23], v[20:21]
    v_pk_fma_f32 v[22:23], v[90:91], s[22:23], v[22:23]
    v_pk_add_f32 v[8:9], v[24:25], v[72:73] neg_lo:[0,1] neg_hi:[0,1]
    v_pk_add_f32 v[10:11], v[26:27], v[74:75] neg_lo:[0,1] neg_hi:[0,1]
    v_pk_fma_f32 v[20:21], v[72:73], s[14:15], v[20:21]
    v_pk_fma_f32 v[22:23], v[74:75], s[14:15], v[22:23]
    v_pk_mul_f32 v[80:81], v[12:13], s[32:33]
    v_pk_mul_f32 v[82:83], v[14:15], s[32:33]
    v_pk_fma_f32 v[20:21], v[8:9], s[12:13], v[20:21]
    v_pk_fma_f32 v[22:23], v[10:11], s[12:13], v[22:23]
    v_pk_fma_f32 v[80:81], v[4:5], s[34:35], v[80:81]
    v_pk_fma_f32 v[82:83], v[6:7], s[34:35], v[82:83]
    v_pk_fma_f32 v[64:65], v[4:5], s[24:25], v[20:21] neg_lo:[0,0,1] neg_hi:[0,0,1]
    v_pk_fma_f32 v[66:67], v[6:7], s[24:25], v[22:23] neg_lo:[0,0,1] neg_hi:[0,0,1]
    v_pk_fma_f32 v[64:65], v[12:13], s[26:27], v[64:65]
    v_pk_fma_f32 v[66:67], v[14:15], s[26:27], v[66:67]
    v_pk_fma_f32 v[80:81], v[64:65], s[38:39], v[80:81]
    v_pk_fma_f32 v[82:83], v[66:67], s[38:39], v[82:83]
    v_pk_add_f32 v[4:5], v[4:5], v[64:65] neg_lo:[0,1] neg_hi:[0,1]
    v_pk_add_f32 v[6:7], v[6:7], v[66:67] neg_lo:[0,1] neg_hi:[0,1]
    v_pk_add_f32 v[4:5], v[4:5], v[80:81] neg_lo:[0,1] neg_hi:[0,1]
    v_pk_add_f32 v[6:7], v[6:7], v[82:83] neg_lo:[0,1] neg_hi:[0,1]
    s_waitcnt lgkmcnt(0)
    v_pk_add_f32 v[92:93], v[56:57], v[60:61]
    v_pk_add_f32 v[94:95], v[58:59], v[62:63]
    v_pk_add_f32 v[56:57], v[36:37], v[40:41]
    v_pk_add_f32 v[58:59], v[38:39], v[42:43]
    v_pk_add_f32 v[36:37], v[36:37], v[40:41] neg_lo:[0,1] neg_hi:[0,1]
    v_pk_add_f32 v[38:39], v[38:39], v[42:43] neg_lo:[0,1] neg_hi:[0,1]
    v_pk_add_f32 v[76:77], v[44:45], v[48:49]
    v_pk_add_f32 v[78:79], v[46:47], v[50:51]
    v_pk_add_f32 v[44:45], v[44:45], v[48:49] neg_lo:[0,1] neg_hi:[0,1]
    v_pk_add_f32 v[46:47], v[46:47], v[50:51] neg_lo:[0,1] neg_hi:[0,1]
    v_pk_fma_f32 v[76:77], v[56:57], s[4:5], v[76:77]
    v_pk_fma_f32 v[78:79], v[58:59], s[4:5], v[78:79]
    v_pk_fma_f32 v[52:53], v[32:33], s[10:11], v[52:53]
    v_pk_fma_f32 v[54:55], v[34:35], s[10:11], v[54:55]
    v_pk_fma_f32 v[76:77], v[32:33], s[6:7], v[76:77]
    v_pk_fma_f32 v[78:79], v[34:35], s[6:7], v[78:79]
    v_pk_add_f32 v[56:57], v[56:57], v[32:33] neg_lo:[0,1] neg_hi:[0,1]
    v_pk_add_f32 v[58:59], v[58:59], v[34:35] neg_lo:[0,1] neg_hi:[0,1]
    v_pk_fma_f32 v[76:77], v[92:93], s[8:9], v[76:77]
    v_pk_fma_f32 v[78:79], v[94:95], s[8:9], v[78:79]
    v_pk_add_f32 v[56:57], v[56:57], v[92:93] neg_lo:[0,1] neg_hi:[0,1]
    v_pk_add_f32 v[58:59], v[58:59], v[94:95] neg_lo:[0,1] neg_hi:[0,1]
    v_pk_fma_f32 v[52:53], v[92:93], s[22:23], v[52:53]
    v_pk_fma_f32 v[54:55], v[94:95], s[22:23], v[54:55]
    v_pk_add_f32 v[40:41], v[56:57], v[76:77] neg_lo:[0,1] neg_hi:[0,1]
    v_pk_add_f32 v[42:43], v[58:59], v[78:79] neg_lo:[0,1] neg_hi:[0,1]
    v_pk_fma_f32 v[52:53], v[76:77], s[14:15], v[52:53]
    v_pk_fma_f32 v[54:55], v[78:79], s[14:15], v[54:55]
    v_pk_mul_f32 v[84:85], v[44:45], s[32:33]
    v_pk_mul_f32 v[86:87], v[46:47], s[32:33]
    v_pk_fma_f32 v[52:53], v[40:41], s[12:13], v[52:53]
    v_pk_fma_f32 v[54:55], v[42:43], s[12:13], v[54:55]
    v_pk_fma_f32 v[84:85], v[36:37], s[34:35], v[84:85]
    v_pk_fma_f32 v[86:87], v[38:39], s[34:35], v[86:87]
    v_pk_fma_f32 v[68:69], v[36:37], s[24:25], v[52:53] neg_lo:[0,0,1] neg_hi:[0,0,1]
    v_pk_fma_f32 v[70:71], v[38:39], s[24:25], v[54:55] neg_lo:[0,0,1] neg_hi:[0,0,1]
    v_pk_fma_f32 v[68:69], v[44:45], s[26:27], v[68:69]
    v_pk_fma_f32 v[70:71], v[46:47], s[26:27], v[70:71]
    v_pk_fma_f32 v[84:85], v[68:69], s[38:39], v[84:85]
    v_pk_fma_f32 v[86:87], v[70:71], s[38:39], v[86:87]
    v_pk_add_f32 v[36:37], v[36:37], v[68:69] neg_lo:[0,1] neg_hi:[0,1]
    v_pk_add_f32 v[38:39], v[38:39], v[70:71] neg_lo:[0,1] neg_hi:[0,1]
    v_pk_add_f32 v[36:37], v[36:37], v[84:85] neg_lo:[0,1] neg_hi:[0,1]
    v_pk_add_f32 v[38:39], v[38:39], v[86:87] neg_lo:[0,1] neg_hi:[0,1]
    s_mov_b32 s36, 0x00010001
    s_mov_b32 s37, 0x00010001
    s_mov_b64 exec, s[36:37]
    ds_write_b128 v127, v[0:3] offset:0
    ds_write_b128 v127, v[32:35] offset:16
    ds_write_b128 v127, v[4:7] offset:32
    ds_write_b128 v127, v[36:39] offset:48
    ds_write_b128 v127, v[8:11] offset:64
    ds_write_b128 v127, v[40:43] offset:80
    s_mov_b64 exec, -1
    v_mov_b32 v44, 0xc0135761
    v_mov_b32 v45, v44
    v_cvt_pk_bf16_f32 v48, v64, v68
    v_cvt_pk_bf16_f32 v49, v65, v69
    v_cvt_pk_bf16_f32 v50, v66, v70
    v_cvt_pk_bf16_f32 v51, v67, v71
    s_mov_b32 s44, 0
    buffer_store_dwordx4 v[48:51], v122, s[16:19], s44 offen sc1
    s_waitcnt lgkmcnt(0)
    s_barrier
    ds_read_b128 v[96:99], v127 offset:512
    ds_read_b128 v[100:103], v127 offset:528
    ds_read_b128 v[104:107], v127 offset:544
    ds_read_b128 v[108:111], v127 offset:560
    ds_read_b128 v[112:115], v127 offset:576
    ds_read_b128 v[116:119], v127 offset:592
    s_waitcnt lgkmcnt(4)
    v_mov_b32_dpp v96, v0 row_shl:1 row_mask:0xf bank_mask:0xf
    v_mov_b32_dpp v97, v1 row_shl:1 row_mask:0xf bank_mask:0xf
    v_mov_b32_dpp v98, v2 row_shl:1 row_mask:0xf bank_mask:0xf
    v_mov_b32_dpp v99, v3 row_shl:1 row_mask:0xf bank_mask:0xf
    v_mov_b32_dpp v100, v32 row_shl:1 row_mask:0xf bank_mask:0xf
    v_mov_b32_dpp v101, v33 row_shl:1 row_mask:0xf bank_mask:0xf
    v_mov_b32_dpp v102, v34 row_shl:1 row_mask:0xf bank_mask:0xf
    v_mov_b32_dpp v103, v35 row_shl:1 row_mask:0xf bank_mask:0xf
    v_pk_add_f32 v[72:73], v[72:73], v[96:97]
    v_pk_add_f32 v[74:75], v[74:75], v[98:99]
    v_pk_add_f32 v[76:77], v[76:77], v[100:101]
    v_pk_add_f32 v[78:79], v[78:79], v[102:103]
    v_cvt_pk_bf16_f32 v52, v72, v76
    v_cvt_pk_bf16_f32 v53, v73, v77
    v_cvt_pk_bf16_f32 v54, v74, v78
    v_cvt_pk_bf16_f32 v55, v75, v79
    s_mov_b32 s44, 65536
    buffer_store_dwordx4 v[52:55], v122, s[16:19], s44 offen sc1
    s_waitcnt lgkmcnt(2)
    v_mov_b32_dpp v104, v4 row_shl:1 row_mask:0xf bank_mask:0xf
    v_mov_b32_dpp v105, v5 row_shl:1 row_mask:0xf bank_mask:0xf
    v_mov_b32_dpp v106, v6 row_shl:1 row_mask:0xf bank_mask:0xf
    v_mov_b32_dpp v107, v7 row_shl:1 row_mask:0xf bank_mask:0xf
    v_mov_b32_dpp v108, v36 row_shl:1 row_mask:0xf bank_mask:0xf
    v_mov_b32_dpp v109, v37 row_shl:1 row_mask:0xf bank_mask:0xf
    v_mov_b32_dpp v110, v38 row_shl:1 row_mask:0xf bank_mask:0xf
    v_mov_b32_dpp v111, v39 row_shl:1 row_mask:0xf bank_mask:0xf
    v_pk_add_f32 v[80:81], v[80:81], v[104:105]
    v_pk_add_f32 v[82:83], v[82:83], v[106:107]
    v_pk_add_f32 v[84:85], v[84:85], v[108:109]
    v_pk_add_f32 v[86:87], v[86:87], v[110:111]
    v_cvt_pk_bf16_f32 v56, v80, v84
    v_cvt_pk_bf16_f32 v57, v81, v85
    v_cvt_pk_bf16_f32 v58, v82, v86
    v_cvt_pk_bf16_f32 v59, v83, v87
    s_mov_b32 s44, 131072
    buffer_store_dwordx4 v[56:59], v122, s[16:19], s44 offen sc1
    s_waitcnt lgkmcnt(0)
    v_mov_b32_dpp v112, v8 row_shl:1 row_mask:0xf bank_mask:0xf
    v_mov_b32_dpp v113, v9 row_shl:1 row_mask:0xf bank_mask:0xf
    v_mov_b32_dpp v114, v10 row_shl:1 row_mask:0xf bank_mask:0xf
    v_mov_b32_dpp v115, v11 row_shl:1 row_mask:0xf bank_mask:0xf
    v_mov_b32_dpp v116, v40 row_shl:1 row_mask:0xf bank_mask:0xf
    v_mov_b32_dpp v117, v41 row_shl:1 row_mask:0xf bank_mask:0xf
    v_mov_b32_dpp v118, v42 row_shl:1 row_mask:0xf bank_mask:0xf
    v_mov_b32_dpp v119, v43 row_shl:1 row_mask:0xf bank_mask:0xf
    v_pk_add_f32 v[88:89], v[88:89], v[112:113]
    v_pk_add_f32 v[90:91], v[90:91], v[114:115]
    v_pk_add_f32 v[92:93], v[92:93], v[116:117]
    v_pk_add_f32 v[94:95], v[94:95], v[118:119]
    v_cvt_pk_bf16_f32 v60, v88, v92
    v_cvt_pk_bf16_f32 v61, v89, v93
    v_cvt_pk_bf16_f32 v62, v90, v94
    v_cvt_pk_bf16_f32 v63, v91, v95
    s_mov_b32 s44, 196608
    buffer_store_dwordx4 v[60:63], v122, s[16:19], s44 offen sc1
L_conv2_kernel_end:
L_conv2_kernel_done:
    s_endpgm
.globl joint_kernel
.p2align 8
.type joint_kernel,@function
joint_kernel:
    s_cmp_ge_u32 s2, 250
    s_cbranch_scc1 L_joint_kernel_done
    s_load_dwordx2 s[28:29], s[0:1], 56
    s_load_dwordx2 s[30:31], s[0:1], 72
    v_readfirstlane_b32 s20, v0
    s_lshr_b32 s20, s20, 6
    s_and_b32 s21, s20, 7
    v_and_b32 v127, 63, v0
    v_lshlrev_b32 v126, 4, v127
    s_cmp_ge_u32 s20, 8
    s_mov_b32 s33, 44171264
    s_cselect_b32 s33, 44040192, s33
    s_lshl_b32 s36, s21, 14
    s_add_u32 s33, s33, s36
    s_mov_b32 s14, 16384
    s_mov_b32 s15, 0x00020000
    s_lshl_b32 s35, s2, 9
    s_cmp_ge_u32 s2, 125
    s_cselect_b32 s36, 2033152, 0
    s_cselect_b32 s34, 8192, 0
    s_add_u32 s35, s35, s36
    s_add_u32 s34, s34, 44302336
    s_mov_b32 s10, 12582912
    s_mov_b32 s11, 0x00020000
    s_mov_b32 s42, 24576
    s_mov_b32 s43, 0x00020000
    s_cmp_ge_u32 s20, 8
    s_cbranch_scc1 L_joint_kernel_T
    v_lshrrev_b32 v124, 5, v127
    v_and_b32 v123, 0x1ff, v126
    v_mul_u32_u24 v125, 65536, v124
    v_add_u32 v123, v125, v123
    s_mul_i32 s36, s21, 262144
    s_add_u32 s36, s36, s35
    s_waitcnt lgkmcnt(0)
    s_add_u32 s8, s30, 27262976
    s_addc_u32 s9, s31, 0
    s_add_u32 s37, s36, 8388608
    buffer_load_dwordx4 v[64:67], v123, s[8:11], s36 offen
    buffer_load_dwordx4 v[72:75], v123, s[8:11], s37 offen
    s_add_u32 s36, s36, 131072
    s_add_u32 s37, s36, 8388608
    buffer_load_dwordx4 v[68:71], v123, s[8:11], s36 offen
    buffer_load_dwordx4 v[76:79], v123, s[8:11], s37 offen
    v_mov_b32 v0, 99456
    v_mov_b32 v2, 0
    v_mov_b32 v3, 0
    ds_write_b64 v0, v[2:3]
    s_add_u32 s12, s30, s33
    s_addc_u32 s13, s31, 0
    s_add_u32 s40, s30, s34
    s_addc_u32 s41, s31, 0
    s_lshl_b32 s38, s21, 10
    s_add_u32 s38, s38, 16384
    buffer_load_dwordx4 v[80:83], v126, s[40:43], s38 offen
    s_waitcnt lgkmcnt(0)
    s_barrier
    s_lshl_b32 s35, s2, 17
    s_add_u32 s16, s28, s35
    s_addc_u32 s17, s29, 0
    s_mov_b32 s18, 131072
    s_mov_b32 s19, 0x00020000
    s_mov_b32 s46, 0xbdd2d3e8
    s_mov_b32 s47, s46
    v_mov_b32 v120, 0xc0135761
    v_mov_b32 v121, v120
    s_mov_b32 s48, 1.0
    s_mov_b32 s49, 1.0
    v_bfe_u32 v123, v127, 2, 3
    v_lshl_add_u32 v124, v123, 2, v124
    v_mul_u32_u24 v124, 528, v124
    v_and_b32 v123, 0x30, v126
    s_lshl_b32 s36, s21, 6
    v_add3_u32 v124, v124, v123, s36
    s_mov_b32 s45, 0xffff0000
    s_mul_i32 s36, s21, 1040
    s_add_u32 s36, s36, 91136
    v_add_u32 v123, s36, v126
    s_mov_b32 s22, 2
    s_waitcnt vmcnt(3)
L_joint_kernel_floop:
    v_lshlrev_b32 v88, 16, v64
    v_and_b32 v89, s45, v64
    v_lshlrev_b32 v96, 16, v72
    v_and_b32 v97, s45, v72
    v_lshlrev_b32 v90, 16, v65
    v_and_b32 v91, s45, v65
    v_lshlrev_b32 v98, 16, v73
    v_and_b32 v99, s45, v73
    v_lshlrev_b32 v92, 16, v66
    v_and_b32 v93, s45, v66
    v_lshlrev_b32 v100, 16, v74
    v_and_b32 v101, s45, v74
    v_lshlrev_b32 v94, 16, v67
    v_and_b32 v95, s45, v67
    v_lshlrev_b32 v102, 16, v75
    v_and_b32 v103, s45, v75
    v_pk_add_f32 v[88:89], v[88:89], v[96:97]
    v_pk_add_f32 v[90:91], v[90:91], v[98:99]
    v_pk_add_f32 v[92:93], v[92:93], v[100:101]
    v_pk_add_f32 v[94:95], v[94:95], v[102:103]
    v_pk_mul_f32 v[96:97], v[88:89], v[88:89]
    v_pk_mul_f32 v[98:99], v[90:91], v[90:91]
    v_pk_mul_f32 v[100:101], v[92:93], v[92:93]
    v_pk_mul_f32 v[102:103], v[94:95], v[94:95]
    v_pk_fma_f32 v[96:97], v[96:97], s[46:47], v[120:121]
    v_pk_fma_f32 v[98:99], v[98:99], s[46:47], v[120:121]
    v_pk_fma_f32 v[100:101], v[100:101], s[46:47], v[120:121]
    v_pk_fma_f32 v[102:103], v[102:103], s[46:47], v[120:121]
    v_pk_mul_f32 v[96:97], v[96:97], v[88:89]
    v_pk_mul_f32 v[98:99], v[98:99], v[90:91]
    v_pk_mul_f32 v[100:101], v[100:101], v[92:93]
    v_pk_mul_f32 v[102:103], v[102:103], v[94:95]
    v_exp_f32 v96, v96
    v_exp_f32 v97, v97
    v_exp_f32 v98, v98
    v_exp_f32 v99, v99
    v_exp_f32 v100, v100
    v_exp_f32 v101, v101
    v_exp_f32 v102, v102
    v_exp_f32 v103, v103
    v_pk_add_f32 v[96:97], v[96:97], s[48:49]
    v_pk_add_f32 v[98:99], v[98:99], s[48:49]
    v_pk_add_f32 v[100:101], v[100:101], s[48:49]
    v_pk_add_f32 v[102:103], v[102:103], s[48:49]
    v_rcp_f32 v96, v96
    v_rcp_f32 v97, v97
    v_rcp_f32 v98, v98
    v_rcp_f32 v99, v99
    v_rcp_f32 v100, v100
    v_rcp_f32 v101, v101
    v_rcp_f32 v102, v102
    v_rcp_f32 v103, v103
    v_pk_mul_f32 v[88:89], v[88:89], v[96:97]
    v_pk_mul_f32 v[90:91], v[90:91], v[98:99]
    v_pk_mul_f32 v[92:93], v[92:93], v[100:101]
    v_pk_mul_f32 v[94:95], v[94:95], v[102:103]
    v_cvt_pk_bf16_f32 v104, v88, v89
    v_cvt_pk_bf16_f32 v105, v90, v91
    v_cvt_pk_bf16_f32 v106, v92, v93
    v_cvt_pk_bf16_f32 v107, v94, v95
    ds_write_b128 v124, v[104:107] offset:32768
    s_waitcnt vmcnt(0)
    v_pk_mov_b32 v[64:65], v[68:69], v[68:69] op_sel:[0,1]
    v_pk_mov_b32 v[72:73], v[76:77], v[76:77] op_sel:[0,1]
    v_pk_mov_b32 v[66:67], v[70:71], v[70:71] op_sel:[0,1]
    v_pk_mov_b32 v[74:75], v[78:79], v[78:79] op_sel:[0,1]
    v_add_u32 v124, 1056, v124
    s_sub_u32 s22, s22, 1
    s_cmp_lg_u32 s22, 0
    s_cbranch_scc1 L_joint_kernel_floop
    ds_write_b128 v123, v[80:83]
    s_waitcnt lgkmcnt(0)
    v_mov_b32 v120, 99456
    v_mov_b32 v121, 1
    s_mov_b64 exec, 1
    ds_add_u32 v120, v121 offset:0
    s_mov_b64 exec, -1
L_joint_kernel_ow:
    ds_read_b32 v121, v120 offset:4
    s_waitcnt lgkmcnt(0)
    v_readfirstlane_b32 s37, v121
    s_cmp_ge_u32 s37, 8
    s_cbranch_scc1 L_joint_kernel_ow_d
    s_sleep 1
    s_branch L_joint_kernel_ow
L_joint_kernel_ow_d:
    s_mov_b32 s36, 0
    buffer_load_dwordx4 v[0:3], v126, s[12:15], s36 offen offset:0
    buffer_load_dwordx4 v[4:7], v126, s[12:15], s36 offen offset:1024
    buffer_load_dwordx4 v[8:11], v126, s[12:15], s36 offen offset:2048
    buffer_load_dwordx4 v[12:15], v126, s[12:15], s36 offen offset:3072
    s_mov_b32 s36, 4096
    buffer_load_dwordx4 v[16:19], v126, s[12:15], s36 offen offset:0
    buffer_load_dwordx4 v[20:23], v126, s[12:15], s36 offen offset:1024
    buffer_load_dwordx4 v[24:27], v126, s[12:15], s36 offen offset:2048
    buffer_load_dwordx4 v[28:31], v126, s[12:15], s36 offen offset:3072
    s_mov_b32 s36, 8192
    buffer_load_dwordx4 v[32:35], v126, s[12:15], s36 offen offset:0
    buffer_load_dwordx4 v[36:39], v126, s[12:15], s36 offen offset:1024
    buffer_load_dwordx4 v[40:43], v126, s[12:15], s36 offen offset:2048
    buffer_load_dwordx4 v[44:47], v126, s[12:15], s36 offen offset:3072
    s_mov_b32 s36, 12288
    buffer_load_dwordx4 v[48:51], v126, s[12:15], s36 offen offset:0
    buffer_load_dwordx4 v[52:55], v126, s[12:15], s36 offen offset:1024
    buffer_load_dwordx4 v[56:59], v126, s[12:15], s36 offen offset:2048
    buffer_load_dwordx4 v[60:63], v126, s[12:15], s36 offen offset:3072
    v_lshrrev_b32 v125, 4, v127
    v_lshlrev_b32 v125, 11, v125
    v_and_b32 v124, 15, v127
    v_lshl_add_u32 v125, v124, 2, v125
    s_lshl_b32 s36, s21, 6
    v_add_u32 v125, s36, v125
    s_mov_b32 s44, 8192
    s_setprio 1
    s_barrier
    ds_read_b128 v[96:99], v126 offset:0
    ds_read_b128 v[100:103], v126 offset:1024
    ds_read_b128 v[104:107], v126 offset:2048
    ds_read_b128 v[108:111], v126 offset:3072
    s_waitcnt vmcnt(14) lgkmcnt(3)
    v_mfma_f32_16x16x32_bf16 v[64:67], v[96:99], v[0:3], 0
    v_mfma_f32_16x16x32_bf16 v[68:71], v[96:99], v[4:7], 0
    ds_read_b128 v[96:99], v126 offset:4096
    s_waitcnt lgkmcnt(3)
    v_mfma_f32_16x16x32_bf16 v[72:75], v[100:103], v[0:3], 0
    v_mfma_f32_16x16x32_bf16 v[76:79], v[100:103], v[4:7], 0
    ds_read_b128 v[100:103], v126 offset:5120
    s_waitcnt vmcnt(12) lgkmcnt(3)
    v_mfma_f32_16x16x32_bf16 v[64:67], v[104:107], v[8:11], v[64:67]
    v_mfma_f32_16x16x32_bf16 v[68:71], v[104:107], v[12:15], v[68:71]
    ds_read_b128 v[104:107], v126 offset:6144
    s_waitcnt lgkmcnt(3)
    v_mfma_f32_16x16x32_bf16 v[72:75], v[108:111], v[8:11], v[72:75]
    v_mfma_f32_16x16x32_bf16 v[76:79], v[108:111], v[12:15], v[76:79]
    ds_read_b128 v[108:111], v126 offset:7168
    s_waitcnt vmcnt(10) lgkmcnt(3)
    v_mfma_f32_16x16x32_bf16 v[64:67], v[96:99], v[16:19], v[64:67]
    v_mfma_f32_16x16x32_bf16 v[68:71], v[96:99], v[20:23], v[68:71]
    ds_read_b128 v[96:99], v126 offset:8192
    s_waitcnt lgkmcnt(3)
    v_mfma_f32_16x16x32_bf16 v[72:75], v[100:103], v[16:19], v[72:75]
    v_mfma_f32_16x16x32_bf16 v[76:79], v[100:103], v[20:23], v[76:79]
    ds_read_b128 v[100:103], v126 offset:9216
    s_waitcnt vmcnt(8) lgkmcnt(3)
    v_mfma_f32_16x16x32_bf16 v[64:67], v[104:107], v[24:27], v[64:67]
    v_mfma_f32_16x16x32_bf16 v[68:71], v[104:107], v[28:31], v[68:71]
    ds_read_b128 v[104:107], v126 offset:10240
    s_waitcnt lgkmcnt(3)
    v_mfma_f32_16x16x32_bf16 v[72:75], v[108:111], v[24:27], v[72:75]
    v_mfma_f32_16x16x32_bf16 v[76:79], v[108:111], v[28:31], v[76:79]
    ds_read_b128 v[108:111], v126 offset:11264
    s_waitcnt vmcnt(6) lgkmcnt(3)
    v_mfma_f32_16x16x32_bf16 v[64:67], v[96:99], v[32:35], v[64:67]
    v_mfma_f32_16x16x32_bf16 v[68:71], v[96:99], v[36:39], v[68:71]
    ds_read_b128 v[96:99], v126 offset:12288
    s_waitcnt lgkmcnt(3)
    v_mfma_f32_16x16x32_bf16 v[72:75], v[100:103], v[32:35], v[72:75]
    v_mfma_f32_16x16x32_bf16 v[76:79], v[100:103], v[36:39], v[76:79]
    ds_read_b128 v[100:103], v126 offset:13312
    s_waitcnt vmcnt(4) lgkmcnt(3)
    v_mfma_f32_16x16x32_bf16 v[64:67], v[104:107], v[40:43], v[64:67]
    v_mfma_f32_16x16x32_bf16 v[68:71], v[104:107], v[44:47], v[68:71]
    ds_read_b128 v[104:107], v126 offset:14336
    s_waitcnt lgkmcnt(3)
    v_mfma_f32_16x16x32_bf16 v[72:75], v[108:111], v[40:43], v[72:75]
    v_mfma_f32_16x16x32_bf16 v[76:79], v[108:111], v[44:47], v[76:79]
    ds_read_b128 v[108:111], v126 offset:15360
    s_waitcnt vmcnt(2) lgkmcnt(3)
    v_mfma_f32_16x16x32_bf16 v[64:67], v[96:99], v[48:51], v[64:67]
    v_mfma_f32_16x16x32_bf16 v[68:71], v[96:99], v[52:55], v[68:71]
    s_waitcnt lgkmcnt(0)
    s_barrier
    ds_read_b128 v[96:99], v126 offset:16384
    v_mfma_f32_16x16x32_bf16 v[72:75], v[100:103], v[48:51], v[72:75]
    v_mfma_f32_16x16x32_bf16 v[76:79], v[100:103], v[52:55], v[76:79]
    ds_read_b128 v[100:103], v126 offset:17408
    s_waitcnt vmcnt(0)
    v_mfma_f32_16x16x32_bf16 v[64:67], v[104:107], v[56:59], v[64:67]
    v_mfma_f32_16x16x32_bf16 v[68:71], v[104:107], v[60:63], v[68:71]
    ds_read_b128 v[104:107], v126 offset:18432
    v_mfma_f32_16x16x32_bf16 v[72:75], v[108:111], v[56:59], v[72:75]
    v_mfma_f32_16x16x32_bf16 v[76:79], v[108:111], v[60:63], v[76:79]
    ds_read_b128 v[108:111], v126 offset:19456
    s_mov_b32 s22, 4
L_joint_kernel_oloop:
    s_waitcnt lgkmcnt(3)
    v_mfma_f32_16x16x32_bf16 v[80:83], v[96:99], v[0:3], 0
    v_mfma_f32_16x16x32_bf16 v[84:87], v[96:99], v[4:7], 0
    ds_read_b128 v[96:99], v126 offset:20480
    s_waitcnt lgkmcnt(3)
    v_mfma_f32_16x16x32_bf16 v[88:91], v[100:103], v[0:3], 0
    v_mfma_f32_16x16x32_bf16 v[92:95], v[100:103], v[4:7], 0
    ds_read_b128 v[100:103], v126 offset:21504
    s_waitcnt lgkmcnt(3)
    v_mfma_f32_16x16x32_bf16 v[80:83], v[104:107], v[8:11], v[80:83]
    v_mfma_f32_16x16x32_bf16 v[84:87], v[104:107], v[12:15], v[84:87]
    ds_read_b128 v[104:107], v126 offset:22528
    s_waitcnt lgkmcnt(3)
    v_mfma_f32_16x16x32_bf16 v[88:91], v[108:111], v[8:11], v[88:91]
    v_cvt_pk_bf16_f32 v112, v64, v68
    v_mfma_f32_16x16x32_bf16 v[92:95], v[108:111], v[12:15], v[92:95]
    buffer_store_dword v112, v125, s[16:19], 0 offen offset:0 nt
    ds_read_b128 v[108:111], v126 offset:23552
    s_waitcnt lgkmcnt(3)
    v_mfma_f32_16x16x32_bf16 v[80:83], v[96:99], v[16:19], v[80:83]
    v_cvt_pk_bf16_f32 v113, v65, v69
    v_mfma_f32_16x16x32_bf16 v[84:87], v[96:99], v[20:23], v[84:87]
    buffer_store_dword v113, v125, s[16:19], 0 offen offset:512 nt
    ds_read_b128 v[96:99], v126 offset:24576
    s_waitcnt lgkmcnt(3)
    v_mfma_f32_16x16x32_bf16 v[88:91], v[100:103], v[16:19], v[88:91]
    v_cvt_pk_bf16_f32 v114, v66, v70
    v_mfma_f32_16x16x32_bf16 v[92:95], v[100:103], v[20:23], v[92:95]
    buffer_store_dword v114, v125, s[16:19], 0 offen offset:1024 nt
    ds_read_b128 v[100:103], v126 offset:25600
    s_waitcnt lgkmcnt(3)
    v_mfma_f32_16x16x32_bf16 v[80:83], v[104:107], v[24:27], v[80:83]
    v_cvt_pk_bf16_f32 v115, v67, v71
    v_mfma_f32_16x16x32_bf16 v[84:87], v[104:107], v[28:31], v[84:87]
    buffer_store_dword v115, v125, s[16:19], 0 offen offset:1536 nt
    ds_read_b128 v[104:107], v126 offset:26624
    s_waitcnt lgkmcnt(3)
    v_mfma_f32_16x16x32_bf16 v[88:91], v[108:111], v[24:27], v[88:91]
    v_cvt_pk_bf16_f32 v116, v72, v76
    v_mfma_f32_16x16x32_bf16 v[92:95], v[108:111], v[28:31], v[92:95]
    buffer_store_dword v116, v125, s[16:19], s44 offen offset:0 nt
    ds_read_b128 v[108:111], v126 offset:27648
    s_waitcnt lgkmcnt(3)
    v_mfma_f32_16x16x32_bf16 v[80:83], v[96:99], v[32:35], v[80:83]
    v_cvt_pk_bf16_f32 v117, v73, v77
    v_mfma_f32_16x16x32_bf16 v[84:87], v[96:99], v[36:39], v[84:87]
    buffer_store_dword v117, v125, s[16:19], s44 offen offset:512 nt
    ds_read_b128 v[96:99], v126 offset:28672
    s_waitcnt lgkmcnt(3)
    v_mfma_f32_16x16x32_bf16 v[88:91], v[100:103], v[32:35], v[88:91]
    v_cvt_pk_bf16_f32 v118, v74, v78
    v_mfma_f32_16x16x32_bf16 v[92:95], v[100:103], v[36:39], v[92:95]
    buffer_store_dword v118, v125, s[16:19], s44 offen offset:1024 nt
    ds_read_b128 v[100:103], v126 offset:29696
    s_waitcnt lgkmcnt(3)
    v_mfma_f32_16x16x32_bf16 v[80:83], v[104:107], v[40:43], v[80:83]
    v_cvt_pk_bf16_f32 v119, v75, v79
    v_mfma_f32_16x16x32_bf16 v[84:87], v[104:107], v[44:47], v[84:87]
    buffer_store_dword v119, v125, s[16:19], s44 offen offset:1536 nt
    ds_read_b128 v[104:107], v126 offset:30720
    s_waitcnt lgkmcnt(3)
    v_mfma_f32_16x16x32_bf16 v[88:91], v[108:111], v[40:43], v[88:91]
    v_add_u32 v125, 16384, v125
    v_mfma_f32_16x16x32_bf16 v[92:95], v[108:111], v[44:47], v[92:95]
    ds_read_b128 v[108:111], v126 offset:31744
    s_waitcnt lgkmcnt(3)
    v_mfma_f32_16x16x32_bf16 v[80:83], v[96:99], v[48:51], v[80:83]
    v_mfma_f32_16x16x32_bf16 v[84:87], v[96:99], v[52:55], v[84:87]
    s_waitcnt lgkmcnt(0)
    s_barrier
    ds_read_b128 v[96:99], v126 offset:0
    v_mfma_f32_16x16x32_bf16 v[88:91], v[100:103], v[48:51], v[88:91]
    v_mfma_f32_16x16x32_bf16 v[92:95], v[100:103], v[52:55], v[92:95]
    ds_read_b128 v[100:103], v126 offset:1024
    v_mfma_f32_16x16x32_bf16 v[80:83], v[104:107], v[56:59], v[80:83]
    v_mfma_f32_16x16x32_bf16 v[84:87], v[104:107], v[60:63], v[84:87]
    ds_read_b128 v[104:107], v126 offset:2048
    v_mfma_f32_16x16x32_bf16 v[88:91], v[108:111], v[56:59], v[88:91]
    v_mfma_f32_16x16x32_bf16 v[92:95], v[108:111], v[60:63], v[92:95]
    ds_read_b128 v[108:111], v126 offset:3072
    s_sub_u32 s22, s22, 1
    s_cmp_eq_u32 s22, 0
    s_cbranch_scc1 L_joint_kernel_oend
    s_waitcnt lgkmcnt(3)
    v_mfma_f32_16x16x32_bf16 v[64:67], v[96:99], v[0:3], 0
    v_mfma_f32_16x16x32_bf16 v[68:71], v[96:99], v[4:7], 0
    ds_read_b128 v[96:99], v126 offset:4096
    s_waitcnt lgkmcnt(3)
    v_mfma_f32_16x16x32_bf16 v[72:75], v[100:103], v[0:3], 0
    v_mfma_f32_16x16x32_bf16 v[76:79], v[100:103], v[4:7], 0
    ds_read_b128 v[100:103], v126 offset:5120
    s_waitcnt lgkmcnt(3)
    v_mfma_f32_16x16x32_bf16 v[64:67], v[104:107], v[8:11], v[64:67]
    v_mfma_f32_16x16x32_bf16 v[68:71], v[104:107], v[12:15], v[68:71]
    ds_read_b128 v[104:107], v126 offset:6144
    s_waitcnt lgkmcnt(3)
    v_mfma_f32_16x16x32_bf16 v[72:75], v[108:111], v[8:11], v[72:75]
    v_cvt_pk_bf16_f32 v112, v80, v84
    v_mfma_f32_16x16x32_bf16 v[76:79], v[108:111], v[12:15], v[76:79]
    buffer_store_dword v112, v125, s[16:19], 0 offen offset:0 nt
    ds_read_b128 v[108:111], v126 offset:7168
    s_waitcnt lgkmcnt(3)
    v_mfma_f32_16x16x32_bf16 v[64:67], v[96:99], v[16:19], v[64:67]
    v_cvt_pk_bf16_f32 v113, v81, v85
    v_mfma_f32_16x16x32_bf16 v[68:71], v[96:99], v[20:23], v[68:71]
    buffer_store_dword v113, v125, s[16:19], 0 offen offset:512 nt
    ds_read_b128 v[96:99], v126 offset:8192
    s_waitcnt lgkmcnt(3)
    v_mfma_f32_16x16x32_bf16 v[72:75], v[100:103], v[16:19], v[72:75]
    v_cvt_pk_bf16_f32 v114, v82, v86
    v_mfma_f32_16x16x32_bf16 v[76:79], v[100:103], v[20:23], v[76:79]
    buffer_store_dword v114, v125, s[16:19], 0 offen offset:1024 nt
    ds_read_b128 v[100:103], v126 offset:9216
    s_waitcnt lgkmcnt(3)
    v_mfma_f32_16x16x32_bf16 v[64:67], v[104:107], v[24:27], v[64:67]
    v_cvt_pk_bf16_f32 v115, v83, v87
    v_mfma_f32_16x16x32_bf16 v[68:71], v[104:107], v[28:31], v[68:71]
    buffer_store_dword v115, v125, s[16:19], 0 offen offset:1536 nt
    ds_read_b128 v[104:107], v126 offset:10240
    s_waitcnt lgkmcnt(3)
    v_mfma_f32_16x16x32_bf16 v[72:75], v[108:111], v[24:27], v[72:75]
    v_cvt_pk_bf16_f32 v116, v88, v92
    v_mfma_f32_16x16x32_bf16 v[76:79], v[108:111], v[28:31], v[76:79]
    buffer_store_dword v116, v125, s[16:19], s44 offen offset:0 nt
    ds_read_b128 v[108:111], v126 offset:11264
    s_waitcnt lgkmcnt(3)
    v_mfma_f32_16x16x32_bf16 v[64:67], v[96:99], v[32:35], v[64:67]
    v_cvt_pk_bf16_f32 v117, v89, v93
    v_mfma_f32_16x16x32_bf16 v[68:71], v[96:99], v[36:39], v[68:71]
    buffer_store_dword v117, v125, s[16:19], s44 offen offset:512 nt
    ds_read_b128 v[96:99], v126 offset:12288
    s_waitcnt lgkmcnt(3)
    v_mfma_f32_16x16x32_bf16 v[72:75], v[100:103], v[32:35], v[72:75]
    v_cvt_pk_bf16_f32 v118, v90, v94
    v_mfma_f32_16x16x32_bf16 v[76:79], v[100:103], v[36:39], v[76:79]
    buffer_store_dword v118, v125, s[16:19], s44 offen offset:1024 nt
    ds_read_b128 v[100:103], v126 offset:13312
    s_waitcnt lgkmcnt(3)
    v_mfma_f32_16x16x32_bf16 v[64:67], v[104:107], v[40:43], v[64:67]
    v_cvt_pk_bf16_f32 v119, v91, v95
    v_mfma_f32_16x16x32_bf16 v[68:71], v[104:107], v[44:47], v[68:71]
    buffer_store_dword v119, v125, s[16:19], s44 offen offset:1536 nt
    ds_read_b128 v[104:107], v126 offset:14336
    s_waitcnt lgkmcnt(3)
    v_mfma_f32_16x16x32_bf16 v[72:75], v[108:111], v[40:43], v[72:75]
    v_add_u32 v125, 16384, v125
    v_mfma_f32_16x16x32_bf16 v[76:79], v[108:111], v[44:47], v[76:79]
    ds_read_b128 v[108:111], v126 offset:15360
    s_waitcnt lgkmcnt(3)
    v_mfma_f32_16x16x32_bf16 v[64:67], v[96:99], v[48:51], v[64:67]
    v_mfma_f32_16x16x32_bf16 v[68:71], v[96:99], v[52:55], v[68:71]
    s_waitcnt lgkmcnt(0)
    s_barrier
    ds_read_b128 v[96:99], v126 offset:16384
    v_mfma_f32_16x16x32_bf16 v[72:75], v[100:103], v[48:51], v[72:75]
    v_mfma_f32_16x16x32_bf16 v[76:79], v[100:103], v[52:55], v[76:79]
    ds_read_b128 v[100:103], v126 offset:17408
    v_mfma_f32_16x16x32_bf16 v[64:67], v[104:107], v[56:59], v[64:67]
    v_mfma_f32_16x16x32_bf16 v[68:71], v[104:107], v[60:63], v[68:71]
    ds_read_b128 v[104:107], v126 offset:18432
    v_mfma_f32_16x16x32_bf16 v[72:75], v[108:111], v[56:59], v[72:75]
    v_mfma_f32_16x16x32_bf16 v[76:79], v[108:111], v[60:63], v[76:79]
    ds_read_b128 v[108:111], v126 offset:19456
    s_waitcnt vmcnt(32)
    s_branch L_joint_kernel_oloop
L_joint_kernel_oend:
    s_nop 7
    v_cvt_pk_bf16_f32 v112, v80, v84
    buffer_store_dword v112, v125, s[16:19], 0 offen offset:0 nt
    v_cvt_pk_bf16_f32 v113, v81, v85
    buffer_store_dword v113, v125, s[16:19], 0 offen offset:512 nt
    v_cvt_pk_bf16_f32 v114, v82, v86
    buffer_store_dword v114, v125, s[16:19], 0 offen offset:1024 nt
    v_cvt_pk_bf16_f32 v115, v83, v87
    buffer_store_dword v115, v125, s[16:19], 0 offen offset:1536 nt
    v_cvt_pk_bf16_f32 v116, v88, v92
    buffer_store_dword v116, v125, s[16:19], s44 offen offset:0 nt
    v_cvt_pk_bf16_f32 v117, v89, v93
    buffer_store_dword v117, v125, s[16:19], s44 offen offset:512 nt
    v_cvt_pk_bf16_f32 v118, v90, v94
    buffer_store_dword v118, v125, s[16:19], s44 offen offset:1024 nt
    v_cvt_pk_bf16_f32 v119, v91, v95
    buffer_store_dword v119, v125, s[16:19], s44 offen offset:1536 nt
    v_add_u32 v125, 16384, v125
    s_branch L_joint_kernel_fin
L_joint_kernel_T:
    s_setprio 3
    s_waitcnt lgkmcnt(0)
    s_add_u32 s12, s30, s33
    s_addc_u32 s13, s31, 0
    s_add_u32 s40, s30, s34
    s_addc_u32 s41, s31, 0
    s_lshl_b32 s36, s21, 2
    s_add_u32 s36, s36, 44335104
    s_add_u32 s36, s30, s36
    s_addc_u32 s37, s31, 0
    s_load_dword s44, s[36:37], 0
    v_and_b32 v123, 15, v127
    v_lshrrev_b32 v121, 4, v127
    v_mul_u32_u24 v125, 528, v123
    v_lshl_add_u32 v125, v121, 4, v125
    v_lshlrev_b32 v121, 5, v121
    v_and_b32 v120, 7, v127
    v_lshl_add_u32 v124, v120, 10, v121
    s_lshl_b32 s38, s21, 7
    v_mul_u32_u24 v120, 1040, v120
    s_add_u32 s36, s38, 91136
    v_add3_u32 v120, v120, v121, s36
    s_mul_i32 s36, s21, 5184
    s_add_u32 s36, s36, 49664
    v_add_u32 v121, s36, v121
    v_mul_u32_u24 v122, 144, v123
    v_add_u32 v122, v122, v121
    v_lshrrev_b32 v123, 3, v123
    v_mul_u32_u24 v123, 144, v123
    v_add_u32 v121, v123, v121
    s_lshl_b32 s36, s21, 11
    v_add_u32 v123, s36, v126
    s_barrier
    s_mov_b32 s36, 0
    buffer_load_dwordx4 v[0:3], v126, s[12:15], s36 offen offset:0
    buffer_load_dwordx4 v[4:7], v126, s[12:15], s36 offen offset:1024
    buffer_load_dwordx4 v[8:11], v126, s[12:15], s36 offen offset:2048
    buffer_load_dwordx4 v[12:15], v126, s[12:15], s36 offen offset:3072
    s_mov_b32 s36, 4096
    buffer_load_dwordx4 v[16:19], v126, s[12:15], s36 offen offset:0
    buffer_load_dwordx4 v[20:23], v126, s[12:15], s36 offen offset:1024
    buffer_load_dwordx4 v[24:27], v126, s[12:15], s36 offen offset:2048
    buffer_load_dwordx4 v[28:31], v126, s[12:15], s36 offen offset:3072
    s_mov_b32 s36, 8192
    buffer_load_dwordx4 v[32:35], v126, s[12:15], s36 offen offset:0
    buffer_load_dwordx4 v[36:39], v126, s[12:15], s36 offen offset:1024
    buffer_load_dwordx4 v[40:43], v126, s[12:15], s36 offen offset:2048
    buffer_load_dwordx4 v[44:47], v126, s[12:15], s36 offen offset:3072
    s_mov_b32 s36, 12288
    buffer_load_dwordx4 v[48:51], v126, s[12:15], s36 offen offset:0
    buffer_load_dwordx4 v[52:55], v126, s[12:15], s36 offen offset:1024
    buffer_load_dwordx4 v[56:59], v126, s[12:15], s36 offen offset:2048
    buffer_load_dwordx4 v[60:63], v126, s[12:15], s36 offen offset:3072
    v_mov_b32 v64, 99456
    v_mov_b32 v65, 1
    s_mov_b64 exec, 1
    ds_add_u32 v64, v65 offset:4
    s_mov_b64 exec, -1
L_joint_kernel_tw:
    ds_read_b32 v65, v64 offset:0
    s_waitcnt lgkmcnt(0)
    v_readfirstlane_b32 s37, v65
    s_cmp_ge_u32 s37, 8
    s_cbranch_scc1 L_joint_kernel_tw_d
    s_sleep 1
    s_branch L_joint_kernel_tw
L_joint_kernel_tw_d:
    ds_read_b128 v[80:83], v125 offset:32768
    ds_read_b128 v[84:87], v125 offset:41216
    ds_read_b128 v[88:91], v125 offset:32832
    ds_read_b128 v[92:95], v125 offset:41280
    ds_read_b128 v[96:99], v125 offset:32896
    ds_read_b128 v[100:103], v125 offset:41344
    ds_read_b128 v[104:107], v125 offset:32960
    ds_read_b128 v[108:111], v125 offset:41408
    s_setprio 0
    s_waitcnt vmcnt(14) lgkmcnt(7)
    v_mfma_f32_16x16x32_bf16 v[64:67], v[0:3], v[80:83], 0
    v_mfma_f32_16x16x32_bf16 v[68:71], v[4:7], v[80:83], 0
    ds_read_b128 v[80:83], v125 offset:33024
    s_waitcnt lgkmcnt(7)
    v_mfma_f32_16x16x32_bf16 v[72:75], v[0:3], v[84:87], 0
    v_mfma_f32_16x16x32_bf16 v[76:79], v[4:7], v[84:87], 0
    ds_read_b128 v[84:87], v125 offset:41472
    s_waitcnt vmcnt(12) lgkmcnt(7)
    v_mfma_f32_16x16x32_bf16 v[64:67], v[8:11], v[88:91], v[64:67]
    v_mfma_f32_16x16x32_bf16 v[68:71], v[12:15], v[88:91], v[68:71]
    ds_read_b128 v[88:91], v125 offset:33088
    s_waitcnt lgkmcnt(7)
    v_mfma_f32_16x16x32_bf16 v[72:75], v[8:11], v[92:95], v[72:75]
    v_mfma_f32_16x16x32_bf16 v[76:79], v[12:15], v[92:95], v[76:79]
    ds_read_b128 v[92:95], v125 offset:41536
    s_waitcnt vmcnt(10) lgkmcnt(7)
    v_mfma_f32_16x16x32_bf16 v[64:67], v[16:19], v[96:99], v[64:67]
    v_mfma_f32_16x16x32_bf16 v[68:71], v[20:23], v[96:99], v[68:71]
    ds_read_b128 v[96:99], v125 offset:33152
    s_waitcnt lgkmcnt(7)
    v_mfma_f32_16x16x32_bf16 v[72:75], v[16:19], v[100:103], v[72:75]
    v_mfma_f32_16x16x32_bf16 v[76:79], v[20:23], v[100:103], v[76:79]
    ds_read_b128 v[100:103], v125 offset:41600
    s_waitcnt vmcnt(8) lgkmcnt(7)
    v_mfma_f32_16x16x32_bf16 v[64:67], v[24:27], v[104:107], v[64:67]
    v_mfma_f32_16x16x32_bf16 v[68:71], v[28:31], v[104:107], v[68:71]
    ds_read_b128 v[104:107], v125 offset:33216
    s_waitcnt lgkmcnt(7)
    v_mfma_f32_16x16x32_bf16 v[72:75], v[24:27], v[108:111], v[72:75]
    v_mfma_f32_16x16x32_bf16 v[76:79], v[28:31], v[108:111], v[76:79]
    ds_read_b128 v[108:111], v125 offset:41664
    s_waitcnt vmcnt(6) lgkmcnt(7)
    v_mfma_f32_16x16x32_bf16 v[64:67], v[32:35], v[80:83], v[64:67]
    v_mfma_f32_16x16x32_bf16 v[68:71], v[36:39], v[80:83], v[68:71]
    ds_read_b128 v[112:115], v120 offset:0
    s_waitcnt lgkmcnt(7)
    v_mfma_f32_16x16x32_bf16 v[72:75], v[32:35], v[84:87], v[72:75]
    v_mfma_f32_16x16x32_bf16 v[76:79], v[36:39], v[84:87], v[76:79]
    ds_read_b128 v[116:119], v120 offset:16
    s_waitcnt vmcnt(4) lgkmcnt(7)
    v_mfma_f32_16x16x32_bf16 v[64:67], v[40:43], v[88:91], v[64:67]
    v_mfma_f32_16x16x32_bf16 v[68:71], v[44:47], v[88:91], v[68:71]
    s_waitcnt lgkmcnt(6)
    v_mfma_f32_16x16x32_bf16 v[72:75], v[40:43], v[92:95], v[72:75]
    v_mfma_f32_16x16x32_bf16 v[76:79], v[44:47], v[92:95], v[76:79]
    s_waitcnt vmcnt(2) lgkmcnt(5)
    v_mfma_f32_16x16x32_bf16 v[64:67], v[48:51], v[96:99], v[64:67]
    v_mfma_f32_16x16x32_bf16 v[68:71], v[52:55], v[96:99], v[68:71]
    s_waitcnt lgkmcnt(4)
    v_mfma_f32_16x16x32_bf16 v[72:75], v[48:51], v[100:103], v[72:75]
    v_mfma_f32_16x16x32_bf16 v[76:79], v[52:55], v[100:103], v[76:79]
    s_waitcnt vmcnt(0) lgkmcnt(3)
    v_mfma_f32_16x16x32_bf16 v[64:67], v[56:59], v[104:107], v[64:67]
    v_mfma_f32_16x16x32_bf16 v[68:71], v[60:63], v[104:107], v[68:71]
    s_waitcnt lgkmcnt(2)
    v_mfma_f32_16x16x32_bf16 v[72:75], v[56:59], v[108:111], v[72:75]
    v_mfma_f32_16x16x32_bf16 v[76:79], v[60:63], v[108:111], v[76:79]
    s_mov_b32 s46, 0xffff0000
    s_mov_b32 s48, 0x4038aa3b
    s_mov_b32 s49, s48
    s_nop 3
    v_mov_b32 v28, 0
    s_waitcnt lgkmcnt(0)
    v_cvt_pk_bf16_f32 v24, v64, v68
    v_cvt_pk_bf16_f32 v25, v65, v69
    v_cvt_pk_bf16_f32 v26, v66, v70
    v_cvt_pk_bf16_f32 v27, v67, v71
    v_lshlrev_b32 v80, 16, v24
    v_and_b32 v81, s46, v24
    v_lshlrev_b32 v82, 16, v25
    v_and_b32 v83, s46, v25
    v_lshlrev_b32 v84, 16, v26
    v_and_b32 v85, s46, v26
    v_lshlrev_b32 v86, 16, v27
    v_and_b32 v87, s46, v27
    v_pk_mul_f32 v[80:81], v[80:81], s[48:49]
    v_pk_mul_f32 v[82:83], v[82:83], s[48:49]
    v_pk_mul_f32 v[84:85], v[84:85], s[48:49]
    v_pk_mul_f32 v[86:87], v[86:87], s[48:49]
    v_exp_f32 v96, v80
    v_exp_f32 v97, v81
    v_exp_f32 v98, v82
    v_exp_f32 v99, v83
    v_max3_f32 v28, |v80|, |v81|, v28
    v_max3_f32 v28, |v82|, |v83|, v28
    ds_write_b128 v122, v[96:99] offset:0
    v_exp_f32 v100, v84
    v_exp_f32 v101, v85
    v_exp_f32 v102, v86
    v_exp_f32 v103, v87
    v_max3_f32 v28, |v84|, |v85|, v28
    v_max3_f32 v28, |v86|, |v87|, v28
    ds_write_b128 v122, v[100:103] offset:16
    v_cvt_pk_bf16_f32 v24, v72, v76
    v_cvt_pk_bf16_f32 v25, v73, v77
    v_cvt_pk_bf16_f32 v26, v74, v78
    v_cvt_pk_bf16_f32 v27, v75, v79
    v_lshlrev_b32 v88, 16, v24
    v_and_b32 v89, s46, v24
    v_lshlrev_b32 v90, 16, v25
    v_and_b32 v91, s46, v25
    v_lshlrev_b32 v92, 16, v26
    v_and_b32 v93, s46, v26
    v_lshlrev_b32 v94, 16, v27
    v_and_b32 v95, s46, v27
    v_pk_mul_f32 v[88:89], v[88:89], s[48:49]
    v_pk_mul_f32 v[90:91], v[90:91], s[48:49]
    v_pk_mul_f32 v[92:93], v[92:93], s[48:49]
    v_pk_mul_f32 v[94:95], v[94:95], s[48:49]
    v_exp_f32 v104, v88
    v_exp_f32 v105, v89
    v_exp_f32 v106, v90
    v_exp_f32 v107, v91
    v_max3_f32 v28, |v88|, |v89|, v28
    v_max3_f32 v28, |v90|, |v91|, v28
    ds_write_b128 v122, v[104:107] offset:2304
    v_exp_f32 v108, v92
    v_exp_f32 v109, v93
    v_exp_f32 v110, v94
    v_exp_f32 v111, v95
    v_max3_f32 v28, |v92|, |v93|, v28
    v_max3_f32 v28, |v94|, |v95|, v28
    ds_write_b128 v122, v[108:111] offset:2320
    v_cmp_lt_f32 vcc, 0x42f00000, v28
    s_mov_b32 s22, 4
    s_or_b32 s44, s44, vcc_lo
    s_or_b32 s44, s44, vcc_hi
    s_cmp_lg_u32 s44, 0
    s_cbranch_scc1 L_joint_kernel_tslow
    ds_read_b128 v[32:35], v121 offset:0
    ds_read_b128 v[36:39], v121 offset:16
    ds_read_b128 v[40:43], v121 offset:288
    ds_read_b128 v[44:47], v121 offset:304
    v_add_u32 v121, 576, v121
    s_waitcnt vmcnt(0) lgkmcnt(0)
L_joint_kernel_tloop1:
    v_fma_f32 v48, v112, v32, 1.0
    v_fma_f32 v49, v113, v33, 1.0
    v_fma_f32 v50, v114, v34, 1.0
    v_fma_f32 v51, v115, v35, 1.0
    v_fma_f32 v52, v116, v36, 1.0
    v_fma_f32 v53, v117, v37, 1.0
    v_fma_f32 v54, v118, v38, 1.0
    v_fma_f32 v55, v119, v39, 1.0
    v_fma_f32 v56, v112, v40, 1.0
    v_fma_f32 v57, v113, v41, 1.0
    v_fma_f32 v58, v114, v42, 1.0
    v_fma_f32 v59, v115, v43, 1.0
    v_fma_f32 v60, v116, v44, 1.0
    v_fma_f32 v61, v117, v45, 1.0
    v_fma_f32 v62, v118, v46, 1.0
    v_fma_f32 v63, v119, v47, 1.0
    ds_read_b128 v[32:35], v121 offset:0
    ds_read_b128 v[36:39], v121 offset:16
    ds_read_b128 v[40:43], v121 offset:288
    ds_read_b128 v[44:47], v121 offset:304
    v_add_u32 v121, 576, v121
    v_rcp_f32 v48, v48
    v_rcp_f32 v49, v49
    v_rcp_f32 v50, v50
    v_rcp_f32 v51, v51
    v_rcp_f32 v52, v52
    v_rcp_f32 v53, v53
    v_rcp_f32 v54, v54
    v_rcp_f32 v55, v55
    v_fma_f32 v48, v48, -2.0, 1.0
    v_fma_f32 v49, v49, -2.0, 1.0
    v_fma_f32 v50, v50, -2.0, 1.0
    v_fma_f32 v51, v51, -2.0, 1.0
    v_fma_f32 v52, v52, -2.0, 1.0
    v_fma_f32 v53, v53, -2.0, 1.0
    v_fma_f32 v54, v54, -2.0, 1.0
    v_fma_f32 v55, v55, -2.0, 1.0
    v_cvt_pk_bf16_f32 v64, v48, v49
    v_cvt_pk_bf16_f32 v65, v50, v51
    v_cvt_pk_bf16_f32 v66, v52, v53
    v_cvt_pk_bf16_f32 v67, v54, v55
    ds_write_b128 v123, v[64:67] offset:0
    v_rcp_f32 v56, v56
    v_rcp_f32 v57, v57
    v_rcp_f32 v58, v58
    v_rcp_f32 v59, v59
    v_rcp_f32 v60, v60
    v_rcp_f32 v61, v61
    v_rcp_f32 v62, v62
    v_rcp_f32 v63, v63
    v_fma_f32 v56, v56, -2.0, 1.0
    v_fma_f32 v57, v57, -2.0, 1.0
    v_fma_f32 v58, v58, -2.0, 1.0
    v_fma_f32 v59, v59, -2.0, 1.0
    v_fma_f32 v60, v60, -2.0, 1.0
    v_fma_f32 v61, v61, -2.0, 1.0
    v_fma_f32 v62, v62, -2.0, 1.0
    v_fma_f32 v63, v63, -2.0, 1.0
    v_cvt_pk_bf16_f32 v68, v56, v57
    v_cvt_pk_bf16_f32 v69, v58, v59
    v_cvt_pk_bf16_f32 v70, v60, v61
    v_cvt_pk_bf16_f32 v71, v62, v63
    ds_write_b128 v123, v[68:71] offset:1024
    s_waitcnt lgkmcnt(0)
    s_barrier
    v_fma_f32 v48, v112, v32, 1.0
    v_fma_f32 v49, v113, v33, 1.0
    v_fma_f32 v50, v114, v34, 1.0
    v_fma_f32 v51, v115, v35, 1.0
    v_fma_f32 v52, v116, v36, 1.0
    v_fma_f32 v53, v117, v37, 1.0
    v_fma_f32 v54, v118, v38, 1.0
    v_fma_f32 v55, v119, v39, 1.0
    v_fma_f32 v56, v112, v40, 1.0
    v_fma_f32 v57, v113, v41, 1.0
    v_fma_f32 v58, v114, v42, 1.0
    v_fma_f32 v59, v115, v43, 1.0
    v_fma_f32 v60, v116, v44, 1.0
    v_fma_f32 v61, v117, v45, 1.0
    v_fma_f32 v62, v118, v46, 1.0
    v_fma_f32 v63, v119, v47, 1.0
    ds_read_b128 v[32:35], v121 offset:0
    ds_read_b128 v[36:39], v121 offset:16
    ds_read_b128 v[40:43], v121 offset:288
    ds_read_b128 v[44:47], v121 offset:304
    v_add_u32 v121, 576, v121
    v_rcp_f32 v48, v48
    v_rcp_f32 v49, v49
    v_rcp_f32 v50, v50
    v_rcp_f32 v51, v51
    v_rcp_f32 v52, v52
    v_rcp_f32 v53, v53
    v_rcp_f32 v54, v54
    v_rcp_f32 v55, v55
    v_fma_f32 v48, v48, -2.0, 1.0
    v_fma_f32 v49, v49, -2.0, 1.0
    v_fma_f32 v50, v50, -2.0, 1.0
    v_fma_f32 v51, v51, -2.0, 1.0
    v_fma_f32 v52, v52, -2.0, 1.0
    v_fma_f32 v53, v53, -2.0, 1.0
    v_fma_f32 v54, v54, -2.0, 1.0
    v_fma_f32 v55, v55, -2.0, 1.0
    v_cvt_pk_bf16_f32 v64, v48, v49
    v_cvt_pk_bf16_f32 v65, v50, v51
    v_cvt_pk_bf16_f32 v66, v52, v53
    v_cvt_pk_bf16_f32 v67, v54, v55
    ds_write_b128 v123, v[64:67] offset:16384
    v_rcp_f32 v56, v56
    v_rcp_f32 v57, v57
    v_rcp_f32 v58, v58
    v_rcp_f32 v59, v59
    v_rcp_f32 v60, v60
    v_rcp_f32 v61, v61
    v_rcp_f32 v62, v62
    v_rcp_f32 v63, v63
    v_fma_f32 v56, v56, -2.0, 1.0
    v_fma_f32 v57, v57, -2.0, 1.0
    v_fma_f32 v58, v58, -2.0, 1.0
    v_fma_f32 v59, v59, -2.0, 1.0
    v_fma_f32 v60, v60, -2.0, 1.0
    v_fma_f32 v61, v61, -2.0, 1.0
    v_fma_f32 v62, v62, -2.0, 1.0
    v_fma_f32 v63, v63, -2.0, 1.0
    v_cvt_pk_bf16_f32 v68, v56, v57
    v_cvt_pk_bf16_f32 v69, v58, v59
    v_cvt_pk_bf16_f32 v70, v60, v61
    v_cvt_pk_bf16_f32 v71, v62, v63
    ds_write_b128 v123, v[68:71] offset:17408
    s_waitcnt lgkmcnt(0)
    s_barrier
    s_sub_u32 s22, s22, 1
    s_cmp_lg_u32 s22, 0
    s_cbranch_scc1 L_joint_kernel_tloop1
    s_branch L_joint_kernel_fin
L_joint_kernel_tslow:
    buffer_load_dwordx4 v[112:115], v124, s[40:43], s38 offen offset:0
    buffer_load_dwordx4 v[116:119], v124, s[40:43], s38 offen offset:16
    ds_write_b128 v122, v[80:83] offset:0
    ds_write_b128 v122, v[84:87] offset:16
    ds_write_b128 v122, v[88:91] offset:2304
    ds_write_b128 v122, v[92:95] offset:2320
    ds_read_b128 v[32:35], v121 offset:0
    ds_read_b128 v[36:39], v121 offset:16
    ds_read_b128 v[40:43], v121 offset:288
    ds_read_b128 v[44:47], v121 offset:304
    v_add_u32 v121, 576, v121
    s_waitcnt vmcnt(0) lgkmcnt(0)
L_joint_kernel_tloop0:
    v_add_f32 v48, v112, v32
    v_add_f32 v49, v113, v33
    v_add_f32 v50, v114, v34
    v_add_f32 v51, v115, v35
    v_add_f32 v52, v116, v36
    v_add_f32 v53, v117, v37
    v_add_f32 v54, v118, v38
    v_add_f32 v55, v119, v39
    v_add_f32 v56, v112, v40
    v_add_f32 v57, v113, v41
    v_add_f32 v58, v114, v42
    v_add_f32 v59, v115, v43
    v_add_f32 v60, v116, v44
    v_add_f32 v61, v117, v45
    v_add_f32 v62, v118, v46
    v_add_f32 v63, v119, v47
    ds_read_b128 v[32:35], v121 offset:0
    ds_read_b128 v[36:39], v121 offset:16
    ds_read_b128 v[40:43], v121 offset:288
    ds_read_b128 v[44:47], v121 offset:304
    v_add_u32 v121, 576, v121
    v_exp_f32 v48, v48
    v_exp_f32 v49, v49
    v_exp_f32 v50, v50
    v_exp_f32 v51, v51
    v_exp_f32 v52, v52
    v_exp_f32 v53, v53
    v_exp_f32 v54, v54
    v_exp_f32 v55, v55
    v_add_f32 v48, 1.0, v48
    v_add_f32 v49, 1.0, v49
    v_add_f32 v50, 1.0, v50
    v_add_f32 v51, 1.0, v51
    v_add_f32 v52, 1.0, v52
    v_add_f32 v53, 1.0, v53
    v_add_f32 v54, 1.0, v54
    v_add_f32 v55, 1.0, v55
    v_rcp_f32 v48, v48
    v_rcp_f32 v49, v49
    v_rcp_f32 v50, v50
    v_rcp_f32 v51, v51
    v_rcp_f32 v52, v52
    v_rcp_f32 v53, v53
    v_rcp_f32 v54, v54
    v_rcp_f32 v55, v55
    v_fma_f32 v48, v48, -2.0, 1.0
    v_fma_f32 v49, v49, -2.0, 1.0
    v_fma_f32 v50, v50, -2.0, 1.0
    v_fma_f32 v51, v51, -2.0, 1.0
    v_fma_f32 v52, v52, -2.0, 1.0
    v_fma_f32 v53, v53, -2.0, 1.0
    v_fma_f32 v54, v54, -2.0, 1.0
    v_fma_f32 v55, v55, -2.0, 1.0
    v_cvt_pk_bf16_f32 v64, v48, v49
    v_cvt_pk_bf16_f32 v65, v50, v51
    v_cvt_pk_bf16_f32 v66, v52, v53
    v_cvt_pk_bf16_f32 v67, v54, v55
    ds_write_b128 v123, v[64:67] offset:0
    v_exp_f32 v56, v56
    v_exp_f32 v57, v57
    v_exp_f32 v58, v58
    v_exp_f32 v59, v59
    v_exp_f32 v60, v60
    v_exp_f32 v61, v61
    v_exp_f32 v62, v62
    v_exp_f32 v63, v63
    v_add_f32 v56, 1.0, v56
    v_add_f32 v57, 1.0, v57
    v_add_f32 v58, 1.0, v58
    v_add_f32 v59, 1.0, v59
    v_add_f32 v60, 1.0, v60
    v_add_f32 v61, 1.0, v61
    v_add_f32 v62, 1.0, v62
    v_add_f32 v63, 1.0, v63
    v_rcp_f32 v56, v56
    v_rcp_f32 v57, v57
    v_rcp_f32 v58, v58
    v_rcp_f32 v59, v59
    v_rcp_f32 v60, v60
    v_rcp_f32 v61, v61
    v_rcp_f32 v62, v62
    v_rcp_f32 v63, v63
    v_fma_f32 v56, v56, -2.0, 1.0
    v_fma_f32 v57, v57, -2.0, 1.0
    v_fma_f32 v58, v58, -2.0, 1.0
    v_fma_f32 v59, v59, -2.0, 1.0
    v_fma_f32 v60, v60, -2.0, 1.0
    v_fma_f32 v61, v61, -2.0, 1.0
    v_fma_f32 v62, v62, -2.0, 1.0
    v_fma_f32 v63, v63, -2.0, 1.0
    v_cvt_pk_bf16_f32 v68, v56, v57
    v_cvt_pk_bf16_f32 v69, v58, v59
    v_cvt_pk_bf16_f32 v70, v60, v61
    v_cvt_pk_bf16_f32 v71, v62, v63
    ds_write_b128 v123, v[68:71] offset:1024
    s_waitcnt lgkmcnt(0)
    s_barrier
    v_add_f32 v48, v112, v32
    v_add_f32 v49, v113, v33
    v_add_f32 v50, v114, v34
    v_add_f32 v51, v115, v35
    v_add_f32 v52, v116, v36
    v_add_f32 v53, v117, v37
    v_add_f32 v54, v118, v38
    v_add_f32 v55, v119, v39
    v_add_f32 v56, v112, v40
    v_add_f32 v57, v113, v41
    v_add_f32 v58, v114, v42
    v_add_f32 v59, v115, v43
    v_add_f32 v60, v116, v44
    v_add_f32 v61, v117, v45
    v_add_f32 v62, v118, v46
    v_add_f32 v63, v119, v47
    ds_read_b128 v[32:35], v121 offset:0
    ds_read_b128 v[36:39], v121 offset:16
    ds_read_b128 v[40:43], v121 offset:288
    ds_read_b128 v[44:47], v121 offset:304
    v_add_u32 v121, 576, v121
    v_exp_f32 v48, v48
    v_exp_f32 v49, v49
    v_exp_f32 v50, v50
    v_exp_f32 v51, v51
    v_exp_f32 v52, v52
    v_exp_f32 v53, v53
    v_exp_f32 v54, v54
    v_exp_f32 v55, v55
    v_add_f32 v48, 1.0, v48
    v_add_f32 v49, 1.0, v49
    v_add_f32 v50, 1.0, v50
    v_add_f32 v51, 1.0, v51
    v_add_f32 v52, 1.0, v52
    v_add_f32 v53, 1.0, v53
    v_add_f32 v54, 1.0, v54
    v_add_f32 v55, 1.0, v55
    v_rcp_f32 v48, v48
    v_rcp_f32 v49, v49
    v_rcp_f32 v50, v50
    v_rcp_f32 v51, v51
    v_rcp_f32 v52, v52
    v_rcp_f32 v53, v53
    v_rcp_f32 v54, v54
    v_rcp_f32 v55, v55
    v_fma_f32 v48, v48, -2.0, 1.0
    v_fma_f32 v49, v49, -2.0, 1.0
    v_fma_f32 v50, v50, -2.0, 1.0
    v_fma_f32 v51, v51, -2.0, 1.0
    v_fma_f32 v52, v52, -2.0, 1.0
    v_fma_f32 v53, v53, -2.0, 1.0
    v_fma_f32 v54, v54, -2.0, 1.0
    v_fma_f32 v55, v55, -2.0, 1.0
    v_cvt_pk_bf16_f32 v64, v48, v49
    v_cvt_pk_bf16_f32 v65, v50, v51
    v_cvt_pk_bf16_f32 v66, v52, v53
    v_cvt_pk_bf16_f32 v67, v54, v55
    ds_write_b128 v123, v[64:67] offset:16384
    v_exp_f32 v56, v56
    v_exp_f32 v57, v57
    v_exp_f32 v58, v58
    v_exp_f32 v59, v59
    v_exp_f32 v60, v60
    v_exp_f32 v61, v61
    v_exp_f32 v62, v62
    v_exp_f32 v63, v63
    v_add_f32 v56, 1.0, v56
    v_add_f32 v57, 1.0, v57
    v_add_f32 v58, 1.0, v58
    v_add_f32 v59, 1.0, v59
    v_add_f32 v60, 1.0, v60
    v_add_f32 v61, 1.0, v61
    v_add_f32 v62, 1.0, v62
    v_add_f32 v63, 1.0, v63
    v_rcp_f32 v56, v56
    v_rcp_f32 v57, v57
    v_rcp_f32 v58, v58
    v_rcp_f32 v59, v59
    v_rcp_f32 v60, v60
    v_rcp_f32 v61, v61
    v_rcp_f32 v62, v62
    v_rcp_f32 v63, v63
    v_fma_f32 v56, v56, -2.0, 1.0
    v_fma_f32 v57, v57, -2.0, 1.0
    v_fma_f32 v58, v58, -2.0, 1.0
    v_fma_f32 v59, v59, -2.0, 1.0
    v_fma_f32 v60, v60, -2.0, 1.0
    v_fma_f32 v61, v61, -2.0, 1.0
    v_fma_f32 v62, v62, -2.0, 1.0
    v_fma_f32 v63, v63, -2.0, 1.0
    v_cvt_pk_bf16_f32 v68, v56, v57
    v_cvt_pk_bf16_f32 v69, v58, v59
    v_cvt_pk_bf16_f32 v70, v60, v61
    v_cvt_pk_bf16_f32 v71, v62, v63
    ds_write_b128 v123, v[68:71] offset:17408
    s_waitcnt lgkmcnt(0)
    s_barrier
    s_sub_u32 s22, s22, 1
    s_cmp_lg_u32 s22, 0
    s_cbranch_scc1 L_joint_kernel_tloop0
L_joint_kernel_fin:
L_joint_kernel_done:
    s_endpgm
.section .rodata,"a"
.p2align 6
.amdhsa_kernel prep_kernel
  .amdhsa_next_free_vgpr 128
  .amdhsa_next_free_sgpr 102
  .amdhsa_accum_offset 128
  .amdhsa_group_segment_fixed_size 0
  .amdhsa_kernarg_size 80
  .amdhsa_user_sgpr_count 2
  .amdhsa_user_sgpr_kernarg_segment_ptr 1
  .amdhsa_system_sgpr_workgroup_id_x 1
.end_amdhsa_kernel
.p2align 6
.amdhsa_kernel conv1_kernel
  .amdhsa_next_free_vgpr 128
  .amdhsa_next_free_sgpr 102
  .amdhsa_accum_offset 128
  .amdhsa_group_segment_fixed_size 0
  .amdhsa_kernarg_size 80
  .amdhsa_user_sgpr_count 2
  .amdhsa_user_sgpr_kernarg_segment_ptr 1
  .amdhsa_system_sgpr_workgroup_id_x 1
.end_amdhsa_kernel
.p2align 6
.amdhsa_kernel conv2_kernel
  .amdhsa_next_free_vgpr 128
  .amdhsa_next_free_sgpr 102
  .amdhsa_accum_offset 128
  .amdhsa_group_segment_fixed_size 0
  .amdhsa_kernarg_size 80
  .amdhsa_user_sgpr_count 2
  .amdhsa_user_sgpr_kernarg_segment_ptr 1
  .amdhsa_system_sgpr_workgroup_id_x 1
.end_amdhsa_kernel
.p2align 6
.amdhsa_kernel joint_kernel
  .amdhsa_next_free_vgpr 128
  .amdhsa_next_free_sgpr 102
  .amdhsa_accum_offset 128
  .amdhsa_group_segment_fixed_size 0
  .amdhsa_kernarg_size 80
  .amdhsa_user_sgpr_count 2
  .amdhsa_user_sgpr_kernarg_segment_ptr 1
  .amdhsa_system_sgpr_workgroup_id_x 1
.end_amdhsa_kernel
```

```asm
; @launch kernel=prep_kernel grid=(256,1,1) block=(384,1,1) lds=4096
; @launch kernel=conv1_kernel grid=(256,1,1) block=(1024,1,1) lds=162816
; @launch kernel=conv2_kernel grid=(256,1,1) block=(1024,1,1) lds=162816
; @launch kernel=joint_kernel grid=(250,1,1) block=(1024,1,1) lds=99472
.amdgcn_target "amdgcn-amd-amdhsa--gfx950"
.text
.globl prep_kernel
.p2align 8
.type prep_kernel,@function
prep_kernel:
    s_cmp_ge_u32 s2, 256
    s_cbranch_scc1 L_prep_kernel_done
    s_mov_b32 s3, s2
    s_load_dwordx16 s[44:59], s[0:1], 0
    s_load_dwordx2 s[30:31], s[0:1], 72
    v_readfirstlane_b32 s40, v0
    s_lshr_b32 s40, s40, 6
    v_and_b32 v1, 63, v0
    s_cmp_lt_u32 s40, 4
    s_cbranch_scc1 L_prep_kernel_w
    s_cmp_ge_u32 s2, 24
    s_cbranch_scc1 L_prep_kernel_done
    s_lshr_b32 s41, s2, 3
    s_and_b32 s42, s2, 7
    s_sub_u32 s43, s40, 4
    s_lshl_b32 s26, s43, 16
    s_lshl_b32 s5, s42, 6
    s_add_u32 s26, s26, s5
    s_mov_b32 s10, 131072
    s_mov_b32 s11, 0x00020000
    v_lshrrev_b32 v2, 4, v1
    v_lshlrev_b32 v2, 12, v2
    v_and_b32 v3, 15, v1
    v_lshl_add_u32 v2, v3, 2, v2
    v_mov_b32 v9, 0
    ds_write_b32 v9, v9 offset:2048
    s_waitcnt lgkmcnt(0)
    s_cmp_eq_u32 s41, 1
    s_cselect_b32 s8, s56, s52
    s_cselect_b32 s9, s57, s53
    s_cmp_eq_u32 s41, 2
    s_cselect_b32 s8, s54, s8
    s_cselect_b32 s9, s55, s9
    s_barrier
    s_cmp_lg_u32 s41, 2
    s_cbranch_scc1 L_prep_kernel_nog
    s_mov_b32 s16, s50
    s_mov_b32 s17, s51
    s_mov_b32 s18, 8192
    s_mov_b32 s19, 0x00020000
    v_and_b32 v6, 0x30, v1
    v_lshl_add_u32 v6, v3, 9, v6
    s_lshl_b32 s6, s43, 8
    buffer_load_dwordx4 v[80:83], v6, s[16:19], s6 offen offset:0
    buffer_load_dwordx4 v[84:87], v6, s[16:19], s6 offen offset:64
    buffer_load_dwordx4 v[88:91], v6, s[16:19], s6 offen offset:128
    buffer_load_dwordx4 v[92:95], v6, s[16:19], s6 offen offset:192
L_prep_kernel_nog:
    buffer_load_dword v16, v2, s[8:11], s26 offen offset:0
    buffer_load_dword v17, v2, s[8:11], s26 offen offset:512
    buffer_load_dword v18, v2, s[8:11], s26 offen offset:1024
    buffer_load_dword v19, v2, s[8:11], s26 offen offset:1536
    buffer_load_dword v20, v2, s[8:11], s26 offen offset:2048
    buffer_load_dword v21, v2, s[8:11], s26 offen offset:2560
    buffer_load_dword v22, v2, s[8:11], s26 offen offset:3072
    buffer_load_dword v23, v2, s[8:11], s26 offen offset:3584
    s_add_u32 s26, s26, 16384
    buffer_load_dword v24, v2, s[8:11], s26 offen offset:0
    buffer_load_dword v25, v2, s[8:11], s26 offen offset:512
    buffer_load_dword v26, v2, s[8:11], s26 offen offset:1024
    buffer_load_dword v27, v2, s[8:11], s26 offen offset:1536
    buffer_load_dword v28, v2, s[8:11], s26 offen offset:2048
    buffer_load_dword v29, v2, s[8:11], s26 offen offset:2560
    buffer_load_dword v30, v2, s[8:11], s26 offen offset:3072
    buffer_load_dword v31, v2, s[8:11], s26 offen offset:3584
    s_add_u32 s26, s26, 16384
    buffer_load_dword v32, v2, s[8:11], s26 offen offset:0
    buffer_load_dword v33, v2, s[8:11], s26 offen offset:512
    buffer_load_dword v34, v2, s[8:11], s26 offen offset:1024
    buffer_load_dword v35, v2, s[8:11], s26 offen offset:1536
    buffer_load_dword v36, v2, s[8:11], s26 offen offset:2048
    buffer_load_dword v37, v2, s[8:11], s26 offen offset:2560
    buffer_load_dword v38, v2, s[8:11], s26 offen offset:3072
    buffer_load_dword v39, v2, s[8:11], s26 offen offset:3584
    s_add_u32 s26, s26, 16384
    buffer_load_dword v40, v2, s[8:11], s26 offen offset:0
    buffer_load_dword v41, v2, s[8:11], s26 offen offset:512
    buffer_load_dword v42, v2, s[8:11], s26 offen offset:1024
    buffer_load_dword v43, v2, s[8:11], s26 offen offset:1536
    buffer_load_dword v44, v2, s[8:11], s26 offen offset:2048
    buffer_load_dword v45, v2, s[8:11], s26 offen offset:2560
    buffer_load_dword v46, v2, s[8:11], s26 offen offset:3072
    buffer_load_dword v47, v2, s[8:11], s26 offen offset:3584
    s_branch L_prep_kernel_small
L_prep_kernel_w:
    s_lshl_b32 s21, s2, 2
    s_add_u32 s20, s40, s21
    s_load_dwordx2 s[8:9], s[0:1], 8
    s_lshr_b32 s22, s20, 8
    s_bfe_u32 s23, s20, 0x40004
    s_bfe_u32 s24, s20, 0x30001
    s_and_b32 s21, s20, 1
    v_lshrrev_b32 v5, 4, v1
    v_lshlrev_b32 v2, 11, v5
    v_and_b32 v3, 15, v1
    v_lshl_add_u32 v2, v3, 2, v2
    s_lshl_b32 s26, s22, 3
    s_lshr_b32 s27, s23, 3
    s_add_u32 s26, s26, s27
    s_lshl_b32 s26, s26, 17
    s_and_b32 s27, s23, 7
    s_lshl_b32 s27, s27, 1
    s_add_u32 s27, s27, s21
    s_lshl_b32 s27, s27, 13
    s_add_u32 s26, s26, s27
    s_lshl_b32 s27, s24, 6
    s_add_u32 s26, s26, s27
    s_mov_b32 s10, 4063232
    s_mov_b32 s11, 0x00020000
    s_add_u32 s37, s26, 262144
    s_add_u32 s38, s26, 524288
    s_add_u32 s39, s26, 786432
    s_mov_b32 s14, 7340032
    s_mov_b32 s15, 0x00020000
    v_lshrrev_b32 v4, 1, v5
    v_lshlrev_b32 v4, 8, v4
    v_lshl_add_u32 v4, v3, 4, v4
    v_and_b32 v5, 1, v5
    v_lshl_add_u32 v4, v5, 10, v4
    s_lshl_b32 s27, s24, 4
    s_add_u32 s27, s27, s23
    s_mul_i32 s27, s27, 57344
    s_lshl_b32 s28, s22, 11
    s_add_u32 s27, s27, s28
    s_lshl_b32 s28, s21, 9
    s_add_u32 s27, s27, s28
    s_mov_b32 s32, 0x05040100
    s_mov_b32 s33, 0x07060302
    s_mov_b32 s34, 0xffff0000
    s_mov_b32 s35, 0x3d2aaaab
    s_mov_b32 s40, 0x3c638e39
    s_waitcnt lgkmcnt(0)
    buffer_load_dword v16, v2, s[8:11], s26 offen offset:0
    buffer_load_dword v17, v2, s[8:11], s26 offen offset:512
    buffer_load_dword v20, v2, s[8:11], s37 offen offset:0
    buffer_load_dword v21, v2, s[8:11], s37 offen offset:512
    buffer_load_dword v24, v2, s[8:11], s38 offen offset:0
    buffer_load_dword v25, v2, s[8:11], s38 offen offset:512
    buffer_load_dword v28, v2, s[8:11], s39 offen offset:0
    buffer_load_dword v29, v2, s[8:11], s39 offen offset:512
    buffer_load_dword v18, v2, s[8:11], s26 offen offset:1024
    buffer_load_dword v19, v2, s[8:11], s26 offen offset:1536
    buffer_load_dword v22, v2, s[8:11], s37 offen offset:1024
    buffer_load_dword v23, v2, s[8:11], s37 offen offset:1536
    buffer_load_dword v26, v2, s[8:11], s38 offen offset:1024
    buffer_load_dword v27, v2, s[8:11], s38 offen offset:1536
    buffer_load_dword v30, v2, s[8:11], s39 offen offset:1024
    buffer_load_dword v31, v2, s[8:11], s39 offen offset:1536
    s_barrier
    s_add_u32 s12, s30, 0
    s_addc_u32 s13, s31, 0
    s_waitcnt vmcnt(8)
    v_perm_b32 v100, v17, v16, s32
    v_perm_b32 v76, v29, v28, s32
    v_lshlrev_b32 v104, 16, v28
    v_lshlrev_b32 v112, 16, v29
    v_lshlrev_b32 v105, 16, v24
    v_lshlrev_b32 v113, 16, v25
    v_lshlrev_b32 v106, 16, v20
    v_lshlrev_b32 v114, 16, v21
    v_lshlrev_b32 v107, 16, v16
    v_lshlrev_b32 v115, 16, v17
    v_add_f32 v108, v104, v106
    v_add_f32 v116, v112, v114
    v_add_f32 v109, v105, v107
    v_add_f32 v117, v113, v115
    v_fma_f32 v110, v106, 4.0, v104
    v_fma_f32 v118, v114, 4.0, v112
    v_fma_f32 v111, v107, 4.0, v105
    v_fma_f32 v119, v115, 4.0, v113
    v_add_f32 v105, v108, v109
    v_add_f32 v113, v116, v117
    v_sub_f32 v106, v108, v109
    v_sub_f32 v114, v116, v117
    v_fma_f32 v107, v111, 2.0, v110
    v_fma_f32 v115, v119, 2.0, v118
    v_fma_f32 v110, v111, -2.0, v110
    v_fma_f32 v118, v119, -2.0, v118
    v_fmamk_f32 v108, v104, 0x41700000, v110
    v_fmamk_f32 v116, v112, 0x41700000, v118
    v_fmamk_f32 v108, v109, 0x41200000, v108
    v_fmamk_f32 v116, v117, 0x41200000, v116
    v_mul_f32 v105, 0.5, v105
    v_mul_f32 v113, 0.5, v113
    v_mul_f32 v106, 0.5, v106
    v_mul_f32 v114, 0.5, v114
    v_mul_f32 v107, s35, v107
    v_mul_f32 v115, s35, v115
    v_mul_f32 v110, s35, v110
    v_mul_f32 v118, s35, v118
    v_mul_f32 v108, s40, v108
    v_mul_f32 v116, s40, v116
    v_cvt_pk_bf16_f32 v80, v105, v113
    v_cvt_pk_bf16_f32 v84, v106, v114
    v_cvt_pk_bf16_f32 v88, v107, v115
    v_cvt_pk_bf16_f32 v92, v110, v118
    v_cvt_pk_bf16_f32 v96, v108, v116
    v_perm_b32 v102, v17, v16, s33
    v_perm_b32 v78, v29, v28, s33
    v_and_b32 v104, s34, v28
    v_and_b32 v112, s34, v29
    v_and_b32 v105, s34, v24
    v_and_b32 v113, s34, v25
    v_and_b32 v106, s34, v20
    v_and_b32 v114, s34, v21
    v_and_b32 v107, s34, v16
    v_and_b32 v115, s34, v17
    v_add_f32 v108, v104, v106
    v_add_f32 v116, v112, v114
    v_add_f32 v109, v105, v107
    v_add_f32 v117, v113, v115
    v_fma_f32 v110, v106, 4.0, v104
    v_fma_f32 v118, v114, 4.0, v112
    v_fma_f32 v111, v107, 4.0, v105
    v_fma_f32 v119, v115, 4.0, v113
    v_add_f32 v105, v108, v109
    v_add_f32 v113, v116, v117
    v_sub_f32 v106, v108, v109
    v_sub_f32 v114, v116, v117
    v_fma_f32 v107, v111, 2.0, v110
    v_fma_f32 v115, v119, 2.0, v118
    v_fma_f32 v110, v111, -2.0, v110
    v_fma_f32 v118, v119, -2.0, v118
    v_fmamk_f32 v108, v104, 0x41700000, v110
    v_fmamk_f32 v116, v112, 0x41700000, v118
    v_fmamk_f32 v108, v109, 0x41200000, v108
    v_fmamk_f32 v116, v117, 0x41200000, v116
    v_mul_f32 v105, 0.5, v105
    v_mul_f32 v113, 0.5, v113
    v_mul_f32 v106, 0.5, v106
    v_mul_f32 v114, 0.5, v114
    v_mul_f32 v107, s35, v107
    v_mul_f32 v115, s35, v115
    v_mul_f32 v110, s35, v110
    v_mul_f32 v118, s35, v118
    v_mul_f32 v108, s40, v108
    v_mul_f32 v116, s40, v116
    v_cvt_pk_bf16_f32 v82, v105, v113
    v_cvt_pk_bf16_f32 v86, v106, v114
    v_cvt_pk_bf16_f32 v90, v107, v115
    v_cvt_pk_bf16_f32 v94, v110, v118
    v_cvt_pk_bf16_f32 v98, v108, v116
    s_waitcnt vmcnt(0)
    s_cmp_lt_u32 s3, 224
    s_cbranch_scc1 L_prep_kernel_ncw
    s_getpc_b64 s[62:63]
L_prep_kernel_pc:
    s_and_b32 s64, s3, 8
    s_lshl_b32 s64, s64, 12
    v_lshlrev_b32 v120, 7, v0
    v_add_u32 v120, s64, v120
    v_min_u32 v120, L_joint_kernel_done-L_prep_kernel_pc, v120
    v_mov_b32 v121, s63
    v_add_co_u32 v120, vcc, s62, v120
    s_nop 1
    v_addc_co_u32 v121, vcc, 0, v121, vcc
    global_load_dword v122, v[120:121], off
L_prep_kernel_ncw:
    v_perm_b32 v101, v19, v18, s32
    v_perm_b32 v77, v31, v30, s32
    v_lshlrev_b32 v104, 16, v30
    v_lshlrev_b32 v112, 16, v31
    v_lshlrev_b32 v105, 16, v26
    v_lshlrev_b32 v113, 16, v27
    v_lshlrev_b32 v106, 16, v22
    v_lshlrev_b32 v114, 16, v23
    v_lshlrev_b32 v107, 16, v18
    v_lshlrev_b32 v115, 16, v19
    v_add_f32 v108, v104, v106
    v_add_f32 v116, v112, v114
    v_add_f32 v109, v105, v107
    v_add_f32 v117, v113, v115
    v_fma_f32 v110, v106, 4.0, v104
    v_fma_f32 v118, v114, 4.0, v112
    v_fma_f32 v111, v107, 4.0, v105
    v_fma_f32 v119, v115, 4.0, v113
    v_add_f32 v105, v108, v109
    v_add_f32 v113, v116, v117
    v_sub_f32 v106, v108, v109
    v_sub_f32 v114, v116, v117
    v_fma_f32 v107, v111, 2.0, v110
    v_fma_f32 v115, v119, 2.0, v118
    v_fma_f32 v110, v111, -2.0, v110
    v_fma_f32 v118, v119, -2.0, v118
    v_fmamk_f32 v108, v104, 0x41700000, v110
    v_fmamk_f32 v116, v112, 0x41700000, v118
    v_fmamk_f32 v108, v109, 0x41200000, v108
    v_fmamk_f32 v116, v117, 0x41200000, v116
    v_mul_f32 v105, 0.5, v105
    v_mul_f32 v113, 0.5, v113
    v_mul_f32 v106, 0.5, v106
    v_mul_f32 v114, 0.5, v114
    v_mul_f32 v107, s35, v107
    v_mul_f32 v115, s35, v115
    v_mul_f32 v110, s35, v110
    v_mul_f32 v118, s35, v118
    v_mul_f32 v108, s40, v108
    v_mul_f32 v116, s40, v116
    v_cvt_pk_bf16_f32 v81, v105, v113
    v_cvt_pk_bf16_f32 v85, v106, v114
    v_cvt_pk_bf16_f32 v89, v107, v115
    v_cvt_pk_bf16_f32 v93, v110, v118
    v_cvt_pk_bf16_f32 v97, v108, v116
    v_perm_b32 v103, v19, v18, s33
    v_perm_b32 v79, v31, v30, s33
    v_and_b32 v104, s34, v30
    v_and_b32 v112, s34, v31
    v_and_b32 v105, s34, v26
    v_and_b32 v113, s34, v27
    v_and_b32 v106, s34, v22
    v_and_b32 v114, s34, v23
    v_and_b32 v107, s34, v18
    v_and_b32 v115, s34, v19
    v_add_f32 v108, v104, v106
    v_add_f32 v116, v112, v114
    v_add_f32 v109, v105, v107
    v_add_f32 v117, v113, v115
    v_fma_f32 v110, v106, 4.0, v104
    v_fma_f32 v118, v114, 4.0, v112
    v_fma_f32 v111, v107, 4.0, v105
    v_fma_f32 v119, v115, 4.0, v113
    v_add_f32 v105, v108, v109
    v_add_f32 v113, v116, v117
    v_sub_f32 v106, v108, v109
    v_sub_f32 v114, v116, v117
    v_fma_f32 v107, v111, 2.0, v110
    v_fma_f32 v115, v119, 2.0, v118
    v_fma_f32 v110, v111, -2.0, v110
    v_fma_f32 v118, v119, -2.0, v118
    v_fmamk_f32 v108, v104, 0x41700000, v110
    v_fmamk_f32 v116, v112, 0x41700000, v118
    v_fmamk_f32 v108, v109, 0x41200000, v108
    v_fmamk_f32 v116, v117, 0x41200000, v116
    v_mul_f32 v105, 0.5, v105
    v_mul_f32 v113, 0.5, v113
    v_mul_f32 v106, 0.5, v106
    v_mul_f32 v114, 0.5, v114
    v_mul_f32 v107, s35, v107
    v_mul_f32 v115, s35, v115
    v_mul_f32 v110, s35, v110
    v_mul_f32 v118, s35, v118
    v_mul_f32 v108, s40, v108
    v_mul_f32 v116, s40, v116
    v_cvt_pk_bf16_f32 v83, v105, v113
    v_cvt_pk_bf16_f32 v87, v106, v114
    v_cvt_pk_bf16_f32 v91, v107, v115
    v_cvt_pk_bf16_f32 v95, v110, v118
    v_cvt_pk_bf16_f32 v99, v108, v116
    v_permlane16_swap_b32 v100, v102
    v_permlane16_swap_b32 v101, v103
    s_add_u32 s28, s27, 49152
    buffer_store_dwordx4 v[100:103], v4, s[12:15], s28 offen sc1
    v_permlane16_swap_b32 v76, v78
    v_permlane16_swap_b32 v77, v79
    s_add_u32 s28, s27, 0
    buffer_store_dwordx4 v[76:79], v4, s[12:15], s28 offen sc1
    v_permlane16_swap_b32 v80, v82
    v_permlane16_swap_b32 v81, v83
    s_add_u32 s28, s27, 8192
    buffer_store_dwordx4 v[80:83], v4, s[12:15], s28 offen sc1
    v_permlane16_swap_b32 v84, v86
    v_permlane16_swap_b32 v85, v87
    s_add_u32 s28, s27, 16384
    buffer_store_dwordx4 v[84:87], v4, s[12:15], s28 offen sc1
    v_permlane16_swap_b32 v88, v90
    v_permlane16_swap_b32 v89, v91
    s_add_u32 s28, s27, 24576
    buffer_store_dwordx4 v[88:91], v4, s[12:15], s28 offen sc1
    v_permlane16_swap_b32 v92, v94
    v_permlane16_swap_b32 v93, v95
    s_add_u32 s28, s27, 32768
    buffer_store_dwordx4 v[92:95], v4, s[12:15], s28 offen sc1
    v_permlane16_swap_b32 v96, v98
    v_permlane16_swap_b32 v97, v99
    s_add_u32 s28, s27, 40960
    buffer_store_dwordx4 v[96:99], v4, s[12:15], s28 offen sc1
L_prep_kernel_done:
    s_endpgm
L_prep_kernel_small:
    v_lshrrev_b32 v2, 4, v1
    s_lshl_b32 s24, s41, 17
    s_add_u32 s24, s24, 44040192
    s_add_u32 s12, s30, s24
    s_addc_u32 s13, s31, 0
    s_mov_b32 s14, 131072
    s_mov_b32 s15, 0x00020000
    s_mov_b32 s32, 0x05040100
    s_mov_b32 s33, 0x07060302
    v_lshlrev_b32 v4, 4, v1
    s_lshl_b32 s24, s42, 14
    s_lshl_b32 s25, s43, 13
    s_add_u32 s24, s24, s25
    s_add_u32 s25, s24, 4096
    s_waitcnt vmcnt(0)
    v_perm_b32 v48, v17, v16, s32
    v_perm_b32 v49, v19, v18, s32
    v_perm_b32 v50, v21, v20, s32
    v_perm_b32 v51, v23, v22, s32
    v_perm_b32 v52, v17, v16, s33
    v_perm_b32 v53, v19, v18, s33
    v_perm_b32 v54, v21, v20, s33
    v_perm_b32 v55, v23, v22, s33
    v_perm_b32 v56, v25, v24, s32
    v_perm_b32 v57, v27, v26, s32
    v_perm_b32 v58, v29, v28, s32
    v_perm_b32 v59, v31, v30, s32
    v_perm_b32 v60, v25, v24, s33
    v_perm_b32 v61, v27, v26, s33
    v_perm_b32 v62, v29, v28, s33
    v_perm_b32 v63, v31, v30, s33
    v_perm_b32 v64, v33, v32, s32
    v_perm_b32 v65, v35, v34, s32
    v_perm_b32 v66, v37, v36, s32
    v_perm_b32 v67, v39, v38, s32
    v_perm_b32 v68, v33, v32, s33
    v_perm_b32 v69, v35, v34, s33
    v_perm_b32 v70, v37, v36, s33
    v_perm_b32 v71, v39, v38, s33
    v_perm_b32 v72, v41, v40, s32
    v_perm_b32 v73, v43, v42, s32
    v_perm_b32 v74, v45, v44, s32
    v_perm_b32 v75, v47, v46, s32
    v_perm_b32 v76, v41, v40, s33
    v_perm_b32 v77, v43, v42, s33
    v_perm_b32 v78, v45, v44, s33
    v_perm_b32 v79, v47, v46, s33
    s_cmp_eq_u32 s41, 2
    s_cbranch_scc1 L_prep_kernel_ge
    buffer_store_dwordx4 v[48:51], v4, s[12:15], s24 offen offset:0 sc1
    buffer_store_dwordx4 v[52:55], v4, s[12:15], s24 offen offset:1024 sc1
    buffer_store_dwordx4 v[56:59], v4, s[12:15], s24 offen offset:2048 sc1
    buffer_store_dwordx4 v[60:63], v4, s[12:15], s24 offen offset:3072 sc1
    buffer_store_dwordx4 v[64:67], v4, s[12:15], s25 offen offset:0 sc1
    buffer_store_dwordx4 v[68:71], v4, s[12:15], s25 offen offset:1024 sc1
    buffer_store_dwordx4 v[72:75], v4, s[12:15], s25 offen offset:2048 sc1
    buffer_store_dwordx4 v[76:79], v4, s[12:15], s25 offen offset:3072 sc1
    s_endpgm
L_prep_kernel_ge:
    v_mfma_f32_16x16x32_bf16 v[96:99], v[48:51], v[80:83], 0
    v_mfma_f32_16x16x32_bf16 v[100:103], v[52:55], v[80:83], 0
    v_mfma_f32_16x16x32_bf16 v[96:99], v[56:59], v[84:87], v[96:99]
    v_mfma_f32_16x16x32_bf16 v[100:103], v[60:63], v[84:87], v[100:103]
    v_mfma_f32_16x16x32_bf16 v[96:99], v[64:67], v[88:91], v[96:99]
    v_mfma_f32_16x16x32_bf16 v[100:103], v[68:71], v[88:91], v[100:103]
    v_mfma_f32_16x16x32_bf16 v[96:99], v[72:75], v[92:95], v[96:99]
    v_mfma_f32_16x16x32_bf16 v[100:103], v[76:79], v[92:95], v[100:103]
    v_mov_b32 v7, v4
    v_mov_b32 v10, 1
    s_nop 0
    s_mov_b32 s14, 16384
    v_lshlrev_b32 v8, 10, v3
    v_lshl_add_u32 v8, v2, 5, v8
    s_lshl_b32 s24, s42, 7
    s_mov_b32 s34, 0xffff0000
    s_mov_b32 s35, 0x4038aa3b
    s_cmp_eq_u32 s43, 0
    s_cbranch_scc1 L_prep_kernel_ge0
    ds_write_b128 v7, v[96:99]
    ds_write_b128 v7, v[100:103] offset:1024
    ds_write_b32 v9, v10 offset:2048
    s_endpgm
L_prep_kernel_ge0:
    ds_read_b32 v10, v9 offset:2048
    s_waitcnt lgkmcnt(0)
    v_readfirstlane_b32 s27, v10
    s_cmp_eq_u32 s27, 0
    s_cbranch_scc1 L_prep_kernel_ge0
    ds_read_b128 v[16:19], v7
    ds_read_b128 v[20:23], v7 offset:1024
    s_waitcnt lgkmcnt(0)
    v_add_f32 v16, v16, v96
    v_add_f32 v17, v17, v97
    v_add_f32 v18, v18, v98
    v_add_f32 v19, v19, v99
    v_add_f32 v20, v20, v100
    v_add_f32 v21, v21, v101
    v_add_f32 v22, v22, v102
    v_add_f32 v23, v23, v103
    v_cvt_pk_bf16_f32 v48, v16, v20
    v_cvt_pk_bf16_f32 v49, v17, v21
    v_cvt_pk_bf16_f32 v50, v18, v22
    v_cvt_pk_bf16_f32 v51, v19, v23
    v_lshlrev_b32 v56, 16, v48
    v_and_b32 v57, s34, v48
    v_lshlrev_b32 v58, 16, v49
    v_and_b32 v59, s34, v49
    v_lshlrev_b32 v60, 16, v50
    v_and_b32 v61, s34, v50
    v_lshlrev_b32 v62, 16, v51
    v_and_b32 v63, s34, v51
    v_mul_f32 v56, s35, v56
    v_mul_f32 v57, s35, v57
    v_mul_f32 v58, s35, v58
    v_mul_f32 v59, s35, v59
    v_mul_f32 v60, s35, v60
    v_mul_f32 v61, s35, v61
    v_mul_f32 v62, s35, v62
    v_mul_f32 v63, s35, v63
    buffer_store_dwordx4 v[56:59], v8, s[12:15], s24 offen sc1
    buffer_store_dwordx4 v[60:63], v8, s[12:15], s24 offen offset:16 sc1
    v_exp_f32 v64, v56
    v_exp_f32 v65, v57
    v_exp_f32 v66, v58
    v_exp_f32 v67, v59
    v_exp_f32 v68, v60
    v_exp_f32 v69, v61
    v_exp_f32 v70, v62
    v_exp_f32 v71, v63
    v_max3_f32 v72, |v56|, |v57|, |v58|
    v_max3_f32 v72, |v59|, |v60|, v72
    v_max3_f32 v72, |v61|, |v62|, v72
    v_max_f32 v72, |v63|, v72
    s_add_u32 s12, s12, 16384
    s_addc_u32 s13, s13, 0
    v_cmp_lt_f32 vcc, 0x42f00000, v72
    buffer_store_dwordx4 v[64:67], v8, s[12:15], s24 offen sc1
    buffer_store_dwordx4 v[68:71], v8, s[12:15], s24 offen offset:16 sc1
    s_add_u32 s12, s12, 16384
    s_addc_u32 s13, s13, 0
    s_or_b32 s26, vcc_lo, vcc_hi
    s_lshl_b32 s24, s42, 2
    v_mov_b32 v73, s26
    v_mov_b32 v74, 0
    buffer_store_dword v73, v74, s[12:15], s24 offen sc1
L_prep_kernel_last:
    s_endpgm
.globl conv1_kernel
.p2align 8
.type conv1_kernel,@function
conv1_kernel:
    s_cmp_ge_u32 s2, 256
    s_cbranch_scc1 L_conv1_kernel_done
    s_load_dwordx2 s[4:5], s[0:1], 0
    s_load_dwordx2 s[30:31], s[0:1], 72
    v_readfirstlane_b32 s20, v0
    s_lshr_b32 s20, s20, 6
    s_xor_b32 s20, s20, 8
    s_and_b32 s36, s2, 0
    s_lshl_b32 s36, s36, 3
    s_bfe_u32 s37, s2, 196611
    s_or_b32 s29, s36, s37
    s_bfe_u32 s36, s2, 196608
    s_lshl_b32 s36, s36, 2
    s_lshr_b32 s37, s2, 6
    s_or_b32 s36, s36, s37
    s_mov_b32 s33, 0
    s_and_b32 s34, s36, 15
    s_lshr_b32 s35, s36, 4
    s_mul_i32 s21, s34, 500
    s_and_b32 s32, s20, 3
    v_and_b32 v127, 63, v0
    v_lshrrev_b32 v5, 2, v127
    v_and_b32 v6, 3, v127
    s_and_b32 s42, s20, 7
    v_lshlrev_b32 v7, 15, v5
    v_lshl_add_u32 v7, v6, 4, v7
    s_lshl_b32 s41, s21, 10
    s_sub_u32 s41, s41, 7680
    s_lshl_b32 s37, s42, 12
    s_add_u32 s37, s37, s41
    v_add_u32 v7, s37, v7
    s_mul_i32 s36, s35, 8192000
    s_mov_b32 s10, 8192000
    s_mov_b32 s11, 0x00020000
    s_mov_b32 s25, 0xffff0000
    s_mov_b32 s47, s36
    s_cmp_ge_u32 s20, 8
    s_cbranch_scc0 L_conv1_kernel_mw
L_conv1_kernel_helper:
    s_setprio 3
    v_add_u32 v92, 0, v7
    v_add_u32 v93, 1024, v7
    v_add_u32 v94, 2048, v7
    v_add_u32 v95, 3072, v7
    v_and_b32 v76, 4, v5
    v_lshrrev_b32 v76, 1, v76
    v_xor_b32 v76, v6, v76
    v_lshlrev_b32 v76, 4, v76
    v_lshl_add_u32 v76, v5, 6, v76
    s_mov_b32 s24, 0
    s_mov_b32 s27, 524288
    s_waitcnt lgkmcnt(0)
    s_add_u32 s8, s4, s47
    s_addc_u32 s9, s5, 0
    buffer_load_dwordx4 v[0:3], v92, s[8:11], s24 offen offset:0
    buffer_load_dwordx4 v[16:19], v92, s[8:11], s24 offen offset:64
    v_add_u32 v92, 128, v92
    buffer_load_dwordx4 v[4:7], v93, s[8:11], s24 offen offset:0
    buffer_load_dwordx4 v[20:23], v93, s[8:11], s24 offen offset:64
    v_add_u32 v93, 128, v93
    buffer_load_dwordx4 v[8:11], v94, s[8:11], s24 offen offset:0
    buffer_load_dwordx4 v[24:27], v94, s[8:11], s24 offen offset:64
    v_add_u32 v94, 128, v94
    buffer_load_dwordx4 v[12:15], v95, s[8:11], s24 offen offset:0
    buffer_load_dwordx4 v[28:31], v95, s[8:11], s24 offen offset:64
    v_add_u32 v95, 128, v95
    s_mul_i32 s36, s42, 1024
    v_add_u32 v96, s36, v76
    v_add_u32 v97, 65536, v96
    s_mul_i32 s36, s42, 1088
    s_add_u32 s36, s36, 98304
    v_add_u32 v98, s36, v76
    s_waitcnt vmcnt(0)
    s_mov_b32 s28, 0
    s_mov_b32 s22, 4
    ds_write_b128 v96, v[0:3] offset:0
    ds_write_b128 v98, v[12:15] offset:0
    v_lshlrev_b32 v76, 16, v0
    v_and_b32 v84, s25, v0
    v_lshlrev_b32 v77, 16, v4
    v_and_b32 v85, s25, v4
    v_lshlrev_b32 v78, 16, v8
    v_and_b32 v86, s25, v8
    v_lshlrev_b32 v79, 16, v12
    v_and_b32 v87, s25, v12
    v_add_f32 v80, v76, v78
    v_add_f32 v88, v84, v86
    v_add_f32 v81, v77, v79
    v_add_f32 v89, v85, v87
    v_fma_f32 v82, v78, 4.0, v76
    v_fma_f32 v90, v86, 4.0, v84
    v_fma_f32 v83, v79, 4.0, v77
    v_fma_f32 v91, v87, 4.0, v85
    v_add_f32 v77, v80, v81
    v_add_f32 v85, v88, v89
    v_sub_f32 v78, v80, v81
    v_sub_f32 v86, v88, v89
    v_fma_f32 v79, v83, 2.0, v82
    v_fma_f32 v87, v91, 2.0, v90
    v_fma_f32 v82, v83, -2.0, v82
    v_fma_f32 v90, v91, -2.0, v90
    v_fmamk_f32 v80, v76, 0x41700000, v82
    v_fmamk_f32 v88, v84, 0x41700000, v90
    v_fmamk_f32 v80, v81, 0x41200000, v80
    v_fmamk_f32 v88, v89, 0x41200000, v88
    v_cvt_pk_bf16_f32 v4, v77, v85
    v_cvt_pk_bf16_f32 v8, v78, v86
    v_cvt_pk_bf16_f32 v64, v79, v87
    v_cvt_pk_bf16_f32 v68, v82, v90
    v_cvt_pk_bf16_f32 v72, v80, v88
    v_lshlrev_b32 v76, 16, v1
    v_and_b32 v84, s25, v1
    v_lshlrev_b32 v77, 16, v5
    v_and_b32 v85, s25, v5
    v_lshlrev_b32 v78, 16, v9
    v_and_b32 v86, s25, v9
    v_lshlrev_b32 v79, 16, v13
    v_and_b32 v87, s25, v13
    v_add_f32 v80, v76, v78
    v_add_f32 v88, v84, v86
    v_add_f32 v81, v77, v79
    v_add_f32 v89, v85, v87
    v_fma_f32 v82, v78, 4.0, v76
    v_fma_f32 v90, v86, 4.0, v84
    v_fma_f32 v83, v79, 4.0, v77
    v_fma_f32 v91, v87, 4.0, v85
    v_add_f32 v77, v80, v81
    v_add_f32 v85, v88, v89
    v_sub_f32 v78, v80, v81
    v_sub_f32 v86, v88, v89
    v_fma_f32 v79, v83, 2.0, v82
    v_fma_f32 v87, v91, 2.0, v90
    v_fma_f32 v82, v83, -2.0, v82
    v_fma_f32 v90, v91, -2.0, v90
    v_fmamk_f32 v80, v76, 0x41700000, v82
    v_fmamk_f32 v88, v84, 0x41700000, v90
    v_fmamk_f32 v80, v81, 0x41200000, v80
    v_fmamk_f32 v88, v89, 0x41200000, v88
    v_cvt_pk_bf16_f32 v5, v77, v85
    v_cvt_pk_bf16_f32 v9, v78, v86
    v_cvt_pk_bf16_f32 v65, v79, v87
    v_cvt_pk_bf16_f32 v69, v82, v90
    v_cvt_pk_bf16_f32 v73, v80, v88
    v_lshlrev_b32 v76, 16, v2
    v_and_b32 v84, s25, v2
    v_lshlrev_b32 v77, 16, v6
    v_and_b32 v85, s25, v6
    v_lshlrev_b32 v78, 16, v10
    v_and_b32 v86, s25, v10
    v_lshlrev_b32 v79, 16, v14
    v_and_b32 v87, s25, v14
    v_add_f32 v80, v76, v78
    v_add_f32 v88, v84, v86
    v_add_f32 v81, v77, v79
    v_add_f32 v89, v85, v87
    v_fma_f32 v82, v78, 4.0, v76
    v_fma_f32 v90, v86, 4.0, v84
    v_fma_f32 v83, v79, 4.0, v77
    v_fma_f32 v91, v87, 4.0, v85
    v_add_f32 v77, v80, v81
    v_add_f32 v85, v88, v89
    v_sub_f32 v78, v80, v81
    v_sub_f32 v86, v88, v89
    v_fma_f32 v79, v83, 2.0, v82
    v_fma_f32 v87, v91, 2.0, v90
    v_fma_f32 v82, v83, -2.0, v82
    v_fma_f32 v90, v91, -2.0, v90
    v_fmamk_f32 v80, v76, 0x41700000, v82
    v_fmamk_f32 v88, v84, 0x41700000, v90
    v_fmamk_f32 v80, v81, 0x41200000, v80
    v_fmamk_f32 v88, v89, 0x41200000, v88
    v_cvt_pk_bf16_f32 v6, v77, v85
    v_cvt_pk_bf16_f32 v10, v78, v86
    v_cvt_pk_bf16_f32 v66, v79, v87
    v_cvt_pk_bf16_f32 v70, v82, v90
    v_cvt_pk_bf16_f32 v74, v80, v88
    v_lshlrev_b32 v76, 16, v3
    v_and_b32 v84, s25, v3
    v_lshlrev_b32 v77, 16, v7
    v_and_b32 v85, s25, v7
    v_lshlrev_b32 v78, 16, v11
    v_and_b32 v86, s25, v11
    v_lshlrev_b32 v79, 16, v15
    v_and_b32 v87, s25, v15
    v_add_f32 v80, v76, v78
    v_add_f32 v88, v84, v86
    v_add_f32 v81, v77, v79
    v_add_f32 v89, v85, v87
    v_fma_f32 v82, v78, 4.0, v76
    v_fma_f32 v90, v86, 4.0, v84
    v_fma_f32 v83, v79, 4.0, v77
    v_fma_f32 v91, v87, 4.0, v85
    v_add_f32 v77, v80, v81
    v_add_f32 v85, v88, v89
    v_sub_f32 v78, v80, v81
    v_sub_f32 v86, v88, v89
    v_fma_f32 v79, v83, 2.0, v82
    v_fma_f32 v87, v91, 2.0, v90
    v_fma_f32 v82, v83, -2.0, v82
    v_fma_f32 v90, v91, -2.0, v90
    v_fmamk_f32 v80, v76, 0x41700000, v82
    v_fmamk_f32 v88, v84, 0x41700000, v90
    v_fmamk_f32 v80, v81, 0x41200000, v80
    v_fmamk_f32 v88, v89, 0x41200000, v88
    v_cvt_pk_bf16_f32 v7, v77, v85
    v_cvt_pk_bf16_f32 v11, v78, v86
    v_cvt_pk_bf16_f32 v67, v79, v87
    v_cvt_pk_bf16_f32 v71, v82, v90
    v_cvt_pk_bf16_f32 v75, v80, v88
    ds_write_b128 v96, v[64:67] offset:49152
    ds_write_b128 v97, v[68:71] offset:0
    ds_write_b128 v97, v[72:75] offset:16384
    ds_write_b128 v96, v[4:7] offset:16384
    ds_write_b128 v96, v[8:11] offset:32768
    s_cmp_ge_u32 s20, 12
    s_cbranch_scc1 L_conv1_kernel_h2
    s_waitcnt lgkmcnt(0)
    s_barrier
    buffer_load_dwordx4 v[32:35], v92, s[8:11], s24 offen offset:0
    buffer_load_dwordx4 v[48:51], v92, s[8:11], s24 offen offset:64
    v_add_u32 v92, 128, v92
    buffer_load_dwordx4 v[36:39], v93, s[8:11], s24 offen offset:0
    buffer_load_dwordx4 v[52:55], v93, s[8:11], s24 offen offset:64
    v_add_u32 v93, 128, v93
    s_setprio 1
L_conv1_kernel_hloop1:
    s_cmp_lt_u32 s28, 13
    s_cselect_b32 s24, 0, 2130706432
    v_lshlrev_b32 v76, 16, v16
    v_and_b32 v84, s25, v16
    v_lshlrev_b32 v77, 16, v20
    v_and_b32 v85, s25, v20
    v_lshlrev_b32 v78, 16, v24
    v_and_b32 v86, s25, v24
    v_lshlrev_b32 v79, 16, v28
    v_and_b32 v87, s25, v28
    v_add_f32 v80, v76, v78
    v_add_f32 v88, v84, v86
    v_add_f32 v81, v77, v79
    v_add_f32 v89, v85, v87
    v_fma_f32 v82, v78, 4.0, v76
    v_fma_f32 v90, v86, 4.0, v84
    v_fma_f32 v83, v79, 4.0, v77
    v_fma_f32 v91, v87, 4.0, v85
    v_add_f32 v77, v80, v81
    v_add_f32 v85, v88, v89
    v_sub_f32 v78, v80, v81
    v_sub_f32 v86, v88, v89
    v_fma_f32 v79, v83, 2.0, v82
    v_fma_f32 v87, v91, 2.0, v90
    v_fma_f32 v82, v83, -2.0, v82
    v_fma_f32 v90, v91, -2.0, v90
    v_fmamk_f32 v80, v76, 0x41700000, v82
    v_fmamk_f32 v88, v84, 0x41700000, v90
    buffer_load_dwordx4 v[40:43], v94, s[8:11], s24 offen offset:0
    buffer_load_dwordx4 v[56:59], v94, s[8:11], s24 offen offset:64
    v_add_u32 v94, 128, v94
    v_fmamk_f32 v80, v81, 0x41200000, v80
    v_fmamk_f32 v88, v89, 0x41200000, v88
    v_cvt_pk_bf16_f32 v20, v77, v85
    v_cvt_pk_bf16_f32 v24, v78, v86
    v_cvt_pk_bf16_f32 v64, v79, v87
    v_cvt_pk_bf16_f32 v68, v82, v90
    v_cvt_pk_bf16_f32 v72, v80, v88
    v_lshlrev_b32 v76, 16, v17
    v_and_b32 v84, s25, v17
    v_lshlrev_b32 v77, 16, v21
    v_and_b32 v85, s25, v21
    v_lshlrev_b32 v78, 16, v25
    v_and_b32 v86, s25, v25
    v_lshlrev_b32 v79, 16, v29
    v_and_b32 v87, s25, v29
    v_add_f32 v80, v76, v78
    v_add_f32 v88, v84, v86
    v_add_f32 v81, v77, v79
    v_add_f32 v89, v85, v87
    v_fma_f32 v82, v78, 4.0, v76
    v_fma_f32 v90, v86, 4.0, v84
    v_fma_f32 v83, v79, 4.0, v77
    v_fma_f32 v91, v87, 4.0, v85
    v_add_f32 v77, v80, v81
    v_add_f32 v85, v88, v89
    v_sub_f32 v78, v80, v81
    buffer_load_dwordx4 v[44:47], v95, s[8:11], s24 offen offset:0
    buffer_load_dwordx4 v[60:63], v95, s[8:11], s24 offen offset:64
    v_add_u32 v95, 128, v95
    v_sub_f32 v86, v88, v89
    v_fma_f32 v79, v83, 2.0, v82
    v_fma_f32 v87, v91, 2.0, v90
    v_fma_f32 v82, v83, -2.0, v82
    v_fma_f32 v90, v91, -2.0, v90
    v_fmamk_f32 v80, v76, 0x41700000, v82
    v_fmamk_f32 v88, v84, 0x41700000, v90
    v_fmamk_f32 v80, v81, 0x41200000, v80
    v_fmamk_f32 v88, v89, 0x41200000, v88
    v_cvt_pk_bf16_f32 v21, v77, v85
    v_cvt_pk_bf16_f32 v25, v78, v86
    v_cvt_pk_bf16_f32 v65, v79, v87
    v_cvt_pk_bf16_f32 v69, v82, v90
    v_cvt_pk_bf16_f32 v73, v80, v88
    v_lshlrev_b32 v76, 16, v18
    v_and_b32 v84, s25, v18
    v_lshlrev_b32 v77, 16, v22
    v_and_b32 v85, s25, v22
    v_lshlrev_b32 v78, 16, v26
    v_and_b32 v86, s25, v26
    v_lshlrev_b32 v79, 16, v30
    v_and_b32 v87, s25, v30
    v_add_f32 v80, v76, v78
    v_add_f32 v88, v84, v86
    v_add_f32 v81, v77, v79
    v_add_f32 v89, v85, v87
    v_fma_f32 v82, v78, 4.0, v76
    v_fma_f32 v90, v86, 4.0, v84
    v_fma_f32 v83, v79, 4.0, v77
    v_fma_f32 v91, v87, 4.0, v85
    v_add_f32 v77, v80, v81
    v_add_f32 v85, v88, v89
    v_sub_f32 v78, v80, v81
    v_sub_f32 v86, v88, v89
    v_fma_f32 v79, v83, 2.0, v82
    v_fma_f32 v87, v91, 2.0, v90
    v_fma_f32 v82, v83, -2.0, v82
    v_fma_f32 v90, v91, -2.0, v90
    v_fmamk_f32 v80, v76, 0x41700000, v82
    v_fmamk_f32 v88, v84, 0x41700000, v90
    v_fmamk_f32 v80, v81, 0x41200000, v80
    v_fmamk_f32 v88, v89, 0x41200000, v88
    v_cvt_pk_bf16_f32 v22, v77, v85
    v_cvt_pk_bf16_f32 v26, v78, v86
    v_cvt_pk_bf16_f32 v66, v79, v87
    v_cvt_pk_bf16_f32 v70, v82, v90
    v_cvt_pk_bf16_f32 v74, v80, v88
    v_lshlrev_b32 v76, 16, v19
    v_and_b32 v84, s25, v19
    v_lshlrev_b32 v77, 16, v23
    v_and_b32 v85, s25, v23
    v_lshlrev_b32 v78, 16, v27
    v_and_b32 v86, s25, v27
    v_lshlrev_b32 v79, 16, v31
    v_and_b32 v87, s25, v31
    v_add_f32 v80, v76, v78
    v_add_f32 v88, v84, v86
    v_add_f32 v81, v77, v79
    v_add_f32 v89, v85, v87
    v_fma_f32 v82, v78, 4.0, v76
    v_fma_f32 v90, v86, 4.0, v84
    v_fma_f32 v83, v79, 4.0, v77
    v_fma_f32 v91, v87, 4.0, v85
    v_add_f32 v77, v80, v81
    v_add_f32 v85, v88, v89
    v_sub_f32 v78, v80, v81
    v_sub_f32 v86, v88, v89
    v_fma_f32 v79, v83, 2.0, v82
    v_fma_f32 v87, v91, 2.0, v90
    v_fma_f32 v82, v83, -2.0, v82
    v_fma_f32 v90, v91, -2.0, v90
    v_fmamk_f32 v80, v76, 0x41700000, v82
    v_fmamk_f32 v88, v84, 0x41700000, v90
    v_fmamk_f32 v80, v81, 0x41200000, v80
    v_fmamk_f32 v88, v89, 0x41200000, v88
    v_cvt_pk_bf16_f32 v23, v77, v85
    v_cvt_pk_bf16_f32 v27, v78, v86
    v_cvt_pk_bf16_f32 v67, v79, v87
    v_cvt_pk_bf16_f32 v71, v82, v90
    v_cvt_pk_bf16_f32 v75, v80, v88
    ds_write_b128 v96, v[64:67] offset:57344
    ds_write_b128 v97, v[68:71] offset:8192
    ds_write_b128 v97, v[72:75] offset:24576
    ds_write_b128 v96, v[16:19] offset:8192
    ds_write_b128 v96, v[20:23] offset:24576
    ds_write_b128 v96, v[24:27] offset:40960
    ds_write_b128 v98, v[28:31] offset:8704
    s_add_u32 s28, s28, 1
    s_waitcnt lgkmcnt(0)
    s_barrier
    s_cmp_lt_u32 s28, 13
    s_cselect_b32 s24, 0, 2130706432
    s_waitcnt vmcnt(0)
    v_lshlrev_b32 v76, 16, v32
    v_and_b32 v84, s25, v32
    v_lshlrev_b32 v77, 16, v36
    v_and_b32 v85, s25, v36
    v_lshlrev_b32 v78, 16, v40
    v_and_b32 v86, s25, v40
    v_lshlrev_b32 v79, 16, v44
    v_and_b32 v87, s25, v44
    v_add_f32 v80, v76, v78
    v_add_f32 v88, v84, v86
    v_add_f32 v81, v77, v79
    v_add_f32 v89, v85, v87
    v_fma_f32 v82, v78, 4.0, v76
    v_fma_f32 v90, v86, 4.0, v84
    v_fma_f32 v83, v79, 4.0, v77
    v_fma_f32 v91, v87, 4.0, v85
    v_add_f32 v77, v80, v81
    v_add_f32 v85, v88, v89
    v_sub_f32 v78, v80, v81
    v_sub_f32 v86, v88, v89
    v_fma_f32 v79, v83, 2.0, v82
    v_fma_f32 v87, v91, 2.0, v90
    v_fma_f32 v82, v83, -2.0, v82
    v_fma_f32 v90, v91, -2.0, v90
    v_fmamk_f32 v80, v76, 0x41700000, v82
    v_fmamk_f32 v88, v84, 0x41700000, v90
    buffer_load_dwordx4 v[0:3], v92, s[8:11], s24 offen offset:0
    buffer_load_dwordx4 v[16:19], v92, s[8:11], s24 offen offset:64
    v_add_u32 v92, 128, v92
    v_fmamk_f32 v80, v81, 0x41200000, v80
    v_fmamk_f32 v88, v89, 0x41200000, v88
    v_cvt_pk_bf16_f32 v36, v77, v85
    v_cvt_pk_bf16_f32 v40, v78, v86
    v_cvt_pk_bf16_f32 v64, v79, v87
    v_cvt_pk_bf16_f32 v68, v82, v90
    v_cvt_pk_bf16_f32 v72, v80, v88
    v_lshlrev_b32 v76, 16, v33
    v_and_b32 v84, s25, v33
    v_lshlrev_b32 v77, 16, v37
    v_and_b32 v85, s25, v37
    v_lshlrev_b32 v78, 16, v41
    v_and_b32 v86, s25, v41
    v_lshlrev_b32 v79, 16, v45
    v_and_b32 v87, s25, v45
    v_add_f32 v80, v76, v78
    v_add_f32 v88, v84, v86
    v_add_f32 v81, v77, v79
    v_add_f32 v89, v85, v87
    v_fma_f32 v82, v78, 4.0, v76
    v_fma_f32 v90, v86, 4.0, v84
    v_fma_f32 v83, v79, 4.0, v77
    v_fma_f32 v91, v87, 4.0, v85
    v_add_f32 v77, v80, v81
    v_add_f32 v85, v88, v89
    v_sub_f32 v78, v80, v81
    buffer_load_dwordx4 v[4:7], v93, s[8:11], s24 offen offset:0
    buffer_load_dwordx4 v[20:23], v93, s[8:11], s24 offen offset:64
    v_add_u32 v93, 128, v93
    v_sub_f32 v86, v88, v89
    v_fma_f32 v79, v83, 2.0, v82
    v_fma_f32 v87, v91, 2.0, v90
    v_fma_f32 v82, v83, -2.0, v82
    v_fma_f32 v90, v91, -2.0, v90
    v_fmamk_f32 v80, v76, 0x41700000, v82
    v_fmamk_f32 v88, v84, 0x41700000, v90
    v_fmamk_f32 v80, v81, 0x41200000, v80
    v_fmamk_f32 v88, v89, 0x41200000, v88
    v_cvt_pk_bf16_f32 v37, v77, v85
    v_cvt_pk_bf16_f32 v41, v78, v86
    v_cvt_pk_bf16_f32 v65, v79, v87
    v_cvt_pk_bf16_f32 v69, v82, v90
    v_cvt_pk_bf16_f32 v73, v80, v88
    v_lshlrev_b32 v76, 16, v34
    v_and_b32 v84, s25, v34
    v_lshlrev_b32 v77, 16, v38
    v_and_b32 v85, s25, v38
    v_lshlrev_b32 v78, 16, v42
    v_and_b32 v86, s25, v42
    v_lshlrev_b32 v79, 16, v46
    v_and_b32 v87, s25, v46
    v_add_f32 v80, v76, v78
    v_add_f32 v88, v84, v86
    v_add_f32 v81, v77, v79
    v_add_f32 v89, v85, v87
    v_fma_f32 v82, v78, 4.0, v76
    v_fma_f32 v90, v86, 4.0, v84
    v_fma_f32 v83, v79, 4.0, v77
    v_fma_f32 v91, v87, 4.0, v85
    v_add_f32 v77, v80, v81
    v_add_f32 v85, v88, v89
    v_sub_f32 v78, v80, v81
    v_sub_f32 v86, v88, v89
    v_fma_f32 v79, v83, 2.0, v82
    v_fma_f32 v87, v91, 2.0, v90
    v_fma_f32 v82, v83, -2.0, v82
    v_fma_f32 v90, v91, -2.0, v90
    v_fmamk_f32 v80, v76, 0x41700000, v82
    v_fmamk_f32 v88, v84, 0x41700000, v90
    v_fmamk_f32 v80, v81, 0x41200000, v80
    v_fmamk_f32 v88, v89, 0x41200000, v88
    v_cvt_pk_bf16_f32 v38, v77, v85
    v_cvt_pk_bf16_f32 v42, v78, v86
    v_cvt_pk_bf16_f32 v66, v79, v87
    v_cvt_pk_bf16_f32 v70, v82, v90
    v_cvt_pk_bf16_f32 v74, v80, v88
    v_lshlrev_b32 v76, 16, v35
    v_and_b32 v84, s25, v35
    v_lshlrev_b32 v77, 16, v39
    v_and_b32 v85, s25, v39
    v_lshlrev_b32 v78, 16, v43
    v_and_b32 v86, s25, v43
    v_lshlrev_b32 v79, 16, v47
    v_and_b32 v87, s25, v47
    v_add_f32 v80, v76, v78
    v_add_f32 v88, v84, v86
    v_add_f32 v81, v77, v79
    v_add_f32 v89, v85, v87
    v_fma_f32 v82, v78, 4.0, v76
    v_fma_f32 v90, v86, 4.0, v84
    v_fma_f32 v83, v79, 4.0, v77
    v_fma_f32 v91, v87, 4.0, v85
    v_add_f32 v77, v80, v81
    v_add_f32 v85, v88, v89
    v_sub_f32 v78, v80, v81
    v_sub_f32 v86, v88, v89
    v_fma_f32 v79, v83, 2.0, v82
    v_fma_f32 v87, v91, 2.0, v90
    v_fma_f32 v82, v83, -2.0, v82
    v_fma_f32 v90, v91, -2.0, v90
    v_fmamk_f32 v80, v76, 0x41700000, v82
    v_fmamk_f32 v88, v84, 0x41700000, v90
    v_fmamk_f32 v80, v81, 0x41200000, v80
    v_fmamk_f32 v88, v89, 0x41200000, v88
    v_cvt_pk_bf16_f32 v39, v77, v85
    v_cvt_pk_bf16_f32 v43, v78, v86
    v_cvt_pk_bf16_f32 v67, v79, v87
    v_cvt_pk_bf16_f32 v71, v82, v90
    v_cvt_pk_bf16_f32 v75, v80, v88
    ds_write_b128 v96, v[64:67] offset:49152
    ds_write_b128 v97, v[68:71] offset:0
    ds_write_b128 v97, v[72:75] offset:16384
    ds_write_b128 v96, v[32:35] offset:0
    ds_write_b128 v96, v[36:39] offset:16384
    ds_write_b128 v96, v[40:43] offset:32768
    ds_write_b128 v98, v[44:47] offset:0
    s_add_u32 s28, s28, 1
    s_waitcnt lgkmcnt(0)
    s_barrier
    s_cmp_lt_u32 s28, 13
    s_cselect_b32 s24, 0, 2130706432
    v_lshlrev_b32 v76, 16, v48
    v_and_b32 v84, s25, v48
    v_lshlrev_b32 v77, 16, v52
    v_and_b32 v85, s25, v52
    v_lshlrev_b32 v78, 16, v56
    v_and_b32 v86, s25, v56
    v_lshlrev_b32 v79, 16, v60
    v_and_b32 v87, s25, v60
    v_add_f32 v80, v76, v78
    v_add_f32 v88, v84, v86
    v_add_f32 v81, v77, v79
    v_add_f32 v89, v85, v87
    v_fma_f32 v82, v78, 4.0, v76
    v_fma_f32 v90, v86, 4.0, v84
    v_fma_f32 v83, v79, 4.0, v77
    v_fma_f32 v91, v87, 4.0, v85
    v_add_f32 v77, v80, v81
    v_add_f32 v85, v88, v89
    v_sub_f32 v78, v80, v81
    v_sub_f32 v86, v88, v89
    v_fma_f32 v79, v83, 2.0, v82
    v_fma_f32 v87, v91, 2.0, v90
    v_fma_f32 v82, v83, -2.0, v82
    v_fma_f32 v90, v91, -2.0, v90
    v_fmamk_f32 v80, v76, 0x41700000, v82
    v_fmamk_f32 v88, v84, 0x41700000, v90
    buffer_load_dwordx4 v[8:11], v94, s[8:11], s24 offen offset:0
    buffer_load_dwordx4 v[24:27], v94, s[8:11], s24 offen offset:64
    v_add_u32 v94, 128, v94
    v_fmamk_f32 v80, v81, 0x41200000, v80
    v_fmamk_f32 v88, v89, 0x41200000, v88
    v_cvt_pk_bf16_f32 v52, v77, v85
    v_cvt_pk_bf16_f32 v56, v78, v86
    v_cvt_pk_bf16_f32 v64, v79, v87
    v_cvt_pk_bf16_f32 v68, v82, v90
    v_cvt_pk_bf16_f32 v72, v80, v88
    v_lshlrev_b32 v76, 16, v49
    v_and_b32 v84, s25, v49
    v_lshlrev_b32 v77, 16, v53
    v_and_b32 v85, s25, v53
    v_lshlrev_b32 v78, 16, v57
    v_and_b32 v86, s25, v57
    v_lshlrev_b32 v79, 16, v61
    v_and_b32 v87, s25, v61
    v_add_f32 v80, v76, v78
    v_add_f32 v88, v84, v86
    v_add_f32 v81, v77, v79
    v_add_f32 v89, v85, v87
    v_fma_f32 v82, v78, 4.0, v76
    v_fma_f32 v90, v86, 4.0, v84
    v_fma_f32 v83, v79, 4.0, v77
    v_fma_f32 v91, v87, 4.0, v85
    v_add_f32 v77, v80, v81
    v_add_f32 v85, v88, v89
    v_sub_f32 v78, v80, v81
    buffer_load_dwordx4 v[12:15], v95, s[8:11], s24 offen offset:0
    buffer_load_dwordx4 v[28:31], v95, s[8:11], s24 offen offset:64
    v_add_u32 v95, 128, v95
    v_sub_f32 v86, v88, v89
    v_fma_f32 v79, v83, 2.0, v82
    v_fma_f32 v87, v91, 2.0, v90
    v_fma_f32 v82, v83, -2.0, v82
    v_fma_f32 v90, v91, -2.0, v90
    v_fmamk_f32 v80, v76, 0x41700000, v82
    v_fmamk_f32 v88, v84, 0x41700000, v90
    v_fmamk_f32 v80, v81, 0x41200000, v80
    v_fmamk_f32 v88, v89, 0x41200000, v88
    v_cvt_pk_bf16_f32 v53, v77, v85
    v_cvt_pk_bf16_f32 v57, v78, v86
    v_cvt_pk_bf16_f32 v65, v79, v87
    v_cvt_pk_bf16_f32 v69, v82, v90
    v_cvt_pk_bf16_f32 v73, v80, v88
    v_lshlrev_b32 v76, 16, v50
    v_and_b32 v84, s25, v50
    v_lshlrev_b32 v77, 16, v54
    v_and_b32 v85, s25, v54
    v_lshlrev_b32 v78, 16, v58
    v_and_b32 v86, s25, v58
    v_lshlrev_b32 v79, 16, v62
    v_and_b32 v87, s25, v62
    v_add_f32 v80, v76, v78
    v_add_f32 v88, v84, v86
    v_add_f32 v81, v77, v79
    v_add_f32 v89, v85, v87
    v_fma_f32 v82, v78, 4.0, v76
    v_fma_f32 v90, v86, 4.0, v84
    v_fma_f32 v83, v79, 4.0, v77
    v_fma_f32 v91, v87, 4.0, v85
    v_add_f32 v77, v80, v81
    v_add_f32 v85, v88, v89
    v_sub_f32 v78, v80, v81
    v_sub_f32 v86, v88, v89
    v_fma_f32 v79, v83, 2.0, v82
    v_fma_f32 v87, v91, 2.0, v90
    v_fma_f32 v82, v83, -2.0, v82
    v_fma_f32 v90, v91, -2.0, v90
    v_fmamk_f32 v80, v76, 0x41700000, v82
    v_fmamk_f32 v88, v84, 0x41700000, v90
    v_fmamk_f32 v80, v81, 0x41200000, v80
    v_fmamk_f32 v88, v89, 0x41200000, v88
    v_cvt_pk_bf16_f32 v54, v77, v85
    v_cvt_pk_bf16_f32 v58, v78, v86
    v_cvt_pk_bf16_f32 v66, v79, v87
    v_cvt_pk_bf16_f32 v70, v82, v90
    v_cvt_pk_bf16_f32 v74, v80, v88
    v_lshlrev_b32 v76, 16, v51
    v_and_b32 v84, s25, v51
    v_lshlrev_b32 v77, 16, v55
    v_and_b32 v85, s25, v55
    v_lshlrev_b32 v78, 16, v59
    v_and_b32 v86, s25, v59
    v_lshlrev_b32 v79, 16, v63
    v_and_b32 v87, s25, v63
    v_add_f32 v80, v76, v78
    v_add_f32 v88, v84, v86
    v_add_f32 v81, v77, v79
    v_add_f32 v89, v85, v87
    v_fma_f32 v82, v78, 4.0, v76
    v_fma_f32 v90, v86, 4.0, v84
    v_fma_f32 v83, v79, 4.0, v77
    v_fma_f32 v91, v87, 4.0, v85
    v_add_f32 v77, v80, v81
    v_add_f32 v85, v88, v89
    v_sub_f32 v78, v80, v81
    v_sub_f32 v86, v88, v89
    v_fma_f32 v79, v83, 2.0, v82
    v_fma_f32 v87, v91, 2.0, v90
    v_fma_f32 v82, v83, -2.0, v82
    v_fma_f32 v90, v91, -2.0, v90
    v_fmamk_f32 v80, v76, 0x41700000, v82
    v_fmamk_f32 v88, v84, 0x41700000, v90
    v_fmamk_f32 v80, v81, 0x41200000, v80
    v_fmamk_f32 v88, v89, 0x41200000, v88
    v_cvt_pk_bf16_f32 v55, v77, v85
    v_cvt_pk_bf16_f32 v59, v78, v86
    v_cvt_pk_bf16_f32 v67, v79, v87
    v_cvt_pk_bf16_f32 v71, v82, v90
    v_cvt_pk_bf16_f32 v75, v80, v88
    ds_write_b128 v96, v[64:67] offset:57344
    ds_write_b128 v97, v[68:71] offset:8192
    ds_write_b128 v97, v[72:75] offset:24576
    ds_write_b128 v96, v[48:51] offset:8192
    ds_write_b128 v96, v[52:55] offset:24576
    ds_write_b128 v96, v[56:59] offset:40960
    ds_write_b128 v98, v[60:63] offset:8704
    s_add_u32 s28, s28, 1
    s_waitcnt lgkmcnt(0)
    s_barrier
    s_cmp_eq_u32 s22, 1
    s_cbranch_scc1 L_conv1_kernel_hlast1
    s_cmp_lt_u32 s28, 13
    s_cselect_b32 s24, 0, 2130706432
    s_waitcnt vmcnt(0)
    v_lshlrev_b32 v76, 16, v0
    v_and_b32 v84, s25, v0
    v_lshlrev_b32 v77, 16, v4
    v_and_b32 v85, s25, v4
    v_lshlrev_b32 v78, 16, v8
    v_and_b32 v86, s25, v8
    v_lshlrev_b32 v79, 16, v12
    v_and_b32 v87, s25, v12
    v_add_f32 v80, v76, v78
    v_add_f32 v88, v84, v86
    v_add_f32 v81, v77, v79
    v_add_f32 v89, v85, v87
    v_fma_f32 v82, v78, 4.0, v76
    v_fma_f32 v90, v86, 4.0, v84
    v_fma_f32 v83, v79, 4.0, v77
    v_fma_f32 v91, v87, 4.0, v85
    v_add_f32 v77, v80, v81
    v_add_f32 v85, v88, v89
    v_sub_f32 v78, v80, v81
    v_sub_f32 v86, v88, v89
    v_fma_f32 v79, v83, 2.0, v82
    v_fma_f32 v87, v91, 2.0, v90
    v_fma_f32 v82, v83, -2.0, v82
    v_fma_f32 v90, v91, -2.0, v90
    v_fmamk_f32 v80, v76, 0x41700000, v82
    v_fmamk_f32 v88, v84, 0x41700000, v90
    buffer_load_dwordx4 v[32:35], v92, s[8:11], s24 offen offset:0
    buffer_load_dwordx4 v[48:51], v92, s[8:11], s24 offen offset:64
    v_add_u32 v92, 128, v92
    v_fmamk_f32 v80, v81, 0x41200000, v80
    v_fmamk_f32 v88, v89, 0x41200000, v88
    v_cvt_pk_bf16_f32 v4, v77, v85
    v_cvt_pk_bf16_f32 v8, v78, v86
    v_cvt_pk_bf16_f32 v64, v79, v87
    v_cvt_pk_bf16_f32 v68, v82, v90
    v_cvt_pk_bf16_f32 v72, v80, v88
    v_lshlrev_b32 v76, 16, v1
    v_and_b32 v84, s25, v1
    v_lshlrev_b32 v77, 16, v5
    v_and_b32 v85, s25, v5
    v_lshlrev_b32 v78, 16, v9
    v_and_b32 v86, s25, v9
    v_lshlrev_b32 v79, 16, v13
    v_and_b32 v87, s25, v13
    v_add_f32 v80, v76, v78
    v_add_f32 v88, v84, v86
    v_add_f32 v81, v77, v79
    v_add_f32 v89, v85, v87
    v_fma_f32 v82, v78, 4.0, v76
    v_fma_f32 v90, v86, 4.0, v84
    v_fma_f32 v83, v79, 4.0, v77
    v_fma_f32 v91, v87, 4.0, v85
    v_add_f32 v77, v80, v81
    v_add_f32 v85, v88, v89
    v_sub_f32 v78, v80, v81
    buffer_load_dwordx4 v[36:39], v93, s[8:11], s24 offen offset:0
    buffer_load_dwordx4 v[52:55], v93, s[8:11], s24 offen offset:64
    v_add_u32 v93, 128, v93
    v_sub_f32 v86, v88, v89
    v_fma_f32 v79, v83, 2.0, v82
    v_fma_f32 v87, v91, 2.0, v90
    v_fma_f32 v82, v83, -2.0, v82
    v_fma_f32 v90, v91, -2.0, v90
    v_fmamk_f32 v80, v76, 0x41700000, v82
    v_fmamk_f32 v88, v84, 0x41700000, v90
    v_fmamk_f32 v80, v81, 0x41200000, v80
    v_fmamk_f32 v88, v89, 0x41200000, v88
    v_cvt_pk_bf16_f32 v5, v77, v85
    v_cvt_pk_bf16_f32 v9, v78, v86
    v_cvt_pk_bf16_f32 v65, v79, v87
    v_cvt_pk_bf16_f32 v69, v82, v90
    v_cvt_pk_bf16_f32 v73, v80, v88
    v_lshlrev_b32 v76, 16, v2
    v_and_b32 v84, s25, v2
    v_lshlrev_b32 v77, 16, v6
    v_and_b32 v85, s25, v6
    v_lshlrev_b32 v78, 16, v10
    v_and_b32 v86, s25, v10
    v_lshlrev_b32 v79, 16, v14
    v_and_b32 v87, s25, v14
    v_add_f32 v80, v76, v78
    v_add_f32 v88, v84, v86
    v_add_f32 v81, v77, v79
    v_add_f32 v89, v85, v87
    v_fma_f32 v82, v78, 4.0, v76
    v_fma_f32 v90, v86, 4.0, v84
    v_fma_f32 v83, v79, 4.0, v77
    v_fma_f32 v91, v87, 4.0, v85
    v_add_f32 v77, v80, v81
    v_add_f32 v85, v88, v89
    v_sub_f32 v78, v80, v81
    v_sub_f32 v86, v88, v89
    v_fma_f32 v79, v83, 2.0, v82
    v_fma_f32 v87, v91, 2.0, v90
    v_fma_f32 v82, v83, -2.0, v82
    v_fma_f32 v90, v91, -2.0, v90
    v_fmamk_f32 v80, v76, 0x41700000, v82
    v_fmamk_f32 v88, v84, 0x41700000, v90
    v_fmamk_f32 v80, v81, 0x41200000, v80
    v_fmamk_f32 v88, v89, 0x41200000, v88
    v_cvt_pk_bf16_f32 v6, v77, v85
    v_cvt_pk_bf16_f32 v10, v78, v86
    v_cvt_pk_bf16_f32 v66, v79, v87
    v_cvt_pk_bf16_f32 v70, v82, v90
    v_cvt_pk_bf16_f32 v74, v80, v88
    v_lshlrev_b32 v76, 16, v3
    v_and_b32 v84, s25, v3
    v_lshlrev_b32 v77, 16, v7
    v_and_b32 v85, s25, v7
    v_lshlrev_b32 v78, 16, v11
    v_and_b32 v86, s25, v11
    v_lshlrev_b32 v79, 16, v15
    v_and_b32 v87, s25, v15
    v_add_f32 v80, v76, v78
    v_add_f32 v88, v84, v86
    v_add_f32 v81, v77, v79
    v_add_f32 v89, v85, v87
    v_fma_f32 v82, v78, 4.0, v76
    v_fma_f32 v90, v86, 4.0, v84
    v_fma_f32 v83, v79, 4.0, v77
    v_fma_f32 v91, v87, 4.0, v85
    v_add_f32 v77, v80, v81
    v_add_f32 v85, v88, v89
    v_sub_f32 v78, v80, v81
    v_sub_f32 v86, v88, v89
    v_fma_f32 v79, v83, 2.0, v82
    v_fma_f32 v87, v91, 2.0, v90
    v_fma_f32 v82, v83, -2.0, v82
    v_fma_f32 v90, v91, -2.0, v90
    v_fmamk_f32 v80, v76, 0x41700000, v82
    v_fmamk_f32 v88, v84, 0x41700000, v90
    v_fmamk_f32 v80, v81, 0x41200000, v80
    v_fmamk_f32 v88, v89, 0x41200000, v88
    v_cvt_pk_bf16_f32 v7, v77, v85
    v_cvt_pk_bf16_f32 v11, v78, v86
    v_cvt_pk_bf16_f32 v67, v79, v87
    v_cvt_pk_bf16_f32 v71, v82, v90
    v_cvt_pk_bf16_f32 v75, v80, v88
    ds_write_b128 v96, v[64:67] offset:49152
    ds_write_b128 v97, v[68:71] offset:0
    ds_write_b128 v97, v[72:75] offset:16384
    ds_write_b128 v96, v[0:3] offset:0
    ds_write_b128 v96, v[4:7] offset:16384
    ds_write_b128 v96, v[8:11] offset:32768
    ds_write_b128 v98, v[12:15] offset:0
    s_add_u32 s28, s28, 1
    s_waitcnt lgkmcnt(0)
    s_barrier
    s_sub_u32 s22, s22, 1
    s_branch L_conv1_kernel_hloop1
L_conv1_kernel_hlast1:
    s_cmp_ge_u32 s2, 32
    s_cbranch_scc1 L_conv1_kernel_ntw
    s_getpc_b64 s[36:37]
L_conv1_kernel_pc:
    s_lshl_b32 s38, s32, 13
    s_add_u32 s38, s38, L_conv1_kernel_epi-L_conv1_kernel_pc
    v_lshl_add_u32 v2, v127, 7, s38
    v_min_u32 v2, L_conv2_kernel_done-L_conv1_kernel_pc, v2
    v_mov_b32 v3, s37
    v_add_co_u32 v2, vcc, s36, v2
    s_nop 1
    v_addc_co_u32 v3, vcc, 0, v3, vcc
    global_load_dword v4, v[2:3], off
L_conv1_kernel_ntw:
    s_branch L_conv1_kernel_end
L_conv1_kernel_h2:
    s_waitcnt lgkmcnt(0)
    s_barrier
    buffer_load_dwordx4 v[32:35], v92, s[8:11], s24 offen offset:0
    buffer_load_dwordx4 v[48:51], v92, s[8:11], s24 offen offset:64
    v_add_u32 v92, 128, v92
    buffer_load_dwordx4 v[36:39], v93, s[8:11], s24 offen offset:0
    buffer_load_dwordx4 v[52:55], v93, s[8:11], s24 offen offset:64
    v_add_u32 v93, 128, v93
    buffer_load_dwordx4 v[40:43], v94, s[8:11], s24 offen offset:0
    buffer_load_dwordx4 v[56:59], v94, s[8:11], s24 offen offset:64
    v_add_u32 v94, 128, v94
    buffer_load_dwordx4 v[44:47], v95, s[8:11], s24 offen offset:0
    buffer_load_dwordx4 v[60:63], v95, s[8:11], s24 offen offset:64
    v_add_u32 v95, 128, v95
    s_setprio 0
    v_lshlrev_b32 v76, 16, v16
    v_and_b32 v84, s25, v16
    v_lshlrev_b32 v77, 16, v20
    v_and_b32 v85, s25, v20
    v_lshlrev_b32 v78, 16, v24
    v_and_b32 v86, s25, v24
    v_lshlrev_b32 v79, 16, v28
    v_and_b32 v87, s25, v28
    v_add_f32 v80, v76, v78
    v_add_f32 v88, v84, v86
    v_add_f32 v81, v77, v79
    v_add_f32 v89, v85, v87
    v_fma_f32 v82, v78, 4.0, v76
    v_fma_f32 v90, v86, 4.0, v84
    v_fma_f32 v83, v79, 4.0, v77
    v_fma_f32 v91, v87, 4.0, v85
    v_add_f32 v77, v80, v81
    v_add_f32 v85, v88, v89
    v_sub_f32 v78, v80, v81
    v_sub_f32 v86, v88, v89
    v_fma_f32 v79, v83, 2.0, v82
    v_fma_f32 v87, v91, 2.0, v90
    v_fma_f32 v82, v83, -2.0, v82
    v_fma_f32 v90, v91, -2.0, v90
    v_fmamk_f32 v80, v76, 0x41700000, v82
    v_fmamk_f32 v88, v84, 0x41700000, v90
    v_fmamk_f32 v80, v81, 0x41200000, v80
    v_fmamk_f32 v88, v89, 0x41200000, v88
    v_cvt_pk_bf16_f32 v20, v77, v85
    v_cvt_pk_bf16_f32 v24, v78, v86
    v_cvt_pk_bf16_f32 v64, v79, v87
    v_cvt_pk_bf16_f32 v68, v82, v90
    v_cvt_pk_bf16_f32 v72, v80, v88
    v_lshlrev_b32 v76, 16, v17
    v_and_b32 v84, s25, v17
    v_lshlrev_b32 v77, 16, v21
    v_and_b32 v85, s25, v21
    v_lshlrev_b32 v78, 16, v25
    v_and_b32 v86, s25, v25
    v_lshlrev_b32 v79, 16, v29
    v_and_b32 v87, s25, v29
    v_add_f32 v80, v76, v78
    v_add_f32 v88, v84, v86
    v_add_f32 v81, v77, v79
    v_add_f32 v89, v85, v87
    v_fma_f32 v82, v78, 4.0, v76
    v_fma_f32 v90, v86, 4.0, v84
    v_fma_f32 v83, v79, 4.0, v77
    v_fma_f32 v91, v87, 4.0, v85
    v_add_f32 v77, v80, v81
    v_add_f32 v85, v88, v89
    v_sub_f32 v78, v80, v81
    v_sub_f32 v86, v88, v89
    v_fma_f32 v79, v83, 2.0, v82
    v_fma_f32 v87, v91, 2.0, v90
    v_fma_f32 v82, v83, -2.0, v82
    v_fma_f32 v90, v91, -2.0, v90
    v_fmamk_f32 v80, v76, 0x41700000, v82
    v_fmamk_f32 v88, v84, 0x41700000, v90
    v_fmamk_f32 v80, v81, 0x41200000, v80
    v_fmamk_f32 v88, v89, 0x41200000, v88
    v_cvt_pk_bf16_f32 v21, v77, v85
    v_cvt_pk_bf16_f32 v25, v78, v86
    v_cvt_pk_bf16_f32 v65, v79, v87
    v_cvt_pk_bf16_f32 v69, v82, v90
    v_cvt_pk_bf16_f32 v73, v80, v88
    v_lshlrev_b32 v76, 16, v18
    v_and_b32 v84, s25, v18
    v_lshlrev_b32 v77, 16, v22
    v_and_b32 v85, s25, v22
    v_lshlrev_b32 v78, 16, v26
    v_and_b32 v86, s25, v26
    v_lshlrev_b32 v79, 16, v30
    v_and_b32 v87, s25, v30
    v_add_f32 v80, v76, v78
    v_add_f32 v88, v84, v86
    v_add_f32 v81, v77, v79
    v_add_f32 v89, v85, v87
    v_fma_f32 v82, v78, 4.0, v76
    v_fma_f32 v90, v86, 4.0, v84
    v_fma_f32 v83, v79, 4.0, v77
    v_fma_f32 v91, v87, 4.0, v85
    v_add_f32 v77, v80, v81
    v_add_f32 v85, v88, v89
    v_sub_f32 v78, v80, v81
    v_sub_f32 v86, v88, v89
    v_fma_f32 v79, v83, 2.0, v82
    v_fma_f32 v87, v91, 2.0, v90
    v_fma_f32 v82, v83, -2.0, v82
    v_fma_f32 v90, v91, -2.0, v90
    v_fmamk_f32 v80, v76, 0x41700000, v82
    v_fmamk_f32 v88, v84, 0x41700000, v90
    v_fmamk_f32 v80, v81, 0x41200000, v80
    v_fmamk_f32 v88, v89, 0x41200000, v88
    v_cvt_pk_bf16_f32 v22, v77, v85
    v_cvt_pk_bf16_f32 v26, v78, v86
    v_cvt_pk_bf16_f32 v66, v79, v87
    v_cvt_pk_bf16_f32 v70, v82, v90
    v_cvt_pk_bf16_f32 v74, v80, v88
    v_lshlrev_b32 v76, 16, v19
    v_and_b32 v84, s25, v19
    v_lshlrev_b32 v77, 16, v23
    v_and_b32 v85, s25, v23
    v_lshlrev_b32 v78, 16, v27
    v_and_b32 v86, s25, v27
    v_lshlrev_b32 v79, 16, v31
    v_and_b32 v87, s25, v31
    v_add_f32 v80, v76, v78
    v_add_f32 v88, v84, v86
    v_add_f32 v81, v77, v79
    v_add_f32 v89, v85, v87
    v_fma_f32 v82, v78, 4.0, v76
    v_fma_f32 v90, v86, 4.0, v84
    v_fma_f32 v83, v79, 4.0, v77
    v_fma_f32 v91, v87, 4.0, v85
    v_add_f32 v77, v80, v81
    v_add_f32 v85, v88, v89
    v_sub_f32 v78, v80, v81
    v_sub_f32 v86, v88, v89
    v_fma_f32 v79, v83, 2.0, v82
    v_fma_f32 v87, v91, 2.0, v90
    v_fma_f32 v82, v83, -2.0, v82
    v_fma_f32 v90, v91, -2.0, v90
    v_fmamk_f32 v80, v76, 0x41700000, v82
    v_fmamk_f32 v88, v84, 0x41700000, v90
    v_fmamk_f32 v80, v81, 0x41200000, v80
    v_fmamk_f32 v88, v89, 0x41200000, v88
    v_cvt_pk_bf16_f32 v23, v77, v85
    v_cvt_pk_bf16_f32 v27, v78, v86
    v_cvt_pk_bf16_f32 v67, v79, v87
    v_cvt_pk_bf16_f32 v71, v82, v90
    v_cvt_pk_bf16_f32 v75, v80, v88
L_conv1_kernel_hloop2:
    s_cmp_lt_u32 s28, 12
    s_cselect_b32 s24, 0, 2130706432
    ds_write_b128 v96, v[64:67] offset:57344
    ds_write_b128 v97, v[68:71] offset:8192
    ds_write_b128 v97, v[72:75] offset:24576
    ds_write_b128 v96, v[16:19] offset:8192
    ds_write_b128 v96, v[20:23] offset:24576
    ds_write_b128 v96, v[24:27] offset:40960
    ds_write_b128 v98, v[28:31] offset:8704
    s_waitcnt vmcnt(0)
    v_lshlrev_b32 v76, 16, v32
    v_and_b32 v84, s25, v32
    v_lshlrev_b32 v77, 16, v36
    v_and_b32 v85, s25, v36
    v_lshlrev_b32 v78, 16, v40
    v_and_b32 v86, s25, v40
    v_lshlrev_b32 v79, 16, v44
    v_and_b32 v87, s25, v44
    v_add_f32 v80, v76, v78
    v_add_f32 v88, v84, v86
    v_add_f32 v81, v77, v79
    v_add_f32 v89, v85, v87
    v_fma_f32 v82, v78, 4.0, v76
    v_fma_f32 v90, v86, 4.0, v84
    v_fma_f32 v83, v79, 4.0, v77
    v_fma_f32 v91, v87, 4.0, v85
    v_add_f32 v77, v80, v81
    v_add_f32 v85, v88, v89
    v_sub_f32 v78, v80, v81
    v_sub_f32 v86, v88, v89
    v_fma_f32 v79, v83, 2.0, v82
    v_fma_f32 v87, v91, 2.0, v90
    v_fma_f32 v82, v83, -2.0, v82
    v_fma_f32 v90, v91, -2.0, v90
    v_fmamk_f32 v80, v76, 0x41700000, v82
    v_fmamk_f32 v88, v84, 0x41700000, v90
    v_fmamk_f32 v80, v81, 0x41200000, v80
    v_fmamk_f32 v88, v89, 0x41200000, v88
    v_cvt_pk_bf16_f32 v36, v77, v85
    v_cvt_pk_bf16_f32 v40, v78, v86
    v_cvt_pk_bf16_f32 v64, v79, v87
    v_cvt_pk_bf16_f32 v68, v82, v90
    v_cvt_pk_bf16_f32 v72, v80, v88
    v_lshlrev_b32 v76, 16, v33
    v_and_b32 v84, s25, v33
    v_lshlrev_b32 v77, 16, v37
    v_and_b32 v85, s25, v37
    v_lshlrev_b32 v78, 16, v41
    v_and_b32 v86, s25, v41
    buffer_load_dwordx4 v[0:3], v92, s[8:11], s24 offen offset:0
    buffer_load_dwordx4 v[16:19], v92, s[8:11], s24 offen offset:64
    v_add_u32 v92, 128, v92
    v_lshlrev_b32 v79, 16, v45
    v_and_b32 v87, s25, v45
    v_add_f32 v80, v76, v78
    v_add_f32 v88, v84, v86
    v_add_f32 v81, v77, v79
    v_add_f32 v89, v85, v87
    v_fma_f32 v82, v78, 4.0, v76
    v_fma_f32 v90, v86, 4.0, v84
    v_fma_f32 v83, v79, 4.0, v77
    v_fma_f32 v91, v87, 4.0, v85
    v_add_f32 v77, v80, v81
    v_add_f32 v85, v88, v89
    v_sub_f32 v78, v80, v81
    v_sub_f32 v86, v88, v89
    v_fma_f32 v79, v83, 2.0, v82
    v_fma_f32 v87, v91, 2.0, v90
    v_fma_f32 v82, v83, -2.0, v82
    v_fma_f32 v90, v91, -2.0, v90
    v_fmamk_f32 v80, v76, 0x41700000, v82
    v_fmamk_f32 v88, v84, 0x41700000, v90
    v_fmamk_f32 v80, v81, 0x41200000, v80
    v_fmamk_f32 v88, v89, 0x41200000, v88
    v_cvt_pk_bf16_f32 v37, v77, v85
    v_cvt_pk_bf16_f32 v41, v78, v86
    v_cvt_pk_bf16_f32 v65, v79, v87
    v_cvt_pk_bf16_f32 v69, v82, v90
    v_cvt_pk_bf16_f32 v73, v80, v88
    buffer_load_dwordx4 v[4:7], v93, s[8:11], s24 offen offset:0
    buffer_load_dwordx4 v[20:23], v93, s[8:11], s24 offen offset:64
    v_add_u32 v93, 128, v93
    v_lshlrev_b32 v76, 16, v34
    v_and_b32 v84, s25, v34
    v_lshlrev_b32 v77, 16, v38
    v_and_b32 v85, s25, v38
    v_lshlrev_b32 v78, 16, v42
    v_and_b32 v86, s25, v42
    v_lshlrev_b32 v79, 16, v46
    v_and_b32 v87, s25, v46
    v_add_f32 v80, v76, v78
    v_add_f32 v88, v84, v86
    v_add_f32 v81, v77, v79
    v_add_f32 v89, v85, v87
    v_fma_f32 v82, v78, 4.0, v76
    v_fma_f32 v90, v86, 4.0, v84
    v_fma_f32 v83, v79, 4.0, v77
    v_fma_f32 v91, v87, 4.0, v85
    v_add_f32 v77, v80, v81
    v_add_f32 v85, v88, v89
    v_sub_f32 v78, v80, v81
    v_sub_f32 v86, v88, v89
    v_fma_f32 v79, v83, 2.0, v82
    v_fma_f32 v87, v91, 2.0, v90
    v_fma_f32 v82, v83, -2.0, v82
    v_fma_f32 v90, v91, -2.0, v90
    v_fmamk_f32 v80, v76, 0x41700000, v82
    v_fmamk_f32 v88, v84, 0x41700000, v90
    v_fmamk_f32 v80, v81, 0x41200000, v80
    v_fmamk_f32 v88, v89, 0x41200000, v88
    v_cvt_pk_bf16_f32 v38, v77, v85
    v_cvt_pk_bf16_f32 v42, v78, v86
    v_cvt_pk_bf16_f32 v66, v79, v87
    v_cvt_pk_bf16_f32 v70, v82, v90
    v_cvt_pk_bf16_f32 v74, v80, v88
    v_lshlrev_b32 v76, 16, v35
    v_and_b32 v84, s25, v35
    v_lshlrev_b32 v77, 16, v39
    v_and_b32 v85, s25, v39
    v_lshlrev_b32 v78, 16, v43
    v_and_b32 v86, s25, v43
    v_lshlrev_b32 v79, 16, v47
    v_and_b32 v87, s25, v47
    v_add_f32 v80, v76, v78
    v_add_f32 v88, v84, v86
    v_add_f32 v81, v77, v79
    v_add_f32 v89, v85, v87
    v_fma_f32 v82, v78, 4.0, v76
    v_fma_f32 v90, v86, 4.0, v84
    v_fma_f32 v83, v79, 4.0, v77
    v_fma_f32 v91, v87, 4.0, v85
    v_add_f32 v77, v80, v81
    v_add_f32 v85, v88, v89
    v_sub_f32 v78, v80, v81
    v_sub_f32 v86, v88, v89
    v_fma_f32 v79, v83, 2.0, v82
    v_fma_f32 v87, v91, 2.0, v90
    v_fma_f32 v82, v83, -2.0, v82
    v_fma_f32 v90, v91, -2.0, v90
    v_fmamk_f32 v80, v76, 0x41700000, v82
    v_fmamk_f32 v88, v84, 0x41700000, v90
    v_fmamk_f32 v80, v81, 0x41200000, v80
    v_fmamk_f32 v88, v89, 0x41200000, v88
    v_cvt_pk_bf16_f32 v39, v77, v85
    v_cvt_pk_bf16_f32 v43, v78, v86
    v_cvt_pk_bf16_f32 v67, v79, v87
    v_cvt_pk_bf16_f32 v71, v82, v90
    v_cvt_pk_bf16_f32 v75, v80, v88
    s_add_u32 s28, s28, 1
    s_waitcnt lgkmcnt(0)
    s_barrier
    s_cmp_lt_u32 s28, 12
    s_cselect_b32 s24, 0, 2130706432
    ds_write_b128 v96, v[64:67] offset:49152
    ds_write_b128 v97, v[68:71] offset:0
    ds_write_b128 v97, v[72:75] offset:16384
    ds_write_b128 v96, v[32:35] offset:0
    ds_write_b128 v96, v[36:39] offset:16384
    ds_write_b128 v96, v[40:43] offset:32768
    ds_write_b128 v98, v[44:47] offset:0
    v_lshlrev_b32 v76, 16, v48
    v_and_b32 v84, s25, v48
    v_lshlrev_b32 v77, 16, v52
    v_and_b32 v85, s25, v52
    v_lshlrev_b32 v78, 16, v56
    v_and_b32 v86, s25, v56
    v_lshlrev_b32 v79, 16, v60
    v_and_b32 v87, s25, v60
    v_add_f32 v80, v76, v78
    v_add_f32 v88, v84, v86
    v_add_f32 v81, v77, v79
    v_add_f32 v89, v85, v87
    v_fma_f32 v82, v78, 4.0, v76
    v_fma_f32 v90, v86, 4.0, v84
    v_fma_f32 v83, v79, 4.0, v77
    v_fma_f32 v91, v87, 4.0, v85
    v_add_f32 v77, v80, v81
    v_add_f32 v85, v88, v89
    v_sub_f32 v78, v80, v81
    v_sub_f32 v86, v88, v89
    v_fma_f32 v79, v83, 2.0, v82
    v_fma_f32 v87, v91, 2.0, v90
    v_fma_f32 v82, v83, -2.0, v82
    v_fma_f32 v90, v91, -2.0, v90
    v_fmamk_f32 v80, v76, 0x41700000, v82
    v_fmamk_f32 v88, v84, 0x41700000, v90
    v_fmamk_f32 v80, v81, 0x41200000, v80
    v_fmamk_f32 v88, v89, 0x41200000, v88
    v_cvt_pk_bf16_f32 v52, v77, v85
    v_cvt_pk_bf16_f32 v56, v78, v86
    v_cvt_pk_bf16_f32 v64, v79, v87
    v_cvt_pk_bf16_f32 v68, v82, v90
    v_cvt_pk_bf16_f32 v72, v80, v88
    v_lshlrev_b32 v76, 16, v49
    v_and_b32 v84, s25, v49
    v_lshlrev_b32 v77, 16, v53
    v_and_b32 v85, s25, v53
    v_lshlrev_b32 v78, 16, v57
    v_and_b32 v86, s25, v57
    buffer_load_dwordx4 v[8:11], v94, s[8:11], s24 offen offset:0
    buffer_load_dwordx4 v[24:27], v94, s[8:11], s24 offen offset:64
    v_add_u32 v94, 128, v94
    v_lshlrev_b32 v79, 16, v61
    v_and_b32 v87, s25, v61
    v_add_f32 v80, v76, v78
    v_add_f32 v88, v84, v86
    v_add_f32 v81, v77, v79
    v_add_f32 v89, v85, v87
    v_fma_f32 v82, v78, 4.0, v76
    v_fma_f32 v90, v86, 4.0, v84
    v_fma_f32 v83, v79, 4.0, v77
    v_fma_f32 v91, v87, 4.0, v85
    v_add_f32 v77, v80, v81
    v_add_f32 v85, v88, v89
    v_sub_f32 v78, v80, v81
    v_sub_f32 v86, v88, v89
    v_fma_f32 v79, v83, 2.0, v82
    v_fma_f32 v87, v91, 2.0, v90
    v_fma_f32 v82, v83, -2.0, v82
    v_fma_f32 v90, v91, -2.0, v90
    v_fmamk_f32 v80, v76, 0x41700000, v82
    v_fmamk_f32 v88, v84, 0x41700000, v90
    v_fmamk_f32 v80, v81, 0x41200000, v80
    v_fmamk_f32 v88, v89, 0x41200000, v88
    v_cvt_pk_bf16_f32 v53, v77, v85
    v_cvt_pk_bf16_f32 v57, v78, v86
    v_cvt_pk_bf16_f32 v65, v79, v87
    v_cvt_pk_bf16_f32 v69, v82, v90
    v_cvt_pk_bf16_f32 v73, v80, v88
    buffer_load_dwordx4 v[12:15], v95, s[8:11], s24 offen offset:0
    buffer_load_dwordx4 v[28:31], v95, s[8:11], s24 offen offset:64
    v_add_u32 v95, 128, v95
    v_lshlrev_b32 v76, 16, v50
    v_and_b32 v84, s25, v50
    v_lshlrev_b32 v77, 16, v54
    v_and_b32 v85, s25, v54
    v_lshlrev_b32 v78, 16, v58
    v_and_b32 v86, s25, v58
    v_lshlrev_b32 v79, 16, v62
    v_and_b32 v87, s25, v62
    v_add_f32 v80, v76, v78
    v_add_f32 v88, v84, v86
    v_add_f32 v81, v77, v79
    v_add_f32 v89, v85, v87
    v_fma_f32 v82, v78, 4.0, v76
    v_fma_f32 v90, v86, 4.0, v84
    v_fma_f32 v83, v79, 4.0, v77
    v_fma_f32 v91, v87, 4.0, v85
    v_add_f32 v77, v80, v81
    v_add_f32 v85, v88, v89
    v_sub_f32 v78, v80, v81
    v_sub_f32 v86, v88, v89
    v_fma_f32 v79, v83, 2.0, v82
    v_fma_f32 v87, v91, 2.0, v90
    v_fma_f32 v82, v83, -2.0, v82
    v_fma_f32 v90, v91, -2.0, v90
    v_fmamk_f32 v80, v76, 0x41700000, v82
    v_fmamk_f32 v88, v84, 0x41700000, v90
    v_fmamk_f32 v80, v81, 0x41200000, v80
    v_fmamk_f32 v88, v89, 0x41200000, v88
    v_cvt_pk_bf16_f32 v54, v77, v85
    v_cvt_pk_bf16_f32 v58, v78, v86
    v_cvt_pk_bf16_f32 v66, v79, v87
    v_cvt_pk_bf16_f32 v70, v82, v90
    v_cvt_pk_bf16_f32 v74, v80, v88
    v_lshlrev_b32 v76, 16, v51
    v_and_b32 v84, s25, v51
    v_lshlrev_b32 v77, 16, v55
    v_and_b32 v85, s25, v55
    v_lshlrev_b32 v78, 16, v59
    v_and_b32 v86, s25, v59
    v_lshlrev_b32 v79, 16, v63
    v_and_b32 v87, s25, v63
    v_add_f32 v80, v76, v78
    v_add_f32 v88, v84, v86
    v_add_f32 v81, v77, v79
    v_add_f32 v89, v85, v87
    v_fma_f32 v82, v78, 4.0, v76
    v_fma_f32 v90, v86, 4.0, v84
    v_fma_f32 v83, v79, 4.0, v77
    v_fma_f32 v91, v87, 4.0, v85
    v_add_f32 v77, v80, v81
    v_add_f32 v85, v88, v89
    v_sub_f32 v78, v80, v81
    v_sub_f32 v86, v88, v89
    v_fma_f32 v79, v83, 2.0, v82
    v_fma_f32 v87, v91, 2.0, v90
    v_fma_f32 v82, v83, -2.0, v82
    v_fma_f32 v90, v91, -2.0, v90
    v_fmamk_f32 v80, v76, 0x41700000, v82
    v_fmamk_f32 v88, v84, 0x41700000, v90
    v_fmamk_f32 v80, v81, 0x41200000, v80
    v_fmamk_f32 v88, v89, 0x41200000, v88
    v_cvt_pk_bf16_f32 v55, v77, v85
    v_cvt_pk_bf16_f32 v59, v78, v86
    v_cvt_pk_bf16_f32 v67, v79, v87
    v_cvt_pk_bf16_f32 v71, v82, v90
    v_cvt_pk_bf16_f32 v75, v80, v88
    s_add_u32 s28, s28, 1
    s_waitcnt lgkmcnt(0)
    s_barrier
    s_cmp_eq_u32 s22, 1
    s_cbranch_scc1 L_conv1_kernel_hlast2
    s_cmp_lt_u32 s28, 12
    s_cselect_b32 s24, 0, 2130706432
    ds_write_b128 v96, v[64:67] offset:57344
    ds_write_b128 v97, v[68:71] offset:8192
    ds_write_b128 v97, v[72:75] offset:24576
    ds_write_b128 v96, v[48:51] offset:8192
    ds_write_b128 v96, v[52:55] offset:24576
    ds_write_b128 v96, v[56:59] offset:40960
    ds_write_b128 v98, v[60:63] offset:8704
    s_waitcnt vmcnt(0)
    v_lshlrev_b32 v76, 16, v0
    v_and_b32 v84, s25, v0
    v_lshlrev_b32 v77, 16, v4
    v_and_b32 v85, s25, v4
    v_lshlrev_b32 v78, 16, v8
    v_and_b32 v86, s25, v8
    v_lshlrev_b32 v79, 16, v12
    v_and_b32 v87, s25, v12
    v_add_f32 v80, v76, v78
    v_add_f32 v88, v84, v86
    v_add_f32 v81, v77, v79
    v_add_f32 v89, v85, v87
    v_fma_f32 v82, v78, 4.0, v76
    v_fma_f32 v90, v86, 4.0, v84
    v_fma_f32 v83, v79, 4.0, v77
    v_fma_f32 v91, v87, 4.0, v85
    v_add_f32 v77, v80, v81
    v_add_f32 v85, v88, v89
    v_sub_f32 v78, v80, v81
    v_sub_f32 v86, v88, v89
    v_fma_f32 v79, v83, 2.0, v82
    v_fma_f32 v87, v91, 2.0, v90
    v_fma_f32 v82, v83, -2.0, v82
    v_fma_f32 v90, v91, -2.0, v90
    v_fmamk_f32 v80, v76, 0x41700000, v82
    v_fmamk_f32 v88, v84, 0x41700000, v90
    v_fmamk_f32 v80, v81, 0x41200000, v80
    v_fmamk_f32 v88, v89, 0x41200000, v88
    v_cvt_pk_bf16_f32 v4, v77, v85
    v_cvt_pk_bf16_f32 v8, v78, v86
    v_cvt_pk_bf16_f32 v64, v79, v87
    v_cvt_pk_bf16_f32 v68, v82, v90
    v_cvt_pk_bf16_f32 v72, v80, v88
    v_lshlrev_b32 v76, 16, v1
    v_and_b32 v84, s25, v1
    v_lshlrev_b32 v77, 16, v5
    v_and_b32 v85, s25, v5
    v_lshlrev_b32 v78, 16, v9
    v_and_b32 v86, s25, v9
    buffer_load_dwordx4 v[32:35], v92, s[8:11], s24 offen offset:0
    buffer_load_dwordx4 v[48:51], v92, s[8:11], s24 offen offset:64
    v_add_u32 v92, 128, v92
    v_lshlrev_b32 v79, 16, v13
    v_and_b32 v87, s25, v13
    v_add_f32 v80, v76, v78
    v_add_f32 v88, v84, v86
    v_add_f32 v81, v77, v79
    v_add_f32 v89, v85, v87
    v_fma_f32 v82, v78, 4.0, v76
    v_fma_f32 v90, v86, 4.0, v84
    v_fma_f32 v83, v79, 4.0, v77
    v_fma_f32 v91, v87, 4.0, v85
    v_add_f32 v77, v80, v81
    v_add_f32 v85, v88, v89
    v_sub_f32 v78, v80, v81
    v_sub_f32 v86, v88, v89
    v_fma_f32 v79, v83, 2.0, v82
    v_fma_f32 v87, v91, 2.0, v90
    v_fma_f32 v82, v83, -2.0, v82
    v_fma_f32 v90, v91, -2.0, v90
    v_fmamk_f32 v80, v76, 0x41700000, v82
    v_fmamk_f32 v88, v84, 0x41700000, v90
    v_fmamk_f32 v80, v81, 0x41200000, v80
    v_fmamk_f32 v88, v89, 0x41200000, v88
    v_cvt_pk_bf16_f32 v5, v77, v85
    v_cvt_pk_bf16_f32 v9, v78, v86
    v_cvt_pk_bf16_f32 v65, v79, v87
    v_cvt_pk_bf16_f32 v69, v82, v90
    v_cvt_pk_bf16_f32 v73, v80, v88
    buffer_load_dwordx4 v[36:39], v93, s[8:11], s24 offen offset:0
    buffer_load_dwordx4 v[52:55], v93, s[8:11], s24 offen offset:64
    v_add_u32 v93, 128, v93
    v_lshlrev_b32 v76, 16, v2
    v_and_b32 v84, s25, v2
    v_lshlrev_b32 v77, 16, v6
    v_and_b32 v85, s25, v6
    v_lshlrev_b32 v78, 16, v10
    v_and_b32 v86, s25, v10
    v_lshlrev_b32 v79, 16, v14
    v_and_b32 v87, s25, v14
    v_add_f32 v80, v76, v78
    v_add_f32 v88, v84, v86
    v_add_f32 v81, v77, v79
    v_add_f32 v89, v85, v87
    v_fma_f32 v82, v78, 4.0, v76
    v_fma_f32 v90, v86, 4.0, v84
    v_fma_f32 v83, v79, 4.0, v77
    v_fma_f32 v91, v87, 4.0, v85
    v_add_f32 v77, v80, v81
    v_add_f32 v85, v88, v89
    v_sub_f32 v78, v80, v81
    v_sub_f32 v86, v88, v89
    v_fma_f32 v79, v83, 2.0, v82
    v_fma_f32 v87, v91, 2.0, v90
    v_fma_f32 v82, v83, -2.0, v82
    v_fma_f32 v90, v91, -2.0, v90
    v_fmamk_f32 v80, v76, 0x41700000, v82
    v_fmamk_f32 v88, v84, 0x41700000, v90
    v_fmamk_f32 v80, v81, 0x41200000, v80
    v_fmamk_f32 v88, v89, 0x41200000, v88
    v_cvt_pk_bf16_f32 v6, v77, v85
    v_cvt_pk_bf16_f32 v10, v78, v86
    v_cvt_pk_bf16_f32 v66, v79, v87
    v_cvt_pk_bf16_f32 v70, v82, v90
    v_cvt_pk_bf16_f32 v74, v80, v88
    v_lshlrev_b32 v76, 16, v3
    v_and_b32 v84, s25, v3
    v_lshlrev_b32 v77, 16, v7
    v_and_b32 v85, s25, v7
    v_lshlrev_b32 v78, 16, v11
    v_and_b32 v86, s25, v11
    v_lshlrev_b32 v79, 16, v15
    v_and_b32 v87, s25, v15
    v_add_f32 v80, v76, v78
    v_add_f32 v88, v84, v86
    v_add_f32 v81, v77, v79
    v_add_f32 v89, v85, v87
    v_fma_f32 v82, v78, 4.0, v76
    v_fma_f32 v90, v86, 4.0, v84
    v_fma_f32 v83, v79, 4.0, v77
    v_fma_f32 v91, v87, 4.0, v85
    v_add_f32 v77, v80, v81
    v_add_f32 v85, v88, v89
    v_sub_f32 v78, v80, v81
    v_sub_f32 v86, v88, v89
    v_fma_f32 v79, v83, 2.0, v82
    v_fma_f32 v87, v91, 2.0, v90
    v_fma_f32 v82, v83, -2.0, v82
    v_fma_f32 v90, v91, -2.0, v90
    v_fmamk_f32 v80, v76, 0x41700000, v82
    v_fmamk_f32 v88, v84, 0x41700000, v90
    v_fmamk_f32 v80, v81, 0x41200000, v80
    v_fmamk_f32 v88, v89, 0x41200000, v88
    v_cvt_pk_bf16_f32 v7, v77, v85
    v_cvt_pk_bf16_f32 v11, v78, v86
    v_cvt_pk_bf16_f32 v67, v79, v87
    v_cvt_pk_bf16_f32 v71, v82, v90
    v_cvt_pk_bf16_f32 v75, v80, v88
    s_add_u32 s28, s28, 1
    s_waitcnt lgkmcnt(0)
    s_barrier
    s_cmp_lt_u32 s28, 12
    s_cselect_b32 s24, 0, 2130706432
    ds_write_b128 v96, v[64:67] offset:49152
    ds_write_b128 v97, v[68:71] offset:0
    ds_write_b128 v97, v[72:75] offset:16384
    ds_write_b128 v96, v[0:3] offset:0
    ds_write_b128 v96, v[4:7] offset:16384
    ds_write_b128 v96, v[8:11] offset:32768
    ds_write_b128 v98, v[12:15] offset:0
    v_lshlrev_b32 v76, 16, v16
    v_and_b32 v84, s25, v16
    v_lshlrev_b32 v77, 16, v20
    v_and_b32 v85, s25, v20
    v_lshlrev_b32 v78, 16, v24
    v_and_b32 v86, s25, v24
    v_lshlrev_b32 v79, 16, v28
    v_and_b32 v87, s25, v28
    v_add_f32 v80, v76, v78
    v_add_f32 v88, v84, v86
    v_add_f32 v81, v77, v79
    v_add_f32 v89, v85, v87
    v_fma_f32 v82, v78, 4.0, v76
    v_fma_f32 v90, v86, 4.0, v84
    v_fma_f32 v83, v79, 4.0, v77
    v_fma_f32 v91, v87, 4.0, v85
    v_add_f32 v77, v80, v81
    v_add_f32 v85, v88, v89
    v_sub_f32 v78, v80, v81
    v_sub_f32 v86, v88, v89
    v_fma_f32 v79, v83, 2.0, v82
    v_fma_f32 v87, v91, 2.0, v90
    v_fma_f32 v82, v83, -2.0, v82
    v_fma_f32 v90, v91, -2.0, v90
    v_fmamk_f32 v80, v76, 0x41700000, v82
    v_fmamk_f32 v88, v84, 0x41700000, v90
    v_fmamk_f32 v80, v81, 0x41200000, v80
    v_fmamk_f32 v88, v89, 0x41200000, v88
    v_cvt_pk_bf16_f32 v20, v77, v85
    v_cvt_pk_bf16_f32 v24, v78, v86
    v_cvt_pk_bf16_f32 v64, v79, v87
    v_cvt_pk_bf16_f32 v68, v82, v90
    v_cvt_pk_bf16_f32 v72, v80, v88
    v_lshlrev_b32 v76, 16, v17
    v_and_b32 v84, s25, v17
    v_lshlrev_b32 v77, 16, v21
    v_and_b32 v85, s25, v21
    v_lshlrev_b32 v78, 16, v25
    v_and_b32 v86, s25, v25
    buffer_load_dwordx4 v[40:43], v94, s[8:11], s24 offen offset:0
    buffer_load_dwordx4 v[56:59], v94, s[8:11], s24 offen offset:64
    v_add_u32 v94, 128, v94
    v_lshlrev_b32 v79, 16, v29
    v_and_b32 v87, s25, v29
    v_add_f32 v80, v76, v78
    v_add_f32 v88, v84, v86
    v_add_f32 v81, v77, v79
    v_add_f32 v89, v85, v87
    v_fma_f32 v82, v78, 4.0, v76
    v_fma_f32 v90, v86, 4.0, v84
    v_fma_f32 v83, v79, 4.0, v77
    v_fma_f32 v91, v87, 4.0, v85
    v_add_f32 v77, v80, v81
    v_add_f32 v85, v88, v89
    v_sub_f32 v78, v80, v81
    v_sub_f32 v86, v88, v89
    v_fma_f32 v79, v83, 2.0, v82
    v_fma_f32 v87, v91, 2.0, v90
    v_fma_f32 v82, v83, -2.0, v82
    v_fma_f32 v90, v91, -2.0, v90
    v_fmamk_f32 v80, v76, 0x41700000, v82
    v_fmamk_f32 v88, v84, 0x41700000, v90
    v_fmamk_f32 v80, v81, 0x41200000, v80
    v_fmamk_f32 v88, v89, 0x41200000, v88
    v_cvt_pk_bf16_f32 v21, v77, v85
    v_cvt_pk_bf16_f32 v25, v78, v86
    v_cvt_pk_bf16_f32 v65, v79, v87
    v_cvt_pk_bf16_f32 v69, v82, v90
    v_cvt_pk_bf16_f32 v73, v80, v88
    buffer_load_dwordx4 v[44:47], v95, s[8:11], s24 offen offset:0
    buffer_load_dwordx4 v[60:63], v95, s[8:11], s24 offen offset:64
    v_add_u32 v95, 128, v95
    v_lshlrev_b32 v76, 16, v18
    v_and_b32 v84, s25, v18
    v_lshlrev_b32 v77, 16, v22
    v_and_b32 v85, s25, v22
    v_lshlrev_b32 v78, 16, v26
    v_and_b32 v86, s25, v26
    v_lshlrev_b32 v79, 16, v30
    v_and_b32 v87, s25, v30
    v_add_f32 v80, v76, v78
    v_add_f32 v88, v84, v86
    v_add_f32 v81, v77, v79
    v_add_f32 v89, v85, v87
    v_fma_f32 v82, v78, 4.0, v76
    v_fma_f32 v90, v86, 4.0, v84
    v_fma_f32 v83, v79, 4.0, v77
    v_fma_f32 v91, v87, 4.0, v85
    v_add_f32 v77, v80, v81
    v_add_f32 v85, v88, v89
    v_sub_f32 v78, v80, v81
    v_sub_f32 v86, v88, v89
    v_fma_f32 v79, v83, 2.0, v82
    v_fma_f32 v87, v91, 2.0, v90
    v_fma_f32 v82, v83, -2.0, v82
    v_fma_f32 v90, v91, -2.0, v90
    v_fmamk_f32 v80, v76, 0x41700000, v82
    v_fmamk_f32 v88, v84, 0x41700000, v90
    v_fmamk_f32 v80, v81, 0x41200000, v80
    v_fmamk_f32 v88, v89, 0x41200000, v88
    v_cvt_pk_bf16_f32 v22, v77, v85
    v_cvt_pk_bf16_f32 v26, v78, v86
    v_cvt_pk_bf16_f32 v66, v79, v87
    v_cvt_pk_bf16_f32 v70, v82, v90
    v_cvt_pk_bf16_f32 v74, v80, v88
    v_lshlrev_b32 v76, 16, v19
    v_and_b32 v84, s25, v19
    v_lshlrev_b32 v77, 16, v23
    v_and_b32 v85, s25, v23
    v_lshlrev_b32 v78, 16, v27
    v_and_b32 v86, s25, v27
    v_lshlrev_b32 v79, 16, v31
    v_and_b32 v87, s25, v31
    v_add_f32 v80, v76, v78
    v_add_f32 v88, v84, v86
    v_add_f32 v81, v77, v79
    v_add_f32 v89, v85, v87
    v_fma_f32 v82, v78, 4.0, v76
    v_fma_f32 v90, v86, 4.0, v84
    v_fma_f32 v83, v79, 4.0, v77
    v_fma_f32 v91, v87, 4.0, v85
    v_add_f32 v77, v80, v81
    v_add_f32 v85, v88, v89
    v_sub_f32 v78, v80, v81
    v_sub_f32 v86, v88, v89
    v_fma_f32 v79, v83, 2.0, v82
    v_fma_f32 v87, v91, 2.0, v90
    v_fma_f32 v82, v83, -2.0, v82
    v_fma_f32 v90, v91, -2.0, v90
    v_fmamk_f32 v80, v76, 0x41700000, v82
    v_fmamk_f32 v88, v84, 0x41700000, v90
    v_fmamk_f32 v80, v81, 0x41200000, v80
    v_fmamk_f32 v88, v89, 0x41200000, v88
    v_cvt_pk_bf16_f32 v23, v77, v85
    v_cvt_pk_bf16_f32 v27, v78, v86
    v_cvt_pk_bf16_f32 v67, v79, v87
    v_cvt_pk_bf16_f32 v71, v82, v90
    v_cvt_pk_bf16_f32 v75, v80, v88
    s_add_u32 s28, s28, 1
    s_waitcnt lgkmcnt(0)
    s_barrier
    s_sub_u32 s22, s22, 1
    s_branch L_conv1_kernel_hloop2
L_conv1_kernel_hlast2:
    s_waitcnt vmcnt(0)
    s_mov_b32 s58, s20
    s_lshl_b32 s20, s2, 2
    s_add_u32 s20, s20, s32
    v_mov_b32 v1, v127
    s_load_dwordx2 s[8:9], s[0:1], 16
    s_lshr_b32 s22, s20, 8
    s_bfe_u32 s23, s20, 0x40004
    s_bfe_u32 s24, s20, 0x30001
    s_and_b32 s21, s20, 1
    v_lshrrev_b32 v2, 4, v1
    v_lshlrev_b32 v2, 12, v2
    v_and_b32 v3, 15, v1
    v_lshl_add_u32 v2, v3, 2, v2
    s_lshl_b32 s26, s22, 3
    s_lshr_b32 s27, s23, 3
    s_add_u32 s26, s26, s27
    s_lshl_b32 s26, s26, 17
    s_and_b32 s27, s23, 7
    s_lshl_b32 s27, s27, 14
    s_add_u32 s26, s26, s27
    s_lshl_b32 s27, s24, 6
    s_add_u32 s26, s26, s27
    s_mov_b32 s10, 4063232
    s_mov_b32 s11, 0x00020000
    s_add_u32 s37, s26, 262144
    s_add_u32 s38, s26, 524288
    s_add_u32 s39, s26, 786432
    s_waitcnt lgkmcnt(0)
    buffer_load_dword v16, v2, s[8:11], s26 offen offset:0
    buffer_load_dword v17, v2, s[8:11], s26 offen offset:512
    buffer_load_dword v24, v2, s[8:11], s37 offen offset:0
    buffer_load_dword v25, v2, s[8:11], s37 offen offset:512
    buffer_load_dword v32, v2, s[8:11], s38 offen offset:0
    buffer_load_dword v33, v2, s[8:11], s38 offen offset:512
    buffer_load_dword v40, v2, s[8:11], s39 offen offset:0
    buffer_load_dword v41, v2, s[8:11], s39 offen offset:512
    buffer_load_dword v18, v2, s[8:11], s26 offen offset:1024
    buffer_load_dword v19, v2, s[8:11], s26 offen offset:1536
    buffer_load_dword v26, v2, s[8:11], s37 offen offset:1024
    buffer_load_dword v27, v2, s[8:11], s37 offen offset:1536
    buffer_load_dword v34, v2, s[8:11], s38 offen offset:1024
    buffer_load_dword v35, v2, s[8:11], s38 offen offset:1536
    buffer_load_dword v42, v2, s[8:11], s39 offen offset:1024
    buffer_load_dword v43, v2, s[8:11], s39 offen offset:1536
    buffer_load_dword v20, v2, s[8:11], s26 offen offset:2048
    buffer_load_dword v21, v2, s[8:11], s26 offen offset:2560
    buffer_load_dword v28, v2, s[8:11], s37 offen offset:2048
    buffer_load_dword v29, v2, s[8:11], s37 offen offset:2560
    buffer_load_dword v36, v2, s[8:11], s38 offen offset:2048
    buffer_load_dword v37, v2, s[8:11], s38 offen offset:2560
    buffer_load_dword v44, v2, s[8:11], s39 offen offset:2048
    buffer_load_dword v45, v2, s[8:11], s39 offen offset:2560
    buffer_load_dword v22, v2, s[8:11], s26 offen offset:3072
    buffer_load_dword v23, v2, s[8:11], s26 offen offset:3584
    buffer_load_dword v30, v2, s[8:11], s37 offen offset:3072
    buffer_load_dword v31, v2, s[8:11], s37 offen offset:3584
    buffer_load_dword v38, v2, s[8:11], s38 offen offset:3072
    buffer_load_dword v39, v2, s[8:11], s38 offen offset:3584
    buffer_load_dword v46, v2, s[8:11], s39 offen offset:3072
    buffer_load_dword v47, v2, s[8:11], s39 offen offset:3584
    s_add_u32 s12, s30, 9437184
    s_addc_u32 s13, s31, 0
    s_mov_b32 s14, 7340032
    s_mov_b32 s15, 0x00020000
    v_lshlrev_b32 v4, 4, v1
    s_lshl_b32 s27, s24, 4
    s_add_u32 s27, s27, s23
    s_mul_i32 s27, s27, 57344
    s_lshl_b32 s28, s22, 11
    s_add_u32 s27, s27, s28
    s_lshl_b32 s28, s21, 10
    s_add_u32 s27, s27, s28
    s_cmp_eq_u32 s21, 0
    s_mov_b32 s32, 0x07060302
    s_cselect_b32 s32, 0x05040100, s32
    s_mov_b32 s33, 0x03020c0c
    s_cselect_b32 s33, 0x01000c0c, s33
    s_mov_b32 s35, 0x3d2aaaab
    s_mov_b32 s36, 0x3c638e39
    s_mov_b32 s25, 0xffff0000
    ds_write_b128 v96, v[64:67] offset:57344
    ds_write_b128 v97, v[68:71] offset:8192
    ds_write_b128 v97, v[72:75] offset:24576
    ds_write_b128 v96, v[48:51] offset:8192
    ds_write_b128 v96, v[52:55] offset:24576
    ds_write_b128 v96, v[56:59] offset:40960
    ds_write_b128 v98, v[60:63] offset:8704
    s_waitcnt lgkmcnt(0)
    s_barrier
    s_waitcnt vmcnt(24)
    v_perm_b32 v72, v17, v16, s32
    v_perm_b32 v48, v41, v40, s32
    v_perm_b32 v76, v76, v40, s33
    v_perm_b32 v84, v84, v41, s33
    v_perm_b32 v77, v77, v32, s33
    v_perm_b32 v85, v85, v33, s33
    v_perm_b32 v78, v78, v24, s33
    v_perm_b32 v86, v86, v25, s33
    v_perm_b32 v79, v79, v16, s33
    v_perm_b32 v87, v87, v17, s33
    v_add_f32 v80, v76, v78
    v_add_f32 v88, v84, v86
    v_add_f32 v81, v77, v79
    v_add_f32 v89, v85, v87
    v_fma_f32 v82, v78, 4.0, v76
    v_fma_f32 v90, v86, 4.0, v84
    v_fma_f32 v83, v79, 4.0, v77
    v_fma_f32 v91, v87, 4.0, v85
    v_add_f32 v77, v80, v81
    v_add_f32 v85, v88, v89
    v_sub_f32 v78, v80, v81
    v_sub_f32 v86, v88, v89
    v_fma_f32 v79, v83, 2.0, v82
    v_fma_f32 v87, v91, 2.0, v90
    v_fma_f32 v82, v83, -2.0, v82
    v_fma_f32 v90, v91, -2.0, v90
    v_fmamk_f32 v80, v76, 0x41700000, v82
    v_fmamk_f32 v88, v84, 0x41700000, v90
    v_fmamk_f32 v80, v81, 0x41200000, v80
    v_fmamk_f32 v88, v89, 0x41200000, v88
    v_mul_f32 v77, 0.5, v77
    v_mul_f32 v85, 0.5, v85
    v_mul_f32 v78, 0.5, v78
    v_mul_f32 v86, 0.5, v86
    v_mul_f32 v79, s35, v79
    v_mul_f32 v87, s35, v87
    v_mul_f32 v82, s35, v82
    v_mul_f32 v90, s35, v90
    v_mul_f32 v80, s36, v80
    v_mul_f32 v88, s36, v88
    v_cvt_pk_bf16_f32 v52, v77, v85
    v_cvt_pk_bf16_f32 v56, v78, v86
    v_cvt_pk_bf16_f32 v60, v79, v87
    v_cvt_pk_bf16_f32 v64, v82, v90
    v_cvt_pk_bf16_f32 v68, v80, v88
    s_waitcnt vmcnt(16)
    v_perm_b32 v73, v19, v18, s32
    v_perm_b32 v49, v43, v42, s32
    v_perm_b32 v76, v76, v42, s33
    v_perm_b32 v84, v84, v43, s33
    v_perm_b32 v77, v77, v34, s33
    v_perm_b32 v85, v85, v35, s33
    v_perm_b32 v78, v78, v26, s33
    v_perm_b32 v86, v86, v27, s33
    v_perm_b32 v79, v79, v18, s33
    v_perm_b32 v87, v87, v19, s33
    v_add_f32 v80, v76, v78
    v_add_f32 v88, v84, v86
    v_add_f32 v81, v77, v79
    v_add_f32 v89, v85, v87
    v_fma_f32 v82, v78, 4.0, v76
    v_fma_f32 v90, v86, 4.0, v84
    v_fma_f32 v83, v79, 4.0, v77
    v_fma_f32 v91, v87, 4.0, v85
    v_add_f32 v77, v80, v81
    v_add_f32 v85, v88, v89
    v_sub_f32 v78, v80, v81
    v_sub_f32 v86, v88, v89
    v_fma_f32 v79, v83, 2.0, v82
    v_fma_f32 v87, v91, 2.0, v90
    v_fma_f32 v82, v83, -2.0, v82
    v_fma_f32 v90, v91, -2.0, v90
    v_fmamk_f32 v80, v76, 0x41700000, v82
    v_fmamk_f32 v88, v84, 0x41700000, v90
    v_fmamk_f32 v80, v81, 0x41200000, v80
    v_fmamk_f32 v88, v89, 0x41200000, v88
    v_mul_f32 v77, 0.5, v77
    v_mul_f32 v85, 0.5, v85
    v_mul_f32 v78, 0.5, v78
    v_mul_f32 v86, 0.5, v86
    v_mul_f32 v79, s35, v79
    v_mul_f32 v87, s35, v87
    v_mul_f32 v82, s35, v82
    v_mul_f32 v90, s35, v90
    v_mul_f32 v80, s36, v80
    v_mul_f32 v88, s36, v88
    v_cvt_pk_bf16_f32 v53, v77, v85
    v_cvt_pk_bf16_f32 v57, v78, v86
    v_cvt_pk_bf16_f32 v61, v79, v87
    v_cvt_pk_bf16_f32 v65, v82, v90
    v_cvt_pk_bf16_f32 v69, v80, v88
    s_waitcnt vmcnt(8)
    v_perm_b32 v74, v21, v20, s32
    v_perm_b32 v50, v45, v44, s32
    v_perm_b32 v76, v76, v44, s33
    v_perm_b32 v84, v84, v45, s33
    v_perm_b32 v77, v77, v36, s33
    v_perm_b32 v85, v85, v37, s33
    v_perm_b32 v78, v78, v28, s33
    v_perm_b32 v86, v86, v29, s33
    v_perm_b32 v79, v79, v20, s33
    v_perm_b32 v87, v87, v21, s33
    v_add_f32 v80, v76, v78
    v_add_f32 v88, v84, v86
    v_add_f32 v81, v77, v79
    v_add_f32 v89, v85, v87
    v_fma_f32 v82, v78, 4.0, v76
    v_fma_f32 v90, v86, 4.0, v84
    v_fma_f32 v83, v79, 4.0, v77
    v_fma_f32 v91, v87, 4.0, v85
    v_add_f32 v77, v80, v81
    v_add_f32 v85, v88, v89
    v_sub_f32 v78, v80, v81
    v_sub_f32 v86, v88, v89
    v_fma_f32 v79, v83, 2.0, v82
    v_fma_f32 v87, v91, 2.0, v90
    v_fma_f32 v82, v83, -2.0, v82
    v_fma_f32 v90, v91, -2.0, v90
    v_fmamk_f32 v80, v76, 0x41700000, v82
    v_fmamk_f32 v88, v84, 0x41700000, v90
    v_fmamk_f32 v80, v81, 0x41200000, v80
    v_fmamk_f32 v88, v89, 0x41200000, v88
    v_mul_f32 v77, 0.5, v77
    v_mul_f32 v85, 0.5, v85
    v_mul_f32 v78, 0.5, v78
    v_mul_f32 v86, 0.5, v86
    v_mul_f32 v79, s35, v79
    v_mul_f32 v87, s35, v87
    v_mul_f32 v82, s35, v82
    v_mul_f32 v90, s35, v90
    v_mul_f32 v80, s36, v80
    v_mul_f32 v88, s36, v88
    v_cvt_pk_bf16_f32 v54, v77, v85
    v_cvt_pk_bf16_f32 v58, v78, v86
    v_cvt_pk_bf16_f32 v62, v79, v87
    v_cvt_pk_bf16_f32 v66, v82, v90
    v_cvt_pk_bf16_f32 v70, v80, v88
    s_waitcnt vmcnt(0)
    v_perm_b32 v75, v23, v22, s32
    v_perm_b32 v51, v47, v46, s32
    v_perm_b32 v76, v76, v46, s33
    v_perm_b32 v84, v84, v47, s33
    v_perm_b32 v77, v77, v38, s33
    v_perm_b32 v85, v85, v39, s33
    v_perm_b32 v78, v78, v30, s33
    v_perm_b32 v86, v86, v31, s33
    v_perm_b32 v79, v79, v22, s33
    v_perm_b32 v87, v87, v23, s33
    v_add_f32 v80, v76, v78
    v_add_f32 v88, v84, v86
    v_add_f32 v81, v77, v79
    v_add_f32 v89, v85, v87
    v_fma_f32 v82, v78, 4.0, v76
    v_fma_f32 v90, v86, 4.0, v84
    v_fma_f32 v83, v79, 4.0, v77
    v_fma_f32 v91, v87, 4.0, v85
    v_add_f32 v77, v80, v81
    v_add_f32 v85, v88, v89
    v_sub_f32 v78, v80, v81
    v_sub_f32 v86, v88, v89
    v_fma_f32 v79, v83, 2.0, v82
    v_fma_f32 v87, v91, 2.0, v90
    v_fma_f32 v82, v83, -2.0, v82
    v_fma_f32 v90, v91, -2.0, v90
    v_fmamk_f32 v80, v76, 0x41700000, v82
    v_fmamk_f32 v88, v84, 0x41700000, v90
    v_fmamk_f32 v80, v81, 0x41200000, v80
    v_fmamk_f32 v88, v89, 0x41200000, v88
    v_mul_f32 v77, 0.5, v77
    v_mul_f32 v85, 0.5, v85
    v_mul_f32 v78, 0.5, v78
    v_mul_f32 v86, 0.5, v86
    v_mul_f32 v79, s35, v79
    v_mul_f32 v87, s35, v87
    v_mul_f32 v82, s35, v82
    v_mul_f32 v90, s35, v90
    v_mul_f32 v80, s36, v80
    v_mul_f32 v88, s36, v88
    v_cvt_pk_bf16_f32 v55, v77, v85
    v_cvt_pk_bf16_f32 v59, v78, v86
    v_cvt_pk_bf16_f32 v63, v79, v87
    v_cvt_pk_bf16_f32 v67, v82, v90
    v_cvt_pk_bf16_f32 v71, v80, v88
    s_add_u32 s28, s27, 49152
    buffer_store_dwordx4 v[72:75], v4, s[12:15], s28 offen sc1
    s_add_u32 s28, s27, 0
    buffer_store_dwordx4 v[48:51], v4, s[12:15], s28 offen sc1
    s_add_u32 s28, s27, 8192
    buffer_store_dwordx4 v[52:55], v4, s[12:15], s28 offen sc1
    s_add_u32 s28, s27, 16384
    buffer_store_dwordx4 v[56:59], v4, s[12:15], s28 offen sc1
    s_add_u32 s28, s27, 24576
    buffer_store_dwordx4 v[60:63], v4, s[12:15], s28 offen sc1
    s_add_u32 s28, s27, 32768
    buffer_store_dwordx4 v[64:67], v4, s[12:15], s28 offen sc1
    s_add_u32 s28, s27, 40960
    buffer_store_dwordx4 v[68:71], v4, s[12:15], s28 offen sc1
    s_mov_b32 s20, s58
    s_branch L_conv1_kernel_end
L_conv1_kernel_mw:
    s_add_u32 s37, s41, 524288
    v_lshl_add_u32 v108, v127, 4, s37
    v_add_u32 v109, 1024, v108
    v_add_u32 v110, 2048, v108
    s_waitcnt lgkmcnt(0)
    s_add_u32 s8, s4, s47
    s_addc_u32 s9, s5, 0
    s_lshl_b32 s36, s29, 4
    s_lshl_b32 s37, s33, 3
    s_add_u32 s36, s36, s37
    s_mul_i32 s36, s36, 57344
    s_add_u32 s36, s36, 0
    s_add_u32 s12, s30, s36
    s_addc_u32 s13, s31, 0
    s_mov_b32 s14, 917504
    s_mov_b32 s15, 0x00020000
    s_mul_i32 s36, s35, 4194304
    s_add_u32 s36, s36, 18874368
    s_add_u32 s16, s30, s36
    s_addc_u32 s17, s31, 0
    s_mov_b32 s18, 4194304
    s_mov_b32 s19, 0x00020000
    v_and_b32 v10, 15, v127
    v_lshrrev_b32 v11, 4, v127
    v_add_u32 v8, 0, v10
    v_and_b32 v16, 4, v8
    v_lshrrev_b32 v16, 1, v16
    v_xor_b32 v16, v11, v16
    v_lshlrev_b32 v16, 4, v16
    v_lshl_add_u32 v8, v8, 6, v16
    v_add_u32 v9, 1, v10
    v_and_b32 v16, 4, v9
    v_lshrrev_b32 v16, 1, v16
    v_xor_b32 v16, v11, v16
    v_lshlrev_b32 v16, 4, v16
    v_lshl_add_u32 v9, v9, 6, v16
    s_lshr_b32 s38, s32, 1
    s_and_b32 s39, s32, 1
    s_add_u32 s40, s38, 4
    s_lshl_b32 s43, s39, 10
    s_cmp_lt_u32 s20, 4
    s_cselect_b32 s40, s20, s40
    s_cselect_b32 s36, 0, s43
    s_lshl_b32 s37, s40, 13
    s_add_u32 s37, s37, s36
    v_lshl_add_u32 v125, v127, 4, s37
    s_mul_i32 s37, s40, 16384
    v_add_u32 v120, s37, v8
    v_add_u32 v121, s37, v9
    s_lshl_b32 s37, s40, 10
    s_add_u32 s37, s37, 115712
    v_lshl_add_u32 v16, v11, 4, s37
    v_cmp_eq_u32 vcc, 15, v10
    v_mov_b32 v17, 8192
    v_mov_b32 v18, 4294959104
    v_mov_b32 v19, 64
    v_cndmask_b32 v122, v121, v16, vcc
    v_cndmask_b32 v123, v17, v19, vcc
    v_cndmask_b32 v124, v18, v19, vcc
    v_lshl_add_u32 v126, v127, 4, s37
    s_mov_b32 s44, 0x3f800000
    s_mov_b32 s45, 0x00000000
    s_mov_b32 s46, 0x00000000
    s_cmp_eq_u32 s40, 1
    s_cselect_b32 s45, 0x3f800000, s45
    s_cselect_b32 s46, 0x3f800000, s46
    s_cmp_eq_u32 s40, 2
    s_cselect_b32 s45, 0xbf800000, s45
    s_cselect_b32 s46, 0x3f800000, s46
    s_cmp_eq_u32 s40, 3
    s_cselect_b32 s45, 0x40000000, s45
    s_cselect_b32 s46, 0x40800000, s46
    s_cmp_eq_u32 s40, 4
    s_cselect_b32 s45, 0xc0000000, s45
    s_cselect_b32 s46, 0x40800000, s46
    s_cmp_eq_u32 s40, 5
    s_cselect_b32 s44, 0x41800000, s44
    s_cselect_b32 s45, 0x41000000, s45
    s_cselect_b32 s46, 0x40800000, s46
    s_cmp_ge_u32 s20, 4
    s_cbranch_scc1 L_conv1_kernel_m2
    v_mov_b32 v0, 0
    v_mov_b32 v1, 0
    v_mov_b32 v2, 0
    v_mov_b32 v3, 0
    v_mov_b32 v4, 0
    v_mov_b32 v5, 0
    v_mov_b32 v6, 0
    v_mov_b32 v7, 0
    v_mov_b32 v8, 0
    v_mov_b32 v9, 0
    v_mov_b32 v10, 0
    v_mov_b32 v11, 0
    v_mov_b32 v12, 0
    v_mov_b32 v13, 0
    v_mov_b32 v14, 0
    v_mov_b32 v15, 0
    v_mov_b32 v16, 0
    v_mov_b32 v17, 0
    v_mov_b32 v18, 0
    v_mov_b32 v19, 0
    v_mov_b32 v20, 0
    v_mov_b32 v21, 0
    v_mov_b32 v22, 0
    v_mov_b32 v23, 0
    v_mov_b32 v24, 0
    v_mov_b32 v25, 0
    v_mov_b32 v26, 0
    v_mov_b32 v27, 0
    v_mov_b32 v28, 0
    v_mov_b32 v29, 0
    v_mov_b32 v30, 0
    v_mov_b32 v31, 0
    v_mov_b32 v32, 0
    v_mov_b32 v33, 0
    v_mov_b32 v34, 0
    v_mov_b32 v35, 0
    v_mov_b32 v36, 0
    v_mov_b32 v37, 0
    v_mov_b32 v38, 0
    v_mov_b32 v39, 0
    v_mov_b32 v40, 0
    v_mov_b32 v41, 0
    v_mov_b32 v42, 0
    v_mov_b32 v43, 0
    v_mov_b32 v44, 0
    v_mov_b32 v45, 0
    v_mov_b32 v46, 0
    v_mov_b32 v47, 0
    v_mov_b32 v48, 0
    v_mov_b32 v49, 0
    v_mov_b32 v50, 0
    v_mov_b32 v51, 0
    v_mov_b32 v52, 0
    v_mov_b32 v53, 0
    v_mov_b32 v54, 0
    v_mov_b32 v55, 0
    v_mov_b32 v56, 0
    v_mov_b32 v57, 0
    v_mov_b32 v58, 0
    v_mov_b32 v59, 0
    v_mov_b32 v60, 0
    v_mov_b32 v61, 0
    v_mov_b32 v62, 0
    v_mov_b32 v63, 0
    buffer_load_dwordx4 v[96:99], v108, s[8:11], 0 offen
    buffer_load_dwordx4 v[100:103], v109, s[8:11], 0 offen
    buffer_load_dwordx4 v[104:107], v110, s[8:11], 0 offen
    s_mov_b32 s23, 0
    s_mov_b32 s26, 4096
    buffer_load_dwordx4 v[64:67], v125, s[12:15], s23 offen offset:0
    buffer_load_dwordx4 v[68:71], v125, s[12:15], s23 offen offset:1024
    buffer_load_dwordx4 v[72:75], v125, s[12:15], s23 offen offset:2048
    buffer_load_dwordx4 v[76:79], v125, s[12:15], s23 offen offset:3072
    buffer_load_dwordx4 v[80:83], v125, s[12:15], s26 offen offset:0
    buffer_load_dwordx4 v[84:87], v125, s[12:15], s26 offen offset:1024
    buffer_load_dwordx4 v[88:91], v125, s[12:15], s26 offen offset:2048
    buffer_load_dwordx4 v[92:95], v125, s[12:15], s26 offen offset:3072
    s_mov_b32 s23, 57344
    s_mov_b32 s26, 61440
    s_waitcnt vmcnt(8)
    v_lshlrev_b32 v108, 16, v96
    v_and_b32 v111, s25, v96
    v_lshlrev_b32 v109, 16, v100
    v_and_b32 v112, s25, v100
    v_lshlrev_b32 v110, 16, v104
    v_and_b32 v113, s25, v104
    v_mul_f32 v114, s44, v108
    v_mul_f32 v115, s44, v111
    v_fmac_f32 v114, s45, v109
    v_fmac_f32 v115, s45, v112
    v_fmac_f32 v114, s46, v110
    v_fmac_f32 v115, s46, v113
    v_cvt_pk_bf16_f32 v96, v114, v115
    v_lshlrev_b32 v108, 16, v97
    v_and_b32 v111, s25, v97
    v_lshlrev_b32 v109, 16, v101
    v_and_b32 v112, s25, v101
    v_lshlrev_b32 v110, 16, v105
    v_and_b32 v113, s25, v105
    v_mul_f32 v114, s44, v108
    v_mul_f32 v115, s44, v111
    v_fmac_f32 v114, s45, v109
    v_fmac_f32 v115, s45, v112
    v_fmac_f32 v114, s46, v110
    v_fmac_f32 v115, s46, v113
    v_cvt_pk_bf16_f32 v97, v114, v115
    v_lshlrev_b32 v108, 16, v98
    v_and_b32 v111, s25, v98
    v_lshlrev_b32 v109, 16, v102
    v_and_b32 v112, s25, v102
    v_lshlrev_b32 v110, 16, v106
    v_and_b32 v113, s25, v106
    v_mul_f32 v114, s44, v108
    v_mul_f32 v115, s44, v111
    v_fmac_f32 v114, s45, v109
    v_fmac_f32 v115, s45, v112
    v_fmac_f32 v114, s46, v110
    v_fmac_f32 v115, s46, v113
    v_cvt_pk_bf16_f32 v98, v114, v115
    v_lshlrev_b32 v108, 16, v99
    v_and_b32 v111, s25, v99
    v_lshlrev_b32 v109, 16, v103
    v_and_b32 v112, s25, v103
    v_lshlrev_b32 v110, 16, v107
    v_and_b32 v113, s25, v107
    v_mul_f32 v114, s44, v108
    v_mul_f32 v115, s44, v111
    v_fmac_f32 v114, s45, v109
    v_fmac_f32 v115, s45, v112
    v_fmac_f32 v114, s46, v110
    v_fmac_f32 v115, s46, v113
    v_cvt_pk_bf16_f32 v99, v114, v115
    ds_write_b128 v126, v[96:99]
    s_waitcnt lgkmcnt(0)
    s_barrier
    s_mov_b32 s22, 8
    s_setprio 2
L_conv1_kernel_mloop1:
    ds_read_b128 v[96:99], v120 offset:0
    ds_read_b128 v[100:103], v120 offset:1024
    ds_read_b128 v[104:107], v120 offset:2048
    ds_read_b128 v[108:111], v120 offset:3072
    ds_read_b128 v[112:115], v120 offset:4096
    ds_read_b128 v[116:119], v120 offset:5120
    s_waitcnt vmcnt(6) lgkmcnt(5)
    v_mfma_f32_16x16x32_bf16 v[0:3], v[64:67], v[96:99], v[0:3]
    v_mfma_f32_16x16x32_bf16 v[32:35], v[68:71], v[96:99], v[32:35]
    ds_read_b128 v[96:99], v120 offset:6144
    s_waitcnt vmcnt(4) lgkmcnt(5)
    v_mfma_f32_16x16x32_bf16 v[4:7], v[64:67], v[100:103], v[4:7]
    v_mfma_f32_16x16x32_bf16 v[36:39], v[68:71], v[100:103], v[36:39]
    v_mfma_f32_16x16x32_bf16 v[0:3], v[72:75], v[100:103], v[0:3]
    v_mfma_f32_16x16x32_bf16 v[32:35], v[76:79], v[100:103], v[32:35]
    ds_read_b128 v[100:103], v120 offset:7168
    s_waitcnt vmcnt(2) lgkmcnt(5)
    v_mfma_f32_16x16x32_bf16 v[8:11], v[64:67], v[104:107], v[8:11]
    v_mfma_f32_16x16x32_bf16 v[40:43], v[68:71], v[104:107], v[40:43]
    v_mfma_f32_16x16x32_bf16 v[4:7], v[72:75], v[104:107], v[4:7]
    v_mfma_f32_16x16x32_bf16 v[36:39], v[76:79], v[104:107], v[36:39]
    v_mfma_f32_16x16x32_bf16 v[0:3], v[80:83], v[104:107], v[0:3]
    v_mfma_f32_16x16x32_bf16 v[32:35], v[84:87], v[104:107], v[32:35]
    ds_read_b128 v[104:107], v122 offset:0
    v_add_u32 v122, v123, v122
    s_waitcnt vmcnt(0) lgkmcnt(5)
    v_mfma_f32_16x16x32_bf16 v[12:15], v[64:67], v[108:111], v[12:15]
    v_mfma_f32_16x16x32_bf16 v[44:47], v[68:71], v[108:111], v[44:47]
    v_mfma_f32_16x16x32_bf16 v[8:11], v[72:75], v[108:111], v[8:11]
    v_mfma_f32_16x16x32_bf16 v[40:43], v[76:79], v[108:111], v[40:43]
    v_mfma_f32_16x16x32_bf16 v[4:7], v[80:83], v[108:111], v[4:7]
    v_mfma_f32_16x16x32_bf16 v[36:39], v[84:87], v[108:111], v[36:39]
    v_mfma_f32_16x16x32_bf16 v[0:3], v[88:91], v[108:111], v[0:3]
    v_mfma_f32_16x16x32_bf16 v[32:35], v[92:95], v[108:111], v[32:35]
    ds_read_b128 v[108:111], v121 offset:1024
    s_waitcnt lgkmcnt(5)
    v_mfma_f32_16x16x32_bf16 v[16:19], v[64:67], v[112:115], v[16:19]
    v_mfma_f32_16x16x32_bf16 v[48:51], v[68:71], v[112:115], v[48:51]
    v_mfma_f32_16x16x32_bf16 v[12:15], v[72:75], v[112:115], v[12:15]
    v_mfma_f32_16x16x32_bf16 v[44:47], v[76:79], v[112:115], v[44:47]
    v_mfma_f32_16x16x32_bf16 v[8:11], v[80:83], v[112:115], v[8:11]
    v_mfma_f32_16x16x32_bf16 v[40:43], v[84:87], v[112:115], v[40:43]
    v_mfma_f32_16x16x32_bf16 v[4:7], v[88:91], v[112:115], v[4:7]
    v_mfma_f32_16x16x32_bf16 v[36:39], v[92:95], v[112:115], v[36:39]
    ds_read_b128 v[112:115], v121 offset:2048
    s_waitcnt lgkmcnt(5)
    v_mfma_f32_16x16x32_bf16 v[20:23], v[64:67], v[116:119], v[20:23]
    v_mfma_f32_16x16x32_bf16 v[52:55], v[68:71], v[116:119], v[52:55]
    v_mfma_f32_16x16x32_bf16 v[16:19], v[72:75], v[116:119], v[16:19]
    v_mfma_f32_16x16x32_bf16 v[48:51], v[76:79], v[116:119], v[48:51]
    v_mfma_f32_16x16x32_bf16 v[12:15], v[80:83], v[116:119], v[12:15]
    v_mfma_f32_16x16x32_bf16 v[44:47], v[84:87], v[116:119], v[44:47]
    v_mfma_f32_16x16x32_bf16 v[8:11], v[88:91], v[116:119], v[8:11]
    v_mfma_f32_16x16x32_bf16 v[40:43], v[92:95], v[116:119], v[40:43]
    s_waitcnt lgkmcnt(4)
    v_mfma_f32_16x16x32_bf16 v[24:27], v[64:67], v[96:99], v[24:27]
    v_mfma_f32_16x16x32_bf16 v[56:59], v[68:71], v[96:99], v[56:59]
    v_mfma_f32_16x16x32_bf16 v[20:23], v[72:75], v[96:99], v[20:23]
    v_mfma_f32_16x16x32_bf16 v[52:55], v[76:79], v[96:99], v[52:55]
    v_mfma_f32_16x16x32_bf16 v[16:19], v[80:83], v[96:99], v[16:19]
    v_mfma_f32_16x16x32_bf16 v[48:51], v[84:87], v[96:99], v[48:51]
    v_mfma_f32_16x16x32_bf16 v[12:15], v[88:91], v[96:99], v[12:15]
    v_mfma_f32_16x16x32_bf16 v[44:47], v[92:95], v[96:99], v[44:47]
    s_waitcnt lgkmcnt(3)
    v_mfma_f32_16x16x32_bf16 v[28:31], v[64:67], v[100:103], v[28:31]
    v_mfma_f32_16x16x32_bf16 v[60:63], v[68:71], v[100:103], v[60:63]
    v_mfma_f32_16x16x32_bf16 v[24:27], v[72:75], v[100:103], v[24:27]
    v_mfma_f32_16x16x32_bf16 v[56:59], v[76:79], v[100:103], v[56:59]
    v_mfma_f32_16x16x32_bf16 v[20:23], v[80:83], v[100:103], v[20:23]
    v_mfma_f32_16x16x32_bf16 v[52:55], v[84:87], v[100:103], v[52:55]
    v_mfma_f32_16x16x32_bf16 v[16:19], v[88:91], v[100:103], v[16:19]
    v_mfma_f32_16x16x32_bf16 v[48:51], v[92:95], v[100:103], v[48:51]
    buffer_load_dwordx4 v[64:67], v125, s[12:15], s23 offen offset:0
    buffer_load_dwordx4 v[68:71], v125, s[12:15], s23 offen offset:1024
    s_waitcnt lgkmcnt(2)
    v_mfma_f32_16x16x32_bf16 v[28:31], v[72:75], v[104:107], v[28:31]
    v_mfma_f32_16x16x32_bf16 v[60:63], v[76:79], v[104:107], v[60:63]
    v_mfma_f32_16x16x32_bf16 v[24:27], v[80:83], v[104:107], v[24:27]
    v_mfma_f32_16x16x32_bf16 v[56:59], v[84:87], v[104:107], v[56:59]
    v_mfma_f32_16x16x32_bf16 v[20:23], v[88:91], v[104:107], v[20:23]
    v_mfma_f32_16x16x32_bf16 v[52:55], v[92:95], v[104:107], v[52:55]
    buffer_load_dwordx4 v[72:75], v125, s[12:15], s23 offen offset:2048
    buffer_load_dwordx4 v[76:79], v125, s[12:15], s23 offen offset:3072
    s_waitcnt lgkmcnt(1)
    v_mfma_f32_16x16x32_bf16 v[28:31], v[80:83], v[108:111], v[28:31]
    v_mfma_f32_16x16x32_bf16 v[60:63], v[84:87], v[108:111], v[60:63]
    v_mfma_f32_16x16x32_bf16 v[24:27], v[88:91], v[108:111], v[24:27]
    v_mfma_f32_16x16x32_bf16 v[56:59], v[92:95], v[108:111], v[56:59]
    buffer_load_dwordx4 v[80:83], v125, s[12:15], s26 offen offset:0
    buffer_load_dwordx4 v[84:87], v125, s[12:15], s26 offen offset:1024
    s_waitcnt lgkmcnt(0)
    v_mfma_f32_16x16x32_bf16 v[28:31], v[88:91], v[112:115], v[28:31]
    v_mfma_f32_16x16x32_bf16 v[60:63], v[92:95], v[112:115], v[60:63]
    buffer_load_dwordx4 v[88:91], v125, s[12:15], s26 offen offset:2048
    buffer_load_dwordx4 v[92:95], v125, s[12:15], s26 offen offset:3072
    s_add_u32 s23, s23, 57344
    s_add_u32 s26, s26, 57344
    s_barrier
    s_sub_u32 s22, s22, 1
    s_cmp_eq_u32 s22, 0
    s_cbranch_scc1 L_conv1_kernel_mlast1
    ds_read_b128 v[96:99], v120 offset:8192
    ds_read_b128 v[100:103], v120 offset:9216
    ds_read_b128 v[104:107], v120 offset:10240
    ds_read_b128 v[108:111], v120 offset:11264
    ds_read_b128 v[112:115], v120 offset:12288
    ds_read_b128 v[116:119], v120 offset:13312
    s_waitcnt vmcnt(6) lgkmcnt(5)
    v_mfma_f32_16x16x32_bf16 v[0:3], v[64:67], v[96:99], v[0:3]
    v_mfma_f32_16x16x32_bf16 v[32:35], v[68:71], v[96:99], v[32:35]
    ds_read_b128 v[96:99], v120 offset:14336
    s_waitcnt vmcnt(4) lgkmcnt(5)
    v_mfma_f32_16x16x32_bf16 v[4:7], v[64:67], v[100:103], v[4:7]
    v_mfma_f32_16x16x32_bf16 v[36:39], v[68:71], v[100:103], v[36:39]
    v_mfma_f32_16x16x32_bf16 v[0:3], v[72:75], v[100:103], v[0:3]
    v_mfma_f32_16x16x32_bf16 v[32:35], v[76:79], v[100:103], v[32:35]
    ds_read_b128 v[100:103], v120 offset:15360
    s_waitcnt vmcnt(2) lgkmcnt(5)
    v_mfma_f32_16x16x32_bf16 v[8:11], v[64:67], v[104:107], v[8:11]
    v_mfma_f32_16x16x32_bf16 v[40:43], v[68:71], v[104:107], v[40:43]
    v_mfma_f32_16x16x32_bf16 v[4:7], v[72:75], v[104:107], v[4:7]
    v_mfma_f32_16x16x32_bf16 v[36:39], v[76:79], v[104:107], v[36:39]
    v_mfma_f32_16x16x32_bf16 v[0:3], v[80:83], v[104:107], v[0:3]
    v_mfma_f32_16x16x32_bf16 v[32:35], v[84:87], v[104:107], v[32:35]
    ds_read_b128 v[104:107], v122 offset:0
    v_add_u32 v122, v124, v122
    s_waitcnt vmcnt(0) lgkmcnt(5)
    v_mfma_f32_16x16x32_bf16 v[12:15], v[64:67], v[108:111], v[12:15]
    v_mfma_f32_16x16x32_bf16 v[44:47], v[68:71], v[108:111], v[44:47]
    v_mfma_f32_16x16x32_bf16 v[8:11], v[72:75], v[108:111], v[8:11]
    v_mfma_f32_16x16x32_bf16 v[40:43], v[76:79], v[108:111], v[40:43]
    v_mfma_f32_16x16x32_bf16 v[4:7], v[80:83], v[108:111], v[4:7]
    v_mfma_f32_16x16x32_bf16 v[36:39], v[84:87], v[108:111], v[36:39]
    v_mfma_f32_16x16x32_bf16 v[0:3], v[88:91], v[108:111], v[0:3]
    v_mfma_f32_16x16x32_bf16 v[32:35], v[92:95], v[108:111], v[32:35]
    ds_read_b128 v[108:111], v121 offset:9216
    s_waitcnt lgkmcnt(5)
    v_mfma_f32_16x16x32_bf16 v[16:19], v[64:67], v[112:115], v[16:19]
    v_mfma_f32_16x16x32_bf16 v[48:51], v[68:71], v[112:115], v[48:51]
    v_mfma_f32_16x16x32_bf16 v[12:15], v[72:75], v[112:115], v[12:15]
    v_mfma_f32_16x16x32_bf16 v[44:47], v[76:79], v[112:115], v[44:47]
    v_mfma_f32_16x16x32_bf16 v[8:11], v[80:83], v[112:115], v[8:11]
    v_mfma_f32_16x16x32_bf16 v[40:43], v[84:87], v[112:115], v[40:43]
    v_mfma_f32_16x16x32_bf16 v[4:7], v[88:91], v[112:115], v[4:7]
    v_mfma_f32_16x16x32_bf16 v[36:39], v[92:95], v[112:115], v[36:39]
    ds_read_b128 v[112:115], v121 offset:10240
    s_waitcnt lgkmcnt(5)
    v_mfma_f32_16x16x32_bf16 v[20:23], v[64:67], v[116:119], v[20:23]
    v_mfma_f32_16x16x32_bf16 v[52:55], v[68:71], v[116:119], v[52:55]
    v_mfma_f32_16x16x32_bf16 v[16:19], v[72:75], v[116:119], v[16:19]
    v_mfma_f32_16x16x32_bf16 v[48:51], v[76:79], v[116:119], v[48:51]
    v_mfma_f32_16x16x32_bf16 v[12:15], v[80:83], v[116:119], v[12:15]
    v_mfma_f32_16x16x32_bf16 v[44:47], v[84:87], v[116:119], v[44:47]
    v_mfma_f32_16x16x32_bf16 v[8:11], v[88:91], v[116:119], v[8:11]
    v_mfma_f32_16x16x32_bf16 v[40:43], v[92:95], v[116:119], v[40:43]
    s_waitcnt lgkmcnt(4)
    v_mfma_f32_16x16x32_bf16 v[24:27], v[64:67], v[96:99], v[24:27]
    v_mfma_f32_16x16x32_bf16 v[56:59], v[68:71], v[96:99], v[56:59]
    v_mfma_f32_16x16x32_bf16 v[20:23], v[72:75], v[96:99], v[20:23]
    v_mfma_f32_16x16x32_bf16 v[52:55], v[76:79], v[96:99], v[52:55]
    v_mfma_f32_16x16x32_bf16 v[16:19], v[80:83], v[96:99], v[16:19]
    v_mfma_f32_16x16x32_bf16 v[48:51], v[84:87], v[96:99], v[48:51]
    v_mfma_f32_16x16x32_bf16 v[12:15], v[88:91], v[96:99], v[12:15]
    v_mfma_f32_16x16x32_bf16 v[44:47], v[92:95], v[96:99], v[44:47]
    s_waitcnt lgkmcnt(3)
    v_mfma_f32_16x16x32_bf16 v[28:31], v[64:67], v[100:103], v[28:31]
    v_mfma_f32_16x16x32_bf16 v[60:63], v[68:71], v[100:103], v[60:63]
    v_mfma_f32_16x16x32_bf16 v[24:27], v[72:75], v[100:103], v[24:27]
    v_mfma_f32_16x16x32_bf16 v[56:59], v[76:79], v[100:103], v[56:59]
    v_mfma_f32_16x16x32_bf16 v[20:23], v[80:83], v[100:103], v[20:23]
    v_mfma_f32_16x16x32_bf16 v[52:55], v[84:87], v[100:103], v[52:55]
    v_mfma_f32_16x16x32_bf16 v[16:19], v[88:91], v[100:103], v[16:19]
    v_mfma_f32_16x16x32_bf16 v[48:51], v[92:95], v[100:103], v[48:51]
    buffer_load_dwordx4 v[64:67], v125, s[12:15], s23 offen offset:0
    buffer_load_dwordx4 v[68:71], v125, s[12:15], s23 offen offset:1024
    s_waitcnt lgkmcnt(2)
    v_mfma_f32_16x16x32_bf16 v[28:31], v[72:75], v[104:107], v[28:31]
    v_mfma_f32_16x16x32_bf16 v[60:63], v[76:79], v[104:107], v[60:63]
    v_mfma_f32_16x16x32_bf16 v[24:27], v[80:83], v[104:107], v[24:27]
    v_mfma_f32_16x16x32_bf16 v[56:59], v[84:87], v[104:107], v[56:59]
    v_mfma_f32_16x16x32_bf16 v[20:23], v[88:91], v[104:107], v[20:23]
    v_mfma_f32_16x16x32_bf16 v[52:55], v[92:95], v[104:107], v[52:55]
    buffer_load_dwordx4 v[72:75], v125, s[12:15], s23 offen offset:2048
    buffer_load_dwordx4 v[76:79], v125, s[12:15], s23 offen offset:3072
    s_waitcnt lgkmcnt(1)
    v_mfma_f32_16x16x32_bf16 v[28:31], v[80:83], v[108:111], v[28:31]
    v_mfma_f32_16x16x32_bf16 v[60:63], v[84:87], v[108:111], v[60:63]
    v_mfma_f32_16x16x32_bf16 v[24:27], v[88:91], v[108:111], v[24:27]
    v_mfma_f32_16x16x32_bf16 v[56:59], v[92:95], v[108:111], v[56:59]
    buffer_load_dwordx4 v[80:83], v125, s[12:15], s26 offen offset:0
    buffer_load_dwordx4 v[84:87], v125, s[12:15], s26 offen offset:1024
    s_waitcnt lgkmcnt(0)
    v_mfma_f32_16x16x32_bf16 v[28:31], v[88:91], v[112:115], v[28:31]
    v_mfma_f32_16x16x32_bf16 v[60:63], v[92:95], v[112:115], v[60:63]
    buffer_load_dwordx4 v[88:91], v125, s[12:15], s26 offen offset:2048
    buffer_load_dwordx4 v[92:95], v125, s[12:15], s26 offen offset:3072
    s_add_u32 s23, s23, 57344
    s_add_u32 s26, s26, 57344
    s_barrier
    s_branch L_conv1_kernel_mloop1
L_conv1_kernel_mlast1:
    v_and_b32 v125, 15, v127
    v_and_b32 v126, 7, v127
    v_lshlrev_b32 v126, 4, v126
    v_lshl_add_u32 v125, v125, 7, v126
    v_lshrrev_b32 v126, 4, v127
    v_lshl_add_u32 v125, v126, 11, v125
    s_lshl_b32 s36, s20, 14
    s_add_u32 s37, s36, 8192
    v_add_u32 v126, s37, v125
    v_add_u32 v125, s36, v125
    ds_read_b128 v[96:99], v120 offset:8192
    ds_read_b128 v[100:103], v120 offset:9216
    ds_read_b128 v[104:107], v120 offset:10240
    ds_read_b128 v[108:111], v120 offset:11264
    ds_read_b128 v[112:115], v120 offset:12288
    ds_read_b128 v[116:119], v120 offset:13312
    s_waitcnt vmcnt(6) lgkmcnt(5)
    v_mfma_f32_16x16x32_bf16 v[0:3], v[64:67], v[96:99], v[0:3]
    v_mfma_f32_16x16x32_bf16 v[32:35], v[68:71], v[96:99], v[32:35]
    ds_read_b128 v[96:99], v120 offset:14336
    s_waitcnt vmcnt(4) lgkmcnt(5)
    v_mfma_f32_16x16x32_bf16 v[4:7], v[64:67], v[100:103], v[4:7]
    v_mfma_f32_16x16x32_bf16 v[36:39], v[68:71], v[100:103], v[36:39]
    v_mfma_f32_16x16x32_bf16 v[0:3], v[72:75], v[100:103], v[0:3]
    v_mfma_f32_16x16x32_bf16 v[32:35], v[76:79], v[100:103], v[32:35]
    ds_read_b128 v[100:103], v120 offset:15360
    s_waitcnt vmcnt(2) lgkmcnt(5)
    v_mfma_f32_16x16x32_bf16 v[8:11], v[64:67], v[104:107], v[8:11]
    v_mfma_f32_16x16x32_bf16 v[40:43], v[68:71], v[104:107], v[40:43]
    v_mfma_f32_16x16x32_bf16 v[4:7], v[72:75], v[104:107], v[4:7]
    v_mfma_f32_16x16x32_bf16 v[36:39], v[76:79], v[104:107], v[36:39]
    v_mfma_f32_16x16x32_bf16 v[0:3], v[80:83], v[104:107], v[0:3]
    v_mfma_f32_16x16x32_bf16 v[32:35], v[84:87], v[104:107], v[32:35]
    ds_read_b128 v[104:107], v122 offset:0
    s_waitcnt vmcnt(0) lgkmcnt(5)
    v_mfma_f32_16x16x32_bf16 v[12:15], v[64:67], v[108:111], v[12:15]
    v_mfma_f32_16x16x32_bf16 v[44:47], v[68:71], v[108:111], v[44:47]
    v_mfma_f32_16x16x32_bf16 v[8:11], v[72:75], v[108:111], v[8:11]
    v_mfma_f32_16x16x32_bf16 v[40:43], v[76:79], v[108:111], v[40:43]
    v_mfma_f32_16x16x32_bf16 v[4:7], v[80:83], v[108:111], v[4:7]
    v_mfma_f32_16x16x32_bf16 v[36:39], v[84:87], v[108:111], v[36:39]
    v_mfma_f32_16x16x32_bf16 v[0:3], v[88:91], v[108:111], v[0:3]
    v_mfma_f32_16x16x32_bf16 v[32:35], v[92:95], v[108:111], v[32:35]
    ds_read_b128 v[108:111], v121 offset:9216
    s_waitcnt lgkmcnt(5)
    v_mfma_f32_16x16x32_bf16 v[16:19], v[64:67], v[112:115], v[16:19]
    v_mfma_f32_16x16x32_bf16 v[48:51], v[68:71], v[112:115], v[48:51]
    v_mfma_f32_16x16x32_bf16 v[12:15], v[72:75], v[112:115], v[12:15]
    v_mfma_f32_16x16x32_bf16 v[44:47], v[76:79], v[112:115], v[44:47]
    v_mfma_f32_16x16x32_bf16 v[8:11], v[80:83], v[112:115], v[8:11]
    v_mfma_f32_16x16x32_bf16 v[40:43], v[84:87], v[112:115], v[40:43]
    v_mfma_f32_16x16x32_bf16 v[4:7], v[88:91], v[112:115], v[4:7]
    v_mfma_f32_16x16x32_bf16 v[36:39], v[92:95], v[112:115], v[36:39]
    ds_read_b128 v[112:115], v121 offset:10240
    v_xor_b32 v123, 0, v125
    ds_write_b128 v123, v[0:3]
    s_waitcnt lgkmcnt(6)
    v_mfma_f32_16x16x32_bf16 v[20:23], v[64:67], v[116:119], v[20:23]
    v_mfma_f32_16x16x32_bf16 v[52:55], v[68:71], v[116:119], v[52:55]
    v_mfma_f32_16x16x32_bf16 v[16:19], v[72:75], v[116:119], v[16:19]
    v_mfma_f32_16x16x32_bf16 v[48:51], v[76:79], v[116:119], v[48:51]
    v_mfma_f32_16x16x32_bf16 v[12:15], v[80:83], v[116:119], v[12:15]
    v_mfma_f32_16x16x32_bf16 v[44:47], v[84:87], v[116:119], v[44:47]
    v_mfma_f32_16x16x32_bf16 v[8:11], v[88:91], v[116:119], v[8:11]
    v_mfma_f32_16x16x32_bf16 v[40:43], v[92:95], v[116:119], v[40:43]
    v_xor_b32 v124, 16, v125
    ds_write_b128 v124, v[4:7]
    s_waitcnt lgkmcnt(2)
    v_mfma_f32_16x16x32_bf16 v[24:27], v[64:67], v[96:99], v[24:27]
    v_mfma_f32_16x16x32_bf16 v[56:59], v[68:71], v[96:99], v[56:59]
    v_mfma_f32_16x16x32_bf16 v[20:23], v[72:75], v[96:99], v[20:23]
    v_mfma_f32_16x16x32_bf16 v[52:55], v[76:79], v[96:99], v[52:55]
    v_mfma_f32_16x16x32_bf16 v[16:19], v[80:83], v[96:99], v[16:19]
    v_mfma_f32_16x16x32_bf16 v[48:51], v[84:87], v[96:99], v[48:51]
    v_mfma_f32_16x16x32_bf16 v[12:15], v[88:91], v[96:99], v[12:15]
    v_mfma_f32_16x16x32_bf16 v[44:47], v[92:95], v[96:99], v[44:47]
    v_xor_b32 v123, 32, v125
    ds_write_b128 v123, v[8:11]
    v_xor_b32 v124, 0, v126
    ds_write_b128 v124, v[32:35]
    v_mfma_f32_16x16x32_bf16 v[28:31], v[64:67], v[100:103], v[28:31]
    v_mfma_f32_16x16x32_bf16 v[60:63], v[68:71], v[100:103], v[60:63]
    v_mfma_f32_16x16x32_bf16 v[24:27], v[72:75], v[100:103], v[24:27]
    v_mfma_f32_16x16x32_bf16 v[56:59], v[76:79], v[100:103], v[56:59]
    v_mfma_f32_16x16x32_bf16 v[20:23], v[80:83], v[100:103], v[20:23]
    v_mfma_f32_16x16x32_bf16 v[52:55], v[84:87], v[100:103], v[52:55]
    v_mfma_f32_16x16x32_bf16 v[16:19], v[88:91], v[100:103], v[16:19]
    v_mfma_f32_16x16x32_bf16 v[48:51], v[92:95], v[100:103], v[48:51]
    v_xor_b32 v123, 16, v126
    ds_write_b128 v123, v[36:39]
    v_xor_b32 v124, 32, v126
    ds_write_b128 v124, v[40:43]
    v_mfma_f32_16x16x32_bf16 v[28:31], v[72:75], v[104:107], v[28:31]
    v_mfma_f32_16x16x32_bf16 v[60:63], v[76:79], v[104:107], v[60:63]
    v_mfma_f32_16x16x32_bf16 v[24:27], v[80:83], v[104:107], v[24:27]
    v_mfma_f32_16x16x32_bf16 v[56:59], v[84:87], v[104:107], v[56:59]
    v_mfma_f32_16x16x32_bf16 v[20:23], v[88:91], v[104:107], v[20:23]
    v_mfma_f32_16x16x32_bf16 v[52:55], v[92:95], v[104:107], v[52:55]
    v_xor_b32 v124, 48, v125
    ds_write_b128 v124, v[12:15]
    v_xor_b32 v123, 48, v126
    ds_write_b128 v123, v[44:47]
    v_mfma_f32_16x16x32_bf16 v[28:31], v[80:83], v[108:111], v[28:31]
    v_mfma_f32_16x16x32_bf16 v[60:63], v[84:87], v[108:111], v[60:63]
    v_mfma_f32_16x16x32_bf16 v[24:27], v[88:91], v[108:111], v[24:27]
    v_mfma_f32_16x16x32_bf16 v[56:59], v[92:95], v[108:111], v[56:59]
    v_xor_b32 v123, 64, v125
    ds_write_b128 v123, v[16:19]
    v_xor_b32 v124, 64, v126
    ds_write_b128 v124, v[48:51]
    v_mfma_f32_16x16x32_bf16 v[28:31], v[88:91], v[112:115], v[28:31]
    v_mfma_f32_16x16x32_bf16 v[60:63], v[92:95], v[112:115], v[60:63]
    v_xor_b32 v124, 80, v125
    ds_write_b128 v124, v[20:23]
    v_xor_b32 v123, 80, v126
    ds_write_b128 v123, v[52:55]
    v_and_b32 v108, 15, v127
    v_lshrrev_b32 v109, 4, v127
    v_lshrrev_b32 v110, 3, v108
    s_lshl_b32 s36, s20, 1
    v_add_u32 v110, s36, v110
    v_xor_b32 v111, v110, v108
    v_and_b32 v111, 7, v111
    v_lshlrev_b32 v111, 4, v111
    v_xor_b32 v123, 96, v125
    ds_write_b128 v123, v[24:27]
    v_lshl_add_u32 v111, v110, 7, v111
    v_lshl_add_u32 v120, v109, 11, v111
    v_add_u32 v121, 65536, v120
    v_add_u32 v64, 131072, v120
    s_lshl_b32 s36, s20, 9
    s_add_u32 s36, s36, 115712
    v_lshl_add_u32 v127, v109, 7, s36
    s_lshl_b32 s36, s20, 4
    v_add_u32 v108, s36, v108
    v_lshlrev_b32 v110, 6, v108
    v_lshl_add_u32 v110, v109, 4, v110
    s_mul_i32 s36, s29, 524288
    v_xor_b32 v124, 96, v126
    ds_write_b128 v124, v[56:59]
    s_lshl_b32 s37, s21, 4
    s_add_u32 s36, s36, s37
    v_add_u32 v110, s36, v110
    v_mov_b32 v111, 2130706432
    v_cmp_gt_u32 vcc, 125, v108
    s_mov_b32 s4, 0xbeaaaaab
    s_mov_b32 s5, s4
    s_mov_b32 s6, 0x3e800000
    s_mov_b32 s7, s6
    s_mov_b32 s8, 0xc0a00000
    s_mov_b32 s9, s8
    s_mov_b32 s10, 0xc0638e39
    v_xor_b32 v124, 112, v125
    ds_write_b128 v124, v[28:31]
    s_mov_b32 s11, s10
    s_mov_b32 s12, 0xbf638e39
    s_mov_b32 s13, s12
    s_mov_b32 s14, 0xbe638e39
    s_mov_b32 s15, s14
    s_mov_b32 s22, 0xbd638e39
    s_mov_b32 s23, s22
    s_mov_b32 s24, 0x3ff1c71c
    s_mov_b32 s25, s24
    s_mov_b32 s26, 0xbf2aaaab
    s_mov_b32 s27, s26
    s_mov_b32 s32, 0x3ecccccd
    v_xor_b32 v123, 112, v126
    s_waitcnt lgkmcnt(8)
    ds_write_b128 v123, v[60:63]
    s_mov_b32 s33, s32
    s_mov_b32 s34, 0xbd888889
    s_mov_b32 s35, s34
    s_mov_b32 s38, 0xbe4ccccd
    s_mov_b32 s39, s38
    s_mov_b32 s40, 0xbdd2d3e8
    s_mov_b32 s41, s40
    s_mov_b32 s42, 0x3f800000
    s_mov_b32 s43, s42
    s_setprio 0
    s_branch L_conv1_kernel_epi
L_conv1_kernel_m2:
    s_mul_i32 s37, s38, 2176
    s_add_u32 s37, s37, 98304
    v_add_u32 v116, s37, v8
    v_add_u32 v118, s37, v9
    v_add_u32 v117, 104832, v8
    s_cmp_eq_u32 s38, 0
    s_cbranch_scc1 L_conv1_kernel_hh0
    v_add_u32 v117, 98304, v9
L_conv1_kernel_hh0:
    s_lshl_b32 s37, s38, 12
    s_add_u32 s37, s37, s43
    s_add_u32 s37, s37, 49152
    v_lshl_add_u32 v119, v127, 4, s37
    v_mov_b32 v0, 0
    v_mov_b32 v1, 0
    v_mov_b32 v2, 0
    v_mov_b32 v3, 0
    v_mov_b32 v4, 0
    v_mov_b32 v5, 0
    v_mov_b32 v6, 0
    v_mov_b32 v7, 0
    v_mov_b32 v8, 0
    v_mov_b32 v9, 0
    v_mov_b32 v10, 0
    v_mov_b32 v11, 0
    v_mov_b32 v12, 0
    v_mov_b32 v13, 0
    v_mov_b32 v14, 0
    v_mov_b32 v15, 0
    v_mov_b32 v16, 0
    v_mov_b32 v17, 0
    v_mov_b32 v18, 0
    v_mov_b32 v19, 0
    v_mov_b32 v20, 0
    v_mov_b32 v21, 0
    v_mov_b32 v22, 0
    v_mov_b32 v23, 0
    v_mov_b32 v24, 0
    v_mov_b32 v25, 0
    v_mov_b32 v26, 0
    v_mov_b32 v27, 0
    v_mov_b32 v28, 0
    v_mov_b32 v29, 0
    v_mov_b32 v30, 0
    v_mov_b32 v31, 0
    v_mov_b32 v32, 0
    v_mov_b32 v33, 0
    v_mov_b32 v34, 0
    v_mov_b32 v35, 0
    v_mov_b32 v36, 0
    v_mov_b32 v37, 0
    v_mov_b32 v38, 0
    v_mov_b32 v39, 0
    v_mov_b32 v40, 0
    v_mov_b32 v41, 0
    v_mov_b32 v42, 0
    v_mov_b32 v43, 0
    v_mov_b32 v44, 0
    v_mov_b32 v45, 0
    v_mov_b32 v46, 0
    v_mov_b32 v47, 0
    v_mov_b32 v48, 0
    v_mov_b32 v49, 0
    v_mov_b32 v50, 0
    v_mov_b32 v51, 0
    v_mov_b32 v52, 0
    v_mov_b32 v53, 0
    v_mov_b32 v54, 0
    v_mov_b32 v55, 0
    v_mov_b32 v56, 0
    v_mov_b32 v57, 0
    v_mov_b32 v58, 0
    v_mov_b32 v59, 0
    v_mov_b32 v60, 0
    v_mov_b32 v61, 0
    v_mov_b32 v62, 0
    v_mov_b32 v63, 0
    buffer_load_dwordx4 v[96:99], v108, s[8:11], 0 offen
    buffer_load_dwordx4 v[100:103], v109, s[8:11], 0 offen
    buffer_load_dwordx4 v[104:107], v110, s[8:11], 0 offen
    s_mov_b32 s23, 0
    s_mov_b32 s26, 4096
    buffer_load_dwordx4 v[64:67], v125, s[12:15], s23 offen offset:0
    buffer_load_dwordx4 v[68:71], v125, s[12:15], s23 offen offset:2048
    buffer_load_dwordx4 v[80:83], v119, s[12:15], s23 offen offset:0
    buffer_load_dwordx4 v[72:75], v125, s[12:15], s26 offen offset:0
    buffer_load_dwordx4 v[84:87], v119, s[12:15], s23 offen offset:2048
    buffer_load_dwordx4 v[76:79], v125, s[12:15], s26 offen offset:2048
    s_mov_b32 s23, 57344
    s_mov_b32 s26, 61440
    s_waitcnt vmcnt(6)
    v_lshlrev_b32 v108, 16, v96
    v_and_b32 v111, s25, v96
    v_lshlrev_b32 v109, 16, v100
    v_and_b32 v112, s25, v100
    v_lshlrev_b32 v110, 16, v104
    v_and_b32 v113, s25, v104
    v_mul_f32 v114, s44, v108
    v_mul_f32 v115, s44, v111
    v_fmac_f32 v114, s45, v109
    v_fmac_f32 v115, s45, v112
    v_fmac_f32 v114, s46, v110
    v_fmac_f32 v115, s46, v113
    v_cvt_pk_bf16_f32 v96, v114, v115
    v_lshlrev_b32 v108, 16, v97
    v_and_b32 v111, s25, v97
    v_lshlrev_b32 v109, 16, v101
    v_and_b32 v112, s25, v101
    v_lshlrev_b32 v110, 16, v105
    v_and_b32 v113, s25, v105
    v_mul_f32 v114, s44, v108
    v_mul_f32 v115, s44, v111
    v_fmac_f32 v114, s45, v109
    v_fmac_f32 v115, s45, v112
    v_fmac_f32 v114, s46, v110
    v_fmac_f32 v115, s46, v113
    v_cvt_pk_bf16_f32 v97, v114, v115
    v_lshlrev_b32 v108, 16, v98
    v_and_b32 v111, s25, v98
    v_lshlrev_b32 v109, 16, v102
    v_and_b32 v112, s25, v102
    v_lshlrev_b32 v110, 16, v106
    v_and_b32 v113, s25, v106
    v_mul_f32 v114, s44, v108
    v_mul_f32 v115, s44, v111
    v_fmac_f32 v114, s45, v109
    v_fmac_f32 v115, s45, v112
    v_fmac_f32 v114, s46, v110
    v_fmac_f32 v115, s46, v113
    v_cvt_pk_bf16_f32 v98, v114, v115
    v_lshlrev_b32 v108, 16, v99
    v_and_b32 v111, s25, v99
    v_lshlrev_b32 v109, 16, v103
    v_and_b32 v112, s25, v103
    v_lshlrev_b32 v110, 16, v107
    v_and_b32 v113, s25, v107
    v_mul_f32 v114, s44, v108
    v_mul_f32 v115, s44, v111
    v_fmac_f32 v114, s45, v109
    v_fmac_f32 v115, s45, v112
    v_fmac_f32 v114, s46, v110
    v_fmac_f32 v115, s46, v113
    v_cvt_pk_bf16_f32 v99, v114, v115
    ds_write_b128 v126, v[96:99]
    v_and_b32 v111, 15, v127
    v_lshlrev_b32 v111, 2, v111
    v_add_u32 v111, 99328, v111
    ds_write_b32 v111, v0
    ds_write_b32 v111, v0 offset:8704
    s_waitcnt lgkmcnt(0)
    s_barrier
    s_mov_b32 s22, 8
    s_setprio 2
L_conv1_kernel_mloop2:
    ds_read_b128 v[88:91], v120 offset:0
    ds_read_b128 v[92:95], v120 offset:1024
    ds_read_b128 v[96:99], v116 offset:0
    ds_read_b128 v[100:103], v120 offset:2048
    ds_read_b128 v[104:107], v116 offset:1088
    ds_read_b128 v[108:111], v120 offset:3072
    ds_read_b128 v[112:115], v116 offset:2176
    s_waitcnt vmcnt(5) lgkmcnt(6)
    v_mfma_f32_16x16x32_bf16 v[0:3], v[64:67], v[88:91], v[0:3]
    ds_read_b128 v[88:91], v120 offset:4096
    s_waitcnt vmcnt(4) lgkmcnt(6)
    v_mfma_f32_16x16x32_bf16 v[4:7], v[64:67], v[92:95], v[4:7]
    v_mfma_f32_16x16x32_bf16 v[0:3], v[68:71], v[92:95], v[0:3]
    ds_read_b128 v[92:95], v116 offset:3264
    s_waitcnt vmcnt(3) lgkmcnt(6)
    v_mfma_f32_16x16x32_bf16 v[32:35], v[80:83], v[96:99], v[32:35]
    ds_read_b128 v[96:99], v120 offset:5120
    s_waitcnt vmcnt(2) lgkmcnt(6)
    v_mfma_f32_16x16x32_bf16 v[8:11], v[64:67], v[100:103], v[8:11]
    v_mfma_f32_16x16x32_bf16 v[4:7], v[68:71], v[100:103], v[4:7]
    v_mfma_f32_16x16x32_bf16 v[0:3], v[72:75], v[100:103], v[0:3]
    ds_read_b128 v[100:103], v116 offset:4352
    s_waitcnt vmcnt(1) lgkmcnt(6)
    v_mfma_f32_16x16x32_bf16 v[36:39], v[80:83], v[104:107], v[36:39]
    v_mfma_f32_16x16x32_bf16 v[32:35], v[84:87], v[104:107], v[32:35]
    ds_read_b128 v[104:107], v120 offset:6144
    s_waitcnt vmcnt(0) lgkmcnt(6)
    v_mfma_f32_16x16x32_bf16 v[12:15], v[64:67], v[108:111], v[12:15]
    v_mfma_f32_16x16x32_bf16 v[8:11], v[68:71], v[108:111], v[8:11]
    v_mfma_f32_16x16x32_bf16 v[4:7], v[72:75], v[108:111], v[4:7]
    v_mfma_f32_16x16x32_bf16 v[0:3], v[76:79], v[108:111], v[0:3]
    ds_read_b128 v[108:111], v116 offset:5440
    s_waitcnt lgkmcnt(6)
    v_mfma_f32_16x16x32_bf16 v[40:43], v[80:83], v[112:115], v[40:43]
    v_mfma_f32_16x16x32_bf16 v[36:39], v[84:87], v[112:115], v[36:39]
    ds_read_b128 v[112:115], v120 offset:7168
    s_waitcnt lgkmcnt(6)
    v_mfma_f32_16x16x32_bf16 v[16:19], v[64:67], v[88:91], v[16:19]
    v_mfma_f32_16x16x32_bf16 v[12:15], v[68:71], v[88:91], v[12:15]
    v_mfma_f32_16x16x32_bf16 v[8:11], v[72:75], v[88:91], v[8:11]
    v_mfma_f32_16x16x32_bf16 v[4:7], v[76:79], v[88:91], v[4:7]
    ds_read_b128 v[88:91], v117 offset:0
    s_waitcnt lgkmcnt(6)
    v_mfma_f32_16x16x32_bf16 v[44:47], v[80:83], v[92:95], v[44:47]
    v_mfma_f32_16x16x32_bf16 v[40:43], v[84:87], v[92:95], v[40:43]
    ds_read_b128 v[92:95], v122 offset:0
    v_add_u32 v122, v123, v122
    s_waitcnt lgkmcnt(6)
    v_mfma_f32_16x16x32_bf16 v[20:23], v[64:67], v[96:99], v[20:23]
    v_mfma_f32_16x16x32_bf16 v[16:19], v[68:71], v[96:99], v[16:19]
    v_mfma_f32_16x16x32_bf16 v[12:15], v[72:75], v[96:99], v[12:15]
    v_mfma_f32_16x16x32_bf16 v[8:11], v[76:79], v[96:99], v[8:11]
    ds_read_b128 v[96:99], v117 offset:1088
    s_waitcnt lgkmcnt(6)
    v_mfma_f32_16x16x32_bf16 v[48:51], v[80:83], v[100:103], v[48:51]
    v_mfma_f32_16x16x32_bf16 v[44:47], v[84:87], v[100:103], v[44:47]
    ds_read_b128 v[100:103], v121 offset:1024
    s_waitcnt lgkmcnt(6)
    v_mfma_f32_16x16x32_bf16 v[24:27], v[64:67], v[104:107], v[24:27]
    v_mfma_f32_16x16x32_bf16 v[20:23], v[68:71], v[104:107], v[20:23]
    v_mfma_f32_16x16x32_bf16 v[16:19], v[72:75], v[104:107], v[16:19]
    v_mfma_f32_16x16x32_bf16 v[12:15], v[76:79], v[104:107], v[12:15]
    ds_read_b128 v[104:107], v118 offset:0
    s_waitcnt lgkmcnt(6)
    v_mfma_f32_16x16x32_bf16 v[52:55], v[80:83], v[108:111], v[52:55]
    v_mfma_f32_16x16x32_bf16 v[48:51], v[84:87], v[108:111], v[48:51]
    ds_read_b128 v[108:111], v121 offset:2048
    s_waitcnt lgkmcnt(6)
    v_mfma_f32_16x16x32_bf16 v[28:31], v[64:67], v[112:115], v[28:31]
    v_mfma_f32_16x16x32_bf16 v[24:27], v[68:71], v[112:115], v[24:27]
    v_mfma_f32_16x16x32_bf16 v[20:23], v[72:75], v[112:115], v[20:23]
    v_mfma_f32_16x16x32_bf16 v[16:19], v[76:79], v[112:115], v[16:19]
    buffer_load_dwordx4 v[64:67], v125, s[12:15], s23 offen offset:0
    s_waitcnt lgkmcnt(5)
    v_mfma_f32_16x16x32_bf16 v[56:59], v[80:83], v[88:91], v[56:59]
    v_mfma_f32_16x16x32_bf16 v[52:55], v[84:87], v[88:91], v[52:55]
    s_waitcnt lgkmcnt(0)
    s_barrier
    v_mfma_f32_16x16x32_bf16 v[28:31], v[68:71], v[92:95], v[28:31]
    v_mfma_f32_16x16x32_bf16 v[24:27], v[72:75], v[92:95], v[24:27]
    v_mfma_f32_16x16x32_bf16 v[20:23], v[76:79], v[92:95], v[20:23]
    buffer_load_dwordx4 v[68:71], v125, s[12:15], s23 offen offset:2048
    v_mfma_f32_16x16x32_bf16 v[60:63], v[80:83], v[96:99], v[60:63]
    v_mfma_f32_16x16x32_bf16 v[56:59], v[84:87], v[96:99], v[56:59]
    buffer_load_dwordx4 v[80:83], v119, s[12:15], s23 offen offset:0
    v_mfma_f32_16x16x32_bf16 v[28:31], v[72:75], v[100:103], v[28:31]
    v_mfma_f32_16x16x32_bf16 v[24:27], v[76:79], v[100:103], v[24:27]
    buffer_load_dwordx4 v[72:75], v125, s[12:15], s26 offen offset:0
    v_mfma_f32_16x16x32_bf16 v[60:63], v[84:87], v[104:107], v[60:63]
    buffer_load_dwordx4 v[84:87], v119, s[12:15], s23 offen offset:2048
    v_mfma_f32_16x16x32_bf16 v[28:31], v[76:79], v[108:111], v[28:31]
    buffer_load_dwordx4 v[76:79], v125, s[12:15], s26 offen offset:2048
    s_add_u32 s23, s23, 57344
    s_add_u32 s26, s26, 57344
    s_sub_u32 s22, s22, 1
    s_cmp_eq_u32 s22, 0
    s_cbranch_scc1 L_conv1_kernel_mlast2
    ds_read_b128 v[88:91], v120 offset:8192
    ds_read_b128 v[92:95], v120 offset:9216
    ds_read_b128 v[96:99], v116 offset:8704
    ds_read_b128 v[100:103], v120 offset:10240
    ds_read_b128 v[104:107], v116 offset:9792
    ds_read_b128 v[108:111], v120 offset:11264
    ds_read_b128 v[112:115], v116 offset:10880
    s_waitcnt vmcnt(5) lgkmcnt(6)
    v_mfma_f32_16x16x32_bf16 v[0:3], v[64:67], v[88:91], v[0:3]
    ds_read_b128 v[88:91], v120 offset:12288
    s_waitcnt vmcnt(4) lgkmcnt(6)
    v_mfma_f32_16x16x32_bf16 v[4:7], v[64:67], v[92:95], v[4:7]
    v_mfma_f32_16x16x32_bf16 v[0:3], v[68:71], v[92:95], v[0:3]
    ds_read_b128 v[92:95], v116 offset:11968
    s_waitcnt vmcnt(3) lgkmcnt(6)
    v_mfma_f32_16x16x32_bf16 v[32:35], v[80:83], v[96:99], v[32:35]
    ds_read_b128 v[96:99], v120 offset:13312
    s_waitcnt vmcnt(2) lgkmcnt(6)
    v_mfma_f32_16x16x32_bf16 v[8:11], v[64:67], v[100:103], v[8:11]
    v_mfma_f32_16x16x32_bf16 v[4:7], v[68:71], v[100:103], v[4:7]
    v_mfma_f32_16x16x32_bf16 v[0:3], v[72:75], v[100:103], v[0:3]
    ds_read_b128 v[100:103], v116 offset:13056
    s_waitcnt vmcnt(1) lgkmcnt(6)
    v_mfma_f32_16x16x32_bf16 v[36:39], v[80:83], v[104:107], v[36:39]
    v_mfma_f32_16x16x32_bf16 v[32:35], v[84:87], v[104:107], v[32:35]
    ds_read_b128 v[104:107], v120 offset:14336
    s_waitcnt vmcnt(0) lgkmcnt(6)
    v_mfma_f32_16x16x32_bf16 v[12:15], v[64:67], v[108:111], v[12:15]
    v_mfma_f32_16x16x32_bf16 v[8:11], v[68:71], v[108:111], v[8:11]
    v_mfma_f32_16x16x32_bf16 v[4:7], v[72:75], v[108:111], v[4:7]
    v_mfma_f32_16x16x32_bf16 v[0:3], v[76:79], v[108:111], v[0:3]
    ds_read_b128 v[108:111], v116 offset:14144
    s_waitcnt lgkmcnt(6)
    v_mfma_f32_16x16x32_bf16 v[40:43], v[80:83], v[112:115], v[40:43]
    v_mfma_f32_16x16x32_bf16 v[36:39], v[84:87], v[112:115], v[36:39]
    ds_read_b128 v[112:115], v120 offset:15360
    s_waitcnt lgkmcnt(6)
    v_mfma_f32_16x16x32_bf16 v[16:19], v[64:67], v[88:91], v[16:19]
    v_mfma_f32_16x16x32_bf16 v[12:15], v[68:71], v[88:91], v[12:15]
    v_mfma_f32_16x16x32_bf16 v[8:11], v[72:75], v[88:91], v[8:11]
    v_mfma_f32_16x16x32_bf16 v[4:7], v[76:79], v[88:91], v[4:7]
    ds_read_b128 v[88:91], v117 offset:8704
    s_waitcnt lgkmcnt(6)
    v_mfma_f32_16x16x32_bf16 v[44:47], v[80:83], v[92:95], v[44:47]
    v_mfma_f32_16x16x32_bf16 v[40:43], v[84:87], v[92:95], v[40:43]
    ds_read_b128 v[92:95], v122 offset:0
    v_add_u32 v122, v124, v122
    s_waitcnt lgkmcnt(6)
    v_mfma_f32_16x16x32_bf16 v[20:23], v[64:67], v[96:99], v[20:23]
    v_mfma_f32_16x16x32_bf16 v[16:19], v[68:71], v[96:99], v[16:19]
    v_mfma_f32_16x16x32_bf16 v[12:15], v[72:75], v[96:99], v[12:15]
    v_mfma_f32_16x16x32_bf16 v[8:11], v[76:79], v[96:99], v[8:11]
    ds_read_b128 v[96:99], v117 offset:9792
    s_waitcnt lgkmcnt(6)
    v_mfma_f32_16x16x32_bf16 v[48:51], v[80:83], v[100:103], v[48:51]
    v_mfma_f32_16x16x32_bf16 v[44:47], v[84:87], v[100:103], v[44:47]
    ds_read_b128 v[100:103], v121 offset:9216
    s_waitcnt lgkmcnt(6)
    v_mfma_f32_16x16x32_bf16 v[24:27], v[64:67], v[104:107], v[24:27]
    v_mfma_f32_16x16x32_bf16 v[20:23], v[68:71], v[104:107], v[20:23]
    v_mfma_f32_16x16x32_bf16 v[16:19], v[72:75], v[104:107], v[16:19]
    v_mfma_f32_16x16x32_bf16 v[12:15], v[76:79], v[104:107], v[12:15]
    ds_read_b128 v[104:107], v118 offset:8704
    s_waitcnt lgkmcnt(6)
    v_mfma_f32_16x16x32_bf16 v[52:55], v[80:83], v[108:111], v[52:55]
    v_mfma_f32_16x16x32_bf16 v[48:51], v[84:87], v[108:111], v[48:51]
    ds_read_b128 v[108:111], v121 offset:10240
    s_waitcnt lgkmcnt(6)
    v_mfma_f32_16x16x32_bf16 v[28:31], v[64:67], v[112:115], v[28:31]
    v_mfma_f32_16x16x32_bf16 v[24:27], v[68:71], v[112:115], v[24:27]
    v_mfma_f32_16x16x32_bf16 v[20:23], v[72:75], v[112:115], v[20:23]
    v_mfma_f32_16x16x32_bf16 v[16:19], v[76:79], v[112:115], v[16:19]
    buffer_load_dwordx4 v[64:67], v125, s[12:15], s23 offen offset:0
    s_waitcnt lgkmcnt(5)
    v_mfma_f32_16x16x32_bf16 v[56:59], v[80:83], v[88:91], v[56:59]
    v_mfma_f32_16x16x32_bf16 v[52:55], v[84:87], v[88:91], v[52:55]
    s_waitcnt lgkmcnt(0)
    s_barrier
    v_mfma_f32_16x16x32_bf16 v[28:31], v[68:71], v[92:95], v[28:31]
    v_mfma_f32_16x16x32_bf16 v[24:27], v[72:75], v[92:95], v[24:27]
    v_mfma_f32_16x16x32_bf16 v[20:23], v[76:79], v[92:95], v[20:23]
    buffer_load_dwordx4 v[68:71], v125, s[12:15], s23 offen offset:2048
    v_mfma_f32_16x16x32_bf16 v[60:63], v[80:83], v[96:99], v[60:63]
    v_mfma_f32_16x16x32_bf16 v[56:59], v[84:87], v[96:99], v[56:59]
    buffer_load_dwordx4 v[80:83], v119, s[12:15], s23 offen offset:0
    v_mfma_f32_16x16x32_bf16 v[28:31], v[72:75], v[100:103], v[28:31]
    v_mfma_f32_16x16x32_bf16 v[24:27], v[76:79], v[100:103], v[24:27]
    buffer_load_dwordx4 v[72:75], v125, s[12:15], s26 offen offset:0
    v_mfma_f32_16x16x32_bf16 v[60:63], v[84:87], v[104:107], v[60:63]
    buffer_load_dwordx4 v[84:87], v119, s[12:15], s23 offen offset:2048
    v_mfma_f32_16x16x32_bf16 v[28:31], v[76:79], v[108:111], v[28:31]
    buffer_load_dwordx4 v[76:79], v125, s[12:15], s26 offen offset:2048
    s_add_u32 s23, s23, 57344
    s_add_u32 s26, s26, 57344
    s_branch L_conv1_kernel_mloop2
L_conv1_kernel_mlast2:
    v_and_b32 v125, 15, v127
    v_and_b32 v126, 7, v127
    v_lshlrev_b32 v126, 4, v126
    v_lshl_add_u32 v125, v125, 7, v126
    v_lshrrev_b32 v126, 4, v127
    v_lshl_add_u32 v125, v126, 11, v125
    s_mov_b32 s36, 65536
    s_cmp_eq_u32 s32, 1
    s_cselect_b32 s36, 121856, s36
    s_cmp_eq_u32 s32, 2
    s_cselect_b32 s36, 81920, s36
    s_cmp_eq_u32 s32, 3
    s_cselect_b32 s36, 130048, s36
    s_mov_b32 s37, 98304
    s_cmp_eq_u32 s32, 1
    s_cselect_b32 s37, 138240, s37
    s_cmp_eq_u32 s32, 2
    s_cselect_b32 s37, 146432, s37
    s_cmp_eq_u32 s32, 3
    s_cselect_b32 s37, 154624, s37
    v_add_u32 v126, s37, v125
    v_add_u32 v125, s36, v125
    ds_read_b128 v[88:91], v120 offset:8192
    ds_read_b128 v[92:95], v120 offset:9216
    ds_read_b128 v[96:99], v116 offset:8704
    ds_read_b128 v[100:103], v120 offset:10240
    ds_read_b128 v[104:107], v116 offset:9792
    ds_read_b128 v[108:111], v120 offset:11264
    ds_read_b128 v[112:115], v116 offset:10880
    s_waitcnt vmcnt(5) lgkmcnt(6)
    v_mfma_f32_16x16x32_bf16 v[0:3], v[64:67], v[88:91], v[0:3]
    ds_read_b128 v[88:91], v120 offset:12288
    s_waitcnt vmcnt(4) lgkmcnt(6)
    v_mfma_f32_16x16x32_bf16 v[4:7], v[64:67], v[92:95], v[4:7]
    v_mfma_f32_16x16x32_bf16 v[0:3], v[68:71], v[92:95], v[0:3]
    ds_read_b128 v[92:95], v116 offset:11968
    s_waitcnt vmcnt(3) lgkmcnt(6)
    v_mfma_f32_16x16x32_bf16 v[32:35], v[80:83], v[96:99], v[32:35]
    ds_read_b128 v[96:99], v120 offset:13312
    s_waitcnt vmcnt(2) lgkmcnt(6)
    v_mfma_f32_16x16x32_bf16 v[8:11], v[64:67], v[100:103], v[8:11]
    v_mfma_f32_16x16x32_bf16 v[4:7], v[68:71], v[100:103], v[4:7]
    v_mfma_f32_16x16x32_bf16 v[0:3], v[72:75], v[100:103], v[0:3]
    ds_read_b128 v[100:103], v116 offset:13056
    s_waitcnt vmcnt(1) lgkmcnt(6)
    v_mfma_f32_16x16x32_bf16 v[36:39], v[80:83], v[104:107], v[36:39]
    v_mfma_f32_16x16x32_bf16 v[32:35], v[84:87], v[104:107], v[32:35]
    ds_read_b128 v[104:107], v120 offset:14336
    s_waitcnt vmcnt(0) lgkmcnt(6)
    v_mfma_f32_16x16x32_bf16 v[12:15], v[64:67], v[108:111], v[12:15]
    v_mfma_f32_16x16x32_bf16 v[8:11], v[68:71], v[108:111], v[8:11]
    v_mfma_f32_16x16x32_bf16 v[4:7], v[72:75], v[108:111], v[4:7]
    v_mfma_f32_16x16x32_bf16 v[0:3], v[76:79], v[108:111], v[0:3]
    ds_read_b128 v[108:111], v116 offset:14144
    s_waitcnt lgkmcnt(6)
    v_mfma_f32_16x16x32_bf16 v[40:43], v[80:83], v[112:115], v[40:43]
    v_mfma_f32_16x16x32_bf16 v[36:39], v[84:87], v[112:115], v[36:39]
    ds_read_b128 v[112:115], v120 offset:15360
    s_waitcnt lgkmcnt(6)
    v_mfma_f32_16x16x32_bf16 v[16:19], v[64:67], v[88:91], v[16:19]
    v_mfma_f32_16x16x32_bf16 v[12:15], v[68:71], v[88:91], v[12:15]
    v_mfma_f32_16x16x32_bf16 v[8:11], v[72:75], v[88:91], v[8:11]
    v_mfma_f32_16x16x32_bf16 v[4:7], v[76:79], v[88:91], v[4:7]
    ds_read_b128 v[88:91], v117 offset:8704
    v_xor_b32 v124, 0, v126
    ds_write_b128 v124, v[32:35]
    s_waitcnt lgkmcnt(7)
    v_mfma_f32_16x16x32_bf16 v[44:47], v[80:83], v[92:95], v[44:47]
    v_mfma_f32_16x16x32_bf16 v[40:43], v[84:87], v[92:95], v[40:43]
    ds_read_b128 v[92:95], v122 offset:0
    v_xor_b32 v123, 0, v125
    ds_write_b128 v123, v[0:3]
    s_waitcnt lgkmcnt(8)
    v_mfma_f32_16x16x32_bf16 v[20:23], v[64:67], v[96:99], v[20:23]
    v_mfma_f32_16x16x32_bf16 v[16:19], v[68:71], v[96:99], v[16:19]
    v_mfma_f32_16x16x32_bf16 v[12:15], v[72:75], v[96:99], v[12:15]
    v_mfma_f32_16x16x32_bf16 v[8:11], v[76:79], v[96:99], v[8:11]
    ds_read_b128 v[96:99], v117 offset:9792
    v_xor_b32 v123, 16, v126
    ds_write_b128 v123, v[36:39]
    s_waitcnt lgkmcnt(9)
    v_mfma_f32_16x16x32_bf16 v[48:51], v[80:83], v[100:103], v[48:51]
    v_mfma_f32_16x16x32_bf16 v[44:47], v[84:87], v[100:103], v[44:47]
    ds_read_b128 v[100:103], v121 offset:9216
    v_xor_b32 v124, 16, v125
    ds_write_b128 v124, v[4:7]
    s_waitcnt lgkmcnt(10)
    v_mfma_f32_16x16x32_bf16 v[24:27], v[64:67], v[104:107], v[24:27]
    v_mfma_f32_16x16x32_bf16 v[20:23], v[68:71], v[104:107], v[20:23]
    v_mfma_f32_16x16x32_bf16 v[16:19], v[72:75], v[104:107], v[16:19]
    v_mfma_f32_16x16x32_bf16 v[12:15], v[76:79], v[104:107], v[12:15]
    ds_read_b128 v[104:107], v118 offset:8704
    v_xor_b32 v124, 32, v126
    ds_write_b128 v124, v[40:43]
    s_waitcnt lgkmcnt(11)
    v_mfma_f32_16x16x32_bf16 v[52:55], v[80:83], v[108:111], v[52:55]
    v_mfma_f32_16x16x32_bf16 v[48:51], v[84:87], v[108:111], v[48:51]
    ds_read_b128 v[108:111], v121 offset:10240
    v_xor_b32 v123, 32, v125
    ds_write_b128 v123, v[8:11]
    s_waitcnt lgkmcnt(12)
    v_mfma_f32_16x16x32_bf16 v[28:31], v[64:67], v[112:115], v[28:31]
    v_mfma_f32_16x16x32_bf16 v[24:27], v[68:71], v[112:115], v[24:27]
    v_mfma_f32_16x16x32_bf16 v[20:23], v[72:75], v[112:115], v[20:23]
    v_mfma_f32_16x16x32_bf16 v[16:19], v[76:79], v[112:115], v[16:19]
    v_xor_b32 v123, 48, v126
    ds_write_b128 v123, v[44:47]
    s_waitcnt lgkmcnt(12)
    v_mfma_f32_16x16x32_bf16 v[56:59], v[80:83], v[88:91], v[56:59]
    v_mfma_f32_16x16x32_bf16 v[52:55], v[84:87], v[88:91], v[52:55]
    v_xor_b32 v124, 48, v125
    ds_write_b128 v124, v[12:15]
    s_waitcnt lgkmcnt(11)
    v_mfma_f32_16x16x32_bf16 v[28:31], v[68:71], v[92:95], v[28:31]
    v_mfma_f32_16x16x32_bf16 v[24:27], v[72:75], v[92:95], v[24:27]
    v_mfma_f32_16x16x32_bf16 v[20:23], v[76:79], v[92:95], v[20:23]
    v_xor_b32 v124, 64, v126
    ds_write_b128 v124, v[48:51]
    s_waitcnt lgkmcnt(10)
    v_mfma_f32_16x16x32_bf16 v[60:63], v[80:83], v[96:99], v[60:63]
    v_mfma_f32_16x16x32_bf16 v[56:59], v[84:87], v[96:99], v[56:59]
    v_xor_b32 v123, 64, v125
    ds_write_b128 v123, v[16:19]
    s_waitcnt lgkmcnt(9)
    v_mfma_f32_16x16x32_bf16 v[28:31], v[72:75], v[100:103], v[28:31]
    v_mfma_f32_16x16x32_bf16 v[24:27], v[76:79], v[100:103], v[24:27]
    v_xor_b32 v123, 80, v126
    ds_write_b128 v123, v[52:55]
    s_waitcnt lgkmcnt(8)
    v_mfma_f32_16x16x32_bf16 v[60:63], v[84:87], v[104:107], v[60:63]
    v_xor_b32 v124, 80, v125
    ds_write_b128 v124, v[20:23]
    s_waitcnt lgkmcnt(7)
    v_mfma_f32_16x16x32_bf16 v[28:31], v[76:79], v[108:111], v[28:31]
    v_xor_b32 v124, 96, v126
    ds_write_b128 v124, v[56:59]
    v_and_b32 v108, 15, v127
    v_lshrrev_b32 v109, 4, v127
    v_lshrrev_b32 v110, 3, v108
    s_lshl_b32 s36, s20, 1
    v_add_u32 v110, s36, v110
    v_xor_b32 v111, v110, v108
    v_and_b32 v111, 7, v111
    v_lshlrev_b32 v111, 4, v111
    v_xor_b32 v123, 96, v125
    ds_write_b128 v123, v[24:27]
    v_lshl_add_u32 v111, v110, 7, v111
    v_lshl_add_u32 v120, v109, 11, v111
    v_add_u32 v121, 65536, v120
    v_add_u32 v64, 131072, v120
    s_lshl_b32 s36, s20, 9
    s_add_u32 s36, s36, 115712
    v_lshl_add_u32 v127, v109, 7, s36
    s_lshl_b32 s36, s20, 4
    v_add_u32 v108, s36, v108
    v_lshlrev_b32 v110, 6, v108
    v_lshl_add_u32 v110, v109, 4, v110
    s_mul_i32 s36, s29, 524288
    v_xor_b32 v123, 112, v126
    ds_write_b128 v123, v[60:63]
    s_lshl_b32 s37, s21, 4
    s_add_u32 s36, s36, s37
    v_add_u32 v110, s36, v110
    v_mov_b32 v111, 2130706432
    v_cmp_gt_u32 vcc, 125, v108
    s_mov_b32 s4, 0xbeaaaaab
    s_mov_b32 s5, s4
    s_mov_b32 s6, 0x3e800000
    s_mov_b32 s7, s6
    s_mov_b32 s8, 0xc0a00000
    s_mov_b32 s9, s8
    s_mov_b32 s10, 0xc0638e39
    v_xor_b32 v124, 112, v125
    ds_write_b128 v124, v[28:31]
    s_mov_b32 s11, s10
    s_mov_b32 s12, 0xbf638e39
    s_mov_b32 s13, s12
    s_mov_b32 s14, 0xbe638e39
    s_mov_b32 s15, s14
    s_mov_b32 s22, 0xbd638e39
    s_mov_b32 s23, s22
    s_mov_b32 s24, 0x3ff1c71c
    s_mov_b32 s25, s24
    s_mov_b32 s26, 0xbf2aaaab
    s_mov_b32 s27, s26
    s_mov_b32 s32, 0x3ecccccd
    s_mov_b32 s33, s32
    s_mov_b32 s34, 0xbd888889
    s_mov_b32 s35, s34
    s_mov_b32 s38, 0xbe4ccccd
    s_mov_b32 s39, s38
    s_mov_b32 s40, 0xbdd2d3e8
    s_mov_b32 s41, s40
    s_mov_b32 s42, 0x3f800000
    s_mov_b32 s43, s42
    s_setprio 0
    s_branch L_conv1_kernel_epi
L_conv1_kernel_epi:
    s_waitcnt lgkmcnt(0)
    s_barrier
    v_cndmask_b32 v122, v111, v110, vcc
    ds_read_b128 v[0:3], v120 offset:0
    ds_read_b128 v[4:7], v120 offset:16384
    ds_read_b128 v[8:11], v120 offset:32768
    ds_read_b128 v[12:15], v120 offset:49152
    ds_read_b128 v[16:19], v121 offset:0
    ds_read_b128 v[20:23], v121 offset:16384
    ds_read_b128 v[24:27], v121 offset:32768
    ds_read_b128 v[28:31], v64 offset:15360
    ds_read_b128 v[32:35], v120 offset:8192
    ds_read_b128 v[36:39], v120 offset:24576
    ds_read_b128 v[40:43], v120 offset:40960
    ds_read_b128 v[44:47], v120 offset:57344
    ds_read_b128 v[48:51], v121 offset:56320
    ds_read_b128 v[52:55], v121 offset:64512
    ds_read_b128 v[56:59], v64 offset:7168
    s_waitcnt lgkmcnt(7)
    ds_read_b128 v[60:63], v64 offset:23552
    s_waitcnt lgkmcnt(8)
    v_pk_add_f32 v[88:89], v[24:25], v[28:29]
    v_pk_add_f32 v[90:91], v[26:27], v[30:31]
    v_pk_add_f32 v[24:25], v[4:5], v[8:9]
    v_pk_add_f32 v[26:27], v[6:7], v[10:11]
    v_pk_add_f32 v[4:5], v[4:5], v[8:9] neg_lo:[0,1] neg_hi:[0,1]
    v_pk_add_f32 v[6:7], v[6:7], v[10:11] neg_lo:[0,1] neg_hi:[0,1]
    v_pk_add_f32 v[72:73], v[12:13], v[16:17]
    v_pk_add_f32 v[74:75], v[14:15], v[18:19]
    v_pk_add_f32 v[12:13], v[12:13], v[16:17] neg_lo:[0,1] neg_hi:[0,1]
    v_pk_add_f32 v[14:15], v[14:15], v[18:19] neg_lo:[0,1] neg_hi:[0,1]
    v_pk_fma_f32 v[72:73], v[24:25], s[4:5], v[72:73]
    v_pk_fma_f32 v[74:75], v[26:27], s[4:5], v[74:75]
    v_pk_fma_f32 v[20:21], v[0:1], s[10:11], v[20:21]
    v_pk_fma_f32 v[22:23], v[2:3], s[10:11], v[22:23]
    v_pk_fma_f32 v[72:73], v[0:1], s[6:7], v[72:73]
    v_pk_fma_f32 v[74:75], v[2:3], s[6:7], v[74:75]
    v_pk_add_f32 v[24:25], v[24:25], v[0:1] neg_lo:[0,1] neg_hi:[0,1]
    v_pk_add_f32 v[26:27], v[26:27], v[2:3] neg_lo:[0,1] neg_hi:[0,1]
    v_pk_fma_f32 v[72:73], v[88:89], s[8:9], v[72:73]
    v_pk_fma_f32 v[74:75], v[90:91], s[8:9], v[74:75]
    v_pk_add_f32 v[24:25], v[24:25], v[88:89] neg_lo:[0,1] neg_hi:[0,1]
    v_pk_add_f32 v[26:27], v[26:27], v[90:91] neg_lo:[0,1] neg_hi:[0,1]
    v_pk_fma_f32 v[20:21], v[88:89], s[22:23], v[20:21]
    v_pk_fma_f32 v[22:23], v[90:91], s[22:23], v[22:23]
    v_pk_add_f32 v[8:9], v[24:25], v[72:73] neg_lo:[0,1] neg_hi:[0,1]
    v_pk_add_f32 v[10:11], v[26:27], v[74:75] neg_lo:[0,1] neg_hi:[0,1]
    v_pk_fma_f32 v[20:21], v[72:73], s[14:15], v[20:21]
    v_pk_fma_f32 v[22:23], v[74:75], s[14:15], v[22:23]
    v_pk_mul_f32 v[80:81], v[12:13], s[32:33]
    v_pk_mul_f32 v[82:83], v[14:15], s[32:33]
    v_pk_fma_f32 v[20:21], v[8:9], s[12:13], v[20:21]
    v_pk_fma_f32 v[22:23], v[10:11], s[12:13], v[22:23]
    v_pk_fma_f32 v[80:81], v[4:5], s[34:35], v[80:81]
    v_pk_fma_f32 v[82:83], v[6:7], s[34:35], v[82:83]
    v_pk_fma_f32 v[64:65], v[4:5], s[24:25], v[20:21] neg_lo:[0,0,1] neg_hi:[0,0,1]
    v_pk_fma_f32 v[66:67], v[6:7], s[24:25], v[22:23] neg_lo:[0,0,1] neg_hi:[0,0,1]
    v_pk_fma_f32 v[64:65], v[12:13], s[26:27], v[64:65]
    v_pk_fma_f32 v[66:67], v[14:15], s[26:27], v[66:67]
    v_pk_fma_f32 v[80:81], v[64:65], s[38:39], v[80:81]
    v_pk_fma_f32 v[82:83], v[66:67], s[38:39], v[82:83]
    v_pk_add_f32 v[4:5], v[4:5], v[64:65] neg_lo:[0,1] neg_hi:[0,1]
    v_pk_add_f32 v[6:7], v[6:7], v[66:67] neg_lo:[0,1] neg_hi:[0,1]
    v_pk_add_f32 v[4:5], v[4:5], v[80:81] neg_lo:[0,1] neg_hi:[0,1]
    v_pk_add_f32 v[6:7], v[6:7], v[82:83] neg_lo:[0,1] neg_hi:[0,1]
    s_waitcnt lgkmcnt(0)
    v_pk_add_f32 v[92:93], v[56:57], v[60:61]
    v_pk_add_f32 v[94:95], v[58:59], v[62:63]
    v_pk_add_f32 v[56:57], v[36:37], v[40:41]
    v_pk_add_f32 v[58:59], v[38:39], v[42:43]
    v_pk_add_f32 v[36:37], v[36:37], v[40:41] neg_lo:[0,1] neg_hi:[0,1]
    v_pk_add_f32 v[38:39], v[38:39], v[42:43] neg_lo:[0,1] neg_hi:[0,1]
    v_pk_add_f32 v[76:77], v[44:45], v[48:49]
    v_pk_add_f32 v[78:79], v[46:47], v[50:51]
    v_pk_add_f32 v[44:45], v[44:45], v[48:49] neg_lo:[0,1] neg_hi:[0,1]
    v_pk_add_f32 v[46:47], v[46:47], v[50:51] neg_lo:[0,1] neg_hi:[0,1]
    v_pk_fma_f32 v[76:77], v[56:57], s[4:5], v[76:77]
    v_pk_fma_f32 v[78:79], v[58:59], s[4:5], v[78:79]
    v_pk_fma_f32 v[52:53], v[32:33], s[10:11], v[52:53]
    v_pk_fma_f32 v[54:55], v[34:35], s[10:11], v[54:55]
    v_pk_fma_f32 v[76:77], v[32:33], s[6:7], v[76:77]
    v_pk_fma_f32 v[78:79], v[34:35], s[6:7], v[78:79]
    v_pk_add_f32 v[56:57], v[56:57], v[32:33] neg_lo:[0,1] neg_hi:[0,1]
    v_pk_add_f32 v[58:59], v[58:59], v[34:35] neg_lo:[0,1] neg_hi:[0,1]
    v_pk_fma_f32 v[76:77], v[92:93], s[8:9], v[76:77]
    v_pk_fma_f32 v[78:79], v[94:95], s[8:9], v[78:79]
    v_pk_add_f32 v[56:57], v[56:57], v[92:93] neg_lo:[0,1] neg_hi:[0,1]
    v_pk_add_f32 v[58:59], v[58:59], v[94:95] neg_lo:[0,1] neg_hi:[0,1]
    v_pk_fma_f32 v[52:53], v[92:93], s[22:23], v[52:53]
    v_pk_fma_f32 v[54:55], v[94:95], s[22:23], v[54:55]
    v_pk_add_f32 v[40:41], v[56:57], v[76:77] neg_lo:[0,1] neg_hi:[0,1]
    v_pk_add_f32 v[42:43], v[58:59], v[78:79] neg_lo:[0,1] neg_hi:[0,1]
    v_pk_fma_f32 v[52:53], v[76:77], s[14:15], v[52:53]
    v_pk_fma_f32 v[54:55], v[78:79], s[14:15], v[54:55]
    v_pk_mul_f32 v[84:85], v[44:45], s[32:33]
    v_pk_mul_f32 v[86:87], v[46:47], s[32:33]
    v_pk_fma_f32 v[52:53], v[40:41], s[12:13], v[52:53]
    v_pk_fma_f32 v[54:55], v[42:43], s[12:13], v[54:55]
    v_pk_fma_f32 v[84:85], v[36:37], s[34:35], v[84:85]
    v_pk_fma_f32 v[86:87], v[38:39], s[34:35], v[86:87]
    v_pk_fma_f32 v[68:69], v[36:37], s[24:25], v[52:53] neg_lo:[0,0,1] neg_hi:[0,0,1]
    v_pk_fma_f32 v[70:71], v[38:39], s[24:25], v[54:55] neg_lo:[0,0,1] neg_hi:[0,0,1]
    v_pk_fma_f32 v[68:69], v[44:45], s[26:27], v[68:69]
    v_pk_fma_f32 v[70:71], v[46:47], s[26:27], v[70:71]
    v_pk_fma_f32 v[84:85], v[68:69], s[38:39], v[84:85]
    v_pk_fma_f32 v[86:87], v[70:71], s[38:39], v[86:87]
    v_pk_add_f32 v[36:37], v[36:37], v[68:69] neg_lo:[0,1] neg_hi:[0,1]
    v_pk_add_f32 v[38:39], v[38:39], v[70:71] neg_lo:[0,1] neg_hi:[0,1]
    v_pk_add_f32 v[36:37], v[36:37], v[84:85] neg_lo:[0,1] neg_hi:[0,1]
    v_pk_add_f32 v[38:39], v[38:39], v[86:87] neg_lo:[0,1] neg_hi:[0,1]
    s_mov_b32 s36, 0x00010001
    s_mov_b32 s37, 0x00010001
    s_mov_b64 exec, s[36:37]
    ds_write_b128 v127, v[0:3] offset:0
    ds_write_b128 v127, v[32:35] offset:16
    ds_write_b128 v127, v[4:7] offset:32
    ds_write_b128 v127, v[36:39] offset:48
    ds_write_b128 v127, v[8:11] offset:64
    ds_write_b128 v127, v[40:43] offset:80
    s_mov_b64 exec, -1
    v_mov_b32 v44, 0xc0135761
    v_mov_b32 v45, v44
    v_pk_mul_f32 v[16:17], v[64:65], v[64:65]
    v_pk_mul_f32 v[18:19], v[66:67], v[66:67]
    v_pk_mul_f32 v[20:21], v[68:69], v[68:69]
    v_pk_mul_f32 v[22:23], v[70:71], v[70:71]
    v_pk_fma_f32 v[16:17], v[16:17], s[40:41], v[44:45]
    v_pk_fma_f32 v[18:19], v[18:19], s[40:41], v[44:45]
    v_pk_fma_f32 v[20:21], v[20:21], s[40:41], v[44:45]
    v_pk_fma_f32 v[22:23], v[22:23], s[40:41], v[44:45]
    v_pk_mul_f32 v[16:17], v[16:17], v[64:65]
    v_pk_mul_f32 v[18:19], v[18:19], v[66:67]
    v_pk_mul_f32 v[20:21], v[20:21], v[68:69]
    v_pk_mul_f32 v[22:23], v[22:23], v[70:71]
    v_exp_f32 v16, v16
    v_exp_f32 v17, v17
    v_exp_f32 v18, v18
    v_exp_f32 v19, v19
    v_exp_f32 v20, v20
    v_exp_f32 v21, v21
    v_exp_f32 v22, v22
    v_exp_f32 v23, v23
    v_pk_add_f32 v[16:17], v[16:17], s[42:43]
    v_pk_add_f32 v[18:19], v[18:19], s[42:43]
    v_pk_add_f32 v[20:21], v[20:21], s[42:43]
    v_pk_add_f32 v[22:23], v[22:23], s[42:43]
    v_rcp_f32 v16, v16
    v_rcp_f32 v17, v17
    v_rcp_f32 v18, v18
    v_rcp_f32 v19, v19
    v_rcp_f32 v20, v20
    v_rcp_f32 v21, v21
    v_rcp_f32 v22, v22
    v_rcp_f32 v23, v23
    v_pk_mul_f32 v[64:65], v[64:65], v[16:17]
    v_pk_mul_f32 v[66:67], v[66:67], v[18:19]
    v_pk_mul_f32 v[68:69], v[68:69], v[20:21]
    v_pk_mul_f32 v[70:71], v[70:71], v[22:23]
    v_cvt_pk_bf16_f32 v48, v64, v68
    v_cvt_pk_bf16_f32 v49, v65, v69
    v_cvt_pk_bf16_f32 v50, v66, v70
    v_cvt_pk_bf16_f32 v51, v67, v71
    s_mov_b32 s44, 393280
    buffer_store_dwordx4 v[48:51], v122, s[16:19], s44 offen sc1
    s_waitcnt lgkmcnt(0)
    s_barrier
    ds_read_b128 v[96:99], v127 offset:512
    ds_read_b128 v[100:103], v127 offset:528
    ds_read_b128 v[104:107], v127 offset:544
    ds_read_b128 v[108:111], v127 offset:560
    ds_read_b128 v[112:115], v127 offset:576
    ds_read_b128 v[116:119], v127 offset:592
    s_waitcnt lgkmcnt(4)
    v_mov_b32_dpp v96, v0 row_shl:1 row_mask:0xf bank_mask:0xf
    v_mov_b32_dpp v97, v1 row_shl:1 row_mask:0xf bank_mask:0xf
    v_mov_b32_dpp v98, v2 row_shl:1 row_mask:0xf bank_mask:0xf
    v_mov_b32_dpp v99, v3 row_shl:1 row_mask:0xf bank_mask:0xf
    v_mov_b32_dpp v100, v32 row_shl:1 row_mask:0xf bank_mask:0xf
    v_mov_b32_dpp v101, v33 row_shl:1 row_mask:0xf bank_mask:0xf
    v_mov_b32_dpp v102, v34 row_shl:1 row_mask:0xf bank_mask:0xf
    v_mov_b32_dpp v103, v35 row_shl:1 row_mask:0xf bank_mask:0xf
    v_pk_add_f32 v[72:73], v[72:73], v[96:97]
    v_pk_add_f32 v[74:75], v[74:75], v[98:99]
    v_pk_add_f32 v[76:77], v[76:77], v[100:101]
    v_pk_add_f32 v[78:79], v[78:79], v[102:103]
    v_pk_mul_f32 v[24:25], v[72:73], v[72:73]
    v_pk_mul_f32 v[26:27], v[74:75], v[74:75]
    v_pk_mul_f32 v[28:29], v[76:77], v[76:77]
    v_pk_mul_f32 v[30:31], v[78:79], v[78:79]
    v_pk_fma_f32 v[24:25], v[24:25], s[40:41], v[44:45]
    v_pk_fma_f32 v[26:27], v[26:27], s[40:41], v[44:45]
    v_pk_fma_f32 v[28:29], v[28:29], s[40:41], v[44:45]
    v_pk_fma_f32 v[30:31], v[30:31], s[40:41], v[44:45]
    v_pk_mul_f32 v[24:25], v[24:25], v[72:73]
    v_pk_mul_f32 v[26:27], v[26:27], v[74:75]
    v_pk_mul_f32 v[28:29], v[28:29], v[76:77]
    v_pk_mul_f32 v[30:31], v[30:31], v[78:79]
    v_exp_f32 v24, v24
    v_exp_f32 v25, v25
    v_exp_f32 v26, v26
    v_exp_f32 v27, v27
    v_exp_f32 v28, v28
    v_exp_f32 v29, v29
    v_exp_f32 v30, v30
    v_exp_f32 v31, v31
    v_pk_add_f32 v[24:25], v[24:25], s[42:43]
    v_pk_add_f32 v[26:27], v[26:27], s[42:43]
    v_pk_add_f32 v[28:29], v[28:29], s[42:43]
    v_pk_add_f32 v[30:31], v[30:31], s[42:43]
    v_rcp_f32 v24, v24
    v_rcp_f32 v25, v25
    v_rcp_f32 v26, v26
    v_rcp_f32 v27, v27
    v_rcp_f32 v28, v28
    v_rcp_f32 v29, v29
    v_rcp_f32 v30, v30
    v_rcp_f32 v31, v31
    v_pk_mul_f32 v[72:73], v[72:73], v[24:25]
    v_pk_mul_f32 v[74:75], v[74:75], v[26:27]
    v_pk_mul_f32 v[76:77], v[76:77], v[28:29]
    v_pk_mul_f32 v[78:79], v[78:79], v[30:31]
    v_cvt_pk_bf16_f32 v52, v72, v76
    v_cvt_pk_bf16_f32 v53, v73, v77
    v_cvt_pk_bf16_f32 v54, v74, v78
    v_cvt_pk_bf16_f32 v55, v75, v79
    s_mov_b32 s44, 128
    buffer_store_dwordx4 v[52:55], v122, s[16:19], s44 offen sc1
    s_waitcnt lgkmcnt(2)
    v_mov_b32_dpp v104, v4 row_shl:1 row_mask:0xf bank_mask:0xf
    v_mov_b32_dpp v105, v5 row_shl:1 row_mask:0xf bank_mask:0xf
    v_mov_b32_dpp v106, v6 row_shl:1 row_mask:0xf bank_mask:0xf
    v_mov_b32_dpp v107, v7 row_shl:1 row_mask:0xf bank_mask:0xf
    v_mov_b32_dpp v108, v36 row_shl:1 row_mask:0xf bank_mask:0xf
    v_mov_b32_dpp v109, v37 row_shl:1 row_mask:0xf bank_mask:0xf
    v_mov_b32_dpp v110, v38 row_shl:1 row_mask:0xf bank_mask:0xf
    v_mov_b32_dpp v111, v39 row_shl:1 row_mask:0xf bank_mask:0xf
    v_pk_add_f32 v[80:81], v[80:81], v[104:105]
    v_pk_add_f32 v[82:83], v[82:83], v[106:107]
    v_pk_add_f32 v[84:85], v[84:85], v[108:109]
    v_pk_add_f32 v[86:87], v[86:87], v[110:111]
    v_pk_mul_f32 v[16:17], v[80:81], v[80:81]
    v_pk_mul_f32 v[18:19], v[82:83], v[82:83]
    v_pk_mul_f32 v[20:21], v[84:85], v[84:85]
    v_pk_mul_f32 v[22:23], v[86:87], v[86:87]
    v_pk_fma_f32 v[16:17], v[16:17], s[40:41], v[44:45]
    v_pk_fma_f32 v[18:19], v[18:19], s[40:41], v[44:45]
    v_pk_fma_f32 v[20:21], v[20:21], s[40:41], v[44:45]
    v_pk_fma_f32 v[22:23], v[22:23], s[40:41], v[44:45]
    v_pk_mul_f32 v[16:17], v[16:17], v[80:81]
    v_pk_mul_f32 v[18:19], v[18:19], v[82:83]
    v_pk_mul_f32 v[20:21], v[20:21], v[84:85]
    v_pk_mul_f32 v[22:23], v[22:23], v[86:87]
    v_exp_f32 v16, v16
    v_exp_f32 v17, v17
    v_exp_f32 v18, v18
    v_exp_f32 v19, v19
    v_exp_f32 v20, v20
    v_exp_f32 v21, v21
    v_exp_f32 v22, v22
    v_exp_f32 v23, v23
    v_pk_add_f32 v[16:17], v[16:17], s[42:43]
    v_pk_add_f32 v[18:19], v[18:19], s[42:43]
    v_pk_add_f32 v[20:21], v[20:21], s[42:43]
    v_pk_add_f32 v[22:23], v[22:23], s[42:43]
    v_rcp_f32 v16, v16
    v_rcp_f32 v17, v17
    v_rcp_f32 v18, v18
    v_rcp_f32 v19, v19
    v_rcp_f32 v20, v20
    v_rcp_f32 v21, v21
    v_rcp_f32 v22, v22
    v_rcp_f32 v23, v23
    v_pk_mul_f32 v[80:81], v[80:81], v[16:17]
    v_pk_mul_f32 v[82:83], v[82:83], v[18:19]
    v_pk_mul_f32 v[84:85], v[84:85], v[20:21]
    v_pk_mul_f32 v[86:87], v[86:87], v[22:23]
    v_cvt_pk_bf16_f32 v56, v80, v84
    v_cvt_pk_bf16_f32 v57, v81, v85
    v_cvt_pk_bf16_f32 v58, v82, v86
    v_cvt_pk_bf16_f32 v59, v83, v87
    s_mov_b32 s44, 131200
    buffer_store_dwordx4 v[56:59], v122, s[16:19], s44 offen sc1
    s_waitcnt lgkmcnt(0)
    v_mov_b32_dpp v112, v8 row_shl:1 row_mask:0xf bank_mask:0xf
    v_mov_b32_dpp v113, v9 row_shl:1 row_mask:0xf bank_mask:0xf
    v_mov_b32_dpp v114, v10 row_shl:1 row_mask:0xf bank_mask:0xf
    v_mov_b32_dpp v115, v11 row_shl:1 row_mask:0xf bank_mask:0xf
    v_mov_b32_dpp v116, v40 row_shl:1 row_mask:0xf bank_mask:0xf
    v_mov_b32_dpp v117, v41 row_shl:1 row_mask:0xf bank_mask:0xf
    v_mov_b32_dpp v118, v42 row_shl:1 row_mask:0xf bank_mask:0xf
    v_mov_b32_dpp v119, v43 row_shl:1 row_mask:0xf bank_mask:0xf
    v_pk_add_f32 v[88:89], v[88:89], v[112:113]
    v_pk_add_f32 v[90:91], v[90:91], v[114:115]
    v_pk_add_f32 v[92:93], v[92:93], v[116:117]
    v_pk_add_f32 v[94:95], v[94:95], v[118:119]
    v_pk_mul_f32 v[24:25], v[88:89], v[88:89]
    v_pk_mul_f32 v[26:27], v[90:91], v[90:91]
    v_pk_mul_f32 v[28:29], v[92:93], v[92:93]
    v_pk_mul_f32 v[30:31], v[94:95], v[94:95]
    v_pk_fma_f32 v[24:25], v[24:25], s[40:41], v[44:45]
    v_pk_fma_f32 v[26:27], v[26:27], s[40:41], v[44:45]
    v_pk_fma_f32 v[28:29], v[28:29], s[40:41], v[44:45]
    v_pk_fma_f32 v[30:31], v[30:31], s[40:41], v[44:45]
    v_pk_mul_f32 v[24:25], v[24:25], v[88:89]
    v_pk_mul_f32 v[26:27], v[26:27], v[90:91]
    v_pk_mul_f32 v[28:29], v[28:29], v[92:93]
    v_pk_mul_f32 v[30:31], v[30:31], v[94:95]
    v_exp_f32 v24, v24
    v_exp_f32 v25, v25
    v_exp_f32 v26, v26
    v_exp_f32 v27, v27
    v_exp_f32 v28, v28
    v_exp_f32 v29, v29
    v_exp_f32 v30, v30
    v_exp_f32 v31, v31
    v_pk_add_f32 v[24:25], v[24:25], s[42:43]
    v_pk_add_f32 v[26:27], v[26:27], s[42:43]
    v_pk_add_f32 v[28:29], v[28:29], s[42:43]
    v_pk_add_f32 v[30:31], v[30:31], s[42:43]
    v_rcp_f32 v24, v24
    v_rcp_f32 v25, v25
    v_rcp_f32 v26, v26
    v_rcp_f32 v27, v27
    v_rcp_f32 v28, v28
    v_rcp_f32 v29, v29
    v_rcp_f32 v30, v30
    v_rcp_f32 v31, v31
    v_pk_mul_f32 v[88:89], v[88:89], v[24:25]
    v_pk_mul_f32 v[90:91], v[90:91], v[26:27]
    v_pk_mul_f32 v[92:93], v[92:93], v[28:29]
    v_pk_mul_f32 v[94:95], v[94:95], v[30:31]
    v_cvt_pk_bf16_f32 v60, v88, v92
    v_cvt_pk_bf16_f32 v61, v89, v93
    v_cvt_pk_bf16_f32 v62, v90, v94
    v_cvt_pk_bf16_f32 v63, v91, v95
    s_mov_b32 s44, 262272
    buffer_store_dwordx4 v[60:63], v122, s[16:19], s44 offen sc1
L_conv1_kernel_end:
L_conv1_kernel_done:
    s_endpgm
.globl conv2_kernel
.p2align 8
.type conv2_kernel,@function
conv2_kernel:
    s_cmp_ge_u32 s2, 256
    s_cbranch_scc1 L_conv2_kernel_done
    s_load_dwordx2 s[4:5], s[0:1], 72
    s_load_dwordx2 s[30:31], s[0:1], 72
    v_readfirstlane_b32 s20, v0
    s_lshr_b32 s20, s20, 6
    s_xor_b32 s20, s20, 8
    s_and_b32 s36, s2, 0
    s_lshl_b32 s36, s36, 3
    s_bfe_u32 s37, s2, 196611
    s_or_b32 s29, s36, s37
    s_bfe_u32 s36, s2, 196608
    s_lshl_b32 s36, s36, 2
    s_lshr_b32 s37, s2, 6
    s_or_b32 s36, s36, s37
    s_lshr_b32 s33, s36, 4
    s_and_b32 s34, s36, 7
    s_bfe_u32 s35, s36, 0x10003
    s_mul_i32 s21, s34, 500
    s_and_b32 s32, s20, 3
    v_and_b32 v127, 63, v0
    v_lshrrev_b32 v5, 2, v127
    v_and_b32 v6, 3, v127
    s_and_b32 s42, s20, 7
    s_lshr_b32 s41, s21, 2
    s_sub_u32 s41, s41, 1
    s_add_u32 s37, s41, s42
    v_lshl_add_u32 v7, v5, 3, s37
    s_mul_i32 s36, s35, 4194304
    s_add_u32 s36, s36, 18874368
    s_mov_b32 s10, 4194304
    s_mov_b32 s11, 0x00020000
    s_mov_b32 s25, 0xffff0000
    s_mov_b32 s47, s36
    s_cmp_ge_u32 s20, 8
    s_cbranch_scc0 L_conv2_kernel_mw
L_conv2_kernel_helper:
    s_setprio 3
    v_lshlrev_b32 v8, 4, v6
    s_add_u32 s37, s33, 4294967289
    v_lshl_add_u32 v9, v7, 3, s37
    v_cmp_gt_u32 vcc, 8000, v9
    s_mul_i32 s37, s33, 131072
    s_add_u32 s37, s37, 0
    v_lshl_add_u32 v92, v7, 7, s37
    v_add_u32 v92, v92, v8
    v_mov_b32 v9, 2130706432
    v_cndmask_b32 v92, v9, v92, vcc
    s_add_u32 s37, s33, 4294967291
    v_lshl_add_u32 v9, v7, 3, s37
    v_cmp_gt_u32 vcc, 8000, v9
    s_mul_i32 s37, s33, 131072
    s_add_u32 s37, s37, 262144
    v_lshl_add_u32 v93, v7, 7, s37
    v_add_u32 v93, v93, v8
    v_mov_b32 v9, 2130706432
    v_cndmask_b32 v93, v9, v93, vcc
    s_add_u32 s37, s33, 4294967293
    v_lshl_add_u32 v9, v7, 3, s37
    v_cmp_gt_u32 vcc, 8000, v9
    s_mul_i32 s37, s33, 131072
    s_add_u32 s37, s37, 64
    v_lshl_add_u32 v94, v7, 7, s37
    v_add_u32 v94, v94, v8
    v_mov_b32 v9, 2130706432
    v_cndmask_b32 v94, v9, v94, vcc
    s_add_u32 s37, s33, 4294967295
    v_lshl_add_u32 v9, v7, 3, s37
    v_cmp_gt_u32 vcc, 8000, v9
    s_mul_i32 s37, s33, 131072
    s_add_u32 s37, s37, 262208
    v_lshl_add_u32 v95, v7, 7, s37
    v_add_u32 v95, v95, v8
    v_mov_b32 v9, 2130706432
    v_cndmask_b32 v95, v9, v95, vcc
    v_and_b32 v76, 4, v5
    v_lshrrev_b32 v76, 1, v76
    v_xor_b32 v76, v6, v76
    v_lshlrev_b32 v76, 4, v76
    v_lshl_add_u32 v76, v5, 6, v76
    s_mov_b32 s24, 0
    s_mov_b32 s27, 524288
    s_waitcnt lgkmcnt(0)
    s_add_u32 s8, s4, s47
    s_addc_u32 s9, s5, 0
    buffer_load_dwordx4 v[0:3], v92, s[8:11], s24 offen
    buffer_load_dwordx4 v[8:11], v94, s[8:11], s24 offen
    buffer_load_dwordx4 v[4:7], v93, s[8:11], s24 offen
    buffer_load_dwordx4 v[12:15], v95, s[8:11], s24 offen
    buffer_load_dwordx4 v[16:19], v92, s[8:11], s27 offen
    buffer_load_dwordx4 v[24:27], v94, s[8:11], s27 offen
    buffer_load_dwordx4 v[20:23], v93, s[8:11], s27 offen
    buffer_load_dwordx4 v[28:31], v95, s[8:11], s27 offen
    s_mul_i32 s36, s42, 1024
    v_add_u32 v96, s36, v76
    v_add_u32 v97, 65536, v96
    s_mul_i32 s36, s42, 1088
    s_add_u32 s36, s36, 98304
    v_add_u32 v98, s36, v76
    s_mov_b32 s28, 0
    s_mov_b32 s24, 1048576
    s_cmp_ge_u32 s20, 12
    s_cselect_b32 s44, 252, 0
    s_cselect_b32 s45, 129, -1
    s_setprio 0
    s_cbranch_scc1 L_conv2_kernel_hloop
    s_setprio 1
L_conv2_kernel_hloop:
    s_waitcnt vmcnt(4)
    v_lshlrev_b32 v76, 16, v0
    v_and_b32 v84, s25, v0
    v_lshlrev_b32 v77, 16, v4
    v_and_b32 v85, s25, v4
    v_lshlrev_b32 v78, 16, v8
    v_and_b32 v86, s25, v8
    v_lshlrev_b32 v79, 16, v12
    v_and_b32 v87, s25, v12
    v_add_f32 v80, v76, v78
    v_add_f32 v88, v84, v86
    v_add_f32 v81, v77, v79
    v_add_f32 v89, v85, v87
    v_fma_f32 v82, v78, 4.0, v76
    v_fma_f32 v90, v86, 4.0, v84
    v_fma_f32 v83, v79, 4.0, v77
    v_fma_f32 v91, v87, 4.0, v85
    v_add_f32 v77, v80, v81
    v_add_f32 v85, v88, v89
    v_sub_f32 v78, v80, v81
    v_sub_f32 v86, v88, v89
    v_fma_f32 v79, v83, 2.0, v82
    v_fma_f32 v87, v91, 2.0, v90
    v_fma_f32 v82, v83, -2.0, v82
    v_fma_f32 v90, v91, -2.0, v90
    v_fmamk_f32 v80, v76, 0x41700000, v82
    v_fmamk_f32 v88, v84, 0x41700000, v90
    v_fmamk_f32 v80, v81, 0x41200000, v80
    v_fmamk_f32 v88, v89, 0x41200000, v88
    v_cvt_pk_bf16_f32 v4, v77, v85
    v_cvt_pk_bf16_f32 v8, v78, v86
    v_cvt_pk_bf16_f32 v64, v79, v87
    v_cvt_pk_bf16_f32 v68, v82, v90
    v_cvt_pk_bf16_f32 v72, v80, v88
    v_lshlrev_b32 v76, 16, v1
    v_and_b32 v84, s25, v1
    v_lshlrev_b32 v77, 16, v5
    v_and_b32 v85, s25, v5
    v_lshlrev_b32 v78, 16, v9
    v_and_b32 v86, s25, v9
    v_lshlrev_b32 v79, 16, v13
    v_and_b32 v87, s25, v13
    v_add_f32 v80, v76, v78
    v_add_f32 v88, v84, v86
    v_add_f32 v81, v77, v79
    v_add_f32 v89, v85, v87
    v_fma_f32 v82, v78, 4.0, v76
    v_fma_f32 v90, v86, 4.0, v84
    v_fma_f32 v83, v79, 4.0, v77
    v_fma_f32 v91, v87, 4.0, v85
    v_add_f32 v77, v80, v81
    v_add_f32 v85, v88, v89
    v_sub_f32 v78, v80, v81
    v_sub_f32 v86, v88, v89
    v_fma_f32 v79, v83, 2.0, v82
    v_fma_f32 v87, v91, 2.0, v90
    v_fma_f32 v82, v83, -2.0, v82
    v_fma_f32 v90, v91, -2.0, v90
    v_fmamk_f32 v80, v76, 0x41700000, v82
    v_fmamk_f32 v88, v84, 0x41700000, v90
    v_fmamk_f32 v80, v81, 0x41200000, v80
    v_fmamk_f32 v88, v89, 0x41200000, v88
    v_cvt_pk_bf16_f32 v5, v77, v85
    v_cvt_pk_bf16_f32 v9, v78, v86
    v_cvt_pk_bf16_f32 v65, v79, v87
    v_cvt_pk_bf16_f32 v69, v82, v90
    v_cvt_pk_bf16_f32 v73, v80, v88
    v_lshlrev_b32 v76, 16, v2
    v_and_b32 v84, s25, v2
    v_lshlrev_b32 v77, 16, v6
    v_and_b32 v85, s25, v6
    v_lshlrev_b32 v78, 16, v10
    v_and_b32 v86, s25, v10
    v_lshlrev_b32 v79, 16, v14
    v_and_b32 v87, s25, v14
    v_add_f32 v80, v76, v78
    v_add_f32 v88, v84, v86
    v_add_f32 v81, v77, v79
    v_add_f32 v89, v85, v87
    v_fma_f32 v82, v78, 4.0, v76
    v_fma_f32 v90, v86, 4.0, v84
    v_fma_f32 v83, v79, 4.0, v77
    v_fma_f32 v91, v87, 4.0, v85
    v_add_f32 v77, v80, v81
    v_add_f32 v85, v88, v89
    v_sub_f32 v78, v80, v81
    v_sub_f32 v86, v88, v89
    v_fma_f32 v79, v83, 2.0, v82
    v_fma_f32 v87, v91, 2.0, v90
    v_fma_f32 v82, v83, -2.0, v82
    v_fma_f32 v90, v91, -2.0, v90
    v_fmamk_f32 v80, v76, 0x41700000, v82
    v_fmamk_f32 v88, v84, 0x41700000, v90
    v_fmamk_f32 v80, v81, 0x41200000, v80
    v_fmamk_f32 v88, v89, 0x41200000, v88
    v_cvt_pk_bf16_f32 v6, v77, v85
    v_cvt_pk_bf16_f32 v10, v78, v86
    v_cvt_pk_bf16_f32 v66, v79, v87
    v_cvt_pk_bf16_f32 v70, v82, v90
    v_cvt_pk_bf16_f32 v74, v80, v88
    v_lshlrev_b32 v76, 16, v3
    v_and_b32 v84, s25, v3
    v_lshlrev_b32 v77, 16, v7
    v_and_b32 v85, s25, v7
    v_lshlrev_b32 v78, 16, v11
    v_and_b32 v86, s25, v11
    v_lshlrev_b32 v79, 16, v15
    v_and_b32 v87, s25, v15
    v_add_f32 v80, v76, v78
    v_add_f32 v88, v84, v86
    v_add_f32 v81, v77, v79
    v_add_f32 v89, v85, v87
    v_fma_f32 v82, v78, 4.0, v76
    v_fma_f32 v90, v86, 4.0, v84
    v_fma_f32 v83, v79, 4.0, v77
    v_fma_f32 v91, v87, 4.0, v85
    v_add_f32 v77, v80, v81
    v_add_f32 v85, v88, v89
    v_sub_f32 v78, v80, v81
    v_sub_f32 v86, v88, v89
    v_fma_f32 v79, v83, 2.0, v82
    v_fma_f32 v87, v91, 2.0, v90
    v_fma_f32 v82, v83, -2.0, v82
    v_fma_f32 v90, v91, -2.0, v90
    v_fmamk_f32 v80, v76, 0x41700000, v82
    v_fmamk_f32 v88, v84, 0x41700000, v90
    v_fmamk_f32 v80, v81, 0x41200000, v80
    v_fmamk_f32 v88, v89, 0x41200000, v88
    v_cvt_pk_bf16_f32 v7, v77, v85
    v_cvt_pk_bf16_f32 v11, v78, v86
    v_cvt_pk_bf16_f32 v67, v79, v87
    v_cvt_pk_bf16_f32 v71, v82, v90
    v_cvt_pk_bf16_f32 v75, v80, v88
    s_bitcmp1_b32 s44, s28
    s_cbranch_scc0 L_conv2_kernel_sa0
    s_waitcnt lgkmcnt(0)
    s_barrier
L_conv2_kernel_sa0:
    ds_write_b128 v96, v[64:67] offset:49152
    ds_write_b128 v97, v[68:71] offset:0
    ds_write_b128 v97, v[72:75] offset:16384
    ds_write_b128 v96, v[0:3] offset:0
    ds_write_b128 v96, v[4:7] offset:16384
    ds_write_b128 v96, v[8:11] offset:32768
    ds_write_b128 v98, v[12:15] offset:0
    buffer_load_dwordx4 v[0:3], v92, s[8:11], s24 offen
    buffer_load_dwordx4 v[8:11], v94, s[8:11], s24 offen
    buffer_load_dwordx4 v[4:7], v93, s[8:11], s24 offen
    buffer_load_dwordx4 v[12:15], v95, s[8:11], s24 offen
    s_add_u32 s24, s24, 524288
    s_bitcmp1_b32 s45, s28
    s_cbranch_scc0 L_conv2_kernel_sb0
    s_waitcnt lgkmcnt(0)
    s_barrier
L_conv2_kernel_sb0:
    s_add_u32 s28, s28, 1
    s_waitcnt vmcnt(4)
    v_lshlrev_b32 v76, 16, v16
    v_and_b32 v84, s25, v16
    v_lshlrev_b32 v77, 16, v20
    v_and_b32 v85, s25, v20
    v_lshlrev_b32 v78, 16, v24
    v_and_b32 v86, s25, v24
    v_lshlrev_b32 v79, 16, v28
    v_and_b32 v87, s25, v28
    v_add_f32 v80, v76, v78
    v_add_f32 v88, v84, v86
    v_add_f32 v81, v77, v79
    v_add_f32 v89, v85, v87
    v_fma_f32 v82, v78, 4.0, v76
    v_fma_f32 v90, v86, 4.0, v84
    v_fma_f32 v83, v79, 4.0, v77
    v_fma_f32 v91, v87, 4.0, v85
    v_add_f32 v77, v80, v81
    v_add_f32 v85, v88, v89
    v_sub_f32 v78, v80, v81
    v_sub_f32 v86, v88, v89
    v_fma_f32 v79, v83, 2.0, v82
    v_fma_f32 v87, v91, 2.0, v90
    v_fma_f32 v82, v83, -2.0, v82
    v_fma_f32 v90, v91, -2.0, v90
    v_fmamk_f32 v80, v76, 0x41700000, v82
    v_fmamk_f32 v88, v84, 0x41700000, v90
    v_fmamk_f32 v80, v81, 0x41200000, v80
    v_fmamk_f32 v88, v89, 0x41200000, v88
    v_cvt_pk_bf16_f32 v20, v77, v85
    v_cvt_pk_bf16_f32 v24, v78, v86
    v_cvt_pk_bf16_f32 v64, v79, v87
    v_cvt_pk_bf16_f32 v68, v82, v90
    v_cvt_pk_bf16_f32 v72, v80, v88
    v_lshlrev_b32 v76, 16, v17
    v_and_b32 v84, s25, v17
    v_lshlrev_b32 v77, 16, v21
    v_and_b32 v85, s25, v21
    v_lshlrev_b32 v78, 16, v25
    v_and_b32 v86, s25, v25
    v_lshlrev_b32 v79, 16, v29
    v_and_b32 v87, s25, v29
    v_add_f32 v80, v76, v78
    v_add_f32 v88, v84, v86
    v_add_f32 v81, v77, v79
    v_add_f32 v89, v85, v87
    v_fma_f32 v82, v78, 4.0, v76
    v_fma_f32 v90, v86, 4.0, v84
    v_fma_f32 v83, v79, 4.0, v77
    v_fma_f32 v91, v87, 4.0, v85
    v_add_f32 v77, v80, v81
    v_add_f32 v85, v88, v89
    v_sub_f32 v78, v80, v81
    v_sub_f32 v86, v88, v89
    v_fma_f32 v79, v83, 2.0, v82
    v_fma_f32 v87, v91, 2.0, v90
    v_fma_f32 v82, v83, -2.0, v82
    v_fma_f32 v90, v91, -2.0, v90
    v_fmamk_f32 v80, v76, 0x41700000, v82
    v_fmamk_f32 v88, v84, 0x41700000, v90
    v_fmamk_f32 v80, v81, 0x41200000, v80
    v_fmamk_f32 v88, v89, 0x41200000, v88
    v_cvt_pk_bf16_f32 v21, v77, v85
    v_cvt_pk_bf16_f32 v25, v78, v86
    v_cvt_pk_bf16_f32 v65, v79, v87
    v_cvt_pk_bf16_f32 v69, v82, v90
    v_cvt_pk_bf16_f32 v73, v80, v88
    v_lshlrev_b32 v76, 16, v18
    v_and_b32 v84, s25, v18
    v_lshlrev_b32 v77, 16, v22
    v_and_b32 v85, s25, v22
    v_lshlrev_b32 v78, 16, v26
    v_and_b32 v86, s25, v26
    v_lshlrev_b32 v79, 16, v30
    v_and_b32 v87, s25, v30
    v_add_f32 v80, v76, v78
    v_add_f32 v88, v84, v86
    v_add_f32 v81, v77, v79
    v_add_f32 v89, v85, v87
    v_fma_f32 v82, v78, 4.0, v76
    v_fma_f32 v90, v86, 4.0, v84
    v_fma_f32 v83, v79, 4.0, v77
    v_fma_f32 v91, v87, 4.0, v85
    v_add_f32 v77, v80, v81
    v_add_f32 v85, v88, v89
    v_sub_f32 v78, v80, v81
    v_sub_f32 v86, v88, v89
    v_fma_f32 v79, v83, 2.0, v82
    v_fma_f32 v87, v91, 2.0, v90
    v_fma_f32 v82, v83, -2.0, v82
    v_fma_f32 v90, v91, -2.0, v90
    v_fmamk_f32 v80, v76, 0x41700000, v82
    v_fmamk_f32 v88, v84, 0x41700000, v90
    v_fmamk_f32 v80, v81, 0x41200000, v80
    v_fmamk_f32 v88, v89, 0x41200000, v88
    v_cvt_pk_bf16_f32 v22, v77, v85
    v_cvt_pk_bf16_f32 v26, v78, v86
    v_cvt_pk_bf16_f32 v66, v79, v87
    v_cvt_pk_bf16_f32 v70, v82, v90
    v_cvt_pk_bf16_f32 v74, v80, v88
    v_lshlrev_b32 v76, 16, v19
    v_and_b32 v84, s25, v19
    v_lshlrev_b32 v77, 16, v23
    v_and_b32 v85, s25, v23
    v_lshlrev_b32 v78, 16, v27
    v_and_b32 v86, s25, v27
    v_lshlrev_b32 v79, 16, v31
    v_and_b32 v87, s25, v31
    v_add_f32 v80, v76, v78
    v_add_f32 v88, v84, v86
    v_add_f32 v81, v77, v79
    v_add_f32 v89, v85, v87
    v_fma_f32 v82, v78, 4.0, v76
    v_fma_f32 v90, v86, 4.0, v84
    v_fma_f32 v83, v79, 4.0, v77
    v_fma_f32 v91, v87, 4.0, v85
    v_add_f32 v77, v80, v81
    v_add_f32 v85, v88, v89
    v_sub_f32 v78, v80, v81
    v_sub_f32 v86, v88, v89
    v_fma_f32 v79, v83, 2.0, v82
    v_fma_f32 v87, v91, 2.0, v90
    v_fma_f32 v82, v83, -2.0, v82
    v_fma_f32 v90, v91, -2.0, v90
    v_fmamk_f32 v80, v76, 0x41700000, v82
    v_fmamk_f32 v88, v84, 0x41700000, v90
    v_fmamk_f32 v80, v81, 0x41200000, v80
    v_fmamk_f32 v88, v89, 0x41200000, v88
    v_cvt_pk_bf16_f32 v23, v77, v85
    v_cvt_pk_bf16_f32 v27, v78, v86
    v_cvt_pk_bf16_f32 v67, v79, v87
    v_cvt_pk_bf16_f32 v71, v82, v90
    v_cvt_pk_bf16_f32 v75, v80, v88
    s_bitcmp1_b32 s44, s28
    s_cbranch_scc0 L_conv2_kernel_sa1
    s_waitcnt lgkmcnt(0)
    s_barrier
L_conv2_kernel_sa1:
    ds_write_b128 v96, v[64:67] offset:57344
    ds_write_b128 v97, v[68:71] offset:8192
    ds_write_b128 v97, v[72:75] offset:24576
    ds_write_b128 v96, v[16:19] offset:8192
    ds_write_b128 v96, v[20:23] offset:24576
    ds_write_b128 v96, v[24:27] offset:40960
    ds_write_b128 v98, v[28:31] offset:8704
    buffer_load_dwordx4 v[16:19], v92, s[8:11], s24 offen
    buffer_load_dwordx4 v[24:27], v94, s[8:11], s24 offen
    buffer_load_dwordx4 v[20:23], v93, s[8:11], s24 offen
    buffer_load_dwordx4 v[28:31], v95, s[8:11], s24 offen
    s_add_u32 s24, s24, 524288
    s_bitcmp1_b32 s45, s28
    s_cbranch_scc0 L_conv2_kernel_sb1
    s_waitcnt lgkmcnt(0)
    s_barrier
L_conv2_kernel_sb1:
    s_add_u32 s28, s28, 1
    s_cmp_lt_u32 s28, 8
    s_cbranch_scc1 L_conv2_kernel_hloop
    s_cmp_ge_u32 s20, 12
    s_cbranch_scc1 L_conv2_kernel_end
    s_add_u32 s12, s30, 44040192
    s_addc_u32 s13, s31, 0
    s_mov_b32 s14, 294912
    s_mov_b32 s15, 0x00020000
    s_lshr_b32 s36, s2, 3
    s_lshl_b32 s36, s36, 2
    s_add_u32 s36, s36, s32
    s_mul_i32 s36, s36, 2304
    v_lshlrev_b32 v1, 4, v127
    buffer_load_dwordx4 v[4:7], v1, s[12:15], s36 offen offset:0
    buffer_load_dwordx4 v[4:7], v1, s[12:15], s36 offen offset:1024
    buffer_load_dwordx4 v[4:7], v1, s[12:15], s36 offen offset:2048
    s_cmp_ge_u32 s2, 32
    s_cbranch_scc1 L_conv2_kernel_ntw
    s_getpc_b64 s[36:37]
L_conv2_kernel_pc:
    s_lshl_b32 s38, s32, 13
    s_add_u32 s38, s38, L_conv2_kernel_epi-L_conv2_kernel_pc
    v_lshl_add_u32 v2, v127, 7, s38
    v_min_u32 v2, L_joint_kernel_done-L_conv2_kernel_pc, v2
    v_mov_b32 v3, s37
    v_add_co_u32 v2, vcc, s36, v2
    s_nop 1
    v_addc_co_u32 v3, vcc, 0, v3, vcc
    global_load_dword v4, v[2:3], off
L_conv2_kernel_ntw:
    s_branch L_conv2_kernel_end
L_conv2_kernel_mw:
    s_add_u32 s37, s41, 128
    v_mov_b32 v16, s37
    v_mul_u32_u24 v17, 524288, v5
    v_lshl_add_u32 v17, v6, 4, v17
    s_add_u32 s37, s33, 4294967289
    v_lshl_add_u32 v18, v16, 3, s37
    v_cmp_gt_u32 vcc, 8000, v18
    s_mul_i32 s37, s33, 131072
    s_add_u32 s37, s37, 0
    v_lshl_add_u32 v108, v16, 7, s37
    v_add_u32 v108, v108, v17
    v_mov_b32 v18, 2130706432
    v_cndmask_b32 v108, v18, v108, vcc
    s_add_u32 s37, s33, 4294967291
    v_lshl_add_u32 v18, v16, 3, s37
    v_cmp_gt_u32 vcc, 8000, v18
    s_mul_i32 s37, s33, 131072
    s_add_u32 s37, s37, 262144
    v_lshl_add_u32 v109, v16, 7, s37
    v_add_u32 v109, v109, v17
    v_mov_b32 v18, 2130706432
    v_cndmask_b32 v109, v18, v109, vcc
    s_add_u32 s37, s33, 4294967293
    v_lshl_add_u32 v18, v16, 3, s37
    v_cmp_gt_u32 vcc, 8000, v18
    s_mul_i32 s37, s33, 131072
    s_add_u32 s37, s37, 64
    v_lshl_add_u32 v110, v16, 7, s37
    v_add_u32 v110, v110, v17
    v_mov_b32 v18, 2130706432
    v_cndmask_b32 v110, v18, v110, vcc
    s_waitcnt lgkmcnt(0)
    s_add_u32 s8, s4, s47
    s_addc_u32 s9, s5, 0
    s_lshl_b32 s36, s29, 4
    s_lshl_b32 s37, s33, 3
    s_add_u32 s36, s36, s37
    s_mul_i32 s36, s36, 57344
    s_add_u32 s36, s36, 9437184
    s_add_u32 s12, s30, s36
    s_addc_u32 s13, s31, 0
    s_mov_b32 s14, 458752
    s_mov_b32 s15, 0x00020000
    s_mul_i32 s36, s35, 2097152
    s_add_u32 s36, s36, 27262976
    s_mul_i32 s37, s33, 8388608
    s_add_u32 s36, s36, s37
    s_add_u32 s16, s30, s36
    s_addc_u32 s17, s31, 0
    s_mov_b32 s18, 2097152
    s_mov_b32 s19, 0x00020000
    v_and_b32 v10, 15, v127
    v_lshrrev_b32 v11, 4, v127
    v_add_u32 v8, 0, v10
    v_and_b32 v16, 4, v8
    v_lshrrev_b32 v16, 1, v16
    v_xor_b32 v16, v11, v16
    v_lshlrev_b32 v16, 4, v16
    v_lshl_add_u32 v8, v8, 6, v16
    v_add_u32 v9, 1, v10
    v_and_b32 v16, 4, v9
    v_lshrrev_b32 v16, 1, v16
    v_xor_b32 v16, v11, v16
    v_lshlrev_b32 v16, 4, v16
    v_lshl_add_u32 v9, v9, 6, v16
    s_lshr_b32 s38, s32, 1
    s_and_b32 s39, s32, 1
    s_add_u32 s40, s38, 4
    s_lshl_b32 s43, s39, 10
    s_cmp_lt_u32 s20, 4
    s_cselect_b32 s40, s20, s40
    s_cselect_b32 s36, 0, s43
    s_lshl_b32 s37, s40, 13
    s_add_u32 s37, s37, s36
    v_lshl_add_u32 v125, v127, 4, s37
    s_mul_i32 s37, s40, 16384
    v_add_u32 v120, s37, v8
    v_add_u32 v121, s37, v9
    s_lshl_b32 s37, s40, 10
    s_add_u32 s37, s37, 115712
    v_lshl_add_u32 v16, v11, 4, s37
    v_cmp_eq_u32 vcc, 15, v10
    v_mov_b32 v17, 8192
    v_mov_b32 v18, 4294959104
    v_mov_b32 v19, 64
    v_cndmask_b32 v122, v121, v16, vcc
    v_cndmask_b32 v123, v17, v19, vcc
    v_cndmask_b32 v124, v18, v19, vcc
    v_lshl_add_u32 v126, v127, 4, s37
    s_mov_b32 s44, 0x3f800000
    s_mov_b32 s45, 0x00000000
    s_mov_b32 s46, 0x00000000
    s_cmp_eq_u32 s40, 1
    s_cselect_b32 s45, 0x3f800000, s45
    s_cselect_b32 s46, 0x3f800000, s46
    s_cmp_eq_u32 s40, 2
    s_cselect_b32 s45, 0xbf800000, s45
    s_cselect_b32 s46, 0x3f800000, s46
    s_cmp_eq_u32 s40, 3
    s_cselect_b32 s45, 0x40000000, s45
    s_cselect_b32 s46, 0x40800000, s46
    s_cmp_eq_u32 s40, 4
    s_cselect_b32 s45, 0xc0000000, s45
    s_cselect_b32 s46, 0x40800000, s46
    s_cmp_eq_u32 s40, 5
    s_cselect_b32 s44, 0x41800000, s44
    s_cselect_b32 s45, 0x41000000, s45
    s_cselect_b32 s46, 0x40800000, s46
    s_cmp_ge_u32 s20, 4
    s_cbranch_scc1 L_conv2_kernel_m2
    v_mov_b32 v0, 0
    v_mov_b32 v1, 0
    v_mov_b32 v2, 0
    v_mov_b32 v3, 0
    v_mov_b32 v4, 0
    v_mov_b32 v5, 0
    v_mov_b32 v6, 0
    v_mov_b32 v7, 0
    v_mov_b32 v8, 0
    v_mov_b32 v9, 0
    v_mov_b32 v10, 0
    v_mov_b32 v11, 0
    v_mov_b32 v12, 0
    v_mov_b32 v13, 0
    v_mov_b32 v14, 0
    v_mov_b32 v15, 0
    v_mov_b32 v16, 0
    v_mov_b32 v17, 0
    v_mov_b32 v18, 0
    v_mov_b32 v19, 0
    v_mov_b32 v20, 0
    v_mov_b32 v21, 0
    v_mov_b32 v22, 0
    v_mov_b32 v23, 0
    v_mov_b32 v24, 0
    v_mov_b32 v25, 0
    v_mov_b32 v26, 0
    v_mov_b32 v27, 0
    v_mov_b32 v28, 0
    v_mov_b32 v29, 0
    v_mov_b32 v30, 0
    v_mov_b32 v31, 0
    v_mov_b32 v32, 0
    v_mov_b32 v33, 0
    v_mov_b32 v34, 0
    v_mov_b32 v35, 0
    v_mov_b32 v36, 0
    v_mov_b32 v37, 0
    v_mov_b32 v38, 0
    v_mov_b32 v39, 0
    v_mov_b32 v40, 0
    v_mov_b32 v41, 0
    v_mov_b32 v42, 0
    v_mov_b32 v43, 0
    v_mov_b32 v44, 0
    v_mov_b32 v45, 0
    v_mov_b32 v46, 0
    v_mov_b32 v47, 0
    v_mov_b32 v48, 0
    v_mov_b32 v49, 0
    v_mov_b32 v50, 0
    v_mov_b32 v51, 0
    v_mov_b32 v52, 0
    v_mov_b32 v53, 0
    v_mov_b32 v54, 0
    v_mov_b32 v55, 0
    v_mov_b32 v56, 0
    v_mov_b32 v57, 0
    v_mov_b32 v58, 0
    v_mov_b32 v59, 0
    v_mov_b32 v60, 0
    v_mov_b32 v61, 0
    v_mov_b32 v62, 0
    v_mov_b32 v63, 0
    buffer_load_dwordx4 v[96:99], v108, s[8:11], 0 offen
    buffer_load_dwordx4 v[100:103], v109, s[8:11], 0 offen
    buffer_load_dwordx4 v[104:107], v110, s[8:11], 0 offen
    s_mov_b32 s23, 0
    s_mov_b32 s26, 4096
    buffer_load_dwordx4 v[64:67], v125, s[12:15], s23 offen offset:0
    buffer_load_dwordx4 v[68:71], v125, s[12:15], s23 offen offset:1024
    buffer_load_dwordx4 v[72:75], v125, s[12:15], s23 offen offset:2048
    buffer_load_dwordx4 v[76:79], v125, s[12:15], s23 offen offset:3072
    buffer_load_dwordx4 v[80:83], v125, s[12:15], s26 offen offset:0
    buffer_load_dwordx4 v[84:87], v125, s[12:15], s26 offen offset:1024
    buffer_load_dwordx4 v[88:91], v125, s[12:15], s26 offen offset:2048
    buffer_load_dwordx4 v[92:95], v125, s[12:15], s26 offen offset:3072
    s_mov_b32 s23, 57344
    s_mov_b32 s26, 61440
    s_waitcnt vmcnt(8)
    v_lshlrev_b32 v108, 16, v96
    v_and_b32 v111, s25, v96
    v_lshlrev_b32 v109, 16, v100
    v_and_b32 v112, s25, v100
    v_lshlrev_b32 v110, 16, v104
    v_and_b32 v113, s25, v104
    v_mul_f32 v114, s44, v108
    v_mul_f32 v115, s44, v111
    v_fmac_f32 v114, s45, v109
    v_fmac_f32 v115, s45, v112
    v_fmac_f32 v114, s46, v110
    v_fmac_f32 v115, s46, v113
    v_cvt_pk_bf16_f32 v96, v114, v115
    v_lshlrev_b32 v108, 16, v97
    v_and_b32 v111, s25, v97
    v_lshlrev_b32 v109, 16, v101
    v_and_b32 v112, s25, v101
    v_lshlrev_b32 v110, 16, v105
    v_and_b32 v113, s25, v105
    v_mul_f32 v114, s44, v108
    v_mul_f32 v115, s44, v111
    v_fmac_f32 v114, s45, v109
    v_fmac_f32 v115, s45, v112
    v_fmac_f32 v114, s46, v110
    v_fmac_f32 v115, s46, v113
    v_cvt_pk_bf16_f32 v97, v114, v115
    v_lshlrev_b32 v108, 16, v98
    v_and_b32 v111, s25, v98
    v_lshlrev_b32 v109, 16, v102
    v_and_b32 v112, s25, v102
    v_lshlrev_b32 v110, 16, v106
    v_and_b32 v113, s25, v106
    v_mul_f32 v114, s44, v108
    v_mul_f32 v115, s44, v111
    v_fmac_f32 v114, s45, v109
    v_fmac_f32 v115, s45, v112
    v_fmac_f32 v114, s46, v110
    v_fmac_f32 v115, s46, v113
    v_cvt_pk_bf16_f32 v98, v114, v115
    v_lshlrev_b32 v108, 16, v99
    v_and_b32 v111, s25, v99
    v_lshlrev_b32 v109, 16, v103
    v_and_b32 v112, s25, v103
    v_lshlrev_b32 v110, 16, v107
    v_and_b32 v113, s25, v107
    v_mul_f32 v114, s44, v108
    v_mul_f32 v115, s44, v111
    v_fmac_f32 v114, s45, v109
    v_fmac_f32 v115, s45, v112
    v_fmac_f32 v114, s46, v110
    v_fmac_f32 v115, s46, v113
    v_cvt_pk_bf16_f32 v99, v114, v115
    ds_write_b128 v126, v[96:99]
    s_waitcnt lgkmcnt(0)
    s_barrier
    s_mov_b32 s22, 4
    s_setprio 2
L_conv2_kernel_mloop1:
    ds_read_b128 v[96:99], v120 offset:0
    ds_read_b128 v[100:103], v120 offset:1024
    ds_read_b128 v[104:107], v120 offset:2048
    ds_read_b128 v[108:111], v120 offset:3072
    ds_read_b128 v[112:115], v120 offset:4096
    ds_read_b128 v[116:119], v120 offset:5120
    s_waitcnt vmcnt(6) lgkmcnt(5)
    v_mfma_f32_16x16x32_bf16 v[0:3], v[64:67], v[96:99], v[0:3]
    v_mfma_f32_16x16x32_bf16 v[32:35], v[68:71], v[96:99], v[32:35]
    ds_read_b128 v[96:99], v120 offset:6144
    s_waitcnt vmcnt(4) lgkmcnt(5)
    v_mfma_f32_16x16x32_bf16 v[4:7], v[64:67], v[100:103], v[4:7]
    v_mfma_f32_16x16x32_bf16 v[36:39], v[68:71], v[100:103], v[36:39]
    v_mfma_f32_16x16x32_bf16 v[0:3], v[72:75], v[100:103], v[0:3]
    v_mfma_f32_16x16x32_bf16 v[32:35], v[76:79], v[100:103], v[32:35]
    ds_read_b128 v[100:103], v120 offset:7168
    s_waitcnt vmcnt(2) lgkmcnt(5)
    v_mfma_f32_16x16x32_bf16 v[8:11], v[64:67], v[104:107], v[8:11]
    v_mfma_f32_16x16x32_bf16 v[40:43], v[68:71], v[104:107], v[40:43]
    v_mfma_f32_16x16x32_bf16 v[4:7], v[72:75], v[104:107], v[4:7]
    v_mfma_f32_16x16x32_bf16 v[36:39], v[76:79], v[104:107], v[36:39]
    v_mfma_f32_16x16x32_bf16 v[0:3], v[80:83], v[104:107], v[0:3]
    v_mfma_f32_16x16x32_bf16 v[32:35], v[84:87], v[104:107], v[32:35]
    ds_read_b128 v[104:107], v122 offset:0
    v_add_u32 v122, v123, v122
    s_waitcnt vmcnt(0) lgkmcnt(5)
    v_mfma_f32_16x16x32_bf16 v[12:15], v[64:67], v[108:111], v[12:15]
    v_mfma_f32_16x16x32_bf16 v[44:47], v[68:71], v[108:111], v[44:47]
    v_mfma_f32_16x16x32_bf16 v[8:11], v[72:75], v[108:111], v[8:11]
    v_mfma_f32_16x16x32_bf16 v[40:43], v[76:79], v[108:111], v[40:43]
    v_mfma_f32_16x16x32_bf16 v[4:7], v[80:83], v[108:111], v[4:7]
    v_mfma_f32_16x16x32_bf16 v[36:39], v[84:87], v[108:111], v[36:39]
    v_mfma_f32_16x16x32_bf16 v[0:3], v[88:91], v[108:111], v[0:3]
    v_mfma_f32_16x16x32_bf16 v[32:35], v[92:95], v[108:111], v[32:35]
    ds_read_b128 v[108:111], v121 offset:1024
    s_waitcnt lgkmcnt(5)
    v_mfma_f32_16x16x32_bf16 v[16:19], v[64:67], v[112:115], v[16:19]
    v_mfma_f32_16x16x32_bf16 v[48:51], v[68:71], v[112:115], v[48:51]
    v_mfma_f32_16x16x32_bf16 v[12:15], v[72:75], v[112:115], v[12:15]
    v_mfma_f32_16x16x32_bf16 v[44:47], v[76:79], v[112:115], v[44:47]
    v_mfma_f32_16x16x32_bf16 v[8:11], v[80:83], v[112:115], v[8:11]
    v_mfma_f32_16x16x32_bf16 v[40:43], v[84:87], v[112:115], v[40:43]
    v_mfma_f32_16x16x32_bf16 v[4:7], v[88:91], v[112:115], v[4:7]
    v_mfma_f32_16x16x32_bf16 v[36:39], v[92:95], v[112:115], v[36:39]
    ds_read_b128 v[112:115], v121 offset:2048
    s_waitcnt lgkmcnt(5)
    v_mfma_f32_16x16x32_bf16 v[20:23], v[64:67], v[116:119], v[20:23]
    v_mfma_f32_16x16x32_bf16 v[52:55], v[68:71], v[116:119], v[52:55]
    v_mfma_f32_16x16x32_bf16 v[16:19], v[72:75], v[116:119], v[16:19]
    v_mfma_f32_16x16x32_bf16 v[48:51], v[76:79], v[116:119], v[48:51]
    v_mfma_f32_16x16x32_bf16 v[12:15], v[80:83], v[116:119], v[12:15]
    v_mfma_f32_16x16x32_bf16 v[44:47], v[84:87], v[116:119], v[44:47]
    v_mfma_f32_16x16x32_bf16 v[8:11], v[88:91], v[116:119], v[8:11]
    v_mfma_f32_16x16x32_bf16 v[40:43], v[92:95], v[116:119], v[40:43]
    s_waitcnt lgkmcnt(4)
    v_mfma_f32_16x16x32_bf16 v[24:27], v[64:67], v[96:99], v[24:27]
    v_mfma_f32_16x16x32_bf16 v[56:59], v[68:71], v[96:99], v[56:59]
    v_mfma_f32_16x16x32_bf16 v[20:23], v[72:75], v[96:99], v[20:23]
    v_mfma_f32_16x16x32_bf16 v[52:55], v[76:79], v[96:99], v[52:55]
    v_mfma_f32_16x16x32_bf16 v[16:19], v[80:83], v[96:99], v[16:19]
    v_mfma_f32_16x16x32_bf16 v[48:51], v[84:87], v[96:99], v[48:51]
    v_mfma_f32_16x16x32_bf16 v[12:15], v[88:91], v[96:99], v[12:15]
    v_mfma_f32_16x16x32_bf16 v[44:47], v[92:95], v[96:99], v[44:47]
    s_waitcnt lgkmcnt(3)
    v_mfma_f32_16x16x32_bf16 v[28:31], v[64:67], v[100:103], v[28:31]
    v_mfma_f32_16x16x32_bf16 v[60:63], v[68:71], v[100:103], v[60:63]
    v_mfma_f32_16x16x32_bf16 v[24:27], v[72:75], v[100:103], v[24:27]
    v_mfma_f32_16x16x32_bf16 v[56:59], v[76:79], v[100:103], v[56:59]
    v_mfma_f32_16x16x32_bf16 v[20:23], v[80:83], v[100:103], v[20:23]
    v_mfma_f32_16x16x32_bf16 v[52:55], v[84:87], v[100:103], v[52:55]
    v_mfma_f32_16x16x32_bf16 v[16:19], v[88:91], v[100:103], v[16:19]
    v_mfma_f32_16x16x32_bf16 v[48:51], v[92:95], v[100:103], v[48:51]
    buffer_load_dwordx4 v[64:67], v125, s[12:15], s23 offen offset:0
    buffer_load_dwordx4 v[68:71], v125, s[12:15], s23 offen offset:1024
    s_waitcnt lgkmcnt(2)
    v_mfma_f32_16x16x32_bf16 v[28:31], v[72:75], v[104:107], v[28:31]
    v_mfma_f32_16x16x32_bf16 v[60:63], v[76:79], v[104:107], v[60:63]
    v_mfma_f32_16x16x32_bf16 v[24:27], v[80:83], v[104:107], v[24:27]
    v_mfma_f32_16x16x32_bf16 v[56:59], v[84:87], v[104:107], v[56:59]
    v_mfma_f32_16x16x32_bf16 v[20:23], v[88:91], v[104:107], v[20:23]
    v_mfma_f32_16x16x32_bf16 v[52:55], v[92:95], v[104:107], v[52:55]
    buffer_load_dwordx4 v[72:75], v125, s[12:15], s23 offen offset:2048
    buffer_load_dwordx4 v[76:79], v125, s[12:15], s23 offen offset:3072
    s_waitcnt lgkmcnt(1)
    v_mfma_f32_16x16x32_bf16 v[28:31], v[80:83], v[108:111], v[28:31]
    v_mfma_f32_16x16x32_bf16 v[60:63], v[84:87], v[108:111], v[60:63]
    v_mfma_f32_16x16x32_bf16 v[24:27], v[88:91], v[108:111], v[24:27]
    v_mfma_f32_16x16x32_bf16 v[56:59], v[92:95], v[108:111], v[56:59]
    buffer_load_dwordx4 v[80:83], v125, s[12:15], s26 offen offset:0
    buffer_load_dwordx4 v[84:87], v125, s[12:15], s26 offen offset:1024
    s_waitcnt lgkmcnt(0)
    v_mfma_f32_16x16x32_bf16 v[28:31], v[88:91], v[112:115], v[28:31]
    v_mfma_f32_16x16x32_bf16 v[60:63], v[92:95], v[112:115], v[60:63]
    buffer_load_dwordx4 v[88:91], v125, s[12:15], s26 offen offset:2048
    buffer_load_dwordx4 v[92:95], v125, s[12:15], s26 offen offset:3072
    s_add_u32 s23, s23, 57344
    s_add_u32 s26, s26, 57344
    s_barrier
    s_sub_u32 s22, s22, 1
    s_cmp_eq_u32 s22, 0
    s_cbranch_scc1 L_conv2_kernel_mlast1
    ds_read_b128 v[96:99], v120 offset:8192
    ds_read_b128 v[100:103], v120 offset:9216
    ds_read_b128 v[104:107], v120 offset:10240
    ds_read_b128 v[108:111], v120 offset:11264
    ds_read_b128 v[112:115], v120 offset:12288
    ds_read_b128 v[116:119], v120 offset:13312
    s_waitcnt vmcnt(6) lgkmcnt(5)
    v_mfma_f32_16x16x32_bf16 v[0:3], v[64:67], v[96:99], v[0:3]
    v_mfma_f32_16x16x32_bf16 v[32:35], v[68:71], v[96:99], v[32:35]
    ds_read_b128 v[96:99], v120 offset:14336
    s_waitcnt vmcnt(4) lgkmcnt(5)
    v_mfma_f32_16x16x32_bf16 v[4:7], v[64:67], v[100:103], v[4:7]
    v_mfma_f32_16x16x32_bf16 v[36:39], v[68:71], v[100:103], v[36:39]
    v_mfma_f32_16x16x32_bf16 v[0:3], v[72:75], v[100:103], v[0:3]
    v_mfma_f32_16x16x32_bf16 v[32:35], v[76:79], v[100:103], v[32:35]
    ds_read_b128 v[100:103], v120 offset:15360
    s_waitcnt vmcnt(2) lgkmcnt(5)
    v_mfma_f32_16x16x32_bf16 v[8:11], v[64:67], v[104:107], v[8:11]
    v_mfma_f32_16x16x32_bf16 v[40:43], v[68:71], v[104:107], v[40:43]
    v_mfma_f32_16x16x32_bf16 v[4:7], v[72:75], v[104:107], v[4:7]
    v_mfma_f32_16x16x32_bf16 v[36:39], v[76:79], v[104:107], v[36:39]
    v_mfma_f32_16x16x32_bf16 v[0:3], v[80:83], v[104:107], v[0:3]
    v_mfma_f32_16x16x32_bf16 v[32:35], v[84:87], v[104:107], v[32:35]
    ds_read_b128 v[104:107], v122 offset:0
    v_add_u32 v122, v124, v122
    s_waitcnt vmcnt(0) lgkmcnt(5)
    v_mfma_f32_16x16x32_bf16 v[12:15], v[64:67], v[108:111], v[12:15]
    v_mfma_f32_16x16x32_bf16 v[44:47], v[68:71], v[108:111], v[44:47]
    v_mfma_f32_16x16x32_bf16 v[8:11], v[72:75], v[108:111], v[8:11]
    v_mfma_f32_16x16x32_bf16 v[40:43], v[76:79], v[108:111], v[40:43]
    v_mfma_f32_16x16x32_bf16 v[4:7], v[80:83], v[108:111], v[4:7]
    v_mfma_f32_16x16x32_bf16 v[36:39], v[84:87], v[108:111], v[36:39]
    v_mfma_f32_16x16x32_bf16 v[0:3], v[88:91], v[108:111], v[0:3]
    v_mfma_f32_16x16x32_bf16 v[32:35], v[92:95], v[108:111], v[32:35]
    ds_read_b128 v[108:111], v121 offset:9216
    s_waitcnt lgkmcnt(5)
    v_mfma_f32_16x16x32_bf16 v[16:19], v[64:67], v[112:115], v[16:19]
    v_mfma_f32_16x16x32_bf16 v[48:51], v[68:71], v[112:115], v[48:51]
    v_mfma_f32_16x16x32_bf16 v[12:15], v[72:75], v[112:115], v[12:15]
    v_mfma_f32_16x16x32_bf16 v[44:47], v[76:79], v[112:115], v[44:47]
    v_mfma_f32_16x16x32_bf16 v[8:11], v[80:83], v[112:115], v[8:11]
    v_mfma_f32_16x16x32_bf16 v[40:43], v[84:87], v[112:115], v[40:43]
    v_mfma_f32_16x16x32_bf16 v[4:7], v[88:91], v[112:115], v[4:7]
    v_mfma_f32_16x16x32_bf16 v[36:39], v[92:95], v[112:115], v[36:39]
    ds_read_b128 v[112:115], v121 offset:10240
    s_waitcnt lgkmcnt(5)
    v_mfma_f32_16x16x32_bf16 v[20:23], v[64:67], v[116:119], v[20:23]
    v_mfma_f32_16x16x32_bf16 v[52:55], v[68:71], v[116:119], v[52:55]
    v_mfma_f32_16x16x32_bf16 v[16:19], v[72:75], v[116:119], v[16:19]
    v_mfma_f32_16x16x32_bf16 v[48:51], v[76:79], v[116:119], v[48:51]
    v_mfma_f32_16x16x32_bf16 v[12:15], v[80:83], v[116:119], v[12:15]
    v_mfma_f32_16x16x32_bf16 v[44:47], v[84:87], v[116:119], v[44:47]
    v_mfma_f32_16x16x32_bf16 v[8:11], v[88:91], v[116:119], v[8:11]
    v_mfma_f32_16x16x32_bf16 v[40:43], v[92:95], v[116:119], v[40:43]
    s_waitcnt lgkmcnt(4)
    v_mfma_f32_16x16x32_bf16 v[24:27], v[64:67], v[96:99], v[24:27]
    v_mfma_f32_16x16x32_bf16 v[56:59], v[68:71], v[96:99], v[56:59]
    v_mfma_f32_16x16x32_bf16 v[20:23], v[72:75], v[96:99], v[20:23]
    v_mfma_f32_16x16x32_bf16 v[52:55], v[76:79], v[96:99], v[52:55]
    v_mfma_f32_16x16x32_bf16 v[16:19], v[80:83], v[96:99], v[16:19]
    v_mfma_f32_16x16x32_bf16 v[48:51], v[84:87], v[96:99], v[48:51]
    v_mfma_f32_16x16x32_bf16 v[12:15], v[88:91], v[96:99], v[12:15]
    v_mfma_f32_16x16x32_bf16 v[44:47], v[92:95], v[96:99], v[44:47]
    s_waitcnt lgkmcnt(3)
    v_mfma_f32_16x16x32_bf16 v[28:31], v[64:67], v[100:103], v[28:31]
    v_mfma_f32_16x16x32_bf16 v[60:63], v[68:71], v[100:103], v[60:63]
    v_mfma_f32_16x16x32_bf16 v[24:27], v[72:75], v[100:103], v[24:27]
    v_mfma_f32_16x16x32_bf16 v[56:59], v[76:79], v[100:103], v[56:59]
    v_mfma_f32_16x16x32_bf16 v[20:23], v[80:83], v[100:103], v[20:23]
    v_mfma_f32_16x16x32_bf16 v[52:55], v[84:87], v[100:103], v[52:55]
    v_mfma_f32_16x16x32_bf16 v[16:19], v[88:91], v[100:103], v[16:19]
    v_mfma_f32_16x16x32_bf16 v[48:51], v[92:95], v[100:103], v[48:51]
    buffer_load_dwordx4 v[64:67], v125, s[12:15], s23 offen offset:0
    buffer_load_dwordx4 v[68:71], v125, s[12:15], s23 offen offset:1024
    s_waitcnt lgkmcnt(2)
    v_mfma_f32_16x16x32_bf16 v[28:31], v[72:75], v[104:107], v[28:31]
    v_mfma_f32_16x16x32_bf16 v[60:63], v[76:79], v[104:107], v[60:63]
    v_mfma_f32_16x16x32_bf16 v[24:27], v[80:83], v[104:107], v[24:27]
    v_mfma_f32_16x16x32_bf16 v[56:59], v[84:87], v[104:107], v[56:59]
    v_mfma_f32_16x16x32_bf16 v[20:23], v[88:91], v[104:107], v[20:23]
    v_mfma_f32_16x16x32_bf16 v[52:55], v[92:95], v[104:107], v[52:55]
    buffer_load_dwordx4 v[72:75], v125, s[12:15], s23 offen offset:2048
    buffer_load_dwordx4 v[76:79], v125, s[12:15], s23 offen offset:3072
    s_waitcnt lgkmcnt(1)
    v_mfma_f32_16x16x32_bf16 v[28:31], v[80:83], v[108:111], v[28:31]
    v_mfma_f32_16x16x32_bf16 v[60:63], v[84:87], v[108:111], v[60:63]
    v_mfma_f32_16x16x32_bf16 v[24:27], v[88:91], v[108:111], v[24:27]
    v_mfma_f32_16x16x32_bf16 v[56:59], v[92:95], v[108:111], v[56:59]
    buffer_load_dwordx4 v[80:83], v125, s[12:15], s26 offen offset:0
    buffer_load_dwordx4 v[84:87], v125, s[12:15], s26 offen offset:1024
    s_waitcnt lgkmcnt(0)
    v_mfma_f32_16x16x32_bf16 v[28:31], v[88:91], v[112:115], v[28:31]
    v_mfma_f32_16x16x32_bf16 v[60:63], v[92:95], v[112:115], v[60:63]
    buffer_load_dwordx4 v[88:91], v125, s[12:15], s26 offen offset:2048
    buffer_load_dwordx4 v[92:95], v125, s[12:15], s26 offen offset:3072
    s_add_u32 s23, s23, 57344
    s_add_u32 s26, s26, 57344
    s_barrier
    s_branch L_conv2_kernel_mloop1
L_conv2_kernel_mlast1:
    v_and_b32 v125, 15, v127
    v_and_b32 v126, 7, v127
    v_lshlrev_b32 v126, 4, v126
    v_lshl_add_u32 v125, v125, 7, v126
    v_lshrrev_b32 v126, 4, v127
    v_lshl_add_u32 v125, v126, 11, v125
    s_lshl_b32 s36, s20, 14
    s_add_u32 s37, s36, 8192
    v_add_u32 v126, s37, v125
    v_add_u32 v125, s36, v125
    ds_read_b128 v[96:99], v120 offset:8192
    ds_read_b128 v[100:103], v120 offset:9216
    ds_read_b128 v[104:107], v120 offset:10240
    ds_read_b128 v[108:111], v120 offset:11264
    ds_read_b128 v[112:115], v120 offset:12288
    ds_read_b128 v[116:119], v120 offset:13312
    s_waitcnt vmcnt(6) lgkmcnt(5)
    v_mfma_f32_16x16x32_bf16 v[0:3], v[64:67], v[96:99], v[0:3]
    v_mfma_f32_16x16x32_bf16 v[32:35], v[68:71], v[96:99], v[32:35]
    ds_read_b128 v[96:99], v120 offset:14336
    s_waitcnt vmcnt(4) lgkmcnt(5)
    v_mfma_f32_16x16x32_bf16 v[4:7], v[64:67], v[100:103], v[4:7]
    v_mfma_f32_16x16x32_bf16 v[36:39], v[68:71], v[100:103], v[36:39]
    v_mfma_f32_16x16x32_bf16 v[0:3], v[72:75], v[100:103], v[0:3]
    v_mfma_f32_16x16x32_bf16 v[32:35], v[76:79], v[100:103], v[32:35]
    ds_read_b128 v[100:103], v120 offset:15360
    s_waitcnt vmcnt(2) lgkmcnt(5)
    v_mfma_f32_16x16x32_bf16 v[8:11], v[64:67], v[104:107], v[8:11]
    v_mfma_f32_16x16x32_bf16 v[40:43], v[68:71], v[104:107], v[40:43]
    v_mfma_f32_16x16x32_bf16 v[4:7], v[72:75], v[104:107], v[4:7]
    v_mfma_f32_16x16x32_bf16 v[36:39], v[76:79], v[104:107], v[36:39]
    v_mfma_f32_16x16x32_bf16 v[0:3], v[80:83], v[104:107], v[0:3]
    v_mfma_f32_16x16x32_bf16 v[32:35], v[84:87], v[104:107], v[32:35]
    ds_read_b128 v[104:107], v122 offset:0
    s_waitcnt vmcnt(0) lgkmcnt(5)
    v_mfma_f32_16x16x32_bf16 v[12:15], v[64:67], v[108:111], v[12:15]
    v_mfma_f32_16x16x32_bf16 v[44:47], v[68:71], v[108:111], v[44:47]
    v_mfma_f32_16x16x32_bf16 v[8:11], v[72:75], v[108:111], v[8:11]
    v_mfma_f32_16x16x32_bf16 v[40:43], v[76:79], v[108:111], v[40:43]
    v_mfma_f32_16x16x32_bf16 v[4:7], v[80:83], v[108:111], v[4:7]
    v_mfma_f32_16x16x32_bf16 v[36:39], v[84:87], v[108:111], v[36:39]
    v_mfma_f32_16x16x32_bf16 v[0:3], v[88:91], v[108:111], v[0:3]
    v_mfma_f32_16x16x32_bf16 v[32:35], v[92:95], v[108:111], v[32:35]
    ds_read_b128 v[108:111], v121 offset:9216
    s_waitcnt lgkmcnt(5)
    v_mfma_f32_16x16x32_bf16 v[16:19], v[64:67], v[112:115], v[16:19]
    v_mfma_f32_16x16x32_bf16 v[48:51], v[68:71], v[112:115], v[48:51]
    v_mfma_f32_16x16x32_bf16 v[12:15], v[72:75], v[112:115], v[12:15]
    v_mfma_f32_16x16x32_bf16 v[44:47], v[76:79], v[112:115], v[44:47]
    v_mfma_f32_16x16x32_bf16 v[8:11], v[80:83], v[112:115], v[8:11]
    v_mfma_f32_16x16x32_bf16 v[40:43], v[84:87], v[112:115], v[40:43]
    v_mfma_f32_16x16x32_bf16 v[4:7], v[88:91], v[112:115], v[4:7]
    v_mfma_f32_16x16x32_bf16 v[36:39], v[92:95], v[112:115], v[36:39]
    ds_read_b128 v[112:115], v121 offset:10240
    v_xor_b32 v123, 0, v125
    ds_write_b128 v123, v[0:3]
    s_waitcnt lgkmcnt(6)
    v_mfma_f32_16x16x32_bf16 v[20:23], v[64:67], v[116:119], v[20:23]
    v_mfma_f32_16x16x32_bf16 v[52:55], v[68:71], v[116:119], v[52:55]
    v_mfma_f32_16x16x32_bf16 v[16:19], v[72:75], v[116:119], v[16:19]
    v_mfma_f32_16x16x32_bf16 v[48:51], v[76:79], v[116:119], v[48:51]
    v_mfma_f32_16x16x32_bf16 v[12:15], v[80:83], v[116:119], v[12:15]
    v_mfma_f32_16x16x32_bf16 v[44:47], v[84:87], v[116:119], v[44:47]
    v_mfma_f32_16x16x32_bf16 v[8:11], v[88:91], v[116:119], v[8:11]
    v_mfma_f32_16x16x32_bf16 v[40:43], v[92:95], v[116:119], v[40:43]
    v_xor_b32 v124, 16, v125
    ds_write_b128 v124, v[4:7]
    s_waitcnt lgkmcnt(2)
    v_mfma_f32_16x16x32_bf16 v[24:27], v[64:67], v[96:99], v[24:27]
    v_mfma_f32_16x16x32_bf16 v[56:59], v[68:71], v[96:99], v[56:59]
    v_mfma_f32_16x16x32_bf16 v[20:23], v[72:75], v[96:99], v[20:23]
    v_mfma_f32_16x16x32_bf16 v[52:55], v[76:79], v[96:99], v[52:55]
    v_mfma_f32_16x16x32_bf16 v[16:19], v[80:83], v[96:99], v[16:19]
    v_mfma_f32_16x16x32_bf16 v[48:51], v[84:87], v[96:99], v[48:51]
    v_mfma_f32_16x16x32_bf16 v[12:15], v[88:91], v[96:99], v[12:15]
    v_mfma_f32_16x16x32_bf16 v[44:47], v[92:95], v[96:99], v[44:47]
    v_xor_b32 v123, 32, v125
    ds_write_b128 v123, v[8:11]
    v_xor_b32 v124, 0, v126
    ds_write_b128 v124, v[32:35]
    v_mfma_f32_16x16x32_bf16 v[28:31], v[64:67], v[100:103], v[28:31]
    v_mfma_f32_16x16x32_bf16 v[60:63], v[68:71], v[100:103], v[60:63]
    v_mfma_f32_16x16x32_bf16 v[24:27], v[72:75], v[100:103], v[24:27]
    v_mfma_f32_16x16x32_bf16 v[56:59], v[76:79], v[100:103], v[56:59]
    v_mfma_f32_16x16x32_bf16 v[20:23], v[80:83], v[100:103], v[20:23]
    v_mfma_f32_16x16x32_bf16 v[52:55], v[84:87], v[100:103], v[52:55]
    v_mfma_f32_16x16x32_bf16 v[16:19], v[88:91], v[100:103], v[16:19]
    v_mfma_f32_16x16x32_bf16 v[48:51], v[92:95], v[100:103], v[48:51]
    v_xor_b32 v123, 16, v126
    ds_write_b128 v123, v[36:39]
    v_xor_b32 v124, 32, v126
    ds_write_b128 v124, v[40:43]
    v_mfma_f32_16x16x32_bf16 v[28:31], v[72:75], v[104:107], v[28:31]
    v_mfma_f32_16x16x32_bf16 v[60:63], v[76:79], v[104:107], v[60:63]
    v_mfma_f32_16x16x32_bf16 v[24:27], v[80:83], v[104:107], v[24:27]
    v_mfma_f32_16x16x32_bf16 v[56:59], v[84:87], v[104:107], v[56:59]
    v_mfma_f32_16x16x32_bf16 v[20:23], v[88:91], v[104:107], v[20:23]
    v_mfma_f32_16x16x32_bf16 v[52:55], v[92:95], v[104:107], v[52:55]
    v_xor_b32 v124, 48, v125
    ds_write_b128 v124, v[12:15]
    v_xor_b32 v123, 48, v126
    ds_write_b128 v123, v[44:47]
    v_mfma_f32_16x16x32_bf16 v[28:31], v[80:83], v[108:111], v[28:31]
    v_mfma_f32_16x16x32_bf16 v[60:63], v[84:87], v[108:111], v[60:63]
    v_mfma_f32_16x16x32_bf16 v[24:27], v[88:91], v[108:111], v[24:27]
    v_mfma_f32_16x16x32_bf16 v[56:59], v[92:95], v[108:111], v[56:59]
    v_xor_b32 v123, 64, v125
    ds_write_b128 v123, v[16:19]
    v_xor_b32 v124, 64, v126
    ds_write_b128 v124, v[48:51]
    v_mfma_f32_16x16x32_bf16 v[28:31], v[88:91], v[112:115], v[28:31]
    v_mfma_f32_16x16x32_bf16 v[60:63], v[92:95], v[112:115], v[60:63]
    v_xor_b32 v124, 80, v125
    ds_write_b128 v124, v[20:23]
    v_xor_b32 v123, 80, v126
    ds_write_b128 v123, v[52:55]
    v_and_b32 v108, 15, v127
    v_lshrrev_b32 v109, 4, v127
    v_lshrrev_b32 v110, 3, v108
    s_lshl_b32 s36, s20, 1
    v_add_u32 v110, s36, v110
    v_xor_b32 v111, v110, v108
    v_and_b32 v111, 7, v111
    v_lshlrev_b32 v111, 4, v111
    v_xor_b32 v123, 96, v125
    ds_write_b128 v123, v[24:27]
    v_lshl_add_u32 v111, v110, 7, v111
    v_lshl_add_u32 v120, v109, 11, v111
    v_add_u32 v121, 65536, v120
    v_add_u32 v64, 131072, v120
    s_lshl_b32 s36, s20, 9
    s_add_u32 s36, s36, 115712
    v_lshl_add_u32 v127, v109, 7, s36
    s_lshl_b32 s36, s20, 4
    v_add_u32 v108, s36, v108
    v_lshlrev_b32 v110, 6, v108
    v_lshl_add_u32 v110, v109, 4, v110
    s_mul_i32 s36, s29, 262144
    v_xor_b32 v124, 96, v126
    ds_write_b128 v124, v[56:59]
    s_lshl_b32 s37, s21, 4
    s_add_u32 s36, s36, s37
    v_add_u32 v110, s36, v110
    v_mov_b32 v111, 2130706432
    v_cmp_gt_u32 vcc, 125, v108
    s_mov_b32 s4, 0xbeaaaaab
    s_mov_b32 s5, s4
    s_mov_b32 s6, 0x3e800000
    s_mov_b32 s7, s6
    s_mov_b32 s8, 0xc0a00000
    s_mov_b32 s9, s8
    s_mov_b32 s10, 0xc0638e39
    v_xor_b32 v124, 112, v125
    ds_write_b128 v124, v[28:31]
    s_mov_b32 s11, s10
    s_mov_b32 s12, 0xbf638e39
    s_mov_b32 s13, s12
    s_mov_b32 s14, 0xbe638e39
    s_mov_b32 s15, s14
    s_mov_b32 s22, 0xbd638e39
    s_mov_b32 s23, s22
    s_mov_b32 s24, 0x3ff1c71c
    s_mov_b32 s25, s24
    s_mov_b32 s26, 0xbf2aaaab
    s_mov_b32 s27, s26
    s_mov_b32 s32, 0x3ecccccd
    v_xor_b32 v123, 112, v126
    s_waitcnt lgkmcnt(8)
    ds_write_b128 v123, v[60:63]
    s_mov_b32 s33, s32
    s_mov_b32 s34, 0xbd888889
    s_mov_b32 s35, s34
    s_mov_b32 s38, 0xbe4ccccd
    s_mov_b32 s39, s38
    s_mov_b32 s40, 0xbdd2d3e8
    s_mov_b32 s41, s40
    s_mov_b32 s42, 0x3f800000
    s_mov_b32 s43, s42
    s_setprio 0
    s_branch L_conv2_kernel_epi
L_conv2_kernel_m2:
    s_mul_i32 s37, s38, 2176
    s_add_u32 s37, s37, 98304
    v_add_u32 v116, s37, v8
    v_add_u32 v118, s37, v9
    v_add_u32 v117, 104832, v8
    s_cmp_eq_u32 s38, 0
    s_cbranch_scc1 L_conv2_kernel_hh0
    v_add_u32 v117, 98304, v9
L_conv2_kernel_hh0:
    s_lshl_b32 s37, s38, 12
    s_add_u32 s37, s37, s43
    s_add_u32 s37, s37, 49152
    v_lshl_add_u32 v119, v127, 4, s37
    v_mov_b32 v0, 0
    v_mov_b32 v1, 0
    v_mov_b32 v2, 0
    v_mov_b32 v3, 0
    v_mov_b32 v4, 0
    v_mov_b32 v5, 0
    v_mov_b32 v6, 0
    v_mov_b32 v7, 0
    v_mov_b32 v8, 0
    v_mov_b32 v9, 0
    v_mov_b32 v10, 0
    v_mov_b32 v11, 0
    v_mov_b32 v12, 0
    v_mov_b32 v13, 0
    v_mov_b32 v14, 0
    v_mov_b32 v15, 0
    v_mov_b32 v16, 0
    v_mov_b32 v17, 0
    v_mov_b32 v18, 0
    v_mov_b32 v19, 0
    v_mov_b32 v20, 0
    v_mov_b32 v21, 0
    v_mov_b32 v22, 0
    v_mov_b32 v23, 0
    v_mov_b32 v24, 0
    v_mov_b32 v25, 0
    v_mov_b32 v26, 0
    v_mov_b32 v27, 0
    v_mov_b32 v28, 0
    v_mov_b32 v29, 0
    v_mov_b32 v30, 0
    v_mov_b32 v31, 0
    v_mov_b32 v32, 0
    v_mov_b32 v33, 0
    v_mov_b32 v34, 0
    v_mov_b32 v35, 0
    v_mov_b32 v36, 0
    v_mov_b32 v37, 0
    v_mov_b32 v38, 0
    v_mov_b32 v39, 0
    v_mov_b32 v40, 0
    v_mov_b32 v41, 0
    v_mov_b32 v42, 0
    v_mov_b32 v43, 0
    v_mov_b32 v44, 0
    v_mov_b32 v45, 0
    v_mov_b32 v46, 0
    v_mov_b32 v47, 0
    v_mov_b32 v48, 0
    v_mov_b32 v49, 0
    v_mov_b32 v50, 0
    v_mov_b32 v51, 0
    v_mov_b32 v52, 0
    v_mov_b32 v53, 0
    v_mov_b32 v54, 0
    v_mov_b32 v55, 0
    v_mov_b32 v56, 0
    v_mov_b32 v57, 0
    v_mov_b32 v58, 0
    v_mov_b32 v59, 0
    v_mov_b32 v60, 0
    v_mov_b32 v61, 0
    v_mov_b32 v62, 0
    v_mov_b32 v63, 0
    buffer_load_dwordx4 v[96:99], v108, s[8:11], 0 offen
    buffer_load_dwordx4 v[100:103], v109, s[8:11], 0 offen
    buffer_load_dwordx4 v[104:107], v110, s[8:11], 0 offen
    s_mov_b32 s23, 0
    s_mov_b32 s26, 4096
    buffer_load_dwordx4 v[64:67], v125, s[12:15], s23 offen offset:0
    buffer_load_dwordx4 v[68:71], v125, s[12:15], s23 offen offset:2048
    buffer_load_dwordx4 v[80:83], v119, s[12:15], s23 offen offset:0
    buffer_load_dwordx4 v[72:75], v125, s[12:15], s26 offen offset:0
    buffer_load_dwordx4 v[84:87], v119, s[12:15], s23 offen offset:2048
    buffer_load_dwordx4 v[76:79], v125, s[12:15], s26 offen offset:2048
    s_mov_b32 s23, 57344
    s_mov_b32 s26, 61440
    s_waitcnt vmcnt(6)
    v_lshlrev_b32 v108, 16, v96
    v_and_b32 v111, s25, v96
    v_lshlrev_b32 v109, 16, v100
    v_and_b32 v112, s25, v100
    v_lshlrev_b32 v110, 16, v104
    v_and_b32 v113, s25, v104
    v_mul_f32 v114, s44, v108
    v_mul_f32 v115, s44, v111
    v_fmac_f32 v114, s45, v109
    v_fmac_f32 v115, s45, v112
    v_fmac_f32 v114, s46, v110
    v_fmac_f32 v115, s46, v113
    v_cvt_pk_bf16_f32 v96, v114, v115
    v_lshlrev_b32 v108, 16, v97
    v_and_b32 v111, s25, v97
    v_lshlrev_b32 v109, 16, v101
    v_and_b32 v112, s25, v101
    v_lshlrev_b32 v110, 16, v105
    v_and_b32 v113, s25, v105
    v_mul_f32 v114, s44, v108
    v_mul_f32 v115, s44, v111
    v_fmac_f32 v114, s45, v109
    v_fmac_f32 v115, s45, v112
    v_fmac_f32 v114, s46, v110
    v_fmac_f32 v115, s46, v113
    v_cvt_pk_bf16_f32 v97, v114, v115
    v_lshlrev_b32 v108, 16, v98
    v_and_b32 v111, s25, v98
    v_lshlrev_b32 v109, 16, v102
    v_and_b32 v112, s25, v102
    v_lshlrev_b32 v110, 16, v106
    v_and_b32 v113, s25, v106
    v_mul_f32 v114, s44, v108
    v_mul_f32 v115, s44, v111
    v_fmac_f32 v114, s45, v109
    v_fmac_f32 v115, s45, v112
    v_fmac_f32 v114, s46, v110
    v_fmac_f32 v115, s46, v113
    v_cvt_pk_bf16_f32 v98, v114, v115
    v_lshlrev_b32 v108, 16, v99
    v_and_b32 v111, s25, v99
    v_lshlrev_b32 v109, 16, v103
    v_and_b32 v112, s25, v103
    v_lshlrev_b32 v110, 16, v107
    v_and_b32 v113, s25, v107
    v_mul_f32 v114, s44, v108
    v_mul_f32 v115, s44, v111
    v_fmac_f32 v114, s45, v109
    v_fmac_f32 v115, s45, v112
    v_fmac_f32 v114, s46, v110
    v_fmac_f32 v115, s46, v113
    v_cvt_pk_bf16_f32 v99, v114, v115
    ds_write_b128 v126, v[96:99]
    v_and_b32 v111, 15, v127
    v_lshlrev_b32 v111, 2, v111
    v_add_u32 v111, 99328, v111
    ds_write_b32 v111, v0
    ds_write_b32 v111, v0 offset:8704
    s_waitcnt lgkmcnt(0)
    s_barrier
    s_mov_b32 s22, 4
    s_setprio 2
L_conv2_kernel_mloop2:
    ds_read_b128 v[88:91], v120 offset:0
    ds_read_b128 v[92:95], v120 offset:1024
    ds_read_b128 v[96:99], v116 offset:0
    ds_read_b128 v[100:103], v120 offset:2048
    ds_read_b128 v[104:107], v116 offset:1088
    ds_read_b128 v[108:111], v120 offset:3072
    ds_read_b128 v[112:115], v116 offset:2176
    s_waitcnt vmcnt(5) lgkmcnt(6)
    v_mfma_f32_16x16x32_bf16 v[0:3], v[64:67], v[88:91], v[0:3]
    ds_read_b128 v[88:91], v120 offset:4096
    s_waitcnt vmcnt(4) lgkmcnt(6)
    v_mfma_f32_16x16x32_bf16 v[4:7], v[64:67], v[92:95], v[4:7]
    v_mfma_f32_16x16x32_bf16 v[0:3], v[68:71], v[92:95], v[0:3]
    ds_read_b128 v[92:95], v116 offset:3264
    s_waitcnt vmcnt(3) lgkmcnt(6)
    v_mfma_f32_16x16x32_bf16 v[32:35], v[80:83], v[96:99], v[32:35]
    ds_read_b128 v[96:99], v120 offset:5120
    s_waitcnt vmcnt(2) lgkmcnt(6)
    v_mfma_f32_16x16x32_bf16 v[8:11], v[64:67], v[100:103], v[8:11]
    v_mfma_f32_16x16x32_bf16 v[4:7], v[68:71], v[100:103], v[4:7]
    v_mfma_f32_16x16x32_bf16 v[0:3], v[72:75], v[100:103], v[0:3]
    ds_read_b128 v[100:103], v116 offset:4352
    s_waitcnt vmcnt(1) lgkmcnt(6)
    v_mfma_f32_16x16x32_bf16 v[36:39], v[80:83], v[104:107], v[36:39]
    v_mfma_f32_16x16x32_bf16 v[32:35], v[84:87], v[104:107], v[32:35]
    ds_read_b128 v[104:107], v120 offset:6144
    s_waitcnt vmcnt(0) lgkmcnt(6)
    v_mfma_f32_16x16x32_bf16 v[12:15], v[64:67], v[108:111], v[12:15]
    v_mfma_f32_16x16x32_bf16 v[8:11], v[68:71], v[108:111], v[8:11]
    v_mfma_f32_16x16x32_bf16 v[4:7], v[72:75], v[108:111], v[4:7]
    v_mfma_f32_16x16x32_bf16 v[0:3], v[76:79], v[108:111], v[0:3]
    ds_read_b128 v[108:111], v116 offset:5440
    s_waitcnt lgkmcnt(6)
    v_mfma_f32_16x16x32_bf16 v[40:43], v[80:83], v[112:115], v[40:43]
    v_mfma_f32_16x16x32_bf16 v[36:39], v[84:87], v[112:115], v[36:39]
    ds_read_b128 v[112:115], v120 offset:7168
    s_waitcnt lgkmcnt(6)
    v_mfma_f32_16x16x32_bf16 v[16:19], v[64:67], v[88:91], v[16:19]
    v_mfma_f32_16x16x32_bf16 v[12:15], v[68:71], v[88:91], v[12:15]
    v_mfma_f32_16x16x32_bf16 v[8:11], v[72:75], v[88:91], v[8:11]
    v_mfma_f32_16x16x32_bf16 v[4:7], v[76:79], v[88:91], v[4:7]
    ds_read_b128 v[88:91], v117 offset:0
    s_waitcnt lgkmcnt(6)
    v_mfma_f32_16x16x32_bf16 v[44:47], v[80:83], v[92:95], v[44:47]
    v_mfma_f32_16x16x32_bf16 v[40:43], v[84:87], v[92:95], v[40:43]
    ds_read_b128 v[92:95], v122 offset:0
    v_add_u32 v122, v123, v122
    s_waitcnt lgkmcnt(6)
    v_mfma_f32_16x16x32_bf16 v[20:23], v[64:67], v[96:99], v[20:23]
    v_mfma_f32_16x16x32_bf16 v[16:19], v[68:71], v[96:99], v[16:19]
    v_mfma_f32_16x16x32_bf16 v[12:15], v[72:75], v[96:99], v[12:15]
    v_mfma_f32_16x16x32_bf16 v[8:11], v[76:79], v[96:99], v[8:11]
    ds_read_b128 v[96:99], v117 offset:1088
    s_waitcnt lgkmcnt(6)
    v_mfma_f32_16x16x32_bf16 v[48:51], v[80:83], v[100:103], v[48:51]
    v_mfma_f32_16x16x32_bf16 v[44:47], v[84:87], v[100:103], v[44:47]
    ds_read_b128 v[100:103], v121 offset:1024
    s_waitcnt lgkmcnt(6)
    v_mfma_f32_16x16x32_bf16 v[24:27], v[64:67], v[104:107], v[24:27]
    v_mfma_f32_16x16x32_bf16 v[20:23], v[68:71], v[104:107], v[20:23]
    v_mfma_f32_16x16x32_bf16 v[16:19], v[72:75], v[104:107], v[16:19]
    v_mfma_f32_16x16x32_bf16 v[12:15], v[76:79], v[104:107], v[12:15]
    ds_read_b128 v[104:107], v118 offset:0
    s_waitcnt lgkmcnt(6)
    v_mfma_f32_16x16x32_bf16 v[52:55], v[80:83], v[108:111], v[52:55]
    v_mfma_f32_16x16x32_bf16 v[48:51], v[84:87], v[108:111], v[48:51]
    ds_read_b128 v[108:111], v121 offset:2048
    s_waitcnt lgkmcnt(6)
    v_mfma_f32_16x16x32_bf16 v[28:31], v[64:67], v[112:115], v[28:31]
    v_mfma_f32_16x16x32_bf16 v[24:27], v[68:71], v[112:115], v[24:27]
    v_mfma_f32_16x16x32_bf16 v[20:23], v[72:75], v[112:115], v[20:23]
    v_mfma_f32_16x16x32_bf16 v[16:19], v[76:79], v[112:115], v[16:19]
    buffer_load_dwordx4 v[64:67], v125, s[12:15], s23 offen offset:0
    s_waitcnt lgkmcnt(5)
    v_mfma_f32_16x16x32_bf16 v[56:59], v[80:83], v[88:91], v[56:59]
    v_mfma_f32_16x16x32_bf16 v[52:55], v[84:87], v[88:91], v[52:55]
    s_waitcnt lgkmcnt(0)
    s_barrier
    v_mfma_f32_16x16x32_bf16 v[28:31], v[68:71], v[92:95], v[28:31]
    v_mfma_f32_16x16x32_bf16 v[24:27], v[72:75], v[92:95], v[24:27]
    v_mfma_f32_16x16x32_bf16 v[20:23], v[76:79], v[92:95], v[20:23]
    buffer_load_dwordx4 v[68:71], v125, s[12:15], s23 offen offset:2048
    v_mfma_f32_16x16x32_bf16 v[60:63], v[80:83], v[96:99], v[60:63]
    v_mfma_f32_16x16x32_bf16 v[56:59], v[84:87], v[96:99], v[56:59]
    buffer_load_dwordx4 v[80:83], v119, s[12:15], s23 offen offset:0
    v_mfma_f32_16x16x32_bf16 v[28:31], v[72:75], v[100:103], v[28:31]
    v_mfma_f32_16x16x32_bf16 v[24:27], v[76:79], v[100:103], v[24:27]
    buffer_load_dwordx4 v[72:75], v125, s[12:15], s26 offen offset:0
    v_mfma_f32_16x16x32_bf16 v[60:63], v[84:87], v[104:107], v[60:63]
    buffer_load_dwordx4 v[84:87], v119, s[12:15], s23 offen offset:2048
    v_mfma_f32_16x16x32_bf16 v[28:31], v[76:79], v[108:111], v[28:31]
    buffer_load_dwordx4 v[76:79], v125, s[12:15], s26 offen offset:2048
    s_add_u32 s23, s23, 57344
    s_add_u32 s26, s26, 57344
    s_sub_u32 s22, s22, 1
    s_cmp_eq_u32 s22, 0
    s_cbranch_scc1 L_conv2_kernel_mlast2
    ds_read_b128 v[88:91], v120 offset:8192
    ds_read_b128 v[92:95], v120 offset:9216
    ds_read_b128 v[96:99], v116 offset:8704
    ds_read_b128 v[100:103], v120 offset:10240
    ds_read_b128 v[104:107], v116 offset:9792
    ds_read_b128 v[108:111], v120 offset:11264
    ds_read_b128 v[112:115], v116 offset:10880
    s_waitcnt vmcnt(5) lgkmcnt(6)
    v_mfma_f32_16x16x32_bf16 v[0:3], v[64:67], v[88:91], v[0:3]
    ds_read_b128 v[88:91], v120 offset:12288
    s_waitcnt vmcnt(4) lgkmcnt(6)
    v_mfma_f32_16x16x32_bf16 v[4:7], v[64:67], v[92:95], v[4:7]
    v_mfma_f32_16x16x32_bf16 v[0:3], v[68:71], v[92:95], v[0:3]
    ds_read_b128 v[92:95], v116 offset:11968
    s_waitcnt vmcnt(3) lgkmcnt(6)
    v_mfma_f32_16x16x32_bf16 v[32:35], v[80:83], v[96:99], v[32:35]
    ds_read_b128 v[96:99], v120 offset:13312
    s_waitcnt vmcnt(2) lgkmcnt(6)
    v_mfma_f32_16x16x32_bf16 v[8:11], v[64:67], v[100:103], v[8:11]
    v_mfma_f32_16x16x32_bf16 v[4:7], v[68:71], v[100:103], v[4:7]
    v_mfma_f32_16x16x32_bf16 v[0:3], v[72:75], v[100:103], v[0:3]
    ds_read_b128 v[100:103], v116 offset:13056
    s_waitcnt vmcnt(1) lgkmcnt(6)
    v_mfma_f32_16x16x32_bf16 v[36:39], v[80:83], v[104:107], v[36:39]
    v_mfma_f32_16x16x32_bf16 v[32:35], v[84:87], v[104:107], v[32:35]
    ds_read_b128 v[104:107], v120 offset:14336
    s_waitcnt vmcnt(0) lgkmcnt(6)
    v_mfma_f32_16x16x32_bf16 v[12:15], v[64:67], v[108:111], v[12:15]
    v_mfma_f32_16x16x32_bf16 v[8:11], v[68:71], v[108:111], v[8:11]
    v_mfma_f32_16x16x32_bf16 v[4:7], v[72:75], v[108:111], v[4:7]
    v_mfma_f32_16x16x32_bf16 v[0:3], v[76:79], v[108:111], v[0:3]
    ds_read_b128 v[108:111], v116 offset:14144
    s_waitcnt lgkmcnt(6)
    v_mfma_f32_16x16x32_bf16 v[40:43], v[80:83], v[112:115], v[40:43]
    v_mfma_f32_16x16x32_bf16 v[36:39], v[84:87], v[112:115], v[36:39]
    ds_read_b128 v[112:115], v120 offset:15360
    s_waitcnt lgkmcnt(6)
    v_mfma_f32_16x16x32_bf16 v[16:19], v[64:67], v[88:91], v[16:19]
    v_mfma_f32_16x16x32_bf16 v[12:15], v[68:71], v[88:91], v[12:15]
    v_mfma_f32_16x16x32_bf16 v[8:11], v[72:75], v[88:91], v[8:11]
    v_mfma_f32_16x16x32_bf16 v[4:7], v[76:79], v[88:91], v[4:7]
    ds_read_b128 v[88:91], v117 offset:8704
    s_waitcnt lgkmcnt(6)
    v_mfma_f32_16x16x32_bf16 v[44:47], v[80:83], v[92:95], v[44:47]
    v_mfma_f32_16x16x32_bf16 v[40:43], v[84:87], v[92:95], v[40:43]
    ds_read_b128 v[92:95], v122 offset:0
    v_add_u32 v122, v124, v122
    s_waitcnt lgkmcnt(6)
    v_mfma_f32_16x16x32_bf16 v[20:23], v[64:67], v[96:99], v[20:23]
    v_mfma_f32_16x16x32_bf16 v[16:19], v[68:71], v[96:99], v[16:19]
    v_mfma_f32_16x16x32_bf16 v[12:15], v[72:75], v[96:99], v[12:15]
    v_mfma_f32_16x16x32_bf16 v[8:11], v[76:79], v[96:99], v[8:11]
    ds_read_b128 v[96:99], v117 offset:9792
    s_waitcnt lgkmcnt(6)
    v_mfma_f32_16x16x32_bf16 v[48:51], v[80:83], v[100:103], v[48:51]
    v_mfma_f32_16x16x32_bf16 v[44:47], v[84:87], v[100:103], v[44:47]
    ds_read_b128 v[100:103], v121 offset:9216
    s_waitcnt lgkmcnt(6)
    v_mfma_f32_16x16x32_bf16 v[24:27], v[64:67], v[104:107], v[24:27]
    v_mfma_f32_16x16x32_bf16 v[20:23], v[68:71], v[104:107], v[20:23]
    v_mfma_f32_16x16x32_bf16 v[16:19], v[72:75], v[104:107], v[16:19]
    v_mfma_f32_16x16x32_bf16 v[12:15], v[76:79], v[104:107], v[12:15]
    ds_read_b128 v[104:107], v118 offset:8704
    s_waitcnt lgkmcnt(6)
    v_mfma_f32_16x16x32_bf16 v[52:55], v[80:83], v[108:111], v[52:55]
    v_mfma_f32_16x16x32_bf16 v[48:51], v[84:87], v[108:111], v[48:51]
    ds_read_b128 v[108:111], v121 offset:10240
    s_waitcnt lgkmcnt(6)
    v_mfma_f32_16x16x32_bf16 v[28:31], v[64:67], v[112:115], v[28:31]
    v_mfma_f32_16x16x32_bf16 v[24:27], v[68:71], v[112:115], v[24:27]
    v_mfma_f32_16x16x32_bf16 v[20:23], v[72:75], v[112:115], v[20:23]
    v_mfma_f32_16x16x32_bf16 v[16:19], v[76:79], v[112:115], v[16:19]
    buffer_load_dwordx4 v[64:67], v125, s[12:15], s23 offen offset:0
    s_waitcnt lgkmcnt(5)
    v_mfma_f32_16x16x32_bf16 v[56:59], v[80:83], v[88:91], v[56:59]
    v_mfma_f32_16x16x32_bf16 v[52:55], v[84:87], v[88:91], v[52:55]
    s_waitcnt lgkmcnt(0)
    s_barrier
    v_mfma_f32_16x16x32_bf16 v[28:31], v[68:71], v[92:95], v[28:31]
    v_mfma_f32_16x16x32_bf16 v[24:27], v[72:75], v[92:95], v[24:27]
    v_mfma_f32_16x16x32_bf16 v[20:23], v[76:79], v[92:95], v[20:23]
    buffer_load_dwordx4 v[68:71], v125, s[12:15], s23 offen offset:2048
    v_mfma_f32_16x16x32_bf16 v[60:63], v[80:83], v[96:99], v[60:63]
    v_mfma_f32_16x16x32_bf16 v[56:59], v[84:87], v[96:99], v[56:59]
    buffer_load_dwordx4 v[80:83], v119, s[12:15], s23 offen offset:0
    v_mfma_f32_16x16x32_bf16 v[28:31], v[72:75], v[100:103], v[28:31]
    v_mfma_f32_16x16x32_bf16 v[24:27], v[76:79], v[100:103], v[24:27]
    buffer_load_dwordx4 v[72:75], v125, s[12:15], s26 offen offset:0
    v_mfma_f32_16x16x32_bf16 v[60:63], v[84:87], v[104:107], v[60:63]
    buffer_load_dwordx4 v[84:87], v119, s[12:15], s23 offen offset:2048
    v_mfma_f32_16x16x32_bf16 v[28:31], v[76:79], v[108:111], v[28:31]
    buffer_load_dwordx4 v[76:79], v125, s[12:15], s26 offen offset:2048
    s_add_u32 s23, s23, 57344
    s_add_u32 s26, s26, 57344
    s_branch L_conv2_kernel_mloop2
L_conv2_kernel_mlast2:
    v_and_b32 v125, 15, v127
    v_and_b32 v126, 7, v127
    v_lshlrev_b32 v126, 4, v126
    v_lshl_add_u32 v125, v125, 7, v126
    v_lshrrev_b32 v126, 4, v127
    v_lshl_add_u32 v125, v126, 11, v125
    s_mov_b32 s36, 65536
    s_cmp_eq_u32 s32, 1
    s_cselect_b32 s36, 121856, s36
    s_cmp_eq_u32 s32, 2
    s_cselect_b32 s36, 81920, s36
    s_cmp_eq_u32 s32, 3
    s_cselect_b32 s36, 130048, s36
    s_mov_b32 s37, 98304
    s_cmp_eq_u32 s32, 1
    s_cselect_b32 s37, 138240, s37
    s_cmp_eq_u32 s32, 2
    s_cselect_b32 s37, 146432, s37
    s_cmp_eq_u32 s32, 3
    s_cselect_b32 s37, 154624, s37
    v_add_u32 v126, s37, v125
    v_add_u32 v125, s36, v125
    ds_read_b128 v[88:91], v120 offset:8192
    ds_read_b128 v[92:95], v120 offset:9216
    ds_read_b128 v[96:99], v116 offset:8704
    ds_read_b128 v[100:103], v120 offset:10240
    ds_read_b128 v[104:107], v116 offset:9792
    ds_read_b128 v[108:111], v120 offset:11264
    ds_read_b128 v[112:115], v116 offset:10880
    s_waitcnt vmcnt(5) lgkmcnt(6)
    v_mfma_f32_16x16x32_bf16 v[0:3], v[64:67], v[88:91], v[0:3]
    ds_read_b128 v[88:91], v120 offset:12288
    s_waitcnt vmcnt(4) lgkmcnt(6)
    v_mfma_f32_16x16x32_bf16 v[4:7], v[64:67], v[92:95], v[4:7]
    v_mfma_f32_16x16x32_bf16 v[0:3], v[68:71], v[92:95], v[0:3]
    ds_read_b128 v[92:95], v116 offset:11968
    s_waitcnt vmcnt(3) lgkmcnt(6)
    v_mfma_f32_16x16x32_bf16 v[32:35], v[80:83], v[96:99], v[32:35]
    ds_read_b128 v[96:99], v120 offset:13312
    s_waitcnt vmcnt(2) lgkmcnt(6)
    v_mfma_f32_16x16x32_bf16 v[8:11], v[64:67], v[100:103], v[8:11]
    v_mfma_f32_16x16x32_bf16 v[4:7], v[68:71], v[100:103], v[4:7]
    v_mfma_f32_16x16x32_bf16 v[0:3], v[72:75], v[100:103], v[0:3]
    ds_read_b128 v[100:103], v116 offset:13056
    s_waitcnt vmcnt(1) lgkmcnt(6)
    v_mfma_f32_16x16x32_bf16 v[36:39], v[80:83], v[104:107], v[36:39]
    v_mfma_f32_16x16x32_bf16 v[32:35], v[84:87], v[104:107], v[32:35]
    ds_read_b128 v[104:107], v120 offset:14336
    s_waitcnt vmcnt(0) lgkmcnt(6)
    v_mfma_f32_16x16x32_bf16 v[12:15], v[64:67], v[108:111], v[12:15]
    v_mfma_f32_16x16x32_bf16 v[8:11], v[68:71], v[108:111], v[8:11]
    v_mfma_f32_16x16x32_bf16 v[4:7], v[72:75], v[108:111], v[4:7]
    v_mfma_f32_16x16x32_bf16 v[0:3], v[76:79], v[108:111], v[0:3]
    ds_read_b128 v[108:111], v116 offset:14144
    s_waitcnt lgkmcnt(6)
    v_mfma_f32_16x16x32_bf16 v[40:43], v[80:83], v[112:115], v[40:43]
    v_mfma_f32_16x16x32_bf16 v[36:39], v[84:87], v[112:115], v[36:39]
    ds_read_b128 v[112:115], v120 offset:15360
    s_waitcnt lgkmcnt(6)
    v_mfma_f32_16x16x32_bf16 v[16:19], v[64:67], v[88:91], v[16:19]
    v_mfma_f32_16x16x32_bf16 v[12:15], v[68:71], v[88:91], v[12:15]
    v_mfma_f32_16x16x32_bf16 v[8:11], v[72:75], v[88:91], v[8:11]
    v_mfma_f32_16x16x32_bf16 v[4:7], v[76:79], v[88:91], v[4:7]
    ds_read_b128 v[88:91], v117 offset:8704
    v_xor_b32 v124, 0, v126
    ds_write_b128 v124, v[32:35]
    s_waitcnt lgkmcnt(7)
    v_mfma_f32_16x16x32_bf16 v[44:47], v[80:83], v[92:95], v[44:47]
    v_mfma_f32_16x16x32_bf16 v[40:43], v[84:87], v[92:95], v[40:43]
    ds_read_b128 v[92:95], v122 offset:0
    v_xor_b32 v123, 0, v125
    ds_write_b128 v123, v[0:3]
    s_waitcnt lgkmcnt(8)
    v_mfma_f32_16x16x32_bf16 v[20:23], v[64:67], v[96:99], v[20:23]
    v_mfma_f32_16x16x32_bf16 v[16:19], v[68:71], v[96:99], v[16:19]
    v_mfma_f32_16x16x32_bf16 v[12:15], v[72:75], v[96:99], v[12:15]
    v_mfma_f32_16x16x32_bf16 v[8:11], v[76:79], v[96:99], v[8:11]
    ds_read_b128 v[96:99], v117 offset:9792
    v_xor_b32 v123, 16, v126
    ds_write_b128 v123, v[36:39]
    s_waitcnt lgkmcnt(9)
    v_mfma_f32_16x16x32_bf16 v[48:51], v[80:83], v[100:103], v[48:51]
    v_mfma_f32_16x16x32_bf16 v[44:47], v[84:87], v[100:103], v[44:47]
    ds_read_b128 v[100:103], v121 offset:9216
    v_xor_b32 v124, 16, v125
    ds_write_b128 v124, v[4:7]
    s_waitcnt lgkmcnt(10)
    v_mfma_f32_16x16x32_bf16 v[24:27], v[64:67], v[104:107], v[24:27]
    v_mfma_f32_16x16x32_bf16 v[20:23], v[68:71], v[104:107], v[20:23]
    v_mfma_f32_16x16x32_bf16 v[16:19], v[72:75], v[104:107], v[16:19]
    v_mfma_f32_16x16x32_bf16 v[12:15], v[76:79], v[104:107], v[12:15]
    ds_read_b128 v[104:107], v118 offset:8704
    v_xor_b32 v124, 32, v126
    ds_write_b128 v124, v[40:43]
    s_waitcnt lgkmcnt(11)
    v_mfma_f32_16x16x32_bf16 v[52:55], v[80:83], v[108:111], v[52:55]
    v_mfma_f32_16x16x32_bf16 v[48:51], v[84:87], v[108:111], v[48:51]
    ds_read_b128 v[108:111], v121 offset:10240
    v_xor_b32 v123, 32, v125
    ds_write_b128 v123, v[8:11]
    s_waitcnt lgkmcnt(12)
    v_mfma_f32_16x16x32_bf16 v[28:31], v[64:67], v[112:115], v[28:31]
    v_mfma_f32_16x16x32_bf16 v[24:27], v[68:71], v[112:115], v[24:27]
    v_mfma_f32_16x16x32_bf16 v[20:23], v[72:75], v[112:115], v[20:23]
    v_mfma_f32_16x16x32_bf16 v[16:19], v[76:79], v[112:115], v[16:19]
    v_xor_b32 v123, 48, v126
    ds_write_b128 v123, v[44:47]
    s_waitcnt lgkmcnt(12)
    v_mfma_f32_16x16x32_bf16 v[56:59], v[80:83], v[88:91], v[56:59]
    v_mfma_f32_16x16x32_bf16 v[52:55], v[84:87], v[88:91], v[52:55]
    v_xor_b32 v124, 48, v125
    ds_write_b128 v124, v[12:15]
    s_waitcnt lgkmcnt(11)
    v_mfma_f32_16x16x32_bf16 v[28:31], v[68:71], v[92:95], v[28:31]
    v_mfma_f32_16x16x32_bf16 v[24:27], v[72:75], v[92:95], v[24:27]
    v_mfma_f32_16x16x32_bf16 v[20:23], v[76:79], v[92:95], v[20:23]
    v_xor_b32 v124, 64, v126
    ds_write_b128 v124, v[48:51]
    s_waitcnt lgkmcnt(10)
    v_mfma_f32_16x16x32_bf16 v[60:63], v[80:83], v[96:99], v[60:63]
    v_mfma_f32_16x16x32_bf16 v[56:59], v[84:87], v[96:99], v[56:59]
    v_xor_b32 v123, 64, v125
    ds_write_b128 v123, v[16:19]
    s_waitcnt lgkmcnt(9)
    v_mfma_f32_16x16x32_bf16 v[28:31], v[72:75], v[100:103], v[28:31]
    v_mfma_f32_16x16x32_bf16 v[24:27], v[76:79], v[100:103], v[24:27]
    v_xor_b32 v123, 80, v126
    ds_write_b128 v123, v[52:55]
    s_waitcnt lgkmcnt(8)
    v_mfma_f32_16x16x32_bf16 v[60:63], v[84:87], v[104:107], v[60:63]
    v_xor_b32 v124, 80, v125
    ds_write_b128 v124, v[20:23]
    s_waitcnt lgkmcnt(7)
    v_mfma_f32_16x16x32_bf16 v[28:31], v[76:79], v[108:111], v[28:31]
    v_xor_b32 v124, 96, v126
    ds_write_b128 v124, v[56:59]
    v_and_b32 v108, 15, v127
    v_lshrrev_b32 v109, 4, v127
    v_lshrrev_b32 v110, 3, v108
    s_lshl_b32 s36, s20, 1
    v_add_u32 v110, s36, v110
    v_xor_b32 v111, v110, v108
    v_and_b32 v111, 7, v111
    v_lshlrev_b32 v111, 4, v111
    v_xor_b32 v123, 96, v125
    ds_write_b128 v123, v[24:27]
    v_lshl_add_u32 v111, v110, 7, v111
    v_lshl_add_u32 v120, v109, 11, v111
    v_add_u32 v121, 65536, v120
    v_add_u32 v64, 131072, v120
    s_lshl_b32 s36, s20, 9
    s_add_u32 s36, s36, 115712
    v_lshl_add_u32 v127, v109, 7, s36
    s_lshl_b32 s36, s20, 4
    v_add_u32 v108, s36, v108
    v_lshlrev_b32 v110, 6, v108
    v_lshl_add_u32 v110, v109, 4, v110
    s_mul_i32 s36, s29, 262144
    v_xor_b32 v123, 112, v126
    ds_write_b128 v123, v[60:63]
    s_lshl_b32 s37, s21, 4
    s_add_u32 s36, s36, s37
    v_add_u32 v110, s36, v110
    v_mov_b32 v111, 2130706432
    v_cmp_gt_u32 vcc, 125, v108
    s_mov_b32 s4, 0xbeaaaaab
    s_mov_b32 s5, s4
    s_mov_b32 s6, 0x3e800000
    s_mov_b32 s7, s6
    s_mov_b32 s8, 0xc0a00000
    s_mov_b32 s9, s8
    s_mov_b32 s10, 0xc0638e39
    v_xor_b32 v124, 112, v125
    ds_write_b128 v124, v[28:31]
    s_mov_b32 s11, s10
    s_mov_b32 s12, 0xbf638e39
    s_mov_b32 s13, s12
    s_mov_b32 s14, 0xbe638e39
    s_mov_b32 s15, s14
    s_mov_b32 s22, 0xbd638e39
    s_mov_b32 s23, s22
    s_mov_b32 s24, 0x3ff1c71c
    s_mov_b32 s25, s24
    s_mov_b32 s26, 0xbf2aaaab
    s_mov_b32 s27, s26
    s_mov_b32 s32, 0x3ecccccd
    s_mov_b32 s33, s32
    s_mov_b32 s34, 0xbd888889
    s_mov_b32 s35, s34
    s_mov_b32 s38, 0xbe4ccccd
    s_mov_b32 s39, s38
    s_mov_b32 s40, 0xbdd2d3e8
    s_mov_b32 s41, s40
    s_mov_b32 s42, 0x3f800000
    s_mov_b32 s43, s42
    s_setprio 0
    s_branch L_conv2_kernel_epi
L_conv2_kernel_epi:
    s_waitcnt lgkmcnt(0)
    s_barrier
    v_cndmask_b32 v122, v111, v110, vcc
    ds_read_b128 v[0:3], v120 offset:0
    ds_read_b128 v[4:7], v120 offset:16384
    ds_read_b128 v[8:11], v120 offset:32768
    ds_read_b128 v[12:15], v120 offset:49152
    ds_read_b128 v[16:19], v121 offset:0
    ds_read_b128 v[20:23], v121 offset:16384
    ds_read_b128 v[24:27], v121 offset:32768
    ds_read_b128 v[28:31], v64 offset:15360
    ds_read_b128 v[32:35], v120 offset:8192
    ds_read_b128 v[36:39], v120 offset:24576
    ds_read_b128 v[40:43], v120 offset:40960
    ds_read_b128 v[44:47], v120 offset:57344
    ds_read_b128 v[48:51], v121 offset:56320
    ds_read_b128 v[52:55], v121 offset:64512
    ds_read_b128 v[56:59], v64 offset:7168
    s_waitcnt lgkmcnt(7)
    ds_read_b128 v[60:63], v64 offset:23552
    s_waitcnt lgkmcnt(8)
    v_pk_add_f32 v[88:89], v[24:25], v[28:29]
    v_pk_add_f32 v[90:91], v[26:27], v[30:31]
    v_pk_add_f32 v[24:25], v[4:5], v[8:9]
    v_pk_add_f32 v[26:27], v[6:7], v[10:11]
    v_pk_add_f32 v[4:5], v[4:5], v[8:9] neg_lo:[0,1] neg_hi:[0,1]
    v_pk_add_f32 v[6:7], v[6:7], v[10:11] neg_lo:[0,1] neg_hi:[0,1]
    v_pk_add_f32 v[72:73], v[12:13], v[16:17]
    v_pk_add_f32 v[74:75], v[14:15], v[18:19]
    v_pk_add_f32 v[12:13], v[12:13], v[16:17] neg_lo:[0,1] neg_hi:[0,1]
    v_pk_add_f32 v[14:15], v[14:15], v[18:19] neg_lo:[0,1] neg_hi:[0,1]
    v_pk_fma_f32 v[72:73], v[24:25], s[4:5], v[72:73]
    v_pk_fma_f32 v[74:75], v[26:27], s[4:5], v[74:75]
    v_pk_fma_f32 v[20:21], v[0:1], s[10:11], v[20:21]
    v_pk_fma_f32 v[22:23], v[2:3], s[10:11], v[22:23]
    v_pk_fma_f32 v[72:73], v[0:1], s[6:7], v[72:73]
    v_pk_fma_f32 v[74:75], v[2:3], s[6:7], v[74:75]
    v_pk_add_f32 v[24:25], v[24:25], v[0:1] neg_lo:[0,1] neg_hi:[0,1]
    v_pk_add_f32 v[26:27], v[26:27], v[2:3] neg_lo:[0,1] neg_hi:[0,1]
    v_pk_fma_f32 v[72:73], v[88:89], s[8:9], v[72:73]
    v_pk_fma_f32 v[74:75], v[90:91], s[8:9], v[74:75]
    v_pk_add_f32 v[24:25], v[24:25], v[88:89] neg_lo:[0,1] neg_hi:[0,1]
    v_pk_add_f32 v[26:27], v[26:27], v[90:91] neg_lo:[0,1] neg_hi:[0,1]
    v_pk_fma_f32 v[20:21], v[88:89], s[22:23], v[20:21]
    v_pk_fma_f32 v[22:23], v[90:91], s[22:23], v[22:23]
    v_pk_add_f32 v[8:9], v[24:25], v[72:73] neg_lo:[0,1] neg_hi:[0,1]
    v_pk_add_f32 v[10:11], v[26:27], v[74:75] neg_lo:[0,1] neg_hi:[0,1]
    v_pk_fma_f32 v[20:21], v[72:73], s[14:15], v[20:21]
    v_pk_fma_f32 v[22:23], v[74:75], s[14:15], v[22:23]
    v_pk_mul_f32 v[80:81], v[12:13], s[32:33]
    v_pk_mul_f32 v[82:83], v[14:15], s[32:33]
    v_pk_fma_f32 v[20:21], v[8:9], s[12:13], v[20:21]
    v_pk_fma_f32 v[22:23], v[10:11], s[12:13], v[22:23]
    v_pk_fma_f32 v[80:81], v[4:5], s[34:35], v[80:81]
    v_pk_fma_f32 v[82:83], v[6:7], s[34:35], v[82:83]
    v_pk_fma_f32 v[64:65], v[4:5], s[24:25], v[20:21] neg_lo:[0,0,1] neg_hi:[0,0,1]
    v_pk_fma_f32 v[66:67], v[6:7], s[24:25], v[22:23] neg_lo:[0,0,1] neg_hi:[0,0,1]
    v_pk_fma_f32 v[64:65], v[12:13], s[26:27], v[64:65]
    v_pk_fma_f32 v[66:67], v[14:15], s[26:27], v[66:67]
    v_pk_fma_f32 v[80:81], v[64:65], s[38:39], v[80:81]
    v_pk_fma_f32 v[82:83], v[66:67], s[38:39], v[82:83]
    v_pk_add_f32 v[4:5], v[4:5], v[64:65] neg_lo:[0,1] neg_hi:[0,1]
    v_pk_add_f32 v[6:7], v[6:7], v[66:67] neg_lo:[0,1] neg_hi:[0,1]
    v_pk_add_f32 v[4:5], v[4:5], v[80:81] neg_lo:[0,1] neg_hi:[0,1]
    v_pk_add_f32 v[6:7], v[6:7], v[82:83] neg_lo:[0,1] neg_hi:[0,1]
    s_waitcnt lgkmcnt(0)
    v_pk_add_f32 v[92:93], v[56:57], v[60:61]
    v_pk_add_f32 v[94:95], v[58:59], v[62:63]
    v_pk_add_f32 v[56:57], v[36:37], v[40:41]
    v_pk_add_f32 v[58:59], v[38:39], v[42:43]
    v_pk_add_f32 v[36:37], v[36:37], v[40:41] neg_lo:[0,1] neg_hi:[0,1]
    v_pk_add_f32 v[38:39], v[38:39], v[42:43] neg_lo:[0,1] neg_hi:[0,1]
    v_pk_add_f32 v[76:77], v[44:45], v[48:49]
    v_pk_add_f32 v[78:79], v[46:47], v[50:51]
    v_pk_add_f32 v[44:45], v[44:45], v[48:49] neg_lo:[0,1] neg_hi:[0,1]
    v_pk_add_f32 v[46:47], v[46:47], v[50:51] neg_lo:[0,1] neg_hi:[0,1]
    v_pk_fma_f32 v[76:77], v[56:57], s[4:5], v[76:77]
    v_pk_fma_f32 v[78:79], v[58:59], s[4:5], v[78:79]
    v_pk_fma_f32 v[52:53], v[32:33], s[10:11], v[52:53]
    v_pk_fma_f32 v[54:55], v[34:35], s[10:11], v[54:55]
    v_pk_fma_f32 v[76:77], v[32:33], s[6:7], v[76:77]
    v_pk_fma_f32 v[78:79], v[34:35], s[6:7], v[78:79]
    v_pk_add_f32 v[56:57], v[56:57], v[32:33] neg_lo:[0,1] neg_hi:[0,1]
    v_pk_add_f32 v[58:59], v[58:59], v[34:35] neg_lo:[0,1] neg_hi:[0,1]
    v_pk_fma_f32 v[76:77], v[92:93], s[8:9], v[76:77]
    v_pk_fma_f32 v[78:79], v[94:95], s[8:9], v[78:79]
    v_pk_add_f32 v[56:57], v[56:57], v[92:93] neg_lo:[0,1] neg_hi:[0,1]
    v_pk_add_f32 v[58:59], v[58:59], v[94:95] neg_lo:[0,1] neg_hi:[0,1]
    v_pk_fma_f32 v[52:53], v[92:93], s[22:23], v[52:53]
    v_pk_fma_f32 v[54:55], v[94:95], s[22:23], v[54:55]
    v_pk_add_f32 v[40:41], v[56:57], v[76:77] neg_lo:[0,1] neg_hi:[0,1]
    v_pk_add_f32 v[42:43], v[58:59], v[78:79] neg_lo:[0,1] neg_hi:[0,1]
    v_pk_fma_f32 v[52:53], v[76:77], s[14:15], v[52:53]
    v_pk_fma_f32 v[54:55], v[78:79], s[14:15], v[54:55]
    v_pk_mul_f32 v[84:85], v[44:45], s[32:33]
    v_pk_mul_f32 v[86:87], v[46:47], s[32:33]
    v_pk_fma_f32 v[52:53], v[40:41], s[12:13], v[52:53]
    v_pk_fma_f32 v[54:55], v[42:43], s[12:13], v[54:55]
    v_pk_fma_f32 v[84:85], v[36:37], s[34:35], v[84:85]
    v_pk_fma_f32 v[86:87], v[38:39], s[34:35], v[86:87]
    v_pk_fma_f32 v[68:69], v[36:37], s[24:25], v[52:53] neg_lo:[0,0,1] neg_hi:[0,0,1]
    v_pk_fma_f32 v[70:71], v[38:39], s[24:25], v[54:55] neg_lo:[0,0,1] neg_hi:[0,0,1]
    v_pk_fma_f32 v[68:69], v[44:45], s[26:27], v[68:69]
    v_pk_fma_f32 v[70:71], v[46:47], s[26:27], v[70:71]
    v_pk_fma_f32 v[84:85], v[68:69], s[38:39], v[84:85]
    v_pk_fma_f32 v[86:87], v[70:71], s[38:39], v[86:87]
    v_pk_add_f32 v[36:37], v[36:37], v[68:69] neg_lo:[0,1] neg_hi:[0,1]
    v_pk_add_f32 v[38:39], v[38:39], v[70:71] neg_lo:[0,1] neg_hi:[0,1]
    v_pk_add_f32 v[36:37], v[36:37], v[84:85] neg_lo:[0,1] neg_hi:[0,1]
    v_pk_add_f32 v[38:39], v[38:39], v[86:87] neg_lo:[0,1] neg_hi:[0,1]
    s_mov_b32 s36, 0x00010001
    s_mov_b32 s37, 0x00010001
    s_mov_b64 exec, s[36:37]
    ds_write_b128 v127, v[0:3] offset:0
    ds_write_b128 v127, v[32:35] offset:16
    ds_write_b128 v127, v[4:7] offset:32
    ds_write_b128 v127, v[36:39] offset:48
    ds_write_b128 v127, v[8:11] offset:64
    ds_write_b128 v127, v[40:43] offset:80
    s_mov_b64 exec, -1
    v_mov_b32 v44, 0xc0135761
    v_mov_b32 v45, v44
    v_cvt_pk_bf16_f32 v48, v64, v68
    v_cvt_pk_bf16_f32 v49, v65, v69
    v_cvt_pk_bf16_f32 v50, v66, v70
    v_cvt_pk_bf16_f32 v51, v67, v71
    s_mov_b32 s44, 0
    buffer_store_dwordx4 v[48:51], v122, s[16:19], s44 offen sc1
    s_waitcnt lgkmcnt(0)
    s_barrier
    ds_read_b128 v[96:99], v127 offset:512
    ds_read_b128 v[100:103], v127 offset:528
    ds_read_b128 v[104:107], v127 offset:544
    ds_read_b128 v[108:111], v127 offset:560
    ds_read_b128 v[112:115], v127 offset:576
    ds_read_b128 v[116:119], v127 offset:592
    s_waitcnt lgkmcnt(4)
    v_mov_b32_dpp v96, v0 row_shl:1 row_mask:0xf bank_mask:0xf
    v_mov_b32_dpp v97, v1 row_shl:1 row_mask:0xf bank_mask:0xf
    v_mov_b32_dpp v98, v2 row_shl:1 row_mask:0xf bank_mask:0xf
    v_mov_b32_dpp v99, v3 row_shl:1 row_mask:0xf bank_mask:0xf
    v_mov_b32_dpp v100, v32 row_shl:1 row_mask:0xf bank_mask:0xf
    v_mov_b32_dpp v101, v33 row_shl:1 row_mask:0xf bank_mask:0xf
    v_mov_b32_dpp v102, v34 row_shl:1 row_mask:0xf bank_mask:0xf
    v_mov_b32_dpp v103, v35 row_shl:1 row_mask:0xf bank_mask:0xf
    v_pk_add_f32 v[72:73], v[72:73], v[96:97]
    v_pk_add_f32 v[74:75], v[74:75], v[98:99]
    v_pk_add_f32 v[76:77], v[76:77], v[100:101]
    v_pk_add_f32 v[78:79], v[78:79], v[102:103]
    v_cvt_pk_bf16_f32 v52, v72, v76
    v_cvt_pk_bf16_f32 v53, v73, v77
    v_cvt_pk_bf16_f32 v54, v74, v78
    v_cvt_pk_bf16_f32 v55, v75, v79
    s_mov_b32 s44, 65536
    buffer_store_dwordx4 v[52:55], v122, s[16:19], s44 offen sc1
    s_waitcnt lgkmcnt(2)
    v_mov_b32_dpp v104, v4 row_shl:1 row_mask:0xf bank_mask:0xf
    v_mov_b32_dpp v105, v5 row_shl:1 row_mask:0xf bank_mask:0xf
    v_mov_b32_dpp v106, v6 row_shl:1 row_mask:0xf bank_mask:0xf
    v_mov_b32_dpp v107, v7 row_shl:1 row_mask:0xf bank_mask:0xf
    v_mov_b32_dpp v108, v36 row_shl:1 row_mask:0xf bank_mask:0xf
    v_mov_b32_dpp v109, v37 row_shl:1 row_mask:0xf bank_mask:0xf
    v_mov_b32_dpp v110, v38 row_shl:1 row_mask:0xf bank_mask:0xf
    v_mov_b32_dpp v111, v39 row_shl:1 row_mask:0xf bank_mask:0xf
    v_pk_add_f32 v[80:81], v[80:81], v[104:105]
    v_pk_add_f32 v[82:83], v[82:83], v[106:107]
    v_pk_add_f32 v[84:85], v[84:85], v[108:109]
    v_pk_add_f32 v[86:87], v[86:87], v[110:111]
    v_cvt_pk_bf16_f32 v56, v80, v84
    v_cvt_pk_bf16_f32 v57, v81, v85
    v_cvt_pk_bf16_f32 v58, v82, v86
    v_cvt_pk_bf16_f32 v59, v83, v87
    s_mov_b32 s44, 131072
    buffer_store_dwordx4 v[56:59], v122, s[16:19], s44 offen sc1
    s_waitcnt lgkmcnt(0)
    v_mov_b32_dpp v112, v8 row_shl:1 row_mask:0xf bank_mask:0xf
    v_mov_b32_dpp v113, v9 row_shl:1 row_mask:0xf bank_mask:0xf
    v_mov_b32_dpp v114, v10 row_shl:1 row_mask:0xf bank_mask:0xf
    v_mov_b32_dpp v115, v11 row_shl:1 row_mask:0xf bank_mask:0xf
    v_mov_b32_dpp v116, v40 row_shl:1 row_mask:0xf bank_mask:0xf
    v_mov_b32_dpp v117, v41 row_shl:1 row_mask:0xf bank_mask:0xf
    v_mov_b32_dpp v118, v42 row_shl:1 row_mask:0xf bank_mask:0xf
    v_mov_b32_dpp v119, v43 row_shl:1 row_mask:0xf bank_mask:0xf
    v_pk_add_f32 v[88:89], v[88:89], v[112:113]
    v_pk_add_f32 v[90:91], v[90:91], v[114:115]
    v_pk_add_f32 v[92:93], v[92:93], v[116:117]
    v_pk_add_f32 v[94:95], v[94:95], v[118:119]
    v_cvt_pk_bf16_f32 v60, v88, v92
    v_cvt_pk_bf16_f32 v61, v89, v93
    v_cvt_pk_bf16_f32 v62, v90, v94
    v_cvt_pk_bf16_f32 v63, v91, v95
    s_mov_b32 s44, 196608
    buffer_store_dwordx4 v[60:63], v122, s[16:19], s44 offen sc1
L_conv2_kernel_end:
L_conv2_kernel_done:
    s_endpgm
.globl joint_kernel
.p2align 8
.type joint_kernel,@function
joint_kernel:
    s_cmp_ge_u32 s2, 250
    s_cbranch_scc1 L_joint_kernel_done
    s_load_dwordx2 s[28:29], s[0:1], 56
    s_load_dwordx2 s[30:31], s[0:1], 72
    v_readfirstlane_b32 s20, v0
    s_lshr_b32 s20, s20, 6
    s_and_b32 s21, s20, 7
    v_and_b32 v127, 63, v0
    v_lshlrev_b32 v126, 4, v127
    s_cmp_ge_u32 s20, 8
    s_mov_b32 s33, 44171264
    s_cselect_b32 s33, 44040192, s33
    s_lshl_b32 s36, s21, 14
    s_add_u32 s33, s33, s36
    s_mov_b32 s14, 16384
    s_mov_b32 s15, 0x00020000
    s_lshl_b32 s35, s2, 9
    s_cmp_ge_u32 s2, 125
    s_cselect_b32 s36, 2033152, 0
    s_cselect_b32 s34, 8192, 0
    s_add_u32 s35, s35, s36
    s_add_u32 s34, s34, 44302336
    s_mov_b32 s10, 12582912
    s_mov_b32 s11, 0x00020000
    s_mov_b32 s42, 24576
    s_mov_b32 s43, 0x00020000
    s_cmp_ge_u32 s20, 8
    s_cbranch_scc1 L_joint_kernel_T
    v_lshrrev_b32 v124, 5, v127
    v_and_b32 v123, 0x1ff, v126
    v_mul_u32_u24 v125, 65536, v124
    v_add_u32 v123, v125, v123
    s_mul_i32 s36, s21, 262144
    s_add_u32 s36, s36, s35
    s_waitcnt lgkmcnt(0)
    s_add_u32 s8, s30, 27262976
    s_addc_u32 s9, s31, 0
    s_add_u32 s37, s36, 8388608
    buffer_load_dwordx4 v[64:67], v123, s[8:11], s36 offen
    buffer_load_dwordx4 v[72:75], v123, s[8:11], s37 offen
    s_add_u32 s36, s36, 131072
    s_add_u32 s37, s36, 8388608
    buffer_load_dwordx4 v[68:71], v123, s[8:11], s36 offen
    buffer_load_dwordx4 v[76:79], v123, s[8:11], s37 offen
    v_mov_b32 v0, 99456
    v_mov_b32 v2, 0
    v_mov_b32 v3, 0
    ds_write_b64 v0, v[2:3]
    s_add_u32 s12, s30, s33
    s_addc_u32 s13, s31, 0
    s_add_u32 s40, s30, s34
    s_addc_u32 s41, s31, 0
    s_lshl_b32 s38, s21, 10
    s_add_u32 s38, s38, 16384
    buffer_load_dwordx4 v[80:83], v126, s[40:43], s38 offen
    s_waitcnt lgkmcnt(0)
    s_barrier
    s_lshl_b32 s35, s2, 17
    s_add_u32 s16, s28, s35
    s_addc_u32 s17, s29, 0
    s_mov_b32 s18, 131072
    s_mov_b32 s19, 0x00020000
    s_mov_b32 s46, 0xbdd2d3e8
    s_mov_b32 s47, s46
    v_mov_b32 v120, 0xc0135761
    v_mov_b32 v121, v120
    s_mov_b32 s48, 1.0
    s_mov_b32 s49, 1.0
    v_bfe_u32 v123, v127, 2, 3
    v_lshl_add_u32 v124, v123, 2, v124
    v_mul_u32_u24 v124, 528, v124
    v_and_b32 v123, 0x30, v126
    s_lshl_b32 s36, s21, 6
    v_add3_u32 v124, v124, v123, s36
    s_mov_b32 s45, 0xffff0000
    s_mul_i32 s36, s21, 1040
    s_add_u32 s36, s36, 91136
    v_add_u32 v123, s36, v126
    s_mov_b32 s22, 2
    s_waitcnt vmcnt(3)
L_joint_kernel_floop:
    v_lshlrev_b32 v88, 16, v64
    v_and_b32 v89, s45, v64
    v_lshlrev_b32 v96, 16, v72
    v_and_b32 v97, s45, v72
    v_lshlrev_b32 v90, 16, v65
    v_and_b32 v91, s45, v65
    v_lshlrev_b32 v98, 16, v73
    v_and_b32 v99, s45, v73
    v_lshlrev_b32 v92, 16, v66
    v_and_b32 v93, s45, v66
    v_lshlrev_b32 v100, 16, v74
    v_and_b32 v101, s45, v74
    v_lshlrev_b32 v94, 16, v67
    v_and_b32 v95, s45, v67
    v_lshlrev_b32 v102, 16, v75
    v_and_b32 v103, s45, v75
    v_pk_add_f32 v[88:89], v[88:89], v[96:97]
    v_pk_add_f32 v[90:91], v[90:91], v[98:99]
    v_pk_add_f32 v[92:93], v[92:93], v[100:101]
    v_pk_add_f32 v[94:95], v[94:95], v[102:103]
    v_pk_mul_f32 v[96:97], v[88:89], v[88:89]
    v_pk_mul_f32 v[98:99], v[90:91], v[90:91]
    v_pk_mul_f32 v[100:101], v[92:93], v[92:93]
    v_pk_mul_f32 v[102:103], v[94:95], v[94:95]
    v_pk_fma_f32 v[96:97], v[96:97], s[46:47], v[120:121]
    v_pk_fma_f32 v[98:99], v[98:99], s[46:47], v[120:121]
    v_pk_fma_f32 v[100:101], v[100:101], s[46:47], v[120:121]
    v_pk_fma_f32 v[102:103], v[102:103], s[46:47], v[120:121]
    v_pk_mul_f32 v[96:97], v[96:97], v[88:89]
    v_pk_mul_f32 v[98:99], v[98:99], v[90:91]
    v_pk_mul_f32 v[100:101], v[100:101], v[92:93]
    v_pk_mul_f32 v[102:103], v[102:103], v[94:95]
    v_exp_f32 v96, v96
    v_exp_f32 v97, v97
    v_exp_f32 v98, v98
    v_exp_f32 v99, v99
    v_exp_f32 v100, v100
    v_exp_f32 v101, v101
    v_exp_f32 v102, v102
    v_exp_f32 v103, v103
    v_pk_add_f32 v[96:97], v[96:97], s[48:49]
    v_pk_add_f32 v[98:99], v[98:99], s[48:49]
    v_pk_add_f32 v[100:101], v[100:101], s[48:49]
    v_pk_add_f32 v[102:103], v[102:103], s[48:49]
    v_rcp_f32 v96, v96
    v_rcp_f32 v97, v97
    v_rcp_f32 v98, v98
    v_rcp_f32 v99, v99
    v_rcp_f32 v100, v100
    v_rcp_f32 v101, v101
    v_rcp_f32 v102, v102
    v_rcp_f32 v103, v103
    v_pk_mul_f32 v[88:89], v[88:89], v[96:97]
    v_pk_mul_f32 v[90:91], v[90:91], v[98:99]
    v_pk_mul_f32 v[92:93], v[92:93], v[100:101]
    v_pk_mul_f32 v[94:95], v[94:95], v[102:103]
    v_cvt_pk_bf16_f32 v104, v88, v89
    v_cvt_pk_bf16_f32 v105, v90, v91
    v_cvt_pk_bf16_f32 v106, v92, v93
    v_cvt_pk_bf16_f32 v107, v94, v95
    ds_write_b128 v124, v[104:107] offset:32768
    s_waitcnt vmcnt(0)
    v_pk_mov_b32 v[64:65], v[68:69], v[68:69] op_sel:[0,1]
    v_pk_mov_b32 v[72:73], v[76:77], v[76:77] op_sel:[0,1]
    v_pk_mov_b32 v[66:67], v[70:71], v[70:71] op_sel:[0,1]
    v_pk_mov_b32 v[74:75], v[78:79], v[78:79] op_sel:[0,1]
    v_add_u32 v124, 1056, v124
    s_sub_u32 s22, s22, 1
    s_cmp_lg_u32 s22, 0
    s_cbranch_scc1 L_joint_kernel_floop
    ds_write_b128 v123, v[80:83]
    s_waitcnt lgkmcnt(0)
    v_mov_b32 v120, 99456
    v_mov_b32 v121, 1
    s_mov_b64 exec, 1
    ds_add_u32 v120, v121 offset:0
    s_mov_b64 exec, -1
L_joint_kernel_ow:
    ds_read_b32 v121, v120 offset:4
    s_waitcnt lgkmcnt(0)
    v_readfirstlane_b32 s37, v121
    s_cmp_ge_u32 s37, 8
    s_cbranch_scc1 L_joint_kernel_ow_d
    s_sleep 1
    s_branch L_joint_kernel_ow
L_joint_kernel_ow_d:
    s_mov_b32 s36, 0
    buffer_load_dwordx4 v[0:3], v126, s[12:15], s36 offen offset:0
    buffer_load_dwordx4 v[4:7], v126, s[12:15], s36 offen offset:1024
    buffer_load_dwordx4 v[8:11], v126, s[12:15], s36 offen offset:2048
    buffer_load_dwordx4 v[12:15], v126, s[12:15], s36 offen offset:3072
    s_mov_b32 s36, 4096
    buffer_load_dwordx4 v[16:19], v126, s[12:15], s36 offen offset:0
    buffer_load_dwordx4 v[20:23], v126, s[12:15], s36 offen offset:1024
    buffer_load_dwordx4 v[24:27], v126, s[12:15], s36 offen offset:2048
    buffer_load_dwordx4 v[28:31], v126, s[12:15], s36 offen offset:3072
    s_mov_b32 s36, 8192
    buffer_load_dwordx4 v[32:35], v126, s[12:15], s36 offen offset:0
    buffer_load_dwordx4 v[36:39], v126, s[12:15], s36 offen offset:1024
    buffer_load_dwordx4 v[40:43], v126, s[12:15], s36 offen offset:2048
    buffer_load_dwordx4 v[44:47], v126, s[12:15], s36 offen offset:3072
    s_mov_b32 s36, 12288
    buffer_load_dwordx4 v[48:51], v126, s[12:15], s36 offen offset:0
    buffer_load_dwordx4 v[52:55], v126, s[12:15], s36 offen offset:1024
    buffer_load_dwordx4 v[56:59], v126, s[12:15], s36 offen offset:2048
    buffer_load_dwordx4 v[60:63], v126, s[12:15], s36 offen offset:3072
    v_lshrrev_b32 v125, 4, v127
    v_lshlrev_b32 v125, 11, v125
    v_and_b32 v124, 15, v127
    v_lshl_add_u32 v125, v124, 2, v125
    s_lshl_b32 s36, s21, 6
    v_add_u32 v125, s36, v125
    s_mov_b32 s44, 8192
    s_setprio 1
    s_barrier
    ds_read_b128 v[96:99], v126 offset:0
    ds_read_b128 v[100:103], v126 offset:1024
    ds_read_b128 v[104:107], v126 offset:2048
    ds_read_b128 v[108:111], v126 offset:3072
    s_waitcnt vmcnt(14) lgkmcnt(3)
    v_mfma_f32_16x16x32_bf16 v[64:67], v[96:99], v[0:3], 0
    v_mfma_f32_16x16x32_bf16 v[68:71], v[96:99], v[4:7], 0
    ds_read_b128 v[96:99], v126 offset:4096
    s_waitcnt lgkmcnt(3)
    v_mfma_f32_16x16x32_bf16 v[72:75], v[100:103], v[0:3], 0
    v_mfma_f32_16x16x32_bf16 v[76:79], v[100:103], v[4:7], 0
    ds_read_b128 v[100:103], v126 offset:5120
    s_waitcnt vmcnt(12) lgkmcnt(3)
    v_mfma_f32_16x16x32_bf16 v[64:67], v[104:107], v[8:11], v[64:67]
    v_mfma_f32_16x16x32_bf16 v[68:71], v[104:107], v[12:15], v[68:71]
    ds_read_b128 v[104:107], v126 offset:6144
    s_waitcnt lgkmcnt(3)
    v_mfma_f32_16x16x32_bf16 v[72:75], v[108:111], v[8:11], v[72:75]
    v_mfma_f32_16x16x32_bf16 v[76:79], v[108:111], v[12:15], v[76:79]
    ds_read_b128 v[108:111], v126 offset:7168
    s_waitcnt vmcnt(10) lgkmcnt(3)
    v_mfma_f32_16x16x32_bf16 v[64:67], v[96:99], v[16:19], v[64:67]
    v_mfma_f32_16x16x32_bf16 v[68:71], v[96:99], v[20:23], v[68:71]
    ds_read_b128 v[96:99], v126 offset:8192
    s_waitcnt lgkmcnt(3)
    v_mfma_f32_16x16x32_bf16 v[72:75], v[100:103], v[16:19], v[72:75]
    v_mfma_f32_16x16x32_bf16 v[76:79], v[100:103], v[20:23], v[76:79]
    ds_read_b128 v[100:103], v126 offset:9216
    s_waitcnt vmcnt(8) lgkmcnt(3)
    v_mfma_f32_16x16x32_bf16 v[64:67], v[104:107], v[24:27], v[64:67]
    v_mfma_f32_16x16x32_bf16 v[68:71], v[104:107], v[28:31], v[68:71]
    ds_read_b128 v[104:107], v126 offset:10240
    s_waitcnt lgkmcnt(3)
    v_mfma_f32_16x16x32_bf16 v[72:75], v[108:111], v[24:27], v[72:75]
    v_mfma_f32_16x16x32_bf16 v[76:79], v[108:111], v[28:31], v[76:79]
    ds_read_b128 v[108:111], v126 offset:11264
    s_waitcnt vmcnt(6) lgkmcnt(3)
    v_mfma_f32_16x16x32_bf16 v[64:67], v[96:99], v[32:35], v[64:67]
    v_mfma_f32_16x16x32_bf16 v[68:71], v[96:99], v[36:39], v[68:71]
    ds_read_b128 v[96:99], v126 offset:12288
    s_waitcnt lgkmcnt(3)
    v_mfma_f32_16x16x32_bf16 v[72:75], v[100:103], v[32:35], v[72:75]
    v_mfma_f32_16x16x32_bf16 v[76:79], v[100:103], v[36:39], v[76:79]
    ds_read_b128 v[100:103], v126 offset:13312
    s_waitcnt vmcnt(4) lgkmcnt(3)
    v_mfma_f32_16x16x32_bf16 v[64:67], v[104:107], v[40:43], v[64:67]
    v_mfma_f32_16x16x32_bf16 v[68:71], v[104:107], v[44:47], v[68:71]
    ds_read_b128 v[104:107], v126 offset:14336
    s_waitcnt lgkmcnt(3)
    v_mfma_f32_16x16x32_bf16 v[72:75], v[108:111], v[40:43], v[72:75]
    v_mfma_f32_16x16x32_bf16 v[76:79], v[108:111], v[44:47], v[76:79]
    ds_read_b128 v[108:111], v126 offset:15360
    s_waitcnt vmcnt(2) lgkmcnt(3)
    v_mfma_f32_16x16x32_bf16 v[64:67], v[96:99], v[48:51], v[64:67]
    v_mfma_f32_16x16x32_bf16 v[68:71], v[96:99], v[52:55], v[68:71]
    s_waitcnt lgkmcnt(0)
    s_barrier
    ds_read_b128 v[96:99], v126 offset:16384
    v_mfma_f32_16x16x32_bf16 v[72:75], v[100:103], v[48:51], v[72:75]
    v_mfma_f32_16x16x32_bf16 v[76:79], v[100:103], v[52:55], v[76:79]
    ds_read_b128 v[100:103], v126 offset:17408
    s_waitcnt vmcnt(0)
    v_mfma_f32_16x16x32_bf16 v[64:67], v[104:107], v[56:59], v[64:67]
    v_mfma_f32_16x16x32_bf16 v[68:71], v[104:107], v[60:63], v[68:71]
    ds_read_b128 v[104:107], v126 offset:18432
    v_mfma_f32_16x16x32_bf16 v[72:75], v[108:111], v[56:59], v[72:75]
    v_mfma_f32_16x16x32_bf16 v[76:79], v[108:111], v[60:63], v[76:79]
    ds_read_b128 v[108:111], v126 offset:19456
    s_mov_b32 s22, 4
L_joint_kernel_oloop:
    s_waitcnt lgkmcnt(3)
    v_mfma_f32_16x16x32_bf16 v[80:83], v[96:99], v[0:3], 0
    v_mfma_f32_16x16x32_bf16 v[84:87], v[96:99], v[4:7], 0
    ds_read_b128 v[96:99], v126 offset:20480
    s_waitcnt lgkmcnt(3)
    v_mfma_f32_16x16x32_bf16 v[88:91], v[100:103], v[0:3], 0
    v_mfma_f32_16x16x32_bf16 v[92:95], v[100:103], v[4:7], 0
    ds_read_b128 v[100:103], v126 offset:21504
    s_waitcnt lgkmcnt(3)
    v_mfma_f32_16x16x32_bf16 v[80:83], v[104:107], v[8:11], v[80:83]
    v_mfma_f32_16x16x32_bf16 v[84:87], v[104:107], v[12:15], v[84:87]
    ds_read_b128 v[104:107], v126 offset:22528
    s_waitcnt lgkmcnt(3)
    v_mfma_f32_16x16x32_bf16 v[88:91], v[108:111], v[8:11], v[88:91]
    v_cvt_pk_bf16_f32 v112, v64, v68
    v_mfma_f32_16x16x32_bf16 v[92:95], v[108:111], v[12:15], v[92:95]
    buffer_store_dword v112, v125, s[16:19], 0 offen offset:0 nt
    ds_read_b128 v[108:111], v126 offset:23552
    s_waitcnt lgkmcnt(3)
    v_mfma_f32_16x16x32_bf16 v[80:83], v[96:99], v[16:19], v[80:83]
    v_cvt_pk_bf16_f32 v113, v65, v69
    v_mfma_f32_16x16x32_bf16 v[84:87], v[96:99], v[20:23], v[84:87]
    buffer_store_dword v113, v125, s[16:19], 0 offen offset:512 nt
    ds_read_b128 v[96:99], v126 offset:24576
    s_waitcnt lgkmcnt(3)
    v_mfma_f32_16x16x32_bf16 v[88:91], v[100:103], v[16:19], v[88:91]
    v_cvt_pk_bf16_f32 v114, v66, v70
    v_mfma_f32_16x16x32_bf16 v[92:95], v[100:103], v[20:23], v[92:95]
    buffer_store_dword v114, v125, s[16:19], 0 offen offset:1024 nt
    ds_read_b128 v[100:103], v126 offset:25600
    s_waitcnt lgkmcnt(3)
    v_mfma_f32_16x16x32_bf16 v[80:83], v[104:107], v[24:27], v[80:83]
    v_cvt_pk_bf16_f32 v115, v67, v71
    v_mfma_f32_16x16x32_bf16 v[84:87], v[104:107], v[28:31], v[84:87]
    buffer_store_dword v115, v125, s[16:19], 0 offen offset:1536 nt
    ds_read_b128 v[104:107], v126 offset:26624
    s_waitcnt lgkmcnt(3)
    v_mfma_f32_16x16x32_bf16 v[88:91], v[108:111], v[24:27], v[88:91]
    v_cvt_pk_bf16_f32 v116, v72, v76
    v_mfma_f32_16x16x32_bf16 v[92:95], v[108:111], v[28:31], v[92:95]
    buffer_store_dword v116, v125, s[16:19], s44 offen offset:0 nt
    ds_read_b128 v[108:111], v126 offset:27648
    s_waitcnt lgkmcnt(3)
    v_mfma_f32_16x16x32_bf16 v[80:83], v[96:99], v[32:35], v[80:83]
    v_cvt_pk_bf16_f32 v117, v73, v77
    v_mfma_f32_16x16x32_bf16 v[84:87], v[96:99], v[36:39], v[84:87]
    buffer_store_dword v117, v125, s[16:19], s44 offen offset:512 nt
    ds_read_b128 v[96:99], v126 offset:28672
    s_waitcnt lgkmcnt(3)
    v_mfma_f32_16x16x32_bf16 v[88:91], v[100:103], v[32:35], v[88:91]
    v_cvt_pk_bf16_f32 v118, v74, v78
    v_mfma_f32_16x16x32_bf16 v[92:95], v[100:103], v[36:39], v[92:95]
    buffer_store_dword v118, v125, s[16:19], s44 offen offset:1024 nt
    ds_read_b128 v[100:103], v126 offset:29696
    s_waitcnt lgkmcnt(3)
    v_mfma_f32_16x16x32_bf16 v[80:83], v[104:107], v[40:43], v[80:83]
    v_cvt_pk_bf16_f32 v119, v75, v79
    v_mfma_f32_16x16x32_bf16 v[84:87], v[104:107], v[44:47], v[84:87]
    buffer_store_dword v119, v125, s[16:19], s44 offen offset:1536 nt
    ds_read_b128 v[104:107], v126 offset:30720
    s_waitcnt lgkmcnt(3)
    v_mfma_f32_16x16x32_bf16 v[88:91], v[108:111], v[40:43], v[88:91]
    v_add_u32 v125, 16384, v125
    v_mfma_f32_16x16x32_bf16 v[92:95], v[108:111], v[44:47], v[92:95]
    ds_read_b128 v[108:111], v126 offset:31744
    s_waitcnt lgkmcnt(3)
    v_mfma_f32_16x16x32_bf16 v[80:83], v[96:99], v[48:51], v[80:83]
    v_mfma_f32_16x16x32_bf16 v[84:87], v[96:99], v[52:55], v[84:87]
    s_waitcnt lgkmcnt(0)
    s_barrier
    ds_read_b128 v[96:99], v126 offset:0
    v_mfma_f32_16x16x32_bf16 v[88:91], v[100:103], v[48:51], v[88:91]
    v_mfma_f32_16x16x32_bf16 v[92:95], v[100:103], v[52:55], v[92:95]
    ds_read_b128 v[100:103], v126 offset:1024
    v_mfma_f32_16x16x32_bf16 v[80:83], v[104:107], v[56:59], v[80:83]
    v_mfma_f32_16x16x32_bf16 v[84:87], v[104:107], v[60:63], v[84:87]
    ds_read_b128 v[104:107], v126 offset:2048
    v_mfma_f32_16x16x32_bf16 v[88:91], v[108:111], v[56:59], v[88:91]
    v_mfma_f32_16x16x32_bf16 v[92:95], v[108:111], v[60:63], v[92:95]
    ds_read_b128 v[108:111], v126 offset:3072
    s_sub_u32 s22, s22, 1
    s_cmp_eq_u32 s22, 0
    s_cbranch_scc1 L_joint_kernel_oend
    s_waitcnt lgkmcnt(3)
    v_mfma_f32_16x16x32_bf16 v[64:67], v[96:99], v[0:3], 0
    v_mfma_f32_16x16x32_bf16 v[68:71], v[96:99], v[4:7], 0
    ds_read_b128 v[96:99], v126 offset:4096
    s_waitcnt lgkmcnt(3)
    v_mfma_f32_16x16x32_bf16 v[72:75], v[100:103], v[0:3], 0
    v_mfma_f32_16x16x32_bf16 v[76:79], v[100:103], v[4:7], 0
    ds_read_b128 v[100:103], v126 offset:5120
    s_waitcnt lgkmcnt(3)
    v_mfma_f32_16x16x32_bf16 v[64:67], v[104:107], v[8:11], v[64:67]
    v_mfma_f32_16x16x32_bf16 v[68:71], v[104:107], v[12:15], v[68:71]
    ds_read_b128 v[104:107], v126 offset:6144
    s_waitcnt lgkmcnt(3)
    v_mfma_f32_16x16x32_bf16 v[72:75], v[108:111], v[8:11], v[72:75]
    v_cvt_pk_bf16_f32 v112, v80, v84
    v_mfma_f32_16x16x32_bf16 v[76:79], v[108:111], v[12:15], v[76:79]
    buffer_store_dword v112, v125, s[16:19], 0 offen offset:0 nt
    ds_read_b128 v[108:111], v126 offset:7168
    s_waitcnt lgkmcnt(3)
    v_mfma_f32_16x16x32_bf16 v[64:67], v[96:99], v[16:19], v[64:67]
    v_cvt_pk_bf16_f32 v113, v81, v85
    v_mfma_f32_16x16x32_bf16 v[68:71], v[96:99], v[20:23], v[68:71]
    buffer_store_dword v113, v125, s[16:19], 0 offen offset:512 nt
    ds_read_b128 v[96:99], v126 offset:8192
    s_waitcnt lgkmcnt(3)
    v_mfma_f32_16x16x32_bf16 v[72:75], v[100:103], v[16:19], v[72:75]
    v_cvt_pk_bf16_f32 v114, v82, v86
    v_mfma_f32_16x16x32_bf16 v[76:79], v[100:103], v[20:23], v[76:79]
    buffer_store_dword v114, v125, s[16:19], 0 offen offset:1024 nt
    ds_read_b128 v[100:103], v126 offset:9216
    s_waitcnt lgkmcnt(3)
    v_mfma_f32_16x16x32_bf16 v[64:67], v[104:107], v[24:27], v[64:67]
    v_cvt_pk_bf16_f32 v115, v83, v87
    v_mfma_f32_16x16x32_bf16 v[68:71], v[104:107], v[28:31], v[68:71]
    buffer_store_dword v115, v125, s[16:19], 0 offen offset:1536 nt
    ds_read_b128 v[104:107], v126 offset:10240
    s_waitcnt lgkmcnt(3)
    v_mfma_f32_16x16x32_bf16 v[72:75], v[108:111], v[24:27], v[72:75]
    v_cvt_pk_bf16_f32 v116, v88, v92
    v_mfma_f32_16x16x32_bf16 v[76:79], v[108:111], v[28:31], v[76:79]
    buffer_store_dword v116, v125, s[16:19], s44 offen offset:0 nt
    ds_read_b128 v[108:111], v126 offset:11264
    s_waitcnt lgkmcnt(3)
    v_mfma_f32_16x16x32_bf16 v[64:67], v[96:99], v[32:35], v[64:67]
    v_cvt_pk_bf16_f32 v117, v89, v93
    v_mfma_f32_16x16x32_bf16 v[68:71], v[96:99], v[36:39], v[68:71]
    buffer_store_dword v117, v125, s[16:19], s44 offen offset:512 nt
    ds_read_b128 v[96:99], v126 offset:12288
    s_waitcnt lgkmcnt(3)
    v_mfma_f32_16x16x32_bf16 v[72:75], v[100:103], v[32:35], v[72:75]
    v_cvt_pk_bf16_f32 v118, v90, v94
    v_mfma_f32_16x16x32_bf16 v[76:79], v[100:103], v[36:39], v[76:79]
    buffer_store_dword v118, v125, s[16:19], s44 offen offset:1024 nt
    ds_read_b128 v[100:103], v126 offset:13312
    s_waitcnt lgkmcnt(3)
    v_mfma_f32_16x16x32_bf16 v[64:67], v[104:107], v[40:43], v[64:67]
    v_cvt_pk_bf16_f32 v119, v91, v95
    v_mfma_f32_16x16x32_bf16 v[68:71], v[104:107], v[44:47], v[68:71]
    buffer_store_dword v119, v125, s[16:19], s44 offen offset:1536 nt
    ds_read_b128 v[104:107], v126 offset:14336
    s_waitcnt lgkmcnt(3)
    v_mfma_f32_16x16x32_bf16 v[72:75], v[108:111], v[40:43], v[72:75]
    v_add_u32 v125, 16384, v125
    v_mfma_f32_16x16x32_bf16 v[76:79], v[108:111], v[44:47], v[76:79]
    ds_read_b128 v[108:111], v126 offset:15360
    s_waitcnt lgkmcnt(3)
    v_mfma_f32_16x16x32_bf16 v[64:67], v[96:99], v[48:51], v[64:67]
    v_mfma_f32_16x16x32_bf16 v[68:71], v[96:99], v[52:55], v[68:71]
    s_waitcnt lgkmcnt(0)
    s_barrier
    ds_read_b128 v[96:99], v126 offset:16384
    v_mfma_f32_16x16x32_bf16 v[72:75], v[100:103], v[48:51], v[72:75]
    v_mfma_f32_16x16x32_bf16 v[76:79], v[100:103], v[52:55], v[76:79]
    ds_read_b128 v[100:103], v126 offset:17408
    v_mfma_f32_16x16x32_bf16 v[64:67], v[104:107], v[56:59], v[64:67]
    v_mfma_f32_16x16x32_bf16 v[68:71], v[104:107], v[60:63], v[68:71]
    ds_read_b128 v[104:107], v126 offset:18432
    v_mfma_f32_16x16x32_bf16 v[72:75], v[108:111], v[56:59], v[72:75]
    v_mfma_f32_16x16x32_bf16 v[76:79], v[108:111], v[60:63], v[76:79]
    ds_read_b128 v[108:111], v126 offset:19456
    s_waitcnt vmcnt(32)
    s_branch L_joint_kernel_oloop
L_joint_kernel_oend:
    s_nop 7
    v_cvt_pk_bf16_f32 v112, v80, v84
    buffer_store_dword v112, v125, s[16:19], 0 offen offset:0 nt
    v_cvt_pk_bf16_f32 v113, v81, v85
    buffer_store_dword v113, v125, s[16:19], 0 offen offset:512 nt
    v_cvt_pk_bf16_f32 v114, v82, v86
    buffer_store_dword v114, v125, s[16:19], 0 offen offset:1024 nt
    v_cvt_pk_bf16_f32 v115, v83, v87
    buffer_store_dword v115, v125, s[16:19], 0 offen offset:1536 nt
    v_cvt_pk_bf16_f32 v116, v88, v92
    buffer_store_dword v116, v125, s[16:19], s44 offen offset:0 nt
    v_cvt_pk_bf16_f32 v117, v89, v93
    buffer_store_dword v117, v125, s[16:19], s44 offen offset:512 nt
    v_cvt_pk_bf16_f32 v118, v90, v94
    buffer_store_dword v118, v125, s[16:19], s44 offen offset:1024 nt
    v_cvt_pk_bf16_f32 v119, v91, v95
    buffer_store_dword v119, v125, s[16:19], s44 offen offset:1536 nt
    v_add_u32 v125, 16384, v125
    s_branch L_joint_kernel_fin
L_joint_kernel_T:
    s_setprio 3
    s_waitcnt lgkmcnt(0)
    s_add_u32 s12, s30, s33
    s_addc_u32 s13, s31, 0
    s_add_u32 s40, s30, s34
    s_addc_u32 s41, s31, 0
    s_lshl_b32 s36, s21, 2
    s_add_u32 s36, s36, 44335104
    s_add_u32 s36, s30, s36
    s_addc_u32 s37, s31, 0
    s_load_dword s44, s[36:37], 0
    v_and_b32 v123, 15, v127
    v_lshrrev_b32 v121, 4, v127
    v_mul_u32_u24 v125, 528, v123
    v_lshl_add_u32 v125, v121, 4, v125
    v_lshlrev_b32 v121, 5, v121
    v_and_b32 v120, 7, v127
    v_lshl_add_u32 v124, v120, 10, v121
    s_lshl_b32 s38, s21, 7
    v_mul_u32_u24 v120, 1040, v120
    s_add_u32 s36, s38, 91136
    v_add3_u32 v120, v120, v121, s36
    s_mul_i32 s36, s21, 5184
    s_add_u32 s36, s36, 49664
    v_add_u32 v121, s36, v121
    v_mul_u32_u24 v122, 144, v123
    v_add_u32 v122, v122, v121
    v_lshrrev_b32 v123, 3, v123
    v_mul_u32_u24 v123, 144, v123
    v_add_u32 v121, v123, v121
    s_lshl_b32 s36, s21, 11
    v_add_u32 v123, s36, v126
    s_barrier
    s_mov_b32 s36, 0
    buffer_load_dwordx4 v[0:3], v126, s[12:15], s36 offen offset:0
    buffer_load_dwordx4 v[4:7], v126, s[12:15], s36 offen offset:1024
    buffer_load_dwordx4 v[8:11], v126, s[12:15], s36 offen offset:2048
    buffer_load_dwordx4 v[12:15], v126, s[12:15], s36 offen offset:3072
    s_mov_b32 s36, 4096
    buffer_load_dwordx4 v[16:19], v126, s[12:15], s36 offen offset:0
    buffer_load_dwordx4 v[20:23], v126, s[12:15], s36 offen offset:1024
    buffer_load_dwordx4 v[24:27], v126, s[12:15], s36 offen offset:2048
    buffer_load_dwordx4 v[28:31], v126, s[12:15], s36 offen offset:3072
    s_mov_b32 s36, 8192
    buffer_load_dwordx4 v[32:35], v126, s[12:15], s36 offen offset:0
    buffer_load_dwordx4 v[36:39], v126, s[12:15], s36 offen offset:1024
    buffer_load_dwordx4 v[40:43], v126, s[12:15], s36 offen offset:2048
    buffer_load_dwordx4 v[44:47], v126, s[12:15], s36 offen offset:3072
    s_mov_b32 s36, 12288
    buffer_load_dwordx4 v[48:51], v126, s[12:15], s36 offen offset:0
    buffer_load_dwordx4 v[52:55], v126, s[12:15], s36 offen offset:1024
    buffer_load_dwordx4 v[56:59], v126, s[12:15], s36 offen offset:2048
    buffer_load_dwordx4 v[60:63], v126, s[12:15], s36 offen offset:3072
    v_mov_b32 v64, 99456
    v_mov_b32 v65, 1
    s_mov_b64 exec, 1
    ds_add_u32 v64, v65 offset:4
    s_mov_b64 exec, -1
L_joint_kernel_tw:
    ds_read_b32 v65, v64 offset:0
    s_waitcnt lgkmcnt(0)
    v_readfirstlane_b32 s37, v65
    s_cmp_ge_u32 s37, 8
    s_cbranch_scc1 L_joint_kernel_tw_d
    s_sleep 1
    s_branch L_joint_kernel_tw
L_joint_kernel_tw_d:
    ds_read_b128 v[80:83], v125 offset:32768
    ds_read_b128 v[84:87], v125 offset:41216
    ds_read_b128 v[88:91], v125 offset:32832
    ds_read_b128 v[92:95], v125 offset:41280
    ds_read_b128 v[96:99], v125 offset:32896
    ds_read_b128 v[100:103], v125 offset:41344
    ds_read_b128 v[104:107], v125 offset:32960
    ds_read_b128 v[108:111], v125 offset:41408
    s_setprio 0
    s_waitcnt vmcnt(14) lgkmcnt(7)
    v_mfma_f32_16x16x32_bf16 v[64:67], v[0:3], v[80:83], 0
    v_mfma_f32_16x16x32_bf16 v[68:71], v[4:7], v[80:83], 0
    ds_read_b128 v[80:83], v125 offset:33024
    s_waitcnt lgkmcnt(7)
    v_mfma_f32_16x16x32_bf16 v[72:75], v[0:3], v[84:87], 0
    v_mfma_f32_16x16x32_bf16 v[76:79], v[4:7], v[84:87], 0
    ds_read_b128 v[84:87], v125 offset:41472
    s_waitcnt vmcnt(12) lgkmcnt(7)
    v_mfma_f32_16x16x32_bf16 v[64:67], v[8:11], v[88:91], v[64:67]
    v_mfma_f32_16x16x32_bf16 v[68:71], v[12:15], v[88:91], v[68:71]
    ds_read_b128 v[88:91], v125 offset:33088
    s_waitcnt lgkmcnt(7)
    v_mfma_f32_16x16x32_bf16 v[72:75], v[8:11], v[92:95], v[72:75]
    v_mfma_f32_16x16x32_bf16 v[76:79], v[12:15], v[92:95], v[76:79]
    ds_read_b128 v[92:95], v125 offset:41536
    s_waitcnt vmcnt(10) lgkmcnt(7)
    v_mfma_f32_16x16x32_bf16 v[64:67], v[16:19], v[96:99], v[64:67]
    v_mfma_f32_16x16x32_bf16 v[68:71], v[20:23], v[96:99], v[68:71]
    ds_read_b128 v[96:99], v125 offset:33152
    s_waitcnt lgkmcnt(7)
    v_mfma_f32_16x16x32_bf16 v[72:75], v[16:19], v[100:103], v[72:75]
    v_mfma_f32_16x16x32_bf16 v[76:79], v[20:23], v[100:103], v[76:79]
    ds_read_b128 v[100:103], v125 offset:41600
    s_waitcnt vmcnt(8) lgkmcnt(7)
    v_mfma_f32_16x16x32_bf16 v[64:67], v[24:27], v[104:107], v[64:67]
    v_mfma_f32_16x16x32_bf16 v[68:71], v[28:31], v[104:107], v[68:71]
    ds_read_b128 v[104:107], v125 offset:33216
    s_waitcnt lgkmcnt(7)
    v_mfma_f32_16x16x32_bf16 v[72:75], v[24:27], v[108:111], v[72:75]
    v_mfma_f32_16x16x32_bf16 v[76:79], v[28:31], v[108:111], v[76:79]
    ds_read_b128 v[108:111], v125 offset:41664
    s_waitcnt vmcnt(6) lgkmcnt(7)
    v_mfma_f32_16x16x32_bf16 v[64:67], v[32:35], v[80:83], v[64:67]
    v_mfma_f32_16x16x32_bf16 v[68:71], v[36:39], v[80:83], v[68:71]
    ds_read_b128 v[112:115], v120 offset:0
    s_waitcnt lgkmcnt(7)
    v_mfma_f32_16x16x32_bf16 v[72:75], v[32:35], v[84:87], v[72:75]
    v_mfma_f32_16x16x32_bf16 v[76:79], v[36:39], v[84:87], v[76:79]
    ds_read_b128 v[116:119], v120 offset:16
    s_waitcnt vmcnt(4) lgkmcnt(7)
    v_mfma_f32_16x16x32_bf16 v[64:67], v[40:43], v[88:91], v[64:67]
    v_mfma_f32_16x16x32_bf16 v[68:71], v[44:47], v[88:91], v[68:71]
    s_waitcnt lgkmcnt(6)
    v_mfma_f32_16x16x32_bf16 v[72:75], v[40:43], v[92:95], v[72:75]
    v_mfma_f32_16x16x32_bf16 v[76:79], v[44:47], v[92:95], v[76:79]
    s_waitcnt vmcnt(2) lgkmcnt(5)
    v_mfma_f32_16x16x32_bf16 v[64:67], v[48:51], v[96:99], v[64:67]
    v_mfma_f32_16x16x32_bf16 v[68:71], v[52:55], v[96:99], v[68:71]
    s_waitcnt lgkmcnt(4)
    v_mfma_f32_16x16x32_bf16 v[72:75], v[48:51], v[100:103], v[72:75]
    v_mfma_f32_16x16x32_bf16 v[76:79], v[52:55], v[100:103], v[76:79]
    s_waitcnt vmcnt(0) lgkmcnt(3)
    v_mfma_f32_16x16x32_bf16 v[64:67], v[56:59], v[104:107], v[64:67]
    v_mfma_f32_16x16x32_bf16 v[68:71], v[60:63], v[104:107], v[68:71]
    s_waitcnt lgkmcnt(2)
    v_mfma_f32_16x16x32_bf16 v[72:75], v[56:59], v[108:111], v[72:75]
    v_mfma_f32_16x16x32_bf16 v[76:79], v[60:63], v[108:111], v[76:79]
    s_mov_b32 s46, 0xffff0000
    s_mov_b32 s48, 0x4038aa3b
    s_mov_b32 s49, s48
    s_nop 3
    v_mov_b32 v28, 0
    s_waitcnt lgkmcnt(0)
    v_cvt_pk_bf16_f32 v24, v64, v68
    v_cvt_pk_bf16_f32 v25, v65, v69
    v_cvt_pk_bf16_f32 v26, v66, v70
    v_cvt_pk_bf16_f32 v27, v67, v71
    v_lshlrev_b32 v80, 16, v24
    v_and_b32 v81, s46, v24
    v_lshlrev_b32 v82, 16, v25
    v_and_b32 v83, s46, v25
    v_lshlrev_b32 v84, 16, v26
    v_and_b32 v85, s46, v26
    v_lshlrev_b32 v86, 16, v27
    v_and_b32 v87, s46, v27
    v_pk_mul_f32 v[80:81], v[80:81], s[48:49]
    v_pk_mul_f32 v[82:83], v[82:83], s[48:49]
    v_pk_mul_f32 v[84:85], v[84:85], s[48:49]
    v_pk_mul_f32 v[86:87], v[86:87], s[48:49]
    v_exp_f32 v96, v80
    v_exp_f32 v97, v81
    v_exp_f32 v98, v82
    v_exp_f32 v99, v83
    v_max3_f32 v28, |v80|, |v81|, v28
    v_max3_f32 v28, |v82|, |v83|, v28
    ds_write_b128 v122, v[96:99] offset:0
    v_exp_f32 v100, v84
    v_exp_f32 v101, v85
    v_exp_f32 v102, v86
    v_exp_f32 v103, v87
    v_max3_f32 v28, |v84|, |v85|, v28
    v_max3_f32 v28, |v86|, |v87|, v28
    ds_write_b128 v122, v[100:103] offset:16
    v_cvt_pk_bf16_f32 v24, v72, v76
    v_cvt_pk_bf16_f32 v25, v73, v77
    v_cvt_pk_bf16_f32 v26, v74, v78
    v_cvt_pk_bf16_f32 v27, v75, v79
    v_lshlrev_b32 v88, 16, v24
    v_and_b32 v89, s46, v24
    v_lshlrev_b32 v90, 16, v25
    v_and_b32 v91, s46, v25
    v_lshlrev_b32 v92, 16, v26
    v_and_b32 v93, s46, v26
    v_lshlrev_b32 v94, 16, v27
    v_and_b32 v95, s46, v27
    v_pk_mul_f32 v[88:89], v[88:89], s[48:49]
    v_pk_mul_f32 v[90:91], v[90:91], s[48:49]
    v_pk_mul_f32 v[92:93], v[92:93], s[48:49]
    v_pk_mul_f32 v[94:95], v[94:95], s[48:49]
    v_exp_f32 v104, v88
    v_exp_f32 v105, v89
    v_exp_f32 v106, v90
    v_exp_f32 v107, v91
    v_max3_f32 v28, |v88|, |v89|, v28
    v_max3_f32 v28, |v90|, |v91|, v28
    ds_write_b128 v122, v[104:107] offset:2304
    v_exp_f32 v108, v92
    v_exp_f32 v109, v93
    v_exp_f32 v110, v94
    v_exp_f32 v111, v95
    v_max3_f32 v28, |v92|, |v93|, v28
    v_max3_f32 v28, |v94|, |v95|, v28
    ds_write_b128 v122, v[108:111] offset:2320
    v_cmp_lt_f32 vcc, 0x42f00000, v28
    s_mov_b32 s22, 4
    s_or_b32 s44, s44, vcc_lo
    s_or_b32 s44, s44, vcc_hi
    s_cmp_lg_u32 s44, 0
    s_cbranch_scc1 L_joint_kernel_tslow
    ds_read_b128 v[32:35], v121 offset:0
    ds_read_b128 v[36:39], v121 offset:16
    ds_read_b128 v[40:43], v121 offset:288
    ds_read_b128 v[44:47], v121 offset:304
    v_add_u32 v121, 576, v121
    s_waitcnt vmcnt(0) lgkmcnt(0)
L_joint_kernel_tloop1:
    v_fma_f32 v48, v112, v32, 1.0
    v_fma_f32 v49, v113, v33, 1.0
    v_fma_f32 v50, v114, v34, 1.0
    v_fma_f32 v51, v115, v35, 1.0
    v_fma_f32 v52, v116, v36, 1.0
    v_fma_f32 v53, v117, v37, 1.0
    v_fma_f32 v54, v118, v38, 1.0
    v_fma_f32 v55, v119, v39, 1.0
    v_fma_f32 v56, v112, v40, 1.0
    v_fma_f32 v57, v113, v41, 1.0
    v_fma_f32 v58, v114, v42, 1.0
    v_fma_f32 v59, v115, v43, 1.0
    v_fma_f32 v60, v116, v44, 1.0
    v_fma_f32 v61, v117, v45, 1.0
    v_fma_f32 v62, v118, v46, 1.0
    v_fma_f32 v63, v119, v47, 1.0
    ds_read_b128 v[32:35], v121 offset:0
    ds_read_b128 v[36:39], v121 offset:16
    ds_read_b128 v[40:43], v121 offset:288
    ds_read_b128 v[44:47], v121 offset:304
    v_add_u32 v121, 576, v121
    v_rcp_f32 v48, v48
    v_rcp_f32 v49, v49
    v_rcp_f32 v50, v50
    v_rcp_f32 v51, v51
    v_rcp_f32 v52, v52
    v_rcp_f32 v53, v53
    v_rcp_f32 v54, v54
    v_rcp_f32 v55, v55
    v_fma_f32 v48, v48, -2.0, 1.0
    v_fma_f32 v49, v49, -2.0, 1.0
    v_fma_f32 v50, v50, -2.0, 1.0
    v_fma_f32 v51, v51, -2.0, 1.0
    v_fma_f32 v52, v52, -2.0, 1.0
    v_fma_f32 v53, v53, -2.0, 1.0
    v_fma_f32 v54, v54, -2.0, 1.0
    v_fma_f32 v55, v55, -2.0, 1.0
    v_cvt_pk_bf16_f32 v64, v48, v49
    v_cvt_pk_bf16_f32 v65, v50, v51
    v_cvt_pk_bf16_f32 v66, v52, v53
    v_cvt_pk_bf16_f32 v67, v54, v55
    ds_write_b128 v123, v[64:67] offset:0
    v_rcp_f32 v56, v56
    v_rcp_f32 v57, v57
    v_rcp_f32 v58, v58
    v_rcp_f32 v59, v59
    v_rcp_f32 v60, v60
    v_rcp_f32 v61, v61
    v_rcp_f32 v62, v62
    v_rcp_f32 v63, v63
    v_fma_f32 v56, v56, -2.0, 1.0
    v_fma_f32 v57, v57, -2.0, 1.0
    v_fma_f32 v58, v58, -2.0, 1.0
    v_fma_f32 v59, v59, -2.0, 1.0
    v_fma_f32 v60, v60, -2.0, 1.0
    v_fma_f32 v61, v61, -2.0, 1.0
    v_fma_f32 v62, v62, -2.0, 1.0
    v_fma_f32 v63, v63, -2.0, 1.0
    v_cvt_pk_bf16_f32 v68, v56, v57
    v_cvt_pk_bf16_f32 v69, v58, v59
    v_cvt_pk_bf16_f32 v70, v60, v61
    v_cvt_pk_bf16_f32 v71, v62, v63
    ds_write_b128 v123, v[68:71] offset:1024
    s_waitcnt lgkmcnt(0)
    s_barrier
    v_fma_f32 v48, v112, v32, 1.0
    v_fma_f32 v49, v113, v33, 1.0
    v_fma_f32 v50, v114, v34, 1.0
    v_fma_f32 v51, v115, v35, 1.0
    v_fma_f32 v52, v116, v36, 1.0
    v_fma_f32 v53, v117, v37, 1.0
    v_fma_f32 v54, v118, v38, 1.0
    v_fma_f32 v55, v119, v39, 1.0
    v_fma_f32 v56, v112, v40, 1.0
    v_fma_f32 v57, v113, v41, 1.0
    v_fma_f32 v58, v114, v42, 1.0
    v_fma_f32 v59, v115, v43, 1.0
    v_fma_f32 v60, v116, v44, 1.0
    v_fma_f32 v61, v117, v45, 1.0
    v_fma_f32 v62, v118, v46, 1.0
    v_fma_f32 v63, v119, v47, 1.0
    ds_read_b128 v[32:35], v121 offset:0
    ds_read_b128 v[36:39], v121 offset:16
    ds_read_b128 v[40:43], v121 offset:288
    ds_read_b128 v[44:47], v121 offset:304
    v_add_u32 v121, 576, v121
    v_rcp_f32 v48, v48
    v_rcp_f32 v49, v49
    v_rcp_f32 v50, v50
    v_rcp_f32 v51, v51
    v_rcp_f32 v52, v52
    v_rcp_f32 v53, v53
    v_rcp_f32 v54, v54
    v_rcp_f32 v55, v55
    v_fma_f32 v48, v48, -2.0, 1.0
    v_fma_f32 v49, v49, -2.0, 1.0
    v_fma_f32 v50, v50, -2.0, 1.0
    v_fma_f32 v51, v51, -2.0, 1.0
    v_fma_f32 v52, v52, -2.0, 1.0
    v_fma_f32 v53, v53, -2.0, 1.0
    v_fma_f32 v54, v54, -2.0, 1.0
    v_fma_f32 v55, v55, -2.0, 1.0
    v_cvt_pk_bf16_f32 v64, v48, v49
    v_cvt_pk_bf16_f32 v65, v50, v51
    v_cvt_pk_bf16_f32 v66, v52, v53
    v_cvt_pk_bf16_f32 v67, v54, v55
    ds_write_b128 v123, v[64:67] offset:16384
    v_rcp_f32 v56, v56
    v_rcp_f32 v57, v57
    v_rcp_f32 v58, v58
    v_rcp_f32 v59, v59
    v_rcp_f32 v60, v60
    v_rcp_f32 v61, v61
    v_rcp_f32 v62, v62
    v_rcp_f32 v63, v63
    v_fma_f32 v56, v56, -2.0, 1.0
    v_fma_f32 v57, v57, -2.0, 1.0
    v_fma_f32 v58, v58, -2.0, 1.0
    v_fma_f32 v59, v59, -2.0, 1.0
    v_fma_f32 v60, v60, -2.0, 1.0
    v_fma_f32 v61, v61, -2.0, 1.0
    v_fma_f32 v62, v62, -2.0, 1.0
    v_fma_f32 v63, v63, -2.0, 1.0
    v_cvt_pk_bf16_f32 v68, v56, v57
    v_cvt_pk_bf16_f32 v69, v58, v59
    v_cvt_pk_bf16_f32 v70, v60, v61
    v_cvt_pk_bf16_f32 v71, v62, v63
    ds_write_b128 v123, v[68:71] offset:17408
    s_waitcnt lgkmcnt(0)
    s_barrier
    s_sub_u32 s22, s22, 1
    s_cmp_lg_u32 s22, 0
    s_cbranch_scc1 L_joint_kernel_tloop1
    s_branch L_joint_kernel_fin
L_joint_kernel_tslow:
    buffer_load_dwordx4 v[112:115], v124, s[40:43], s38 offen offset:0
    buffer_load_dwordx4 v[116:119], v124, s[40:43], s38 offen offset:16
    ds_write_b128 v122, v[80:83] offset:0
    ds_write_b128 v122, v[84:87] offset:16
    ds_write_b128 v122, v[88:91] offset:2304
    ds_write_b128 v122, v[92:95] offset:2320
    ds_read_b128 v[32:35], v121 offset:0
    ds_read_b128 v[36:39], v121 offset:16
    ds_read_b128 v[40:43], v121 offset:288
    ds_read_b128 v[44:47], v121 offset:304
    v_add_u32 v121, 576, v121
    s_waitcnt vmcnt(0) lgkmcnt(0)
L_joint_kernel_tloop0:
    v_add_f32 v48, v112, v32
    v_add_f32 v49, v113, v33
    v_add_f32 v50, v114, v34
    v_add_f32 v51, v115, v35
    v_add_f32 v52, v116, v36
    v_add_f32 v53, v117, v37
    v_add_f32 v54, v118, v38
    v_add_f32 v55, v119, v39
    v_add_f32 v56, v112, v40
    v_add_f32 v57, v113, v41
    v_add_f32 v58, v114, v42
    v_add_f32 v59, v115, v43
    v_add_f32 v60, v116, v44
    v_add_f32 v61, v117, v45
    v_add_f32 v62, v118, v46
    v_add_f32 v63, v119, v47
    ds_read_b128 v[32:35], v121 offset:0
    ds_read_b128 v[36:39], v121 offset:16
    ds_read_b128 v[40:43], v121 offset:288
    ds_read_b128 v[44:47], v121 offset:304
    v_add_u32 v121, 576, v121
    v_exp_f32 v48, v48
    v_exp_f32 v49, v49
    v_exp_f32 v50, v50
    v_exp_f32 v51, v51
    v_exp_f32 v52, v52
    v_exp_f32 v53, v53
    v_exp_f32 v54, v54
    v_exp_f32 v55, v55
    v_add_f32 v48, 1.0, v48
    v_add_f32 v49, 1.0, v49
    v_add_f32 v50, 1.0, v50
    v_add_f32 v51, 1.0, v51
    v_add_f32 v52, 1.0, v52
    v_add_f32 v53, 1.0, v53
    v_add_f32 v54, 1.0, v54
    v_add_f32 v55, 1.0, v55
    v_rcp_f32 v48, v48
    v_rcp_f32 v49, v49
    v_rcp_f32 v50, v50
    v_rcp_f32 v51, v51
    v_rcp_f32 v52, v52
    v_rcp_f32 v53, v53
    v_rcp_f32 v54, v54
    v_rcp_f32 v55, v55
    v_fma_f32 v48, v48, -2.0, 1.0
    v_fma_f32 v49, v49, -2.0, 1.0
    v_fma_f32 v50, v50, -2.0, 1.0
    v_fma_f32 v51, v51, -2.0, 1.0
    v_fma_f32 v52, v52, -2.0, 1.0
    v_fma_f32 v53, v53, -2.0, 1.0
    v_fma_f32 v54, v54, -2.0, 1.0
    v_fma_f32 v55, v55, -2.0, 1.0
    v_cvt_pk_bf16_f32 v64, v48, v49
    v_cvt_pk_bf16_f32 v65, v50, v51
    v_cvt_pk_bf16_f32 v66, v52, v53
    v_cvt_pk_bf16_f32 v67, v54, v55
    ds_write_b128 v123, v[64:67] offset:0
    v_exp_f32 v56, v56
    v_exp_f32 v57, v57
    v_exp_f32 v58, v58
    v_exp_f32 v59, v59
    v_exp_f32 v60, v60
    v_exp_f32 v61, v61
    v_exp_f32 v62, v62
    v_exp_f32 v63, v63
    v_add_f32 v56, 1.0, v56
    v_add_f32 v57, 1.0, v57
    v_add_f32 v58, 1.0, v58
    v_add_f32 v59, 1.0, v59
    v_add_f32 v60, 1.0, v60
    v_add_f32 v61, 1.0, v61
    v_add_f32 v62, 1.0, v62
    v_add_f32 v63, 1.0, v63
    v_rcp_f32 v56, v56
    v_rcp_f32 v57, v57
    v_rcp_f32 v58, v58
    v_rcp_f32 v59, v59
    v_rcp_f32 v60, v60
    v_rcp_f32 v61, v61
    v_rcp_f32 v62, v62
    v_rcp_f32 v63, v63
    v_fma_f32 v56, v56, -2.0, 1.0
    v_fma_f32 v57, v57, -2.0, 1.0
    v_fma_f32 v58, v58, -2.0, 1.0
    v_fma_f32 v59, v59, -2.0, 1.0
    v_fma_f32 v60, v60, -2.0, 1.0
    v_fma_f32 v61, v61, -2.0, 1.0
    v_fma_f32 v62, v62, -2.0, 1.0
    v_fma_f32 v63, v63, -2.0, 1.0
    v_cvt_pk_bf16_f32 v68, v56, v57
    v_cvt_pk_bf16_f32 v69, v58, v59
    v_cvt_pk_bf16_f32 v70, v60, v61
    v_cvt_pk_bf16_f32 v71, v62, v63
    ds_write_b128 v123, v[68:71] offset:1024
    s_waitcnt lgkmcnt(0)
    s_barrier
    v_add_f32 v48, v112, v32
    v_add_f32 v49, v113, v33
    v_add_f32 v50, v114, v34
    v_add_f32 v51, v115, v35
    v_add_f32 v52, v116, v36
    v_add_f32 v53, v117, v37
    v_add_f32 v54, v118, v38
    v_add_f32 v55, v119, v39
    v_add_f32 v56, v112, v40
    v_add_f32 v57, v113, v41
    v_add_f32 v58, v114, v42
    v_add_f32 v59, v115, v43
    v_add_f32 v60, v116, v44
    v_add_f32 v61, v117, v45
    v_add_f32 v62, v118, v46
    v_add_f32 v63, v119, v47
    ds_read_b128 v[32:35], v121 offset:0
    ds_read_b128 v[36:39], v121 offset:16
    ds_read_b128 v[40:43], v121 offset:288
    ds_read_b128 v[44:47], v121 offset:304
    v_add_u32 v121, 576, v121
    v_exp_f32 v48, v48
    v_exp_f32 v49, v49
    v_exp_f32 v50, v50
    v_exp_f32 v51, v51
    v_exp_f32 v52, v52
    v_exp_f32 v53, v53
    v_exp_f32 v54, v54
    v_exp_f32 v55, v55
    v_add_f32 v48, 1.0, v48
    v_add_f32 v49, 1.0, v49
    v_add_f32 v50, 1.0, v50
    v_add_f32 v51, 1.0, v51
    v_add_f32 v52, 1.0, v52
    v_add_f32 v53, 1.0, v53
    v_add_f32 v54, 1.0, v54
    v_add_f32 v55, 1.0, v55
    v_rcp_f32 v48, v48
    v_rcp_f32 v49, v49
    v_rcp_f32 v50, v50
    v_rcp_f32 v51, v51
    v_rcp_f32 v52, v52
    v_rcp_f32 v53, v53
    v_rcp_f32 v54, v54
    v_rcp_f32 v55, v55
    v_fma_f32 v48, v48, -2.0, 1.0
    v_fma_f32 v49, v49, -2.0, 1.0
    v_fma_f32 v50, v50, -2.0, 1.0
    v_fma_f32 v51, v51, -2.0, 1.0
    v_fma_f32 v52, v52, -2.0, 1.0
    v_fma_f32 v53, v53, -2.0, 1.0
    v_fma_f32 v54, v54, -2.0, 1.0
    v_fma_f32 v55, v55, -2.0, 1.0
    v_cvt_pk_bf16_f32 v64, v48, v49
    v_cvt_pk_bf16_f32 v65, v50, v51
    v_cvt_pk_bf16_f32 v66, v52, v53
    v_cvt_pk_bf16_f32 v67, v54, v55
    ds_write_b128 v123, v[64:67] offset:16384
    v_exp_f32 v56, v56
    v_exp_f32 v57, v57
    v_exp_f32 v58, v58
    v_exp_f32 v59, v59
    v_exp_f32 v60, v60
    v_exp_f32 v61, v61
    v_exp_f32 v62, v62
    v_exp_f32 v63, v63
    v_add_f32 v56, 1.0, v56
    v_add_f32 v57, 1.0, v57
    v_add_f32 v58, 1.0, v58
    v_add_f32 v59, 1.0, v59
    v_add_f32 v60, 1.0, v60
    v_add_f32 v61, 1.0, v61
    v_add_f32 v62, 1.0, v62
    v_add_f32 v63, 1.0, v63
    v_rcp_f32 v56, v56
    v_rcp_f32 v57, v57
    v_rcp_f32 v58, v58
    v_rcp_f32 v59, v59
    v_rcp_f32 v60, v60
    v_rcp_f32 v61, v61
    v_rcp_f32 v62, v62
    v_rcp_f32 v63, v63
    v_fma_f32 v56, v56, -2.0, 1.0
    v_fma_f32 v57, v57, -2.0, 1.0
    v_fma_f32 v58, v58, -2.0, 1.0
    v_fma_f32 v59, v59, -2.0, 1.0
    v_fma_f32 v60, v60, -2.0, 1.0
    v_fma_f32 v61, v61, -2.0, 1.0
    v_fma_f32 v62, v62, -2.0, 1.0
    v_fma_f32 v63, v63, -2.0, 1.0
    v_cvt_pk_bf16_f32 v68, v56, v57
    v_cvt_pk_bf16_f32 v69, v58, v59
    v_cvt_pk_bf16_f32 v70, v60, v61
    v_cvt_pk_bf16_f32 v71, v62, v63
    ds_write_b128 v123, v[68:71] offset:17408
    s_waitcnt lgkmcnt(0)
    s_barrier
    s_sub_u32 s22, s22, 1
    s_cmp_lg_u32 s22, 0
    s_cbranch_scc1 L_joint_kernel_tloop0
L_joint_kernel_fin:
L_joint_kernel_done:
    s_endpgm
.section .rodata,"a"
.p2align 6
.amdhsa_kernel prep_kernel
  .amdhsa_next_free_vgpr 128
  .amdhsa_next_free_sgpr 102
  .amdhsa_accum_offset 128
  .amdhsa_group_segment_fixed_size 0
  .amdhsa_kernarg_size 80
  .amdhsa_user_sgpr_count 2
  .amdhsa_user_sgpr_kernarg_segment_ptr 1
  .amdhsa_system_sgpr_workgroup_id_x 1
.end_amdhsa_kernel
.p2align 6
.amdhsa_kernel conv1_kernel
  .amdhsa_next_free_vgpr 128
  .amdhsa_next_free_sgpr 102
  .amdhsa_accum_offset 128
  .amdhsa_group_segment_fixed_size 0
  .amdhsa_kernarg_size 80
  .amdhsa_user_sgpr_count 2
  .amdhsa_user_sgpr_kernarg_segment_ptr 1
  .amdhsa_system_sgpr_workgroup_id_x 1
.end_amdhsa_kernel
.p2align 6
.amdhsa_kernel conv2_kernel
  .amdhsa_next_free_vgpr 128
  .amdhsa_next_free_sgpr 102
  .amdhsa_accum_offset 128
  .amdhsa_group_segment_fixed_size 0
  .amdhsa_kernarg_size 80
  .amdhsa_user_sgpr_count 2
  .amdhsa_user_sgpr_kernarg_segment_ptr 1
  .amdhsa_system_sgpr_workgroup_id_x 1
.end_amdhsa_kernel
.p2align 6
.amdhsa_kernel joint_kernel
  .amdhsa_next_free_vgpr 128
  .amdhsa_next_free_sgpr 102
  .amdhsa_accum_offset 128
  .amdhsa_group_segment_fixed_size 0
  .amdhsa_kernarg_size 80
  .amdhsa_user_sgpr_count 2
  .amdhsa_user_sgpr_kernarg_segment_ptr 1
  .amdhsa_system_sgpr_workgroup_id_x 1
.end_amdhsa_kernel
```

```asm
; @launch kernel=prep_kernel grid=(256,1,1) block=(384,1,1) lds=4096
; @launch kernel=conv1_kernel grid=(256,1,1) block=(1024,1,1) lds=162816
; @launch kernel=conv2_kernel grid=(256,1,1) block=(1024,1,1) lds=162816
; @launch kernel=joint_kernel grid=(250,1,1) block=(1024,1,1) lds=99472
.amdgcn_target "amdgcn-amd-amdhsa--gfx950"
.text
.globl prep_kernel
.p2align 8
.type prep_kernel,@function
prep_kernel:
    s_cmp_ge_u32 s2, 256
    s_cbranch_scc1 L_prep_kernel_done
    s_mov_b32 s3, s2
    s_load_dwordx16 s[44:59], s[0:1], 0
    s_load_dwordx2 s[30:31], s[0:1], 72
    v_readfirstlane_b32 s40, v0
    s_lshr_b32 s40, s40, 6
    v_and_b32 v1, 63, v0
    s_cmp_lt_u32 s40, 4
    s_cbranch_scc1 L_prep_kernel_w
    s_cmp_lt_u32 s2, 24
    s_cbranch_scc1 L_prep_kernel_sh
    s_endpgm
L_prep_kernel_sh:
    s_lshr_b32 s41, s2, 3
    s_and_b32 s42, s2, 7
    s_sub_u32 s43, s40, 4
    s_lshl_b32 s26, s43, 16
    s_lshl_b32 s5, s42, 6
    s_add_u32 s26, s26, s5
    s_mov_b32 s10, 131072
    s_mov_b32 s11, 0x00020000
    v_lshrrev_b32 v2, 4, v1
    v_lshlrev_b32 v2, 12, v2
    v_and_b32 v3, 15, v1
    v_lshl_add_u32 v2, v3, 2, v2
    v_mov_b32 v9, 0
    ds_write_b32 v9, v9 offset:2048
    s_waitcnt lgkmcnt(0)
    s_cmp_eq_u32 s41, 1
    s_cselect_b32 s8, s56, s52
    s_cselect_b32 s9, s57, s53
    s_cmp_eq_u32 s41, 2
    s_cselect_b32 s8, s54, s8
    s_cselect_b32 s9, s55, s9
    s_barrier
    s_cmp_lg_u32 s41, 2
    s_cbranch_scc1 L_prep_kernel_nog
    s_mov_b32 s16, s50
    s_mov_b32 s17, s51
    s_mov_b32 s18, 8192
    s_mov_b32 s19, 0x00020000
    v_and_b32 v6, 0x30, v1
    v_lshl_add_u32 v6, v3, 9, v6
    s_lshl_b32 s6, s43, 8
    buffer_load_dwordx4 v[80:83], v6, s[16:19], s6 offen offset:0
    buffer_load_dwordx4 v[84:87], v6, s[16:19], s6 offen offset:64
    buffer_load_dwordx4 v[88:91], v6, s[16:19], s6 offen offset:128
    buffer_load_dwordx4 v[92:95], v6, s[16:19], s6 offen offset:192
L_prep_kernel_nog:
    buffer_load_dword v16, v2, s[8:11], s26 offen offset:0
    buffer_load_dword v17, v2, s[8:11], s26 offen offset:512
    buffer_load_dword v18, v2, s[8:11], s26 offen offset:1024
    buffer_load_dword v19, v2, s[8:11], s26 offen offset:1536
    buffer_load_dword v20, v2, s[8:11], s26 offen offset:2048
    buffer_load_dword v21, v2, s[8:11], s26 offen offset:2560
    buffer_load_dword v22, v2, s[8:11], s26 offen offset:3072
    buffer_load_dword v23, v2, s[8:11], s26 offen offset:3584
    s_add_u32 s26, s26, 16384
    buffer_load_dword v24, v2, s[8:11], s26 offen offset:0
    buffer_load_dword v25, v2, s[8:11], s26 offen offset:512
    buffer_load_dword v26, v2, s[8:11], s26 offen offset:1024
    buffer_load_dword v27, v2, s[8:11], s26 offen offset:1536
    buffer_load_dword v28, v2, s[8:11], s26 offen offset:2048
    buffer_load_dword v29, v2, s[8:11], s26 offen offset:2560
    buffer_load_dword v30, v2, s[8:11], s26 offen offset:3072
    buffer_load_dword v31, v2, s[8:11], s26 offen offset:3584
    s_add_u32 s26, s26, 16384
    buffer_load_dword v32, v2, s[8:11], s26 offen offset:0
    buffer_load_dword v33, v2, s[8:11], s26 offen offset:512
    buffer_load_dword v34, v2, s[8:11], s26 offen offset:1024
    buffer_load_dword v35, v2, s[8:11], s26 offen offset:1536
    buffer_load_dword v36, v2, s[8:11], s26 offen offset:2048
    buffer_load_dword v37, v2, s[8:11], s26 offen offset:2560
    buffer_load_dword v38, v2, s[8:11], s26 offen offset:3072
    buffer_load_dword v39, v2, s[8:11], s26 offen offset:3584
    s_add_u32 s26, s26, 16384
    buffer_load_dword v40, v2, s[8:11], s26 offen offset:0
    buffer_load_dword v41, v2, s[8:11], s26 offen offset:512
    buffer_load_dword v42, v2, s[8:11], s26 offen offset:1024
    buffer_load_dword v43, v2, s[8:11], s26 offen offset:1536
    buffer_load_dword v44, v2, s[8:11], s26 offen offset:2048
    buffer_load_dword v45, v2, s[8:11], s26 offen offset:2560
    buffer_load_dword v46, v2, s[8:11], s26 offen offset:3072
    buffer_load_dword v47, v2, s[8:11], s26 offen offset:3584
    s_branch L_prep_kernel_small
L_prep_kernel_w:
    s_lshl_b32 s21, s2, 2
    s_add_u32 s20, s40, s21
    s_load_dwordx2 s[8:9], s[0:1], 8
    s_lshr_b32 s22, s20, 8
    s_bfe_u32 s23, s20, 0x40004
    s_bfe_u32 s24, s20, 0x30001
    s_and_b32 s21, s20, 1
    v_lshrrev_b32 v5, 4, v1
    v_lshlrev_b32 v2, 11, v5
    v_and_b32 v3, 15, v1
    v_lshl_add_u32 v2, v3, 2, v2
    s_lshl_b32 s26, s22, 3
    s_lshr_b32 s27, s23, 3
    s_add_u32 s26, s26, s27
    s_lshl_b32 s26, s26, 17
    s_and_b32 s27, s23, 7
    s_lshl_b32 s27, s27, 1
    s_add_u32 s27, s27, s21
    s_lshl_b32 s27, s27, 13
    s_add_u32 s26, s26, s27
    s_lshl_b32 s27, s24, 6
    s_add_u32 s26, s26, s27
    s_mov_b32 s10, 4063232
    s_mov_b32 s11, 0x00020000
    s_add_u32 s37, s26, 262144
    s_add_u32 s38, s26, 524288
    s_add_u32 s39, s26, 786432
    s_mov_b32 s14, 7340032
    s_mov_b32 s15, 0x00020000
    v_lshrrev_b32 v4, 1, v5
    v_lshlrev_b32 v4, 8, v4
    v_lshl_add_u32 v4, v3, 4, v4
    v_and_b32 v5, 1, v5
    v_lshl_add_u32 v4, v5, 10, v4
    s_lshl_b32 s27, s24, 4
    s_add_u32 s27, s27, s23
    s_mul_i32 s27, s27, 57344
    s_lshl_b32 s28, s22, 11
    s_add_u32 s27, s27, s28
    s_lshl_b32 s28, s21, 9
    s_add_u32 s27, s27, s28
    s_mov_b32 s32, 0x05040100
    s_mov_b32 s33, 0x07060302
    s_mov_b32 s34, 0xffff0000
    s_mov_b32 s35, 0x3d2aaaab
    s_mov_b32 s40, 0x3c638e39
    s_waitcnt lgkmcnt(0)
    buffer_load_dword v16, v2, s[8:11], s26 offen offset:0
    buffer_load_dword v17, v2, s[8:11], s26 offen offset:512
    buffer_load_dword v20, v2, s[8:11], s37 offen offset:0
    buffer_load_dword v21, v2, s[8:11], s37 offen offset:512
    buffer_load_dword v24, v2, s[8:11], s38 offen offset:0
    buffer_load_dword v25, v2, s[8:11], s38 offen offset:512
    buffer_load_dword v28, v2, s[8:11], s39 offen offset:0
    buffer_load_dword v29, v2, s[8:11], s39 offen offset:512
    buffer_load_dword v18, v2, s[8:11], s26 offen offset:1024
    buffer_load_dword v19, v2, s[8:11], s26 offen offset:1536
    buffer_load_dword v22, v2, s[8:11], s37 offen offset:1024
    buffer_load_dword v23, v2, s[8:11], s37 offen offset:1536
    buffer_load_dword v26, v2, s[8:11], s38 offen offset:1024
    buffer_load_dword v27, v2, s[8:11], s38 offen offset:1536
    buffer_load_dword v30, v2, s[8:11], s39 offen offset:1024
    buffer_load_dword v31, v2, s[8:11], s39 offen offset:1536
    s_cmp_ge_u32 s2, 24
    s_cbranch_scc1 L_prep_kernel_nb
    s_barrier
L_prep_kernel_nb:
    s_add_u32 s12, s30, 0
    s_addc_u32 s13, s31, 0
    s_waitcnt vmcnt(8)
    v_perm_b32 v100, v17, v16, s32
    v_perm_b32 v76, v29, v28, s32
    v_lshlrev_b32 v104, 16, v28
    v_lshlrev_b32 v112, 16, v29
    v_lshlrev_b32 v105, 16, v24
    v_lshlrev_b32 v113, 16, v25
    v_lshlrev_b32 v106, 16, v20
    v_lshlrev_b32 v114, 16, v21
    v_lshlrev_b32 v107, 16, v16
    v_lshlrev_b32 v115, 16, v17
    v_add_f32 v108, v104, v106
    v_add_f32 v116, v112, v114
    v_add_f32 v109, v105, v107
    v_add_f32 v117, v113, v115
    v_fma_f32 v110, v106, 4.0, v104
    v_fma_f32 v118, v114, 4.0, v112
    v_fma_f32 v111, v107, 4.0, v105
    v_fma_f32 v119, v115, 4.0, v113
    v_add_f32 v105, v108, v109
    v_add_f32 v113, v116, v117
    v_sub_f32 v106, v108, v109
    v_sub_f32 v114, v116, v117
    v_fma_f32 v107, v111, 2.0, v110
    v_fma_f32 v115, v119, 2.0, v118
    v_fma_f32 v110, v111, -2.0, v110
    v_fma_f32 v118, v119, -2.0, v118
    v_fmamk_f32 v108, v104, 0x41700000, v110
    v_fmamk_f32 v116, v112, 0x41700000, v118
    v_fmamk_f32 v108, v109, 0x41200000, v108
    v_fmamk_f32 v116, v117, 0x41200000, v116
    v_mul_f32 v105, 0.5, v105
    v_mul_f32 v113, 0.5, v113
    v_mul_f32 v106, 0.5, v106
    v_mul_f32 v114, 0.5, v114
    v_mul_f32 v107, s35, v107
    v_mul_f32 v115, s35, v115
    v_mul_f32 v110, s35, v110
    v_mul_f32 v118, s35, v118
    v_mul_f32 v108, s40, v108
    v_mul_f32 v116, s40, v116
    v_cvt_pk_bf16_f32 v80, v105, v113
    v_cvt_pk_bf16_f32 v84, v106, v114
    v_cvt_pk_bf16_f32 v88, v107, v115
    v_cvt_pk_bf16_f32 v92, v110, v118
    v_cvt_pk_bf16_f32 v96, v108, v116
    v_perm_b32 v102, v17, v16, s33
    v_perm_b32 v78, v29, v28, s33
    v_and_b32 v104, s34, v28
    v_and_b32 v112, s34, v29
    v_and_b32 v105, s34, v24
    v_and_b32 v113, s34, v25
    v_and_b32 v106, s34, v20
    v_and_b32 v114, s34, v21
    v_and_b32 v107, s34, v16
    v_and_b32 v115, s34, v17
    v_add_f32 v108, v104, v106
    v_add_f32 v116, v112, v114
    v_add_f32 v109, v105, v107
    v_add_f32 v117, v113, v115
    v_fma_f32 v110, v106, 4.0, v104
    v_fma_f32 v118, v114, 4.0, v112
    v_fma_f32 v111, v107, 4.0, v105
    v_fma_f32 v119, v115, 4.0, v113
    v_add_f32 v105, v108, v109
    v_add_f32 v113, v116, v117
    v_sub_f32 v106, v108, v109
    v_sub_f32 v114, v116, v117
    v_fma_f32 v107, v111, 2.0, v110
    v_fma_f32 v115, v119, 2.0, v118
    v_fma_f32 v110, v111, -2.0, v110
    v_fma_f32 v118, v119, -2.0, v118
    v_fmamk_f32 v108, v104, 0x41700000, v110
    v_fmamk_f32 v116, v112, 0x41700000, v118
    v_fmamk_f32 v108, v109, 0x41200000, v108
    v_fmamk_f32 v116, v117, 0x41200000, v116
    v_mul_f32 v105, 0.5, v105
    v_mul_f32 v113, 0.5, v113
    v_mul_f32 v106, 0.5, v106
    v_mul_f32 v114, 0.5, v114
    v_mul_f32 v107, s35, v107
    v_mul_f32 v115, s35, v115
    v_mul_f32 v110, s35, v110
    v_mul_f32 v118, s35, v118
    v_mul_f32 v108, s40, v108
    v_mul_f32 v116, s40, v116
    v_cvt_pk_bf16_f32 v82, v105, v113
    v_cvt_pk_bf16_f32 v86, v106, v114
    v_cvt_pk_bf16_f32 v90, v107, v115
    v_cvt_pk_bf16_f32 v94, v110, v118
    v_cvt_pk_bf16_f32 v98, v108, v116
    s_waitcnt vmcnt(0)
    s_cmp_lt_u32 s3, 224
    s_cbranch_scc1 L_prep_kernel_ncw
    s_getpc_b64 s[62:63]
L_prep_kernel_pc:
    s_and_b32 s64, s3, 8
    s_lshl_b32 s64, s64, 12
    v_lshlrev_b32 v120, 7, v0
    v_add_u32 v120, s64, v120
    v_min_u32 v120, L_joint_kernel_done-L_prep_kernel_pc, v120
    v_mov_b32 v121, s63
    v_add_co_u32 v120, vcc, s62, v120
    s_nop 1
    v_addc_co_u32 v121, vcc, 0, v121, vcc
    global_load_dword v122, v[120:121], off
L_prep_kernel_ncw:
    v_perm_b32 v101, v19, v18, s32
    v_perm_b32 v77, v31, v30, s32
    v_lshlrev_b32 v104, 16, v30
    v_lshlrev_b32 v112, 16, v31
    v_lshlrev_b32 v105, 16, v26
    v_lshlrev_b32 v113, 16, v27
    v_lshlrev_b32 v106, 16, v22
    v_lshlrev_b32 v114, 16, v23
    v_lshlrev_b32 v107, 16, v18
    v_lshlrev_b32 v115, 16, v19
    v_add_f32 v108, v104, v106
    v_add_f32 v116, v112, v114
    v_add_f32 v109, v105, v107
    v_add_f32 v117, v113, v115
    v_fma_f32 v110, v106, 4.0, v104
    v_fma_f32 v118, v114, 4.0, v112
    v_fma_f32 v111, v107, 4.0, v105
    v_fma_f32 v119, v115, 4.0, v113
    v_add_f32 v105, v108, v109
    v_add_f32 v113, v116, v117
    v_sub_f32 v106, v108, v109
    v_sub_f32 v114, v116, v117
    v_fma_f32 v107, v111, 2.0, v110
    v_fma_f32 v115, v119, 2.0, v118
    v_fma_f32 v110, v111, -2.0, v110
    v_fma_f32 v118, v119, -2.0, v118
    v_fmamk_f32 v108, v104, 0x41700000, v110
    v_fmamk_f32 v116, v112, 0x41700000, v118
    v_fmamk_f32 v108, v109, 0x41200000, v108
    v_fmamk_f32 v116, v117, 0x41200000, v116
    v_mul_f32 v105, 0.5, v105
    v_mul_f32 v113, 0.5, v113
    v_mul_f32 v106, 0.5, v106
    v_mul_f32 v114, 0.5, v114
    v_mul_f32 v107, s35, v107
    v_mul_f32 v115, s35, v115
    v_mul_f32 v110, s35, v110
    v_mul_f32 v118, s35, v118
    v_mul_f32 v108, s40, v108
    v_mul_f32 v116, s40, v116
    v_cvt_pk_bf16_f32 v81, v105, v113
    v_cvt_pk_bf16_f32 v85, v106, v114
    v_cvt_pk_bf16_f32 v89, v107, v115
    v_cvt_pk_bf16_f32 v93, v110, v118
    v_cvt_pk_bf16_f32 v97, v108, v116
    v_perm_b32 v103, v19, v18, s33
    v_perm_b32 v79, v31, v30, s33
    v_and_b32 v104, s34, v30
    v_and_b32 v112, s34, v31
    v_and_b32 v105, s34, v26
    v_and_b32 v113, s34, v27
    v_and_b32 v106, s34, v22
    v_and_b32 v114, s34, v23
    v_and_b32 v107, s34, v18
    v_and_b32 v115, s34, v19
    v_add_f32 v108, v104, v106
    v_add_f32 v116, v112, v114
    v_add_f32 v109, v105, v107
    v_add_f32 v117, v113, v115
    v_fma_f32 v110, v106, 4.0, v104
    v_fma_f32 v118, v114, 4.0, v112
    v_fma_f32 v111, v107, 4.0, v105
    v_fma_f32 v119, v115, 4.0, v113
    v_add_f32 v105, v108, v109
    v_add_f32 v113, v116, v117
    v_sub_f32 v106, v108, v109
    v_sub_f32 v114, v116, v117
    v_fma_f32 v107, v111, 2.0, v110
    v_fma_f32 v115, v119, 2.0, v118
    v_fma_f32 v110, v111, -2.0, v110
    v_fma_f32 v118, v119, -2.0, v118
    v_fmamk_f32 v108, v104, 0x41700000, v110
    v_fmamk_f32 v116, v112, 0x41700000, v118
    v_fmamk_f32 v108, v109, 0x41200000, v108
    v_fmamk_f32 v116, v117, 0x41200000, v116
    v_mul_f32 v105, 0.5, v105
    v_mul_f32 v113, 0.5, v113
    v_mul_f32 v106, 0.5, v106
    v_mul_f32 v114, 0.5, v114
    v_mul_f32 v107, s35, v107
    v_mul_f32 v115, s35, v115
    v_mul_f32 v110, s35, v110
    v_mul_f32 v118, s35, v118
    v_mul_f32 v108, s40, v108
    v_mul_f32 v116, s40, v116
    v_cvt_pk_bf16_f32 v83, v105, v113
    v_cvt_pk_bf16_f32 v87, v106, v114
    v_cvt_pk_bf16_f32 v91, v107, v115
    v_cvt_pk_bf16_f32 v95, v110, v118
    v_cvt_pk_bf16_f32 v99, v108, v116
    v_permlane16_swap_b32 v100, v102
    v_permlane16_swap_b32 v101, v103
    s_add_u32 s28, s27, 49152
    buffer_store_dwordx4 v[100:103], v4, s[12:15], s28 offen sc1
    v_permlane16_swap_b32 v76, v78
    v_permlane16_swap_b32 v77, v79
    s_add_u32 s28, s27, 0
    buffer_store_dwordx4 v[76:79], v4, s[12:15], s28 offen sc1
    v_permlane16_swap_b32 v80, v82
    v_permlane16_swap_b32 v81, v83
    s_add_u32 s28, s27, 8192
    buffer_store_dwordx4 v[80:83], v4, s[12:15], s28 offen sc1
    v_permlane16_swap_b32 v84, v86
    v_permlane16_swap_b32 v85, v87
    s_add_u32 s28, s27, 16384
    buffer_store_dwordx4 v[84:87], v4, s[12:15], s28 offen sc1
    v_permlane16_swap_b32 v88, v90
    v_permlane16_swap_b32 v89, v91
    s_add_u32 s28, s27, 24576
    buffer_store_dwordx4 v[88:91], v4, s[12:15], s28 offen sc1
    v_permlane16_swap_b32 v92, v94
    v_permlane16_swap_b32 v93, v95
    s_add_u32 s28, s27, 32768
    buffer_store_dwordx4 v[92:95], v4, s[12:15], s28 offen sc1
    v_permlane16_swap_b32 v96, v98
    v_permlane16_swap_b32 v97, v99
    s_add_u32 s28, s27, 40960
    buffer_store_dwordx4 v[96:99], v4, s[12:15], s28 offen sc1
L_prep_kernel_done:
    s_endpgm
L_prep_kernel_small:
    v_lshrrev_b32 v2, 4, v1
    s_lshl_b32 s24, s41, 17
    s_add_u32 s24, s24, 44040192
    s_add_u32 s12, s30, s24
    s_addc_u32 s13, s31, 0
    s_mov_b32 s14, 131072
    s_mov_b32 s15, 0x00020000
    s_mov_b32 s32, 0x05040100
    s_mov_b32 s33, 0x07060302
    v_lshlrev_b32 v4, 4, v1
    s_lshl_b32 s24, s42, 14
    s_lshl_b32 s25, s43, 13
    s_add_u32 s24, s24, s25
    s_add_u32 s25, s24, 4096
    s_waitcnt vmcnt(0)
    v_perm_b32 v48, v17, v16, s32
    v_perm_b32 v49, v19, v18, s32
    v_perm_b32 v50, v21, v20, s32
    v_perm_b32 v51, v23, v22, s32
    v_perm_b32 v52, v17, v16, s33
    v_perm_b32 v53, v19, v18, s33
    v_perm_b32 v54, v21, v20, s33
    v_perm_b32 v55, v23, v22, s33
    v_perm_b32 v56, v25, v24, s32
    v_perm_b32 v57, v27, v26, s32
    v_perm_b32 v58, v29, v28, s32
    v_perm_b32 v59, v31, v30, s32
    v_perm_b32 v60, v25, v24, s33
    v_perm_b32 v61, v27, v26, s33
    v_perm_b32 v62, v29, v28, s33
    v_perm_b32 v63, v31, v30, s33
    v_perm_b32 v64, v33, v32, s32
    v_perm_b32 v65, v35, v34, s32
    v_perm_b32 v66, v37, v36, s32
    v_perm_b32 v67, v39, v38, s32
    v_perm_b32 v68, v33, v32, s33
    v_perm_b32 v69, v35, v34, s33
    v_perm_b32 v70, v37, v36, s33
    v_perm_b32 v71, v39, v38, s33
    v_perm_b32 v72, v41, v40, s32
    v_perm_b32 v73, v43, v42, s32
    v_perm_b32 v74, v45, v44, s32
    v_perm_b32 v75, v47, v46, s32
    v_perm_b32 v76, v41, v40, s33
    v_perm_b32 v77, v43, v42, s33
    v_perm_b32 v78, v45, v44, s33
    v_perm_b32 v79, v47, v46, s33
    s_cmp_eq_u32 s41, 2
    s_cbranch_scc1 L_prep_kernel_ge
    buffer_store_dwordx4 v[48:51], v4, s[12:15], s24 offen offset:0 sc1
    buffer_store_dwordx4 v[52:55], v4, s[12:15], s24 offen offset:1024 sc1
    buffer_store_dwordx4 v[56:59], v4, s[12:15], s24 offen offset:2048 sc1
    buffer_store_dwordx4 v[60:63], v4, s[12:15], s24 offen offset:3072 sc1
    buffer_store_dwordx4 v[64:67], v4, s[12:15], s25 offen offset:0 sc1
    buffer_store_dwordx4 v[68:71], v4, s[12:15], s25 offen offset:1024 sc1
    buffer_store_dwordx4 v[72:75], v4, s[12:15], s25 offen offset:2048 sc1
    buffer_store_dwordx4 v[76:79], v4, s[12:15], s25 offen offset:3072 sc1
    s_endpgm
L_prep_kernel_ge:
    v_mfma_f32_16x16x32_bf16 v[96:99], v[48:51], v[80:83], 0
    v_mfma_f32_16x16x32_bf16 v[100:103], v[52:55], v[80:83], 0
    v_mfma_f32_16x16x32_bf16 v[96:99], v[56:59], v[84:87], v[96:99]
    v_mfma_f32_16x16x32_bf16 v[100:103], v[60:63], v[84:87], v[100:103]
    v_mfma_f32_16x16x32_bf16 v[96:99], v[64:67], v[88:91], v[96:99]
    v_mfma_f32_16x16x32_bf16 v[100:103], v[68:71], v[88:91], v[100:103]
    v_mfma_f32_16x16x32_bf16 v[96:99], v[72:75], v[92:95], v[96:99]
    v_mfma_f32_16x16x32_bf16 v[100:103], v[76:79], v[92:95], v[100:103]
    v_mov_b32 v7, v4
    v_mov_b32 v10, 1
    s_nop 0
    s_mov_b32 s14, 16384
    v_lshlrev_b32 v8, 10, v3
    v_lshl_add_u32 v8, v2, 5, v8
    s_lshl_b32 s24, s42, 7
    s_mov_b32 s34, 0xffff0000
    s_mov_b32 s35, 0x4038aa3b
    s_cmp_eq_u32 s43, 0
    s_cbranch_scc1 L_prep_kernel_ge0
    ds_write_b128 v7, v[96:99]
    ds_write_b128 v7, v[100:103] offset:1024
    ds_write_b32 v9, v10 offset:2048
    s_endpgm
L_prep_kernel_ge0:
    ds_read_b32 v10, v9 offset:2048
    s_waitcnt lgkmcnt(0)
    v_readfirstlane_b32 s27, v10
    s_cmp_eq_u32 s27, 0
    s_cbranch_scc1 L_prep_kernel_ge0
    ds_read_b128 v[16:19], v7
    ds_read_b128 v[20:23], v7 offset:1024
    s_waitcnt lgkmcnt(0)
    v_add_f32 v16, v16, v96
    v_add_f32 v17, v17, v97
    v_add_f32 v18, v18, v98
    v_add_f32 v19, v19, v99
    v_add_f32 v20, v20, v100
    v_add_f32 v21, v21, v101
    v_add_f32 v22, v22, v102
    v_add_f32 v23, v23, v103
    v_cvt_pk_bf16_f32 v48, v16, v20
    v_cvt_pk_bf16_f32 v49, v17, v21
    v_cvt_pk_bf16_f32 v50, v18, v22
    v_cvt_pk_bf16_f32 v51, v19, v23
    v_lshlrev_b32 v56, 16, v48
    v_and_b32 v57, s34, v48
    v_lshlrev_b32 v58, 16, v49
    v_and_b32 v59, s34, v49
    v_lshlrev_b32 v60, 16, v50
    v_and_b32 v61, s34, v50
    v_lshlrev_b32 v62, 16, v51
    v_and_b32 v63, s34, v51
    v_mul_f32 v56, s35, v56
    v_mul_f32 v57, s35, v57
    v_mul_f32 v58, s35, v58
    v_mul_f32 v59, s35, v59
    v_mul_f32 v60, s35, v60
    v_mul_f32 v61, s35, v61
    v_mul_f32 v62, s35, v62
    v_mul_f32 v63, s35, v63
    buffer_store_dwordx4 v[56:59], v8, s[12:15], s24 offen sc1
    buffer_store_dwordx4 v[60:63], v8, s[12:15], s24 offen offset:16 sc1
    v_exp_f32 v64, v56
    v_exp_f32 v65, v57
    v_exp_f32 v66, v58
    v_exp_f32 v67, v59
    v_exp_f32 v68, v60
    v_exp_f32 v69, v61
    v_exp_f32 v70, v62
    v_exp_f32 v71, v63
    v_max3_f32 v72, |v56|, |v57|, |v58|
    v_max3_f32 v72, |v59|, |v60|, v72
    v_max3_f32 v72, |v61|, |v62|, v72
    v_max_f32 v72, |v63|, v72
    s_add_u32 s12, s12, 16384
    s_addc_u32 s13, s13, 0
    v_cmp_lt_f32 vcc, 0x42f00000, v72
    buffer_store_dwordx4 v[64:67], v8, s[12:15], s24 offen sc1
    buffer_store_dwordx4 v[68:71], v8, s[12:15], s24 offen offset:16 sc1
    s_add_u32 s12, s12, 16384
    s_addc_u32 s13, s13, 0
    s_or_b32 s26, vcc_lo, vcc_hi
    s_lshl_b32 s24, s42, 2
    v_mov_b32 v73, s26
    v_mov_b32 v74, 0
    buffer_store_dword v73, v74, s[12:15], s24 offen sc1
L_prep_kernel_last:
    s_endpgm
.globl conv1_kernel
.p2align 8
.type conv1_kernel,@function
conv1_kernel:
    s_cmp_ge_u32 s2, 256
    s_cbranch_scc1 L_conv1_kernel_done
    s_load_dwordx2 s[4:5], s[0:1], 0
    s_load_dwordx2 s[30:31], s[0:1], 72
    v_readfirstlane_b32 s20, v0
    s_lshr_b32 s20, s20, 6
    s_xor_b32 s20, s20, 8
    s_and_b32 s36, s2, 0
    s_lshl_b32 s36, s36, 3
    s_bfe_u32 s37, s2, 196611
    s_or_b32 s29, s36, s37
    s_bfe_u32 s36, s2, 196608
    s_lshl_b32 s36, s36, 2
    s_lshr_b32 s37, s2, 6
    s_or_b32 s36, s36, s37
    s_mov_b32 s33, 0
    s_and_b32 s34, s36, 15
    s_lshr_b32 s35, s36, 4
    s_mul_i32 s21, s34, 500
    s_and_b32 s32, s20, 3
    v_and_b32 v127, 63, v0
    v_lshrrev_b32 v5, 2, v127
    v_and_b32 v6, 3, v127
    s_and_b32 s42, s20, 7
    v_lshlrev_b32 v7, 15, v5
    v_lshl_add_u32 v7, v6, 4, v7
    s_lshl_b32 s41, s21, 10
    s_sub_u32 s41, s41, 7680
    s_lshl_b32 s37, s42, 12
    s_add_u32 s37, s37, s41
    v_add_u32 v7, s37, v7
    s_mul_i32 s36, s35, 8192000
    s_mov_b32 s10, 8192000
    s_mov_b32 s11, 0x00020000
    s_mov_b32 s25, 0xffff0000
    s_mov_b32 s47, s36
    s_cmp_ge_u32 s20, 8
    s_cbranch_scc0 L_conv1_kernel_mw
L_conv1_kernel_helper:
    s_setprio 3
    v_add_u32 v92, 0, v7
    v_add_u32 v93, 1024, v7
    v_add_u32 v94, 2048, v7
    v_add_u32 v95, 3072, v7
    v_and_b32 v76, 4, v5
    v_lshrrev_b32 v76, 1, v76
    v_xor_b32 v76, v6, v76
    v_lshlrev_b32 v76, 4, v76
    v_lshl_add_u32 v76, v5, 6, v76
    s_mov_b32 s24, 0
    s_mov_b32 s27, 524288
    s_waitcnt lgkmcnt(0)
    s_add_u32 s8, s4, s47
    s_addc_u32 s9, s5, 0
    buffer_load_dwordx4 v[0:3], v92, s[8:11], s24 offen offset:0
    buffer_load_dwordx4 v[16:19], v92, s[8:11], s24 offen offset:64
    v_add_u32 v92, 128, v92
    buffer_load_dwordx4 v[4:7], v93, s[8:11], s24 offen offset:0
    buffer_load_dwordx4 v[20:23], v93, s[8:11], s24 offen offset:64
    v_add_u32 v93, 128, v93
    buffer_load_dwordx4 v[8:11], v94, s[8:11], s24 offen offset:0
    buffer_load_dwordx4 v[24:27], v94, s[8:11], s24 offen offset:64
    v_add_u32 v94, 128, v94
    buffer_load_dwordx4 v[12:15], v95, s[8:11], s24 offen offset:0
    buffer_load_dwordx4 v[28:31], v95, s[8:11], s24 offen offset:64
    v_add_u32 v95, 128, v95
    s_mul_i32 s36, s42, 1024
    v_add_u32 v96, s36, v76
    v_add_u32 v97, 65536, v96
    s_mul_i32 s36, s42, 1088
    s_add_u32 s36, s36, 98304
    v_add_u32 v98, s36, v76
    s_waitcnt vmcnt(0)
    s_mov_b32 s28, 0
    s_mov_b32 s22, 4
    ds_write_b128 v96, v[0:3] offset:0
    ds_write_b128 v98, v[12:15] offset:0
    v_lshlrev_b32 v76, 16, v0
    v_and_b32 v84, s25, v0
    v_lshlrev_b32 v77, 16, v4
    v_and_b32 v85, s25, v4
    v_lshlrev_b32 v78, 16, v8
    v_and_b32 v86, s25, v8
    v_lshlrev_b32 v79, 16, v12
    v_and_b32 v87, s25, v12
    v_add_f32 v80, v76, v78
    v_add_f32 v88, v84, v86
    v_add_f32 v81, v77, v79
    v_add_f32 v89, v85, v87
    v_fma_f32 v82, v78, 4.0, v76
    v_fma_f32 v90, v86, 4.0, v84
    v_fma_f32 v83, v79, 4.0, v77
    v_fma_f32 v91, v87, 4.0, v85
    v_add_f32 v77, v80, v81
    v_add_f32 v85, v88, v89
    v_sub_f32 v78, v80, v81
    v_sub_f32 v86, v88, v89
    v_fma_f32 v79, v83, 2.0, v82
    v_fma_f32 v87, v91, 2.0, v90
    v_fma_f32 v82, v83, -2.0, v82
    v_fma_f32 v90, v91, -2.0, v90
    v_fmamk_f32 v80, v76, 0x41700000, v82
    v_fmamk_f32 v88, v84, 0x41700000, v90
    v_fmamk_f32 v80, v81, 0x41200000, v80
    v_fmamk_f32 v88, v89, 0x41200000, v88
    v_cvt_pk_bf16_f32 v4, v77, v85
    v_cvt_pk_bf16_f32 v8, v78, v86
    v_cvt_pk_bf16_f32 v64, v79, v87
    v_cvt_pk_bf16_f32 v68, v82, v90
    v_cvt_pk_bf16_f32 v72, v80, v88
    v_lshlrev_b32 v76, 16, v1
    v_and_b32 v84, s25, v1
    v_lshlrev_b32 v77, 16, v5
    v_and_b32 v85, s25, v5
    v_lshlrev_b32 v78, 16, v9
    v_and_b32 v86, s25, v9
    v_lshlrev_b32 v79, 16, v13
    v_and_b32 v87, s25, v13
    v_add_f32 v80, v76, v78
    v_add_f32 v88, v84, v86
    v_add_f32 v81, v77, v79
    v_add_f32 v89, v85, v87
    v_fma_f32 v82, v78, 4.0, v76
    v_fma_f32 v90, v86, 4.0, v84
    v_fma_f32 v83, v79, 4.0, v77
    v_fma_f32 v91, v87, 4.0, v85
    v_add_f32 v77, v80, v81
    v_add_f32 v85, v88, v89
    v_sub_f32 v78, v80, v81
    v_sub_f32 v86, v88, v89
    v_fma_f32 v79, v83, 2.0, v82
    v_fma_f32 v87, v91, 2.0, v90
    v_fma_f32 v82, v83, -2.0, v82
    v_fma_f32 v90, v91, -2.0, v90
    v_fmamk_f32 v80, v76, 0x41700000, v82
    v_fmamk_f32 v88, v84, 0x41700000, v90
    v_fmamk_f32 v80, v81, 0x41200000, v80
    v_fmamk_f32 v88, v89, 0x41200000, v88
    v_cvt_pk_bf16_f32 v5, v77, v85
    v_cvt_pk_bf16_f32 v9, v78, v86
    v_cvt_pk_bf16_f32 v65, v79, v87
    v_cvt_pk_bf16_f32 v69, v82, v90
    v_cvt_pk_bf16_f32 v73, v80, v88
    v_lshlrev_b32 v76, 16, v2
    v_and_b32 v84, s25, v2
    v_lshlrev_b32 v77, 16, v6
    v_and_b32 v85, s25, v6
    v_lshlrev_b32 v78, 16, v10
    v_and_b32 v86, s25, v10
    v_lshlrev_b32 v79, 16, v14
    v_and_b32 v87, s25, v14
    v_add_f32 v80, v76, v78
    v_add_f32 v88, v84, v86
    v_add_f32 v81, v77, v79
    v_add_f32 v89, v85, v87
    v_fma_f32 v82, v78, 4.0, v76
    v_fma_f32 v90, v86, 4.0, v84
    v_fma_f32 v83, v79, 4.0, v77
    v_fma_f32 v91, v87, 4.0, v85
    v_add_f32 v77, v80, v81
    v_add_f32 v85, v88, v89
    v_sub_f32 v78, v80, v81
    v_sub_f32 v86, v88, v89
    v_fma_f32 v79, v83, 2.0, v82
    v_fma_f32 v87, v91, 2.0, v90
    v_fma_f32 v82, v83, -2.0, v82
    v_fma_f32 v90, v91, -2.0, v90
    v_fmamk_f32 v80, v76, 0x41700000, v82
    v_fmamk_f32 v88, v84, 0x41700000, v90
    v_fmamk_f32 v80, v81, 0x41200000, v80
    v_fmamk_f32 v88, v89, 0x41200000, v88
    v_cvt_pk_bf16_f32 v6, v77, v85
    v_cvt_pk_bf16_f32 v10, v78, v86
    v_cvt_pk_bf16_f32 v66, v79, v87
    v_cvt_pk_bf16_f32 v70, v82, v90
    v_cvt_pk_bf16_f32 v74, v80, v88
    v_lshlrev_b32 v76, 16, v3
    v_and_b32 v84, s25, v3
    v_lshlrev_b32 v77, 16, v7
    v_and_b32 v85, s25, v7
    v_lshlrev_b32 v78, 16, v11
    v_and_b32 v86, s25, v11
    v_lshlrev_b32 v79, 16, v15
    v_and_b32 v87, s25, v15
    v_add_f32 v80, v76, v78
    v_add_f32 v88, v84, v86
    v_add_f32 v81, v77, v79
    v_add_f32 v89, v85, v87
    v_fma_f32 v82, v78, 4.0, v76
    v_fma_f32 v90, v86, 4.0, v84
    v_fma_f32 v83, v79, 4.0, v77
    v_fma_f32 v91, v87, 4.0, v85
    v_add_f32 v77, v80, v81
    v_add_f32 v85, v88, v89
    v_sub_f32 v78, v80, v81
    v_sub_f32 v86, v88, v89
    v_fma_f32 v79, v83, 2.0, v82
    v_fma_f32 v87, v91, 2.0, v90
    v_fma_f32 v82, v83, -2.0, v82
    v_fma_f32 v90, v91, -2.0, v90
    v_fmamk_f32 v80, v76, 0x41700000, v82
    v_fmamk_f32 v88, v84, 0x41700000, v90
    v_fmamk_f32 v80, v81, 0x41200000, v80
    v_fmamk_f32 v88, v89, 0x41200000, v88
    v_cvt_pk_bf16_f32 v7, v77, v85
    v_cvt_pk_bf16_f32 v11, v78, v86
    v_cvt_pk_bf16_f32 v67, v79, v87
    v_cvt_pk_bf16_f32 v71, v82, v90
    v_cvt_pk_bf16_f32 v75, v80, v88
    ds_write_b128 v96, v[64:67] offset:49152
    ds_write_b128 v97, v[68:71] offset:0
    ds_write_b128 v97, v[72:75] offset:16384
    ds_write_b128 v96, v[4:7] offset:16384
    ds_write_b128 v96, v[8:11] offset:32768
    s_cmp_ge_u32 s20, 12
    s_cbranch_scc1 L_conv1_kernel_h2
    s_waitcnt lgkmcnt(0)
    s_barrier
    buffer_load_dwordx4 v[32:35], v92, s[8:11], s24 offen offset:0
    buffer_load_dwordx4 v[48:51], v92, s[8:11], s24 offen offset:64
    v_add_u32 v92, 128, v92
    buffer_load_dwordx4 v[36:39], v93, s[8:11], s24 offen offset:0
    buffer_load_dwordx4 v[52:55], v93, s[8:11], s24 offen offset:64
    v_add_u32 v93, 128, v93
    s_setprio 1
L_conv1_kernel_hloop1:
    s_cmp_lt_u32 s28, 13
    s_cselect_b32 s24, 0, 2130706432
    v_lshlrev_b32 v76, 16, v16
    v_and_b32 v84, s25, v16
    v_lshlrev_b32 v77, 16, v20
    v_and_b32 v85, s25, v20
    v_lshlrev_b32 v78, 16, v24
    v_and_b32 v86, s25, v24
    v_lshlrev_b32 v79, 16, v28
    v_and_b32 v87, s25, v28
    v_add_f32 v80, v76, v78
    v_add_f32 v88, v84, v86
    v_add_f32 v81, v77, v79
    v_add_f32 v89, v85, v87
    v_fma_f32 v82, v78, 4.0, v76
    v_fma_f32 v90, v86, 4.0, v84
    v_fma_f32 v83, v79, 4.0, v77
    v_fma_f32 v91, v87, 4.0, v85
    v_add_f32 v77, v80, v81
    v_add_f32 v85, v88, v89
    v_sub_f32 v78, v80, v81
    v_sub_f32 v86, v88, v89
    v_fma_f32 v79, v83, 2.0, v82
    v_fma_f32 v87, v91, 2.0, v90
    v_fma_f32 v82, v83, -2.0, v82
    v_fma_f32 v90, v91, -2.0, v90
    v_fmamk_f32 v80, v76, 0x41700000, v82
    v_fmamk_f32 v88, v84, 0x41700000, v90
    buffer_load_dwordx4 v[40:43], v94, s[8:11], s24 offen offset:0
    buffer_load_dwordx4 v[56:59], v94, s[8:11], s24 offen offset:64
    v_add_u32 v94, 128, v94
    v_fmamk_f32 v80, v81, 0x41200000, v80
    v_fmamk_f32 v88, v89, 0x41200000, v88
    v_cvt_pk_bf16_f32 v20, v77, v85
    v_cvt_pk_bf16_f32 v24, v78, v86
    v_cvt_pk_bf16_f32 v64, v79, v87
    v_cvt_pk_bf16_f32 v68, v82, v90
    v_cvt_pk_bf16_f32 v72, v80, v88
    v_lshlrev_b32 v76, 16, v17
    v_and_b32 v84, s25, v17
    v_lshlrev_b32 v77, 16, v21
    v_and_b32 v85, s25, v21
    v_lshlrev_b32 v78, 16, v25
    v_and_b32 v86, s25, v25
    v_lshlrev_b32 v79, 16, v29
    v_and_b32 v87, s25, v29
    v_add_f32 v80, v76, v78
    v_add_f32 v88, v84, v86
    v_add_f32 v81, v77, v79
    v_add_f32 v89, v85, v87
    v_fma_f32 v82, v78, 4.0, v76
    v_fma_f32 v90, v86, 4.0, v84
    v_fma_f32 v83, v79, 4.0, v77
    v_fma_f32 v91, v87, 4.0, v85
    v_add_f32 v77, v80, v81
    v_add_f32 v85, v88, v89
    v_sub_f32 v78, v80, v81
    buffer_load_dwordx4 v[44:47], v95, s[8:11], s24 offen offset:0
    buffer_load_dwordx4 v[60:63], v95, s[8:11], s24 offen offset:64
    v_add_u32 v95, 128, v95
    v_sub_f32 v86, v88, v89
    v_fma_f32 v79, v83, 2.0, v82
    v_fma_f32 v87, v91, 2.0, v90
    v_fma_f32 v82, v83, -2.0, v82
    v_fma_f32 v90, v91, -2.0, v90
    v_fmamk_f32 v80, v76, 0x41700000, v82
    v_fmamk_f32 v88, v84, 0x41700000, v90
    v_fmamk_f32 v80, v81, 0x41200000, v80
    v_fmamk_f32 v88, v89, 0x41200000, v88
    v_cvt_pk_bf16_f32 v21, v77, v85
    v_cvt_pk_bf16_f32 v25, v78, v86
    v_cvt_pk_bf16_f32 v65, v79, v87
    v_cvt_pk_bf16_f32 v69, v82, v90
    v_cvt_pk_bf16_f32 v73, v80, v88
    v_lshlrev_b32 v76, 16, v18
    v_and_b32 v84, s25, v18
    v_lshlrev_b32 v77, 16, v22
    v_and_b32 v85, s25, v22
    v_lshlrev_b32 v78, 16, v26
    v_and_b32 v86, s25, v26
    v_lshlrev_b32 v79, 16, v30
    v_and_b32 v87, s25, v30
    v_add_f32 v80, v76, v78
    v_add_f32 v88, v84, v86
    v_add_f32 v81, v77, v79
    v_add_f32 v89, v85, v87
    v_fma_f32 v82, v78, 4.0, v76
    v_fma_f32 v90, v86, 4.0, v84
    v_fma_f32 v83, v79, 4.0, v77
    v_fma_f32 v91, v87, 4.0, v85
    v_add_f32 v77, v80, v81
    v_add_f32 v85, v88, v89
    v_sub_f32 v78, v80, v81
    v_sub_f32 v86, v88, v89
    v_fma_f32 v79, v83, 2.0, v82
    v_fma_f32 v87, v91, 2.0, v90
    v_fma_f32 v82, v83, -2.0, v82
    v_fma_f32 v90, v91, -2.0, v90
    v_fmamk_f32 v80, v76, 0x41700000, v82
    v_fmamk_f32 v88, v84, 0x41700000, v90
    v_fmamk_f32 v80, v81, 0x41200000, v80
    v_fmamk_f32 v88, v89, 0x41200000, v88
    v_cvt_pk_bf16_f32 v22, v77, v85
    v_cvt_pk_bf16_f32 v26, v78, v86
    v_cvt_pk_bf16_f32 v66, v79, v87
    v_cvt_pk_bf16_f32 v70, v82, v90
    v_cvt_pk_bf16_f32 v74, v80, v88
    v_lshlrev_b32 v76, 16, v19
    v_and_b32 v84, s25, v19
    v_lshlrev_b32 v77, 16, v23
    v_and_b32 v85, s25, v23
    v_lshlrev_b32 v78, 16, v27
    v_and_b32 v86, s25, v27
    v_lshlrev_b32 v79, 16, v31
    v_and_b32 v87, s25, v31
    v_add_f32 v80, v76, v78
    v_add_f32 v88, v84, v86
    v_add_f32 v81, v77, v79
    v_add_f32 v89, v85, v87
    v_fma_f32 v82, v78, 4.0, v76
    v_fma_f32 v90, v86, 4.0, v84
    v_fma_f32 v83, v79, 4.0, v77
    v_fma_f32 v91, v87, 4.0, v85
    v_add_f32 v77, v80, v81
    v_add_f32 v85, v88, v89
    v_sub_f32 v78, v80, v81
    v_sub_f32 v86, v88, v89
    v_fma_f32 v79, v83, 2.0, v82
    v_fma_f32 v87, v91, 2.0, v90
    v_fma_f32 v82, v83, -2.0, v82
    v_fma_f32 v90, v91, -2.0, v90
    v_fmamk_f32 v80, v76, 0x41700000, v82
    v_fmamk_f32 v88, v84, 0x41700000, v90
    v_fmamk_f32 v80, v81, 0x41200000, v80
    v_fmamk_f32 v88, v89, 0x41200000, v88
    v_cvt_pk_bf16_f32 v23, v77, v85
    v_cvt_pk_bf16_f32 v27, v78, v86
    v_cvt_pk_bf16_f32 v67, v79, v87
    v_cvt_pk_bf16_f32 v71, v82, v90
    v_cvt_pk_bf16_f32 v75, v80, v88
    ds_write_b128 v96, v[64:67] offset:57344
    ds_write_b128 v97, v[68:71] offset:8192
    ds_write_b128 v97, v[72:75] offset:24576
    ds_write_b128 v96, v[16:19] offset:8192
    ds_write_b128 v96, v[20:23] offset:24576
    ds_write_b128 v96, v[24:27] offset:40960
    ds_write_b128 v98, v[28:31] offset:8704
    s_add_u32 s28, s28, 1
    s_waitcnt lgkmcnt(0)
    s_barrier
    s_cmp_lt_u32 s28, 13
    s_cselect_b32 s24, 0, 2130706432
    s_waitcnt vmcnt(0)
    v_lshlrev_b32 v76, 16, v32
    v_and_b32 v84, s25, v32
    v_lshlrev_b32 v77, 16, v36
    v_and_b32 v85, s25, v36
    v_lshlrev_b32 v78, 16, v40
    v_and_b32 v86, s25, v40
    v_lshlrev_b32 v79, 16, v44
    v_and_b32 v87, s25, v44
    v_add_f32 v80, v76, v78
    v_add_f32 v88, v84, v86
    v_add_f32 v81, v77, v79
    v_add_f32 v89, v85, v87
    v_fma_f32 v82, v78, 4.0, v76
    v_fma_f32 v90, v86, 4.0, v84
    v_fma_f32 v83, v79, 4.0, v77
    v_fma_f32 v91, v87, 4.0, v85
    v_add_f32 v77, v80, v81
    v_add_f32 v85, v88, v89
    v_sub_f32 v78, v80, v81
    v_sub_f32 v86, v88, v89
    v_fma_f32 v79, v83, 2.0, v82
    v_fma_f32 v87, v91, 2.0, v90
    v_fma_f32 v82, v83, -2.0, v82
    v_fma_f32 v90, v91, -2.0, v90
    v_fmamk_f32 v80, v76, 0x41700000, v82
    v_fmamk_f32 v88, v84, 0x41700000, v90
    buffer_load_dwordx4 v[0:3], v92, s[8:11], s24 offen offset:0
    buffer_load_dwordx4 v[16:19], v92, s[8:11], s24 offen offset:64
    v_add_u32 v92, 128, v92
    v_fmamk_f32 v80, v81, 0x41200000, v80
    v_fmamk_f32 v88, v89, 0x41200000, v88
    v_cvt_pk_bf16_f32 v36, v77, v85
    v_cvt_pk_bf16_f32 v40, v78, v86
    v_cvt_pk_bf16_f32 v64, v79, v87
    v_cvt_pk_bf16_f32 v68, v82, v90
    v_cvt_pk_bf16_f32 v72, v80, v88
    v_lshlrev_b32 v76, 16, v33
    v_and_b32 v84, s25, v33
    v_lshlrev_b32 v77, 16, v37
    v_and_b32 v85, s25, v37
    v_lshlrev_b32 v78, 16, v41
    v_and_b32 v86, s25, v41
    v_lshlrev_b32 v79, 16, v45
    v_and_b32 v87, s25, v45
    v_add_f32 v80, v76, v78
    v_add_f32 v88, v84, v86
    v_add_f32 v81, v77, v79
    v_add_f32 v89, v85, v87
    v_fma_f32 v82, v78, 4.0, v76
    v_fma_f32 v90, v86, 4.0, v84
    v_fma_f32 v83, v79, 4.0, v77
    v_fma_f32 v91, v87, 4.0, v85
    v_add_f32 v77, v80, v81
    v_add_f32 v85, v88, v89
    v_sub_f32 v78, v80, v81
    buffer_load_dwordx4 v[4:7], v93, s[8:11], s24 offen offset:0
    buffer_load_dwordx4 v[20:23], v93, s[8:11], s24 offen offset:64
    v_add_u32 v93, 128, v93
    v_sub_f32 v86, v88, v89
    v_fma_f32 v79, v83, 2.0, v82
    v_fma_f32 v87, v91, 2.0, v90
    v_fma_f32 v82, v83, -2.0, v82
    v_fma_f32 v90, v91, -2.0, v90
    v_fmamk_f32 v80, v76, 0x41700000, v82
    v_fmamk_f32 v88, v84, 0x41700000, v90
    v_fmamk_f32 v80, v81, 0x41200000, v80
    v_fmamk_f32 v88, v89, 0x41200000, v88
    v_cvt_pk_bf16_f32 v37, v77, v85
    v_cvt_pk_bf16_f32 v41, v78, v86
    v_cvt_pk_bf16_f32 v65, v79, v87
    v_cvt_pk_bf16_f32 v69, v82, v90
    v_cvt_pk_bf16_f32 v73, v80, v88
    v_lshlrev_b32 v76, 16, v34
    v_and_b32 v84, s25, v34
    v_lshlrev_b32 v77, 16, v38
    v_and_b32 v85, s25, v38
    v_lshlrev_b32 v78, 16, v42
    v_and_b32 v86, s25, v42
    v_lshlrev_b32 v79, 16, v46
    v_and_b32 v87, s25, v46
    v_add_f32 v80, v76, v78
    v_add_f32 v88, v84, v86
    v_add_f32 v81, v77, v79
    v_add_f32 v89, v85, v87
    v_fma_f32 v82, v78, 4.0, v76
    v_fma_f32 v90, v86, 4.0, v84
    v_fma_f32 v83, v79, 4.0, v77
    v_fma_f32 v91, v87, 4.0, v85
    v_add_f32 v77, v80, v81
    v_add_f32 v85, v88, v89
    v_sub_f32 v78, v80, v81
    v_sub_f32 v86, v88, v89
    v_fma_f32 v79, v83, 2.0, v82
    v_fma_f32 v87, v91, 2.0, v90
    v_fma_f32 v82, v83, -2.0, v82
    v_fma_f32 v90, v91, -2.0, v90
    v_fmamk_f32 v80, v76, 0x41700000, v82
    v_fmamk_f32 v88, v84, 0x41700000, v90
    v_fmamk_f32 v80, v81, 0x41200000, v80
    v_fmamk_f32 v88, v89, 0x41200000, v88
    v_cvt_pk_bf16_f32 v38, v77, v85
    v_cvt_pk_bf16_f32 v42, v78, v86
    v_cvt_pk_bf16_f32 v66, v79, v87
    v_cvt_pk_bf16_f32 v70, v82, v90
    v_cvt_pk_bf16_f32 v74, v80, v88
    v_lshlrev_b32 v76, 16, v35
    v_and_b32 v84, s25, v35
    v_lshlrev_b32 v77, 16, v39
    v_and_b32 v85, s25, v39
    v_lshlrev_b32 v78, 16, v43
    v_and_b32 v86, s25, v43
    v_lshlrev_b32 v79, 16, v47
    v_and_b32 v87, s25, v47
    v_add_f32 v80, v76, v78
    v_add_f32 v88, v84, v86
    v_add_f32 v81, v77, v79
    v_add_f32 v89, v85, v87
    v_fma_f32 v82, v78, 4.0, v76
    v_fma_f32 v90, v86, 4.0, v84
    v_fma_f32 v83, v79, 4.0, v77
    v_fma_f32 v91, v87, 4.0, v85
    v_add_f32 v77, v80, v81
    v_add_f32 v85, v88, v89
    v_sub_f32 v78, v80, v81
    v_sub_f32 v86, v88, v89
    v_fma_f32 v79, v83, 2.0, v82
    v_fma_f32 v87, v91, 2.0, v90
    v_fma_f32 v82, v83, -2.0, v82
    v_fma_f32 v90, v91, -2.0, v90
    v_fmamk_f32 v80, v76, 0x41700000, v82
    v_fmamk_f32 v88, v84, 0x41700000, v90
    v_fmamk_f32 v80, v81, 0x41200000, v80
    v_fmamk_f32 v88, v89, 0x41200000, v88
    v_cvt_pk_bf16_f32 v39, v77, v85
    v_cvt_pk_bf16_f32 v43, v78, v86
    v_cvt_pk_bf16_f32 v67, v79, v87
    v_cvt_pk_bf16_f32 v71, v82, v90
    v_cvt_pk_bf16_f32 v75, v80, v88
    ds_write_b128 v96, v[64:67] offset:49152
    ds_write_b128 v97, v[68:71] offset:0
    ds_write_b128 v97, v[72:75] offset:16384
    ds_write_b128 v96, v[32:35] offset:0
    ds_write_b128 v96, v[36:39] offset:16384
    ds_write_b128 v96, v[40:43] offset:32768
    ds_write_b128 v98, v[44:47] offset:0
    s_add_u32 s28, s28, 1
    s_waitcnt lgkmcnt(0)
    s_barrier
    s_cmp_lt_u32 s28, 13
    s_cselect_b32 s24, 0, 2130706432
    v_lshlrev_b32 v76, 16, v48
    v_and_b32 v84, s25, v48
    v_lshlrev_b32 v77, 16, v52
    v_and_b32 v85, s25, v52
    v_lshlrev_b32 v78, 16, v56
    v_and_b32 v86, s25, v56
    v_lshlrev_b32 v79, 16, v60
    v_and_b32 v87, s25, v60
    v_add_f32 v80, v76, v78
    v_add_f32 v88, v84, v86
    v_add_f32 v81, v77, v79
    v_add_f32 v89, v85, v87
    v_fma_f32 v82, v78, 4.0, v76
    v_fma_f32 v90, v86, 4.0, v84
    v_fma_f32 v83, v79, 4.0, v77
    v_fma_f32 v91, v87, 4.0, v85
    v_add_f32 v77, v80, v81
    v_add_f32 v85, v88, v89
    v_sub_f32 v78, v80, v81
    v_sub_f32 v86, v88, v89
    v_fma_f32 v79, v83, 2.0, v82
    v_fma_f32 v87, v91, 2.0, v90
    v_fma_f32 v82, v83, -2.0, v82
    v_fma_f32 v90, v91, -2.0, v90
    v_fmamk_f32 v80, v76, 0x41700000, v82
    v_fmamk_f32 v88, v84, 0x41700000, v90
    buffer_load_dwordx4 v[8:11], v94, s[8:11], s24 offen offset:0
    buffer_load_dwordx4 v[24:27], v94, s[8:11], s24 offen offset:64
    v_add_u32 v94, 128, v94
    v_fmamk_f32 v80, v81, 0x41200000, v80
    v_fmamk_f32 v88, v89, 0x41200000, v88
    v_cvt_pk_bf16_f32 v52, v77, v85
    v_cvt_pk_bf16_f32 v56, v78, v86
    v_cvt_pk_bf16_f32 v64, v79, v87
    v_cvt_pk_bf16_f32 v68, v82, v90
    v_cvt_pk_bf16_f32 v72, v80, v88
    v_lshlrev_b32 v76, 16, v49
    v_and_b32 v84, s25, v49
    v_lshlrev_b32 v77, 16, v53
    v_and_b32 v85, s25, v53
    v_lshlrev_b32 v78, 16, v57
    v_and_b32 v86, s25, v57
    v_lshlrev_b32 v79, 16, v61
    v_and_b32 v87, s25, v61
    v_add_f32 v80, v76, v78
    v_add_f32 v88, v84, v86
    v_add_f32 v81, v77, v79
    v_add_f32 v89, v85, v87
    v_fma_f32 v82, v78, 4.0, v76
    v_fma_f32 v90, v86, 4.0, v84
    v_fma_f32 v83, v79, 4.0, v77
    v_fma_f32 v91, v87, 4.0, v85
    v_add_f32 v77, v80, v81
    v_add_f32 v85, v88, v89
    v_sub_f32 v78, v80, v81
    buffer_load_dwordx4 v[12:15], v95, s[8:11], s24 offen offset:0
    buffer_load_dwordx4 v[28:31], v95, s[8:11], s24 offen offset:64
    v_add_u32 v95, 128, v95
    v_sub_f32 v86, v88, v89
    v_fma_f32 v79, v83, 2.0, v82
    v_fma_f32 v87, v91, 2.0, v90
    v_fma_f32 v82, v83, -2.0, v82
    v_fma_f32 v90, v91, -2.0, v90
    v_fmamk_f32 v80, v76, 0x41700000, v82
    v_fmamk_f32 v88, v84, 0x41700000, v90
    v_fmamk_f32 v80, v81, 0x41200000, v80
    v_fmamk_f32 v88, v89, 0x41200000, v88
    v_cvt_pk_bf16_f32 v53, v77, v85
    v_cvt_pk_bf16_f32 v57, v78, v86
    v_cvt_pk_bf16_f32 v65, v79, v87
    v_cvt_pk_bf16_f32 v69, v82, v90
    v_cvt_pk_bf16_f32 v73, v80, v88
    v_lshlrev_b32 v76, 16, v50
    v_and_b32 v84, s25, v50
    v_lshlrev_b32 v77, 16, v54
    v_and_b32 v85, s25, v54
    v_lshlrev_b32 v78, 16, v58
    v_and_b32 v86, s25, v58
    v_lshlrev_b32 v79, 16, v62
    v_and_b32 v87, s25, v62
    v_add_f32 v80, v76, v78
    v_add_f32 v88, v84, v86
    v_add_f32 v81, v77, v79
    v_add_f32 v89, v85, v87
    v_fma_f32 v82, v78, 4.0, v76
    v_fma_f32 v90, v86, 4.0, v84
    v_fma_f32 v83, v79, 4.0, v77
    v_fma_f32 v91, v87, 4.0, v85
    v_add_f32 v77, v80, v81
    v_add_f32 v85, v88, v89
    v_sub_f32 v78, v80, v81
    v_sub_f32 v86, v88, v89
    v_fma_f32 v79, v83, 2.0, v82
    v_fma_f32 v87, v91, 2.0, v90
    v_fma_f32 v82, v83, -2.0, v82
    v_fma_f32 v90, v91, -2.0, v90
    v_fmamk_f32 v80, v76, 0x41700000, v82
    v_fmamk_f32 v88, v84, 0x41700000, v90
    v_fmamk_f32 v80, v81, 0x41200000, v80
    v_fmamk_f32 v88, v89, 0x41200000, v88
    v_cvt_pk_bf16_f32 v54, v77, v85
    v_cvt_pk_bf16_f32 v58, v78, v86
    v_cvt_pk_bf16_f32 v66, v79, v87
    v_cvt_pk_bf16_f32 v70, v82, v90
    v_cvt_pk_bf16_f32 v74, v80, v88
    v_lshlrev_b32 v76, 16, v51
    v_and_b32 v84, s25, v51
    v_lshlrev_b32 v77, 16, v55
    v_and_b32 v85, s25, v55
    v_lshlrev_b32 v78, 16, v59
    v_and_b32 v86, s25, v59
    v_lshlrev_b32 v79, 16, v63
    v_and_b32 v87, s25, v63
    v_add_f32 v80, v76, v78
    v_add_f32 v88, v84, v86
    v_add_f32 v81, v77, v79
    v_add_f32 v89, v85, v87
    v_fma_f32 v82, v78, 4.0, v76
    v_fma_f32 v90, v86, 4.0, v84
    v_fma_f32 v83, v79, 4.0, v77
    v_fma_f32 v91, v87, 4.0, v85
    v_add_f32 v77, v80, v81
    v_add_f32 v85, v88, v89
    v_sub_f32 v78, v80, v81
    v_sub_f32 v86, v88, v89
    v_fma_f32 v79, v83, 2.0, v82
    v_fma_f32 v87, v91, 2.0, v90
    v_fma_f32 v82, v83, -2.0, v82
    v_fma_f32 v90, v91, -2.0, v90
    v_fmamk_f32 v80, v76, 0x41700000, v82
    v_fmamk_f32 v88, v84, 0x41700000, v90
    v_fmamk_f32 v80, v81, 0x41200000, v80
    v_fmamk_f32 v88, v89, 0x41200000, v88
    v_cvt_pk_bf16_f32 v55, v77, v85
    v_cvt_pk_bf16_f32 v59, v78, v86
    v_cvt_pk_bf16_f32 v67, v79, v87
    v_cvt_pk_bf16_f32 v71, v82, v90
    v_cvt_pk_bf16_f32 v75, v80, v88
    ds_write_b128 v96, v[64:67] offset:57344
    ds_write_b128 v97, v[68:71] offset:8192
    ds_write_b128 v97, v[72:75] offset:24576
    ds_write_b128 v96, v[48:51] offset:8192
    ds_write_b128 v96, v[52:55] offset:24576
    ds_write_b128 v96, v[56:59] offset:40960
    ds_write_b128 v98, v[60:63] offset:8704
    s_add_u32 s28, s28, 1
    s_waitcnt lgkmcnt(0)
    s_barrier
    s_cmp_eq_u32 s22, 1
    s_cbranch_scc1 L_conv1_kernel_hlast1
    s_cmp_lt_u32 s28, 13
    s_cselect_b32 s24, 0, 2130706432
    s_waitcnt vmcnt(0)
    v_lshlrev_b32 v76, 16, v0
    v_and_b32 v84, s25, v0
    v_lshlrev_b32 v77, 16, v4
    v_and_b32 v85, s25, v4
    v_lshlrev_b32 v78, 16, v8
    v_and_b32 v86, s25, v8
    v_lshlrev_b32 v79, 16, v12
    v_and_b32 v87, s25, v12
    v_add_f32 v80, v76, v78
    v_add_f32 v88, v84, v86
    v_add_f32 v81, v77, v79
    v_add_f32 v89, v85, v87
    v_fma_f32 v82, v78, 4.0, v76
    v_fma_f32 v90, v86, 4.0, v84
    v_fma_f32 v83, v79, 4.0, v77
    v_fma_f32 v91, v87, 4.0, v85
    v_add_f32 v77, v80, v81
    v_add_f32 v85, v88, v89
    v_sub_f32 v78, v80, v81
    v_sub_f32 v86, v88, v89
    v_fma_f32 v79, v83, 2.0, v82
    v_fma_f32 v87, v91, 2.0, v90
    v_fma_f32 v82, v83, -2.0, v82
    v_fma_f32 v90, v91, -2.0, v90
    v_fmamk_f32 v80, v76, 0x41700000, v82
    v_fmamk_f32 v88, v84, 0x41700000, v90
    buffer_load_dwordx4 v[32:35], v92, s[8:11], s24 offen offset:0
    buffer_load_dwordx4 v[48:51], v92, s[8:11], s24 offen offset:64
    v_add_u32 v92, 128, v92
    v_fmamk_f32 v80, v81, 0x41200000, v80
    v_fmamk_f32 v88, v89, 0x41200000, v88
    v_cvt_pk_bf16_f32 v4, v77, v85
    v_cvt_pk_bf16_f32 v8, v78, v86
    v_cvt_pk_bf16_f32 v64, v79, v87
    v_cvt_pk_bf16_f32 v68, v82, v90
    v_cvt_pk_bf16_f32 v72, v80, v88
    v_lshlrev_b32 v76, 16, v1
    v_and_b32 v84, s25, v1
    v_lshlrev_b32 v77, 16, v5
    v_and_b32 v85, s25, v5
    v_lshlrev_b32 v78, 16, v9
    v_and_b32 v86, s25, v9
    v_lshlrev_b32 v79, 16, v13
    v_and_b32 v87, s25, v13
    v_add_f32 v80, v76, v78
    v_add_f32 v88, v84, v86
    v_add_f32 v81, v77, v79
    v_add_f32 v89, v85, v87
    v_fma_f32 v82, v78, 4.0, v76
    v_fma_f32 v90, v86, 4.0, v84
    v_fma_f32 v83, v79, 4.0, v77
    v_fma_f32 v91, v87, 4.0, v85
    v_add_f32 v77, v80, v81
    v_add_f32 v85, v88, v89
    v_sub_f32 v78, v80, v81
    buffer_load_dwordx4 v[36:39], v93, s[8:11], s24 offen offset:0
    buffer_load_dwordx4 v[52:55], v93, s[8:11], s24 offen offset:64
    v_add_u32 v93, 128, v93
    v_sub_f32 v86, v88, v89
    v_fma_f32 v79, v83, 2.0, v82
    v_fma_f32 v87, v91, 2.0, v90
    v_fma_f32 v82, v83, -2.0, v82
    v_fma_f32 v90, v91, -2.0, v90
    v_fmamk_f32 v80, v76, 0x41700000, v82
    v_fmamk_f32 v88, v84, 0x41700000, v90
    v_fmamk_f32 v80, v81, 0x41200000, v80
    v_fmamk_f32 v88, v89, 0x41200000, v88
    v_cvt_pk_bf16_f32 v5, v77, v85
    v_cvt_pk_bf16_f32 v9, v78, v86
    v_cvt_pk_bf16_f32 v65, v79, v87
    v_cvt_pk_bf16_f32 v69, v82, v90
    v_cvt_pk_bf16_f32 v73, v80, v88
    v_lshlrev_b32 v76, 16, v2
    v_and_b32 v84, s25, v2
    v_lshlrev_b32 v77, 16, v6
    v_and_b32 v85, s25, v6
    v_lshlrev_b32 v78, 16, v10
    v_and_b32 v86, s25, v10
    v_lshlrev_b32 v79, 16, v14
    v_and_b32 v87, s25, v14
    v_add_f32 v80, v76, v78
    v_add_f32 v88, v84, v86
    v_add_f32 v81, v77, v79
    v_add_f32 v89, v85, v87
    v_fma_f32 v82, v78, 4.0, v76
    v_fma_f32 v90, v86, 4.0, v84
    v_fma_f32 v83, v79, 4.0, v77
    v_fma_f32 v91, v87, 4.0, v85
    v_add_f32 v77, v80, v81
    v_add_f32 v85, v88, v89
    v_sub_f32 v78, v80, v81
    v_sub_f32 v86, v88, v89
    v_fma_f32 v79, v83, 2.0, v82
    v_fma_f32 v87, v91, 2.0, v90
    v_fma_f32 v82, v83, -2.0, v82
    v_fma_f32 v90, v91, -2.0, v90
    v_fmamk_f32 v80, v76, 0x41700000, v82
    v_fmamk_f32 v88, v84, 0x41700000, v90
    v_fmamk_f32 v80, v81, 0x41200000, v80
    v_fmamk_f32 v88, v89, 0x41200000, v88
    v_cvt_pk_bf16_f32 v6, v77, v85
    v_cvt_pk_bf16_f32 v10, v78, v86
    v_cvt_pk_bf16_f32 v66, v79, v87
    v_cvt_pk_bf16_f32 v70, v82, v90
    v_cvt_pk_bf16_f32 v74, v80, v88
    v_lshlrev_b32 v76, 16, v3
    v_and_b32 v84, s25, v3
    v_lshlrev_b32 v77, 16, v7
    v_and_b32 v85, s25, v7
    v_lshlrev_b32 v78, 16, v11
    v_and_b32 v86, s25, v11
    v_lshlrev_b32 v79, 16, v15
    v_and_b32 v87, s25, v15
    v_add_f32 v80, v76, v78
    v_add_f32 v88, v84, v86
    v_add_f32 v81, v77, v79
    v_add_f32 v89, v85, v87
    v_fma_f32 v82, v78, 4.0, v76
    v_fma_f32 v90, v86, 4.0, v84
    v_fma_f32 v83, v79, 4.0, v77
    v_fma_f32 v91, v87, 4.0, v85
    v_add_f32 v77, v80, v81
    v_add_f32 v85, v88, v89
    v_sub_f32 v78, v80, v81
    v_sub_f32 v86, v88, v89
    v_fma_f32 v79, v83, 2.0, v82
    v_fma_f32 v87, v91, 2.0, v90
    v_fma_f32 v82, v83, -2.0, v82
    v_fma_f32 v90, v91, -2.0, v90
    v_fmamk_f32 v80, v76, 0x41700000, v82
    v_fmamk_f32 v88, v84, 0x41700000, v90
    v_fmamk_f32 v80, v81, 0x41200000, v80
    v_fmamk_f32 v88, v89, 0x41200000, v88
    v_cvt_pk_bf16_f32 v7, v77, v85
    v_cvt_pk_bf16_f32 v11, v78, v86
    v_cvt_pk_bf16_f32 v67, v79, v87
    v_cvt_pk_bf16_f32 v71, v82, v90
    v_cvt_pk_bf16_f32 v75, v80, v88
    ds_write_b128 v96, v[64:67] offset:49152
    ds_write_b128 v97, v[68:71] offset:0
    ds_write_b128 v97, v[72:75] offset:16384
    ds_write_b128 v96, v[0:3] offset:0
    ds_write_b128 v96, v[4:7] offset:16384
    ds_write_b128 v96, v[8:11] offset:32768
    ds_write_b128 v98, v[12:15] offset:0
    s_add_u32 s28, s28, 1
    s_waitcnt lgkmcnt(0)
    s_barrier
    s_sub_u32 s22, s22, 1
    s_branch L_conv1_kernel_hloop1
L_conv1_kernel_hlast1:
    s_cmp_ge_u32 s2, 32
    s_cbranch_scc1 L_conv1_kernel_ntw
    s_getpc_b64 s[36:37]
L_conv1_kernel_pc:
    s_lshl_b32 s38, s32, 13
    s_add_u32 s38, s38, L_conv1_kernel_epi-L_conv1_kernel_pc
    v_lshl_add_u32 v2, v127, 7, s38
    v_min_u32 v2, L_conv2_kernel_done-L_conv1_kernel_pc, v2
    v_mov_b32 v3, s37
    v_add_co_u32 v2, vcc, s36, v2
    s_nop 1
    v_addc_co_u32 v3, vcc, 0, v3, vcc
    global_load_dword v4, v[2:3], off
L_conv1_kernel_ntw:
    s_endpgm
L_conv1_kernel_h2:
    s_waitcnt lgkmcnt(0)
    s_barrier
    buffer_load_dwordx4 v[32:35], v92, s[8:11], s24 offen offset:0
    buffer_load_dwordx4 v[48:51], v92, s[8:11], s24 offen offset:64
    v_add_u32 v92, 128, v92
    buffer_load_dwordx4 v[36:39], v93, s[8:11], s24 offen offset:0
    buffer_load_dwordx4 v[52:55], v93, s[8:11], s24 offen offset:64
    v_add_u32 v93, 128, v93
    buffer_load_dwordx4 v[40:43], v94, s[8:11], s24 offen offset:0
    buffer_load_dwordx4 v[56:59], v94, s[8:11], s24 offen offset:64
    v_add_u32 v94, 128, v94
    buffer_load_dwordx4 v[44:47], v95, s[8:11], s24 offen offset:0
    buffer_load_dwordx4 v[60:63], v95, s[8:11], s24 offen offset:64
    v_add_u32 v95, 128, v95
    s_setprio 0
    v_lshlrev_b32 v76, 16, v16
    v_and_b32 v84, s25, v16
    v_lshlrev_b32 v77, 16, v20
    v_and_b32 v85, s25, v20
    v_lshlrev_b32 v78, 16, v24
    v_and_b32 v86, s25, v24
    v_lshlrev_b32 v79, 16, v28
    v_and_b32 v87, s25, v28
    v_add_f32 v80, v76, v78
    v_add_f32 v88, v84, v86
    v_add_f32 v81, v77, v79
    v_add_f32 v89, v85, v87
    v_fma_f32 v82, v78, 4.0, v76
    v_fma_f32 v90, v86, 4.0, v84
    v_fma_f32 v83, v79, 4.0, v77
    v_fma_f32 v91, v87, 4.0, v85
    v_add_f32 v77, v80, v81
    v_add_f32 v85, v88, v89
    v_sub_f32 v78, v80, v81
    v_sub_f32 v86, v88, v89
    v_fma_f32 v79, v83, 2.0, v82
    v_fma_f32 v87, v91, 2.0, v90
    v_fma_f32 v82, v83, -2.0, v82
    v_fma_f32 v90, v91, -2.0, v90
    v_fmamk_f32 v80, v76, 0x41700000, v82
    v_fmamk_f32 v88, v84, 0x41700000, v90
    v_fmamk_f32 v80, v81, 0x41200000, v80
    v_fmamk_f32 v88, v89, 0x41200000, v88
    v_cvt_pk_bf16_f32 v20, v77, v85
    v_cvt_pk_bf16_f32 v24, v78, v86
    v_cvt_pk_bf16_f32 v64, v79, v87
    v_cvt_pk_bf16_f32 v68, v82, v90
    v_cvt_pk_bf16_f32 v72, v80, v88
    v_lshlrev_b32 v76, 16, v17
    v_and_b32 v84, s25, v17
    v_lshlrev_b32 v77, 16, v21
    v_and_b32 v85, s25, v21
    v_lshlrev_b32 v78, 16, v25
    v_and_b32 v86, s25, v25
    v_lshlrev_b32 v79, 16, v29
    v_and_b32 v87, s25, v29
    v_add_f32 v80, v76, v78
    v_add_f32 v88, v84, v86
    v_add_f32 v81, v77, v79
    v_add_f32 v89, v85, v87
    v_fma_f32 v82, v78, 4.0, v76
    v_fma_f32 v90, v86, 4.0, v84
    v_fma_f32 v83, v79, 4.0, v77
    v_fma_f32 v91, v87, 4.0, v85
    v_add_f32 v77, v80, v81
    v_add_f32 v85, v88, v89
    v_sub_f32 v78, v80, v81
    v_sub_f32 v86, v88, v89
    v_fma_f32 v79, v83, 2.0, v82
    v_fma_f32 v87, v91, 2.0, v90
    v_fma_f32 v82, v83, -2.0, v82
    v_fma_f32 v90, v91, -2.0, v90
    v_fmamk_f32 v80, v76, 0x41700000, v82
    v_fmamk_f32 v88, v84, 0x41700000, v90
    v_fmamk_f32 v80, v81, 0x41200000, v80
    v_fmamk_f32 v88, v89, 0x41200000, v88
    v_cvt_pk_bf16_f32 v21, v77, v85
    v_cvt_pk_bf16_f32 v25, v78, v86
    v_cvt_pk_bf16_f32 v65, v79, v87
    v_cvt_pk_bf16_f32 v69, v82, v90
    v_cvt_pk_bf16_f32 v73, v80, v88
    v_lshlrev_b32 v76, 16, v18
    v_and_b32 v84, s25, v18
    v_lshlrev_b32 v77, 16, v22
    v_and_b32 v85, s25, v22
    v_lshlrev_b32 v78, 16, v26
    v_and_b32 v86, s25, v26
    v_lshlrev_b32 v79, 16, v30
    v_and_b32 v87, s25, v30
    v_add_f32 v80, v76, v78
    v_add_f32 v88, v84, v86
    v_add_f32 v81, v77, v79
    v_add_f32 v89, v85, v87
    v_fma_f32 v82, v78, 4.0, v76
    v_fma_f32 v90, v86, 4.0, v84
    v_fma_f32 v83, v79, 4.0, v77
    v_fma_f32 v91, v87, 4.0, v85
    v_add_f32 v77, v80, v81
    v_add_f32 v85, v88, v89
    v_sub_f32 v78, v80, v81
    v_sub_f32 v86, v88, v89
    v_fma_f32 v79, v83, 2.0, v82
    v_fma_f32 v87, v91, 2.0, v90
    v_fma_f32 v82, v83, -2.0, v82
    v_fma_f32 v90, v91, -2.0, v90
    v_fmamk_f32 v80, v76, 0x41700000, v82
    v_fmamk_f32 v88, v84, 0x41700000, v90
    v_fmamk_f32 v80, v81, 0x41200000, v80
    v_fmamk_f32 v88, v89, 0x41200000, v88
    v_cvt_pk_bf16_f32 v22, v77, v85
    v_cvt_pk_bf16_f32 v26, v78, v86
    v_cvt_pk_bf16_f32 v66, v79, v87
    v_cvt_pk_bf16_f32 v70, v82, v90
    v_cvt_pk_bf16_f32 v74, v80, v88
    v_lshlrev_b32 v76, 16, v19
    v_and_b32 v84, s25, v19
    v_lshlrev_b32 v77, 16, v23
    v_and_b32 v85, s25, v23
    v_lshlrev_b32 v78, 16, v27
    v_and_b32 v86, s25, v27
    v_lshlrev_b32 v79, 16, v31
    v_and_b32 v87, s25, v31
    v_add_f32 v80, v76, v78
    v_add_f32 v88, v84, v86
    v_add_f32 v81, v77, v79
    v_add_f32 v89, v85, v87
    v_fma_f32 v82, v78, 4.0, v76
    v_fma_f32 v90, v86, 4.0, v84
    v_fma_f32 v83, v79, 4.0, v77
    v_fma_f32 v91, v87, 4.0, v85
    v_add_f32 v77, v80, v81
    v_add_f32 v85, v88, v89
    v_sub_f32 v78, v80, v81
    v_sub_f32 v86, v88, v89
    v_fma_f32 v79, v83, 2.0, v82
    v_fma_f32 v87, v91, 2.0, v90
    v_fma_f32 v82, v83, -2.0, v82
    v_fma_f32 v90, v91, -2.0, v90
    v_fmamk_f32 v80, v76, 0x41700000, v82
    v_fmamk_f32 v88, v84, 0x41700000, v90
    v_fmamk_f32 v80, v81, 0x41200000, v80
    v_fmamk_f32 v88, v89, 0x41200000, v88
    v_cvt_pk_bf16_f32 v23, v77, v85
    v_cvt_pk_bf16_f32 v27, v78, v86
    v_cvt_pk_bf16_f32 v67, v79, v87
    v_cvt_pk_bf16_f32 v71, v82, v90
    v_cvt_pk_bf16_f32 v75, v80, v88
L_conv1_kernel_hloop2:
    s_cmp_lt_u32 s28, 12
    s_cselect_b32 s24, 0, 2130706432
    ds_write_b128 v96, v[64:67] offset:57344
    ds_write_b128 v97, v[68:71] offset:8192
    ds_write_b128 v97, v[72:75] offset:24576
    ds_write_b128 v96, v[16:19] offset:8192
    ds_write_b128 v96, v[20:23] offset:24576
    ds_write_b128 v96, v[24:27] offset:40960
    ds_write_b128 v98, v[28:31] offset:8704
    s_waitcnt vmcnt(0)
    v_lshlrev_b32 v76, 16, v32
    v_and_b32 v84, s25, v32
    v_lshlrev_b32 v77, 16, v36
    v_and_b32 v85, s25, v36
    v_lshlrev_b32 v78, 16, v40
    v_and_b32 v86, s25, v40
    v_lshlrev_b32 v79, 16, v44
    v_and_b32 v87, s25, v44
    v_add_f32 v80, v76, v78
    v_add_f32 v88, v84, v86
    v_add_f32 v81, v77, v79
    v_add_f32 v89, v85, v87
    v_fma_f32 v82, v78, 4.0, v76
    v_fma_f32 v90, v86, 4.0, v84
    v_fma_f32 v83, v79, 4.0, v77
    v_fma_f32 v91, v87, 4.0, v85
    v_add_f32 v77, v80, v81
    v_add_f32 v85, v88, v89
    v_sub_f32 v78, v80, v81
    v_sub_f32 v86, v88, v89
    v_fma_f32 v79, v83, 2.0, v82
    v_fma_f32 v87, v91, 2.0, v90
    v_fma_f32 v82, v83, -2.0, v82
    v_fma_f32 v90, v91, -2.0, v90
    v_fmamk_f32 v80, v76, 0x41700000, v82
    v_fmamk_f32 v88, v84, 0x41700000, v90
    v_fmamk_f32 v80, v81, 0x41200000, v80
    v_fmamk_f32 v88, v89, 0x41200000, v88
    v_cvt_pk_bf16_f32 v36, v77, v85
    v_cvt_pk_bf16_f32 v40, v78, v86
    v_cvt_pk_bf16_f32 v64, v79, v87
    v_cvt_pk_bf16_f32 v68, v82, v90
    v_cvt_pk_bf16_f32 v72, v80, v88
    v_lshlrev_b32 v76, 16, v33
    v_and_b32 v84, s25, v33
    v_lshlrev_b32 v77, 16, v37
    v_and_b32 v85, s25, v37
    v_lshlrev_b32 v78, 16, v41
    v_and_b32 v86, s25, v41
    buffer_load_dwordx4 v[0:3], v92, s[8:11], s24 offen offset:0
    buffer_load_dwordx4 v[16:19], v92, s[8:11], s24 offen offset:64
    v_add_u32 v92, 128, v92
    v_lshlrev_b32 v79, 16, v45
    v_and_b32 v87, s25, v45
    v_add_f32 v80, v76, v78
    v_add_f32 v88, v84, v86
    v_add_f32 v81, v77, v79
    v_add_f32 v89, v85, v87
    v_fma_f32 v82, v78, 4.0, v76
    v_fma_f32 v90, v86, 4.0, v84
    v_fma_f32 v83, v79, 4.0, v77
    v_fma_f32 v91, v87, 4.0, v85
    v_add_f32 v77, v80, v81
    v_add_f32 v85, v88, v89
    v_sub_f32 v78, v80, v81
    v_sub_f32 v86, v88, v89
    v_fma_f32 v79, v83, 2.0, v82
    v_fma_f32 v87, v91, 2.0, v90
    v_fma_f32 v82, v83, -2.0, v82
    v_fma_f32 v90, v91, -2.0, v90
    v_fmamk_f32 v80, v76, 0x41700000, v82
    v_fmamk_f32 v88, v84, 0x41700000, v90
    v_fmamk_f32 v80, v81, 0x41200000, v80
    v_fmamk_f32 v88, v89, 0x41200000, v88
    v_cvt_pk_bf16_f32 v37, v77, v85
    v_cvt_pk_bf16_f32 v41, v78, v86
    v_cvt_pk_bf16_f32 v65, v79, v87
    v_cvt_pk_bf16_f32 v69, v82, v90
    v_cvt_pk_bf16_f32 v73, v80, v88
    buffer_load_dwordx4 v[4:7], v93, s[8:11], s24 offen offset:0
    buffer_load_dwordx4 v[20:23], v93, s[8:11], s24 offen offset:64
    v_add_u32 v93, 128, v93
    v_lshlrev_b32 v76, 16, v34
    v_and_b32 v84, s25, v34
    v_lshlrev_b32 v77, 16, v38
    v_and_b32 v85, s25, v38
    v_lshlrev_b32 v78, 16, v42
    v_and_b32 v86, s25, v42
    v_lshlrev_b32 v79, 16, v46
    v_and_b32 v87, s25, v46
    v_add_f32 v80, v76, v78
    v_add_f32 v88, v84, v86
    v_add_f32 v81, v77, v79
    v_add_f32 v89, v85, v87
    v_fma_f32 v82, v78, 4.0, v76
    v_fma_f32 v90, v86, 4.0, v84
    v_fma_f32 v83, v79, 4.0, v77
    v_fma_f32 v91, v87, 4.0, v85
    v_add_f32 v77, v80, v81
    v_add_f32 v85, v88, v89
    v_sub_f32 v78, v80, v81
    v_sub_f32 v86, v88, v89
    v_fma_f32 v79, v83, 2.0, v82
    v_fma_f32 v87, v91, 2.0, v90
    v_fma_f32 v82, v83, -2.0, v82
    v_fma_f32 v90, v91, -2.0, v90
    v_fmamk_f32 v80, v76, 0x41700000, v82
    v_fmamk_f32 v88, v84, 0x41700000, v90
    v_fmamk_f32 v80, v81, 0x41200000, v80
    v_fmamk_f32 v88, v89, 0x41200000, v88
    v_cvt_pk_bf16_f32 v38, v77, v85
    v_cvt_pk_bf16_f32 v42, v78, v86
    v_cvt_pk_bf16_f32 v66, v79, v87
    v_cvt_pk_bf16_f32 v70, v82, v90
    v_cvt_pk_bf16_f32 v74, v80, v88
    v_lshlrev_b32 v76, 16, v35
    v_and_b32 v84, s25, v35
    v_lshlrev_b32 v77, 16, v39
    v_and_b32 v85, s25, v39
    v_lshlrev_b32 v78, 16, v43
    v_and_b32 v86, s25, v43
    v_lshlrev_b32 v79, 16, v47
    v_and_b32 v87, s25, v47
    v_add_f32 v80, v76, v78
    v_add_f32 v88, v84, v86
    v_add_f32 v81, v77, v79
    v_add_f32 v89, v85, v87
    v_fma_f32 v82, v78, 4.0, v76
    v_fma_f32 v90, v86, 4.0, v84
    v_fma_f32 v83, v79, 4.0, v77
    v_fma_f32 v91, v87, 4.0, v85
    v_add_f32 v77, v80, v81
    v_add_f32 v85, v88, v89
    v_sub_f32 v78, v80, v81
    v_sub_f32 v86, v88, v89
    v_fma_f32 v79, v83, 2.0, v82
    v_fma_f32 v87, v91, 2.0, v90
    v_fma_f32 v82, v83, -2.0, v82
    v_fma_f32 v90, v91, -2.0, v90
    v_fmamk_f32 v80, v76, 0x41700000, v82
    v_fmamk_f32 v88, v84, 0x41700000, v90
    v_fmamk_f32 v80, v81, 0x41200000, v80
    v_fmamk_f32 v88, v89, 0x41200000, v88
    v_cvt_pk_bf16_f32 v39, v77, v85
    v_cvt_pk_bf16_f32 v43, v78, v86
    v_cvt_pk_bf16_f32 v67, v79, v87
    v_cvt_pk_bf16_f32 v71, v82, v90
    v_cvt_pk_bf16_f32 v75, v80, v88
    s_add_u32 s28, s28, 1
    s_waitcnt lgkmcnt(0)
    s_barrier
    s_cmp_lt_u32 s28, 12
    s_cselect_b32 s24, 0, 2130706432
    ds_write_b128 v96, v[64:67] offset:49152
    ds_write_b128 v97, v[68:71] offset:0
    ds_write_b128 v97, v[72:75] offset:16384
    ds_write_b128 v96, v[32:35] offset:0
    ds_write_b128 v96, v[36:39] offset:16384
    ds_write_b128 v96, v[40:43] offset:32768
    ds_write_b128 v98, v[44:47] offset:0
    v_lshlrev_b32 v76, 16, v48
    v_and_b32 v84, s25, v48
    v_lshlrev_b32 v77, 16, v52
    v_and_b32 v85, s25, v52
    v_lshlrev_b32 v78, 16, v56
    v_and_b32 v86, s25, v56
    v_lshlrev_b32 v79, 16, v60
    v_and_b32 v87, s25, v60
    v_add_f32 v80, v76, v78
    v_add_f32 v88, v84, v86
    v_add_f32 v81, v77, v79
    v_add_f32 v89, v85, v87
    v_fma_f32 v82, v78, 4.0, v76
    v_fma_f32 v90, v86, 4.0, v84
    v_fma_f32 v83, v79, 4.0, v77
    v_fma_f32 v91, v87, 4.0, v85
    v_add_f32 v77, v80, v81
    v_add_f32 v85, v88, v89
    v_sub_f32 v78, v80, v81
    v_sub_f32 v86, v88, v89
    v_fma_f32 v79, v83, 2.0, v82
    v_fma_f32 v87, v91, 2.0, v90
    v_fma_f32 v82, v83, -2.0, v82
    v_fma_f32 v90, v91, -2.0, v90
    v_fmamk_f32 v80, v76, 0x41700000, v82
    v_fmamk_f32 v88, v84, 0x41700000, v90
    v_fmamk_f32 v80, v81, 0x41200000, v80
    v_fmamk_f32 v88, v89, 0x41200000, v88
    v_cvt_pk_bf16_f32 v52, v77, v85
    v_cvt_pk_bf16_f32 v56, v78, v86
    v_cvt_pk_bf16_f32 v64, v79, v87
    v_cvt_pk_bf16_f32 v68, v82, v90
    v_cvt_pk_bf16_f32 v72, v80, v88
    v_lshlrev_b32 v76, 16, v49
    v_and_b32 v84, s25, v49
    v_lshlrev_b32 v77, 16, v53
    v_and_b32 v85, s25, v53
    v_lshlrev_b32 v78, 16, v57
    v_and_b32 v86, s25, v57
    buffer_load_dwordx4 v[8:11], v94, s[8:11], s24 offen offset:0
    buffer_load_dwordx4 v[24:27], v94, s[8:11], s24 offen offset:64
    v_add_u32 v94, 128, v94
    v_lshlrev_b32 v79, 16, v61
    v_and_b32 v87, s25, v61
    v_add_f32 v80, v76, v78
    v_add_f32 v88, v84, v86
    v_add_f32 v81, v77, v79
    v_add_f32 v89, v85, v87
    v_fma_f32 v82, v78, 4.0, v76
    v_fma_f32 v90, v86, 4.0, v84
    v_fma_f32 v83, v79, 4.0, v77
    v_fma_f32 v91, v87, 4.0, v85
    v_add_f32 v77, v80, v81
    v_add_f32 v85, v88, v89
    v_sub_f32 v78, v80, v81
    v_sub_f32 v86, v88, v89
    v_fma_f32 v79, v83, 2.0, v82
    v_fma_f32 v87, v91, 2.0, v90
    v_fma_f32 v82, v83, -2.0, v82
    v_fma_f32 v90, v91, -2.0, v90
    v_fmamk_f32 v80, v76, 0x41700000, v82
    v_fmamk_f32 v88, v84, 0x41700000, v90
    v_fmamk_f32 v80, v81, 0x41200000, v80
    v_fmamk_f32 v88, v89, 0x41200000, v88
    v_cvt_pk_bf16_f32 v53, v77, v85
    v_cvt_pk_bf16_f32 v57, v78, v86
    v_cvt_pk_bf16_f32 v65, v79, v87
    v_cvt_pk_bf16_f32 v69, v82, v90
    v_cvt_pk_bf16_f32 v73, v80, v88
    buffer_load_dwordx4 v[12:15], v95, s[8:11], s24 offen offset:0
    buffer_load_dwordx4 v[28:31], v95, s[8:11], s24 offen offset:64
    v_add_u32 v95, 128, v95
    v_lshlrev_b32 v76, 16, v50
    v_and_b32 v84, s25, v50
    v_lshlrev_b32 v77, 16, v54
    v_and_b32 v85, s25, v54
    v_lshlrev_b32 v78, 16, v58
    v_and_b32 v86, s25, v58
    v_lshlrev_b32 v79, 16, v62
    v_and_b32 v87, s25, v62
    v_add_f32 v80, v76, v78
    v_add_f32 v88, v84, v86
    v_add_f32 v81, v77, v79
    v_add_f32 v89, v85, v87
    v_fma_f32 v82, v78, 4.0, v76
    v_fma_f32 v90, v86, 4.0, v84
    v_fma_f32 v83, v79, 4.0, v77
    v_fma_f32 v91, v87, 4.0, v85
    v_add_f32 v77, v80, v81
    v_add_f32 v85, v88, v89
    v_sub_f32 v78, v80, v81
    v_sub_f32 v86, v88, v89
    v_fma_f32 v79, v83, 2.0, v82
    v_fma_f32 v87, v91, 2.0, v90
    v_fma_f32 v82, v83, -2.0, v82
    v_fma_f32 v90, v91, -2.0, v90
    v_fmamk_f32 v80, v76, 0x41700000, v82
    v_fmamk_f32 v88, v84, 0x41700000, v90
    v_fmamk_f32 v80, v81, 0x41200000, v80
    v_fmamk_f32 v88, v89, 0x41200000, v88
    v_cvt_pk_bf16_f32 v54, v77, v85
    v_cvt_pk_bf16_f32 v58, v78, v86
    v_cvt_pk_bf16_f32 v66, v79, v87
    v_cvt_pk_bf16_f32 v70, v82, v90
    v_cvt_pk_bf16_f32 v74, v80, v88
    v_lshlrev_b32 v76, 16, v51
    v_and_b32 v84, s25, v51
    v_lshlrev_b32 v77, 16, v55
    v_and_b32 v85, s25, v55
    v_lshlrev_b32 v78, 16, v59
    v_and_b32 v86, s25, v59
    v_lshlrev_b32 v79, 16, v63
    v_and_b32 v87, s25, v63
    v_add_f32 v80, v76, v78
    v_add_f32 v88, v84, v86
    v_add_f32 v81, v77, v79
    v_add_f32 v89, v85, v87
    v_fma_f32 v82, v78, 4.0, v76
    v_fma_f32 v90, v86, 4.0, v84
    v_fma_f32 v83, v79, 4.0, v77
    v_fma_f32 v91, v87, 4.0, v85
    v_add_f32 v77, v80, v81
    v_add_f32 v85, v88, v89
    v_sub_f32 v78, v80, v81
    v_sub_f32 v86, v88, v89
    v_fma_f32 v79, v83, 2.0, v82
    v_fma_f32 v87, v91, 2.0, v90
    v_fma_f32 v82, v83, -2.0, v82
    v_fma_f32 v90, v91, -2.0, v90
    v_fmamk_f32 v80, v76, 0x41700000, v82
    v_fmamk_f32 v88, v84, 0x41700000, v90
    v_fmamk_f32 v80, v81, 0x41200000, v80
    v_fmamk_f32 v88, v89, 0x41200000, v88
    v_cvt_pk_bf16_f32 v55, v77, v85
    v_cvt_pk_bf16_f32 v59, v78, v86
    v_cvt_pk_bf16_f32 v67, v79, v87
    v_cvt_pk_bf16_f32 v71, v82, v90
    v_cvt_pk_bf16_f32 v75, v80, v88
    s_add_u32 s28, s28, 1
    s_waitcnt lgkmcnt(0)
    s_barrier
    s_cmp_eq_u32 s22, 1
    s_cbranch_scc1 L_conv1_kernel_hlast2
    s_cmp_lt_u32 s28, 12
    s_cselect_b32 s24, 0, 2130706432
    ds_write_b128 v96, v[64:67] offset:57344
    ds_write_b128 v97, v[68:71] offset:8192
    ds_write_b128 v97, v[72:75] offset:24576
    ds_write_b128 v96, v[48:51] offset:8192
    ds_write_b128 v96, v[52:55] offset:24576
    ds_write_b128 v96, v[56:59] offset:40960
    ds_write_b128 v98, v[60:63] offset:8704
    s_waitcnt vmcnt(0)
    v_lshlrev_b32 v76, 16, v0
    v_and_b32 v84, s25, v0
    v_lshlrev_b32 v77, 16, v4
    v_and_b32 v85, s25, v4
    v_lshlrev_b32 v78, 16, v8
    v_and_b32 v86, s25, v8
    v_lshlrev_b32 v79, 16, v12
    v_and_b32 v87, s25, v12
    v_add_f32 v80, v76, v78
    v_add_f32 v88, v84, v86
    v_add_f32 v81, v77, v79
    v_add_f32 v89, v85, v87
    v_fma_f32 v82, v78, 4.0, v76
    v_fma_f32 v90, v86, 4.0, v84
    v_fma_f32 v83, v79, 4.0, v77
    v_fma_f32 v91, v87, 4.0, v85
    v_add_f32 v77, v80, v81
    v_add_f32 v85, v88, v89
    v_sub_f32 v78, v80, v81
    v_sub_f32 v86, v88, v89
    v_fma_f32 v79, v83, 2.0, v82
    v_fma_f32 v87, v91, 2.0, v90
    v_fma_f32 v82, v83, -2.0, v82
    v_fma_f32 v90, v91, -2.0, v90
    v_fmamk_f32 v80, v76, 0x41700000, v82
    v_fmamk_f32 v88, v84, 0x41700000, v90
    v_fmamk_f32 v80, v81, 0x41200000, v80
    v_fmamk_f32 v88, v89, 0x41200000, v88
    v_cvt_pk_bf16_f32 v4, v77, v85
    v_cvt_pk_bf16_f32 v8, v78, v86
    v_cvt_pk_bf16_f32 v64, v79, v87
    v_cvt_pk_bf16_f32 v68, v82, v90
    v_cvt_pk_bf16_f32 v72, v80, v88
    v_lshlrev_b32 v76, 16, v1
    v_and_b32 v84, s25, v1
    v_lshlrev_b32 v77, 16, v5
    v_and_b32 v85, s25, v5
    v_lshlrev_b32 v78, 16, v9
    v_and_b32 v86, s25, v9
    buffer_load_dwordx4 v[32:35], v92, s[8:11], s24 offen offset:0
    buffer_load_dwordx4 v[48:51], v92, s[8:11], s24 offen offset:64
    v_add_u32 v92, 128, v92
    v_lshlrev_b32 v79, 16, v13
    v_and_b32 v87, s25, v13
    v_add_f32 v80, v76, v78
    v_add_f32 v88, v84, v86
    v_add_f32 v81, v77, v79
    v_add_f32 v89, v85, v87
    v_fma_f32 v82, v78, 4.0, v76
    v_fma_f32 v90, v86, 4.0, v84
    v_fma_f32 v83, v79, 4.0, v77
    v_fma_f32 v91, v87, 4.0, v85
    v_add_f32 v77, v80, v81
    v_add_f32 v85, v88, v89
    v_sub_f32 v78, v80, v81
    v_sub_f32 v86, v88, v89
    v_fma_f32 v79, v83, 2.0, v82
    v_fma_f32 v87, v91, 2.0, v90
    v_fma_f32 v82, v83, -2.0, v82
    v_fma_f32 v90, v91, -2.0, v90
    v_fmamk_f32 v80, v76, 0x41700000, v82
    v_fmamk_f32 v88, v84, 0x41700000, v90
    v_fmamk_f32 v80, v81, 0x41200000, v80
    v_fmamk_f32 v88, v89, 0x41200000, v88
    v_cvt_pk_bf16_f32 v5, v77, v85
    v_cvt_pk_bf16_f32 v9, v78, v86
    v_cvt_pk_bf16_f32 v65, v79, v87
    v_cvt_pk_bf16_f32 v69, v82, v90
    v_cvt_pk_bf16_f32 v73, v80, v88
    buffer_load_dwordx4 v[36:39], v93, s[8:11], s24 offen offset:0
    buffer_load_dwordx4 v[52:55], v93, s[8:11], s24 offen offset:64
    v_add_u32 v93, 128, v93
    v_lshlrev_b32 v76, 16, v2
    v_and_b32 v84, s25, v2
    v_lshlrev_b32 v77, 16, v6
    v_and_b32 v85, s25, v6
    v_lshlrev_b32 v78, 16, v10
    v_and_b32 v86, s25, v10
    v_lshlrev_b32 v79, 16, v14
    v_and_b32 v87, s25, v14
    v_add_f32 v80, v76, v78
    v_add_f32 v88, v84, v86
    v_add_f32 v81, v77, v79
    v_add_f32 v89, v85, v87
    v_fma_f32 v82, v78, 4.0, v76
    v_fma_f32 v90, v86, 4.0, v84
    v_fma_f32 v83, v79, 4.0, v77
    v_fma_f32 v91, v87, 4.0, v85
    v_add_f32 v77, v80, v81
    v_add_f32 v85, v88, v89
    v_sub_f32 v78, v80, v81
    v_sub_f32 v86, v88, v89
    v_fma_f32 v79, v83, 2.0, v82
    v_fma_f32 v87, v91, 2.0, v90
    v_fma_f32 v82, v83, -2.0, v82
    v_fma_f32 v90, v91, -2.0, v90
    v_fmamk_f32 v80, v76, 0x41700000, v82
    v_fmamk_f32 v88, v84, 0x41700000, v90
    v_fmamk_f32 v80, v81, 0x41200000, v80
    v_fmamk_f32 v88, v89, 0x41200000, v88
    v_cvt_pk_bf16_f32 v6, v77, v85
    v_cvt_pk_bf16_f32 v10, v78, v86
    v_cvt_pk_bf16_f32 v66, v79, v87
    v_cvt_pk_bf16_f32 v70, v82, v90
    v_cvt_pk_bf16_f32 v74, v80, v88
    v_lshlrev_b32 v76, 16, v3
    v_and_b32 v84, s25, v3
    v_lshlrev_b32 v77, 16, v7
    v_and_b32 v85, s25, v7
    v_lshlrev_b32 v78, 16, v11
    v_and_b32 v86, s25, v11
    v_lshlrev_b32 v79, 16, v15
    v_and_b32 v87, s25, v15
    v_add_f32 v80, v76, v78
    v_add_f32 v88, v84, v86
    v_add_f32 v81, v77, v79
    v_add_f32 v89, v85, v87
    v_fma_f32 v82, v78, 4.0, v76
    v_fma_f32 v90, v86, 4.0, v84
    v_fma_f32 v83, v79, 4.0, v77
    v_fma_f32 v91, v87, 4.0, v85
    v_add_f32 v77, v80, v81
    v_add_f32 v85, v88, v89
    v_sub_f32 v78, v80, v81
    v_sub_f32 v86, v88, v89
    v_fma_f32 v79, v83, 2.0, v82
    v_fma_f32 v87, v91, 2.0, v90
    v_fma_f32 v82, v83, -2.0, v82
    v_fma_f32 v90, v91, -2.0, v90
    v_fmamk_f32 v80, v76, 0x41700000, v82
    v_fmamk_f32 v88, v84, 0x41700000, v90
    v_fmamk_f32 v80, v81, 0x41200000, v80
    v_fmamk_f32 v88, v89, 0x41200000, v88
    v_cvt_pk_bf16_f32 v7, v77, v85
    v_cvt_pk_bf16_f32 v11, v78, v86
    v_cvt_pk_bf16_f32 v67, v79, v87
    v_cvt_pk_bf16_f32 v71, v82, v90
    v_cvt_pk_bf16_f32 v75, v80, v88
    s_add_u32 s28, s28, 1
    s_waitcnt lgkmcnt(0)
    s_barrier
    s_cmp_lt_u32 s28, 12
    s_cselect_b32 s24, 0, 2130706432
    ds_write_b128 v96, v[64:67] offset:49152
    ds_write_b128 v97, v[68:71] offset:0
    ds_write_b128 v97, v[72:75] offset:16384
    ds_write_b128 v96, v[0:3] offset:0
    ds_write_b128 v96, v[4:7] offset:16384
    ds_write_b128 v96, v[8:11] offset:32768
    ds_write_b128 v98, v[12:15] offset:0
    v_lshlrev_b32 v76, 16, v16
    v_and_b32 v84, s25, v16
    v_lshlrev_b32 v77, 16, v20
    v_and_b32 v85, s25, v20
    v_lshlrev_b32 v78, 16, v24
    v_and_b32 v86, s25, v24
    v_lshlrev_b32 v79, 16, v28
    v_and_b32 v87, s25, v28
    v_add_f32 v80, v76, v78
    v_add_f32 v88, v84, v86
    v_add_f32 v81, v77, v79
    v_add_f32 v89, v85, v87
    v_fma_f32 v82, v78, 4.0, v76
    v_fma_f32 v90, v86, 4.0, v84
    v_fma_f32 v83, v79, 4.0, v77
    v_fma_f32 v91, v87, 4.0, v85
    v_add_f32 v77, v80, v81
    v_add_f32 v85, v88, v89
    v_sub_f32 v78, v80, v81
    v_sub_f32 v86, v88, v89
    v_fma_f32 v79, v83, 2.0, v82
    v_fma_f32 v87, v91, 2.0, v90
    v_fma_f32 v82, v83, -2.0, v82
    v_fma_f32 v90, v91, -2.0, v90
    v_fmamk_f32 v80, v76, 0x41700000, v82
    v_fmamk_f32 v88, v84, 0x41700000, v90
    v_fmamk_f32 v80, v81, 0x41200000, v80
    v_fmamk_f32 v88, v89, 0x41200000, v88
    v_cvt_pk_bf16_f32 v20, v77, v85
    v_cvt_pk_bf16_f32 v24, v78, v86
    v_cvt_pk_bf16_f32 v64, v79, v87
    v_cvt_pk_bf16_f32 v68, v82, v90
    v_cvt_pk_bf16_f32 v72, v80, v88
    v_lshlrev_b32 v76, 16, v17
    v_and_b32 v84, s25, v17
    v_lshlrev_b32 v77, 16, v21
    v_and_b32 v85, s25, v21
    v_lshlrev_b32 v78, 16, v25
    v_and_b32 v86, s25, v25
    buffer_load_dwordx4 v[40:43], v94, s[8:11], s24 offen offset:0
    buffer_load_dwordx4 v[56:59], v94, s[8:11], s24 offen offset:64
    v_add_u32 v94, 128, v94
    v_lshlrev_b32 v79, 16, v29
    v_and_b32 v87, s25, v29
    v_add_f32 v80, v76, v78
    v_add_f32 v88, v84, v86
    v_add_f32 v81, v77, v79
    v_add_f32 v89, v85, v87
    v_fma_f32 v82, v78, 4.0, v76
    v_fma_f32 v90, v86, 4.0, v84
    v_fma_f32 v83, v79, 4.0, v77
    v_fma_f32 v91, v87, 4.0, v85
    v_add_f32 v77, v80, v81
    v_add_f32 v85, v88, v89
    v_sub_f32 v78, v80, v81
    v_sub_f32 v86, v88, v89
    v_fma_f32 v79, v83, 2.0, v82
    v_fma_f32 v87, v91, 2.0, v90
    v_fma_f32 v82, v83, -2.0, v82
    v_fma_f32 v90, v91, -2.0, v90
    v_fmamk_f32 v80, v76, 0x41700000, v82
    v_fmamk_f32 v88, v84, 0x41700000, v90
    v_fmamk_f32 v80, v81, 0x41200000, v80
    v_fmamk_f32 v88, v89, 0x41200000, v88
    v_cvt_pk_bf16_f32 v21, v77, v85
    v_cvt_pk_bf16_f32 v25, v78, v86
    v_cvt_pk_bf16_f32 v65, v79, v87
    v_cvt_pk_bf16_f32 v69, v82, v90
    v_cvt_pk_bf16_f32 v73, v80, v88
    buffer_load_dwordx4 v[44:47], v95, s[8:11], s24 offen offset:0
    buffer_load_dwordx4 v[60:63], v95, s[8:11], s24 offen offset:64
    v_add_u32 v95, 128, v95
    v_lshlrev_b32 v76, 16, v18
    v_and_b32 v84, s25, v18
    v_lshlrev_b32 v77, 16, v22
    v_and_b32 v85, s25, v22
    v_lshlrev_b32 v78, 16, v26
    v_and_b32 v86, s25, v26
    v_lshlrev_b32 v79, 16, v30
    v_and_b32 v87, s25, v30
    v_add_f32 v80, v76, v78
    v_add_f32 v88, v84, v86
    v_add_f32 v81, v77, v79
    v_add_f32 v89, v85, v87
    v_fma_f32 v82, v78, 4.0, v76
    v_fma_f32 v90, v86, 4.0, v84
    v_fma_f32 v83, v79, 4.0, v77
    v_fma_f32 v91, v87, 4.0, v85
    v_add_f32 v77, v80, v81
    v_add_f32 v85, v88, v89
    v_sub_f32 v78, v80, v81
    v_sub_f32 v86, v88, v89
    v_fma_f32 v79, v83, 2.0, v82
    v_fma_f32 v87, v91, 2.0, v90
    v_fma_f32 v82, v83, -2.0, v82
    v_fma_f32 v90, v91, -2.0, v90
    v_fmamk_f32 v80, v76, 0x41700000, v82
    v_fmamk_f32 v88, v84, 0x41700000, v90
    v_fmamk_f32 v80, v81, 0x41200000, v80
    v_fmamk_f32 v88, v89, 0x41200000, v88
    v_cvt_pk_bf16_f32 v22, v77, v85
    v_cvt_pk_bf16_f32 v26, v78, v86
    v_cvt_pk_bf16_f32 v66, v79, v87
    v_cvt_pk_bf16_f32 v70, v82, v90
    v_cvt_pk_bf16_f32 v74, v80, v88
    v_lshlrev_b32 v76, 16, v19
    v_and_b32 v84, s25, v19
    v_lshlrev_b32 v77, 16, v23
    v_and_b32 v85, s25, v23
    v_lshlrev_b32 v78, 16, v27
    v_and_b32 v86, s25, v27
    v_lshlrev_b32 v79, 16, v31
    v_and_b32 v87, s25, v31
    v_add_f32 v80, v76, v78
    v_add_f32 v88, v84, v86
    v_add_f32 v81, v77, v79
    v_add_f32 v89, v85, v87
    v_fma_f32 v82, v78, 4.0, v76
    v_fma_f32 v90, v86, 4.0, v84
    v_fma_f32 v83, v79, 4.0, v77
    v_fma_f32 v91, v87, 4.0, v85
    v_add_f32 v77, v80, v81
    v_add_f32 v85, v88, v89
    v_sub_f32 v78, v80, v81
    v_sub_f32 v86, v88, v89
    v_fma_f32 v79, v83, 2.0, v82
    v_fma_f32 v87, v91, 2.0, v90
    v_fma_f32 v82, v83, -2.0, v82
    v_fma_f32 v90, v91, -2.0, v90
    v_fmamk_f32 v80, v76, 0x41700000, v82
    v_fmamk_f32 v88, v84, 0x41700000, v90
    v_fmamk_f32 v80, v81, 0x41200000, v80
    v_fmamk_f32 v88, v89, 0x41200000, v88
    v_cvt_pk_bf16_f32 v23, v77, v85
    v_cvt_pk_bf16_f32 v27, v78, v86
    v_cvt_pk_bf16_f32 v67, v79, v87
    v_cvt_pk_bf16_f32 v71, v82, v90
    v_cvt_pk_bf16_f32 v75, v80, v88
    s_add_u32 s28, s28, 1
    s_waitcnt lgkmcnt(0)
    s_barrier
    s_sub_u32 s22, s22, 1
    s_branch L_conv1_kernel_hloop2
L_conv1_kernel_hlast2:
    s_waitcnt vmcnt(0)
    s_mov_b32 s58, s20
    s_lshl_b32 s20, s2, 2
    s_add_u32 s20, s20, s32
    v_mov_b32 v1, v127
    s_load_dwordx2 s[8:9], s[0:1], 16
    s_lshr_b32 s22, s20, 8
    s_bfe_u32 s23, s20, 0x40004
    s_bfe_u32 s24, s20, 0x30001
    s_and_b32 s21, s20, 1
    v_lshrrev_b32 v2, 4, v1
    v_lshlrev_b32 v2, 12, v2
    v_and_b32 v3, 15, v1
    v_lshl_add_u32 v2, v3, 2, v2
    s_lshl_b32 s26, s22, 3
    s_lshr_b32 s27, s23, 3
    s_add_u32 s26, s26, s27
    s_lshl_b32 s26, s26, 17
    s_and_b32 s27, s23, 7
    s_lshl_b32 s27, s27, 14
    s_add_u32 s26, s26, s27
    s_lshl_b32 s27, s24, 6
    s_add_u32 s26, s26, s27
    s_mov_b32 s10, 4063232
    s_mov_b32 s11, 0x00020000
    s_add_u32 s37, s26, 262144
    s_add_u32 s38, s26, 524288
    s_add_u32 s39, s26, 786432
    s_waitcnt lgkmcnt(0)
    buffer_load_dword v16, v2, s[8:11], s26 offen offset:0
    buffer_load_dword v17, v2, s[8:11], s26 offen offset:512
    buffer_load_dword v24, v2, s[8:11], s37 offen offset:0
    buffer_load_dword v25, v2, s[8:11], s37 offen offset:512
    buffer_load_dword v32, v2, s[8:11], s38 offen offset:0
    buffer_load_dword v33, v2, s[8:11], s38 offen offset:512
    buffer_load_dword v40, v2, s[8:11], s39 offen offset:0
    buffer_load_dword v41, v2, s[8:11], s39 offen offset:512
    buffer_load_dword v18, v2, s[8:11], s26 offen offset:1024
    buffer_load_dword v19, v2, s[8:11], s26 offen offset:1536
    buffer_load_dword v26, v2, s[8:11], s37 offen offset:1024
    buffer_load_dword v27, v2, s[8:11], s37 offen offset:1536
    buffer_load_dword v34, v2, s[8:11], s38 offen offset:1024
    buffer_load_dword v35, v2, s[8:11], s38 offen offset:1536
    buffer_load_dword v42, v2, s[8:11], s39 offen offset:1024
    buffer_load_dword v43, v2, s[8:11], s39 offen offset:1536
    buffer_load_dword v20, v2, s[8:11], s26 offen offset:2048
    buffer_load_dword v21, v2, s[8:11], s26 offen offset:2560
    buffer_load_dword v28, v2, s[8:11], s37 offen offset:2048
    buffer_load_dword v29, v2, s[8:11], s37 offen offset:2560
    buffer_load_dword v36, v2, s[8:11], s38 offen offset:2048
    buffer_load_dword v37, v2, s[8:11], s38 offen offset:2560
    buffer_load_dword v44, v2, s[8:11], s39 offen offset:2048
    buffer_load_dword v45, v2, s[8:11], s39 offen offset:2560
    buffer_load_dword v22, v2, s[8:11], s26 offen offset:3072
    buffer_load_dword v23, v2, s[8:11], s26 offen offset:3584
    buffer_load_dword v30, v2, s[8:11], s37 offen offset:3072
    buffer_load_dword v31, v2, s[8:11], s37 offen offset:3584
    buffer_load_dword v38, v2, s[8:11], s38 offen offset:3072
    buffer_load_dword v39, v2, s[8:11], s38 offen offset:3584
    buffer_load_dword v46, v2, s[8:11], s39 offen offset:3072
    buffer_load_dword v47, v2, s[8:11], s39 offen offset:3584
    s_add_u32 s12, s30, 9437184
    s_addc_u32 s13, s31, 0
    s_mov_b32 s14, 7340032
    s_mov_b32 s15, 0x00020000
    v_lshlrev_b32 v4, 4, v1
    s_lshl_b32 s27, s24, 4
    s_add_u32 s27, s27, s23
    s_mul_i32 s27, s27, 57344
    s_lshl_b32 s28, s22, 11
    s_add_u32 s27, s27, s28
    s_lshl_b32 s28, s21, 10
    s_add_u32 s27, s27, s28
    s_cmp_eq_u32 s21, 0
    s_mov_b32 s32, 0x07060302
    s_cselect_b32 s32, 0x05040100, s32
    s_mov_b32 s33, 0x03020c0c
    s_cselect_b32 s33, 0x01000c0c, s33
    s_mov_b32 s35, 0x3d2aaaab
    s_mov_b32 s36, 0x3c638e39
    s_mov_b32 s25, 0xffff0000
    ds_write_b128 v96, v[64:67] offset:57344
    ds_write_b128 v97, v[68:71] offset:8192
    ds_write_b128 v97, v[72:75] offset:24576
    ds_write_b128 v96, v[48:51] offset:8192
    ds_write_b128 v96, v[52:55] offset:24576
    ds_write_b128 v96, v[56:59] offset:40960
    ds_write_b128 v98, v[60:63] offset:8704
    s_waitcnt lgkmcnt(0)
    s_barrier
    s_waitcnt vmcnt(24)
    v_perm_b32 v72, v17, v16, s32
    v_perm_b32 v48, v41, v40, s32
    v_perm_b32 v76, v76, v40, s33
    v_perm_b32 v84, v84, v41, s33
    v_perm_b32 v77, v77, v32, s33
    v_perm_b32 v85, v85, v33, s33
    v_perm_b32 v78, v78, v24, s33
    v_perm_b32 v86, v86, v25, s33
    v_perm_b32 v79, v79, v16, s33
    v_perm_b32 v87, v87, v17, s33
    v_add_f32 v80, v76, v78
    v_add_f32 v88, v84, v86
    v_add_f32 v81, v77, v79
    v_add_f32 v89, v85, v87
    v_fma_f32 v82, v78, 4.0, v76
    v_fma_f32 v90, v86, 4.0, v84
    v_fma_f32 v83, v79, 4.0, v77
    v_fma_f32 v91, v87, 4.0, v85
    v_add_f32 v77, v80, v81
    v_add_f32 v85, v88, v89
    v_sub_f32 v78, v80, v81
    v_sub_f32 v86, v88, v89
    v_fma_f32 v79, v83, 2.0, v82
    v_fma_f32 v87, v91, 2.0, v90
    v_fma_f32 v82, v83, -2.0, v82
    v_fma_f32 v90, v91, -2.0, v90
    v_fmamk_f32 v80, v76, 0x41700000, v82
    v_fmamk_f32 v88, v84, 0x41700000, v90
    v_fmamk_f32 v80, v81, 0x41200000, v80
    v_fmamk_f32 v88, v89, 0x41200000, v88
    v_mul_f32 v77, 0.5, v77
    v_mul_f32 v85, 0.5, v85
    v_mul_f32 v78, 0.5, v78
    v_mul_f32 v86, 0.5, v86
    v_mul_f32 v79, s35, v79
    v_mul_f32 v87, s35, v87
    v_mul_f32 v82, s35, v82
    v_mul_f32 v90, s35, v90
    v_mul_f32 v80, s36, v80
    v_mul_f32 v88, s36, v88
    v_cvt_pk_bf16_f32 v52, v77, v85
    v_cvt_pk_bf16_f32 v56, v78, v86
    v_cvt_pk_bf16_f32 v60, v79, v87
    v_cvt_pk_bf16_f32 v64, v82, v90
    v_cvt_pk_bf16_f32 v68, v80, v88
    s_waitcnt vmcnt(16)
    v_perm_b32 v73, v19, v18, s32
    v_perm_b32 v49, v43, v42, s32
    v_perm_b32 v76, v76, v42, s33
    v_perm_b32 v84, v84, v43, s33
    v_perm_b32 v77, v77, v34, s33
    v_perm_b32 v85, v85, v35, s33
    v_perm_b32 v78, v78, v26, s33
    v_perm_b32 v86, v86, v27, s33
    v_perm_b32 v79, v79, v18, s33
    v_perm_b32 v87, v87, v19, s33
    v_add_f32 v80, v76, v78
    v_add_f32 v88, v84, v86
    v_add_f32 v81, v77, v79
    v_add_f32 v89, v85, v87
    v_fma_f32 v82, v78, 4.0, v76
    v_fma_f32 v90, v86, 4.0, v84
    v_fma_f32 v83, v79, 4.0, v77
    v_fma_f32 v91, v87, 4.0, v85
    v_add_f32 v77, v80, v81
    v_add_f32 v85, v88, v89
    v_sub_f32 v78, v80, v81
    v_sub_f32 v86, v88, v89
    v_fma_f32 v79, v83, 2.0, v82
    v_fma_f32 v87, v91, 2.0, v90
    v_fma_f32 v82, v83, -2.0, v82
    v_fma_f32 v90, v91, -2.0, v90
    v_fmamk_f32 v80, v76, 0x41700000, v82
    v_fmamk_f32 v88, v84, 0x41700000, v90
    v_fmamk_f32 v80, v81, 0x41200000, v80
    v_fmamk_f32 v88, v89, 0x41200000, v88
    v_mul_f32 v77, 0.5, v77
    v_mul_f32 v85, 0.5, v85
    v_mul_f32 v78, 0.5, v78
    v_mul_f32 v86, 0.5, v86
    v_mul_f32 v79, s35, v79
    v_mul_f32 v87, s35, v87
    v_mul_f32 v82, s35, v82
    v_mul_f32 v90, s35, v90
    v_mul_f32 v80, s36, v80
    v_mul_f32 v88, s36, v88
    v_cvt_pk_bf16_f32 v53, v77, v85
    v_cvt_pk_bf16_f32 v57, v78, v86
    v_cvt_pk_bf16_f32 v61, v79, v87
    v_cvt_pk_bf16_f32 v65, v82, v90
    v_cvt_pk_bf16_f32 v69, v80, v88
    s_waitcnt vmcnt(8)
    v_perm_b32 v74, v21, v20, s32
    v_perm_b32 v50, v45, v44, s32
    v_perm_b32 v76, v76, v44, s33
    v_perm_b32 v84, v84, v45, s33
    v_perm_b32 v77, v77, v36, s33
    v_perm_b32 v85, v85, v37, s33
    v_perm_b32 v78, v78, v28, s33
    v_perm_b32 v86, v86, v29, s33
    v_perm_b32 v79, v79, v20, s33
    v_perm_b32 v87, v87, v21, s33
    v_add_f32 v80, v76, v78
    v_add_f32 v88, v84, v86
    v_add_f32 v81, v77, v79
    v_add_f32 v89, v85, v87
    v_fma_f32 v82, v78, 4.0, v76
    v_fma_f32 v90, v86, 4.0, v84
    v_fma_f32 v83, v79, 4.0, v77
    v_fma_f32 v91, v87, 4.0, v85
    v_add_f32 v77, v80, v81
    v_add_f32 v85, v88, v89
    v_sub_f32 v78, v80, v81
    v_sub_f32 v86, v88, v89
    v_fma_f32 v79, v83, 2.0, v82
    v_fma_f32 v87, v91, 2.0, v90
    v_fma_f32 v82, v83, -2.0, v82
    v_fma_f32 v90, v91, -2.0, v90
    v_fmamk_f32 v80, v76, 0x41700000, v82
    v_fmamk_f32 v88, v84, 0x41700000, v90
    v_fmamk_f32 v80, v81, 0x41200000, v80
    v_fmamk_f32 v88, v89, 0x41200000, v88
    v_mul_f32 v77, 0.5, v77
    v_mul_f32 v85, 0.5, v85
    v_mul_f32 v78, 0.5, v78
    v_mul_f32 v86, 0.5, v86
    v_mul_f32 v79, s35, v79
    v_mul_f32 v87, s35, v87
    v_mul_f32 v82, s35, v82
    v_mul_f32 v90, s35, v90
    v_mul_f32 v80, s36, v80
    v_mul_f32 v88, s36, v88
    v_cvt_pk_bf16_f32 v54, v77, v85
    v_cvt_pk_bf16_f32 v58, v78, v86
    v_cvt_pk_bf16_f32 v62, v79, v87
    v_cvt_pk_bf16_f32 v66, v82, v90
    v_cvt_pk_bf16_f32 v70, v80, v88
    s_waitcnt vmcnt(0)
    v_perm_b32 v75, v23, v22, s32
    v_perm_b32 v51, v47, v46, s32
    v_perm_b32 v76, v76, v46, s33
    v_perm_b32 v84, v84, v47, s33
    v_perm_b32 v77, v77, v38, s33
    v_perm_b32 v85, v85, v39, s33
    v_perm_b32 v78, v78, v30, s33
    v_perm_b32 v86, v86, v31, s33
    v_perm_b32 v79, v79, v22, s33
    v_perm_b32 v87, v87, v23, s33
    v_add_f32 v80, v76, v78
    v_add_f32 v88, v84, v86
    v_add_f32 v81, v77, v79
    v_add_f32 v89, v85, v87
    v_fma_f32 v82, v78, 4.0, v76
    v_fma_f32 v90, v86, 4.0, v84
    v_fma_f32 v83, v79, 4.0, v77
    v_fma_f32 v91, v87, 4.0, v85
    v_add_f32 v77, v80, v81
    v_add_f32 v85, v88, v89
    v_sub_f32 v78, v80, v81
    v_sub_f32 v86, v88, v89
    v_fma_f32 v79, v83, 2.0, v82
    v_fma_f32 v87, v91, 2.0, v90
    v_fma_f32 v82, v83, -2.0, v82
    v_fma_f32 v90, v91, -2.0, v90
    v_fmamk_f32 v80, v76, 0x41700000, v82
    v_fmamk_f32 v88, v84, 0x41700000, v90
    v_fmamk_f32 v80, v81, 0x41200000, v80
    v_fmamk_f32 v88, v89, 0x41200000, v88
    v_mul_f32 v77, 0.5, v77
    v_mul_f32 v85, 0.5, v85
    v_mul_f32 v78, 0.5, v78
    v_mul_f32 v86, 0.5, v86
    v_mul_f32 v79, s35, v79
    v_mul_f32 v87, s35, v87
    v_mul_f32 v82, s35, v82
    v_mul_f32 v90, s35, v90
    v_mul_f32 v80, s36, v80
    v_mul_f32 v88, s36, v88
    v_cvt_pk_bf16_f32 v55, v77, v85
    v_cvt_pk_bf16_f32 v59, v78, v86
    v_cvt_pk_bf16_f32 v63, v79, v87
    v_cvt_pk_bf16_f32 v67, v82, v90
    v_cvt_pk_bf16_f32 v71, v80, v88
    s_add_u32 s28, s27, 49152
    buffer_store_dwordx4 v[72:75], v4, s[12:15], s28 offen sc1
    s_add_u32 s28, s27, 0
    buffer_store_dwordx4 v[48:51], v4, s[12:15], s28 offen sc1
    s_add_u32 s28, s27, 8192
    buffer_store_dwordx4 v[52:55], v4, s[12:15], s28 offen sc1
    s_add_u32 s28, s27, 16384
    buffer_store_dwordx4 v[56:59], v4, s[12:15], s28 offen sc1
    s_add_u32 s28, s27, 24576
    buffer_store_dwordx4 v[60:63], v4, s[12:15], s28 offen sc1
    s_add_u32 s28, s27, 32768
    buffer_store_dwordx4 v[64:67], v4, s[12:15], s28 offen sc1
    s_add_u32 s28, s27, 40960
    buffer_store_dwordx4 v[68:71], v4, s[12:15], s28 offen sc1
    s_mov_b32 s20, s58
    s_barrier
    s_endpgm
L_conv1_kernel_mw:
    s_add_u32 s37, s41, 524288
    v_lshl_add_u32 v108, v127, 4, s37
    v_add_u32 v109, 1024, v108
    v_add_u32 v110, 2048, v108
    s_waitcnt lgkmcnt(0)
    s_add_u32 s8, s4, s47
    s_addc_u32 s9, s5, 0
    s_lshl_b32 s36, s29, 4
    s_lshl_b32 s37, s33, 3
    s_add_u32 s36, s36, s37
    s_mul_i32 s36, s36, 57344
    s_add_u32 s36, s36, 0
    s_add_u32 s12, s30, s36
    s_addc_u32 s13, s31, 0
    s_mov_b32 s14, 917504
    s_mov_b32 s15, 0x00020000
    s_mul_i32 s36, s35, 4194304
    s_add_u32 s36, s36, 18874368
    s_add_u32 s16, s30, s36
    s_addc_u32 s17, s31, 0
    s_mov_b32 s18, 4194304
    s_mov_b32 s19, 0x00020000
    v_and_b32 v10, 15, v127
    v_lshrrev_b32 v11, 4, v127
    v_add_u32 v8, 0, v10
    v_and_b32 v16, 4, v8
    v_lshrrev_b32 v16, 1, v16
    v_xor_b32 v16, v11, v16
    v_lshlrev_b32 v16, 4, v16
    v_lshl_add_u32 v8, v8, 6, v16
    v_add_u32 v9, 1, v10
    v_and_b32 v16, 4, v9
    v_lshrrev_b32 v16, 1, v16
    v_xor_b32 v16, v11, v16
    v_lshlrev_b32 v16, 4, v16
    v_lshl_add_u32 v9, v9, 6, v16
    s_lshr_b32 s38, s32, 1
    s_and_b32 s39, s32, 1
    s_add_u32 s40, s38, 4
    s_lshl_b32 s43, s39, 10
    s_cmp_lt_u32 s20, 4
    s_cselect_b32 s40, s20, s40
    s_cselect_b32 s36, 0, s43
    s_lshl_b32 s37, s40, 13
    s_add_u32 s37, s37, s36
    v_lshl_add_u32 v125, v127, 4, s37
    s_mul_i32 s37, s40, 16384
    v_add_u32 v120, s37, v8
    v_add_u32 v121, s37, v9
    s_lshl_b32 s37, s40, 10
    s_add_u32 s37, s37, 115712
    v_lshl_add_u32 v16, v11, 4, s37
    v_cmp_eq_u32 vcc, 15, v10
    v_mov_b32 v17, 8192
    v_mov_b32 v18, 4294959104
    v_mov_b32 v19, 64
    v_cndmask_b32 v122, v121, v16, vcc
    v_cndmask_b32 v123, v17, v19, vcc
    v_cndmask_b32 v124, v18, v19, vcc
    v_lshl_add_u32 v126, v127, 4, s37
    s_mov_b32 s44, 0x3f800000
    s_mov_b32 s45, 0x00000000
    s_mov_b32 s46, 0x00000000
    s_cmp_eq_u32 s40, 1
    s_cselect_b32 s45, 0x3f800000, s45
    s_cselect_b32 s46, 0x3f800000, s46
    s_cmp_eq_u32 s40, 2
    s_cselect_b32 s45, 0xbf800000, s45
    s_cselect_b32 s46, 0x3f800000, s46
    s_cmp_eq_u32 s40, 3
    s_cselect_b32 s45, 0x40000000, s45
    s_cselect_b32 s46, 0x40800000, s46
    s_cmp_eq_u32 s40, 4
    s_cselect_b32 s45, 0xc0000000, s45
    s_cselect_b32 s46, 0x40800000, s46
    s_cmp_eq_u32 s40, 5
    s_cselect_b32 s44, 0x41800000, s44
    s_cselect_b32 s45, 0x41000000, s45
    s_cselect_b32 s46, 0x40800000, s46
    s_cmp_ge_u32 s20, 4
    s_cbranch_scc1 L_conv1_kernel_m2
    v_mov_b32 v0, 0
    v_mov_b32 v1, 0
    v_mov_b32 v2, 0
    v_mov_b32 v3, 0
    v_mov_b32 v4, 0
    v_mov_b32 v5, 0
    v_mov_b32 v6, 0
    v_mov_b32 v7, 0
    v_mov_b32 v8, 0
    v_mov_b32 v9, 0
    v_mov_b32 v10, 0
    v_mov_b32 v11, 0
    v_mov_b32 v12, 0
    v_mov_b32 v13, 0
    v_mov_b32 v14, 0
    v_mov_b32 v15, 0
    v_mov_b32 v16, 0
    v_mov_b32 v17, 0
    v_mov_b32 v18, 0
    v_mov_b32 v19, 0
    v_mov_b32 v20, 0
    v_mov_b32 v21, 0
    v_mov_b32 v22, 0
    v_mov_b32 v23, 0
    v_mov_b32 v24, 0
    v_mov_b32 v25, 0
    v_mov_b32 v26, 0
    v_mov_b32 v27, 0
    v_mov_b32 v28, 0
    v_mov_b32 v29, 0
    v_mov_b32 v30, 0
    v_mov_b32 v31, 0
    v_mov_b32 v32, 0
    v_mov_b32 v33, 0
    v_mov_b32 v34, 0
    v_mov_b32 v35, 0
    v_mov_b32 v36, 0
    v_mov_b32 v37, 0
    v_mov_b32 v38, 0
    v_mov_b32 v39, 0
    v_mov_b32 v40, 0
    v_mov_b32 v41, 0
    v_mov_b32 v42, 0
    v_mov_b32 v43, 0
    v_mov_b32 v44, 0
    v_mov_b32 v45, 0
    v_mov_b32 v46, 0
    v_mov_b32 v47, 0
    v_mov_b32 v48, 0
    v_mov_b32 v49, 0
    v_mov_b32 v50, 0
    v_mov_b32 v51, 0
    v_mov_b32 v52, 0
    v_mov_b32 v53, 0
    v_mov_b32 v54, 0
    v_mov_b32 v55, 0
    v_mov_b32 v56, 0
    v_mov_b32 v57, 0
    v_mov_b32 v58, 0
    v_mov_b32 v59, 0
    v_mov_b32 v60, 0
    v_mov_b32 v61, 0
    v_mov_b32 v62, 0
    v_mov_b32 v63, 0
    buffer_load_dwordx4 v[96:99], v108, s[8:11], 0 offen
    buffer_load_dwordx4 v[100:103], v109, s[8:11], 0 offen
    buffer_load_dwordx4 v[104:107], v110, s[8:11], 0 offen
    s_mov_b32 s23, 0
    s_mov_b32 s26, 4096
    buffer_load_dwordx4 v[64:67], v125, s[12:15], s23 offen offset:0
    buffer_load_dwordx4 v[68:71], v125, s[12:15], s23 offen offset:1024
    buffer_load_dwordx4 v[72:75], v125, s[12:15], s23 offen offset:2048
    buffer_load_dwordx4 v[76:79], v125, s[12:15], s23 offen offset:3072
    buffer_load_dwordx4 v[80:83], v125, s[12:15], s26 offen offset:0
    buffer_load_dwordx4 v[84:87], v125, s[12:15], s26 offen offset:1024
    buffer_load_dwordx4 v[88:91], v125, s[12:15], s26 offen offset:2048
    buffer_load_dwordx4 v[92:95], v125, s[12:15], s26 offen offset:3072
    s_mov_b32 s23, 57344
    s_mov_b32 s26, 61440
    s_waitcnt vmcnt(8)
    v_lshlrev_b32 v108, 16, v96
    v_and_b32 v111, s25, v96
    v_lshlrev_b32 v109, 16, v100
    v_and_b32 v112, s25, v100
    v_lshlrev_b32 v110, 16, v104
    v_and_b32 v113, s25, v104
    v_mul_f32 v114, s44, v108
    v_mul_f32 v115, s44, v111
    v_fmac_f32 v114, s45, v109
    v_fmac_f32 v115, s45, v112
    v_fmac_f32 v114, s46, v110
    v_fmac_f32 v115, s46, v113
    v_cvt_pk_bf16_f32 v96, v114, v115
    v_lshlrev_b32 v108, 16, v97
    v_and_b32 v111, s25, v97
    v_lshlrev_b32 v109, 16, v101
    v_and_b32 v112, s25, v101
    v_lshlrev_b32 v110, 16, v105
    v_and_b32 v113, s25, v105
    v_mul_f32 v114, s44, v108
    v_mul_f32 v115, s44, v111
    v_fmac_f32 v114, s45, v109
    v_fmac_f32 v115, s45, v112
    v_fmac_f32 v114, s46, v110
    v_fmac_f32 v115, s46, v113
    v_cvt_pk_bf16_f32 v97, v114, v115
    v_lshlrev_b32 v108, 16, v98
    v_and_b32 v111, s25, v98
    v_lshlrev_b32 v109, 16, v102
    v_and_b32 v112, s25, v102
    v_lshlrev_b32 v110, 16, v106
    v_and_b32 v113, s25, v106
    v_mul_f32 v114, s44, v108
    v_mul_f32 v115, s44, v111
    v_fmac_f32 v114, s45, v109
    v_fmac_f32 v115, s45, v112
    v_fmac_f32 v114, s46, v110
    v_fmac_f32 v115, s46, v113
    v_cvt_pk_bf16_f32 v98, v114, v115
    v_lshlrev_b32 v108, 16, v99
    v_and_b32 v111, s25, v99
    v_lshlrev_b32 v109, 16, v103
    v_and_b32 v112, s25, v103
    v_lshlrev_b32 v110, 16, v107
    v_and_b32 v113, s25, v107
    v_mul_f32 v114, s44, v108
    v_mul_f32 v115, s44, v111
    v_fmac_f32 v114, s45, v109
    v_fmac_f32 v115, s45, v112
    v_fmac_f32 v114, s46, v110
    v_fmac_f32 v115, s46, v113
    v_cvt_pk_bf16_f32 v99, v114, v115
    ds_write_b128 v126, v[96:99]
    s_waitcnt lgkmcnt(0)
    s_barrier
    s_mov_b32 s22, 8
    s_setprio 2
L_conv1_kernel_mloop1:
    ds_read_b128 v[96:99], v120 offset:0
    ds_read_b128 v[100:103], v120 offset:1024
    ds_read_b128 v[104:107], v120 offset:2048
    ds_read_b128 v[108:111], v120 offset:3072
    ds_read_b128 v[112:115], v120 offset:4096
    ds_read_b128 v[116:119], v120 offset:5120
    s_waitcnt vmcnt(6) lgkmcnt(5)
    v_mfma_f32_16x16x32_bf16 v[0:3], v[64:67], v[96:99], v[0:3]
    v_mfma_f32_16x16x32_bf16 v[32:35], v[68:71], v[96:99], v[32:35]
    ds_read_b128 v[96:99], v120 offset:6144
    s_waitcnt vmcnt(4) lgkmcnt(5)
    v_mfma_f32_16x16x32_bf16 v[4:7], v[64:67], v[100:103], v[4:7]
    v_mfma_f32_16x16x32_bf16 v[36:39], v[68:71], v[100:103], v[36:39]
    v_mfma_f32_16x16x32_bf16 v[0:3], v[72:75], v[100:103], v[0:3]
    v_mfma_f32_16x16x32_bf16 v[32:35], v[76:79], v[100:103], v[32:35]
    ds_read_b128 v[100:103], v120 offset:7168
    s_waitcnt vmcnt(2) lgkmcnt(5)
    v_mfma_f32_16x16x32_bf16 v[8:11], v[64:67], v[104:107], v[8:11]
    v_mfma_f32_16x16x32_bf16 v[40:43], v[68:71], v[104:107], v[40:43]
    v_mfma_f32_16x16x32_bf16 v[4:7], v[72:75], v[104:107], v[4:7]
    v_mfma_f32_16x16x32_bf16 v[36:39], v[76:79], v[104:107], v[36:39]
    v_mfma_f32_16x16x32_bf16 v[0:3], v[80:83], v[104:107], v[0:3]
    v_mfma_f32_16x16x32_bf16 v[32:35], v[84:87], v[104:107], v[32:35]
    ds_read_b128 v[104:107], v122 offset:0
    v_add_u32 v122, v123, v122
    s_waitcnt vmcnt(0) lgkmcnt(5)
    v_mfma_f32_16x16x32_bf16 v[12:15], v[64:67], v[108:111], v[12:15]
    v_mfma_f32_16x16x32_bf16 v[44:47], v[68:71], v[108:111], v[44:47]
    v_mfma_f32_16x16x32_bf16 v[8:11], v[72:75], v[108:111], v[8:11]
    v_mfma_f32_16x16x32_bf16 v[40:43], v[76:79], v[108:111], v[40:43]
    v_mfma_f32_16x16x32_bf16 v[4:7], v[80:83], v[108:111], v[4:7]
    v_mfma_f32_16x16x32_bf16 v[36:39], v[84:87], v[108:111], v[36:39]
    v_mfma_f32_16x16x32_bf16 v[0:3], v[88:91], v[108:111], v[0:3]
    v_mfma_f32_16x16x32_bf16 v[32:35], v[92:95], v[108:111], v[32:35]
    ds_read_b128 v[108:111], v121 offset:1024
    s_waitcnt lgkmcnt(5)
    v_mfma_f32_16x16x32_bf16 v[16:19], v[64:67], v[112:115], v[16:19]
    v_mfma_f32_16x16x32_bf16 v[48:51], v[68:71], v[112:115], v[48:51]
    v_mfma_f32_16x16x32_bf16 v[12:15], v[72:75], v[112:115], v[12:15]
    v_mfma_f32_16x16x32_bf16 v[44:47], v[76:79], v[112:115], v[44:47]
    v_mfma_f32_16x16x32_bf16 v[8:11], v[80:83], v[112:115], v[8:11]
    v_mfma_f32_16x16x32_bf16 v[40:43], v[84:87], v[112:115], v[40:43]
    v_mfma_f32_16x16x32_bf16 v[4:7], v[88:91], v[112:115], v[4:7]
    v_mfma_f32_16x16x32_bf16 v[36:39], v[92:95], v[112:115], v[36:39]
    ds_read_b128 v[112:115], v121 offset:2048
    s_waitcnt lgkmcnt(5)
    v_mfma_f32_16x16x32_bf16 v[20:23], v[64:67], v[116:119], v[20:23]
    v_mfma_f32_16x16x32_bf16 v[52:55], v[68:71], v[116:119], v[52:55]
    v_mfma_f32_16x16x32_bf16 v[16:19], v[72:75], v[116:119], v[16:19]
    v_mfma_f32_16x16x32_bf16 v[48:51], v[76:79], v[116:119], v[48:51]
    v_mfma_f32_16x16x32_bf16 v[12:15], v[80:83], v[116:119], v[12:15]
    v_mfma_f32_16x16x32_bf16 v[44:47], v[84:87], v[116:119], v[44:47]
    v_mfma_f32_16x16x32_bf16 v[8:11], v[88:91], v[116:119], v[8:11]
    v_mfma_f32_16x16x32_bf16 v[40:43], v[92:95], v[116:119], v[40:43]
    s_waitcnt lgkmcnt(4)
    v_mfma_f32_16x16x32_bf16 v[24:27], v[64:67], v[96:99], v[24:27]
    v_mfma_f32_16x16x32_bf16 v[56:59], v[68:71], v[96:99], v[56:59]
    v_mfma_f32_16x16x32_bf16 v[20:23], v[72:75], v[96:99], v[20:23]
    v_mfma_f32_16x16x32_bf16 v[52:55], v[76:79], v[96:99], v[52:55]
    v_mfma_f32_16x16x32_bf16 v[16:19], v[80:83], v[96:99], v[16:19]
    v_mfma_f32_16x16x32_bf16 v[48:51], v[84:87], v[96:99], v[48:51]
    v_mfma_f32_16x16x32_bf16 v[12:15], v[88:91], v[96:99], v[12:15]
    v_mfma_f32_16x16x32_bf16 v[44:47], v[92:95], v[96:99], v[44:47]
    s_waitcnt lgkmcnt(3)
    v_mfma_f32_16x16x32_bf16 v[28:31], v[64:67], v[100:103], v[28:31]
    v_mfma_f32_16x16x32_bf16 v[60:63], v[68:71], v[100:103], v[60:63]
    v_mfma_f32_16x16x32_bf16 v[24:27], v[72:75], v[100:103], v[24:27]
    v_mfma_f32_16x16x32_bf16 v[56:59], v[76:79], v[100:103], v[56:59]
    v_mfma_f32_16x16x32_bf16 v[20:23], v[80:83], v[100:103], v[20:23]
    v_mfma_f32_16x16x32_bf16 v[52:55], v[84:87], v[100:103], v[52:55]
    v_mfma_f32_16x16x32_bf16 v[16:19], v[88:91], v[100:103], v[16:19]
    v_mfma_f32_16x16x32_bf16 v[48:51], v[92:95], v[100:103], v[48:51]
    buffer_load_dwordx4 v[64:67], v125, s[12:15], s23 offen offset:0
    buffer_load_dwordx4 v[68:71], v125, s[12:15], s23 offen offset:1024
    s_waitcnt lgkmcnt(2)
    v_mfma_f32_16x16x32_bf16 v[28:31], v[72:75], v[104:107], v[28:31]
    v_mfma_f32_16x16x32_bf16 v[60:63], v[76:79], v[104:107], v[60:63]
    v_mfma_f32_16x16x32_bf16 v[24:27], v[80:83], v[104:107], v[24:27]
    v_mfma_f32_16x16x32_bf16 v[56:59], v[84:87], v[104:107], v[56:59]
    v_mfma_f32_16x16x32_bf16 v[20:23], v[88:91], v[104:107], v[20:23]
    v_mfma_f32_16x16x32_bf16 v[52:55], v[92:95], v[104:107], v[52:55]
    buffer_load_dwordx4 v[72:75], v125, s[12:15], s23 offen offset:2048
    buffer_load_dwordx4 v[76:79], v125, s[12:15], s23 offen offset:3072
    s_waitcnt lgkmcnt(1)
    v_mfma_f32_16x16x32_bf16 v[28:31], v[80:83], v[108:111], v[28:31]
    v_mfma_f32_16x16x32_bf16 v[60:63], v[84:87], v[108:111], v[60:63]
    v_mfma_f32_16x16x32_bf16 v[24:27], v[88:91], v[108:111], v[24:27]
    v_mfma_f32_16x16x32_bf16 v[56:59], v[92:95], v[108:111], v[56:59]
    buffer_load_dwordx4 v[80:83], v125, s[12:15], s26 offen offset:0
    buffer_load_dwordx4 v[84:87], v125, s[12:15], s26 offen offset:1024
    s_waitcnt lgkmcnt(0)
    v_mfma_f32_16x16x32_bf16 v[28:31], v[88:91], v[112:115], v[28:31]
    v_mfma_f32_16x16x32_bf16 v[60:63], v[92:95], v[112:115], v[60:63]
    buffer_load_dwordx4 v[88:91], v125, s[12:15], s26 offen offset:2048
    buffer_load_dwordx4 v[92:95], v125, s[12:15], s26 offen offset:3072
    s_add_u32 s23, s23, 57344
    s_add_u32 s26, s26, 57344
    s_barrier
    s_sub_u32 s22, s22, 1
    s_cmp_eq_u32 s22, 0
    s_cbranch_scc1 L_conv1_kernel_mlast1
    ds_read_b128 v[96:99], v120 offset:8192
    ds_read_b128 v[100:103], v120 offset:9216
    ds_read_b128 v[104:107], v120 offset:10240
    ds_read_b128 v[108:111], v120 offset:11264
    ds_read_b128 v[112:115], v120 offset:12288
    ds_read_b128 v[116:119], v120 offset:13312
    s_waitcnt vmcnt(6) lgkmcnt(5)
    v_mfma_f32_16x16x32_bf16 v[0:3], v[64:67], v[96:99], v[0:3]
    v_mfma_f32_16x16x32_bf16 v[32:35], v[68:71], v[96:99], v[32:35]
    ds_read_b128 v[96:99], v120 offset:14336
    s_waitcnt vmcnt(4) lgkmcnt(5)
    v_mfma_f32_16x16x32_bf16 v[4:7], v[64:67], v[100:103], v[4:7]
    v_mfma_f32_16x16x32_bf16 v[36:39], v[68:71], v[100:103], v[36:39]
    v_mfma_f32_16x16x32_bf16 v[0:3], v[72:75], v[100:103], v[0:3]
    v_mfma_f32_16x16x32_bf16 v[32:35], v[76:79], v[100:103], v[32:35]
    ds_read_b128 v[100:103], v120 offset:15360
    s_waitcnt vmcnt(2) lgkmcnt(5)
    v_mfma_f32_16x16x32_bf16 v[8:11], v[64:67], v[104:107], v[8:11]
    v_mfma_f32_16x16x32_bf16 v[40:43], v[68:71], v[104:107], v[40:43]
    v_mfma_f32_16x16x32_bf16 v[4:7], v[72:75], v[104:107], v[4:7]
    v_mfma_f32_16x16x32_bf16 v[36:39], v[76:79], v[104:107], v[36:39]
    v_mfma_f32_16x16x32_bf16 v[0:3], v[80:83], v[104:107], v[0:3]
    v_mfma_f32_16x16x32_bf16 v[32:35], v[84:87], v[104:107], v[32:35]
    ds_read_b128 v[104:107], v122 offset:0
    v_add_u32 v122, v124, v122
    s_waitcnt vmcnt(0) lgkmcnt(5)
    v_mfma_f32_16x16x32_bf16 v[12:15], v[64:67], v[108:111], v[12:15]
    v_mfma_f32_16x16x32_bf16 v[44:47], v[68:71], v[108:111], v[44:47]
    v_mfma_f32_16x16x32_bf16 v[8:11], v[72:75], v[108:111], v[8:11]
    v_mfma_f32_16x16x32_bf16 v[40:43], v[76:79], v[108:111], v[40:43]
    v_mfma_f32_16x16x32_bf16 v[4:7], v[80:83], v[108:111], v[4:7]
    v_mfma_f32_16x16x32_bf16 v[36:39], v[84:87], v[108:111], v[36:39]
    v_mfma_f32_16x16x32_bf16 v[0:3], v[88:91], v[108:111], v[0:3]
    v_mfma_f32_16x16x32_bf16 v[32:35], v[92:95], v[108:111], v[32:35]
    ds_read_b128 v[108:111], v121 offset:9216
    s_waitcnt lgkmcnt(5)
    v_mfma_f32_16x16x32_bf16 v[16:19], v[64:67], v[112:115], v[16:19]
    v_mfma_f32_16x16x32_bf16 v[48:51], v[68:71], v[112:115], v[48:51]
    v_mfma_f32_16x16x32_bf16 v[12:15], v[72:75], v[112:115], v[12:15]
    v_mfma_f32_16x16x32_bf16 v[44:47], v[76:79], v[112:115], v[44:47]
    v_mfma_f32_16x16x32_bf16 v[8:11], v[80:83], v[112:115], v[8:11]
    v_mfma_f32_16x16x32_bf16 v[40:43], v[84:87], v[112:115], v[40:43]
    v_mfma_f32_16x16x32_bf16 v[4:7], v[88:91], v[112:115], v[4:7]
    v_mfma_f32_16x16x32_bf16 v[36:39], v[92:95], v[112:115], v[36:39]
    ds_read_b128 v[112:115], v121 offset:10240
    s_waitcnt lgkmcnt(5)
    v_mfma_f32_16x16x32_bf16 v[20:23], v[64:67], v[116:119], v[20:23]
    v_mfma_f32_16x16x32_bf16 v[52:55], v[68:71], v[116:119], v[52:55]
    v_mfma_f32_16x16x32_bf16 v[16:19], v[72:75], v[116:119], v[16:19]
    v_mfma_f32_16x16x32_bf16 v[48:51], v[76:79], v[116:119], v[48:51]
    v_mfma_f32_16x16x32_bf16 v[12:15], v[80:83], v[116:119], v[12:15]
    v_mfma_f32_16x16x32_bf16 v[44:47], v[84:87], v[116:119], v[44:47]
    v_mfma_f32_16x16x32_bf16 v[8:11], v[88:91], v[116:119], v[8:11]
    v_mfma_f32_16x16x32_bf16 v[40:43], v[92:95], v[116:119], v[40:43]
    s_waitcnt lgkmcnt(4)
    v_mfma_f32_16x16x32_bf16 v[24:27], v[64:67], v[96:99], v[24:27]
    v_mfma_f32_16x16x32_bf16 v[56:59], v[68:71], v[96:99], v[56:59]
    v_mfma_f32_16x16x32_bf16 v[20:23], v[72:75], v[96:99], v[20:23]
    v_mfma_f32_16x16x32_bf16 v[52:55], v[76:79], v[96:99], v[52:55]
    v_mfma_f32_16x16x32_bf16 v[16:19], v[80:83], v[96:99], v[16:19]
    v_mfma_f32_16x16x32_bf16 v[48:51], v[84:87], v[96:99], v[48:51]
    v_mfma_f32_16x16x32_bf16 v[12:15], v[88:91], v[96:99], v[12:15]
    v_mfma_f32_16x16x32_bf16 v[44:47], v[92:95], v[96:99], v[44:47]
    s_waitcnt lgkmcnt(3)
    v_mfma_f32_16x16x32_bf16 v[28:31], v[64:67], v[100:103], v[28:31]
    v_mfma_f32_16x16x32_bf16 v[60:63], v[68:71], v[100:103], v[60:63]
    v_mfma_f32_16x16x32_bf16 v[24:27], v[72:75], v[100:103], v[24:27]
    v_mfma_f32_16x16x32_bf16 v[56:59], v[76:79], v[100:103], v[56:59]
    v_mfma_f32_16x16x32_bf16 v[20:23], v[80:83], v[100:103], v[20:23]
    v_mfma_f32_16x16x32_bf16 v[52:55], v[84:87], v[100:103], v[52:55]
    v_mfma_f32_16x16x32_bf16 v[16:19], v[88:91], v[100:103], v[16:19]
    v_mfma_f32_16x16x32_bf16 v[48:51], v[92:95], v[100:103], v[48:51]
    buffer_load_dwordx4 v[64:67], v125, s[12:15], s23 offen offset:0
    buffer_load_dwordx4 v[68:71], v125, s[12:15], s23 offen offset:1024
    s_waitcnt lgkmcnt(2)
    v_mfma_f32_16x16x32_bf16 v[28:31], v[72:75], v[104:107], v[28:31]
    v_mfma_f32_16x16x32_bf16 v[60:63], v[76:79], v[104:107], v[60:63]
    v_mfma_f32_16x16x32_bf16 v[24:27], v[80:83], v[104:107], v[24:27]
    v_mfma_f32_16x16x32_bf16 v[56:59], v[84:87], v[104:107], v[56:59]
    v_mfma_f32_16x16x32_bf16 v[20:23], v[88:91], v[104:107], v[20:23]
    v_mfma_f32_16x16x32_bf16 v[52:55], v[92:95], v[104:107], v[52:55]
    buffer_load_dwordx4 v[72:75], v125, s[12:15], s23 offen offset:2048
    buffer_load_dwordx4 v[76:79], v125, s[12:15], s23 offen offset:3072
    s_waitcnt lgkmcnt(1)
    v_mfma_f32_16x16x32_bf16 v[28:31], v[80:83], v[108:111], v[28:31]
    v_mfma_f32_16x16x32_bf16 v[60:63], v[84:87], v[108:111], v[60:63]
    v_mfma_f32_16x16x32_bf16 v[24:27], v[88:91], v[108:111], v[24:27]
    v_mfma_f32_16x16x32_bf16 v[56:59], v[92:95], v[108:111], v[56:59]
    buffer_load_dwordx4 v[80:83], v125, s[12:15], s26 offen offset:0
    buffer_load_dwordx4 v[84:87], v125, s[12:15], s26 offen offset:1024
    s_waitcnt lgkmcnt(0)
    v_mfma_f32_16x16x32_bf16 v[28:31], v[88:91], v[112:115], v[28:31]
    v_mfma_f32_16x16x32_bf16 v[60:63], v[92:95], v[112:115], v[60:63]
    buffer_load_dwordx4 v[88:91], v125, s[12:15], s26 offen offset:2048
    buffer_load_dwordx4 v[92:95], v125, s[12:15], s26 offen offset:3072
    s_add_u32 s23, s23, 57344
    s_add_u32 s26, s26, 57344
    s_barrier
    s_branch L_conv1_kernel_mloop1
L_conv1_kernel_mlast1:
    v_and_b32 v125, 15, v127
    v_and_b32 v126, 7, v127
    v_lshlrev_b32 v126, 4, v126
    v_lshl_add_u32 v125, v125, 7, v126
    v_lshrrev_b32 v126, 4, v127
    v_lshl_add_u32 v125, v126, 11, v125
    s_lshl_b32 s36, s20, 14
    s_add_u32 s37, s36, 8192
    v_add_u32 v126, s37, v125
    v_add_u32 v125, s36, v125
    ds_read_b128 v[96:99], v120 offset:8192
    ds_read_b128 v[100:103], v120 offset:9216
    ds_read_b128 v[104:107], v120 offset:10240
    ds_read_b128 v[108:111], v120 offset:11264
    ds_read_b128 v[112:115], v120 offset:12288
    ds_read_b128 v[116:119], v120 offset:13312
    s_waitcnt vmcnt(6) lgkmcnt(5)
    v_mfma_f32_16x16x32_bf16 v[0:3], v[64:67], v[96:99], v[0:3]
    v_mfma_f32_16x16x32_bf16 v[32:35], v[68:71], v[96:99], v[32:35]
    ds_read_b128 v[96:99], v120 offset:14336
    s_waitcnt vmcnt(4) lgkmcnt(5)
    v_mfma_f32_16x16x32_bf16 v[4:7], v[64:67], v[100:103], v[4:7]
    v_mfma_f32_16x16x32_bf16 v[36:39], v[68:71], v[100:103], v[36:39]
    v_mfma_f32_16x16x32_bf16 v[0:3], v[72:75], v[100:103], v[0:3]
    v_mfma_f32_16x16x32_bf16 v[32:35], v[76:79], v[100:103], v[32:35]
    ds_read_b128 v[100:103], v120 offset:15360
    s_waitcnt vmcnt(2) lgkmcnt(5)
    v_mfma_f32_16x16x32_bf16 v[8:11], v[64:67], v[104:107], v[8:11]
    v_mfma_f32_16x16x32_bf16 v[40:43], v[68:71], v[104:107], v[40:43]
    v_mfma_f32_16x16x32_bf16 v[4:7], v[72:75], v[104:107], v[4:7]
    v_mfma_f32_16x16x32_bf16 v[36:39], v[76:79], v[104:107], v[36:39]
    v_mfma_f32_16x16x32_bf16 v[0:3], v[80:83], v[104:107], v[0:3]
    v_mfma_f32_16x16x32_bf16 v[32:35], v[84:87], v[104:107], v[32:35]
    ds_read_b128 v[104:107], v122 offset:0
    s_waitcnt vmcnt(0) lgkmcnt(5)
    v_mfma_f32_16x16x32_bf16 v[12:15], v[64:67], v[108:111], v[12:15]
    v_mfma_f32_16x16x32_bf16 v[44:47], v[68:71], v[108:111], v[44:47]
    v_mfma_f32_16x16x32_bf16 v[8:11], v[72:75], v[108:111], v[8:11]
    v_mfma_f32_16x16x32_bf16 v[40:43], v[76:79], v[108:111], v[40:43]
    v_mfma_f32_16x16x32_bf16 v[4:7], v[80:83], v[108:111], v[4:7]
    v_mfma_f32_16x16x32_bf16 v[36:39], v[84:87], v[108:111], v[36:39]
    v_mfma_f32_16x16x32_bf16 v[0:3], v[88:91], v[108:111], v[0:3]
    v_mfma_f32_16x16x32_bf16 v[32:35], v[92:95], v[108:111], v[32:35]
    ds_read_b128 v[108:111], v121 offset:9216
    s_waitcnt lgkmcnt(5)
    v_mfma_f32_16x16x32_bf16 v[16:19], v[64:67], v[112:115], v[16:19]
    v_mfma_f32_16x16x32_bf16 v[48:51], v[68:71], v[112:115], v[48:51]
    v_mfma_f32_16x16x32_bf16 v[12:15], v[72:75], v[112:115], v[12:15]
    v_mfma_f32_16x16x32_bf16 v[44:47], v[76:79], v[112:115], v[44:47]
    v_mfma_f32_16x16x32_bf16 v[8:11], v[80:83], v[112:115], v[8:11]
    v_mfma_f32_16x16x32_bf16 v[40:43], v[84:87], v[112:115], v[40:43]
    v_mfma_f32_16x16x32_bf16 v[4:7], v[88:91], v[112:115], v[4:7]
    v_mfma_f32_16x16x32_bf16 v[36:39], v[92:95], v[112:115], v[36:39]
    ds_read_b128 v[112:115], v121 offset:10240
    v_xor_b32 v123, 0, v125
    ds_write_b128 v123, v[0:3]
    s_waitcnt lgkmcnt(6)
    v_mfma_f32_16x16x32_bf16 v[20:23], v[64:67], v[116:119], v[20:23]
    v_mfma_f32_16x16x32_bf16 v[52:55], v[68:71], v[116:119], v[52:55]
    v_mfma_f32_16x16x32_bf16 v[16:19], v[72:75], v[116:119], v[16:19]
    v_mfma_f32_16x16x32_bf16 v[48:51], v[76:79], v[116:119], v[48:51]
    v_mfma_f32_16x16x32_bf16 v[12:15], v[80:83], v[116:119], v[12:15]
    v_mfma_f32_16x16x32_bf16 v[44:47], v[84:87], v[116:119], v[44:47]
    v_mfma_f32_16x16x32_bf16 v[8:11], v[88:91], v[116:119], v[8:11]
    v_mfma_f32_16x16x32_bf16 v[40:43], v[92:95], v[116:119], v[40:43]
    v_xor_b32 v124, 16, v125
    ds_write_b128 v124, v[4:7]
    s_waitcnt lgkmcnt(2)
    v_mfma_f32_16x16x32_bf16 v[24:27], v[64:67], v[96:99], v[24:27]
    v_mfma_f32_16x16x32_bf16 v[56:59], v[68:71], v[96:99], v[56:59]
    v_mfma_f32_16x16x32_bf16 v[20:23], v[72:75], v[96:99], v[20:23]
    v_mfma_f32_16x16x32_bf16 v[52:55], v[76:79], v[96:99], v[52:55]
    v_mfma_f32_16x16x32_bf16 v[16:19], v[80:83], v[96:99], v[16:19]
    v_mfma_f32_16x16x32_bf16 v[48:51], v[84:87], v[96:99], v[48:51]
    v_mfma_f32_16x16x32_bf16 v[12:15], v[88:91], v[96:99], v[12:15]
    v_mfma_f32_16x16x32_bf16 v[44:47], v[92:95], v[96:99], v[44:47]
    v_xor_b32 v123, 32, v125
    ds_write_b128 v123, v[8:11]
    v_xor_b32 v124, 0, v126
    ds_write_b128 v124, v[32:35]
    v_mfma_f32_16x16x32_bf16 v[28:31], v[64:67], v[100:103], v[28:31]
    v_mfma_f32_16x16x32_bf16 v[60:63], v[68:71], v[100:103], v[60:63]
    v_mfma_f32_16x16x32_bf16 v[24:27], v[72:75], v[100:103], v[24:27]
    v_mfma_f32_16x16x32_bf16 v[56:59], v[76:79], v[100:103], v[56:59]
    v_mfma_f32_16x16x32_bf16 v[20:23], v[80:83], v[100:103], v[20:23]
    v_mfma_f32_16x16x32_bf16 v[52:55], v[84:87], v[100:103], v[52:55]
    v_mfma_f32_16x16x32_bf16 v[16:19], v[88:91], v[100:103], v[16:19]
    v_mfma_f32_16x16x32_bf16 v[48:51], v[92:95], v[100:103], v[48:51]
    v_xor_b32 v123, 16, v126
    ds_write_b128 v123, v[36:39]
    v_xor_b32 v124, 32, v126
    ds_write_b128 v124, v[40:43]
    v_mfma_f32_16x16x32_bf16 v[28:31], v[72:75], v[104:107], v[28:31]
    v_mfma_f32_16x16x32_bf16 v[60:63], v[76:79], v[104:107], v[60:63]
    v_mfma_f32_16x16x32_bf16 v[24:27], v[80:83], v[104:107], v[24:27]
    v_mfma_f32_16x16x32_bf16 v[56:59], v[84:87], v[104:107], v[56:59]
    v_mfma_f32_16x16x32_bf16 v[20:23], v[88:91], v[104:107], v[20:23]
    v_mfma_f32_16x16x32_bf16 v[52:55], v[92:95], v[104:107], v[52:55]
    v_xor_b32 v124, 48, v125
    ds_write_b128 v124, v[12:15]
    v_xor_b32 v123, 48, v126
    ds_write_b128 v123, v[44:47]
    v_mfma_f32_16x16x32_bf16 v[28:31], v[80:83], v[108:111], v[28:31]
    v_mfma_f32_16x16x32_bf16 v[60:63], v[84:87], v[108:111], v[60:63]
    v_mfma_f32_16x16x32_bf16 v[24:27], v[88:91], v[108:111], v[24:27]
    v_mfma_f32_16x16x32_bf16 v[56:59], v[92:95], v[108:111], v[56:59]
    v_xor_b32 v123, 64, v125
    ds_write_b128 v123, v[16:19]
    v_xor_b32 v124, 64, v126
    ds_write_b128 v124, v[48:51]
    v_mfma_f32_16x16x32_bf16 v[28:31], v[88:91], v[112:115], v[28:31]
    v_mfma_f32_16x16x32_bf16 v[60:63], v[92:95], v[112:115], v[60:63]
    v_xor_b32 v124, 80, v125
    ds_write_b128 v124, v[20:23]
    v_xor_b32 v123, 80, v126
    ds_write_b128 v123, v[52:55]
    v_and_b32 v108, 15, v127
    v_lshrrev_b32 v109, 4, v127
    v_lshrrev_b32 v110, 3, v108
    s_lshl_b32 s36, s20, 1
    v_add_u32 v110, s36, v110
    v_xor_b32 v111, v110, v108
    v_and_b32 v111, 7, v111
    v_lshlrev_b32 v111, 4, v111
    v_xor_b32 v123, 96, v125
    ds_write_b128 v123, v[24:27]
    v_lshl_add_u32 v111, v110, 7, v111
    v_lshl_add_u32 v120, v109, 11, v111
    v_add_u32 v121, 65536, v120
    v_add_u32 v64, 131072, v120
    s_lshl_b32 s36, s20, 9
    s_add_u32 s36, s36, 115712
    v_lshl_add_u32 v127, v109, 7, s36
    s_lshl_b32 s36, s20, 4
    v_add_u32 v108, s36, v108
    v_lshlrev_b32 v110, 6, v108
    v_lshl_add_u32 v110, v109, 4, v110
    s_mul_i32 s36, s29, 524288
    v_xor_b32 v124, 96, v126
    ds_write_b128 v124, v[56:59]
    s_lshl_b32 s37, s21, 4
    s_add_u32 s36, s36, s37
    v_add_u32 v110, s36, v110
    v_mov_b32 v111, 2130706432
    v_cmp_gt_u32 vcc, 125, v108
    s_mov_b32 s4, 0xbeaaaaab
    s_mov_b32 s5, s4
    s_mov_b32 s6, 0x3e800000
    s_mov_b32 s7, s6
    s_mov_b32 s8, 0xc0a00000
    s_mov_b32 s9, s8
    s_mov_b32 s10, 0xc0638e39
    v_xor_b32 v124, 112, v125
    ds_write_b128 v124, v[28:31]
    s_mov_b32 s11, s10
    s_mov_b32 s12, 0xbf638e39
    s_mov_b32 s13, s12
    s_mov_b32 s14, 0xbe638e39
    s_mov_b32 s15, s14
    s_mov_b32 s22, 0xbd638e39
    s_mov_b32 s23, s22
    s_mov_b32 s24, 0x3ff1c71c
    s_mov_b32 s25, s24
    s_mov_b32 s26, 0xbf2aaaab
    s_mov_b32 s27, s26
    s_mov_b32 s32, 0x3ecccccd
    v_xor_b32 v123, 112, v126
    s_waitcnt lgkmcnt(8)
    ds_write_b128 v123, v[60:63]
    s_mov_b32 s33, s32
    s_mov_b32 s34, 0xbd888889
    s_mov_b32 s35, s34
    s_mov_b32 s38, 0xbe4ccccd
    s_mov_b32 s39, s38
    s_mov_b32 s40, 0xbdd2d3e8
    s_mov_b32 s41, s40
    s_mov_b32 s42, 0x3f800000
    s_mov_b32 s43, s42
    s_setprio 0
    s_branch L_conv1_kernel_epi
L_conv1_kernel_m2:
    s_mul_i32 s37, s38, 2176
    s_add_u32 s37, s37, 98304
    v_add_u32 v116, s37, v8
    v_add_u32 v118, s37, v9
    v_add_u32 v117, 104832, v8
    s_cmp_eq_u32 s38, 0
    s_cbranch_scc1 L_conv1_kernel_hh0
    v_add_u32 v117, 98304, v9
L_conv1_kernel_hh0:
    s_lshl_b32 s37, s38, 12
    s_add_u32 s37, s37, s43
    s_add_u32 s37, s37, 49152
    v_lshl_add_u32 v119, v127, 4, s37
    v_mov_b32 v0, 0
    v_mov_b32 v1, 0
    v_mov_b32 v2, 0
    v_mov_b32 v3, 0
    v_mov_b32 v4, 0
    v_mov_b32 v5, 0
    v_mov_b32 v6, 0
    v_mov_b32 v7, 0
    v_mov_b32 v8, 0
    v_mov_b32 v9, 0
    v_mov_b32 v10, 0
    v_mov_b32 v11, 0
    v_mov_b32 v12, 0
    v_mov_b32 v13, 0
    v_mov_b32 v14, 0
    v_mov_b32 v15, 0
    v_mov_b32 v16, 0
    v_mov_b32 v17, 0
    v_mov_b32 v18, 0
    v_mov_b32 v19, 0
    v_mov_b32 v20, 0
    v_mov_b32 v21, 0
    v_mov_b32 v22, 0
    v_mov_b32 v23, 0
    v_mov_b32 v24, 0
    v_mov_b32 v25, 0
    v_mov_b32 v26, 0
    v_mov_b32 v27, 0
    v_mov_b32 v28, 0
    v_mov_b32 v29, 0
    v_mov_b32 v30, 0
    v_mov_b32 v31, 0
    v_mov_b32 v32, 0
    v_mov_b32 v33, 0
    v_mov_b32 v34, 0
    v_mov_b32 v35, 0
    v_mov_b32 v36, 0
    v_mov_b32 v37, 0
    v_mov_b32 v38, 0
    v_mov_b32 v39, 0
    v_mov_b32 v40, 0
    v_mov_b32 v41, 0
    v_mov_b32 v42, 0
    v_mov_b32 v43, 0
    v_mov_b32 v44, 0
    v_mov_b32 v45, 0
    v_mov_b32 v46, 0
    v_mov_b32 v47, 0
    v_mov_b32 v48, 0
    v_mov_b32 v49, 0
    v_mov_b32 v50, 0
    v_mov_b32 v51, 0
    v_mov_b32 v52, 0
    v_mov_b32 v53, 0
    v_mov_b32 v54, 0
    v_mov_b32 v55, 0
    v_mov_b32 v56, 0
    v_mov_b32 v57, 0
    v_mov_b32 v58, 0
    v_mov_b32 v59, 0
    v_mov_b32 v60, 0
    v_mov_b32 v61, 0
    v_mov_b32 v62, 0
    v_mov_b32 v63, 0
    buffer_load_dwordx4 v[96:99], v108, s[8:11], 0 offen
    buffer_load_dwordx4 v[100:103], v109, s[8:11], 0 offen
    buffer_load_dwordx4 v[104:107], v110, s[8:11], 0 offen
    s_mov_b32 s23, 0
    s_mov_b32 s26, 4096
    buffer_load_dwordx4 v[64:67], v125, s[12:15], s23 offen offset:0
    buffer_load_dwordx4 v[68:71], v125, s[12:15], s23 offen offset:2048
    buffer_load_dwordx4 v[80:83], v119, s[12:15], s23 offen offset:0
    buffer_load_dwordx4 v[72:75], v125, s[12:15], s26 offen offset:0
    buffer_load_dwordx4 v[84:87], v119, s[12:15], s23 offen offset:2048
    buffer_load_dwordx4 v[76:79], v125, s[12:15], s26 offen offset:2048
    s_mov_b32 s23, 57344
    s_mov_b32 s26, 61440
    s_waitcnt vmcnt(6)
    v_lshlrev_b32 v108, 16, v96
    v_and_b32 v111, s25, v96
    v_lshlrev_b32 v109, 16, v100
    v_and_b32 v112, s25, v100
    v_lshlrev_b32 v110, 16, v104
    v_and_b32 v113, s25, v104
    v_mul_f32 v114, s44, v108
    v_mul_f32 v115, s44, v111
    v_fmac_f32 v114, s45, v109
    v_fmac_f32 v115, s45, v112
    v_fmac_f32 v114, s46, v110
    v_fmac_f32 v115, s46, v113
    v_cvt_pk_bf16_f32 v96, v114, v115
    v_lshlrev_b32 v108, 16, v97
    v_and_b32 v111, s25, v97
    v_lshlrev_b32 v109, 16, v101
    v_and_b32 v112, s25, v101
    v_lshlrev_b32 v110, 16, v105
    v_and_b32 v113, s25, v105
    v_mul_f32 v114, s44, v108
    v_mul_f32 v115, s44, v111
    v_fmac_f32 v114, s45, v109
    v_fmac_f32 v115, s45, v112
    v_fmac_f32 v114, s46, v110
    v_fmac_f32 v115, s46, v113
    v_cvt_pk_bf16_f32 v97, v114, v115
    v_lshlrev_b32 v108, 16, v98
    v_and_b32 v111, s25, v98
    v_lshlrev_b32 v109, 16, v102
    v_and_b32 v112, s25, v102
    v_lshlrev_b32 v110, 16, v106
    v_and_b32 v113, s25, v106
    v_mul_f32 v114, s44, v108
    v_mul_f32 v115, s44, v111
    v_fmac_f32 v114, s45, v109
    v_fmac_f32 v115, s45, v112
    v_fmac_f32 v114, s46, v110
    v_fmac_f32 v115, s46, v113
    v_cvt_pk_bf16_f32 v98, v114, v115
    v_lshlrev_b32 v108, 16, v99
    v_and_b32 v111, s25, v99
    v_lshlrev_b32 v109, 16, v103
    v_and_b32 v112, s25, v103
    v_lshlrev_b32 v110, 16, v107
    v_and_b32 v113, s25, v107
    v_mul_f32 v114, s44, v108
    v_mul_f32 v115, s44, v111
    v_fmac_f32 v114, s45, v109
    v_fmac_f32 v115, s45, v112
    v_fmac_f32 v114, s46, v110
    v_fmac_f32 v115, s46, v113
    v_cvt_pk_bf16_f32 v99, v114, v115
    ds_write_b128 v126, v[96:99]
    v_and_b32 v111, 15, v127
    v_lshlrev_b32 v111, 2, v111
    v_add_u32 v111, 99328, v111
    ds_write_b32 v111, v0
    ds_write_b32 v111, v0 offset:8704
    s_waitcnt lgkmcnt(0)
    s_barrier
    s_mov_b32 s22, 8
    s_setprio 2
L_conv1_kernel_mloop2:
    ds_read_b128 v[88:91], v120 offset:0
    ds_read_b128 v[92:95], v120 offset:1024
    ds_read_b128 v[96:99], v116 offset:0
    ds_read_b128 v[100:103], v120 offset:2048
    ds_read_b128 v[104:107], v116 offset:1088
    ds_read_b128 v[108:111], v120 offset:3072
    ds_read_b128 v[112:115], v116 offset:2176
    s_waitcnt vmcnt(5) lgkmcnt(6)
    v_mfma_f32_16x16x32_bf16 v[0:3], v[64:67], v[88:91], v[0:3]
    ds_read_b128 v[88:91], v120 offset:4096
    s_waitcnt vmcnt(4) lgkmcnt(6)
    v_mfma_f32_16x16x32_bf16 v[4:7], v[64:67], v[92:95], v[4:7]
    v_mfma_f32_16x16x32_bf16 v[0:3], v[68:71], v[92:95], v[0:3]
    ds_read_b128 v[92:95], v116 offset:3264
    s_waitcnt vmcnt(3) lgkmcnt(6)
    v_mfma_f32_16x16x32_bf16 v[32:35], v[80:83], v[96:99], v[32:35]
    ds_read_b128 v[96:99], v120 offset:5120
    s_waitcnt vmcnt(2) lgkmcnt(6)
    v_mfma_f32_16x16x32_bf16 v[8:11], v[64:67], v[100:103], v[8:11]
    v_mfma_f32_16x16x32_bf16 v[4:7], v[68:71], v[100:103], v[4:7]
    v_mfma_f32_16x16x32_bf16 v[0:3], v[72:75], v[100:103], v[0:3]
    ds_read_b128 v[100:103], v116 offset:4352
    s_waitcnt vmcnt(1) lgkmcnt(6)
    v_mfma_f32_16x16x32_bf16 v[36:39], v[80:83], v[104:107], v[36:39]
    v_mfma_f32_16x16x32_bf16 v[32:35], v[84:87], v[104:107], v[32:35]
    ds_read_b128 v[104:107], v120 offset:6144
    s_waitcnt vmcnt(0) lgkmcnt(6)
    v_mfma_f32_16x16x32_bf16 v[12:15], v[64:67], v[108:111], v[12:15]
    v_mfma_f32_16x16x32_bf16 v[8:11], v[68:71], v[108:111], v[8:11]
    v_mfma_f32_16x16x32_bf16 v[4:7], v[72:75], v[108:111], v[4:7]
    v_mfma_f32_16x16x32_bf16 v[0:3], v[76:79], v[108:111], v[0:3]
    ds_read_b128 v[108:111], v116 offset:5440
    s_waitcnt lgkmcnt(6)
    v_mfma_f32_16x16x32_bf16 v[40:43], v[80:83], v[112:115], v[40:43]
    v_mfma_f32_16x16x32_bf16 v[36:39], v[84:87], v[112:115], v[36:39]
    ds_read_b128 v[112:115], v120 offset:7168
    s_waitcnt lgkmcnt(6)
    v_mfma_f32_16x16x32_bf16 v[16:19], v[64:67], v[88:91], v[16:19]
    v_mfma_f32_16x16x32_bf16 v[12:15], v[68:71], v[88:91], v[12:15]
    v_mfma_f32_16x16x32_bf16 v[8:11], v[72:75], v[88:91], v[8:11]
    v_mfma_f32_16x16x32_bf16 v[4:7], v[76:79], v[88:91], v[4:7]
    ds_read_b128 v[88:91], v117 offset:0
    s_waitcnt lgkmcnt(6)
    v_mfma_f32_16x16x32_bf16 v[44:47], v[80:83], v[92:95], v[44:47]
    v_mfma_f32_16x16x32_bf16 v[40:43], v[84:87], v[92:95], v[40:43]
    ds_read_b128 v[92:95], v122 offset:0
    v_add_u32 v122, v123, v122
    s_waitcnt lgkmcnt(6)
    v_mfma_f32_16x16x32_bf16 v[20:23], v[64:67], v[96:99], v[20:23]
    v_mfma_f32_16x16x32_bf16 v[16:19], v[68:71], v[96:99], v[16:19]
    v_mfma_f32_16x16x32_bf16 v[12:15], v[72:75], v[96:99], v[12:15]
    v_mfma_f32_16x16x32_bf16 v[8:11], v[76:79], v[96:99], v[8:11]
    ds_read_b128 v[96:99], v117 offset:1088
    s_waitcnt lgkmcnt(6)
    v_mfma_f32_16x16x32_bf16 v[48:51], v[80:83], v[100:103], v[48:51]
    v_mfma_f32_16x16x32_bf16 v[44:47], v[84:87], v[100:103], v[44:47]
    ds_read_b128 v[100:103], v121 offset:1024
    s_waitcnt lgkmcnt(6)
    v_mfma_f32_16x16x32_bf16 v[24:27], v[64:67], v[104:107], v[24:27]
    v_mfma_f32_16x16x32_bf16 v[20:23], v[68:71], v[104:107], v[20:23]
    v_mfma_f32_16x16x32_bf16 v[16:19], v[72:75], v[104:107], v[16:19]
    v_mfma_f32_16x16x32_bf16 v[12:15], v[76:79], v[104:107], v[12:15]
    ds_read_b128 v[104:107], v118 offset:0
    s_waitcnt lgkmcnt(6)
    v_mfma_f32_16x16x32_bf16 v[52:55], v[80:83], v[108:111], v[52:55]
    v_mfma_f32_16x16x32_bf16 v[48:51], v[84:87], v[108:111], v[48:51]
    ds_read_b128 v[108:111], v121 offset:2048
    s_waitcnt lgkmcnt(6)
    v_mfma_f32_16x16x32_bf16 v[28:31], v[64:67], v[112:115], v[28:31]
    v_mfma_f32_16x16x32_bf16 v[24:27], v[68:71], v[112:115], v[24:27]
    v_mfma_f32_16x16x32_bf16 v[20:23], v[72:75], v[112:115], v[20:23]
    v_mfma_f32_16x16x32_bf16 v[16:19], v[76:79], v[112:115], v[16:19]
    buffer_load_dwordx4 v[64:67], v125, s[12:15], s23 offen offset:0
    s_waitcnt lgkmcnt(5)
    v_mfma_f32_16x16x32_bf16 v[56:59], v[80:83], v[88:91], v[56:59]
    v_mfma_f32_16x16x32_bf16 v[52:55], v[84:87], v[88:91], v[52:55]
    s_waitcnt lgkmcnt(0)
    s_barrier
    v_mfma_f32_16x16x32_bf16 v[28:31], v[68:71], v[92:95], v[28:31]
    v_mfma_f32_16x16x32_bf16 v[24:27], v[72:75], v[92:95], v[24:27]
    v_mfma_f32_16x16x32_bf16 v[20:23], v[76:79], v[92:95], v[20:23]
    buffer_load_dwordx4 v[68:71], v125, s[12:15], s23 offen offset:2048
    v_mfma_f32_16x16x32_bf16 v[60:63], v[80:83], v[96:99], v[60:63]
    v_mfma_f32_16x16x32_bf16 v[56:59], v[84:87], v[96:99], v[56:59]
    buffer_load_dwordx4 v[80:83], v119, s[12:15], s23 offen offset:0
    v_mfma_f32_16x16x32_bf16 v[28:31], v[72:75], v[100:103], v[28:31]
    v_mfma_f32_16x16x32_bf16 v[24:27], v[76:79], v[100:103], v[24:27]
    buffer_load_dwordx4 v[72:75], v125, s[12:15], s26 offen offset:0
    v_mfma_f32_16x16x32_bf16 v[60:63], v[84:87], v[104:107], v[60:63]
    buffer_load_dwordx4 v[84:87], v119, s[12:15], s23 offen offset:2048
    v_mfma_f32_16x16x32_bf16 v[28:31], v[76:79], v[108:111], v[28:31]
    buffer_load_dwordx4 v[76:79], v125, s[12:15], s26 offen offset:2048
    s_add_u32 s23, s23, 57344
    s_add_u32 s26, s26, 57344
    s_sub_u32 s22, s22, 1
    s_cmp_eq_u32 s22, 0
    s_cbranch_scc1 L_conv1_kernel_mlast2
    ds_read_b128 v[88:91], v120 offset:8192
    ds_read_b128 v[92:95], v120 offset:9216
    ds_read_b128 v[96:99], v116 offset:8704
    ds_read_b128 v[100:103], v120 offset:10240
    ds_read_b128 v[104:107], v116 offset:9792
    ds_read_b128 v[108:111], v120 offset:11264
    ds_read_b128 v[112:115], v116 offset:10880
    s_waitcnt vmcnt(5) lgkmcnt(6)
    v_mfma_f32_16x16x32_bf16 v[0:3], v[64:67], v[88:91], v[0:3]
    ds_read_b128 v[88:91], v120 offset:12288
    s_waitcnt vmcnt(4) lgkmcnt(6)
    v_mfma_f32_16x16x32_bf16 v[4:7], v[64:67], v[92:95], v[4:7]
    v_mfma_f32_16x16x32_bf16 v[0:3], v[68:71], v[92:95], v[0:3]
    ds_read_b128 v[92:95], v116 offset:11968
    s_waitcnt vmcnt(3) lgkmcnt(6)
    v_mfma_f32_16x16x32_bf16 v[32:35], v[80:83], v[96:99], v[32:35]
    ds_read_b128 v[96:99], v120 offset:13312
    s_waitcnt vmcnt(2) lgkmcnt(6)
    v_mfma_f32_16x16x32_bf16 v[8:11], v[64:67], v[100:103], v[8:11]
    v_mfma_f32_16x16x32_bf16 v[4:7], v[68:71], v[100:103], v[4:7]
    v_mfma_f32_16x16x32_bf16 v[0:3], v[72:75], v[100:103], v[0:3]
    ds_read_b128 v[100:103], v116 offset:13056
    s_waitcnt vmcnt(1) lgkmcnt(6)
    v_mfma_f32_16x16x32_bf16 v[36:39], v[80:83], v[104:107], v[36:39]
    v_mfma_f32_16x16x32_bf16 v[32:35], v[84:87], v[104:107], v[32:35]
    ds_read_b128 v[104:107], v120 offset:14336
    s_waitcnt vmcnt(0) lgkmcnt(6)
    v_mfma_f32_16x16x32_bf16 v[12:15], v[64:67], v[108:111], v[12:15]
    v_mfma_f32_16x16x32_bf16 v[8:11], v[68:71], v[108:111], v[8:11]
    v_mfma_f32_16x16x32_bf16 v[4:7], v[72:75], v[108:111], v[4:7]
    v_mfma_f32_16x16x32_bf16 v[0:3], v[76:79], v[108:111], v[0:3]
    ds_read_b128 v[108:111], v116 offset:14144
    s_waitcnt lgkmcnt(6)
    v_mfma_f32_16x16x32_bf16 v[40:43], v[80:83], v[112:115], v[40:43]
    v_mfma_f32_16x16x32_bf16 v[36:39], v[84:87], v[112:115], v[36:39]
    ds_read_b128 v[112:115], v120 offset:15360
    s_waitcnt lgkmcnt(6)
    v_mfma_f32_16x16x32_bf16 v[16:19], v[64:67], v[88:91], v[16:19]
    v_mfma_f32_16x16x32_bf16 v[12:15], v[68:71], v[88:91], v[12:15]
    v_mfma_f32_16x16x32_bf16 v[8:11], v[72:75], v[88:91], v[8:11]
    v_mfma_f32_16x16x32_bf16 v[4:7], v[76:79], v[88:91], v[4:7]
    ds_read_b128 v[88:91], v117 offset:8704
    s_waitcnt lgkmcnt(6)
    v_mfma_f32_16x16x32_bf16 v[44:47], v[80:83], v[92:95], v[44:47]
    v_mfma_f32_16x16x32_bf16 v[40:43], v[84:87], v[92:95], v[40:43]
    ds_read_b128 v[92:95], v122 offset:0
    v_add_u32 v122, v124, v122
    s_waitcnt lgkmcnt(6)
    v_mfma_f32_16x16x32_bf16 v[20:23], v[64:67], v[96:99], v[20:23]
    v_mfma_f32_16x16x32_bf16 v[16:19], v[68:71], v[96:99], v[16:19]
    v_mfma_f32_16x16x32_bf16 v[12:15], v[72:75], v[96:99], v[12:15]
    v_mfma_f32_16x16x32_bf16 v[8:11], v[76:79], v[96:99], v[8:11]
    ds_read_b128 v[96:99], v117 offset:9792
    s_waitcnt lgkmcnt(6)
    v_mfma_f32_16x16x32_bf16 v[48:51], v[80:83], v[100:103], v[48:51]
    v_mfma_f32_16x16x32_bf16 v[44:47], v[84:87], v[100:103], v[44:47]
    ds_read_b128 v[100:103], v121 offset:9216
    s_waitcnt lgkmcnt(6)
    v_mfma_f32_16x16x32_bf16 v[24:27], v[64:67], v[104:107], v[24:27]
    v_mfma_f32_16x16x32_bf16 v[20:23], v[68:71], v[104:107], v[20:23]
    v_mfma_f32_16x16x32_bf16 v[16:19], v[72:75], v[104:107], v[16:19]
    v_mfma_f32_16x16x32_bf16 v[12:15], v[76:79], v[104:107], v[12:15]
    ds_read_b128 v[104:107], v118 offset:8704
    s_waitcnt lgkmcnt(6)
    v_mfma_f32_16x16x32_bf16 v[52:55], v[80:83], v[108:111], v[52:55]
    v_mfma_f32_16x16x32_bf16 v[48:51], v[84:87], v[108:111], v[48:51]
    ds_read_b128 v[108:111], v121 offset:10240
    s_waitcnt lgkmcnt(6)
    v_mfma_f32_16x16x32_bf16 v[28:31], v[64:67], v[112:115], v[28:31]
    v_mfma_f32_16x16x32_bf16 v[24:27], v[68:71], v[112:115], v[24:27]
    v_mfma_f32_16x16x32_bf16 v[20:23], v[72:75], v[112:115], v[20:23]
    v_mfma_f32_16x16x32_bf16 v[16:19], v[76:79], v[112:115], v[16:19]
    buffer_load_dwordx4 v[64:67], v125, s[12:15], s23 offen offset:0
    s_waitcnt lgkmcnt(5)
    v_mfma_f32_16x16x32_bf16 v[56:59], v[80:83], v[88:91], v[56:59]
    v_mfma_f32_16x16x32_bf16 v[52:55], v[84:87], v[88:91], v[52:55]
    s_waitcnt lgkmcnt(0)
    s_barrier
    v_mfma_f32_16x16x32_bf16 v[28:31], v[68:71], v[92:95], v[28:31]
    v_mfma_f32_16x16x32_bf16 v[24:27], v[72:75], v[92:95], v[24:27]
    v_mfma_f32_16x16x32_bf16 v[20:23], v[76:79], v[92:95], v[20:23]
    buffer_load_dwordx4 v[68:71], v125, s[12:15], s23 offen offset:2048
    v_mfma_f32_16x16x32_bf16 v[60:63], v[80:83], v[96:99], v[60:63]
    v_mfma_f32_16x16x32_bf16 v[56:59], v[84:87], v[96:99], v[56:59]
    buffer_load_dwordx4 v[80:83], v119, s[12:15], s23 offen offset:0
    v_mfma_f32_16x16x32_bf16 v[28:31], v[72:75], v[100:103], v[28:31]
    v_mfma_f32_16x16x32_bf16 v[24:27], v[76:79], v[100:103], v[24:27]
    buffer_load_dwordx4 v[72:75], v125, s[12:15], s26 offen offset:0
    v_mfma_f32_16x16x32_bf16 v[60:63], v[84:87], v[104:107], v[60:63]
    buffer_load_dwordx4 v[84:87], v119, s[12:15], s23 offen offset:2048
    v_mfma_f32_16x16x32_bf16 v[28:31], v[76:79], v[108:111], v[28:31]
    buffer_load_dwordx4 v[76:79], v125, s[12:15], s26 offen offset:2048
    s_add_u32 s23, s23, 57344
    s_add_u32 s26, s26, 57344
    s_branch L_conv1_kernel_mloop2
L_conv1_kernel_mlast2:
    v_and_b32 v125, 15, v127
    v_and_b32 v126, 7, v127
    v_lshlrev_b32 v126, 4, v126
    v_lshl_add_u32 v125, v125, 7, v126
    v_lshrrev_b32 v126, 4, v127
    v_lshl_add_u32 v125, v126, 11, v125
    s_mov_b32 s36, 65536
    s_cmp_eq_u32 s32, 1
    s_cselect_b32 s36, 121856, s36
    s_cmp_eq_u32 s32, 2
    s_cselect_b32 s36, 81920, s36
    s_cmp_eq_u32 s32, 3
    s_cselect_b32 s36, 130048, s36
    s_mov_b32 s37, 98304
    s_cmp_eq_u32 s32, 1
    s_cselect_b32 s37, 138240, s37
    s_cmp_eq_u32 s32, 2
    s_cselect_b32 s37, 146432, s37
    s_cmp_eq_u32 s32, 3
    s_cselect_b32 s37, 154624, s37
    v_add_u32 v126, s37, v125
    v_add_u32 v125, s36, v125
    ds_read_b128 v[88:91], v120 offset:8192
    ds_read_b128 v[92:95], v120 offset:9216
    ds_read_b128 v[96:99], v116 offset:8704
    ds_read_b128 v[100:103], v120 offset:10240
    ds_read_b128 v[104:107], v116 offset:9792
    ds_read_b128 v[108:111], v120 offset:11264
    ds_read_b128 v[112:115], v116 offset:10880
    s_waitcnt vmcnt(5) lgkmcnt(6)
    v_mfma_f32_16x16x32_bf16 v[0:3], v[64:67], v[88:91], v[0:3]
    ds_read_b128 v[88:91], v120 offset:12288
    s_waitcnt vmcnt(4) lgkmcnt(6)
    v_mfma_f32_16x16x32_bf16 v[4:7], v[64:67], v[92:95], v[4:7]
    v_mfma_f32_16x16x32_bf16 v[0:3], v[68:71], v[92:95], v[0:3]
    ds_read_b128 v[92:95], v116 offset:11968
    s_waitcnt vmcnt(3) lgkmcnt(6)
    v_mfma_f32_16x16x32_bf16 v[32:35], v[80:83], v[96:99], v[32:35]
    ds_read_b128 v[96:99], v120 offset:13312
    s_waitcnt vmcnt(2) lgkmcnt(6)
    v_mfma_f32_16x16x32_bf16 v[8:11], v[64:67], v[100:103], v[8:11]
    v_mfma_f32_16x16x32_bf16 v[4:7], v[68:71], v[100:103], v[4:7]
    v_mfma_f32_16x16x32_bf16 v[0:3], v[72:75], v[100:103], v[0:3]
    ds_read_b128 v[100:103], v116 offset:13056
    s_waitcnt vmcnt(1) lgkmcnt(6)
    v_mfma_f32_16x16x32_bf16 v[36:39], v[80:83], v[104:107], v[36:39]
    v_mfma_f32_16x16x32_bf16 v[32:35], v[84:87], v[104:107], v[32:35]
    ds_read_b128 v[104:107], v120 offset:14336
    s_waitcnt vmcnt(0) lgkmcnt(6)
    v_mfma_f32_16x16x32_bf16 v[12:15], v[64:67], v[108:111], v[12:15]
    v_mfma_f32_16x16x32_bf16 v[8:11], v[68:71], v[108:111], v[8:11]
    v_mfma_f32_16x16x32_bf16 v[4:7], v[72:75], v[108:111], v[4:7]
    v_mfma_f32_16x16x32_bf16 v[0:3], v[76:79], v[108:111], v[0:3]
    ds_read_b128 v[108:111], v116 offset:14144
    s_waitcnt lgkmcnt(6)
    v_mfma_f32_16x16x32_bf16 v[40:43], v[80:83], v[112:115], v[40:43]
    v_mfma_f32_16x16x32_bf16 v[36:39], v[84:87], v[112:115], v[36:39]
    ds_read_b128 v[112:115], v120 offset:15360
    s_waitcnt lgkmcnt(6)
    v_mfma_f32_16x16x32_bf16 v[16:19], v[64:67], v[88:91], v[16:19]
    v_mfma_f32_16x16x32_bf16 v[12:15], v[68:71], v[88:91], v[12:15]
    v_mfma_f32_16x16x32_bf16 v[8:11], v[72:75], v[88:91], v[8:11]
    v_mfma_f32_16x16x32_bf16 v[4:7], v[76:79], v[88:91], v[4:7]
    ds_read_b128 v[88:91], v117 offset:8704
    v_xor_b32 v124, 0, v126
    ds_write_b128 v124, v[32:35]
    s_waitcnt lgkmcnt(7)
    v_mfma_f32_16x16x32_bf16 v[44:47], v[80:83], v[92:95], v[44:47]
    v_mfma_f32_16x16x32_bf16 v[40:43], v[84:87], v[92:95], v[40:43]
    ds_read_b128 v[92:95], v122 offset:0
    v_xor_b32 v123, 0, v125
    ds_write_b128 v123, v[0:3]
    s_waitcnt lgkmcnt(8)
    v_mfma_f32_16x16x32_bf16 v[20:23], v[64:67], v[96:99], v[20:23]
    v_mfma_f32_16x16x32_bf16 v[16:19], v[68:71], v[96:99], v[16:19]
    v_mfma_f32_16x16x32_bf16 v[12:15], v[72:75], v[96:99], v[12:15]
    v_mfma_f32_16x16x32_bf16 v[8:11], v[76:79], v[96:99], v[8:11]
    ds_read_b128 v[96:99], v117 offset:9792
    v_xor_b32 v123, 16, v126
    ds_write_b128 v123, v[36:39]
    s_waitcnt lgkmcnt(9)
    v_mfma_f32_16x16x32_bf16 v[48:51], v[80:83], v[100:103], v[48:51]
    v_mfma_f32_16x16x32_bf16 v[44:47], v[84:87], v[100:103], v[44:47]
    ds_read_b128 v[100:103], v121 offset:9216
    v_xor_b32 v124, 16, v125
    ds_write_b128 v124, v[4:7]
    s_waitcnt lgkmcnt(10)
    v_mfma_f32_16x16x32_bf16 v[24:27], v[64:67], v[104:107], v[24:27]
    v_mfma_f32_16x16x32_bf16 v[20:23], v[68:71], v[104:107], v[20:23]
    v_mfma_f32_16x16x32_bf16 v[16:19], v[72:75], v[104:107], v[16:19]
    v_mfma_f32_16x16x32_bf16 v[12:15], v[76:79], v[104:107], v[12:15]
    ds_read_b128 v[104:107], v118 offset:8704
    v_xor_b32 v124, 32, v126
    ds_write_b128 v124, v[40:43]
    s_waitcnt lgkmcnt(11)
    v_mfma_f32_16x16x32_bf16 v[52:55], v[80:83], v[108:111], v[52:55]
    v_mfma_f32_16x16x32_bf16 v[48:51], v[84:87], v[108:111], v[48:51]
    ds_read_b128 v[108:111], v121 offset:10240
    v_xor_b32 v123, 32, v125
    ds_write_b128 v123, v[8:11]
    s_waitcnt lgkmcnt(12)
    v_mfma_f32_16x16x32_bf16 v[28:31], v[64:67], v[112:115], v[28:31]
    v_mfma_f32_16x16x32_bf16 v[24:27], v[68:71], v[112:115], v[24:27]
    v_mfma_f32_16x16x32_bf16 v[20:23], v[72:75], v[112:115], v[20:23]
    v_mfma_f32_16x16x32_bf16 v[16:19], v[76:79], v[112:115], v[16:19]
    v_xor_b32 v123, 48, v126
    ds_write_b128 v123, v[44:47]
    s_waitcnt lgkmcnt(12)
    v_mfma_f32_16x16x32_bf16 v[56:59], v[80:83], v[88:91], v[56:59]
    v_mfma_f32_16x16x32_bf16 v[52:55], v[84:87], v[88:91], v[52:55]
    v_xor_b32 v124, 48, v125
    ds_write_b128 v124, v[12:15]
    s_waitcnt lgkmcnt(11)
    v_mfma_f32_16x16x32_bf16 v[28:31], v[68:71], v[92:95], v[28:31]
    v_mfma_f32_16x16x32_bf16 v[24:27], v[72:75], v[92:95], v[24:27]
    v_mfma_f32_16x16x32_bf16 v[20:23], v[76:79], v[92:95], v[20:23]
    v_xor_b32 v124, 64, v126
    ds_write_b128 v124, v[48:51]
    s_waitcnt lgkmcnt(10)
    v_mfma_f32_16x16x32_bf16 v[60:63], v[80:83], v[96:99], v[60:63]
    v_mfma_f32_16x16x32_bf16 v[56:59], v[84:87], v[96:99], v[56:59]
    v_xor_b32 v123, 64, v125
    ds_write_b128 v123, v[16:19]
    s_waitcnt lgkmcnt(9)
    v_mfma_f32_16x16x32_bf16 v[28:31], v[72:75], v[100:103], v[28:31]
    v_mfma_f32_16x16x32_bf16 v[24:27], v[76:79], v[100:103], v[24:27]
    v_xor_b32 v123, 80, v126
    ds_write_b128 v123, v[52:55]
    s_waitcnt lgkmcnt(8)
    v_mfma_f32_16x16x32_bf16 v[60:63], v[84:87], v[104:107], v[60:63]
    v_xor_b32 v124, 80, v125
    ds_write_b128 v124, v[20:23]
    s_waitcnt lgkmcnt(7)
    v_mfma_f32_16x16x32_bf16 v[28:31], v[76:79], v[108:111], v[28:31]
    v_xor_b32 v124, 96, v126
    ds_write_b128 v124, v[56:59]
    v_and_b32 v108, 15, v127
    v_lshrrev_b32 v109, 4, v127
    v_lshrrev_b32 v110, 3, v108
    s_lshl_b32 s36, s20, 1
    v_add_u32 v110, s36, v110
    v_xor_b32 v111, v110, v108
    v_and_b32 v111, 7, v111
    v_lshlrev_b32 v111, 4, v111
    v_xor_b32 v123, 96, v125
    ds_write_b128 v123, v[24:27]
    v_lshl_add_u32 v111, v110, 7, v111
    v_lshl_add_u32 v120, v109, 11, v111
    v_add_u32 v121, 65536, v120
    v_add_u32 v64, 131072, v120
    s_lshl_b32 s36, s20, 9
    s_add_u32 s36, s36, 115712
    v_lshl_add_u32 v127, v109, 7, s36
    s_lshl_b32 s36, s20, 4
    v_add_u32 v108, s36, v108
    v_lshlrev_b32 v110, 6, v108
    v_lshl_add_u32 v110, v109, 4, v110
    s_mul_i32 s36, s29, 524288
    v_xor_b32 v123, 112, v126
    ds_write_b128 v123, v[60:63]
    s_lshl_b32 s37, s21, 4
    s_add_u32 s36, s36, s37
    v_add_u32 v110, s36, v110
    v_mov_b32 v111, 2130706432
    v_cmp_gt_u32 vcc, 125, v108
    s_mov_b32 s4, 0xbeaaaaab
    s_mov_b32 s5, s4
    s_mov_b32 s6, 0x3e800000
    s_mov_b32 s7, s6
    s_mov_b32 s8, 0xc0a00000
    s_mov_b32 s9, s8
    s_mov_b32 s10, 0xc0638e39
    v_xor_b32 v124, 112, v125
    ds_write_b128 v124, v[28:31]
    s_mov_b32 s11, s10
    s_mov_b32 s12, 0xbf638e39
    s_mov_b32 s13, s12
    s_mov_b32 s14, 0xbe638e39
    s_mov_b32 s15, s14
    s_mov_b32 s22, 0xbd638e39
    s_mov_b32 s23, s22
    s_mov_b32 s24, 0x3ff1c71c
    s_mov_b32 s25, s24
    s_mov_b32 s26, 0xbf2aaaab
    s_mov_b32 s27, s26
    s_mov_b32 s32, 0x3ecccccd
    s_mov_b32 s33, s32
    s_mov_b32 s34, 0xbd888889
    s_mov_b32 s35, s34
    s_mov_b32 s38, 0xbe4ccccd
    s_mov_b32 s39, s38
    s_mov_b32 s40, 0xbdd2d3e8
    s_mov_b32 s41, s40
    s_mov_b32 s42, 0x3f800000
    s_mov_b32 s43, s42
    s_setprio 0
    s_branch L_conv1_kernel_epi
L_conv1_kernel_epi:
    s_waitcnt lgkmcnt(0)
    s_barrier
    v_cndmask_b32 v122, v111, v110, vcc
    ds_read_b128 v[0:3], v120 offset:0
    ds_read_b128 v[4:7], v120 offset:16384
    ds_read_b128 v[8:11], v120 offset:32768
    ds_read_b128 v[12:15], v120 offset:49152
    ds_read_b128 v[16:19], v121 offset:0
    ds_read_b128 v[20:23], v121 offset:16384
    ds_read_b128 v[24:27], v121 offset:32768
    ds_read_b128 v[28:31], v64 offset:15360
    ds_read_b128 v[32:35], v120 offset:8192
    ds_read_b128 v[36:39], v120 offset:24576
    ds_read_b128 v[40:43], v120 offset:40960
    ds_read_b128 v[44:47], v120 offset:57344
    ds_read_b128 v[48:51], v121 offset:56320
    ds_read_b128 v[52:55], v121 offset:64512
    ds_read_b128 v[56:59], v64 offset:7168
    s_waitcnt lgkmcnt(7)
    ds_read_b128 v[60:63], v64 offset:23552
    s_waitcnt lgkmcnt(8)
    v_pk_add_f32 v[88:89], v[24:25], v[28:29]
    v_pk_add_f32 v[90:91], v[26:27], v[30:31]
    v_pk_add_f32 v[24:25], v[4:5], v[8:9]
    v_pk_add_f32 v[26:27], v[6:7], v[10:11]
    v_pk_add_f32 v[4:5], v[4:5], v[8:9] neg_lo:[0,1] neg_hi:[0,1]
    v_pk_add_f32 v[6:7], v[6:7], v[10:11] neg_lo:[0,1] neg_hi:[0,1]
    v_pk_add_f32 v[72:73], v[12:13], v[16:17]
    v_pk_add_f32 v[74:75], v[14:15], v[18:19]
    v_pk_add_f32 v[12:13], v[12:13], v[16:17] neg_lo:[0,1] neg_hi:[0,1]
    v_pk_add_f32 v[14:15], v[14:15], v[18:19] neg_lo:[0,1] neg_hi:[0,1]
    v_pk_fma_f32 v[72:73], v[24:25], s[4:5], v[72:73]
    v_pk_fma_f32 v[74:75], v[26:27], s[4:5], v[74:75]
    v_pk_fma_f32 v[20:21], v[0:1], s[10:11], v[20:21]
    v_pk_fma_f32 v[22:23], v[2:3], s[10:11], v[22:23]
    v_pk_fma_f32 v[72:73], v[0:1], s[6:7], v[72:73]
    v_pk_fma_f32 v[74:75], v[2:3], s[6:7], v[74:75]
    v_pk_add_f32 v[24:25], v[24:25], v[0:1] neg_lo:[0,1] neg_hi:[0,1]
    v_pk_add_f32 v[26:27], v[26:27], v[2:3] neg_lo:[0,1] neg_hi:[0,1]
    v_pk_fma_f32 v[72:73], v[88:89], s[8:9], v[72:73]
    v_pk_fma_f32 v[74:75], v[90:91], s[8:9], v[74:75]
    v_pk_add_f32 v[24:25], v[24:25], v[88:89] neg_lo:[0,1] neg_hi:[0,1]
    v_pk_add_f32 v[26:27], v[26:27], v[90:91] neg_lo:[0,1] neg_hi:[0,1]
    v_pk_fma_f32 v[20:21], v[88:89], s[22:23], v[20:21]
    v_pk_fma_f32 v[22:23], v[90:91], s[22:23], v[22:23]
    v_pk_add_f32 v[8:9], v[24:25], v[72:73] neg_lo:[0,1] neg_hi:[0,1]
    v_pk_add_f32 v[10:11], v[26:27], v[74:75] neg_lo:[0,1] neg_hi:[0,1]
    v_pk_fma_f32 v[20:21], v[72:73], s[14:15], v[20:21]
    v_pk_fma_f32 v[22:23], v[74:75], s[14:15], v[22:23]
    v_pk_mul_f32 v[80:81], v[12:13], s[32:33]
    v_pk_mul_f32 v[82:83], v[14:15], s[32:33]
    v_pk_fma_f32 v[20:21], v[8:9], s[12:13], v[20:21]
    v_pk_fma_f32 v[22:23], v[10:11], s[12:13], v[22:23]
    v_pk_fma_f32 v[80:81], v[4:5], s[34:35], v[80:81]
    v_pk_fma_f32 v[82:83], v[6:7], s[34:35], v[82:83]
    v_pk_fma_f32 v[64:65], v[4:5], s[24:25], v[20:21] neg_lo:[0,0,1] neg_hi:[0,0,1]
    v_pk_fma_f32 v[66:67], v[6:7], s[24:25], v[22:23] neg_lo:[0,0,1] neg_hi:[0,0,1]
    v_pk_fma_f32 v[64:65], v[12:13], s[26:27], v[64:65]
    v_pk_fma_f32 v[66:67], v[14:15], s[26:27], v[66:67]
    v_pk_fma_f32 v[80:81], v[64:65], s[38:39], v[80:81]
    v_pk_fma_f32 v[82:83], v[66:67], s[38:39], v[82:83]
    v_pk_add_f32 v[4:5], v[4:5], v[64:65] neg_lo:[0,1] neg_hi:[0,1]
    v_pk_add_f32 v[6:7], v[6:7], v[66:67] neg_lo:[0,1] neg_hi:[0,1]
    v_pk_add_f32 v[4:5], v[4:5], v[80:81] neg_lo:[0,1] neg_hi:[0,1]
    v_pk_add_f32 v[6:7], v[6:7], v[82:83] neg_lo:[0,1] neg_hi:[0,1]
    s_waitcnt lgkmcnt(0)
    v_pk_add_f32 v[92:93], v[56:57], v[60:61]
    v_pk_add_f32 v[94:95], v[58:59], v[62:63]
    v_pk_add_f32 v[56:57], v[36:37], v[40:41]
    v_pk_add_f32 v[58:59], v[38:39], v[42:43]
    v_pk_add_f32 v[36:37], v[36:37], v[40:41] neg_lo:[0,1] neg_hi:[0,1]
    v_pk_add_f32 v[38:39], v[38:39], v[42:43] neg_lo:[0,1] neg_hi:[0,1]
    v_pk_add_f32 v[76:77], v[44:45], v[48:49]
    v_pk_add_f32 v[78:79], v[46:47], v[50:51]
    v_pk_add_f32 v[44:45], v[44:45], v[48:49] neg_lo:[0,1] neg_hi:[0,1]
    v_pk_add_f32 v[46:47], v[46:47], v[50:51] neg_lo:[0,1] neg_hi:[0,1]
    v_pk_fma_f32 v[76:77], v[56:57], s[4:5], v[76:77]
    v_pk_fma_f32 v[78:79], v[58:59], s[4:5], v[78:79]
    v_pk_fma_f32 v[52:53], v[32:33], s[10:11], v[52:53]
    v_pk_fma_f32 v[54:55], v[34:35], s[10:11], v[54:55]
    v_pk_fma_f32 v[76:77], v[32:33], s[6:7], v[76:77]
    v_pk_fma_f32 v[78:79], v[34:35], s[6:7], v[78:79]
    v_pk_add_f32 v[56:57], v[56:57], v[32:33] neg_lo:[0,1] neg_hi:[0,1]
    v_pk_add_f32 v[58:59], v[58:59], v[34:35] neg_lo:[0,1] neg_hi:[0,1]
    v_pk_fma_f32 v[76:77], v[92:93], s[8:9], v[76:77]
    v_pk_fma_f32 v[78:79], v[94:95], s[8:9], v[78:79]
    v_pk_add_f32 v[56:57], v[56:57], v[92:93] neg_lo:[0,1] neg_hi:[0,1]
    v_pk_add_f32 v[58:59], v[58:59], v[94:95] neg_lo:[0,1] neg_hi:[0,1]
    v_pk_fma_f32 v[52:53], v[92:93], s[22:23], v[52:53]
    v_pk_fma_f32 v[54:55], v[94:95], s[22:23], v[54:55]
    v_pk_add_f32 v[40:41], v[56:57], v[76:77] neg_lo:[0,1] neg_hi:[0,1]
    v_pk_add_f32 v[42:43], v[58:59], v[78:79] neg_lo:[0,1] neg_hi:[0,1]
    v_pk_fma_f32 v[52:53], v[76:77], s[14:15], v[52:53]
    v_pk_fma_f32 v[54:55], v[78:79], s[14:15], v[54:55]
    v_pk_mul_f32 v[84:85], v[44:45], s[32:33]
    v_pk_mul_f32 v[86:87], v[46:47], s[32:33]
    v_pk_fma_f32 v[52:53], v[40:41], s[12:13], v[52:53]
    v_pk_fma_f32 v[54:55], v[42:43], s[12:13], v[54:55]
    v_pk_fma_f32 v[84:85], v[36:37], s[34:35], v[84:85]
    v_pk_fma_f32 v[86:87], v[38:39], s[34:35], v[86:87]
    v_pk_fma_f32 v[68:69], v[36:37], s[24:25], v[52:53] neg_lo:[0,0,1] neg_hi:[0,0,1]
    v_pk_fma_f32 v[70:71], v[38:39], s[24:25], v[54:55] neg_lo:[0,0,1] neg_hi:[0,0,1]
    v_pk_fma_f32 v[68:69], v[44:45], s[26:27], v[68:69]
    v_pk_fma_f32 v[70:71], v[46:47], s[26:27], v[70:71]
    v_pk_fma_f32 v[84:85], v[68:69], s[38:39], v[84:85]
    v_pk_fma_f32 v[86:87], v[70:71], s[38:39], v[86:87]
    v_pk_add_f32 v[36:37], v[36:37], v[68:69] neg_lo:[0,1] neg_hi:[0,1]
    v_pk_add_f32 v[38:39], v[38:39], v[70:71] neg_lo:[0,1] neg_hi:[0,1]
    v_pk_add_f32 v[36:37], v[36:37], v[84:85] neg_lo:[0,1] neg_hi:[0,1]
    v_pk_add_f32 v[38:39], v[38:39], v[86:87] neg_lo:[0,1] neg_hi:[0,1]
    s_mov_b32 s36, 0x00010001
    s_mov_b32 s37, 0x00010001
    s_mov_b64 exec, s[36:37]
    ds_write_b128 v127, v[0:3] offset:0
    ds_write_b128 v127, v[32:35] offset:16
    ds_write_b128 v127, v[4:7] offset:32
    ds_write_b128 v127, v[36:39] offset:48
    ds_write_b128 v127, v[8:11] offset:64
    ds_write_b128 v127, v[40:43] offset:80
    s_mov_b64 exec, -1
    v_mov_b32 v44, 0xc0135761
    v_mov_b32 v45, v44
    v_pk_mul_f32 v[16:17], v[64:65], v[64:65]
    v_pk_mul_f32 v[18:19], v[66:67], v[66:67]
    v_pk_mul_f32 v[20:21], v[68:69], v[68:69]
    v_pk_mul_f32 v[22:23], v[70:71], v[70:71]
    v_pk_fma_f32 v[16:17], v[16:17], s[40:41], v[44:45]
    v_pk_fma_f32 v[18:19], v[18:19], s[40:41], v[44:45]
    v_pk_fma_f32 v[20:21], v[20:21], s[40:41], v[44:45]
    v_pk_fma_f32 v[22:23], v[22:23], s[40:41], v[44:45]
    v_pk_mul_f32 v[16:17], v[16:17], v[64:65]
    v_pk_mul_f32 v[18:19], v[18:19], v[66:67]
    v_pk_mul_f32 v[20:21], v[20:21], v[68:69]
    v_pk_mul_f32 v[22:23], v[22:23], v[70:71]
    v_exp_f32 v16, v16
    v_exp_f32 v17, v17
    v_exp_f32 v18, v18
    v_exp_f32 v19, v19
    v_exp_f32 v20, v20
    v_exp_f32 v21, v21
    v_exp_f32 v22, v22
    v_exp_f32 v23, v23
    v_pk_add_f32 v[16:17], v[16:17], s[42:43]
    v_pk_add_f32 v[18:19], v[18:19], s[42:43]
    v_pk_add_f32 v[20:21], v[20:21], s[42:43]
    v_pk_add_f32 v[22:23], v[22:23], s[42:43]
    v_rcp_f32 v16, v16
    v_rcp_f32 v17, v17
    v_rcp_f32 v18, v18
    v_rcp_f32 v19, v19
    v_rcp_f32 v20, v20
    v_rcp_f32 v21, v21
    v_rcp_f32 v22, v22
    v_rcp_f32 v23, v23
    v_pk_mul_f32 v[64:65], v[64:65], v[16:17]
    v_pk_mul_f32 v[66:67], v[66:67], v[18:19]
    v_pk_mul_f32 v[68:69], v[68:69], v[20:21]
    v_pk_mul_f32 v[70:71], v[70:71], v[22:23]
    v_cvt_pk_bf16_f32 v48, v64, v68
    v_cvt_pk_bf16_f32 v49, v65, v69
    v_cvt_pk_bf16_f32 v50, v66, v70
    v_cvt_pk_bf16_f32 v51, v67, v71
    s_mov_b32 s44, 393280
    buffer_store_dwordx4 v[48:51], v122, s[16:19], s44 offen sc1
    s_waitcnt lgkmcnt(0)
    s_barrier
    ds_read_b128 v[96:99], v127 offset:512
    ds_read_b128 v[100:103], v127 offset:528
    ds_read_b128 v[104:107], v127 offset:544
    ds_read_b128 v[108:111], v127 offset:560
    ds_read_b128 v[112:115], v127 offset:576
    ds_read_b128 v[116:119], v127 offset:592
    s_waitcnt lgkmcnt(4)
    v_mov_b32_dpp v96, v0 row_shl:1 row_mask:0xf bank_mask:0xf
    v_mov_b32_dpp v97, v1 row_shl:1 row_mask:0xf bank_mask:0xf
    v_mov_b32_dpp v98, v2 row_shl:1 row_mask:0xf bank_mask:0xf
    v_mov_b32_dpp v99, v3 row_shl:1 row_mask:0xf bank_mask:0xf
    v_mov_b32_dpp v100, v32 row_shl:1 row_mask:0xf bank_mask:0xf
    v_mov_b32_dpp v101, v33 row_shl:1 row_mask:0xf bank_mask:0xf
    v_mov_b32_dpp v102, v34 row_shl:1 row_mask:0xf bank_mask:0xf
    v_mov_b32_dpp v103, v35 row_shl:1 row_mask:0xf bank_mask:0xf
    v_pk_add_f32 v[72:73], v[72:73], v[96:97]
    v_pk_add_f32 v[74:75], v[74:75], v[98:99]
    v_pk_add_f32 v[76:77], v[76:77], v[100:101]
    v_pk_add_f32 v[78:79], v[78:79], v[102:103]
    v_pk_mul_f32 v[24:25], v[72:73], v[72:73]
    v_pk_mul_f32 v[26:27], v[74:75], v[74:75]
    v_pk_mul_f32 v[28:29], v[76:77], v[76:77]
    v_pk_mul_f32 v[30:31], v[78:79], v[78:79]
    v_pk_fma_f32 v[24:25], v[24:25], s[40:41], v[44:45]
    v_pk_fma_f32 v[26:27], v[26:27], s[40:41], v[44:45]
    v_pk_fma_f32 v[28:29], v[28:29], s[40:41], v[44:45]
    v_pk_fma_f32 v[30:31], v[30:31], s[40:41], v[44:45]
    v_pk_mul_f32 v[24:25], v[24:25], v[72:73]
    v_pk_mul_f32 v[26:27], v[26:27], v[74:75]
    v_pk_mul_f32 v[28:29], v[28:29], v[76:77]
    v_pk_mul_f32 v[30:31], v[30:31], v[78:79]
    v_exp_f32 v24, v24
    v_exp_f32 v25, v25
    v_exp_f32 v26, v26
    v_exp_f32 v27, v27
    v_exp_f32 v28, v28
    v_exp_f32 v29, v29
    v_exp_f32 v30, v30
    v_exp_f32 v31, v31
    v_pk_add_f32 v[24:25], v[24:25], s[42:43]
    v_pk_add_f32 v[26:27], v[26:27], s[42:43]
    v_pk_add_f32 v[28:29], v[28:29], s[42:43]
    v_pk_add_f32 v[30:31], v[30:31], s[42:43]
    v_rcp_f32 v24, v24
    v_rcp_f32 v25, v25
    v_rcp_f32 v26, v26
    v_rcp_f32 v27, v27
    v_rcp_f32 v28, v28
    v_rcp_f32 v29, v29
    v_rcp_f32 v30, v30
    v_rcp_f32 v31, v31
    v_pk_mul_f32 v[72:73], v[72:73], v[24:25]
    v_pk_mul_f32 v[74:75], v[74:75], v[26:27]
    v_pk_mul_f32 v[76:77], v[76:77], v[28:29]
    v_pk_mul_f32 v[78:79], v[78:79], v[30:31]
    v_cvt_pk_bf16_f32 v52, v72, v76
    v_cvt_pk_bf16_f32 v53, v73, v77
    v_cvt_pk_bf16_f32 v54, v74, v78
    v_cvt_pk_bf16_f32 v55, v75, v79
    s_mov_b32 s44, 128
    buffer_store_dwordx4 v[52:55], v122, s[16:19], s44 offen sc1
    s_waitcnt lgkmcnt(2)
    v_mov_b32_dpp v104, v4 row_shl:1 row_mask:0xf bank_mask:0xf
    v_mov_b32_dpp v105, v5 row_shl:1 row_mask:0xf bank_mask:0xf
    v_mov_b32_dpp v106, v6 row_shl:1 row_mask:0xf bank_mask:0xf
    v_mov_b32_dpp v107, v7 row_shl:1 row_mask:0xf bank_mask:0xf
    v_mov_b32_dpp v108, v36 row_shl:1 row_mask:0xf bank_mask:0xf
    v_mov_b32_dpp v109, v37 row_shl:1 row_mask:0xf bank_mask:0xf
    v_mov_b32_dpp v110, v38 row_shl:1 row_mask:0xf bank_mask:0xf
    v_mov_b32_dpp v111, v39 row_shl:1 row_mask:0xf bank_mask:0xf
    v_pk_add_f32 v[80:81], v[80:81], v[104:105]
    v_pk_add_f32 v[82:83], v[82:83], v[106:107]
    v_pk_add_f32 v[84:85], v[84:85], v[108:109]
    v_pk_add_f32 v[86:87], v[86:87], v[110:111]
    v_pk_mul_f32 v[16:17], v[80:81], v[80:81]
    v_pk_mul_f32 v[18:19], v[82:83], v[82:83]
    v_pk_mul_f32 v[20:21], v[84:85], v[84:85]
    v_pk_mul_f32 v[22:23], v[86:87], v[86:87]
    v_pk_fma_f32 v[16:17], v[16:17], s[40:41], v[44:45]
    v_pk_fma_f32 v[18:19], v[18:19], s[40:41], v[44:45]
    v_pk_fma_f32 v[20:21], v[20:21], s[40:41], v[44:45]
    v_pk_fma_f32 v[22:23], v[22:23], s[40:41], v[44:45]
    v_pk_mul_f32 v[16:17], v[16:17], v[80:81]
    v_pk_mul_f32 v[18:19], v[18:19], v[82:83]
    v_pk_mul_f32 v[20:21], v[20:21], v[84:85]
    v_pk_mul_f32 v[22:23], v[22:23], v[86:87]
    v_exp_f32 v16, v16
    v_exp_f32 v17, v17
    v_exp_f32 v18, v18
    v_exp_f32 v19, v19
    v_exp_f32 v20, v20
    v_exp_f32 v21, v21
    v_exp_f32 v22, v22
    v_exp_f32 v23, v23
    v_pk_add_f32 v[16:17], v[16:17], s[42:43]
    v_pk_add_f32 v[18:19], v[18:19], s[42:43]
    v_pk_add_f32 v[20:21], v[20:21], s[42:43]
    v_pk_add_f32 v[22:23], v[22:23], s[42:43]
    v_rcp_f32 v16, v16
    v_rcp_f32 v17, v17
    v_rcp_f32 v18, v18
    v_rcp_f32 v19, v19
    v_rcp_f32 v20, v20
    v_rcp_f32 v21, v21
    v_rcp_f32 v22, v22
    v_rcp_f32 v23, v23
    v_pk_mul_f32 v[80:81], v[80:81], v[16:17]
    v_pk_mul_f32 v[82:83], v[82:83], v[18:19]
    v_pk_mul_f32 v[84:85], v[84:85], v[20:21]
    v_pk_mul_f32 v[86:87], v[86:87], v[22:23]
    v_cvt_pk_bf16_f32 v56, v80, v84
    v_cvt_pk_bf16_f32 v57, v81, v85
    v_cvt_pk_bf16_f32 v58, v82, v86
    v_cvt_pk_bf16_f32 v59, v83, v87
    s_mov_b32 s44, 131200
    buffer_store_dwordx4 v[56:59], v122, s[16:19], s44 offen sc1
    s_waitcnt lgkmcnt(0)
    v_mov_b32_dpp v112, v8 row_shl:1 row_mask:0xf bank_mask:0xf
    v_mov_b32_dpp v113, v9 row_shl:1 row_mask:0xf bank_mask:0xf
    v_mov_b32_dpp v114, v10 row_shl:1 row_mask:0xf bank_mask:0xf
    v_mov_b32_dpp v115, v11 row_shl:1 row_mask:0xf bank_mask:0xf
    v_mov_b32_dpp v116, v40 row_shl:1 row_mask:0xf bank_mask:0xf
    v_mov_b32_dpp v117, v41 row_shl:1 row_mask:0xf bank_mask:0xf
    v_mov_b32_dpp v118, v42 row_shl:1 row_mask:0xf bank_mask:0xf
    v_mov_b32_dpp v119, v43 row_shl:1 row_mask:0xf bank_mask:0xf
    v_pk_add_f32 v[88:89], v[88:89], v[112:113]
    v_pk_add_f32 v[90:91], v[90:91], v[114:115]
    v_pk_add_f32 v[92:93], v[92:93], v[116:117]
    v_pk_add_f32 v[94:95], v[94:95], v[118:119]
    v_pk_mul_f32 v[24:25], v[88:89], v[88:89]
    v_pk_mul_f32 v[26:27], v[90:91], v[90:91]
    v_pk_mul_f32 v[28:29], v[92:93], v[92:93]
    v_pk_mul_f32 v[30:31], v[94:95], v[94:95]
    v_pk_fma_f32 v[24:25], v[24:25], s[40:41], v[44:45]
    v_pk_fma_f32 v[26:27], v[26:27], s[40:41], v[44:45]
    v_pk_fma_f32 v[28:29], v[28:29], s[40:41], v[44:45]
    v_pk_fma_f32 v[30:31], v[30:31], s[40:41], v[44:45]
    v_pk_mul_f32 v[24:25], v[24:25], v[88:89]
    v_pk_mul_f32 v[26:27], v[26:27], v[90:91]
    v_pk_mul_f32 v[28:29], v[28:29], v[92:93]
    v_pk_mul_f32 v[30:31], v[30:31], v[94:95]
    v_exp_f32 v24, v24
    v_exp_f32 v25, v25
    v_exp_f32 v26, v26
    v_exp_f32 v27, v27
    v_exp_f32 v28, v28
    v_exp_f32 v29, v29
    v_exp_f32 v30, v30
    v_exp_f32 v31, v31
    v_pk_add_f32 v[24:25], v[24:25], s[42:43]
    v_pk_add_f32 v[26:27], v[26:27], s[42:43]
    v_pk_add_f32 v[28:29], v[28:29], s[42:43]
    v_pk_add_f32 v[30:31], v[30:31], s[42:43]
    v_rcp_f32 v24, v24
    v_rcp_f32 v25, v25
    v_rcp_f32 v26, v26
    v_rcp_f32 v27, v27
    v_rcp_f32 v28, v28
    v_rcp_f32 v29, v29
    v_rcp_f32 v30, v30
    v_rcp_f32 v31, v31
    v_pk_mul_f32 v[88:89], v[88:89], v[24:25]
    v_pk_mul_f32 v[90:91], v[90:91], v[26:27]
    v_pk_mul_f32 v[92:93], v[92:93], v[28:29]
    v_pk_mul_f32 v[94:95], v[94:95], v[30:31]
    v_cvt_pk_bf16_f32 v60, v88, v92
    v_cvt_pk_bf16_f32 v61, v89, v93
    v_cvt_pk_bf16_f32 v62, v90, v94
    v_cvt_pk_bf16_f32 v63, v91, v95
    s_mov_b32 s44, 262272
    buffer_store_dwordx4 v[60:63], v122, s[16:19], s44 offen sc1
L_conv1_kernel_end:
L_conv1_kernel_done:
    s_endpgm
.globl conv2_kernel
.p2align 8
.type conv2_kernel,@function
conv2_kernel:
    s_cmp_ge_u32 s2, 256
    s_cbranch_scc1 L_conv2_kernel_done
    s_load_dwordx2 s[4:5], s[0:1], 72
    s_load_dwordx2 s[30:31], s[0:1], 72
    v_readfirstlane_b32 s20, v0
    s_lshr_b32 s20, s20, 6
    s_xor_b32 s20, s20, 8
    s_and_b32 s36, s2, 0
    s_lshl_b32 s36, s36, 3
    s_bfe_u32 s37, s2, 196611
    s_or_b32 s29, s36, s37
    s_bfe_u32 s36, s2, 196608
    s_lshl_b32 s36, s36, 2
    s_lshr_b32 s37, s2, 6
    s_or_b32 s36, s36, s37
    s_lshr_b32 s33, s36, 4
    s_and_b32 s34, s36, 7
    s_bfe_u32 s35, s36, 0x10003
    s_mul_i32 s21, s34, 500
    s_and_b32 s32, s20, 3
    v_and_b32 v127, 63, v0
    v_lshrrev_b32 v5, 2, v127
    v_and_b32 v6, 3, v127
    s_and_b32 s42, s20, 7
    s_lshr_b32 s41, s21, 2
    s_sub_u32 s41, s41, 1
    s_add_u32 s37, s41, s42
    v_lshl_add_u32 v7, v5, 3, s37
    s_mul_i32 s36, s35, 4194304
    s_add_u32 s36, s36, 18874368
    s_mov_b32 s10, 4194304
    s_mov_b32 s11, 0x00020000
    s_mov_b32 s25, 0xffff0000
    s_mov_b32 s47, s36
    s_cmp_ge_u32 s20, 8
    s_cbranch_scc0 L_conv2_kernel_mw
L_conv2_kernel_helper:
    s_setprio 3
    v_lshlrev_b32 v8, 4, v6
    s_add_u32 s37, s33, 4294967289
    v_lshl_add_u32 v9, v7, 3, s37
    v_cmp_gt_u32 vcc, 8000, v9
    s_mul_i32 s37, s33, 131072
    s_add_u32 s37, s37, 0
    v_lshl_add_u32 v92, v7, 7, s37
    v_add_u32 v92, v92, v8
    v_mov_b32 v9, 2130706432
    v_cndmask_b32 v92, v9, v92, vcc
    s_add_u32 s37, s33, 4294967291
    v_lshl_add_u32 v9, v7, 3, s37
    v_cmp_gt_u32 vcc, 8000, v9
    s_mul_i32 s37, s33, 131072
    s_add_u32 s37, s37, 262144
    v_lshl_add_u32 v93, v7, 7, s37
    v_add_u32 v93, v93, v8
    v_mov_b32 v9, 2130706432
    v_cndmask_b32 v93, v9, v93, vcc
    s_add_u32 s37, s33, 4294967293
    v_lshl_add_u32 v9, v7, 3, s37
    v_cmp_gt_u32 vcc, 8000, v9
    s_mul_i32 s37, s33, 131072
    s_add_u32 s37, s37, 64
    v_lshl_add_u32 v94, v7, 7, s37
    v_add_u32 v94, v94, v8
    v_mov_b32 v9, 2130706432
    v_cndmask_b32 v94, v9, v94, vcc
    s_add_u32 s37, s33, 4294967295
    v_lshl_add_u32 v9, v7, 3, s37
    v_cmp_gt_u32 vcc, 8000, v9
    s_mul_i32 s37, s33, 131072
    s_add_u32 s37, s37, 262208
    v_lshl_add_u32 v95, v7, 7, s37
    v_add_u32 v95, v95, v8
    v_mov_b32 v9, 2130706432
    v_cndmask_b32 v95, v9, v95, vcc
    v_and_b32 v76, 4, v5
    v_lshrrev_b32 v76, 1, v76
    v_xor_b32 v76, v6, v76
    v_lshlrev_b32 v76, 4, v76
    v_lshl_add_u32 v76, v5, 6, v76
    s_mov_b32 s24, 0
    s_mov_b32 s27, 524288
    s_waitcnt lgkmcnt(0)
    s_add_u32 s8, s4, s47
    s_addc_u32 s9, s5, 0
    buffer_load_dwordx4 v[0:3], v92, s[8:11], s24 offen
    buffer_load_dwordx4 v[8:11], v94, s[8:11], s24 offen
    buffer_load_dwordx4 v[4:7], v93, s[8:11], s24 offen
    buffer_load_dwordx4 v[12:15], v95, s[8:11], s24 offen
    buffer_load_dwordx4 v[16:19], v92, s[8:11], s27 offen
    buffer_load_dwordx4 v[24:27], v94, s[8:11], s27 offen
    buffer_load_dwordx4 v[20:23], v93, s[8:11], s27 offen
    buffer_load_dwordx4 v[28:31], v95, s[8:11], s27 offen
    s_mul_i32 s36, s42, 1024
    v_add_u32 v96, s36, v76
    v_add_u32 v97, 65536, v96
    s_mul_i32 s36, s42, 1088
    s_add_u32 s36, s36, 98304
    v_add_u32 v98, s36, v76
    s_mov_b32 s28, 0
    s_mov_b32 s24, 1048576
    s_cmp_ge_u32 s20, 12
    s_cselect_b32 s44, 252, 0
    s_cselect_b32 s45, 129, -1
    s_setprio 0
    s_cbranch_scc1 L_conv2_kernel_hloop
    s_setprio 1
L_conv2_kernel_hloop:
    s_waitcnt vmcnt(4)
    v_lshlrev_b32 v76, 16, v0
    v_and_b32 v84, s25, v0
    v_lshlrev_b32 v77, 16, v4
    v_and_b32 v85, s25, v4
    v_lshlrev_b32 v78, 16, v8
    v_and_b32 v86, s25, v8
    v_lshlrev_b32 v79, 16, v12
    v_and_b32 v87, s25, v12
    v_add_f32 v80, v76, v78
    v_add_f32 v88, v84, v86
    v_add_f32 v81, v77, v79
    v_add_f32 v89, v85, v87
    v_fma_f32 v82, v78, 4.0, v76
    v_fma_f32 v90, v86, 4.0, v84
    v_fma_f32 v83, v79, 4.0, v77
    v_fma_f32 v91, v87, 4.0, v85
    v_add_f32 v77, v80, v81
    v_add_f32 v85, v88, v89
    v_sub_f32 v78, v80, v81
    v_sub_f32 v86, v88, v89
    v_fma_f32 v79, v83, 2.0, v82
    v_fma_f32 v87, v91, 2.0, v90
    v_fma_f32 v82, v83, -2.0, v82
    v_fma_f32 v90, v91, -2.0, v90
    v_fmamk_f32 v80, v76, 0x41700000, v82
    v_fmamk_f32 v88, v84, 0x41700000, v90
    v_fmamk_f32 v80, v81, 0x41200000, v80
    v_fmamk_f32 v88, v89, 0x41200000, v88
    v_cvt_pk_bf16_f32 v4, v77, v85
    v_cvt_pk_bf16_f32 v8, v78, v86
    v_cvt_pk_bf16_f32 v64, v79, v87
    v_cvt_pk_bf16_f32 v68, v82, v90
    v_cvt_pk_bf16_f32 v72, v80, v88
    v_lshlrev_b32 v76, 16, v1
    v_and_b32 v84, s25, v1
    v_lshlrev_b32 v77, 16, v5
    v_and_b32 v85, s25, v5
    v_lshlrev_b32 v78, 16, v9
    v_and_b32 v86, s25, v9
    v_lshlrev_b32 v79, 16, v13
    v_and_b32 v87, s25, v13
    v_add_f32 v80, v76, v78
    v_add_f32 v88, v84, v86
    v_add_f32 v81, v77, v79
    v_add_f32 v89, v85, v87
    v_fma_f32 v82, v78, 4.0, v76
    v_fma_f32 v90, v86, 4.0, v84
    v_fma_f32 v83, v79, 4.0, v77
    v_fma_f32 v91, v87, 4.0, v85
    v_add_f32 v77, v80, v81
    v_add_f32 v85, v88, v89
    v_sub_f32 v78, v80, v81
    v_sub_f32 v86, v88, v89
    v_fma_f32 v79, v83, 2.0, v82
    v_fma_f32 v87, v91, 2.0, v90
    v_fma_f32 v82, v83, -2.0, v82
    v_fma_f32 v90, v91, -2.0, v90
    v_fmamk_f32 v80, v76, 0x41700000, v82
    v_fmamk_f32 v88, v84, 0x41700000, v90
    v_fmamk_f32 v80, v81, 0x41200000, v80
    v_fmamk_f32 v88, v89, 0x41200000, v88
    v_cvt_pk_bf16_f32 v5, v77, v85
    v_cvt_pk_bf16_f32 v9, v78, v86
    v_cvt_pk_bf16_f32 v65, v79, v87
    v_cvt_pk_bf16_f32 v69, v82, v90
    v_cvt_pk_bf16_f32 v73, v80, v88
    v_lshlrev_b32 v76, 16, v2
    v_and_b32 v84, s25, v2
    v_lshlrev_b32 v77, 16, v6
    v_and_b32 v85, s25, v6
    v_lshlrev_b32 v78, 16, v10
    v_and_b32 v86, s25, v10
    v_lshlrev_b32 v79, 16, v14
    v_and_b32 v87, s25, v14
    v_add_f32 v80, v76, v78
    v_add_f32 v88, v84, v86
    v_add_f32 v81, v77, v79
    v_add_f32 v89, v85, v87
    v_fma_f32 v82, v78, 4.0, v76
    v_fma_f32 v90, v86, 4.0, v84
    v_fma_f32 v83, v79, 4.0, v77
    v_fma_f32 v91, v87, 4.0, v85
    v_add_f32 v77, v80, v81
    v_add_f32 v85, v88, v89
    v_sub_f32 v78, v80, v81
    v_sub_f32 v86, v88, v89
    v_fma_f32 v79, v83, 2.0, v82
    v_fma_f32 v87, v91, 2.0, v90
    v_fma_f32 v82, v83, -2.0, v82
    v_fma_f32 v90, v91, -2.0, v90
    v_fmamk_f32 v80, v76, 0x41700000, v82
    v_fmamk_f32 v88, v84, 0x41700000, v90
    v_fmamk_f32 v80, v81, 0x41200000, v80
    v_fmamk_f32 v88, v89, 0x41200000, v88
    v_cvt_pk_bf16_f32 v6, v77, v85
    v_cvt_pk_bf16_f32 v10, v78, v86
    v_cvt_pk_bf16_f32 v66, v79, v87
    v_cvt_pk_bf16_f32 v70, v82, v90
    v_cvt_pk_bf16_f32 v74, v80, v88
    v_lshlrev_b32 v76, 16, v3
    v_and_b32 v84, s25, v3
    v_lshlrev_b32 v77, 16, v7
    v_and_b32 v85, s25, v7
    v_lshlrev_b32 v78, 16, v11
    v_and_b32 v86, s25, v11
    v_lshlrev_b32 v79, 16, v15
    v_and_b32 v87, s25, v15
    v_add_f32 v80, v76, v78
    v_add_f32 v88, v84, v86
    v_add_f32 v81, v77, v79
    v_add_f32 v89, v85, v87
    v_fma_f32 v82, v78, 4.0, v76
    v_fma_f32 v90, v86, 4.0, v84
    v_fma_f32 v83, v79, 4.0, v77
    v_fma_f32 v91, v87, 4.0, v85
    v_add_f32 v77, v80, v81
    v_add_f32 v85, v88, v89
    v_sub_f32 v78, v80, v81
    v_sub_f32 v86, v88, v89
    v_fma_f32 v79, v83, 2.0, v82
    v_fma_f32 v87, v91, 2.0, v90
    v_fma_f32 v82, v83, -2.0, v82
    v_fma_f32 v90, v91, -2.0, v90
    v_fmamk_f32 v80, v76, 0x41700000, v82
    v_fmamk_f32 v88, v84, 0x41700000, v90
    v_fmamk_f32 v80, v81, 0x41200000, v80
    v_fmamk_f32 v88, v89, 0x41200000, v88
    v_cvt_pk_bf16_f32 v7, v77, v85
    v_cvt_pk_bf16_f32 v11, v78, v86
    v_cvt_pk_bf16_f32 v67, v79, v87
    v_cvt_pk_bf16_f32 v71, v82, v90
    v_cvt_pk_bf16_f32 v75, v80, v88
    s_bitcmp1_b32 s44, s28
    s_cbranch_scc0 L_conv2_kernel_sa0
    s_waitcnt lgkmcnt(0)
    s_barrier
L_conv2_kernel_sa0:
    ds_write_b128 v96, v[64:67] offset:49152
    ds_write_b128 v97, v[68:71] offset:0
    ds_write_b128 v97, v[72:75] offset:16384
    ds_write_b128 v96, v[0:3] offset:0
    ds_write_b128 v96, v[4:7] offset:16384
    ds_write_b128 v96, v[8:11] offset:32768
    ds_write_b128 v98, v[12:15] offset:0
    buffer_load_dwordx4 v[0:3], v92, s[8:11], s24 offen
    buffer_load_dwordx4 v[8:11], v94, s[8:11], s24 offen
    buffer_load_dwordx4 v[4:7], v93, s[8:11], s24 offen
    buffer_load_dwordx4 v[12:15], v95, s[8:11], s24 offen
    s_add_u32 s24, s24, 524288
    s_bitcmp1_b32 s45, s28
    s_cbranch_scc0 L_conv2_kernel_sb0
    s_waitcnt lgkmcnt(0)
    s_barrier
L_conv2_kernel_sb0:
    s_add_u32 s28, s28, 1
    s_waitcnt vmcnt(4)
    v_lshlrev_b32 v76, 16, v16
    v_and_b32 v84, s25, v16
    v_lshlrev_b32 v77, 16, v20
    v_and_b32 v85, s25, v20
    v_lshlrev_b32 v78, 16, v24
    v_and_b32 v86, s25, v24
    v_lshlrev_b32 v79, 16, v28
    v_and_b32 v87, s25, v28
    v_add_f32 v80, v76, v78
    v_add_f32 v88, v84, v86
    v_add_f32 v81, v77, v79
    v_add_f32 v89, v85, v87
    v_fma_f32 v82, v78, 4.0, v76
    v_fma_f32 v90, v86, 4.0, v84
    v_fma_f32 v83, v79, 4.0, v77
    v_fma_f32 v91, v87, 4.0, v85
    v_add_f32 v77, v80, v81
    v_add_f32 v85, v88, v89
    v_sub_f32 v78, v80, v81
    v_sub_f32 v86, v88, v89
    v_fma_f32 v79, v83, 2.0, v82
    v_fma_f32 v87, v91, 2.0, v90
    v_fma_f32 v82, v83, -2.0, v82
    v_fma_f32 v90, v91, -2.0, v90
    v_fmamk_f32 v80, v76, 0x41700000, v82
    v_fmamk_f32 v88, v84, 0x41700000, v90
    v_fmamk_f32 v80, v81, 0x41200000, v80
    v_fmamk_f32 v88, v89, 0x41200000, v88
    v_cvt_pk_bf16_f32 v20, v77, v85
    v_cvt_pk_bf16_f32 v24, v78, v86
    v_cvt_pk_bf16_f32 v64, v79, v87
    v_cvt_pk_bf16_f32 v68, v82, v90
    v_cvt_pk_bf16_f32 v72, v80, v88
    v_lshlrev_b32 v76, 16, v17
    v_and_b32 v84, s25, v17
    v_lshlrev_b32 v77, 16, v21
    v_and_b32 v85, s25, v21
    v_lshlrev_b32 v78, 16, v25
    v_and_b32 v86, s25, v25
    v_lshlrev_b32 v79, 16, v29
    v_and_b32 v87, s25, v29
    v_add_f32 v80, v76, v78
    v_add_f32 v88, v84, v86
    v_add_f32 v81, v77, v79
    v_add_f32 v89, v85, v87
    v_fma_f32 v82, v78, 4.0, v76
    v_fma_f32 v90, v86, 4.0, v84
    v_fma_f32 v83, v79, 4.0, v77
    v_fma_f32 v91, v87, 4.0, v85
    v_add_f32 v77, v80, v81
    v_add_f32 v85, v88, v89
    v_sub_f32 v78, v80, v81
    v_sub_f32 v86, v88, v89
    v_fma_f32 v79, v83, 2.0, v82
    v_fma_f32 v87, v91, 2.0, v90
    v_fma_f32 v82, v83, -2.0, v82
    v_fma_f32 v90, v91, -2.0, v90
    v_fmamk_f32 v80, v76, 0x41700000, v82
    v_fmamk_f32 v88, v84, 0x41700000, v90
    v_fmamk_f32 v80, v81, 0x41200000, v80
    v_fmamk_f32 v88, v89, 0x41200000, v88
    v_cvt_pk_bf16_f32 v21, v77, v85
    v_cvt_pk_bf16_f32 v25, v78, v86
    v_cvt_pk_bf16_f32 v65, v79, v87
    v_cvt_pk_bf16_f32 v69, v82, v90
    v_cvt_pk_bf16_f32 v73, v80, v88
    v_lshlrev_b32 v76, 16, v18
    v_and_b32 v84, s25, v18
    v_lshlrev_b32 v77, 16, v22
    v_and_b32 v85, s25, v22
    v_lshlrev_b32 v78, 16, v26
    v_and_b32 v86, s25, v26
    v_lshlrev_b32 v79, 16, v30
    v_and_b32 v87, s25, v30
    v_add_f32 v80, v76, v78
    v_add_f32 v88, v84, v86
    v_add_f32 v81, v77, v79
    v_add_f32 v89, v85, v87
    v_fma_f32 v82, v78, 4.0, v76
    v_fma_f32 v90, v86, 4.0, v84
    v_fma_f32 v83, v79, 4.0, v77
    v_fma_f32 v91, v87, 4.0, v85
    v_add_f32 v77, v80, v81
    v_add_f32 v85, v88, v89
    v_sub_f32 v78, v80, v81
    v_sub_f32 v86, v88, v89
    v_fma_f32 v79, v83, 2.0, v82
    v_fma_f32 v87, v91, 2.0, v90
    v_fma_f32 v82, v83, -2.0, v82
    v_fma_f32 v90, v91, -2.0, v90
    v_fmamk_f32 v80, v76, 0x41700000, v82
    v_fmamk_f32 v88, v84, 0x41700000, v90
    v_fmamk_f32 v80, v81, 0x41200000, v80
    v_fmamk_f32 v88, v89, 0x41200000, v88
    v_cvt_pk_bf16_f32 v22, v77, v85
    v_cvt_pk_bf16_f32 v26, v78, v86
    v_cvt_pk_bf16_f32 v66, v79, v87
    v_cvt_pk_bf16_f32 v70, v82, v90
    v_cvt_pk_bf16_f32 v74, v80, v88
    v_lshlrev_b32 v76, 16, v19
    v_and_b32 v84, s25, v19
    v_lshlrev_b32 v77, 16, v23
    v_and_b32 v85, s25, v23
    v_lshlrev_b32 v78, 16, v27
    v_and_b32 v86, s25, v27
    v_lshlrev_b32 v79, 16, v31
    v_and_b32 v87, s25, v31
    v_add_f32 v80, v76, v78
    v_add_f32 v88, v84, v86
    v_add_f32 v81, v77, v79
    v_add_f32 v89, v85, v87
    v_fma_f32 v82, v78, 4.0, v76
    v_fma_f32 v90, v86, 4.0, v84
    v_fma_f32 v83, v79, 4.0, v77
    v_fma_f32 v91, v87, 4.0, v85
    v_add_f32 v77, v80, v81
    v_add_f32 v85, v88, v89
    v_sub_f32 v78, v80, v81
    v_sub_f32 v86, v88, v89
    v_fma_f32 v79, v83, 2.0, v82
    v_fma_f32 v87, v91, 2.0, v90
    v_fma_f32 v82, v83, -2.0, v82
    v_fma_f32 v90, v91, -2.0, v90
    v_fmamk_f32 v80, v76, 0x41700000, v82
    v_fmamk_f32 v88, v84, 0x41700000, v90
    v_fmamk_f32 v80, v81, 0x41200000, v80
    v_fmamk_f32 v88, v89, 0x41200000, v88
    v_cvt_pk_bf16_f32 v23, v77, v85
    v_cvt_pk_bf16_f32 v27, v78, v86
    v_cvt_pk_bf16_f32 v67, v79, v87
    v_cvt_pk_bf16_f32 v71, v82, v90
    v_cvt_pk_bf16_f32 v75, v80, v88
    s_bitcmp1_b32 s44, s28
    s_cbranch_scc0 L_conv2_kernel_sa1
    s_waitcnt lgkmcnt(0)
    s_barrier
L_conv2_kernel_sa1:
    ds_write_b128 v96, v[64:67] offset:57344
    ds_write_b128 v97, v[68:71] offset:8192
    ds_write_b128 v97, v[72:75] offset:24576
    ds_write_b128 v96, v[16:19] offset:8192
    ds_write_b128 v96, v[20:23] offset:24576
    ds_write_b128 v96, v[24:27] offset:40960
    ds_write_b128 v98, v[28:31] offset:8704
    buffer_load_dwordx4 v[16:19], v92, s[8:11], s24 offen
    buffer_load_dwordx4 v[24:27], v94, s[8:11], s24 offen
    buffer_load_dwordx4 v[20:23], v93, s[8:11], s24 offen
    buffer_load_dwordx4 v[28:31], v95, s[8:11], s24 offen
    s_add_u32 s24, s24, 524288
    s_bitcmp1_b32 s45, s28
    s_cbranch_scc0 L_conv2_kernel_sb1
    s_waitcnt lgkmcnt(0)
    s_barrier
L_conv2_kernel_sb1:
    s_add_u32 s28, s28, 1
    s_cmp_lt_u32 s28, 8
    s_cbranch_scc1 L_conv2_kernel_hloop
    s_cmp_ge_u32 s20, 12
    s_cbranch_scc1 L_conv2_kernel_hend
    s_add_u32 s12, s30, 44040192
    s_addc_u32 s13, s31, 0
    s_mov_b32 s14, 294912
    s_mov_b32 s15, 0x00020000
    s_lshr_b32 s36, s2, 3
    s_lshl_b32 s36, s36, 2
    s_add_u32 s36, s36, s32
    s_mul_i32 s36, s36, 2304
    v_lshlrev_b32 v1, 4, v127
    buffer_load_dwordx4 v[4:7], v1, s[12:15], s36 offen offset:0
    buffer_load_dwordx4 v[4:7], v1, s[12:15], s36 offen offset:1024
    buffer_load_dwordx4 v[4:7], v1, s[12:15], s36 offen offset:2048
    s_cmp_ge_u32 s2, 32
    s_cbranch_scc1 L_conv2_kernel_ntw
    s_getpc_b64 s[36:37]
L_conv2_kernel_pc:
    s_lshl_b32 s38, s32, 13
    s_add_u32 s38, s38, L_conv2_kernel_epi-L_conv2_kernel_pc
    v_lshl_add_u32 v2, v127, 7, s38
    v_min_u32 v2, L_joint_kernel_done-L_conv2_kernel_pc, v2
    v_mov_b32 v3, s37
    v_add_co_u32 v2, vcc, s36, v2
    s_nop 1
    v_addc_co_u32 v3, vcc, 0, v3, vcc
    global_load_dword v4, v[2:3], off
L_conv2_kernel_ntw:
L_conv2_kernel_hend:
    s_endpgm
L_conv2_kernel_mw:
    s_add_u32 s37, s41, 128
    v_mov_b32 v16, s37
    v_mul_u32_u24 v17, 524288, v5
    v_lshl_add_u32 v17, v6, 4, v17
    s_add_u32 s37, s33, 4294967289
    v_lshl_add_u32 v18, v16, 3, s37
    v_cmp_gt_u32 vcc, 8000, v18
    s_mul_i32 s37, s33, 131072
    s_add_u32 s37, s37, 0
    v_lshl_add_u32 v108, v16, 7, s37
    v_add_u32 v108, v108, v17
    v_mov_b32 v18, 2130706432
    v_cndmask_b32 v108, v18, v108, vcc
    s_add_u32 s37, s33, 4294967291
    v_lshl_add_u32 v18, v16, 3, s37
    v_cmp_gt_u32 vcc, 8000, v18
    s_mul_i32 s37, s33, 131072
    s_add_u32 s37, s37, 262144
    v_lshl_add_u32 v109, v16, 7, s37
    v_add_u32 v109, v109, v17
    v_mov_b32 v18, 2130706432
    v_cndmask_b32 v109, v18, v109, vcc
    s_add_u32 s37, s33, 4294967293
    v_lshl_add_u32 v18, v16, 3, s37
    v_cmp_gt_u32 vcc, 8000, v18
    s_mul_i32 s37, s33, 131072
    s_add_u32 s37, s37, 64
    v_lshl_add_u32 v110, v16, 7, s37
    v_add_u32 v110, v110, v17
    v_mov_b32 v18, 2130706432
    v_cndmask_b32 v110, v18, v110, vcc
    s_waitcnt lgkmcnt(0)
    s_add_u32 s8, s4, s47
    s_addc_u32 s9, s5, 0
    s_lshl_b32 s36, s29, 4
    s_lshl_b32 s37, s33, 3
    s_add_u32 s36, s36, s37
    s_mul_i32 s36, s36, 57344
    s_add_u32 s36, s36, 9437184
    s_add_u32 s12, s30, s36
    s_addc_u32 s13, s31, 0
    s_mov_b32 s14, 458752
    s_mov_b32 s15, 0x00020000
    s_mul_i32 s36, s35, 2097152
    s_add_u32 s36, s36, 27262976
    s_mul_i32 s37, s33, 8388608
    s_add_u32 s36, s36, s37
    s_add_u32 s16, s30, s36
    s_addc_u32 s17, s31, 0
    s_mov_b32 s18, 2097152
    s_mov_b32 s19, 0x00020000
    v_and_b32 v10, 15, v127
    v_lshrrev_b32 v11, 4, v127
    v_add_u32 v8, 0, v10
    v_and_b32 v16, 4, v8
    v_lshrrev_b32 v16, 1, v16
    v_xor_b32 v16, v11, v16
    v_lshlrev_b32 v16, 4, v16
    v_lshl_add_u32 v8, v8, 6, v16
    v_add_u32 v9, 1, v10
    v_and_b32 v16, 4, v9
    v_lshrrev_b32 v16, 1, v16
    v_xor_b32 v16, v11, v16
    v_lshlrev_b32 v16, 4, v16
    v_lshl_add_u32 v9, v9, 6, v16
    s_lshr_b32 s38, s32, 1
    s_and_b32 s39, s32, 1
    s_add_u32 s40, s38, 4
    s_lshl_b32 s43, s39, 10
    s_cmp_lt_u32 s20, 4
    s_cselect_b32 s40, s20, s40
    s_cselect_b32 s36, 0, s43
    s_lshl_b32 s37, s40, 13
    s_add_u32 s37, s37, s36
    v_lshl_add_u32 v125, v127, 4, s37
    s_mul_i32 s37, s40, 16384
    v_add_u32 v120, s37, v8
    v_add_u32 v121, s37, v9
    s_lshl_b32 s37, s40, 10
    s_add_u32 s37, s37, 115712
    v_lshl_add_u32 v16, v11, 4, s37
    v_cmp_eq_u32 vcc, 15, v10
    v_mov_b32 v17, 8192
    v_mov_b32 v18, 4294959104
    v_mov_b32 v19, 64
    v_cndmask_b32 v122, v121, v16, vcc
    v_cndmask_b32 v123, v17, v19, vcc
    v_cndmask_b32 v124, v18, v19, vcc
    v_lshl_add_u32 v126, v127, 4, s37
    s_mov_b32 s44, 0x3f800000
    s_mov_b32 s45, 0x00000000
    s_mov_b32 s46, 0x00000000
    s_cmp_eq_u32 s40, 1
    s_cselect_b32 s45, 0x3f800000, s45
    s_cselect_b32 s46, 0x3f800000, s46
    s_cmp_eq_u32 s40, 2
    s_cselect_b32 s45, 0xbf800000, s45
    s_cselect_b32 s46, 0x3f800000, s46
    s_cmp_eq_u32 s40, 3
    s_cselect_b32 s45, 0x40000000, s45
    s_cselect_b32 s46, 0x40800000, s46
    s_cmp_eq_u32 s40, 4
    s_cselect_b32 s45, 0xc0000000, s45
    s_cselect_b32 s46, 0x40800000, s46
    s_cmp_eq_u32 s40, 5
    s_cselect_b32 s44, 0x41800000, s44
    s_cselect_b32 s45, 0x41000000, s45
    s_cselect_b32 s46, 0x40800000, s46
    s_cmp_ge_u32 s20, 4
    s_cbranch_scc1 L_conv2_kernel_m2
    v_mov_b32 v0, 0
    v_mov_b32 v1, 0
    v_mov_b32 v2, 0
    v_mov_b32 v3, 0
    v_mov_b32 v4, 0
    v_mov_b32 v5, 0
    v_mov_b32 v6, 0
    v_mov_b32 v7, 0
    v_mov_b32 v8, 0
    v_mov_b32 v9, 0
    v_mov_b32 v10, 0
    v_mov_b32 v11, 0
    v_mov_b32 v12, 0
    v_mov_b32 v13, 0
    v_mov_b32 v14, 0
    v_mov_b32 v15, 0
    v_mov_b32 v16, 0
    v_mov_b32 v17, 0
    v_mov_b32 v18, 0
    v_mov_b32 v19, 0
    v_mov_b32 v20, 0
    v_mov_b32 v21, 0
    v_mov_b32 v22, 0
    v_mov_b32 v23, 0
    v_mov_b32 v24, 0
    v_mov_b32 v25, 0
    v_mov_b32 v26, 0
    v_mov_b32 v27, 0
    v_mov_b32 v28, 0
    v_mov_b32 v29, 0
    v_mov_b32 v30, 0
    v_mov_b32 v31, 0
    v_mov_b32 v32, 0
    v_mov_b32 v33, 0
    v_mov_b32 v34, 0
    v_mov_b32 v35, 0
    v_mov_b32 v36, 0
    v_mov_b32 v37, 0
    v_mov_b32 v38, 0
    v_mov_b32 v39, 0
    v_mov_b32 v40, 0
    v_mov_b32 v41, 0
    v_mov_b32 v42, 0
    v_mov_b32 v43, 0
    v_mov_b32 v44, 0
    v_mov_b32 v45, 0
    v_mov_b32 v46, 0
    v_mov_b32 v47, 0
    v_mov_b32 v48, 0
    v_mov_b32 v49, 0
    v_mov_b32 v50, 0
    v_mov_b32 v51, 0
    v_mov_b32 v52, 0
    v_mov_b32 v53, 0
    v_mov_b32 v54, 0
    v_mov_b32 v55, 0
    v_mov_b32 v56, 0
    v_mov_b32 v57, 0
    v_mov_b32 v58, 0
    v_mov_b32 v59, 0
    v_mov_b32 v60, 0
    v_mov_b32 v61, 0
    v_mov_b32 v62, 0
    v_mov_b32 v63, 0
    buffer_load_dwordx4 v[96:99], v108, s[8:11], 0 offen
    buffer_load_dwordx4 v[100:103], v109, s[8:11], 0 offen
    buffer_load_dwordx4 v[104:107], v110, s[8:11], 0 offen
    s_mov_b32 s23, 0
    s_mov_b32 s26, 4096
    buffer_load_dwordx4 v[64:67], v125, s[12:15], s23 offen offset:0
    buffer_load_dwordx4 v[68:71], v125, s[12:15], s23 offen offset:1024
    buffer_load_dwordx4 v[72:75], v125, s[12:15], s23 offen offset:2048
    buffer_load_dwordx4 v[76:79], v125, s[12:15], s23 offen offset:3072
    buffer_load_dwordx4 v[80:83], v125, s[12:15], s26 offen offset:0
    buffer_load_dwordx4 v[84:87], v125, s[12:15], s26 offen offset:1024
    buffer_load_dwordx4 v[88:91], v125, s[12:15], s26 offen offset:2048
    buffer_load_dwordx4 v[92:95], v125, s[12:15], s26 offen offset:3072
    s_mov_b32 s23, 57344
    s_mov_b32 s26, 61440
    s_waitcnt vmcnt(8)
    v_lshlrev_b32 v108, 16, v96
    v_and_b32 v111, s25, v96
    v_lshlrev_b32 v109, 16, v100
    v_and_b32 v112, s25, v100
    v_lshlrev_b32 v110, 16, v104
    v_and_b32 v113, s25, v104
    v_mul_f32 v114, s44, v108
    v_mul_f32 v115, s44, v111
    v_fmac_f32 v114, s45, v109
    v_fmac_f32 v115, s45, v112
    v_fmac_f32 v114, s46, v110
    v_fmac_f32 v115, s46, v113
    v_cvt_pk_bf16_f32 v96, v114, v115
    v_lshlrev_b32 v108, 16, v97
    v_and_b32 v111, s25, v97
    v_lshlrev_b32 v109, 16, v101
    v_and_b32 v112, s25, v101
    v_lshlrev_b32 v110, 16, v105
    v_and_b32 v113, s25, v105
    v_mul_f32 v114, s44, v108
    v_mul_f32 v115, s44, v111
    v_fmac_f32 v114, s45, v109
    v_fmac_f32 v115, s45, v112
    v_fmac_f32 v114, s46, v110
    v_fmac_f32 v115, s46, v113
    v_cvt_pk_bf16_f32 v97, v114, v115
    v_lshlrev_b32 v108, 16, v98
    v_and_b32 v111, s25, v98
    v_lshlrev_b32 v109, 16, v102
    v_and_b32 v112, s25, v102
    v_lshlrev_b32 v110, 16, v106
    v_and_b32 v113, s25, v106
    v_mul_f32 v114, s44, v108
    v_mul_f32 v115, s44, v111
    v_fmac_f32 v114, s45, v109
    v_fmac_f32 v115, s45, v112
    v_fmac_f32 v114, s46, v110
    v_fmac_f32 v115, s46, v113
    v_cvt_pk_bf16_f32 v98, v114, v115
    v_lshlrev_b32 v108, 16, v99
    v_and_b32 v111, s25, v99
    v_lshlrev_b32 v109, 16, v103
    v_and_b32 v112, s25, v103
    v_lshlrev_b32 v110, 16, v107
    v_and_b32 v113, s25, v107
    v_mul_f32 v114, s44, v108
    v_mul_f32 v115, s44, v111
    v_fmac_f32 v114, s45, v109
    v_fmac_f32 v115, s45, v112
    v_fmac_f32 v114, s46, v110
    v_fmac_f32 v115, s46, v113
    v_cvt_pk_bf16_f32 v99, v114, v115
    ds_write_b128 v126, v[96:99]
    s_waitcnt lgkmcnt(0)
    s_barrier
    s_mov_b32 s22, 4
    s_setprio 2
L_conv2_kernel_mloop1:
    ds_read_b128 v[96:99], v120 offset:0
    ds_read_b128 v[100:103], v120 offset:1024
    ds_read_b128 v[104:107], v120 offset:2048
    ds_read_b128 v[108:111], v120 offset:3072
    ds_read_b128 v[112:115], v120 offset:4096
    ds_read_b128 v[116:119], v120 offset:5120
    s_waitcnt vmcnt(6) lgkmcnt(5)
    v_mfma_f32_16x16x32_bf16 v[0:3], v[64:67], v[96:99], v[0:3]
    v_mfma_f32_16x16x32_bf16 v[32:35], v[68:71], v[96:99], v[32:35]
    ds_read_b128 v[96:99], v120 offset:6144
    s_waitcnt vmcnt(4) lgkmcnt(5)
    v_mfma_f32_16x16x32_bf16 v[4:7], v[64:67], v[100:103], v[4:7]
    v_mfma_f32_16x16x32_bf16 v[36:39], v[68:71], v[100:103], v[36:39]
    v_mfma_f32_16x16x32_bf16 v[0:3], v[72:75], v[100:103], v[0:3]
    v_mfma_f32_16x16x32_bf16 v[32:35], v[76:79], v[100:103], v[32:35]
    ds_read_b128 v[100:103], v120 offset:7168
    s_waitcnt vmcnt(2) lgkmcnt(5)
    v_mfma_f32_16x16x32_bf16 v[8:11], v[64:67], v[104:107], v[8:11]
    v_mfma_f32_16x16x32_bf16 v[40:43], v[68:71], v[104:107], v[40:43]
    v_mfma_f32_16x16x32_bf16 v[4:7], v[72:75], v[104:107], v[4:7]
    v_mfma_f32_16x16x32_bf16 v[36:39], v[76:79], v[104:107], v[36:39]
    v_mfma_f32_16x16x32_bf16 v[0:3], v[80:83], v[104:107], v[0:3]
    v_mfma_f32_16x16x32_bf16 v[32:35], v[84:87], v[104:107], v[32:35]
    ds_read_b128 v[104:107], v122 offset:0
    v_add_u32 v122, v123, v122
    s_waitcnt vmcnt(0) lgkmcnt(5)
    v_mfma_f32_16x16x32_bf16 v[12:15], v[64:67], v[108:111], v[12:15]
    v_mfma_f32_16x16x32_bf16 v[44:47], v[68:71], v[108:111], v[44:47]
    v_mfma_f32_16x16x32_bf16 v[8:11], v[72:75], v[108:111], v[8:11]
    v_mfma_f32_16x16x32_bf16 v[40:43], v[76:79], v[108:111], v[40:43]
    v_mfma_f32_16x16x32_bf16 v[4:7], v[80:83], v[108:111], v[4:7]
    v_mfma_f32_16x16x32_bf16 v[36:39], v[84:87], v[108:111], v[36:39]
    v_mfma_f32_16x16x32_bf16 v[0:3], v[88:91], v[108:111], v[0:3]
    v_mfma_f32_16x16x32_bf16 v[32:35], v[92:95], v[108:111], v[32:35]
    ds_read_b128 v[108:111], v121 offset:1024
    s_waitcnt lgkmcnt(5)
    v_mfma_f32_16x16x32_bf16 v[16:19], v[64:67], v[112:115], v[16:19]
    v_mfma_f32_16x16x32_bf16 v[48:51], v[68:71], v[112:115], v[48:51]
    v_mfma_f32_16x16x32_bf16 v[12:15], v[72:75], v[112:115], v[12:15]
    v_mfma_f32_16x16x32_bf16 v[44:47], v[76:79], v[112:115], v[44:47]
    v_mfma_f32_16x16x32_bf16 v[8:11], v[80:83], v[112:115], v[8:11]
    v_mfma_f32_16x16x32_bf16 v[40:43], v[84:87], v[112:115], v[40:43]
    v_mfma_f32_16x16x32_bf16 v[4:7], v[88:91], v[112:115], v[4:7]
    v_mfma_f32_16x16x32_bf16 v[36:39], v[92:95], v[112:115], v[36:39]
    ds_read_b128 v[112:115], v121 offset:2048
    s_waitcnt lgkmcnt(5)
    v_mfma_f32_16x16x32_bf16 v[20:23], v[64:67], v[116:119], v[20:23]
    v_mfma_f32_16x16x32_bf16 v[52:55], v[68:71], v[116:119], v[52:55]
    v_mfma_f32_16x16x32_bf16 v[16:19], v[72:75], v[116:119], v[16:19]
    v_mfma_f32_16x16x32_bf16 v[48:51], v[76:79], v[116:119], v[48:51]
    v_mfma_f32_16x16x32_bf16 v[12:15], v[80:83], v[116:119], v[12:15]
    v_mfma_f32_16x16x32_bf16 v[44:47], v[84:87], v[116:119], v[44:47]
    v_mfma_f32_16x16x32_bf16 v[8:11], v[88:91], v[116:119], v[8:11]
    v_mfma_f32_16x16x32_bf16 v[40:43], v[92:95], v[116:119], v[40:43]
    s_waitcnt lgkmcnt(4)
    v_mfma_f32_16x16x32_bf16 v[24:27], v[64:67], v[96:99], v[24:27]
    v_mfma_f32_16x16x32_bf16 v[56:59], v[68:71], v[96:99], v[56:59]
    v_mfma_f32_16x16x32_bf16 v[20:23], v[72:75], v[96:99], v[20:23]
    v_mfma_f32_16x16x32_bf16 v[52:55], v[76:79], v[96:99], v[52:55]
    v_mfma_f32_16x16x32_bf16 v[16:19], v[80:83], v[96:99], v[16:19]
    v_mfma_f32_16x16x32_bf16 v[48:51], v[84:87], v[96:99], v[48:51]
    v_mfma_f32_16x16x32_bf16 v[12:15], v[88:91], v[96:99], v[12:15]
    v_mfma_f32_16x16x32_bf16 v[44:47], v[92:95], v[96:99], v[44:47]
    s_waitcnt lgkmcnt(3)
    v_mfma_f32_16x16x32_bf16 v[28:31], v[64:67], v[100:103], v[28:31]
    v_mfma_f32_16x16x32_bf16 v[60:63], v[68:71], v[100:103], v[60:63]
    v_mfma_f32_16x16x32_bf16 v[24:27], v[72:75], v[100:103], v[24:27]
    v_mfma_f32_16x16x32_bf16 v[56:59], v[76:79], v[100:103], v[56:59]
    v_mfma_f32_16x16x32_bf16 v[20:23], v[80:83], v[100:103], v[20:23]
    v_mfma_f32_16x16x32_bf16 v[52:55], v[84:87], v[100:103], v[52:55]
    v_mfma_f32_16x16x32_bf16 v[16:19], v[88:91], v[100:103], v[16:19]
    v_mfma_f32_16x16x32_bf16 v[48:51], v[92:95], v[100:103], v[48:51]
    buffer_load_dwordx4 v[64:67], v125, s[12:15], s23 offen offset:0
    buffer_load_dwordx4 v[68:71], v125, s[12:15], s23 offen offset:1024
    s_waitcnt lgkmcnt(2)
    v_mfma_f32_16x16x32_bf16 v[28:31], v[72:75], v[104:107], v[28:31]
    v_mfma_f32_16x16x32_bf16 v[60:63], v[76:79], v[104:107], v[60:63]
    v_mfma_f32_16x16x32_bf16 v[24:27], v[80:83], v[104:107], v[24:27]
    v_mfma_f32_16x16x32_bf16 v[56:59], v[84:87], v[104:107], v[56:59]
    v_mfma_f32_16x16x32_bf16 v[20:23], v[88:91], v[104:107], v[20:23]
    v_mfma_f32_16x16x32_bf16 v[52:55], v[92:95], v[104:107], v[52:55]
    buffer_load_dwordx4 v[72:75], v125, s[12:15], s23 offen offset:2048
    buffer_load_dwordx4 v[76:79], v125, s[12:15], s23 offen offset:3072
    s_waitcnt lgkmcnt(1)
    v_mfma_f32_16x16x32_bf16 v[28:31], v[80:83], v[108:111], v[28:31]
    v_mfma_f32_16x16x32_bf16 v[60:63], v[84:87], v[108:111], v[60:63]
    v_mfma_f32_16x16x32_bf16 v[24:27], v[88:91], v[108:111], v[24:27]
    v_mfma_f32_16x16x32_bf16 v[56:59], v[92:95], v[108:111], v[56:59]
    buffer_load_dwordx4 v[80:83], v125, s[12:15], s26 offen offset:0
    buffer_load_dwordx4 v[84:87], v125, s[12:15], s26 offen offset:1024
    s_waitcnt lgkmcnt(0)
    v_mfma_f32_16x16x32_bf16 v[28:31], v[88:91], v[112:115], v[28:31]
    v_mfma_f32_16x16x32_bf16 v[60:63], v[92:95], v[112:115], v[60:63]
    buffer_load_dwordx4 v[88:91], v125, s[12:15], s26 offen offset:2048
    buffer_load_dwordx4 v[92:95], v125, s[12:15], s26 offen offset:3072
    s_add_u32 s23, s23, 57344
    s_add_u32 s26, s26, 57344
    s_barrier
    s_sub_u32 s22, s22, 1
    s_cmp_eq_u32 s22, 0
    s_cbranch_scc1 L_conv2_kernel_mlast1
    ds_read_b128 v[96:99], v120 offset:8192
    ds_read_b128 v[100:103], v120 offset:9216
    ds_read_b128 v[104:107], v120 offset:10240
    ds_read_b128 v[108:111], v120 offset:11264
    ds_read_b128 v[112:115], v120 offset:12288
    ds_read_b128 v[116:119], v120 offset:13312
    s_waitcnt vmcnt(6) lgkmcnt(5)
    v_mfma_f32_16x16x32_bf16 v[0:3], v[64:67], v[96:99], v[0:3]
    v_mfma_f32_16x16x32_bf16 v[32:35], v[68:71], v[96:99], v[32:35]
    ds_read_b128 v[96:99], v120 offset:14336
    s_waitcnt vmcnt(4) lgkmcnt(5)
    v_mfma_f32_16x16x32_bf16 v[4:7], v[64:67], v[100:103], v[4:7]
    v_mfma_f32_16x16x32_bf16 v[36:39], v[68:71], v[100:103], v[36:39]
    v_mfma_f32_16x16x32_bf16 v[0:3], v[72:75], v[100:103], v[0:3]
    v_mfma_f32_16x16x32_bf16 v[32:35], v[76:79], v[100:103], v[32:35]
    ds_read_b128 v[100:103], v120 offset:15360
    s_waitcnt vmcnt(2) lgkmcnt(5)
    v_mfma_f32_16x16x32_bf16 v[8:11], v[64:67], v[104:107], v[8:11]
    v_mfma_f32_16x16x32_bf16 v[40:43], v[68:71], v[104:107], v[40:43]
    v_mfma_f32_16x16x32_bf16 v[4:7], v[72:75], v[104:107], v[4:7]
    v_mfma_f32_16x16x32_bf16 v[36:39], v[76:79], v[104:107], v[36:39]
    v_mfma_f32_16x16x32_bf16 v[0:3], v[80:83], v[104:107], v[0:3]
    v_mfma_f32_16x16x32_bf16 v[32:35], v[84:87], v[104:107], v[32:35]
    ds_read_b128 v[104:107], v122 offset:0
    v_add_u32 v122, v124, v122
    s_waitcnt vmcnt(0) lgkmcnt(5)
    v_mfma_f32_16x16x32_bf16 v[12:15], v[64:67], v[108:111], v[12:15]
    v_mfma_f32_16x16x32_bf16 v[44:47], v[68:71], v[108:111], v[44:47]
    v_mfma_f32_16x16x32_bf16 v[8:11], v[72:75], v[108:111], v[8:11]
    v_mfma_f32_16x16x32_bf16 v[40:43], v[76:79], v[108:111], v[40:43]
    v_mfma_f32_16x16x32_bf16 v[4:7], v[80:83], v[108:111], v[4:7]
    v_mfma_f32_16x16x32_bf16 v[36:39], v[84:87], v[108:111], v[36:39]
    v_mfma_f32_16x16x32_bf16 v[0:3], v[88:91], v[108:111], v[0:3]
    v_mfma_f32_16x16x32_bf16 v[32:35], v[92:95], v[108:111], v[32:35]
    ds_read_b128 v[108:111], v121 offset:9216
    s_waitcnt lgkmcnt(5)
    v_mfma_f32_16x16x32_bf16 v[16:19], v[64:67], v[112:115], v[16:19]
    v_mfma_f32_16x16x32_bf16 v[48:51], v[68:71], v[112:115], v[48:51]
    v_mfma_f32_16x16x32_bf16 v[12:15], v[72:75], v[112:115], v[12:15]
    v_mfma_f32_16x16x32_bf16 v[44:47], v[76:79], v[112:115], v[44:47]
    v_mfma_f32_16x16x32_bf16 v[8:11], v[80:83], v[112:115], v[8:11]
    v_mfma_f32_16x16x32_bf16 v[40:43], v[84:87], v[112:115], v[40:43]
    v_mfma_f32_16x16x32_bf16 v[4:7], v[88:91], v[112:115], v[4:7]
    v_mfma_f32_16x16x32_bf16 v[36:39], v[92:95], v[112:115], v[36:39]
    ds_read_b128 v[112:115], v121 offset:10240
    s_waitcnt lgkmcnt(5)
    v_mfma_f32_16x16x32_bf16 v[20:23], v[64:67], v[116:119], v[20:23]
    v_mfma_f32_16x16x32_bf16 v[52:55], v[68:71], v[116:119], v[52:55]
    v_mfma_f32_16x16x32_bf16 v[16:19], v[72:75], v[116:119], v[16:19]
    v_mfma_f32_16x16x32_bf16 v[48:51], v[76:79], v[116:119], v[48:51]
    v_mfma_f32_16x16x32_bf16 v[12:15], v[80:83], v[116:119], v[12:15]
    v_mfma_f32_16x16x32_bf16 v[44:47], v[84:87], v[116:119], v[44:47]
    v_mfma_f32_16x16x32_bf16 v[8:11], v[88:91], v[116:119], v[8:11]
    v_mfma_f32_16x16x32_bf16 v[40:43], v[92:95], v[116:119], v[40:43]
    s_waitcnt lgkmcnt(4)
    v_mfma_f32_16x16x32_bf16 v[24:27], v[64:67], v[96:99], v[24:27]
    v_mfma_f32_16x16x32_bf16 v[56:59], v[68:71], v[96:99], v[56:59]
    v_mfma_f32_16x16x32_bf16 v[20:23], v[72:75], v[96:99], v[20:23]
    v_mfma_f32_16x16x32_bf16 v[52:55], v[76:79], v[96:99], v[52:55]
    v_mfma_f32_16x16x32_bf16 v[16:19], v[80:83], v[96:99], v[16:19]
    v_mfma_f32_16x16x32_bf16 v[48:51], v[84:87], v[96:99], v[48:51]
    v_mfma_f32_16x16x32_bf16 v[12:15], v[88:91], v[96:99], v[12:15]
    v_mfma_f32_16x16x32_bf16 v[44:47], v[92:95], v[96:99], v[44:47]
    s_waitcnt lgkmcnt(3)
    v_mfma_f32_16x16x32_bf16 v[28:31], v[64:67], v[100:103], v[28:31]
    v_mfma_f32_16x16x32_bf16 v[60:63], v[68:71], v[100:103], v[60:63]
    v_mfma_f32_16x16x32_bf16 v[24:27], v[72:75], v[100:103], v[24:27]
    v_mfma_f32_16x16x32_bf16 v[56:59], v[76:79], v[100:103], v[56:59]
    v_mfma_f32_16x16x32_bf16 v[20:23], v[80:83], v[100:103], v[20:23]
    v_mfma_f32_16x16x32_bf16 v[52:55], v[84:87], v[100:103], v[52:55]
    v_mfma_f32_16x16x32_bf16 v[16:19], v[88:91], v[100:103], v[16:19]
    v_mfma_f32_16x16x32_bf16 v[48:51], v[92:95], v[100:103], v[48:51]
    buffer_load_dwordx4 v[64:67], v125, s[12:15], s23 offen offset:0
    buffer_load_dwordx4 v[68:71], v125, s[12:15], s23 offen offset:1024
    s_waitcnt lgkmcnt(2)
    v_mfma_f32_16x16x32_bf16 v[28:31], v[72:75], v[104:107], v[28:31]
    v_mfma_f32_16x16x32_bf16 v[60:63], v[76:79], v[104:107], v[60:63]
    v_mfma_f32_16x16x32_bf16 v[24:27], v[80:83], v[104:107], v[24:27]
    v_mfma_f32_16x16x32_bf16 v[56:59], v[84:87], v[104:107], v[56:59]
    v_mfma_f32_16x16x32_bf16 v[20:23], v[88:91], v[104:107], v[20:23]
    v_mfma_f32_16x16x32_bf16 v[52:55], v[92:95], v[104:107], v[52:55]
    buffer_load_dwordx4 v[72:75], v125, s[12:15], s23 offen offset:2048
    buffer_load_dwordx4 v[76:79], v125, s[12:15], s23 offen offset:3072
    s_waitcnt lgkmcnt(1)
    v_mfma_f32_16x16x32_bf16 v[28:31], v[80:83], v[108:111], v[28:31]
    v_mfma_f32_16x16x32_bf16 v[60:63], v[84:87], v[108:111], v[60:63]
    v_mfma_f32_16x16x32_bf16 v[24:27], v[88:91], v[108:111], v[24:27]
    v_mfma_f32_16x16x32_bf16 v[56:59], v[92:95], v[108:111], v[56:59]
    buffer_load_dwordx4 v[80:83], v125, s[12:15], s26 offen offset:0
    buffer_load_dwordx4 v[84:87], v125, s[12:15], s26 offen offset:1024
    s_waitcnt lgkmcnt(0)
    v_mfma_f32_16x16x32_bf16 v[28:31], v[88:91], v[112:115], v[28:31]
    v_mfma_f32_16x16x32_bf16 v[60:63], v[92:95], v[112:115], v[60:63]
    buffer_load_dwordx4 v[88:91], v125, s[12:15], s26 offen offset:2048
    buffer_load_dwordx4 v[92:95], v125, s[12:15], s26 offen offset:3072
    s_add_u32 s23, s23, 57344
    s_add_u32 s26, s26, 57344
    s_barrier
    s_branch L_conv2_kernel_mloop1
L_conv2_kernel_mlast1:
    v_and_b32 v125, 15, v127
    v_and_b32 v126, 7, v127
    v_lshlrev_b32 v126, 4, v126
    v_lshl_add_u32 v125, v125, 7, v126
    v_lshrrev_b32 v126, 4, v127
    v_lshl_add_u32 v125, v126, 11, v125
    s_lshl_b32 s36, s20, 14
    s_add_u32 s37, s36, 8192
    v_add_u32 v126, s37, v125
    v_add_u32 v125, s36, v125
    ds_read_b128 v[96:99], v120 offset:8192
    ds_read_b128 v[100:103], v120 offset:9216
    ds_read_b128 v[104:107], v120 offset:10240
    ds_read_b128 v[108:111], v120 offset:11264
    ds_read_b128 v[112:115], v120 offset:12288
    ds_read_b128 v[116:119], v120 offset:13312
    s_waitcnt vmcnt(6) lgkmcnt(5)
    v_mfma_f32_16x16x32_bf16 v[0:3], v[64:67], v[96:99], v[0:3]
    v_mfma_f32_16x16x32_bf16 v[32:35], v[68:71], v[96:99], v[32:35]
    ds_read_b128 v[96:99], v120 offset:14336
    s_waitcnt vmcnt(4) lgkmcnt(5)
    v_mfma_f32_16x16x32_bf16 v[4:7], v[64:67], v[100:103], v[4:7]
    v_mfma_f32_16x16x32_bf16 v[36:39], v[68:71], v[100:103], v[36:39]
    v_mfma_f32_16x16x32_bf16 v[0:3], v[72:75], v[100:103], v[0:3]
    v_mfma_f32_16x16x32_bf16 v[32:35], v[76:79], v[100:103], v[32:35]
    ds_read_b128 v[100:103], v120 offset:15360
    s_waitcnt vmcnt(2) lgkmcnt(5)
    v_mfma_f32_16x16x32_bf16 v[8:11], v[64:67], v[104:107], v[8:11]
    v_mfma_f32_16x16x32_bf16 v[40:43], v[68:71], v[104:107], v[40:43]
    v_mfma_f32_16x16x32_bf16 v[4:7], v[72:75], v[104:107], v[4:7]
    v_mfma_f32_16x16x32_bf16 v[36:39], v[76:79], v[104:107], v[36:39]
    v_mfma_f32_16x16x32_bf16 v[0:3], v[80:83], v[104:107], v[0:3]
    v_mfma_f32_16x16x32_bf16 v[32:35], v[84:87], v[104:107], v[32:35]
    ds_read_b128 v[104:107], v122 offset:0
    s_waitcnt vmcnt(0) lgkmcnt(5)
    v_mfma_f32_16x16x32_bf16 v[12:15], v[64:67], v[108:111], v[12:15]
    v_mfma_f32_16x16x32_bf16 v[44:47], v[68:71], v[108:111], v[44:47]
    v_mfma_f32_16x16x32_bf16 v[8:11], v[72:75], v[108:111], v[8:11]
    v_mfma_f32_16x16x32_bf16 v[40:43], v[76:79], v[108:111], v[40:43]
    v_mfma_f32_16x16x32_bf16 v[4:7], v[80:83], v[108:111], v[4:7]
    v_mfma_f32_16x16x32_bf16 v[36:39], v[84:87], v[108:111], v[36:39]
    v_mfma_f32_16x16x32_bf16 v[0:3], v[88:91], v[108:111], v[0:3]
    v_mfma_f32_16x16x32_bf16 v[32:35], v[92:95], v[108:111], v[32:35]
    ds_read_b128 v[108:111], v121 offset:9216
    s_waitcnt lgkmcnt(5)
    v_mfma_f32_16x16x32_bf16 v[16:19], v[64:67], v[112:115], v[16:19]
    v_mfma_f32_16x16x32_bf16 v[48:51], v[68:71], v[112:115], v[48:51]
    v_mfma_f32_16x16x32_bf16 v[12:15], v[72:75], v[112:115], v[12:15]
    v_mfma_f32_16x16x32_bf16 v[44:47], v[76:79], v[112:115], v[44:47]
    v_mfma_f32_16x16x32_bf16 v[8:11], v[80:83], v[112:115], v[8:11]
    v_mfma_f32_16x16x32_bf16 v[40:43], v[84:87], v[112:115], v[40:43]
    v_mfma_f32_16x16x32_bf16 v[4:7], v[88:91], v[112:115], v[4:7]
    v_mfma_f32_16x16x32_bf16 v[36:39], v[92:95], v[112:115], v[36:39]
    ds_read_b128 v[112:115], v121 offset:10240
    v_xor_b32 v123, 0, v125
    ds_write_b128 v123, v[0:3]
    s_waitcnt lgkmcnt(6)
    v_mfma_f32_16x16x32_bf16 v[20:23], v[64:67], v[116:119], v[20:23]
    v_mfma_f32_16x16x32_bf16 v[52:55], v[68:71], v[116:119], v[52:55]
    v_mfma_f32_16x16x32_bf16 v[16:19], v[72:75], v[116:119], v[16:19]
    v_mfma_f32_16x16x32_bf16 v[48:51], v[76:79], v[116:119], v[48:51]
    v_mfma_f32_16x16x32_bf16 v[12:15], v[80:83], v[116:119], v[12:15]
    v_mfma_f32_16x16x32_bf16 v[44:47], v[84:87], v[116:119], v[44:47]
    v_mfma_f32_16x16x32_bf16 v[8:11], v[88:91], v[116:119], v[8:11]
    v_mfma_f32_16x16x32_bf16 v[40:43], v[92:95], v[116:119], v[40:43]
    v_xor_b32 v124, 16, v125
    ds_write_b128 v124, v[4:7]
    s_waitcnt lgkmcnt(2)
    v_mfma_f32_16x16x32_bf16 v[24:27], v[64:67], v[96:99], v[24:27]
    v_mfma_f32_16x16x32_bf16 v[56:59], v[68:71], v[96:99], v[56:59]
    v_mfma_f32_16x16x32_bf16 v[20:23], v[72:75], v[96:99], v[20:23]
    v_mfma_f32_16x16x32_bf16 v[52:55], v[76:79], v[96:99], v[52:55]
    v_mfma_f32_16x16x32_bf16 v[16:19], v[80:83], v[96:99], v[16:19]
    v_mfma_f32_16x16x32_bf16 v[48:51], v[84:87], v[96:99], v[48:51]
    v_mfma_f32_16x16x32_bf16 v[12:15], v[88:91], v[96:99], v[12:15]
    v_mfma_f32_16x16x32_bf16 v[44:47], v[92:95], v[96:99], v[44:47]
    v_xor_b32 v123, 32, v125
    ds_write_b128 v123, v[8:11]
    v_xor_b32 v124, 0, v126
    ds_write_b128 v124, v[32:35]
    v_mfma_f32_16x16x32_bf16 v[28:31], v[64:67], v[100:103], v[28:31]
    v_mfma_f32_16x16x32_bf16 v[60:63], v[68:71], v[100:103], v[60:63]
    v_mfma_f32_16x16x32_bf16 v[24:27], v[72:75], v[100:103], v[24:27]
    v_mfma_f32_16x16x32_bf16 v[56:59], v[76:79], v[100:103], v[56:59]
    v_mfma_f32_16x16x32_bf16 v[20:23], v[80:83], v[100:103], v[20:23]
    v_mfma_f32_16x16x32_bf16 v[52:55], v[84:87], v[100:103], v[52:55]
    v_mfma_f32_16x16x32_bf16 v[16:19], v[88:91], v[100:103], v[16:19]
    v_mfma_f32_16x16x32_bf16 v[48:51], v[92:95], v[100:103], v[48:51]
    v_xor_b32 v123, 16, v126
    ds_write_b128 v123, v[36:39]
    v_xor_b32 v124, 32, v126
    ds_write_b128 v124, v[40:43]
    v_mfma_f32_16x16x32_bf16 v[28:31], v[72:75], v[104:107], v[28:31]
    v_mfma_f32_16x16x32_bf16 v[60:63], v[76:79], v[104:107], v[60:63]
    v_mfma_f32_16x16x32_bf16 v[24:27], v[80:83], v[104:107], v[24:27]
    v_mfma_f32_16x16x32_bf16 v[56:59], v[84:87], v[104:107], v[56:59]
    v_mfma_f32_16x16x32_bf16 v[20:23], v[88:91], v[104:107], v[20:23]
    v_mfma_f32_16x16x32_bf16 v[52:55], v[92:95], v[104:107], v[52:55]
    v_xor_b32 v124, 48, v125
    ds_write_b128 v124, v[12:15]
    v_xor_b32 v123, 48, v126
    ds_write_b128 v123, v[44:47]
    v_mfma_f32_16x16x32_bf16 v[28:31], v[80:83], v[108:111], v[28:31]
    v_mfma_f32_16x16x32_bf16 v[60:63], v[84:87], v[108:111], v[60:63]
    v_mfma_f32_16x16x32_bf16 v[24:27], v[88:91], v[108:111], v[24:27]
    v_mfma_f32_16x16x32_bf16 v[56:59], v[92:95], v[108:111], v[56:59]
    v_xor_b32 v123, 64, v125
    ds_write_b128 v123, v[16:19]
    v_xor_b32 v124, 64, v126
    ds_write_b128 v124, v[48:51]
    v_mfma_f32_16x16x32_bf16 v[28:31], v[88:91], v[112:115], v[28:31]
    v_mfma_f32_16x16x32_bf16 v[60:63], v[92:95], v[112:115], v[60:63]
    v_xor_b32 v124, 80, v125
    ds_write_b128 v124, v[20:23]
    v_xor_b32 v123, 80, v126
    ds_write_b128 v123, v[52:55]
    v_and_b32 v108, 15, v127
    v_lshrrev_b32 v109, 4, v127
    v_lshrrev_b32 v110, 3, v108
    s_lshl_b32 s36, s20, 1
    v_add_u32 v110, s36, v110
    v_xor_b32 v111, v110, v108
    v_and_b32 v111, 7, v111
    v_lshlrev_b32 v111, 4, v111
    v_xor_b32 v123, 96, v125
    ds_write_b128 v123, v[24:27]
    v_lshl_add_u32 v111, v110, 7, v111
    v_lshl_add_u32 v120, v109, 11, v111
    v_add_u32 v121, 65536, v120
    v_add_u32 v64, 131072, v120
    s_lshl_b32 s36, s20, 9
    s_add_u32 s36, s36, 115712
    v_lshl_add_u32 v127, v109, 7, s36
    s_lshl_b32 s36, s20, 4
    v_add_u32 v108, s36, v108
    v_lshlrev_b32 v110, 6, v108
    v_lshl_add_u32 v110, v109, 4, v110
    s_mul_i32 s36, s29, 262144
    v_xor_b32 v124, 96, v126
    ds_write_b128 v124, v[56:59]
    s_lshl_b32 s37, s21, 4
    s_add_u32 s36, s36, s37
    v_add_u32 v110, s36, v110
    v_mov_b32 v111, 2130706432
    v_cmp_gt_u32 vcc, 125, v108
    s_mov_b32 s4, 0xbeaaaaab
    s_mov_b32 s5, s4
    s_mov_b32 s6, 0x3e800000
    s_mov_b32 s7, s6
    s_mov_b32 s8, 0xc0a00000
    s_mov_b32 s9, s8
    s_mov_b32 s10, 0xc0638e39
    v_xor_b32 v124, 112, v125
    ds_write_b128 v124, v[28:31]
    s_mov_b32 s11, s10
    s_mov_b32 s12, 0xbf638e39
    s_mov_b32 s13, s12
    s_mov_b32 s14, 0xbe638e39
    s_mov_b32 s15, s14
    s_mov_b32 s22, 0xbd638e39
    s_mov_b32 s23, s22
    s_mov_b32 s24, 0x3ff1c71c
    s_mov_b32 s25, s24
    s_mov_b32 s26, 0xbf2aaaab
    s_mov_b32 s27, s26
    s_mov_b32 s32, 0x3ecccccd
    v_xor_b32 v123, 112, v126
    s_waitcnt lgkmcnt(8)
    ds_write_b128 v123, v[60:63]
    s_mov_b32 s33, s32
    s_mov_b32 s34, 0xbd888889
    s_mov_b32 s35, s34
    s_mov_b32 s38, 0xbe4ccccd
    s_mov_b32 s39, s38
    s_mov_b32 s40, 0xbdd2d3e8
    s_mov_b32 s41, s40
    s_mov_b32 s42, 0x3f800000
    s_mov_b32 s43, s42
    s_setprio 0
    s_branch L_conv2_kernel_epi
L_conv2_kernel_m2:
    s_mul_i32 s37, s38, 2176
    s_add_u32 s37, s37, 98304
    v_add_u32 v116, s37, v8
    v_add_u32 v118, s37, v9
    v_add_u32 v117, 104832, v8
    s_cmp_eq_u32 s38, 0
    s_cbranch_scc1 L_conv2_kernel_hh0
    v_add_u32 v117, 98304, v9
L_conv2_kernel_hh0:
    s_lshl_b32 s37, s38, 12
    s_add_u32 s37, s37, s43
    s_add_u32 s37, s37, 49152
    v_lshl_add_u32 v119, v127, 4, s37
    v_mov_b32 v0, 0
    v_mov_b32 v1, 0
    v_mov_b32 v2, 0
    v_mov_b32 v3, 0
    v_mov_b32 v4, 0
    v_mov_b32 v5, 0
    v_mov_b32 v6, 0
    v_mov_b32 v7, 0
    v_mov_b32 v8, 0
    v_mov_b32 v9, 0
    v_mov_b32 v10, 0
    v_mov_b32 v11, 0
    v_mov_b32 v12, 0
    v_mov_b32 v13, 0
    v_mov_b32 v14, 0
    v_mov_b32 v15, 0
    v_mov_b32 v16, 0
    v_mov_b32 v17, 0
    v_mov_b32 v18, 0
    v_mov_b32 v19, 0
    v_mov_b32 v20, 0
    v_mov_b32 v21, 0
    v_mov_b32 v22, 0
    v_mov_b32 v23, 0
    v_mov_b32 v24, 0
    v_mov_b32 v25, 0
    v_mov_b32 v26, 0
    v_mov_b32 v27, 0
    v_mov_b32 v28, 0
    v_mov_b32 v29, 0
    v_mov_b32 v30, 0
    v_mov_b32 v31, 0
    v_mov_b32 v32, 0
    v_mov_b32 v33, 0
    v_mov_b32 v34, 0
    v_mov_b32 v35, 0
    v_mov_b32 v36, 0
    v_mov_b32 v37, 0
    v_mov_b32 v38, 0
    v_mov_b32 v39, 0
    v_mov_b32 v40, 0
    v_mov_b32 v41, 0
    v_mov_b32 v42, 0
    v_mov_b32 v43, 0
    v_mov_b32 v44, 0
    v_mov_b32 v45, 0
    v_mov_b32 v46, 0
    v_mov_b32 v47, 0
    v_mov_b32 v48, 0
    v_mov_b32 v49, 0
    v_mov_b32 v50, 0
    v_mov_b32 v51, 0
    v_mov_b32 v52, 0
    v_mov_b32 v53, 0
    v_mov_b32 v54, 0
    v_mov_b32 v55, 0
    v_mov_b32 v56, 0
    v_mov_b32 v57, 0
    v_mov_b32 v58, 0
    v_mov_b32 v59, 0
    v_mov_b32 v60, 0
    v_mov_b32 v61, 0
    v_mov_b32 v62, 0
    v_mov_b32 v63, 0
    buffer_load_dwordx4 v[96:99], v108, s[8:11], 0 offen
    buffer_load_dwordx4 v[100:103], v109, s[8:11], 0 offen
    buffer_load_dwordx4 v[104:107], v110, s[8:11], 0 offen
    s_mov_b32 s23, 0
    s_mov_b32 s26, 4096
    buffer_load_dwordx4 v[64:67], v125, s[12:15], s23 offen offset:0
    buffer_load_dwordx4 v[68:71], v125, s[12:15], s23 offen offset:2048
    buffer_load_dwordx4 v[80:83], v119, s[12:15], s23 offen offset:0
    buffer_load_dwordx4 v[72:75], v125, s[12:15], s26 offen offset:0
    buffer_load_dwordx4 v[84:87], v119, s[12:15], s23 offen offset:2048
    buffer_load_dwordx4 v[76:79], v125, s[12:15], s26 offen offset:2048
    s_mov_b32 s23, 57344
    s_mov_b32 s26, 61440
    s_waitcnt vmcnt(6)
    v_lshlrev_b32 v108, 16, v96
    v_and_b32 v111, s25, v96
    v_lshlrev_b32 v109, 16, v100
    v_and_b32 v112, s25, v100
    v_lshlrev_b32 v110, 16, v104
    v_and_b32 v113, s25, v104
    v_mul_f32 v114, s44, v108
    v_mul_f32 v115, s44, v111
    v_fmac_f32 v114, s45, v109
    v_fmac_f32 v115, s45, v112
    v_fmac_f32 v114, s46, v110
    v_fmac_f32 v115, s46, v113
    v_cvt_pk_bf16_f32 v96, v114, v115
    v_lshlrev_b32 v108, 16, v97
    v_and_b32 v111, s25, v97
    v_lshlrev_b32 v109, 16, v101
    v_and_b32 v112, s25, v101
    v_lshlrev_b32 v110, 16, v105
    v_and_b32 v113, s25, v105
    v_mul_f32 v114, s44, v108
    v_mul_f32 v115, s44, v111
    v_fmac_f32 v114, s45, v109
    v_fmac_f32 v115, s45, v112
    v_fmac_f32 v114, s46, v110
    v_fmac_f32 v115, s46, v113
    v_cvt_pk_bf16_f32 v97, v114, v115
    v_lshlrev_b32 v108, 16, v98
    v_and_b32 v111, s25, v98
    v_lshlrev_b32 v109, 16, v102
    v_and_b32 v112, s25, v102
    v_lshlrev_b32 v110, 16, v106
    v_and_b32 v113, s25, v106
    v_mul_f32 v114, s44, v108
    v_mul_f32 v115, s44, v111
    v_fmac_f32 v114, s45, v109
    v_fmac_f32 v115, s45, v112
    v_fmac_f32 v114, s46, v110
    v_fmac_f32 v115, s46, v113
    v_cvt_pk_bf16_f32 v98, v114, v115
    v_lshlrev_b32 v108, 16, v99
    v_and_b32 v111, s25, v99
    v_lshlrev_b32 v109, 16, v103
    v_and_b32 v112, s25, v103
    v_lshlrev_b32 v110, 16, v107
    v_and_b32 v113, s25, v107
    v_mul_f32 v114, s44, v108
    v_mul_f32 v115, s44, v111
    v_fmac_f32 v114, s45, v109
    v_fmac_f32 v115, s45, v112
    v_fmac_f32 v114, s46, v110
    v_fmac_f32 v115, s46, v113
    v_cvt_pk_bf16_f32 v99, v114, v115
    ds_write_b128 v126, v[96:99]
    v_and_b32 v111, 15, v127
    v_lshlrev_b32 v111, 2, v111
    v_add_u32 v111, 99328, v111
    ds_write_b32 v111, v0
    ds_write_b32 v111, v0 offset:8704
    s_waitcnt lgkmcnt(0)
    s_barrier
    s_mov_b32 s22, 4
    s_setprio 2
L_conv2_kernel_mloop2:
    ds_read_b128 v[88:91], v120 offset:0
    ds_read_b128 v[92:95], v120 offset:1024
    ds_read_b128 v[96:99], v116 offset:0
    ds_read_b128 v[100:103], v120 offset:2048
    ds_read_b128 v[104:107], v116 offset:1088
    ds_read_b128 v[108:111], v120 offset:3072
    ds_read_b128 v[112:115], v116 offset:2176
    s_waitcnt vmcnt(5) lgkmcnt(6)
    v_mfma_f32_16x16x32_bf16 v[0:3], v[64:67], v[88:91], v[0:3]
    ds_read_b128 v[88:91], v120 offset:4096
    s_waitcnt vmcnt(4) lgkmcnt(6)
    v_mfma_f32_16x16x32_bf16 v[4:7], v[64:67], v[92:95], v[4:7]
    v_mfma_f32_16x16x32_bf16 v[0:3], v[68:71], v[92:95], v[0:3]
    ds_read_b128 v[92:95], v116 offset:3264
    s_waitcnt vmcnt(3) lgkmcnt(6)
    v_mfma_f32_16x16x32_bf16 v[32:35], v[80:83], v[96:99], v[32:35]
    ds_read_b128 v[96:99], v120 offset:5120
    s_waitcnt vmcnt(2) lgkmcnt(6)
    v_mfma_f32_16x16x32_bf16 v[8:11], v[64:67], v[100:103], v[8:11]
    v_mfma_f32_16x16x32_bf16 v[4:7], v[68:71], v[100:103], v[4:7]
    v_mfma_f32_16x16x32_bf16 v[0:3], v[72:75], v[100:103], v[0:3]
    ds_read_b128 v[100:103], v116 offset:4352
    s_waitcnt vmcnt(1) lgkmcnt(6)
    v_mfma_f32_16x16x32_bf16 v[36:39], v[80:83], v[104:107], v[36:39]
    v_mfma_f32_16x16x32_bf16 v[32:35], v[84:87], v[104:107], v[32:35]
    ds_read_b128 v[104:107], v120 offset:6144
    s_waitcnt vmcnt(0) lgkmcnt(6)
    v_mfma_f32_16x16x32_bf16 v[12:15], v[64:67], v[108:111], v[12:15]
    v_mfma_f32_16x16x32_bf16 v[8:11], v[68:71], v[108:111], v[8:11]
    v_mfma_f32_16x16x32_bf16 v[4:7], v[72:75], v[108:111], v[4:7]
    v_mfma_f32_16x16x32_bf16 v[0:3], v[76:79], v[108:111], v[0:3]
    ds_read_b128 v[108:111], v116 offset:5440
    s_waitcnt lgkmcnt(6)
    v_mfma_f32_16x16x32_bf16 v[40:43], v[80:83], v[112:115], v[40:43]
    v_mfma_f32_16x16x32_bf16 v[36:39], v[84:87], v[112:115], v[36:39]
    ds_read_b128 v[112:115], v120 offset:7168
    s_waitcnt lgkmcnt(6)
    v_mfma_f32_16x16x32_bf16 v[16:19], v[64:67], v[88:91], v[16:19]
    v_mfma_f32_16x16x32_bf16 v[12:15], v[68:71], v[88:91], v[12:15]
    v_mfma_f32_16x16x32_bf16 v[8:11], v[72:75], v[88:91], v[8:11]
    v_mfma_f32_16x16x32_bf16 v[4:7], v[76:79], v[88:91], v[4:7]
    ds_read_b128 v[88:91], v117 offset:0
    s_waitcnt lgkmcnt(6)
    v_mfma_f32_16x16x32_bf16 v[44:47], v[80:83], v[92:95], v[44:47]
    v_mfma_f32_16x16x32_bf16 v[40:43], v[84:87], v[92:95], v[40:43]
    ds_read_b128 v[92:95], v122 offset:0
    v_add_u32 v122, v123, v122
    s_waitcnt lgkmcnt(6)
    v_mfma_f32_16x16x32_bf16 v[20:23], v[64:67], v[96:99], v[20:23]
    v_mfma_f32_16x16x32_bf16 v[16:19], v[68:71], v[96:99], v[16:19]
    v_mfma_f32_16x16x32_bf16 v[12:15], v[72:75], v[96:99], v[12:15]
    v_mfma_f32_16x16x32_bf16 v[8:11], v[76:79], v[96:99], v[8:11]
    ds_read_b128 v[96:99], v117 offset:1088
    s_waitcnt lgkmcnt(6)
    v_mfma_f32_16x16x32_bf16 v[48:51], v[80:83], v[100:103], v[48:51]
    v_mfma_f32_16x16x32_bf16 v[44:47], v[84:87], v[100:103], v[44:47]
    ds_read_b128 v[100:103], v121 offset:1024
    s_waitcnt lgkmcnt(6)
    v_mfma_f32_16x16x32_bf16 v[24:27], v[64:67], v[104:107], v[24:27]
    v_mfma_f32_16x16x32_bf16 v[20:23], v[68:71], v[104:107], v[20:23]
    v_mfma_f32_16x16x32_bf16 v[16:19], v[72:75], v[104:107], v[16:19]
    v_mfma_f32_16x16x32_bf16 v[12:15], v[76:79], v[104:107], v[12:15]
    ds_read_b128 v[104:107], v118 offset:0
    s_waitcnt lgkmcnt(6)
    v_mfma_f32_16x16x32_bf16 v[52:55], v[80:83], v[108:111], v[52:55]
    v_mfma_f32_16x16x32_bf16 v[48:51], v[84:87], v[108:111], v[48:51]
    ds_read_b128 v[108:111], v121 offset:2048
    s_waitcnt lgkmcnt(6)
    v_mfma_f32_16x16x32_bf16 v[28:31], v[64:67], v[112:115], v[28:31]
    v_mfma_f32_16x16x32_bf16 v[24:27], v[68:71], v[112:115], v[24:27]
    v_mfma_f32_16x16x32_bf16 v[20:23], v[72:75], v[112:115], v[20:23]
    v_mfma_f32_16x16x32_bf16 v[16:19], v[76:79], v[112:115], v[16:19]
    buffer_load_dwordx4 v[64:67], v125, s[12:15], s23 offen offset:0
    s_waitcnt lgkmcnt(5)
    v_mfma_f32_16x16x32_bf16 v[56:59], v[80:83], v[88:91], v[56:59]
    v_mfma_f32_16x16x32_bf16 v[52:55], v[84:87], v[88:91], v[52:55]
    s_waitcnt lgkmcnt(0)
    s_barrier
    v_mfma_f32_16x16x32_bf16 v[28:31], v[68:71], v[92:95], v[28:31]
    v_mfma_f32_16x16x32_bf16 v[24:27], v[72:75], v[92:95], v[24:27]
    v_mfma_f32_16x16x32_bf16 v[20:23], v[76:79], v[92:95], v[20:23]
    buffer_load_dwordx4 v[68:71], v125, s[12:15], s23 offen offset:2048
    v_mfma_f32_16x16x32_bf16 v[60:63], v[80:83], v[96:99], v[60:63]
    v_mfma_f32_16x16x32_bf16 v[56:59], v[84:87], v[96:99], v[56:59]
    buffer_load_dwordx4 v[80:83], v119, s[12:15], s23 offen offset:0
    v_mfma_f32_16x16x32_bf16 v[28:31], v[72:75], v[100:103], v[28:31]
    v_mfma_f32_16x16x32_bf16 v[24:27], v[76:79], v[100:103], v[24:27]
    buffer_load_dwordx4 v[72:75], v125, s[12:15], s26 offen offset:0
    v_mfma_f32_16x16x32_bf16 v[60:63], v[84:87], v[104:107], v[60:63]
    buffer_load_dwordx4 v[84:87], v119, s[12:15], s23 offen offset:2048
    v_mfma_f32_16x16x32_bf16 v[28:31], v[76:79], v[108:111], v[28:31]
    buffer_load_dwordx4 v[76:79], v125, s[12:15], s26 offen offset:2048
    s_add_u32 s23, s23, 57344
    s_add_u32 s26, s26, 57344
    s_sub_u32 s22, s22, 1
    s_cmp_eq_u32 s22, 0
    s_cbranch_scc1 L_conv2_kernel_mlast2
    ds_read_b128 v[88:91], v120 offset:8192
    ds_read_b128 v[92:95], v120 offset:9216
    ds_read_b128 v[96:99], v116 offset:8704
    ds_read_b128 v[100:103], v120 offset:10240
    ds_read_b128 v[104:107], v116 offset:9792
    ds_read_b128 v[108:111], v120 offset:11264
    ds_read_b128 v[112:115], v116 offset:10880
    s_waitcnt vmcnt(5) lgkmcnt(6)
    v_mfma_f32_16x16x32_bf16 v[0:3], v[64:67], v[88:91], v[0:3]
    ds_read_b128 v[88:91], v120 offset:12288
    s_waitcnt vmcnt(4) lgkmcnt(6)
    v_mfma_f32_16x16x32_bf16 v[4:7], v[64:67], v[92:95], v[4:7]
    v_mfma_f32_16x16x32_bf16 v[0:3], v[68:71], v[92:95], v[0:3]
    ds_read_b128 v[92:95], v116 offset:11968
    s_waitcnt vmcnt(3) lgkmcnt(6)
    v_mfma_f32_16x16x32_bf16 v[32:35], v[80:83], v[96:99], v[32:35]
    ds_read_b128 v[96:99], v120 offset:13312
    s_waitcnt vmcnt(2) lgkmcnt(6)
    v_mfma_f32_16x16x32_bf16 v[8:11], v[64:67], v[100:103], v[8:11]
    v_mfma_f32_16x16x32_bf16 v[4:7], v[68:71], v[100:103], v[4:7]
    v_mfma_f32_16x16x32_bf16 v[0:3], v[72:75], v[100:103], v[0:3]
    ds_read_b128 v[100:103], v116 offset:13056
    s_waitcnt vmcnt(1) lgkmcnt(6)
    v_mfma_f32_16x16x32_bf16 v[36:39], v[80:83], v[104:107], v[36:39]
    v_mfma_f32_16x16x32_bf16 v[32:35], v[84:87], v[104:107], v[32:35]
    ds_read_b128 v[104:107], v120 offset:14336
    s_waitcnt vmcnt(0) lgkmcnt(6)
    v_mfma_f32_16x16x32_bf16 v[12:15], v[64:67], v[108:111], v[12:15]
    v_mfma_f32_16x16x32_bf16 v[8:11], v[68:71], v[108:111], v[8:11]
    v_mfma_f32_16x16x32_bf16 v[4:7], v[72:75], v[108:111], v[4:7]
    v_mfma_f32_16x16x32_bf16 v[0:3], v[76:79], v[108:111], v[0:3]
    ds_read_b128 v[108:111], v116 offset:14144
    s_waitcnt lgkmcnt(6)
    v_mfma_f32_16x16x32_bf16 v[40:43], v[80:83], v[112:115], v[40:43]
    v_mfma_f32_16x16x32_bf16 v[36:39], v[84:87], v[112:115], v[36:39]
    ds_read_b128 v[112:115], v120 offset:15360
    s_waitcnt lgkmcnt(6)
    v_mfma_f32_16x16x32_bf16 v[16:19], v[64:67], v[88:91], v[16:19]
    v_mfma_f32_16x16x32_bf16 v[12:15], v[68:71], v[88:91], v[12:15]
    v_mfma_f32_16x16x32_bf16 v[8:11], v[72:75], v[88:91], v[8:11]
    v_mfma_f32_16x16x32_bf16 v[4:7], v[76:79], v[88:91], v[4:7]
    ds_read_b128 v[88:91], v117 offset:8704
    s_waitcnt lgkmcnt(6)
    v_mfma_f32_16x16x32_bf16 v[44:47], v[80:83], v[92:95], v[44:47]
    v_mfma_f32_16x16x32_bf16 v[40:43], v[84:87], v[92:95], v[40:43]
    ds_read_b128 v[92:95], v122 offset:0
    v_add_u32 v122, v124, v122
    s_waitcnt lgkmcnt(6)
    v_mfma_f32_16x16x32_bf16 v[20:23], v[64:67], v[96:99], v[20:23]
    v_mfma_f32_16x16x32_bf16 v[16:19], v[68:71], v[96:99], v[16:19]
    v_mfma_f32_16x16x32_bf16 v[12:15], v[72:75], v[96:99], v[12:15]
    v_mfma_f32_16x16x32_bf16 v[8:11], v[76:79], v[96:99], v[8:11]
    ds_read_b128 v[96:99], v117 offset:9792
    s_waitcnt lgkmcnt(6)
    v_mfma_f32_16x16x32_bf16 v[48:51], v[80:83], v[100:103], v[48:51]
    v_mfma_f32_16x16x32_bf16 v[44:47], v[84:87], v[100:103], v[44:47]
    ds_read_b128 v[100:103], v121 offset:9216
    s_waitcnt lgkmcnt(6)
    v_mfma_f32_16x16x32_bf16 v[24:27], v[64:67], v[104:107], v[24:27]
    v_mfma_f32_16x16x32_bf16 v[20:23], v[68:71], v[104:107], v[20:23]
    v_mfma_f32_16x16x32_bf16 v[16:19], v[72:75], v[104:107], v[16:19]
    v_mfma_f32_16x16x32_bf16 v[12:15], v[76:79], v[104:107], v[12:15]
    ds_read_b128 v[104:107], v118 offset:8704
    s_waitcnt lgkmcnt(6)
    v_mfma_f32_16x16x32_bf16 v[52:55], v[80:83], v[108:111], v[52:55]
    v_mfma_f32_16x16x32_bf16 v[48:51], v[84:87], v[108:111], v[48:51]
    ds_read_b128 v[108:111], v121 offset:10240
    s_waitcnt lgkmcnt(6)
    v_mfma_f32_16x16x32_bf16 v[28:31], v[64:67], v[112:115], v[28:31]
    v_mfma_f32_16x16x32_bf16 v[24:27], v[68:71], v[112:115], v[24:27]
    v_mfma_f32_16x16x32_bf16 v[20:23], v[72:75], v[112:115], v[20:23]
    v_mfma_f32_16x16x32_bf16 v[16:19], v[76:79], v[112:115], v[16:19]
    buffer_load_dwordx4 v[64:67], v125, s[12:15], s23 offen offset:0
    s_waitcnt lgkmcnt(5)
    v_mfma_f32_16x16x32_bf16 v[56:59], v[80:83], v[88:91], v[56:59]
    v_mfma_f32_16x16x32_bf16 v[52:55], v[84:87], v[88:91], v[52:55]
    s_waitcnt lgkmcnt(0)
    s_barrier
    v_mfma_f32_16x16x32_bf16 v[28:31], v[68:71], v[92:95], v[28:31]
    v_mfma_f32_16x16x32_bf16 v[24:27], v[72:75], v[92:95], v[24:27]
    v_mfma_f32_16x16x32_bf16 v[20:23], v[76:79], v[92:95], v[20:23]
    buffer_load_dwordx4 v[68:71], v125, s[12:15], s23 offen offset:2048
    v_mfma_f32_16x16x32_bf16 v[60:63], v[80:83], v[96:99], v[60:63]
    v_mfma_f32_16x16x32_bf16 v[56:59], v[84:87], v[96:99], v[56:59]
    buffer_load_dwordx4 v[80:83], v119, s[12:15], s23 offen offset:0
    v_mfma_f32_16x16x32_bf16 v[28:31], v[72:75], v[100:103], v[28:31]
    v_mfma_f32_16x16x32_bf16 v[24:27], v[76:79], v[100:103], v[24:27]
    buffer_load_dwordx4 v[72:75], v125, s[12:15], s26 offen offset:0
    v_mfma_f32_16x16x32_bf16 v[60:63], v[84:87], v[104:107], v[60:63]
    buffer_load_dwordx4 v[84:87], v119, s[12:15], s23 offen offset:2048
    v_mfma_f32_16x16x32_bf16 v[28:31], v[76:79], v[108:111], v[28:31]
    buffer_load_dwordx4 v[76:79], v125, s[12:15], s26 offen offset:2048
    s_add_u32 s23, s23, 57344
    s_add_u32 s26, s26, 57344
    s_branch L_conv2_kernel_mloop2
L_conv2_kernel_mlast2:
    v_and_b32 v125, 15, v127
    v_and_b32 v126, 7, v127
    v_lshlrev_b32 v126, 4, v126
    v_lshl_add_u32 v125, v125, 7, v126
    v_lshrrev_b32 v126, 4, v127
    v_lshl_add_u32 v125, v126, 11, v125
    s_mov_b32 s36, 65536
    s_cmp_eq_u32 s32, 1
    s_cselect_b32 s36, 121856, s36
    s_cmp_eq_u32 s32, 2
    s_cselect_b32 s36, 81920, s36
    s_cmp_eq_u32 s32, 3
    s_cselect_b32 s36, 130048, s36
    s_mov_b32 s37, 98304
    s_cmp_eq_u32 s32, 1
    s_cselect_b32 s37, 138240, s37
    s_cmp_eq_u32 s32, 2
    s_cselect_b32 s37, 146432, s37
    s_cmp_eq_u32 s32, 3
    s_cselect_b32 s37, 154624, s37
    v_add_u32 v126, s37, v125
    v_add_u32 v125, s36, v125
    ds_read_b128 v[88:91], v120 offset:8192
    ds_read_b128 v[92:95], v120 offset:9216
    ds_read_b128 v[96:99], v116 offset:8704
    ds_read_b128 v[100:103], v120 offset:10240
    ds_read_b128 v[104:107], v116 offset:9792
    ds_read_b128 v[108:111], v120 offset:11264
    ds_read_b128 v[112:115], v116 offset:10880
    s_waitcnt vmcnt(5) lgkmcnt(6)
    v_mfma_f32_16x16x32_bf16 v[0:3], v[64:67], v[88:91], v[0:3]
    ds_read_b128 v[88:91], v120 offset:12288
    s_waitcnt vmcnt(4) lgkmcnt(6)
    v_mfma_f32_16x16x32_bf16 v[4:7], v[64:67], v[92:95], v[4:7]
    v_mfma_f32_16x16x32_bf16 v[0:3], v[68:71], v[92:95], v[0:3]
    ds_read_b128 v[92:95], v116 offset:11968
    s_waitcnt vmcnt(3) lgkmcnt(6)
    v_mfma_f32_16x16x32_bf16 v[32:35], v[80:83], v[96:99], v[32:35]
    ds_read_b128 v[96:99], v120 offset:13312
    s_waitcnt vmcnt(2) lgkmcnt(6)
    v_mfma_f32_16x16x32_bf16 v[8:11], v[64:67], v[100:103], v[8:11]
    v_mfma_f32_16x16x32_bf16 v[4:7], v[68:71], v[100:103], v[4:7]
    v_mfma_f32_16x16x32_bf16 v[0:3], v[72:75], v[100:103], v[0:3]
    ds_read_b128 v[100:103], v116 offset:13056
    s_waitcnt vmcnt(1) lgkmcnt(6)
    v_mfma_f32_16x16x32_bf16 v[36:39], v[80:83], v[104:107], v[36:39]
    v_mfma_f32_16x16x32_bf16 v[32:35], v[84:87], v[104:107], v[32:35]
    ds_read_b128 v[104:107], v120 offset:14336
    s_waitcnt vmcnt(0) lgkmcnt(6)
    v_mfma_f32_16x16x32_bf16 v[12:15], v[64:67], v[108:111], v[12:15]
    v_mfma_f32_16x16x32_bf16 v[8:11], v[68:71], v[108:111], v[8:11]
    v_mfma_f32_16x16x32_bf16 v[4:7], v[72:75], v[108:111], v[4:7]
    v_mfma_f32_16x16x32_bf16 v[0:3], v[76:79], v[108:111], v[0:3]
    ds_read_b128 v[108:111], v116 offset:14144
    s_waitcnt lgkmcnt(6)
    v_mfma_f32_16x16x32_bf16 v[40:43], v[80:83], v[112:115], v[40:43]
    v_mfma_f32_16x16x32_bf16 v[36:39], v[84:87], v[112:115], v[36:39]
    ds_read_b128 v[112:115], v120 offset:15360
    s_waitcnt lgkmcnt(6)
    v_mfma_f32_16x16x32_bf16 v[16:19], v[64:67], v[88:91], v[16:19]
    v_mfma_f32_16x16x32_bf16 v[12:15], v[68:71], v[88:91], v[12:15]
    v_mfma_f32_16x16x32_bf16 v[8:11], v[72:75], v[88:91], v[8:11]
    v_mfma_f32_16x16x32_bf16 v[4:7], v[76:79], v[88:91], v[4:7]
    ds_read_b128 v[88:91], v117 offset:8704
    v_xor_b32 v124, 0, v126
    ds_write_b128 v124, v[32:35]
    s_waitcnt lgkmcnt(7)
    v_mfma_f32_16x16x32_bf16 v[44:47], v[80:83], v[92:95], v[44:47]
    v_mfma_f32_16x16x32_bf16 v[40:43], v[84:87], v[92:95], v[40:43]
    ds_read_b128 v[92:95], v122 offset:0
    v_xor_b32 v123, 0, v125
    ds_write_b128 v123, v[0:3]
    s_waitcnt lgkmcnt(8)
    v_mfma_f32_16x16x32_bf16 v[20:23], v[64:67], v[96:99], v[20:23]
    v_mfma_f32_16x16x32_bf16 v[16:19], v[68:71], v[96:99], v[16:19]
    v_mfma_f32_16x16x32_bf16 v[12:15], v[72:75], v[96:99], v[12:15]
    v_mfma_f32_16x16x32_bf16 v[8:11], v[76:79], v[96:99], v[8:11]
    ds_read_b128 v[96:99], v117 offset:9792
    v_xor_b32 v123, 16, v126
    ds_write_b128 v123, v[36:39]
    s_waitcnt lgkmcnt(9)
    v_mfma_f32_16x16x32_bf16 v[48:51], v[80:83], v[100:103], v[48:51]
    v_mfma_f32_16x16x32_bf16 v[44:47], v[84:87], v[100:103], v[44:47]
    ds_read_b128 v[100:103], v121 offset:9216
    v_xor_b32 v124, 16, v125
    ds_write_b128 v124, v[4:7]
    s_waitcnt lgkmcnt(10)
    v_mfma_f32_16x16x32_bf16 v[24:27], v[64:67], v[104:107], v[24:27]
    v_mfma_f32_16x16x32_bf16 v[20:23], v[68:71], v[104:107], v[20:23]
    v_mfma_f32_16x16x32_bf16 v[16:19], v[72:75], v[104:107], v[16:19]
    v_mfma_f32_16x16x32_bf16 v[12:15], v[76:79], v[104:107], v[12:15]
    ds_read_b128 v[104:107], v118 offset:8704
    v_xor_b32 v124, 32, v126
    ds_write_b128 v124, v[40:43]
    s_waitcnt lgkmcnt(11)
    v_mfma_f32_16x16x32_bf16 v[52:55], v[80:83], v[108:111], v[52:55]
    v_mfma_f32_16x16x32_bf16 v[48:51], v[84:87], v[108:111], v[48:51]
    ds_read_b128 v[108:111], v121 offset:10240
    v_xor_b32 v123, 32, v125
    ds_write_b128 v123, v[8:11]
    s_waitcnt lgkmcnt(12)
    v_mfma_f32_16x16x32_bf16 v[28:31], v[64:67], v[112:115], v[28:31]
    v_mfma_f32_16x16x32_bf16 v[24:27], v[68:71], v[112:115], v[24:27]
    v_mfma_f32_16x16x32_bf16 v[20:23], v[72:75], v[112:115], v[20:23]
    v_mfma_f32_16x16x32_bf16 v[16:19], v[76:79], v[112:115], v[16:19]
    v_xor_b32 v123, 48, v126
    ds_write_b128 v123, v[44:47]
    s_waitcnt lgkmcnt(12)
    v_mfma_f32_16x16x32_bf16 v[56:59], v[80:83], v[88:91], v[56:59]
    v_mfma_f32_16x16x32_bf16 v[52:55], v[84:87], v[88:91], v[52:55]
    v_xor_b32 v124, 48, v125
    ds_write_b128 v124, v[12:15]
    s_waitcnt lgkmcnt(11)
    v_mfma_f32_16x16x32_bf16 v[28:31], v[68:71], v[92:95], v[28:31]
    v_mfma_f32_16x16x32_bf16 v[24:27], v[72:75], v[92:95], v[24:27]
    v_mfma_f32_16x16x32_bf16 v[20:23], v[76:79], v[92:95], v[20:23]
    v_xor_b32 v124, 64, v126
    ds_write_b128 v124, v[48:51]
    s_waitcnt lgkmcnt(10)
    v_mfma_f32_16x16x32_bf16 v[60:63], v[80:83], v[96:99], v[60:63]
    v_mfma_f32_16x16x32_bf16 v[56:59], v[84:87], v[96:99], v[56:59]
    v_xor_b32 v123, 64, v125
    ds_write_b128 v123, v[16:19]
    s_waitcnt lgkmcnt(9)
    v_mfma_f32_16x16x32_bf16 v[28:31], v[72:75], v[100:103], v[28:31]
    v_mfma_f32_16x16x32_bf16 v[24:27], v[76:79], v[100:103], v[24:27]
    v_xor_b32 v123, 80, v126
    ds_write_b128 v123, v[52:55]
    s_waitcnt lgkmcnt(8)
    v_mfma_f32_16x16x32_bf16 v[60:63], v[84:87], v[104:107], v[60:63]
    v_xor_b32 v124, 80, v125
    ds_write_b128 v124, v[20:23]
    s_waitcnt lgkmcnt(7)
    v_mfma_f32_16x16x32_bf16 v[28:31], v[76:79], v[108:111], v[28:31]
    v_xor_b32 v124, 96, v126
    ds_write_b128 v124, v[56:59]
    v_and_b32 v108, 15, v127
    v_lshrrev_b32 v109, 4, v127
    v_lshrrev_b32 v110, 3, v108
    s_lshl_b32 s36, s20, 1
    v_add_u32 v110, s36, v110
    v_xor_b32 v111, v110, v108
    v_and_b32 v111, 7, v111
    v_lshlrev_b32 v111, 4, v111
    v_xor_b32 v123, 96, v125
    ds_write_b128 v123, v[24:27]
    v_lshl_add_u32 v111, v110, 7, v111
    v_lshl_add_u32 v120, v109, 11, v111
    v_add_u32 v121, 65536, v120
    v_add_u32 v64, 131072, v120
    s_lshl_b32 s36, s20, 9
    s_add_u32 s36, s36, 115712
    v_lshl_add_u32 v127, v109, 7, s36
    s_lshl_b32 s36, s20, 4
    v_add_u32 v108, s36, v108
    v_lshlrev_b32 v110, 6, v108
    v_lshl_add_u32 v110, v109, 4, v110
    s_mul_i32 s36, s29, 262144
    v_xor_b32 v123, 112, v126
    ds_write_b128 v123, v[60:63]
    s_lshl_b32 s37, s21, 4
    s_add_u32 s36, s36, s37
    v_add_u32 v110, s36, v110
    v_mov_b32 v111, 2130706432
    v_cmp_gt_u32 vcc, 125, v108
    s_mov_b32 s4, 0xbeaaaaab
    s_mov_b32 s5, s4
    s_mov_b32 s6, 0x3e800000
    s_mov_b32 s7, s6
    s_mov_b32 s8, 0xc0a00000
    s_mov_b32 s9, s8
    s_mov_b32 s10, 0xc0638e39
    v_xor_b32 v124, 112, v125
    ds_write_b128 v124, v[28:31]
    s_mov_b32 s11, s10
    s_mov_b32 s12, 0xbf638e39
    s_mov_b32 s13, s12
    s_mov_b32 s14, 0xbe638e39
    s_mov_b32 s15, s14
    s_mov_b32 s22, 0xbd638e39
    s_mov_b32 s23, s22
    s_mov_b32 s24, 0x3ff1c71c
    s_mov_b32 s25, s24
    s_mov_b32 s26, 0xbf2aaaab
    s_mov_b32 s27, s26
    s_mov_b32 s32, 0x3ecccccd
    s_mov_b32 s33, s32
    s_mov_b32 s34, 0xbd888889
    s_mov_b32 s35, s34
    s_mov_b32 s38, 0xbe4ccccd
    s_mov_b32 s39, s38
    s_mov_b32 s40, 0xbdd2d3e8
    s_mov_b32 s41, s40
    s_mov_b32 s42, 0x3f800000
    s_mov_b32 s43, s42
    s_setprio 0
    s_branch L_conv2_kernel_epi
L_conv2_kernel_epi:
    s_waitcnt lgkmcnt(0)
    s_barrier
    v_cndmask_b32 v122, v111, v110, vcc
    ds_read_b128 v[0:3], v120 offset:0
    ds_read_b128 v[4:7], v120 offset:16384
    ds_read_b128 v[8:11], v120 offset:32768
    ds_read_b128 v[12:15], v120 offset:49152
    ds_read_b128 v[16:19], v121 offset:0
    ds_read_b128 v[20:23], v121 offset:16384
    ds_read_b128 v[24:27], v121 offset:32768
    ds_read_b128 v[28:31], v64 offset:15360
    ds_read_b128 v[32:35], v120 offset:8192
    ds_read_b128 v[36:39], v120 offset:24576
    ds_read_b128 v[40:43], v120 offset:40960
    ds_read_b128 v[44:47], v120 offset:57344
    ds_read_b128 v[48:51], v121 offset:56320
    ds_read_b128 v[52:55], v121 offset:64512
    ds_read_b128 v[56:59], v64 offset:7168
    s_waitcnt lgkmcnt(7)
    ds_read_b128 v[60:63], v64 offset:23552
    s_waitcnt lgkmcnt(8)
    v_pk_add_f32 v[88:89], v[24:25], v[28:29]
    v_pk_add_f32 v[90:91], v[26:27], v[30:31]
    v_pk_add_f32 v[24:25], v[4:5], v[8:9]
    v_pk_add_f32 v[26:27], v[6:7], v[10:11]
    v_pk_add_f32 v[4:5], v[4:5], v[8:9] neg_lo:[0,1] neg_hi:[0,1]
    v_pk_add_f32 v[6:7], v[6:7], v[10:11] neg_lo:[0,1] neg_hi:[0,1]
    v_pk_add_f32 v[72:73], v[12:13], v[16:17]
    v_pk_add_f32 v[74:75], v[14:15], v[18:19]
    v_pk_add_f32 v[12:13], v[12:13], v[16:17] neg_lo:[0,1] neg_hi:[0,1]
    v_pk_add_f32 v[14:15], v[14:15], v[18:19] neg_lo:[0,1] neg_hi:[0,1]
    v_pk_fma_f32 v[72:73], v[24:25], s[4:5], v[72:73]
    v_pk_fma_f32 v[74:75], v[26:27], s[4:5], v[74:75]
    v_pk_fma_f32 v[20:21], v[0:1], s[10:11], v[20:21]
    v_pk_fma_f32 v[22:23], v[2:3], s[10:11], v[22:23]
    v_pk_fma_f32 v[72:73], v[0:1], s[6:7], v[72:73]
    v_pk_fma_f32 v[74:75], v[2:3], s[6:7], v[74:75]
    v_pk_add_f32 v[24:25], v[24:25], v[0:1] neg_lo:[0,1] neg_hi:[0,1]
    v_pk_add_f32 v[26:27], v[26:27], v[2:3] neg_lo:[0,1] neg_hi:[0,1]
    v_pk_fma_f32 v[72:73], v[88:89], s[8:9], v[72:73]
    v_pk_fma_f32 v[74:75], v[90:91], s[8:9], v[74:75]
    v_pk_add_f32 v[24:25], v[24:25], v[88:89] neg_lo:[0,1] neg_hi:[0,1]
    v_pk_add_f32 v[26:27], v[26:27], v[90:91] neg_lo:[0,1] neg_hi:[0,1]
    v_pk_fma_f32 v[20:21], v[88:89], s[22:23], v[20:21]
    v_pk_fma_f32 v[22:23], v[90:91], s[22:23], v[22:23]
    v_pk_add_f32 v[8:9], v[24:25], v[72:73] neg_lo:[0,1] neg_hi:[0,1]
    v_pk_add_f32 v[10:11], v[26:27], v[74:75] neg_lo:[0,1] neg_hi:[0,1]
    v_pk_fma_f32 v[20:21], v[72:73], s[14:15], v[20:21]
    v_pk_fma_f32 v[22:23], v[74:75], s[14:15], v[22:23]
    v_pk_mul_f32 v[80:81], v[12:13], s[32:33]
    v_pk_mul_f32 v[82:83], v[14:15], s[32:33]
    v_pk_fma_f32 v[20:21], v[8:9], s[12:13], v[20:21]
    v_pk_fma_f32 v[22:23], v[10:11], s[12:13], v[22:23]
    v_pk_fma_f32 v[80:81], v[4:5], s[34:35], v[80:81]
    v_pk_fma_f32 v[82:83], v[6:7], s[34:35], v[82:83]
    v_pk_fma_f32 v[64:65], v[4:5], s[24:25], v[20:21] neg_lo:[0,0,1] neg_hi:[0,0,1]
    v_pk_fma_f32 v[66:67], v[6:7], s[24:25], v[22:23] neg_lo:[0,0,1] neg_hi:[0,0,1]
    v_pk_fma_f32 v[64:65], v[12:13], s[26:27], v[64:65]
    v_pk_fma_f32 v[66:67], v[14:15], s[26:27], v[66:67]
    v_pk_fma_f32 v[80:81], v[64:65], s[38:39], v[80:81]
    v_pk_fma_f32 v[82:83], v[66:67], s[38:39], v[82:83]
    v_pk_add_f32 v[4:5], v[4:5], v[64:65] neg_lo:[0,1] neg_hi:[0,1]
    v_pk_add_f32 v[6:7], v[6:7], v[66:67] neg_lo:[0,1] neg_hi:[0,1]
    v_pk_add_f32 v[4:5], v[4:5], v[80:81] neg_lo:[0,1] neg_hi:[0,1]
    v_pk_add_f32 v[6:7], v[6:7], v[82:83] neg_lo:[0,1] neg_hi:[0,1]
    s_waitcnt lgkmcnt(0)
    v_pk_add_f32 v[92:93], v[56:57], v[60:61]
    v_pk_add_f32 v[94:95], v[58:59], v[62:63]
    v_pk_add_f32 v[56:57], v[36:37], v[40:41]
    v_pk_add_f32 v[58:59], v[38:39], v[42:43]
    v_pk_add_f32 v[36:37], v[36:37], v[40:41] neg_lo:[0,1] neg_hi:[0,1]
    v_pk_add_f32 v[38:39], v[38:39], v[42:43] neg_lo:[0,1] neg_hi:[0,1]
    v_pk_add_f32 v[76:77], v[44:45], v[48:49]
    v_pk_add_f32 v[78:79], v[46:47], v[50:51]
    v_pk_add_f32 v[44:45], v[44:45], v[48:49] neg_lo:[0,1] neg_hi:[0,1]
    v_pk_add_f32 v[46:47], v[46:47], v[50:51] neg_lo:[0,1] neg_hi:[0,1]
    v_pk_fma_f32 v[76:77], v[56:57], s[4:5], v[76:77]
    v_pk_fma_f32 v[78:79], v[58:59], s[4:5], v[78:79]
    v_pk_fma_f32 v[52:53], v[32:33], s[10:11], v[52:53]
    v_pk_fma_f32 v[54:55], v[34:35], s[10:11], v[54:55]
    v_pk_fma_f32 v[76:77], v[32:33], s[6:7], v[76:77]
    v_pk_fma_f32 v[78:79], v[34:35], s[6:7], v[78:79]
    v_pk_add_f32 v[56:57], v[56:57], v[32:33] neg_lo:[0,1] neg_hi:[0,1]
    v_pk_add_f32 v[58:59], v[58:59], v[34:35] neg_lo:[0,1] neg_hi:[0,1]
    v_pk_fma_f32 v[76:77], v[92:93], s[8:9], v[76:77]
    v_pk_fma_f32 v[78:79], v[94:95], s[8:9], v[78:79]
    v_pk_add_f32 v[56:57], v[56:57], v[92:93] neg_lo:[0,1] neg_hi:[0,1]
    v_pk_add_f32 v[58:59], v[58:59], v[94:95] neg_lo:[0,1] neg_hi:[0,1]
    v_pk_fma_f32 v[52:53], v[92:93], s[22:23], v[52:53]
    v_pk_fma_f32 v[54:55], v[94:95], s[22:23], v[54:55]
    v_pk_add_f32 v[40:41], v[56:57], v[76:77] neg_lo:[0,1] neg_hi:[0,1]
    v_pk_add_f32 v[42:43], v[58:59], v[78:79] neg_lo:[0,1] neg_hi:[0,1]
    v_pk_fma_f32 v[52:53], v[76:77], s[14:15], v[52:53]
    v_pk_fma_f32 v[54:55], v[78:79], s[14:15], v[54:55]
    v_pk_mul_f32 v[84:85], v[44:45], s[32:33]
    v_pk_mul_f32 v[86:87], v[46:47], s[32:33]
    v_pk_fma_f32 v[52:53], v[40:41], s[12:13], v[52:53]
    v_pk_fma_f32 v[54:55], v[42:43], s[12:13], v[54:55]
    v_pk_fma_f32 v[84:85], v[36:37], s[34:35], v[84:85]
    v_pk_fma_f32 v[86:87], v[38:39], s[34:35], v[86:87]
    v_pk_fma_f32 v[68:69], v[36:37], s[24:25], v[52:53] neg_lo:[0,0,1] neg_hi:[0,0,1]
    v_pk_fma_f32 v[70:71], v[38:39], s[24:25], v[54:55] neg_lo:[0,0,1] neg_hi:[0,0,1]
    v_pk_fma_f32 v[68:69], v[44:45], s[26:27], v[68:69]
    v_pk_fma_f32 v[70:71], v[46:47], s[26:27], v[70:71]
    v_pk_fma_f32 v[84:85], v[68:69], s[38:39], v[84:85]
    v_pk_fma_f32 v[86:87], v[70:71], s[38:39], v[86:87]
    v_pk_add_f32 v[36:37], v[36:37], v[68:69] neg_lo:[0,1] neg_hi:[0,1]
    v_pk_add_f32 v[38:39], v[38:39], v[70:71] neg_lo:[0,1] neg_hi:[0,1]
    v_pk_add_f32 v[36:37], v[36:37], v[84:85] neg_lo:[0,1] neg_hi:[0,1]
    v_pk_add_f32 v[38:39], v[38:39], v[86:87] neg_lo:[0,1] neg_hi:[0,1]
    s_mov_b32 s36, 0x00010001
    s_mov_b32 s37, 0x00010001
    s_mov_b64 exec, s[36:37]
    ds_write_b128 v127, v[0:3] offset:0
    ds_write_b128 v127, v[32:35] offset:16
    ds_write_b128 v127, v[4:7] offset:32
    ds_write_b128 v127, v[36:39] offset:48
    ds_write_b128 v127, v[8:11] offset:64
    ds_write_b128 v127, v[40:43] offset:80
    s_mov_b64 exec, -1
    v_mov_b32 v44, 0xc0135761
    v_mov_b32 v45, v44
    v_cvt_pk_bf16_f32 v48, v64, v68
    v_cvt_pk_bf16_f32 v49, v65, v69
    v_cvt_pk_bf16_f32 v50, v66, v70
    v_cvt_pk_bf16_f32 v51, v67, v71
    s_mov_b32 s44, 0
    buffer_store_dwordx4 v[48:51], v122, s[16:19], s44 offen sc1
    s_waitcnt lgkmcnt(0)
    s_barrier
    ds_read_b128 v[96:99], v127 offset:512
    ds_read_b128 v[100:103], v127 offset:528
    ds_read_b128 v[104:107], v127 offset:544
    ds_read_b128 v[108:111], v127 offset:560
    ds_read_b128 v[112:115], v127 offset:576
    ds_read_b128 v[116:119], v127 offset:592
    s_waitcnt lgkmcnt(4)
    v_mov_b32_dpp v96, v0 row_shl:1 row_mask:0xf bank_mask:0xf
    v_mov_b32_dpp v97, v1 row_shl:1 row_mask:0xf bank_mask:0xf
    v_mov_b32_dpp v98, v2 row_shl:1 row_mask:0xf bank_mask:0xf
    v_mov_b32_dpp v99, v3 row_shl:1 row_mask:0xf bank_mask:0xf
    v_mov_b32_dpp v100, v32 row_shl:1 row_mask:0xf bank_mask:0xf
    v_mov_b32_dpp v101, v33 row_shl:1 row_mask:0xf bank_mask:0xf
    v_mov_b32_dpp v102, v34 row_shl:1 row_mask:0xf bank_mask:0xf
    v_mov_b32_dpp v103, v35 row_shl:1 row_mask:0xf bank_mask:0xf
    v_pk_add_f32 v[72:73], v[72:73], v[96:97]
    v_pk_add_f32 v[74:75], v[74:75], v[98:99]
    v_pk_add_f32 v[76:77], v[76:77], v[100:101]
    v_pk_add_f32 v[78:79], v[78:79], v[102:103]
    v_cvt_pk_bf16_f32 v52, v72, v76
    v_cvt_pk_bf16_f32 v53, v73, v77
    v_cvt_pk_bf16_f32 v54, v74, v78
    v_cvt_pk_bf16_f32 v55, v75, v79
    s_mov_b32 s44, 65536
    buffer_store_dwordx4 v[52:55], v122, s[16:19], s44 offen sc1
    s_waitcnt lgkmcnt(2)
    v_mov_b32_dpp v104, v4 row_shl:1 row_mask:0xf bank_mask:0xf
    v_mov_b32_dpp v105, v5 row_shl:1 row_mask:0xf bank_mask:0xf
    v_mov_b32_dpp v106, v6 row_shl:1 row_mask:0xf bank_mask:0xf
    v_mov_b32_dpp v107, v7 row_shl:1 row_mask:0xf bank_mask:0xf
    v_mov_b32_dpp v108, v36 row_shl:1 row_mask:0xf bank_mask:0xf
    v_mov_b32_dpp v109, v37 row_shl:1 row_mask:0xf bank_mask:0xf
    v_mov_b32_dpp v110, v38 row_shl:1 row_mask:0xf bank_mask:0xf
    v_mov_b32_dpp v111, v39 row_shl:1 row_mask:0xf bank_mask:0xf
    v_pk_add_f32 v[80:81], v[80:81], v[104:105]
    v_pk_add_f32 v[82:83], v[82:83], v[106:107]
    v_pk_add_f32 v[84:85], v[84:85], v[108:109]
    v_pk_add_f32 v[86:87], v[86:87], v[110:111]
    v_cvt_pk_bf16_f32 v56, v80, v84
    v_cvt_pk_bf16_f32 v57, v81, v85
    v_cvt_pk_bf16_f32 v58, v82, v86
    v_cvt_pk_bf16_f32 v59, v83, v87
    s_mov_b32 s44, 131072
    buffer_store_dwordx4 v[56:59], v122, s[16:19], s44 offen sc1
    s_waitcnt lgkmcnt(0)
    v_mov_b32_dpp v112, v8 row_shl:1 row_mask:0xf bank_mask:0xf
    v_mov_b32_dpp v113, v9 row_shl:1 row_mask:0xf bank_mask:0xf
    v_mov_b32_dpp v114, v10 row_shl:1 row_mask:0xf bank_mask:0xf
    v_mov_b32_dpp v115, v11 row_shl:1 row_mask:0xf bank_mask:0xf
    v_mov_b32_dpp v116, v40 row_shl:1 row_mask:0xf bank_mask:0xf
    v_mov_b32_dpp v117, v41 row_shl:1 row_mask:0xf bank_mask:0xf
    v_mov_b32_dpp v118, v42 row_shl:1 row_mask:0xf bank_mask:0xf
    v_mov_b32_dpp v119, v43 row_shl:1 row_mask:0xf bank_mask:0xf
    v_pk_add_f32 v[88:89], v[88:89], v[112:113]
    v_pk_add_f32 v[90:91], v[90:91], v[114:115]
    v_pk_add_f32 v[92:93], v[92:93], v[116:117]
    v_pk_add_f32 v[94:95], v[94:95], v[118:119]
    v_cvt_pk_bf16_f32 v60, v88, v92
    v_cvt_pk_bf16_f32 v61, v89, v93
    v_cvt_pk_bf16_f32 v62, v90, v94
    v_cvt_pk_bf16_f32 v63, v91, v95
    s_mov_b32 s44, 196608
    buffer_store_dwordx4 v[60:63], v122, s[16:19], s44 offen sc1
L_conv2_kernel_end:
L_conv2_kernel_done:
    s_endpgm
.globl joint_kernel
.p2align 8
.type joint_kernel,@function
joint_kernel:
    s_cmp_ge_u32 s2, 250
    s_cbranch_scc1 L_joint_kernel_done
    s_load_dwordx2 s[28:29], s[0:1], 56
    s_load_dwordx2 s[30:31], s[0:1], 72
    v_readfirstlane_b32 s20, v0
    s_lshr_b32 s20, s20, 6
    s_and_b32 s21, s20, 7
    v_and_b32 v127, 63, v0
    v_lshlrev_b32 v126, 4, v127
    s_cmp_ge_u32 s20, 8
    s_mov_b32 s33, 44171264
    s_cselect_b32 s33, 44040192, s33
    s_lshl_b32 s36, s21, 14
    s_add_u32 s33, s33, s36
    s_mov_b32 s14, 16384
    s_mov_b32 s15, 0x00020000
    s_lshl_b32 s35, s2, 9
    s_cmp_ge_u32 s2, 125
    s_cselect_b32 s36, 2033152, 0
    s_cselect_b32 s34, 8192, 0
    s_add_u32 s35, s35, s36
    s_add_u32 s34, s34, 44302336
    s_mov_b32 s10, 12582912
    s_mov_b32 s11, 0x00020000
    s_mov_b32 s42, 24576
    s_mov_b32 s43, 0x00020000
    s_cmp_ge_u32 s20, 8
    s_cbranch_scc1 L_joint_kernel_T
    v_lshrrev_b32 v124, 5, v127
    v_and_b32 v123, 0x1ff, v126
    v_mul_u32_u24 v125, 65536, v124
    v_add_u32 v123, v125, v123
    s_mul_i32 s36, s21, 262144
    s_add_u32 s36, s36, s35
    s_waitcnt lgkmcnt(0)
    s_add_u32 s8, s30, 27262976
    s_addc_u32 s9, s31, 0
    s_add_u32 s37, s36, 8388608
    buffer_load_dwordx4 v[64:67], v123, s[8:11], s36 offen
    buffer_load_dwordx4 v[72:75], v123, s[8:11], s37 offen
    s_add_u32 s36, s36, 131072
    s_add_u32 s37, s36, 8388608
    buffer_load_dwordx4 v[68:71], v123, s[8:11], s36 offen
    buffer_load_dwordx4 v[76:79], v123, s[8:11], s37 offen
    v_mov_b32 v0, 99456
    v_mov_b32 v2, 0
    v_mov_b32 v3, 0
    ds_write_b64 v0, v[2:3]
    s_add_u32 s12, s30, s33
    s_addc_u32 s13, s31, 0
    s_add_u32 s40, s30, s34
    s_addc_u32 s41, s31, 0
    s_lshl_b32 s38, s21, 10
    s_add_u32 s38, s38, 16384
    buffer_load_dwordx4 v[80:83], v126, s[40:43], s38 offen
    s_waitcnt lgkmcnt(0)
    s_barrier
    s_lshl_b32 s35, s2, 17
    s_add_u32 s16, s28, s35
    s_addc_u32 s17, s29, 0
    s_mov_b32 s18, 131072
    s_mov_b32 s19, 0x00020000
    s_mov_b32 s46, 0xbdd2d3e8
    s_mov_b32 s47, s46
    v_mov_b32 v120, 0xc0135761
    v_mov_b32 v121, v120
    s_mov_b32 s48, 1.0
    s_mov_b32 s49, 1.0
    v_bfe_u32 v123, v127, 2, 3
    v_lshl_add_u32 v124, v123, 2, v124
    v_mul_u32_u24 v124, 528, v124
    v_and_b32 v123, 0x30, v126
    s_lshl_b32 s36, s21, 6
    v_add3_u32 v124, v124, v123, s36
    s_mov_b32 s45, 0xffff0000
    s_mul_i32 s36, s21, 1040
    s_add_u32 s36, s36, 91136
    v_add_u32 v123, s36, v126
    s_mov_b32 s22, 2
    s_waitcnt vmcnt(3)
L_joint_kernel_floop:
    v_lshlrev_b32 v88, 16, v64
    v_and_b32 v89, s45, v64
    v_lshlrev_b32 v96, 16, v72
    v_and_b32 v97, s45, v72
    v_lshlrev_b32 v90, 16, v65
    v_and_b32 v91, s45, v65
    v_lshlrev_b32 v98, 16, v73
    v_and_b32 v99, s45, v73
    v_lshlrev_b32 v92, 16, v66
    v_and_b32 v93, s45, v66
    v_lshlrev_b32 v100, 16, v74
    v_and_b32 v101, s45, v74
    v_lshlrev_b32 v94, 16, v67
    v_and_b32 v95, s45, v67
    v_lshlrev_b32 v102, 16, v75
    v_and_b32 v103, s45, v75
    v_pk_add_f32 v[88:89], v[88:89], v[96:97]
    v_pk_add_f32 v[90:91], v[90:91], v[98:99]
    v_pk_add_f32 v[92:93], v[92:93], v[100:101]
    v_pk_add_f32 v[94:95], v[94:95], v[102:103]
    v_pk_mul_f32 v[96:97], v[88:89], v[88:89]
    v_pk_mul_f32 v[98:99], v[90:91], v[90:91]
    v_pk_mul_f32 v[100:101], v[92:93], v[92:93]
    v_pk_mul_f32 v[102:103], v[94:95], v[94:95]
    v_pk_fma_f32 v[96:97], v[96:97], s[46:47], v[120:121]
    v_pk_fma_f32 v[98:99], v[98:99], s[46:47], v[120:121]
    v_pk_fma_f32 v[100:101], v[100:101], s[46:47], v[120:121]
    v_pk_fma_f32 v[102:103], v[102:103], s[46:47], v[120:121]
    v_pk_mul_f32 v[96:97], v[96:97], v[88:89]
    v_pk_mul_f32 v[98:99], v[98:99], v[90:91]
    v_pk_mul_f32 v[100:101], v[100:101], v[92:93]
    v_pk_mul_f32 v[102:103], v[102:103], v[94:95]
    v_exp_f32 v96, v96
    v_exp_f32 v97, v97
    v_exp_f32 v98, v98
    v_exp_f32 v99, v99
    v_exp_f32 v100, v100
    v_exp_f32 v101, v101
    v_exp_f32 v102, v102
    v_exp_f32 v103, v103
    v_pk_add_f32 v[96:97], v[96:97], s[48:49]
    v_pk_add_f32 v[98:99], v[98:99], s[48:49]
    v_pk_add_f32 v[100:101], v[100:101], s[48:49]
    v_pk_add_f32 v[102:103], v[102:103], s[48:49]
    v_rcp_f32 v96, v96
    v_rcp_f32 v97, v97
    v_rcp_f32 v98, v98
    v_rcp_f32 v99, v99
    v_rcp_f32 v100, v100
    v_rcp_f32 v101, v101
    v_rcp_f32 v102, v102
    v_rcp_f32 v103, v103
    v_pk_mul_f32 v[88:89], v[88:89], v[96:97]
    v_pk_mul_f32 v[90:91], v[90:91], v[98:99]
    v_pk_mul_f32 v[92:93], v[92:93], v[100:101]
    v_pk_mul_f32 v[94:95], v[94:95], v[102:103]
    v_cvt_pk_bf16_f32 v104, v88, v89
    v_cvt_pk_bf16_f32 v105, v90, v91
    v_cvt_pk_bf16_f32 v106, v92, v93
    v_cvt_pk_bf16_f32 v107, v94, v95
    ds_write_b128 v124, v[104:107] offset:32768
    s_waitcnt vmcnt(0)
    v_pk_mov_b32 v[64:65], v[68:69], v[68:69] op_sel:[0,1]
    v_pk_mov_b32 v[72:73], v[76:77], v[76:77] op_sel:[0,1]
    v_pk_mov_b32 v[66:67], v[70:71], v[70:71] op_sel:[0,1]
    v_pk_mov_b32 v[74:75], v[78:79], v[78:79] op_sel:[0,1]
    v_add_u32 v124, 1056, v124
    s_sub_u32 s22, s22, 1
    s_cmp_lg_u32 s22, 0
    s_cbranch_scc1 L_joint_kernel_floop
    ds_write_b128 v123, v[80:83]
    s_waitcnt lgkmcnt(0)
    v_mov_b32 v120, 99456
    v_mov_b32 v121, 1
    s_mov_b64 exec, 1
    ds_add_u32 v120, v121 offset:0
    s_mov_b64 exec, -1
L_joint_kernel_ow:
    ds_read_b32 v121, v120 offset:4
    s_waitcnt lgkmcnt(0)
    v_readfirstlane_b32 s37, v121
    s_cmp_ge_u32 s37, 8
    s_cbranch_scc1 L_joint_kernel_ow_d
    s_sleep 1
    s_branch L_joint_kernel_ow
L_joint_kernel_ow_d:
    s_mov_b32 s36, 0
    buffer_load_dwordx4 v[0:3], v126, s[12:15], s36 offen offset:0
    buffer_load_dwordx4 v[4:7], v126, s[12:15], s36 offen offset:1024
    buffer_load_dwordx4 v[8:11], v126, s[12:15], s36 offen offset:2048
    buffer_load_dwordx4 v[12:15], v126, s[12:15], s36 offen offset:3072
    s_mov_b32 s36, 4096
    buffer_load_dwordx4 v[16:19], v126, s[12:15], s36 offen offset:0
    buffer_load_dwordx4 v[20:23], v126, s[12:15], s36 offen offset:1024
    buffer_load_dwordx4 v[24:27], v126, s[12:15], s36 offen offset:2048
    buffer_load_dwordx4 v[28:31], v126, s[12:15], s36 offen offset:3072
    s_mov_b32 s36, 8192
    buffer_load_dwordx4 v[32:35], v126, s[12:15], s36 offen offset:0
    buffer_load_dwordx4 v[36:39], v126, s[12:15], s36 offen offset:1024
    buffer_load_dwordx4 v[40:43], v126, s[12:15], s36 offen offset:2048
    buffer_load_dwordx4 v[44:47], v126, s[12:15], s36 offen offset:3072
    s_mov_b32 s36, 12288
    buffer_load_dwordx4 v[48:51], v126, s[12:15], s36 offen offset:0
    buffer_load_dwordx4 v[52:55], v126, s[12:15], s36 offen offset:1024
    buffer_load_dwordx4 v[56:59], v126, s[12:15], s36 offen offset:2048
    buffer_load_dwordx4 v[60:63], v126, s[12:15], s36 offen offset:3072
    v_lshrrev_b32 v125, 4, v127
    v_lshlrev_b32 v125, 11, v125
    v_and_b32 v124, 15, v127
    v_lshl_add_u32 v125, v124, 2, v125
    s_lshl_b32 s36, s21, 6
    v_add_u32 v125, s36, v125
    s_mov_b32 s44, 8192
    s_setprio 1
    s_barrier
    ds_read_b128 v[96:99], v126 offset:0
    ds_read_b128 v[100:103], v126 offset:1024
    ds_read_b128 v[104:107], v126 offset:2048
    ds_read_b128 v[108:111], v126 offset:3072
    s_waitcnt vmcnt(14) lgkmcnt(3)
    v_mfma_f32_16x16x32_bf16 v[64:67], v[96:99], v[0:3], 0
    v_mfma_f32_16x16x32_bf16 v[68:71], v[96:99], v[4:7], 0
    ds_read_b128 v[96:99], v126 offset:4096
    s_waitcnt lgkmcnt(3)
    v_mfma_f32_16x16x32_bf16 v[72:75], v[100:103], v[0:3], 0
    v_mfma_f32_16x16x32_bf16 v[76:79], v[100:103], v[4:7], 0
    ds_read_b128 v[100:103], v126 offset:5120
    s_waitcnt vmcnt(12) lgkmcnt(3)
    v_mfma_f32_16x16x32_bf16 v[64:67], v[104:107], v[8:11], v[64:67]
    v_mfma_f32_16x16x32_bf16 v[68:71], v[104:107], v[12:15], v[68:71]
    ds_read_b128 v[104:107], v126 offset:6144
    s_waitcnt lgkmcnt(3)
    v_mfma_f32_16x16x32_bf16 v[72:75], v[108:111], v[8:11], v[72:75]
    v_mfma_f32_16x16x32_bf16 v[76:79], v[108:111], v[12:15], v[76:79]
    ds_read_b128 v[108:111], v126 offset:7168
    s_waitcnt vmcnt(10) lgkmcnt(3)
    v_mfma_f32_16x16x32_bf16 v[64:67], v[96:99], v[16:19], v[64:67]
    v_mfma_f32_16x16x32_bf16 v[68:71], v[96:99], v[20:23], v[68:71]
    ds_read_b128 v[96:99], v126 offset:8192
    s_waitcnt lgkmcnt(3)
    v_mfma_f32_16x16x32_bf16 v[72:75], v[100:103], v[16:19], v[72:75]
    v_mfma_f32_16x16x32_bf16 v[76:79], v[100:103], v[20:23], v[76:79]
    ds_read_b128 v[100:103], v126 offset:9216
    s_waitcnt vmcnt(8) lgkmcnt(3)
    v_mfma_f32_16x16x32_bf16 v[64:67], v[104:107], v[24:27], v[64:67]
    v_mfma_f32_16x16x32_bf16 v[68:71], v[104:107], v[28:31], v[68:71]
    ds_read_b128 v[104:107], v126 offset:10240
    s_waitcnt lgkmcnt(3)
    v_mfma_f32_16x16x32_bf16 v[72:75], v[108:111], v[24:27], v[72:75]
    v_mfma_f32_16x16x32_bf16 v[76:79], v[108:111], v[28:31], v[76:79]
    ds_read_b128 v[108:111], v126 offset:11264
    s_waitcnt vmcnt(6) lgkmcnt(3)
    v_mfma_f32_16x16x32_bf16 v[64:67], v[96:99], v[32:35], v[64:67]
    v_mfma_f32_16x16x32_bf16 v[68:71], v[96:99], v[36:39], v[68:71]
    ds_read_b128 v[96:99], v126 offset:12288
    s_waitcnt lgkmcnt(3)
    v_mfma_f32_16x16x32_bf16 v[72:75], v[100:103], v[32:35], v[72:75]
    v_mfma_f32_16x16x32_bf16 v[76:79], v[100:103], v[36:39], v[76:79]
    ds_read_b128 v[100:103], v126 offset:13312
    s_waitcnt vmcnt(4) lgkmcnt(3)
    v_mfma_f32_16x16x32_bf16 v[64:67], v[104:107], v[40:43], v[64:67]
    v_mfma_f32_16x16x32_bf16 v[68:71], v[104:107], v[44:47], v[68:71]
    ds_read_b128 v[104:107], v126 offset:14336
    s_waitcnt lgkmcnt(3)
    v_mfma_f32_16x16x32_bf16 v[72:75], v[108:111], v[40:43], v[72:75]
    v_mfma_f32_16x16x32_bf16 v[76:79], v[108:111], v[44:47], v[76:79]
    ds_read_b128 v[108:111], v126 offset:15360
    s_waitcnt vmcnt(2) lgkmcnt(3)
    v_mfma_f32_16x16x32_bf16 v[64:67], v[96:99], v[48:51], v[64:67]
    v_mfma_f32_16x16x32_bf16 v[68:71], v[96:99], v[52:55], v[68:71]
    s_waitcnt lgkmcnt(0)
    s_barrier
    ds_read_b128 v[96:99], v126 offset:16384
    v_mfma_f32_16x16x32_bf16 v[72:75], v[100:103], v[48:51], v[72:75]
    v_mfma_f32_16x16x32_bf16 v[76:79], v[100:103], v[52:55], v[76:79]
    ds_read_b128 v[100:103], v126 offset:17408
    s_waitcnt vmcnt(0)
    v_mfma_f32_16x16x32_bf16 v[64:67], v[104:107], v[56:59], v[64:67]
    v_mfma_f32_16x16x32_bf16 v[68:71], v[104:107], v[60:63], v[68:71]
    ds_read_b128 v[104:107], v126 offset:18432
    v_mfma_f32_16x16x32_bf16 v[72:75], v[108:111], v[56:59], v[72:75]
    v_mfma_f32_16x16x32_bf16 v[76:79], v[108:111], v[60:63], v[76:79]
    ds_read_b128 v[108:111], v126 offset:19456
    s_mov_b32 s22, 4
L_joint_kernel_oloop:
    s_waitcnt lgkmcnt(3)
    v_mfma_f32_16x16x32_bf16 v[80:83], v[96:99], v[0:3], 0
    v_mfma_f32_16x16x32_bf16 v[84:87], v[96:99], v[4:7], 0
    ds_read_b128 v[96:99], v126 offset:20480
    s_waitcnt lgkmcnt(3)
    v_mfma_f32_16x16x32_bf16 v[88:91], v[100:103], v[0:3], 0
    v_mfma_f32_16x16x32_bf16 v[92:95], v[100:103], v[4:7], 0
    ds_read_b128 v[100:103], v126 offset:21504
    s_waitcnt lgkmcnt(3)
    v_mfma_f32_16x16x32_bf16 v[80:83], v[104:107], v[8:11], v[80:83]
    v_mfma_f32_16x16x32_bf16 v[84:87], v[104:107], v[12:15], v[84:87]
    ds_read_b128 v[104:107], v126 offset:22528
    s_waitcnt lgkmcnt(3)
    v_mfma_f32_16x16x32_bf16 v[88:91], v[108:111], v[8:11], v[88:91]
    v_cvt_pk_bf16_f32 v112, v64, v68
    v_mfma_f32_16x16x32_bf16 v[92:95], v[108:111], v[12:15], v[92:95]
    buffer_store_dword v112, v125, s[16:19], 0 offen offset:0 nt
    ds_read_b128 v[108:111], v126 offset:23552
    s_waitcnt lgkmcnt(3)
    v_mfma_f32_16x16x32_bf16 v[80:83], v[96:99], v[16:19], v[80:83]
    v_cvt_pk_bf16_f32 v113, v65, v69
    v_mfma_f32_16x16x32_bf16 v[84:87], v[96:99], v[20:23], v[84:87]
    buffer_store_dword v113, v125, s[16:19], 0 offen offset:512 nt
    ds_read_b128 v[96:99], v126 offset:24576
    s_waitcnt lgkmcnt(3)
    v_mfma_f32_16x16x32_bf16 v[88:91], v[100:103], v[16:19], v[88:91]
    v_cvt_pk_bf16_f32 v114, v66, v70
    v_mfma_f32_16x16x32_bf16 v[92:95], v[100:103], v[20:23], v[92:95]
    buffer_store_dword v114, v125, s[16:19], 0 offen offset:1024 nt
    ds_read_b128 v[100:103], v126 offset:25600
    s_waitcnt lgkmcnt(3)
    v_mfma_f32_16x16x32_bf16 v[80:83], v[104:107], v[24:27], v[80:83]
    v_cvt_pk_bf16_f32 v115, v67, v71
    v_mfma_f32_16x16x32_bf16 v[84:87], v[104:107], v[28:31], v[84:87]
    buffer_store_dword v115, v125, s[16:19], 0 offen offset:1536 nt
    ds_read_b128 v[104:107], v126 offset:26624
    s_waitcnt lgkmcnt(3)
    v_mfma_f32_16x16x32_bf16 v[88:91], v[108:111], v[24:27], v[88:91]
    v_cvt_pk_bf16_f32 v116, v72, v76
    v_mfma_f32_16x16x32_bf16 v[92:95], v[108:111], v[28:31], v[92:95]
    buffer_store_dword v116, v125, s[16:19], s44 offen offset:0 nt
    ds_read_b128 v[108:111], v126 offset:27648
    s_waitcnt lgkmcnt(3)
    v_mfma_f32_16x16x32_bf16 v[80:83], v[96:99], v[32:35], v[80:83]
    v_cvt_pk_bf16_f32 v117, v73, v77
    v_mfma_f32_16x16x32_bf16 v[84:87], v[96:99], v[36:39], v[84:87]
    buffer_store_dword v117, v125, s[16:19], s44 offen offset:512 nt
    ds_read_b128 v[96:99], v126 offset:28672
    s_waitcnt lgkmcnt(3)
    v_mfma_f32_16x16x32_bf16 v[88:91], v[100:103], v[32:35], v[88:91]
    v_cvt_pk_bf16_f32 v118, v74, v78
    v_mfma_f32_16x16x32_bf16 v[92:95], v[100:103], v[36:39], v[92:95]
    buffer_store_dword v118, v125, s[16:19], s44 offen offset:1024 nt
    ds_read_b128 v[100:103], v126 offset:29696
    s_waitcnt lgkmcnt(3)
    v_mfma_f32_16x16x32_bf16 v[80:83], v[104:107], v[40:43], v[80:83]
    v_cvt_pk_bf16_f32 v119, v75, v79
    v_mfma_f32_16x16x32_bf16 v[84:87], v[104:107], v[44:47], v[84:87]
    buffer_store_dword v119, v125, s[16:19], s44 offen offset:1536 nt
    ds_read_b128 v[104:107], v126 offset:30720
    s_waitcnt lgkmcnt(3)
    v_mfma_f32_16x16x32_bf16 v[88:91], v[108:111], v[40:43], v[88:91]
    v_add_u32 v125, 16384, v125
    v_mfma_f32_16x16x32_bf16 v[92:95], v[108:111], v[44:47], v[92:95]
    ds_read_b128 v[108:111], v126 offset:31744
    s_waitcnt lgkmcnt(3)
    v_mfma_f32_16x16x32_bf16 v[80:83], v[96:99], v[48:51], v[80:83]
    v_mfma_f32_16x16x32_bf16 v[84:87], v[96:99], v[52:55], v[84:87]
    s_waitcnt lgkmcnt(0)
    s_barrier
    ds_read_b128 v[96:99], v126 offset:0
    v_mfma_f32_16x16x32_bf16 v[88:91], v[100:103], v[48:51], v[88:91]
    v_mfma_f32_16x16x32_bf16 v[92:95], v[100:103], v[52:55], v[92:95]
    ds_read_b128 v[100:103], v126 offset:1024
    v_mfma_f32_16x16x32_bf16 v[80:83], v[104:107], v[56:59], v[80:83]
    v_mfma_f32_16x16x32_bf16 v[84:87], v[104:107], v[60:63], v[84:87]
    ds_read_b128 v[104:107], v126 offset:2048
    v_mfma_f32_16x16x32_bf16 v[88:91], v[108:111], v[56:59], v[88:91]
    v_mfma_f32_16x16x32_bf16 v[92:95], v[108:111], v[60:63], v[92:95]
    ds_read_b128 v[108:111], v126 offset:3072
    s_sub_u32 s22, s22, 1
    s_cmp_eq_u32 s22, 0
    s_cbranch_scc1 L_joint_kernel_oend
    s_waitcnt lgkmcnt(3)
    v_mfma_f32_16x16x32_bf16 v[64:67], v[96:99], v[0:3], 0
    v_mfma_f32_16x16x32_bf16 v[68:71], v[96:99], v[4:7], 0
    ds_read_b128 v[96:99], v126 offset:4096
    s_waitcnt lgkmcnt(3)
    v_mfma_f32_16x16x32_bf16 v[72:75], v[100:103], v[0:3], 0
    v_mfma_f32_16x16x32_bf16 v[76:79], v[100:103], v[4:7], 0
    ds_read_b128 v[100:103], v126 offset:5120
    s_waitcnt lgkmcnt(3)
    v_mfma_f32_16x16x32_bf16 v[64:67], v[104:107], v[8:11], v[64:67]
    v_mfma_f32_16x16x32_bf16 v[68:71], v[104:107], v[12:15], v[68:71]
    ds_read_b128 v[104:107], v126 offset:6144
    s_waitcnt lgkmcnt(3)
    v_mfma_f32_16x16x32_bf16 v[72:75], v[108:111], v[8:11], v[72:75]
    v_cvt_pk_bf16_f32 v112, v80, v84
    v_mfma_f32_16x16x32_bf16 v[76:79], v[108:111], v[12:15], v[76:79]
    buffer_store_dword v112, v125, s[16:19], 0 offen offset:0 nt
    ds_read_b128 v[108:111], v126 offset:7168
    s_waitcnt lgkmcnt(3)
    v_mfma_f32_16x16x32_bf16 v[64:67], v[96:99], v[16:19], v[64:67]
    v_cvt_pk_bf16_f32 v113, v81, v85
    v_mfma_f32_16x16x32_bf16 v[68:71], v[96:99], v[20:23], v[68:71]
    buffer_store_dword v113, v125, s[16:19], 0 offen offset:512 nt
    ds_read_b128 v[96:99], v126 offset:8192
    s_waitcnt lgkmcnt(3)
    v_mfma_f32_16x16x32_bf16 v[72:75], v[100:103], v[16:19], v[72:75]
    v_cvt_pk_bf16_f32 v114, v82, v86
    v_mfma_f32_16x16x32_bf16 v[76:79], v[100:103], v[20:23], v[76:79]
    buffer_store_dword v114, v125, s[16:19], 0 offen offset:1024 nt
    ds_read_b128 v[100:103], v126 offset:9216
    s_waitcnt lgkmcnt(3)
    v_mfma_f32_16x16x32_bf16 v[64:67], v[104:107], v[24:27], v[64:67]
    v_cvt_pk_bf16_f32 v115, v83, v87
    v_mfma_f32_16x16x32_bf16 v[68:71], v[104:107], v[28:31], v[68:71]
    buffer_store_dword v115, v125, s[16:19], 0 offen offset:1536 nt
    ds_read_b128 v[104:107], v126 offset:10240
    s_waitcnt lgkmcnt(3)
    v_mfma_f32_16x16x32_bf16 v[72:75], v[108:111], v[24:27], v[72:75]
    v_cvt_pk_bf16_f32 v116, v88, v92
    v_mfma_f32_16x16x32_bf16 v[76:79], v[108:111], v[28:31], v[76:79]
    buffer_store_dword v116, v125, s[16:19], s44 offen offset:0 nt
    ds_read_b128 v[108:111], v126 offset:11264
    s_waitcnt lgkmcnt(3)
    v_mfma_f32_16x16x32_bf16 v[64:67], v[96:99], v[32:35], v[64:67]
    v_cvt_pk_bf16_f32 v117, v89, v93
    v_mfma_f32_16x16x32_bf16 v[68:71], v[96:99], v[36:39], v[68:71]
    buffer_store_dword v117, v125, s[16:19], s44 offen offset:512 nt
    ds_read_b128 v[96:99], v126 offset:12288
    s_waitcnt lgkmcnt(3)
    v_mfma_f32_16x16x32_bf16 v[72:75], v[100:103], v[32:35], v[72:75]
    v_cvt_pk_bf16_f32 v118, v90, v94
    v_mfma_f32_16x16x32_bf16 v[76:79], v[100:103], v[36:39], v[76:79]
    buffer_store_dword v118, v125, s[16:19], s44 offen offset:1024 nt
    ds_read_b128 v[100:103], v126 offset:13312
    s_waitcnt lgkmcnt(3)
    v_mfma_f32_16x16x32_bf16 v[64:67], v[104:107], v[40:43], v[64:67]
    v_cvt_pk_bf16_f32 v119, v91, v95
    v_mfma_f32_16x16x32_bf16 v[68:71], v[104:107], v[44:47], v[68:71]
    buffer_store_dword v119, v125, s[16:19], s44 offen offset:1536 nt
    ds_read_b128 v[104:107], v126 offset:14336
    s_waitcnt lgkmcnt(3)
    v_mfma_f32_16x16x32_bf16 v[72:75], v[108:111], v[40:43], v[72:75]
    v_add_u32 v125, 16384, v125
    v_mfma_f32_16x16x32_bf16 v[76:79], v[108:111], v[44:47], v[76:79]
    ds_read_b128 v[108:111], v126 offset:15360
    s_waitcnt lgkmcnt(3)
    v_mfma_f32_16x16x32_bf16 v[64:67], v[96:99], v[48:51], v[64:67]
    v_mfma_f32_16x16x32_bf16 v[68:71], v[96:99], v[52:55], v[68:71]
    s_waitcnt lgkmcnt(0)
    s_barrier
    ds_read_b128 v[96:99], v126 offset:16384
    v_mfma_f32_16x16x32_bf16 v[72:75], v[100:103], v[48:51], v[72:75]
    v_mfma_f32_16x16x32_bf16 v[76:79], v[100:103], v[52:55], v[76:79]
    ds_read_b128 v[100:103], v126 offset:17408
    v_mfma_f32_16x16x32_bf16 v[64:67], v[104:107], v[56:59], v[64:67]
    v_mfma_f32_16x16x32_bf16 v[68:71], v[104:107], v[60:63], v[68:71]
    ds_read_b128 v[104:107], v126 offset:18432
    v_mfma_f32_16x16x32_bf16 v[72:75], v[108:111], v[56:59], v[72:75]
    v_mfma_f32_16x16x32_bf16 v[76:79], v[108:111], v[60:63], v[76:79]
    ds_read_b128 v[108:111], v126 offset:19456
    s_waitcnt vmcnt(32)
    s_branch L_joint_kernel_oloop
L_joint_kernel_oend:
    s_nop 7
    v_cvt_pk_bf16_f32 v112, v80, v84
    buffer_store_dword v112, v125, s[16:19], 0 offen offset:0 nt
    v_cvt_pk_bf16_f32 v113, v81, v85
    buffer_store_dword v113, v125, s[16:19], 0 offen offset:512 nt
    v_cvt_pk_bf16_f32 v114, v82, v86
    buffer_store_dword v114, v125, s[16:19], 0 offen offset:1024 nt
    v_cvt_pk_bf16_f32 v115, v83, v87
    buffer_store_dword v115, v125, s[16:19], 0 offen offset:1536 nt
    v_cvt_pk_bf16_f32 v116, v88, v92
    buffer_store_dword v116, v125, s[16:19], s44 offen offset:0 nt
    v_cvt_pk_bf16_f32 v117, v89, v93
    buffer_store_dword v117, v125, s[16:19], s44 offen offset:512 nt
    v_cvt_pk_bf16_f32 v118, v90, v94
    buffer_store_dword v118, v125, s[16:19], s44 offen offset:1024 nt
    v_cvt_pk_bf16_f32 v119, v91, v95
    buffer_store_dword v119, v125, s[16:19], s44 offen offset:1536 nt
    v_add_u32 v125, 16384, v125
    s_endpgm
L_joint_kernel_T:
    s_setprio 3
    s_waitcnt lgkmcnt(0)
    s_add_u32 s12, s30, s33
    s_addc_u32 s13, s31, 0
    s_add_u32 s40, s30, s34
    s_addc_u32 s41, s31, 0
    s_lshl_b32 s36, s21, 2
    s_add_u32 s36, s36, 44335104
    s_add_u32 s36, s30, s36
    s_addc_u32 s37, s31, 0
    s_load_dword s44, s[36:37], 0
    v_and_b32 v123, 15, v127
    v_lshrrev_b32 v121, 4, v127
    v_mul_u32_u24 v125, 528, v123
    v_lshl_add_u32 v125, v121, 4, v125
    v_lshlrev_b32 v121, 5, v121
    v_and_b32 v120, 7, v127
    v_lshl_add_u32 v124, v120, 10, v121
    s_lshl_b32 s38, s21, 7
    v_mul_u32_u24 v120, 1040, v120
    s_add_u32 s36, s38, 91136
    v_add3_u32 v120, v120, v121, s36
    s_mul_i32 s36, s21, 5184
    s_add_u32 s36, s36, 49664
    v_add_u32 v121, s36, v121
    v_mul_u32_u24 v122, 144, v123
    v_add_u32 v122, v122, v121
    v_lshrrev_b32 v123, 3, v123
    v_mul_u32_u24 v123, 144, v123
    v_add_u32 v121, v123, v121
    s_lshl_b32 s36, s21, 11
    v_add_u32 v123, s36, v126
    s_barrier
    s_mov_b32 s36, 0
    buffer_load_dwordx4 v[0:3], v126, s[12:15], s36 offen offset:0
    buffer_load_dwordx4 v[4:7], v126, s[12:15], s36 offen offset:1024
    buffer_load_dwordx4 v[8:11], v126, s[12:15], s36 offen offset:2048
    buffer_load_dwordx4 v[12:15], v126, s[12:15], s36 offen offset:3072
    s_mov_b32 s36, 4096
    buffer_load_dwordx4 v[16:19], v126, s[12:15], s36 offen offset:0
    buffer_load_dwordx4 v[20:23], v126, s[12:15], s36 offen offset:1024
    buffer_load_dwordx4 v[24:27], v126, s[12:15], s36 offen offset:2048
    buffer_load_dwordx4 v[28:31], v126, s[12:15], s36 offen offset:3072
    s_mov_b32 s36, 8192
    buffer_load_dwordx4 v[32:35], v126, s[12:15], s36 offen offset:0
    buffer_load_dwordx4 v[36:39], v126, s[12:15], s36 offen offset:1024
    buffer_load_dwordx4 v[40:43], v126, s[12:15], s36 offen offset:2048
    buffer_load_dwordx4 v[44:47], v126, s[12:15], s36 offen offset:3072
    s_mov_b32 s36, 12288
    buffer_load_dwordx4 v[48:51], v126, s[12:15], s36 offen offset:0
    buffer_load_dwordx4 v[52:55], v126, s[12:15], s36 offen offset:1024
    buffer_load_dwordx4 v[56:59], v126, s[12:15], s36 offen offset:2048
    buffer_load_dwordx4 v[60:63], v126, s[12:15], s36 offen offset:3072
    v_mov_b32 v64, 99456
    v_mov_b32 v65, 1
    s_mov_b64 exec, 1
    ds_add_u32 v64, v65 offset:4
    s_mov_b64 exec, -1
L_joint_kernel_tw:
    ds_read_b32 v65, v64 offset:0
    s_waitcnt lgkmcnt(0)
    v_readfirstlane_b32 s37, v65
    s_cmp_ge_u32 s37, 8
    s_cbranch_scc1 L_joint_kernel_tw_d
    s_sleep 1
    s_branch L_joint_kernel_tw
L_joint_kernel_tw_d:
    ds_read_b128 v[80:83], v125 offset:32768
    ds_read_b128 v[84:87], v125 offset:41216
    ds_read_b128 v[88:91], v125 offset:32832
    ds_read_b128 v[92:95], v125 offset:41280
    ds_read_b128 v[96:99], v125 offset:32896
    ds_read_b128 v[100:103], v125 offset:41344
    ds_read_b128 v[104:107], v125 offset:32960
    ds_read_b128 v[108:111], v125 offset:41408
    s_setprio 0
    s_waitcnt vmcnt(14) lgkmcnt(7)
    v_mfma_f32_16x16x32_bf16 v[64:67], v[0:3], v[80:83], 0
    v_mfma_f32_16x16x32_bf16 v[68:71], v[4:7], v[80:83], 0
    ds_read_b128 v[80:83], v125 offset:33024
    s_waitcnt lgkmcnt(7)
    v_mfma_f32_16x16x32_bf16 v[72:75], v[0:3], v[84:87], 0
    v_mfma_f32_16x16x32_bf16 v[76:79], v[4:7], v[84:87], 0
    ds_read_b128 v[84:87], v125 offset:41472
    s_waitcnt vmcnt(12) lgkmcnt(7)
    v_mfma_f32_16x16x32_bf16 v[64:67], v[8:11], v[88:91], v[64:67]
    v_mfma_f32_16x16x32_bf16 v[68:71], v[12:15], v[88:91], v[68:71]
    ds_read_b128 v[88:91], v125 offset:33088
    s_waitcnt lgkmcnt(7)
    v_mfma_f32_16x16x32_bf16 v[72:75], v[8:11], v[92:95], v[72:75]
    v_mfma_f32_16x16x32_bf16 v[76:79], v[12:15], v[92:95], v[76:79]
    ds_read_b128 v[92:95], v125 offset:41536
    s_waitcnt vmcnt(10) lgkmcnt(7)
    v_mfma_f32_16x16x32_bf16 v[64:67], v[16:19], v[96:99], v[64:67]
    v_mfma_f32_16x16x32_bf16 v[68:71], v[20:23], v[96:99], v[68:71]
    ds_read_b128 v[96:99], v125 offset:33152
    s_waitcnt lgkmcnt(7)
    v_mfma_f32_16x16x32_bf16 v[72:75], v[16:19], v[100:103], v[72:75]
    v_mfma_f32_16x16x32_bf16 v[76:79], v[20:23], v[100:103], v[76:79]
    ds_read_b128 v[100:103], v125 offset:41600
    s_waitcnt vmcnt(8) lgkmcnt(7)
    v_mfma_f32_16x16x32_bf16 v[64:67], v[24:27], v[104:107], v[64:67]
    v_mfma_f32_16x16x32_bf16 v[68:71], v[28:31], v[104:107], v[68:71]
    ds_read_b128 v[104:107], v125 offset:33216
    s_waitcnt lgkmcnt(7)
    v_mfma_f32_16x16x32_bf16 v[72:75], v[24:27], v[108:111], v[72:75]
    v_mfma_f32_16x16x32_bf16 v[76:79], v[28:31], v[108:111], v[76:79]
    ds_read_b128 v[108:111], v125 offset:41664
    s_waitcnt vmcnt(6) lgkmcnt(7)
    v_mfma_f32_16x16x32_bf16 v[64:67], v[32:35], v[80:83], v[64:67]
    v_mfma_f32_16x16x32_bf16 v[68:71], v[36:39], v[80:83], v[68:71]
    ds_read_b128 v[112:115], v120 offset:0
    s_waitcnt lgkmcnt(7)
    v_mfma_f32_16x16x32_bf16 v[72:75], v[32:35], v[84:87], v[72:75]
    v_mfma_f32_16x16x32_bf16 v[76:79], v[36:39], v[84:87], v[76:79]
    ds_read_b128 v[116:119], v120 offset:16
    s_waitcnt vmcnt(4) lgkmcnt(7)
    v_mfma_f32_16x16x32_bf16 v[64:67], v[40:43], v[88:91], v[64:67]
    v_mfma_f32_16x16x32_bf16 v[68:71], v[44:47], v[88:91], v[68:71]
    s_waitcnt lgkmcnt(6)
    v_mfma_f32_16x16x32_bf16 v[72:75], v[40:43], v[92:95], v[72:75]
    v_mfma_f32_16x16x32_bf16 v[76:79], v[44:47], v[92:95], v[76:79]
    s_waitcnt vmcnt(2) lgkmcnt(5)
    v_mfma_f32_16x16x32_bf16 v[64:67], v[48:51], v[96:99], v[64:67]
    v_mfma_f32_16x16x32_bf16 v[68:71], v[52:55], v[96:99], v[68:71]
    s_waitcnt lgkmcnt(4)
    v_mfma_f32_16x16x32_bf16 v[72:75], v[48:51], v[100:103], v[72:75]
    v_mfma_f32_16x16x32_bf16 v[76:79], v[52:55], v[100:103], v[76:79]
    s_waitcnt vmcnt(0) lgkmcnt(3)
    v_mfma_f32_16x16x32_bf16 v[64:67], v[56:59], v[104:107], v[64:67]
    v_mfma_f32_16x16x32_bf16 v[68:71], v[60:63], v[104:107], v[68:71]
    s_waitcnt lgkmcnt(2)
    v_mfma_f32_16x16x32_bf16 v[72:75], v[56:59], v[108:111], v[72:75]
    v_mfma_f32_16x16x32_bf16 v[76:79], v[60:63], v[108:111], v[76:79]
    s_mov_b32 s46, 0xffff0000
    s_mov_b32 s48, 0x4038aa3b
    s_mov_b32 s49, s48
    s_nop 3
    v_mov_b32 v28, 0
    s_waitcnt lgkmcnt(0)
    v_cvt_pk_bf16_f32 v24, v64, v68
    v_cvt_pk_bf16_f32 v25, v65, v69
    v_cvt_pk_bf16_f32 v26, v66, v70
    v_cvt_pk_bf16_f32 v27, v67, v71
    v_lshlrev_b32 v80, 16, v24
    v_and_b32 v81, s46, v24
    v_lshlrev_b32 v82, 16, v25
    v_and_b32 v83, s46, v25
    v_lshlrev_b32 v84, 16, v26
    v_and_b32 v85, s46, v26
    v_lshlrev_b32 v86, 16, v27
    v_and_b32 v87, s46, v27
    v_pk_mul_f32 v[80:81], v[80:81], s[48:49]
    v_pk_mul_f32 v[82:83], v[82:83], s[48:49]
    v_pk_mul_f32 v[84:85], v[84:85], s[48:49]
    v_pk_mul_f32 v[86:87], v[86:87], s[48:49]
    v_exp_f32 v96, v80
    v_exp_f32 v97, v81
    v_exp_f32 v98, v82
    v_exp_f32 v99, v83
    v_max3_f32 v28, |v80|, |v81|, v28
    v_max3_f32 v28, |v82|, |v83|, v28
    ds_write_b128 v122, v[96:99] offset:0
    v_exp_f32 v100, v84
    v_exp_f32 v101, v85
    v_exp_f32 v102, v86
    v_exp_f32 v103, v87
    v_max3_f32 v28, |v84|, |v85|, v28
    v_max3_f32 v28, |v86|, |v87|, v28
    ds_write_b128 v122, v[100:103] offset:16
    v_cvt_pk_bf16_f32 v24, v72, v76
    v_cvt_pk_bf16_f32 v25, v73, v77
    v_cvt_pk_bf16_f32 v26, v74, v78
    v_cvt_pk_bf16_f32 v27, v75, v79
    v_lshlrev_b32 v88, 16, v24
    v_and_b32 v89, s46, v24
    v_lshlrev_b32 v90, 16, v25
    v_and_b32 v91, s46, v25
    v_lshlrev_b32 v92, 16, v26
    v_and_b32 v93, s46, v26
    v_lshlrev_b32 v94, 16, v27
    v_and_b32 v95, s46, v27
    v_pk_mul_f32 v[88:89], v[88:89], s[48:49]
    v_pk_mul_f32 v[90:91], v[90:91], s[48:49]
    v_pk_mul_f32 v[92:93], v[92:93], s[48:49]
    v_pk_mul_f32 v[94:95], v[94:95], s[48:49]
    v_exp_f32 v104, v88
    v_exp_f32 v105, v89
    v_exp_f32 v106, v90
    v_exp_f32 v107, v91
    v_max3_f32 v28, |v88|, |v89|, v28
    v_max3_f32 v28, |v90|, |v91|, v28
    ds_write_b128 v122, v[104:107] offset:2304
    v_exp_f32 v108, v92
    v_exp_f32 v109, v93
    v_exp_f32 v110, v94
    v_exp_f32 v111, v95
    v_max3_f32 v28, |v92|, |v93|, v28
    v_max3_f32 v28, |v94|, |v95|, v28
    ds_write_b128 v122, v[108:111] offset:2320
    v_cmp_lt_f32 vcc, 0x42f00000, v28
    s_mov_b32 s22, 4
    s_or_b32 s44, s44, vcc_lo
    s_or_b32 s44, s44, vcc_hi
    s_cmp_lg_u32 s44, 0
    s_cbranch_scc1 L_joint_kernel_tslow
    ds_read_b128 v[32:35], v121 offset:0
    ds_read_b128 v[36:39], v121 offset:16
    ds_read_b128 v[40:43], v121 offset:288
    ds_read_b128 v[44:47], v121 offset:304
    v_add_u32 v121, 576, v121
    s_waitcnt vmcnt(0) lgkmcnt(0)
L_joint_kernel_tloop1:
    v_fma_f32 v48, v112, v32, 1.0
    v_fma_f32 v49, v113, v33, 1.0
    v_fma_f32 v50, v114, v34, 1.0
    v_fma_f32 v51, v115, v35, 1.0
    v_fma_f32 v52, v116, v36, 1.0
    v_fma_f32 v53, v117, v37, 1.0
    v_fma_f32 v54, v118, v38, 1.0
    v_fma_f32 v55, v119, v39, 1.0
    v_fma_f32 v56, v112, v40, 1.0
    v_fma_f32 v57, v113, v41, 1.0
    v_fma_f32 v58, v114, v42, 1.0
    v_fma_f32 v59, v115, v43, 1.0
    v_fma_f32 v60, v116, v44, 1.0
    v_fma_f32 v61, v117, v45, 1.0
    v_fma_f32 v62, v118, v46, 1.0
    v_fma_f32 v63, v119, v47, 1.0
    ds_read_b128 v[32:35], v121 offset:0
    ds_read_b128 v[36:39], v121 offset:16
    ds_read_b128 v[40:43], v121 offset:288
    ds_read_b128 v[44:47], v121 offset:304
    v_add_u32 v121, 576, v121
    v_rcp_f32 v48, v48
    v_rcp_f32 v49, v49
    v_rcp_f32 v50, v50
    v_rcp_f32 v51, v51
    v_rcp_f32 v52, v52
    v_rcp_f32 v53, v53
    v_rcp_f32 v54, v54
    v_rcp_f32 v55, v55
    v_fma_f32 v48, v48, -2.0, 1.0
    v_fma_f32 v49, v49, -2.0, 1.0
    v_fma_f32 v50, v50, -2.0, 1.0
    v_fma_f32 v51, v51, -2.0, 1.0
    v_fma_f32 v52, v52, -2.0, 1.0
    v_fma_f32 v53, v53, -2.0, 1.0
    v_fma_f32 v54, v54, -2.0, 1.0
    v_fma_f32 v55, v55, -2.0, 1.0
    v_cvt_pk_bf16_f32 v64, v48, v49
    v_cvt_pk_bf16_f32 v65, v50, v51
    v_cvt_pk_bf16_f32 v66, v52, v53
    v_cvt_pk_bf16_f32 v67, v54, v55
    ds_write_b128 v123, v[64:67] offset:0
    v_rcp_f32 v56, v56
    v_rcp_f32 v57, v57
    v_rcp_f32 v58, v58
    v_rcp_f32 v59, v59
    v_rcp_f32 v60, v60
    v_rcp_f32 v61, v61
    v_rcp_f32 v62, v62
    v_rcp_f32 v63, v63
    v_fma_f32 v56, v56, -2.0, 1.0
    v_fma_f32 v57, v57, -2.0, 1.0
    v_fma_f32 v58, v58, -2.0, 1.0
    v_fma_f32 v59, v59, -2.0, 1.0
    v_fma_f32 v60, v60, -2.0, 1.0
    v_fma_f32 v61, v61, -2.0, 1.0
    v_fma_f32 v62, v62, -2.0, 1.0
    v_fma_f32 v63, v63, -2.0, 1.0
    v_cvt_pk_bf16_f32 v68, v56, v57
    v_cvt_pk_bf16_f32 v69, v58, v59
    v_cvt_pk_bf16_f32 v70, v60, v61
    v_cvt_pk_bf16_f32 v71, v62, v63
    ds_write_b128 v123, v[68:71] offset:1024
    s_waitcnt lgkmcnt(0)
    s_barrier
    v_fma_f32 v48, v112, v32, 1.0
    v_fma_f32 v49, v113, v33, 1.0
    v_fma_f32 v50, v114, v34, 1.0
    v_fma_f32 v51, v115, v35, 1.0
    v_fma_f32 v52, v116, v36, 1.0
    v_fma_f32 v53, v117, v37, 1.0
    v_fma_f32 v54, v118, v38, 1.0
    v_fma_f32 v55, v119, v39, 1.0
    v_fma_f32 v56, v112, v40, 1.0
    v_fma_f32 v57, v113, v41, 1.0
    v_fma_f32 v58, v114, v42, 1.0
    v_fma_f32 v59, v115, v43, 1.0
    v_fma_f32 v60, v116, v44, 1.0
    v_fma_f32 v61, v117, v45, 1.0
    v_fma_f32 v62, v118, v46, 1.0
    v_fma_f32 v63, v119, v47, 1.0
    ds_read_b128 v[32:35], v121 offset:0
    ds_read_b128 v[36:39], v121 offset:16
    ds_read_b128 v[40:43], v121 offset:288
    ds_read_b128 v[44:47], v121 offset:304
    v_add_u32 v121, 576, v121
    v_rcp_f32 v48, v48
    v_rcp_f32 v49, v49
    v_rcp_f32 v50, v50
    v_rcp_f32 v51, v51
    v_rcp_f32 v52, v52
    v_rcp_f32 v53, v53
    v_rcp_f32 v54, v54
    v_rcp_f32 v55, v55
    v_fma_f32 v48, v48, -2.0, 1.0
    v_fma_f32 v49, v49, -2.0, 1.0
    v_fma_f32 v50, v50, -2.0, 1.0
    v_fma_f32 v51, v51, -2.0, 1.0
    v_fma_f32 v52, v52, -2.0, 1.0
    v_fma_f32 v53, v53, -2.0, 1.0
    v_fma_f32 v54, v54, -2.0, 1.0
    v_fma_f32 v55, v55, -2.0, 1.0
    v_cvt_pk_bf16_f32 v64, v48, v49
    v_cvt_pk_bf16_f32 v65, v50, v51
    v_cvt_pk_bf16_f32 v66, v52, v53
    v_cvt_pk_bf16_f32 v67, v54, v55
    ds_write_b128 v123, v[64:67] offset:16384
    v_rcp_f32 v56, v56
    v_rcp_f32 v57, v57
    v_rcp_f32 v58, v58
    v_rcp_f32 v59, v59
    v_rcp_f32 v60, v60
    v_rcp_f32 v61, v61
    v_rcp_f32 v62, v62
    v_rcp_f32 v63, v63
    v_fma_f32 v56, v56, -2.0, 1.0
    v_fma_f32 v57, v57, -2.0, 1.0
    v_fma_f32 v58, v58, -2.0, 1.0
    v_fma_f32 v59, v59, -2.0, 1.0
    v_fma_f32 v60, v60, -2.0, 1.0
    v_fma_f32 v61, v61, -2.0, 1.0
    v_fma_f32 v62, v62, -2.0, 1.0
    v_fma_f32 v63, v63, -2.0, 1.0
    v_cvt_pk_bf16_f32 v68, v56, v57
    v_cvt_pk_bf16_f32 v69, v58, v59
    v_cvt_pk_bf16_f32 v70, v60, v61
    v_cvt_pk_bf16_f32 v71, v62, v63
    ds_write_b128 v123, v[68:71] offset:17408
    s_waitcnt lgkmcnt(0)
    s_barrier
    s_sub_u32 s22, s22, 1
    s_cmp_lg_u32 s22, 0
    s_cbranch_scc1 L_joint_kernel_tloop1
    s_endpgm
L_joint_kernel_tslow:
    buffer_load_dwordx4 v[112:115], v124, s[40:43], s38 offen offset:0
    buffer_load_dwordx4 v[116:119], v124, s[40:43], s38 offen offset:16
    ds_write_b128 v122, v[80:83] offset:0
    ds_write_b128 v122, v[84:87] offset:16
    ds_write_b128 v122, v[88:91] offset:2304
    ds_write_b128 v122, v[92:95] offset:2320
    ds_read_b128 v[32:35], v121 offset:0
    ds_read_b128 v[36:39], v121 offset:16
    ds_read_b128 v[40:43], v121 offset:288
    ds_read_b128 v[44:47], v121 offset:304
    v_add_u32 v121, 576, v121
    s_waitcnt vmcnt(0) lgkmcnt(0)
L_joint_kernel_tloop0:
    v_add_f32 v48, v112, v32
    v_add_f32 v49, v113, v33
    v_add_f32 v50, v114, v34
    v_add_f32 v51, v115, v35
    v_add_f32 v52, v116, v36
    v_add_f32 v53, v117, v37
    v_add_f32 v54, v118, v38
    v_add_f32 v55, v119, v39
    v_add_f32 v56, v112, v40
    v_add_f32 v57, v113, v41
    v_add_f32 v58, v114, v42
    v_add_f32 v59, v115, v43
    v_add_f32 v60, v116, v44
    v_add_f32 v61, v117, v45
    v_add_f32 v62, v118, v46
    v_add_f32 v63, v119, v47
    ds_read_b128 v[32:35], v121 offset:0
    ds_read_b128 v[36:39], v121 offset:16
    ds_read_b128 v[40:43], v121 offset:288
    ds_read_b128 v[44:47], v121 offset:304
    v_add_u32 v121, 576, v121
    v_exp_f32 v48, v48
    v_exp_f32 v49, v49
    v_exp_f32 v50, v50
    v_exp_f32 v51, v51
    v_exp_f32 v52, v52
    v_exp_f32 v53, v53
    v_exp_f32 v54, v54
    v_exp_f32 v55, v55
    v_add_f32 v48, 1.0, v48
    v_add_f32 v49, 1.0, v49
    v_add_f32 v50, 1.0, v50
    v_add_f32 v51, 1.0, v51
    v_add_f32 v52, 1.0, v52
    v_add_f32 v53, 1.0, v53
    v_add_f32 v54, 1.0, v54
    v_add_f32 v55, 1.0, v55
    v_rcp_f32 v48, v48
    v_rcp_f32 v49, v49
    v_rcp_f32 v50, v50
    v_rcp_f32 v51, v51
    v_rcp_f32 v52, v52
    v_rcp_f32 v53, v53
    v_rcp_f32 v54, v54
    v_rcp_f32 v55, v55
    v_fma_f32 v48, v48, -2.0, 1.0
    v_fma_f32 v49, v49, -2.0, 1.0
    v_fma_f32 v50, v50, -2.0, 1.0
    v_fma_f32 v51, v51, -2.0, 1.0
    v_fma_f32 v52, v52, -2.0, 1.0
    v_fma_f32 v53, v53, -2.0, 1.0
    v_fma_f32 v54, v54, -2.0, 1.0
    v_fma_f32 v55, v55, -2.0, 1.0
    v_cvt_pk_bf16_f32 v64, v48, v49
    v_cvt_pk_bf16_f32 v65, v50, v51
    v_cvt_pk_bf16_f32 v66, v52, v53
    v_cvt_pk_bf16_f32 v67, v54, v55
    ds_write_b128 v123, v[64:67] offset:0
    v_exp_f32 v56, v56
    v_exp_f32 v57, v57
    v_exp_f32 v58, v58
    v_exp_f32 v59, v59
    v_exp_f32 v60, v60
    v_exp_f32 v61, v61
    v_exp_f32 v62, v62
    v_exp_f32 v63, v63
    v_add_f32 v56, 1.0, v56
    v_add_f32 v57, 1.0, v57
    v_add_f32 v58, 1.0, v58
    v_add_f32 v59, 1.0, v59
    v_add_f32 v60, 1.0, v60
    v_add_f32 v61, 1.0, v61
    v_add_f32 v62, 1.0, v62
    v_add_f32 v63, 1.0, v63
    v_rcp_f32 v56, v56
    v_rcp_f32 v57, v57
    v_rcp_f32 v58, v58
    v_rcp_f32 v59, v59
    v_rcp_f32 v60, v60
    v_rcp_f32 v61, v61
    v_rcp_f32 v62, v62
    v_rcp_f32 v63, v63
    v_fma_f32 v56, v56, -2.0, 1.0
    v_fma_f32 v57, v57, -2.0, 1.0
    v_fma_f32 v58, v58, -2.0, 1.0
    v_fma_f32 v59, v59, -2.0, 1.0
    v_fma_f32 v60, v60, -2.0, 1.0
    v_fma_f32 v61, v61, -2.0, 1.0
    v_fma_f32 v62, v62, -2.0, 1.0
    v_fma_f32 v63, v63, -2.0, 1.0
    v_cvt_pk_bf16_f32 v68, v56, v57
    v_cvt_pk_bf16_f32 v69, v58, v59
    v_cvt_pk_bf16_f32 v70, v60, v61
    v_cvt_pk_bf16_f32 v71, v62, v63
    ds_write_b128 v123, v[68:71] offset:1024
    s_waitcnt lgkmcnt(0)
    s_barrier
    v_add_f32 v48, v112, v32
    v_add_f32 v49, v113, v33
    v_add_f32 v50, v114, v34
    v_add_f32 v51, v115, v35
    v_add_f32 v52, v116, v36
    v_add_f32 v53, v117, v37
    v_add_f32 v54, v118, v38
    v_add_f32 v55, v119, v39
    v_add_f32 v56, v112, v40
    v_add_f32 v57, v113, v41
    v_add_f32 v58, v114, v42
    v_add_f32 v59, v115, v43
    v_add_f32 v60, v116, v44
    v_add_f32 v61, v117, v45
    v_add_f32 v62, v118, v46
    v_add_f32 v63, v119, v47
    ds_read_b128 v[32:35], v121 offset:0
    ds_read_b128 v[36:39], v121 offset:16
    ds_read_b128 v[40:43], v121 offset:288
    ds_read_b128 v[44:47], v121 offset:304
    v_add_u32 v121, 576, v121
    v_exp_f32 v48, v48
    v_exp_f32 v49, v49
    v_exp_f32 v50, v50
    v_exp_f32 v51, v51
    v_exp_f32 v52, v52
    v_exp_f32 v53, v53
    v_exp_f32 v54, v54
    v_exp_f32 v55, v55
    v_add_f32 v48, 1.0, v48
    v_add_f32 v49, 1.0, v49
    v_add_f32 v50, 1.0, v50
    v_add_f32 v51, 1.0, v51
    v_add_f32 v52, 1.0, v52
    v_add_f32 v53, 1.0, v53
    v_add_f32 v54, 1.0, v54
    v_add_f32 v55, 1.0, v55
    v_rcp_f32 v48, v48
    v_rcp_f32 v49, v49
    v_rcp_f32 v50, v50
    v_rcp_f32 v51, v51
    v_rcp_f32 v52, v52
    v_rcp_f32 v53, v53
    v_rcp_f32 v54, v54
    v_rcp_f32 v55, v55
    v_fma_f32 v48, v48, -2.0, 1.0
    v_fma_f32 v49, v49, -2.0, 1.0
    v_fma_f32 v50, v50, -2.0, 1.0
    v_fma_f32 v51, v51, -2.0, 1.0
    v_fma_f32 v52, v52, -2.0, 1.0
    v_fma_f32 v53, v53, -2.0, 1.0
    v_fma_f32 v54, v54, -2.0, 1.0
    v_fma_f32 v55, v55, -2.0, 1.0
    v_cvt_pk_bf16_f32 v64, v48, v49
    v_cvt_pk_bf16_f32 v65, v50, v51
    v_cvt_pk_bf16_f32 v66, v52, v53
    v_cvt_pk_bf16_f32 v67, v54, v55
    ds_write_b128 v123, v[64:67] offset:16384
    v_exp_f32 v56, v56
    v_exp_f32 v57, v57
    v_exp_f32 v58, v58
    v_exp_f32 v59, v59
    v_exp_f32 v60, v60
    v_exp_f32 v61, v61
    v_exp_f32 v62, v62
    v_exp_f32 v63, v63
    v_add_f32 v56, 1.0, v56
    v_add_f32 v57, 1.0, v57
    v_add_f32 v58, 1.0, v58
    v_add_f32 v59, 1.0, v59
    v_add_f32 v60, 1.0, v60
    v_add_f32 v61, 1.0, v61
    v_add_f32 v62, 1.0, v62
    v_add_f32 v63, 1.0, v63
    v_rcp_f32 v56, v56
    v_rcp_f32 v57, v57
    v_rcp_f32 v58, v58
    v_rcp_f32 v59, v59
    v_rcp_f32 v60, v60
    v_rcp_f32 v61, v61
    v_rcp_f32 v62, v62
    v_rcp_f32 v63, v63
    v_fma_f32 v56, v56, -2.0, 1.0
    v_fma_f32 v57, v57, -2.0, 1.0
    v_fma_f32 v58, v58, -2.0, 1.0
    v_fma_f32 v59, v59, -2.0, 1.0
    v_fma_f32 v60, v60, -2.0, 1.0
    v_fma_f32 v61, v61, -2.0, 1.0
    v_fma_f32 v62, v62, -2.0, 1.0
    v_fma_f32 v63, v63, -2.0, 1.0
    v_cvt_pk_bf16_f32 v68, v56, v57
    v_cvt_pk_bf16_f32 v69, v58, v59
    v_cvt_pk_bf16_f32 v70, v60, v61
    v_cvt_pk_bf16_f32 v71, v62, v63
    ds_write_b128 v123, v[68:71] offset:17408
    s_waitcnt lgkmcnt(0)
    s_barrier
    s_sub_u32 s22, s22, 1
    s_cmp_lg_u32 s22, 0
    s_cbranch_scc1 L_joint_kernel_tloop0
L_joint_kernel_fin:
L_joint_kernel_done:
    s_endpgm
.section .rodata,"a"
.p2align 6
.amdhsa_kernel prep_kernel
  .amdhsa_next_free_vgpr 128
  .amdhsa_next_free_sgpr 102
  .amdhsa_accum_offset 128
  .amdhsa_group_segment_fixed_size 0
  .amdhsa_kernarg_size 80
  .amdhsa_user_sgpr_count 2
  .amdhsa_user_sgpr_kernarg_segment_ptr 1
  .amdhsa_system_sgpr_workgroup_id_x 1
.end_amdhsa_kernel
.p2align 6
.amdhsa_kernel conv1_kernel
  .amdhsa_next_free_vgpr 128
  .amdhsa_next_free_sgpr 102
  .amdhsa_accum_offset 128
  .amdhsa_group_segment_fixed_size 0
  .amdhsa_kernarg_size 80
  .amdhsa_user_sgpr_count 2
  .amdhsa_user_sgpr_kernarg_segment_ptr 1
  .amdhsa_system_sgpr_workgroup_id_x 1
.end_amdhsa_kernel
.p2align 6
.amdhsa_kernel conv2_kernel
  .amdhsa_next_free_vgpr 128
  .amdhsa_next_free_sgpr 102
  .amdhsa_accum_offset 128
  .amdhsa_group_segment_fixed_size 0
  .amdhsa_kernarg_size 80
  .amdhsa_user_sgpr_count 2
  .amdhsa_user_sgpr_kernarg_segment_ptr 1
  .amdhsa_system_sgpr_workgroup_id_x 1
.end_amdhsa_kernel
.p2align 6
.amdhsa_kernel joint_kernel
  .amdhsa_next_free_vgpr 128
  .amdhsa_next_free_sgpr 102
  .amdhsa_accum_offset 128
  .amdhsa_group_segment_fixed_size 0
  .amdhsa_kernarg_size 80
  .amdhsa_user_sgpr_count 2
  .amdhsa_user_sgpr_kernarg_segment_ptr 1
  .amdhsa_system_sgpr_workgroup_id_x 1
.end_amdhsa_kernel
```

```asm
; @launch kernel=prep_kernel grid=(256,1,1) block=(384,1,1) lds=4096
; @launch kernel=conv1_kernel grid=(256,1,1) block=(1024,1,1) lds=162816
; @launch kernel=conv2_kernel grid=(256,1,1) block=(1024,1,1) lds=162816
; @launch kernel=joint_kernel grid=(250,1,1) block=(1024,1,1) lds=99472
.amdgcn_target "amdgcn-amd-amdhsa--gfx950"
.text
.globl prep_kernel
.p2align 8
.type prep_kernel,@function
prep_kernel:
    s_cmp_ge_u32 s2, 256
    s_cbranch_scc1 L_prep_kernel_done
    s_mov_b32 s3, s2
    s_load_dwordx16 s[44:59], s[0:1], 0
    s_load_dwordx2 s[30:31], s[0:1], 72
    v_readfirstlane_b32 s40, v0
    s_lshr_b32 s40, s40, 6
    v_and_b32 v1, 63, v0
    s_cmp_lt_u32 s40, 4
    s_cbranch_scc1 L_prep_kernel_w
    s_cmp_lt_u32 s2, 24
    s_cbranch_scc1 L_prep_kernel_sh
    s_endpgm
L_prep_kernel_sh:
    s_lshr_b32 s41, s2, 3
    s_and_b32 s42, s2, 7
    s_sub_u32 s43, s40, 4
    s_lshl_b32 s26, s43, 16
    s_lshl_b32 s5, s42, 6
    s_add_u32 s26, s26, s5
    s_mov_b32 s10, 131072
    s_mov_b32 s11, 0x00020000
    v_lshrrev_b32 v2, 4, v1
    v_lshlrev_b32 v2, 12, v2
    v_and_b32 v3, 15, v1
    v_lshl_add_u32 v2, v3, 2, v2
    v_mov_b32 v9, 0
    ds_write_b32 v9, v9 offset:2048
    s_waitcnt lgkmcnt(0)
    s_cmp_eq_u32 s41, 1
    s_cselect_b32 s8, s56, s52
    s_cselect_b32 s9, s57, s53
    s_cmp_eq_u32 s41, 2
    s_cselect_b32 s8, s54, s8
    s_cselect_b32 s9, s55, s9
    s_barrier
    s_cmp_lg_u32 s41, 2
    s_cbranch_scc1 L_prep_kernel_nog
    s_mov_b32 s16, s50
    s_mov_b32 s17, s51
    s_mov_b32 s18, 8192
    s_mov_b32 s19, 0x00020000
    v_and_b32 v6, 0x30, v1
    v_lshl_add_u32 v6, v3, 9, v6
    s_lshl_b32 s6, s43, 8
    buffer_load_dwordx4 v[80:83], v6, s[16:19], s6 offen offset:0
    buffer_load_dwordx4 v[84:87], v6, s[16:19], s6 offen offset:64
    buffer_load_dwordx4 v[88:91], v6, s[16:19], s6 offen offset:128
    buffer_load_dwordx4 v[92:95], v6, s[16:19], s6 offen offset:192
L_prep_kernel_nog:
    buffer_load_dword v16, v2, s[8:11], s26 offen offset:0
    buffer_load_dword v17, v2, s[8:11], s26 offen offset:512
    buffer_load_dword v18, v2, s[8:11], s26 offen offset:1024
    buffer_load_dword v19, v2, s[8:11], s26 offen offset:1536
    buffer_load_dword v20, v2, s[8:11], s26 offen offset:2048
    buffer_load_dword v21, v2, s[8:11], s26 offen offset:2560
    buffer_load_dword v22, v2, s[8:11], s26 offen offset:3072
    buffer_load_dword v23, v2, s[8:11], s26 offen offset:3584
    s_add_u32 s26, s26, 16384
    buffer_load_dword v24, v2, s[8:11], s26 offen offset:0
    buffer_load_dword v25, v2, s[8:11], s26 offen offset:512
    buffer_load_dword v26, v2, s[8:11], s26 offen offset:1024
    buffer_load_dword v27, v2, s[8:11], s26 offen offset:1536
    buffer_load_dword v28, v2, s[8:11], s26 offen offset:2048
    buffer_load_dword v29, v2, s[8:11], s26 offen offset:2560
    buffer_load_dword v30, v2, s[8:11], s26 offen offset:3072
    buffer_load_dword v31, v2, s[8:11], s26 offen offset:3584
    s_add_u32 s26, s26, 16384
    buffer_load_dword v32, v2, s[8:11], s26 offen offset:0
    buffer_load_dword v33, v2, s[8:11], s26 offen offset:512
    buffer_load_dword v34, v2, s[8:11], s26 offen offset:1024
    buffer_load_dword v35, v2, s[8:11], s26 offen offset:1536
    buffer_load_dword v36, v2, s[8:11], s26 offen offset:2048
    buffer_load_dword v37, v2, s[8:11], s26 offen offset:2560
    buffer_load_dword v38, v2, s[8:11], s26 offen offset:3072
    buffer_load_dword v39, v2, s[8:11], s26 offen offset:3584
    s_add_u32 s26, s26, 16384
    buffer_load_dword v40, v2, s[8:11], s26 offen offset:0
    buffer_load_dword v41, v2, s[8:11], s26 offen offset:512
    buffer_load_dword v42, v2, s[8:11], s26 offen offset:1024
    buffer_load_dword v43, v2, s[8:11], s26 offen offset:1536
    buffer_load_dword v44, v2, s[8:11], s26 offen offset:2048
    buffer_load_dword v45, v2, s[8:11], s26 offen offset:2560
    buffer_load_dword v46, v2, s[8:11], s26 offen offset:3072
    buffer_load_dword v47, v2, s[8:11], s26 offen offset:3584
    s_branch L_prep_kernel_small
L_prep_kernel_w:
    s_lshl_b32 s21, s2, 2
    s_add_u32 s20, s40, s21
    s_load_dwordx2 s[8:9], s[0:1], 8
    s_lshr_b32 s22, s20, 8
    s_bfe_u32 s23, s20, 0x40004
    s_bfe_u32 s24, s20, 0x30001
    s_and_b32 s21, s20, 1
    v_lshrrev_b32 v5, 4, v1
    v_lshlrev_b32 v2, 11, v5
    v_and_b32 v3, 15, v1
    v_lshl_add_u32 v2, v3, 2, v2
    s_lshl_b32 s26, s22, 3
    s_lshr_b32 s27, s23, 3
    s_add_u32 s26, s26, s27
    s_lshl_b32 s26, s26, 17
    s_and_b32 s27, s23, 7
    s_lshl_b32 s27, s27, 1
    s_add_u32 s27, s27, s21
    s_lshl_b32 s27, s27, 13
    s_add_u32 s26, s26, s27
    s_lshl_b32 s27, s24, 6
    s_add_u32 s26, s26, s27
    s_mov_b32 s10, 4063232
    s_mov_b32 s11, 0x00020000
    s_add_u32 s37, s26, 262144
    s_add_u32 s38, s26, 524288
    s_add_u32 s39, s26, 786432
    s_mov_b32 s14, 7340032
    s_mov_b32 s15, 0x00020000
    v_lshrrev_b32 v4, 1, v5
    v_lshlrev_b32 v4, 8, v4
    v_lshl_add_u32 v4, v3, 4, v4
    v_and_b32 v5, 1, v5
    v_lshl_add_u32 v4, v5, 10, v4
    s_lshl_b32 s27, s24, 4
    s_add_u32 s27, s27, s23
    s_mul_i32 s27, s27, 57344
    s_lshl_b32 s28, s22, 11
    s_add_u32 s27, s27, s28
    s_lshl_b32 s28, s21, 9
    s_add_u32 s27, s27, s28
    s_mov_b32 s32, 0x05040100
    s_mov_b32 s33, 0x07060302
    s_mov_b32 s34, 0xffff0000
    s_mov_b32 s35, 0x3d2aaaab
    s_mov_b32 s40, 0x3c638e39
    s_waitcnt lgkmcnt(0)
    buffer_load_dword v16, v2, s[8:11], s26 offen offset:0
    buffer_load_dword v17, v2, s[8:11], s26 offen offset:512
    buffer_load_dword v20, v2, s[8:11], s37 offen offset:0
    buffer_load_dword v21, v2, s[8:11], s37 offen offset:512
    buffer_load_dword v24, v2, s[8:11], s38 offen offset:0
    buffer_load_dword v25, v2, s[8:11], s38 offen offset:512
    buffer_load_dword v28, v2, s[8:11], s39 offen offset:0
    buffer_load_dword v29, v2, s[8:11], s39 offen offset:512
    buffer_load_dword v18, v2, s[8:11], s26 offen offset:1024
    buffer_load_dword v19, v2, s[8:11], s26 offen offset:1536
    buffer_load_dword v22, v2, s[8:11], s37 offen offset:1024
    buffer_load_dword v23, v2, s[8:11], s37 offen offset:1536
    buffer_load_dword v26, v2, s[8:11], s38 offen offset:1024
    buffer_load_dword v27, v2, s[8:11], s38 offen offset:1536
    buffer_load_dword v30, v2, s[8:11], s39 offen offset:1024
    buffer_load_dword v31, v2, s[8:11], s39 offen offset:1536
    s_cmp_ge_u32 s2, 24
    s_cbranch_scc1 L_prep_kernel_nb
    s_barrier
L_prep_kernel_nb:
    s_add_u32 s12, s30, 0
    s_addc_u32 s13, s31, 0
    s_waitcnt vmcnt(8)
    v_perm_b32 v100, v17, v16, s32
    v_perm_b32 v76, v29, v28, s32
    v_lshlrev_b32 v104, 16, v28
    v_lshlrev_b32 v112, 16, v29
    v_lshlrev_b32 v105, 16, v24
    v_lshlrev_b32 v113, 16, v25
    v_lshlrev_b32 v106, 16, v20
    v_lshlrev_b32 v114, 16, v21
    v_lshlrev_b32 v107, 16, v16
    v_lshlrev_b32 v115, 16, v17
    v_add_f32 v108, v104, v106
    v_add_f32 v116, v112, v114
    v_add_f32 v109, v105, v107
    v_add_f32 v117, v113, v115
    v_fma_f32 v110, v106, 4.0, v104
    v_fma_f32 v118, v114, 4.0, v112
    v_fma_f32 v111, v107, 4.0, v105
    v_fma_f32 v119, v115, 4.0, v113
    v_add_f32 v105, v108, v109
    v_add_f32 v113, v116, v117
    v_sub_f32 v106, v108, v109
    v_sub_f32 v114, v116, v117
    v_fma_f32 v107, v111, 2.0, v110
    v_fma_f32 v115, v119, 2.0, v118
    v_fma_f32 v110, v111, -2.0, v110
    v_fma_f32 v118, v119, -2.0, v118
    v_fmamk_f32 v108, v104, 0x41700000, v110
    v_fmamk_f32 v116, v112, 0x41700000, v118
    v_fmamk_f32 v108, v109, 0x41200000, v108
    v_fmamk_f32 v116, v117, 0x41200000, v116
    v_mul_f32 v105, 0.5, v105
    v_mul_f32 v113, 0.5, v113
    v_mul_f32 v106, 0.5, v106
    v_mul_f32 v114, 0.5, v114
    v_mul_f32 v107, s35, v107
    v_mul_f32 v115, s35, v115
    v_mul_f32 v110, s35, v110
    v_mul_f32 v118, s35, v118
    v_mul_f32 v108, s40, v108
    v_mul_f32 v116, s40, v116
    v_cvt_pk_bf16_f32 v80, v105, v113
    v_cvt_pk_bf16_f32 v84, v106, v114
    v_cvt_pk_bf16_f32 v88, v107, v115
    v_cvt_pk_bf16_f32 v92, v110, v118
    v_cvt_pk_bf16_f32 v96, v108, v116
    v_perm_b32 v102, v17, v16, s33
    v_perm_b32 v78, v29, v28, s33
    v_and_b32 v104, s34, v28
    v_and_b32 v112, s34, v29
    v_and_b32 v105, s34, v24
    v_and_b32 v113, s34, v25
    v_and_b32 v106, s34, v20
    v_and_b32 v114, s34, v21
    v_and_b32 v107, s34, v16
    v_and_b32 v115, s34, v17
    v_add_f32 v108, v104, v106
    v_add_f32 v116, v112, v114
    v_add_f32 v109, v105, v107
    v_add_f32 v117, v113, v115
    v_fma_f32 v110, v106, 4.0, v104
    v_fma_f32 v118, v114, 4.0, v112
    v_fma_f32 v111, v107, 4.0, v105
    v_fma_f32 v119, v115, 4.0, v113
    v_add_f32 v105, v108, v109
    v_add_f32 v113, v116, v117
    v_sub_f32 v106, v108, v109
    v_sub_f32 v114, v116, v117
    v_fma_f32 v107, v111, 2.0, v110
    v_fma_f32 v115, v119, 2.0, v118
    v_fma_f32 v110, v111, -2.0, v110
    v_fma_f32 v118, v119, -2.0, v118
    v_fmamk_f32 v108, v104, 0x41700000, v110
    v_fmamk_f32 v116, v112, 0x41700000, v118
    v_fmamk_f32 v108, v109, 0x41200000, v108
    v_fmamk_f32 v116, v117, 0x41200000, v116
    v_mul_f32 v105, 0.5, v105
    v_mul_f32 v113, 0.5, v113
    v_mul_f32 v106, 0.5, v106
    v_mul_f32 v114, 0.5, v114
    v_mul_f32 v107, s35, v107
    v_mul_f32 v115, s35, v115
    v_mul_f32 v110, s35, v110
    v_mul_f32 v118, s35, v118
    v_mul_f32 v108, s40, v108
    v_mul_f32 v116, s40, v116
    v_cvt_pk_bf16_f32 v82, v105, v113
    v_cvt_pk_bf16_f32 v86, v106, v114
    v_cvt_pk_bf16_f32 v90, v107, v115
    v_cvt_pk_bf16_f32 v94, v110, v118
    v_cvt_pk_bf16_f32 v98, v108, v116
    s_waitcnt vmcnt(0)
    s_cmp_lt_u32 s3, 224
    s_cbranch_scc1 L_prep_kernel_ncw
    s_getpc_b64 s[62:63]
L_prep_kernel_pc:
    s_and_b32 s64, s3, 8
    s_lshl_b32 s64, s64, 12
    v_lshlrev_b32 v120, 7, v0
    v_add_u32 v120, s64, v120
    v_min_u32 v120, L_joint_kernel_done-L_prep_kernel_pc, v120
    v_mov_b32 v121, s63
    v_add_co_u32 v120, vcc, s62, v120
    s_nop 1
    v_addc_co_u32 v121, vcc, 0, v121, vcc
    global_load_dword v122, v[120:121], off
L_prep_kernel_ncw:
    v_perm_b32 v101, v19, v18, s32
    v_perm_b32 v77, v31, v30, s32
    v_lshlrev_b32 v104, 16, v30
    v_lshlrev_b32 v112, 16, v31
    v_lshlrev_b32 v105, 16, v26
    v_lshlrev_b32 v113, 16, v27
    v_lshlrev_b32 v106, 16, v22
    v_lshlrev_b32 v114, 16, v23
    v_lshlrev_b32 v107, 16, v18
    v_lshlrev_b32 v115, 16, v19
    v_add_f32 v108, v104, v106
    v_add_f32 v116, v112, v114
    v_add_f32 v109, v105, v107
    v_add_f32 v117, v113, v115
    v_fma_f32 v110, v106, 4.0, v104
    v_fma_f32 v118, v114, 4.0, v112
    v_fma_f32 v111, v107, 4.0, v105
    v_fma_f32 v119, v115, 4.0, v113
    v_add_f32 v105, v108, v109
    v_add_f32 v113, v116, v117
    v_sub_f32 v106, v108, v109
    v_sub_f32 v114, v116, v117
    v_fma_f32 v107, v111, 2.0, v110
    v_fma_f32 v115, v119, 2.0, v118
    v_fma_f32 v110, v111, -2.0, v110
    v_fma_f32 v118, v119, -2.0, v118
    v_fmamk_f32 v108, v104, 0x41700000, v110
    v_fmamk_f32 v116, v112, 0x41700000, v118
    v_fmamk_f32 v108, v109, 0x41200000, v108
    v_fmamk_f32 v116, v117, 0x41200000, v116
    v_mul_f32 v105, 0.5, v105
    v_mul_f32 v113, 0.5, v113
    v_mul_f32 v106, 0.5, v106
    v_mul_f32 v114, 0.5, v114
    v_mul_f32 v107, s35, v107
    v_mul_f32 v115, s35, v115
    v_mul_f32 v110, s35, v110
    v_mul_f32 v118, s35, v118
    v_mul_f32 v108, s40, v108
    v_mul_f32 v116, s40, v116
    v_cvt_pk_bf16_f32 v81, v105, v113
    v_cvt_pk_bf16_f32 v85, v106, v114
    v_cvt_pk_bf16_f32 v89, v107, v115
    v_cvt_pk_bf16_f32 v93, v110, v118
    v_cvt_pk_bf16_f32 v97, v108, v116
    v_perm_b32 v103, v19, v18, s33
    v_perm_b32 v79, v31, v30, s33
    v_and_b32 v104, s34, v30
    v_and_b32 v112, s34, v31
    v_and_b32 v105, s34, v26
    v_and_b32 v113, s34, v27
    v_and_b32 v106, s34, v22
    v_and_b32 v114, s34, v23
    v_and_b32 v107, s34, v18
    v_and_b32 v115, s34, v19
    v_add_f32 v108, v104, v106
    v_add_f32 v116, v112, v114
    v_add_f32 v109, v105, v107
    v_add_f32 v117, v113, v115
    v_fma_f32 v110, v106, 4.0, v104
    v_fma_f32 v118, v114, 4.0, v112
    v_fma_f32 v111, v107, 4.0, v105
    v_fma_f32 v119, v115, 4.0, v113
    v_add_f32 v105, v108, v109
    v_add_f32 v113, v116, v117
    v_sub_f32 v106, v108, v109
    v_sub_f32 v114, v116, v117
    v_fma_f32 v107, v111, 2.0, v110
    v_fma_f32 v115, v119, 2.0, v118
    v_fma_f32 v110, v111, -2.0, v110
    v_fma_f32 v118, v119, -2.0, v118
    v_fmamk_f32 v108, v104, 0x41700000, v110
    v_fmamk_f32 v116, v112, 0x41700000, v118
    v_fmamk_f32 v108, v109, 0x41200000, v108
    v_fmamk_f32 v116, v117, 0x41200000, v116
    v_mul_f32 v105, 0.5, v105
    v_mul_f32 v113, 0.5, v113
    v_mul_f32 v106, 0.5, v106
    v_mul_f32 v114, 0.5, v114
    v_mul_f32 v107, s35, v107
    v_mul_f32 v115, s35, v115
    v_mul_f32 v110, s35, v110
    v_mul_f32 v118, s35, v118
    v_mul_f32 v108, s40, v108
    v_mul_f32 v116, s40, v116
    v_cvt_pk_bf16_f32 v83, v105, v113
    v_cvt_pk_bf16_f32 v87, v106, v114
    v_cvt_pk_bf16_f32 v91, v107, v115
    v_cvt_pk_bf16_f32 v95, v110, v118
    v_cvt_pk_bf16_f32 v99, v108, v116
    v_permlane16_swap_b32 v100, v102
    v_permlane16_swap_b32 v101, v103
    s_add_u32 s28, s27, 49152
    buffer_store_dwordx4 v[100:103], v4, s[12:15], s28 offen sc1
    v_permlane16_swap_b32 v76, v78
    v_permlane16_swap_b32 v77, v79
    s_add_u32 s28, s27, 0
    buffer_store_dwordx4 v[76:79], v4, s[12:15], s28 offen sc1
    v_permlane16_swap_b32 v80, v82
    v_permlane16_swap_b32 v81, v83
    s_add_u32 s28, s27, 8192
    buffer_store_dwordx4 v[80:83], v4, s[12:15], s28 offen sc1
    v_permlane16_swap_b32 v84, v86
    v_permlane16_swap_b32 v85, v87
    s_add_u32 s28, s27, 16384
    buffer_store_dwordx4 v[84:87], v4, s[12:15], s28 offen sc1
    v_permlane16_swap_b32 v88, v90
    v_permlane16_swap_b32 v89, v91
    s_add_u32 s28, s27, 24576
    buffer_store_dwordx4 v[88:91], v4, s[12:15], s28 offen sc1
    v_permlane16_swap_b32 v92, v94
    v_permlane16_swap_b32 v93, v95
    s_add_u32 s28, s27, 32768
    buffer_store_dwordx4 v[92:95], v4, s[12:15], s28 offen sc1
    v_permlane16_swap_b32 v96, v98
    v_permlane16_swap_b32 v97, v99
    s_add_u32 s28, s27, 40960
    buffer_store_dwordx4 v[96:99], v4, s[12:15], s28 offen sc1
L_prep_kernel_done:
    s_endpgm
L_prep_kernel_small:
    v_lshrrev_b32 v2, 4, v1
    s_lshl_b32 s24, s41, 17
    s_add_u32 s24, s24, 44040192
    s_add_u32 s12, s30, s24
    s_addc_u32 s13, s31, 0
    s_mov_b32 s14, 131072
    s_mov_b32 s15, 0x00020000
    s_mov_b32 s32, 0x05040100
    s_mov_b32 s33, 0x07060302
    v_lshlrev_b32 v4, 4, v1
    s_lshl_b32 s24, s42, 14
    s_lshl_b32 s25, s43, 13
    s_add_u32 s24, s24, s25
    s_add_u32 s25, s24, 4096
    s_waitcnt vmcnt(0)
    v_perm_b32 v48, v17, v16, s32
    v_perm_b32 v49, v19, v18, s32
    v_perm_b32 v50, v21, v20, s32
    v_perm_b32 v51, v23, v22, s32
    v_perm_b32 v52, v17, v16, s33
    v_perm_b32 v53, v19, v18, s33
    v_perm_b32 v54, v21, v20, s33
    v_perm_b32 v55, v23, v22, s33
    v_perm_b32 v56, v25, v24, s32
    v_perm_b32 v57, v27, v26, s32
    v_perm_b32 v58, v29, v28, s32
    v_perm_b32 v59, v31, v30, s32
    v_perm_b32 v60, v25, v24, s33
    v_perm_b32 v61, v27, v26, s33
    v_perm_b32 v62, v29, v28, s33
    v_perm_b32 v63, v31, v30, s33
    v_perm_b32 v64, v33, v32, s32
    v_perm_b32 v65, v35, v34, s32
    v_perm_b32 v66, v37, v36, s32
    v_perm_b32 v67, v39, v38, s32
    v_perm_b32 v68, v33, v32, s33
    v_perm_b32 v69, v35, v34, s33
    v_perm_b32 v70, v37, v36, s33
    v_perm_b32 v71, v39, v38, s33
    v_perm_b32 v72, v41, v40, s32
    v_perm_b32 v73, v43, v42, s32
    v_perm_b32 v74, v45, v44, s32
    v_perm_b32 v75, v47, v46, s32
    v_perm_b32 v76, v41, v40, s33
    v_perm_b32 v77, v43, v42, s33
    v_perm_b32 v78, v45, v44, s33
    v_perm_b32 v79, v47, v46, s33
    s_cmp_eq_u32 s41, 2
    s_cbranch_scc1 L_prep_kernel_ge
    buffer_store_dwordx4 v[48:51], v4, s[12:15], s24 offen offset:0 sc1
    buffer_store_dwordx4 v[52:55], v4, s[12:15], s24 offen offset:1024 sc1
    buffer_store_dwordx4 v[56:59], v4, s[12:15], s24 offen offset:2048 sc1
    buffer_store_dwordx4 v[60:63], v4, s[12:15], s24 offen offset:3072 sc1
    buffer_store_dwordx4 v[64:67], v4, s[12:15], s25 offen offset:0 sc1
    buffer_store_dwordx4 v[68:71], v4, s[12:15], s25 offen offset:1024 sc1
    buffer_store_dwordx4 v[72:75], v4, s[12:15], s25 offen offset:2048 sc1
    buffer_store_dwordx4 v[76:79], v4, s[12:15], s25 offen offset:3072 sc1
    s_endpgm
L_prep_kernel_ge:
    v_mfma_f32_16x16x32_bf16 v[96:99], v[48:51], v[80:83], 0
    v_mfma_f32_16x16x32_bf16 v[100:103], v[52:55], v[80:83], 0
    v_mfma_f32_16x16x32_bf16 v[96:99], v[56:59], v[84:87], v[96:99]
    v_mfma_f32_16x16x32_bf16 v[100:103], v[60:63], v[84:87], v[100:103]
    v_mfma_f32_16x16x32_bf16 v[96:99], v[64:67], v[88:91], v[96:99]
    v_mfma_f32_16x16x32_bf16 v[100:103], v[68:71], v[88:91], v[100:103]
    v_mfma_f32_16x16x32_bf16 v[96:99], v[72:75], v[92:95], v[96:99]
    v_mfma_f32_16x16x32_bf16 v[100:103], v[76:79], v[92:95], v[100:103]
    v_mov_b32 v7, v4
    v_mov_b32 v10, 1
    s_nop 0
    s_mov_b32 s14, 16384
    v_lshlrev_b32 v8, 10, v3
    v_lshl_add_u32 v8, v2, 5, v8
    s_lshl_b32 s24, s42, 7
    s_mov_b32 s34, 0xffff0000
    s_mov_b32 s35, 0x4038aa3b
    s_cmp_eq_u32 s43, 0
    s_cbranch_scc1 L_prep_kernel_ge0
    ds_write_b128 v7, v[96:99]
    ds_write_b128 v7, v[100:103] offset:1024
    ds_write_b32 v9, v10 offset:2048
    s_endpgm
L_prep_kernel_ge0:
    ds_read_b32 v10, v9 offset:2048
    s_waitcnt lgkmcnt(0)
    v_readfirstlane_b32 s27, v10
    s_cmp_eq_u32 s27, 0
    s_cbranch_scc1 L_prep_kernel_ge0
    ds_read_b128 v[16:19], v7
    ds_read_b128 v[20:23], v7 offset:1024
    s_waitcnt lgkmcnt(0)
    v_add_f32 v16, v16, v96
    v_add_f32 v17, v17, v97
    v_add_f32 v18, v18, v98
    v_add_f32 v19, v19, v99
    v_add_f32 v20, v20, v100
    v_add_f32 v21, v21, v101
    v_add_f32 v22, v22, v102
    v_add_f32 v23, v23, v103
    v_cvt_pk_bf16_f32 v48, v16, v20
    v_cvt_pk_bf16_f32 v49, v17, v21
    v_cvt_pk_bf16_f32 v50, v18, v22
    v_cvt_pk_bf16_f32 v51, v19, v23
    v_lshlrev_b32 v56, 16, v48
    v_and_b32 v57, s34, v48
    v_lshlrev_b32 v58, 16, v49
    v_and_b32 v59, s34, v49
    v_lshlrev_b32 v60, 16, v50
    v_and_b32 v61, s34, v50
    v_lshlrev_b32 v62, 16, v51
    v_and_b32 v63, s34, v51
    v_mul_f32 v56, s35, v56
    v_mul_f32 v57, s35, v57
    v_mul_f32 v58, s35, v58
    v_mul_f32 v59, s35, v59
    v_mul_f32 v60, s35, v60
    v_mul_f32 v61, s35, v61
    v_mul_f32 v62, s35, v62
    v_mul_f32 v63, s35, v63
    buffer_store_dwordx4 v[56:59], v8, s[12:15], s24 offen sc1
    buffer_store_dwordx4 v[60:63], v8, s[12:15], s24 offen offset:16 sc1
    v_exp_f32 v64, v56
    v_exp_f32 v65, v57
    v_exp_f32 v66, v58
    v_exp_f32 v67, v59
    v_exp_f32 v68, v60
    v_exp_f32 v69, v61
    v_exp_f32 v70, v62
    v_exp_f32 v71, v63
    v_max3_f32 v72, |v56|, |v57|, |v58|
    v_max3_f32 v72, |v59|, |v60|, v72
    v_max3_f32 v72, |v61|, |v62|, v72
    v_max_f32 v72, |v63|, v72
    s_add_u32 s12, s12, 16384
    s_addc_u32 s13, s13, 0
    v_cmp_lt_f32 vcc, 0x42f00000, v72
    buffer_store_dwordx4 v[64:67], v8, s[12:15], s24 offen sc1
    buffer_store_dwordx4 v[68:71], v8, s[12:15], s24 offen offset:16 sc1
    s_add_u32 s12, s12, 16384
    s_addc_u32 s13, s13, 0
    s_or_b32 s26, vcc_lo, vcc_hi
    s_lshl_b32 s24, s42, 2
    v_mov_b32 v73, s26
    v_mov_b32 v74, 0
    buffer_store_dword v73, v74, s[12:15], s24 offen sc1
L_prep_kernel_last:
    s_endpgm
.globl conv1_kernel
.p2align 8
.type conv1_kernel,@function
conv1_kernel:
    s_cmp_ge_u32 s2, 256
    s_cbranch_scc1 L_conv1_kernel_done
    s_load_dwordx2 s[4:5], s[0:1], 0
    s_load_dwordx2 s[30:31], s[0:1], 72
    v_readfirstlane_b32 s20, v0
    s_lshr_b32 s20, s20, 6
    s_xor_b32 s20, s20, 8
    s_and_b32 s36, s2, 0
    s_lshl_b32 s36, s36, 3
    s_bfe_u32 s37, s2, 196611
    s_or_b32 s29, s36, s37
    s_bfe_u32 s36, s2, 196608
    s_lshl_b32 s36, s36, 2
    s_lshr_b32 s37, s2, 6
    s_or_b32 s36, s36, s37
    s_mov_b32 s33, 0
    s_and_b32 s34, s36, 15
    s_lshr_b32 s35, s36, 4
    s_mul_i32 s21, s34, 500
    s_and_b32 s32, s20, 3
    v_and_b32 v127, 63, v0
    v_lshrrev_b32 v5, 2, v127
    v_and_b32 v6, 3, v127
    s_and_b32 s42, s20, 7
    v_lshlrev_b32 v7, 15, v5
    v_lshl_add_u32 v7, v6, 4, v7
    s_lshl_b32 s41, s21, 10
    s_sub_u32 s41, s41, 7680
    s_lshl_b32 s37, s42, 12
    s_add_u32 s37, s37, s41
    v_add_u32 v7, s37, v7
    s_mul_i32 s36, s35, 8192000
    s_mov_b32 s10, 8192000
    s_mov_b32 s11, 0x00020000
    s_mov_b32 s25, 0xffff0000
    s_mov_b32 s47, s36
    s_cmp_ge_u32 s20, 8
    s_cbranch_scc0 L_conv1_kernel_mw
L_conv1_kernel_helper:
    s_setprio 3
    v_add_u32 v92, 0, v7
    v_add_u32 v93, 1024, v7
    v_add_u32 v94, 2048, v7
    v_add_u32 v95, 3072, v7
    v_and_b32 v76, 4, v5
    v_lshrrev_b32 v76, 1, v76
    v_xor_b32 v76, v6, v76
    v_lshlrev_b32 v76, 4, v76
    v_lshl_add_u32 v76, v5, 6, v76
    s_mov_b32 s24, 0
    s_mov_b32 s27, 524288
    s_waitcnt lgkmcnt(0)
    s_add_u32 s8, s4, s47
    s_addc_u32 s9, s5, 0
    buffer_load_dwordx4 v[0:3], v92, s[8:11], s24 offen offset:0
    buffer_load_dwordx4 v[16:19], v92, s[8:11], s24 offen offset:64
    v_add_u32 v92, 128, v92
    buffer_load_dwordx4 v[4:7], v93, s[8:11], s24 offen offset:0
    buffer_load_dwordx4 v[20:23], v93, s[8:11], s24 offen offset:64
    v_add_u32 v93, 128, v93
    buffer_load_dwordx4 v[8:11], v94, s[8:11], s24 offen offset:0
    buffer_load_dwordx4 v[24:27], v94, s[8:11], s24 offen offset:64
    v_add_u32 v94, 128, v94
    buffer_load_dwordx4 v[12:15], v95, s[8:11], s24 offen offset:0
    buffer_load_dwordx4 v[28:31], v95, s[8:11], s24 offen offset:64
    v_add_u32 v95, 128, v95
    s_mul_i32 s36, s42, 1024
    v_add_u32 v96, s36, v76
    v_add_u32 v97, 65536, v96
    s_mul_i32 s36, s42, 1088
    s_add_u32 s36, s36, 98304
    v_add_u32 v98, s36, v76
    s_waitcnt vmcnt(0)
    s_mov_b32 s28, 0
    s_mov_b32 s22, 4
    ds_write_b128 v96, v[0:3] offset:0
    ds_write_b128 v98, v[12:15] offset:0
    v_lshlrev_b32 v76, 16, v0
    v_and_b32 v84, s25, v0
    v_lshlrev_b32 v77, 16, v4
    v_and_b32 v85, s25, v4
    v_lshlrev_b32 v78, 16, v8
    v_and_b32 v86, s25, v8
    v_lshlrev_b32 v79, 16, v12
    v_and_b32 v87, s25, v12
    v_add_f32 v80, v76, v78
    v_add_f32 v88, v84, v86
    v_add_f32 v81, v77, v79
    v_add_f32 v89, v85, v87
    v_fma_f32 v82, v78, 4.0, v76
    v_fma_f32 v90, v86, 4.0, v84
    v_fma_f32 v83, v79, 4.0, v77
    v_fma_f32 v91, v87, 4.0, v85
    v_add_f32 v77, v80, v81
    v_add_f32 v85, v88, v89
    v_sub_f32 v78, v80, v81
    v_sub_f32 v86, v88, v89
    v_fma_f32 v79, v83, 2.0, v82
    v_fma_f32 v87, v91, 2.0, v90
    v_fma_f32 v82, v83, -2.0, v82
    v_fma_f32 v90, v91, -2.0, v90
    v_fmamk_f32 v80, v76, 0x41700000, v82
    v_fmamk_f32 v88, v84, 0x41700000, v90
    v_fmamk_f32 v80, v81, 0x41200000, v80
    v_fmamk_f32 v88, v89, 0x41200000, v88
    v_cvt_pk_bf16_f32 v4, v77, v85
    v_cvt_pk_bf16_f32 v8, v78, v86
    v_cvt_pk_bf16_f32 v64, v79, v87
    v_cvt_pk_bf16_f32 v68, v82, v90
    v_cvt_pk_bf16_f32 v72, v80, v88
    v_lshlrev_b32 v76, 16, v1
    v_and_b32 v84, s25, v1
    v_lshlrev_b32 v77, 16, v5
    v_and_b32 v85, s25, v5
    v_lshlrev_b32 v78, 16, v9
    v_and_b32 v86, s25, v9
    v_lshlrev_b32 v79, 16, v13
    v_and_b32 v87, s25, v13
    v_add_f32 v80, v76, v78
    v_add_f32 v88, v84, v86
    v_add_f32 v81, v77, v79
    v_add_f32 v89, v85, v87
    v_fma_f32 v82, v78, 4.0, v76
    v_fma_f32 v90, v86, 4.0, v84
    v_fma_f32 v83, v79, 4.0, v77
    v_fma_f32 v91, v87, 4.0, v85
    v_add_f32 v77, v80, v81
    v_add_f32 v85, v88, v89
    v_sub_f32 v78, v80, v81
    v_sub_f32 v86, v88, v89
    v_fma_f32 v79, v83, 2.0, v82
    v_fma_f32 v87, v91, 2.0, v90
    v_fma_f32 v82, v83, -2.0, v82
    v_fma_f32 v90, v91, -2.0, v90
    v_fmamk_f32 v80, v76, 0x41700000, v82
    v_fmamk_f32 v88, v84, 0x41700000, v90
    v_fmamk_f32 v80, v81, 0x41200000, v80
    v_fmamk_f32 v88, v89, 0x41200000, v88
    v_cvt_pk_bf16_f32 v5, v77, v85
    v_cvt_pk_bf16_f32 v9, v78, v86
    v_cvt_pk_bf16_f32 v65, v79, v87
    v_cvt_pk_bf16_f32 v69, v82, v90
    v_cvt_pk_bf16_f32 v73, v80, v88
    v_lshlrev_b32 v76, 16, v2
    v_and_b32 v84, s25, v2
    v_lshlrev_b32 v77, 16, v6
    v_and_b32 v85, s25, v6
    v_lshlrev_b32 v78, 16, v10
    v_and_b32 v86, s25, v10
    v_lshlrev_b32 v79, 16, v14
    v_and_b32 v87, s25, v14
    v_add_f32 v80, v76, v78
    v_add_f32 v88, v84, v86
    v_add_f32 v81, v77, v79
    v_add_f32 v89, v85, v87
    v_fma_f32 v82, v78, 4.0, v76
    v_fma_f32 v90, v86, 4.0, v84
    v_fma_f32 v83, v79, 4.0, v77
    v_fma_f32 v91, v87, 4.0, v85
    v_add_f32 v77, v80, v81
    v_add_f32 v85, v88, v89
    v_sub_f32 v78, v80, v81
    v_sub_f32 v86, v88, v89
    v_fma_f32 v79, v83, 2.0, v82
    v_fma_f32 v87, v91, 2.0, v90
    v_fma_f32 v82, v83, -2.0, v82
    v_fma_f32 v90, v91, -2.0, v90
    v_fmamk_f32 v80, v76, 0x41700000, v82
    v_fmamk_f32 v88, v84, 0x41700000, v90
    v_fmamk_f32 v80, v81, 0x41200000, v80
    v_fmamk_f32 v88, v89, 0x41200000, v88
    v_cvt_pk_bf16_f32 v6, v77, v85
    v_cvt_pk_bf16_f32 v10, v78, v86
    v_cvt_pk_bf16_f32 v66, v79, v87
    v_cvt_pk_bf16_f32 v70, v82, v90
    v_cvt_pk_bf16_f32 v74, v80, v88
    v_lshlrev_b32 v76, 16, v3
    v_and_b32 v84, s25, v3
    v_lshlrev_b32 v77, 16, v7
    v_and_b32 v85, s25, v7
    v_lshlrev_b32 v78, 16, v11
    v_and_b32 v86, s25, v11
    v_lshlrev_b32 v79, 16, v15
    v_and_b32 v87, s25, v15
    v_add_f32 v80, v76, v78
    v_add_f32 v88, v84, v86
    v_add_f32 v81, v77, v79
    v_add_f32 v89, v85, v87
    v_fma_f32 v82, v78, 4.0, v76
    v_fma_f32 v90, v86, 4.0, v84
    v_fma_f32 v83, v79, 4.0, v77
    v_fma_f32 v91, v87, 4.0, v85
    v_add_f32 v77, v80, v81
    v_add_f32 v85, v88, v89
    v_sub_f32 v78, v80, v81
    v_sub_f32 v86, v88, v89
    v_fma_f32 v79, v83, 2.0, v82
    v_fma_f32 v87, v91, 2.0, v90
    v_fma_f32 v82, v83, -2.0, v82
    v_fma_f32 v90, v91, -2.0, v90
    v_fmamk_f32 v80, v76, 0x41700000, v82
    v_fmamk_f32 v88, v84, 0x41700000, v90
    v_fmamk_f32 v80, v81, 0x41200000, v80
    v_fmamk_f32 v88, v89, 0x41200000, v88
    v_cvt_pk_bf16_f32 v7, v77, v85
    v_cvt_pk_bf16_f32 v11, v78, v86
    v_cvt_pk_bf16_f32 v67, v79, v87
    v_cvt_pk_bf16_f32 v71, v82, v90
    v_cvt_pk_bf16_f32 v75, v80, v88
    ds_write_b128 v96, v[64:67] offset:49152
    ds_write_b128 v97, v[68:71] offset:0
    ds_write_b128 v97, v[72:75] offset:16384
    ds_write_b128 v96, v[4:7] offset:16384
    ds_write_b128 v96, v[8:11] offset:32768
    s_cmp_ge_u32 s20, 12
    s_cbranch_scc1 L_conv1_kernel_h2
    s_waitcnt lgkmcnt(0)
    s_barrier
    buffer_load_dwordx4 v[32:35], v92, s[8:11], s24 offen offset:0
    buffer_load_dwordx4 v[48:51], v92, s[8:11], s24 offen offset:64
    v_add_u32 v92, 128, v92
    buffer_load_dwordx4 v[36:39], v93, s[8:11], s24 offen offset:0
    buffer_load_dwordx4 v[52:55], v93, s[8:11], s24 offen offset:64
    v_add_u32 v93, 128, v93
    s_setprio 1
L_conv1_kernel_hloop1:
    s_cmp_lt_u32 s28, 13
    s_nop 0
    s_cselect_b32 s24, 0, 2130706432
    v_lshlrev_b32 v76, 16, v16
    v_and_b32 v84, s25, v16
    v_lshlrev_b32 v77, 16, v20
    v_and_b32 v85, s25, v20
    v_lshlrev_b32 v78, 16, v24
    v_and_b32 v86, s25, v24
    v_lshlrev_b32 v79, 16, v28
    v_and_b32 v87, s25, v28
    v_add_f32 v80, v76, v78
    v_add_f32 v88, v84, v86
    v_add_f32 v81, v77, v79
    v_add_f32 v89, v85, v87
    v_fma_f32 v82, v78, 4.0, v76
    v_fma_f32 v90, v86, 4.0, v84
    v_fma_f32 v83, v79, 4.0, v77
    v_fma_f32 v91, v87, 4.0, v85
    v_add_f32 v77, v80, v81
    v_add_f32 v85, v88, v89
    v_sub_f32 v78, v80, v81
    v_sub_f32 v86, v88, v89
    v_fma_f32 v79, v83, 2.0, v82
    v_fma_f32 v87, v91, 2.0, v90
    v_fma_f32 v82, v83, -2.0, v82
    v_fma_f32 v90, v91, -2.0, v90
    v_fmamk_f32 v80, v76, 0x41700000, v82
    v_fmamk_f32 v88, v84, 0x41700000, v90
    buffer_load_dwordx4 v[40:43], v94, s[8:11], s24 offen offset:0
    buffer_load_dwordx4 v[56:59], v94, s[8:11], s24 offen offset:64
    v_add_u32 v94, 128, v94
    v_fmamk_f32 v80, v81, 0x41200000, v80
    v_fmamk_f32 v88, v89, 0x41200000, v88
    v_cvt_pk_bf16_f32 v20, v77, v85
    v_cvt_pk_bf16_f32 v24, v78, v86
    v_cvt_pk_bf16_f32 v64, v79, v87
    v_cvt_pk_bf16_f32 v68, v82, v90
    v_cvt_pk_bf16_f32 v72, v80, v88
    v_lshlrev_b32 v76, 16, v17
    v_and_b32 v84, s25, v17
    v_lshlrev_b32 v77, 16, v21
    v_and_b32 v85, s25, v21
    v_lshlrev_b32 v78, 16, v25
    v_and_b32 v86, s25, v25
    v_lshlrev_b32 v79, 16, v29
    v_and_b32 v87, s25, v29
    v_add_f32 v80, v76, v78
    v_add_f32 v88, v84, v86
    v_add_f32 v81, v77, v79
    v_add_f32 v89, v85, v87
    v_fma_f32 v82, v78, 4.0, v76
    v_fma_f32 v90, v86, 4.0, v84
    v_fma_f32 v83, v79, 4.0, v77
    v_fma_f32 v91, v87, 4.0, v85
    v_add_f32 v77, v80, v81
    v_add_f32 v85, v88, v89
    v_sub_f32 v78, v80, v81
    s_nop 0
    buffer_load_dwordx4 v[44:47], v95, s[8:11], s24 offen offset:0
    buffer_load_dwordx4 v[60:63], v95, s[8:11], s24 offen offset:64
    v_add_u32 v95, 128, v95
    v_sub_f32 v86, v88, v89
    s_nop 0
    v_fma_f32 v79, v83, 2.0, v82
    v_fma_f32 v87, v91, 2.0, v90
    v_fma_f32 v82, v83, -2.0, v82
    v_fma_f32 v90, v91, -2.0, v90
    v_fmamk_f32 v80, v76, 0x41700000, v82
    v_fmamk_f32 v88, v84, 0x41700000, v90
    v_fmamk_f32 v80, v81, 0x41200000, v80
    v_fmamk_f32 v88, v89, 0x41200000, v88
    v_cvt_pk_bf16_f32 v21, v77, v85
    v_cvt_pk_bf16_f32 v25, v78, v86
    v_cvt_pk_bf16_f32 v65, v79, v87
    v_cvt_pk_bf16_f32 v69, v82, v90
    v_cvt_pk_bf16_f32 v73, v80, v88
    v_lshlrev_b32 v76, 16, v18
    v_and_b32 v84, s25, v18
    v_lshlrev_b32 v77, 16, v22
    v_and_b32 v85, s25, v22
    v_lshlrev_b32 v78, 16, v26
    v_and_b32 v86, s25, v26
    v_lshlrev_b32 v79, 16, v30
    v_and_b32 v87, s25, v30
    v_add_f32 v80, v76, v78
    v_add_f32 v88, v84, v86
    v_add_f32 v81, v77, v79
    v_add_f32 v89, v85, v87
    v_fma_f32 v82, v78, 4.0, v76
    v_fma_f32 v90, v86, 4.0, v84
    v_fma_f32 v83, v79, 4.0, v77
    v_fma_f32 v91, v87, 4.0, v85
    v_add_f32 v77, v80, v81
    v_add_f32 v85, v88, v89
    v_sub_f32 v78, v80, v81
    v_sub_f32 v86, v88, v89
    v_fma_f32 v79, v83, 2.0, v82
    v_fma_f32 v87, v91, 2.0, v90
    v_fma_f32 v82, v83, -2.0, v82
    v_fma_f32 v90, v91, -2.0, v90
    v_fmamk_f32 v80, v76, 0x41700000, v82
    v_fmamk_f32 v88, v84, 0x41700000, v90
    v_fmamk_f32 v80, v81, 0x41200000, v80
    v_fmamk_f32 v88, v89, 0x41200000, v88
    v_cvt_pk_bf16_f32 v22, v77, v85
    v_cvt_pk_bf16_f32 v26, v78, v86
    v_cvt_pk_bf16_f32 v66, v79, v87
    v_cvt_pk_bf16_f32 v70, v82, v90
    v_cvt_pk_bf16_f32 v74, v80, v88
    v_lshlrev_b32 v76, 16, v19
    v_and_b32 v84, s25, v19
    v_lshlrev_b32 v77, 16, v23
    v_and_b32 v85, s25, v23
    v_lshlrev_b32 v78, 16, v27
    v_and_b32 v86, s25, v27
    v_lshlrev_b32 v79, 16, v31
    v_and_b32 v87, s25, v31
    v_add_f32 v80, v76, v78
    v_add_f32 v88, v84, v86
    v_add_f32 v81, v77, v79
    v_add_f32 v89, v85, v87
    v_fma_f32 v82, v78, 4.0, v76
    v_fma_f32 v90, v86, 4.0, v84
    v_fma_f32 v83, v79, 4.0, v77
    v_fma_f32 v91, v87, 4.0, v85
    v_add_f32 v77, v80, v81
    v_add_f32 v85, v88, v89
    v_sub_f32 v78, v80, v81
    v_sub_f32 v86, v88, v89
    v_fma_f32 v79, v83, 2.0, v82
    v_fma_f32 v87, v91, 2.0, v90
    v_fma_f32 v82, v83, -2.0, v82
    v_fma_f32 v90, v91, -2.0, v90
    v_fmamk_f32 v80, v76, 0x41700000, v82
    v_fmamk_f32 v88, v84, 0x41700000, v90
    v_fmamk_f32 v80, v81, 0x41200000, v80
    v_fmamk_f32 v88, v89, 0x41200000, v88
    v_cvt_pk_bf16_f32 v23, v77, v85
    v_cvt_pk_bf16_f32 v27, v78, v86
    v_cvt_pk_bf16_f32 v67, v79, v87
    v_cvt_pk_bf16_f32 v71, v82, v90
    v_cvt_pk_bf16_f32 v75, v80, v88
    ds_write_b128 v96, v[64:67] offset:57344
    ds_write_b128 v97, v[68:71] offset:8192
    ds_write_b128 v97, v[72:75] offset:24576
    ds_write_b128 v96, v[16:19] offset:8192
    ds_write_b128 v96, v[20:23] offset:24576
    ds_write_b128 v96, v[24:27] offset:40960
    ds_write_b128 v98, v[28:31] offset:8704
    s_add_u32 s28, s28, 1
    s_waitcnt lgkmcnt(0)
    s_barrier
    s_cmp_lt_u32 s28, 13
    s_cselect_b32 s24, 0, 2130706432
    s_waitcnt vmcnt(0)
    v_lshlrev_b32 v76, 16, v32
    v_and_b32 v84, s25, v32
    v_lshlrev_b32 v77, 16, v36
    v_and_b32 v85, s25, v36
    v_lshlrev_b32 v78, 16, v40
    v_and_b32 v86, s25, v40
    v_lshlrev_b32 v79, 16, v44
    v_and_b32 v87, s25, v44
    v_add_f32 v80, v76, v78
    v_add_f32 v88, v84, v86
    v_add_f32 v81, v77, v79
    v_add_f32 v89, v85, v87
    s_nop 0
    v_fma_f32 v82, v78, 4.0, v76
    v_fma_f32 v90, v86, 4.0, v84
    v_fma_f32 v83, v79, 4.0, v77
    v_fma_f32 v91, v87, 4.0, v85
    v_add_f32 v77, v80, v81
    v_add_f32 v85, v88, v89
    v_sub_f32 v78, v80, v81
    v_sub_f32 v86, v88, v89
    v_fma_f32 v79, v83, 2.0, v82
    v_fma_f32 v87, v91, 2.0, v90
    v_fma_f32 v82, v83, -2.0, v82
    v_fma_f32 v90, v91, -2.0, v90
    v_fmamk_f32 v80, v76, 0x41700000, v82
    v_fmamk_f32 v88, v84, 0x41700000, v90
    buffer_load_dwordx4 v[0:3], v92, s[8:11], s24 offen offset:0
    buffer_load_dwordx4 v[16:19], v92, s[8:11], s24 offen offset:64
    v_add_u32 v92, 128, v92
    v_fmamk_f32 v80, v81, 0x41200000, v80
    v_fmamk_f32 v88, v89, 0x41200000, v88
    v_cvt_pk_bf16_f32 v36, v77, v85
    v_cvt_pk_bf16_f32 v40, v78, v86
    v_cvt_pk_bf16_f32 v64, v79, v87
    v_cvt_pk_bf16_f32 v68, v82, v90
    v_cvt_pk_bf16_f32 v72, v80, v88
    v_lshlrev_b32 v76, 16, v33
    v_and_b32 v84, s25, v33
    v_lshlrev_b32 v77, 16, v37
    v_and_b32 v85, s25, v37
    v_lshlrev_b32 v78, 16, v41
    v_and_b32 v86, s25, v41
    v_lshlrev_b32 v79, 16, v45
    v_and_b32 v87, s25, v45
    v_add_f32 v80, v76, v78
    v_add_f32 v88, v84, v86
    v_add_f32 v81, v77, v79
    v_add_f32 v89, v85, v87
    v_fma_f32 v82, v78, 4.0, v76
    v_fma_f32 v90, v86, 4.0, v84
    v_fma_f32 v83, v79, 4.0, v77
    v_fma_f32 v91, v87, 4.0, v85
    v_add_f32 v77, v80, v81
    v_add_f32 v85, v88, v89
    v_sub_f32 v78, v80, v81
    s_nop 0
    buffer_load_dwordx4 v[4:7], v93, s[8:11], s24 offen offset:0
    buffer_load_dwordx4 v[20:23], v93, s[8:11], s24 offen offset:64
    v_add_u32 v93, 128, v93
    v_sub_f32 v86, v88, v89
    s_nop 0
    v_fma_f32 v79, v83, 2.0, v82
    v_fma_f32 v87, v91, 2.0, v90
    v_fma_f32 v82, v83, -2.0, v82
    v_fma_f32 v90, v91, -2.0, v90
    v_fmamk_f32 v80, v76, 0x41700000, v82
    v_fmamk_f32 v88, v84, 0x41700000, v90
    v_fmamk_f32 v80, v81, 0x41200000, v80
    v_fmamk_f32 v88, v89, 0x41200000, v88
    v_cvt_pk_bf16_f32 v37, v77, v85
    v_cvt_pk_bf16_f32 v41, v78, v86
    v_cvt_pk_bf16_f32 v65, v79, v87
    v_cvt_pk_bf16_f32 v69, v82, v90
    v_cvt_pk_bf16_f32 v73, v80, v88
    v_lshlrev_b32 v76, 16, v34
    v_and_b32 v84, s25, v34
    v_lshlrev_b32 v77, 16, v38
    v_and_b32 v85, s25, v38
    v_lshlrev_b32 v78, 16, v42
    v_and_b32 v86, s25, v42
    v_lshlrev_b32 v79, 16, v46
    v_and_b32 v87, s25, v46
    v_add_f32 v80, v76, v78
    v_add_f32 v88, v84, v86
    v_add_f32 v81, v77, v79
    v_add_f32 v89, v85, v87
    v_fma_f32 v82, v78, 4.0, v76
    v_fma_f32 v90, v86, 4.0, v84
    v_fma_f32 v83, v79, 4.0, v77
    v_fma_f32 v91, v87, 4.0, v85
    v_add_f32 v77, v80, v81
    v_add_f32 v85, v88, v89
    v_sub_f32 v78, v80, v81
    v_sub_f32 v86, v88, v89
    v_fma_f32 v79, v83, 2.0, v82
    v_fma_f32 v87, v91, 2.0, v90
    v_fma_f32 v82, v83, -2.0, v82
    v_fma_f32 v90, v91, -2.0, v90
    v_fmamk_f32 v80, v76, 0x41700000, v82
    v_fmamk_f32 v88, v84, 0x41700000, v90
    v_fmamk_f32 v80, v81, 0x41200000, v80
    v_fmamk_f32 v88, v89, 0x41200000, v88
    v_cvt_pk_bf16_f32 v38, v77, v85
    v_cvt_pk_bf16_f32 v42, v78, v86
    v_cvt_pk_bf16_f32 v66, v79, v87
    v_cvt_pk_bf16_f32 v70, v82, v90
    v_cvt_pk_bf16_f32 v74, v80, v88
    v_lshlrev_b32 v76, 16, v35
    v_and_b32 v84, s25, v35
    v_lshlrev_b32 v77, 16, v39
    v_and_b32 v85, s25, v39
    v_lshlrev_b32 v78, 16, v43
    v_and_b32 v86, s25, v43
    v_lshlrev_b32 v79, 16, v47
    v_and_b32 v87, s25, v47
    v_add_f32 v80, v76, v78
    v_add_f32 v88, v84, v86
    v_add_f32 v81, v77, v79
    v_add_f32 v89, v85, v87
    v_fma_f32 v82, v78, 4.0, v76
    v_fma_f32 v90, v86, 4.0, v84
    v_fma_f32 v83, v79, 4.0, v77
    v_fma_f32 v91, v87, 4.0, v85
    v_add_f32 v77, v80, v81
    v_add_f32 v85, v88, v89
    v_sub_f32 v78, v80, v81
    v_sub_f32 v86, v88, v89
    v_fma_f32 v79, v83, 2.0, v82
    v_fma_f32 v87, v91, 2.0, v90
    v_fma_f32 v82, v83, -2.0, v82
    v_fma_f32 v90, v91, -2.0, v90
    v_fmamk_f32 v80, v76, 0x41700000, v82
    v_fmamk_f32 v88, v84, 0x41700000, v90
    v_fmamk_f32 v80, v81, 0x41200000, v80
    v_fmamk_f32 v88, v89, 0x41200000, v88
    v_cvt_pk_bf16_f32 v39, v77, v85
    v_cvt_pk_bf16_f32 v43, v78, v86
    v_cvt_pk_bf16_f32 v67, v79, v87
    v_cvt_pk_bf16_f32 v71, v82, v90
    v_cvt_pk_bf16_f32 v75, v80, v88
    ds_write_b128 v96, v[64:67] offset:49152
    ds_write_b128 v97, v[68:71] offset:0
    ds_write_b128 v97, v[72:75] offset:16384
    ds_write_b128 v96, v[32:35] offset:0
    ds_write_b128 v96, v[36:39] offset:16384
    ds_write_b128 v96, v[40:43] offset:32768
    ds_write_b128 v98, v[44:47] offset:0
    s_add_u32 s28, s28, 1
    s_waitcnt lgkmcnt(0)
    s_barrier
    s_cmp_lt_u32 s28, 13
    s_cselect_b32 s24, 0, 2130706432
    v_lshlrev_b32 v76, 16, v48
    v_and_b32 v84, s25, v48
    v_lshlrev_b32 v77, 16, v52
    v_and_b32 v85, s25, v52
    v_lshlrev_b32 v78, 16, v56
    v_and_b32 v86, s25, v56
    v_lshlrev_b32 v79, 16, v60
    v_and_b32 v87, s25, v60
    v_add_f32 v80, v76, v78
    v_add_f32 v88, v84, v86
    v_add_f32 v81, v77, v79
    v_add_f32 v89, v85, v87
    v_fma_f32 v82, v78, 4.0, v76
    v_fma_f32 v90, v86, 4.0, v84
    v_fma_f32 v83, v79, 4.0, v77
    v_fma_f32 v91, v87, 4.0, v85
    v_add_f32 v77, v80, v81
    v_add_f32 v85, v88, v89
    v_sub_f32 v78, v80, v81
    v_sub_f32 v86, v88, v89
    v_fma_f32 v79, v83, 2.0, v82
    v_fma_f32 v87, v91, 2.0, v90
    v_fma_f32 v82, v83, -2.0, v82
    v_fma_f32 v90, v91, -2.0, v90
    v_fmamk_f32 v80, v76, 0x41700000, v82
    v_fmamk_f32 v88, v84, 0x41700000, v90
    buffer_load_dwordx4 v[8:11], v94, s[8:11], s24 offen offset:0
    buffer_load_dwordx4 v[24:27], v94, s[8:11], s24 offen offset:64
    v_add_u32 v94, 128, v94
    v_fmamk_f32 v80, v81, 0x41200000, v80
    v_fmamk_f32 v88, v89, 0x41200000, v88
    v_cvt_pk_bf16_f32 v52, v77, v85
    v_cvt_pk_bf16_f32 v56, v78, v86
    v_cvt_pk_bf16_f32 v64, v79, v87
    v_cvt_pk_bf16_f32 v68, v82, v90
    v_cvt_pk_bf16_f32 v72, v80, v88
    v_lshlrev_b32 v76, 16, v49
    v_and_b32 v84, s25, v49
    v_lshlrev_b32 v77, 16, v53
    v_and_b32 v85, s25, v53
    v_lshlrev_b32 v78, 16, v57
    v_and_b32 v86, s25, v57
    v_lshlrev_b32 v79, 16, v61
    v_and_b32 v87, s25, v61
    v_add_f32 v80, v76, v78
    v_add_f32 v88, v84, v86
    v_add_f32 v81, v77, v79
    v_add_f32 v89, v85, v87
    v_fma_f32 v82, v78, 4.0, v76
    v_fma_f32 v90, v86, 4.0, v84
    v_fma_f32 v83, v79, 4.0, v77
    v_fma_f32 v91, v87, 4.0, v85
    v_add_f32 v77, v80, v81
    v_add_f32 v85, v88, v89
    v_sub_f32 v78, v80, v81
    s_nop 0
    buffer_load_dwordx4 v[12:15], v95, s[8:11], s24 offen offset:0
    buffer_load_dwordx4 v[28:31], v95, s[8:11], s24 offen offset:64
    v_add_u32 v95, 128, v95
    v_sub_f32 v86, v88, v89
    s_nop 0
    v_fma_f32 v79, v83, 2.0, v82
    v_fma_f32 v87, v91, 2.0, v90
    v_fma_f32 v82, v83, -2.0, v82
    v_fma_f32 v90, v91, -2.0, v90
    v_fmamk_f32 v80, v76, 0x41700000, v82
    v_fmamk_f32 v88, v84, 0x41700000, v90
    v_fmamk_f32 v80, v81, 0x41200000, v80
    v_fmamk_f32 v88, v89, 0x41200000, v88
    v_cvt_pk_bf16_f32 v53, v77, v85
    v_cvt_pk_bf16_f32 v57, v78, v86
    v_cvt_pk_bf16_f32 v65, v79, v87
    v_cvt_pk_bf16_f32 v69, v82, v90
    v_cvt_pk_bf16_f32 v73, v80, v88
    v_lshlrev_b32 v76, 16, v50
    v_and_b32 v84, s25, v50
    v_lshlrev_b32 v77, 16, v54
    v_and_b32 v85, s25, v54
    v_lshlrev_b32 v78, 16, v58
    v_and_b32 v86, s25, v58
    v_lshlrev_b32 v79, 16, v62
    v_and_b32 v87, s25, v62
    v_add_f32 v80, v76, v78
    v_add_f32 v88, v84, v86
    v_add_f32 v81, v77, v79
    v_add_f32 v89, v85, v87
    v_fma_f32 v82, v78, 4.0, v76
    v_fma_f32 v90, v86, 4.0, v84
    v_fma_f32 v83, v79, 4.0, v77
    v_fma_f32 v91, v87, 4.0, v85
    v_add_f32 v77, v80, v81
    v_add_f32 v85, v88, v89
    v_sub_f32 v78, v80, v81
    v_sub_f32 v86, v88, v89
    v_fma_f32 v79, v83, 2.0, v82
    v_fma_f32 v87, v91, 2.0, v90
    v_fma_f32 v82, v83, -2.0, v82
    v_fma_f32 v90, v91, -2.0, v90
    v_fmamk_f32 v80, v76, 0x41700000, v82
    v_fmamk_f32 v88, v84, 0x41700000, v90
    v_fmamk_f32 v80, v81, 0x41200000, v80
    v_fmamk_f32 v88, v89, 0x41200000, v88
    v_cvt_pk_bf16_f32 v54, v77, v85
    v_cvt_pk_bf16_f32 v58, v78, v86
    v_cvt_pk_bf16_f32 v66, v79, v87
    v_cvt_pk_bf16_f32 v70, v82, v90
    v_cvt_pk_bf16_f32 v74, v80, v88
    v_lshlrev_b32 v76, 16, v51
    v_and_b32 v84, s25, v51
    v_lshlrev_b32 v77, 16, v55
    v_and_b32 v85, s25, v55
    v_lshlrev_b32 v78, 16, v59
    v_and_b32 v86, s25, v59
    v_lshlrev_b32 v79, 16, v63
    v_and_b32 v87, s25, v63
    v_add_f32 v80, v76, v78
    v_add_f32 v88, v84, v86
    v_add_f32 v81, v77, v79
    v_add_f32 v89, v85, v87
    v_fma_f32 v82, v78, 4.0, v76
    v_fma_f32 v90, v86, 4.0, v84
    v_fma_f32 v83, v79, 4.0, v77
    v_fma_f32 v91, v87, 4.0, v85
    v_add_f32 v77, v80, v81
    v_add_f32 v85, v88, v89
    v_sub_f32 v78, v80, v81
    v_sub_f32 v86, v88, v89
    v_fma_f32 v79, v83, 2.0, v82
    v_fma_f32 v87, v91, 2.0, v90
    v_fma_f32 v82, v83, -2.0, v82
    v_fma_f32 v90, v91, -2.0, v90
    v_fmamk_f32 v80, v76, 0x41700000, v82
    v_fmamk_f32 v88, v84, 0x41700000, v90
    v_fmamk_f32 v80, v81, 0x41200000, v80
    v_fmamk_f32 v88, v89, 0x41200000, v88
    v_cvt_pk_bf16_f32 v55, v77, v85
    v_cvt_pk_bf16_f32 v59, v78, v86
    v_cvt_pk_bf16_f32 v67, v79, v87
    v_cvt_pk_bf16_f32 v71, v82, v90
    v_cvt_pk_bf16_f32 v75, v80, v88
    ds_write_b128 v96, v[64:67] offset:57344
    ds_write_b128 v97, v[68:71] offset:8192
    ds_write_b128 v97, v[72:75] offset:24576
    ds_write_b128 v96, v[48:51] offset:8192
    ds_write_b128 v96, v[52:55] offset:24576
    ds_write_b128 v96, v[56:59] offset:40960
    ds_write_b128 v98, v[60:63] offset:8704
    s_add_u32 s28, s28, 1
    s_waitcnt lgkmcnt(0)
    s_barrier
    s_cmp_eq_u32 s22, 1
    s_cbranch_scc1 L_conv1_kernel_hlast1
    s_cmp_lt_u32 s28, 13
    s_cselect_b32 s24, 0, 2130706432
    s_waitcnt vmcnt(0)
    v_lshlrev_b32 v76, 16, v0
    v_and_b32 v84, s25, v0
    v_lshlrev_b32 v77, 16, v4
    v_and_b32 v85, s25, v4
    v_lshlrev_b32 v78, 16, v8
    v_and_b32 v86, s25, v8
    v_lshlrev_b32 v79, 16, v12
    v_and_b32 v87, s25, v12
    v_add_f32 v80, v76, v78
    v_add_f32 v88, v84, v86
    v_add_f32 v81, v77, v79
    v_add_f32 v89, v85, v87
    s_nop 0
    v_fma_f32 v82, v78, 4.0, v76
    v_fma_f32 v90, v86, 4.0, v84
    v_fma_f32 v83, v79, 4.0, v77
    v_fma_f32 v91, v87, 4.0, v85
    v_add_f32 v77, v80, v81
    v_add_f32 v85, v88, v89
    v_sub_f32 v78, v80, v81
    v_sub_f32 v86, v88, v89
    v_fma_f32 v79, v83, 2.0, v82
    v_fma_f32 v87, v91, 2.0, v90
    v_fma_f32 v82, v83, -2.0, v82
    v_fma_f32 v90, v91, -2.0, v90
    v_fmamk_f32 v80, v76, 0x41700000, v82
    v_fmamk_f32 v88, v84, 0x41700000, v90
    buffer_load_dwordx4 v[32:35], v92, s[8:11], s24 offen offset:0
    buffer_load_dwordx4 v[48:51], v92, s[8:11], s24 offen offset:64
    v_add_u32 v92, 128, v92
    v_fmamk_f32 v80, v81, 0x41200000, v80
    v_fmamk_f32 v88, v89, 0x41200000, v88
    v_cvt_pk_bf16_f32 v4, v77, v85
    v_cvt_pk_bf16_f32 v8, v78, v86
    v_cvt_pk_bf16_f32 v64, v79, v87
    v_cvt_pk_bf16_f32 v68, v82, v90
    v_cvt_pk_bf16_f32 v72, v80, v88
    v_lshlrev_b32 v76, 16, v1
    v_and_b32 v84, s25, v1
    v_lshlrev_b32 v77, 16, v5
    v_and_b32 v85, s25, v5
    v_lshlrev_b32 v78, 16, v9
    v_and_b32 v86, s25, v9
    v_lshlrev_b32 v79, 16, v13
    v_and_b32 v87, s25, v13
    v_add_f32 v80, v76, v78
    v_add_f32 v88, v84, v86
    v_add_f32 v81, v77, v79
    v_add_f32 v89, v85, v87
    v_fma_f32 v82, v78, 4.0, v76
    v_fma_f32 v90, v86, 4.0, v84
    v_fma_f32 v83, v79, 4.0, v77
    v_fma_f32 v91, v87, 4.0, v85
    v_add_f32 v77, v80, v81
    v_add_f32 v85, v88, v89
    v_sub_f32 v78, v80, v81
    s_nop 0
    buffer_load_dwordx4 v[36:39], v93, s[8:11], s24 offen offset:0
    buffer_load_dwordx4 v[52:55], v93, s[8:11], s24 offen offset:64
    v_add_u32 v93, 128, v93
    v_sub_f32 v86, v88, v89
    s_nop 0
    v_fma_f32 v79, v83, 2.0, v82
    v_fma_f32 v87, v91, 2.0, v90
    v_fma_f32 v82, v83, -2.0, v82
    v_fma_f32 v90, v91, -2.0, v90
    v_fmamk_f32 v80, v76, 0x41700000, v82
    v_fmamk_f32 v88, v84, 0x41700000, v90
    v_fmamk_f32 v80, v81, 0x41200000, v80
    v_fmamk_f32 v88, v89, 0x41200000, v88
    v_cvt_pk_bf16_f32 v5, v77, v85
    v_cvt_pk_bf16_f32 v9, v78, v86
    v_cvt_pk_bf16_f32 v65, v79, v87
    v_cvt_pk_bf16_f32 v69, v82, v90
    v_cvt_pk_bf16_f32 v73, v80, v88
    v_lshlrev_b32 v76, 16, v2
    v_and_b32 v84, s25, v2
    v_lshlrev_b32 v77, 16, v6
    v_and_b32 v85, s25, v6
    v_lshlrev_b32 v78, 16, v10
    v_and_b32 v86, s25, v10
    v_lshlrev_b32 v79, 16, v14
    v_and_b32 v87, s25, v14
    v_add_f32 v80, v76, v78
    v_add_f32 v88, v84, v86
    v_add_f32 v81, v77, v79
    v_add_f32 v89, v85, v87
    v_fma_f32 v82, v78, 4.0, v76
    v_fma_f32 v90, v86, 4.0, v84
    v_fma_f32 v83, v79, 4.0, v77
    v_fma_f32 v91, v87, 4.0, v85
    v_add_f32 v77, v80, v81
    v_add_f32 v85, v88, v89
    v_sub_f32 v78, v80, v81
    v_sub_f32 v86, v88, v89
    v_fma_f32 v79, v83, 2.0, v82
    v_fma_f32 v87, v91, 2.0, v90
    v_fma_f32 v82, v83, -2.0, v82
    v_fma_f32 v90, v91, -2.0, v90
    v_fmamk_f32 v80, v76, 0x41700000, v82
    v_fmamk_f32 v88, v84, 0x41700000, v90
    v_fmamk_f32 v80, v81, 0x41200000, v80
    v_fmamk_f32 v88, v89, 0x41200000, v88
    v_cvt_pk_bf16_f32 v6, v77, v85
    v_cvt_pk_bf16_f32 v10, v78, v86
    v_cvt_pk_bf16_f32 v66, v79, v87
    v_cvt_pk_bf16_f32 v70, v82, v90
    v_cvt_pk_bf16_f32 v74, v80, v88
    v_lshlrev_b32 v76, 16, v3
    v_and_b32 v84, s25, v3
    v_lshlrev_b32 v77, 16, v7
    v_and_b32 v85, s25, v7
    v_lshlrev_b32 v78, 16, v11
    v_and_b32 v86, s25, v11
    v_lshlrev_b32 v79, 16, v15
    v_and_b32 v87, s25, v15
    v_add_f32 v80, v76, v78
    v_add_f32 v88, v84, v86
    v_add_f32 v81, v77, v79
    v_add_f32 v89, v85, v87
    v_fma_f32 v82, v78, 4.0, v76
    v_fma_f32 v90, v86, 4.0, v84
    v_fma_f32 v83, v79, 4.0, v77
    v_fma_f32 v91, v87, 4.0, v85
    v_add_f32 v77, v80, v81
    v_add_f32 v85, v88, v89
    v_sub_f32 v78, v80, v81
    v_sub_f32 v86, v88, v89
    v_fma_f32 v79, v83, 2.0, v82
    v_fma_f32 v87, v91, 2.0, v90
    v_fma_f32 v82, v83, -2.0, v82
    v_fma_f32 v90, v91, -2.0, v90
    v_fmamk_f32 v80, v76, 0x41700000, v82
    v_fmamk_f32 v88, v84, 0x41700000, v90
    v_fmamk_f32 v80, v81, 0x41200000, v80
    v_fmamk_f32 v88, v89, 0x41200000, v88
    v_cvt_pk_bf16_f32 v7, v77, v85
    v_cvt_pk_bf16_f32 v11, v78, v86
    v_cvt_pk_bf16_f32 v67, v79, v87
    v_cvt_pk_bf16_f32 v71, v82, v90
    v_cvt_pk_bf16_f32 v75, v80, v88
    ds_write_b128 v96, v[64:67] offset:49152
    ds_write_b128 v97, v[68:71] offset:0
    ds_write_b128 v97, v[72:75] offset:16384
    ds_write_b128 v96, v[0:3] offset:0
    ds_write_b128 v96, v[4:7] offset:16384
    ds_write_b128 v96, v[8:11] offset:32768
    ds_write_b128 v98, v[12:15] offset:0
    s_add_u32 s28, s28, 1
    s_waitcnt lgkmcnt(0)
    s_barrier
    s_sub_u32 s22, s22, 1
    s_branch L_conv1_kernel_hloop1
L_conv1_kernel_hlast1:
    s_cmp_ge_u32 s2, 32
    s_cbranch_scc1 L_conv1_kernel_ntw
    s_getpc_b64 s[36:37]
L_conv1_kernel_pc:
    s_lshl_b32 s38, s32, 13
    s_add_u32 s38, s38, L_conv1_kernel_epi-L_conv1_kernel_pc
    v_lshl_add_u32 v2, v127, 7, s38
    v_min_u32 v2, L_conv2_kernel_done-L_conv1_kernel_pc, v2
    v_mov_b32 v3, s37
    v_add_co_u32 v2, vcc, s36, v2
    s_nop 1
    v_addc_co_u32 v3, vcc, 0, v3, vcc
    global_load_dword v4, v[2:3], off
L_conv1_kernel_ntw:
    s_endpgm
L_conv1_kernel_h2:
    s_waitcnt lgkmcnt(0)
    s_barrier
    buffer_load_dwordx4 v[32:35], v92, s[8:11], s24 offen offset:0
    buffer_load_dwordx4 v[48:51], v92, s[8:11], s24 offen offset:64
    v_add_u32 v92, 128, v92
    buffer_load_dwordx4 v[36:39], v93, s[8:11], s24 offen offset:0
    buffer_load_dwordx4 v[52:55], v93, s[8:11], s24 offen offset:64
    v_add_u32 v93, 128, v93
    buffer_load_dwordx4 v[40:43], v94, s[8:11], s24 offen offset:0
    buffer_load_dwordx4 v[56:59], v94, s[8:11], s24 offen offset:64
    v_add_u32 v94, 128, v94
    buffer_load_dwordx4 v[44:47], v95, s[8:11], s24 offen offset:0
    buffer_load_dwordx4 v[60:63], v95, s[8:11], s24 offen offset:64
    v_add_u32 v95, 128, v95
    s_setprio 0
    v_lshlrev_b32 v76, 16, v16
    v_and_b32 v84, s25, v16
    v_lshlrev_b32 v77, 16, v20
    v_and_b32 v85, s25, v20
    v_lshlrev_b32 v78, 16, v24
    v_and_b32 v86, s25, v24
    v_lshlrev_b32 v79, 16, v28
    v_and_b32 v87, s25, v28
    v_add_f32 v80, v76, v78
    v_add_f32 v88, v84, v86
    v_add_f32 v81, v77, v79
    v_add_f32 v89, v85, v87
    v_fma_f32 v82, v78, 4.0, v76
    v_fma_f32 v90, v86, 4.0, v84
    v_fma_f32 v83, v79, 4.0, v77
    v_fma_f32 v91, v87, 4.0, v85
    v_add_f32 v77, v80, v81
    v_add_f32 v85, v88, v89
    v_sub_f32 v78, v80, v81
    v_sub_f32 v86, v88, v89
    v_fma_f32 v79, v83, 2.0, v82
    v_fma_f32 v87, v91, 2.0, v90
    v_fma_f32 v82, v83, -2.0, v82
    v_fma_f32 v90, v91, -2.0, v90
    v_fmamk_f32 v80, v76, 0x41700000, v82
    v_fmamk_f32 v88, v84, 0x41700000, v90
    v_fmamk_f32 v80, v81, 0x41200000, v80
    v_fmamk_f32 v88, v89, 0x41200000, v88
    v_cvt_pk_bf16_f32 v20, v77, v85
    v_cvt_pk_bf16_f32 v24, v78, v86
    v_cvt_pk_bf16_f32 v64, v79, v87
    v_cvt_pk_bf16_f32 v68, v82, v90
    v_cvt_pk_bf16_f32 v72, v80, v88
    v_lshlrev_b32 v76, 16, v17
    v_and_b32 v84, s25, v17
    v_lshlrev_b32 v77, 16, v21
    v_and_b32 v85, s25, v21
    v_lshlrev_b32 v78, 16, v25
    v_and_b32 v86, s25, v25
    v_lshlrev_b32 v79, 16, v29
    v_and_b32 v87, s25, v29
    v_add_f32 v80, v76, v78
    v_add_f32 v88, v84, v86
    v_add_f32 v81, v77, v79
    v_add_f32 v89, v85, v87
    v_fma_f32 v82, v78, 4.0, v76
    v_fma_f32 v90, v86, 4.0, v84
    v_fma_f32 v83, v79, 4.0, v77
    v_fma_f32 v91, v87, 4.0, v85
    v_add_f32 v77, v80, v81
    v_add_f32 v85, v88, v89
    v_sub_f32 v78, v80, v81
    v_sub_f32 v86, v88, v89
    v_fma_f32 v79, v83, 2.0, v82
    v_fma_f32 v87, v91, 2.0, v90
    v_fma_f32 v82, v83, -2.0, v82
    v_fma_f32 v90, v91, -2.0, v90
    v_fmamk_f32 v80, v76, 0x41700000, v82
    v_fmamk_f32 v88, v84, 0x41700000, v90
    v_fmamk_f32 v80, v81, 0x41200000, v80
    v_fmamk_f32 v88, v89, 0x41200000, v88
    v_cvt_pk_bf16_f32 v21, v77, v85
    v_cvt_pk_bf16_f32 v25, v78, v86
    v_cvt_pk_bf16_f32 v65, v79, v87
    v_cvt_pk_bf16_f32 v69, v82, v90
    v_cvt_pk_bf16_f32 v73, v80, v88
    v_lshlrev_b32 v76, 16, v18
    v_and_b32 v84, s25, v18
    v_lshlrev_b32 v77, 16, v22
    v_and_b32 v85, s25, v22
    v_lshlrev_b32 v78, 16, v26
    v_and_b32 v86, s25, v26
    v_lshlrev_b32 v79, 16, v30
    v_and_b32 v87, s25, v30
    v_add_f32 v80, v76, v78
    v_add_f32 v88, v84, v86
    v_add_f32 v81, v77, v79
    v_add_f32 v89, v85, v87
    v_fma_f32 v82, v78, 4.0, v76
    v_fma_f32 v90, v86, 4.0, v84
    v_fma_f32 v83, v79, 4.0, v77
    v_fma_f32 v91, v87, 4.0, v85
    v_add_f32 v77, v80, v81
    v_add_f32 v85, v88, v89
    v_sub_f32 v78, v80, v81
    v_sub_f32 v86, v88, v89
    v_fma_f32 v79, v83, 2.0, v82
    v_fma_f32 v87, v91, 2.0, v90
    v_fma_f32 v82, v83, -2.0, v82
    v_fma_f32 v90, v91, -2.0, v90
    v_fmamk_f32 v80, v76, 0x41700000, v82
    v_fmamk_f32 v88, v84, 0x41700000, v90
    v_fmamk_f32 v80, v81, 0x41200000, v80
    v_fmamk_f32 v88, v89, 0x41200000, v88
    v_cvt_pk_bf16_f32 v22, v77, v85
    v_cvt_pk_bf16_f32 v26, v78, v86
    v_cvt_pk_bf16_f32 v66, v79, v87
    v_cvt_pk_bf16_f32 v70, v82, v90
    v_cvt_pk_bf16_f32 v74, v80, v88
    v_lshlrev_b32 v76, 16, v19
    v_and_b32 v84, s25, v19
    v_lshlrev_b32 v77, 16, v23
    v_and_b32 v85, s25, v23
    v_lshlrev_b32 v78, 16, v27
    v_and_b32 v86, s25, v27
    v_lshlrev_b32 v79, 16, v31
    v_and_b32 v87, s25, v31
    v_add_f32 v80, v76, v78
    v_add_f32 v88, v84, v86
    v_add_f32 v81, v77, v79
    v_add_f32 v89, v85, v87
    v_fma_f32 v82, v78, 4.0, v76
    v_fma_f32 v90, v86, 4.0, v84
    v_fma_f32 v83, v79, 4.0, v77
    v_fma_f32 v91, v87, 4.0, v85
    v_add_f32 v77, v80, v81
    v_add_f32 v85, v88, v89
    v_sub_f32 v78, v80, v81
    v_sub_f32 v86, v88, v89
    v_fma_f32 v79, v83, 2.0, v82
    v_fma_f32 v87, v91, 2.0, v90
    v_fma_f32 v82, v83, -2.0, v82
    v_fma_f32 v90, v91, -2.0, v90
    v_fmamk_f32 v80, v76, 0x41700000, v82
    v_fmamk_f32 v88, v84, 0x41700000, v90
    v_fmamk_f32 v80, v81, 0x41200000, v80
    v_fmamk_f32 v88, v89, 0x41200000, v88
    v_cvt_pk_bf16_f32 v23, v77, v85
    v_cvt_pk_bf16_f32 v27, v78, v86
    v_cvt_pk_bf16_f32 v67, v79, v87
    v_cvt_pk_bf16_f32 v71, v82, v90
    v_cvt_pk_bf16_f32 v75, v80, v88
    s_nop 0
L_conv1_kernel_hloop2:
    s_cmp_lt_u32 s28, 12
    s_nop 0
    s_cselect_b32 s24, 0, 2130706432
    ds_write_b128 v96, v[64:67] offset:57344
    ds_write_b128 v97, v[68:71] offset:8192
    ds_write_b128 v97, v[72:75] offset:24576
    ds_write_b128 v96, v[16:19] offset:8192
    ds_write_b128 v96, v[20:23] offset:24576
    ds_write_b128 v96, v[24:27] offset:40960
    ds_write_b128 v98, v[28:31] offset:8704
    s_waitcnt vmcnt(0)
    v_lshlrev_b32 v76, 16, v32
    v_and_b32 v84, s25, v32
    v_lshlrev_b32 v77, 16, v36
    v_and_b32 v85, s25, v36
    v_lshlrev_b32 v78, 16, v40
    v_and_b32 v86, s25, v40
    v_lshlrev_b32 v79, 16, v44
    v_and_b32 v87, s25, v44
    v_add_f32 v80, v76, v78
    v_add_f32 v88, v84, v86
    v_add_f32 v81, v77, v79
    v_add_f32 v89, v85, v87
    s_nop 0
    v_fma_f32 v82, v78, 4.0, v76
    v_fma_f32 v90, v86, 4.0, v84
    v_fma_f32 v83, v79, 4.0, v77
    v_fma_f32 v91, v87, 4.0, v85
    v_add_f32 v77, v80, v81
    v_add_f32 v85, v88, v89
    v_sub_f32 v78, v80, v81
    v_sub_f32 v86, v88, v89
    v_fma_f32 v79, v83, 2.0, v82
    v_fma_f32 v87, v91, 2.0, v90
    v_fma_f32 v82, v83, -2.0, v82
    v_fma_f32 v90, v91, -2.0, v90
    v_fmamk_f32 v80, v76, 0x41700000, v82
    v_fmamk_f32 v88, v84, 0x41700000, v90
    v_fmamk_f32 v80, v81, 0x41200000, v80
    v_fmamk_f32 v88, v89, 0x41200000, v88
    v_cvt_pk_bf16_f32 v36, v77, v85
    v_cvt_pk_bf16_f32 v40, v78, v86
    v_cvt_pk_bf16_f32 v64, v79, v87
    v_cvt_pk_bf16_f32 v68, v82, v90
    v_cvt_pk_bf16_f32 v72, v80, v88
    v_lshlrev_b32 v76, 16, v33
    v_and_b32 v84, s25, v33
    v_lshlrev_b32 v77, 16, v37
    v_and_b32 v85, s25, v37
    v_lshlrev_b32 v78, 16, v41
    v_and_b32 v86, s25, v41
    buffer_load_dwordx4 v[0:3], v92, s[8:11], s24 offen offset:0
    buffer_load_dwordx4 v[16:19], v92, s[8:11], s24 offen offset:64
    v_add_u32 v92, 128, v92
    v_lshlrev_b32 v79, 16, v45
    v_and_b32 v87, s25, v45
    v_add_f32 v80, v76, v78
    v_add_f32 v88, v84, v86
    v_add_f32 v81, v77, v79
    v_add_f32 v89, v85, v87
    v_fma_f32 v82, v78, 4.0, v76
    v_fma_f32 v90, v86, 4.0, v84
    v_fma_f32 v83, v79, 4.0, v77
    v_fma_f32 v91, v87, 4.0, v85
    v_add_f32 v77, v80, v81
    v_add_f32 v85, v88, v89
    v_sub_f32 v78, v80, v81
    v_sub_f32 v86, v88, v89
    v_fma_f32 v79, v83, 2.0, v82
    v_fma_f32 v87, v91, 2.0, v90
    v_fma_f32 v82, v83, -2.0, v82
    v_fma_f32 v90, v91, -2.0, v90
    v_fmamk_f32 v80, v76, 0x41700000, v82
    v_fmamk_f32 v88, v84, 0x41700000, v90
    v_fmamk_f32 v80, v81, 0x41200000, v80
    v_fmamk_f32 v88, v89, 0x41200000, v88
    v_cvt_pk_bf16_f32 v37, v77, v85
    v_cvt_pk_bf16_f32 v41, v78, v86
    v_cvt_pk_bf16_f32 v65, v79, v87
    v_cvt_pk_bf16_f32 v69, v82, v90
    v_cvt_pk_bf16_f32 v73, v80, v88
    buffer_load_dwordx4 v[4:7], v93, s[8:11], s24 offen offset:0
    buffer_load_dwordx4 v[20:23], v93, s[8:11], s24 offen offset:64
    v_add_u32 v93, 128, v93
    v_lshlrev_b32 v76, 16, v34
    v_and_b32 v84, s25, v34
    v_lshlrev_b32 v77, 16, v38
    v_and_b32 v85, s25, v38
    v_lshlrev_b32 v78, 16, v42
    v_and_b32 v86, s25, v42
    v_lshlrev_b32 v79, 16, v46
    v_and_b32 v87, s25, v46
    v_add_f32 v80, v76, v78
    v_add_f32 v88, v84, v86
    v_add_f32 v81, v77, v79
    v_add_f32 v89, v85, v87
    v_fma_f32 v82, v78, 4.0, v76
    v_fma_f32 v90, v86, 4.0, v84
    v_fma_f32 v83, v79, 4.0, v77
    v_fma_f32 v91, v87, 4.0, v85
    v_add_f32 v77, v80, v81
    v_add_f32 v85, v88, v89
    v_sub_f32 v78, v80, v81
    v_sub_f32 v86, v88, v89
    v_fma_f32 v79, v83, 2.0, v82
    v_fma_f32 v87, v91, 2.0, v90
    v_fma_f32 v82, v83, -2.0, v82
    v_fma_f32 v90, v91, -2.0, v90
    v_fmamk_f32 v80, v76, 0x41700000, v82
    v_fmamk_f32 v88, v84, 0x41700000, v90
    v_fmamk_f32 v80, v81, 0x41200000, v80
    v_fmamk_f32 v88, v89, 0x41200000, v88
    v_cvt_pk_bf16_f32 v38, v77, v85
    v_cvt_pk_bf16_f32 v42, v78, v86
    v_cvt_pk_bf16_f32 v66, v79, v87
    v_cvt_pk_bf16_f32 v70, v82, v90
    v_cvt_pk_bf16_f32 v74, v80, v88
    v_lshlrev_b32 v76, 16, v35
    v_and_b32 v84, s25, v35
    v_lshlrev_b32 v77, 16, v39
    v_and_b32 v85, s25, v39
    v_lshlrev_b32 v78, 16, v43
    v_and_b32 v86, s25, v43
    v_lshlrev_b32 v79, 16, v47
    v_and_b32 v87, s25, v47
    v_add_f32 v80, v76, v78
    v_add_f32 v88, v84, v86
    v_add_f32 v81, v77, v79
    v_add_f32 v89, v85, v87
    v_fma_f32 v82, v78, 4.0, v76
    v_fma_f32 v90, v86, 4.0, v84
    v_fma_f32 v83, v79, 4.0, v77
    v_fma_f32 v91, v87, 4.0, v85
    v_add_f32 v77, v80, v81
    v_add_f32 v85, v88, v89
    v_sub_f32 v78, v80, v81
    v_sub_f32 v86, v88, v89
    v_fma_f32 v79, v83, 2.0, v82
    v_fma_f32 v87, v91, 2.0, v90
    v_fma_f32 v82, v83, -2.0, v82
    v_fma_f32 v90, v91, -2.0, v90
    v_fmamk_f32 v80, v76, 0x41700000, v82
    v_fmamk_f32 v88, v84, 0x41700000, v90
    v_fmamk_f32 v80, v81, 0x41200000, v80
    v_fmamk_f32 v88, v89, 0x41200000, v88
    v_cvt_pk_bf16_f32 v39, v77, v85
    v_cvt_pk_bf16_f32 v43, v78, v86
    v_cvt_pk_bf16_f32 v67, v79, v87
    v_cvt_pk_bf16_f32 v71, v82, v90
    v_cvt_pk_bf16_f32 v75, v80, v88
    s_add_u32 s28, s28, 1
    s_waitcnt lgkmcnt(0)
    s_barrier
    s_cmp_lt_u32 s28, 12
    s_cselect_b32 s24, 0, 2130706432
    ds_write_b128 v96, v[64:67] offset:49152
    ds_write_b128 v97, v[68:71] offset:0
    ds_write_b128 v97, v[72:75] offset:16384
    ds_write_b128 v96, v[32:35] offset:0
    ds_write_b128 v96, v[36:39] offset:16384
    ds_write_b128 v96, v[40:43] offset:32768
    ds_write_b128 v98, v[44:47] offset:0
    v_lshlrev_b32 v76, 16, v48
    v_and_b32 v84, s25, v48
    v_lshlrev_b32 v77, 16, v52
    v_and_b32 v85, s25, v52
    v_lshlrev_b32 v78, 16, v56
    v_and_b32 v86, s25, v56
    v_lshlrev_b32 v79, 16, v60
    v_and_b32 v87, s25, v60
    v_add_f32 v80, v76, v78
    v_add_f32 v88, v84, v86
    v_add_f32 v81, v77, v79
    v_add_f32 v89, v85, v87
    v_fma_f32 v82, v78, 4.0, v76
    v_fma_f32 v90, v86, 4.0, v84
    v_fma_f32 v83, v79, 4.0, v77
    v_fma_f32 v91, v87, 4.0, v85
    v_add_f32 v77, v80, v81
    v_add_f32 v85, v88, v89
    v_sub_f32 v78, v80, v81
    v_sub_f32 v86, v88, v89
    v_fma_f32 v79, v83, 2.0, v82
    v_fma_f32 v87, v91, 2.0, v90
    v_fma_f32 v82, v83, -2.0, v82
    v_fma_f32 v90, v91, -2.0, v90
    v_fmamk_f32 v80, v76, 0x41700000, v82
    v_fmamk_f32 v88, v84, 0x41700000, v90
    v_fmamk_f32 v80, v81, 0x41200000, v80
    v_fmamk_f32 v88, v89, 0x41200000, v88
    v_cvt_pk_bf16_f32 v52, v77, v85
    v_cvt_pk_bf16_f32 v56, v78, v86
    v_cvt_pk_bf16_f32 v64, v79, v87
    v_cvt_pk_bf16_f32 v68, v82, v90
    v_cvt_pk_bf16_f32 v72, v80, v88
    v_lshlrev_b32 v76, 16, v49
    v_and_b32 v84, s25, v49
    v_lshlrev_b32 v77, 16, v53
    v_and_b32 v85, s25, v53
    v_lshlrev_b32 v78, 16, v57
    v_and_b32 v86, s25, v57
    buffer_load_dwordx4 v[8:11], v94, s[8:11], s24 offen offset:0
    buffer_load_dwordx4 v[24:27], v94, s[8:11], s24 offen offset:64
    v_add_u32 v94, 128, v94
    v_lshlrev_b32 v79, 16, v61
    v_and_b32 v87, s25, v61
    v_add_f32 v80, v76, v78
    v_add_f32 v88, v84, v86
    v_add_f32 v81, v77, v79
    v_add_f32 v89, v85, v87
    v_fma_f32 v82, v78, 4.0, v76
    v_fma_f32 v90, v86, 4.0, v84
    v_fma_f32 v83, v79, 4.0, v77
    v_fma_f32 v91, v87, 4.0, v85
    v_add_f32 v77, v80, v81
    v_add_f32 v85, v88, v89
    v_sub_f32 v78, v80, v81
    v_sub_f32 v86, v88, v89
    v_fma_f32 v79, v83, 2.0, v82
    v_fma_f32 v87, v91, 2.0, v90
    v_fma_f32 v82, v83, -2.0, v82
    v_fma_f32 v90, v91, -2.0, v90
    v_fmamk_f32 v80, v76, 0x41700000, v82
    v_fmamk_f32 v88, v84, 0x41700000, v90
    v_fmamk_f32 v80, v81, 0x41200000, v80
    v_fmamk_f32 v88, v89, 0x41200000, v88
    v_cvt_pk_bf16_f32 v53, v77, v85
    v_cvt_pk_bf16_f32 v57, v78, v86
    v_cvt_pk_bf16_f32 v65, v79, v87
    v_cvt_pk_bf16_f32 v69, v82, v90
    v_cvt_pk_bf16_f32 v73, v80, v88
    buffer_load_dwordx4 v[12:15], v95, s[8:11], s24 offen offset:0
    buffer_load_dwordx4 v[28:31], v95, s[8:11], s24 offen offset:64
    v_add_u32 v95, 128, v95
    v_lshlrev_b32 v76, 16, v50
    v_and_b32 v84, s25, v50
    v_lshlrev_b32 v77, 16, v54
    v_and_b32 v85, s25, v54
    v_lshlrev_b32 v78, 16, v58
    v_and_b32 v86, s25, v58
    v_lshlrev_b32 v79, 16, v62
    v_and_b32 v87, s25, v62
    v_add_f32 v80, v76, v78
    v_add_f32 v88, v84, v86
    v_add_f32 v81, v77, v79
    v_add_f32 v89, v85, v87
    v_fma_f32 v82, v78, 4.0, v76
    v_fma_f32 v90, v86, 4.0, v84
    v_fma_f32 v83, v79, 4.0, v77
    v_fma_f32 v91, v87, 4.0, v85
    v_add_f32 v77, v80, v81
    v_add_f32 v85, v88, v89
    v_sub_f32 v78, v80, v81
    v_sub_f32 v86, v88, v89
    v_fma_f32 v79, v83, 2.0, v82
    v_fma_f32 v87, v91, 2.0, v90
    v_fma_f32 v82, v83, -2.0, v82
    v_fma_f32 v90, v91, -2.0, v90
    v_fmamk_f32 v80, v76, 0x41700000, v82
    v_fmamk_f32 v88, v84, 0x41700000, v90
    v_fmamk_f32 v80, v81, 0x41200000, v80
    v_fmamk_f32 v88, v89, 0x41200000, v88
    v_cvt_pk_bf16_f32 v54, v77, v85
    v_cvt_pk_bf16_f32 v58, v78, v86
    v_cvt_pk_bf16_f32 v66, v79, v87
    v_cvt_pk_bf16_f32 v70, v82, v90
    v_cvt_pk_bf16_f32 v74, v80, v88
    v_lshlrev_b32 v76, 16, v51
    v_and_b32 v84, s25, v51
    v_lshlrev_b32 v77, 16, v55
    v_and_b32 v85, s25, v55
    v_lshlrev_b32 v78, 16, v59
    v_and_b32 v86, s25, v59
    v_lshlrev_b32 v79, 16, v63
    v_and_b32 v87, s25, v63
    v_add_f32 v80, v76, v78
    v_add_f32 v88, v84, v86
    v_add_f32 v81, v77, v79
    v_add_f32 v89, v85, v87
    v_fma_f32 v82, v78, 4.0, v76
    v_fma_f32 v90, v86, 4.0, v84
    v_fma_f32 v83, v79, 4.0, v77
    v_fma_f32 v91, v87, 4.0, v85
    v_add_f32 v77, v80, v81
    v_add_f32 v85, v88, v89
    v_sub_f32 v78, v80, v81
    v_sub_f32 v86, v88, v89
    v_fma_f32 v79, v83, 2.0, v82
    v_fma_f32 v87, v91, 2.0, v90
    v_fma_f32 v82, v83, -2.0, v82
    v_fma_f32 v90, v91, -2.0, v90
    v_fmamk_f32 v80, v76, 0x41700000, v82
    v_fmamk_f32 v88, v84, 0x41700000, v90
    v_fmamk_f32 v80, v81, 0x41200000, v80
    v_fmamk_f32 v88, v89, 0x41200000, v88
    v_cvt_pk_bf16_f32 v55, v77, v85
    v_cvt_pk_bf16_f32 v59, v78, v86
    v_cvt_pk_bf16_f32 v67, v79, v87
    v_cvt_pk_bf16_f32 v71, v82, v90
    v_cvt_pk_bf16_f32 v75, v80, v88
    s_add_u32 s28, s28, 1
    s_waitcnt lgkmcnt(0)
    s_barrier
    s_cmp_eq_u32 s22, 1
    s_cbranch_scc1 L_conv1_kernel_hlast2
    s_cmp_lt_u32 s28, 12
    s_cselect_b32 s24, 0, 2130706432
    ds_write_b128 v96, v[64:67] offset:57344
    ds_write_b128 v97, v[68:71] offset:8192
    ds_write_b128 v97, v[72:75] offset:24576
    ds_write_b128 v96, v[48:51] offset:8192
    ds_write_b128 v96, v[52:55] offset:24576
    ds_write_b128 v96, v[56:59] offset:40960
    ds_write_b128 v98, v[60:63] offset:8704
    s_waitcnt vmcnt(0)
    v_lshlrev_b32 v76, 16, v0
    v_and_b32 v84, s25, v0
    v_lshlrev_b32 v77, 16, v4
    v_and_b32 v85, s25, v4
    v_lshlrev_b32 v78, 16, v8
    v_and_b32 v86, s25, v8
    v_lshlrev_b32 v79, 16, v12
    v_and_b32 v87, s25, v12
    v_add_f32 v80, v76, v78
    v_add_f32 v88, v84, v86
    v_add_f32 v81, v77, v79
    v_add_f32 v89, v85, v87
    s_nop 0
    v_fma_f32 v82, v78, 4.0, v76
    v_fma_f32 v90, v86, 4.0, v84
    v_fma_f32 v83, v79, 4.0, v77
    v_fma_f32 v91, v87, 4.0, v85
    v_add_f32 v77, v80, v81
    v_add_f32 v85, v88, v89
    v_sub_f32 v78, v80, v81
    v_sub_f32 v86, v88, v89
    v_fma_f32 v79, v83, 2.0, v82
    v_fma_f32 v87, v91, 2.0, v90
    v_fma_f32 v82, v83, -2.0, v82
    v_fma_f32 v90, v91, -2.0, v90
    v_fmamk_f32 v80, v76, 0x41700000, v82
    v_fmamk_f32 v88, v84, 0x41700000, v90
    v_fmamk_f32 v80, v81, 0x41200000, v80
    v_fmamk_f32 v88, v89, 0x41200000, v88
    v_cvt_pk_bf16_f32 v4, v77, v85
    v_cvt_pk_bf16_f32 v8, v78, v86
    v_cvt_pk_bf16_f32 v64, v79, v87
    v_cvt_pk_bf16_f32 v68, v82, v90
    v_cvt_pk_bf16_f32 v72, v80, v88
    v_lshlrev_b32 v76, 16, v1
    v_and_b32 v84, s25, v1
    v_lshlrev_b32 v77, 16, v5
    v_and_b32 v85, s25, v5
    v_lshlrev_b32 v78, 16, v9
    v_and_b32 v86, s25, v9
    buffer_load_dwordx4 v[32:35], v92, s[8:11], s24 offen offset:0
    buffer_load_dwordx4 v[48:51], v92, s[8:11], s24 offen offset:64
    v_add_u32 v92, 128, v92
    v_lshlrev_b32 v79, 16, v13
    v_and_b32 v87, s25, v13
    v_add_f32 v80, v76, v78
    v_add_f32 v88, v84, v86
    v_add_f32 v81, v77, v79
    v_add_f32 v89, v85, v87
    v_fma_f32 v82, v78, 4.0, v76
    v_fma_f32 v90, v86, 4.0, v84
    v_fma_f32 v83, v79, 4.0, v77
    v_fma_f32 v91, v87, 4.0, v85
    v_add_f32 v77, v80, v81
    v_add_f32 v85, v88, v89
    v_sub_f32 v78, v80, v81
    v_sub_f32 v86, v88, v89
    v_fma_f32 v79, v83, 2.0, v82
    v_fma_f32 v87, v91, 2.0, v90
    v_fma_f32 v82, v83, -2.0, v82
    v_fma_f32 v90, v91, -2.0, v90
    v_fmamk_f32 v80, v76, 0x41700000, v82
    v_fmamk_f32 v88, v84, 0x41700000, v90
    v_fmamk_f32 v80, v81, 0x41200000, v80
    v_fmamk_f32 v88, v89, 0x41200000, v88
    v_cvt_pk_bf16_f32 v5, v77, v85
    v_cvt_pk_bf16_f32 v9, v78, v86
    v_cvt_pk_bf16_f32 v65, v79, v87
    v_cvt_pk_bf16_f32 v69, v82, v90
    v_cvt_pk_bf16_f32 v73, v80, v88
    buffer_load_dwordx4 v[36:39], v93, s[8:11], s24 offen offset:0
    buffer_load_dwordx4 v[52:55], v93, s[8:11], s24 offen offset:64
    v_add_u32 v93, 128, v93
    v_lshlrev_b32 v76, 16, v2
    v_and_b32 v84, s25, v2
    v_lshlrev_b32 v77, 16, v6
    v_and_b32 v85, s25, v6
    v_lshlrev_b32 v78, 16, v10
    v_and_b32 v86, s25, v10
    v_lshlrev_b32 v79, 16, v14
    v_and_b32 v87, s25, v14
    v_add_f32 v80, v76, v78
    v_add_f32 v88, v84, v86
    v_add_f32 v81, v77, v79
    v_add_f32 v89, v85, v87
    v_fma_f32 v82, v78, 4.0, v76
    v_fma_f32 v90, v86, 4.0, v84
    v_fma_f32 v83, v79, 4.0, v77
    v_fma_f32 v91, v87, 4.0, v85
    v_add_f32 v77, v80, v81
    v_add_f32 v85, v88, v89
    v_sub_f32 v78, v80, v81
    v_sub_f32 v86, v88, v89
    v_fma_f32 v79, v83, 2.0, v82
    v_fma_f32 v87, v91, 2.0, v90
    v_fma_f32 v82, v83, -2.0, v82
    v_fma_f32 v90, v91, -2.0, v90
    v_fmamk_f32 v80, v76, 0x41700000, v82
    v_fmamk_f32 v88, v84, 0x41700000, v90
    v_fmamk_f32 v80, v81, 0x41200000, v80
    v_fmamk_f32 v88, v89, 0x41200000, v88
    v_cvt_pk_bf16_f32 v6, v77, v85
    v_cvt_pk_bf16_f32 v10, v78, v86
    v_cvt_pk_bf16_f32 v66, v79, v87
    v_cvt_pk_bf16_f32 v70, v82, v90
    v_cvt_pk_bf16_f32 v74, v80, v88
    v_lshlrev_b32 v76, 16, v3
    v_and_b32 v84, s25, v3
    v_lshlrev_b32 v77, 16, v7
    v_and_b32 v85, s25, v7
    v_lshlrev_b32 v78, 16, v11
    v_and_b32 v86, s25, v11
    v_lshlrev_b32 v79, 16, v15
    v_and_b32 v87, s25, v15
    v_add_f32 v80, v76, v78
    v_add_f32 v88, v84, v86
    v_add_f32 v81, v77, v79
    v_add_f32 v89, v85, v87
    v_fma_f32 v82, v78, 4.0, v76
    v_fma_f32 v90, v86, 4.0, v84
    v_fma_f32 v83, v79, 4.0, v77
    v_fma_f32 v91, v87, 4.0, v85
    v_add_f32 v77, v80, v81
    v_add_f32 v85, v88, v89
    v_sub_f32 v78, v80, v81
    v_sub_f32 v86, v88, v89
    v_fma_f32 v79, v83, 2.0, v82
    v_fma_f32 v87, v91, 2.0, v90
    v_fma_f32 v82, v83, -2.0, v82
    v_fma_f32 v90, v91, -2.0, v90
    v_fmamk_f32 v80, v76, 0x41700000, v82
    v_fmamk_f32 v88, v84, 0x41700000, v90
    v_fmamk_f32 v80, v81, 0x41200000, v80
    v_fmamk_f32 v88, v89, 0x41200000, v88
    v_cvt_pk_bf16_f32 v7, v77, v85
    v_cvt_pk_bf16_f32 v11, v78, v86
    v_cvt_pk_bf16_f32 v67, v79, v87
    v_cvt_pk_bf16_f32 v71, v82, v90
    v_cvt_pk_bf16_f32 v75, v80, v88
    s_add_u32 s28, s28, 1
    s_waitcnt lgkmcnt(0)
    s_barrier
    s_cmp_lt_u32 s28, 12
    s_cselect_b32 s24, 0, 2130706432
    ds_write_b128 v96, v[64:67] offset:49152
    ds_write_b128 v97, v[68:71] offset:0
    ds_write_b128 v97, v[72:75] offset:16384
    ds_write_b128 v96, v[0:3] offset:0
    ds_write_b128 v96, v[4:7] offset:16384
    ds_write_b128 v96, v[8:11] offset:32768
    ds_write_b128 v98, v[12:15] offset:0
    v_lshlrev_b32 v76, 16, v16
    v_and_b32 v84, s25, v16
    v_lshlrev_b32 v77, 16, v20
    v_and_b32 v85, s25, v20
    v_lshlrev_b32 v78, 16, v24
    v_and_b32 v86, s25, v24
    v_lshlrev_b32 v79, 16, v28
    v_and_b32 v87, s25, v28
    v_add_f32 v80, v76, v78
    v_add_f32 v88, v84, v86
    v_add_f32 v81, v77, v79
    v_add_f32 v89, v85, v87
    v_fma_f32 v82, v78, 4.0, v76
    v_fma_f32 v90, v86, 4.0, v84
    v_fma_f32 v83, v79, 4.0, v77
    v_fma_f32 v91, v87, 4.0, v85
    v_add_f32 v77, v80, v81
    v_add_f32 v85, v88, v89
    v_sub_f32 v78, v80, v81
    v_sub_f32 v86, v88, v89
    v_fma_f32 v79, v83, 2.0, v82
    v_fma_f32 v87, v91, 2.0, v90
    v_fma_f32 v82, v83, -2.0, v82
    v_fma_f32 v90, v91, -2.0, v90
    v_fmamk_f32 v80, v76, 0x41700000, v82
    v_fmamk_f32 v88, v84, 0x41700000, v90
    v_fmamk_f32 v80, v81, 0x41200000, v80
    v_fmamk_f32 v88, v89, 0x41200000, v88
    v_cvt_pk_bf16_f32 v20, v77, v85
    v_cvt_pk_bf16_f32 v24, v78, v86
    v_cvt_pk_bf16_f32 v64, v79, v87
    v_cvt_pk_bf16_f32 v68, v82, v90
    v_cvt_pk_bf16_f32 v72, v80, v88
    v_lshlrev_b32 v76, 16, v17
    v_and_b32 v84, s25, v17
    v_lshlrev_b32 v77, 16, v21
    v_and_b32 v85, s25, v21
    v_lshlrev_b32 v78, 16, v25
    v_and_b32 v86, s25, v25
    buffer_load_dwordx4 v[40:43], v94, s[8:11], s24 offen offset:0
    buffer_load_dwordx4 v[56:59], v94, s[8:11], s24 offen offset:64
    v_add_u32 v94, 128, v94
    v_lshlrev_b32 v79, 16, v29
    v_and_b32 v87, s25, v29
    v_add_f32 v80, v76, v78
    v_add_f32 v88, v84, v86
    v_add_f32 v81, v77, v79
    v_add_f32 v89, v85, v87
    v_fma_f32 v82, v78, 4.0, v76
    v_fma_f32 v90, v86, 4.0, v84
    v_fma_f32 v83, v79, 4.0, v77
    v_fma_f32 v91, v87, 4.0, v85
    v_add_f32 v77, v80, v81
    v_add_f32 v85, v88, v89
    v_sub_f32 v78, v80, v81
    v_sub_f32 v86, v88, v89
    v_fma_f32 v79, v83, 2.0, v82
    v_fma_f32 v87, v91, 2.0, v90
    v_fma_f32 v82, v83, -2.0, v82
    v_fma_f32 v90, v91, -2.0, v90
    v_fmamk_f32 v80, v76, 0x41700000, v82
    v_fmamk_f32 v88, v84, 0x41700000, v90
    v_fmamk_f32 v80, v81, 0x41200000, v80
    v_fmamk_f32 v88, v89, 0x41200000, v88
    v_cvt_pk_bf16_f32 v21, v77, v85
    v_cvt_pk_bf16_f32 v25, v78, v86
    v_cvt_pk_bf16_f32 v65, v79, v87
    v_cvt_pk_bf16_f32 v69, v82, v90
    v_cvt_pk_bf16_f32 v73, v80, v88
    buffer_load_dwordx4 v[44:47], v95, s[8:11], s24 offen offset:0
    buffer_load_dwordx4 v[60:63], v95, s[8:11], s24 offen offset:64
    v_add_u32 v95, 128, v95
    v_lshlrev_b32 v76, 16, v18
    v_and_b32 v84, s25, v18
    v_lshlrev_b32 v77, 16, v22
    v_and_b32 v85, s25, v22
    v_lshlrev_b32 v78, 16, v26
    v_and_b32 v86, s25, v26
    v_lshlrev_b32 v79, 16, v30
    v_and_b32 v87, s25, v30
    v_add_f32 v80, v76, v78
    v_add_f32 v88, v84, v86
    v_add_f32 v81, v77, v79
    v_add_f32 v89, v85, v87
    v_fma_f32 v82, v78, 4.0, v76
    v_fma_f32 v90, v86, 4.0, v84
    v_fma_f32 v83, v79, 4.0, v77
    v_fma_f32 v91, v87, 4.0, v85
    v_add_f32 v77, v80, v81
    v_add_f32 v85, v88, v89
    v_sub_f32 v78, v80, v81
    v_sub_f32 v86, v88, v89
    v_fma_f32 v79, v83, 2.0, v82
    v_fma_f32 v87, v91, 2.0, v90
    v_fma_f32 v82, v83, -2.0, v82
    v_fma_f32 v90, v91, -2.0, v90
    v_fmamk_f32 v80, v76, 0x41700000, v82
    v_fmamk_f32 v88, v84, 0x41700000, v90
    v_fmamk_f32 v80, v81, 0x41200000, v80
    v_fmamk_f32 v88, v89, 0x41200000, v88
    v_cvt_pk_bf16_f32 v22, v77, v85
    v_cvt_pk_bf16_f32 v26, v78, v86
    v_cvt_pk_bf16_f32 v66, v79, v87
    v_cvt_pk_bf16_f32 v70, v82, v90
    v_cvt_pk_bf16_f32 v74, v80, v88
    v_lshlrev_b32 v76, 16, v19
    v_and_b32 v84, s25, v19
    v_lshlrev_b32 v77, 16, v23
    v_and_b32 v85, s25, v23
    v_lshlrev_b32 v78, 16, v27
    v_and_b32 v86, s25, v27
    v_lshlrev_b32 v79, 16, v31
    v_and_b32 v87, s25, v31
    v_add_f32 v80, v76, v78
    v_add_f32 v88, v84, v86
    v_add_f32 v81, v77, v79
    v_add_f32 v89, v85, v87
    v_fma_f32 v82, v78, 4.0, v76
    v_fma_f32 v90, v86, 4.0, v84
    v_fma_f32 v83, v79, 4.0, v77
    v_fma_f32 v91, v87, 4.0, v85
    v_add_f32 v77, v80, v81
    v_add_f32 v85, v88, v89
    v_sub_f32 v78, v80, v81
    v_sub_f32 v86, v88, v89
    v_fma_f32 v79, v83, 2.0, v82
    v_fma_f32 v87, v91, 2.0, v90
    v_fma_f32 v82, v83, -2.0, v82
    v_fma_f32 v90, v91, -2.0, v90
    v_fmamk_f32 v80, v76, 0x41700000, v82
    v_fmamk_f32 v88, v84, 0x41700000, v90
    v_fmamk_f32 v80, v81, 0x41200000, v80
    v_fmamk_f32 v88, v89, 0x41200000, v88
    v_cvt_pk_bf16_f32 v23, v77, v85
    v_cvt_pk_bf16_f32 v27, v78, v86
    v_cvt_pk_bf16_f32 v67, v79, v87
    v_cvt_pk_bf16_f32 v71, v82, v90
    v_cvt_pk_bf16_f32 v75, v80, v88
    s_add_u32 s28, s28, 1
    s_waitcnt lgkmcnt(0)
    s_barrier
    s_sub_u32 s22, s22, 1
    s_branch L_conv1_kernel_hloop2
L_conv1_kernel_hlast2:
    s_waitcnt vmcnt(0)
    s_mov_b32 s58, s20
    s_lshl_b32 s20, s2, 2
    s_add_u32 s20, s20, s32
    v_mov_b32 v1, v127
    s_load_dwordx2 s[8:9], s[0:1], 16
    s_lshr_b32 s22, s20, 8
    s_bfe_u32 s23, s20, 0x40004
    s_bfe_u32 s24, s20, 0x30001
    s_and_b32 s21, s20, 1
    v_lshrrev_b32 v2, 4, v1
    v_lshlrev_b32 v2, 12, v2
    v_and_b32 v3, 15, v1
    v_lshl_add_u32 v2, v3, 2, v2
    s_lshl_b32 s26, s22, 3
    s_lshr_b32 s27, s23, 3
    s_add_u32 s26, s26, s27
    s_lshl_b32 s26, s26, 17
    s_and_b32 s27, s23, 7
    s_lshl_b32 s27, s27, 14
    s_add_u32 s26, s26, s27
    s_lshl_b32 s27, s24, 6
    s_add_u32 s26, s26, s27
    s_mov_b32 s10, 4063232
    s_mov_b32 s11, 0x00020000
    s_add_u32 s37, s26, 262144
    s_add_u32 s38, s26, 524288
    s_add_u32 s39, s26, 786432
    s_waitcnt lgkmcnt(0)
    buffer_load_dword v16, v2, s[8:11], s26 offen offset:0
    buffer_load_dword v17, v2, s[8:11], s26 offen offset:512
    buffer_load_dword v24, v2, s[8:11], s37 offen offset:0
    buffer_load_dword v25, v2, s[8:11], s37 offen offset:512
    buffer_load_dword v32, v2, s[8:11], s38 offen offset:0
    buffer_load_dword v33, v2, s[8:11], s38 offen offset:512
    buffer_load_dword v40, v2, s[8:11], s39 offen offset:0
    buffer_load_dword v41, v2, s[8:11], s39 offen offset:512
    buffer_load_dword v18, v2, s[8:11], s26 offen offset:1024
    buffer_load_dword v19, v2, s[8:11], s26 offen offset:1536
    buffer_load_dword v26, v2, s[8:11], s37 offen offset:1024
    buffer_load_dword v27, v2, s[8:11], s37 offen offset:1536
    buffer_load_dword v34, v2, s[8:11], s38 offen offset:1024
    buffer_load_dword v35, v2, s[8:11], s38 offen offset:1536
    buffer_load_dword v42, v2, s[8:11], s39 offen offset:1024
    buffer_load_dword v43, v2, s[8:11], s39 offen offset:1536
    buffer_load_dword v20, v2, s[8:11], s26 offen offset:2048
    buffer_load_dword v21, v2, s[8:11], s26 offen offset:2560
    buffer_load_dword v28, v2, s[8:11], s37 offen offset:2048
    buffer_load_dword v29, v2, s[8:11], s37 offen offset:2560
    buffer_load_dword v36, v2, s[8:11], s38 offen offset:2048
    buffer_load_dword v37, v2, s[8:11], s38 offen offset:2560
    buffer_load_dword v44, v2, s[8:11], s39 offen offset:2048
    buffer_load_dword v45, v2, s[8:11], s39 offen offset:2560
    buffer_load_dword v22, v2, s[8:11], s26 offen offset:3072
    buffer_load_dword v23, v2, s[8:11], s26 offen offset:3584
    buffer_load_dword v30, v2, s[8:11], s37 offen offset:3072
    buffer_load_dword v31, v2, s[8:11], s37 offen offset:3584
    buffer_load_dword v38, v2, s[8:11], s38 offen offset:3072
    buffer_load_dword v39, v2, s[8:11], s38 offen offset:3584
    buffer_load_dword v46, v2, s[8:11], s39 offen offset:3072
    buffer_load_dword v47, v2, s[8:11], s39 offen offset:3584
    s_add_u32 s12, s30, 9437184
    s_addc_u32 s13, s31, 0
    s_mov_b32 s14, 7340032
    s_mov_b32 s15, 0x00020000
    v_lshlrev_b32 v4, 4, v1
    s_lshl_b32 s27, s24, 4
    s_add_u32 s27, s27, s23
    s_mul_i32 s27, s27, 57344
    s_lshl_b32 s28, s22, 11
    s_add_u32 s27, s27, s28
    s_lshl_b32 s28, s21, 10
    s_add_u32 s27, s27, s28
    s_cmp_eq_u32 s21, 0
    s_mov_b32 s32, 0x07060302
    s_cselect_b32 s32, 0x05040100, s32
    s_mov_b32 s33, 0x03020c0c
    s_cselect_b32 s33, 0x01000c0c, s33
    s_mov_b32 s35, 0x3d2aaaab
    s_mov_b32 s36, 0x3c638e39
    s_mov_b32 s25, 0xffff0000
    ds_write_b128 v96, v[64:67] offset:57344
    ds_write_b128 v97, v[68:71] offset:8192
    ds_write_b128 v97, v[72:75] offset:24576
    ds_write_b128 v96, v[48:51] offset:8192
    ds_write_b128 v96, v[52:55] offset:24576
    ds_write_b128 v96, v[56:59] offset:40960
    ds_write_b128 v98, v[60:63] offset:8704
    s_waitcnt lgkmcnt(0)
    s_barrier
    s_waitcnt vmcnt(24)
    v_perm_b32 v72, v17, v16, s32
    v_perm_b32 v48, v41, v40, s32
    v_perm_b32 v76, v76, v40, s33
    v_perm_b32 v84, v84, v41, s33
    v_perm_b32 v77, v77, v32, s33
    v_perm_b32 v85, v85, v33, s33
    v_perm_b32 v78, v78, v24, s33
    v_perm_b32 v86, v86, v25, s33
    v_perm_b32 v79, v79, v16, s33
    v_perm_b32 v87, v87, v17, s33
    v_add_f32 v80, v76, v78
    v_add_f32 v88, v84, v86
    v_add_f32 v81, v77, v79
    v_add_f32 v89, v85, v87
    v_fma_f32 v82, v78, 4.0, v76
    v_fma_f32 v90, v86, 4.0, v84
    v_fma_f32 v83, v79, 4.0, v77
    v_fma_f32 v91, v87, 4.0, v85
    v_add_f32 v77, v80, v81
    v_add_f32 v85, v88, v89
    v_sub_f32 v78, v80, v81
    v_sub_f32 v86, v88, v89
    v_fma_f32 v79, v83, 2.0, v82
    v_fma_f32 v87, v91, 2.0, v90
    v_fma_f32 v82, v83, -2.0, v82
    v_fma_f32 v90, v91, -2.0, v90
    v_fmamk_f32 v80, v76, 0x41700000, v82
    v_fmamk_f32 v88, v84, 0x41700000, v90
    v_fmamk_f32 v80, v81, 0x41200000, v80
    v_fmamk_f32 v88, v89, 0x41200000, v88
    v_mul_f32 v77, 0.5, v77
    v_mul_f32 v85, 0.5, v85
    v_mul_f32 v78, 0.5, v78
    v_mul_f32 v86, 0.5, v86
    v_mul_f32 v79, s35, v79
    v_mul_f32 v87, s35, v87
    v_mul_f32 v82, s35, v82
    v_mul_f32 v90, s35, v90
    v_mul_f32 v80, s36, v80
    v_mul_f32 v88, s36, v88
    v_cvt_pk_bf16_f32 v52, v77, v85
    v_cvt_pk_bf16_f32 v56, v78, v86
    v_cvt_pk_bf16_f32 v60, v79, v87
    v_cvt_pk_bf16_f32 v64, v82, v90
    v_cvt_pk_bf16_f32 v68, v80, v88
    s_waitcnt vmcnt(16)
    v_perm_b32 v73, v19, v18, s32
    v_perm_b32 v49, v43, v42, s32
    v_perm_b32 v76, v76, v42, s33
    v_perm_b32 v84, v84, v43, s33
    v_perm_b32 v77, v77, v34, s33
    v_perm_b32 v85, v85, v35, s33
    v_perm_b32 v78, v78, v26, s33
    v_perm_b32 v86, v86, v27, s33
    v_perm_b32 v79, v79, v18, s33
    v_perm_b32 v87, v87, v19, s33
    v_add_f32 v80, v76, v78
    v_add_f32 v88, v84, v86
    v_add_f32 v81, v77, v79
    v_add_f32 v89, v85, v87
    v_fma_f32 v82, v78, 4.0, v76
    v_fma_f32 v90, v86, 4.0, v84
    v_fma_f32 v83, v79, 4.0, v77
    v_fma_f32 v91, v87, 4.0, v85
    v_add_f32 v77, v80, v81
    v_add_f32 v85, v88, v89
    v_sub_f32 v78, v80, v81
    v_sub_f32 v86, v88, v89
    v_fma_f32 v79, v83, 2.0, v82
    v_fma_f32 v87, v91, 2.0, v90
    v_fma_f32 v82, v83, -2.0, v82
    v_fma_f32 v90, v91, -2.0, v90
    v_fmamk_f32 v80, v76, 0x41700000, v82
    v_fmamk_f32 v88, v84, 0x41700000, v90
    v_fmamk_f32 v80, v81, 0x41200000, v80
    v_fmamk_f32 v88, v89, 0x41200000, v88
    v_mul_f32 v77, 0.5, v77
    v_mul_f32 v85, 0.5, v85
    v_mul_f32 v78, 0.5, v78
    v_mul_f32 v86, 0.5, v86
    v_mul_f32 v79, s35, v79
    v_mul_f32 v87, s35, v87
    v_mul_f32 v82, s35, v82
    v_mul_f32 v90, s35, v90
    v_mul_f32 v80, s36, v80
    v_mul_f32 v88, s36, v88
    v_cvt_pk_bf16_f32 v53, v77, v85
    v_cvt_pk_bf16_f32 v57, v78, v86
    v_cvt_pk_bf16_f32 v61, v79, v87
    v_cvt_pk_bf16_f32 v65, v82, v90
    v_cvt_pk_bf16_f32 v69, v80, v88
    s_waitcnt vmcnt(8)
    v_perm_b32 v74, v21, v20, s32
    v_perm_b32 v50, v45, v44, s32
    v_perm_b32 v76, v76, v44, s33
    v_perm_b32 v84, v84, v45, s33
    v_perm_b32 v77, v77, v36, s33
    v_perm_b32 v85, v85, v37, s33
    v_perm_b32 v78, v78, v28, s33
    v_perm_b32 v86, v86, v29, s33
    v_perm_b32 v79, v79, v20, s33
    v_perm_b32 v87, v87, v21, s33
    v_add_f32 v80, v76, v78
    v_add_f32 v88, v84, v86
    v_add_f32 v81, v77, v79
    v_add_f32 v89, v85, v87
    v_fma_f32 v82, v78, 4.0, v76
    v_fma_f32 v90, v86, 4.0, v84
    v_fma_f32 v83, v79, 4.0, v77
    v_fma_f32 v91, v87, 4.0, v85
    v_add_f32 v77, v80, v81
    v_add_f32 v85, v88, v89
    v_sub_f32 v78, v80, v81
    v_sub_f32 v86, v88, v89
    v_fma_f32 v79, v83, 2.0, v82
    v_fma_f32 v87, v91, 2.0, v90
    v_fma_f32 v82, v83, -2.0, v82
    v_fma_f32 v90, v91, -2.0, v90
    v_fmamk_f32 v80, v76, 0x41700000, v82
    v_fmamk_f32 v88, v84, 0x41700000, v90
    v_fmamk_f32 v80, v81, 0x41200000, v80
    v_fmamk_f32 v88, v89, 0x41200000, v88
    v_mul_f32 v77, 0.5, v77
    v_mul_f32 v85, 0.5, v85
    v_mul_f32 v78, 0.5, v78
    v_mul_f32 v86, 0.5, v86
    v_mul_f32 v79, s35, v79
    v_mul_f32 v87, s35, v87
    v_mul_f32 v82, s35, v82
    v_mul_f32 v90, s35, v90
    v_mul_f32 v80, s36, v80
    v_mul_f32 v88, s36, v88
    v_cvt_pk_bf16_f32 v54, v77, v85
    v_cvt_pk_bf16_f32 v58, v78, v86
    v_cvt_pk_bf16_f32 v62, v79, v87
    v_cvt_pk_bf16_f32 v66, v82, v90
    v_cvt_pk_bf16_f32 v70, v80, v88
    s_waitcnt vmcnt(0)
    v_perm_b32 v75, v23, v22, s32
    v_perm_b32 v51, v47, v46, s32
    v_perm_b32 v76, v76, v46, s33
    v_perm_b32 v84, v84, v47, s33
    v_perm_b32 v77, v77, v38, s33
    v_perm_b32 v85, v85, v39, s33
    v_perm_b32 v78, v78, v30, s33
    v_perm_b32 v86, v86, v31, s33
    v_perm_b32 v79, v79, v22, s33
    v_perm_b32 v87, v87, v23, s33
    v_add_f32 v80, v76, v78
    v_add_f32 v88, v84, v86
    v_add_f32 v81, v77, v79
    v_add_f32 v89, v85, v87
    v_fma_f32 v82, v78, 4.0, v76
    v_fma_f32 v90, v86, 4.0, v84
    v_fma_f32 v83, v79, 4.0, v77
    v_fma_f32 v91, v87, 4.0, v85
    v_add_f32 v77, v80, v81
    v_add_f32 v85, v88, v89
    v_sub_f32 v78, v80, v81
    v_sub_f32 v86, v88, v89
    v_fma_f32 v79, v83, 2.0, v82
    v_fma_f32 v87, v91, 2.0, v90
    v_fma_f32 v82, v83, -2.0, v82
    v_fma_f32 v90, v91, -2.0, v90
    v_fmamk_f32 v80, v76, 0x41700000, v82
    v_fmamk_f32 v88, v84, 0x41700000, v90
    v_fmamk_f32 v80, v81, 0x41200000, v80
    v_fmamk_f32 v88, v89, 0x41200000, v88
    v_mul_f32 v77, 0.5, v77
    v_mul_f32 v85, 0.5, v85
    v_mul_f32 v78, 0.5, v78
    v_mul_f32 v86, 0.5, v86
    v_mul_f32 v79, s35, v79
    v_mul_f32 v87, s35, v87
    v_mul_f32 v82, s35, v82
    v_mul_f32 v90, s35, v90
    v_mul_f32 v80, s36, v80
    v_mul_f32 v88, s36, v88
    v_cvt_pk_bf16_f32 v55, v77, v85
    v_cvt_pk_bf16_f32 v59, v78, v86
    v_cvt_pk_bf16_f32 v63, v79, v87
    v_cvt_pk_bf16_f32 v67, v82, v90
    v_cvt_pk_bf16_f32 v71, v80, v88
    s_add_u32 s28, s27, 49152
    buffer_store_dwordx4 v[72:75], v4, s[12:15], s28 offen sc1
    s_add_u32 s28, s27, 0
    buffer_store_dwordx4 v[48:51], v4, s[12:15], s28 offen sc1
    s_add_u32 s28, s27, 8192
    buffer_store_dwordx4 v[52:55], v4, s[12:15], s28 offen sc1
    s_add_u32 s28, s27, 16384
    buffer_store_dwordx4 v[56:59], v4, s[12:15], s28 offen sc1
    s_add_u32 s28, s27, 24576
    buffer_store_dwordx4 v[60:63], v4, s[12:15], s28 offen sc1
    s_add_u32 s28, s27, 32768
    buffer_store_dwordx4 v[64:67], v4, s[12:15], s28 offen sc1
    s_add_u32 s28, s27, 40960
    buffer_store_dwordx4 v[68:71], v4, s[12:15], s28 offen sc1
    s_mov_b32 s20, s58
    s_barrier
    s_endpgm
L_conv1_kernel_mw:
    s_add_u32 s37, s41, 524288
    v_lshl_add_u32 v108, v127, 4, s37
    v_add_u32 v109, 1024, v108
    v_add_u32 v110, 2048, v108
    s_waitcnt lgkmcnt(0)
    s_add_u32 s8, s4, s47
    s_addc_u32 s9, s5, 0
    s_lshl_b32 s36, s29, 4
    s_lshl_b32 s37, s33, 3
    s_add_u32 s36, s36, s37
    s_mul_i32 s36, s36, 57344
    s_add_u32 s36, s36, 0
    s_add_u32 s12, s30, s36
    s_addc_u32 s13, s31, 0
    s_mov_b32 s14, 917504
    s_mov_b32 s15, 0x00020000
    s_mul_i32 s36, s35, 4194304
    s_add_u32 s36, s36, 18874368
    s_add_u32 s16, s30, s36
    s_addc_u32 s17, s31, 0
    s_mov_b32 s18, 4194304
    s_mov_b32 s19, 0x00020000
    v_and_b32 v10, 15, v127
    v_lshrrev_b32 v11, 4, v127
    v_add_u32 v8, 0, v10
    v_and_b32 v16, 4, v8
    v_lshrrev_b32 v16, 1, v16
    v_xor_b32 v16, v11, v16
    v_lshlrev_b32 v16, 4, v16
    v_lshl_add_u32 v8, v8, 6, v16
    v_add_u32 v9, 1, v10
    v_and_b32 v16, 4, v9
    v_lshrrev_b32 v16, 1, v16
    v_xor_b32 v16, v11, v16
    v_lshlrev_b32 v16, 4, v16
    v_lshl_add_u32 v9, v9, 6, v16
    s_lshr_b32 s38, s32, 1
    s_and_b32 s39, s32, 1
    s_add_u32 s40, s38, 4
    s_lshl_b32 s43, s39, 10
    s_cmp_lt_u32 s20, 4
    s_cselect_b32 s40, s20, s40
    s_cselect_b32 s36, 0, s43
    s_lshl_b32 s37, s40, 13
    s_add_u32 s37, s37, s36
    v_lshl_add_u32 v125, v127, 4, s37
    s_mul_i32 s37, s40, 16384
    v_add_u32 v120, s37, v8
    v_add_u32 v121, s37, v9
    s_lshl_b32 s37, s40, 10
    s_add_u32 s37, s37, 115712
    v_lshl_add_u32 v16, v11, 4, s37
    v_cmp_eq_u32 vcc, 15, v10
    v_mov_b32 v17, 8192
    v_mov_b32 v18, 4294959104
    v_mov_b32 v19, 64
    v_cndmask_b32 v122, v121, v16, vcc
    v_cndmask_b32 v123, v17, v19, vcc
    v_cndmask_b32 v124, v18, v19, vcc
    v_lshl_add_u32 v126, v127, 4, s37
    s_mov_b32 s44, 0x3f800000
    s_mov_b32 s45, 0x00000000
    s_mov_b32 s46, 0x00000000
    s_cmp_eq_u32 s40, 1
    s_cselect_b32 s45, 0x3f800000, s45
    s_cselect_b32 s46, 0x3f800000, s46
    s_cmp_eq_u32 s40, 2
    s_cselect_b32 s45, 0xbf800000, s45
    s_cselect_b32 s46, 0x3f800000, s46
    s_cmp_eq_u32 s40, 3
    s_cselect_b32 s45, 0x40000000, s45
    s_cselect_b32 s46, 0x40800000, s46
    s_cmp_eq_u32 s40, 4
    s_cselect_b32 s45, 0xc0000000, s45
    s_cselect_b32 s46, 0x40800000, s46
    s_cmp_eq_u32 s40, 5
    s_cselect_b32 s44, 0x41800000, s44
    s_cselect_b32 s45, 0x41000000, s45
    s_cselect_b32 s46, 0x40800000, s46
    s_cmp_ge_u32 s20, 4
    s_cbranch_scc1 L_conv1_kernel_m2
    v_mov_b32 v0, 0
    v_mov_b32 v1, 0
    v_mov_b32 v2, 0
    v_mov_b32 v3, 0
    v_mov_b32 v4, 0
    v_mov_b32 v5, 0
    v_mov_b32 v6, 0
    v_mov_b32 v7, 0
    v_mov_b32 v8, 0
    v_mov_b32 v9, 0
    v_mov_b32 v10, 0
    v_mov_b32 v11, 0
    v_mov_b32 v12, 0
    v_mov_b32 v13, 0
    v_mov_b32 v14, 0
    v_mov_b32 v15, 0
    v_mov_b32 v16, 0
    v_mov_b32 v17, 0
    v_mov_b32 v18, 0
    v_mov_b32 v19, 0
    v_mov_b32 v20, 0
    v_mov_b32 v21, 0
    v_mov_b32 v22, 0
    v_mov_b32 v23, 0
    v_mov_b32 v24, 0
    v_mov_b32 v25, 0
    v_mov_b32 v26, 0
    v_mov_b32 v27, 0
    v_mov_b32 v28, 0
    v_mov_b32 v29, 0
    v_mov_b32 v30, 0
    v_mov_b32 v31, 0
    v_mov_b32 v32, 0
    v_mov_b32 v33, 0
    v_mov_b32 v34, 0
    v_mov_b32 v35, 0
    v_mov_b32 v36, 0
    v_mov_b32 v37, 0
    v_mov_b32 v38, 0
    v_mov_b32 v39, 0
    v_mov_b32 v40, 0
    v_mov_b32 v41, 0
    v_mov_b32 v42, 0
    v_mov_b32 v43, 0
    v_mov_b32 v44, 0
    v_mov_b32 v45, 0
    v_mov_b32 v46, 0
    v_mov_b32 v47, 0
    v_mov_b32 v48, 0
    v_mov_b32 v49, 0
    v_mov_b32 v50, 0
    v_mov_b32 v51, 0
    v_mov_b32 v52, 0
    v_mov_b32 v53, 0
    v_mov_b32 v54, 0
    v_mov_b32 v55, 0
    v_mov_b32 v56, 0
    v_mov_b32 v57, 0
    v_mov_b32 v58, 0
    v_mov_b32 v59, 0
    v_mov_b32 v60, 0
    v_mov_b32 v61, 0
    v_mov_b32 v62, 0
    v_mov_b32 v63, 0
    buffer_load_dwordx4 v[96:99], v108, s[8:11], 0 offen
    buffer_load_dwordx4 v[100:103], v109, s[8:11], 0 offen
    buffer_load_dwordx4 v[104:107], v110, s[8:11], 0 offen
    s_mov_b32 s23, 0
    s_mov_b32 s26, 4096
    buffer_load_dwordx4 v[64:67], v125, s[12:15], s23 offen offset:0
    buffer_load_dwordx4 v[68:71], v125, s[12:15], s23 offen offset:1024
    buffer_load_dwordx4 v[72:75], v125, s[12:15], s23 offen offset:2048
    buffer_load_dwordx4 v[76:79], v125, s[12:15], s23 offen offset:3072
    buffer_load_dwordx4 v[80:83], v125, s[12:15], s26 offen offset:0
    buffer_load_dwordx4 v[84:87], v125, s[12:15], s26 offen offset:1024
    buffer_load_dwordx4 v[88:91], v125, s[12:15], s26 offen offset:2048
    buffer_load_dwordx4 v[92:95], v125, s[12:15], s26 offen offset:3072
    s_mov_b32 s23, 57344
    s_mov_b32 s26, 61440
    s_waitcnt vmcnt(8)
    v_lshlrev_b32 v108, 16, v96
    v_and_b32 v111, s25, v96
    v_lshlrev_b32 v109, 16, v100
    v_and_b32 v112, s25, v100
    v_lshlrev_b32 v110, 16, v104
    v_and_b32 v113, s25, v104
    v_mul_f32 v114, s44, v108
    v_mul_f32 v115, s44, v111
    v_fmac_f32 v114, s45, v109
    v_fmac_f32 v115, s45, v112
    v_fmac_f32 v114, s46, v110
    v_fmac_f32 v115, s46, v113
    v_cvt_pk_bf16_f32 v96, v114, v115
    v_lshlrev_b32 v108, 16, v97
    v_and_b32 v111, s25, v97
    v_lshlrev_b32 v109, 16, v101
    v_and_b32 v112, s25, v101
    v_lshlrev_b32 v110, 16, v105
    v_and_b32 v113, s25, v105
    v_mul_f32 v114, s44, v108
    v_mul_f32 v115, s44, v111
    v_fmac_f32 v114, s45, v109
    v_fmac_f32 v115, s45, v112
    v_fmac_f32 v114, s46, v110
    v_fmac_f32 v115, s46, v113
    v_cvt_pk_bf16_f32 v97, v114, v115
    v_lshlrev_b32 v108, 16, v98
    v_and_b32 v111, s25, v98
    v_lshlrev_b32 v109, 16, v102
    v_and_b32 v112, s25, v102
    v_lshlrev_b32 v110, 16, v106
    v_and_b32 v113, s25, v106
    v_mul_f32 v114, s44, v108
    v_mul_f32 v115, s44, v111
    v_fmac_f32 v114, s45, v109
    v_fmac_f32 v115, s45, v112
    v_fmac_f32 v114, s46, v110
    v_fmac_f32 v115, s46, v113
    v_cvt_pk_bf16_f32 v98, v114, v115
    v_lshlrev_b32 v108, 16, v99
    v_and_b32 v111, s25, v99
    v_lshlrev_b32 v109, 16, v103
    v_and_b32 v112, s25, v103
    v_lshlrev_b32 v110, 16, v107
    v_and_b32 v113, s25, v107
    v_mul_f32 v114, s44, v108
    v_mul_f32 v115, s44, v111
    v_fmac_f32 v114, s45, v109
    v_fmac_f32 v115, s45, v112
    v_fmac_f32 v114, s46, v110
    v_fmac_f32 v115, s46, v113
    v_cvt_pk_bf16_f32 v99, v114, v115
    ds_write_b128 v126, v[96:99]
    s_waitcnt lgkmcnt(0)
    s_barrier
    s_mov_b32 s22, 8
    s_setprio 2
    s_nop 0
L_conv1_kernel_mloop1:
    ds_read_b128 v[96:99], v120 offset:0
    ds_read_b128 v[100:103], v120 offset:1024
    ds_read_b128 v[104:107], v120 offset:2048
    ds_read_b128 v[108:111], v120 offset:3072
    ds_read_b128 v[112:115], v120 offset:4096
    ds_read_b128 v[116:119], v120 offset:5120
    s_waitcnt vmcnt(6) lgkmcnt(5)
    s_nop 0
    v_mfma_f32_16x16x32_bf16 v[0:3], v[64:67], v[96:99], v[0:3]
    v_mfma_f32_16x16x32_bf16 v[32:35], v[68:71], v[96:99], v[32:35]
    ds_read_b128 v[96:99], v120 offset:6144
    s_waitcnt vmcnt(4) lgkmcnt(5)
    s_nop 0
    v_mfma_f32_16x16x32_bf16 v[4:7], v[64:67], v[100:103], v[4:7]
    v_mfma_f32_16x16x32_bf16 v[36:39], v[68:71], v[100:103], v[36:39]
    v_mfma_f32_16x16x32_bf16 v[0:3], v[72:75], v[100:103], v[0:3]
    v_mfma_f32_16x16x32_bf16 v[32:35], v[76:79], v[100:103], v[32:35]
    ds_read_b128 v[100:103], v120 offset:7168
    s_waitcnt vmcnt(2) lgkmcnt(5)
    s_nop 0
    v_mfma_f32_16x16x32_bf16 v[8:11], v[64:67], v[104:107], v[8:11]
    v_mfma_f32_16x16x32_bf16 v[40:43], v[68:71], v[104:107], v[40:43]
    v_mfma_f32_16x16x32_bf16 v[4:7], v[72:75], v[104:107], v[4:7]
    v_mfma_f32_16x16x32_bf16 v[36:39], v[76:79], v[104:107], v[36:39]
    v_mfma_f32_16x16x32_bf16 v[0:3], v[80:83], v[104:107], v[0:3]
    v_mfma_f32_16x16x32_bf16 v[32:35], v[84:87], v[104:107], v[32:35]
    ds_read_b128 v[104:107], v122 offset:0
    v_add_u32 v122, v123, v122
    s_waitcnt vmcnt(0) lgkmcnt(5)
    v_mfma_f32_16x16x32_bf16 v[12:15], v[64:67], v[108:111], v[12:15]
    v_mfma_f32_16x16x32_bf16 v[44:47], v[68:71], v[108:111], v[44:47]
    v_mfma_f32_16x16x32_bf16 v[8:11], v[72:75], v[108:111], v[8:11]
    v_mfma_f32_16x16x32_bf16 v[40:43], v[76:79], v[108:111], v[40:43]
    v_mfma_f32_16x16x32_bf16 v[4:7], v[80:83], v[108:111], v[4:7]
    v_mfma_f32_16x16x32_bf16 v[36:39], v[84:87], v[108:111], v[36:39]
    v_mfma_f32_16x16x32_bf16 v[0:3], v[88:91], v[108:111], v[0:3]
    v_mfma_f32_16x16x32_bf16 v[32:35], v[92:95], v[108:111], v[32:35]
    ds_read_b128 v[108:111], v121 offset:1024
    s_waitcnt lgkmcnt(5)
    s_nop 0
    v_mfma_f32_16x16x32_bf16 v[16:19], v[64:67], v[112:115], v[16:19]
    v_mfma_f32_16x16x32_bf16 v[48:51], v[68:71], v[112:115], v[48:51]
    v_mfma_f32_16x16x32_bf16 v[12:15], v[72:75], v[112:115], v[12:15]
    v_mfma_f32_16x16x32_bf16 v[44:47], v[76:79], v[112:115], v[44:47]
    v_mfma_f32_16x16x32_bf16 v[8:11], v[80:83], v[112:115], v[8:11]
    v_mfma_f32_16x16x32_bf16 v[40:43], v[84:87], v[112:115], v[40:43]
    v_mfma_f32_16x16x32_bf16 v[4:7], v[88:91], v[112:115], v[4:7]
    v_mfma_f32_16x16x32_bf16 v[36:39], v[92:95], v[112:115], v[36:39]
    ds_read_b128 v[112:115], v121 offset:2048
    s_waitcnt lgkmcnt(5)
    s_nop 0
    v_mfma_f32_16x16x32_bf16 v[20:23], v[64:67], v[116:119], v[20:23]
    v_mfma_f32_16x16x32_bf16 v[52:55], v[68:71], v[116:119], v[52:55]
    v_mfma_f32_16x16x32_bf16 v[16:19], v[72:75], v[116:119], v[16:19]
    v_mfma_f32_16x16x32_bf16 v[48:51], v[76:79], v[116:119], v[48:51]
    v_mfma_f32_16x16x32_bf16 v[12:15], v[80:83], v[116:119], v[12:15]
    v_mfma_f32_16x16x32_bf16 v[44:47], v[84:87], v[116:119], v[44:47]
    v_mfma_f32_16x16x32_bf16 v[8:11], v[88:91], v[116:119], v[8:11]
    v_mfma_f32_16x16x32_bf16 v[40:43], v[92:95], v[116:119], v[40:43]
    s_waitcnt lgkmcnt(4)
    s_nop 0
    v_mfma_f32_16x16x32_bf16 v[24:27], v[64:67], v[96:99], v[24:27]
    v_mfma_f32_16x16x32_bf16 v[56:59], v[68:71], v[96:99], v[56:59]
    v_mfma_f32_16x16x32_bf16 v[20:23], v[72:75], v[96:99], v[20:23]
    v_mfma_f32_16x16x32_bf16 v[52:55], v[76:79], v[96:99], v[52:55]
    v_mfma_f32_16x16x32_bf16 v[16:19], v[80:83], v[96:99], v[16:19]
    v_mfma_f32_16x16x32_bf16 v[48:51], v[84:87], v[96:99], v[48:51]
    v_mfma_f32_16x16x32_bf16 v[12:15], v[88:91], v[96:99], v[12:15]
    v_mfma_f32_16x16x32_bf16 v[44:47], v[92:95], v[96:99], v[44:47]
    s_waitcnt lgkmcnt(3)
    s_nop 0
    v_mfma_f32_16x16x32_bf16 v[28:31], v[64:67], v[100:103], v[28:31]
    v_mfma_f32_16x16x32_bf16 v[60:63], v[68:71], v[100:103], v[60:63]
    v_mfma_f32_16x16x32_bf16 v[24:27], v[72:75], v[100:103], v[24:27]
    v_mfma_f32_16x16x32_bf16 v[56:59], v[76:79], v[100:103], v[56:59]
    v_mfma_f32_16x16x32_bf16 v[20:23], v[80:83], v[100:103], v[20:23]
    v_mfma_f32_16x16x32_bf16 v[52:55], v[84:87], v[100:103], v[52:55]
    v_mfma_f32_16x16x32_bf16 v[16:19], v[88:91], v[100:103], v[16:19]
    v_mfma_f32_16x16x32_bf16 v[48:51], v[92:95], v[100:103], v[48:51]
    buffer_load_dwordx4 v[64:67], v125, s[12:15], s23 offen offset:0
    buffer_load_dwordx4 v[68:71], v125, s[12:15], s23 offen offset:1024
    s_waitcnt lgkmcnt(2)
    s_nop 0
    v_mfma_f32_16x16x32_bf16 v[28:31], v[72:75], v[104:107], v[28:31]
    v_mfma_f32_16x16x32_bf16 v[60:63], v[76:79], v[104:107], v[60:63]
    v_mfma_f32_16x16x32_bf16 v[24:27], v[80:83], v[104:107], v[24:27]
    v_mfma_f32_16x16x32_bf16 v[56:59], v[84:87], v[104:107], v[56:59]
    v_mfma_f32_16x16x32_bf16 v[20:23], v[88:91], v[104:107], v[20:23]
    v_mfma_f32_16x16x32_bf16 v[52:55], v[92:95], v[104:107], v[52:55]
    buffer_load_dwordx4 v[72:75], v125, s[12:15], s23 offen offset:2048
    buffer_load_dwordx4 v[76:79], v125, s[12:15], s23 offen offset:3072
    s_waitcnt lgkmcnt(1)
    s_nop 0
    v_mfma_f32_16x16x32_bf16 v[28:31], v[80:83], v[108:111], v[28:31]
    v_mfma_f32_16x16x32_bf16 v[60:63], v[84:87], v[108:111], v[60:63]
    v_mfma_f32_16x16x32_bf16 v[24:27], v[88:91], v[108:111], v[24:27]
    v_mfma_f32_16x16x32_bf16 v[56:59], v[92:95], v[108:111], v[56:59]
    buffer_load_dwordx4 v[80:83], v125, s[12:15], s26 offen offset:0
    buffer_load_dwordx4 v[84:87], v125, s[12:15], s26 offen offset:1024
    s_waitcnt lgkmcnt(0)
    s_nop 0
    v_mfma_f32_16x16x32_bf16 v[28:31], v[88:91], v[112:115], v[28:31]
    v_mfma_f32_16x16x32_bf16 v[60:63], v[92:95], v[112:115], v[60:63]
    buffer_load_dwordx4 v[88:91], v125, s[12:15], s26 offen offset:2048
    buffer_load_dwordx4 v[92:95], v125, s[12:15], s26 offen offset:3072
    s_add_u32 s23, s23, 57344
    s_add_u32 s26, s26, 57344
    s_barrier
    s_sub_u32 s22, s22, 1
    s_cmp_eq_u32 s22, 0
    s_cbranch_scc1 L_conv1_kernel_mlast1
    ds_read_b128 v[96:99], v120 offset:8192
    ds_read_b128 v[100:103], v120 offset:9216
    ds_read_b128 v[104:107], v120 offset:10240
    ds_read_b128 v[108:111], v120 offset:11264
    ds_read_b128 v[112:115], v120 offset:12288
    ds_read_b128 v[116:119], v120 offset:13312
    s_waitcnt vmcnt(6) lgkmcnt(5)
    s_nop 0
    v_mfma_f32_16x16x32_bf16 v[0:3], v[64:67], v[96:99], v[0:3]
    v_mfma_f32_16x16x32_bf16 v[32:35], v[68:71], v[96:99], v[32:35]
    ds_read_b128 v[96:99], v120 offset:14336
    s_waitcnt vmcnt(4) lgkmcnt(5)
    s_nop 0
    v_mfma_f32_16x16x32_bf16 v[4:7], v[64:67], v[100:103], v[4:7]
    v_mfma_f32_16x16x32_bf16 v[36:39], v[68:71], v[100:103], v[36:39]
    v_mfma_f32_16x16x32_bf16 v[0:3], v[72:75], v[100:103], v[0:3]
    v_mfma_f32_16x16x32_bf16 v[32:35], v[76:79], v[100:103], v[32:35]
    ds_read_b128 v[100:103], v120 offset:15360
    s_waitcnt vmcnt(2) lgkmcnt(5)
    s_nop 0
    v_mfma_f32_16x16x32_bf16 v[8:11], v[64:67], v[104:107], v[8:11]
    v_mfma_f32_16x16x32_bf16 v[40:43], v[68:71], v[104:107], v[40:43]
    v_mfma_f32_16x16x32_bf16 v[4:7], v[72:75], v[104:107], v[4:7]
    v_mfma_f32_16x16x32_bf16 v[36:39], v[76:79], v[104:107], v[36:39]
    v_mfma_f32_16x16x32_bf16 v[0:3], v[80:83], v[104:107], v[0:3]
    v_mfma_f32_16x16x32_bf16 v[32:35], v[84:87], v[104:107], v[32:35]
    ds_read_b128 v[104:107], v122 offset:0
    v_add_u32 v122, v124, v122
    s_waitcnt vmcnt(0) lgkmcnt(5)
    v_mfma_f32_16x16x32_bf16 v[12:15], v[64:67], v[108:111], v[12:15]
    v_mfma_f32_16x16x32_bf16 v[44:47], v[68:71], v[108:111], v[44:47]
    v_mfma_f32_16x16x32_bf16 v[8:11], v[72:75], v[108:111], v[8:11]
    v_mfma_f32_16x16x32_bf16 v[40:43], v[76:79], v[108:111], v[40:43]
    v_mfma_f32_16x16x32_bf16 v[4:7], v[80:83], v[108:111], v[4:7]
    v_mfma_f32_16x16x32_bf16 v[36:39], v[84:87], v[108:111], v[36:39]
    v_mfma_f32_16x16x32_bf16 v[0:3], v[88:91], v[108:111], v[0:3]
    v_mfma_f32_16x16x32_bf16 v[32:35], v[92:95], v[108:111], v[32:35]
    ds_read_b128 v[108:111], v121 offset:9216
    s_waitcnt lgkmcnt(5)
    s_nop 0
    v_mfma_f32_16x16x32_bf16 v[16:19], v[64:67], v[112:115], v[16:19]
    v_mfma_f32_16x16x32_bf16 v[48:51], v[68:71], v[112:115], v[48:51]
    v_mfma_f32_16x16x32_bf16 v[12:15], v[72:75], v[112:115], v[12:15]
    v_mfma_f32_16x16x32_bf16 v[44:47], v[76:79], v[112:115], v[44:47]
    v_mfma_f32_16x16x32_bf16 v[8:11], v[80:83], v[112:115], v[8:11]
    v_mfma_f32_16x16x32_bf16 v[40:43], v[84:87], v[112:115], v[40:43]
    v_mfma_f32_16x16x32_bf16 v[4:7], v[88:91], v[112:115], v[4:7]
    v_mfma_f32_16x16x32_bf16 v[36:39], v[92:95], v[112:115], v[36:39]
    ds_read_b128 v[112:115], v121 offset:10240
    s_waitcnt lgkmcnt(5)
    s_nop 0
    v_mfma_f32_16x16x32_bf16 v[20:23], v[64:67], v[116:119], v[20:23]
    v_mfma_f32_16x16x32_bf16 v[52:55], v[68:71], v[116:119], v[52:55]
    v_mfma_f32_16x16x32_bf16 v[16:19], v[72:75], v[116:119], v[16:19]
    v_mfma_f32_16x16x32_bf16 v[48:51], v[76:79], v[116:119], v[48:51]
    v_mfma_f32_16x16x32_bf16 v[12:15], v[80:83], v[116:119], v[12:15]
    v_mfma_f32_16x16x32_bf16 v[44:47], v[84:87], v[116:119], v[44:47]
    v_mfma_f32_16x16x32_bf16 v[8:11], v[88:91], v[116:119], v[8:11]
    v_mfma_f32_16x16x32_bf16 v[40:43], v[92:95], v[116:119], v[40:43]
    s_waitcnt lgkmcnt(4)
    s_nop 0
    v_mfma_f32_16x16x32_bf16 v[24:27], v[64:67], v[96:99], v[24:27]
    v_mfma_f32_16x16x32_bf16 v[56:59], v[68:71], v[96:99], v[56:59]
    v_mfma_f32_16x16x32_bf16 v[20:23], v[72:75], v[96:99], v[20:23]
    v_mfma_f32_16x16x32_bf16 v[52:55], v[76:79], v[96:99], v[52:55]
    v_mfma_f32_16x16x32_bf16 v[16:19], v[80:83], v[96:99], v[16:19]
    v_mfma_f32_16x16x32_bf16 v[48:51], v[84:87], v[96:99], v[48:51]
    v_mfma_f32_16x16x32_bf16 v[12:15], v[88:91], v[96:99], v[12:15]
    v_mfma_f32_16x16x32_bf16 v[44:47], v[92:95], v[96:99], v[44:47]
    s_waitcnt lgkmcnt(3)
    s_nop 0
    v_mfma_f32_16x16x32_bf16 v[28:31], v[64:67], v[100:103], v[28:31]
    v_mfma_f32_16x16x32_bf16 v[60:63], v[68:71], v[100:103], v[60:63]
    v_mfma_f32_16x16x32_bf16 v[24:27], v[72:75], v[100:103], v[24:27]
    v_mfma_f32_16x16x32_bf16 v[56:59], v[76:79], v[100:103], v[56:59]
    v_mfma_f32_16x16x32_bf16 v[20:23], v[80:83], v[100:103], v[20:23]
    v_mfma_f32_16x16x32_bf16 v[52:55], v[84:87], v[100:103], v[52:55]
    v_mfma_f32_16x16x32_bf16 v[16:19], v[88:91], v[100:103], v[16:19]
    v_mfma_f32_16x16x32_bf16 v[48:51], v[92:95], v[100:103], v[48:51]
    buffer_load_dwordx4 v[64:67], v125, s[12:15], s23 offen offset:0
    buffer_load_dwordx4 v[68:71], v125, s[12:15], s23 offen offset:1024
    s_waitcnt lgkmcnt(2)
    s_nop 0
    v_mfma_f32_16x16x32_bf16 v[28:31], v[72:75], v[104:107], v[28:31]
    v_mfma_f32_16x16x32_bf16 v[60:63], v[76:79], v[104:107], v[60:63]
    v_mfma_f32_16x16x32_bf16 v[24:27], v[80:83], v[104:107], v[24:27]
    v_mfma_f32_16x16x32_bf16 v[56:59], v[84:87], v[104:107], v[56:59]
    v_mfma_f32_16x16x32_bf16 v[20:23], v[88:91], v[104:107], v[20:23]
    v_mfma_f32_16x16x32_bf16 v[52:55], v[92:95], v[104:107], v[52:55]
    buffer_load_dwordx4 v[72:75], v125, s[12:15], s23 offen offset:2048
    buffer_load_dwordx4 v[76:79], v125, s[12:15], s23 offen offset:3072
    s_waitcnt lgkmcnt(1)
    s_nop 0
    v_mfma_f32_16x16x32_bf16 v[28:31], v[80:83], v[108:111], v[28:31]
    v_mfma_f32_16x16x32_bf16 v[60:63], v[84:87], v[108:111], v[60:63]
    v_mfma_f32_16x16x32_bf16 v[24:27], v[88:91], v[108:111], v[24:27]
    v_mfma_f32_16x16x32_bf16 v[56:59], v[92:95], v[108:111], v[56:59]
    buffer_load_dwordx4 v[80:83], v125, s[12:15], s26 offen offset:0
    buffer_load_dwordx4 v[84:87], v125, s[12:15], s26 offen offset:1024
    s_waitcnt lgkmcnt(0)
    s_nop 0
    v_mfma_f32_16x16x32_bf16 v[28:31], v[88:91], v[112:115], v[28:31]
    v_mfma_f32_16x16x32_bf16 v[60:63], v[92:95], v[112:115], v[60:63]
    buffer_load_dwordx4 v[88:91], v125, s[12:15], s26 offen offset:2048
    buffer_load_dwordx4 v[92:95], v125, s[12:15], s26 offen offset:3072
    s_add_u32 s23, s23, 57344
    s_add_u32 s26, s26, 57344
    s_barrier
    s_branch L_conv1_kernel_mloop1
L_conv1_kernel_mlast1:
    v_and_b32 v125, 15, v127
    v_and_b32 v126, 7, v127
    v_lshlrev_b32 v126, 4, v126
    v_lshl_add_u32 v125, v125, 7, v126
    v_lshrrev_b32 v126, 4, v127
    v_lshl_add_u32 v125, v126, 11, v125
    s_lshl_b32 s36, s20, 14
    s_add_u32 s37, s36, 8192
    v_add_u32 v126, s37, v125
    v_add_u32 v125, s36, v125
    ds_read_b128 v[96:99], v120 offset:8192
    ds_read_b128 v[100:103], v120 offset:9216
    ds_read_b128 v[104:107], v120 offset:10240
    ds_read_b128 v[108:111], v120 offset:11264
    ds_read_b128 v[112:115], v120 offset:12288
    ds_read_b128 v[116:119], v120 offset:13312
    s_waitcnt vmcnt(6) lgkmcnt(5)
    v_mfma_f32_16x16x32_bf16 v[0:3], v[64:67], v[96:99], v[0:3]
    v_mfma_f32_16x16x32_bf16 v[32:35], v[68:71], v[96:99], v[32:35]
    ds_read_b128 v[96:99], v120 offset:14336
    s_waitcnt vmcnt(4) lgkmcnt(5)
    v_mfma_f32_16x16x32_bf16 v[4:7], v[64:67], v[100:103], v[4:7]
    v_mfma_f32_16x16x32_bf16 v[36:39], v[68:71], v[100:103], v[36:39]
    v_mfma_f32_16x16x32_bf16 v[0:3], v[72:75], v[100:103], v[0:3]
    v_mfma_f32_16x16x32_bf16 v[32:35], v[76:79], v[100:103], v[32:35]
    ds_read_b128 v[100:103], v120 offset:15360
    s_waitcnt vmcnt(2) lgkmcnt(5)
    v_mfma_f32_16x16x32_bf16 v[8:11], v[64:67], v[104:107], v[8:11]
    v_mfma_f32_16x16x32_bf16 v[40:43], v[68:71], v[104:107], v[40:43]
    v_mfma_f32_16x16x32_bf16 v[4:7], v[72:75], v[104:107], v[4:7]
    v_mfma_f32_16x16x32_bf16 v[36:39], v[76:79], v[104:107], v[36:39]
    v_mfma_f32_16x16x32_bf16 v[0:3], v[80:83], v[104:107], v[0:3]
    v_mfma_f32_16x16x32_bf16 v[32:35], v[84:87], v[104:107], v[32:35]
    ds_read_b128 v[104:107], v122 offset:0
    s_waitcnt vmcnt(0) lgkmcnt(5)
    v_mfma_f32_16x16x32_bf16 v[12:15], v[64:67], v[108:111], v[12:15]
    v_mfma_f32_16x16x32_bf16 v[44:47], v[68:71], v[108:111], v[44:47]
    v_mfma_f32_16x16x32_bf16 v[8:11], v[72:75], v[108:111], v[8:11]
    v_mfma_f32_16x16x32_bf16 v[40:43], v[76:79], v[108:111], v[40:43]
    v_mfma_f32_16x16x32_bf16 v[4:7], v[80:83], v[108:111], v[4:7]
    v_mfma_f32_16x16x32_bf16 v[36:39], v[84:87], v[108:111], v[36:39]
    v_mfma_f32_16x16x32_bf16 v[0:3], v[88:91], v[108:111], v[0:3]
    v_mfma_f32_16x16x32_bf16 v[32:35], v[92:95], v[108:111], v[32:35]
    ds_read_b128 v[108:111], v121 offset:9216
    s_waitcnt lgkmcnt(5)
    v_mfma_f32_16x16x32_bf16 v[16:19], v[64:67], v[112:115], v[16:19]
    v_mfma_f32_16x16x32_bf16 v[48:51], v[68:71], v[112:115], v[48:51]
    v_mfma_f32_16x16x32_bf16 v[12:15], v[72:75], v[112:115], v[12:15]
    v_mfma_f32_16x16x32_bf16 v[44:47], v[76:79], v[112:115], v[44:47]
    v_mfma_f32_16x16x32_bf16 v[8:11], v[80:83], v[112:115], v[8:11]
    v_mfma_f32_16x16x32_bf16 v[40:43], v[84:87], v[112:115], v[40:43]
    v_mfma_f32_16x16x32_bf16 v[4:7], v[88:91], v[112:115], v[4:7]
    v_mfma_f32_16x16x32_bf16 v[36:39], v[92:95], v[112:115], v[36:39]
    ds_read_b128 v[112:115], v121 offset:10240
    v_xor_b32 v123, 0, v125
    ds_write_b128 v123, v[0:3]
    s_waitcnt lgkmcnt(6)
    v_mfma_f32_16x16x32_bf16 v[20:23], v[64:67], v[116:119], v[20:23]
    v_mfma_f32_16x16x32_bf16 v[52:55], v[68:71], v[116:119], v[52:55]
    v_mfma_f32_16x16x32_bf16 v[16:19], v[72:75], v[116:119], v[16:19]
    v_mfma_f32_16x16x32_bf16 v[48:51], v[76:79], v[116:119], v[48:51]
    v_mfma_f32_16x16x32_bf16 v[12:15], v[80:83], v[116:119], v[12:15]
    v_mfma_f32_16x16x32_bf16 v[44:47], v[84:87], v[116:119], v[44:47]
    v_mfma_f32_16x16x32_bf16 v[8:11], v[88:91], v[116:119], v[8:11]
    v_mfma_f32_16x16x32_bf16 v[40:43], v[92:95], v[116:119], v[40:43]
    v_xor_b32 v124, 16, v125
    ds_write_b128 v124, v[4:7]
    s_waitcnt lgkmcnt(2)
    v_mfma_f32_16x16x32_bf16 v[24:27], v[64:67], v[96:99], v[24:27]
    v_mfma_f32_16x16x32_bf16 v[56:59], v[68:71], v[96:99], v[56:59]
    v_mfma_f32_16x16x32_bf16 v[20:23], v[72:75], v[96:99], v[20:23]
    v_mfma_f32_16x16x32_bf16 v[52:55], v[76:79], v[96:99], v[52:55]
    v_mfma_f32_16x16x32_bf16 v[16:19], v[80:83], v[96:99], v[16:19]
    v_mfma_f32_16x16x32_bf16 v[48:51], v[84:87], v[96:99], v[48:51]
    v_mfma_f32_16x16x32_bf16 v[12:15], v[88:91], v[96:99], v[12:15]
    v_mfma_f32_16x16x32_bf16 v[44:47], v[92:95], v[96:99], v[44:47]
    v_xor_b32 v123, 32, v125
    ds_write_b128 v123, v[8:11]
    v_xor_b32 v124, 0, v126
    ds_write_b128 v124, v[32:35]
    v_mfma_f32_16x16x32_bf16 v[28:31], v[64:67], v[100:103], v[28:31]
    v_mfma_f32_16x16x32_bf16 v[60:63], v[68:71], v[100:103], v[60:63]
    v_mfma_f32_16x16x32_bf16 v[24:27], v[72:75], v[100:103], v[24:27]
    v_mfma_f32_16x16x32_bf16 v[56:59], v[76:79], v[100:103], v[56:59]
    v_mfma_f32_16x16x32_bf16 v[20:23], v[80:83], v[100:103], v[20:23]
    v_mfma_f32_16x16x32_bf16 v[52:55], v[84:87], v[100:103], v[52:55]
    v_mfma_f32_16x16x32_bf16 v[16:19], v[88:91], v[100:103], v[16:19]
    v_mfma_f32_16x16x32_bf16 v[48:51], v[92:95], v[100:103], v[48:51]
    v_xor_b32 v123, 16, v126
    ds_write_b128 v123, v[36:39]
    v_xor_b32 v124, 32, v126
    ds_write_b128 v124, v[40:43]
    v_mfma_f32_16x16x32_bf16 v[28:31], v[72:75], v[104:107], v[28:31]
    v_mfma_f32_16x16x32_bf16 v[60:63], v[76:79], v[104:107], v[60:63]
    v_mfma_f32_16x16x32_bf16 v[24:27], v[80:83], v[104:107], v[24:27]
    v_mfma_f32_16x16x32_bf16 v[56:59], v[84:87], v[104:107], v[56:59]
    v_mfma_f32_16x16x32_bf16 v[20:23], v[88:91], v[104:107], v[20:23]
    v_mfma_f32_16x16x32_bf16 v[52:55], v[92:95], v[104:107], v[52:55]
    v_xor_b32 v124, 48, v125
    ds_write_b128 v124, v[12:15]
    v_xor_b32 v123, 48, v126
    ds_write_b128 v123, v[44:47]
    v_mfma_f32_16x16x32_bf16 v[28:31], v[80:83], v[108:111], v[28:31]
    v_mfma_f32_16x16x32_bf16 v[60:63], v[84:87], v[108:111], v[60:63]
    v_mfma_f32_16x16x32_bf16 v[24:27], v[88:91], v[108:111], v[24:27]
    v_mfma_f32_16x16x32_bf16 v[56:59], v[92:95], v[108:111], v[56:59]
    v_xor_b32 v123, 64, v125
    ds_write_b128 v123, v[16:19]
    v_xor_b32 v124, 64, v126
    ds_write_b128 v124, v[48:51]
    v_mfma_f32_16x16x32_bf16 v[28:31], v[88:91], v[112:115], v[28:31]
    v_mfma_f32_16x16x32_bf16 v[60:63], v[92:95], v[112:115], v[60:63]
    v_xor_b32 v124, 80, v125
    ds_write_b128 v124, v[20:23]
    v_xor_b32 v123, 80, v126
    ds_write_b128 v123, v[52:55]
    v_and_b32 v108, 15, v127
    v_lshrrev_b32 v109, 4, v127
    v_lshrrev_b32 v110, 3, v108
    s_lshl_b32 s36, s20, 1
    v_add_u32 v110, s36, v110
    v_xor_b32 v111, v110, v108
    v_and_b32 v111, 7, v111
    v_lshlrev_b32 v111, 4, v111
    v_xor_b32 v123, 96, v125
    ds_write_b128 v123, v[24:27]
    v_lshl_add_u32 v111, v110, 7, v111
    v_lshl_add_u32 v120, v109, 11, v111
    v_add_u32 v121, 65536, v120
    v_add_u32 v64, 131072, v120
    s_lshl_b32 s36, s20, 9
    s_add_u32 s36, s36, 115712
    v_lshl_add_u32 v127, v109, 7, s36
    s_lshl_b32 s36, s20, 4
    v_add_u32 v108, s36, v108
    v_lshlrev_b32 v110, 6, v108
    v_lshl_add_u32 v110, v109, 4, v110
    s_mul_i32 s36, s29, 524288
    v_xor_b32 v124, 96, v126
    ds_write_b128 v124, v[56:59]
    s_lshl_b32 s37, s21, 4
    s_add_u32 s36, s36, s37
    v_add_u32 v110, s36, v110
    v_mov_b32 v111, 2130706432
    v_cmp_gt_u32 vcc, 125, v108
    s_mov_b32 s4, 0xbeaaaaab
    s_mov_b32 s5, s4
    s_mov_b32 s6, 0x3e800000
    s_mov_b32 s7, s6
    s_mov_b32 s8, 0xc0a00000
    s_mov_b32 s9, s8
    s_mov_b32 s10, 0xc0638e39
    v_xor_b32 v124, 112, v125
    ds_write_b128 v124, v[28:31]
    s_mov_b32 s11, s10
    s_mov_b32 s12, 0xbf638e39
    s_mov_b32 s13, s12
    s_mov_b32 s14, 0xbe638e39
    s_mov_b32 s15, s14
    s_mov_b32 s22, 0xbd638e39
    s_mov_b32 s23, s22
    s_mov_b32 s24, 0x3ff1c71c
    s_mov_b32 s25, s24
    s_mov_b32 s26, 0xbf2aaaab
    s_mov_b32 s27, s26
    s_mov_b32 s32, 0x3ecccccd
    v_xor_b32 v123, 112, v126
    s_waitcnt lgkmcnt(8)
    ds_write_b128 v123, v[60:63]
    s_mov_b32 s33, s32
    s_mov_b32 s34, 0xbd888889
    s_mov_b32 s35, s34
    s_mov_b32 s38, 0xbe4ccccd
    s_mov_b32 s39, s38
    s_mov_b32 s40, 0xbdd2d3e8
    s_mov_b32 s41, s40
    s_mov_b32 s42, 0x3f800000
    s_mov_b32 s43, s42
    s_setprio 0
    s_branch L_conv1_kernel_epi
L_conv1_kernel_m2:
    s_mul_i32 s37, s38, 2176
    s_add_u32 s37, s37, 98304
    v_add_u32 v116, s37, v8
    v_add_u32 v118, s37, v9
    v_add_u32 v117, 104832, v8
    s_cmp_eq_u32 s38, 0
    s_cbranch_scc1 L_conv1_kernel_hh0
    v_add_u32 v117, 98304, v9
L_conv1_kernel_hh0:
    s_lshl_b32 s37, s38, 12
    s_add_u32 s37, s37, s43
    s_add_u32 s37, s37, 49152
    v_lshl_add_u32 v119, v127, 4, s37
    v_mov_b32 v0, 0
    v_mov_b32 v1, 0
    v_mov_b32 v2, 0
    v_mov_b32 v3, 0
    v_mov_b32 v4, 0
    v_mov_b32 v5, 0
    v_mov_b32 v6, 0
    v_mov_b32 v7, 0
    v_mov_b32 v8, 0
    v_mov_b32 v9, 0
    v_mov_b32 v10, 0
    v_mov_b32 v11, 0
    v_mov_b32 v12, 0
    v_mov_b32 v13, 0
    v_mov_b32 v14, 0
    v_mov_b32 v15, 0
    v_mov_b32 v16, 0
    v_mov_b32 v17, 0
    v_mov_b32 v18, 0
    v_mov_b32 v19, 0
    v_mov_b32 v20, 0
    v_mov_b32 v21, 0
    v_mov_b32 v22, 0
    v_mov_b32 v23, 0
    v_mov_b32 v24, 0
    v_mov_b32 v25, 0
    v_mov_b32 v26, 0
    v_mov_b32 v27, 0
    v_mov_b32 v28, 0
    v_mov_b32 v29, 0
    v_mov_b32 v30, 0
    v_mov_b32 v31, 0
    v_mov_b32 v32, 0
    v_mov_b32 v33, 0
    v_mov_b32 v34, 0
    v_mov_b32 v35, 0
    v_mov_b32 v36, 0
    v_mov_b32 v37, 0
    v_mov_b32 v38, 0
    v_mov_b32 v39, 0
    v_mov_b32 v40, 0
    v_mov_b32 v41, 0
    v_mov_b32 v42, 0
    v_mov_b32 v43, 0
    v_mov_b32 v44, 0
    v_mov_b32 v45, 0
    v_mov_b32 v46, 0
    v_mov_b32 v47, 0
    v_mov_b32 v48, 0
    v_mov_b32 v49, 0
    v_mov_b32 v50, 0
    v_mov_b32 v51, 0
    v_mov_b32 v52, 0
    v_mov_b32 v53, 0
    v_mov_b32 v54, 0
    v_mov_b32 v55, 0
    v_mov_b32 v56, 0
    v_mov_b32 v57, 0
    v_mov_b32 v58, 0
    v_mov_b32 v59, 0
    v_mov_b32 v60, 0
    v_mov_b32 v61, 0
    v_mov_b32 v62, 0
    v_mov_b32 v63, 0
    buffer_load_dwordx4 v[96:99], v108, s[8:11], 0 offen
    buffer_load_dwordx4 v[100:103], v109, s[8:11], 0 offen
    buffer_load_dwordx4 v[104:107], v110, s[8:11], 0 offen
    s_mov_b32 s23, 0
    s_mov_b32 s26, 4096
    buffer_load_dwordx4 v[64:67], v125, s[12:15], s23 offen offset:0
    buffer_load_dwordx4 v[68:71], v125, s[12:15], s23 offen offset:2048
    buffer_load_dwordx4 v[80:83], v119, s[12:15], s23 offen offset:0
    buffer_load_dwordx4 v[72:75], v125, s[12:15], s26 offen offset:0
    buffer_load_dwordx4 v[84:87], v119, s[12:15], s23 offen offset:2048
    buffer_load_dwordx4 v[76:79], v125, s[12:15], s26 offen offset:2048
    s_mov_b32 s23, 57344
    s_mov_b32 s26, 61440
    s_waitcnt vmcnt(6)
    v_lshlrev_b32 v108, 16, v96
    v_and_b32 v111, s25, v96
    v_lshlrev_b32 v109, 16, v100
    v_and_b32 v112, s25, v100
    v_lshlrev_b32 v110, 16, v104
    v_and_b32 v113, s25, v104
    v_mul_f32 v114, s44, v108
    v_mul_f32 v115, s44, v111
    v_fmac_f32 v114, s45, v109
    v_fmac_f32 v115, s45, v112
    v_fmac_f32 v114, s46, v110
    v_fmac_f32 v115, s46, v113
    v_cvt_pk_bf16_f32 v96, v114, v115
    v_lshlrev_b32 v108, 16, v97
    v_and_b32 v111, s25, v97
    v_lshlrev_b32 v109, 16, v101
    v_and_b32 v112, s25, v101
    v_lshlrev_b32 v110, 16, v105
    v_and_b32 v113, s25, v105
    v_mul_f32 v114, s44, v108
    v_mul_f32 v115, s44, v111
    v_fmac_f32 v114, s45, v109
    v_fmac_f32 v115, s45, v112
    v_fmac_f32 v114, s46, v110
    v_fmac_f32 v115, s46, v113
    v_cvt_pk_bf16_f32 v97, v114, v115
    v_lshlrev_b32 v108, 16, v98
    v_and_b32 v111, s25, v98
    v_lshlrev_b32 v109, 16, v102
    v_and_b32 v112, s25, v102
    v_lshlrev_b32 v110, 16, v106
    v_and_b32 v113, s25, v106
    v_mul_f32 v114, s44, v108
    v_mul_f32 v115, s44, v111
    v_fmac_f32 v114, s45, v109
    v_fmac_f32 v115, s45, v112
    v_fmac_f32 v114, s46, v110
    v_fmac_f32 v115, s46, v113
    v_cvt_pk_bf16_f32 v98, v114, v115
    v_lshlrev_b32 v108, 16, v99
    v_and_b32 v111, s25, v99
    v_lshlrev_b32 v109, 16, v103
    v_and_b32 v112, s25, v103
    v_lshlrev_b32 v110, 16, v107
    v_and_b32 v113, s25, v107
    v_mul_f32 v114, s44, v108
    v_mul_f32 v115, s44, v111
    v_fmac_f32 v114, s45, v109
    v_fmac_f32 v115, s45, v112
    v_fmac_f32 v114, s46, v110
    v_fmac_f32 v115, s46, v113
    v_cvt_pk_bf16_f32 v99, v114, v115
    ds_write_b128 v126, v[96:99]
    v_and_b32 v111, 15, v127
    v_lshlrev_b32 v111, 2, v111
    v_add_u32 v111, 99328, v111
    ds_write_b32 v111, v0
    ds_write_b32 v111, v0 offset:8704
    s_waitcnt lgkmcnt(0)
    s_barrier
    s_mov_b32 s22, 8
    s_setprio 2
L_conv1_kernel_mloop2:
    ds_read_b128 v[88:91], v120 offset:0
    ds_read_b128 v[92:95], v120 offset:1024
    ds_read_b128 v[96:99], v116 offset:0
    ds_read_b128 v[100:103], v120 offset:2048
    ds_read_b128 v[104:107], v116 offset:1088
    ds_read_b128 v[108:111], v120 offset:3072
    ds_read_b128 v[112:115], v116 offset:2176
    s_waitcnt vmcnt(5) lgkmcnt(6)
    v_mfma_f32_16x16x32_bf16 v[0:3], v[64:67], v[88:91], v[0:3]
    ds_read_b128 v[88:91], v120 offset:4096
    s_waitcnt vmcnt(4) lgkmcnt(6)
    v_mfma_f32_16x16x32_bf16 v[4:7], v[64:67], v[92:95], v[4:7]
    v_mfma_f32_16x16x32_bf16 v[0:3], v[68:71], v[92:95], v[0:3]
    ds_read_b128 v[92:95], v116 offset:3264
    s_waitcnt vmcnt(3) lgkmcnt(6)
    v_mfma_f32_16x16x32_bf16 v[32:35], v[80:83], v[96:99], v[32:35]
    ds_read_b128 v[96:99], v120 offset:5120
    s_waitcnt vmcnt(2) lgkmcnt(6)
    v_mfma_f32_16x16x32_bf16 v[8:11], v[64:67], v[100:103], v[8:11]
    v_mfma_f32_16x16x32_bf16 v[4:7], v[68:71], v[100:103], v[4:7]
    v_mfma_f32_16x16x32_bf16 v[0:3], v[72:75], v[100:103], v[0:3]
    ds_read_b128 v[100:103], v116 offset:4352
    s_waitcnt vmcnt(1) lgkmcnt(6)
    v_mfma_f32_16x16x32_bf16 v[36:39], v[80:83], v[104:107], v[36:39]
    v_mfma_f32_16x16x32_bf16 v[32:35], v[84:87], v[104:107], v[32:35]
    ds_read_b128 v[104:107], v120 offset:6144
    s_waitcnt vmcnt(0) lgkmcnt(6)
    v_mfma_f32_16x16x32_bf16 v[12:15], v[64:67], v[108:111], v[12:15]
    v_mfma_f32_16x16x32_bf16 v[8:11], v[68:71], v[108:111], v[8:11]
    v_mfma_f32_16x16x32_bf16 v[4:7], v[72:75], v[108:111], v[4:7]
    v_mfma_f32_16x16x32_bf16 v[0:3], v[76:79], v[108:111], v[0:3]
    ds_read_b128 v[108:111], v116 offset:5440
    s_waitcnt lgkmcnt(6)
    v_mfma_f32_16x16x32_bf16 v[40:43], v[80:83], v[112:115], v[40:43]
    v_mfma_f32_16x16x32_bf16 v[36:39], v[84:87], v[112:115], v[36:39]
    ds_read_b128 v[112:115], v120 offset:7168
    s_waitcnt lgkmcnt(6)
    v_mfma_f32_16x16x32_bf16 v[16:19], v[64:67], v[88:91], v[16:19]
    v_mfma_f32_16x16x32_bf16 v[12:15], v[68:71], v[88:91], v[12:15]
    v_mfma_f32_16x16x32_bf16 v[8:11], v[72:75], v[88:91], v[8:11]
    v_mfma_f32_16x16x32_bf16 v[4:7], v[76:79], v[88:91], v[4:7]
    ds_read_b128 v[88:91], v117 offset:0
    s_waitcnt lgkmcnt(6)
    v_mfma_f32_16x16x32_bf16 v[44:47], v[80:83], v[92:95], v[44:47]
    v_mfma_f32_16x16x32_bf16 v[40:43], v[84:87], v[92:95], v[40:43]
    ds_read_b128 v[92:95], v122 offset:0
    v_add_u32 v122, v123, v122
    s_waitcnt lgkmcnt(6)
    v_mfma_f32_16x16x32_bf16 v[20:23], v[64:67], v[96:99], v[20:23]
    v_mfma_f32_16x16x32_bf16 v[16:19], v[68:71], v[96:99], v[16:19]
    v_mfma_f32_16x16x32_bf16 v[12:15], v[72:75], v[96:99], v[12:15]
    v_mfma_f32_16x16x32_bf16 v[8:11], v[76:79], v[96:99], v[8:11]
    ds_read_b128 v[96:99], v117 offset:1088
    s_waitcnt lgkmcnt(6)
    v_mfma_f32_16x16x32_bf16 v[48:51], v[80:83], v[100:103], v[48:51]
    v_mfma_f32_16x16x32_bf16 v[44:47], v[84:87], v[100:103], v[44:47]
    ds_read_b128 v[100:103], v121 offset:1024
    s_waitcnt lgkmcnt(6)
    v_mfma_f32_16x16x32_bf16 v[24:27], v[64:67], v[104:107], v[24:27]
    v_mfma_f32_16x16x32_bf16 v[20:23], v[68:71], v[104:107], v[20:23]
    v_mfma_f32_16x16x32_bf16 v[16:19], v[72:75], v[104:107], v[16:19]
    v_mfma_f32_16x16x32_bf16 v[12:15], v[76:79], v[104:107], v[12:15]
    ds_read_b128 v[104:107], v118 offset:0
    s_waitcnt lgkmcnt(6)
    v_mfma_f32_16x16x32_bf16 v[52:55], v[80:83], v[108:111], v[52:55]
    v_mfma_f32_16x16x32_bf16 v[48:51], v[84:87], v[108:111], v[48:51]
    ds_read_b128 v[108:111], v121 offset:2048
    s_waitcnt lgkmcnt(6)
    v_mfma_f32_16x16x32_bf16 v[28:31], v[64:67], v[112:115], v[28:31]
    v_mfma_f32_16x16x32_bf16 v[24:27], v[68:71], v[112:115], v[24:27]
    v_mfma_f32_16x16x32_bf16 v[20:23], v[72:75], v[112:115], v[20:23]
    v_mfma_f32_16x16x32_bf16 v[16:19], v[76:79], v[112:115], v[16:19]
    buffer_load_dwordx4 v[64:67], v125, s[12:15], s23 offen offset:0
    s_waitcnt lgkmcnt(5)
    v_mfma_f32_16x16x32_bf16 v[56:59], v[80:83], v[88:91], v[56:59]
    v_mfma_f32_16x16x32_bf16 v[52:55], v[84:87], v[88:91], v[52:55]
    s_waitcnt lgkmcnt(0)
    s_barrier
    v_mfma_f32_16x16x32_bf16 v[28:31], v[68:71], v[92:95], v[28:31]
    v_mfma_f32_16x16x32_bf16 v[24:27], v[72:75], v[92:95], v[24:27]
    v_mfma_f32_16x16x32_bf16 v[20:23], v[76:79], v[92:95], v[20:23]
    buffer_load_dwordx4 v[68:71], v125, s[12:15], s23 offen offset:2048
    v_mfma_f32_16x16x32_bf16 v[60:63], v[80:83], v[96:99], v[60:63]
    v_mfma_f32_16x16x32_bf16 v[56:59], v[84:87], v[96:99], v[56:59]
    buffer_load_dwordx4 v[80:83], v119, s[12:15], s23 offen offset:0
    v_mfma_f32_16x16x32_bf16 v[28:31], v[72:75], v[100:103], v[28:31]
    v_mfma_f32_16x16x32_bf16 v[24:27], v[76:79], v[100:103], v[24:27]
    buffer_load_dwordx4 v[72:75], v125, s[12:15], s26 offen offset:0
    v_mfma_f32_16x16x32_bf16 v[60:63], v[84:87], v[104:107], v[60:63]
    buffer_load_dwordx4 v[84:87], v119, s[12:15], s23 offen offset:2048
    v_mfma_f32_16x16x32_bf16 v[28:31], v[76:79], v[108:111], v[28:31]
    buffer_load_dwordx4 v[76:79], v125, s[12:15], s26 offen offset:2048
    s_add_u32 s23, s23, 57344
    s_add_u32 s26, s26, 57344
    s_sub_u32 s22, s22, 1
    s_cmp_eq_u32 s22, 0
    s_cbranch_scc1 L_conv1_kernel_mlast2
    ds_read_b128 v[88:91], v120 offset:8192
    ds_read_b128 v[92:95], v120 offset:9216
    ds_read_b128 v[96:99], v116 offset:8704
    ds_read_b128 v[100:103], v120 offset:10240
    ds_read_b128 v[104:107], v116 offset:9792
    ds_read_b128 v[108:111], v120 offset:11264
    ds_read_b128 v[112:115], v116 offset:10880
    s_waitcnt vmcnt(5) lgkmcnt(6)
    v_mfma_f32_16x16x32_bf16 v[0:3], v[64:67], v[88:91], v[0:3]
    ds_read_b128 v[88:91], v120 offset:12288
    s_waitcnt vmcnt(4) lgkmcnt(6)
    v_mfma_f32_16x16x32_bf16 v[4:7], v[64:67], v[92:95], v[4:7]
    v_mfma_f32_16x16x32_bf16 v[0:3], v[68:71], v[92:95], v[0:3]
    ds_read_b128 v[92:95], v116 offset:11968
    s_waitcnt vmcnt(3) lgkmcnt(6)
    v_mfma_f32_16x16x32_bf16 v[32:35], v[80:83], v[96:99], v[32:35]
    ds_read_b128 v[96:99], v120 offset:13312
    s_waitcnt vmcnt(2) lgkmcnt(6)
    v_mfma_f32_16x16x32_bf16 v[8:11], v[64:67], v[100:103], v[8:11]
    v_mfma_f32_16x16x32_bf16 v[4:7], v[68:71], v[100:103], v[4:7]
    v_mfma_f32_16x16x32_bf16 v[0:3], v[72:75], v[100:103], v[0:3]
    ds_read_b128 v[100:103], v116 offset:13056
    s_waitcnt vmcnt(1) lgkmcnt(6)
    v_mfma_f32_16x16x32_bf16 v[36:39], v[80:83], v[104:107], v[36:39]
    v_mfma_f32_16x16x32_bf16 v[32:35], v[84:87], v[104:107], v[32:35]
    ds_read_b128 v[104:107], v120 offset:14336
    s_waitcnt vmcnt(0) lgkmcnt(6)
    v_mfma_f32_16x16x32_bf16 v[12:15], v[64:67], v[108:111], v[12:15]
    v_mfma_f32_16x16x32_bf16 v[8:11], v[68:71], v[108:111], v[8:11]
    v_mfma_f32_16x16x32_bf16 v[4:7], v[72:75], v[108:111], v[4:7]
    v_mfma_f32_16x16x32_bf16 v[0:3], v[76:79], v[108:111], v[0:3]
    ds_read_b128 v[108:111], v116 offset:14144
    s_waitcnt lgkmcnt(6)
    v_mfma_f32_16x16x32_bf16 v[40:43], v[80:83], v[112:115], v[40:43]
    v_mfma_f32_16x16x32_bf16 v[36:39], v[84:87], v[112:115], v[36:39]
    ds_read_b128 v[112:115], v120 offset:15360
    s_waitcnt lgkmcnt(6)
    v_mfma_f32_16x16x32_bf16 v[16:19], v[64:67], v[88:91], v[16:19]
    v_mfma_f32_16x16x32_bf16 v[12:15], v[68:71], v[88:91], v[12:15]
    v_mfma_f32_16x16x32_bf16 v[8:11], v[72:75], v[88:91], v[8:11]
    v_mfma_f32_16x16x32_bf16 v[4:7], v[76:79], v[88:91], v[4:7]
    ds_read_b128 v[88:91], v117 offset:8704
    s_waitcnt lgkmcnt(6)
    v_mfma_f32_16x16x32_bf16 v[44:47], v[80:83], v[92:95], v[44:47]
    v_mfma_f32_16x16x32_bf16 v[40:43], v[84:87], v[92:95], v[40:43]
    ds_read_b128 v[92:95], v122 offset:0
    v_add_u32 v122, v124, v122
    s_waitcnt lgkmcnt(6)
    v_mfma_f32_16x16x32_bf16 v[20:23], v[64:67], v[96:99], v[20:23]
    v_mfma_f32_16x16x32_bf16 v[16:19], v[68:71], v[96:99], v[16:19]
    v_mfma_f32_16x16x32_bf16 v[12:15], v[72:75], v[96:99], v[12:15]
    v_mfma_f32_16x16x32_bf16 v[8:11], v[76:79], v[96:99], v[8:11]
    ds_read_b128 v[96:99], v117 offset:9792
    s_waitcnt lgkmcnt(6)
    v_mfma_f32_16x16x32_bf16 v[48:51], v[80:83], v[100:103], v[48:51]
    v_mfma_f32_16x16x32_bf16 v[44:47], v[84:87], v[100:103], v[44:47]
    ds_read_b128 v[100:103], v121 offset:9216
    s_waitcnt lgkmcnt(6)
    v_mfma_f32_16x16x32_bf16 v[24:27], v[64:67], v[104:107], v[24:27]
    v_mfma_f32_16x16x32_bf16 v[20:23], v[68:71], v[104:107], v[20:23]
    v_mfma_f32_16x16x32_bf16 v[16:19], v[72:75], v[104:107], v[16:19]
    v_mfma_f32_16x16x32_bf16 v[12:15], v[76:79], v[104:107], v[12:15]
    ds_read_b128 v[104:107], v118 offset:8704
    s_waitcnt lgkmcnt(6)
    v_mfma_f32_16x16x32_bf16 v[52:55], v[80:83], v[108:111], v[52:55]
    v_mfma_f32_16x16x32_bf16 v[48:51], v[84:87], v[108:111], v[48:51]
    ds_read_b128 v[108:111], v121 offset:10240
    s_waitcnt lgkmcnt(6)
    v_mfma_f32_16x16x32_bf16 v[28:31], v[64:67], v[112:115], v[28:31]
    v_mfma_f32_16x16x32_bf16 v[24:27], v[68:71], v[112:115], v[24:27]
    v_mfma_f32_16x16x32_bf16 v[20:23], v[72:75], v[112:115], v[20:23]
    v_mfma_f32_16x16x32_bf16 v[16:19], v[76:79], v[112:115], v[16:19]
    buffer_load_dwordx4 v[64:67], v125, s[12:15], s23 offen offset:0
    s_waitcnt lgkmcnt(5)
    v_mfma_f32_16x16x32_bf16 v[56:59], v[80:83], v[88:91], v[56:59]
    v_mfma_f32_16x16x32_bf16 v[52:55], v[84:87], v[88:91], v[52:55]
    s_waitcnt lgkmcnt(0)
    s_barrier
    v_mfma_f32_16x16x32_bf16 v[28:31], v[68:71], v[92:95], v[28:31]
    v_mfma_f32_16x16x32_bf16 v[24:27], v[72:75], v[92:95], v[24:27]
    v_mfma_f32_16x16x32_bf16 v[20:23], v[76:79], v[92:95], v[20:23]
    buffer_load_dwordx4 v[68:71], v125, s[12:15], s23 offen offset:2048
    v_mfma_f32_16x16x32_bf16 v[60:63], v[80:83], v[96:99], v[60:63]
    v_mfma_f32_16x16x32_bf16 v[56:59], v[84:87], v[96:99], v[56:59]
    buffer_load_dwordx4 v[80:83], v119, s[12:15], s23 offen offset:0
    v_mfma_f32_16x16x32_bf16 v[28:31], v[72:75], v[100:103], v[28:31]
    v_mfma_f32_16x16x32_bf16 v[24:27], v[76:79], v[100:103], v[24:27]
    buffer_load_dwordx4 v[72:75], v125, s[12:15], s26 offen offset:0
    v_mfma_f32_16x16x32_bf16 v[60:63], v[84:87], v[104:107], v[60:63]
    buffer_load_dwordx4 v[84:87], v119, s[12:15], s23 offen offset:2048
    v_mfma_f32_16x16x32_bf16 v[28:31], v[76:79], v[108:111], v[28:31]
    buffer_load_dwordx4 v[76:79], v125, s[12:15], s26 offen offset:2048
    s_add_u32 s23, s23, 57344
    s_add_u32 s26, s26, 57344
    s_branch L_conv1_kernel_mloop2
L_conv1_kernel_mlast2:
    v_and_b32 v125, 15, v127
    v_and_b32 v126, 7, v127
    v_lshlrev_b32 v126, 4, v126
    v_lshl_add_u32 v125, v125, 7, v126
    v_lshrrev_b32 v126, 4, v127
    v_lshl_add_u32 v125, v126, 11, v125
    s_mov_b32 s36, 65536
    s_cmp_eq_u32 s32, 1
    s_cselect_b32 s36, 121856, s36
    s_cmp_eq_u32 s32, 2
    s_cselect_b32 s36, 81920, s36
    s_cmp_eq_u32 s32, 3
    s_cselect_b32 s36, 130048, s36
    s_mov_b32 s37, 98304
    s_cmp_eq_u32 s32, 1
    s_cselect_b32 s37, 138240, s37
    s_cmp_eq_u32 s32, 2
    s_cselect_b32 s37, 146432, s37
    s_cmp_eq_u32 s32, 3
    s_cselect_b32 s37, 154624, s37
    v_add_u32 v126, s37, v125
    v_add_u32 v125, s36, v125
    ds_read_b128 v[88:91], v120 offset:8192
    ds_read_b128 v[92:95], v120 offset:9216
    ds_read_b128 v[96:99], v116 offset:8704
    ds_read_b128 v[100:103], v120 offset:10240
    ds_read_b128 v[104:107], v116 offset:9792
    ds_read_b128 v[108:111], v120 offset:11264
    ds_read_b128 v[112:115], v116 offset:10880
    s_waitcnt vmcnt(5) lgkmcnt(6)
    v_mfma_f32_16x16x32_bf16 v[0:3], v[64:67], v[88:91], v[0:3]
    ds_read_b128 v[88:91], v120 offset:12288
    s_waitcnt vmcnt(4) lgkmcnt(6)
    v_mfma_f32_16x16x32_bf16 v[4:7], v[64:67], v[92:95], v[4:7]
    v_mfma_f32_16x16x32_bf16 v[0:3], v[68:71], v[92:95], v[0:3]
    ds_read_b128 v[92:95], v116 offset:11968
    s_waitcnt vmcnt(3) lgkmcnt(6)
    v_mfma_f32_16x16x32_bf16 v[32:35], v[80:83], v[96:99], v[32:35]
    ds_read_b128 v[96:99], v120 offset:13312
    s_waitcnt vmcnt(2) lgkmcnt(6)
    v_mfma_f32_16x16x32_bf16 v[8:11], v[64:67], v[100:103], v[8:11]
    v_mfma_f32_16x16x32_bf16 v[4:7], v[68:71], v[100:103], v[4:7]
    v_mfma_f32_16x16x32_bf16 v[0:3], v[72:75], v[100:103], v[0:3]
    ds_read_b128 v[100:103], v116 offset:13056
    s_waitcnt vmcnt(1) lgkmcnt(6)
    v_mfma_f32_16x16x32_bf16 v[36:39], v[80:83], v[104:107], v[36:39]
    v_mfma_f32_16x16x32_bf16 v[32:35], v[84:87], v[104:107], v[32:35]
    ds_read_b128 v[104:107], v120 offset:14336
    s_waitcnt vmcnt(0) lgkmcnt(6)
    v_mfma_f32_16x16x32_bf16 v[12:15], v[64:67], v[108:111], v[12:15]
    v_mfma_f32_16x16x32_bf16 v[8:11], v[68:71], v[108:111], v[8:11]
    v_mfma_f32_16x16x32_bf16 v[4:7], v[72:75], v[108:111], v[4:7]
    v_mfma_f32_16x16x32_bf16 v[0:3], v[76:79], v[108:111], v[0:3]
    ds_read_b128 v[108:111], v116 offset:14144
    s_waitcnt lgkmcnt(6)
    v_mfma_f32_16x16x32_bf16 v[40:43], v[80:83], v[112:115], v[40:43]
    v_mfma_f32_16x16x32_bf16 v[36:39], v[84:87], v[112:115], v[36:39]
    ds_read_b128 v[112:115], v120 offset:15360
    s_waitcnt lgkmcnt(6)
    v_mfma_f32_16x16x32_bf16 v[16:19], v[64:67], v[88:91], v[16:19]
    v_mfma_f32_16x16x32_bf16 v[12:15], v[68:71], v[88:91], v[12:15]
    v_mfma_f32_16x16x32_bf16 v[8:11], v[72:75], v[88:91], v[8:11]
    v_mfma_f32_16x16x32_bf16 v[4:7], v[76:79], v[88:91], v[4:7]
    ds_read_b128 v[88:91], v117 offset:8704
    v_xor_b32 v124, 0, v126
    ds_write_b128 v124, v[32:35]
    s_waitcnt lgkmcnt(7)
    v_mfma_f32_16x16x32_bf16 v[44:47], v[80:83], v[92:95], v[44:47]
    v_mfma_f32_16x16x32_bf16 v[40:43], v[84:87], v[92:95], v[40:43]
    ds_read_b128 v[92:95], v122 offset:0
    v_xor_b32 v123, 0, v125
    ds_write_b128 v123, v[0:3]
    s_waitcnt lgkmcnt(8)
    v_mfma_f32_16x16x32_bf16 v[20:23], v[64:67], v[96:99], v[20:23]
    v_mfma_f32_16x16x32_bf16 v[16:19], v[68:71], v[96:99], v[16:19]
    v_mfma_f32_16x16x32_bf16 v[12:15], v[72:75], v[96:99], v[12:15]
    v_mfma_f32_16x16x32_bf16 v[8:11], v[76:79], v[96:99], v[8:11]
    ds_read_b128 v[96:99], v117 offset:9792
    v_xor_b32 v123, 16, v126
    ds_write_b128 v123, v[36:39]
    s_waitcnt lgkmcnt(9)
    v_mfma_f32_16x16x32_bf16 v[48:51], v[80:83], v[100:103], v[48:51]
    v_mfma_f32_16x16x32_bf16 v[44:47], v[84:87], v[100:103], v[44:47]
    ds_read_b128 v[100:103], v121 offset:9216
    v_xor_b32 v124, 16, v125
    ds_write_b128 v124, v[4:7]
    s_waitcnt lgkmcnt(10)
    v_mfma_f32_16x16x32_bf16 v[24:27], v[64:67], v[104:107], v[24:27]
    v_mfma_f32_16x16x32_bf16 v[20:23], v[68:71], v[104:107], v[20:23]
    v_mfma_f32_16x16x32_bf16 v[16:19], v[72:75], v[104:107], v[16:19]
    v_mfma_f32_16x16x32_bf16 v[12:15], v[76:79], v[104:107], v[12:15]
    ds_read_b128 v[104:107], v118 offset:8704
    v_xor_b32 v124, 32, v126
    ds_write_b128 v124, v[40:43]
    s_waitcnt lgkmcnt(11)
    v_mfma_f32_16x16x32_bf16 v[52:55], v[80:83], v[108:111], v[52:55]
    v_mfma_f32_16x16x32_bf16 v[48:51], v[84:87], v[108:111], v[48:51]
    ds_read_b128 v[108:111], v121 offset:10240
    v_xor_b32 v123, 32, v125
    ds_write_b128 v123, v[8:11]
    s_waitcnt lgkmcnt(12)
    v_mfma_f32_16x16x32_bf16 v[28:31], v[64:67], v[112:115], v[28:31]
    v_mfma_f32_16x16x32_bf16 v[24:27], v[68:71], v[112:115], v[24:27]
    v_mfma_f32_16x16x32_bf16 v[20:23], v[72:75], v[112:115], v[20:23]
    v_mfma_f32_16x16x32_bf16 v[16:19], v[76:79], v[112:115], v[16:19]
    v_xor_b32 v123, 48, v126
    ds_write_b128 v123, v[44:47]
    s_waitcnt lgkmcnt(12)
    v_mfma_f32_16x16x32_bf16 v[56:59], v[80:83], v[88:91], v[56:59]
    v_mfma_f32_16x16x32_bf16 v[52:55], v[84:87], v[88:91], v[52:55]
    v_xor_b32 v124, 48, v125
    ds_write_b128 v124, v[12:15]
    s_waitcnt lgkmcnt(11)
    v_mfma_f32_16x16x32_bf16 v[28:31], v[68:71], v[92:95], v[28:31]
    v_mfma_f32_16x16x32_bf16 v[24:27], v[72:75], v[92:95], v[24:27]
    v_mfma_f32_16x16x32_bf16 v[20:23], v[76:79], v[92:95], v[20:23]
    v_xor_b32 v124, 64, v126
    ds_write_b128 v124, v[48:51]
    s_waitcnt lgkmcnt(10)
    v_mfma_f32_16x16x32_bf16 v[60:63], v[80:83], v[96:99], v[60:63]
    v_mfma_f32_16x16x32_bf16 v[56:59], v[84:87], v[96:99], v[56:59]
    v_xor_b32 v123, 64, v125
    ds_write_b128 v123, v[16:19]
    s_waitcnt lgkmcnt(9)
    v_mfma_f32_16x16x32_bf16 v[28:31], v[72:75], v[100:103], v[28:31]
    v_mfma_f32_16x16x32_bf16 v[24:27], v[76:79], v[100:103], v[24:27]
    v_xor_b32 v123, 80, v126
    ds_write_b128 v123, v[52:55]
    s_waitcnt lgkmcnt(8)
    v_mfma_f32_16x16x32_bf16 v[60:63], v[84:87], v[104:107], v[60:63]
    v_xor_b32 v124, 80, v125
    ds_write_b128 v124, v[20:23]
    s_waitcnt lgkmcnt(7)
    v_mfma_f32_16x16x32_bf16 v[28:31], v[76:79], v[108:111], v[28:31]
    v_xor_b32 v124, 96, v126
    ds_write_b128 v124, v[56:59]
    v_and_b32 v108, 15, v127
    v_lshrrev_b32 v109, 4, v127
    v_lshrrev_b32 v110, 3, v108
    s_lshl_b32 s36, s20, 1
    v_add_u32 v110, s36, v110
    v_xor_b32 v111, v110, v108
    v_and_b32 v111, 7, v111
    v_lshlrev_b32 v111, 4, v111
    v_xor_b32 v123, 96, v125
    ds_write_b128 v123, v[24:27]
    v_lshl_add_u32 v111, v110, 7, v111
    v_lshl_add_u32 v120, v109, 11, v111
    v_add_u32 v121, 65536, v120
    v_add_u32 v64, 131072, v120
    s_lshl_b32 s36, s20, 9
    s_add_u32 s36, s36, 115712
    v_lshl_add_u32 v127, v109, 7, s36
    s_lshl_b32 s36, s20, 4
    v_add_u32 v108, s36, v108
    v_lshlrev_b32 v110, 6, v108
    v_lshl_add_u32 v110, v109, 4, v110
    s_mul_i32 s36, s29, 524288
    v_xor_b32 v123, 112, v126
    ds_write_b128 v123, v[60:63]
    s_lshl_b32 s37, s21, 4
    s_add_u32 s36, s36, s37
    v_add_u32 v110, s36, v110
    v_mov_b32 v111, 2130706432
    v_cmp_gt_u32 vcc, 125, v108
    s_mov_b32 s4, 0xbeaaaaab
    s_mov_b32 s5, s4
    s_mov_b32 s6, 0x3e800000
    s_mov_b32 s7, s6
    s_mov_b32 s8, 0xc0a00000
    s_mov_b32 s9, s8
    s_mov_b32 s10, 0xc0638e39
    v_xor_b32 v124, 112, v125
    ds_write_b128 v124, v[28:31]
    s_mov_b32 s11, s10
    s_mov_b32 s12, 0xbf638e39
    s_mov_b32 s13, s12
    s_mov_b32 s14, 0xbe638e39
    s_mov_b32 s15, s14
    s_mov_b32 s22, 0xbd638e39
    s_mov_b32 s23, s22
    s_mov_b32 s24, 0x3ff1c71c
    s_mov_b32 s25, s24
    s_mov_b32 s26, 0xbf2aaaab
    s_mov_b32 s27, s26
    s_mov_b32 s32, 0x3ecccccd
    s_mov_b32 s33, s32
    s_mov_b32 s34, 0xbd888889
    s_mov_b32 s35, s34
    s_mov_b32 s38, 0xbe4ccccd
    s_mov_b32 s39, s38
    s_mov_b32 s40, 0xbdd2d3e8
    s_mov_b32 s41, s40
    s_mov_b32 s42, 0x3f800000
    s_mov_b32 s43, s42
    s_setprio 0
    s_branch L_conv1_kernel_epi
L_conv1_kernel_epi:
    s_waitcnt lgkmcnt(0)
    s_barrier
    v_cndmask_b32 v122, v111, v110, vcc
    ds_read_b128 v[0:3], v120 offset:0
    ds_read_b128 v[4:7], v120 offset:16384
    ds_read_b128 v[8:11], v120 offset:32768
    ds_read_b128 v[12:15], v120 offset:49152
    ds_read_b128 v[16:19], v121 offset:0
    ds_read_b128 v[20:23], v121 offset:16384
    ds_read_b128 v[24:27], v121 offset:32768
    ds_read_b128 v[28:31], v64 offset:15360
    ds_read_b128 v[32:35], v120 offset:8192
    ds_read_b128 v[36:39], v120 offset:24576
    ds_read_b128 v[40:43], v120 offset:40960
    ds_read_b128 v[44:47], v120 offset:57344
    ds_read_b128 v[48:51], v121 offset:56320
    ds_read_b128 v[52:55], v121 offset:64512
    ds_read_b128 v[56:59], v64 offset:7168
    s_waitcnt lgkmcnt(7)
    ds_read_b128 v[60:63], v64 offset:23552
    s_waitcnt lgkmcnt(8)
    v_pk_add_f32 v[88:89], v[24:25], v[28:29]
    v_pk_add_f32 v[90:91], v[26:27], v[30:31]
    v_pk_add_f32 v[24:25], v[4:5], v[8:9]
    v_pk_add_f32 v[26:27], v[6:7], v[10:11]
    v_pk_add_f32 v[4:5], v[4:5], v[8:9] neg_lo:[0,1] neg_hi:[0,1]
    v_pk_add_f32 v[6:7], v[6:7], v[10:11] neg_lo:[0,1] neg_hi:[0,1]
    v_pk_add_f32 v[72:73], v[12:13], v[16:17]
    v_pk_add_f32 v[74:75], v[14:15], v[18:19]
    v_pk_add_f32 v[12:13], v[12:13], v[16:17] neg_lo:[0,1] neg_hi:[0,1]
    v_pk_add_f32 v[14:15], v[14:15], v[18:19] neg_lo:[0,1] neg_hi:[0,1]
    v_pk_fma_f32 v[72:73], v[24:25], s[4:5], v[72:73]
    v_pk_fma_f32 v[74:75], v[26:27], s[4:5], v[74:75]
    v_pk_fma_f32 v[20:21], v[0:1], s[10:11], v[20:21]
    v_pk_fma_f32 v[22:23], v[2:3], s[10:11], v[22:23]
    v_pk_fma_f32 v[72:73], v[0:1], s[6:7], v[72:73]
    v_pk_fma_f32 v[74:75], v[2:3], s[6:7], v[74:75]
    v_pk_add_f32 v[24:25], v[24:25], v[0:1] neg_lo:[0,1] neg_hi:[0,1]
    v_pk_add_f32 v[26:27], v[26:27], v[2:3] neg_lo:[0,1] neg_hi:[0,1]
    v_pk_fma_f32 v[72:73], v[88:89], s[8:9], v[72:73]
    v_pk_fma_f32 v[74:75], v[90:91], s[8:9], v[74:75]
    v_pk_add_f32 v[24:25], v[24:25], v[88:89] neg_lo:[0,1] neg_hi:[0,1]
    v_pk_add_f32 v[26:27], v[26:27], v[90:91] neg_lo:[0,1] neg_hi:[0,1]
    v_pk_fma_f32 v[20:21], v[88:89], s[22:23], v[20:21]
    v_pk_fma_f32 v[22:23], v[90:91], s[22:23], v[22:23]
    v_pk_add_f32 v[8:9], v[24:25], v[72:73] neg_lo:[0,1] neg_hi:[0,1]
    v_pk_add_f32 v[10:11], v[26:27], v[74:75] neg_lo:[0,1] neg_hi:[0,1]
    v_pk_fma_f32 v[20:21], v[72:73], s[14:15], v[20:21]
    v_pk_fma_f32 v[22:23], v[74:75], s[14:15], v[22:23]
    v_pk_mul_f32 v[80:81], v[12:13], s[32:33]
    v_pk_mul_f32 v[82:83], v[14:15], s[32:33]
    v_pk_fma_f32 v[20:21], v[8:9], s[12:13], v[20:21]
    v_pk_fma_f32 v[22:23], v[10:11], s[12:13], v[22:23]
    v_pk_fma_f32 v[80:81], v[4:5], s[34:35], v[80:81]
    v_pk_fma_f32 v[82:83], v[6:7], s[34:35], v[82:83]
    v_pk_fma_f32 v[64:65], v[4:5], s[24:25], v[20:21] neg_lo:[0,0,1] neg_hi:[0,0,1]
    v_pk_fma_f32 v[66:67], v[6:7], s[24:25], v[22:23] neg_lo:[0,0,1] neg_hi:[0,0,1]
    v_pk_fma_f32 v[64:65], v[12:13], s[26:27], v[64:65]
    v_pk_fma_f32 v[66:67], v[14:15], s[26:27], v[66:67]
    v_pk_fma_f32 v[80:81], v[64:65], s[38:39], v[80:81]
    v_pk_fma_f32 v[82:83], v[66:67], s[38:39], v[82:83]
    v_pk_add_f32 v[4:5], v[4:5], v[64:65] neg_lo:[0,1] neg_hi:[0,1]
    v_pk_add_f32 v[6:7], v[6:7], v[66:67] neg_lo:[0,1] neg_hi:[0,1]
    v_pk_add_f32 v[4:5], v[4:5], v[80:81] neg_lo:[0,1] neg_hi:[0,1]
    v_pk_add_f32 v[6:7], v[6:7], v[82:83] neg_lo:[0,1] neg_hi:[0,1]
    s_waitcnt lgkmcnt(0)
    v_pk_add_f32 v[92:93], v[56:57], v[60:61]
    v_pk_add_f32 v[94:95], v[58:59], v[62:63]
    v_pk_add_f32 v[56:57], v[36:37], v[40:41]
    v_pk_add_f32 v[58:59], v[38:39], v[42:43]
    v_pk_add_f32 v[36:37], v[36:37], v[40:41] neg_lo:[0,1] neg_hi:[0,1]
    v_pk_add_f32 v[38:39], v[38:39], v[42:43] neg_lo:[0,1] neg_hi:[0,1]
    v_pk_add_f32 v[76:77], v[44:45], v[48:49]
    v_pk_add_f32 v[78:79], v[46:47], v[50:51]
    v_pk_add_f32 v[44:45], v[44:45], v[48:49] neg_lo:[0,1] neg_hi:[0,1]
    v_pk_add_f32 v[46:47], v[46:47], v[50:51] neg_lo:[0,1] neg_hi:[0,1]
    v_pk_fma_f32 v[76:77], v[56:57], s[4:5], v[76:77]
    v_pk_fma_f32 v[78:79], v[58:59], s[4:5], v[78:79]
    v_pk_fma_f32 v[52:53], v[32:33], s[10:11], v[52:53]
    v_pk_fma_f32 v[54:55], v[34:35], s[10:11], v[54:55]
    v_pk_fma_f32 v[76:77], v[32:33], s[6:7], v[76:77]
    v_pk_fma_f32 v[78:79], v[34:35], s[6:7], v[78:79]
    v_pk_add_f32 v[56:57], v[56:57], v[32:33] neg_lo:[0,1] neg_hi:[0,1]
    v_pk_add_f32 v[58:59], v[58:59], v[34:35] neg_lo:[0,1] neg_hi:[0,1]
    v_pk_fma_f32 v[76:77], v[92:93], s[8:9], v[76:77]
    v_pk_fma_f32 v[78:79], v[94:95], s[8:9], v[78:79]
    v_pk_add_f32 v[56:57], v[56:57], v[92:93] neg_lo:[0,1] neg_hi:[0,1]
    v_pk_add_f32 v[58:59], v[58:59], v[94:95] neg_lo:[0,1] neg_hi:[0,1]
    v_pk_fma_f32 v[52:53], v[92:93], s[22:23], v[52:53]
    v_pk_fma_f32 v[54:55], v[94:95], s[22:23], v[54:55]
    v_pk_add_f32 v[40:41], v[56:57], v[76:77] neg_lo:[0,1] neg_hi:[0,1]
    v_pk_add_f32 v[42:43], v[58:59], v[78:79] neg_lo:[0,1] neg_hi:[0,1]
    v_pk_fma_f32 v[52:53], v[76:77], s[14:15], v[52:53]
    v_pk_fma_f32 v[54:55], v[78:79], s[14:15], v[54:55]
    v_pk_mul_f32 v[84:85], v[44:45], s[32:33]
    v_pk_mul_f32 v[86:87], v[46:47], s[32:33]
    v_pk_fma_f32 v[52:53], v[40:41], s[12:13], v[52:53]
    v_pk_fma_f32 v[54:55], v[42:43], s[12:13], v[54:55]
    v_pk_fma_f32 v[84:85], v[36:37], s[34:35], v[84:85]
    v_pk_fma_f32 v[86:87], v[38:39], s[34:35], v[86:87]
    v_pk_fma_f32 v[68:69], v[36:37], s[24:25], v[52:53] neg_lo:[0,0,1] neg_hi:[0,0,1]
    v_pk_fma_f32 v[70:71], v[38:39], s[24:25], v[54:55] neg_lo:[0,0,1] neg_hi:[0,0,1]
    v_pk_fma_f32 v[68:69], v[44:45], s[26:27], v[68:69]
    v_pk_fma_f32 v[70:71], v[46:47], s[26:27], v[70:71]
    v_pk_fma_f32 v[84:85], v[68:69], s[38:39], v[84:85]
    v_pk_fma_f32 v[86:87], v[70:71], s[38:39], v[86:87]
    v_pk_add_f32 v[36:37], v[36:37], v[68:69] neg_lo:[0,1] neg_hi:[0,1]
    v_pk_add_f32 v[38:39], v[38:39], v[70:71] neg_lo:[0,1] neg_hi:[0,1]
    v_pk_add_f32 v[36:37], v[36:37], v[84:85] neg_lo:[0,1] neg_hi:[0,1]
    v_pk_add_f32 v[38:39], v[38:39], v[86:87] neg_lo:[0,1] neg_hi:[0,1]
    s_mov_b32 s36, 0x00010001
    s_mov_b32 s37, 0x00010001
    s_mov_b64 exec, s[36:37]
    ds_write_b128 v127, v[0:3] offset:0
    ds_write_b128 v127, v[32:35] offset:16
    ds_write_b128 v127, v[4:7] offset:32
    ds_write_b128 v127, v[36:39] offset:48
    ds_write_b128 v127, v[8:11] offset:64
    ds_write_b128 v127, v[40:43] offset:80
    s_mov_b64 exec, -1
    v_mov_b32 v44, 0xc0135761
    v_mov_b32 v45, v44
    v_pk_mul_f32 v[16:17], v[64:65], v[64:65]
    v_pk_mul_f32 v[18:19], v[66:67], v[66:67]
    v_pk_mul_f32 v[20:21], v[68:69], v[68:69]
    v_pk_mul_f32 v[22:23], v[70:71], v[70:71]
    v_pk_fma_f32 v[16:17], v[16:17], s[40:41], v[44:45]
    v_pk_fma_f32 v[18:19], v[18:19], s[40:41], v[44:45]
    v_pk_fma_f32 v[20:21], v[20:21], s[40:41], v[44:45]
    v_pk_fma_f32 v[22:23], v[22:23], s[40:41], v[44:45]
    v_pk_mul_f32 v[16:17], v[16:17], v[64:65]
    v_pk_mul_f32 v[18:19], v[18:19], v[66:67]
    v_pk_mul_f32 v[20:21], v[20:21], v[68:69]
    v_pk_mul_f32 v[22:23], v[22:23], v[70:71]
    v_exp_f32 v16, v16
    v_exp_f32 v17, v17
    v_exp_f32 v18, v18
    v_exp_f32 v19, v19
    v_exp_f32 v20, v20
    v_exp_f32 v21, v21
    v_exp_f32 v22, v22
    v_exp_f32 v23, v23
    v_pk_add_f32 v[16:17], v[16:17], s[42:43]
    v_pk_add_f32 v[18:19], v[18:19], s[42:43]
    v_pk_add_f32 v[20:21], v[20:21], s[42:43]
    v_pk_add_f32 v[22:23], v[22:23], s[42:43]
    v_rcp_f32 v16, v16
    v_rcp_f32 v17, v17
    v_rcp_f32 v18, v18
    v_rcp_f32 v19, v19
    v_rcp_f32 v20, v20
    v_rcp_f32 v21, v21
    v_rcp_f32 v22, v22
    v_rcp_f32 v23, v23
    v_pk_mul_f32 v[64:65], v[64:65], v[16:17]
    v_pk_mul_f32 v[66:67], v[66:67], v[18:19]
    v_pk_mul_f32 v[68:69], v[68:69], v[20:21]
    v_pk_mul_f32 v[70:71], v[70:71], v[22:23]
    v_cvt_pk_bf16_f32 v48, v64, v68
    v_cvt_pk_bf16_f32 v49, v65, v69
    v_cvt_pk_bf16_f32 v50, v66, v70
    v_cvt_pk_bf16_f32 v51, v67, v71
    s_mov_b32 s44, 393280
    buffer_store_dwordx4 v[48:51], v122, s[16:19], s44 offen sc1
    s_waitcnt lgkmcnt(0)
    s_barrier
    ds_read_b128 v[96:99], v127 offset:512
    ds_read_b128 v[100:103], v127 offset:528
    ds_read_b128 v[104:107], v127 offset:544
    ds_read_b128 v[108:111], v127 offset:560
    ds_read_b128 v[112:115], v127 offset:576
    ds_read_b128 v[116:119], v127 offset:592
    s_waitcnt lgkmcnt(4)
    v_mov_b32_dpp v96, v0 row_shl:1 row_mask:0xf bank_mask:0xf
    v_mov_b32_dpp v97, v1 row_shl:1 row_mask:0xf bank_mask:0xf
    v_mov_b32_dpp v98, v2 row_shl:1 row_mask:0xf bank_mask:0xf
    v_mov_b32_dpp v99, v3 row_shl:1 row_mask:0xf bank_mask:0xf
    v_mov_b32_dpp v100, v32 row_shl:1 row_mask:0xf bank_mask:0xf
    v_mov_b32_dpp v101, v33 row_shl:1 row_mask:0xf bank_mask:0xf
    v_mov_b32_dpp v102, v34 row_shl:1 row_mask:0xf bank_mask:0xf
    v_mov_b32_dpp v103, v35 row_shl:1 row_mask:0xf bank_mask:0xf
    v_pk_add_f32 v[72:73], v[72:73], v[96:97]
    v_pk_add_f32 v[74:75], v[74:75], v[98:99]
    v_pk_add_f32 v[76:77], v[76:77], v[100:101]
    v_pk_add_f32 v[78:79], v[78:79], v[102:103]
    v_pk_mul_f32 v[24:25], v[72:73], v[72:73]
    v_pk_mul_f32 v[26:27], v[74:75], v[74:75]
    v_pk_mul_f32 v[28:29], v[76:77], v[76:77]
    v_pk_mul_f32 v[30:31], v[78:79], v[78:79]
    v_pk_fma_f32 v[24:25], v[24:25], s[40:41], v[44:45]
    v_pk_fma_f32 v[26:27], v[26:27], s[40:41], v[44:45]
    v_pk_fma_f32 v[28:29], v[28:29], s[40:41], v[44:45]
    v_pk_fma_f32 v[30:31], v[30:31], s[40:41], v[44:45]
    v_pk_mul_f32 v[24:25], v[24:25], v[72:73]
    v_pk_mul_f32 v[26:27], v[26:27], v[74:75]
    v_pk_mul_f32 v[28:29], v[28:29], v[76:77]
    v_pk_mul_f32 v[30:31], v[30:31], v[78:79]
    v_exp_f32 v24, v24
    v_exp_f32 v25, v25
    v_exp_f32 v26, v26
    v_exp_f32 v27, v27
    v_exp_f32 v28, v28
    v_exp_f32 v29, v29
    v_exp_f32 v30, v30
    v_exp_f32 v31, v31
    v_pk_add_f32 v[24:25], v[24:25], s[42:43]
    v_pk_add_f32 v[26:27], v[26:27], s[42:43]
    v_pk_add_f32 v[28:29], v[28:29], s[42:43]
    v_pk_add_f32 v[30:31], v[30:31], s[42:43]
    v_rcp_f32 v24, v24
    v_rcp_f32 v25, v25
    v_rcp_f32 v26, v26
    v_rcp_f32 v27, v27
    v_rcp_f32 v28, v28
    v_rcp_f32 v29, v29
    v_rcp_f32 v30, v30
    v_rcp_f32 v31, v31
    v_pk_mul_f32 v[72:73], v[72:73], v[24:25]
    v_pk_mul_f32 v[74:75], v[74:75], v[26:27]
    v_pk_mul_f32 v[76:77], v[76:77], v[28:29]
    v_pk_mul_f32 v[78:79], v[78:79], v[30:31]
    v_cvt_pk_bf16_f32 v52, v72, v76
    v_cvt_pk_bf16_f32 v53, v73, v77
    v_cvt_pk_bf16_f32 v54, v74, v78
    v_cvt_pk_bf16_f32 v55, v75, v79
    s_mov_b32 s44, 128
    buffer_store_dwordx4 v[52:55], v122, s[16:19], s44 offen sc1
    s_waitcnt lgkmcnt(2)
    v_mov_b32_dpp v104, v4 row_shl:1 row_mask:0xf bank_mask:0xf
    v_mov_b32_dpp v105, v5 row_shl:1 row_mask:0xf bank_mask:0xf
    v_mov_b32_dpp v106, v6 row_shl:1 row_mask:0xf bank_mask:0xf
    v_mov_b32_dpp v107, v7 row_shl:1 row_mask:0xf bank_mask:0xf
    v_mov_b32_dpp v108, v36 row_shl:1 row_mask:0xf bank_mask:0xf
    v_mov_b32_dpp v109, v37 row_shl:1 row_mask:0xf bank_mask:0xf
    v_mov_b32_dpp v110, v38 row_shl:1 row_mask:0xf bank_mask:0xf
    v_mov_b32_dpp v111, v39 row_shl:1 row_mask:0xf bank_mask:0xf
    v_pk_add_f32 v[80:81], v[80:81], v[104:105]
    v_pk_add_f32 v[82:83], v[82:83], v[106:107]
    v_pk_add_f32 v[84:85], v[84:85], v[108:109]
    v_pk_add_f32 v[86:87], v[86:87], v[110:111]
    v_pk_mul_f32 v[16:17], v[80:81], v[80:81]
    v_pk_mul_f32 v[18:19], v[82:83], v[82:83]
    v_pk_mul_f32 v[20:21], v[84:85], v[84:85]
    v_pk_mul_f32 v[22:23], v[86:87], v[86:87]
    v_pk_fma_f32 v[16:17], v[16:17], s[40:41], v[44:45]
    v_pk_fma_f32 v[18:19], v[18:19], s[40:41], v[44:45]
    v_pk_fma_f32 v[20:21], v[20:21], s[40:41], v[44:45]
    v_pk_fma_f32 v[22:23], v[22:23], s[40:41], v[44:45]
    v_pk_mul_f32 v[16:17], v[16:17], v[80:81]
    v_pk_mul_f32 v[18:19], v[18:19], v[82:83]
    v_pk_mul_f32 v[20:21], v[20:21], v[84:85]
    v_pk_mul_f32 v[22:23], v[22:23], v[86:87]
    v_exp_f32 v16, v16
    v_exp_f32 v17, v17
    v_exp_f32 v18, v18
    v_exp_f32 v19, v19
    v_exp_f32 v20, v20
    v_exp_f32 v21, v21
    v_exp_f32 v22, v22
    v_exp_f32 v23, v23
    v_pk_add_f32 v[16:17], v[16:17], s[42:43]
    v_pk_add_f32 v[18:19], v[18:19], s[42:43]
    v_pk_add_f32 v[20:21], v[20:21], s[42:43]
    v_pk_add_f32 v[22:23], v[22:23], s[42:43]
    v_rcp_f32 v16, v16
    v_rcp_f32 v17, v17
    v_rcp_f32 v18, v18
    v_rcp_f32 v19, v19
    v_rcp_f32 v20, v20
    v_rcp_f32 v21, v21
    v_rcp_f32 v22, v22
    v_rcp_f32 v23, v23
    v_pk_mul_f32 v[80:81], v[80:81], v[16:17]
    v_pk_mul_f32 v[82:83], v[82:83], v[18:19]
    v_pk_mul_f32 v[84:85], v[84:85], v[20:21]
    v_pk_mul_f32 v[86:87], v[86:87], v[22:23]
    v_cvt_pk_bf16_f32 v56, v80, v84
    v_cvt_pk_bf16_f32 v57, v81, v85
    v_cvt_pk_bf16_f32 v58, v82, v86
    v_cvt_pk_bf16_f32 v59, v83, v87
    s_mov_b32 s44, 131200
    buffer_store_dwordx4 v[56:59], v122, s[16:19], s44 offen sc1
    s_waitcnt lgkmcnt(0)
    v_mov_b32_dpp v112, v8 row_shl:1 row_mask:0xf bank_mask:0xf
    v_mov_b32_dpp v113, v9 row_shl:1 row_mask:0xf bank_mask:0xf
    v_mov_b32_dpp v114, v10 row_shl:1 row_mask:0xf bank_mask:0xf
    v_mov_b32_dpp v115, v11 row_shl:1 row_mask:0xf bank_mask:0xf
    v_mov_b32_dpp v116, v40 row_shl:1 row_mask:0xf bank_mask:0xf
    v_mov_b32_dpp v117, v41 row_shl:1 row_mask:0xf bank_mask:0xf
    v_mov_b32_dpp v118, v42 row_shl:1 row_mask:0xf bank_mask:0xf
    v_mov_b32_dpp v119, v43 row_shl:1 row_mask:0xf bank_mask:0xf
    v_pk_add_f32 v[88:89], v[88:89], v[112:113]
    v_pk_add_f32 v[90:91], v[90:91], v[114:115]
    v_pk_add_f32 v[92:93], v[92:93], v[116:117]
    v_pk_add_f32 v[94:95], v[94:95], v[118:119]
    v_pk_mul_f32 v[24:25], v[88:89], v[88:89]
    v_pk_mul_f32 v[26:27], v[90:91], v[90:91]
    v_pk_mul_f32 v[28:29], v[92:93], v[92:93]
    v_pk_mul_f32 v[30:31], v[94:95], v[94:95]
    v_pk_fma_f32 v[24:25], v[24:25], s[40:41], v[44:45]
    v_pk_fma_f32 v[26:27], v[26:27], s[40:41], v[44:45]
    v_pk_fma_f32 v[28:29], v[28:29], s[40:41], v[44:45]
    v_pk_fma_f32 v[30:31], v[30:31], s[40:41], v[44:45]
    v_pk_mul_f32 v[24:25], v[24:25], v[88:89]
    v_pk_mul_f32 v[26:27], v[26:27], v[90:91]
    v_pk_mul_f32 v[28:29], v[28:29], v[92:93]
    v_pk_mul_f32 v[30:31], v[30:31], v[94:95]
    v_exp_f32 v24, v24
    v_exp_f32 v25, v25
    v_exp_f32 v26, v26
    v_exp_f32 v27, v27
    v_exp_f32 v28, v28
    v_exp_f32 v29, v29
    v_exp_f32 v30, v30
    v_exp_f32 v31, v31
    v_pk_add_f32 v[24:25], v[24:25], s[42:43]
    v_pk_add_f32 v[26:27], v[26:27], s[42:43]
    v_pk_add_f32 v[28:29], v[28:29], s[42:43]
    v_pk_add_f32 v[30:31], v[30:31], s[42:43]
    v_rcp_f32 v24, v24
    v_rcp_f32 v25, v25
    v_rcp_f32 v26, v26
    v_rcp_f32 v27, v27
    v_rcp_f32 v28, v28
    v_rcp_f32 v29, v29
    v_rcp_f32 v30, v30
    v_rcp_f32 v31, v31
    v_pk_mul_f32 v[88:89], v[88:89], v[24:25]
    v_pk_mul_f32 v[90:91], v[90:91], v[26:27]
    v_pk_mul_f32 v[92:93], v[92:93], v[28:29]
    v_pk_mul_f32 v[94:95], v[94:95], v[30:31]
    v_cvt_pk_bf16_f32 v60, v88, v92
    v_cvt_pk_bf16_f32 v61, v89, v93
    v_cvt_pk_bf16_f32 v62, v90, v94
    v_cvt_pk_bf16_f32 v63, v91, v95
    s_mov_b32 s44, 262272
    buffer_store_dwordx4 v[60:63], v122, s[16:19], s44 offen sc1
L_conv1_kernel_end:
L_conv1_kernel_done:
    s_endpgm
.globl conv2_kernel
.p2align 8
.type conv2_kernel,@function
conv2_kernel:
    s_cmp_ge_u32 s2, 256
    s_cbranch_scc1 L_conv2_kernel_done
    s_load_dwordx2 s[4:5], s[0:1], 72
    s_load_dwordx2 s[30:31], s[0:1], 72
    v_readfirstlane_b32 s20, v0
    s_lshr_b32 s20, s20, 6
    s_xor_b32 s20, s20, 8
    s_and_b32 s36, s2, 0
    s_lshl_b32 s36, s36, 3
    s_bfe_u32 s37, s2, 196611
    s_or_b32 s29, s36, s37
    s_bfe_u32 s36, s2, 196608
    s_lshl_b32 s36, s36, 2
    s_lshr_b32 s37, s2, 6
    s_or_b32 s36, s36, s37
    s_lshr_b32 s33, s36, 4
    s_and_b32 s34, s36, 7
    s_bfe_u32 s35, s36, 0x10003
    s_mul_i32 s21, s34, 500
    s_and_b32 s32, s20, 3
    v_and_b32 v127, 63, v0
    v_lshrrev_b32 v5, 2, v127
    v_and_b32 v6, 3, v127
    s_and_b32 s42, s20, 7
    s_lshr_b32 s41, s21, 2
    s_sub_u32 s41, s41, 1
    s_add_u32 s37, s41, s42
    v_lshl_add_u32 v7, v5, 3, s37
    s_mul_i32 s36, s35, 4194304
    s_add_u32 s36, s36, 18874368
    s_mov_b32 s10, 4194304
    s_mov_b32 s11, 0x00020000
    s_mov_b32 s25, 0xffff0000
    s_mov_b32 s47, s36
    s_cmp_ge_u32 s20, 8
    s_cbranch_scc0 L_conv2_kernel_mw
L_conv2_kernel_helper:
    s_setprio 3
    v_lshlrev_b32 v8, 4, v6
    s_add_u32 s37, s33, 4294967289
    v_lshl_add_u32 v9, v7, 3, s37
    v_cmp_gt_u32 vcc, 8000, v9
    s_mul_i32 s37, s33, 131072
    s_add_u32 s37, s37, 0
    v_lshl_add_u32 v92, v7, 7, s37
    v_add_u32 v92, v92, v8
    v_mov_b32 v9, 2130706432
    v_cndmask_b32 v92, v9, v92, vcc
    s_add_u32 s37, s33, 4294967291
    v_lshl_add_u32 v9, v7, 3, s37
    v_cmp_gt_u32 vcc, 8000, v9
    s_mul_i32 s37, s33, 131072
    s_add_u32 s37, s37, 262144
    v_lshl_add_u32 v93, v7, 7, s37
    v_add_u32 v93, v93, v8
    v_mov_b32 v9, 2130706432
    v_cndmask_b32 v93, v9, v93, vcc
    s_add_u32 s37, s33, 4294967293
    v_lshl_add_u32 v9, v7, 3, s37
    v_cmp_gt_u32 vcc, 8000, v9
    s_mul_i32 s37, s33, 131072
    s_add_u32 s37, s37, 64
    v_lshl_add_u32 v94, v7, 7, s37
    v_add_u32 v94, v94, v8
    v_mov_b32 v9, 2130706432
    v_cndmask_b32 v94, v9, v94, vcc
    s_add_u32 s37, s33, 4294967295
    v_lshl_add_u32 v9, v7, 3, s37
    v_cmp_gt_u32 vcc, 8000, v9
    s_mul_i32 s37, s33, 131072
    s_add_u32 s37, s37, 262208
    v_lshl_add_u32 v95, v7, 7, s37
    v_add_u32 v95, v95, v8
    v_mov_b32 v9, 2130706432
    v_cndmask_b32 v95, v9, v95, vcc
    v_and_b32 v76, 4, v5
    v_lshrrev_b32 v76, 1, v76
    v_xor_b32 v76, v6, v76
    v_lshlrev_b32 v76, 4, v76
    v_lshl_add_u32 v76, v5, 6, v76
    s_mov_b32 s24, 0
    s_mov_b32 s27, 524288
    s_waitcnt lgkmcnt(0)
    s_add_u32 s8, s4, s47
    s_addc_u32 s9, s5, 0
    buffer_load_dwordx4 v[0:3], v92, s[8:11], s24 offen
    buffer_load_dwordx4 v[8:11], v94, s[8:11], s24 offen
    buffer_load_dwordx4 v[4:7], v93, s[8:11], s24 offen
    buffer_load_dwordx4 v[12:15], v95, s[8:11], s24 offen
    buffer_load_dwordx4 v[16:19], v92, s[8:11], s27 offen
    buffer_load_dwordx4 v[24:27], v94, s[8:11], s27 offen
    buffer_load_dwordx4 v[20:23], v93, s[8:11], s27 offen
    buffer_load_dwordx4 v[28:31], v95, s[8:11], s27 offen
    s_mul_i32 s36, s42, 1024
    v_add_u32 v96, s36, v76
    v_add_u32 v97, 65536, v96
    s_mul_i32 s36, s42, 1088
    s_add_u32 s36, s36, 98304
    v_add_u32 v98, s36, v76
    s_mov_b32 s28, 0
    s_mov_b32 s24, 1048576
    s_cmp_ge_u32 s20, 12
    s_cselect_b32 s44, 252, 0
    s_cselect_b32 s45, 129, -1
    s_setprio 0
    s_cbranch_scc1 L_conv2_kernel_hloop
    s_setprio 1
L_conv2_kernel_hloop:
    s_waitcnt vmcnt(4)
    v_lshlrev_b32 v76, 16, v0
    v_and_b32 v84, s25, v0
    v_lshlrev_b32 v77, 16, v4
    v_and_b32 v85, s25, v4
    v_lshlrev_b32 v78, 16, v8
    v_and_b32 v86, s25, v8
    v_lshlrev_b32 v79, 16, v12
    v_and_b32 v87, s25, v12
    v_add_f32 v80, v76, v78
    v_add_f32 v88, v84, v86
    v_add_f32 v81, v77, v79
    v_add_f32 v89, v85, v87
    s_nop 0
    v_fma_f32 v82, v78, 4.0, v76
    v_fma_f32 v90, v86, 4.0, v84
    v_fma_f32 v83, v79, 4.0, v77
    v_fma_f32 v91, v87, 4.0, v85
    v_add_f32 v77, v80, v81
    v_add_f32 v85, v88, v89
    v_sub_f32 v78, v80, v81
    v_sub_f32 v86, v88, v89
    v_fma_f32 v79, v83, 2.0, v82
    v_fma_f32 v87, v91, 2.0, v90
    v_fma_f32 v82, v83, -2.0, v82
    v_fma_f32 v90, v91, -2.0, v90
    v_fmamk_f32 v80, v76, 0x41700000, v82
    v_fmamk_f32 v88, v84, 0x41700000, v90
    v_fmamk_f32 v80, v81, 0x41200000, v80
    v_fmamk_f32 v88, v89, 0x41200000, v88
    v_cvt_pk_bf16_f32 v4, v77, v85
    v_cvt_pk_bf16_f32 v8, v78, v86
    v_cvt_pk_bf16_f32 v64, v79, v87
    v_cvt_pk_bf16_f32 v68, v82, v90
    v_cvt_pk_bf16_f32 v72, v80, v88
    v_lshlrev_b32 v76, 16, v1
    v_and_b32 v84, s25, v1
    v_lshlrev_b32 v77, 16, v5
    v_and_b32 v85, s25, v5
    v_lshlrev_b32 v78, 16, v9
    v_and_b32 v86, s25, v9
    v_lshlrev_b32 v79, 16, v13
    v_and_b32 v87, s25, v13
    v_add_f32 v80, v76, v78
    v_add_f32 v88, v84, v86
    v_add_f32 v81, v77, v79
    v_add_f32 v89, v85, v87
    v_fma_f32 v82, v78, 4.0, v76
    v_fma_f32 v90, v86, 4.0, v84
    v_fma_f32 v83, v79, 4.0, v77
    v_fma_f32 v91, v87, 4.0, v85
    v_add_f32 v77, v80, v81
    v_add_f32 v85, v88, v89
    v_sub_f32 v78, v80, v81
    v_sub_f32 v86, v88, v89
    v_fma_f32 v79, v83, 2.0, v82
    v_fma_f32 v87, v91, 2.0, v90
    v_fma_f32 v82, v83, -2.0, v82
    v_fma_f32 v90, v91, -2.0, v90
    v_fmamk_f32 v80, v76, 0x41700000, v82
    v_fmamk_f32 v88, v84, 0x41700000, v90
    v_fmamk_f32 v80, v81, 0x41200000, v80
    v_fmamk_f32 v88, v89, 0x41200000, v88
    v_cvt_pk_bf16_f32 v5, v77, v85
    v_cvt_pk_bf16_f32 v9, v78, v86
    v_cvt_pk_bf16_f32 v65, v79, v87
    v_cvt_pk_bf16_f32 v69, v82, v90
    v_cvt_pk_bf16_f32 v73, v80, v88
    v_lshlrev_b32 v76, 16, v2
    v_and_b32 v84, s25, v2
    v_lshlrev_b32 v77, 16, v6
    v_and_b32 v85, s25, v6
    v_lshlrev_b32 v78, 16, v10
    v_and_b32 v86, s25, v10
    v_lshlrev_b32 v79, 16, v14
    v_and_b32 v87, s25, v14
    v_add_f32 v80, v76, v78
    v_add_f32 v88, v84, v86
    v_add_f32 v81, v77, v79
    v_add_f32 v89, v85, v87
    v_fma_f32 v82, v78, 4.0, v76
    v_fma_f32 v90, v86, 4.0, v84
    v_fma_f32 v83, v79, 4.0, v77
    v_fma_f32 v91, v87, 4.0, v85
    v_add_f32 v77, v80, v81
    v_add_f32 v85, v88, v89
    v_sub_f32 v78, v80, v81
    v_sub_f32 v86, v88, v89
    v_fma_f32 v79, v83, 2.0, v82
    v_fma_f32 v87, v91, 2.0, v90
    v_fma_f32 v82, v83, -2.0, v82
    v_fma_f32 v90, v91, -2.0, v90
    v_fmamk_f32 v80, v76, 0x41700000, v82
    v_fmamk_f32 v88, v84, 0x41700000, v90
    v_fmamk_f32 v80, v81, 0x41200000, v80
    v_fmamk_f32 v88, v89, 0x41200000, v88
    v_cvt_pk_bf16_f32 v6, v77, v85
    v_cvt_pk_bf16_f32 v10, v78, v86
    v_cvt_pk_bf16_f32 v66, v79, v87
    v_cvt_pk_bf16_f32 v70, v82, v90
    v_cvt_pk_bf16_f32 v74, v80, v88
    v_lshlrev_b32 v76, 16, v3
    v_and_b32 v84, s25, v3
    v_lshlrev_b32 v77, 16, v7
    v_and_b32 v85, s25, v7
    v_lshlrev_b32 v78, 16, v11
    v_and_b32 v86, s25, v11
    v_lshlrev_b32 v79, 16, v15
    v_and_b32 v87, s25, v15
    v_add_f32 v80, v76, v78
    v_add_f32 v88, v84, v86
    v_add_f32 v81, v77, v79
    v_add_f32 v89, v85, v87
    v_fma_f32 v82, v78, 4.0, v76
    v_fma_f32 v90, v86, 4.0, v84
    v_fma_f32 v83, v79, 4.0, v77
    v_fma_f32 v91, v87, 4.0, v85
    v_add_f32 v77, v80, v81
    v_add_f32 v85, v88, v89
    v_sub_f32 v78, v80, v81
    v_sub_f32 v86, v88, v89
    v_fma_f32 v79, v83, 2.0, v82
    v_fma_f32 v87, v91, 2.0, v90
    v_fma_f32 v82, v83, -2.0, v82
    v_fma_f32 v90, v91, -2.0, v90
    v_fmamk_f32 v80, v76, 0x41700000, v82
    v_fmamk_f32 v88, v84, 0x41700000, v90
    v_fmamk_f32 v80, v81, 0x41200000, v80
    v_fmamk_f32 v88, v89, 0x41200000, v88
    v_cvt_pk_bf16_f32 v7, v77, v85
    v_cvt_pk_bf16_f32 v11, v78, v86
    v_cvt_pk_bf16_f32 v67, v79, v87
    v_cvt_pk_bf16_f32 v71, v82, v90
    v_cvt_pk_bf16_f32 v75, v80, v88
    s_bitcmp1_b32 s44, s28
    s_cbranch_scc0 L_conv2_kernel_sa0
    s_waitcnt lgkmcnt(0)
    s_barrier
L_conv2_kernel_sa0:
    ds_write_b128 v96, v[64:67] offset:49152
    ds_write_b128 v97, v[68:71] offset:0
    ds_write_b128 v97, v[72:75] offset:16384
    ds_write_b128 v96, v[0:3] offset:0
    ds_write_b128 v96, v[4:7] offset:16384
    ds_write_b128 v96, v[8:11] offset:32768
    ds_write_b128 v98, v[12:15] offset:0
    buffer_load_dwordx4 v[0:3], v92, s[8:11], s24 offen
    buffer_load_dwordx4 v[8:11], v94, s[8:11], s24 offen
    buffer_load_dwordx4 v[4:7], v93, s[8:11], s24 offen
    buffer_load_dwordx4 v[12:15], v95, s[8:11], s24 offen
    s_add_u32 s24, s24, 524288
    s_bitcmp1_b32 s45, s28
    s_cbranch_scc0 L_conv2_kernel_sb0
    s_waitcnt lgkmcnt(0)
    s_barrier
L_conv2_kernel_sb0:
    s_add_u32 s28, s28, 1
    s_waitcnt vmcnt(4)
    v_lshlrev_b32 v76, 16, v16
    v_and_b32 v84, s25, v16
    v_lshlrev_b32 v77, 16, v20
    v_and_b32 v85, s25, v20
    v_lshlrev_b32 v78, 16, v24
    v_and_b32 v86, s25, v24
    v_lshlrev_b32 v79, 16, v28
    v_and_b32 v87, s25, v28
    v_add_f32 v80, v76, v78
    v_add_f32 v88, v84, v86
    v_add_f32 v81, v77, v79
    v_add_f32 v89, v85, v87
    v_fma_f32 v82, v78, 4.0, v76
    v_fma_f32 v90, v86, 4.0, v84
    v_fma_f32 v83, v79, 4.0, v77
    v_fma_f32 v91, v87, 4.0, v85
    v_add_f32 v77, v80, v81
    v_add_f32 v85, v88, v89
    v_sub_f32 v78, v80, v81
    v_sub_f32 v86, v88, v89
    v_fma_f32 v79, v83, 2.0, v82
    v_fma_f32 v87, v91, 2.0, v90
    v_fma_f32 v82, v83, -2.0, v82
    v_fma_f32 v90, v91, -2.0, v90
    v_fmamk_f32 v80, v76, 0x41700000, v82
    v_fmamk_f32 v88, v84, 0x41700000, v90
    v_fmamk_f32 v80, v81, 0x41200000, v80
    v_fmamk_f32 v88, v89, 0x41200000, v88
    v_cvt_pk_bf16_f32 v20, v77, v85
    v_cvt_pk_bf16_f32 v24, v78, v86
    v_cvt_pk_bf16_f32 v64, v79, v87
    v_cvt_pk_bf16_f32 v68, v82, v90
    v_cvt_pk_bf16_f32 v72, v80, v88
    v_lshlrev_b32 v76, 16, v17
    v_and_b32 v84, s25, v17
    v_lshlrev_b32 v77, 16, v21
    v_and_b32 v85, s25, v21
    v_lshlrev_b32 v78, 16, v25
    v_and_b32 v86, s25, v25
    v_lshlrev_b32 v79, 16, v29
    v_and_b32 v87, s25, v29
    v_add_f32 v80, v76, v78
    v_add_f32 v88, v84, v86
    v_add_f32 v81, v77, v79
    v_add_f32 v89, v85, v87
    v_fma_f32 v82, v78, 4.0, v76
    v_fma_f32 v90, v86, 4.0, v84
    v_fma_f32 v83, v79, 4.0, v77
    v_fma_f32 v91, v87, 4.0, v85
    v_add_f32 v77, v80, v81
    v_add_f32 v85, v88, v89
    v_sub_f32 v78, v80, v81
    v_sub_f32 v86, v88, v89
    v_fma_f32 v79, v83, 2.0, v82
    v_fma_f32 v87, v91, 2.0, v90
    v_fma_f32 v82, v83, -2.0, v82
    v_fma_f32 v90, v91, -2.0, v90
    v_fmamk_f32 v80, v76, 0x41700000, v82
    v_fmamk_f32 v88, v84, 0x41700000, v90
    v_fmamk_f32 v80, v81, 0x41200000, v80
    v_fmamk_f32 v88, v89, 0x41200000, v88
    v_cvt_pk_bf16_f32 v21, v77, v85
    v_cvt_pk_bf16_f32 v25, v78, v86
    v_cvt_pk_bf16_f32 v65, v79, v87
    v_cvt_pk_bf16_f32 v69, v82, v90
    v_cvt_pk_bf16_f32 v73, v80, v88
    v_lshlrev_b32 v76, 16, v18
    v_and_b32 v84, s25, v18
    v_lshlrev_b32 v77, 16, v22
    v_and_b32 v85, s25, v22
    v_lshlrev_b32 v78, 16, v26
    v_and_b32 v86, s25, v26
    v_lshlrev_b32 v79, 16, v30
    v_and_b32 v87, s25, v30
    v_add_f32 v80, v76, v78
    v_add_f32 v88, v84, v86
    v_add_f32 v81, v77, v79
    v_add_f32 v89, v85, v87
    v_fma_f32 v82, v78, 4.0, v76
    v_fma_f32 v90, v86, 4.0, v84
    v_fma_f32 v83, v79, 4.0, v77
    v_fma_f32 v91, v87, 4.0, v85
    v_add_f32 v77, v80, v81
    v_add_f32 v85, v88, v89
    v_sub_f32 v78, v80, v81
    v_sub_f32 v86, v88, v89
    v_fma_f32 v79, v83, 2.0, v82
    v_fma_f32 v87, v91, 2.0, v90
    v_fma_f32 v82, v83, -2.0, v82
    v_fma_f32 v90, v91, -2.0, v90
    v_fmamk_f32 v80, v76, 0x41700000, v82
    v_fmamk_f32 v88, v84, 0x41700000, v90
    v_fmamk_f32 v80, v81, 0x41200000, v80
    v_fmamk_f32 v88, v89, 0x41200000, v88
    v_cvt_pk_bf16_f32 v22, v77, v85
    v_cvt_pk_bf16_f32 v26, v78, v86
    v_cvt_pk_bf16_f32 v66, v79, v87
    v_cvt_pk_bf16_f32 v70, v82, v90
    v_cvt_pk_bf16_f32 v74, v80, v88
    v_lshlrev_b32 v76, 16, v19
    v_and_b32 v84, s25, v19
    v_lshlrev_b32 v77, 16, v23
    v_and_b32 v85, s25, v23
    v_lshlrev_b32 v78, 16, v27
    v_and_b32 v86, s25, v27
    v_lshlrev_b32 v79, 16, v31
    v_and_b32 v87, s25, v31
    v_add_f32 v80, v76, v78
    v_add_f32 v88, v84, v86
    v_add_f32 v81, v77, v79
    v_add_f32 v89, v85, v87
    v_fma_f32 v82, v78, 4.0, v76
    v_fma_f32 v90, v86, 4.0, v84
    v_fma_f32 v83, v79, 4.0, v77
    v_fma_f32 v91, v87, 4.0, v85
    v_add_f32 v77, v80, v81
    v_add_f32 v85, v88, v89
    v_sub_f32 v78, v80, v81
    v_sub_f32 v86, v88, v89
    v_fma_f32 v79, v83, 2.0, v82
    v_fma_f32 v87, v91, 2.0, v90
    v_fma_f32 v82, v83, -2.0, v82
    v_fma_f32 v90, v91, -2.0, v90
    v_fmamk_f32 v80, v76, 0x41700000, v82
    v_fmamk_f32 v88, v84, 0x41700000, v90
    v_fmamk_f32 v80, v81, 0x41200000, v80
    v_fmamk_f32 v88, v89, 0x41200000, v88
    v_cvt_pk_bf16_f32 v23, v77, v85
    v_cvt_pk_bf16_f32 v27, v78, v86
    v_cvt_pk_bf16_f32 v67, v79, v87
    v_cvt_pk_bf16_f32 v71, v82, v90
    v_cvt_pk_bf16_f32 v75, v80, v88
    s_bitcmp1_b32 s44, s28
    s_cbranch_scc0 L_conv2_kernel_sa1
    s_waitcnt lgkmcnt(0)
    s_barrier
L_conv2_kernel_sa1:
    ds_write_b128 v96, v[64:67] offset:57344
    ds_write_b128 v97, v[68:71] offset:8192
    ds_write_b128 v97, v[72:75] offset:24576
    ds_write_b128 v96, v[16:19] offset:8192
    ds_write_b128 v96, v[20:23] offset:24576
    ds_write_b128 v96, v[24:27] offset:40960
    ds_write_b128 v98, v[28:31] offset:8704
    buffer_load_dwordx4 v[16:19], v92, s[8:11], s24 offen
    buffer_load_dwordx4 v[24:27], v94, s[8:11], s24 offen
    buffer_load_dwordx4 v[20:23], v93, s[8:11], s24 offen
    buffer_load_dwordx4 v[28:31], v95, s[8:11], s24 offen
    s_add_u32 s24, s24, 524288
    s_bitcmp1_b32 s45, s28
    s_cbranch_scc0 L_conv2_kernel_sb1
    s_waitcnt lgkmcnt(0)
    s_barrier
L_conv2_kernel_sb1:
    s_add_u32 s28, s28, 1
    s_cmp_lt_u32 s28, 8
    s_cbranch_scc1 L_conv2_kernel_hloop
    s_cmp_ge_u32 s20, 12
    s_cbranch_scc1 L_conv2_kernel_hend
    s_add_u32 s12, s30, 44040192
    s_addc_u32 s13, s31, 0
    s_mov_b32 s14, 294912
    s_mov_b32 s15, 0x00020000
    s_lshr_b32 s36, s2, 3
    s_lshl_b32 s36, s36, 2
    s_add_u32 s36, s36, s32
    s_mul_i32 s36, s36, 2304
    v_lshlrev_b32 v1, 4, v127
    buffer_load_dwordx4 v[4:7], v1, s[12:15], s36 offen offset:0
    buffer_load_dwordx4 v[4:7], v1, s[12:15], s36 offen offset:1024
    buffer_load_dwordx4 v[4:7], v1, s[12:15], s36 offen offset:2048
    s_cmp_ge_u32 s2, 32
    s_cbranch_scc1 L_conv2_kernel_ntw
    s_getpc_b64 s[36:37]
L_conv2_kernel_pc:
    s_lshl_b32 s38, s32, 13
    s_add_u32 s38, s38, L_conv2_kernel_epi-L_conv2_kernel_pc
    v_lshl_add_u32 v2, v127, 7, s38
    v_min_u32 v2, L_joint_kernel_done-L_conv2_kernel_pc, v2
    v_mov_b32 v3, s37
    v_add_co_u32 v2, vcc, s36, v2
    s_nop 1
    v_addc_co_u32 v3, vcc, 0, v3, vcc
    global_load_dword v4, v[2:3], off
L_conv2_kernel_ntw:
L_conv2_kernel_hend:
    s_endpgm
L_conv2_kernel_mw:
    s_add_u32 s37, s41, 128
    v_mov_b32 v16, s37
    v_mul_u32_u24 v17, 524288, v5
    v_lshl_add_u32 v17, v6, 4, v17
    s_add_u32 s37, s33, 4294967289
    v_lshl_add_u32 v18, v16, 3, s37
    v_cmp_gt_u32 vcc, 8000, v18
    s_mul_i32 s37, s33, 131072
    s_add_u32 s37, s37, 0
    v_lshl_add_u32 v108, v16, 7, s37
    v_add_u32 v108, v108, v17
    v_mov_b32 v18, 2130706432
    v_cndmask_b32 v108, v18, v108, vcc
    s_add_u32 s37, s33, 4294967291
    v_lshl_add_u32 v18, v16, 3, s37
    v_cmp_gt_u32 vcc, 8000, v18
    s_mul_i32 s37, s33, 131072
    s_add_u32 s37, s37, 262144
    v_lshl_add_u32 v109, v16, 7, s37
    v_add_u32 v109, v109, v17
    v_mov_b32 v18, 2130706432
    v_cndmask_b32 v109, v18, v109, vcc
    s_add_u32 s37, s33, 4294967293
    v_lshl_add_u32 v18, v16, 3, s37
    v_cmp_gt_u32 vcc, 8000, v18
    s_mul_i32 s37, s33, 131072
    s_add_u32 s37, s37, 64
    v_lshl_add_u32 v110, v16, 7, s37
    v_add_u32 v110, v110, v17
    v_mov_b32 v18, 2130706432
    v_cndmask_b32 v110, v18, v110, vcc
    s_waitcnt lgkmcnt(0)
    s_add_u32 s8, s4, s47
    s_addc_u32 s9, s5, 0
    s_lshl_b32 s36, s29, 4
    s_lshl_b32 s37, s33, 3
    s_add_u32 s36, s36, s37
    s_mul_i32 s36, s36, 57344
    s_add_u32 s36, s36, 9437184
    s_add_u32 s12, s30, s36
    s_addc_u32 s13, s31, 0
    s_mov_b32 s14, 458752
    s_mov_b32 s15, 0x00020000
    s_mul_i32 s36, s35, 2097152
    s_add_u32 s36, s36, 27262976
    s_mul_i32 s37, s33, 8388608
    s_add_u32 s36, s36, s37
    s_add_u32 s16, s30, s36
    s_addc_u32 s17, s31, 0
    s_mov_b32 s18, 2097152
    s_mov_b32 s19, 0x00020000
    v_and_b32 v10, 15, v127
    v_lshrrev_b32 v11, 4, v127
    v_add_u32 v8, 0, v10
    v_and_b32 v16, 4, v8
    v_lshrrev_b32 v16, 1, v16
    v_xor_b32 v16, v11, v16
    v_lshlrev_b32 v16, 4, v16
    v_lshl_add_u32 v8, v8, 6, v16
    v_add_u32 v9, 1, v10
    v_and_b32 v16, 4, v9
    v_lshrrev_b32 v16, 1, v16
    v_xor_b32 v16, v11, v16
    v_lshlrev_b32 v16, 4, v16
    v_lshl_add_u32 v9, v9, 6, v16
    s_lshr_b32 s38, s32, 1
    s_and_b32 s39, s32, 1
    s_add_u32 s40, s38, 4
    s_lshl_b32 s43, s39, 10
    s_cmp_lt_u32 s20, 4
    s_cselect_b32 s40, s20, s40
    s_cselect_b32 s36, 0, s43
    s_lshl_b32 s37, s40, 13
    s_add_u32 s37, s37, s36
    v_lshl_add_u32 v125, v127, 4, s37
    s_mul_i32 s37, s40, 16384
    v_add_u32 v120, s37, v8
    v_add_u32 v121, s37, v9
    s_lshl_b32 s37, s40, 10
    s_add_u32 s37, s37, 115712
    v_lshl_add_u32 v16, v11, 4, s37
    v_cmp_eq_u32 vcc, 15, v10
    v_mov_b32 v17, 8192
    v_mov_b32 v18, 4294959104
    v_mov_b32 v19, 64
    v_cndmask_b32 v122, v121, v16, vcc
    v_cndmask_b32 v123, v17, v19, vcc
    v_cndmask_b32 v124, v18, v19, vcc
    v_lshl_add_u32 v126, v127, 4, s37
    s_mov_b32 s44, 0x3f800000
    s_mov_b32 s45, 0x00000000
    s_mov_b32 s46, 0x00000000
    s_cmp_eq_u32 s40, 1
    s_cselect_b32 s45, 0x3f800000, s45
    s_cselect_b32 s46, 0x3f800000, s46
    s_cmp_eq_u32 s40, 2
    s_cselect_b32 s45, 0xbf800000, s45
    s_cselect_b32 s46, 0x3f800000, s46
    s_cmp_eq_u32 s40, 3
    s_cselect_b32 s45, 0x40000000, s45
    s_cselect_b32 s46, 0x40800000, s46
    s_cmp_eq_u32 s40, 4
    s_cselect_b32 s45, 0xc0000000, s45
    s_cselect_b32 s46, 0x40800000, s46
    s_cmp_eq_u32 s40, 5
    s_cselect_b32 s44, 0x41800000, s44
    s_cselect_b32 s45, 0x41000000, s45
    s_cselect_b32 s46, 0x40800000, s46
    s_cmp_ge_u32 s20, 4
    s_cbranch_scc1 L_conv2_kernel_m2
    v_mov_b32 v0, 0
    v_mov_b32 v1, 0
    v_mov_b32 v2, 0
    v_mov_b32 v3, 0
    v_mov_b32 v4, 0
    v_mov_b32 v5, 0
    v_mov_b32 v6, 0
    v_mov_b32 v7, 0
    v_mov_b32 v8, 0
    v_mov_b32 v9, 0
    v_mov_b32 v10, 0
    v_mov_b32 v11, 0
    v_mov_b32 v12, 0
    v_mov_b32 v13, 0
    v_mov_b32 v14, 0
    v_mov_b32 v15, 0
    v_mov_b32 v16, 0
    v_mov_b32 v17, 0
    v_mov_b32 v18, 0
    v_mov_b32 v19, 0
    v_mov_b32 v20, 0
    v_mov_b32 v21, 0
    v_mov_b32 v22, 0
    v_mov_b32 v23, 0
    v_mov_b32 v24, 0
    v_mov_b32 v25, 0
    v_mov_b32 v26, 0
    v_mov_b32 v27, 0
    v_mov_b32 v28, 0
    v_mov_b32 v29, 0
    v_mov_b32 v30, 0
    v_mov_b32 v31, 0
    v_mov_b32 v32, 0
    v_mov_b32 v33, 0
    v_mov_b32 v34, 0
    v_mov_b32 v35, 0
    v_mov_b32 v36, 0
    v_mov_b32 v37, 0
    v_mov_b32 v38, 0
    v_mov_b32 v39, 0
    v_mov_b32 v40, 0
    v_mov_b32 v41, 0
    v_mov_b32 v42, 0
    v_mov_b32 v43, 0
    v_mov_b32 v44, 0
    v_mov_b32 v45, 0
    v_mov_b32 v46, 0
    v_mov_b32 v47, 0
    v_mov_b32 v48, 0
    v_mov_b32 v49, 0
    v_mov_b32 v50, 0
    v_mov_b32 v51, 0
    v_mov_b32 v52, 0
    v_mov_b32 v53, 0
    v_mov_b32 v54, 0
    v_mov_b32 v55, 0
    v_mov_b32 v56, 0
    v_mov_b32 v57, 0
    v_mov_b32 v58, 0
    v_mov_b32 v59, 0
    v_mov_b32 v60, 0
    v_mov_b32 v61, 0
    v_mov_b32 v62, 0
    v_mov_b32 v63, 0
    buffer_load_dwordx4 v[96:99], v108, s[8:11], 0 offen
    buffer_load_dwordx4 v[100:103], v109, s[8:11], 0 offen
    buffer_load_dwordx4 v[104:107], v110, s[8:11], 0 offen
    s_mov_b32 s23, 0
    s_mov_b32 s26, 4096
    buffer_load_dwordx4 v[64:67], v125, s[12:15], s23 offen offset:0
    buffer_load_dwordx4 v[68:71], v125, s[12:15], s23 offen offset:1024
    buffer_load_dwordx4 v[72:75], v125, s[12:15], s23 offen offset:2048
    buffer_load_dwordx4 v[76:79], v125, s[12:15], s23 offen offset:3072
    buffer_load_dwordx4 v[80:83], v125, s[12:15], s26 offen offset:0
    buffer_load_dwordx4 v[84:87], v125, s[12:15], s26 offen offset:1024
    buffer_load_dwordx4 v[88:91], v125, s[12:15], s26 offen offset:2048
    buffer_load_dwordx4 v[92:95], v125, s[12:15], s26 offen offset:3072
    s_mov_b32 s23, 57344
    s_mov_b32 s26, 61440
    s_waitcnt vmcnt(8)
    v_lshlrev_b32 v108, 16, v96
    v_and_b32 v111, s25, v96
    v_lshlrev_b32 v109, 16, v100
    v_and_b32 v112, s25, v100
    v_lshlrev_b32 v110, 16, v104
    v_and_b32 v113, s25, v104
    v_mul_f32 v114, s44, v108
    v_mul_f32 v115, s44, v111
    v_fmac_f32 v114, s45, v109
    v_fmac_f32 v115, s45, v112
    v_fmac_f32 v114, s46, v110
    v_fmac_f32 v115, s46, v113
    v_cvt_pk_bf16_f32 v96, v114, v115
    v_lshlrev_b32 v108, 16, v97
    v_and_b32 v111, s25, v97
    v_lshlrev_b32 v109, 16, v101
    v_and_b32 v112, s25, v101
    v_lshlrev_b32 v110, 16, v105
    v_and_b32 v113, s25, v105
    v_mul_f32 v114, s44, v108
    v_mul_f32 v115, s44, v111
    v_fmac_f32 v114, s45, v109
    v_fmac_f32 v115, s45, v112
    v_fmac_f32 v114, s46, v110
    v_fmac_f32 v115, s46, v113
    v_cvt_pk_bf16_f32 v97, v114, v115
    v_lshlrev_b32 v108, 16, v98
    v_and_b32 v111, s25, v98
    v_lshlrev_b32 v109, 16, v102
    v_and_b32 v112, s25, v102
    v_lshlrev_b32 v110, 16, v106
    v_and_b32 v113, s25, v106
    v_mul_f32 v114, s44, v108
    v_mul_f32 v115, s44, v111
    v_fmac_f32 v114, s45, v109
    v_fmac_f32 v115, s45, v112
    v_fmac_f32 v114, s46, v110
    v_fmac_f32 v115, s46, v113
    v_cvt_pk_bf16_f32 v98, v114, v115
    v_lshlrev_b32 v108, 16, v99
    v_and_b32 v111, s25, v99
    v_lshlrev_b32 v109, 16, v103
    v_and_b32 v112, s25, v103
    v_lshlrev_b32 v110, 16, v107
    v_and_b32 v113, s25, v107
    v_mul_f32 v114, s44, v108
    v_mul_f32 v115, s44, v111
    v_fmac_f32 v114, s45, v109
    v_fmac_f32 v115, s45, v112
    v_fmac_f32 v114, s46, v110
    v_fmac_f32 v115, s46, v113
    v_cvt_pk_bf16_f32 v99, v114, v115
    ds_write_b128 v126, v[96:99]
    s_waitcnt lgkmcnt(0)
    s_barrier
    s_mov_b32 s22, 4
    s_setprio 2
L_conv2_kernel_mloop1:
    ds_read_b128 v[96:99], v120 offset:0
    ds_read_b128 v[100:103], v120 offset:1024
    ds_read_b128 v[104:107], v120 offset:2048
    ds_read_b128 v[108:111], v120 offset:3072
    ds_read_b128 v[112:115], v120 offset:4096
    ds_read_b128 v[116:119], v120 offset:5120
    s_waitcnt vmcnt(6) lgkmcnt(5)
    s_nop 0
    v_mfma_f32_16x16x32_bf16 v[0:3], v[64:67], v[96:99], v[0:3]
    v_mfma_f32_16x16x32_bf16 v[32:35], v[68:71], v[96:99], v[32:35]
    ds_read_b128 v[96:99], v120 offset:6144
    s_waitcnt vmcnt(4) lgkmcnt(5)
    s_nop 0
    v_mfma_f32_16x16x32_bf16 v[4:7], v[64:67], v[100:103], v[4:7]
    v_mfma_f32_16x16x32_bf16 v[36:39], v[68:71], v[100:103], v[36:39]
    v_mfma_f32_16x16x32_bf16 v[0:3], v[72:75], v[100:103], v[0:3]
    v_mfma_f32_16x16x32_bf16 v[32:35], v[76:79], v[100:103], v[32:35]
    ds_read_b128 v[100:103], v120 offset:7168
    s_waitcnt vmcnt(2) lgkmcnt(5)
    s_nop 0
    v_mfma_f32_16x16x32_bf16 v[8:11], v[64:67], v[104:107], v[8:11]
    v_mfma_f32_16x16x32_bf16 v[40:43], v[68:71], v[104:107], v[40:43]
    v_mfma_f32_16x16x32_bf16 v[4:7], v[72:75], v[104:107], v[4:7]
    v_mfma_f32_16x16x32_bf16 v[36:39], v[76:79], v[104:107], v[36:39]
    v_mfma_f32_16x16x32_bf16 v[0:3], v[80:83], v[104:107], v[0:3]
    v_mfma_f32_16x16x32_bf16 v[32:35], v[84:87], v[104:107], v[32:35]
    ds_read_b128 v[104:107], v122 offset:0
    v_add_u32 v122, v123, v122
    s_waitcnt vmcnt(0) lgkmcnt(5)
    v_mfma_f32_16x16x32_bf16 v[12:15], v[64:67], v[108:111], v[12:15]
    v_mfma_f32_16x16x32_bf16 v[44:47], v[68:71], v[108:111], v[44:47]
    v_mfma_f32_16x16x32_bf16 v[8:11], v[72:75], v[108:111], v[8:11]
    v_mfma_f32_16x16x32_bf16 v[40:43], v[76:79], v[108:111], v[40:43]
    v_mfma_f32_16x16x32_bf16 v[4:7], v[80:83], v[108:111], v[4:7]
    v_mfma_f32_16x16x32_bf16 v[36:39], v[84:87], v[108:111], v[36:39]
    v_mfma_f32_16x16x32_bf16 v[0:3], v[88:91], v[108:111], v[0:3]
    v_mfma_f32_16x16x32_bf16 v[32:35], v[92:95], v[108:111], v[32:35]
    ds_read_b128 v[108:111], v121 offset:1024
    s_waitcnt lgkmcnt(5)
    s_nop 0
    v_mfma_f32_16x16x32_bf16 v[16:19], v[64:67], v[112:115], v[16:19]
    v_mfma_f32_16x16x32_bf16 v[48:51], v[68:71], v[112:115], v[48:51]
    v_mfma_f32_16x16x32_bf16 v[12:15], v[72:75], v[112:115], v[12:15]
    v_mfma_f32_16x16x32_bf16 v[44:47], v[76:79], v[112:115], v[44:47]
    v_mfma_f32_16x16x32_bf16 v[8:11], v[80:83], v[112:115], v[8:11]
    v_mfma_f32_16x16x32_bf16 v[40:43], v[84:87], v[112:115], v[40:43]
    v_mfma_f32_16x16x32_bf16 v[4:7], v[88:91], v[112:115], v[4:7]
    v_mfma_f32_16x16x32_bf16 v[36:39], v[92:95], v[112:115], v[36:39]
    ds_read_b128 v[112:115], v121 offset:2048
    s_waitcnt lgkmcnt(5)
    s_nop 0
    v_mfma_f32_16x16x32_bf16 v[20:23], v[64:67], v[116:119], v[20:23]
    v_mfma_f32_16x16x32_bf16 v[52:55], v[68:71], v[116:119], v[52:55]
    v_mfma_f32_16x16x32_bf16 v[16:19], v[72:75], v[116:119], v[16:19]
    v_mfma_f32_16x16x32_bf16 v[48:51], v[76:79], v[116:119], v[48:51]
    v_mfma_f32_16x16x32_bf16 v[12:15], v[80:83], v[116:119], v[12:15]
    v_mfma_f32_16x16x32_bf16 v[44:47], v[84:87], v[116:119], v[44:47]
    v_mfma_f32_16x16x32_bf16 v[8:11], v[88:91], v[116:119], v[8:11]
    v_mfma_f32_16x16x32_bf16 v[40:43], v[92:95], v[116:119], v[40:43]
    s_waitcnt lgkmcnt(4)
    s_nop 0
    v_mfma_f32_16x16x32_bf16 v[24:27], v[64:67], v[96:99], v[24:27]
    v_mfma_f32_16x16x32_bf16 v[56:59], v[68:71], v[96:99], v[56:59]
    v_mfma_f32_16x16x32_bf16 v[20:23], v[72:75], v[96:99], v[20:23]
    v_mfma_f32_16x16x32_bf16 v[52:55], v[76:79], v[96:99], v[52:55]
    v_mfma_f32_16x16x32_bf16 v[16:19], v[80:83], v[96:99], v[16:19]
    v_mfma_f32_16x16x32_bf16 v[48:51], v[84:87], v[96:99], v[48:51]
    v_mfma_f32_16x16x32_bf16 v[12:15], v[88:91], v[96:99], v[12:15]
    v_mfma_f32_16x16x32_bf16 v[44:47], v[92:95], v[96:99], v[44:47]
    s_waitcnt lgkmcnt(3)
    s_nop 0
    v_mfma_f32_16x16x32_bf16 v[28:31], v[64:67], v[100:103], v[28:31]
    v_mfma_f32_16x16x32_bf16 v[60:63], v[68:71], v[100:103], v[60:63]
    v_mfma_f32_16x16x32_bf16 v[24:27], v[72:75], v[100:103], v[24:27]
    v_mfma_f32_16x16x32_bf16 v[56:59], v[76:79], v[100:103], v[56:59]
    v_mfma_f32_16x16x32_bf16 v[20:23], v[80:83], v[100:103], v[20:23]
    v_mfma_f32_16x16x32_bf16 v[52:55], v[84:87], v[100:103], v[52:55]
    v_mfma_f32_16x16x32_bf16 v[16:19], v[88:91], v[100:103], v[16:19]
    v_mfma_f32_16x16x32_bf16 v[48:51], v[92:95], v[100:103], v[48:51]
    buffer_load_dwordx4 v[64:67], v125, s[12:15], s23 offen offset:0
    buffer_load_dwordx4 v[68:71], v125, s[12:15], s23 offen offset:1024
    s_waitcnt lgkmcnt(2)
    s_nop 0
    v_mfma_f32_16x16x32_bf16 v[28:31], v[72:75], v[104:107], v[28:31]
    v_mfma_f32_16x16x32_bf16 v[60:63], v[76:79], v[104:107], v[60:63]
    v_mfma_f32_16x16x32_bf16 v[24:27], v[80:83], v[104:107], v[24:27]
    v_mfma_f32_16x16x32_bf16 v[56:59], v[84:87], v[104:107], v[56:59]
    v_mfma_f32_16x16x32_bf16 v[20:23], v[88:91], v[104:107], v[20:23]
    v_mfma_f32_16x16x32_bf16 v[52:55], v[92:95], v[104:107], v[52:55]
    buffer_load_dwordx4 v[72:75], v125, s[12:15], s23 offen offset:2048
    buffer_load_dwordx4 v[76:79], v125, s[12:15], s23 offen offset:3072
    s_waitcnt lgkmcnt(1)
    s_nop 0
    v_mfma_f32_16x16x32_bf16 v[28:31], v[80:83], v[108:111], v[28:31]
    v_mfma_f32_16x16x32_bf16 v[60:63], v[84:87], v[108:111], v[60:63]
    v_mfma_f32_16x16x32_bf16 v[24:27], v[88:91], v[108:111], v[24:27]
    v_mfma_f32_16x16x32_bf16 v[56:59], v[92:95], v[108:111], v[56:59]
    buffer_load_dwordx4 v[80:83], v125, s[12:15], s26 offen offset:0
    buffer_load_dwordx4 v[84:87], v125, s[12:15], s26 offen offset:1024
    s_waitcnt lgkmcnt(0)
    s_nop 0
    v_mfma_f32_16x16x32_bf16 v[28:31], v[88:91], v[112:115], v[28:31]
    v_mfma_f32_16x16x32_bf16 v[60:63], v[92:95], v[112:115], v[60:63]
    buffer_load_dwordx4 v[88:91], v125, s[12:15], s26 offen offset:2048
    buffer_load_dwordx4 v[92:95], v125, s[12:15], s26 offen offset:3072
    s_add_u32 s23, s23, 57344
    s_add_u32 s26, s26, 57344
    s_barrier
    s_sub_u32 s22, s22, 1
    s_cmp_eq_u32 s22, 0
    s_cbranch_scc1 L_conv2_kernel_mlast1
    ds_read_b128 v[96:99], v120 offset:8192
    ds_read_b128 v[100:103], v120 offset:9216
    ds_read_b128 v[104:107], v120 offset:10240
    ds_read_b128 v[108:111], v120 offset:11264
    ds_read_b128 v[112:115], v120 offset:12288
    ds_read_b128 v[116:119], v120 offset:13312
    s_waitcnt vmcnt(6) lgkmcnt(5)
    s_nop 0
    v_mfma_f32_16x16x32_bf16 v[0:3], v[64:67], v[96:99], v[0:3]
    v_mfma_f32_16x16x32_bf16 v[32:35], v[68:71], v[96:99], v[32:35]
    ds_read_b128 v[96:99], v120 offset:14336
    s_waitcnt vmcnt(4) lgkmcnt(5)
    s_nop 0
    v_mfma_f32_16x16x32_bf16 v[4:7], v[64:67], v[100:103], v[4:7]
    v_mfma_f32_16x16x32_bf16 v[36:39], v[68:71], v[100:103], v[36:39]
    v_mfma_f32_16x16x32_bf16 v[0:3], v[72:75], v[100:103], v[0:3]
    v_mfma_f32_16x16x32_bf16 v[32:35], v[76:79], v[100:103], v[32:35]
    ds_read_b128 v[100:103], v120 offset:15360
    s_waitcnt vmcnt(2) lgkmcnt(5)
    s_nop 0
    v_mfma_f32_16x16x32_bf16 v[8:11], v[64:67], v[104:107], v[8:11]
    v_mfma_f32_16x16x32_bf16 v[40:43], v[68:71], v[104:107], v[40:43]
    v_mfma_f32_16x16x32_bf16 v[4:7], v[72:75], v[104:107], v[4:7]
    v_mfma_f32_16x16x32_bf16 v[36:39], v[76:79], v[104:107], v[36:39]
    v_mfma_f32_16x16x32_bf16 v[0:3], v[80:83], v[104:107], v[0:3]
    v_mfma_f32_16x16x32_bf16 v[32:35], v[84:87], v[104:107], v[32:35]
    ds_read_b128 v[104:107], v122 offset:0
    v_add_u32 v122, v124, v122
    s_waitcnt vmcnt(0) lgkmcnt(5)
    v_mfma_f32_16x16x32_bf16 v[12:15], v[64:67], v[108:111], v[12:15]
    v_mfma_f32_16x16x32_bf16 v[44:47], v[68:71], v[108:111], v[44:47]
    v_mfma_f32_16x16x32_bf16 v[8:11], v[72:75], v[108:111], v[8:11]
    v_mfma_f32_16x16x32_bf16 v[40:43], v[76:79], v[108:111], v[40:43]
    v_mfma_f32_16x16x32_bf16 v[4:7], v[80:83], v[108:111], v[4:7]
    v_mfma_f32_16x16x32_bf16 v[36:39], v[84:87], v[108:111], v[36:39]
    v_mfma_f32_16x16x32_bf16 v[0:3], v[88:91], v[108:111], v[0:3]
    v_mfma_f32_16x16x32_bf16 v[32:35], v[92:95], v[108:111], v[32:35]
    ds_read_b128 v[108:111], v121 offset:9216
    s_waitcnt lgkmcnt(5)
    s_nop 0
    v_mfma_f32_16x16x32_bf16 v[16:19], v[64:67], v[112:115], v[16:19]
    v_mfma_f32_16x16x32_bf16 v[48:51], v[68:71], v[112:115], v[48:51]
    v_mfma_f32_16x16x32_bf16 v[12:15], v[72:75], v[112:115], v[12:15]
    v_mfma_f32_16x16x32_bf16 v[44:47], v[76:79], v[112:115], v[44:47]
    v_mfma_f32_16x16x32_bf16 v[8:11], v[80:83], v[112:115], v[8:11]
    v_mfma_f32_16x16x32_bf16 v[40:43], v[84:87], v[112:115], v[40:43]
    v_mfma_f32_16x16x32_bf16 v[4:7], v[88:91], v[112:115], v[4:7]
    v_mfma_f32_16x16x32_bf16 v[36:39], v[92:95], v[112:115], v[36:39]
    ds_read_b128 v[112:115], v121 offset:10240
    s_waitcnt lgkmcnt(5)
    s_nop 0
    v_mfma_f32_16x16x32_bf16 v[20:23], v[64:67], v[116:119], v[20:23]
    v_mfma_f32_16x16x32_bf16 v[52:55], v[68:71], v[116:119], v[52:55]
    v_mfma_f32_16x16x32_bf16 v[16:19], v[72:75], v[116:119], v[16:19]
    v_mfma_f32_16x16x32_bf16 v[48:51], v[76:79], v[116:119], v[48:51]
    v_mfma_f32_16x16x32_bf16 v[12:15], v[80:83], v[116:119], v[12:15]
    v_mfma_f32_16x16x32_bf16 v[44:47], v[84:87], v[116:119], v[44:47]
    v_mfma_f32_16x16x32_bf16 v[8:11], v[88:91], v[116:119], v[8:11]
    v_mfma_f32_16x16x32_bf16 v[40:43], v[92:95], v[116:119], v[40:43]
    s_waitcnt lgkmcnt(4)
    s_nop 0
    v_mfma_f32_16x16x32_bf16 v[24:27], v[64:67], v[96:99], v[24:27]
    v_mfma_f32_16x16x32_bf16 v[56:59], v[68:71], v[96:99], v[56:59]
    v_mfma_f32_16x16x32_bf16 v[20:23], v[72:75], v[96:99], v[20:23]
    v_mfma_f32_16x16x32_bf16 v[52:55], v[76:79], v[96:99], v[52:55]
    v_mfma_f32_16x16x32_bf16 v[16:19], v[80:83], v[96:99], v[16:19]
    v_mfma_f32_16x16x32_bf16 v[48:51], v[84:87], v[96:99], v[48:51]
    v_mfma_f32_16x16x32_bf16 v[12:15], v[88:91], v[96:99], v[12:15]
    v_mfma_f32_16x16x32_bf16 v[44:47], v[92:95], v[96:99], v[44:47]
    s_waitcnt lgkmcnt(3)
    s_nop 0
    v_mfma_f32_16x16x32_bf16 v[28:31], v[64:67], v[100:103], v[28:31]
    v_mfma_f32_16x16x32_bf16 v[60:63], v[68:71], v[100:103], v[60:63]
    v_mfma_f32_16x16x32_bf16 v[24:27], v[72:75], v[100:103], v[24:27]
    v_mfma_f32_16x16x32_bf16 v[56:59], v[76:79], v[100:103], v[56:59]
    v_mfma_f32_16x16x32_bf16 v[20:23], v[80:83], v[100:103], v[20:23]
    v_mfma_f32_16x16x32_bf16 v[52:55], v[84:87], v[100:103], v[52:55]
    v_mfma_f32_16x16x32_bf16 v[16:19], v[88:91], v[100:103], v[16:19]
    v_mfma_f32_16x16x32_bf16 v[48:51], v[92:95], v[100:103], v[48:51]
    buffer_load_dwordx4 v[64:67], v125, s[12:15], s23 offen offset:0
    buffer_load_dwordx4 v[68:71], v125, s[12:15], s23 offen offset:1024
    s_waitcnt lgkmcnt(2)
    s_nop 0
    v_mfma_f32_16x16x32_bf16 v[28:31], v[72:75], v[104:107], v[28:31]
    v_mfma_f32_16x16x32_bf16 v[60:63], v[76:79], v[104:107], v[60:63]
    v_mfma_f32_16x16x32_bf16 v[24:27], v[80:83], v[104:107], v[24:27]
    v_mfma_f32_16x16x32_bf16 v[56:59], v[84:87], v[104:107], v[56:59]
    v_mfma_f32_16x16x32_bf16 v[20:23], v[88:91], v[104:107], v[20:23]
    v_mfma_f32_16x16x32_bf16 v[52:55], v[92:95], v[104:107], v[52:55]
    buffer_load_dwordx4 v[72:75], v125, s[12:15], s23 offen offset:2048
    buffer_load_dwordx4 v[76:79], v125, s[12:15], s23 offen offset:3072
    s_waitcnt lgkmcnt(1)
    s_nop 0
    v_mfma_f32_16x16x32_bf16 v[28:31], v[80:83], v[108:111], v[28:31]
    v_mfma_f32_16x16x32_bf16 v[60:63], v[84:87], v[108:111], v[60:63]
    v_mfma_f32_16x16x32_bf16 v[24:27], v[88:91], v[108:111], v[24:27]
    v_mfma_f32_16x16x32_bf16 v[56:59], v[92:95], v[108:111], v[56:59]
    buffer_load_dwordx4 v[80:83], v125, s[12:15], s26 offen offset:0
    buffer_load_dwordx4 v[84:87], v125, s[12:15], s26 offen offset:1024
    s_waitcnt lgkmcnt(0)
    s_nop 0
    v_mfma_f32_16x16x32_bf16 v[28:31], v[88:91], v[112:115], v[28:31]
    v_mfma_f32_16x16x32_bf16 v[60:63], v[92:95], v[112:115], v[60:63]
    buffer_load_dwordx4 v[88:91], v125, s[12:15], s26 offen offset:2048
    buffer_load_dwordx4 v[92:95], v125, s[12:15], s26 offen offset:3072
    s_add_u32 s23, s23, 57344
    s_add_u32 s26, s26, 57344
    s_barrier
    s_branch L_conv2_kernel_mloop1
L_conv2_kernel_mlast1:
    v_and_b32 v125, 15, v127
    v_and_b32 v126, 7, v127
    v_lshlrev_b32 v126, 4, v126
    v_lshl_add_u32 v125, v125, 7, v126
    v_lshrrev_b32 v126, 4, v127
    v_lshl_add_u32 v125, v126, 11, v125
    s_lshl_b32 s36, s20, 14
    s_add_u32 s37, s36, 8192
    v_add_u32 v126, s37, v125
    v_add_u32 v125, s36, v125
    ds_read_b128 v[96:99], v120 offset:8192
    ds_read_b128 v[100:103], v120 offset:9216
    ds_read_b128 v[104:107], v120 offset:10240
    ds_read_b128 v[108:111], v120 offset:11264
    ds_read_b128 v[112:115], v120 offset:12288
    ds_read_b128 v[116:119], v120 offset:13312
    s_waitcnt vmcnt(6) lgkmcnt(5)
    v_mfma_f32_16x16x32_bf16 v[0:3], v[64:67], v[96:99], v[0:3]
    v_mfma_f32_16x16x32_bf16 v[32:35], v[68:71], v[96:99], v[32:35]
    ds_read_b128 v[96:99], v120 offset:14336
    s_waitcnt vmcnt(4) lgkmcnt(5)
    v_mfma_f32_16x16x32_bf16 v[4:7], v[64:67], v[100:103], v[4:7]
    v_mfma_f32_16x16x32_bf16 v[36:39], v[68:71], v[100:103], v[36:39]
    v_mfma_f32_16x16x32_bf16 v[0:3], v[72:75], v[100:103], v[0:3]
    v_mfma_f32_16x16x32_bf16 v[32:35], v[76:79], v[100:103], v[32:35]
    ds_read_b128 v[100:103], v120 offset:15360
    s_waitcnt vmcnt(2) lgkmcnt(5)
    v_mfma_f32_16x16x32_bf16 v[8:11], v[64:67], v[104:107], v[8:11]
    v_mfma_f32_16x16x32_bf16 v[40:43], v[68:71], v[104:107], v[40:43]
    v_mfma_f32_16x16x32_bf16 v[4:7], v[72:75], v[104:107], v[4:7]
    v_mfma_f32_16x16x32_bf16 v[36:39], v[76:79], v[104:107], v[36:39]
    v_mfma_f32_16x16x32_bf16 v[0:3], v[80:83], v[104:107], v[0:3]
    v_mfma_f32_16x16x32_bf16 v[32:35], v[84:87], v[104:107], v[32:35]
    ds_read_b128 v[104:107], v122 offset:0
    s_waitcnt vmcnt(0) lgkmcnt(5)
    v_mfma_f32_16x16x32_bf16 v[12:15], v[64:67], v[108:111], v[12:15]
    v_mfma_f32_16x16x32_bf16 v[44:47], v[68:71], v[108:111], v[44:47]
    v_mfma_f32_16x16x32_bf16 v[8:11], v[72:75], v[108:111], v[8:11]
    v_mfma_f32_16x16x32_bf16 v[40:43], v[76:79], v[108:111], v[40:43]
    v_mfma_f32_16x16x32_bf16 v[4:7], v[80:83], v[108:111], v[4:7]
    v_mfma_f32_16x16x32_bf16 v[36:39], v[84:87], v[108:111], v[36:39]
    v_mfma_f32_16x16x32_bf16 v[0:3], v[88:91], v[108:111], v[0:3]
    v_mfma_f32_16x16x32_bf16 v[32:35], v[92:95], v[108:111], v[32:35]
    ds_read_b128 v[108:111], v121 offset:9216
    s_waitcnt lgkmcnt(5)
    v_mfma_f32_16x16x32_bf16 v[16:19], v[64:67], v[112:115], v[16:19]
    v_mfma_f32_16x16x32_bf16 v[48:51], v[68:71], v[112:115], v[48:51]
    v_mfma_f32_16x16x32_bf16 v[12:15], v[72:75], v[112:115], v[12:15]
    v_mfma_f32_16x16x32_bf16 v[44:47], v[76:79], v[112:115], v[44:47]
    v_mfma_f32_16x16x32_bf16 v[8:11], v[80:83], v[112:115], v[8:11]
    v_mfma_f32_16x16x32_bf16 v[40:43], v[84:87], v[112:115], v[40:43]
    v_mfma_f32_16x16x32_bf16 v[4:7], v[88:91], v[112:115], v[4:7]
    v_mfma_f32_16x16x32_bf16 v[36:39], v[92:95], v[112:115], v[36:39]
    ds_read_b128 v[112:115], v121 offset:10240
    v_xor_b32 v123, 0, v125
    ds_write_b128 v123, v[0:3]
    s_waitcnt lgkmcnt(6)
    v_mfma_f32_16x16x32_bf16 v[20:23], v[64:67], v[116:119], v[20:23]
    v_mfma_f32_16x16x32_bf16 v[52:55], v[68:71], v[116:119], v[52:55]
    v_mfma_f32_16x16x32_bf16 v[16:19], v[72:75], v[116:119], v[16:19]
    v_mfma_f32_16x16x32_bf16 v[48:51], v[76:79], v[116:119], v[48:51]
    v_mfma_f32_16x16x32_bf16 v[12:15], v[80:83], v[116:119], v[12:15]
    v_mfma_f32_16x16x32_bf16 v[44:47], v[84:87], v[116:119], v[44:47]
    v_mfma_f32_16x16x32_bf16 v[8:11], v[88:91], v[116:119], v[8:11]
    v_mfma_f32_16x16x32_bf16 v[40:43], v[92:95], v[116:119], v[40:43]
    v_xor_b32 v124, 16, v125
    ds_write_b128 v124, v[4:7]
    s_waitcnt lgkmcnt(2)
    v_mfma_f32_16x16x32_bf16 v[24:27], v[64:67], v[96:99], v[24:27]
    v_mfma_f32_16x16x32_bf16 v[56:59], v[68:71], v[96:99], v[56:59]
    v_mfma_f32_16x16x32_bf16 v[20:23], v[72:75], v[96:99], v[20:23]
    v_mfma_f32_16x16x32_bf16 v[52:55], v[76:79], v[96:99], v[52:55]
    v_mfma_f32_16x16x32_bf16 v[16:19], v[80:83], v[96:99], v[16:19]
    v_mfma_f32_16x16x32_bf16 v[48:51], v[84:87], v[96:99], v[48:51]
    v_mfma_f32_16x16x32_bf16 v[12:15], v[88:91], v[96:99], v[12:15]
    v_mfma_f32_16x16x32_bf16 v[44:47], v[92:95], v[96:99], v[44:47]
    v_xor_b32 v123, 32, v125
    ds_write_b128 v123, v[8:11]
    v_xor_b32 v124, 0, v126
    ds_write_b128 v124, v[32:35]
    v_mfma_f32_16x16x32_bf16 v[28:31], v[64:67], v[100:103], v[28:31]
    v_mfma_f32_16x16x32_bf16 v[60:63], v[68:71], v[100:103], v[60:63]
    v_mfma_f32_16x16x32_bf16 v[24:27], v[72:75], v[100:103], v[24:27]
    v_mfma_f32_16x16x32_bf16 v[56:59], v[76:79], v[100:103], v[56:59]
    v_mfma_f32_16x16x32_bf16 v[20:23], v[80:83], v[100:103], v[20:23]
    v_mfma_f32_16x16x32_bf16 v[52:55], v[84:87], v[100:103], v[52:55]
    v_mfma_f32_16x16x32_bf16 v[16:19], v[88:91], v[100:103], v[16:19]
    v_mfma_f32_16x16x32_bf16 v[48:51], v[92:95], v[100:103], v[48:51]
    v_xor_b32 v123, 16, v126
    ds_write_b128 v123, v[36:39]
    v_xor_b32 v124, 32, v126
    ds_write_b128 v124, v[40:43]
    v_mfma_f32_16x16x32_bf16 v[28:31], v[72:75], v[104:107], v[28:31]
    v_mfma_f32_16x16x32_bf16 v[60:63], v[76:79], v[104:107], v[60:63]
    v_mfma_f32_16x16x32_bf16 v[24:27], v[80:83], v[104:107], v[24:27]
    v_mfma_f32_16x16x32_bf16 v[56:59], v[84:87], v[104:107], v[56:59]
    v_mfma_f32_16x16x32_bf16 v[20:23], v[88:91], v[104:107], v[20:23]
    v_mfma_f32_16x16x32_bf16 v[52:55], v[92:95], v[104:107], v[52:55]
    v_xor_b32 v124, 48, v125
    ds_write_b128 v124, v[12:15]
    v_xor_b32 v123, 48, v126
    ds_write_b128 v123, v[44:47]
    v_mfma_f32_16x16x32_bf16 v[28:31], v[80:83], v[108:111], v[28:31]
    v_mfma_f32_16x16x32_bf16 v[60:63], v[84:87], v[108:111], v[60:63]
    v_mfma_f32_16x16x32_bf16 v[24:27], v[88:91], v[108:111], v[24:27]
    v_mfma_f32_16x16x32_bf16 v[56:59], v[92:95], v[108:111], v[56:59]
    v_xor_b32 v123, 64, v125
    ds_write_b128 v123, v[16:19]
    v_xor_b32 v124, 64, v126
    ds_write_b128 v124, v[48:51]
    v_mfma_f32_16x16x32_bf16 v[28:31], v[88:91], v[112:115], v[28:31]
    v_mfma_f32_16x16x32_bf16 v[60:63], v[92:95], v[112:115], v[60:63]
    v_xor_b32 v124, 80, v125
    ds_write_b128 v124, v[20:23]
    v_xor_b32 v123, 80, v126
    ds_write_b128 v123, v[52:55]
    v_and_b32 v108, 15, v127
    v_lshrrev_b32 v109, 4, v127
    v_lshrrev_b32 v110, 3, v108
    s_lshl_b32 s36, s20, 1
    v_add_u32 v110, s36, v110
    v_xor_b32 v111, v110, v108
    v_and_b32 v111, 7, v111
    v_lshlrev_b32 v111, 4, v111
    v_xor_b32 v123, 96, v125
    ds_write_b128 v123, v[24:27]
    v_lshl_add_u32 v111, v110, 7, v111
    v_lshl_add_u32 v120, v109, 11, v111
    v_add_u32 v121, 65536, v120
    v_add_u32 v64, 131072, v120
    s_lshl_b32 s36, s20, 9
    s_add_u32 s36, s36, 115712
    v_lshl_add_u32 v127, v109, 7, s36
    s_lshl_b32 s36, s20, 4
    v_add_u32 v108, s36, v108
    v_lshlrev_b32 v110, 6, v108
    v_lshl_add_u32 v110, v109, 4, v110
    s_mul_i32 s36, s29, 262144
    v_xor_b32 v124, 96, v126
    ds_write_b128 v124, v[56:59]
    s_lshl_b32 s37, s21, 4
    s_add_u32 s36, s36, s37
    v_add_u32 v110, s36, v110
    v_mov_b32 v111, 2130706432
    v_cmp_gt_u32 vcc, 125, v108
    s_mov_b32 s4, 0xbeaaaaab
    s_mov_b32 s5, s4
    s_mov_b32 s6, 0x3e800000
    s_mov_b32 s7, s6
    s_mov_b32 s8, 0xc0a00000
    s_mov_b32 s9, s8
    s_mov_b32 s10, 0xc0638e39
    v_xor_b32 v124, 112, v125
    ds_write_b128 v124, v[28:31]
    s_mov_b32 s11, s10
    s_mov_b32 s12, 0xbf638e39
    s_mov_b32 s13, s12
    s_mov_b32 s14, 0xbe638e39
    s_mov_b32 s15, s14
    s_mov_b32 s22, 0xbd638e39
    s_mov_b32 s23, s22
    s_mov_b32 s24, 0x3ff1c71c
    s_mov_b32 s25, s24
    s_mov_b32 s26, 0xbf2aaaab
    s_mov_b32 s27, s26
    s_mov_b32 s32, 0x3ecccccd
    v_xor_b32 v123, 112, v126
    s_waitcnt lgkmcnt(8)
    ds_write_b128 v123, v[60:63]
    s_mov_b32 s33, s32
    s_mov_b32 s34, 0xbd888889
    s_mov_b32 s35, s34
    s_mov_b32 s38, 0xbe4ccccd
    s_mov_b32 s39, s38
    s_mov_b32 s40, 0xbdd2d3e8
    s_mov_b32 s41, s40
    s_mov_b32 s42, 0x3f800000
    s_mov_b32 s43, s42
    s_setprio 0
    s_branch L_conv2_kernel_epi
L_conv2_kernel_m2:
    s_mul_i32 s37, s38, 2176
    s_add_u32 s37, s37, 98304
    v_add_u32 v116, s37, v8
    v_add_u32 v118, s37, v9
    v_add_u32 v117, 104832, v8
    s_cmp_eq_u32 s38, 0
    s_cbranch_scc1 L_conv2_kernel_hh0
    v_add_u32 v117, 98304, v9
L_conv2_kernel_hh0:
    s_lshl_b32 s37, s38, 12
    s_add_u32 s37, s37, s43
    s_add_u32 s37, s37, 49152
    v_lshl_add_u32 v119, v127, 4, s37
    v_mov_b32 v0, 0
    v_mov_b32 v1, 0
    v_mov_b32 v2, 0
    v_mov_b32 v3, 0
    v_mov_b32 v4, 0
    v_mov_b32 v5, 0
    v_mov_b32 v6, 0
    v_mov_b32 v7, 0
    v_mov_b32 v8, 0
    v_mov_b32 v9, 0
    v_mov_b32 v10, 0
    v_mov_b32 v11, 0
    v_mov_b32 v12, 0
    v_mov_b32 v13, 0
    v_mov_b32 v14, 0
    v_mov_b32 v15, 0
    v_mov_b32 v16, 0
    v_mov_b32 v17, 0
    v_mov_b32 v18, 0
    v_mov_b32 v19, 0
    v_mov_b32 v20, 0
    v_mov_b32 v21, 0
    v_mov_b32 v22, 0
    v_mov_b32 v23, 0
    v_mov_b32 v24, 0
    v_mov_b32 v25, 0
    v_mov_b32 v26, 0
    v_mov_b32 v27, 0
    v_mov_b32 v28, 0
    v_mov_b32 v29, 0
    v_mov_b32 v30, 0
    v_mov_b32 v31, 0
    v_mov_b32 v32, 0
    v_mov_b32 v33, 0
    v_mov_b32 v34, 0
    v_mov_b32 v35, 0
    v_mov_b32 v36, 0
    v_mov_b32 v37, 0
    v_mov_b32 v38, 0
    v_mov_b32 v39, 0
    v_mov_b32 v40, 0
    v_mov_b32 v41, 0
    v_mov_b32 v42, 0
    v_mov_b32 v43, 0
    v_mov_b32 v44, 0
    v_mov_b32 v45, 0
    v_mov_b32 v46, 0
    v_mov_b32 v47, 0
    v_mov_b32 v48, 0
    v_mov_b32 v49, 0
    v_mov_b32 v50, 0
    v_mov_b32 v51, 0
    v_mov_b32 v52, 0
    v_mov_b32 v53, 0
    v_mov_b32 v54, 0
    v_mov_b32 v55, 0
    v_mov_b32 v56, 0
    v_mov_b32 v57, 0
    v_mov_b32 v58, 0
    v_mov_b32 v59, 0
    v_mov_b32 v60, 0
    v_mov_b32 v61, 0
    v_mov_b32 v62, 0
    v_mov_b32 v63, 0
    buffer_load_dwordx4 v[96:99], v108, s[8:11], 0 offen
    buffer_load_dwordx4 v[100:103], v109, s[8:11], 0 offen
    buffer_load_dwordx4 v[104:107], v110, s[8:11], 0 offen
    s_mov_b32 s23, 0
    s_mov_b32 s26, 4096
    buffer_load_dwordx4 v[64:67], v125, s[12:15], s23 offen offset:0
    buffer_load_dwordx4 v[68:71], v125, s[12:15], s23 offen offset:2048
    buffer_load_dwordx4 v[80:83], v119, s[12:15], s23 offen offset:0
    buffer_load_dwordx4 v[72:75], v125, s[12:15], s26 offen offset:0
    buffer_load_dwordx4 v[84:87], v119, s[12:15], s23 offen offset:2048
    buffer_load_dwordx4 v[76:79], v125, s[12:15], s26 offen offset:2048
    s_mov_b32 s23, 57344
    s_mov_b32 s26, 61440
    s_waitcnt vmcnt(6)
    v_lshlrev_b32 v108, 16, v96
    v_and_b32 v111, s25, v96
    v_lshlrev_b32 v109, 16, v100
    v_and_b32 v112, s25, v100
    v_lshlrev_b32 v110, 16, v104
    v_and_b32 v113, s25, v104
    v_mul_f32 v114, s44, v108
    v_mul_f32 v115, s44, v111
    v_fmac_f32 v114, s45, v109
    v_fmac_f32 v115, s45, v112
    v_fmac_f32 v114, s46, v110
    v_fmac_f32 v115, s46, v113
    v_cvt_pk_bf16_f32 v96, v114, v115
    v_lshlrev_b32 v108, 16, v97
    v_and_b32 v111, s25, v97
    v_lshlrev_b32 v109, 16, v101
    v_and_b32 v112, s25, v101
    v_lshlrev_b32 v110, 16, v105
    v_and_b32 v113, s25, v105
    v_mul_f32 v114, s44, v108
    v_mul_f32 v115, s44, v111
    v_fmac_f32 v114, s45, v109
    v_fmac_f32 v115, s45, v112
    v_fmac_f32 v114, s46, v110
    v_fmac_f32 v115, s46, v113
    v_cvt_pk_bf16_f32 v97, v114, v115
    v_lshlrev_b32 v108, 16, v98
    v_and_b32 v111, s25, v98
    v_lshlrev_b32 v109, 16, v102
    v_and_b32 v112, s25, v102
    v_lshlrev_b32 v110, 16, v106
    v_and_b32 v113, s25, v106
    v_mul_f32 v114, s44, v108
    v_mul_f32 v115, s44, v111
    v_fmac_f32 v114, s45, v109
    v_fmac_f32 v115, s45, v112
    v_fmac_f32 v114, s46, v110
    v_fmac_f32 v115, s46, v113
    v_cvt_pk_bf16_f32 v98, v114, v115
    v_lshlrev_b32 v108, 16, v99
    v_and_b32 v111, s25, v99
    v_lshlrev_b32 v109, 16, v103
    v_and_b32 v112, s25, v103
    v_lshlrev_b32 v110, 16, v107
    v_and_b32 v113, s25, v107
    v_mul_f32 v114, s44, v108
    v_mul_f32 v115, s44, v111
    v_fmac_f32 v114, s45, v109
    v_fmac_f32 v115, s45, v112
    v_fmac_f32 v114, s46, v110
    v_fmac_f32 v115, s46, v113
    v_cvt_pk_bf16_f32 v99, v114, v115
    ds_write_b128 v126, v[96:99]
    v_and_b32 v111, 15, v127
    v_lshlrev_b32 v111, 2, v111
    v_add_u32 v111, 99328, v111
    ds_write_b32 v111, v0
    ds_write_b32 v111, v0 offset:8704
    s_waitcnt lgkmcnt(0)
    s_barrier
    s_mov_b32 s22, 4
    s_setprio 2
L_conv2_kernel_mloop2:
    ds_read_b128 v[88:91], v120 offset:0
    ds_read_b128 v[92:95], v120 offset:1024
    ds_read_b128 v[96:99], v116 offset:0
    ds_read_b128 v[100:103], v120 offset:2048
    ds_read_b128 v[104:107], v116 offset:1088
    ds_read_b128 v[108:111], v120 offset:3072
    ds_read_b128 v[112:115], v116 offset:2176
    s_waitcnt vmcnt(5) lgkmcnt(6)
    v_mfma_f32_16x16x32_bf16 v[0:3], v[64:67], v[88:91], v[0:3]
    ds_read_b128 v[88:91], v120 offset:4096
    s_waitcnt vmcnt(4) lgkmcnt(6)
    v_mfma_f32_16x16x32_bf16 v[4:7], v[64:67], v[92:95], v[4:7]
    v_mfma_f32_16x16x32_bf16 v[0:3], v[68:71], v[92:95], v[0:3]
    ds_read_b128 v[92:95], v116 offset:3264
    s_waitcnt vmcnt(3) lgkmcnt(6)
    v_mfma_f32_16x16x32_bf16 v[32:35], v[80:83], v[96:99], v[32:35]
    ds_read_b128 v[96:99], v120 offset:5120
    s_waitcnt vmcnt(2) lgkmcnt(6)
    v_mfma_f32_16x16x32_bf16 v[8:11], v[64:67], v[100:103], v[8:11]
    v_mfma_f32_16x16x32_bf16 v[4:7], v[68:71], v[100:103], v[4:7]
    v_mfma_f32_16x16x32_bf16 v[0:3], v[72:75], v[100:103], v[0:3]
    ds_read_b128 v[100:103], v116 offset:4352
    s_waitcnt vmcnt(1) lgkmcnt(6)
    v_mfma_f32_16x16x32_bf16 v[36:39], v[80:83], v[104:107], v[36:39]
    v_mfma_f32_16x16x32_bf16 v[32:35], v[84:87], v[104:107], v[32:35]
    ds_read_b128 v[104:107], v120 offset:6144
    s_waitcnt vmcnt(0) lgkmcnt(6)
    v_mfma_f32_16x16x32_bf16 v[12:15], v[64:67], v[108:111], v[12:15]
    v_mfma_f32_16x16x32_bf16 v[8:11], v[68:71], v[108:111], v[8:11]
    v_mfma_f32_16x16x32_bf16 v[4:7], v[72:75], v[108:111], v[4:7]
    v_mfma_f32_16x16x32_bf16 v[0:3], v[76:79], v[108:111], v[0:3]
    ds_read_b128 v[108:111], v116 offset:5440
    s_waitcnt lgkmcnt(6)
    v_mfma_f32_16x16x32_bf16 v[40:43], v[80:83], v[112:115], v[40:43]
    v_mfma_f32_16x16x32_bf16 v[36:39], v[84:87], v[112:115], v[36:39]
    ds_read_b128 v[112:115], v120 offset:7168
    s_waitcnt lgkmcnt(6)
    v_mfma_f32_16x16x32_bf16 v[16:19], v[64:67], v[88:91], v[16:19]
    v_mfma_f32_16x16x32_bf16 v[12:15], v[68:71], v[88:91], v[12:15]
    v_mfma_f32_16x16x32_bf16 v[8:11], v[72:75], v[88:91], v[8:11]
    v_mfma_f32_16x16x32_bf16 v[4:7], v[76:79], v[88:91], v[4:7]
    ds_read_b128 v[88:91], v117 offset:0
    s_waitcnt lgkmcnt(6)
    v_mfma_f32_16x16x32_bf16 v[44:47], v[80:83], v[92:95], v[44:47]
    v_mfma_f32_16x16x32_bf16 v[40:43], v[84:87], v[92:95], v[40:43]
    ds_read_b128 v[92:95], v122 offset:0
    v_add_u32 v122, v123, v122
    s_waitcnt lgkmcnt(6)
    v_mfma_f32_16x16x32_bf16 v[20:23], v[64:67], v[96:99], v[20:23]
    v_mfma_f32_16x16x32_bf16 v[16:19], v[68:71], v[96:99], v[16:19]
    v_mfma_f32_16x16x32_bf16 v[12:15], v[72:75], v[96:99], v[12:15]
    v_mfma_f32_16x16x32_bf16 v[8:11], v[76:79], v[96:99], v[8:11]
    ds_read_b128 v[96:99], v117 offset:1088
    s_waitcnt lgkmcnt(6)
    v_mfma_f32_16x16x32_bf16 v[48:51], v[80:83], v[100:103], v[48:51]
    v_mfma_f32_16x16x32_bf16 v[44:47], v[84:87], v[100:103], v[44:47]
    ds_read_b128 v[100:103], v121 offset:1024
    s_waitcnt lgkmcnt(6)
    v_mfma_f32_16x16x32_bf16 v[24:27], v[64:67], v[104:107], v[24:27]
    v_mfma_f32_16x16x32_bf16 v[20:23], v[68:71], v[104:107], v[20:23]
    v_mfma_f32_16x16x32_bf16 v[16:19], v[72:75], v[104:107], v[16:19]
    v_mfma_f32_16x16x32_bf16 v[12:15], v[76:79], v[104:107], v[12:15]
    ds_read_b128 v[104:107], v118 offset:0
    s_waitcnt lgkmcnt(6)
    v_mfma_f32_16x16x32_bf16 v[52:55], v[80:83], v[108:111], v[52:55]
    v_mfma_f32_16x16x32_bf16 v[48:51], v[84:87], v[108:111], v[48:51]
    ds_read_b128 v[108:111], v121 offset:2048
    s_waitcnt lgkmcnt(6)
    v_mfma_f32_16x16x32_bf16 v[28:31], v[64:67], v[112:115], v[28:31]
    v_mfma_f32_16x16x32_bf16 v[24:27], v[68:71], v[112:115], v[24:27]
    v_mfma_f32_16x16x32_bf16 v[20:23], v[72:75], v[112:115], v[20:23]
    v_mfma_f32_16x16x32_bf16 v[16:19], v[76:79], v[112:115], v[16:19]
    buffer_load_dwordx4 v[64:67], v125, s[12:15], s23 offen offset:0
    s_waitcnt lgkmcnt(5)
    v_mfma_f32_16x16x32_bf16 v[56:59], v[80:83], v[88:91], v[56:59]
    v_mfma_f32_16x16x32_bf16 v[52:55], v[84:87], v[88:91], v[52:55]
    s_waitcnt lgkmcnt(0)
    s_barrier
    v_mfma_f32_16x16x32_bf16 v[28:31], v[68:71], v[92:95], v[28:31]
    v_mfma_f32_16x16x32_bf16 v[24:27], v[72:75], v[92:95], v[24:27]
    v_mfma_f32_16x16x32_bf16 v[20:23], v[76:79], v[92:95], v[20:23]
    buffer_load_dwordx4 v[68:71], v125, s[12:15], s23 offen offset:2048
    v_mfma_f32_16x16x32_bf16 v[60:63], v[80:83], v[96:99], v[60:63]
    v_mfma_f32_16x16x32_bf16 v[56:59], v[84:87], v[96:99], v[56:59]
    buffer_load_dwordx4 v[80:83], v119, s[12:15], s23 offen offset:0
    v_mfma_f32_16x16x32_bf16 v[28:31], v[72:75], v[100:103], v[28:31]
    v_mfma_f32_16x16x32_bf16 v[24:27], v[76:79], v[100:103], v[24:27]
    buffer_load_dwordx4 v[72:75], v125, s[12:15], s26 offen offset:0
    v_mfma_f32_16x16x32_bf16 v[60:63], v[84:87], v[104:107], v[60:63]
    buffer_load_dwordx4 v[84:87], v119, s[12:15], s23 offen offset:2048
    v_mfma_f32_16x16x32_bf16 v[28:31], v[76:79], v[108:111], v[28:31]
    buffer_load_dwordx4 v[76:79], v125, s[12:15], s26 offen offset:2048
    s_add_u32 s23, s23, 57344
    s_add_u32 s26, s26, 57344
    s_sub_u32 s22, s22, 1
    s_cmp_eq_u32 s22, 0
    s_cbranch_scc1 L_conv2_kernel_mlast2
    ds_read_b128 v[88:91], v120 offset:8192
    ds_read_b128 v[92:95], v120 offset:9216
    ds_read_b128 v[96:99], v116 offset:8704
    ds_read_b128 v[100:103], v120 offset:10240
    ds_read_b128 v[104:107], v116 offset:9792
    ds_read_b128 v[108:111], v120 offset:11264
    ds_read_b128 v[112:115], v116 offset:10880
    s_waitcnt vmcnt(5) lgkmcnt(6)
    v_mfma_f32_16x16x32_bf16 v[0:3], v[64:67], v[88:91], v[0:3]
    ds_read_b128 v[88:91], v120 offset:12288
    s_waitcnt vmcnt(4) lgkmcnt(6)
    v_mfma_f32_16x16x32_bf16 v[4:7], v[64:67], v[92:95], v[4:7]
    v_mfma_f32_16x16x32_bf16 v[0:3], v[68:71], v[92:95], v[0:3]
    ds_read_b128 v[92:95], v116 offset:11968
    s_waitcnt vmcnt(3) lgkmcnt(6)
    v_mfma_f32_16x16x32_bf16 v[32:35], v[80:83], v[96:99], v[32:35]
    ds_read_b128 v[96:99], v120 offset:13312
    s_waitcnt vmcnt(2) lgkmcnt(6)
    v_mfma_f32_16x16x32_bf16 v[8:11], v[64:67], v[100:103], v[8:11]
    v_mfma_f32_16x16x32_bf16 v[4:7], v[68:71], v[100:103], v[4:7]
    v_mfma_f32_16x16x32_bf16 v[0:3], v[72:75], v[100:103], v[0:3]
    ds_read_b128 v[100:103], v116 offset:13056
    s_waitcnt vmcnt(1) lgkmcnt(6)
    v_mfma_f32_16x16x32_bf16 v[36:39], v[80:83], v[104:107], v[36:39]
    v_mfma_f32_16x16x32_bf16 v[32:35], v[84:87], v[104:107], v[32:35]
    ds_read_b128 v[104:107], v120 offset:14336
    s_waitcnt vmcnt(0) lgkmcnt(6)
    v_mfma_f32_16x16x32_bf16 v[12:15], v[64:67], v[108:111], v[12:15]
    v_mfma_f32_16x16x32_bf16 v[8:11], v[68:71], v[108:111], v[8:11]
    v_mfma_f32_16x16x32_bf16 v[4:7], v[72:75], v[108:111], v[4:7]
    v_mfma_f32_16x16x32_bf16 v[0:3], v[76:79], v[108:111], v[0:3]
    ds_read_b128 v[108:111], v116 offset:14144
    s_waitcnt lgkmcnt(6)
    v_mfma_f32_16x16x32_bf16 v[40:43], v[80:83], v[112:115], v[40:43]
    v_mfma_f32_16x16x32_bf16 v[36:39], v[84:87], v[112:115], v[36:39]
    ds_read_b128 v[112:115], v120 offset:15360
    s_waitcnt lgkmcnt(6)
    v_mfma_f32_16x16x32_bf16 v[16:19], v[64:67], v[88:91], v[16:19]
    v_mfma_f32_16x16x32_bf16 v[12:15], v[68:71], v[88:91], v[12:15]
    v_mfma_f32_16x16x32_bf16 v[8:11], v[72:75], v[88:91], v[8:11]
    v_mfma_f32_16x16x32_bf16 v[4:7], v[76:79], v[88:91], v[4:7]
    ds_read_b128 v[88:91], v117 offset:8704
    s_waitcnt lgkmcnt(6)
    v_mfma_f32_16x16x32_bf16 v[44:47], v[80:83], v[92:95], v[44:47]
    v_mfma_f32_16x16x32_bf16 v[40:43], v[84:87], v[92:95], v[40:43]
    ds_read_b128 v[92:95], v122 offset:0
    v_add_u32 v122, v124, v122
    s_waitcnt lgkmcnt(6)
    v_mfma_f32_16x16x32_bf16 v[20:23], v[64:67], v[96:99], v[20:23]
    v_mfma_f32_16x16x32_bf16 v[16:19], v[68:71], v[96:99], v[16:19]
    v_mfma_f32_16x16x32_bf16 v[12:15], v[72:75], v[96:99], v[12:15]
    v_mfma_f32_16x16x32_bf16 v[8:11], v[76:79], v[96:99], v[8:11]
    ds_read_b128 v[96:99], v117 offset:9792
    s_waitcnt lgkmcnt(6)
    v_mfma_f32_16x16x32_bf16 v[48:51], v[80:83], v[100:103], v[48:51]
    v_mfma_f32_16x16x32_bf16 v[44:47], v[84:87], v[100:103], v[44:47]
    ds_read_b128 v[100:103], v121 offset:9216
    s_waitcnt lgkmcnt(6)
    v_mfma_f32_16x16x32_bf16 v[24:27], v[64:67], v[104:107], v[24:27]
    v_mfma_f32_16x16x32_bf16 v[20:23], v[68:71], v[104:107], v[20:23]
    v_mfma_f32_16x16x32_bf16 v[16:19], v[72:75], v[104:107], v[16:19]
    v_mfma_f32_16x16x32_bf16 v[12:15], v[76:79], v[104:107], v[12:15]
    ds_read_b128 v[104:107], v118 offset:8704
    s_waitcnt lgkmcnt(6)
    v_mfma_f32_16x16x32_bf16 v[52:55], v[80:83], v[108:111], v[52:55]
    v_mfma_f32_16x16x32_bf16 v[48:51], v[84:87], v[108:111], v[48:51]
    ds_read_b128 v[108:111], v121 offset:10240
    s_waitcnt lgkmcnt(6)
    v_mfma_f32_16x16x32_bf16 v[28:31], v[64:67], v[112:115], v[28:31]
    v_mfma_f32_16x16x32_bf16 v[24:27], v[68:71], v[112:115], v[24:27]
    v_mfma_f32_16x16x32_bf16 v[20:23], v[72:75], v[112:115], v[20:23]
    v_mfma_f32_16x16x32_bf16 v[16:19], v[76:79], v[112:115], v[16:19]
    buffer_load_dwordx4 v[64:67], v125, s[12:15], s23 offen offset:0
    s_waitcnt lgkmcnt(5)
    v_mfma_f32_16x16x32_bf16 v[56:59], v[80:83], v[88:91], v[56:59]
    v_mfma_f32_16x16x32_bf16 v[52:55], v[84:87], v[88:91], v[52:55]
    s_waitcnt lgkmcnt(0)
    s_barrier
    v_mfma_f32_16x16x32_bf16 v[28:31], v[68:71], v[92:95], v[28:31]
    v_mfma_f32_16x16x32_bf16 v[24:27], v[72:75], v[92:95], v[24:27]
    v_mfma_f32_16x16x32_bf16 v[20:23], v[76:79], v[92:95], v[20:23]
    buffer_load_dwordx4 v[68:71], v125, s[12:15], s23 offen offset:2048
    v_mfma_f32_16x16x32_bf16 v[60:63], v[80:83], v[96:99], v[60:63]
    v_mfma_f32_16x16x32_bf16 v[56:59], v[84:87], v[96:99], v[56:59]
    buffer_load_dwordx4 v[80:83], v119, s[12:15], s23 offen offset:0
    v_mfma_f32_16x16x32_bf16 v[28:31], v[72:75], v[100:103], v[28:31]
    v_mfma_f32_16x16x32_bf16 v[24:27], v[76:79], v[100:103], v[24:27]
    buffer_load_dwordx4 v[72:75], v125, s[12:15], s26 offen offset:0
    v_mfma_f32_16x16x32_bf16 v[60:63], v[84:87], v[104:107], v[60:63]
    buffer_load_dwordx4 v[84:87], v119, s[12:15], s23 offen offset:2048
    v_mfma_f32_16x16x32_bf16 v[28:31], v[76:79], v[108:111], v[28:31]
    buffer_load_dwordx4 v[76:79], v125, s[12:15], s26 offen offset:2048
    s_add_u32 s23, s23, 57344
    s_add_u32 s26, s26, 57344
    s_branch L_conv2_kernel_mloop2
L_conv2_kernel_mlast2:
    v_and_b32 v125, 15, v127
    v_and_b32 v126, 7, v127
    v_lshlrev_b32 v126, 4, v126
    v_lshl_add_u32 v125, v125, 7, v126
    v_lshrrev_b32 v126, 4, v127
    v_lshl_add_u32 v125, v126, 11, v125
    s_mov_b32 s36, 65536
    s_cmp_eq_u32 s32, 1
    s_cselect_b32 s36, 121856, s36
    s_cmp_eq_u32 s32, 2
    s_cselect_b32 s36, 81920, s36
    s_cmp_eq_u32 s32, 3
    s_cselect_b32 s36, 130048, s36
    s_mov_b32 s37, 98304
    s_cmp_eq_u32 s32, 1
    s_cselect_b32 s37, 138240, s37
    s_cmp_eq_u32 s32, 2
    s_cselect_b32 s37, 146432, s37
    s_cmp_eq_u32 s32, 3
    s_cselect_b32 s37, 154624, s37
    v_add_u32 v126, s37, v125
    v_add_u32 v125, s36, v125
    ds_read_b128 v[88:91], v120 offset:8192
    ds_read_b128 v[92:95], v120 offset:9216
    ds_read_b128 v[96:99], v116 offset:8704
    ds_read_b128 v[100:103], v120 offset:10240
    ds_read_b128 v[104:107], v116 offset:9792
    ds_read_b128 v[108:111], v120 offset:11264
    ds_read_b128 v[112:115], v116 offset:10880
    s_waitcnt vmcnt(5) lgkmcnt(6)
    v_mfma_f32_16x16x32_bf16 v[0:3], v[64:67], v[88:91], v[0:3]
    ds_read_b128 v[88:91], v120 offset:12288
    s_waitcnt vmcnt(4) lgkmcnt(6)
    v_mfma_f32_16x16x32_bf16 v[4:7], v[64:67], v[92:95], v[4:7]
    v_mfma_f32_16x16x32_bf16 v[0:3], v[68:71], v[92:95], v[0:3]
    ds_read_b128 v[92:95], v116 offset:11968
    s_waitcnt vmcnt(3) lgkmcnt(6)
    v_mfma_f32_16x16x32_bf16 v[32:35], v[80:83], v[96:99], v[32:35]
    ds_read_b128 v[96:99], v120 offset:13312
    s_waitcnt vmcnt(2) lgkmcnt(6)
    v_mfma_f32_16x16x32_bf16 v[8:11], v[64:67], v[100:103], v[8:11]
    v_mfma_f32_16x16x32_bf16 v[4:7], v[68:71], v[100:103], v[4:7]
    v_mfma_f32_16x16x32_bf16 v[0:3], v[72:75], v[100:103], v[0:3]
    ds_read_b128 v[100:103], v116 offset:13056
    s_waitcnt vmcnt(1) lgkmcnt(6)
    v_mfma_f32_16x16x32_bf16 v[36:39], v[80:83], v[104:107], v[36:39]
    v_mfma_f32_16x16x32_bf16 v[32:35], v[84:87], v[104:107], v[32:35]
    ds_read_b128 v[104:107], v120 offset:14336
    s_waitcnt vmcnt(0) lgkmcnt(6)
    v_mfma_f32_16x16x32_bf16 v[12:15], v[64:67], v[108:111], v[12:15]
    v_mfma_f32_16x16x32_bf16 v[8:11], v[68:71], v[108:111], v[8:11]
    v_mfma_f32_16x16x32_bf16 v[4:7], v[72:75], v[108:111], v[4:7]
    v_mfma_f32_16x16x32_bf16 v[0:3], v[76:79], v[108:111], v[0:3]
    ds_read_b128 v[108:111], v116 offset:14144
    s_waitcnt lgkmcnt(6)
    v_mfma_f32_16x16x32_bf16 v[40:43], v[80:83], v[112:115], v[40:43]
    v_mfma_f32_16x16x32_bf16 v[36:39], v[84:87], v[112:115], v[36:39]
    ds_read_b128 v[112:115], v120 offset:15360
    s_waitcnt lgkmcnt(6)
    v_mfma_f32_16x16x32_bf16 v[16:19], v[64:67], v[88:91], v[16:19]
    v_mfma_f32_16x16x32_bf16 v[12:15], v[68:71], v[88:91], v[12:15]
    v_mfma_f32_16x16x32_bf16 v[8:11], v[72:75], v[88:91], v[8:11]
    v_mfma_f32_16x16x32_bf16 v[4:7], v[76:79], v[88:91], v[4:7]
    ds_read_b128 v[88:91], v117 offset:8704
    v_xor_b32 v124, 0, v126
    ds_write_b128 v124, v[32:35]
    s_waitcnt lgkmcnt(7)
    v_mfma_f32_16x16x32_bf16 v[44:47], v[80:83], v[92:95], v[44:47]
    v_mfma_f32_16x16x32_bf16 v[40:43], v[84:87], v[92:95], v[40:43]
    ds_read_b128 v[92:95], v122 offset:0
    v_xor_b32 v123, 0, v125
    ds_write_b128 v123, v[0:3]
    s_waitcnt lgkmcnt(8)
    v_mfma_f32_16x16x32_bf16 v[20:23], v[64:67], v[96:99], v[20:23]
    v_mfma_f32_16x16x32_bf16 v[16:19], v[68:71], v[96:99], v[16:19]
    v_mfma_f32_16x16x32_bf16 v[12:15], v[72:75], v[96:99], v[12:15]
    v_mfma_f32_16x16x32_bf16 v[8:11], v[76:79], v[96:99], v[8:11]
    ds_read_b128 v[96:99], v117 offset:9792
    v_xor_b32 v123, 16, v126
    ds_write_b128 v123, v[36:39]
    s_waitcnt lgkmcnt(9)
    v_mfma_f32_16x16x32_bf16 v[48:51], v[80:83], v[100:103], v[48:51]
    v_mfma_f32_16x16x32_bf16 v[44:47], v[84:87], v[100:103], v[44:47]
    ds_read_b128 v[100:103], v121 offset:9216
    v_xor_b32 v124, 16, v125
    ds_write_b128 v124, v[4:7]
    s_waitcnt lgkmcnt(10)
    v_mfma_f32_16x16x32_bf16 v[24:27], v[64:67], v[104:107], v[24:27]
    v_mfma_f32_16x16x32_bf16 v[20:23], v[68:71], v[104:107], v[20:23]
    v_mfma_f32_16x16x32_bf16 v[16:19], v[72:75], v[104:107], v[16:19]
    v_mfma_f32_16x16x32_bf16 v[12:15], v[76:79], v[104:107], v[12:15]
    ds_read_b128 v[104:107], v118 offset:8704
    v_xor_b32 v124, 32, v126
    ds_write_b128 v124, v[40:43]
    s_waitcnt lgkmcnt(11)
    v_mfma_f32_16x16x32_bf16 v[52:55], v[80:83], v[108:111], v[52:55]
    v_mfma_f32_16x16x32_bf16 v[48:51], v[84:87], v[108:111], v[48:51]
    ds_read_b128 v[108:111], v121 offset:10240
    v_xor_b32 v123, 32, v125
    ds_write_b128 v123, v[8:11]
    s_waitcnt lgkmcnt(12)
    v_mfma_f32_16x16x32_bf16 v[28:31], v[64:67], v[112:115], v[28:31]
    v_mfma_f32_16x16x32_bf16 v[24:27], v[68:71], v[112:115], v[24:27]
    v_mfma_f32_16x16x32_bf16 v[20:23], v[72:75], v[112:115], v[20:23]
    v_mfma_f32_16x16x32_bf16 v[16:19], v[76:79], v[112:115], v[16:19]
    v_xor_b32 v123, 48, v126
    ds_write_b128 v123, v[44:47]
    s_waitcnt lgkmcnt(12)
    v_mfma_f32_16x16x32_bf16 v[56:59], v[80:83], v[88:91], v[56:59]
    v_mfma_f32_16x16x32_bf16 v[52:55], v[84:87], v[88:91], v[52:55]
    v_xor_b32 v124, 48, v125
    ds_write_b128 v124, v[12:15]
    s_waitcnt lgkmcnt(11)
    v_mfma_f32_16x16x32_bf16 v[28:31], v[68:71], v[92:95], v[28:31]
    v_mfma_f32_16x16x32_bf16 v[24:27], v[72:75], v[92:95], v[24:27]
    v_mfma_f32_16x16x32_bf16 v[20:23], v[76:79], v[92:95], v[20:23]
    v_xor_b32 v124, 64, v126
    ds_write_b128 v124, v[48:51]
    s_waitcnt lgkmcnt(10)
    v_mfma_f32_16x16x32_bf16 v[60:63], v[80:83], v[96:99], v[60:63]
    v_mfma_f32_16x16x32_bf16 v[56:59], v[84:87], v[96:99], v[56:59]
    v_xor_b32 v123, 64, v125
    ds_write_b128 v123, v[16:19]
    s_waitcnt lgkmcnt(9)
    v_mfma_f32_16x16x32_bf16 v[28:31], v[72:75], v[100:103], v[28:31]
    v_mfma_f32_16x16x32_bf16 v[24:27], v[76:79], v[100:103], v[24:27]
    v_xor_b32 v123, 80, v126
    ds_write_b128 v123, v[52:55]
    s_waitcnt lgkmcnt(8)
    v_mfma_f32_16x16x32_bf16 v[60:63], v[84:87], v[104:107], v[60:63]
    v_xor_b32 v124, 80, v125
    ds_write_b128 v124, v[20:23]
    s_waitcnt lgkmcnt(7)
    v_mfma_f32_16x16x32_bf16 v[28:31], v[76:79], v[108:111], v[28:31]
    v_xor_b32 v124, 96, v126
    ds_write_b128 v124, v[56:59]
    v_and_b32 v108, 15, v127
    v_lshrrev_b32 v109, 4, v127
    v_lshrrev_b32 v110, 3, v108
    s_lshl_b32 s36, s20, 1
    v_add_u32 v110, s36, v110
    v_xor_b32 v111, v110, v108
    v_and_b32 v111, 7, v111
    v_lshlrev_b32 v111, 4, v111
    v_xor_b32 v123, 96, v125
    ds_write_b128 v123, v[24:27]
    v_lshl_add_u32 v111, v110, 7, v111
    v_lshl_add_u32 v120, v109, 11, v111
    v_add_u32 v121, 65536, v120
    v_add_u32 v64, 131072, v120
    s_lshl_b32 s36, s20, 9
    s_add_u32 s36, s36, 115712
    v_lshl_add_u32 v127, v109, 7, s36
    s_lshl_b32 s36, s20, 4
    v_add_u32 v108, s36, v108
    v_lshlrev_b32 v110, 6, v108
    v_lshl_add_u32 v110, v109, 4, v110
    s_mul_i32 s36, s29, 262144
    v_xor_b32 v123, 112, v126
    ds_write_b128 v123, v[60:63]
    s_lshl_b32 s37, s21, 4
    s_add_u32 s36, s36, s37
    v_add_u32 v110, s36, v110
    v_mov_b32 v111, 2130706432
    v_cmp_gt_u32 vcc, 125, v108
    s_mov_b32 s4, 0xbeaaaaab
    s_mov_b32 s5, s4
    s_mov_b32 s6, 0x3e800000
    s_mov_b32 s7, s6
    s_mov_b32 s8, 0xc0a00000
    s_mov_b32 s9, s8
    s_mov_b32 s10, 0xc0638e39
    v_xor_b32 v124, 112, v125
    ds_write_b128 v124, v[28:31]
    s_mov_b32 s11, s10
    s_mov_b32 s12, 0xbf638e39
    s_mov_b32 s13, s12
    s_mov_b32 s14, 0xbe638e39
    s_mov_b32 s15, s14
    s_mov_b32 s22, 0xbd638e39
    s_mov_b32 s23, s22
    s_mov_b32 s24, 0x3ff1c71c
    s_mov_b32 s25, s24
    s_mov_b32 s26, 0xbf2aaaab
    s_mov_b32 s27, s26
    s_mov_b32 s32, 0x3ecccccd
    s_mov_b32 s33, s32
    s_mov_b32 s34, 0xbd888889
    s_mov_b32 s35, s34
    s_mov_b32 s38, 0xbe4ccccd
    s_mov_b32 s39, s38
    s_mov_b32 s40, 0xbdd2d3e8
    s_mov_b32 s41, s40
    s_mov_b32 s42, 0x3f800000
    s_mov_b32 s43, s42
    s_setprio 0
    s_branch L_conv2_kernel_epi
L_conv2_kernel_epi:
    s_waitcnt lgkmcnt(0)
    s_barrier
    v_cndmask_b32 v122, v111, v110, vcc
    ds_read_b128 v[0:3], v120 offset:0
    ds_read_b128 v[4:7], v120 offset:16384
    ds_read_b128 v[8:11], v120 offset:32768
    ds_read_b128 v[12:15], v120 offset:49152
    ds_read_b128 v[16:19], v121 offset:0
    ds_read_b128 v[20:23], v121 offset:16384
    ds_read_b128 v[24:27], v121 offset:32768
    ds_read_b128 v[28:31], v64 offset:15360
    ds_read_b128 v[32:35], v120 offset:8192
    ds_read_b128 v[36:39], v120 offset:24576
    ds_read_b128 v[40:43], v120 offset:40960
    ds_read_b128 v[44:47], v120 offset:57344
    ds_read_b128 v[48:51], v121 offset:56320
    ds_read_b128 v[52:55], v121 offset:64512
    ds_read_b128 v[56:59], v64 offset:7168
    s_waitcnt lgkmcnt(7)
    ds_read_b128 v[60:63], v64 offset:23552
    s_waitcnt lgkmcnt(8)
    v_pk_add_f32 v[88:89], v[24:25], v[28:29]
    v_pk_add_f32 v[90:91], v[26:27], v[30:31]
    v_pk_add_f32 v[24:25], v[4:5], v[8:9]
    v_pk_add_f32 v[26:27], v[6:7], v[10:11]
    v_pk_add_f32 v[4:5], v[4:5], v[8:9] neg_lo:[0,1] neg_hi:[0,1]
    v_pk_add_f32 v[6:7], v[6:7], v[10:11] neg_lo:[0,1] neg_hi:[0,1]
    v_pk_add_f32 v[72:73], v[12:13], v[16:17]
    v_pk_add_f32 v[74:75], v[14:15], v[18:19]
    v_pk_add_f32 v[12:13], v[12:13], v[16:17] neg_lo:[0,1] neg_hi:[0,1]
    v_pk_add_f32 v[14:15], v[14:15], v[18:19] neg_lo:[0,1] neg_hi:[0,1]
    v_pk_fma_f32 v[72:73], v[24:25], s[4:5], v[72:73]
    v_pk_fma_f32 v[74:75], v[26:27], s[4:5], v[74:75]
    v_pk_fma_f32 v[20:21], v[0:1], s[10:11], v[20:21]
    v_pk_fma_f32 v[22:23], v[2:3], s[10:11], v[22:23]
    v_pk_fma_f32 v[72:73], v[0:1], s[6:7], v[72:73]
    v_pk_fma_f32 v[74:75], v[2:3], s[6:7], v[74:75]
    v_pk_add_f32 v[24:25], v[24:25], v[0:1] neg_lo:[0,1] neg_hi:[0,1]
    v_pk_add_f32 v[26:27], v[26:27], v[2:3] neg_lo:[0,1] neg_hi:[0,1]
    v_pk_fma_f32 v[72:73], v[88:89], s[8:9], v[72:73]
    v_pk_fma_f32 v[74:75], v[90:91], s[8:9], v[74:75]
    v_pk_add_f32 v[24:25], v[24:25], v[88:89] neg_lo:[0,1] neg_hi:[0,1]
    v_pk_add_f32 v[26:27], v[26:27], v[90:91] neg_lo:[0,1] neg_hi:[0,1]
    v_pk_fma_f32 v[20:21], v[88:89], s[22:23], v[20:21]
    v_pk_fma_f32 v[22:23], v[90:91], s[22:23], v[22:23]
    v_pk_add_f32 v[8:9], v[24:25], v[72:73] neg_lo:[0,1] neg_hi:[0,1]
    v_pk_add_f32 v[10:11], v[26:27], v[74:75] neg_lo:[0,1] neg_hi:[0,1]
    v_pk_fma_f32 v[20:21], v[72:73], s[14:15], v[20:21]
    v_pk_fma_f32 v[22:23], v[74:75], s[14:15], v[22:23]
    v_pk_mul_f32 v[80:81], v[12:13], s[32:33]
    v_pk_mul_f32 v[82:83], v[14:15], s[32:33]
    v_pk_fma_f32 v[20:21], v[8:9], s[12:13], v[20:21]
    v_pk_fma_f32 v[22:23], v[10:11], s[12:13], v[22:23]
    v_pk_fma_f32 v[80:81], v[4:5], s[34:35], v[80:81]
    v_pk_fma_f32 v[82:83], v[6:7], s[34:35], v[82:83]
    v_pk_fma_f32 v[64:65], v[4:5], s[24:25], v[20:21] neg_lo:[0,0,1] neg_hi:[0,0,1]
    v_pk_fma_f32 v[66:67], v[6:7], s[24:25], v[22:23] neg_lo:[0,0,1] neg_hi:[0,0,1]
    v_pk_fma_f32 v[64:65], v[12:13], s[26:27], v[64:65]
    v_pk_fma_f32 v[66:67], v[14:15], s[26:27], v[66:67]
    v_pk_fma_f32 v[80:81], v[64:65], s[38:39], v[80:81]
    v_pk_fma_f32 v[82:83], v[66:67], s[38:39], v[82:83]
    v_pk_add_f32 v[4:5], v[4:5], v[64:65] neg_lo:[0,1] neg_hi:[0,1]
    v_pk_add_f32 v[6:7], v[6:7], v[66:67] neg_lo:[0,1] neg_hi:[0,1]
    v_pk_add_f32 v[4:5], v[4:5], v[80:81] neg_lo:[0,1] neg_hi:[0,1]
    v_pk_add_f32 v[6:7], v[6:7], v[82:83] neg_lo:[0,1] neg_hi:[0,1]
    s_waitcnt lgkmcnt(0)
    v_pk_add_f32 v[92:93], v[56:57], v[60:61]
    v_pk_add_f32 v[94:95], v[58:59], v[62:63]
    v_pk_add_f32 v[56:57], v[36:37], v[40:41]
    v_pk_add_f32 v[58:59], v[38:39], v[42:43]
    v_pk_add_f32 v[36:37], v[36:37], v[40:41] neg_lo:[0,1] neg_hi:[0,1]
    v_pk_add_f32 v[38:39], v[38:39], v[42:43] neg_lo:[0,1] neg_hi:[0,1]
    v_pk_add_f32 v[76:77], v[44:45], v[48:49]
    v_pk_add_f32 v[78:79], v[46:47], v[50:51]
    v_pk_add_f32 v[44:45], v[44:45], v[48:49] neg_lo:[0,1] neg_hi:[0,1]
    v_pk_add_f32 v[46:47], v[46:47], v[50:51] neg_lo:[0,1] neg_hi:[0,1]
    v_pk_fma_f32 v[76:77], v[56:57], s[4:5], v[76:77]
    v_pk_fma_f32 v[78:79], v[58:59], s[4:5], v[78:79]
    v_pk_fma_f32 v[52:53], v[32:33], s[10:11], v[52:53]
    v_pk_fma_f32 v[54:55], v[34:35], s[10:11], v[54:55]
    v_pk_fma_f32 v[76:77], v[32:33], s[6:7], v[76:77]
    v_pk_fma_f32 v[78:79], v[34:35], s[6:7], v[78:79]
    v_pk_add_f32 v[56:57], v[56:57], v[32:33] neg_lo:[0,1] neg_hi:[0,1]
    v_pk_add_f32 v[58:59], v[58:59], v[34:35] neg_lo:[0,1] neg_hi:[0,1]
    v_pk_fma_f32 v[76:77], v[92:93], s[8:9], v[76:77]
    v_pk_fma_f32 v[78:79], v[94:95], s[8:9], v[78:79]
    v_pk_add_f32 v[56:57], v[56:57], v[92:93] neg_lo:[0,1] neg_hi:[0,1]
    v_pk_add_f32 v[58:59], v[58:59], v[94:95] neg_lo:[0,1] neg_hi:[0,1]
    v_pk_fma_f32 v[52:53], v[92:93], s[22:23], v[52:53]
    v_pk_fma_f32 v[54:55], v[94:95], s[22:23], v[54:55]
    v_pk_add_f32 v[40:41], v[56:57], v[76:77] neg_lo:[0,1] neg_hi:[0,1]
    v_pk_add_f32 v[42:43], v[58:59], v[78:79] neg_lo:[0,1] neg_hi:[0,1]
    v_pk_fma_f32 v[52:53], v[76:77], s[14:15], v[52:53]
    v_pk_fma_f32 v[54:55], v[78:79], s[14:15], v[54:55]
    v_pk_mul_f32 v[84:85], v[44:45], s[32:33]
    v_pk_mul_f32 v[86:87], v[46:47], s[32:33]
    v_pk_fma_f32 v[52:53], v[40:41], s[12:13], v[52:53]
    v_pk_fma_f32 v[54:55], v[42:43], s[12:13], v[54:55]
    v_pk_fma_f32 v[84:85], v[36:37], s[34:35], v[84:85]
    v_pk_fma_f32 v[86:87], v[38:39], s[34:35], v[86:87]
    v_pk_fma_f32 v[68:69], v[36:37], s[24:25], v[52:53] neg_lo:[0,0,1] neg_hi:[0,0,1]
    v_pk_fma_f32 v[70:71], v[38:39], s[24:25], v[54:55] neg_lo:[0,0,1] neg_hi:[0,0,1]
    v_pk_fma_f32 v[68:69], v[44:45], s[26:27], v[68:69]
    v_pk_fma_f32 v[70:71], v[46:47], s[26:27], v[70:71]
    v_pk_fma_f32 v[84:85], v[68:69], s[38:39], v[84:85]
    v_pk_fma_f32 v[86:87], v[70:71], s[38:39], v[86:87]
    v_pk_add_f32 v[36:37], v[36:37], v[68:69] neg_lo:[0,1] neg_hi:[0,1]
    v_pk_add_f32 v[38:39], v[38:39], v[70:71] neg_lo:[0,1] neg_hi:[0,1]
    v_pk_add_f32 v[36:37], v[36:37], v[84:85] neg_lo:[0,1] neg_hi:[0,1]
    v_pk_add_f32 v[38:39], v[38:39], v[86:87] neg_lo:[0,1] neg_hi:[0,1]
    s_mov_b32 s36, 0x00010001
    s_mov_b32 s37, 0x00010001
    s_mov_b64 exec, s[36:37]
    ds_write_b128 v127, v[0:3] offset:0
    ds_write_b128 v127, v[32:35] offset:16
    ds_write_b128 v127, v[4:7] offset:32
    ds_write_b128 v127, v[36:39] offset:48
    ds_write_b128 v127, v[8:11] offset:64
    ds_write_b128 v127, v[40:43] offset:80
    s_mov_b64 exec, -1
    v_mov_b32 v44, 0xc0135761
    v_mov_b32 v45, v44
    v_cvt_pk_bf16_f32 v48, v64, v68
    v_cvt_pk_bf16_f32 v49, v65, v69
    v_cvt_pk_bf16_f32 v50, v66, v70
    v_cvt_pk_bf16_f32 v51, v67, v71
    s_mov_b32 s44, 0
    buffer_store_dwordx4 v[48:51], v122, s[16:19], s44 offen sc1
    s_waitcnt lgkmcnt(0)
    s_barrier
    ds_read_b128 v[96:99], v127 offset:512
    ds_read_b128 v[100:103], v127 offset:528
    ds_read_b128 v[104:107], v127 offset:544
    ds_read_b128 v[108:111], v127 offset:560
    ds_read_b128 v[112:115], v127 offset:576
    ds_read_b128 v[116:119], v127 offset:592
    s_waitcnt lgkmcnt(4)
    v_mov_b32_dpp v96, v0 row_shl:1 row_mask:0xf bank_mask:0xf
    v_mov_b32_dpp v97, v1 row_shl:1 row_mask:0xf bank_mask:0xf
    v_mov_b32_dpp v98, v2 row_shl:1 row_mask:0xf bank_mask:0xf
    v_mov_b32_dpp v99, v3 row_shl:1 row_mask:0xf bank_mask:0xf
    v_mov_b32_dpp v100, v32 row_shl:1 row_mask:0xf bank_mask:0xf
    v_mov_b32_dpp v101, v33 row_shl:1 row_mask:0xf bank_mask:0xf
    v_mov_b32_dpp v102, v34 row_shl:1 row_mask:0xf bank_mask:0xf
    v_mov_b32_dpp v103, v35 row_shl:1 row_mask:0xf bank_mask:0xf
    v_pk_add_f32 v[72:73], v[72:73], v[96:97]
    v_pk_add_f32 v[74:75], v[74:75], v[98:99]
    v_pk_add_f32 v[76:77], v[76:77], v[100:101]
    v_pk_add_f32 v[78:79], v[78:79], v[102:103]
    v_cvt_pk_bf16_f32 v52, v72, v76
    v_cvt_pk_bf16_f32 v53, v73, v77
    v_cvt_pk_bf16_f32 v54, v74, v78
    v_cvt_pk_bf16_f32 v55, v75, v79
    s_mov_b32 s44, 65536
    buffer_store_dwordx4 v[52:55], v122, s[16:19], s44 offen sc1
    s_waitcnt lgkmcnt(2)
    v_mov_b32_dpp v104, v4 row_shl:1 row_mask:0xf bank_mask:0xf
    v_mov_b32_dpp v105, v5 row_shl:1 row_mask:0xf bank_mask:0xf
    v_mov_b32_dpp v106, v6 row_shl:1 row_mask:0xf bank_mask:0xf
    v_mov_b32_dpp v107, v7 row_shl:1 row_mask:0xf bank_mask:0xf
    v_mov_b32_dpp v108, v36 row_shl:1 row_mask:0xf bank_mask:0xf
    v_mov_b32_dpp v109, v37 row_shl:1 row_mask:0xf bank_mask:0xf
    v_mov_b32_dpp v110, v38 row_shl:1 row_mask:0xf bank_mask:0xf
    v_mov_b32_dpp v111, v39 row_shl:1 row_mask:0xf bank_mask:0xf
    v_pk_add_f32 v[80:81], v[80:81], v[104:105]
    v_pk_add_f32 v[82:83], v[82:83], v[106:107]
    v_pk_add_f32 v[84:85], v[84:85], v[108:109]
    v_pk_add_f32 v[86:87], v[86:87], v[110:111]
    v_cvt_pk_bf16_f32 v56, v80, v84
    v_cvt_pk_bf16_f32 v57, v81, v85
    v_cvt_pk_bf16_f32 v58, v82, v86
    v_cvt_pk_bf16_f32 v59, v83, v87
    s_mov_b32 s44, 131072
    buffer_store_dwordx4 v[56:59], v122, s[16:19], s44 offen sc1
    s_waitcnt lgkmcnt(0)
    v_mov_b32_dpp v112, v8 row_shl:1 row_mask:0xf bank_mask:0xf
    v_mov_b32_dpp v113, v9 row_shl:1 row_mask:0xf bank_mask:0xf
    v_mov_b32_dpp v114, v10 row_shl:1 row_mask:0xf bank_mask:0xf
    v_mov_b32_dpp v115, v11 row_shl:1 row_mask:0xf bank_mask:0xf
    v_mov_b32_dpp v116, v40 row_shl:1 row_mask:0xf bank_mask:0xf
    v_mov_b32_dpp v117, v41 row_shl:1 row_mask:0xf bank_mask:0xf
    v_mov_b32_dpp v118, v42 row_shl:1 row_mask:0xf bank_mask:0xf
    v_mov_b32_dpp v119, v43 row_shl:1 row_mask:0xf bank_mask:0xf
    v_pk_add_f32 v[88:89], v[88:89], v[112:113]
    v_pk_add_f32 v[90:91], v[90:91], v[114:115]
    v_pk_add_f32 v[92:93], v[92:93], v[116:117]
    v_pk_add_f32 v[94:95], v[94:95], v[118:119]
    v_cvt_pk_bf16_f32 v60, v88, v92
    v_cvt_pk_bf16_f32 v61, v89, v93
    v_cvt_pk_bf16_f32 v62, v90, v94
    v_cvt_pk_bf16_f32 v63, v91, v95
    s_mov_b32 s44, 196608
    buffer_store_dwordx4 v[60:63], v122, s[16:19], s44 offen sc1
L_conv2_kernel_end:
L_conv2_kernel_done:
    s_endpgm
.globl joint_kernel
.p2align 8
.type joint_kernel,@function
joint_kernel:
    s_cmp_ge_u32 s2, 250
    s_cbranch_scc1 L_joint_kernel_done
    s_load_dwordx2 s[28:29], s[0:1], 56
    s_load_dwordx2 s[30:31], s[0:1], 72
    v_readfirstlane_b32 s20, v0
    s_lshr_b32 s20, s20, 6
    s_and_b32 s21, s20, 7
    v_and_b32 v127, 63, v0
    v_lshlrev_b32 v126, 4, v127
    s_cmp_ge_u32 s20, 8
    s_mov_b32 s33, 44171264
    s_cselect_b32 s33, 44040192, s33
    s_lshl_b32 s36, s21, 14
    s_add_u32 s33, s33, s36
    s_mov_b32 s14, 16384
    s_mov_b32 s15, 0x00020000
    s_lshl_b32 s35, s2, 9
    s_cmp_ge_u32 s2, 125
    s_cselect_b32 s36, 2033152, 0
    s_cselect_b32 s34, 8192, 0
    s_add_u32 s35, s35, s36
    s_add_u32 s34, s34, 44302336
    s_mov_b32 s10, 12582912
    s_mov_b32 s11, 0x00020000
    s_mov_b32 s42, 24576
    s_mov_b32 s43, 0x00020000
    s_cmp_ge_u32 s20, 8
    s_cbranch_scc1 L_joint_kernel_T
    v_lshrrev_b32 v124, 5, v127
    v_and_b32 v123, 0x1ff, v126
    v_mul_u32_u24 v125, 65536, v124
    v_add_u32 v123, v125, v123
    s_mul_i32 s36, s21, 262144
    s_add_u32 s36, s36, s35
    s_waitcnt lgkmcnt(0)
    s_add_u32 s8, s30, 27262976
    s_addc_u32 s9, s31, 0
    s_add_u32 s37, s36, 8388608
    buffer_load_dwordx4 v[64:67], v123, s[8:11], s36 offen
    buffer_load_dwordx4 v[72:75], v123, s[8:11], s37 offen
    s_add_u32 s36, s36, 131072
    s_add_u32 s37, s36, 8388608
    buffer_load_dwordx4 v[68:71], v123, s[8:11], s36 offen
    buffer_load_dwordx4 v[76:79], v123, s[8:11], s37 offen
    v_mov_b32 v0, 99456
    v_mov_b32 v2, 0
    v_mov_b32 v3, 0
    ds_write_b64 v0, v[2:3]
    s_add_u32 s12, s30, s33
    s_addc_u32 s13, s31, 0
    s_add_u32 s40, s30, s34
    s_addc_u32 s41, s31, 0
    s_lshl_b32 s38, s21, 10
    s_add_u32 s38, s38, 16384
    buffer_load_dwordx4 v[80:83], v126, s[40:43], s38 offen
    s_waitcnt lgkmcnt(0)
    s_barrier
    s_lshl_b32 s35, s2, 17
    s_add_u32 s16, s28, s35
    s_addc_u32 s17, s29, 0
    s_mov_b32 s18, 131072
    s_mov_b32 s19, 0x00020000
    s_mov_b32 s46, 0xbdd2d3e8
    s_mov_b32 s47, s46
    v_mov_b32 v120, 0xc0135761
    v_mov_b32 v121, v120
    s_mov_b32 s48, 1.0
    s_mov_b32 s49, 1.0
    v_bfe_u32 v123, v127, 2, 3
    v_lshl_add_u32 v124, v123, 2, v124
    v_mul_u32_u24 v124, 528, v124
    v_and_b32 v123, 0x30, v126
    s_lshl_b32 s36, s21, 6
    v_add3_u32 v124, v124, v123, s36
    s_mov_b32 s45, 0xffff0000
    s_mul_i32 s36, s21, 1040
    s_add_u32 s36, s36, 91136
    v_add_u32 v123, s36, v126
    s_mov_b32 s22, 2
    s_waitcnt vmcnt(3)
L_joint_kernel_floop:
    v_lshlrev_b32 v88, 16, v64
    v_and_b32 v89, s45, v64
    v_lshlrev_b32 v96, 16, v72
    v_and_b32 v97, s45, v72
    v_lshlrev_b32 v90, 16, v65
    v_and_b32 v91, s45, v65
    v_lshlrev_b32 v98, 16, v73
    v_and_b32 v99, s45, v73
    v_lshlrev_b32 v92, 16, v66
    v_and_b32 v93, s45, v66
    v_lshlrev_b32 v100, 16, v74
    v_and_b32 v101, s45, v74
    v_lshlrev_b32 v94, 16, v67
    v_and_b32 v95, s45, v67
    v_lshlrev_b32 v102, 16, v75
    v_and_b32 v103, s45, v75
    v_pk_add_f32 v[88:89], v[88:89], v[96:97]
    v_pk_add_f32 v[90:91], v[90:91], v[98:99]
    v_pk_add_f32 v[92:93], v[92:93], v[100:101]
    v_pk_add_f32 v[94:95], v[94:95], v[102:103]
    v_pk_mul_f32 v[96:97], v[88:89], v[88:89]
    v_pk_mul_f32 v[98:99], v[90:91], v[90:91]
    v_pk_mul_f32 v[100:101], v[92:93], v[92:93]
    v_pk_mul_f32 v[102:103], v[94:95], v[94:95]
    v_pk_fma_f32 v[96:97], v[96:97], s[46:47], v[120:121]
    v_pk_fma_f32 v[98:99], v[98:99], s[46:47], v[120:121]
    v_pk_fma_f32 v[100:101], v[100:101], s[46:47], v[120:121]
    v_pk_fma_f32 v[102:103], v[102:103], s[46:47], v[120:121]
    v_pk_mul_f32 v[96:97], v[96:97], v[88:89]
    v_pk_mul_f32 v[98:99], v[98:99], v[90:91]
    v_pk_mul_f32 v[100:101], v[100:101], v[92:93]
    v_pk_mul_f32 v[102:103], v[102:103], v[94:95]
    v_exp_f32 v96, v96
    v_exp_f32 v97, v97
    v_exp_f32 v98, v98
    v_exp_f32 v99, v99
    v_exp_f32 v100, v100
    v_exp_f32 v101, v101
    v_exp_f32 v102, v102
    v_exp_f32 v103, v103
    v_pk_add_f32 v[96:97], v[96:97], s[48:49]
    v_pk_add_f32 v[98:99], v[98:99], s[48:49]
    v_pk_add_f32 v[100:101], v[100:101], s[48:49]
    v_pk_add_f32 v[102:103], v[102:103], s[48:49]
    v_rcp_f32 v96, v96
    v_rcp_f32 v97, v97
    v_rcp_f32 v98, v98
    v_rcp_f32 v99, v99
    v_rcp_f32 v100, v100
    v_rcp_f32 v101, v101
    v_rcp_f32 v102, v102
    v_rcp_f32 v103, v103
    v_pk_mul_f32 v[88:89], v[88:89], v[96:97]
    v_pk_mul_f32 v[90:91], v[90:91], v[98:99]
    v_pk_mul_f32 v[92:93], v[92:93], v[100:101]
    v_pk_mul_f32 v[94:95], v[94:95], v[102:103]
    v_cvt_pk_bf16_f32 v104, v88, v89
    v_cvt_pk_bf16_f32 v105, v90, v91
    v_cvt_pk_bf16_f32 v106, v92, v93
    v_cvt_pk_bf16_f32 v107, v94, v95
    ds_write_b128 v124, v[104:107] offset:32768
    s_waitcnt vmcnt(0)
    v_pk_mov_b32 v[64:65], v[68:69], v[68:69] op_sel:[0,1]
    v_pk_mov_b32 v[72:73], v[76:77], v[76:77] op_sel:[0,1]
    v_pk_mov_b32 v[66:67], v[70:71], v[70:71] op_sel:[0,1]
    v_pk_mov_b32 v[74:75], v[78:79], v[78:79] op_sel:[0,1]
    v_add_u32 v124, 1056, v124
    s_sub_u32 s22, s22, 1
    s_cmp_lg_u32 s22, 0
    s_cbranch_scc1 L_joint_kernel_floop
    ds_write_b128 v123, v[80:83]
    s_waitcnt lgkmcnt(0)
    v_mov_b32 v120, 99456
    v_mov_b32 v121, 1
    s_mov_b64 exec, 1
    ds_add_u32 v120, v121 offset:0
    s_mov_b64 exec, -1
L_joint_kernel_ow:
    ds_read_b32 v121, v120 offset:4
    s_waitcnt lgkmcnt(0)
    v_readfirstlane_b32 s37, v121
    s_cmp_ge_u32 s37, 8
    s_cbranch_scc1 L_joint_kernel_ow_d
    s_sleep 1
    s_branch L_joint_kernel_ow
L_joint_kernel_ow_d:
    s_mov_b32 s36, 0
    buffer_load_dwordx4 v[0:3], v126, s[12:15], s36 offen offset:0
    buffer_load_dwordx4 v[4:7], v126, s[12:15], s36 offen offset:1024
    buffer_load_dwordx4 v[8:11], v126, s[12:15], s36 offen offset:2048
    buffer_load_dwordx4 v[12:15], v126, s[12:15], s36 offen offset:3072
    s_mov_b32 s36, 4096
    buffer_load_dwordx4 v[16:19], v126, s[12:15], s36 offen offset:0
    buffer_load_dwordx4 v[20:23], v126, s[12:15], s36 offen offset:1024
    buffer_load_dwordx4 v[24:27], v126, s[12:15], s36 offen offset:2048
    buffer_load_dwordx4 v[28:31], v126, s[12:15], s36 offen offset:3072
    s_mov_b32 s36, 8192
    buffer_load_dwordx4 v[32:35], v126, s[12:15], s36 offen offset:0
    buffer_load_dwordx4 v[36:39], v126, s[12:15], s36 offen offset:1024
    buffer_load_dwordx4 v[40:43], v126, s[12:15], s36 offen offset:2048
    buffer_load_dwordx4 v[44:47], v126, s[12:15], s36 offen offset:3072
    s_mov_b32 s36, 12288
    buffer_load_dwordx4 v[48:51], v126, s[12:15], s36 offen offset:0
    buffer_load_dwordx4 v[52:55], v126, s[12:15], s36 offen offset:1024
    buffer_load_dwordx4 v[56:59], v126, s[12:15], s36 offen offset:2048
    buffer_load_dwordx4 v[60:63], v126, s[12:15], s36 offen offset:3072
    v_lshrrev_b32 v125, 4, v127
    v_lshlrev_b32 v125, 11, v125
    v_and_b32 v124, 15, v127
    v_lshl_add_u32 v125, v124, 2, v125
    s_lshl_b32 s36, s21, 6
    v_add_u32 v125, s36, v125
    s_mov_b32 s44, 8192
    s_setprio 1
    s_barrier
    ds_read_b128 v[96:99], v126 offset:0
    ds_read_b128 v[100:103], v126 offset:1024
    ds_read_b128 v[104:107], v126 offset:2048
    ds_read_b128 v[108:111], v126 offset:3072
    s_waitcnt vmcnt(14) lgkmcnt(3)
    v_mfma_f32_16x16x32_bf16 v[64:67], v[96:99], v[0:3], 0
    v_mfma_f32_16x16x32_bf16 v[68:71], v[96:99], v[4:7], 0
    ds_read_b128 v[96:99], v126 offset:4096
    s_waitcnt lgkmcnt(3)
    v_mfma_f32_16x16x32_bf16 v[72:75], v[100:103], v[0:3], 0
    v_mfma_f32_16x16x32_bf16 v[76:79], v[100:103], v[4:7], 0
    ds_read_b128 v[100:103], v126 offset:5120
    s_waitcnt vmcnt(12) lgkmcnt(3)
    v_mfma_f32_16x16x32_bf16 v[64:67], v[104:107], v[8:11], v[64:67]
    v_mfma_f32_16x16x32_bf16 v[68:71], v[104:107], v[12:15], v[68:71]
    ds_read_b128 v[104:107], v126 offset:6144
    s_waitcnt lgkmcnt(3)
    v_mfma_f32_16x16x32_bf16 v[72:75], v[108:111], v[8:11], v[72:75]
    v_mfma_f32_16x16x32_bf16 v[76:79], v[108:111], v[12:15], v[76:79]
    ds_read_b128 v[108:111], v126 offset:7168
    s_waitcnt vmcnt(10) lgkmcnt(3)
    v_mfma_f32_16x16x32_bf16 v[64:67], v[96:99], v[16:19], v[64:67]
    v_mfma_f32_16x16x32_bf16 v[68:71], v[96:99], v[20:23], v[68:71]
    ds_read_b128 v[96:99], v126 offset:8192
    s_waitcnt lgkmcnt(3)
    v_mfma_f32_16x16x32_bf16 v[72:75], v[100:103], v[16:19], v[72:75]
    v_mfma_f32_16x16x32_bf16 v[76:79], v[100:103], v[20:23], v[76:79]
    ds_read_b128 v[100:103], v126 offset:9216
    s_waitcnt vmcnt(8) lgkmcnt(3)
    v_mfma_f32_16x16x32_bf16 v[64:67], v[104:107], v[24:27], v[64:67]
    v_mfma_f32_16x16x32_bf16 v[68:71], v[104:107], v[28:31], v[68:71]
    ds_read_b128 v[104:107], v126 offset:10240
    s_waitcnt lgkmcnt(3)
    v_mfma_f32_16x16x32_bf16 v[72:75], v[108:111], v[24:27], v[72:75]
    v_mfma_f32_16x16x32_bf16 v[76:79], v[108:111], v[28:31], v[76:79]
    ds_read_b128 v[108:111], v126 offset:11264
    s_waitcnt vmcnt(6) lgkmcnt(3)
    v_mfma_f32_16x16x32_bf16 v[64:67], v[96:99], v[32:35], v[64:67]
    v_mfma_f32_16x16x32_bf16 v[68:71], v[96:99], v[36:39], v[68:71]
    ds_read_b128 v[96:99], v126 offset:12288
    s_waitcnt lgkmcnt(3)
    v_mfma_f32_16x16x32_bf16 v[72:75], v[100:103], v[32:35], v[72:75]
    v_mfma_f32_16x16x32_bf16 v[76:79], v[100:103], v[36:39], v[76:79]
    ds_read_b128 v[100:103], v126 offset:13312
    s_waitcnt vmcnt(4) lgkmcnt(3)
    v_mfma_f32_16x16x32_bf16 v[64:67], v[104:107], v[40:43], v[64:67]
    v_mfma_f32_16x16x32_bf16 v[68:71], v[104:107], v[44:47], v[68:71]
    ds_read_b128 v[104:107], v126 offset:14336
    s_waitcnt lgkmcnt(3)
    v_mfma_f32_16x16x32_bf16 v[72:75], v[108:111], v[40:43], v[72:75]
    v_mfma_f32_16x16x32_bf16 v[76:79], v[108:111], v[44:47], v[76:79]
    ds_read_b128 v[108:111], v126 offset:15360
    s_waitcnt vmcnt(2) lgkmcnt(3)
    v_mfma_f32_16x16x32_bf16 v[64:67], v[96:99], v[48:51], v[64:67]
    v_mfma_f32_16x16x32_bf16 v[68:71], v[96:99], v[52:55], v[68:71]
    s_waitcnt lgkmcnt(0)
    s_barrier
    ds_read_b128 v[96:99], v126 offset:16384
    v_mfma_f32_16x16x32_bf16 v[72:75], v[100:103], v[48:51], v[72:75]
    v_mfma_f32_16x16x32_bf16 v[76:79], v[100:103], v[52:55], v[76:79]
    ds_read_b128 v[100:103], v126 offset:17408
    s_waitcnt vmcnt(0)
    v_mfma_f32_16x16x32_bf16 v[64:67], v[104:107], v[56:59], v[64:67]
    v_mfma_f32_16x16x32_bf16 v[68:71], v[104:107], v[60:63], v[68:71]
    ds_read_b128 v[104:107], v126 offset:18432
    v_mfma_f32_16x16x32_bf16 v[72:75], v[108:111], v[56:59], v[72:75]
    v_mfma_f32_16x16x32_bf16 v[76:79], v[108:111], v[60:63], v[76:79]
    ds_read_b128 v[108:111], v126 offset:19456
    s_mov_b32 s22, 4
L_joint_kernel_oloop:
    s_waitcnt lgkmcnt(3)
    v_mfma_f32_16x16x32_bf16 v[80:83], v[96:99], v[0:3], 0
    v_mfma_f32_16x16x32_bf16 v[84:87], v[96:99], v[4:7], 0
    ds_read_b128 v[96:99], v126 offset:20480
    s_waitcnt lgkmcnt(3)
    v_mfma_f32_16x16x32_bf16 v[88:91], v[100:103], v[0:3], 0
    v_mfma_f32_16x16x32_bf16 v[92:95], v[100:103], v[4:7], 0
    ds_read_b128 v[100:103], v126 offset:21504
    s_waitcnt lgkmcnt(3)
    v_mfma_f32_16x16x32_bf16 v[80:83], v[104:107], v[8:11], v[80:83]
    v_mfma_f32_16x16x32_bf16 v[84:87], v[104:107], v[12:15], v[84:87]
    ds_read_b128 v[104:107], v126 offset:22528
    s_waitcnt lgkmcnt(3)
    v_mfma_f32_16x16x32_bf16 v[88:91], v[108:111], v[8:11], v[88:91]
    v_cvt_pk_bf16_f32 v112, v64, v68
    v_mfma_f32_16x16x32_bf16 v[92:95], v[108:111], v[12:15], v[92:95]
    buffer_store_dword v112, v125, s[16:19], 0 offen offset:0 nt
    ds_read_b128 v[108:111], v126 offset:23552
    s_waitcnt lgkmcnt(3)
    v_mfma_f32_16x16x32_bf16 v[80:83], v[96:99], v[16:19], v[80:83]
    v_cvt_pk_bf16_f32 v113, v65, v69
    v_mfma_f32_16x16x32_bf16 v[84:87], v[96:99], v[20:23], v[84:87]
    buffer_store_dword v113, v125, s[16:19], 0 offen offset:512 nt
    ds_read_b128 v[96:99], v126 offset:24576
    s_waitcnt lgkmcnt(3)
    v_mfma_f32_16x16x32_bf16 v[88:91], v[100:103], v[16:19], v[88:91]
    v_cvt_pk_bf16_f32 v114, v66, v70
    v_mfma_f32_16x16x32_bf16 v[92:95], v[100:103], v[20:23], v[92:95]
    buffer_store_dword v114, v125, s[16:19], 0 offen offset:1024 nt
    ds_read_b128 v[100:103], v126 offset:25600
    s_waitcnt lgkmcnt(3)
    v_mfma_f32_16x16x32_bf16 v[80:83], v[104:107], v[24:27], v[80:83]
    v_cvt_pk_bf16_f32 v115, v67, v71
    v_mfma_f32_16x16x32_bf16 v[84:87], v[104:107], v[28:31], v[84:87]
    buffer_store_dword v115, v125, s[16:19], 0 offen offset:1536 nt
    ds_read_b128 v[104:107], v126 offset:26624
    s_waitcnt lgkmcnt(3)
    v_mfma_f32_16x16x32_bf16 v[88:91], v[108:111], v[24:27], v[88:91]
    v_cvt_pk_bf16_f32 v116, v72, v76
    v_mfma_f32_16x16x32_bf16 v[92:95], v[108:111], v[28:31], v[92:95]
    buffer_store_dword v116, v125, s[16:19], s44 offen offset:0 nt
    ds_read_b128 v[108:111], v126 offset:27648
    s_waitcnt lgkmcnt(3)
    v_mfma_f32_16x16x32_bf16 v[80:83], v[96:99], v[32:35], v[80:83]
    v_cvt_pk_bf16_f32 v117, v73, v77
    v_mfma_f32_16x16x32_bf16 v[84:87], v[96:99], v[36:39], v[84:87]
    buffer_store_dword v117, v125, s[16:19], s44 offen offset:512 nt
    ds_read_b128 v[96:99], v126 offset:28672
    s_waitcnt lgkmcnt(3)
    v_mfma_f32_16x16x32_bf16 v[88:91], v[100:103], v[32:35], v[88:91]
    v_cvt_pk_bf16_f32 v118, v74, v78
    v_mfma_f32_16x16x32_bf16 v[92:95], v[100:103], v[36:39], v[92:95]
    buffer_store_dword v118, v125, s[16:19], s44 offen offset:1024 nt
    ds_read_b128 v[100:103], v126 offset:29696
    s_waitcnt lgkmcnt(3)
    v_mfma_f32_16x16x32_bf16 v[80:83], v[104:107], v[40:43], v[80:83]
    v_cvt_pk_bf16_f32 v119, v75, v79
    v_mfma_f32_16x16x32_bf16 v[84:87], v[104:107], v[44:47], v[84:87]
    buffer_store_dword v119, v125, s[16:19], s44 offen offset:1536 nt
    ds_read_b128 v[104:107], v126 offset:30720
    s_waitcnt lgkmcnt(3)
    v_mfma_f32_16x16x32_bf16 v[88:91], v[108:111], v[40:43], v[88:91]
    v_add_u32 v125, 16384, v125
    v_mfma_f32_16x16x32_bf16 v[92:95], v[108:111], v[44:47], v[92:95]
    ds_read_b128 v[108:111], v126 offset:31744
    s_waitcnt lgkmcnt(3)
    v_mfma_f32_16x16x32_bf16 v[80:83], v[96:99], v[48:51], v[80:83]
    v_mfma_f32_16x16x32_bf16 v[84:87], v[96:99], v[52:55], v[84:87]
    s_waitcnt lgkmcnt(0)
    s_barrier
    ds_read_b128 v[96:99], v126 offset:0
    v_mfma_f32_16x16x32_bf16 v[88:91], v[100:103], v[48:51], v[88:91]
    v_mfma_f32_16x16x32_bf16 v[92:95], v[100:103], v[52:55], v[92:95]
    ds_read_b128 v[100:103], v126 offset:1024
    v_mfma_f32_16x16x32_bf16 v[80:83], v[104:107], v[56:59], v[80:83]
    v_mfma_f32_16x16x32_bf16 v[84:87], v[104:107], v[60:63], v[84:87]
    ds_read_b128 v[104:107], v126 offset:2048
    v_mfma_f32_16x16x32_bf16 v[88:91], v[108:111], v[56:59], v[88:91]
    v_mfma_f32_16x16x32_bf16 v[92:95], v[108:111], v[60:63], v[92:95]
    ds_read_b128 v[108:111], v126 offset:3072
    s_sub_u32 s22, s22, 1
    s_cmp_eq_u32 s22, 0
    s_cbranch_scc1 L_joint_kernel_oend
    s_waitcnt lgkmcnt(3)
    v_mfma_f32_16x16x32_bf16 v[64:67], v[96:99], v[0:3], 0
    v_mfma_f32_16x16x32_bf16 v[68:71], v[96:99], v[4:7], 0
    ds_read_b128 v[96:99], v126 offset:4096
    s_waitcnt lgkmcnt(3)
    v_mfma_f32_16x16x32_bf16 v[72:75], v[100:103], v[0:3], 0
    v_mfma_f32_16x16x32_bf16 v[76:79], v[100:103], v[4:7], 0
    ds_read_b128 v[100:103], v126 offset:5120
    s_waitcnt lgkmcnt(3)
    v_mfma_f32_16x16x32_bf16 v[64:67], v[104:107], v[8:11], v[64:67]
    v_mfma_f32_16x16x32_bf16 v[68:71], v[104:107], v[12:15], v[68:71]
    ds_read_b128 v[104:107], v126 offset:6144
    s_waitcnt lgkmcnt(3)
    v_mfma_f32_16x16x32_bf16 v[72:75], v[108:111], v[8:11], v[72:75]
    v_cvt_pk_bf16_f32 v112, v80, v84
    v_mfma_f32_16x16x32_bf16 v[76:79], v[108:111], v[12:15], v[76:79]
    buffer_store_dword v112, v125, s[16:19], 0 offen offset:0 nt
    ds_read_b128 v[108:111], v126 offset:7168
    s_waitcnt lgkmcnt(3)
    v_mfma_f32_16x16x32_bf16 v[64:67], v[96:99], v[16:19], v[64:67]
    v_cvt_pk_bf16_f32 v113, v81, v85
    v_mfma_f32_16x16x32_bf16 v[68:71], v[96:99], v[20:23], v[68:71]
    buffer_store_dword v113, v125, s[16:19], 0 offen offset:512 nt
    ds_read_b128 v[96:99], v126 offset:8192
    s_waitcnt lgkmcnt(3)
    v_mfma_f32_16x16x32_bf16 v[72:75], v[100:103], v[16:19], v[72:75]
    v_cvt_pk_bf16_f32 v114, v82, v86
    v_mfma_f32_16x16x32_bf16 v[76:79], v[100:103], v[20:23], v[76:79]
    buffer_store_dword v114, v125, s[16:19], 0 offen offset:1024 nt
    ds_read_b128 v[100:103], v126 offset:9216
    s_waitcnt lgkmcnt(3)
    v_mfma_f32_16x16x32_bf16 v[64:67], v[104:107], v[24:27], v[64:67]
    v_cvt_pk_bf16_f32 v115, v83, v87
    v_mfma_f32_16x16x32_bf16 v[68:71], v[104:107], v[28:31], v[68:71]
    buffer_store_dword v115, v125, s[16:19], 0 offen offset:1536 nt
    ds_read_b128 v[104:107], v126 offset:10240
    s_waitcnt lgkmcnt(3)
    v_mfma_f32_16x16x32_bf16 v[72:75], v[108:111], v[24:27], v[72:75]
    v_cvt_pk_bf16_f32 v116, v88, v92
    v_mfma_f32_16x16x32_bf16 v[76:79], v[108:111], v[28:31], v[76:79]
    buffer_store_dword v116, v125, s[16:19], s44 offen offset:0 nt
    ds_read_b128 v[108:111], v126 offset:11264
    s_waitcnt lgkmcnt(3)
    v_mfma_f32_16x16x32_bf16 v[64:67], v[96:99], v[32:35], v[64:67]
    v_cvt_pk_bf16_f32 v117, v89, v93
    v_mfma_f32_16x16x32_bf16 v[68:71], v[96:99], v[36:39], v[68:71]
    buffer_store_dword v117, v125, s[16:19], s44 offen offset:512 nt
    ds_read_b128 v[96:99], v126 offset:12288
    s_waitcnt lgkmcnt(3)
    v_mfma_f32_16x16x32_bf16 v[72:75], v[100:103], v[32:35], v[72:75]
    v_cvt_pk_bf16_f32 v118, v90, v94
    v_mfma_f32_16x16x32_bf16 v[76:79], v[100:103], v[36:39], v[76:79]
    buffer_store_dword v118, v125, s[16:19], s44 offen offset:1024 nt
    ds_read_b128 v[100:103], v126 offset:13312
    s_waitcnt lgkmcnt(3)
    v_mfma_f32_16x16x32_bf16 v[64:67], v[104:107], v[40:43], v[64:67]
    v_cvt_pk_bf16_f32 v119, v91, v95
    v_mfma_f32_16x16x32_bf16 v[68:71], v[104:107], v[44:47], v[68:71]
    buffer_store_dword v119, v125, s[16:19], s44 offen offset:1536 nt
    ds_read_b128 v[104:107], v126 offset:14336
    s_waitcnt lgkmcnt(3)
    v_mfma_f32_16x16x32_bf16 v[72:75], v[108:111], v[40:43], v[72:75]
    v_add_u32 v125, 16384, v125
    v_mfma_f32_16x16x32_bf16 v[76:79], v[108:111], v[44:47], v[76:79]
    ds_read_b128 v[108:111], v126 offset:15360
    s_waitcnt lgkmcnt(3)
    v_mfma_f32_16x16x32_bf16 v[64:67], v[96:99], v[48:51], v[64:67]
    v_mfma_f32_16x16x32_bf16 v[68:71], v[96:99], v[52:55], v[68:71]
    s_waitcnt lgkmcnt(0)
    s_barrier
    ds_read_b128 v[96:99], v126 offset:16384
    v_mfma_f32_16x16x32_bf16 v[72:75], v[100:103], v[48:51], v[72:75]
    v_mfma_f32_16x16x32_bf16 v[76:79], v[100:103], v[52:55], v[76:79]
    ds_read_b128 v[100:103], v126 offset:17408
    v_mfma_f32_16x16x32_bf16 v[64:67], v[104:107], v[56:59], v[64:67]
    v_mfma_f32_16x16x32_bf16 v[68:71], v[104:107], v[60:63], v[68:71]
    ds_read_b128 v[104:107], v126 offset:18432
    v_mfma_f32_16x16x32_bf16 v[72:75], v[108:111], v[56:59], v[72:75]
    v_mfma_f32_16x16x32_bf16 v[76:79], v[108:111], v[60:63], v[76:79]
    ds_read_b128 v[108:111], v126 offset:19456
    s_waitcnt vmcnt(32)
    s_branch L_joint_kernel_oloop
L_joint_kernel_oend:
    s_nop 7
    v_cvt_pk_bf16_f32 v112, v80, v84
    buffer_store_dword v112, v125, s[16:19], 0 offen offset:0 nt
    v_cvt_pk_bf16_f32 v113, v81, v85
    buffer_store_dword v113, v125, s[16:19], 0 offen offset:512 nt
    v_cvt_pk_bf16_f32 v114, v82, v86
    buffer_store_dword v114, v125, s[16:19], 0 offen offset:1024 nt
    v_cvt_pk_bf16_f32 v115, v83, v87
    buffer_store_dword v115, v125, s[16:19], 0 offen offset:1536 nt
    v_cvt_pk_bf16_f32 v116, v88, v92
    buffer_store_dword v116, v125, s[16:19], s44 offen offset:0 nt
    v_cvt_pk_bf16_f32 v117, v89, v93
    buffer_store_dword v117, v125, s[16:19], s44 offen offset:512 nt
    v_cvt_pk_bf16_f32 v118, v90, v94
    buffer_store_dword v118, v125, s[16:19], s44 offen offset:1024 nt
    v_cvt_pk_bf16_f32 v119, v91, v95
    buffer_store_dword v119, v125, s[16:19], s44 offen offset:1536 nt
    v_add_u32 v125, 16384, v125
    s_endpgm
L_joint_kernel_T:
    s_setprio 3
    s_waitcnt lgkmcnt(0)
    s_add_u32 s12, s30, s33
    s_addc_u32 s13, s31, 0
    s_add_u32 s40, s30, s34
    s_addc_u32 s41, s31, 0
    s_lshl_b32 s36, s21, 2
    s_add_u32 s36, s36, 44335104
    s_add_u32 s36, s30, s36
    s_addc_u32 s37, s31, 0
    s_load_dword s44, s[36:37], 0
    v_and_b32 v123, 15, v127
    v_lshrrev_b32 v121, 4, v127
    v_mul_u32_u24 v125, 528, v123
    v_lshl_add_u32 v125, v121, 4, v125
    v_lshlrev_b32 v121, 5, v121
    v_and_b32 v120, 7, v127
    v_lshl_add_u32 v124, v120, 10, v121
    s_lshl_b32 s38, s21, 7
    v_mul_u32_u24 v120, 1040, v120
    s_add_u32 s36, s38, 91136
    v_add3_u32 v120, v120, v121, s36
    s_mul_i32 s36, s21, 5184
    s_add_u32 s36, s36, 49664
    v_add_u32 v121, s36, v121
    v_mul_u32_u24 v122, 144, v123
    v_add_u32 v122, v122, v121
    v_lshrrev_b32 v123, 3, v123
    v_mul_u32_u24 v123, 144, v123
    v_add_u32 v121, v123, v121
    s_lshl_b32 s36, s21, 11
    v_add_u32 v123, s36, v126
    s_barrier
    s_mov_b32 s36, 0
    buffer_load_dwordx4 v[0:3], v126, s[12:15], s36 offen offset:0
    buffer_load_dwordx4 v[4:7], v126, s[12:15], s36 offen offset:1024
    buffer_load_dwordx4 v[8:11], v126, s[12:15], s36 offen offset:2048
    buffer_load_dwordx4 v[12:15], v126, s[12:15], s36 offen offset:3072
    s_mov_b32 s36, 4096
    buffer_load_dwordx4 v[16:19], v126, s[12:15], s36 offen offset:0
    buffer_load_dwordx4 v[20:23], v126, s[12:15], s36 offen offset:1024
    buffer_load_dwordx4 v[24:27], v126, s[12:15], s36 offen offset:2048
    buffer_load_dwordx4 v[28:31], v126, s[12:15], s36 offen offset:3072
    s_mov_b32 s36, 8192
    buffer_load_dwordx4 v[32:35], v126, s[12:15], s36 offen offset:0
    buffer_load_dwordx4 v[36:39], v126, s[12:15], s36 offen offset:1024
    buffer_load_dwordx4 v[40:43], v126, s[12:15], s36 offen offset:2048
    buffer_load_dwordx4 v[44:47], v126, s[12:15], s36 offen offset:3072
    s_mov_b32 s36, 12288
    buffer_load_dwordx4 v[48:51], v126, s[12:15], s36 offen offset:0
    buffer_load_dwordx4 v[52:55], v126, s[12:15], s36 offen offset:1024
    buffer_load_dwordx4 v[56:59], v126, s[12:15], s36 offen offset:2048
    buffer_load_dwordx4 v[60:63], v126, s[12:15], s36 offen offset:3072
    v_mov_b32 v64, 99456
    v_mov_b32 v65, 1
    s_mov_b64 exec, 1
    ds_add_u32 v64, v65 offset:4
    s_mov_b64 exec, -1
L_joint_kernel_tw:
    ds_read_b32 v65, v64 offset:0
    s_waitcnt lgkmcnt(0)
    v_readfirstlane_b32 s37, v65
    s_cmp_ge_u32 s37, 8
    s_cbranch_scc1 L_joint_kernel_tw_d
    s_sleep 1
    s_branch L_joint_kernel_tw
L_joint_kernel_tw_d:
    ds_read_b128 v[80:83], v125 offset:32768
    ds_read_b128 v[84:87], v125 offset:41216
    ds_read_b128 v[88:91], v125 offset:32832
    ds_read_b128 v[92:95], v125 offset:41280
    ds_read_b128 v[96:99], v125 offset:32896
    ds_read_b128 v[100:103], v125 offset:41344
    ds_read_b128 v[104:107], v125 offset:32960
    ds_read_b128 v[108:111], v125 offset:41408
    s_setprio 0
    s_waitcnt vmcnt(14) lgkmcnt(7)
    v_mfma_f32_16x16x32_bf16 v[64:67], v[0:3], v[80:83], 0
    v_mfma_f32_16x16x32_bf16 v[68:71], v[4:7], v[80:83], 0
    ds_read_b128 v[80:83], v125 offset:33024
    s_waitcnt lgkmcnt(7)
    v_mfma_f32_16x16x32_bf16 v[72:75], v[0:3], v[84:87], 0
    v_mfma_f32_16x16x32_bf16 v[76:79], v[4:7], v[84:87], 0
    ds_read_b128 v[84:87], v125 offset:41472
    s_waitcnt vmcnt(12) lgkmcnt(7)
    v_mfma_f32_16x16x32_bf16 v[64:67], v[8:11], v[88:91], v[64:67]
    v_mfma_f32_16x16x32_bf16 v[68:71], v[12:15], v[88:91], v[68:71]
    ds_read_b128 v[88:91], v125 offset:33088
    s_waitcnt lgkmcnt(7)
    v_mfma_f32_16x16x32_bf16 v[72:75], v[8:11], v[92:95], v[72:75]
    v_mfma_f32_16x16x32_bf16 v[76:79], v[12:15], v[92:95], v[76:79]
    ds_read_b128 v[92:95], v125 offset:41536
    s_waitcnt vmcnt(10) lgkmcnt(7)
    v_mfma_f32_16x16x32_bf16 v[64:67], v[16:19], v[96:99], v[64:67]
    v_mfma_f32_16x16x32_bf16 v[68:71], v[20:23], v[96:99], v[68:71]
    ds_read_b128 v[96:99], v125 offset:33152
    s_waitcnt lgkmcnt(7)
    v_mfma_f32_16x16x32_bf16 v[72:75], v[16:19], v[100:103], v[72:75]
    v_mfma_f32_16x16x32_bf16 v[76:79], v[20:23], v[100:103], v[76:79]
    ds_read_b128 v[100:103], v125 offset:41600
    s_waitcnt vmcnt(8) lgkmcnt(7)
    v_mfma_f32_16x16x32_bf16 v[64:67], v[24:27], v[104:107], v[64:67]
    v_mfma_f32_16x16x32_bf16 v[68:71], v[28:31], v[104:107], v[68:71]
    ds_read_b128 v[104:107], v125 offset:33216
    s_waitcnt lgkmcnt(7)
    v_mfma_f32_16x16x32_bf16 v[72:75], v[24:27], v[108:111], v[72:75]
    v_mfma_f32_16x16x32_bf16 v[76:79], v[28:31], v[108:111], v[76:79]
    ds_read_b128 v[108:111], v125 offset:41664
    s_waitcnt vmcnt(6) lgkmcnt(7)
    v_mfma_f32_16x16x32_bf16 v[64:67], v[32:35], v[80:83], v[64:67]
    v_mfma_f32_16x16x32_bf16 v[68:71], v[36:39], v[80:83], v[68:71]
    ds_read_b128 v[112:115], v120 offset:0
    s_waitcnt lgkmcnt(7)
    v_mfma_f32_16x16x32_bf16 v[72:75], v[32:35], v[84:87], v[72:75]
    v_mfma_f32_16x16x32_bf16 v[76:79], v[36:39], v[84:87], v[76:79]
    ds_read_b128 v[116:119], v120 offset:16
    s_waitcnt vmcnt(4) lgkmcnt(7)
    v_mfma_f32_16x16x32_bf16 v[64:67], v[40:43], v[88:91], v[64:67]
    v_mfma_f32_16x16x32_bf16 v[68:71], v[44:47], v[88:91], v[68:71]
    s_waitcnt lgkmcnt(6)
    v_mfma_f32_16x16x32_bf16 v[72:75], v[40:43], v[92:95], v[72:75]
    v_mfma_f32_16x16x32_bf16 v[76:79], v[44:47], v[92:95], v[76:79]
    s_waitcnt vmcnt(2) lgkmcnt(5)
    v_mfma_f32_16x16x32_bf16 v[64:67], v[48:51], v[96:99], v[64:67]
    v_mfma_f32_16x16x32_bf16 v[68:71], v[52:55], v[96:99], v[68:71]
    s_waitcnt lgkmcnt(4)
    v_mfma_f32_16x16x32_bf16 v[72:75], v[48:51], v[100:103], v[72:75]
    v_mfma_f32_16x16x32_bf16 v[76:79], v[52:55], v[100:103], v[76:79]
    s_waitcnt vmcnt(0) lgkmcnt(3)
    v_mfma_f32_16x16x32_bf16 v[64:67], v[56:59], v[104:107], v[64:67]
    v_mfma_f32_16x16x32_bf16 v[68:71], v[60:63], v[104:107], v[68:71]
    s_waitcnt lgkmcnt(2)
    v_mfma_f32_16x16x32_bf16 v[72:75], v[56:59], v[108:111], v[72:75]
    v_mfma_f32_16x16x32_bf16 v[76:79], v[60:63], v[108:111], v[76:79]
    s_mov_b32 s46, 0xffff0000
    s_mov_b32 s48, 0x4038aa3b
    s_mov_b32 s49, s48
    s_nop 3
    v_mov_b32 v28, 0
    s_waitcnt lgkmcnt(0)
    v_cvt_pk_bf16_f32 v24, v64, v68
    v_cvt_pk_bf16_f32 v25, v65, v69
    v_cvt_pk_bf16_f32 v26, v66, v70
    v_cvt_pk_bf16_f32 v27, v67, v71
    v_lshlrev_b32 v80, 16, v24
    v_and_b32 v81, s46, v24
    v_lshlrev_b32 v82, 16, v25
    v_and_b32 v83, s46, v25
    v_lshlrev_b32 v84, 16, v26
    v_and_b32 v85, s46, v26
    v_lshlrev_b32 v86, 16, v27
    v_and_b32 v87, s46, v27
    v_pk_mul_f32 v[80:81], v[80:81], s[48:49]
    v_pk_mul_f32 v[82:83], v[82:83], s[48:49]
    v_pk_mul_f32 v[84:85], v[84:85], s[48:49]
    v_pk_mul_f32 v[86:87], v[86:87], s[48:49]
    v_exp_f32 v96, v80
    v_exp_f32 v97, v81
    v_exp_f32 v98, v82
    v_exp_f32 v99, v83
    v_max3_f32 v28, |v80|, |v81|, v28
    v_max3_f32 v28, |v82|, |v83|, v28
    ds_write_b128 v122, v[96:99] offset:0
    v_exp_f32 v100, v84
    v_exp_f32 v101, v85
    v_exp_f32 v102, v86
    v_exp_f32 v103, v87
    v_max3_f32 v28, |v84|, |v85|, v28
    v_max3_f32 v28, |v86|, |v87|, v28
    ds_write_b128 v122, v[100:103] offset:16
    v_cvt_pk_bf16_f32 v24, v72, v76
    v_cvt_pk_bf16_f32 v25, v73, v77
    v_cvt_pk_bf16_f32 v26, v74, v78
    v_cvt_pk_bf16_f32 v27, v75, v79
    v_lshlrev_b32 v88, 16, v24
    v_and_b32 v89, s46, v24
    v_lshlrev_b32 v90, 16, v25
    v_and_b32 v91, s46, v25
    v_lshlrev_b32 v92, 16, v26
    v_and_b32 v93, s46, v26
    v_lshlrev_b32 v94, 16, v27
    v_and_b32 v95, s46, v27
    v_pk_mul_f32 v[88:89], v[88:89], s[48:49]
    v_pk_mul_f32 v[90:91], v[90:91], s[48:49]
    v_pk_mul_f32 v[92:93], v[92:93], s[48:49]
    v_pk_mul_f32 v[94:95], v[94:95], s[48:49]
    v_exp_f32 v104, v88
    v_exp_f32 v105, v89
    v_exp_f32 v106, v90
    v_exp_f32 v107, v91
    v_max3_f32 v28, |v88|, |v89|, v28
    v_max3_f32 v28, |v90|, |v91|, v28
    ds_write_b128 v122, v[104:107] offset:2304
    v_exp_f32 v108, v92
    v_exp_f32 v109, v93
    v_exp_f32 v110, v94
    v_exp_f32 v111, v95
    v_max3_f32 v28, |v92|, |v93|, v28
    v_max3_f32 v28, |v94|, |v95|, v28
    ds_write_b128 v122, v[108:111] offset:2320
    v_cmp_lt_f32 vcc, 0x42f00000, v28
    s_mov_b32 s22, 4
    s_or_b32 s44, s44, vcc_lo
    s_or_b32 s44, s44, vcc_hi
    s_cmp_lg_u32 s44, 0
    s_cbranch_scc1 L_joint_kernel_tslow
    ds_read_b128 v[32:35], v121 offset:0
    ds_read_b128 v[36:39], v121 offset:16
    ds_read_b128 v[40:43], v121 offset:288
    ds_read_b128 v[44:47], v121 offset:304
    v_add_u32 v121, 576, v121
    s_waitcnt vmcnt(0) lgkmcnt(0)
L_joint_kernel_tloop1:
    v_fma_f32 v48, v112, v32, 1.0
    v_fma_f32 v49, v113, v33, 1.0
    v_fma_f32 v50, v114, v34, 1.0
    v_fma_f32 v51, v115, v35, 1.0
    v_fma_f32 v52, v116, v36, 1.0
    v_fma_f32 v53, v117, v37, 1.0
    v_fma_f32 v54, v118, v38, 1.0
    v_fma_f32 v55, v119, v39, 1.0
    v_fma_f32 v56, v112, v40, 1.0
    v_fma_f32 v57, v113, v41, 1.0
    v_fma_f32 v58, v114, v42, 1.0
    v_fma_f32 v59, v115, v43, 1.0
    v_fma_f32 v60, v116, v44, 1.0
    v_fma_f32 v61, v117, v45, 1.0
    v_fma_f32 v62, v118, v46, 1.0
    v_fma_f32 v63, v119, v47, 1.0
    ds_read_b128 v[32:35], v121 offset:0
    ds_read_b128 v[36:39], v121 offset:16
    ds_read_b128 v[40:43], v121 offset:288
    ds_read_b128 v[44:47], v121 offset:304
    v_add_u32 v121, 576, v121
    v_rcp_f32 v48, v48
    v_rcp_f32 v49, v49
    v_rcp_f32 v50, v50
    v_rcp_f32 v51, v51
    v_rcp_f32 v52, v52
    v_rcp_f32 v53, v53
    v_rcp_f32 v54, v54
    v_rcp_f32 v55, v55
    v_fma_f32 v48, v48, -2.0, 1.0
    v_fma_f32 v49, v49, -2.0, 1.0
    v_fma_f32 v50, v50, -2.0, 1.0
    v_fma_f32 v51, v51, -2.0, 1.0
    v_fma_f32 v52, v52, -2.0, 1.0
    v_fma_f32 v53, v53, -2.0, 1.0
    v_fma_f32 v54, v54, -2.0, 1.0
    v_fma_f32 v55, v55, -2.0, 1.0
    v_cvt_pk_bf16_f32 v64, v48, v49
    v_cvt_pk_bf16_f32 v65, v50, v51
    v_cvt_pk_bf16_f32 v66, v52, v53
    v_cvt_pk_bf16_f32 v67, v54, v55
    ds_write_b128 v123, v[64:67] offset:0
    v_rcp_f32 v56, v56
    v_rcp_f32 v57, v57
    v_rcp_f32 v58, v58
    v_rcp_f32 v59, v59
    v_rcp_f32 v60, v60
    v_rcp_f32 v61, v61
    v_rcp_f32 v62, v62
    v_rcp_f32 v63, v63
    v_fma_f32 v56, v56, -2.0, 1.0
    v_fma_f32 v57, v57, -2.0, 1.0
    v_fma_f32 v58, v58, -2.0, 1.0
    v_fma_f32 v59, v59, -2.0, 1.0
    v_fma_f32 v60, v60, -2.0, 1.0
    v_fma_f32 v61, v61, -2.0, 1.0
    v_fma_f32 v62, v62, -2.0, 1.0
    v_fma_f32 v63, v63, -2.0, 1.0
    v_cvt_pk_bf16_f32 v68, v56, v57
    v_cvt_pk_bf16_f32 v69, v58, v59
    v_cvt_pk_bf16_f32 v70, v60, v61
    v_cvt_pk_bf16_f32 v71, v62, v63
    ds_write_b128 v123, v[68:71] offset:1024
    s_waitcnt lgkmcnt(0)
    s_barrier
    v_fma_f32 v48, v112, v32, 1.0
    v_fma_f32 v49, v113, v33, 1.0
    v_fma_f32 v50, v114, v34, 1.0
    v_fma_f32 v51, v115, v35, 1.0
    v_fma_f32 v52, v116, v36, 1.0
    v_fma_f32 v53, v117, v37, 1.0
    v_fma_f32 v54, v118, v38, 1.0
    v_fma_f32 v55, v119, v39, 1.0
    v_fma_f32 v56, v112, v40, 1.0
    v_fma_f32 v57, v113, v41, 1.0
    v_fma_f32 v58, v114, v42, 1.0
    v_fma_f32 v59, v115, v43, 1.0
    v_fma_f32 v60, v116, v44, 1.0
    v_fma_f32 v61, v117, v45, 1.0
    v_fma_f32 v62, v118, v46, 1.0
    v_fma_f32 v63, v119, v47, 1.0
    ds_read_b128 v[32:35], v121 offset:0
    ds_read_b128 v[36:39], v121 offset:16
    ds_read_b128 v[40:43], v121 offset:288
    ds_read_b128 v[44:47], v121 offset:304
    v_add_u32 v121, 576, v121
    v_rcp_f32 v48, v48
    v_rcp_f32 v49, v49
    v_rcp_f32 v50, v50
    v_rcp_f32 v51, v51
    v_rcp_f32 v52, v52
    v_rcp_f32 v53, v53
    v_rcp_f32 v54, v54
    v_rcp_f32 v55, v55
    v_fma_f32 v48, v48, -2.0, 1.0
    v_fma_f32 v49, v49, -2.0, 1.0
    v_fma_f32 v50, v50, -2.0, 1.0
    v_fma_f32 v51, v51, -2.0, 1.0
    v_fma_f32 v52, v52, -2.0, 1.0
    v_fma_f32 v53, v53, -2.0, 1.0
    v_fma_f32 v54, v54, -2.0, 1.0
    v_fma_f32 v55, v55, -2.0, 1.0
    v_cvt_pk_bf16_f32 v64, v48, v49
    v_cvt_pk_bf16_f32 v65, v50, v51
    v_cvt_pk_bf16_f32 v66, v52, v53
    v_cvt_pk_bf16_f32 v67, v54, v55
    ds_write_b128 v123, v[64:67] offset:16384
    v_rcp_f32 v56, v56
    v_rcp_f32 v57, v57
    v_rcp_f32 v58, v58
    v_rcp_f32 v59, v59
    v_rcp_f32 v60, v60
    v_rcp_f32 v61, v61
    v_rcp_f32 v62, v62
    v_rcp_f32 v63, v63
    v_fma_f32 v56, v56, -2.0, 1.0
    v_fma_f32 v57, v57, -2.0, 1.0
    v_fma_f32 v58, v58, -2.0, 1.0
    v_fma_f32 v59, v59, -2.0, 1.0
    v_fma_f32 v60, v60, -2.0, 1.0
    v_fma_f32 v61, v61, -2.0, 1.0
    v_fma_f32 v62, v62, -2.0, 1.0
    v_fma_f32 v63, v63, -2.0, 1.0
    v_cvt_pk_bf16_f32 v68, v56, v57
    v_cvt_pk_bf16_f32 v69, v58, v59
    v_cvt_pk_bf16_f32 v70, v60, v61
    v_cvt_pk_bf16_f32 v71, v62, v63
    ds_write_b128 v123, v[68:71] offset:17408
    s_waitcnt lgkmcnt(0)
    s_barrier
    s_sub_u32 s22, s22, 1
    s_cmp_lg_u32 s22, 0
    s_cbranch_scc1 L_joint_kernel_tloop1
    s_endpgm
L_joint_kernel_tslow:
    buffer_load_dwordx4 v[112:115], v124, s[40:43], s38 offen offset:0
    buffer_load_dwordx4 v[116:119], v124, s[40:43], s38 offen offset:16
    ds_write_b128 v122, v[80:83] offset:0
    ds_write_b128 v122, v[84:87] offset:16
    ds_write_b128 v122, v[88:91] offset:2304
    ds_write_b128 v122, v[92:95] offset:2320
    ds_read_b128 v[32:35], v121 offset:0
    ds_read_b128 v[36:39], v121 offset:16
    ds_read_b128 v[40:43], v121 offset:288
    ds_read_b128 v[44:47], v121 offset:304
    v_add_u32 v121, 576, v121
    s_waitcnt vmcnt(0) lgkmcnt(0)
L_joint_kernel_tloop0:
    v_add_f32 v48, v112, v32
    v_add_f32 v49, v113, v33
    v_add_f32 v50, v114, v34
    v_add_f32 v51, v115, v35
    v_add_f32 v52, v116, v36
    v_add_f32 v53, v117, v37
    v_add_f32 v54, v118, v38
    v_add_f32 v55, v119, v39
    v_add_f32 v56, v112, v40
    v_add_f32 v57, v113, v41
    v_add_f32 v58, v114, v42
    v_add_f32 v59, v115, v43
    v_add_f32 v60, v116, v44
    v_add_f32 v61, v117, v45
    v_add_f32 v62, v118, v46
    v_add_f32 v63, v119, v47
    ds_read_b128 v[32:35], v121 offset:0
    ds_read_b128 v[36:39], v121 offset:16
    ds_read_b128 v[40:43], v121 offset:288
    ds_read_b128 v[44:47], v121 offset:304
    v_add_u32 v121, 576, v121
    v_exp_f32 v48, v48
    v_exp_f32 v49, v49
    v_exp_f32 v50, v50
    v_exp_f32 v51, v51
    v_exp_f32 v52, v52
    v_exp_f32 v53, v53
    v_exp_f32 v54, v54
    v_exp_f32 v55, v55
    v_add_f32 v48, 1.0, v48
    v_add_f32 v49, 1.0, v49
    v_add_f32 v50, 1.0, v50
    v_add_f32 v51, 1.0, v51
    v_add_f32 v52, 1.0, v52
    v_add_f32 v53, 1.0, v53
    v_add_f32 v54, 1.0, v54
    v_add_f32 v55, 1.0, v55
    v_rcp_f32 v48, v48
    v_rcp_f32 v49, v49
    v_rcp_f32 v50, v50
    v_rcp_f32 v51, v51
    v_rcp_f32 v52, v52
    v_rcp_f32 v53, v53
    v_rcp_f32 v54, v54
    v_rcp_f32 v55, v55
    v_fma_f32 v48, v48, -2.0, 1.0
    v_fma_f32 v49, v49, -2.0, 1.0
    v_fma_f32 v50, v50, -2.0, 1.0
    v_fma_f32 v51, v51, -2.0, 1.0
    v_fma_f32 v52, v52, -2.0, 1.0
    v_fma_f32 v53, v53, -2.0, 1.0
    v_fma_f32 v54, v54, -2.0, 1.0
    v_fma_f32 v55, v55, -2.0, 1.0
    v_cvt_pk_bf16_f32 v64, v48, v49
    v_cvt_pk_bf16_f32 v65, v50, v51
    v_cvt_pk_bf16_f32 v66, v52, v53
    v_cvt_pk_bf16_f32 v67, v54, v55
    ds_write_b128 v123, v[64:67] offset:0
    v_exp_f32 v56, v56
    v_exp_f32 v57, v57
    v_exp_f32 v58, v58
    v_exp_f32 v59, v59
    v_exp_f32 v60, v60
    v_exp_f32 v61, v61
    v_exp_f32 v62, v62
    v_exp_f32 v63, v63
    v_add_f32 v56, 1.0, v56
    v_add_f32 v57, 1.0, v57
    v_add_f32 v58, 1.0, v58
    v_add_f32 v59, 1.0, v59
    v_add_f32 v60, 1.0, v60
    v_add_f32 v61, 1.0, v61
    v_add_f32 v62, 1.0, v62
    v_add_f32 v63, 1.0, v63
    v_rcp_f32 v56, v56
    v_rcp_f32 v57, v57
    v_rcp_f32 v58, v58
    v_rcp_f32 v59, v59
    v_rcp_f32 v60, v60
    v_rcp_f32 v61, v61
    v_rcp_f32 v62, v62
    v_rcp_f32 v63, v63
    v_fma_f32 v56, v56, -2.0, 1.0
    v_fma_f32 v57, v57, -2.0, 1.0
    v_fma_f32 v58, v58, -2.0, 1.0
    v_fma_f32 v59, v59, -2.0, 1.0
    v_fma_f32 v60, v60, -2.0, 1.0
    v_fma_f32 v61, v61, -2.0, 1.0
    v_fma_f32 v62, v62, -2.0, 1.0
    v_fma_f32 v63, v63, -2.0, 1.0
    v_cvt_pk_bf16_f32 v68, v56, v57
    v_cvt_pk_bf16_f32 v69, v58, v59
    v_cvt_pk_bf16_f32 v70, v60, v61
    v_cvt_pk_bf16_f32 v71, v62, v63
    ds_write_b128 v123, v[68:71] offset:1024
    s_waitcnt lgkmcnt(0)
    s_barrier
    v_add_f32 v48, v112, v32
    v_add_f32 v49, v113, v33
    v_add_f32 v50, v114, v34
    v_add_f32 v51, v115, v35
    v_add_f32 v52, v116, v36
    v_add_f32 v53, v117, v37
    v_add_f32 v54, v118, v38
    v_add_f32 v55, v119, v39
    v_add_f32 v56, v112, v40
    v_add_f32 v57, v113, v41
    v_add_f32 v58, v114, v42
    v_add_f32 v59, v115, v43
    v_add_f32 v60, v116, v44
    v_add_f32 v61, v117, v45
    v_add_f32 v62, v118, v46
    v_add_f32 v63, v119, v47
    ds_read_b128 v[32:35], v121 offset:0
    ds_read_b128 v[36:39], v121 offset:16
    ds_read_b128 v[40:43], v121 offset:288
    ds_read_b128 v[44:47], v121 offset:304
    v_add_u32 v121, 576, v121
    v_exp_f32 v48, v48
    v_exp_f32 v49, v49
    v_exp_f32 v50, v50
    v_exp_f32 v51, v51
    v_exp_f32 v52, v52
    v_exp_f32 v53, v53
    v_exp_f32 v54, v54
    v_exp_f32 v55, v55
    v_add_f32 v48, 1.0, v48
    v_add_f32 v49, 1.0, v49
    v_add_f32 v50, 1.0, v50
    v_add_f32 v51, 1.0, v51
    v_add_f32 v52, 1.0, v52
    v_add_f32 v53, 1.0, v53
    v_add_f32 v54, 1.0, v54
    v_add_f32 v55, 1.0, v55
    v_rcp_f32 v48, v48
    v_rcp_f32 v49, v49
    v_rcp_f32 v50, v50
    v_rcp_f32 v51, v51
    v_rcp_f32 v52, v52
    v_rcp_f32 v53, v53
    v_rcp_f32 v54, v54
    v_rcp_f32 v55, v55
    v_fma_f32 v48, v48, -2.0, 1.0
    v_fma_f32 v49, v49, -2.0, 1.0
    v_fma_f32 v50, v50, -2.0, 1.0
    v_fma_f32 v51, v51, -2.0, 1.0
    v_fma_f32 v52, v52, -2.0, 1.0
    v_fma_f32 v53, v53, -2.0, 1.0
    v_fma_f32 v54, v54, -2.0, 1.0
    v_fma_f32 v55, v55, -2.0, 1.0
    v_cvt_pk_bf16_f32 v64, v48, v49
    v_cvt_pk_bf16_f32 v65, v50, v51
    v_cvt_pk_bf16_f32 v66, v52, v53
    v_cvt_pk_bf16_f32 v67, v54, v55
    ds_write_b128 v123, v[64:67] offset:16384
    v_exp_f32 v56, v56
    v_exp_f32 v57, v57
    v_exp_f32 v58, v58
    v_exp_f32 v59, v59
    v_exp_f32 v60, v60
    v_exp_f32 v61, v61
    v_exp_f32 v62, v62
    v_exp_f32 v63, v63
    v_add_f32 v56, 1.0, v56
    v_add_f32 v57, 1.0, v57
    v_add_f32 v58, 1.0, v58
    v_add_f32 v59, 1.0, v59
    v_add_f32 v60, 1.0, v60
    v_add_f32 v61, 1.0, v61
    v_add_f32 v62, 1.0, v62
    v_add_f32 v63, 1.0, v63
    v_rcp_f32 v56, v56
    v_rcp_f32 v57, v57
    v_rcp_f32 v58, v58
    v_rcp_f32 v59, v59
    v_rcp_f32 v60, v60
    v_rcp_f32 v61, v61
    v_rcp_f32 v62, v62
    v_rcp_f32 v63, v63
    v_fma_f32 v56, v56, -2.0, 1.0
    v_fma_f32 v57, v57, -2.0, 1.0
    v_fma_f32 v58, v58, -2.0, 1.0
    v_fma_f32 v59, v59, -2.0, 1.0
    v_fma_f32 v60, v60, -2.0, 1.0
    v_fma_f32 v61, v61, -2.0, 1.0
    v_fma_f32 v62, v62, -2.0, 1.0
    v_fma_f32 v63, v63, -2.0, 1.0
    v_cvt_pk_bf16_f32 v68, v56, v57
    v_cvt_pk_bf16_f32 v69, v58, v59
    v_cvt_pk_bf16_f32 v70, v60, v61
    v_cvt_pk_bf16_f32 v71, v62, v63
    ds_write_b128 v123, v[68:71] offset:17408
    s_waitcnt lgkmcnt(0)
    s_barrier
    s_sub_u32 s22, s22, 1
    s_cmp_lg_u32 s22, 0
    s_cbranch_scc1 L_joint_kernel_tloop0
L_joint_kernel_fin:
L_joint_kernel_done:
    s_endpgm
.section .rodata,"a"
.p2align 6
.amdhsa_kernel prep_kernel
  .amdhsa_next_free_vgpr 128
  .amdhsa_next_free_sgpr 102
  .amdhsa_accum_offset 128
  .amdhsa_group_segment_fixed_size 0
  .amdhsa_kernarg_size 80
  .amdhsa_user_sgpr_count 2
  .amdhsa_user_sgpr_kernarg_segment_ptr 1
  .amdhsa_system_sgpr_workgroup_id_x 1
.end_amdhsa_kernel
.p2align 6
.amdhsa_kernel conv1_kernel
  .amdhsa_next_free_vgpr 128
  .amdhsa_next_free_sgpr 102
  .amdhsa_accum_offset 128
  .amdhsa_group_segment_fixed_size 0
  .amdhsa_kernarg_size 80
  .amdhsa_user_sgpr_count 2
  .amdhsa_user_sgpr_kernarg_segment_ptr 1
  .amdhsa_system_sgpr_workgroup_id_x 1
.end_amdhsa_kernel
.p2align 6
.amdhsa_kernel conv2_kernel
  .amdhsa_next_free_vgpr 128
  .amdhsa_next_free_sgpr 102
  .amdhsa_accum_offset 128
  .amdhsa_group_segment_fixed_size 0
  .amdhsa_kernarg_size 80
  .amdhsa_user_sgpr_count 2
  .amdhsa_user_sgpr_kernarg_segment_ptr 1
  .amdhsa_system_sgpr_workgroup_id_x 1
.end_amdhsa_kernel
.p2align 6
.amdhsa_kernel joint_kernel
  .amdhsa_next_free_vgpr 128
  .amdhsa_next_free_sgpr 102
  .amdhsa_accum_offset 128
  .amdhsa_group_segment_fixed_size 0
  .amdhsa_kernarg_size 80
  .amdhsa_user_sgpr_count 2
  .amdhsa_user_sgpr_kernarg_segment_ptr 1
  .amdhsa_system_sgpr_workgroup_id_x 1
.end_amdhsa_kernel
```
